```python
import torch

def _softmax(x, axis=-1):
    return torch.softmax(x, dim=axis)

def _gelu(x):
    return torch.nn.functional.gelu(x, approximate='tanh')

def _silu(x):
    return torch.nn.functional.silu(x)

def _sigmoid(x):
    return torch.sigmoid(x)

def _layernorm(x, axis=-1, eps=1e-05):
    m = x.mean(dim=axis, keepdim=True)
    v = x.var(dim=axis, keepdim=True, unbiased=False)
    return (x - m) / torch.sqrt(v + eps)

def _scatter_add(tgt, idx, src, axis=0):
    return tgt.clone().index_add_(axis, idx, src)

def _segment_sum(src, seg, n):
    out = torch.zeros((n,) + src.shape[1:], dtype=src.dtype)
    return out.index_add_(0, seg, src)

def _pad(x, pw):
    flat = tuple((v for pair in reversed(pw) for v in pair))
    return torch.nn.functional.pad(x, flat)
kernel_name = 'adaLN_cond__memory_aug_recurrent_mem_tr__mixer_s_mlp__prompt'

def setup_inputs():

    _w = lambda a: (lambda t: t.to(torch.bfloat16) if t.is_floating_point() else t)(torch.as_tensor(a))

    def _A_setup():
        B, S, Dm = (1, 2048, 1024)
        H, Dh = (32, 128)
        M, seg = (8, 32)
        seg = min(seg, S)
        S = S // seg * seg
        return {'x': _w((lambda *s: torch.randn(*s, dtype=torch.bfloat16) * 0.05)(B, S, Dm)), 'mem0': _w((lambda *s: torch.randn(*s, dtype=torch.bfloat16) * 0.4)(B, M, Dm)), 'Wq': _w((lambda *s: torch.randn(*s, dtype=torch.bfloat16) * 3.2)(Dm, H, Dh) * Dm ** (-0.5)), 'Wk': _w((lambda *s: torch.randn(*s, dtype=torch.bfloat16) * 3.2)(Dm, H, Dh) * Dm ** (-0.5)), 'Wv': _w((lambda *s: torch.randn(*s, dtype=torch.bfloat16) * 0.4)(Dm, H, Dh) * Dm ** (-0.5)), 'Wo': _w((lambda *s: torch.randn(*s, dtype=torch.bfloat16) * 0.4)(H, Dh, Dm) * (H * Dh) ** (-0.5)), 'seg_len': seg}
    _A_in = _A_setup()

    def _B_setup():
        B, S, D, F = (1, 2048, 1024, 3584)
        return {'x': _w((lambda *s: torch.randn(*s, dtype=torch.bfloat16) * 0.05)(B, S, D)), 'w1': _w((lambda *s: torch.randn(*s, dtype=torch.bfloat16) * 3.2)(D, D) * D ** (-0.5)), 'w2': _w((lambda *s: torch.randn(*s, dtype=torch.bfloat16) * 3.2)(D, D) * D ** (-0.5)), 'w3': _w((lambda *s: torch.randn(*s, dtype=torch.bfloat16) * 3.2)(D, F) * D ** (-0.5)), 'w4': _w((lambda *s: torch.randn(*s, dtype=torch.bfloat16) * 3.2)(F, D) * F ** (-0.5))}
    _B_in = _B_setup()
    return {'A_x': _A_in['x'], 'A_mem0': _A_in['mem0'], 'A_Wq': _A_in['Wq'], 'A_Wk': _A_in['Wk'], 'A_Wv': _A_in['Wv'], 'A_Wo': _A_in['Wo'], 'A_seg_len': _A_in['seg_len'], 'B_x': _B_in['x'], 'B_w1': _B_in['w1'], 'B_w2': _B_in['w2'], 'B_w3': _B_in['w3'], 'B_w4': _B_in['w4'], 'c': _w((lambda *s: torch.randn(*s, dtype=torch.bfloat16) * 0.1)(1, 1024) * 8.0), 'w_mod': _w((lambda *s: torch.randn(*s, dtype=torch.bfloat16) * 0.1)(1024, 6 * 1024) * 1024 ** (-0.5) * 8.0)}

def reference(A_x, A_mem0, A_Wq, A_Wk, A_Wv, A_Wo, A_seg_len, B_x, B_w1, B_w2, B_w3, B_w4, c, w_mod):

    def _A_ref(x, mem0, Wq, Wk, Wv, Wo, seg_len):
        B, S, Dm = x.shape
        H, Dh = (Wq.shape[1], Wq.shape[2])
        M = mem0.shape[1]
        scale = Dh ** (-0.5)
        n_seg = S // seg_len
        L = M + seg_len
        idx = torch.arange(L)
        mask = (idx[:, None] < M) | (idx[:, None] >= idx[None, :])
        mem = mem0
        outs = []
        for s in range(n_seg):
            xs = x[:, s * seg_len:(s + 1) * seg_len, :].clone()
            h = torch.concatenate([mem, xs], axis=1)
            q = torch.einsum('btd,dhe->bhte', h, Wq)
            k = torch.einsum('btd,dhe->bhte', h, Wk)
            v = torch.einsum('btd,dhe->bhte', h, Wv)
            scores = torch.einsum('bhqe,bhke->bhqk', q, k) * scale
            scores = torch.where(mask[None, None], scores, -1000000000.0)
            p = _softmax(scores, axis=-1)
            o = torch.einsum('bhqk,bhke->bhqe', p, v)
            o = torch.einsum('bhte,hed->btd', o, Wo)
            mem = o[:, :M, :].clone()
            outs.append(o[:, M:, :])
        return torch.concatenate(outs, axis=1)

    def _B_ref(x, w1, w2, w3, w4):
        B, S, D = x.shape
        h = _gelu(_layernorm(x, axis=-1) @ w1)
        c = D // 4
        g0 = _pad(h[:, :, 0 * c:1 * c], ((0, 0), (1, 0), (0, 0)))[:, :S, :]
        g1 = _pad(h[:, :, 1 * c:2 * c], ((0, 0), (0, 1), (0, 0)))[:, 1:, :]
        g2 = _pad(h[:, :, 2 * c:3 * c], ((0, 0), (2, 0), (0, 0)))[:, :S, :]
        g3 = _pad(h[:, :, 3 * c:], ((0, 0), (0, 2), (0, 0)))[:, 2:, :]
        hs = torch.concatenate([g0, g1, g2, g3], axis=-1) @ w2
        x1 = x + hs
        h2 = _gelu(_layernorm(x1, axis=-1) @ w3) @ w4
        return x1 + h2
    x = A_x
    mod = (_silu(c) @ w_mod).reshape(c.shape[0], 6, 1, -1)
    sa, ca, ga, sb, cb, gb = (mod[:, 0].clone(), mod[:, 1].clone(), mod[:, 2].clone(), mod[:, 3].clone(), mod[:, 4].clone(), mod[:, 5].clone())
    h = _layernorm(x, axis=-1) * (1 + ca) + sa
    x = x + ga * _A_ref(h, A_mem0, A_Wq, A_Wk, A_Wv, A_Wo, A_seg_len)
    h = _layernorm(x, axis=-1) * (1 + cb) + sb
    x = x + gb * _B_ref(h, B_w1, B_w2, B_w3, B_w4)
    return x
```

```asm
; @launch kernel=init_kernel grid=(256,1,1) block=(1024,1,1) lds=32768
; @launch kernel=ln1_kernel grid=(512,1,1) block=(256,1,1) lds=2048
; @launch kernel=flow_kernel grid=(256,1,1) block=(256,1,1) lds=163840
.amdgcn_target "amdgcn-amd-amdhsa--gfx950"
.text
.globl init_kernel
.p2align 8
.type init_kernel,@function
init_kernel:
s_cmp_ge_u32 s2,256
s_cbranch_scc1 done_1
s_load_dwordx4 s[4:7],s[0:1],96
s_load_dwordx2 s[8:9],s[0:1],128
v_and_b32 v1,3,v0
v_lshrrev_b32 v2,2,v0
v_mul_u32_u24 v3,12288,v2
v_lshl_add_u32 v3,v1,4,v3
s_lshl_b32 s24,s2,6
v_lshlrev_b32 v4,1,v2
v_mov_b32 v40,-1
v_mov_b32 v41,-1
v_mov_b32 v42,-1
v_mov_b32 v43,-1
v_lshlrev_b32 v44,4,v0
s_lshl_b32 s28,s2,14
s_add_u32 s28,s28,142606336
s_waitcnt lgkmcnt(0)
s_mov_b32 s12,s4
s_and_b32 s13,s5,0xffff
s_mov_b32 s14,0x800
s_mov_b32 s15,0x20000
s_mov_b32 s16,s6
s_and_b32 s17,s7,0xffff
s_mov_b32 s18,0xc00000
s_mov_b32 s19,0x20000
s_mov_b32 s20,s8
s_and_b32 s21,s9,0xffff
s_mov_b32 s22,0x10000000
s_mov_b32 s23,0x20000
buffer_store_dwordx4 v[40:43],v44,s[20:23],s28 offen
s_cmp_ge_u32 s2,192
s_cbranch_scc1 nz_2
s_add_u32 s25,s24,0
buffer_load_dwordx4 v[16:19],v3,s[16:19],s25 offen
buffer_load_ushort v8,v4,s[12:15],0 offen offset:0
s_add_u32 s25,s24,3145728
buffer_load_dwordx4 v[20:23],v3,s[16:19],s25 offen
buffer_load_ushort v9,v4,s[12:15],0 offen offset:512
s_add_u32 s25,s24,6291456
buffer_load_dwordx4 v[24:27],v3,s[16:19],s25 offen
buffer_load_ushort v10,v4,s[12:15],0 offen offset:1024
s_add_u32 s25,s24,9437184
buffer_load_dwordx4 v[28:31],v3,s[16:19],s25 offen
buffer_load_ushort v11,v4,s[12:15],0 offen offset:1536
v_mov_b32 v32,0
v_mov_b32 v33,0
v_mov_b32 v34,0
v_mov_b32 v35,0
v_mov_b32 v36,0
v_mov_b32 v37,0
v_mov_b32 v38,0
v_mov_b32 v39,0
s_mov_b32 s26,0xbfb8aa3b
s_mov_b32 s27,0xffff0000
s_waitcnt vmcnt(0)
v_lshlrev_b32 v8,16,v8
v_mul_f32 v5,s26,v8
v_exp_f32 v5,v5
s_nop 0
v_add_f32 v5,1.0,v5
v_rcp_f32 v5,v5
s_nop 0
v_mul_f32 v5,v5,v8
v_cvt_pk_bf16_f32 v5,v5,v5
v_and_b32 v8,s27,v5
v_lshlrev_b32 v6,16,v16
v_and_b32 v7,s27,v16
v_fmac_f32 v32,v6,v8
v_fmac_f32 v33,v7,v8
v_lshlrev_b32 v6,16,v17
v_and_b32 v7,s27,v17
v_fmac_f32 v34,v6,v8
v_fmac_f32 v35,v7,v8
v_lshlrev_b32 v6,16,v18
v_and_b32 v7,s27,v18
v_fmac_f32 v36,v6,v8
v_fmac_f32 v37,v7,v8
v_lshlrev_b32 v6,16,v19
v_and_b32 v7,s27,v19
v_fmac_f32 v38,v6,v8
v_fmac_f32 v39,v7,v8
v_lshlrev_b32 v9,16,v9
v_mul_f32 v5,s26,v9
v_exp_f32 v5,v5
s_nop 0
v_add_f32 v5,1.0,v5
v_rcp_f32 v5,v5
s_nop 0
v_mul_f32 v5,v5,v9
v_cvt_pk_bf16_f32 v5,v5,v5
v_and_b32 v9,s27,v5
v_lshlrev_b32 v6,16,v20
v_and_b32 v7,s27,v20
v_fmac_f32 v32,v6,v9
v_fmac_f32 v33,v7,v9
v_lshlrev_b32 v6,16,v21
v_and_b32 v7,s27,v21
v_fmac_f32 v34,v6,v9
v_fmac_f32 v35,v7,v9
v_lshlrev_b32 v6,16,v22
v_and_b32 v7,s27,v22
v_fmac_f32 v36,v6,v9
v_fmac_f32 v37,v7,v9
v_lshlrev_b32 v6,16,v23
v_and_b32 v7,s27,v23
v_fmac_f32 v38,v6,v9
v_fmac_f32 v39,v7,v9
v_lshlrev_b32 v10,16,v10
v_mul_f32 v5,s26,v10
v_exp_f32 v5,v5
s_nop 0
v_add_f32 v5,1.0,v5
v_rcp_f32 v5,v5
s_nop 0
v_mul_f32 v5,v5,v10
v_cvt_pk_bf16_f32 v5,v5,v5
v_and_b32 v10,s27,v5
v_lshlrev_b32 v6,16,v24
v_and_b32 v7,s27,v24
v_fmac_f32 v32,v6,v10
v_fmac_f32 v33,v7,v10
v_lshlrev_b32 v6,16,v25
v_and_b32 v7,s27,v25
v_fmac_f32 v34,v6,v10
v_fmac_f32 v35,v7,v10
v_lshlrev_b32 v6,16,v26
v_and_b32 v7,s27,v26
v_fmac_f32 v36,v6,v10
v_fmac_f32 v37,v7,v10
v_lshlrev_b32 v6,16,v27
v_and_b32 v7,s27,v27
v_fmac_f32 v38,v6,v10
v_fmac_f32 v39,v7,v10
v_lshlrev_b32 v11,16,v11
v_mul_f32 v5,s26,v11
v_exp_f32 v5,v5
s_nop 0
v_add_f32 v5,1.0,v5
v_rcp_f32 v5,v5
s_nop 0
v_mul_f32 v5,v5,v11
v_cvt_pk_bf16_f32 v5,v5,v5
v_and_b32 v11,s27,v5
v_lshlrev_b32 v6,16,v28
v_and_b32 v7,s27,v28
v_fmac_f32 v32,v6,v11
v_fmac_f32 v33,v7,v11
v_lshlrev_b32 v6,16,v29
v_and_b32 v7,s27,v29
v_fmac_f32 v34,v6,v11
v_fmac_f32 v35,v7,v11
v_lshlrev_b32 v6,16,v30
v_and_b32 v7,s27,v30
v_fmac_f32 v36,v6,v11
v_fmac_f32 v37,v7,v11
v_lshlrev_b32 v6,16,v31
v_and_b32 v7,s27,v31
v_fmac_f32 v38,v6,v11
v_fmac_f32 v39,v7,v11
v_lshlrev_b32 v5,5,v0
ds_write_b128 v5,v[32:35]
ds_write_b128 v5,v[36:39] offset:16
v_and_b32 v1,31,v0
v_lshrrev_b32 v2,5,v0
v_lshlrev_b32 v3,10,v2
v_lshl_add_u32 v3,v1,2,v3
s_waitcnt lgkmcnt(0)
s_barrier
ds_read_b32 v8,v3 offset:0
ds_read_b32 v9,v3 offset:128
ds_read_b32 v10,v3 offset:256
ds_read_b32 v11,v3 offset:384
ds_read_b32 v12,v3 offset:512
ds_read_b32 v13,v3 offset:640
ds_read_b32 v14,v3 offset:768
ds_read_b32 v15,v3 offset:896
s_waitcnt lgkmcnt(0)
v_add_f32 v8,v8,v9
v_add_f32 v10,v10,v11
v_add_f32 v12,v12,v13
v_add_f32 v14,v14,v15
v_add_f32 v8,v8,v10
v_add_f32 v12,v12,v14
v_add_f32 v8,v8,v12
s_barrier
v_lshlrev_b32 v5,2,v0
ds_write_b32 v5,v8
v_and_b32 v2,3,v2
v_lshlrev_b32 v3,10,v2
v_lshl_add_u32 v3,v1,2,v3
s_waitcnt lgkmcnt(0)
s_barrier
ds_read_b32 v8,v3 offset:0
ds_read_b32 v9,v3 offset:128
ds_read_b32 v10,v3 offset:256
ds_read_b32 v11,v3 offset:384
ds_read_b32 v12,v3 offset:512
ds_read_b32 v13,v3 offset:640
ds_read_b32 v14,v3 offset:768
ds_read_b32 v15,v3 offset:896
s_waitcnt lgkmcnt(0)
v_add_f32 v8,v8,v9
v_add_f32 v10,v10,v11
v_add_f32 v12,v12,v13
v_add_f32 v14,v14,v15
v_add_f32 v8,v8,v10
v_add_f32 v12,v12,v14
v_add_f32 v8,v8,v12
s_barrier
ds_write_b32 v5,v8
v_lshlrev_b32 v3,2,v1
s_waitcnt lgkmcnt(0)
s_barrier
ds_read_b32 v8,v3 offset:0
ds_read_b32 v9,v3 offset:128
ds_read_b32 v10,v3 offset:256
ds_read_b32 v11,v3 offset:384
s_waitcnt lgkmcnt(0)
v_add_f32 v8,v8,v9
v_add_f32 v10,v10,v11
v_add_f32 v8,v8,v10
v_cvt_pk_bf16_f32 v8,v8,v8
v_and_b32 v8,s27,v8
s_lshl_b32 s24,s2,7
s_add_u32 s24,s24,267386880
v_cmp_gt_u32 vcc,32,v0
s_and_saveexec_b64 s[36:37],vcc
s_cbranch_execz done_1
buffer_store_dword v8,v3,s[20:23],s24 offen
s_branch done_1
nz_2:
s_sub_u32 s3,s2,192
s_lshl_b32 s28,s3,15
s_add_u32 s28,s28,134217728
buffer_store_dwordx4 v[40:43],v44,s[20:23],s28 offen
s_add_u32 s28,s28,16384
buffer_store_dwordx4 v[40:43],v44,s[20:23],s28 offen
s_add_u32 s28,s28,33554432
buffer_store_dwordx4 v[40:43],v44,s[20:23],s28 offen
s_sub_u32 s28,s28,16384
buffer_store_dwordx4 v[40:43],v44,s[20:23],s28 offen
v_mov_b32 v12,0
v_mov_b32 v13,0
v_mov_b32 v14,0
v_mov_b32 v15,0
s_cmp_ge_u32 s3,20
s_cbranch_scc1 done_1
s_lshl_b32 s28,s3,14
s_add_u32 s28,s28,138412032
s_cmp_lt_u32 s3,16
s_cbranch_scc1 n2_3
s_and_b32 s28,s3,1
s_lshl_b32 s28,s28,14
s_add_u32 s28,s28,209715200
s_cmp_lt_u32 s3,18
s_cselect_b32 s29,0,4227072
s_add_u32 s28,s28,s29
n2_3:
buffer_store_dwordx4 v[12:15],v44,s[20:23],s28 offen
done_1:
s_endpgm
.globl ln1_kernel
.p2align 8
.type ln1_kernel,@function
ln1_kernel:
s_cmp_ge_u32 s2,512
s_cbranch_scc1 done_4
s_load_dwordx2 s[4:5],s[0:1],0
s_load_dwordx2 s[8:9],s[0:1],128
v_and_b32 v1,63,v0
v_lshrrev_b32 v2,6,v0
s_and_b32 s40,s2,3
s_lshr_b32 s41,s2,2
s_lshl_b32 s41,s41,15
v_readfirstlane_b32 s50,v2
s_mov_b32 s73,0xffff0000
v_and_b32 v2,3,v1
v_lshrrev_b32 v3,2,v1
s_lshl_b32 s64,s40,2
v_add_u32 v4,s64,v2
s_lshl_b32 s65,s50,9
v_lshlrev_b32 v5,4,v3
v_add_u32 v5,s65,v5
v_lshl_add_u32 v8,v4,11,v5
v_lshlrev_b32 v9,1,v5
v_lshrrev_b32 v5,2,v3
v_and_b32 v3,3,v3
s_lshl_b32 s65,s50,13
v_lshlrev_b32 v5,10,v5
v_lshl_add_u32 v5,v3,8,v5
v_lshl_add_u32 v5,v4,4,v5
v_add_u32 v10,s65,v5
s_lshl_b32 s65,s50,9
v_lshlrev_b32 v5,3,v1
v_add_u32 v11,s65,v5
v_lshlrev_b32 v12,3,v2
s_waitcnt lgkmcnt(0)
s_mov_b32 s28,s4
s_and_b32 s29,s5,0xffff
s_mov_b32 s30,0x400000
s_mov_b32 s31,0x20000
s_mov_b32 s20,s8
s_and_b32 s21,s9,0xffff
s_mov_b32 s22,0x10000000
s_mov_b32 s23,0x20000
buffer_load_dwordx4 v[16:19],v8,s[28:31],s41 offen offset:0
buffer_load_dwordx4 v[20:23],v8,s[28:31],s41 offen offset:256
s_mov_b32 s64,267390976
buffer_load_dwordx4 v[48:51],v9,s[20:23],s64 offen offset:0
buffer_load_dwordx4 v[52:55],v9,s[20:23],s64 offen offset:16
buffer_load_dwordx4 v[56:59],v9,s[20:23],s64 offen offset:512
buffer_load_dwordx4 v[60:63],v9,s[20:23],s64 offen offset:528
s_mov_b32 s65,267386880
buffer_load_dwordx4 v[64:67],v9,s[20:23],s65 offen offset:0
buffer_load_dwordx4 v[68:71],v9,s[20:23],s65 offen offset:16
buffer_load_dwordx4 v[72:75],v9,s[20:23],s65 offen offset:512
buffer_load_dwordx4 v[76:79],v9,s[20:23],s65 offen offset:528
s_waitcnt vmcnt(8)
v_lshlrev_b32 v32,16,v16
v_and_b32 v33,s73,v16
v_lshlrev_b32 v34,16,v17
v_and_b32 v35,s73,v17
v_lshlrev_b32 v36,16,v18
v_and_b32 v37,s73,v18
v_lshlrev_b32 v38,16,v19
v_and_b32 v39,s73,v19
v_lshlrev_b32 v40,16,v20
v_and_b32 v41,s73,v20
v_lshlrev_b32 v42,16,v21
v_and_b32 v43,s73,v21
v_lshlrev_b32 v44,16,v22
v_and_b32 v45,s73,v22
v_lshlrev_b32 v46,16,v23
v_and_b32 v47,s73,v23
s_waitcnt vmcnt(0)
v_add_f32 v48,1.0,v48
v_add_f32 v49,1.0,v49
v_add_f32 v50,1.0,v50
v_add_f32 v51,1.0,v51
v_add_f32 v52,1.0,v52
v_add_f32 v53,1.0,v53
v_add_f32 v54,1.0,v54
v_add_f32 v55,1.0,v55
v_add_f32 v56,1.0,v56
v_add_f32 v57,1.0,v57
v_add_f32 v58,1.0,v58
v_add_f32 v59,1.0,v59
v_add_f32 v60,1.0,v60
v_add_f32 v61,1.0,v61
v_add_f32 v62,1.0,v62
v_add_f32 v63,1.0,v63
v_add_f32 v80,v32,v33
v_mul_f32 v81,v32,v32
v_add_f32 v82,v34,v35
v_mul_f32 v83,v33,v33
v_fmac_f32 v81,v34,v34
v_fmac_f32 v83,v35,v35
v_add_f32 v80,v80,v36
v_fmac_f32 v81,v36,v36
v_add_f32 v82,v82,v37
v_fmac_f32 v83,v37,v37
v_add_f32 v80,v80,v38
v_fmac_f32 v81,v38,v38
v_add_f32 v82,v82,v39
v_fmac_f32 v83,v39,v39
v_add_f32 v80,v80,v40
v_fmac_f32 v81,v40,v40
v_add_f32 v82,v82,v41
v_fmac_f32 v83,v41,v41
v_add_f32 v80,v80,v42
v_fmac_f32 v81,v42,v42
v_add_f32 v82,v82,v43
v_fmac_f32 v83,v43,v43
v_add_f32 v80,v80,v44
v_fmac_f32 v81,v44,v44
v_add_f32 v82,v82,v45
v_fmac_f32 v83,v45,v45
v_add_f32 v80,v80,v46
v_fmac_f32 v81,v46,v46
v_add_f32 v82,v82,v47
v_fmac_f32 v83,v47,v47
v_add_f32 v80,v80,v82
v_add_f32 v81,v81,v83
s_nop 0
v_add_f32_dpp v80,v80,v80 row_ror:4 row_mask:0xf bank_mask:0xf
v_add_f32_dpp v81,v81,v81 row_ror:4 row_mask:0xf bank_mask:0xf
s_nop 0
v_add_f32_dpp v80,v80,v80 row_ror:8 row_mask:0xf bank_mask:0xf
v_add_f32_dpp v81,v81,v81 row_ror:8 row_mask:0xf bank_mask:0xf
v_mov_b32 v82,v80
v_mov_b32 v83,v81
s_nop 0
v_permlane16_swap_b32 v82,v80
v_permlane16_swap_b32 v83,v81
v_add_f32 v80,v80,v82
v_add_f32 v81,v81,v83
v_mov_b32 v82,v80
v_mov_b32 v83,v81
s_nop 0
v_permlane32_swap_b32 v82,v80
v_permlane32_swap_b32 v83,v81
v_add_f32 v80,v80,v82
v_add_f32 v81,v81,v83
ds_write_b64 v11,v[80:81] offset:0
s_waitcnt lgkmcnt(0)
s_barrier
ds_read_b64 v[84:85],v12 offset:0
ds_read_b64 v[86:87],v12 offset:512
ds_read_b64 v[88:89],v12 offset:1024
ds_read_b64 v[90:91],v12 offset:1536
s_waitcnt lgkmcnt(0)
v_add_f32 v84,v84,v86
v_add_f32 v85,v85,v87
v_add_f32 v88,v88,v90
v_add_f32 v89,v89,v91
v_add_f32 v84,v84,v88
v_add_f32 v85,v85,v89
v_mul_f32 v80,0xba800000,v84
v_mul_f32 v86,v80,v80
v_mul_f32 v85,0x3a800000,v85
v_sub_f32 v85,v85,v86
v_max_f32 v85,0,v85
v_add_f32 v85,0x3727c5ac,v85
v_rsq_f32 v81,v85
s_nop 0
v_mul_f32 v80,v80,v81
v_fma_f32 v32,v32,v81,v80
v_fma_f32 v33,v33,v81,v80
v_fma_f32 v34,v34,v81,v80
v_fma_f32 v35,v35,v81,v80
v_fma_f32 v36,v36,v81,v80
v_fma_f32 v37,v37,v81,v80
v_fma_f32 v38,v38,v81,v80
v_fma_f32 v39,v39,v81,v80
v_fma_f32 v40,v40,v81,v80
v_fma_f32 v41,v41,v81,v80
v_fma_f32 v42,v42,v81,v80
v_fma_f32 v43,v43,v81,v80
v_fma_f32 v44,v44,v81,v80
v_fma_f32 v45,v45,v81,v80
v_fma_f32 v46,v46,v81,v80
v_fma_f32 v47,v47,v81,v80
v_fma_f32 v32,v32,v48,v64
v_fma_f32 v33,v33,v49,v65
v_fma_f32 v34,v34,v50,v66
v_fma_f32 v35,v35,v51,v67
v_fma_f32 v36,v36,v52,v68
v_fma_f32 v37,v37,v53,v69
v_fma_f32 v38,v38,v54,v70
v_fma_f32 v39,v39,v55,v71
v_fma_f32 v40,v40,v56,v72
v_fma_f32 v41,v41,v57,v73
v_fma_f32 v42,v42,v58,v74
v_fma_f32 v43,v43,v59,v75
v_fma_f32 v44,v44,v60,v76
v_fma_f32 v45,v45,v61,v77
v_fma_f32 v46,v46,v62,v78
v_fma_f32 v47,v47,v63,v79
v_cvt_pk_bf16_f32 v16,v32,v33
v_cvt_pk_bf16_f32 v17,v34,v35
v_cvt_pk_bf16_f32 v18,v36,v37
v_cvt_pk_bf16_f32 v19,v38,v39
v_cvt_pk_bf16_f32 v20,v40,v41
v_cvt_pk_bf16_f32 v21,v42,v43
v_cvt_pk_bf16_f32 v22,v44,v45
v_cvt_pk_bf16_f32 v23,v46,v47
s_add_u32 s41,s41,146800640
s_add_u32 s42,s41,4096
buffer_store_dwordx4 v[16:19],v10,s[20:23],s41 offen
buffer_store_dwordx4 v[20:23],v10,s[20:23],s42 offen
done_4:
s_endpgm
.globl flow_kernel
.p2align 8
.type flow_kernel,@function
flow_kernel:
s_cmp_ge_u32 s2,256
s_cbranch_scc1 done_5
s_load_dwordx2 s[18:19],s[0:1],128
s_getreg_b32 s51,hwreg(HW_REG_XCC_ID)
v_lshrrev_b32 v2,6,v0
v_and_b32 v1,63,v0
s_and_b32 s51,s51,7
v_readfirstlane_b32 s50,v2
s_mov_b32 s90,40000
v_mov_b32 v4,163824
s_waitcnt lgkmcnt(0)
s_mov_b32 s20,s18
s_and_b32 s21,s19,0xffff
s_mov_b32 s22,0x10000000
s_mov_b32 s23,0x20000
s_cmp_lg_u32 s50,0
s_cbranch_scc1 norole_6
s_mov_b64 exec,1
v_mov_b32 v3,1
s_lshl_b32 s52,s51,7
s_add_u32 s52,s52,138510336
buffer_atomic_add v3,off,s[20:23],s52 sc0 sc1
s_waitcnt vmcnt(0)
ds_write_b32 v4,v3
s_waitcnt lgkmcnt(0)
s_mov_b64 exec,-1
norole_6:
s_barrier
ds_read_b32 v3,v4
s_waitcnt lgkmcnt(0)
v_readfirstlane_b32 s49,v3
s_mov_b32 s56,2
s_lshl_b32 s58,s51,5
s_add_u32 s58,s58,s49
s_cmp_ge_u32 s49,32
s_cbranch_scc1 fl_bad
fl_disp:
v_mbcnt_lo_u32_b32 v1,-1,0
v_mbcnt_hi_u32_b32 v1,-1,v1
s_sub_u32 s59,s58,248
s_cbranch_scc1 nx_7
s_branch fl_w2
nx_7:
s_sub_u32 s59,s58,240
s_cbranch_scc1 nx_8
s_branch fl_w1
nx_8:
s_sub_u32 s59,s58,224
s_cbranch_scc1 nx_9
s_branch fl_att
nx_9:
s_sub_u32 s59,s58,220
s_cbranch_scc1 nx_10
s_branch fl_ln2
nx_10:
s_sub_u32 s59,s58,192
s_cbranch_scc1 nx_11
s_branch fl_w3
nx_11:
s_sub_u32 s59,s58,160
s_cbranch_scc1 nx_12
s_branch fl_w4
nx_12:
s_sub_u32 s59,s58,128
s_cbranch_scc1 nx_13
s_branch fl_wo
nx_13:
s_sub_u32 s59,s58,64
s_cbranch_scc1 nx_14
s_branch fl_qkv
nx_14:
s_branch fl_rec
fl_bad:
s_mov_b32 s67,0
s_cmp_eq_u32 s56,1
s_cbranch_scc1 vok_15
v_mbcnt_lo_u32_b32 v16,-1,0
v_and_b32 v16,7,v16
v_lshlrev_b32 v16,7,v16
s_mov_b32 s64,138510336
vpoll_16:
buffer_load_dword v17,v16,s[20:23],s64 offen sc1
s_waitcnt vmcnt(0)
v_readlane_b32 s92,v17,0
v_readlane_b32 s93,v17,1
v_readlane_b32 s94,v17,2
v_readlane_b32 s95,v17,3
v_readlane_b32 s96,v17,4
v_readlane_b32 s97,v17,5
v_readlane_b32 s98,v17,6
v_readlane_b32 s99,v17,7
s_add_u32 s65,s92,s93
s_add_u32 s65,s65,s94
s_add_u32 s65,s65,s95
s_add_u32 s65,s65,s96
s_add_u32 s65,s65,s97
s_add_u32 s65,s65,s98
s_add_u32 s65,s65,s99
s_cmp_ge_u32 s65,256
s_cbranch_scc1 vgot_17
s_sleep 4
s_sub_u32 s90,s90,1
s_cmp_gt_i32 s90,0
s_cbranch_scc1 vpoll_16
vgot_17:
s_min_u32 s65,s92,s93
s_min_u32 s65,s65,s94
s_min_u32 s65,s65,s95
s_min_u32 s65,s65,s96
s_min_u32 s65,s65,s97
s_min_u32 s65,s65,s98
s_min_u32 s65,s65,s99
s_cmp_lt_u32 s65,32
s_cbranch_scc1 fl_slow
s_mov_b32 s56,0
vok_15:
fl_slow:
s_mov_b32 s58,s49
s_cmp_gt_u32 s51,0
s_cselect_b32 s65,s92,0
s_add_u32 s58,s58,s65
s_cmp_gt_u32 s51,1
s_cselect_b32 s65,s93,0
s_add_u32 s58,s58,s65
s_cmp_gt_u32 s51,2
s_cselect_b32 s65,s94,0
s_add_u32 s58,s58,s65
s_cmp_gt_u32 s51,3
s_cselect_b32 s65,s95,0
s_add_u32 s58,s58,s65
s_cmp_gt_u32 s51,4
s_cselect_b32 s65,s96,0
s_add_u32 s58,s58,s65
s_cmp_gt_u32 s51,5
s_cselect_b32 s65,s97,0
s_add_u32 s58,s58,s65
s_cmp_gt_u32 s51,6
s_cselect_b32 s65,s98,0
s_add_u32 s58,s58,s65
s_mov_b32 s56,1
s_waitcnt vmcnt(0) lgkmcnt(0)
s_barrier
s_cmp_lt_u32 s58,256
s_cbranch_scc1 fl_disp
done_5:
s_endpgm
fl_qkv:
v_and_b32 v21,15,v1
v_lshrrev_b32 v22,4,v1
v_lshrrev_b32 v23,2,v21
v_and_b32 v24,3,v21
s_lshl_b32 s61,s50,15
v_lshl_add_u32 v25,v22,3,v23
s_load_dwordx4 s[4:7],s[0:1],16
s_load_dwordx2 s[8:9],s[0:1],32
s_lshl_b32 s52,s59,7
s_and_b32 s64,s50,1
s_lshl_b32 s65,s64,6
s_add_u32 s53,s52,s65
s_lshr_b32 s65,s50,1
s_lshl_b32 s65,s65,6
s_add_u32 s52,s52,s65
s_lshl_b32 s54,s64,3
s_waitcnt lgkmcnt(0)
s_cmp_gt_u32 s50,1
s_cselect_b64 s[10:11],s[4:5],s[6:7]
s_mov_b32 s28,s10
s_and_b32 s29,s11,0xffff
s_mov_b32 s30,0x800000
s_mov_b32 s31,0x20000
s_mov_b32 s32,s8
s_and_b32 s33,s9,0xffff
s_mov_b32 s34,0x800000
s_mov_b32 s35,0x20000
v_lshrrev_b32 v26,2,v1
v_and_b32 v27,3,v1
v_mul_u32_u24 v16,8192,v26
v_lshl_add_u32 v16,v27,4,v16
v_lshlrev_b32 v17,6,v25
v_lshl_add_u32 v17,v24,4,v17
v_add_u32 v17,s61,v17
s_add_u32 s62,s53,0
s_add_u32 m0,s61,0
s_nop 0
buffer_load_dwordx4 v16,s[28:31],s62 offen lds
s_add_u32 s62,s62,131072
s_add_u32 m0,m0,1024
s_nop 0
buffer_load_dwordx4 v16,s[28:31],s62 offen lds
s_add_u32 s62,s62,131072
s_add_u32 m0,m0,1024
s_nop 0
buffer_load_dwordx4 v16,s[28:31],s62 offen lds
s_add_u32 s62,s62,131072
s_add_u32 m0,m0,1024
s_nop 0
buffer_load_dwordx4 v16,s[28:31],s62 offen lds
s_add_u32 s62,s62,131072
s_add_u32 m0,m0,1024
s_nop 0
buffer_load_dwordx4 v16,s[28:31],s62 offen lds
s_add_u32 s62,s62,131072
s_add_u32 m0,m0,1024
s_nop 0
buffer_load_dwordx4 v16,s[28:31],s62 offen lds
s_add_u32 s62,s62,131072
s_add_u32 m0,m0,1024
s_nop 0
buffer_load_dwordx4 v16,s[28:31],s62 offen lds
s_add_u32 s62,s62,131072
s_add_u32 m0,m0,1024
s_nop 0
buffer_load_dwordx4 v16,s[28:31],s62 offen lds
s_add_u32 s62,s62,131072
s_add_u32 m0,m0,1024
s_nop 0
buffer_load_dwordx4 v16,s[28:31],s62 offen lds
s_add_u32 s62,s62,131072
s_add_u32 m0,m0,1024
s_nop 0
buffer_load_dwordx4 v16,s[28:31],s62 offen lds
s_add_u32 s62,s62,131072
s_add_u32 m0,m0,1024
s_nop 0
buffer_load_dwordx4 v16,s[28:31],s62 offen lds
s_add_u32 s62,s62,131072
s_add_u32 m0,m0,1024
s_nop 0
buffer_load_dwordx4 v16,s[28:31],s62 offen lds
s_add_u32 s62,s62,131072
s_add_u32 m0,m0,1024
s_nop 0
buffer_load_dwordx4 v16,s[28:31],s62 offen lds
s_add_u32 s62,s62,131072
s_add_u32 m0,m0,1024
s_nop 0
buffer_load_dwordx4 v16,s[28:31],s62 offen lds
s_add_u32 s62,s62,131072
s_add_u32 m0,m0,1024
s_nop 0
buffer_load_dwordx4 v16,s[28:31],s62 offen lds
s_add_u32 s62,s62,131072
s_add_u32 m0,m0,1024
s_nop 0
buffer_load_dwordx4 v16,s[28:31],s62 offen lds
s_add_u32 s62,s52,0
s_add_u32 m0,s61,16384
s_nop 0
buffer_load_dwordx4 v16,s[32:35],s62 offen lds
s_add_u32 s62,s62,131072
s_add_u32 m0,m0,1024
s_nop 0
buffer_load_dwordx4 v16,s[32:35],s62 offen lds
s_add_u32 s62,s62,131072
s_add_u32 m0,m0,1024
s_nop 0
buffer_load_dwordx4 v16,s[32:35],s62 offen lds
s_add_u32 s62,s62,131072
s_add_u32 m0,m0,1024
s_nop 0
buffer_load_dwordx4 v16,s[32:35],s62 offen lds
s_add_u32 s62,s62,131072
s_add_u32 m0,m0,1024
s_nop 0
buffer_load_dwordx4 v16,s[32:35],s62 offen lds
s_add_u32 s62,s62,131072
s_add_u32 m0,m0,1024
s_nop 0
buffer_load_dwordx4 v16,s[32:35],s62 offen lds
s_add_u32 s62,s62,131072
s_add_u32 m0,m0,1024
s_nop 0
buffer_load_dwordx4 v16,s[32:35],s62 offen lds
s_add_u32 s62,s62,131072
s_add_u32 m0,m0,1024
s_nop 0
buffer_load_dwordx4 v16,s[32:35],s62 offen lds
s_add_u32 s62,s62,131072
s_add_u32 m0,m0,1024
s_nop 0
buffer_load_dwordx4 v16,s[32:35],s62 offen lds
s_add_u32 s62,s62,131072
s_add_u32 m0,m0,1024
s_nop 0
buffer_load_dwordx4 v16,s[32:35],s62 offen lds
s_add_u32 s62,s62,131072
s_add_u32 m0,m0,1024
s_nop 0
buffer_load_dwordx4 v16,s[32:35],s62 offen lds
s_add_u32 s62,s62,131072
s_add_u32 m0,m0,1024
s_nop 0
buffer_load_dwordx4 v16,s[32:35],s62 offen lds
s_add_u32 s62,s62,131072
s_add_u32 m0,m0,1024
s_nop 0
buffer_load_dwordx4 v16,s[32:35],s62 offen lds
s_add_u32 s62,s62,131072
s_add_u32 m0,m0,1024
s_nop 0
buffer_load_dwordx4 v16,s[32:35],s62 offen lds
s_add_u32 s62,s62,131072
s_add_u32 m0,m0,1024
s_nop 0
buffer_load_dwordx4 v16,s[32:35],s62 offen lds
s_add_u32 s62,s62,131072
s_add_u32 m0,m0,1024
s_nop 0
buffer_load_dwordx4 v16,s[32:35],s62 offen lds
s_waitcnt vmcnt(16)
ds_read_b64_tr_b16 a[0:1],v17 offset:0
ds_read_b64_tr_b16 a[2:3],v17 offset:256
ds_read_b64_tr_b16 a[4:5],v17 offset:8
ds_read_b64_tr_b16 a[6:7],v17 offset:264
ds_read_b64_tr_b16 a[12:13],v17 offset:2048
ds_read_b64_tr_b16 a[14:15],v17 offset:2304
ds_read_b64_tr_b16 a[16:17],v17 offset:2056
ds_read_b64_tr_b16 a[18:19],v17 offset:2312
ds_read_b64_tr_b16 a[24:25],v17 offset:4096
ds_read_b64_tr_b16 a[26:27],v17 offset:4352
ds_read_b64_tr_b16 a[28:29],v17 offset:4104
ds_read_b64_tr_b16 a[30:31],v17 offset:4360
s_waitcnt lgkmcnt(0)
ds_read_b64_tr_b16 a[36:37],v17 offset:6144
ds_read_b64_tr_b16 a[38:39],v17 offset:6400
ds_read_b64_tr_b16 a[40:41],v17 offset:6152
ds_read_b64_tr_b16 a[42:43],v17 offset:6408
ds_read_b64_tr_b16 a[48:49],v17 offset:8192
ds_read_b64_tr_b16 a[50:51],v17 offset:8448
ds_read_b64_tr_b16 a[52:53],v17 offset:8200
ds_read_b64_tr_b16 a[54:55],v17 offset:8456
ds_read_b64_tr_b16 a[60:61],v17 offset:10240
ds_read_b64_tr_b16 a[62:63],v17 offset:10496
ds_read_b64_tr_b16 a[64:65],v17 offset:10248
ds_read_b64_tr_b16 a[66:67],v17 offset:10504
s_waitcnt lgkmcnt(0)
ds_read_b64_tr_b16 a[72:73],v17 offset:12288
ds_read_b64_tr_b16 a[74:75],v17 offset:12544
ds_read_b64_tr_b16 a[76:77],v17 offset:12296
ds_read_b64_tr_b16 a[78:79],v17 offset:12552
ds_read_b64_tr_b16 a[84:85],v17 offset:14336
ds_read_b64_tr_b16 a[86:87],v17 offset:14592
ds_read_b64_tr_b16 a[88:89],v17 offset:14344
ds_read_b64_tr_b16 a[90:91],v17 offset:14600
s_waitcnt lgkmcnt(0)
s_add_u32 s62,s53,2097152
s_add_u32 m0,s61,0
s_nop 0
buffer_load_dwordx4 v16,s[28:31],s62 offen lds
s_add_u32 s62,s62,131072
s_add_u32 m0,m0,1024
s_nop 0
buffer_load_dwordx4 v16,s[28:31],s62 offen lds
s_add_u32 s62,s62,131072
s_add_u32 m0,m0,1024
s_nop 0
buffer_load_dwordx4 v16,s[28:31],s62 offen lds
s_add_u32 s62,s62,131072
s_add_u32 m0,m0,1024
s_nop 0
buffer_load_dwordx4 v16,s[28:31],s62 offen lds
s_add_u32 s62,s62,131072
s_add_u32 m0,m0,1024
s_nop 0
buffer_load_dwordx4 v16,s[28:31],s62 offen lds
s_add_u32 s62,s62,131072
s_add_u32 m0,m0,1024
s_nop 0
buffer_load_dwordx4 v16,s[28:31],s62 offen lds
s_add_u32 s62,s62,131072
s_add_u32 m0,m0,1024
s_nop 0
buffer_load_dwordx4 v16,s[28:31],s62 offen lds
s_add_u32 s62,s62,131072
s_add_u32 m0,m0,1024
s_nop 0
buffer_load_dwordx4 v16,s[28:31],s62 offen lds
s_add_u32 s62,s62,131072
s_add_u32 m0,m0,1024
s_nop 0
buffer_load_dwordx4 v16,s[28:31],s62 offen lds
s_add_u32 s62,s62,131072
s_add_u32 m0,m0,1024
s_nop 0
buffer_load_dwordx4 v16,s[28:31],s62 offen lds
s_add_u32 s62,s62,131072
s_add_u32 m0,m0,1024
s_nop 0
buffer_load_dwordx4 v16,s[28:31],s62 offen lds
s_add_u32 s62,s62,131072
s_add_u32 m0,m0,1024
s_nop 0
buffer_load_dwordx4 v16,s[28:31],s62 offen lds
s_add_u32 s62,s62,131072
s_add_u32 m0,m0,1024
s_nop 0
buffer_load_dwordx4 v16,s[28:31],s62 offen lds
s_add_u32 s62,s62,131072
s_add_u32 m0,m0,1024
s_nop 0
buffer_load_dwordx4 v16,s[28:31],s62 offen lds
s_add_u32 s62,s62,131072
s_add_u32 m0,m0,1024
s_nop 0
buffer_load_dwordx4 v16,s[28:31],s62 offen lds
s_add_u32 s62,s62,131072
s_add_u32 m0,m0,1024
s_nop 0
buffer_load_dwordx4 v16,s[28:31],s62 offen lds
s_waitcnt vmcnt(16)
v_add_u32 v18,s54,v17
ds_read_b64_tr_b16 a[8:9],v18 offset:16384
ds_read_b64_tr_b16 a[10:11],v18 offset:16640
ds_read_b64_tr_b16 a[20:21],v18 offset:18432
ds_read_b64_tr_b16 a[22:23],v18 offset:18688
ds_read_b64_tr_b16 a[32:33],v18 offset:20480
ds_read_b64_tr_b16 a[34:35],v18 offset:20736
ds_read_b64_tr_b16 a[44:45],v18 offset:22528
ds_read_b64_tr_b16 a[46:47],v18 offset:22784
ds_read_b64_tr_b16 a[56:57],v18 offset:24576
ds_read_b64_tr_b16 a[58:59],v18 offset:24832
ds_read_b64_tr_b16 a[68:69],v18 offset:26624
ds_read_b64_tr_b16 a[70:71],v18 offset:26880
s_waitcnt lgkmcnt(0)
ds_read_b64_tr_b16 a[80:81],v18 offset:28672
ds_read_b64_tr_b16 a[82:83],v18 offset:28928
ds_read_b64_tr_b16 a[92:93],v18 offset:30720
ds_read_b64_tr_b16 a[94:95],v18 offset:30976
s_waitcnt lgkmcnt(0)
s_add_u32 s62,s52,2097152
s_add_u32 m0,s61,16384
s_nop 0
buffer_load_dwordx4 v16,s[32:35],s62 offen lds
s_add_u32 s62,s62,131072
s_add_u32 m0,m0,1024
s_nop 0
buffer_load_dwordx4 v16,s[32:35],s62 offen lds
s_add_u32 s62,s62,131072
s_add_u32 m0,m0,1024
s_nop 0
buffer_load_dwordx4 v16,s[32:35],s62 offen lds
s_add_u32 s62,s62,131072
s_add_u32 m0,m0,1024
s_nop 0
buffer_load_dwordx4 v16,s[32:35],s62 offen lds
s_add_u32 s62,s62,131072
s_add_u32 m0,m0,1024
s_nop 0
buffer_load_dwordx4 v16,s[32:35],s62 offen lds
s_add_u32 s62,s62,131072
s_add_u32 m0,m0,1024
s_nop 0
buffer_load_dwordx4 v16,s[32:35],s62 offen lds
s_add_u32 s62,s62,131072
s_add_u32 m0,m0,1024
s_nop 0
buffer_load_dwordx4 v16,s[32:35],s62 offen lds
s_add_u32 s62,s62,131072
s_add_u32 m0,m0,1024
s_nop 0
buffer_load_dwordx4 v16,s[32:35],s62 offen lds
s_add_u32 s62,s62,131072
s_add_u32 m0,m0,1024
s_nop 0
buffer_load_dwordx4 v16,s[32:35],s62 offen lds
s_add_u32 s62,s62,131072
s_add_u32 m0,m0,1024
s_nop 0
buffer_load_dwordx4 v16,s[32:35],s62 offen lds
s_add_u32 s62,s62,131072
s_add_u32 m0,m0,1024
s_nop 0
buffer_load_dwordx4 v16,s[32:35],s62 offen lds
s_add_u32 s62,s62,131072
s_add_u32 m0,m0,1024
s_nop 0
buffer_load_dwordx4 v16,s[32:35],s62 offen lds
s_add_u32 s62,s62,131072
s_add_u32 m0,m0,1024
s_nop 0
buffer_load_dwordx4 v16,s[32:35],s62 offen lds
s_add_u32 s62,s62,131072
s_add_u32 m0,m0,1024
s_nop 0
buffer_load_dwordx4 v16,s[32:35],s62 offen lds
s_add_u32 s62,s62,131072
s_add_u32 m0,m0,1024
s_nop 0
buffer_load_dwordx4 v16,s[32:35],s62 offen lds
s_add_u32 s62,s62,131072
s_add_u32 m0,m0,1024
s_nop 0
buffer_load_dwordx4 v16,s[32:35],s62 offen lds
s_waitcnt vmcnt(16)
ds_read_b64_tr_b16 a[96:97],v17 offset:0
ds_read_b64_tr_b16 a[98:99],v17 offset:256
ds_read_b64_tr_b16 a[100:101],v17 offset:8
ds_read_b64_tr_b16 a[102:103],v17 offset:264
ds_read_b64_tr_b16 a[108:109],v17 offset:2048
ds_read_b64_tr_b16 a[110:111],v17 offset:2304
ds_read_b64_tr_b16 a[112:113],v17 offset:2056
ds_read_b64_tr_b16 a[114:115],v17 offset:2312
ds_read_b64_tr_b16 a[120:121],v17 offset:4096
ds_read_b64_tr_b16 a[122:123],v17 offset:4352
ds_read_b64_tr_b16 a[124:125],v17 offset:4104
ds_read_b64_tr_b16 a[126:127],v17 offset:4360
s_waitcnt lgkmcnt(0)
ds_read_b64_tr_b16 a[132:133],v17 offset:6144
ds_read_b64_tr_b16 a[134:135],v17 offset:6400
ds_read_b64_tr_b16 a[136:137],v17 offset:6152
ds_read_b64_tr_b16 a[138:139],v17 offset:6408
ds_read_b64_tr_b16 a[144:145],v17 offset:8192
ds_read_b64_tr_b16 a[146:147],v17 offset:8448
ds_read_b64_tr_b16 a[148:149],v17 offset:8200
ds_read_b64_tr_b16 a[150:151],v17 offset:8456
ds_read_b64_tr_b16 a[156:157],v17 offset:10240
ds_read_b64_tr_b16 a[158:159],v17 offset:10496
ds_read_b64_tr_b16 a[160:161],v17 offset:10248
ds_read_b64_tr_b16 a[162:163],v17 offset:10504
s_waitcnt lgkmcnt(0)
ds_read_b64_tr_b16 a[168:169],v17 offset:12288
ds_read_b64_tr_b16 a[170:171],v17 offset:12544
ds_read_b64_tr_b16 a[172:173],v17 offset:12296
ds_read_b64_tr_b16 a[174:175],v17 offset:12552
ds_read_b64_tr_b16 a[180:181],v17 offset:14336
ds_read_b64_tr_b16 a[182:183],v17 offset:14592
ds_read_b64_tr_b16 a[184:185],v17 offset:14344
ds_read_b64_tr_b16 a[186:187],v17 offset:14600
s_waitcnt lgkmcnt(0)
s_add_u32 s62,s53,4194304
s_add_u32 m0,s61,0
s_nop 0
buffer_load_dwordx4 v16,s[28:31],s62 offen lds
s_add_u32 s62,s62,131072
s_add_u32 m0,m0,1024
s_nop 0
buffer_load_dwordx4 v16,s[28:31],s62 offen lds
s_add_u32 s62,s62,131072
s_add_u32 m0,m0,1024
s_nop 0
buffer_load_dwordx4 v16,s[28:31],s62 offen lds
s_add_u32 s62,s62,131072
s_add_u32 m0,m0,1024
s_nop 0
buffer_load_dwordx4 v16,s[28:31],s62 offen lds
s_add_u32 s62,s62,131072
s_add_u32 m0,m0,1024
s_nop 0
buffer_load_dwordx4 v16,s[28:31],s62 offen lds
s_add_u32 s62,s62,131072
s_add_u32 m0,m0,1024
s_nop 0
buffer_load_dwordx4 v16,s[28:31],s62 offen lds
s_add_u32 s62,s62,131072
s_add_u32 m0,m0,1024
s_nop 0
buffer_load_dwordx4 v16,s[28:31],s62 offen lds
s_add_u32 s62,s62,131072
s_add_u32 m0,m0,1024
s_nop 0
buffer_load_dwordx4 v16,s[28:31],s62 offen lds
s_add_u32 s62,s62,131072
s_add_u32 m0,m0,1024
s_nop 0
buffer_load_dwordx4 v16,s[28:31],s62 offen lds
s_add_u32 s62,s62,131072
s_add_u32 m0,m0,1024
s_nop 0
buffer_load_dwordx4 v16,s[28:31],s62 offen lds
s_add_u32 s62,s62,131072
s_add_u32 m0,m0,1024
s_nop 0
buffer_load_dwordx4 v16,s[28:31],s62 offen lds
s_add_u32 s62,s62,131072
s_add_u32 m0,m0,1024
s_nop 0
buffer_load_dwordx4 v16,s[28:31],s62 offen lds
s_add_u32 s62,s62,131072
s_add_u32 m0,m0,1024
s_nop 0
buffer_load_dwordx4 v16,s[28:31],s62 offen lds
s_add_u32 s62,s62,131072
s_add_u32 m0,m0,1024
s_nop 0
buffer_load_dwordx4 v16,s[28:31],s62 offen lds
s_add_u32 s62,s62,131072
s_add_u32 m0,m0,1024
s_nop 0
buffer_load_dwordx4 v16,s[28:31],s62 offen lds
s_add_u32 s62,s62,131072
s_add_u32 m0,m0,1024
s_nop 0
buffer_load_dwordx4 v16,s[28:31],s62 offen lds
s_waitcnt vmcnt(16)
ds_read_b64_tr_b16 a[104:105],v18 offset:16384
ds_read_b64_tr_b16 a[106:107],v18 offset:16640
ds_read_b64_tr_b16 a[116:117],v18 offset:18432
ds_read_b64_tr_b16 a[118:119],v18 offset:18688
ds_read_b64_tr_b16 a[128:129],v18 offset:20480
ds_read_b64_tr_b16 a[130:131],v18 offset:20736
ds_read_b64_tr_b16 a[140:141],v18 offset:22528
ds_read_b64_tr_b16 a[142:143],v18 offset:22784
ds_read_b64_tr_b16 a[152:153],v18 offset:24576
ds_read_b64_tr_b16 a[154:155],v18 offset:24832
ds_read_b64_tr_b16 a[164:165],v18 offset:26624
ds_read_b64_tr_b16 a[166:167],v18 offset:26880
s_waitcnt lgkmcnt(0)
ds_read_b64_tr_b16 a[176:177],v18 offset:28672
ds_read_b64_tr_b16 a[178:179],v18 offset:28928
ds_read_b64_tr_b16 a[188:189],v18 offset:30720
ds_read_b64_tr_b16 a[190:191],v18 offset:30976
s_waitcnt lgkmcnt(0)
s_add_u32 s62,s52,4194304
s_add_u32 m0,s61,16384
s_nop 0
buffer_load_dwordx4 v16,s[32:35],s62 offen lds
s_add_u32 s62,s62,131072
s_add_u32 m0,m0,1024
s_nop 0
buffer_load_dwordx4 v16,s[32:35],s62 offen lds
s_add_u32 s62,s62,131072
s_add_u32 m0,m0,1024
s_nop 0
buffer_load_dwordx4 v16,s[32:35],s62 offen lds
s_add_u32 s62,s62,131072
s_add_u32 m0,m0,1024
s_nop 0
buffer_load_dwordx4 v16,s[32:35],s62 offen lds
s_add_u32 s62,s62,131072
s_add_u32 m0,m0,1024
s_nop 0
buffer_load_dwordx4 v16,s[32:35],s62 offen lds
s_add_u32 s62,s62,131072
s_add_u32 m0,m0,1024
s_nop 0
buffer_load_dwordx4 v16,s[32:35],s62 offen lds
s_add_u32 s62,s62,131072
s_add_u32 m0,m0,1024
s_nop 0
buffer_load_dwordx4 v16,s[32:35],s62 offen lds
s_add_u32 s62,s62,131072
s_add_u32 m0,m0,1024
s_nop 0
buffer_load_dwordx4 v16,s[32:35],s62 offen lds
s_add_u32 s62,s62,131072
s_add_u32 m0,m0,1024
s_nop 0
buffer_load_dwordx4 v16,s[32:35],s62 offen lds
s_add_u32 s62,s62,131072
s_add_u32 m0,m0,1024
s_nop 0
buffer_load_dwordx4 v16,s[32:35],s62 offen lds
s_add_u32 s62,s62,131072
s_add_u32 m0,m0,1024
s_nop 0
buffer_load_dwordx4 v16,s[32:35],s62 offen lds
s_add_u32 s62,s62,131072
s_add_u32 m0,m0,1024
s_nop 0
buffer_load_dwordx4 v16,s[32:35],s62 offen lds
s_add_u32 s62,s62,131072
s_add_u32 m0,m0,1024
s_nop 0
buffer_load_dwordx4 v16,s[32:35],s62 offen lds
s_add_u32 s62,s62,131072
s_add_u32 m0,m0,1024
s_nop 0
buffer_load_dwordx4 v16,s[32:35],s62 offen lds
s_add_u32 s62,s62,131072
s_add_u32 m0,m0,1024
s_nop 0
buffer_load_dwordx4 v16,s[32:35],s62 offen lds
s_add_u32 s62,s62,131072
s_add_u32 m0,m0,1024
s_nop 0
buffer_load_dwordx4 v16,s[32:35],s62 offen lds
s_waitcnt vmcnt(16)
ds_read_b64_tr_b16 a[192:193],v17 offset:0
ds_read_b64_tr_b16 a[194:195],v17 offset:256
ds_read_b64_tr_b16 a[196:197],v17 offset:8
ds_read_b64_tr_b16 a[198:199],v17 offset:264
ds_read_b64_tr_b16 a[204:205],v17 offset:2048
ds_read_b64_tr_b16 a[206:207],v17 offset:2304
ds_read_b64_tr_b16 a[208:209],v17 offset:2056
ds_read_b64_tr_b16 a[210:211],v17 offset:2312
ds_read_b64_tr_b16 a[216:217],v17 offset:4096
ds_read_b64_tr_b16 a[218:219],v17 offset:4352
ds_read_b64_tr_b16 a[220:221],v17 offset:4104
ds_read_b64_tr_b16 a[222:223],v17 offset:4360
s_waitcnt lgkmcnt(0)
ds_read_b64_tr_b16 a[228:229],v17 offset:6144
ds_read_b64_tr_b16 a[230:231],v17 offset:6400
ds_read_b64_tr_b16 a[232:233],v17 offset:6152
ds_read_b64_tr_b16 a[234:235],v17 offset:6408
ds_read_b64_tr_b16 a[240:241],v17 offset:8192
ds_read_b64_tr_b16 a[242:243],v17 offset:8448
ds_read_b64_tr_b16 a[244:245],v17 offset:8200
ds_read_b64_tr_b16 a[246:247],v17 offset:8456
ds_read_b64_tr_b16 a[252:253],v17 offset:10240
ds_read_b64_tr_b16 a[254:255],v17 offset:10496
ds_read_b64_tr_b16 v[128:129],v17 offset:10248
ds_read_b64_tr_b16 v[130:131],v17 offset:10504
s_waitcnt lgkmcnt(0)
ds_read_b64_tr_b16 v[136:137],v17 offset:12288
ds_read_b64_tr_b16 v[138:139],v17 offset:12544
ds_read_b64_tr_b16 v[140:141],v17 offset:12296
ds_read_b64_tr_b16 v[142:143],v17 offset:12552
ds_read_b64_tr_b16 v[148:149],v17 offset:14336
ds_read_b64_tr_b16 v[150:151],v17 offset:14592
ds_read_b64_tr_b16 v[152:153],v17 offset:14344
ds_read_b64_tr_b16 v[154:155],v17 offset:14600
s_waitcnt lgkmcnt(0)
s_add_u32 s62,s53,6291456
s_add_u32 m0,s61,0
s_nop 0
buffer_load_dwordx4 v16,s[28:31],s62 offen lds
s_add_u32 s62,s62,131072
s_add_u32 m0,m0,1024
s_nop 0
buffer_load_dwordx4 v16,s[28:31],s62 offen lds
s_add_u32 s62,s62,131072
s_add_u32 m0,m0,1024
s_nop 0
buffer_load_dwordx4 v16,s[28:31],s62 offen lds
s_add_u32 s62,s62,131072
s_add_u32 m0,m0,1024
s_nop 0
buffer_load_dwordx4 v16,s[28:31],s62 offen lds
s_add_u32 s62,s62,131072
s_add_u32 m0,m0,1024
s_nop 0
buffer_load_dwordx4 v16,s[28:31],s62 offen lds
s_add_u32 s62,s62,131072
s_add_u32 m0,m0,1024
s_nop 0
buffer_load_dwordx4 v16,s[28:31],s62 offen lds
s_add_u32 s62,s62,131072
s_add_u32 m0,m0,1024
s_nop 0
buffer_load_dwordx4 v16,s[28:31],s62 offen lds
s_add_u32 s62,s62,131072
s_add_u32 m0,m0,1024
s_nop 0
buffer_load_dwordx4 v16,s[28:31],s62 offen lds
s_add_u32 s62,s62,131072
s_add_u32 m0,m0,1024
s_nop 0
buffer_load_dwordx4 v16,s[28:31],s62 offen lds
s_add_u32 s62,s62,131072
s_add_u32 m0,m0,1024
s_nop 0
buffer_load_dwordx4 v16,s[28:31],s62 offen lds
s_add_u32 s62,s62,131072
s_add_u32 m0,m0,1024
s_nop 0
buffer_load_dwordx4 v16,s[28:31],s62 offen lds
s_add_u32 s62,s62,131072
s_add_u32 m0,m0,1024
s_nop 0
buffer_load_dwordx4 v16,s[28:31],s62 offen lds
s_add_u32 s62,s62,131072
s_add_u32 m0,m0,1024
s_nop 0
buffer_load_dwordx4 v16,s[28:31],s62 offen lds
s_add_u32 s62,s62,131072
s_add_u32 m0,m0,1024
s_nop 0
buffer_load_dwordx4 v16,s[28:31],s62 offen lds
s_add_u32 s62,s62,131072
s_add_u32 m0,m0,1024
s_nop 0
buffer_load_dwordx4 v16,s[28:31],s62 offen lds
s_add_u32 s62,s62,131072
s_add_u32 m0,m0,1024
s_nop 0
buffer_load_dwordx4 v16,s[28:31],s62 offen lds
s_waitcnt vmcnt(16)
ds_read_b64_tr_b16 a[200:201],v18 offset:16384
ds_read_b64_tr_b16 a[202:203],v18 offset:16640
ds_read_b64_tr_b16 a[212:213],v18 offset:18432
ds_read_b64_tr_b16 a[214:215],v18 offset:18688
ds_read_b64_tr_b16 a[224:225],v18 offset:20480
ds_read_b64_tr_b16 a[226:227],v18 offset:20736
ds_read_b64_tr_b16 a[236:237],v18 offset:22528
ds_read_b64_tr_b16 a[238:239],v18 offset:22784
ds_read_b64_tr_b16 a[248:249],v18 offset:24576
ds_read_b64_tr_b16 a[250:251],v18 offset:24832
ds_read_b64_tr_b16 v[132:133],v18 offset:26624
ds_read_b64_tr_b16 v[134:135],v18 offset:26880
s_waitcnt lgkmcnt(0)
ds_read_b64_tr_b16 v[144:145],v18 offset:28672
ds_read_b64_tr_b16 v[146:147],v18 offset:28928
ds_read_b64_tr_b16 v[156:157],v18 offset:30720
ds_read_b64_tr_b16 v[158:159],v18 offset:30976
s_waitcnt lgkmcnt(0)
s_add_u32 s62,s52,6291456
s_add_u32 m0,s61,16384
s_nop 0
buffer_load_dwordx4 v16,s[32:35],s62 offen lds
s_add_u32 s62,s62,131072
s_add_u32 m0,m0,1024
s_nop 0
buffer_load_dwordx4 v16,s[32:35],s62 offen lds
s_add_u32 s62,s62,131072
s_add_u32 m0,m0,1024
s_nop 0
buffer_load_dwordx4 v16,s[32:35],s62 offen lds
s_add_u32 s62,s62,131072
s_add_u32 m0,m0,1024
s_nop 0
buffer_load_dwordx4 v16,s[32:35],s62 offen lds
s_add_u32 s62,s62,131072
s_add_u32 m0,m0,1024
s_nop 0
buffer_load_dwordx4 v16,s[32:35],s62 offen lds
s_add_u32 s62,s62,131072
s_add_u32 m0,m0,1024
s_nop 0
buffer_load_dwordx4 v16,s[32:35],s62 offen lds
s_add_u32 s62,s62,131072
s_add_u32 m0,m0,1024
s_nop 0
buffer_load_dwordx4 v16,s[32:35],s62 offen lds
s_add_u32 s62,s62,131072
s_add_u32 m0,m0,1024
s_nop 0
buffer_load_dwordx4 v16,s[32:35],s62 offen lds
s_add_u32 s62,s62,131072
s_add_u32 m0,m0,1024
s_nop 0
buffer_load_dwordx4 v16,s[32:35],s62 offen lds
s_add_u32 s62,s62,131072
s_add_u32 m0,m0,1024
s_nop 0
buffer_load_dwordx4 v16,s[32:35],s62 offen lds
s_add_u32 s62,s62,131072
s_add_u32 m0,m0,1024
s_nop 0
buffer_load_dwordx4 v16,s[32:35],s62 offen lds
s_add_u32 s62,s62,131072
s_add_u32 m0,m0,1024
s_nop 0
buffer_load_dwordx4 v16,s[32:35],s62 offen lds
s_add_u32 s62,s62,131072
s_add_u32 m0,m0,1024
s_nop 0
buffer_load_dwordx4 v16,s[32:35],s62 offen lds
s_add_u32 s62,s62,131072
s_add_u32 m0,m0,1024
s_nop 0
buffer_load_dwordx4 v16,s[32:35],s62 offen lds
s_add_u32 s62,s62,131072
s_add_u32 m0,m0,1024
s_nop 0
buffer_load_dwordx4 v16,s[32:35],s62 offen lds
s_add_u32 s62,s62,131072
s_add_u32 m0,m0,1024
s_nop 0
buffer_load_dwordx4 v16,s[32:35],s62 offen lds
s_waitcnt vmcnt(16)
ds_read_b64_tr_b16 v[160:161],v17 offset:0
ds_read_b64_tr_b16 v[162:163],v17 offset:256
ds_read_b64_tr_b16 v[164:165],v17 offset:8
ds_read_b64_tr_b16 v[166:167],v17 offset:264
ds_read_b64_tr_b16 v[172:173],v17 offset:2048
ds_read_b64_tr_b16 v[174:175],v17 offset:2304
ds_read_b64_tr_b16 v[176:177],v17 offset:2056
ds_read_b64_tr_b16 v[178:179],v17 offset:2312
ds_read_b64_tr_b16 v[184:185],v17 offset:4096
ds_read_b64_tr_b16 v[186:187],v17 offset:4352
ds_read_b64_tr_b16 v[188:189],v17 offset:4104
ds_read_b64_tr_b16 v[190:191],v17 offset:4360
s_waitcnt lgkmcnt(0)
ds_read_b64_tr_b16 v[196:197],v17 offset:6144
ds_read_b64_tr_b16 v[198:199],v17 offset:6400
ds_read_b64_tr_b16 v[200:201],v17 offset:6152
ds_read_b64_tr_b16 v[202:203],v17 offset:6408
ds_read_b64_tr_b16 v[208:209],v17 offset:8192
ds_read_b64_tr_b16 v[210:211],v17 offset:8448
ds_read_b64_tr_b16 v[212:213],v17 offset:8200
ds_read_b64_tr_b16 v[214:215],v17 offset:8456
ds_read_b64_tr_b16 v[220:221],v17 offset:10240
ds_read_b64_tr_b16 v[222:223],v17 offset:10496
ds_read_b64_tr_b16 v[224:225],v17 offset:10248
ds_read_b64_tr_b16 v[226:227],v17 offset:10504
s_waitcnt lgkmcnt(0)
ds_read_b64_tr_b16 v[232:233],v17 offset:12288
ds_read_b64_tr_b16 v[234:235],v17 offset:12544
ds_read_b64_tr_b16 v[236:237],v17 offset:12296
ds_read_b64_tr_b16 v[238:239],v17 offset:12552
ds_read_b64_tr_b16 v[244:245],v17 offset:14336
ds_read_b64_tr_b16 v[246:247],v17 offset:14592
ds_read_b64_tr_b16 v[248:249],v17 offset:14344
ds_read_b64_tr_b16 v[250:251],v17 offset:14600
s_waitcnt lgkmcnt(0)
s_waitcnt vmcnt(0)
ds_read_b64_tr_b16 v[168:169],v18 offset:16384
ds_read_b64_tr_b16 v[170:171],v18 offset:16640
ds_read_b64_tr_b16 v[180:181],v18 offset:18432
ds_read_b64_tr_b16 v[182:183],v18 offset:18688
ds_read_b64_tr_b16 v[192:193],v18 offset:20480
ds_read_b64_tr_b16 v[194:195],v18 offset:20736
ds_read_b64_tr_b16 v[204:205],v18 offset:22528
ds_read_b64_tr_b16 v[206:207],v18 offset:22784
ds_read_b64_tr_b16 v[216:217],v18 offset:24576
ds_read_b64_tr_b16 v[218:219],v18 offset:24832
ds_read_b64_tr_b16 v[228:229],v18 offset:26624
ds_read_b64_tr_b16 v[230:231],v18 offset:26880
s_waitcnt lgkmcnt(0)
ds_read_b64_tr_b16 v[240:241],v18 offset:28672
ds_read_b64_tr_b16 v[242:243],v18 offset:28928
ds_read_b64_tr_b16 v[252:253],v18 offset:30720
ds_read_b64_tr_b16 v[254:255],v18 offset:30976
s_waitcnt lgkmcnt(0)
s_mov_b32 s67,0
s_cmp_eq_u32 s56,1
s_cbranch_scc1 vok_21
v_mbcnt_lo_u32_b32 v16,-1,0
v_and_b32 v16,7,v16
v_lshlrev_b32 v16,7,v16
s_mov_b32 s64,138510336
vpoll_22:
buffer_load_dword v17,v16,s[20:23],s64 offen sc1
s_waitcnt vmcnt(0)
v_readlane_b32 s92,v17,0
v_readlane_b32 s93,v17,1
v_readlane_b32 s94,v17,2
v_readlane_b32 s95,v17,3
v_readlane_b32 s96,v17,4
v_readlane_b32 s97,v17,5
v_readlane_b32 s98,v17,6
v_readlane_b32 s99,v17,7
s_add_u32 s65,s92,s93
s_add_u32 s65,s65,s94
s_add_u32 s65,s65,s95
s_add_u32 s65,s65,s96
s_add_u32 s65,s65,s97
s_add_u32 s65,s65,s98
s_add_u32 s65,s65,s99
s_cmp_ge_u32 s65,256
s_cbranch_scc1 vgot_23
s_sleep 4
s_sub_u32 s90,s90,1
s_cmp_gt_i32 s90,0
s_cbranch_scc1 vpoll_22
vgot_23:
s_min_u32 s65,s92,s93
s_min_u32 s65,s65,s94
s_min_u32 s65,s65,s95
s_min_u32 s65,s65,s96
s_min_u32 s65,s65,s97
s_min_u32 s65,s65,s98
s_min_u32 s65,s65,s99
s_cmp_lt_u32 s65,32
s_cbranch_scc1 fl_slow
s_mov_b32 s56,0
pp_24:
buffer_load_dword v17,off,s[20:23],s64 offset:1024 sc1
s_waitcnt vmcnt(0)
v_readfirstlane_b32 s65,v17
s_cmp_lg_u32 s65,0
s_cbranch_scc1 pg_25
s_sleep 4
s_sub_u32 s90,s90,1
s_cmp_gt_i32 s90,0
s_cbranch_scc1 pp_24
pg_25:
s_and_b32 s65,s65,2
s_lshl_b32 s67,s65,12
vok_21:
s_barrier
v_lshlrev_b32 v0,4,v1
s_mov_b32 s60,0
s_lshl_b32 s63,s50,13
s_add_u32 s61,s63,146800640
s_mov_b32 s70,0
s_lshl_b32 s52,s59,14
s_and_b32 s64,s50,1
s_lshl_b32 s64,s64,11
s_add_u32 s53,s52,s64
s_lshl_b32 s64,s50,10
s_add_u32 s52,s52,s64
s_add_u32 s52,s52,4096
s_cmp_gt_u32 s50,1
s_cselect_b32 s54,0x2000,0
s_lshl_b32 s69,s59,6
s_add_u32 s69,s69,s67
s_add_u32 s69,s69,138412032
v_mov_b32 v4,v0
v_add_u32 v5,32768,v0
s_add_u32 m0,s70,s63
s_add_u32 s62,s61,4096
buffer_load_dwordx4 v0,s[20:23],s61 offen offset:0 lds
buffer_load_dwordx4 v0,s[20:23],s61 offen offset:1024 lds
buffer_load_dwordx4 v0,s[20:23],s61 offen offset:2048 lds
buffer_load_dwordx4 v0,s[20:23],s61 offen offset:3072 lds
s_add_u32 m0,m0,4096
s_nop 0
buffer_load_dwordx4 v0,s[20:23],s62 offen offset:0 lds
buffer_load_dwordx4 v0,s[20:23],s62 offen offset:1024 lds
buffer_load_dwordx4 v0,s[20:23],s62 offen offset:2048 lds
buffer_load_dwordx4 v0,s[20:23],s62 offen offset:3072 lds
s_add_u32 s61,s61,32768
s_add_u32 s70,s70,32768
s_and_b32 s70,s70,0x1ffff
s_add_u32 m0,s70,s63
s_add_u32 s62,s61,4096
buffer_load_dwordx4 v0,s[20:23],s61 offen offset:0 lds
buffer_load_dwordx4 v0,s[20:23],s61 offen offset:1024 lds
buffer_load_dwordx4 v0,s[20:23],s61 offen offset:2048 lds
buffer_load_dwordx4 v0,s[20:23],s61 offen offset:3072 lds
s_add_u32 m0,m0,4096
s_nop 0
buffer_load_dwordx4 v0,s[20:23],s62 offen offset:0 lds
buffer_load_dwordx4 v0,s[20:23],s62 offen offset:1024 lds
buffer_load_dwordx4 v0,s[20:23],s62 offen offset:2048 lds
buffer_load_dwordx4 v0,s[20:23],s62 offen offset:3072 lds
s_add_u32 s61,s61,32768
s_add_u32 s70,s70,32768
s_and_b32 s70,s70,0x1ffff
s_waitcnt vmcnt(8)
s_barrier
ds_read_b128 v[64:67],v4 offset:0
ds_read_b128 v[68:71],v4 offset:1024
ds_read_b128 v[72:75],v4 offset:2048
ds_read_b128 v[76:79],v4 offset:3072
ds_read_b128 v[80:83],v4 offset:4096
top_26:
s_waitcnt lgkmcnt(4)
v_mfma_f32_16x16x32_bf16 v[32:35],a[0:3],v[64:67],0
ds_read_b128 v[84:87],v4 offset:5120
v_mfma_f32_16x16x32_bf16 v[36:39],a[4:7],v[64:67],0
v_mfma_f32_16x16x32_bf16 v[40:43],v[64:67],a[8:11],0
s_waitcnt lgkmcnt(4)
v_mfma_f32_16x16x32_bf16 v[32:35],a[12:15],v[68:71],v[32:35]
ds_read_b128 v[88:91],v4 offset:6144
s_sub_u32 s66,s60,1
s_lshr_b32 s64,s66,1
v_mfma_f32_16x16x32_bf16 v[36:39],a[16:19],v[68:71],v[36:39]
s_lshl_b32 s65,s64,12
s_and_b32 s65,s65,0x2000
v_mfma_f32_16x16x32_bf16 v[40:43],v[68:71],a[20:23],v[40:43]
s_xor_b32 s65,s65,s67
s_lshl_b32 s64,s64,20
s_waitcnt lgkmcnt(4)
v_mfma_f32_16x16x32_bf16 v[32:35],a[24:27],v[72:75],v[32:35]
ds_read_b128 v[92:95],v4 offset:7168
s_add_u32 s64,s64,s65
s_add_u32 s65,s64,s52
v_mfma_f32_16x16x32_bf16 v[36:39],a[28:31],v[72:75],v[36:39]
s_xor_b32 s64,s64,s54
s_add_u32 s66,s64,s53
v_mfma_f32_16x16x32_bf16 v[40:43],v[72:75],a[32:35],v[40:43]
s_cmp_eq_u32 s60,0
s_cselect_b32 s65,138608640,s65
s_waitcnt lgkmcnt(4)
v_mfma_f32_16x16x32_bf16 v[32:35],a[36:39],v[76:79],v[32:35]
ds_read_b128 v[96:99],v4 offset:8192
s_cselect_b32 s66,138608640,s66
v_mfma_f32_16x16x32_bf16 v[36:39],a[40:43],v[76:79],v[36:39]
v_cvt_pk_bf16_f32 v60,v44,v45
v_mfma_f32_16x16x32_bf16 v[40:43],v[76:79],a[44:47],v[40:43]
v_cvt_pk_bf16_f32 v61,v46,v47
s_waitcnt lgkmcnt(4)
v_mfma_f32_16x16x32_bf16 v[32:35],a[48:51],v[80:83],v[32:35]
ds_read_b128 v[100:103],v4 offset:9216
v_cvt_pk_bf16_f32 v62,v48,v49
v_mfma_f32_16x16x32_bf16 v[36:39],a[52:55],v[80:83],v[36:39]
v_cvt_pk_bf16_f32 v63,v50,v51
v_mfma_f32_16x16x32_bf16 v[40:43],v[80:83],a[56:59],v[40:43]
v_cvt_pk_bf16_f32 v58,v52,v53
s_waitcnt lgkmcnt(4)
v_mfma_f32_16x16x32_bf16 v[32:35],a[60:63],v[84:87],v[32:35]
ds_read_b128 v[104:107],v4 offset:10240
v_cvt_pk_bf16_f32 v59,v54,v55
v_mfma_f32_16x16x32_bf16 v[36:39],a[64:67],v[84:87],v[36:39]
buffer_store_dwordx4 v[60:63],v0,s[20:23],s66 offen offset:1024 sc1
v_mfma_f32_16x16x32_bf16 v[40:43],v[84:87],a[68:71],v[40:43]
buffer_store_dwordx4 v[56:59],v0,s[20:23],s65 offen sc1
s_waitcnt lgkmcnt(4)
v_mfma_f32_16x16x32_bf16 v[32:35],a[72:75],v[88:91],v[32:35]
ds_read_b128 v[108:111],v4 offset:11264
v_mfma_f32_16x16x32_bf16 v[36:39],a[76:79],v[88:91],v[36:39]
v_mfma_f32_16x16x32_bf16 v[40:43],v[88:91],a[80:83],v[40:43]
s_waitcnt lgkmcnt(4)
v_mfma_f32_16x16x32_bf16 v[32:35],a[84:87],v[92:95],v[32:35]
ds_read_b128 v[112:115],v4 offset:12288
v_mfma_f32_16x16x32_bf16 v[36:39],a[88:91],v[92:95],v[36:39]
v_mfma_f32_16x16x32_bf16 v[40:43],v[92:95],a[92:95],v[40:43]
s_waitcnt lgkmcnt(4)
v_mfma_f32_16x16x32_bf16 v[32:35],a[96:99],v[96:99],v[32:35]
ds_read_b128 v[116:119],v4 offset:13312
v_mfma_f32_16x16x32_bf16 v[36:39],a[100:103],v[96:99],v[36:39]
v_mfma_f32_16x16x32_bf16 v[40:43],v[96:99],a[104:107],v[40:43]
s_waitcnt lgkmcnt(4)
v_mfma_f32_16x16x32_bf16 v[32:35],a[108:111],v[100:103],v[32:35]
ds_read_b128 v[120:123],v4 offset:14336
v_mfma_f32_16x16x32_bf16 v[36:39],a[112:115],v[100:103],v[36:39]
v_mfma_f32_16x16x32_bf16 v[40:43],v[100:103],a[116:119],v[40:43]
s_waitcnt lgkmcnt(4)
v_mfma_f32_16x16x32_bf16 v[32:35],a[120:123],v[104:107],v[32:35]
ds_read_b128 v[124:127],v4 offset:15360
v_mfma_f32_16x16x32_bf16 v[36:39],a[124:127],v[104:107],v[36:39]
v_mfma_f32_16x16x32_bf16 v[40:43],v[104:107],a[128:131],v[40:43]
s_waitcnt lgkmcnt(4)
v_mfma_f32_16x16x32_bf16 v[32:35],a[132:135],v[108:111],v[32:35]
ds_read_b128 v[64:67],v4 offset:16384
v_mfma_f32_16x16x32_bf16 v[36:39],a[136:139],v[108:111],v[36:39]
v_mfma_f32_16x16x32_bf16 v[40:43],v[108:111],a[140:143],v[40:43]
s_waitcnt lgkmcnt(4)
v_mfma_f32_16x16x32_bf16 v[32:35],a[144:147],v[112:115],v[32:35]
ds_read_b128 v[68:71],v4 offset:17408
v_mfma_f32_16x16x32_bf16 v[36:39],a[148:151],v[112:115],v[36:39]
v_mfma_f32_16x16x32_bf16 v[40:43],v[112:115],a[152:155],v[40:43]
s_waitcnt lgkmcnt(4)
v_mfma_f32_16x16x32_bf16 v[32:35],a[156:159],v[116:119],v[32:35]
ds_read_b128 v[72:75],v4 offset:18432
v_mfma_f32_16x16x32_bf16 v[36:39],a[160:163],v[116:119],v[36:39]
v_mfma_f32_16x16x32_bf16 v[40:43],v[116:119],a[164:167],v[40:43]
s_waitcnt lgkmcnt(4)
v_mfma_f32_16x16x32_bf16 v[32:35],a[168:171],v[120:123],v[32:35]
ds_read_b128 v[76:79],v4 offset:19456
v_mfma_f32_16x16x32_bf16 v[36:39],a[172:175],v[120:123],v[36:39]
v_mfma_f32_16x16x32_bf16 v[40:43],v[120:123],a[176:179],v[40:43]
s_waitcnt lgkmcnt(4)
v_mfma_f32_16x16x32_bf16 v[32:35],a[180:183],v[124:127],v[32:35]
ds_read_b128 v[80:83],v4 offset:20480
v_mfma_f32_16x16x32_bf16 v[36:39],a[184:187],v[124:127],v[36:39]
s_waitcnt vmcnt(2)
s_cmp_lg_u32 s60,2
s_cbranch_scc1 sk_28
s_waitcnt vmcnt(0)
sk_28:
s_cselect_b32 s64,1,s50
s_barrier
s_cmp_ge_u32 s60,126
s_cselect_b32 s61,146800640,s61
s_cmp_lg_u32 s64,0
s_cbranch_scc1 nf_27
s_lshr_b32 s64,s60,1
v_mov_b32 v6,s64
s_mov_b64 exec,1
buffer_store_dword v6,off,s[20:23],s69 sc1
s_mov_b64 exec,-1
nf_27:
v_mfma_f32_16x16x32_bf16 v[40:43],v[124:127],a[188:191],v[40:43]
s_waitcnt lgkmcnt(4)
v_mfma_f32_16x16x32_bf16 v[32:35],a[192:195],v[64:67],v[32:35]
ds_read_b128 v[84:87],v4 offset:21504
s_add_u32 m0,s70,s63
v_mfma_f32_16x16x32_bf16 v[36:39],a[196:199],v[64:67],v[36:39]
v_mfma_f32_16x16x32_bf16 v[40:43],v[64:67],a[200:203],v[40:43]
s_add_u32 s62,s61,4096
s_waitcnt lgkmcnt(4)
v_mfma_f32_16x16x32_bf16 v[32:35],a[204:207],v[68:71],v[32:35]
ds_read_b128 v[88:91],v4 offset:22528
v_mfma_f32_16x16x32_bf16 v[36:39],a[208:211],v[68:71],v[36:39]
buffer_load_dwordx4 v0,s[20:23],s61 offen offset:0 lds
v_mfma_f32_16x16x32_bf16 v[40:43],v[68:71],a[212:215],v[40:43]
s_waitcnt lgkmcnt(4)
v_mfma_f32_16x16x32_bf16 v[32:35],a[216:219],v[72:75],v[32:35]
ds_read_b128 v[92:95],v4 offset:23552
buffer_load_dwordx4 v0,s[20:23],s61 offen offset:1024 lds
v_mfma_f32_16x16x32_bf16 v[36:39],a[220:223],v[72:75],v[36:39]
v_mfma_f32_16x16x32_bf16 v[40:43],v[72:75],a[224:227],v[40:43]
buffer_load_dwordx4 v0,s[20:23],s61 offen offset:2048 lds
s_waitcnt lgkmcnt(4)
v_mfma_f32_16x16x32_bf16 v[32:35],a[228:231],v[76:79],v[32:35]
ds_read_b128 v[96:99],v4 offset:24576
v_mfma_f32_16x16x32_bf16 v[36:39],a[232:235],v[76:79],v[36:39]
buffer_load_dwordx4 v0,s[20:23],s61 offen offset:3072 lds
v_mfma_f32_16x16x32_bf16 v[40:43],v[76:79],a[236:239],v[40:43]
s_waitcnt lgkmcnt(4)
v_mfma_f32_16x16x32_bf16 v[32:35],a[240:243],v[80:83],v[32:35]
ds_read_b128 v[100:103],v4 offset:25600
s_add_u32 m0,m0,4096
v_mfma_f32_16x16x32_bf16 v[36:39],a[244:247],v[80:83],v[36:39]
v_mfma_f32_16x16x32_bf16 v[40:43],v[80:83],a[248:251],v[40:43]
buffer_load_dwordx4 v0,s[20:23],s62 offen offset:0 lds
s_waitcnt lgkmcnt(4)
v_mfma_f32_16x16x32_bf16 v[32:35],a[252:255],v[84:87],v[32:35]
ds_read_b128 v[104:107],v4 offset:26624
v_mfma_f32_16x16x32_bf16 v[36:39],v[128:131],v[84:87],v[36:39]
buffer_load_dwordx4 v0,s[20:23],s62 offen offset:1024 lds
v_mfma_f32_16x16x32_bf16 v[40:43],v[84:87],v[132:135],v[40:43]
s_waitcnt lgkmcnt(4)
v_mfma_f32_16x16x32_bf16 v[32:35],v[136:139],v[88:91],v[32:35]
ds_read_b128 v[108:111],v4 offset:27648
buffer_load_dwordx4 v0,s[20:23],s62 offen offset:2048 lds
v_mfma_f32_16x16x32_bf16 v[36:39],v[140:143],v[88:91],v[36:39]
v_mfma_f32_16x16x32_bf16 v[40:43],v[88:91],v[144:147],v[40:43]
buffer_load_dwordx4 v0,s[20:23],s62 offen offset:3072 lds
s_waitcnt lgkmcnt(4)
v_mfma_f32_16x16x32_bf16 v[32:35],v[148:151],v[92:95],v[32:35]
ds_read_b128 v[112:115],v4 offset:28672
v_mfma_f32_16x16x32_bf16 v[36:39],v[152:155],v[92:95],v[36:39]
s_add_u32 s61,s61,32768
v_mfma_f32_16x16x32_bf16 v[40:43],v[92:95],v[156:159],v[40:43]
s_waitcnt lgkmcnt(4)
v_mfma_f32_16x16x32_bf16 v[32:35],v[160:163],v[96:99],v[32:35]
ds_read_b128 v[116:119],v4 offset:29696
s_add_u32 s70,s70,32768
v_mfma_f32_16x16x32_bf16 v[36:39],v[164:167],v[96:99],v[36:39]
v_mfma_f32_16x16x32_bf16 v[40:43],v[96:99],v[168:171],v[40:43]
s_and_b32 s70,s70,0x1ffff
s_waitcnt lgkmcnt(4)
v_mfma_f32_16x16x32_bf16 v[32:35],v[172:175],v[100:103],v[32:35]
ds_read_b128 v[120:123],v4 offset:30720
v_mfma_f32_16x16x32_bf16 v[36:39],v[176:179],v[100:103],v[36:39]
v_mfma_f32_16x16x32_bf16 v[40:43],v[100:103],v[180:183],v[40:43]
s_waitcnt lgkmcnt(4)
v_mfma_f32_16x16x32_bf16 v[32:35],v[184:187],v[104:107],v[32:35]
ds_read_b128 v[124:127],v4 offset:31744
v_mfma_f32_16x16x32_bf16 v[36:39],v[188:191],v[104:107],v[36:39]
v_mfma_f32_16x16x32_bf16 v[40:43],v[104:107],v[192:195],v[40:43]
s_waitcnt lgkmcnt(4)
v_mfma_f32_16x16x32_bf16 v[32:35],v[196:199],v[108:111],v[32:35]
ds_read_b128 v[64:67],v5 offset:0
v_mfma_f32_16x16x32_bf16 v[36:39],v[200:203],v[108:111],v[36:39]
v_mfma_f32_16x16x32_bf16 v[40:43],v[108:111],v[204:207],v[40:43]
s_waitcnt lgkmcnt(4)
v_mfma_f32_16x16x32_bf16 v[32:35],v[208:211],v[112:115],v[32:35]
ds_read_b128 v[68:71],v5 offset:1024
v_mfma_f32_16x16x32_bf16 v[36:39],v[212:215],v[112:115],v[36:39]
v_mfma_f32_16x16x32_bf16 v[40:43],v[112:115],v[216:219],v[40:43]
s_waitcnt lgkmcnt(4)
v_mfma_f32_16x16x32_bf16 v[32:35],v[220:223],v[116:119],v[32:35]
ds_read_b128 v[72:75],v5 offset:2048
v_mfma_f32_16x16x32_bf16 v[36:39],v[224:227],v[116:119],v[36:39]
v_mfma_f32_16x16x32_bf16 v[40:43],v[116:119],v[228:231],v[40:43]
s_waitcnt lgkmcnt(4)
v_mfma_f32_16x16x32_bf16 v[32:35],v[232:235],v[120:123],v[32:35]
ds_read_b128 v[76:79],v5 offset:3072
v_mfma_f32_16x16x32_bf16 v[36:39],v[236:239],v[120:123],v[36:39]
v_mfma_f32_16x16x32_bf16 v[40:43],v[120:123],v[240:243],v[40:43]
s_waitcnt lgkmcnt(4)
v_mfma_f32_16x16x32_bf16 v[32:35],v[244:247],v[124:127],v[32:35]
ds_read_b128 v[80:83],v5 offset:4096
v_mfma_f32_16x16x32_bf16 v[36:39],v[248:251],v[124:127],v[36:39]
v_mfma_f32_16x16x32_bf16 v[40:43],v[124:127],v[252:255],v[40:43]
v_mov_b32 v4,v5
v_add_u32 v5,32768,v5
v_and_b32 v5,0x1ffff,v5
s_add_u32 s60,s60,1
s_waitcnt lgkmcnt(4)
v_mfma_f32_16x16x32_bf16 v[44:47],a[0:3],v[64:67],0
ds_read_b128 v[84:87],v4 offset:5120
v_mfma_f32_16x16x32_bf16 v[48:51],a[4:7],v[64:67],0
v_mfma_f32_16x16x32_bf16 v[52:55],v[64:67],a[8:11],0
s_waitcnt lgkmcnt(4)
v_mfma_f32_16x16x32_bf16 v[44:47],a[12:15],v[68:71],v[44:47]
ds_read_b128 v[88:91],v4 offset:6144
s_sub_u32 s66,s60,1
s_lshr_b32 s64,s66,1
v_mfma_f32_16x16x32_bf16 v[48:51],a[16:19],v[68:71],v[48:51]
s_lshl_b32 s65,s64,12
s_and_b32 s65,s65,0x2000
v_mfma_f32_16x16x32_bf16 v[52:55],v[68:71],a[20:23],v[52:55]
s_xor_b32 s65,s65,s67
s_lshl_b32 s64,s64,20
s_waitcnt lgkmcnt(4)
v_mfma_f32_16x16x32_bf16 v[44:47],a[24:27],v[72:75],v[44:47]
ds_read_b128 v[92:95],v4 offset:7168
s_add_u32 s64,s64,s65
s_add_u32 s65,s64,s52
v_mfma_f32_16x16x32_bf16 v[48:51],a[28:31],v[72:75],v[48:51]
s_xor_b32 s64,s64,s54
s_add_u32 s66,s64,s53
v_mfma_f32_16x16x32_bf16 v[52:55],v[72:75],a[32:35],v[52:55]
v_cvt_pk_bf16_f32 v60,v32,v33
v_cvt_pk_bf16_f32 v61,v34,v35
s_waitcnt lgkmcnt(4)
v_mfma_f32_16x16x32_bf16 v[44:47],a[36:39],v[76:79],v[44:47]
ds_read_b128 v[96:99],v4 offset:8192
v_cvt_pk_bf16_f32 v62,v36,v37
v_mfma_f32_16x16x32_bf16 v[48:51],a[40:43],v[76:79],v[48:51]
v_cvt_pk_bf16_f32 v63,v38,v39
v_mfma_f32_16x16x32_bf16 v[52:55],v[76:79],a[44:47],v[52:55]
v_cvt_pk_bf16_f32 v56,v40,v41
s_waitcnt lgkmcnt(4)
v_mfma_f32_16x16x32_bf16 v[44:47],a[48:51],v[80:83],v[44:47]
ds_read_b128 v[100:103],v4 offset:9216
v_cvt_pk_bf16_f32 v57,v42,v43
v_mfma_f32_16x16x32_bf16 v[48:51],a[52:55],v[80:83],v[48:51]
buffer_store_dwordx4 v[60:63],v0,s[20:23],s66 offen offset:0 sc1
v_mfma_f32_16x16x32_bf16 v[52:55],v[80:83],a[56:59],v[52:55]
s_waitcnt lgkmcnt(4)
v_mfma_f32_16x16x32_bf16 v[44:47],a[60:63],v[84:87],v[44:47]
ds_read_b128 v[104:107],v4 offset:10240
v_mfma_f32_16x16x32_bf16 v[48:51],a[64:67],v[84:87],v[48:51]
v_mfma_f32_16x16x32_bf16 v[52:55],v[84:87],a[68:71],v[52:55]
s_waitcnt lgkmcnt(4)
v_mfma_f32_16x16x32_bf16 v[44:47],a[72:75],v[88:91],v[44:47]
ds_read_b128 v[108:111],v4 offset:11264
v_mfma_f32_16x16x32_bf16 v[48:51],a[76:79],v[88:91],v[48:51]
v_mfma_f32_16x16x32_bf16 v[52:55],v[88:91],a[80:83],v[52:55]
s_waitcnt lgkmcnt(4)
v_mfma_f32_16x16x32_bf16 v[44:47],a[84:87],v[92:95],v[44:47]
ds_read_b128 v[112:115],v4 offset:12288
v_mfma_f32_16x16x32_bf16 v[48:51],a[88:91],v[92:95],v[48:51]
v_mfma_f32_16x16x32_bf16 v[52:55],v[92:95],a[92:95],v[52:55]
s_waitcnt lgkmcnt(4)
v_mfma_f32_16x16x32_bf16 v[44:47],a[96:99],v[96:99],v[44:47]
ds_read_b128 v[116:119],v4 offset:13312
v_mfma_f32_16x16x32_bf16 v[48:51],a[100:103],v[96:99],v[48:51]
v_mfma_f32_16x16x32_bf16 v[52:55],v[96:99],a[104:107],v[52:55]
s_waitcnt lgkmcnt(4)
v_mfma_f32_16x16x32_bf16 v[44:47],a[108:111],v[100:103],v[44:47]
ds_read_b128 v[120:123],v4 offset:14336
v_mfma_f32_16x16x32_bf16 v[48:51],a[112:115],v[100:103],v[48:51]
v_mfma_f32_16x16x32_bf16 v[52:55],v[100:103],a[116:119],v[52:55]
s_waitcnt lgkmcnt(4)
v_mfma_f32_16x16x32_bf16 v[44:47],a[120:123],v[104:107],v[44:47]
ds_read_b128 v[124:127],v4 offset:15360
v_mfma_f32_16x16x32_bf16 v[48:51],a[124:127],v[104:107],v[48:51]
v_mfma_f32_16x16x32_bf16 v[52:55],v[104:107],a[128:131],v[52:55]
s_waitcnt lgkmcnt(4)
v_mfma_f32_16x16x32_bf16 v[44:47],a[132:135],v[108:111],v[44:47]
ds_read_b128 v[64:67],v4 offset:16384
v_mfma_f32_16x16x32_bf16 v[48:51],a[136:139],v[108:111],v[48:51]
v_mfma_f32_16x16x32_bf16 v[52:55],v[108:111],a[140:143],v[52:55]
s_waitcnt lgkmcnt(4)
v_mfma_f32_16x16x32_bf16 v[44:47],a[144:147],v[112:115],v[44:47]
ds_read_b128 v[68:71],v4 offset:17408
v_mfma_f32_16x16x32_bf16 v[48:51],a[148:151],v[112:115],v[48:51]
v_mfma_f32_16x16x32_bf16 v[52:55],v[112:115],a[152:155],v[52:55]
s_waitcnt lgkmcnt(4)
v_mfma_f32_16x16x32_bf16 v[44:47],a[156:159],v[116:119],v[44:47]
ds_read_b128 v[72:75],v4 offset:18432
v_mfma_f32_16x16x32_bf16 v[48:51],a[160:163],v[116:119],v[48:51]
v_mfma_f32_16x16x32_bf16 v[52:55],v[116:119],a[164:167],v[52:55]
s_waitcnt lgkmcnt(4)
v_mfma_f32_16x16x32_bf16 v[44:47],a[168:171],v[120:123],v[44:47]
ds_read_b128 v[76:79],v4 offset:19456
v_mfma_f32_16x16x32_bf16 v[48:51],a[172:175],v[120:123],v[48:51]
v_mfma_f32_16x16x32_bf16 v[52:55],v[120:123],a[176:179],v[52:55]
s_waitcnt lgkmcnt(4)
v_mfma_f32_16x16x32_bf16 v[44:47],a[180:183],v[124:127],v[44:47]
ds_read_b128 v[80:83],v4 offset:20480
v_mfma_f32_16x16x32_bf16 v[48:51],a[184:187],v[124:127],v[48:51]
s_waitcnt vmcnt(1)
s_mov_b32 s64,s50
s_barrier
s_cmp_ge_u32 s60,126
s_cselect_b32 s61,146800640,s61
s_cmp_lg_u32 s64,0
s_cbranch_scc1 nf_29
s_lshr_b32 s64,s60,1
v_mov_b32 v6,s64
s_mov_b64 exec,1
buffer_store_dword v6,off,s[20:23],s69 sc1
s_mov_b64 exec,-1
nf_29:
v_mfma_f32_16x16x32_bf16 v[52:55],v[124:127],a[188:191],v[52:55]
s_waitcnt lgkmcnt(4)
v_mfma_f32_16x16x32_bf16 v[44:47],a[192:195],v[64:67],v[44:47]
ds_read_b128 v[84:87],v4 offset:21504
s_add_u32 m0,s70,s63
v_mfma_f32_16x16x32_bf16 v[48:51],a[196:199],v[64:67],v[48:51]
v_mfma_f32_16x16x32_bf16 v[52:55],v[64:67],a[200:203],v[52:55]
s_add_u32 s62,s61,4096
s_waitcnt lgkmcnt(4)
v_mfma_f32_16x16x32_bf16 v[44:47],a[204:207],v[68:71],v[44:47]
ds_read_b128 v[88:91],v4 offset:22528
v_mfma_f32_16x16x32_bf16 v[48:51],a[208:211],v[68:71],v[48:51]
buffer_load_dwordx4 v0,s[20:23],s61 offen offset:0 lds
v_mfma_f32_16x16x32_bf16 v[52:55],v[68:71],a[212:215],v[52:55]
s_waitcnt lgkmcnt(4)
v_mfma_f32_16x16x32_bf16 v[44:47],a[216:219],v[72:75],v[44:47]
ds_read_b128 v[92:95],v4 offset:23552
buffer_load_dwordx4 v0,s[20:23],s61 offen offset:1024 lds
v_mfma_f32_16x16x32_bf16 v[48:51],a[220:223],v[72:75],v[48:51]
v_mfma_f32_16x16x32_bf16 v[52:55],v[72:75],a[224:227],v[52:55]
buffer_load_dwordx4 v0,s[20:23],s61 offen offset:2048 lds
s_waitcnt lgkmcnt(4)
v_mfma_f32_16x16x32_bf16 v[44:47],a[228:231],v[76:79],v[44:47]
ds_read_b128 v[96:99],v4 offset:24576
v_mfma_f32_16x16x32_bf16 v[48:51],a[232:235],v[76:79],v[48:51]
buffer_load_dwordx4 v0,s[20:23],s61 offen offset:3072 lds
v_mfma_f32_16x16x32_bf16 v[52:55],v[76:79],a[236:239],v[52:55]
s_waitcnt lgkmcnt(4)
v_mfma_f32_16x16x32_bf16 v[44:47],a[240:243],v[80:83],v[44:47]
ds_read_b128 v[100:103],v4 offset:25600
s_add_u32 m0,m0,4096
v_mfma_f32_16x16x32_bf16 v[48:51],a[244:247],v[80:83],v[48:51]
v_mfma_f32_16x16x32_bf16 v[52:55],v[80:83],a[248:251],v[52:55]
buffer_load_dwordx4 v0,s[20:23],s62 offen offset:0 lds
s_waitcnt lgkmcnt(4)
v_mfma_f32_16x16x32_bf16 v[44:47],a[252:255],v[84:87],v[44:47]
ds_read_b128 v[104:107],v4 offset:26624
v_mfma_f32_16x16x32_bf16 v[48:51],v[128:131],v[84:87],v[48:51]
buffer_load_dwordx4 v0,s[20:23],s62 offen offset:1024 lds
v_mfma_f32_16x16x32_bf16 v[52:55],v[84:87],v[132:135],v[52:55]
s_waitcnt lgkmcnt(4)
v_mfma_f32_16x16x32_bf16 v[44:47],v[136:139],v[88:91],v[44:47]
ds_read_b128 v[108:111],v4 offset:27648
buffer_load_dwordx4 v0,s[20:23],s62 offen offset:2048 lds
v_mfma_f32_16x16x32_bf16 v[48:51],v[140:143],v[88:91],v[48:51]
v_mfma_f32_16x16x32_bf16 v[52:55],v[88:91],v[144:147],v[52:55]
buffer_load_dwordx4 v0,s[20:23],s62 offen offset:3072 lds
s_waitcnt lgkmcnt(4)
v_mfma_f32_16x16x32_bf16 v[44:47],v[148:151],v[92:95],v[44:47]
ds_read_b128 v[112:115],v4 offset:28672
v_mfma_f32_16x16x32_bf16 v[48:51],v[152:155],v[92:95],v[48:51]
s_add_u32 s61,s61,32768
v_mfma_f32_16x16x32_bf16 v[52:55],v[92:95],v[156:159],v[52:55]
s_waitcnt lgkmcnt(4)
v_mfma_f32_16x16x32_bf16 v[44:47],v[160:163],v[96:99],v[44:47]
ds_read_b128 v[116:119],v4 offset:29696
s_add_u32 s70,s70,32768
v_mfma_f32_16x16x32_bf16 v[48:51],v[164:167],v[96:99],v[48:51]
v_mfma_f32_16x16x32_bf16 v[52:55],v[96:99],v[168:171],v[52:55]
s_and_b32 s70,s70,0x1ffff
s_waitcnt lgkmcnt(4)
v_mfma_f32_16x16x32_bf16 v[44:47],v[172:175],v[100:103],v[44:47]
ds_read_b128 v[120:123],v4 offset:30720
v_mfma_f32_16x16x32_bf16 v[48:51],v[176:179],v[100:103],v[48:51]
v_mfma_f32_16x16x32_bf16 v[52:55],v[100:103],v[180:183],v[52:55]
s_waitcnt lgkmcnt(4)
v_mfma_f32_16x16x32_bf16 v[44:47],v[184:187],v[104:107],v[44:47]
ds_read_b128 v[124:127],v4 offset:31744
v_mfma_f32_16x16x32_bf16 v[48:51],v[188:191],v[104:107],v[48:51]
v_mfma_f32_16x16x32_bf16 v[52:55],v[104:107],v[192:195],v[52:55]
s_waitcnt lgkmcnt(4)
v_mfma_f32_16x16x32_bf16 v[44:47],v[196:199],v[108:111],v[44:47]
ds_read_b128 v[64:67],v5 offset:0
v_mfma_f32_16x16x32_bf16 v[48:51],v[200:203],v[108:111],v[48:51]
v_mfma_f32_16x16x32_bf16 v[52:55],v[108:111],v[204:207],v[52:55]
s_waitcnt lgkmcnt(4)
v_mfma_f32_16x16x32_bf16 v[44:47],v[208:211],v[112:115],v[44:47]
ds_read_b128 v[68:71],v5 offset:1024
v_mfma_f32_16x16x32_bf16 v[48:51],v[212:215],v[112:115],v[48:51]
v_mfma_f32_16x16x32_bf16 v[52:55],v[112:115],v[216:219],v[52:55]
s_waitcnt lgkmcnt(4)
v_mfma_f32_16x16x32_bf16 v[44:47],v[220:223],v[116:119],v[44:47]
ds_read_b128 v[72:75],v5 offset:2048
v_mfma_f32_16x16x32_bf16 v[48:51],v[224:227],v[116:119],v[48:51]
v_mfma_f32_16x16x32_bf16 v[52:55],v[116:119],v[228:231],v[52:55]
s_waitcnt lgkmcnt(4)
v_mfma_f32_16x16x32_bf16 v[44:47],v[232:235],v[120:123],v[44:47]
ds_read_b128 v[76:79],v5 offset:3072
v_mfma_f32_16x16x32_bf16 v[48:51],v[236:239],v[120:123],v[48:51]
v_mfma_f32_16x16x32_bf16 v[52:55],v[120:123],v[240:243],v[52:55]
s_waitcnt lgkmcnt(4)
v_mfma_f32_16x16x32_bf16 v[44:47],v[244:247],v[124:127],v[44:47]
ds_read_b128 v[80:83],v5 offset:4096
v_mfma_f32_16x16x32_bf16 v[48:51],v[248:251],v[124:127],v[48:51]
v_mfma_f32_16x16x32_bf16 v[52:55],v[124:127],v[252:255],v[52:55]
v_mov_b32 v4,v5
v_add_u32 v5,32768,v5
v_and_b32 v5,0x1ffff,v5
s_add_u32 s60,s60,1
s_cmp_lt_u32 s60,128
s_cbranch_scc1 top_26
s_sub_u32 s66,s60,1
s_lshr_b32 s64,s66,1
s_lshl_b32 s65,s64,12
s_and_b32 s65,s65,0x2000
s_xor_b32 s65,s65,s67
s_lshl_b32 s64,s64,20
s_add_u32 s64,s64,s65
s_add_u32 s65,s64,s52
s_xor_b32 s64,s64,s54
s_add_u32 s66,s64,s53
s_cmp_eq_u32 s60,0
s_cselect_b32 s65,138608640,s65
s_cselect_b32 s66,138608640,s66
v_cvt_pk_bf16_f32 v60,v44,v45
v_cvt_pk_bf16_f32 v61,v46,v47
v_cvt_pk_bf16_f32 v62,v48,v49
v_cvt_pk_bf16_f32 v63,v50,v51
v_cvt_pk_bf16_f32 v58,v52,v53
v_cvt_pk_bf16_f32 v59,v54,v55
buffer_store_dwordx4 v[60:63],v0,s[20:23],s66 offen offset:1024 sc1
buffer_store_dwordx4 v[56:59],v0,s[20:23],s65 offen sc1
s_waitcnt vmcnt(0) lgkmcnt(0)
s_barrier
s_cmp_lg_u32 s50,0
s_cbranch_scc1 done_20
v_mov_b32 v6,64
s_mov_b64 exec,1
buffer_store_dword v6,off,s[20:23],s69 sc1
s_mov_b64 exec,-1
done_20:
s_endpgm
fl_wo:
v_and_b32 v21,15,v1
v_lshrrev_b32 v22,4,v1
v_lshrrev_b32 v23,2,v21
v_and_b32 v24,3,v21
s_lshl_b32 s61,s50,15
v_lshl_add_u32 v25,v22,3,v23
s_load_dwordx2 s[4:5],s[0:1],40
s_load_dwordx2 s[6:7],s[0:1],0
s_lshr_b32 s52,s59,3
s_and_b32 s53,s59,7
s_mul_i32 s54,s52,2097152
s_lshl_b32 s64,s53,8
s_add_u32 s54,s54,s64
s_lshl_b32 s64,s50,6
s_add_u32 s54,s54,s64
s_waitcnt lgkmcnt(0)
s_mov_b32 s28,s4
s_and_b32 s29,s5,0xffff
s_mov_b32 s30,0x800000
s_mov_b32 s31,0x20000
s_mov_b32 s24,s6
s_and_b32 s25,s7,0xffff
s_mov_b32 s26,0x400000
s_mov_b32 s27,0x20000
v_lshrrev_b32 v26,2,v1
v_and_b32 v27,3,v1
v_mul_u32_u24 v16,2048,v26
v_lshl_add_u32 v16,v27,4,v16
v_lshlrev_b32 v17,6,v25
v_lshl_add_u32 v17,v24,4,v17
v_add_u32 v17,s61,v17
s_xor_b32 s62,s50,0
s_mul_i32 s62,s62,524288
s_add_u32 s62,s62,s54
s_add_u32 m0,s61,0
s_nop 0
buffer_load_dwordx4 v16,s[28:31],s62 offen lds
s_add_u32 s62,s62,32768
s_add_u32 m0,m0,1024
s_nop 0
buffer_load_dwordx4 v16,s[28:31],s62 offen lds
s_add_u32 s62,s62,32768
s_add_u32 m0,m0,1024
s_nop 0
buffer_load_dwordx4 v16,s[28:31],s62 offen lds
s_add_u32 s62,s62,32768
s_add_u32 m0,m0,1024
s_nop 0
buffer_load_dwordx4 v16,s[28:31],s62 offen lds
s_add_u32 s62,s62,32768
s_add_u32 m0,m0,1024
s_nop 0
buffer_load_dwordx4 v16,s[28:31],s62 offen lds
s_add_u32 s62,s62,32768
s_add_u32 m0,m0,1024
s_nop 0
buffer_load_dwordx4 v16,s[28:31],s62 offen lds
s_add_u32 s62,s62,32768
s_add_u32 m0,m0,1024
s_nop 0
buffer_load_dwordx4 v16,s[28:31],s62 offen lds
s_add_u32 s62,s62,32768
s_add_u32 m0,m0,1024
s_nop 0
buffer_load_dwordx4 v16,s[28:31],s62 offen lds
s_add_u32 s62,s62,32768
s_add_u32 m0,m0,1024
s_nop 0
buffer_load_dwordx4 v16,s[28:31],s62 offen lds
s_add_u32 s62,s62,32768
s_add_u32 m0,m0,1024
s_nop 0
buffer_load_dwordx4 v16,s[28:31],s62 offen lds
s_add_u32 s62,s62,32768
s_add_u32 m0,m0,1024
s_nop 0
buffer_load_dwordx4 v16,s[28:31],s62 offen lds
s_add_u32 s62,s62,32768
s_add_u32 m0,m0,1024
s_nop 0
buffer_load_dwordx4 v16,s[28:31],s62 offen lds
s_add_u32 s62,s62,32768
s_add_u32 m0,m0,1024
s_nop 0
buffer_load_dwordx4 v16,s[28:31],s62 offen lds
s_add_u32 s62,s62,32768
s_add_u32 m0,m0,1024
s_nop 0
buffer_load_dwordx4 v16,s[28:31],s62 offen lds
s_add_u32 s62,s62,32768
s_add_u32 m0,m0,1024
s_nop 0
buffer_load_dwordx4 v16,s[28:31],s62 offen lds
s_add_u32 s62,s62,32768
s_add_u32 m0,m0,1024
s_nop 0
buffer_load_dwordx4 v16,s[28:31],s62 offen lds
s_xor_b32 s62,s50,1
s_mul_i32 s62,s62,524288
s_add_u32 s62,s62,s54
s_add_u32 m0,s61,16384
s_nop 0
buffer_load_dwordx4 v16,s[28:31],s62 offen lds
s_add_u32 s62,s62,32768
s_add_u32 m0,m0,1024
s_nop 0
buffer_load_dwordx4 v16,s[28:31],s62 offen lds
s_add_u32 s62,s62,32768
s_add_u32 m0,m0,1024
s_nop 0
buffer_load_dwordx4 v16,s[28:31],s62 offen lds
s_add_u32 s62,s62,32768
s_add_u32 m0,m0,1024
s_nop 0
buffer_load_dwordx4 v16,s[28:31],s62 offen lds
s_add_u32 s62,s62,32768
s_add_u32 m0,m0,1024
s_nop 0
buffer_load_dwordx4 v16,s[28:31],s62 offen lds
s_add_u32 s62,s62,32768
s_add_u32 m0,m0,1024
s_nop 0
buffer_load_dwordx4 v16,s[28:31],s62 offen lds
s_add_u32 s62,s62,32768
s_add_u32 m0,m0,1024
s_nop 0
buffer_load_dwordx4 v16,s[28:31],s62 offen lds
s_add_u32 s62,s62,32768
s_add_u32 m0,m0,1024
s_nop 0
buffer_load_dwordx4 v16,s[28:31],s62 offen lds
s_add_u32 s62,s62,32768
s_add_u32 m0,m0,1024
s_nop 0
buffer_load_dwordx4 v16,s[28:31],s62 offen lds
s_add_u32 s62,s62,32768
s_add_u32 m0,m0,1024
s_nop 0
buffer_load_dwordx4 v16,s[28:31],s62 offen lds
s_add_u32 s62,s62,32768
s_add_u32 m0,m0,1024
s_nop 0
buffer_load_dwordx4 v16,s[28:31],s62 offen lds
s_add_u32 s62,s62,32768
s_add_u32 m0,m0,1024
s_nop 0
buffer_load_dwordx4 v16,s[28:31],s62 offen lds
s_add_u32 s62,s62,32768
s_add_u32 m0,m0,1024
s_nop 0
buffer_load_dwordx4 v16,s[28:31],s62 offen lds
s_add_u32 s62,s62,32768
s_add_u32 m0,m0,1024
s_nop 0
buffer_load_dwordx4 v16,s[28:31],s62 offen lds
s_add_u32 s62,s62,32768
s_add_u32 m0,m0,1024
s_nop 0
buffer_load_dwordx4 v16,s[28:31],s62 offen lds
s_add_u32 s62,s62,32768
s_add_u32 m0,m0,1024
s_nop 0
buffer_load_dwordx4 v16,s[28:31],s62 offen lds
s_waitcnt vmcnt(16)
ds_read_b64_tr_b16 a[0:1],v17 offset:0
ds_read_b64_tr_b16 a[2:3],v17 offset:256
ds_read_b64_tr_b16 a[4:5],v17 offset:8
ds_read_b64_tr_b16 a[6:7],v17 offset:264
ds_read_b64_tr_b16 a[8:9],v17 offset:2048
ds_read_b64_tr_b16 a[10:11],v17 offset:2304
ds_read_b64_tr_b16 a[12:13],v17 offset:2056
ds_read_b64_tr_b16 a[14:15],v17 offset:2312
ds_read_b64_tr_b16 a[16:17],v17 offset:4096
ds_read_b64_tr_b16 a[18:19],v17 offset:4352
ds_read_b64_tr_b16 a[20:21],v17 offset:4104
ds_read_b64_tr_b16 a[22:23],v17 offset:4360
s_waitcnt lgkmcnt(0)
ds_read_b64_tr_b16 a[24:25],v17 offset:6144
ds_read_b64_tr_b16 a[26:27],v17 offset:6400
ds_read_b64_tr_b16 a[28:29],v17 offset:6152
ds_read_b64_tr_b16 a[30:31],v17 offset:6408
ds_read_b64_tr_b16 a[32:33],v17 offset:8192
ds_read_b64_tr_b16 a[34:35],v17 offset:8448
ds_read_b64_tr_b16 a[36:37],v17 offset:8200
ds_read_b64_tr_b16 a[38:39],v17 offset:8456
ds_read_b64_tr_b16 a[40:41],v17 offset:10240
ds_read_b64_tr_b16 a[42:43],v17 offset:10496
ds_read_b64_tr_b16 a[44:45],v17 offset:10248
ds_read_b64_tr_b16 a[46:47],v17 offset:10504
s_waitcnt lgkmcnt(0)
ds_read_b64_tr_b16 a[48:49],v17 offset:12288
ds_read_b64_tr_b16 a[50:51],v17 offset:12544
ds_read_b64_tr_b16 a[52:53],v17 offset:12296
ds_read_b64_tr_b16 a[54:55],v17 offset:12552
ds_read_b64_tr_b16 a[56:57],v17 offset:14336
ds_read_b64_tr_b16 a[58:59],v17 offset:14592
ds_read_b64_tr_b16 a[60:61],v17 offset:14344
ds_read_b64_tr_b16 a[62:63],v17 offset:14600
s_waitcnt lgkmcnt(0)
s_xor_b32 s62,s50,2
s_mul_i32 s62,s62,524288
s_add_u32 s62,s62,s54
s_add_u32 m0,s61,0
s_nop 0
buffer_load_dwordx4 v16,s[28:31],s62 offen lds
s_add_u32 s62,s62,32768
s_add_u32 m0,m0,1024
s_nop 0
buffer_load_dwordx4 v16,s[28:31],s62 offen lds
s_add_u32 s62,s62,32768
s_add_u32 m0,m0,1024
s_nop 0
buffer_load_dwordx4 v16,s[28:31],s62 offen lds
s_add_u32 s62,s62,32768
s_add_u32 m0,m0,1024
s_nop 0
buffer_load_dwordx4 v16,s[28:31],s62 offen lds
s_add_u32 s62,s62,32768
s_add_u32 m0,m0,1024
s_nop 0
buffer_load_dwordx4 v16,s[28:31],s62 offen lds
s_add_u32 s62,s62,32768
s_add_u32 m0,m0,1024
s_nop 0
buffer_load_dwordx4 v16,s[28:31],s62 offen lds
s_add_u32 s62,s62,32768
s_add_u32 m0,m0,1024
s_nop 0
buffer_load_dwordx4 v16,s[28:31],s62 offen lds
s_add_u32 s62,s62,32768
s_add_u32 m0,m0,1024
s_nop 0
buffer_load_dwordx4 v16,s[28:31],s62 offen lds
s_add_u32 s62,s62,32768
s_add_u32 m0,m0,1024
s_nop 0
buffer_load_dwordx4 v16,s[28:31],s62 offen lds
s_add_u32 s62,s62,32768
s_add_u32 m0,m0,1024
s_nop 0
buffer_load_dwordx4 v16,s[28:31],s62 offen lds
s_add_u32 s62,s62,32768
s_add_u32 m0,m0,1024
s_nop 0
buffer_load_dwordx4 v16,s[28:31],s62 offen lds
s_add_u32 s62,s62,32768
s_add_u32 m0,m0,1024
s_nop 0
buffer_load_dwordx4 v16,s[28:31],s62 offen lds
s_add_u32 s62,s62,32768
s_add_u32 m0,m0,1024
s_nop 0
buffer_load_dwordx4 v16,s[28:31],s62 offen lds
s_add_u32 s62,s62,32768
s_add_u32 m0,m0,1024
s_nop 0
buffer_load_dwordx4 v16,s[28:31],s62 offen lds
s_add_u32 s62,s62,32768
s_add_u32 m0,m0,1024
s_nop 0
buffer_load_dwordx4 v16,s[28:31],s62 offen lds
s_add_u32 s62,s62,32768
s_add_u32 m0,m0,1024
s_nop 0
buffer_load_dwordx4 v16,s[28:31],s62 offen lds
s_waitcnt vmcnt(16)
ds_read_b64_tr_b16 a[64:65],v17 offset:16384
ds_read_b64_tr_b16 a[66:67],v17 offset:16640
ds_read_b64_tr_b16 a[68:69],v17 offset:16392
ds_read_b64_tr_b16 a[70:71],v17 offset:16648
ds_read_b64_tr_b16 a[72:73],v17 offset:18432
ds_read_b64_tr_b16 a[74:75],v17 offset:18688
ds_read_b64_tr_b16 a[76:77],v17 offset:18440
ds_read_b64_tr_b16 a[78:79],v17 offset:18696
ds_read_b64_tr_b16 a[80:81],v17 offset:20480
ds_read_b64_tr_b16 a[82:83],v17 offset:20736
ds_read_b64_tr_b16 a[84:85],v17 offset:20488
ds_read_b64_tr_b16 a[86:87],v17 offset:20744
s_waitcnt lgkmcnt(0)
ds_read_b64_tr_b16 a[88:89],v17 offset:22528
ds_read_b64_tr_b16 a[90:91],v17 offset:22784
ds_read_b64_tr_b16 a[92:93],v17 offset:22536
ds_read_b64_tr_b16 a[94:95],v17 offset:22792
ds_read_b64_tr_b16 a[96:97],v17 offset:24576
ds_read_b64_tr_b16 a[98:99],v17 offset:24832
ds_read_b64_tr_b16 a[100:101],v17 offset:24584
ds_read_b64_tr_b16 a[102:103],v17 offset:24840
ds_read_b64_tr_b16 a[104:105],v17 offset:26624
ds_read_b64_tr_b16 a[106:107],v17 offset:26880
ds_read_b64_tr_b16 a[108:109],v17 offset:26632
ds_read_b64_tr_b16 a[110:111],v17 offset:26888
s_waitcnt lgkmcnt(0)
ds_read_b64_tr_b16 a[112:113],v17 offset:28672
ds_read_b64_tr_b16 a[114:115],v17 offset:28928
ds_read_b64_tr_b16 a[116:117],v17 offset:28680
ds_read_b64_tr_b16 a[118:119],v17 offset:28936
ds_read_b64_tr_b16 a[120:121],v17 offset:30720
ds_read_b64_tr_b16 a[122:123],v17 offset:30976
ds_read_b64_tr_b16 a[124:125],v17 offset:30728
ds_read_b64_tr_b16 a[126:127],v17 offset:30984
s_waitcnt lgkmcnt(0)
s_xor_b32 s62,s50,3
s_mul_i32 s62,s62,524288
s_add_u32 s62,s62,s54
s_add_u32 m0,s61,16384
s_nop 0
buffer_load_dwordx4 v16,s[28:31],s62 offen lds
s_add_u32 s62,s62,32768
s_add_u32 m0,m0,1024
s_nop 0
buffer_load_dwordx4 v16,s[28:31],s62 offen lds
s_add_u32 s62,s62,32768
s_add_u32 m0,m0,1024
s_nop 0
buffer_load_dwordx4 v16,s[28:31],s62 offen lds
s_add_u32 s62,s62,32768
s_add_u32 m0,m0,1024
s_nop 0
buffer_load_dwordx4 v16,s[28:31],s62 offen lds
s_add_u32 s62,s62,32768
s_add_u32 m0,m0,1024
s_nop 0
buffer_load_dwordx4 v16,s[28:31],s62 offen lds
s_add_u32 s62,s62,32768
s_add_u32 m0,m0,1024
s_nop 0
buffer_load_dwordx4 v16,s[28:31],s62 offen lds
s_add_u32 s62,s62,32768
s_add_u32 m0,m0,1024
s_nop 0
buffer_load_dwordx4 v16,s[28:31],s62 offen lds
s_add_u32 s62,s62,32768
s_add_u32 m0,m0,1024
s_nop 0
buffer_load_dwordx4 v16,s[28:31],s62 offen lds
s_add_u32 s62,s62,32768
s_add_u32 m0,m0,1024
s_nop 0
buffer_load_dwordx4 v16,s[28:31],s62 offen lds
s_add_u32 s62,s62,32768
s_add_u32 m0,m0,1024
s_nop 0
buffer_load_dwordx4 v16,s[28:31],s62 offen lds
s_add_u32 s62,s62,32768
s_add_u32 m0,m0,1024
s_nop 0
buffer_load_dwordx4 v16,s[28:31],s62 offen lds
s_add_u32 s62,s62,32768
s_add_u32 m0,m0,1024
s_nop 0
buffer_load_dwordx4 v16,s[28:31],s62 offen lds
s_add_u32 s62,s62,32768
s_add_u32 m0,m0,1024
s_nop 0
buffer_load_dwordx4 v16,s[28:31],s62 offen lds
s_add_u32 s62,s62,32768
s_add_u32 m0,m0,1024
s_nop 0
buffer_load_dwordx4 v16,s[28:31],s62 offen lds
s_add_u32 s62,s62,32768
s_add_u32 m0,m0,1024
s_nop 0
buffer_load_dwordx4 v16,s[28:31],s62 offen lds
s_add_u32 s62,s62,32768
s_add_u32 m0,m0,1024
s_nop 0
buffer_load_dwordx4 v16,s[28:31],s62 offen lds
s_waitcnt vmcnt(16)
ds_read_b64_tr_b16 a[128:129],v17 offset:0
ds_read_b64_tr_b16 a[130:131],v17 offset:256
ds_read_b64_tr_b16 a[132:133],v17 offset:8
ds_read_b64_tr_b16 a[134:135],v17 offset:264
ds_read_b64_tr_b16 a[136:137],v17 offset:2048
ds_read_b64_tr_b16 a[138:139],v17 offset:2304
ds_read_b64_tr_b16 a[140:141],v17 offset:2056
ds_read_b64_tr_b16 a[142:143],v17 offset:2312
ds_read_b64_tr_b16 a[144:145],v17 offset:4096
ds_read_b64_tr_b16 a[146:147],v17 offset:4352
ds_read_b64_tr_b16 a[148:149],v17 offset:4104
ds_read_b64_tr_b16 a[150:151],v17 offset:4360
s_waitcnt lgkmcnt(0)
ds_read_b64_tr_b16 a[152:153],v17 offset:6144
ds_read_b64_tr_b16 a[154:155],v17 offset:6400
ds_read_b64_tr_b16 a[156:157],v17 offset:6152
ds_read_b64_tr_b16 a[158:159],v17 offset:6408
ds_read_b64_tr_b16 a[160:161],v17 offset:8192
ds_read_b64_tr_b16 a[162:163],v17 offset:8448
ds_read_b64_tr_b16 a[164:165],v17 offset:8200
ds_read_b64_tr_b16 a[166:167],v17 offset:8456
ds_read_b64_tr_b16 a[168:169],v17 offset:10240
ds_read_b64_tr_b16 a[170:171],v17 offset:10496
ds_read_b64_tr_b16 a[172:173],v17 offset:10248
ds_read_b64_tr_b16 a[174:175],v17 offset:10504
s_waitcnt lgkmcnt(0)
ds_read_b64_tr_b16 a[176:177],v17 offset:12288
ds_read_b64_tr_b16 a[178:179],v17 offset:12544
ds_read_b64_tr_b16 a[180:181],v17 offset:12296
ds_read_b64_tr_b16 a[182:183],v17 offset:12552
ds_read_b64_tr_b16 a[184:185],v17 offset:14336
ds_read_b64_tr_b16 a[186:187],v17 offset:14592
ds_read_b64_tr_b16 a[188:189],v17 offset:14344
ds_read_b64_tr_b16 a[190:191],v17 offset:14600
s_waitcnt lgkmcnt(0)
s_waitcnt vmcnt(0)
ds_read_b64_tr_b16 a[192:193],v17 offset:16384
ds_read_b64_tr_b16 a[194:195],v17 offset:16640
ds_read_b64_tr_b16 a[196:197],v17 offset:16392
ds_read_b64_tr_b16 a[198:199],v17 offset:16648
ds_read_b64_tr_b16 a[200:201],v17 offset:18432
ds_read_b64_tr_b16 a[202:203],v17 offset:18688
ds_read_b64_tr_b16 a[204:205],v17 offset:18440
ds_read_b64_tr_b16 a[206:207],v17 offset:18696
ds_read_b64_tr_b16 a[208:209],v17 offset:20480
ds_read_b64_tr_b16 a[210:211],v17 offset:20736
ds_read_b64_tr_b16 a[212:213],v17 offset:20488
ds_read_b64_tr_b16 a[214:215],v17 offset:20744
s_waitcnt lgkmcnt(0)
ds_read_b64_tr_b16 a[216:217],v17 offset:22528
ds_read_b64_tr_b16 a[218:219],v17 offset:22784
ds_read_b64_tr_b16 a[220:221],v17 offset:22536
ds_read_b64_tr_b16 a[222:223],v17 offset:22792
ds_read_b64_tr_b16 a[224:225],v17 offset:24576
ds_read_b64_tr_b16 a[226:227],v17 offset:24832
ds_read_b64_tr_b16 a[228:229],v17 offset:24584
ds_read_b64_tr_b16 a[230:231],v17 offset:24840
ds_read_b64_tr_b16 a[232:233],v17 offset:26624
ds_read_b64_tr_b16 a[234:235],v17 offset:26880
ds_read_b64_tr_b16 a[236:237],v17 offset:26632
ds_read_b64_tr_b16 a[238:239],v17 offset:26888
s_waitcnt lgkmcnt(0)
ds_read_b64_tr_b16 a[240:241],v17 offset:28672
ds_read_b64_tr_b16 a[242:243],v17 offset:28928
ds_read_b64_tr_b16 a[244:245],v17 offset:28680
ds_read_b64_tr_b16 a[246:247],v17 offset:28936
ds_read_b64_tr_b16 a[248:249],v17 offset:30720
ds_read_b64_tr_b16 a[250:251],v17 offset:30976
ds_read_b64_tr_b16 a[252:253],v17 offset:30728
ds_read_b64_tr_b16 a[254:255],v17 offset:30984
s_waitcnt lgkmcnt(0)
s_mov_b32 s67,0
s_cmp_eq_u32 s56,1
s_cbranch_scc1 vok_31
v_mbcnt_lo_u32_b32 v16,-1,0
v_and_b32 v16,7,v16
v_lshlrev_b32 v16,7,v16
s_mov_b32 s64,138510336
vpoll_32:
buffer_load_dword v17,v16,s[20:23],s64 offen sc1
s_waitcnt vmcnt(0)
v_readlane_b32 s92,v17,0
v_readlane_b32 s93,v17,1
v_readlane_b32 s94,v17,2
v_readlane_b32 s95,v17,3
v_readlane_b32 s96,v17,4
v_readlane_b32 s97,v17,5
v_readlane_b32 s98,v17,6
v_readlane_b32 s99,v17,7
s_add_u32 s65,s92,s93
s_add_u32 s65,s65,s94
s_add_u32 s65,s65,s95
s_add_u32 s65,s65,s96
s_add_u32 s65,s65,s97
s_add_u32 s65,s65,s98
s_add_u32 s65,s65,s99
s_cmp_ge_u32 s65,256
s_cbranch_scc1 vgot_33
s_sleep 4
s_sub_u32 s90,s90,1
s_cmp_gt_i32 s90,0
s_cbranch_scc1 vpoll_32
vgot_33:
s_min_u32 s65,s92,s93
s_min_u32 s65,s65,s94
s_min_u32 s65,s65,s95
s_min_u32 s65,s65,s96
s_min_u32 s65,s65,s97
s_min_u32 s65,s65,s98
s_min_u32 s65,s65,s99
s_cmp_lt_u32 s65,32
s_cbranch_scc1 fl_slow
s_mov_b32 s56,0
vok_31:
s_barrier
v_lshlrev_b32 v0,4,v1
s_mov_b32 s60,0
s_mov_b32 s70,0
s_mov_b32 s55,0
s_lshl_b32 s63,s50,13
v_mov_b32 v3,v0
s_mov_b32 s73,0xffff0000
s_lshl_b32 s64,s52,2
s_add_u32 s64,s64,s50
s_mul_i32 s61,s64,8192
s_add_u32 s61,s61,150994944
s_lshl_b32 s82,s64,8
s_add_u32 s82,s82,138543104
s_mov_b32 s68,s82
s_lshl_b32 s83,s53,2
s_add_u32 s83,s83,s50
s_xor_b32 s64,s50,0
s_lshl_b32 s64,s64,13
v_add_u32 v8,s64,v0
s_xor_b32 s64,s50,1
s_lshl_b32 s64,s64,13
v_add_u32 v9,s64,v0
s_xor_b32 s64,s50,2
s_lshl_b32 s64,s64,13
v_add_u32 v10,s64,v0
s_xor_b32 s64,s50,3
s_lshl_b32 s64,s64,13
v_add_u32 v11,s64,v0
v_min_u32 v2,1,v1
v_lshlrev_b32 v2,2,v2
s_lshl_b32 s66,s83,10
s_lshr_b32 s65,s83,3
s_lshl_b32 s65,s65,8
s_and_b32 s64,s83,7
s_lshl_b32 s64,s64,2
s_add_u32 s69,s64,s65
s_add_u32 s69,s69,138547200
s_lshl_b32 s64,s53,2
s_add_u32 s64,s64,s50
s_mul_i32 s74,s64,24576
s_xor_b32 s64,s50,s52
s_sub_u32 s64,s64,1
s_max_i32 s64,s64,0
s_lshl_b32 s64,s64,11
s_add_u32 s74,s74,s64
s_add_u32 s74,s74,167772160
s_mov_b32 s75,0
s_mov_b32 s76,0
s_mov_b32 s77,0
v_lshlrev_b32 v26,11,v21
v_lshl_add_u32 v26,v22,4,v26
s_lshl_b32 s64,s83,6
v_add_u32 v18,s64,v26
v_lshlrev_b32 v26,5,v22
s_lshl_b32 s64,s83,7
s_add_u32 s64,s64,267395072
buffer_load_dwordx4 v[152:155],v26,s[20:23],s64 offen
buffer_load_dwordx4 v[156:159],v26,s[20:23],s64 offen offset:16
v_mov_b32 v204,-1
v_mov_b32 v205,-1
v_mov_b32 v206,-1
v_mov_b32 v207,-1
s_cmp_eq_u32 s50,s52
s_cbranch_scc1 lfin_36
s_add_u32 s71,s60,0
s_and_b32 s68,s71,1
s_lshl_b32 s68,s68,3
s_add_u32 s68,s68,s82
s_lshr_b32 s71,s71,1
s_add_u32 s71,s71,1
plp_42:
buffer_load_dword v16,v2,s[20:23],s68 offen sc1
s_waitcnt vmcnt(0)
v_cmp_gt_u32 vcc,s71,v16
s_cbranch_vccz pok_43
s_sleep 4
s_sub_u32 s90,s90,1
s_cmp_gt_i32 s90,0
s_cbranch_scc1 plp_42
pok_43:
lag_41:
s_add_u32 m0,s70,s63
s_add_u32 s62,s61,4096
buffer_load_dwordx4 v3,s[20:23],s61 offen offset:0 lds
buffer_load_dwordx4 v3,s[20:23],s61 offen offset:1024 lds
buffer_load_dwordx4 v3,s[20:23],s61 offen offset:2048 lds
buffer_load_dwordx4 v3,s[20:23],s61 offen offset:3072 lds
s_add_u32 m0,m0,4096
s_nop 0
buffer_load_dwordx4 v3,s[20:23],s62 offen offset:0 lds
buffer_load_dwordx4 v3,s[20:23],s62 offen offset:1024 lds
buffer_load_dwordx4 v3,s[20:23],s62 offen offset:2048 lds
buffer_load_dwordx4 v3,s[20:23],s62 offen offset:3072 lds
s_add_u32 s61,s61,131072
s_add_u32 s70,s70,32768
s_and_b32 s70,s70,0x1ffff
buffer_load_dword v17,off,s[20:23],s69
buffer_load_dword v17,off,s[20:23],s69
top_37:
s_add_u32 s71,s60,1
s_and_b32 s68,s71,1
s_lshl_b32 s68,s68,3
s_add_u32 s68,s68,s82
s_lshr_b32 s71,s71,1
s_add_u32 s71,s71,1
buffer_load_dword v16,v2,s[20:23],s68 offen sc1
v_add_u32 v4,s55,v8
v_add_u32 v5,s55,v9
v_add_u32 v6,s55,v10
v_add_u32 v7,s55,v11
s_add_u32 s55,s55,32768
s_and_b32 s55,s55,0x1ffff
s_waitcnt vmcnt(10)
ds_read_b128 v[64:67],v4 offset:0
s_waitcnt vmcnt(9)
ds_read_b128 v[68:71],v4 offset:1024
s_waitcnt vmcnt(8)
ds_read_b128 v[72:75],v4 offset:2048
s_waitcnt lgkmcnt(2)
v_mfma_f32_16x16x32_bf16 v[32:35],a[0:3],v[64:67],0
v_mfma_f32_16x16x32_bf16 v[36:39],a[4:7],v[64:67],0
s_waitcnt vmcnt(7)
ds_read_b128 v[76:79],v4 offset:3072
s_waitcnt lgkmcnt(2)
v_mfma_f32_16x16x32_bf16 v[32:35],a[8:11],v[68:71],v[32:35]
v_mfma_f32_16x16x32_bf16 v[36:39],a[12:15],v[68:71],v[36:39]
s_waitcnt vmcnt(6)
ds_read_b128 v[80:83],v4 offset:4096
s_waitcnt lgkmcnt(2)
v_mfma_f32_16x16x32_bf16 v[32:35],a[16:19],v[72:75],v[32:35]
v_mfma_f32_16x16x32_bf16 v[36:39],a[20:23],v[72:75],v[36:39]
s_waitcnt vmcnt(5)
ds_read_b128 v[84:87],v4 offset:5120
s_waitcnt lgkmcnt(2)
v_mfma_f32_16x16x32_bf16 v[32:35],a[24:27],v[76:79],v[32:35]
v_mfma_f32_16x16x32_bf16 v[36:39],a[28:31],v[76:79],v[36:39]
s_waitcnt vmcnt(4)
ds_read_b128 v[88:91],v4 offset:6144
s_waitcnt lgkmcnt(2)
v_mfma_f32_16x16x32_bf16 v[32:35],a[32:35],v[80:83],v[32:35]
v_mfma_f32_16x16x32_bf16 v[36:39],a[36:39],v[80:83],v[36:39]
s_waitcnt vmcnt(3)
ds_read_b128 v[92:95],v4 offset:7168
s_barrier
s_waitcnt lgkmcnt(2)
v_mfma_f32_16x16x32_bf16 v[32:35],a[40:43],v[84:87],v[32:35]
v_mfma_f32_16x16x32_bf16 v[36:39],a[44:47],v[84:87],v[36:39]
ds_read_b128 v[96:99],v5 offset:0
s_waitcnt lgkmcnt(2)
v_mfma_f32_16x16x32_bf16 v[32:35],a[48:51],v[88:91],v[32:35]
ds_read_b128 v[100:103],v5 offset:1024
ds_read_b128 v[104:107],v5 offset:2048
v_mfma_f32_16x16x32_bf16 v[36:39],a[52:55],v[88:91],v[36:39]
s_waitcnt lgkmcnt(3)
v_mfma_f32_16x16x32_bf16 v[32:35],a[56:59],v[92:95],v[32:35]
ds_read_b128 v[108:111],v5 offset:3072
ds_read_b128 v[112:115],v5 offset:4096
v_mfma_f32_16x16x32_bf16 v[36:39],a[60:63],v[92:95],v[36:39]
s_waitcnt lgkmcnt(4)
v_mfma_f32_16x16x32_bf16 v[32:35],a[64:67],v[96:99],v[32:35]
ds_read_b128 v[116:119],v5 offset:5120
ds_read_b128 v[120:123],v5 offset:6144
v_mfma_f32_16x16x32_bf16 v[36:39],a[68:71],v[96:99],v[36:39]
s_waitcnt lgkmcnt(5)
v_mfma_f32_16x16x32_bf16 v[32:35],a[72:75],v[100:103],v[32:35]
ds_read_b128 v[124:127],v5 offset:7168
v_mfma_f32_16x16x32_bf16 v[36:39],a[76:79],v[100:103],v[36:39]
s_waitcnt lgkmcnt(5)
v_mfma_f32_16x16x32_bf16 v[32:35],a[80:83],v[104:107],v[32:35]
ds_read_b128 v[64:67],v6 offset:0
v_mfma_f32_16x16x32_bf16 v[36:39],a[84:87],v[104:107],v[36:39]
s_waitcnt lgkmcnt(5)
v_mfma_f32_16x16x32_bf16 v[32:35],a[88:91],v[108:111],v[32:35]
ds_read_b128 v[68:71],v6 offset:1024
v_mfma_f32_16x16x32_bf16 v[36:39],a[92:95],v[108:111],v[36:39]
s_waitcnt lgkmcnt(5)
v_mfma_f32_16x16x32_bf16 v[32:35],a[96:99],v[112:115],v[32:35]
ds_read_b128 v[72:75],v6 offset:2048
v_mfma_f32_16x16x32_bf16 v[36:39],a[100:103],v[112:115],v[36:39]
s_waitcnt lgkmcnt(5)
v_mfma_f32_16x16x32_bf16 v[32:35],a[104:107],v[116:119],v[32:35]
ds_read_b128 v[76:79],v6 offset:3072
v_mfma_f32_16x16x32_bf16 v[36:39],a[108:111],v[116:119],v[36:39]
s_waitcnt lgkmcnt(5)
v_mfma_f32_16x16x32_bf16 v[32:35],a[112:115],v[120:123],v[32:35]
ds_read_b128 v[80:83],v6 offset:4096
v_mfma_f32_16x16x32_bf16 v[36:39],a[116:119],v[120:123],v[36:39]
s_waitcnt lgkmcnt(5)
v_mfma_f32_16x16x32_bf16 v[32:35],a[120:123],v[124:127],v[32:35]
ds_read_b128 v[84:87],v6 offset:5120
v_mfma_f32_16x16x32_bf16 v[36:39],a[124:127],v[124:127],v[36:39]
s_waitcnt lgkmcnt(5)
v_mfma_f32_16x16x32_bf16 v[32:35],a[128:131],v[64:67],v[32:35]
ds_read_b128 v[88:91],v6 offset:6144
v_mfma_f32_16x16x32_bf16 v[36:39],a[132:135],v[64:67],v[36:39]
s_waitcnt lgkmcnt(5)
v_mfma_f32_16x16x32_bf16 v[32:35],a[136:139],v[68:71],v[32:35]
ds_read_b128 v[92:95],v6 offset:7168
v_mfma_f32_16x16x32_bf16 v[36:39],a[140:143],v[68:71],v[36:39]
s_waitcnt lgkmcnt(5)
v_mfma_f32_16x16x32_bf16 v[32:35],a[144:147],v[72:75],v[32:35]
ds_read_b128 v[96:99],v7 offset:0
v_mfma_f32_16x16x32_bf16 v[36:39],a[148:151],v[72:75],v[36:39]
s_waitcnt lgkmcnt(5)
v_mfma_f32_16x16x32_bf16 v[32:35],a[152:155],v[76:79],v[32:35]
ds_read_b128 v[100:103],v7 offset:1024
v_mfma_f32_16x16x32_bf16 v[36:39],a[156:159],v[76:79],v[36:39]
s_waitcnt lgkmcnt(5)
v_mfma_f32_16x16x32_bf16 v[32:35],a[160:163],v[80:83],v[32:35]
ds_read_b128 v[104:107],v7 offset:2048
v_mfma_f32_16x16x32_bf16 v[36:39],a[164:167],v[80:83],v[36:39]
s_waitcnt lgkmcnt(5)
v_mfma_f32_16x16x32_bf16 v[32:35],a[168:171],v[84:87],v[32:35]
ds_read_b128 v[108:111],v7 offset:3072
v_mfma_f32_16x16x32_bf16 v[36:39],a[172:175],v[84:87],v[36:39]
s_waitcnt vmcnt(0)
v_cmp_gt_u32 vcc,s71,v16
s_cbranch_vccnz vN_38
s_waitcnt lgkmcnt(5)
v_mfma_f32_16x16x32_bf16 v[32:35],a[176:179],v[88:91],v[32:35]
ds_read_b128 v[112:115],v7 offset:4096
s_add_u32 m0,s70,s63
v_mfma_f32_16x16x32_bf16 v[36:39],a[180:183],v[88:91],v[36:39]
s_add_u32 s62,s61,4096
s_waitcnt lgkmcnt(5)
v_mfma_f32_16x16x32_bf16 v[32:35],a[184:187],v[92:95],v[32:35]
ds_read_b128 v[116:119],v7 offset:5120
buffer_load_dwordx4 v3,s[20:23],s61 offen offset:0 lds
v_mfma_f32_16x16x32_bf16 v[36:39],a[188:191],v[92:95],v[36:39]
buffer_load_dwordx4 v3,s[20:23],s61 offen offset:1024 lds
s_waitcnt lgkmcnt(5)
v_mfma_f32_16x16x32_bf16 v[32:35],a[192:195],v[96:99],v[32:35]
ds_read_b128 v[120:123],v7 offset:6144
buffer_load_dwordx4 v3,s[20:23],s61 offen offset:2048 lds
v_mfma_f32_16x16x32_bf16 v[36:39],a[196:199],v[96:99],v[36:39]
buffer_load_dwordx4 v3,s[20:23],s61 offen offset:3072 lds
s_waitcnt lgkmcnt(5)
v_mfma_f32_16x16x32_bf16 v[32:35],a[200:203],v[100:103],v[32:35]
ds_read_b128 v[124:127],v7 offset:7168
s_add_u32 m0,m0,4096
v_mfma_f32_16x16x32_bf16 v[36:39],a[204:207],v[100:103],v[36:39]
buffer_load_dwordx4 v3,s[20:23],s62 offen offset:0 lds
s_waitcnt lgkmcnt(5)
v_mfma_f32_16x16x32_bf16 v[32:35],a[208:211],v[104:107],v[32:35]
buffer_load_dwordx4 v3,s[20:23],s62 offen offset:1024 lds
v_mfma_f32_16x16x32_bf16 v[36:39],a[212:215],v[104:107],v[36:39]
buffer_load_dwordx4 v3,s[20:23],s62 offen offset:2048 lds
s_waitcnt lgkmcnt(4)
v_mfma_f32_16x16x32_bf16 v[32:35],a[216:219],v[108:111],v[32:35]
buffer_load_dwordx4 v3,s[20:23],s62 offen offset:3072 lds
v_mfma_f32_16x16x32_bf16 v[36:39],a[220:223],v[108:111],v[36:39]
s_add_u32 s61,s61,131072
s_waitcnt lgkmcnt(3)
v_mfma_f32_16x16x32_bf16 v[32:35],a[224:227],v[112:115],v[32:35]
s_add_u32 s70,s70,32768
v_mfma_f32_16x16x32_bf16 v[36:39],a[228:231],v[112:115],v[36:39]
s_and_b32 s70,s70,0x1ffff
s_waitcnt lgkmcnt(2)
v_mfma_f32_16x16x32_bf16 v[32:35],a[232:235],v[116:119],v[32:35]
v_mfma_f32_16x16x32_bf16 v[36:39],a[236:239],v[116:119],v[36:39]
s_waitcnt lgkmcnt(1)
v_mfma_f32_16x16x32_bf16 v[32:35],a[240:243],v[120:123],v[32:35]
v_mfma_f32_16x16x32_bf16 v[36:39],a[244:247],v[120:123],v[36:39]
s_waitcnt lgkmcnt(0)
v_mfma_f32_16x16x32_bf16 v[32:35],a[248:251],v[124:127],v[32:35]
v_mfma_f32_16x16x32_bf16 v[36:39],a[252:255],v[124:127],v[36:39]
s_mov_b32 s72,1
join_39:
s_add_u32 s64,s74,s75
s_cmp_eq_u32 s56,1
s_cbranch_scc1 b1_44
s_nop 2
buffer_store_dwordx4 v[32:35],v0,s[20:23],s64 offen offset:0
buffer_store_dwordx4 v[36:39],v0,s[20:23],s64 offen offset:1024
b2_45:
s_add_u32 s75,s75,6144
s_cmp_eq_u32 s75,24576
s_cselect_b32 s75,0,s75
s_add_u32 s60,s60,1
s_cmp_eq_u32 s72,0
s_cbranch_scc1 slowp_40
s_branch top_37
slowp_40:
s_waitcnt vmcnt(2)
v_cmp_gt_u32 vcc,s71,v16
s_cbranch_vccz lag_41
s_cmp_ge_u32 s60,128
s_cbranch_scc1 done_30
plp_46:
buffer_load_dword v16,v2,s[20:23],s68 offen sc1
s_waitcnt vmcnt(0)
v_cmp_gt_u32 vcc,s71,v16
s_cbranch_vccz pok_47
s_sleep 4
s_sub_u32 s90,s90,1
s_cmp_gt_i32 s90,0
s_cbranch_scc1 plp_46
pok_47:
s_branch lag_41
lfin_36:
s_add_u32 s71,s60,0
s_and_b32 s68,s71,1
s_lshl_b32 s68,s68,3
s_add_u32 s68,s68,s82
s_lshr_b32 s71,s71,1
s_add_u32 s71,s71,1
plp_53:
buffer_load_dword v16,v2,s[20:23],s68 offen sc1
s_waitcnt vmcnt(0)
v_cmp_gt_u32 vcc,s71,v16
s_cbranch_vccz pok_54
s_sleep 4
s_sub_u32 s90,s90,1
s_cmp_gt_i32 s90,0
s_cbranch_scc1 plp_53
pok_54:
lag_52:
s_add_u32 m0,s70,s63
s_add_u32 s62,s61,4096
buffer_load_dwordx4 v3,s[20:23],s61 offen offset:0 lds
buffer_load_dwordx4 v3,s[20:23],s61 offen offset:1024 lds
buffer_load_dwordx4 v3,s[20:23],s61 offen offset:2048 lds
buffer_load_dwordx4 v3,s[20:23],s61 offen offset:3072 lds
s_add_u32 m0,m0,4096
s_nop 0
buffer_load_dwordx4 v3,s[20:23],s62 offen offset:0 lds
buffer_load_dwordx4 v3,s[20:23],s62 offen offset:1024 lds
buffer_load_dwordx4 v3,s[20:23],s62 offen offset:2048 lds
buffer_load_dwordx4 v3,s[20:23],s62 offen offset:3072 lds
s_add_u32 s61,s61,131072
s_add_u32 s70,s70,32768
s_and_b32 s70,s70,0x1ffff
top_48:
s_add_u32 s71,s60,1
s_and_b32 s68,s71,1
s_lshl_b32 s68,s68,3
s_add_u32 s68,s68,s82
s_lshr_b32 s71,s71,1
s_add_u32 s71,s71,1
buffer_load_dword v16,v2,s[20:23],s68 offen sc1
s_add_u32 s64,s74,s75
s_add_u32 s65,s64,4096
buffer_load_dwordx4 v[128:131],v0,s[20:23],s64 offen offset:0 sc1
buffer_load_dwordx4 v[132:135],v0,s[20:23],s64 offen offset:1024 sc1
buffer_load_dwordx4 v[136:139],v0,s[20:23],s64 offen offset:2048 sc1
buffer_load_dwordx4 v[140:143],v0,s[20:23],s64 offen offset:3072 sc1
buffer_load_dwordx4 v[144:147],v0,s[20:23],s65 offen offset:0 sc1
buffer_load_dwordx4 v[148:151],v0,s[20:23],s65 offen offset:1024 sc1
s_and_b32 s64,s66,0xffff8000
buffer_load_dwordx4 v[160:163],v18,s[24:27],s64 offen
v_add_u32 v4,s55,v8
v_add_u32 v5,s55,v9
v_add_u32 v6,s55,v10
v_add_u32 v7,s55,v11
s_add_u32 s55,s55,32768
s_and_b32 s55,s55,0x1ffff
s_waitcnt vmcnt(15)
ds_read_b128 v[64:67],v4 offset:0
s_waitcnt vmcnt(14)
ds_read_b128 v[68:71],v4 offset:1024
s_waitcnt vmcnt(13)
ds_read_b128 v[72:75],v4 offset:2048
s_waitcnt lgkmcnt(2)
v_mfma_f32_16x16x32_bf16 v[32:35],a[0:3],v[64:67],0
v_mfma_f32_16x16x32_bf16 v[36:39],a[4:7],v[64:67],0
s_waitcnt vmcnt(12)
ds_read_b128 v[76:79],v4 offset:3072
s_waitcnt lgkmcnt(2)
v_mfma_f32_16x16x32_bf16 v[32:35],a[8:11],v[68:71],v[32:35]
v_mfma_f32_16x16x32_bf16 v[36:39],a[12:15],v[68:71],v[36:39]
s_waitcnt vmcnt(11)
ds_read_b128 v[80:83],v4 offset:4096
s_waitcnt lgkmcnt(2)
v_mfma_f32_16x16x32_bf16 v[32:35],a[16:19],v[72:75],v[32:35]
v_mfma_f32_16x16x32_bf16 v[36:39],a[20:23],v[72:75],v[36:39]
s_waitcnt vmcnt(10)
ds_read_b128 v[84:87],v4 offset:5120
s_waitcnt lgkmcnt(2)
v_mfma_f32_16x16x32_bf16 v[32:35],a[24:27],v[76:79],v[32:35]
v_mfma_f32_16x16x32_bf16 v[36:39],a[28:31],v[76:79],v[36:39]
s_waitcnt vmcnt(9)
ds_read_b128 v[88:91],v4 offset:6144
s_waitcnt lgkmcnt(2)
v_mfma_f32_16x16x32_bf16 v[32:35],a[32:35],v[80:83],v[32:35]
v_mfma_f32_16x16x32_bf16 v[36:39],a[36:39],v[80:83],v[36:39]
s_waitcnt vmcnt(8)
ds_read_b128 v[92:95],v4 offset:7168
s_barrier
s_waitcnt lgkmcnt(2)
v_mfma_f32_16x16x32_bf16 v[32:35],a[40:43],v[84:87],v[32:35]
v_mfma_f32_16x16x32_bf16 v[36:39],a[44:47],v[84:87],v[36:39]
ds_read_b128 v[96:99],v5 offset:0
s_waitcnt lgkmcnt(2)
v_mfma_f32_16x16x32_bf16 v[32:35],a[48:51],v[88:91],v[32:35]
ds_read_b128 v[100:103],v5 offset:1024
ds_read_b128 v[104:107],v5 offset:2048
v_mfma_f32_16x16x32_bf16 v[36:39],a[52:55],v[88:91],v[36:39]
s_waitcnt lgkmcnt(3)
v_mfma_f32_16x16x32_bf16 v[32:35],a[56:59],v[92:95],v[32:35]
ds_read_b128 v[108:111],v5 offset:3072
ds_read_b128 v[112:115],v5 offset:4096
v_mfma_f32_16x16x32_bf16 v[36:39],a[60:63],v[92:95],v[36:39]
s_waitcnt lgkmcnt(4)
v_mfma_f32_16x16x32_bf16 v[32:35],a[64:67],v[96:99],v[32:35]
ds_read_b128 v[116:119],v5 offset:5120
ds_read_b128 v[120:123],v5 offset:6144
v_mfma_f32_16x16x32_bf16 v[36:39],a[68:71],v[96:99],v[36:39]
s_waitcnt lgkmcnt(5)
v_mfma_f32_16x16x32_bf16 v[32:35],a[72:75],v[100:103],v[32:35]
ds_read_b128 v[124:127],v5 offset:7168
v_mfma_f32_16x16x32_bf16 v[36:39],a[76:79],v[100:103],v[36:39]
s_waitcnt lgkmcnt(5)
v_mfma_f32_16x16x32_bf16 v[32:35],a[80:83],v[104:107],v[32:35]
ds_read_b128 v[64:67],v6 offset:0
v_mfma_f32_16x16x32_bf16 v[36:39],a[84:87],v[104:107],v[36:39]
s_waitcnt lgkmcnt(5)
v_mfma_f32_16x16x32_bf16 v[32:35],a[88:91],v[108:111],v[32:35]
ds_read_b128 v[68:71],v6 offset:1024
v_mfma_f32_16x16x32_bf16 v[36:39],a[92:95],v[108:111],v[36:39]
s_waitcnt lgkmcnt(5)
v_mfma_f32_16x16x32_bf16 v[32:35],a[96:99],v[112:115],v[32:35]
ds_read_b128 v[72:75],v6 offset:2048
v_mfma_f32_16x16x32_bf16 v[36:39],a[100:103],v[112:115],v[36:39]
s_waitcnt lgkmcnt(5)
v_mfma_f32_16x16x32_bf16 v[32:35],a[104:107],v[116:119],v[32:35]
ds_read_b128 v[76:79],v6 offset:3072
v_mfma_f32_16x16x32_bf16 v[36:39],a[108:111],v[116:119],v[36:39]
s_waitcnt lgkmcnt(5)
v_mfma_f32_16x16x32_bf16 v[32:35],a[112:115],v[120:123],v[32:35]
ds_read_b128 v[80:83],v6 offset:4096
v_mfma_f32_16x16x32_bf16 v[36:39],a[116:119],v[120:123],v[36:39]
s_waitcnt lgkmcnt(5)
v_mfma_f32_16x16x32_bf16 v[32:35],a[120:123],v[124:127],v[32:35]
ds_read_b128 v[84:87],v6 offset:5120
v_mfma_f32_16x16x32_bf16 v[36:39],a[124:127],v[124:127],v[36:39]
s_waitcnt lgkmcnt(5)
v_mfma_f32_16x16x32_bf16 v[32:35],a[128:131],v[64:67],v[32:35]
ds_read_b128 v[88:91],v6 offset:6144
v_mfma_f32_16x16x32_bf16 v[36:39],a[132:135],v[64:67],v[36:39]
s_waitcnt lgkmcnt(5)
v_mfma_f32_16x16x32_bf16 v[32:35],a[136:139],v[68:71],v[32:35]
ds_read_b128 v[92:95],v6 offset:7168
v_mfma_f32_16x16x32_bf16 v[36:39],a[140:143],v[68:71],v[36:39]
s_waitcnt lgkmcnt(5)
v_mfma_f32_16x16x32_bf16 v[32:35],a[144:147],v[72:75],v[32:35]
ds_read_b128 v[96:99],v7 offset:0
v_mfma_f32_16x16x32_bf16 v[36:39],a[148:151],v[72:75],v[36:39]
s_waitcnt lgkmcnt(5)
v_mfma_f32_16x16x32_bf16 v[32:35],a[152:155],v[76:79],v[32:35]
ds_read_b128 v[100:103],v7 offset:1024
v_mfma_f32_16x16x32_bf16 v[36:39],a[156:159],v[76:79],v[36:39]
s_waitcnt lgkmcnt(5)
v_mfma_f32_16x16x32_bf16 v[32:35],a[160:163],v[80:83],v[32:35]
ds_read_b128 v[104:107],v7 offset:2048
v_mfma_f32_16x16x32_bf16 v[36:39],a[164:167],v[80:83],v[36:39]
s_waitcnt lgkmcnt(5)
v_mfma_f32_16x16x32_bf16 v[32:35],a[168:171],v[84:87],v[32:35]
ds_read_b128 v[108:111],v7 offset:3072
v_mfma_f32_16x16x32_bf16 v[36:39],a[172:175],v[84:87],v[36:39]
s_waitcnt vmcnt(0)
s_cmp_eq_u32 s77,0
s_cbranch_scc1 np_55
ck_56:
v_pk_add_f32 v[128:129],v[128:129],v[136:137]
v_pk_add_f32 v[144:145],v[144:145],v[40:41]
v_pk_add_f32 v[130:131],v[130:131],v[138:139]
v_pk_add_f32 v[146:147],v[146:147],v[42:43]
v_pk_add_f32 v[132:133],v[132:133],v[140:141]
v_pk_add_f32 v[148:149],v[148:149],v[44:45]
v_pk_add_f32 v[134:135],v[134:135],v[142:143]
v_pk_add_f32 v[150:151],v[150:151],v[46:47]
v_pk_add_f32 v[128:129],v[128:129],v[144:145]
v_pk_add_f32 v[130:131],v[130:131],v[146:147]
v_pk_add_f32 v[132:133],v[132:133],v[148:149]
v_pk_add_f32 v[134:135],v[134:135],v[150:151]
v_pk_add_f32 v[168:169],v[128:129],v[130:131]
v_pk_add_f32 v[170:171],v[132:133],v[134:135]
v_pk_add_f32 v[168:169],v[168:169],v[170:171]
v_cmp_u_f32 vcc,v168,v169
s_cbranch_vccnz rt_57
go_58:
v_lshlrev_b32 v168,16,v160
v_and_b32 v169,s73,v160
v_lshlrev_b32 v170,16,v161
v_and_b32 v171,s73,v161
v_lshlrev_b32 v172,16,v162
v_and_b32 v173,s73,v162
v_lshlrev_b32 v174,16,v163
v_and_b32 v175,s73,v163
v_fma_f32 v168,v128,v152,v168
v_fma_f32 v169,v129,v153,v169
v_fma_f32 v170,v130,v154,v170
v_fma_f32 v171,v131,v155,v171
v_fma_f32 v172,v132,v156,v172
v_fma_f32 v173,v133,v157,v173
v_fma_f32 v174,v134,v158,v174
v_fma_f32 v175,v135,v159,v175
v_cvt_pk_bf16_f32 v176,v168,v169
v_cvt_pk_bf16_f32 v177,v170,v171
v_cvt_pk_bf16_f32 v178,v172,v173
v_cvt_pk_bf16_f32 v179,v174,v175
s_add_u32 s64,s66,201326592
buffer_store_dwordx4 v[176:179],v0,s[20:23],s64 offen sc1
s_add_u32 s64,s74,s75
s_add_u32 s65,s64,4096
s_cmp_eq_u32 s56,1
s_cbranch_scc1 b1_59
buffer_store_dwordx4 v[204:207],v0,s[20:23],s64 offen offset:0
buffer_store_dwordx4 v[204:207],v0,s[20:23],s64 offen offset:1024
buffer_store_dwordx4 v[204:207],v0,s[20:23],s64 offen offset:2048
buffer_store_dwordx4 v[204:207],v0,s[20:23],s64 offen offset:3072
buffer_store_dwordx4 v[204:207],v0,s[20:23],s65 offen offset:0
buffer_store_dwordx4 v[204:207],v0,s[20:23],s65 offen offset:1024
b2_60:
s_add_u32 s66,s66,32768
s_add_u32 s75,s75,6144
s_cmp_eq_u32 s75,24576
s_cselect_b32 s75,0,s75
s_add_u32 s76,s76,1
s_mov_b32 s77,0
np_55:
v_cmp_gt_u32 vcc,s71,v16
s_cbranch_vccnz vN_49
s_waitcnt lgkmcnt(5)
v_mfma_f32_16x16x32_bf16 v[32:35],a[176:179],v[88:91],v[32:35]
ds_read_b128 v[112:115],v7 offset:4096
s_add_u32 m0,s70,s63
v_mfma_f32_16x16x32_bf16 v[36:39],a[180:183],v[88:91],v[36:39]
s_add_u32 s62,s61,4096
s_waitcnt lgkmcnt(5)
v_mfma_f32_16x16x32_bf16 v[32:35],a[184:187],v[92:95],v[32:35]
ds_read_b128 v[116:119],v7 offset:5120
buffer_load_dwordx4 v3,s[20:23],s61 offen offset:0 lds
v_mfma_f32_16x16x32_bf16 v[36:39],a[188:191],v[92:95],v[36:39]
buffer_load_dwordx4 v3,s[20:23],s61 offen offset:1024 lds
s_waitcnt lgkmcnt(5)
v_mfma_f32_16x16x32_bf16 v[32:35],a[192:195],v[96:99],v[32:35]
ds_read_b128 v[120:123],v7 offset:6144
buffer_load_dwordx4 v3,s[20:23],s61 offen offset:2048 lds
v_mfma_f32_16x16x32_bf16 v[36:39],a[196:199],v[96:99],v[36:39]
buffer_load_dwordx4 v3,s[20:23],s61 offen offset:3072 lds
s_waitcnt lgkmcnt(5)
v_mfma_f32_16x16x32_bf16 v[32:35],a[200:203],v[100:103],v[32:35]
ds_read_b128 v[124:127],v7 offset:7168
s_add_u32 m0,m0,4096
v_mfma_f32_16x16x32_bf16 v[36:39],a[204:207],v[100:103],v[36:39]
buffer_load_dwordx4 v3,s[20:23],s62 offen offset:0 lds
s_waitcnt lgkmcnt(5)
v_mfma_f32_16x16x32_bf16 v[32:35],a[208:211],v[104:107],v[32:35]
buffer_load_dwordx4 v3,s[20:23],s62 offen offset:1024 lds
v_mfma_f32_16x16x32_bf16 v[36:39],a[212:215],v[104:107],v[36:39]
buffer_load_dwordx4 v3,s[20:23],s62 offen offset:2048 lds
s_waitcnt lgkmcnt(4)
v_mfma_f32_16x16x32_bf16 v[32:35],a[216:219],v[108:111],v[32:35]
buffer_load_dwordx4 v3,s[20:23],s62 offen offset:3072 lds
v_mfma_f32_16x16x32_bf16 v[36:39],a[220:223],v[108:111],v[36:39]
s_add_u32 s61,s61,131072
s_waitcnt lgkmcnt(3)
v_mfma_f32_16x16x32_bf16 v[32:35],a[224:227],v[112:115],v[32:35]
s_add_u32 s70,s70,32768
v_mfma_f32_16x16x32_bf16 v[36:39],a[228:231],v[112:115],v[36:39]
s_and_b32 s70,s70,0x1ffff
s_waitcnt lgkmcnt(2)
v_mfma_f32_16x16x32_bf16 v[32:35],a[232:235],v[116:119],v[32:35]
v_mfma_f32_16x16x32_bf16 v[36:39],a[236:239],v[116:119],v[36:39]
s_waitcnt lgkmcnt(1)
v_mfma_f32_16x16x32_bf16 v[32:35],a[240:243],v[120:123],v[32:35]
v_mfma_f32_16x16x32_bf16 v[36:39],a[244:247],v[120:123],v[36:39]
s_waitcnt lgkmcnt(0)
v_mfma_f32_16x16x32_bf16 v[32:35],a[248:251],v[124:127],v[32:35]
v_mfma_f32_16x16x32_bf16 v[36:39],a[252:255],v[124:127],v[36:39]
s_mov_b32 s72,1
join_50:
s_nop 5
v_mov_b32 v40,v32
v_mov_b32 v41,v33
v_mov_b32 v42,v34
v_mov_b32 v43,v35
v_mov_b32 v44,v36
v_mov_b32 v45,v37
v_mov_b32 v46,v38
v_mov_b32 v47,v39
s_mov_b32 s77,1
s_add_u32 s60,s60,1
s_cmp_eq_u32 s72,0
s_cbranch_scc1 slowp_51
s_waitcnt vmcnt(14)
v_mov_b32 v17,s76
s_mov_b64 exec,1
buffer_store_dword v17,off,s[20:23],s69 sc1
s_mov_b64 exec,-1
s_branch top_48
slowp_51:
s_waitcnt vmcnt(0)
v_mov_b32 v17,s76
s_mov_b64 exec,1
buffer_store_dword v17,off,s[20:23],s69 sc1
s_mov_b64 exec,-1
v_cmp_gt_u32 vcc,s71,v16
s_cbranch_vccz lag_52
s_and_b32 s64,s66,0xffff8000
buffer_load_dwordx4 v[160:163],v18,s[24:27],s64 offen
s_add_u32 s64,s74,s75
s_add_u32 s65,s64,4096
buffer_load_dwordx4 v[128:131],v0,s[20:23],s64 offen offset:0 sc1
buffer_load_dwordx4 v[132:135],v0,s[20:23],s64 offen offset:1024 sc1
buffer_load_dwordx4 v[136:139],v0,s[20:23],s64 offen offset:2048 sc1
buffer_load_dwordx4 v[140:143],v0,s[20:23],s64 offen offset:3072 sc1
buffer_load_dwordx4 v[144:147],v0,s[20:23],s65 offen offset:0 sc1
buffer_load_dwordx4 v[148:151],v0,s[20:23],s65 offen offset:1024 sc1
s_waitcnt vmcnt(0)
ck_61:
v_pk_add_f32 v[128:129],v[128:129],v[136:137]
v_pk_add_f32 v[144:145],v[144:145],v[40:41]
v_pk_add_f32 v[130:131],v[130:131],v[138:139]
v_pk_add_f32 v[146:147],v[146:147],v[42:43]
v_pk_add_f32 v[132:133],v[132:133],v[140:141]
v_pk_add_f32 v[148:149],v[148:149],v[44:45]
v_pk_add_f32 v[134:135],v[134:135],v[142:143]
v_pk_add_f32 v[150:151],v[150:151],v[46:47]
v_pk_add_f32 v[128:129],v[128:129],v[144:145]
v_pk_add_f32 v[130:131],v[130:131],v[146:147]
v_pk_add_f32 v[132:133],v[132:133],v[148:149]
v_pk_add_f32 v[134:135],v[134:135],v[150:151]
v_pk_add_f32 v[168:169],v[128:129],v[130:131]
v_pk_add_f32 v[170:171],v[132:133],v[134:135]
v_pk_add_f32 v[168:169],v[168:169],v[170:171]
v_cmp_u_f32 vcc,v168,v169
s_cbranch_vccnz rt_62
go_63:
v_lshlrev_b32 v168,16,v160
v_and_b32 v169,s73,v160
v_lshlrev_b32 v170,16,v161
v_and_b32 v171,s73,v161
v_lshlrev_b32 v172,16,v162
v_and_b32 v173,s73,v162
v_lshlrev_b32 v174,16,v163
v_and_b32 v175,s73,v163
v_fma_f32 v168,v128,v152,v168
v_fma_f32 v169,v129,v153,v169
v_fma_f32 v170,v130,v154,v170
v_fma_f32 v171,v131,v155,v171
v_fma_f32 v172,v132,v156,v172
v_fma_f32 v173,v133,v157,v173
v_fma_f32 v174,v134,v158,v174
v_fma_f32 v175,v135,v159,v175
v_cvt_pk_bf16_f32 v176,v168,v169
v_cvt_pk_bf16_f32 v177,v170,v171
v_cvt_pk_bf16_f32 v178,v172,v173
v_cvt_pk_bf16_f32 v179,v174,v175
s_add_u32 s64,s66,201326592
buffer_store_dwordx4 v[176:179],v0,s[20:23],s64 offen sc1
s_add_u32 s64,s74,s75
s_add_u32 s65,s64,4096
s_cmp_eq_u32 s56,1
s_cbranch_scc1 b1_64
buffer_store_dwordx4 v[204:207],v0,s[20:23],s64 offen offset:0
buffer_store_dwordx4 v[204:207],v0,s[20:23],s64 offen offset:1024
buffer_store_dwordx4 v[204:207],v0,s[20:23],s64 offen offset:2048
buffer_store_dwordx4 v[204:207],v0,s[20:23],s64 offen offset:3072
buffer_store_dwordx4 v[204:207],v0,s[20:23],s65 offen offset:0
buffer_store_dwordx4 v[204:207],v0,s[20:23],s65 offen offset:1024
b2_65:
s_add_u32 s66,s66,32768
s_add_u32 s75,s75,6144
s_cmp_eq_u32 s75,24576
s_cselect_b32 s75,0,s75
s_add_u32 s76,s76,1
s_mov_b32 s77,0
s_waitcnt vmcnt(6)
v_mov_b32 v17,s76
s_mov_b64 exec,1
buffer_store_dword v17,off,s[20:23],s69 sc1
s_mov_b64 exec,-1
s_cmp_ge_u32 s60,128
s_cbranch_scc1 done_30
plp_66:
buffer_load_dword v16,v2,s[20:23],s68 offen sc1
s_waitcnt vmcnt(0)
v_cmp_gt_u32 vcc,s71,v16
s_cbranch_vccz pok_67
s_sleep 4
s_sub_u32 s90,s90,1
s_cmp_gt_i32 s90,0
s_cbranch_scc1 plp_66
pok_67:
s_branch lag_52
vN_38:
buffer_load_dword v16,v2,s[20:23],s68 offen sc1
s_waitcnt lgkmcnt(5)
v_mfma_f32_16x16x32_bf16 v[32:35],a[176:179],v[88:91],v[32:35]
ds_read_b128 v[112:115],v7 offset:4096
v_mfma_f32_16x16x32_bf16 v[36:39],a[180:183],v[88:91],v[36:39]
s_waitcnt lgkmcnt(5)
v_mfma_f32_16x16x32_bf16 v[32:35],a[184:187],v[92:95],v[32:35]
ds_read_b128 v[116:119],v7 offset:5120
v_mfma_f32_16x16x32_bf16 v[36:39],a[188:191],v[92:95],v[36:39]
s_waitcnt lgkmcnt(5)
v_mfma_f32_16x16x32_bf16 v[32:35],a[192:195],v[96:99],v[32:35]
ds_read_b128 v[120:123],v7 offset:6144
v_mfma_f32_16x16x32_bf16 v[36:39],a[196:199],v[96:99],v[36:39]
s_waitcnt lgkmcnt(5)
v_mfma_f32_16x16x32_bf16 v[32:35],a[200:203],v[100:103],v[32:35]
ds_read_b128 v[124:127],v7 offset:7168
v_mfma_f32_16x16x32_bf16 v[36:39],a[204:207],v[100:103],v[36:39]
s_waitcnt lgkmcnt(5)
v_mfma_f32_16x16x32_bf16 v[32:35],a[208:211],v[104:107],v[32:35]
v_mfma_f32_16x16x32_bf16 v[36:39],a[212:215],v[104:107],v[36:39]
s_waitcnt lgkmcnt(4)
v_mfma_f32_16x16x32_bf16 v[32:35],a[216:219],v[108:111],v[32:35]
v_mfma_f32_16x16x32_bf16 v[36:39],a[220:223],v[108:111],v[36:39]
s_waitcnt lgkmcnt(3)
v_mfma_f32_16x16x32_bf16 v[32:35],a[224:227],v[112:115],v[32:35]
v_mfma_f32_16x16x32_bf16 v[36:39],a[228:231],v[112:115],v[36:39]
s_waitcnt lgkmcnt(2)
v_mfma_f32_16x16x32_bf16 v[32:35],a[232:235],v[116:119],v[32:35]
v_mfma_f32_16x16x32_bf16 v[36:39],a[236:239],v[116:119],v[36:39]
s_waitcnt lgkmcnt(1)
v_mfma_f32_16x16x32_bf16 v[32:35],a[240:243],v[120:123],v[32:35]
v_mfma_f32_16x16x32_bf16 v[36:39],a[244:247],v[120:123],v[36:39]
s_waitcnt lgkmcnt(0)
v_mfma_f32_16x16x32_bf16 v[32:35],a[248:251],v[124:127],v[32:35]
v_mfma_f32_16x16x32_bf16 v[36:39],a[252:255],v[124:127],v[36:39]
s_mov_b32 s72,0
s_branch join_39
b1_44:
s_nop 7
buffer_store_dwordx4 v[32:35],v0,s[20:23],s64 offen offset:0 sc1
buffer_store_dwordx4 v[36:39],v0,s[20:23],s64 offen offset:1024 sc1
s_branch b2_45
rt_57:
s_sub_u32 s90,s90,1
s_cmp_gt_i32 s90,0
s_cbranch_scc0 go_58
s_add_u32 s64,s74,s75
s_add_u32 s65,s64,4096
buffer_load_dwordx4 v[128:131],v0,s[20:23],s64 offen offset:0 sc1
buffer_load_dwordx4 v[132:135],v0,s[20:23],s64 offen offset:1024 sc1
buffer_load_dwordx4 v[136:139],v0,s[20:23],s64 offen offset:2048 sc1
buffer_load_dwordx4 v[140:143],v0,s[20:23],s64 offen offset:3072 sc1
buffer_load_dwordx4 v[144:147],v0,s[20:23],s65 offen offset:0 sc1
buffer_load_dwordx4 v[148:151],v0,s[20:23],s65 offen offset:1024 sc1
s_waitcnt vmcnt(0)
s_branch ck_56
b1_59:
s_nop 7
buffer_store_dwordx4 v[204:207],v0,s[20:23],s64 offen offset:0 sc1
buffer_store_dwordx4 v[204:207],v0,s[20:23],s64 offen offset:1024 sc1
buffer_store_dwordx4 v[204:207],v0,s[20:23],s64 offen offset:2048 sc1
buffer_store_dwordx4 v[204:207],v0,s[20:23],s64 offen offset:3072 sc1
buffer_store_dwordx4 v[204:207],v0,s[20:23],s65 offen offset:0 sc1
buffer_store_dwordx4 v[204:207],v0,s[20:23],s65 offen offset:1024 sc1
s_branch b2_60
vN_49:
buffer_load_dword v16,v2,s[20:23],s68 offen sc1
s_waitcnt lgkmcnt(5)
v_mfma_f32_16x16x32_bf16 v[32:35],a[176:179],v[88:91],v[32:35]
ds_read_b128 v[112:115],v7 offset:4096
v_mfma_f32_16x16x32_bf16 v[36:39],a[180:183],v[88:91],v[36:39]
s_waitcnt lgkmcnt(5)
v_mfma_f32_16x16x32_bf16 v[32:35],a[184:187],v[92:95],v[32:35]
ds_read_b128 v[116:119],v7 offset:5120
v_mfma_f32_16x16x32_bf16 v[36:39],a[188:191],v[92:95],v[36:39]
s_waitcnt lgkmcnt(5)
v_mfma_f32_16x16x32_bf16 v[32:35],a[192:195],v[96:99],v[32:35]
ds_read_b128 v[120:123],v7 offset:6144
v_mfma_f32_16x16x32_bf16 v[36:39],a[196:199],v[96:99],v[36:39]
s_waitcnt lgkmcnt(5)
v_mfma_f32_16x16x32_bf16 v[32:35],a[200:203],v[100:103],v[32:35]
ds_read_b128 v[124:127],v7 offset:7168
v_mfma_f32_16x16x32_bf16 v[36:39],a[204:207],v[100:103],v[36:39]
s_waitcnt lgkmcnt(5)
v_mfma_f32_16x16x32_bf16 v[32:35],a[208:211],v[104:107],v[32:35]
v_mfma_f32_16x16x32_bf16 v[36:39],a[212:215],v[104:107],v[36:39]
s_waitcnt lgkmcnt(4)
v_mfma_f32_16x16x32_bf16 v[32:35],a[216:219],v[108:111],v[32:35]
v_mfma_f32_16x16x32_bf16 v[36:39],a[220:223],v[108:111],v[36:39]
s_waitcnt lgkmcnt(3)
v_mfma_f32_16x16x32_bf16 v[32:35],a[224:227],v[112:115],v[32:35]
v_mfma_f32_16x16x32_bf16 v[36:39],a[228:231],v[112:115],v[36:39]
s_waitcnt lgkmcnt(2)
v_mfma_f32_16x16x32_bf16 v[32:35],a[232:235],v[116:119],v[32:35]
v_mfma_f32_16x16x32_bf16 v[36:39],a[236:239],v[116:119],v[36:39]
s_waitcnt lgkmcnt(1)
v_mfma_f32_16x16x32_bf16 v[32:35],a[240:243],v[120:123],v[32:35]
v_mfma_f32_16x16x32_bf16 v[36:39],a[244:247],v[120:123],v[36:39]
s_waitcnt lgkmcnt(0)
v_mfma_f32_16x16x32_bf16 v[32:35],a[248:251],v[124:127],v[32:35]
v_mfma_f32_16x16x32_bf16 v[36:39],a[252:255],v[124:127],v[36:39]
s_mov_b32 s72,0
s_branch join_50
rt_62:
s_sub_u32 s90,s90,1
s_cmp_gt_i32 s90,0
s_cbranch_scc0 go_63
s_add_u32 s64,s74,s75
s_add_u32 s65,s64,4096
buffer_load_dwordx4 v[128:131],v0,s[20:23],s64 offen offset:0 sc1
buffer_load_dwordx4 v[132:135],v0,s[20:23],s64 offen offset:1024 sc1
buffer_load_dwordx4 v[136:139],v0,s[20:23],s64 offen offset:2048 sc1
buffer_load_dwordx4 v[140:143],v0,s[20:23],s64 offen offset:3072 sc1
buffer_load_dwordx4 v[144:147],v0,s[20:23],s65 offen offset:0 sc1
buffer_load_dwordx4 v[148:151],v0,s[20:23],s65 offen offset:1024 sc1
s_waitcnt vmcnt(0)
s_branch ck_61
b1_64:
s_nop 7
buffer_store_dwordx4 v[204:207],v0,s[20:23],s64 offen offset:0 sc1
buffer_store_dwordx4 v[204:207],v0,s[20:23],s64 offen offset:1024 sc1
buffer_store_dwordx4 v[204:207],v0,s[20:23],s64 offen offset:2048 sc1
buffer_store_dwordx4 v[204:207],v0,s[20:23],s64 offen offset:3072 sc1
buffer_store_dwordx4 v[204:207],v0,s[20:23],s65 offen offset:0 sc1
buffer_store_dwordx4 v[204:207],v0,s[20:23],s65 offen offset:1024 sc1
s_branch b2_65
done_30:
s_endpgm
fl_w4:
v_and_b32 v21,15,v1
v_lshrrev_b32 v22,4,v1
v_lshrrev_b32 v23,2,v21
v_and_b32 v24,3,v21
s_lshl_b32 s61,s50,15
v_lshl_add_u32 v25,v22,3,v23
s_load_dwordx2 s[4:5],s[0:1],88
s_load_dwordx2 s[6:7],s[0:1],112
s_lshr_b32 s52,s59,3
s_and_b32 s53,s59,7
s_mul_i32 s54,s52,1835008
s_lshl_b32 s64,s53,8
s_add_u32 s54,s54,s64
s_lshl_b32 s64,s50,6
s_add_u32 s54,s54,s64
s_waitcnt lgkmcnt(0)
s_mov_b32 s28,s4
s_and_b32 s29,s5,0xffff
s_mov_b32 s30,0x700000
s_mov_b32 s31,0x20000
s_mov_b32 s24,s6
s_and_b32 s25,s7,0xffff
s_mov_b32 s26,0x400000
s_mov_b32 s27,0x20000
v_lshrrev_b32 v26,2,v1
v_and_b32 v27,3,v1
v_mul_u32_u24 v16,2048,v26
v_lshl_add_u32 v16,v27,4,v16
v_lshlrev_b32 v17,6,v25
v_lshl_add_u32 v17,v24,4,v17
v_add_u32 v17,s61,v17
s_xor_b32 s62,s50,0
s_mul_i32 s62,s62,458752
s_add_u32 s62,s62,s54
s_add_u32 m0,s61,0
s_nop 0
buffer_load_dwordx4 v16,s[28:31],s62 offen lds
s_add_u32 s62,s62,32768
s_add_u32 m0,m0,1024
s_nop 0
buffer_load_dwordx4 v16,s[28:31],s62 offen lds
s_add_u32 s62,s62,32768
s_add_u32 m0,m0,1024
s_nop 0
buffer_load_dwordx4 v16,s[28:31],s62 offen lds
s_add_u32 s62,s62,32768
s_add_u32 m0,m0,1024
s_nop 0
buffer_load_dwordx4 v16,s[28:31],s62 offen lds
s_add_u32 s62,s62,32768
s_add_u32 m0,m0,1024
s_nop 0
buffer_load_dwordx4 v16,s[28:31],s62 offen lds
s_add_u32 s62,s62,32768
s_add_u32 m0,m0,1024
s_nop 0
buffer_load_dwordx4 v16,s[28:31],s62 offen lds
s_add_u32 s62,s62,32768
s_add_u32 m0,m0,1024
s_nop 0
buffer_load_dwordx4 v16,s[28:31],s62 offen lds
s_add_u32 s62,s62,32768
s_add_u32 m0,m0,1024
s_nop 0
buffer_load_dwordx4 v16,s[28:31],s62 offen lds
s_add_u32 s62,s62,32768
s_add_u32 m0,m0,1024
s_nop 0
buffer_load_dwordx4 v16,s[28:31],s62 offen lds
s_add_u32 s62,s62,32768
s_add_u32 m0,m0,1024
s_nop 0
buffer_load_dwordx4 v16,s[28:31],s62 offen lds
s_add_u32 s62,s62,32768
s_add_u32 m0,m0,1024
s_nop 0
buffer_load_dwordx4 v16,s[28:31],s62 offen lds
s_add_u32 s62,s62,32768
s_add_u32 m0,m0,1024
s_nop 0
buffer_load_dwordx4 v16,s[28:31],s62 offen lds
s_add_u32 s62,s62,32768
s_add_u32 m0,m0,1024
s_nop 0
buffer_load_dwordx4 v16,s[28:31],s62 offen lds
s_add_u32 s62,s62,32768
s_add_u32 m0,m0,1024
s_nop 0
buffer_load_dwordx4 v16,s[28:31],s62 offen lds
s_xor_b32 s62,s50,1
s_mul_i32 s62,s62,458752
s_add_u32 s62,s62,s54
s_add_u32 m0,s61,16384
s_nop 0
buffer_load_dwordx4 v16,s[28:31],s62 offen lds
s_add_u32 s62,s62,32768
s_add_u32 m0,m0,1024
s_nop 0
buffer_load_dwordx4 v16,s[28:31],s62 offen lds
s_add_u32 s62,s62,32768
s_add_u32 m0,m0,1024
s_nop 0
buffer_load_dwordx4 v16,s[28:31],s62 offen lds
s_add_u32 s62,s62,32768
s_add_u32 m0,m0,1024
s_nop 0
buffer_load_dwordx4 v16,s[28:31],s62 offen lds
s_add_u32 s62,s62,32768
s_add_u32 m0,m0,1024
s_nop 0
buffer_load_dwordx4 v16,s[28:31],s62 offen lds
s_add_u32 s62,s62,32768
s_add_u32 m0,m0,1024
s_nop 0
buffer_load_dwordx4 v16,s[28:31],s62 offen lds
s_add_u32 s62,s62,32768
s_add_u32 m0,m0,1024
s_nop 0
buffer_load_dwordx4 v16,s[28:31],s62 offen lds
s_add_u32 s62,s62,32768
s_add_u32 m0,m0,1024
s_nop 0
buffer_load_dwordx4 v16,s[28:31],s62 offen lds
s_add_u32 s62,s62,32768
s_add_u32 m0,m0,1024
s_nop 0
buffer_load_dwordx4 v16,s[28:31],s62 offen lds
s_add_u32 s62,s62,32768
s_add_u32 m0,m0,1024
s_nop 0
buffer_load_dwordx4 v16,s[28:31],s62 offen lds
s_add_u32 s62,s62,32768
s_add_u32 m0,m0,1024
s_nop 0
buffer_load_dwordx4 v16,s[28:31],s62 offen lds
s_add_u32 s62,s62,32768
s_add_u32 m0,m0,1024
s_nop 0
buffer_load_dwordx4 v16,s[28:31],s62 offen lds
s_add_u32 s62,s62,32768
s_add_u32 m0,m0,1024
s_nop 0
buffer_load_dwordx4 v16,s[28:31],s62 offen lds
s_add_u32 s62,s62,32768
s_add_u32 m0,m0,1024
s_nop 0
buffer_load_dwordx4 v16,s[28:31],s62 offen lds
s_waitcnt vmcnt(14)
ds_read_b64_tr_b16 a[0:1],v17 offset:0
ds_read_b64_tr_b16 a[2:3],v17 offset:256
ds_read_b64_tr_b16 a[4:5],v17 offset:8
ds_read_b64_tr_b16 a[6:7],v17 offset:264
ds_read_b64_tr_b16 a[8:9],v17 offset:2048
ds_read_b64_tr_b16 a[10:11],v17 offset:2304
ds_read_b64_tr_b16 a[12:13],v17 offset:2056
ds_read_b64_tr_b16 a[14:15],v17 offset:2312
ds_read_b64_tr_b16 a[16:17],v17 offset:4096
ds_read_b64_tr_b16 a[18:19],v17 offset:4352
ds_read_b64_tr_b16 a[20:21],v17 offset:4104
ds_read_b64_tr_b16 a[22:23],v17 offset:4360
s_waitcnt lgkmcnt(0)
ds_read_b64_tr_b16 a[24:25],v17 offset:6144
ds_read_b64_tr_b16 a[26:27],v17 offset:6400
ds_read_b64_tr_b16 a[28:29],v17 offset:6152
ds_read_b64_tr_b16 a[30:31],v17 offset:6408
ds_read_b64_tr_b16 a[32:33],v17 offset:8192
ds_read_b64_tr_b16 a[34:35],v17 offset:8448
ds_read_b64_tr_b16 a[36:37],v17 offset:8200
ds_read_b64_tr_b16 a[38:39],v17 offset:8456
ds_read_b64_tr_b16 a[40:41],v17 offset:10240
ds_read_b64_tr_b16 a[42:43],v17 offset:10496
ds_read_b64_tr_b16 a[44:45],v17 offset:10248
ds_read_b64_tr_b16 a[46:47],v17 offset:10504
s_waitcnt lgkmcnt(0)
ds_read_b64_tr_b16 a[48:49],v17 offset:12288
ds_read_b64_tr_b16 a[50:51],v17 offset:12544
ds_read_b64_tr_b16 a[52:53],v17 offset:12296
ds_read_b64_tr_b16 a[54:55],v17 offset:12552
s_waitcnt lgkmcnt(0)
s_xor_b32 s62,s50,2
s_mul_i32 s62,s62,458752
s_add_u32 s62,s62,s54
s_add_u32 m0,s61,0
s_nop 0
buffer_load_dwordx4 v16,s[28:31],s62 offen lds
s_add_u32 s62,s62,32768
s_add_u32 m0,m0,1024
s_nop 0
buffer_load_dwordx4 v16,s[28:31],s62 offen lds
s_add_u32 s62,s62,32768
s_add_u32 m0,m0,1024
s_nop 0
buffer_load_dwordx4 v16,s[28:31],s62 offen lds
s_add_u32 s62,s62,32768
s_add_u32 m0,m0,1024
s_nop 0
buffer_load_dwordx4 v16,s[28:31],s62 offen lds
s_add_u32 s62,s62,32768
s_add_u32 m0,m0,1024
s_nop 0
buffer_load_dwordx4 v16,s[28:31],s62 offen lds
s_add_u32 s62,s62,32768
s_add_u32 m0,m0,1024
s_nop 0
buffer_load_dwordx4 v16,s[28:31],s62 offen lds
s_add_u32 s62,s62,32768
s_add_u32 m0,m0,1024
s_nop 0
buffer_load_dwordx4 v16,s[28:31],s62 offen lds
s_add_u32 s62,s62,32768
s_add_u32 m0,m0,1024
s_nop 0
buffer_load_dwordx4 v16,s[28:31],s62 offen lds
s_add_u32 s62,s62,32768
s_add_u32 m0,m0,1024
s_nop 0
buffer_load_dwordx4 v16,s[28:31],s62 offen lds
s_add_u32 s62,s62,32768
s_add_u32 m0,m0,1024
s_nop 0
buffer_load_dwordx4 v16,s[28:31],s62 offen lds
s_add_u32 s62,s62,32768
s_add_u32 m0,m0,1024
s_nop 0
buffer_load_dwordx4 v16,s[28:31],s62 offen lds
s_add_u32 s62,s62,32768
s_add_u32 m0,m0,1024
s_nop 0
buffer_load_dwordx4 v16,s[28:31],s62 offen lds
s_add_u32 s62,s62,32768
s_add_u32 m0,m0,1024
s_nop 0
buffer_load_dwordx4 v16,s[28:31],s62 offen lds
s_add_u32 s62,s62,32768
s_add_u32 m0,m0,1024
s_nop 0
buffer_load_dwordx4 v16,s[28:31],s62 offen lds
s_waitcnt vmcnt(14)
ds_read_b64_tr_b16 a[56:57],v17 offset:16384
ds_read_b64_tr_b16 a[58:59],v17 offset:16640
ds_read_b64_tr_b16 a[60:61],v17 offset:16392
ds_read_b64_tr_b16 a[62:63],v17 offset:16648
ds_read_b64_tr_b16 a[64:65],v17 offset:18432
ds_read_b64_tr_b16 a[66:67],v17 offset:18688
ds_read_b64_tr_b16 a[68:69],v17 offset:18440
ds_read_b64_tr_b16 a[70:71],v17 offset:18696
ds_read_b64_tr_b16 a[72:73],v17 offset:20480
ds_read_b64_tr_b16 a[74:75],v17 offset:20736
ds_read_b64_tr_b16 a[76:77],v17 offset:20488
ds_read_b64_tr_b16 a[78:79],v17 offset:20744
s_waitcnt lgkmcnt(0)
ds_read_b64_tr_b16 a[80:81],v17 offset:22528
ds_read_b64_tr_b16 a[82:83],v17 offset:22784
ds_read_b64_tr_b16 a[84:85],v17 offset:22536
ds_read_b64_tr_b16 a[86:87],v17 offset:22792
ds_read_b64_tr_b16 a[88:89],v17 offset:24576
ds_read_b64_tr_b16 a[90:91],v17 offset:24832
ds_read_b64_tr_b16 a[92:93],v17 offset:24584
ds_read_b64_tr_b16 a[94:95],v17 offset:24840
ds_read_b64_tr_b16 a[96:97],v17 offset:26624
ds_read_b64_tr_b16 a[98:99],v17 offset:26880
ds_read_b64_tr_b16 a[100:101],v17 offset:26632
ds_read_b64_tr_b16 a[102:103],v17 offset:26888
s_waitcnt lgkmcnt(0)
ds_read_b64_tr_b16 a[104:105],v17 offset:28672
ds_read_b64_tr_b16 a[106:107],v17 offset:28928
ds_read_b64_tr_b16 a[108:109],v17 offset:28680
ds_read_b64_tr_b16 a[110:111],v17 offset:28936
s_waitcnt lgkmcnt(0)
s_xor_b32 s62,s50,3
s_mul_i32 s62,s62,458752
s_add_u32 s62,s62,s54
s_add_u32 m0,s61,16384
s_nop 0
buffer_load_dwordx4 v16,s[28:31],s62 offen lds
s_add_u32 s62,s62,32768
s_add_u32 m0,m0,1024
s_nop 0
buffer_load_dwordx4 v16,s[28:31],s62 offen lds
s_add_u32 s62,s62,32768
s_add_u32 m0,m0,1024
s_nop 0
buffer_load_dwordx4 v16,s[28:31],s62 offen lds
s_add_u32 s62,s62,32768
s_add_u32 m0,m0,1024
s_nop 0
buffer_load_dwordx4 v16,s[28:31],s62 offen lds
s_add_u32 s62,s62,32768
s_add_u32 m0,m0,1024
s_nop 0
buffer_load_dwordx4 v16,s[28:31],s62 offen lds
s_add_u32 s62,s62,32768
s_add_u32 m0,m0,1024
s_nop 0
buffer_load_dwordx4 v16,s[28:31],s62 offen lds
s_add_u32 s62,s62,32768
s_add_u32 m0,m0,1024
s_nop 0
buffer_load_dwordx4 v16,s[28:31],s62 offen lds
s_add_u32 s62,s62,32768
s_add_u32 m0,m0,1024
s_nop 0
buffer_load_dwordx4 v16,s[28:31],s62 offen lds
s_add_u32 s62,s62,32768
s_add_u32 m0,m0,1024
s_nop 0
buffer_load_dwordx4 v16,s[28:31],s62 offen lds
s_add_u32 s62,s62,32768
s_add_u32 m0,m0,1024
s_nop 0
buffer_load_dwordx4 v16,s[28:31],s62 offen lds
s_add_u32 s62,s62,32768
s_add_u32 m0,m0,1024
s_nop 0
buffer_load_dwordx4 v16,s[28:31],s62 offen lds
s_add_u32 s62,s62,32768
s_add_u32 m0,m0,1024
s_nop 0
buffer_load_dwordx4 v16,s[28:31],s62 offen lds
s_add_u32 s62,s62,32768
s_add_u32 m0,m0,1024
s_nop 0
buffer_load_dwordx4 v16,s[28:31],s62 offen lds
s_add_u32 s62,s62,32768
s_add_u32 m0,m0,1024
s_nop 0
buffer_load_dwordx4 v16,s[28:31],s62 offen lds
s_waitcnt vmcnt(14)
ds_read_b64_tr_b16 a[112:113],v17 offset:0
ds_read_b64_tr_b16 a[114:115],v17 offset:256
ds_read_b64_tr_b16 a[116:117],v17 offset:8
ds_read_b64_tr_b16 a[118:119],v17 offset:264
ds_read_b64_tr_b16 a[120:121],v17 offset:2048
ds_read_b64_tr_b16 a[122:123],v17 offset:2304
ds_read_b64_tr_b16 a[124:125],v17 offset:2056
ds_read_b64_tr_b16 a[126:127],v17 offset:2312
ds_read_b64_tr_b16 a[128:129],v17 offset:4096
ds_read_b64_tr_b16 a[130:131],v17 offset:4352
ds_read_b64_tr_b16 a[132:133],v17 offset:4104
ds_read_b64_tr_b16 a[134:135],v17 offset:4360
s_waitcnt lgkmcnt(0)
ds_read_b64_tr_b16 a[136:137],v17 offset:6144
ds_read_b64_tr_b16 a[138:139],v17 offset:6400
ds_read_b64_tr_b16 a[140:141],v17 offset:6152
ds_read_b64_tr_b16 a[142:143],v17 offset:6408
ds_read_b64_tr_b16 a[144:145],v17 offset:8192
ds_read_b64_tr_b16 a[146:147],v17 offset:8448
ds_read_b64_tr_b16 a[148:149],v17 offset:8200
ds_read_b64_tr_b16 a[150:151],v17 offset:8456
ds_read_b64_tr_b16 a[152:153],v17 offset:10240
ds_read_b64_tr_b16 a[154:155],v17 offset:10496
ds_read_b64_tr_b16 a[156:157],v17 offset:10248
ds_read_b64_tr_b16 a[158:159],v17 offset:10504
s_waitcnt lgkmcnt(0)
ds_read_b64_tr_b16 a[160:161],v17 offset:12288
ds_read_b64_tr_b16 a[162:163],v17 offset:12544
ds_read_b64_tr_b16 a[164:165],v17 offset:12296
ds_read_b64_tr_b16 a[166:167],v17 offset:12552
s_waitcnt lgkmcnt(0)
s_waitcnt vmcnt(0)
ds_read_b64_tr_b16 a[168:169],v17 offset:16384
ds_read_b64_tr_b16 a[170:171],v17 offset:16640
ds_read_b64_tr_b16 a[172:173],v17 offset:16392
ds_read_b64_tr_b16 a[174:175],v17 offset:16648
ds_read_b64_tr_b16 a[176:177],v17 offset:18432
ds_read_b64_tr_b16 a[178:179],v17 offset:18688
ds_read_b64_tr_b16 a[180:181],v17 offset:18440
ds_read_b64_tr_b16 a[182:183],v17 offset:18696
ds_read_b64_tr_b16 a[184:185],v17 offset:20480
ds_read_b64_tr_b16 a[186:187],v17 offset:20736
ds_read_b64_tr_b16 a[188:189],v17 offset:20488
ds_read_b64_tr_b16 a[190:191],v17 offset:20744
s_waitcnt lgkmcnt(0)
ds_read_b64_tr_b16 a[192:193],v17 offset:22528
ds_read_b64_tr_b16 a[194:195],v17 offset:22784
ds_read_b64_tr_b16 a[196:197],v17 offset:22536
ds_read_b64_tr_b16 a[198:199],v17 offset:22792
ds_read_b64_tr_b16 a[200:201],v17 offset:24576
ds_read_b64_tr_b16 a[202:203],v17 offset:24832
ds_read_b64_tr_b16 a[204:205],v17 offset:24584
ds_read_b64_tr_b16 a[206:207],v17 offset:24840
ds_read_b64_tr_b16 a[208:209],v17 offset:26624
ds_read_b64_tr_b16 a[210:211],v17 offset:26880
ds_read_b64_tr_b16 a[212:213],v17 offset:26632
ds_read_b64_tr_b16 a[214:215],v17 offset:26888
s_waitcnt lgkmcnt(0)
ds_read_b64_tr_b16 a[216:217],v17 offset:28672
ds_read_b64_tr_b16 a[218:219],v17 offset:28928
ds_read_b64_tr_b16 a[220:221],v17 offset:28680
ds_read_b64_tr_b16 a[222:223],v17 offset:28936
s_waitcnt lgkmcnt(0)
s_mov_b32 s67,0
s_cmp_eq_u32 s56,1
s_cbranch_scc1 vok_69
v_mbcnt_lo_u32_b32 v16,-1,0
v_and_b32 v16,7,v16
v_lshlrev_b32 v16,7,v16
s_mov_b32 s64,138510336
vpoll_70:
buffer_load_dword v17,v16,s[20:23],s64 offen sc1
s_waitcnt vmcnt(0)
v_readlane_b32 s92,v17,0
v_readlane_b32 s93,v17,1
v_readlane_b32 s94,v17,2
v_readlane_b32 s95,v17,3
v_readlane_b32 s96,v17,4
v_readlane_b32 s97,v17,5
v_readlane_b32 s98,v17,6
v_readlane_b32 s99,v17,7
s_add_u32 s65,s92,s93
s_add_u32 s65,s65,s94
s_add_u32 s65,s65,s95
s_add_u32 s65,s65,s96
s_add_u32 s65,s65,s97
s_add_u32 s65,s65,s98
s_add_u32 s65,s65,s99
s_cmp_ge_u32 s65,256
s_cbranch_scc1 vgot_71
s_sleep 4
s_sub_u32 s90,s90,1
s_cmp_gt_i32 s90,0
s_cbranch_scc1 vpoll_70
vgot_71:
s_min_u32 s65,s92,s93
s_min_u32 s65,s65,s94
s_min_u32 s65,s65,s95
s_min_u32 s65,s65,s96
s_min_u32 s65,s65,s97
s_min_u32 s65,s65,s98
s_min_u32 s65,s65,s99
s_cmp_lt_u32 s65,32
s_cbranch_scc1 fl_slow
s_mov_b32 s56,0
vok_69:
s_barrier
v_lshlrev_b32 v0,4,v1
s_mov_b32 s60,0
s_mov_b32 s70,0
s_mov_b32 s55,0
s_lshl_b32 s63,s50,13
v_mov_b32 v3,v0
s_mov_b32 s73,0xffff0000
s_lshl_b32 s64,s52,2
s_add_u32 s64,s64,s50
s_mul_i32 s61,s64,7168
s_add_u32 s61,s61,219152384
s_lshl_b32 s82,s64,8
s_add_u32 s82,s82,138551296
s_mov_b32 s68,s82
s_lshl_b32 s83,s53,2
s_add_u32 s83,s83,s50
s_xor_b32 s64,s50,0
s_lshl_b32 s64,s64,13
v_add_u32 v8,s64,v0
s_xor_b32 s64,s50,1
s_lshl_b32 s64,s64,13
v_add_u32 v9,s64,v0
s_xor_b32 s64,s50,2
s_lshl_b32 s64,s64,13
v_add_u32 v10,s64,v0
s_xor_b32 s64,s50,3
s_lshl_b32 s64,s64,13
v_add_u32 v11,s64,v0
v_min_u32 v2,6,v1
v_lshlrev_b32 v2,2,v2
s_lshl_b32 s66,s83,10
s_lshr_b32 s65,s83,3
s_lshl_b32 s65,s65,8
s_and_b32 s64,s83,7
s_lshl_b32 s64,s64,2
s_add_u32 s69,s64,s65
s_add_u32 s69,s69,138555392
s_lshl_b32 s64,s53,2
s_add_u32 s64,s64,s50
s_mul_i32 s74,s64,24576
s_xor_b32 s64,s50,s52
s_sub_u32 s64,s64,1
s_max_i32 s64,s64,0
s_lshl_b32 s64,s64,11
s_add_u32 s74,s74,s64
s_add_u32 s74,s74,168820736
s_mov_b32 s75,0
s_mov_b32 s76,0
s_mov_b32 s77,0
v_lshlrev_b32 v26,11,v21
v_lshl_add_u32 v26,v22,4,v26
s_lshl_b32 s64,s83,6
v_add_u32 v18,s64,v26
v_lshlrev_b32 v26,5,v22
s_lshl_b32 s64,s83,7
s_add_u32 s64,s64,267407360
buffer_load_dwordx4 v[152:155],v26,s[20:23],s64 offen
buffer_load_dwordx4 v[156:159],v26,s[20:23],s64 offen offset:16
v_mov_b32 v204,-1
v_mov_b32 v205,-1
v_mov_b32 v206,-1
v_mov_b32 v207,-1
s_cmp_eq_u32 s50,s52
s_cbranch_scc1 lfin_74
s_add_u32 s71,s60,1
plp_80:
buffer_load_dword v16,v2,s[20:23],s68 offen sc1
s_waitcnt vmcnt(0)
v_cmp_gt_u32 vcc,s71,v16
s_cbranch_vccz pok_81
s_sleep 4
s_sub_u32 s90,s90,1
s_cmp_gt_i32 s90,0
s_cbranch_scc1 plp_80
pok_81:
lag_79:
s_add_u32 m0,s70,s63
s_add_u32 s62,s61,4096
buffer_load_dwordx4 v3,s[20:23],s61 offen offset:0 lds
buffer_load_dwordx4 v3,s[20:23],s61 offen offset:1024 lds
buffer_load_dwordx4 v3,s[20:23],s61 offen offset:2048 lds
buffer_load_dwordx4 v3,s[20:23],s61 offen offset:3072 lds
s_add_u32 m0,m0,4096
s_nop 0
buffer_load_dwordx4 v3,s[20:23],s62 offen offset:0 lds
buffer_load_dwordx4 v3,s[20:23],s62 offen offset:1024 lds
buffer_load_dwordx4 v3,s[20:23],s62 offen offset:2048 lds
s_add_u32 s61,s61,114688
s_add_u32 s70,s70,32768
s_and_b32 s70,s70,0x1ffff
buffer_load_dword v17,off,s[20:23],s69
buffer_load_dword v17,off,s[20:23],s69
top_75:
s_add_u32 s71,s60,2
buffer_load_dword v16,v2,s[20:23],s68 offen sc1
v_add_u32 v4,s55,v8
v_add_u32 v5,s55,v9
v_add_u32 v6,s55,v10
v_add_u32 v7,s55,v11
s_add_u32 s55,s55,32768
s_and_b32 s55,s55,0x1ffff
s_waitcnt vmcnt(9)
ds_read_b128 v[64:67],v4 offset:0
s_waitcnt vmcnt(8)
ds_read_b128 v[68:71],v4 offset:1024
s_waitcnt vmcnt(7)
ds_read_b128 v[72:75],v4 offset:2048
s_waitcnt lgkmcnt(2)
v_mfma_f32_16x16x32_bf16 v[32:35],a[0:3],v[64:67],0
v_mfma_f32_16x16x32_bf16 v[36:39],a[4:7],v[64:67],0
s_waitcnt vmcnt(6)
ds_read_b128 v[76:79],v4 offset:3072
s_waitcnt lgkmcnt(2)
v_mfma_f32_16x16x32_bf16 v[32:35],a[8:11],v[68:71],v[32:35]
v_mfma_f32_16x16x32_bf16 v[36:39],a[12:15],v[68:71],v[36:39]
s_waitcnt vmcnt(5)
ds_read_b128 v[80:83],v4 offset:4096
s_waitcnt lgkmcnt(2)
v_mfma_f32_16x16x32_bf16 v[32:35],a[16:19],v[72:75],v[32:35]
v_mfma_f32_16x16x32_bf16 v[36:39],a[20:23],v[72:75],v[36:39]
s_waitcnt vmcnt(4)
ds_read_b128 v[84:87],v4 offset:5120
s_waitcnt lgkmcnt(2)
v_mfma_f32_16x16x32_bf16 v[32:35],a[24:27],v[76:79],v[32:35]
v_mfma_f32_16x16x32_bf16 v[36:39],a[28:31],v[76:79],v[36:39]
s_waitcnt vmcnt(3)
ds_read_b128 v[88:91],v4 offset:6144
s_barrier
s_waitcnt lgkmcnt(2)
v_mfma_f32_16x16x32_bf16 v[32:35],a[32:35],v[80:83],v[32:35]
v_mfma_f32_16x16x32_bf16 v[36:39],a[36:39],v[80:83],v[36:39]
ds_read_b128 v[92:95],v5 offset:0
s_waitcnt lgkmcnt(2)
v_mfma_f32_16x16x32_bf16 v[32:35],a[40:43],v[84:87],v[32:35]
ds_read_b128 v[96:99],v5 offset:1024
ds_read_b128 v[100:103],v5 offset:2048
v_mfma_f32_16x16x32_bf16 v[36:39],a[44:47],v[84:87],v[36:39]
s_waitcnt lgkmcnt(3)
v_mfma_f32_16x16x32_bf16 v[32:35],a[48:51],v[88:91],v[32:35]
ds_read_b128 v[104:107],v5 offset:3072
ds_read_b128 v[108:111],v5 offset:4096
v_mfma_f32_16x16x32_bf16 v[36:39],a[52:55],v[88:91],v[36:39]
s_waitcnt lgkmcnt(4)
v_mfma_f32_16x16x32_bf16 v[32:35],a[56:59],v[92:95],v[32:35]
ds_read_b128 v[112:115],v5 offset:5120
ds_read_b128 v[116:119],v5 offset:6144
v_mfma_f32_16x16x32_bf16 v[36:39],a[60:63],v[92:95],v[36:39]
s_waitcnt lgkmcnt(5)
v_mfma_f32_16x16x32_bf16 v[32:35],a[64:67],v[96:99],v[32:35]
ds_read_b128 v[120:123],v6 offset:0
v_mfma_f32_16x16x32_bf16 v[36:39],a[68:71],v[96:99],v[36:39]
s_waitcnt lgkmcnt(5)
v_mfma_f32_16x16x32_bf16 v[32:35],a[72:75],v[100:103],v[32:35]
ds_read_b128 v[124:127],v6 offset:1024
v_mfma_f32_16x16x32_bf16 v[36:39],a[76:79],v[100:103],v[36:39]
s_waitcnt lgkmcnt(5)
v_mfma_f32_16x16x32_bf16 v[32:35],a[80:83],v[104:107],v[32:35]
ds_read_b128 v[64:67],v6 offset:2048
v_mfma_f32_16x16x32_bf16 v[36:39],a[84:87],v[104:107],v[36:39]
s_waitcnt lgkmcnt(5)
v_mfma_f32_16x16x32_bf16 v[32:35],a[88:91],v[108:111],v[32:35]
ds_read_b128 v[68:71],v6 offset:3072
v_mfma_f32_16x16x32_bf16 v[36:39],a[92:95],v[108:111],v[36:39]
s_waitcnt lgkmcnt(5)
v_mfma_f32_16x16x32_bf16 v[32:35],a[96:99],v[112:115],v[32:35]
ds_read_b128 v[72:75],v6 offset:4096
v_mfma_f32_16x16x32_bf16 v[36:39],a[100:103],v[112:115],v[36:39]
s_waitcnt lgkmcnt(5)
v_mfma_f32_16x16x32_bf16 v[32:35],a[104:107],v[116:119],v[32:35]
ds_read_b128 v[76:79],v6 offset:5120
v_mfma_f32_16x16x32_bf16 v[36:39],a[108:111],v[116:119],v[36:39]
s_waitcnt lgkmcnt(5)
v_mfma_f32_16x16x32_bf16 v[32:35],a[112:115],v[120:123],v[32:35]
ds_read_b128 v[80:83],v6 offset:6144
v_mfma_f32_16x16x32_bf16 v[36:39],a[116:119],v[120:123],v[36:39]
s_waitcnt lgkmcnt(5)
v_mfma_f32_16x16x32_bf16 v[32:35],a[120:123],v[124:127],v[32:35]
ds_read_b128 v[84:87],v7 offset:0
v_mfma_f32_16x16x32_bf16 v[36:39],a[124:127],v[124:127],v[36:39]
s_waitcnt lgkmcnt(5)
v_mfma_f32_16x16x32_bf16 v[32:35],a[128:131],v[64:67],v[32:35]
ds_read_b128 v[88:91],v7 offset:1024
v_mfma_f32_16x16x32_bf16 v[36:39],a[132:135],v[64:67],v[36:39]
s_waitcnt lgkmcnt(5)
v_mfma_f32_16x16x32_bf16 v[32:35],a[136:139],v[68:71],v[32:35]
ds_read_b128 v[92:95],v7 offset:2048
v_mfma_f32_16x16x32_bf16 v[36:39],a[140:143],v[68:71],v[36:39]
s_waitcnt lgkmcnt(5)
v_mfma_f32_16x16x32_bf16 v[32:35],a[144:147],v[72:75],v[32:35]
ds_read_b128 v[96:99],v7 offset:3072
v_mfma_f32_16x16x32_bf16 v[36:39],a[148:151],v[72:75],v[36:39]
s_waitcnt vmcnt(0)
v_cmp_gt_u32 vcc,s71,v16
s_cbranch_vccnz vN_76
s_waitcnt lgkmcnt(5)
v_mfma_f32_16x16x32_bf16 v[32:35],a[152:155],v[76:79],v[32:35]
ds_read_b128 v[100:103],v7 offset:4096
s_add_u32 m0,s70,s63
v_mfma_f32_16x16x32_bf16 v[36:39],a[156:159],v[76:79],v[36:39]
s_add_u32 s62,s61,4096
s_waitcnt lgkmcnt(5)
v_mfma_f32_16x16x32_bf16 v[32:35],a[160:163],v[80:83],v[32:35]
ds_read_b128 v[104:107],v7 offset:5120
buffer_load_dwordx4 v3,s[20:23],s61 offen offset:0 lds
v_mfma_f32_16x16x32_bf16 v[36:39],a[164:167],v[80:83],v[36:39]
buffer_load_dwordx4 v3,s[20:23],s61 offen offset:1024 lds
s_waitcnt lgkmcnt(5)
v_mfma_f32_16x16x32_bf16 v[32:35],a[168:171],v[84:87],v[32:35]
ds_read_b128 v[108:111],v7 offset:6144
buffer_load_dwordx4 v3,s[20:23],s61 offen offset:2048 lds
v_mfma_f32_16x16x32_bf16 v[36:39],a[172:175],v[84:87],v[36:39]
buffer_load_dwordx4 v3,s[20:23],s61 offen offset:3072 lds
s_waitcnt lgkmcnt(5)
v_mfma_f32_16x16x32_bf16 v[32:35],a[176:179],v[88:91],v[32:35]
s_add_u32 m0,m0,4096
v_mfma_f32_16x16x32_bf16 v[36:39],a[180:183],v[88:91],v[36:39]
buffer_load_dwordx4 v3,s[20:23],s62 offen offset:0 lds
s_waitcnt lgkmcnt(4)
v_mfma_f32_16x16x32_bf16 v[32:35],a[184:187],v[92:95],v[32:35]
buffer_load_dwordx4 v3,s[20:23],s62 offen offset:1024 lds
v_mfma_f32_16x16x32_bf16 v[36:39],a[188:191],v[92:95],v[36:39]
buffer_load_dwordx4 v3,s[20:23],s62 offen offset:2048 lds
s_waitcnt lgkmcnt(3)
v_mfma_f32_16x16x32_bf16 v[32:35],a[192:195],v[96:99],v[32:35]
s_add_u32 s61,s61,114688
v_mfma_f32_16x16x32_bf16 v[36:39],a[196:199],v[96:99],v[36:39]
s_add_u32 s70,s70,32768
s_waitcnt lgkmcnt(2)
v_mfma_f32_16x16x32_bf16 v[32:35],a[200:203],v[100:103],v[32:35]
s_and_b32 s70,s70,0x1ffff
v_mfma_f32_16x16x32_bf16 v[36:39],a[204:207],v[100:103],v[36:39]
s_waitcnt lgkmcnt(1)
v_mfma_f32_16x16x32_bf16 v[32:35],a[208:211],v[104:107],v[32:35]
v_mfma_f32_16x16x32_bf16 v[36:39],a[212:215],v[104:107],v[36:39]
s_waitcnt lgkmcnt(0)
v_mfma_f32_16x16x32_bf16 v[32:35],a[216:219],v[108:111],v[32:35]
v_mfma_f32_16x16x32_bf16 v[36:39],a[220:223],v[108:111],v[36:39]
s_mov_b32 s72,1
join_77:
s_add_u32 s64,s74,s75
s_cmp_eq_u32 s56,1
s_cbranch_scc1 b1_82
s_nop 2
buffer_store_dwordx4 v[32:35],v0,s[20:23],s64 offen offset:0
buffer_store_dwordx4 v[36:39],v0,s[20:23],s64 offen offset:1024
b2_83:
s_add_u32 s75,s75,6144
s_cmp_eq_u32 s75,24576
s_cselect_b32 s75,0,s75
s_add_u32 s60,s60,1
s_cmp_eq_u32 s72,0
s_cbranch_scc1 slowp_78
s_branch top_75
slowp_78:
s_waitcnt vmcnt(2)
v_cmp_gt_u32 vcc,s71,v16
s_cbranch_vccz lag_79
s_cmp_ge_u32 s60,128
s_cbranch_scc1 done_68
plp_84:
buffer_load_dword v16,v2,s[20:23],s68 offen sc1
s_waitcnt vmcnt(0)
v_cmp_gt_u32 vcc,s71,v16
s_cbranch_vccz pok_85
s_sleep 4
s_sub_u32 s90,s90,1
s_cmp_gt_i32 s90,0
s_cbranch_scc1 plp_84
pok_85:
s_branch lag_79
lfin_74:
s_add_u32 s71,s60,1
plp_91:
buffer_load_dword v16,v2,s[20:23],s68 offen sc1
s_waitcnt vmcnt(0)
v_cmp_gt_u32 vcc,s71,v16
s_cbranch_vccz pok_92
s_sleep 4
s_sub_u32 s90,s90,1
s_cmp_gt_i32 s90,0
s_cbranch_scc1 plp_91
pok_92:
lag_90:
s_add_u32 m0,s70,s63
s_add_u32 s62,s61,4096
buffer_load_dwordx4 v3,s[20:23],s61 offen offset:0 lds
buffer_load_dwordx4 v3,s[20:23],s61 offen offset:1024 lds
buffer_load_dwordx4 v3,s[20:23],s61 offen offset:2048 lds
buffer_load_dwordx4 v3,s[20:23],s61 offen offset:3072 lds
s_add_u32 m0,m0,4096
s_nop 0
buffer_load_dwordx4 v3,s[20:23],s62 offen offset:0 lds
buffer_load_dwordx4 v3,s[20:23],s62 offen offset:1024 lds
buffer_load_dwordx4 v3,s[20:23],s62 offen offset:2048 lds
s_add_u32 s61,s61,114688
s_add_u32 s70,s70,32768
s_and_b32 s70,s70,0x1ffff
top_86:
s_add_u32 s71,s60,2
buffer_load_dword v16,v2,s[20:23],s68 offen sc1
s_add_u32 s64,s74,s75
s_add_u32 s65,s64,4096
buffer_load_dwordx4 v[128:131],v0,s[20:23],s64 offen offset:0 sc1
buffer_load_dwordx4 v[132:135],v0,s[20:23],s64 offen offset:1024 sc1
buffer_load_dwordx4 v[136:139],v0,s[20:23],s64 offen offset:2048 sc1
buffer_load_dwordx4 v[140:143],v0,s[20:23],s64 offen offset:3072 sc1
buffer_load_dwordx4 v[144:147],v0,s[20:23],s65 offen offset:0 sc1
buffer_load_dwordx4 v[148:151],v0,s[20:23],s65 offen offset:1024 sc1
s_add_u32 s64,s66,201326592
buffer_load_dwordx4 v[160:163],v0,s[20:23],s64 offen
s_add_u32 s64,s66,214958080
buffer_load_dwordx4 v[164:167],v0,s[20:23],s64 offen
v_add_u32 v4,s55,v8
v_add_u32 v5,s55,v9
v_add_u32 v6,s55,v10
v_add_u32 v7,s55,v11
s_add_u32 s55,s55,32768
s_and_b32 s55,s55,0x1ffff
s_waitcnt vmcnt(15)
ds_read_b128 v[64:67],v4 offset:0
s_waitcnt vmcnt(14)
ds_read_b128 v[68:71],v4 offset:1024
s_waitcnt vmcnt(13)
ds_read_b128 v[72:75],v4 offset:2048
s_waitcnt lgkmcnt(2)
v_mfma_f32_16x16x32_bf16 v[32:35],a[0:3],v[64:67],0
v_mfma_f32_16x16x32_bf16 v[36:39],a[4:7],v[64:67],0
s_waitcnt vmcnt(12)
ds_read_b128 v[76:79],v4 offset:3072
s_waitcnt lgkmcnt(2)
v_mfma_f32_16x16x32_bf16 v[32:35],a[8:11],v[68:71],v[32:35]
v_mfma_f32_16x16x32_bf16 v[36:39],a[12:15],v[68:71],v[36:39]
s_waitcnt vmcnt(11)
ds_read_b128 v[80:83],v4 offset:4096
s_waitcnt lgkmcnt(2)
v_mfma_f32_16x16x32_bf16 v[32:35],a[16:19],v[72:75],v[32:35]
v_mfma_f32_16x16x32_bf16 v[36:39],a[20:23],v[72:75],v[36:39]
s_waitcnt vmcnt(10)
ds_read_b128 v[84:87],v4 offset:5120
s_waitcnt lgkmcnt(2)
v_mfma_f32_16x16x32_bf16 v[32:35],a[24:27],v[76:79],v[32:35]
v_mfma_f32_16x16x32_bf16 v[36:39],a[28:31],v[76:79],v[36:39]
s_waitcnt vmcnt(9)
ds_read_b128 v[88:91],v4 offset:6144
s_barrier
s_waitcnt lgkmcnt(2)
v_mfma_f32_16x16x32_bf16 v[32:35],a[32:35],v[80:83],v[32:35]
v_mfma_f32_16x16x32_bf16 v[36:39],a[36:39],v[80:83],v[36:39]
ds_read_b128 v[92:95],v5 offset:0
s_waitcnt lgkmcnt(2)
v_mfma_f32_16x16x32_bf16 v[32:35],a[40:43],v[84:87],v[32:35]
ds_read_b128 v[96:99],v5 offset:1024
ds_read_b128 v[100:103],v5 offset:2048
v_mfma_f32_16x16x32_bf16 v[36:39],a[44:47],v[84:87],v[36:39]
s_waitcnt lgkmcnt(3)
v_mfma_f32_16x16x32_bf16 v[32:35],a[48:51],v[88:91],v[32:35]
ds_read_b128 v[104:107],v5 offset:3072
ds_read_b128 v[108:111],v5 offset:4096
v_mfma_f32_16x16x32_bf16 v[36:39],a[52:55],v[88:91],v[36:39]
s_waitcnt lgkmcnt(4)
v_mfma_f32_16x16x32_bf16 v[32:35],a[56:59],v[92:95],v[32:35]
ds_read_b128 v[112:115],v5 offset:5120
ds_read_b128 v[116:119],v5 offset:6144
v_mfma_f32_16x16x32_bf16 v[36:39],a[60:63],v[92:95],v[36:39]
s_waitcnt lgkmcnt(5)
v_mfma_f32_16x16x32_bf16 v[32:35],a[64:67],v[96:99],v[32:35]
ds_read_b128 v[120:123],v6 offset:0
v_mfma_f32_16x16x32_bf16 v[36:39],a[68:71],v[96:99],v[36:39]
s_waitcnt lgkmcnt(5)
v_mfma_f32_16x16x32_bf16 v[32:35],a[72:75],v[100:103],v[32:35]
ds_read_b128 v[124:127],v6 offset:1024
v_mfma_f32_16x16x32_bf16 v[36:39],a[76:79],v[100:103],v[36:39]
s_waitcnt lgkmcnt(5)
v_mfma_f32_16x16x32_bf16 v[32:35],a[80:83],v[104:107],v[32:35]
ds_read_b128 v[64:67],v6 offset:2048
v_mfma_f32_16x16x32_bf16 v[36:39],a[84:87],v[104:107],v[36:39]
s_waitcnt lgkmcnt(5)
v_mfma_f32_16x16x32_bf16 v[32:35],a[88:91],v[108:111],v[32:35]
ds_read_b128 v[68:71],v6 offset:3072
v_mfma_f32_16x16x32_bf16 v[36:39],a[92:95],v[108:111],v[36:39]
s_waitcnt lgkmcnt(5)
v_mfma_f32_16x16x32_bf16 v[32:35],a[96:99],v[112:115],v[32:35]
ds_read_b128 v[72:75],v6 offset:4096
v_mfma_f32_16x16x32_bf16 v[36:39],a[100:103],v[112:115],v[36:39]
s_waitcnt lgkmcnt(5)
v_mfma_f32_16x16x32_bf16 v[32:35],a[104:107],v[116:119],v[32:35]
ds_read_b128 v[76:79],v6 offset:5120
v_mfma_f32_16x16x32_bf16 v[36:39],a[108:111],v[116:119],v[36:39]
s_waitcnt lgkmcnt(5)
v_mfma_f32_16x16x32_bf16 v[32:35],a[112:115],v[120:123],v[32:35]
ds_read_b128 v[80:83],v6 offset:6144
v_mfma_f32_16x16x32_bf16 v[36:39],a[116:119],v[120:123],v[36:39]
s_waitcnt lgkmcnt(5)
v_mfma_f32_16x16x32_bf16 v[32:35],a[120:123],v[124:127],v[32:35]
ds_read_b128 v[84:87],v7 offset:0
v_mfma_f32_16x16x32_bf16 v[36:39],a[124:127],v[124:127],v[36:39]
s_waitcnt lgkmcnt(5)
v_mfma_f32_16x16x32_bf16 v[32:35],a[128:131],v[64:67],v[32:35]
ds_read_b128 v[88:91],v7 offset:1024
v_mfma_f32_16x16x32_bf16 v[36:39],a[132:135],v[64:67],v[36:39]
s_waitcnt lgkmcnt(5)
v_mfma_f32_16x16x32_bf16 v[32:35],a[136:139],v[68:71],v[32:35]
ds_read_b128 v[92:95],v7 offset:2048
v_mfma_f32_16x16x32_bf16 v[36:39],a[140:143],v[68:71],v[36:39]
s_waitcnt lgkmcnt(5)
v_mfma_f32_16x16x32_bf16 v[32:35],a[144:147],v[72:75],v[32:35]
ds_read_b128 v[96:99],v7 offset:3072
v_mfma_f32_16x16x32_bf16 v[36:39],a[148:151],v[72:75],v[36:39]
s_waitcnt vmcnt(0)
s_cmp_eq_u32 s77,0
s_cbranch_scc1 np_93
ck_94:
v_pk_add_f32 v[128:129],v[128:129],v[136:137]
v_pk_add_f32 v[144:145],v[144:145],v[40:41]
v_pk_add_f32 v[130:131],v[130:131],v[138:139]
v_pk_add_f32 v[146:147],v[146:147],v[42:43]
v_pk_add_f32 v[132:133],v[132:133],v[140:141]
v_pk_add_f32 v[148:149],v[148:149],v[44:45]
v_pk_add_f32 v[134:135],v[134:135],v[142:143]
v_pk_add_f32 v[150:151],v[150:151],v[46:47]
v_pk_add_f32 v[128:129],v[128:129],v[144:145]
v_pk_add_f32 v[130:131],v[130:131],v[146:147]
v_pk_add_f32 v[132:133],v[132:133],v[148:149]
v_pk_add_f32 v[134:135],v[134:135],v[150:151]
v_pk_add_f32 v[168:169],v[128:129],v[130:131]
v_pk_add_f32 v[170:171],v[132:133],v[134:135]
v_pk_add_f32 v[168:169],v[168:169],v[170:171]
v_cmp_u_f32 vcc,v168,v169
s_cbranch_vccnz rt_95
go_96:
v_lshlrev_b32 v168,16,v160
v_and_b32 v169,s73,v160
v_lshlrev_b32 v170,16,v161
v_and_b32 v171,s73,v161
v_lshlrev_b32 v172,16,v162
v_and_b32 v173,s73,v162
v_lshlrev_b32 v174,16,v163
v_and_b32 v175,s73,v163
v_lshlrev_b32 v176,16,v164
v_and_b32 v177,s73,v164
v_lshlrev_b32 v178,16,v165
v_and_b32 v179,s73,v165
v_lshlrev_b32 v180,16,v166
v_and_b32 v181,s73,v166
v_lshlrev_b32 v182,16,v167
v_and_b32 v183,s73,v167
v_pk_add_f32 v[128:129],v[128:129],v[176:177]
v_pk_add_f32 v[130:131],v[130:131],v[178:179]
v_pk_add_f32 v[132:133],v[132:133],v[180:181]
v_pk_add_f32 v[134:135],v[134:135],v[182:183]
v_fma_f32 v168,v128,v152,v168
v_fma_f32 v169,v129,v153,v169
v_fma_f32 v170,v130,v154,v170
v_fma_f32 v171,v131,v155,v171
v_fma_f32 v172,v132,v156,v172
v_fma_f32 v173,v133,v157,v173
v_fma_f32 v174,v134,v158,v174
v_fma_f32 v175,v135,v159,v175
v_cvt_pk_bf16_f32 v176,v168,v169
v_cvt_pk_bf16_f32 v177,v170,v171
v_cvt_pk_bf16_f32 v178,v172,v173
v_cvt_pk_bf16_f32 v179,v174,v175
s_and_b32 s64,s66,0xffff8000
buffer_store_dwordx4 v[176:179],v18,s[24:27],s64 offen
s_add_u32 s64,s74,s75
s_add_u32 s65,s64,4096
s_cmp_eq_u32 s56,1
s_cbranch_scc1 b1_97
buffer_store_dwordx4 v[204:207],v0,s[20:23],s64 offen offset:0
buffer_store_dwordx4 v[204:207],v0,s[20:23],s64 offen offset:1024
buffer_store_dwordx4 v[204:207],v0,s[20:23],s64 offen offset:2048
buffer_store_dwordx4 v[204:207],v0,s[20:23],s64 offen offset:3072
buffer_store_dwordx4 v[204:207],v0,s[20:23],s65 offen offset:0
buffer_store_dwordx4 v[204:207],v0,s[20:23],s65 offen offset:1024
b2_98:
s_add_u32 s66,s66,32768
s_add_u32 s75,s75,6144
s_cmp_eq_u32 s75,24576
s_cselect_b32 s75,0,s75
s_add_u32 s76,s76,1
s_mov_b32 s77,0
np_93:
v_cmp_gt_u32 vcc,s71,v16
s_cbranch_vccnz vN_87
s_waitcnt lgkmcnt(5)
v_mfma_f32_16x16x32_bf16 v[32:35],a[152:155],v[76:79],v[32:35]
ds_read_b128 v[100:103],v7 offset:4096
s_add_u32 m0,s70,s63
v_mfma_f32_16x16x32_bf16 v[36:39],a[156:159],v[76:79],v[36:39]
s_add_u32 s62,s61,4096
s_waitcnt lgkmcnt(5)
v_mfma_f32_16x16x32_bf16 v[32:35],a[160:163],v[80:83],v[32:35]
ds_read_b128 v[104:107],v7 offset:5120
buffer_load_dwordx4 v3,s[20:23],s61 offen offset:0 lds
v_mfma_f32_16x16x32_bf16 v[36:39],a[164:167],v[80:83],v[36:39]
buffer_load_dwordx4 v3,s[20:23],s61 offen offset:1024 lds
s_waitcnt lgkmcnt(5)
v_mfma_f32_16x16x32_bf16 v[32:35],a[168:171],v[84:87],v[32:35]
ds_read_b128 v[108:111],v7 offset:6144
buffer_load_dwordx4 v3,s[20:23],s61 offen offset:2048 lds
v_mfma_f32_16x16x32_bf16 v[36:39],a[172:175],v[84:87],v[36:39]
buffer_load_dwordx4 v3,s[20:23],s61 offen offset:3072 lds
s_waitcnt lgkmcnt(5)
v_mfma_f32_16x16x32_bf16 v[32:35],a[176:179],v[88:91],v[32:35]
s_add_u32 m0,m0,4096
v_mfma_f32_16x16x32_bf16 v[36:39],a[180:183],v[88:91],v[36:39]
buffer_load_dwordx4 v3,s[20:23],s62 offen offset:0 lds
s_waitcnt lgkmcnt(4)
v_mfma_f32_16x16x32_bf16 v[32:35],a[184:187],v[92:95],v[32:35]
buffer_load_dwordx4 v3,s[20:23],s62 offen offset:1024 lds
v_mfma_f32_16x16x32_bf16 v[36:39],a[188:191],v[92:95],v[36:39]
buffer_load_dwordx4 v3,s[20:23],s62 offen offset:2048 lds
s_waitcnt lgkmcnt(3)
v_mfma_f32_16x16x32_bf16 v[32:35],a[192:195],v[96:99],v[32:35]
s_add_u32 s61,s61,114688
v_mfma_f32_16x16x32_bf16 v[36:39],a[196:199],v[96:99],v[36:39]
s_add_u32 s70,s70,32768
s_waitcnt lgkmcnt(2)
v_mfma_f32_16x16x32_bf16 v[32:35],a[200:203],v[100:103],v[32:35]
s_and_b32 s70,s70,0x1ffff
v_mfma_f32_16x16x32_bf16 v[36:39],a[204:207],v[100:103],v[36:39]
s_waitcnt lgkmcnt(1)
v_mfma_f32_16x16x32_bf16 v[32:35],a[208:211],v[104:107],v[32:35]
v_mfma_f32_16x16x32_bf16 v[36:39],a[212:215],v[104:107],v[36:39]
s_waitcnt lgkmcnt(0)
v_mfma_f32_16x16x32_bf16 v[32:35],a[216:219],v[108:111],v[32:35]
v_mfma_f32_16x16x32_bf16 v[36:39],a[220:223],v[108:111],v[36:39]
s_mov_b32 s72,1
join_88:
s_nop 5
v_mov_b32 v40,v32
v_mov_b32 v41,v33
v_mov_b32 v42,v34
v_mov_b32 v43,v35
v_mov_b32 v44,v36
v_mov_b32 v45,v37
v_mov_b32 v46,v38
v_mov_b32 v47,v39
s_mov_b32 s77,1
s_add_u32 s60,s60,1
s_cmp_eq_u32 s72,0
s_cbranch_scc1 slowp_89
s_branch top_86
slowp_89:
s_waitcnt vmcnt(0)
v_cmp_gt_u32 vcc,s71,v16
s_cbranch_vccz lag_90
s_add_u32 s64,s66,201326592
buffer_load_dwordx4 v[160:163],v0,s[20:23],s64 offen
s_add_u32 s64,s66,214958080
buffer_load_dwordx4 v[164:167],v0,s[20:23],s64 offen
s_add_u32 s64,s74,s75
s_add_u32 s65,s64,4096
buffer_load_dwordx4 v[128:131],v0,s[20:23],s64 offen offset:0 sc1
buffer_load_dwordx4 v[132:135],v0,s[20:23],s64 offen offset:1024 sc1
buffer_load_dwordx4 v[136:139],v0,s[20:23],s64 offen offset:2048 sc1
buffer_load_dwordx4 v[140:143],v0,s[20:23],s64 offen offset:3072 sc1
buffer_load_dwordx4 v[144:147],v0,s[20:23],s65 offen offset:0 sc1
buffer_load_dwordx4 v[148:151],v0,s[20:23],s65 offen offset:1024 sc1
s_waitcnt vmcnt(0)
ck_99:
v_pk_add_f32 v[128:129],v[128:129],v[136:137]
v_pk_add_f32 v[144:145],v[144:145],v[40:41]
v_pk_add_f32 v[130:131],v[130:131],v[138:139]
v_pk_add_f32 v[146:147],v[146:147],v[42:43]
v_pk_add_f32 v[132:133],v[132:133],v[140:141]
v_pk_add_f32 v[148:149],v[148:149],v[44:45]
v_pk_add_f32 v[134:135],v[134:135],v[142:143]
v_pk_add_f32 v[150:151],v[150:151],v[46:47]
v_pk_add_f32 v[128:129],v[128:129],v[144:145]
v_pk_add_f32 v[130:131],v[130:131],v[146:147]
v_pk_add_f32 v[132:133],v[132:133],v[148:149]
v_pk_add_f32 v[134:135],v[134:135],v[150:151]
v_pk_add_f32 v[168:169],v[128:129],v[130:131]
v_pk_add_f32 v[170:171],v[132:133],v[134:135]
v_pk_add_f32 v[168:169],v[168:169],v[170:171]
v_cmp_u_f32 vcc,v168,v169
s_cbranch_vccnz rt_100
go_101:
v_lshlrev_b32 v168,16,v160
v_and_b32 v169,s73,v160
v_lshlrev_b32 v170,16,v161
v_and_b32 v171,s73,v161
v_lshlrev_b32 v172,16,v162
v_and_b32 v173,s73,v162
v_lshlrev_b32 v174,16,v163
v_and_b32 v175,s73,v163
v_lshlrev_b32 v176,16,v164
v_and_b32 v177,s73,v164
v_lshlrev_b32 v178,16,v165
v_and_b32 v179,s73,v165
v_lshlrev_b32 v180,16,v166
v_and_b32 v181,s73,v166
v_lshlrev_b32 v182,16,v167
v_and_b32 v183,s73,v167
v_pk_add_f32 v[128:129],v[128:129],v[176:177]
v_pk_add_f32 v[130:131],v[130:131],v[178:179]
v_pk_add_f32 v[132:133],v[132:133],v[180:181]
v_pk_add_f32 v[134:135],v[134:135],v[182:183]
v_fma_f32 v168,v128,v152,v168
v_fma_f32 v169,v129,v153,v169
v_fma_f32 v170,v130,v154,v170
v_fma_f32 v171,v131,v155,v171
v_fma_f32 v172,v132,v156,v172
v_fma_f32 v173,v133,v157,v173
v_fma_f32 v174,v134,v158,v174
v_fma_f32 v175,v135,v159,v175
v_cvt_pk_bf16_f32 v176,v168,v169
v_cvt_pk_bf16_f32 v177,v170,v171
v_cvt_pk_bf16_f32 v178,v172,v173
v_cvt_pk_bf16_f32 v179,v174,v175
s_and_b32 s64,s66,0xffff8000
buffer_store_dwordx4 v[176:179],v18,s[24:27],s64 offen
s_add_u32 s64,s74,s75
s_add_u32 s65,s64,4096
s_cmp_eq_u32 s56,1
s_cbranch_scc1 b1_102
buffer_store_dwordx4 v[204:207],v0,s[20:23],s64 offen offset:0
buffer_store_dwordx4 v[204:207],v0,s[20:23],s64 offen offset:1024
buffer_store_dwordx4 v[204:207],v0,s[20:23],s64 offen offset:2048
buffer_store_dwordx4 v[204:207],v0,s[20:23],s64 offen offset:3072
buffer_store_dwordx4 v[204:207],v0,s[20:23],s65 offen offset:0
buffer_store_dwordx4 v[204:207],v0,s[20:23],s65 offen offset:1024
b2_103:
s_add_u32 s66,s66,32768
s_add_u32 s75,s75,6144
s_cmp_eq_u32 s75,24576
s_cselect_b32 s75,0,s75
s_add_u32 s76,s76,1
s_mov_b32 s77,0
s_cmp_ge_u32 s60,128
s_cbranch_scc1 done_68
plp_104:
buffer_load_dword v16,v2,s[20:23],s68 offen sc1
s_waitcnt vmcnt(0)
v_cmp_gt_u32 vcc,s71,v16
s_cbranch_vccz pok_105
s_sleep 4
s_sub_u32 s90,s90,1
s_cmp_gt_i32 s90,0
s_cbranch_scc1 plp_104
pok_105:
s_branch lag_90
vN_76:
buffer_load_dword v16,v2,s[20:23],s68 offen sc1
s_waitcnt lgkmcnt(5)
v_mfma_f32_16x16x32_bf16 v[32:35],a[152:155],v[76:79],v[32:35]
ds_read_b128 v[100:103],v7 offset:4096
v_mfma_f32_16x16x32_bf16 v[36:39],a[156:159],v[76:79],v[36:39]
s_waitcnt lgkmcnt(5)
v_mfma_f32_16x16x32_bf16 v[32:35],a[160:163],v[80:83],v[32:35]
ds_read_b128 v[104:107],v7 offset:5120
v_mfma_f32_16x16x32_bf16 v[36:39],a[164:167],v[80:83],v[36:39]
s_waitcnt lgkmcnt(5)
v_mfma_f32_16x16x32_bf16 v[32:35],a[168:171],v[84:87],v[32:35]
ds_read_b128 v[108:111],v7 offset:6144
v_mfma_f32_16x16x32_bf16 v[36:39],a[172:175],v[84:87],v[36:39]
s_waitcnt lgkmcnt(5)
v_mfma_f32_16x16x32_bf16 v[32:35],a[176:179],v[88:91],v[32:35]
v_mfma_f32_16x16x32_bf16 v[36:39],a[180:183],v[88:91],v[36:39]
s_waitcnt lgkmcnt(4)
v_mfma_f32_16x16x32_bf16 v[32:35],a[184:187],v[92:95],v[32:35]
v_mfma_f32_16x16x32_bf16 v[36:39],a[188:191],v[92:95],v[36:39]
s_waitcnt lgkmcnt(3)
v_mfma_f32_16x16x32_bf16 v[32:35],a[192:195],v[96:99],v[32:35]
v_mfma_f32_16x16x32_bf16 v[36:39],a[196:199],v[96:99],v[36:39]
s_waitcnt lgkmcnt(2)
v_mfma_f32_16x16x32_bf16 v[32:35],a[200:203],v[100:103],v[32:35]
v_mfma_f32_16x16x32_bf16 v[36:39],a[204:207],v[100:103],v[36:39]
s_waitcnt lgkmcnt(1)
v_mfma_f32_16x16x32_bf16 v[32:35],a[208:211],v[104:107],v[32:35]
v_mfma_f32_16x16x32_bf16 v[36:39],a[212:215],v[104:107],v[36:39]
s_waitcnt lgkmcnt(0)
v_mfma_f32_16x16x32_bf16 v[32:35],a[216:219],v[108:111],v[32:35]
v_mfma_f32_16x16x32_bf16 v[36:39],a[220:223],v[108:111],v[36:39]
s_mov_b32 s72,0
s_branch join_77
b1_82:
s_nop 7
buffer_store_dwordx4 v[32:35],v0,s[20:23],s64 offen offset:0 sc1
buffer_store_dwordx4 v[36:39],v0,s[20:23],s64 offen offset:1024 sc1
s_branch b2_83
rt_95:
s_sub_u32 s90,s90,1
s_cmp_gt_i32 s90,0
s_cbranch_scc0 go_96
s_add_u32 s64,s74,s75
s_add_u32 s65,s64,4096
buffer_load_dwordx4 v[128:131],v0,s[20:23],s64 offen offset:0 sc1
buffer_load_dwordx4 v[132:135],v0,s[20:23],s64 offen offset:1024 sc1
buffer_load_dwordx4 v[136:139],v0,s[20:23],s64 offen offset:2048 sc1
buffer_load_dwordx4 v[140:143],v0,s[20:23],s64 offen offset:3072 sc1
buffer_load_dwordx4 v[144:147],v0,s[20:23],s65 offen offset:0 sc1
buffer_load_dwordx4 v[148:151],v0,s[20:23],s65 offen offset:1024 sc1
s_waitcnt vmcnt(0)
s_branch ck_94
b1_97:
s_nop 7
buffer_store_dwordx4 v[204:207],v0,s[20:23],s64 offen offset:0 sc1
buffer_store_dwordx4 v[204:207],v0,s[20:23],s64 offen offset:1024 sc1
buffer_store_dwordx4 v[204:207],v0,s[20:23],s64 offen offset:2048 sc1
buffer_store_dwordx4 v[204:207],v0,s[20:23],s64 offen offset:3072 sc1
buffer_store_dwordx4 v[204:207],v0,s[20:23],s65 offen offset:0 sc1
buffer_store_dwordx4 v[204:207],v0,s[20:23],s65 offen offset:1024 sc1
s_branch b2_98
vN_87:
buffer_load_dword v16,v2,s[20:23],s68 offen sc1
s_waitcnt lgkmcnt(5)
v_mfma_f32_16x16x32_bf16 v[32:35],a[152:155],v[76:79],v[32:35]
ds_read_b128 v[100:103],v7 offset:4096
v_mfma_f32_16x16x32_bf16 v[36:39],a[156:159],v[76:79],v[36:39]
s_waitcnt lgkmcnt(5)
v_mfma_f32_16x16x32_bf16 v[32:35],a[160:163],v[80:83],v[32:35]
ds_read_b128 v[104:107],v7 offset:5120
v_mfma_f32_16x16x32_bf16 v[36:39],a[164:167],v[80:83],v[36:39]
s_waitcnt lgkmcnt(5)
v_mfma_f32_16x16x32_bf16 v[32:35],a[168:171],v[84:87],v[32:35]
ds_read_b128 v[108:111],v7 offset:6144
v_mfma_f32_16x16x32_bf16 v[36:39],a[172:175],v[84:87],v[36:39]
s_waitcnt lgkmcnt(5)
v_mfma_f32_16x16x32_bf16 v[32:35],a[176:179],v[88:91],v[32:35]
v_mfma_f32_16x16x32_bf16 v[36:39],a[180:183],v[88:91],v[36:39]
s_waitcnt lgkmcnt(4)
v_mfma_f32_16x16x32_bf16 v[32:35],a[184:187],v[92:95],v[32:35]
v_mfma_f32_16x16x32_bf16 v[36:39],a[188:191],v[92:95],v[36:39]
s_waitcnt lgkmcnt(3)
v_mfma_f32_16x16x32_bf16 v[32:35],a[192:195],v[96:99],v[32:35]
v_mfma_f32_16x16x32_bf16 v[36:39],a[196:199],v[96:99],v[36:39]
s_waitcnt lgkmcnt(2)
v_mfma_f32_16x16x32_bf16 v[32:35],a[200:203],v[100:103],v[32:35]
v_mfma_f32_16x16x32_bf16 v[36:39],a[204:207],v[100:103],v[36:39]
s_waitcnt lgkmcnt(1)
v_mfma_f32_16x16x32_bf16 v[32:35],a[208:211],v[104:107],v[32:35]
v_mfma_f32_16x16x32_bf16 v[36:39],a[212:215],v[104:107],v[36:39]
s_waitcnt lgkmcnt(0)
v_mfma_f32_16x16x32_bf16 v[32:35],a[216:219],v[108:111],v[32:35]
v_mfma_f32_16x16x32_bf16 v[36:39],a[220:223],v[108:111],v[36:39]
s_mov_b32 s72,0
s_branch join_88
rt_100:
s_sub_u32 s90,s90,1
s_cmp_gt_i32 s90,0
s_cbranch_scc0 go_101
s_add_u32 s64,s74,s75
s_add_u32 s65,s64,4096
buffer_load_dwordx4 v[128:131],v0,s[20:23],s64 offen offset:0 sc1
buffer_load_dwordx4 v[132:135],v0,s[20:23],s64 offen offset:1024 sc1
buffer_load_dwordx4 v[136:139],v0,s[20:23],s64 offen offset:2048 sc1
buffer_load_dwordx4 v[140:143],v0,s[20:23],s64 offen offset:3072 sc1
buffer_load_dwordx4 v[144:147],v0,s[20:23],s65 offen offset:0 sc1
buffer_load_dwordx4 v[148:151],v0,s[20:23],s65 offen offset:1024 sc1
s_waitcnt vmcnt(0)
s_branch ck_99
b1_102:
s_nop 7
buffer_store_dwordx4 v[204:207],v0,s[20:23],s64 offen offset:0 sc1
buffer_store_dwordx4 v[204:207],v0,s[20:23],s64 offen offset:1024 sc1
buffer_store_dwordx4 v[204:207],v0,s[20:23],s64 offen offset:2048 sc1
buffer_store_dwordx4 v[204:207],v0,s[20:23],s64 offen offset:3072 sc1
buffer_store_dwordx4 v[204:207],v0,s[20:23],s65 offen offset:0 sc1
buffer_store_dwordx4 v[204:207],v0,s[20:23],s65 offen offset:1024 sc1
s_branch b2_103
done_68:
s_endpgm
fl_w3:
v_and_b32 v21,15,v1
v_lshrrev_b32 v22,4,v1
v_lshrrev_b32 v23,2,v21
v_and_b32 v24,3,v21
s_lshl_b32 s61,s50,15
v_lshl_add_u32 v25,v22,3,v23
s_load_dwordx2 s[4:5],s[0:1],80
s_mov_b32 s52,0
s_mov_b32 s53,s59
s_mul_i32 s54,s52,7340032
s_lshl_b32 s64,s53,8
s_add_u32 s54,s54,s64
s_lshl_b32 s64,s50,6
s_add_u32 s54,s54,s64
s_waitcnt lgkmcnt(0)
s_mov_b32 s28,s4
s_and_b32 s29,s5,0xffff
s_mov_b32 s30,0x700000
s_mov_b32 s31,0x20000
v_lshrrev_b32 v26,2,v1
v_and_b32 v27,3,v1
v_mul_u32_u24 v16,7168,v26
v_lshl_add_u32 v16,v27,4,v16
v_lshlrev_b32 v17,6,v25
v_lshl_add_u32 v17,v24,4,v17
v_add_u32 v17,s61,v17
s_xor_b32 s62,s50,0
s_mul_i32 s62,s62,1835008
s_add_u32 s62,s62,s54
s_add_u32 m0,s61,0
s_nop 0
buffer_load_dwordx4 v16,s[28:31],s62 offen lds
s_add_u32 s62,s62,114688
s_add_u32 m0,m0,1024
s_nop 0
buffer_load_dwordx4 v16,s[28:31],s62 offen lds
s_add_u32 s62,s62,114688
s_add_u32 m0,m0,1024
s_nop 0
buffer_load_dwordx4 v16,s[28:31],s62 offen lds
s_add_u32 s62,s62,114688
s_add_u32 m0,m0,1024
s_nop 0
buffer_load_dwordx4 v16,s[28:31],s62 offen lds
s_add_u32 s62,s62,114688
s_add_u32 m0,m0,1024
s_nop 0
buffer_load_dwordx4 v16,s[28:31],s62 offen lds
s_add_u32 s62,s62,114688
s_add_u32 m0,m0,1024
s_nop 0
buffer_load_dwordx4 v16,s[28:31],s62 offen lds
s_add_u32 s62,s62,114688
s_add_u32 m0,m0,1024
s_nop 0
buffer_load_dwordx4 v16,s[28:31],s62 offen lds
s_add_u32 s62,s62,114688
s_add_u32 m0,m0,1024
s_nop 0
buffer_load_dwordx4 v16,s[28:31],s62 offen lds
s_add_u32 s62,s62,114688
s_add_u32 m0,m0,1024
s_nop 0
buffer_load_dwordx4 v16,s[28:31],s62 offen lds
s_add_u32 s62,s62,114688
s_add_u32 m0,m0,1024
s_nop 0
buffer_load_dwordx4 v16,s[28:31],s62 offen lds
s_add_u32 s62,s62,114688
s_add_u32 m0,m0,1024
s_nop 0
buffer_load_dwordx4 v16,s[28:31],s62 offen lds
s_add_u32 s62,s62,114688
s_add_u32 m0,m0,1024
s_nop 0
buffer_load_dwordx4 v16,s[28:31],s62 offen lds
s_add_u32 s62,s62,114688
s_add_u32 m0,m0,1024
s_nop 0
buffer_load_dwordx4 v16,s[28:31],s62 offen lds
s_add_u32 s62,s62,114688
s_add_u32 m0,m0,1024
s_nop 0
buffer_load_dwordx4 v16,s[28:31],s62 offen lds
s_add_u32 s62,s62,114688
s_add_u32 m0,m0,1024
s_nop 0
buffer_load_dwordx4 v16,s[28:31],s62 offen lds
s_add_u32 s62,s62,114688
s_add_u32 m0,m0,1024
s_nop 0
buffer_load_dwordx4 v16,s[28:31],s62 offen lds
s_xor_b32 s62,s50,1
s_mul_i32 s62,s62,1835008
s_add_u32 s62,s62,s54
s_add_u32 m0,s61,16384
s_nop 0
buffer_load_dwordx4 v16,s[28:31],s62 offen lds
s_add_u32 s62,s62,114688
s_add_u32 m0,m0,1024
s_nop 0
buffer_load_dwordx4 v16,s[28:31],s62 offen lds
s_add_u32 s62,s62,114688
s_add_u32 m0,m0,1024
s_nop 0
buffer_load_dwordx4 v16,s[28:31],s62 offen lds
s_add_u32 s62,s62,114688
s_add_u32 m0,m0,1024
s_nop 0
buffer_load_dwordx4 v16,s[28:31],s62 offen lds
s_add_u32 s62,s62,114688
s_add_u32 m0,m0,1024
s_nop 0
buffer_load_dwordx4 v16,s[28:31],s62 offen lds
s_add_u32 s62,s62,114688
s_add_u32 m0,m0,1024
s_nop 0
buffer_load_dwordx4 v16,s[28:31],s62 offen lds
s_add_u32 s62,s62,114688
s_add_u32 m0,m0,1024
s_nop 0
buffer_load_dwordx4 v16,s[28:31],s62 offen lds
s_add_u32 s62,s62,114688
s_add_u32 m0,m0,1024
s_nop 0
buffer_load_dwordx4 v16,s[28:31],s62 offen lds
s_add_u32 s62,s62,114688
s_add_u32 m0,m0,1024
s_nop 0
buffer_load_dwordx4 v16,s[28:31],s62 offen lds
s_add_u32 s62,s62,114688
s_add_u32 m0,m0,1024
s_nop 0
buffer_load_dwordx4 v16,s[28:31],s62 offen lds
s_add_u32 s62,s62,114688
s_add_u32 m0,m0,1024
s_nop 0
buffer_load_dwordx4 v16,s[28:31],s62 offen lds
s_add_u32 s62,s62,114688
s_add_u32 m0,m0,1024
s_nop 0
buffer_load_dwordx4 v16,s[28:31],s62 offen lds
s_add_u32 s62,s62,114688
s_add_u32 m0,m0,1024
s_nop 0
buffer_load_dwordx4 v16,s[28:31],s62 offen lds
s_add_u32 s62,s62,114688
s_add_u32 m0,m0,1024
s_nop 0
buffer_load_dwordx4 v16,s[28:31],s62 offen lds
s_add_u32 s62,s62,114688
s_add_u32 m0,m0,1024
s_nop 0
buffer_load_dwordx4 v16,s[28:31],s62 offen lds
s_add_u32 s62,s62,114688
s_add_u32 m0,m0,1024
s_nop 0
buffer_load_dwordx4 v16,s[28:31],s62 offen lds
s_waitcnt vmcnt(16)
ds_read_b64_tr_b16 a[0:1],v17 offset:0
ds_read_b64_tr_b16 a[2:3],v17 offset:256
ds_read_b64_tr_b16 a[4:5],v17 offset:8
ds_read_b64_tr_b16 a[6:7],v17 offset:264
ds_read_b64_tr_b16 a[8:9],v17 offset:2048
ds_read_b64_tr_b16 a[10:11],v17 offset:2304
ds_read_b64_tr_b16 a[12:13],v17 offset:2056
ds_read_b64_tr_b16 a[14:15],v17 offset:2312
ds_read_b64_tr_b16 a[16:17],v17 offset:4096
ds_read_b64_tr_b16 a[18:19],v17 offset:4352
ds_read_b64_tr_b16 a[20:21],v17 offset:4104
ds_read_b64_tr_b16 a[22:23],v17 offset:4360
s_waitcnt lgkmcnt(0)
ds_read_b64_tr_b16 a[24:25],v17 offset:6144
ds_read_b64_tr_b16 a[26:27],v17 offset:6400
ds_read_b64_tr_b16 a[28:29],v17 offset:6152
ds_read_b64_tr_b16 a[30:31],v17 offset:6408
ds_read_b64_tr_b16 a[32:33],v17 offset:8192
ds_read_b64_tr_b16 a[34:35],v17 offset:8448
ds_read_b64_tr_b16 a[36:37],v17 offset:8200
ds_read_b64_tr_b16 a[38:39],v17 offset:8456
ds_read_b64_tr_b16 a[40:41],v17 offset:10240
ds_read_b64_tr_b16 a[42:43],v17 offset:10496
ds_read_b64_tr_b16 a[44:45],v17 offset:10248
ds_read_b64_tr_b16 a[46:47],v17 offset:10504
s_waitcnt lgkmcnt(0)
ds_read_b64_tr_b16 a[48:49],v17 offset:12288
ds_read_b64_tr_b16 a[50:51],v17 offset:12544
ds_read_b64_tr_b16 a[52:53],v17 offset:12296
ds_read_b64_tr_b16 a[54:55],v17 offset:12552
ds_read_b64_tr_b16 a[56:57],v17 offset:14336
ds_read_b64_tr_b16 a[58:59],v17 offset:14592
ds_read_b64_tr_b16 a[60:61],v17 offset:14344
ds_read_b64_tr_b16 a[62:63],v17 offset:14600
s_waitcnt lgkmcnt(0)
s_xor_b32 s62,s50,2
s_mul_i32 s62,s62,1835008
s_add_u32 s62,s62,s54
s_add_u32 m0,s61,0
s_nop 0
buffer_load_dwordx4 v16,s[28:31],s62 offen lds
s_add_u32 s62,s62,114688
s_add_u32 m0,m0,1024
s_nop 0
buffer_load_dwordx4 v16,s[28:31],s62 offen lds
s_add_u32 s62,s62,114688
s_add_u32 m0,m0,1024
s_nop 0
buffer_load_dwordx4 v16,s[28:31],s62 offen lds
s_add_u32 s62,s62,114688
s_add_u32 m0,m0,1024
s_nop 0
buffer_load_dwordx4 v16,s[28:31],s62 offen lds
s_add_u32 s62,s62,114688
s_add_u32 m0,m0,1024
s_nop 0
buffer_load_dwordx4 v16,s[28:31],s62 offen lds
s_add_u32 s62,s62,114688
s_add_u32 m0,m0,1024
s_nop 0
buffer_load_dwordx4 v16,s[28:31],s62 offen lds
s_add_u32 s62,s62,114688
s_add_u32 m0,m0,1024
s_nop 0
buffer_load_dwordx4 v16,s[28:31],s62 offen lds
s_add_u32 s62,s62,114688
s_add_u32 m0,m0,1024
s_nop 0
buffer_load_dwordx4 v16,s[28:31],s62 offen lds
s_add_u32 s62,s62,114688
s_add_u32 m0,m0,1024
s_nop 0
buffer_load_dwordx4 v16,s[28:31],s62 offen lds
s_add_u32 s62,s62,114688
s_add_u32 m0,m0,1024
s_nop 0
buffer_load_dwordx4 v16,s[28:31],s62 offen lds
s_add_u32 s62,s62,114688
s_add_u32 m0,m0,1024
s_nop 0
buffer_load_dwordx4 v16,s[28:31],s62 offen lds
s_add_u32 s62,s62,114688
s_add_u32 m0,m0,1024
s_nop 0
buffer_load_dwordx4 v16,s[28:31],s62 offen lds
s_add_u32 s62,s62,114688
s_add_u32 m0,m0,1024
s_nop 0
buffer_load_dwordx4 v16,s[28:31],s62 offen lds
s_add_u32 s62,s62,114688
s_add_u32 m0,m0,1024
s_nop 0
buffer_load_dwordx4 v16,s[28:31],s62 offen lds
s_add_u32 s62,s62,114688
s_add_u32 m0,m0,1024
s_nop 0
buffer_load_dwordx4 v16,s[28:31],s62 offen lds
s_add_u32 s62,s62,114688
s_add_u32 m0,m0,1024
s_nop 0
buffer_load_dwordx4 v16,s[28:31],s62 offen lds
s_waitcnt vmcnt(16)
ds_read_b64_tr_b16 a[64:65],v17 offset:16384
ds_read_b64_tr_b16 a[66:67],v17 offset:16640
ds_read_b64_tr_b16 a[68:69],v17 offset:16392
ds_read_b64_tr_b16 a[70:71],v17 offset:16648
ds_read_b64_tr_b16 a[72:73],v17 offset:18432
ds_read_b64_tr_b16 a[74:75],v17 offset:18688
ds_read_b64_tr_b16 a[76:77],v17 offset:18440
ds_read_b64_tr_b16 a[78:79],v17 offset:18696
ds_read_b64_tr_b16 a[80:81],v17 offset:20480
ds_read_b64_tr_b16 a[82:83],v17 offset:20736
ds_read_b64_tr_b16 a[84:85],v17 offset:20488
ds_read_b64_tr_b16 a[86:87],v17 offset:20744
s_waitcnt lgkmcnt(0)
ds_read_b64_tr_b16 a[88:89],v17 offset:22528
ds_read_b64_tr_b16 a[90:91],v17 offset:22784
ds_read_b64_tr_b16 a[92:93],v17 offset:22536
ds_read_b64_tr_b16 a[94:95],v17 offset:22792
ds_read_b64_tr_b16 a[96:97],v17 offset:24576
ds_read_b64_tr_b16 a[98:99],v17 offset:24832
ds_read_b64_tr_b16 a[100:101],v17 offset:24584
ds_read_b64_tr_b16 a[102:103],v17 offset:24840
ds_read_b64_tr_b16 a[104:105],v17 offset:26624
ds_read_b64_tr_b16 a[106:107],v17 offset:26880
ds_read_b64_tr_b16 a[108:109],v17 offset:26632
ds_read_b64_tr_b16 a[110:111],v17 offset:26888
s_waitcnt lgkmcnt(0)
ds_read_b64_tr_b16 a[112:113],v17 offset:28672
ds_read_b64_tr_b16 a[114:115],v17 offset:28928
ds_read_b64_tr_b16 a[116:117],v17 offset:28680
ds_read_b64_tr_b16 a[118:119],v17 offset:28936
ds_read_b64_tr_b16 a[120:121],v17 offset:30720
ds_read_b64_tr_b16 a[122:123],v17 offset:30976
ds_read_b64_tr_b16 a[124:125],v17 offset:30728
ds_read_b64_tr_b16 a[126:127],v17 offset:30984
s_waitcnt lgkmcnt(0)
s_xor_b32 s62,s50,3
s_mul_i32 s62,s62,1835008
s_add_u32 s62,s62,s54
s_add_u32 m0,s61,16384
s_nop 0
buffer_load_dwordx4 v16,s[28:31],s62 offen lds
s_add_u32 s62,s62,114688
s_add_u32 m0,m0,1024
s_nop 0
buffer_load_dwordx4 v16,s[28:31],s62 offen lds
s_add_u32 s62,s62,114688
s_add_u32 m0,m0,1024
s_nop 0
buffer_load_dwordx4 v16,s[28:31],s62 offen lds
s_add_u32 s62,s62,114688
s_add_u32 m0,m0,1024
s_nop 0
buffer_load_dwordx4 v16,s[28:31],s62 offen lds
s_add_u32 s62,s62,114688
s_add_u32 m0,m0,1024
s_nop 0
buffer_load_dwordx4 v16,s[28:31],s62 offen lds
s_add_u32 s62,s62,114688
s_add_u32 m0,m0,1024
s_nop 0
buffer_load_dwordx4 v16,s[28:31],s62 offen lds
s_add_u32 s62,s62,114688
s_add_u32 m0,m0,1024
s_nop 0
buffer_load_dwordx4 v16,s[28:31],s62 offen lds
s_add_u32 s62,s62,114688
s_add_u32 m0,m0,1024
s_nop 0
buffer_load_dwordx4 v16,s[28:31],s62 offen lds
s_add_u32 s62,s62,114688
s_add_u32 m0,m0,1024
s_nop 0
buffer_load_dwordx4 v16,s[28:31],s62 offen lds
s_add_u32 s62,s62,114688
s_add_u32 m0,m0,1024
s_nop 0
buffer_load_dwordx4 v16,s[28:31],s62 offen lds
s_add_u32 s62,s62,114688
s_add_u32 m0,m0,1024
s_nop 0
buffer_load_dwordx4 v16,s[28:31],s62 offen lds
s_add_u32 s62,s62,114688
s_add_u32 m0,m0,1024
s_nop 0
buffer_load_dwordx4 v16,s[28:31],s62 offen lds
s_add_u32 s62,s62,114688
s_add_u32 m0,m0,1024
s_nop 0
buffer_load_dwordx4 v16,s[28:31],s62 offen lds
s_add_u32 s62,s62,114688
s_add_u32 m0,m0,1024
s_nop 0
buffer_load_dwordx4 v16,s[28:31],s62 offen lds
s_add_u32 s62,s62,114688
s_add_u32 m0,m0,1024
s_nop 0
buffer_load_dwordx4 v16,s[28:31],s62 offen lds
s_add_u32 s62,s62,114688
s_add_u32 m0,m0,1024
s_nop 0
buffer_load_dwordx4 v16,s[28:31],s62 offen lds
s_waitcnt vmcnt(16)
ds_read_b64_tr_b16 a[128:129],v17 offset:0
ds_read_b64_tr_b16 a[130:131],v17 offset:256
ds_read_b64_tr_b16 a[132:133],v17 offset:8
ds_read_b64_tr_b16 a[134:135],v17 offset:264
ds_read_b64_tr_b16 a[136:137],v17 offset:2048
ds_read_b64_tr_b16 a[138:139],v17 offset:2304
ds_read_b64_tr_b16 a[140:141],v17 offset:2056
ds_read_b64_tr_b16 a[142:143],v17 offset:2312
ds_read_b64_tr_b16 a[144:145],v17 offset:4096
ds_read_b64_tr_b16 a[146:147],v17 offset:4352
ds_read_b64_tr_b16 a[148:149],v17 offset:4104
ds_read_b64_tr_b16 a[150:151],v17 offset:4360
s_waitcnt lgkmcnt(0)
ds_read_b64_tr_b16 a[152:153],v17 offset:6144
ds_read_b64_tr_b16 a[154:155],v17 offset:6400
ds_read_b64_tr_b16 a[156:157],v17 offset:6152
ds_read_b64_tr_b16 a[158:159],v17 offset:6408
ds_read_b64_tr_b16 a[160:161],v17 offset:8192
ds_read_b64_tr_b16 a[162:163],v17 offset:8448
ds_read_b64_tr_b16 a[164:165],v17 offset:8200
ds_read_b64_tr_b16 a[166:167],v17 offset:8456
ds_read_b64_tr_b16 a[168:169],v17 offset:10240
ds_read_b64_tr_b16 a[170:171],v17 offset:10496
ds_read_b64_tr_b16 a[172:173],v17 offset:10248
ds_read_b64_tr_b16 a[174:175],v17 offset:10504
s_waitcnt lgkmcnt(0)
ds_read_b64_tr_b16 a[176:177],v17 offset:12288
ds_read_b64_tr_b16 a[178:179],v17 offset:12544
ds_read_b64_tr_b16 a[180:181],v17 offset:12296
ds_read_b64_tr_b16 a[182:183],v17 offset:12552
ds_read_b64_tr_b16 a[184:185],v17 offset:14336
ds_read_b64_tr_b16 a[186:187],v17 offset:14592
ds_read_b64_tr_b16 a[188:189],v17 offset:14344
ds_read_b64_tr_b16 a[190:191],v17 offset:14600
s_waitcnt lgkmcnt(0)
s_waitcnt vmcnt(0)
ds_read_b64_tr_b16 a[192:193],v17 offset:16384
ds_read_b64_tr_b16 a[194:195],v17 offset:16640
ds_read_b64_tr_b16 a[196:197],v17 offset:16392
ds_read_b64_tr_b16 a[198:199],v17 offset:16648
ds_read_b64_tr_b16 a[200:201],v17 offset:18432
ds_read_b64_tr_b16 a[202:203],v17 offset:18688
ds_read_b64_tr_b16 a[204:205],v17 offset:18440
ds_read_b64_tr_b16 a[206:207],v17 offset:18696
ds_read_b64_tr_b16 a[208:209],v17 offset:20480
ds_read_b64_tr_b16 a[210:211],v17 offset:20736
ds_read_b64_tr_b16 a[212:213],v17 offset:20488
ds_read_b64_tr_b16 a[214:215],v17 offset:20744
s_waitcnt lgkmcnt(0)
ds_read_b64_tr_b16 a[216:217],v17 offset:22528
ds_read_b64_tr_b16 a[218:219],v17 offset:22784
ds_read_b64_tr_b16 a[220:221],v17 offset:22536
ds_read_b64_tr_b16 a[222:223],v17 offset:22792
ds_read_b64_tr_b16 a[224:225],v17 offset:24576
ds_read_b64_tr_b16 a[226:227],v17 offset:24832
ds_read_b64_tr_b16 a[228:229],v17 offset:24584
ds_read_b64_tr_b16 a[230:231],v17 offset:24840
ds_read_b64_tr_b16 a[232:233],v17 offset:26624
ds_read_b64_tr_b16 a[234:235],v17 offset:26880
ds_read_b64_tr_b16 a[236:237],v17 offset:26632
ds_read_b64_tr_b16 a[238:239],v17 offset:26888
s_waitcnt lgkmcnt(0)
ds_read_b64_tr_b16 a[240:241],v17 offset:28672
ds_read_b64_tr_b16 a[242:243],v17 offset:28928
ds_read_b64_tr_b16 a[244:245],v17 offset:28680
ds_read_b64_tr_b16 a[246:247],v17 offset:28936
ds_read_b64_tr_b16 a[248:249],v17 offset:30720
ds_read_b64_tr_b16 a[250:251],v17 offset:30976
ds_read_b64_tr_b16 a[252:253],v17 offset:30728
ds_read_b64_tr_b16 a[254:255],v17 offset:30984
s_waitcnt lgkmcnt(0)
s_mov_b32 s67,0
s_cmp_eq_u32 s56,1
s_cbranch_scc1 vok_107
v_mbcnt_lo_u32_b32 v16,-1,0
v_and_b32 v16,7,v16
v_lshlrev_b32 v16,7,v16
s_mov_b32 s64,138510336
vpoll_108:
buffer_load_dword v17,v16,s[20:23],s64 offen sc1
s_waitcnt vmcnt(0)
v_readlane_b32 s92,v17,0
v_readlane_b32 s93,v17,1
v_readlane_b32 s94,v17,2
v_readlane_b32 s95,v17,3
v_readlane_b32 s96,v17,4
v_readlane_b32 s97,v17,5
v_readlane_b32 s98,v17,6
v_readlane_b32 s99,v17,7
s_add_u32 s65,s92,s93
s_add_u32 s65,s65,s94
s_add_u32 s65,s65,s95
s_add_u32 s65,s65,s96
s_add_u32 s65,s65,s97
s_add_u32 s65,s65,s98
s_add_u32 s65,s65,s99
s_cmp_ge_u32 s65,256
s_cbranch_scc1 vgot_109
s_sleep 4
s_sub_u32 s90,s90,1
s_cmp_gt_i32 s90,0
s_cbranch_scc1 vpoll_108
vgot_109:
s_min_u32 s65,s92,s93
s_min_u32 s65,s65,s94
s_min_u32 s65,s65,s95
s_min_u32 s65,s65,s96
s_min_u32 s65,s65,s97
s_min_u32 s65,s65,s98
s_min_u32 s65,s65,s99
s_cmp_lt_u32 s65,32
s_cbranch_scc1 fl_slow
s_mov_b32 s56,0
vok_107:
s_barrier
v_lshlrev_b32 v0,4,v1
s_mov_b32 s60,0
s_mov_b32 s70,0
s_mov_b32 s55,0
s_lshl_b32 s63,s50,13
v_mov_b32 v3,v0
s_mov_b32 s73,0xffff0000
s_lshl_b32 s64,s52,2
s_add_u32 s64,s64,s50
s_mul_i32 s61,s64,8192
s_add_u32 s61,s61,214958080
s_lshl_b32 s82,s64,8
s_add_u32 s82,s82,138550272
s_mov_b32 s68,s82
s_lshl_b32 s83,s53,2
s_add_u32 s83,s83,s50
s_xor_b32 s64,s50,0
s_lshl_b32 s64,s64,13
v_add_u32 v8,s64,v0
s_xor_b32 s64,s50,1
s_lshl_b32 s64,s64,13
v_add_u32 v9,s64,v0
s_xor_b32 s64,s50,2
s_lshl_b32 s64,s64,13
v_add_u32 v10,s64,v0
s_xor_b32 s64,s50,3
s_lshl_b32 s64,s64,13
v_add_u32 v11,s64,v0
v_min_u32 v2,7,v1
v_lshlrev_b32 v2,2,v2
s_lshl_b32 s66,s83,10
s_mul_i32 s65,s83,147
s_lshr_b32 s65,s65,10
s_mul_i32 s69,s65,228
s_lshl_b32 s64,s83,2
s_add_u32 s69,s69,s64
s_add_u32 s69,s69,138551296
s_lshl_b32 s64,s50,9
s_add_u32 s64,s64,131072
v_lshlrev_b32 v26,3,v1
v_add_u32 v19,s64,v26
v_lshl_add_u32 v26,v23,4,v21
v_lshlrev_b32 v26,3,v26
v_add_u32 v20,131072,v26
s_mov_b32 s74,0x22222222
s_mov_b32 s75,0x22222222
s_mov_b32 s76,0x44444444
s_mov_b32 s77,0x44444444
s_mov_b32 s78,0x88888888
s_mov_b32 s79,0x88888888
s_mov_b32 s80,0xc0135761
s_mov_b32 s81,0xbdd2d3e8
v_mov_b32 v191,s80
v_mov_b32 v12,0x3f803f80
v_mov_b32 v13,0x3f803f80
v_mov_b32 v14,0x3f803f80
v_mov_b32 v15,0x3f803f80
s_nop 1
v_mfma_f32_16x16x32_bf16 v[152:155],a[0:3],v[12:15],0
v_mfma_f32_16x16x32_bf16 v[156:159],a[4:7],v[12:15],0
v_mfma_f32_16x16x32_bf16 v[152:155],a[8:11],v[12:15],v[152:155]
v_mfma_f32_16x16x32_bf16 v[156:159],a[12:15],v[12:15],v[156:159]
v_mfma_f32_16x16x32_bf16 v[152:155],a[16:19],v[12:15],v[152:155]
v_mfma_f32_16x16x32_bf16 v[156:159],a[20:23],v[12:15],v[156:159]
v_mfma_f32_16x16x32_bf16 v[152:155],a[24:27],v[12:15],v[152:155]
v_mfma_f32_16x16x32_bf16 v[156:159],a[28:31],v[12:15],v[156:159]
v_mfma_f32_16x16x32_bf16 v[152:155],a[32:35],v[12:15],v[152:155]
v_mfma_f32_16x16x32_bf16 v[156:159],a[36:39],v[12:15],v[156:159]
v_mfma_f32_16x16x32_bf16 v[152:155],a[40:43],v[12:15],v[152:155]
v_mfma_f32_16x16x32_bf16 v[156:159],a[44:47],v[12:15],v[156:159]
v_mfma_f32_16x16x32_bf16 v[152:155],a[48:51],v[12:15],v[152:155]
v_mfma_f32_16x16x32_bf16 v[156:159],a[52:55],v[12:15],v[156:159]
v_mfma_f32_16x16x32_bf16 v[152:155],a[56:59],v[12:15],v[152:155]
v_mfma_f32_16x16x32_bf16 v[156:159],a[60:63],v[12:15],v[156:159]
v_mfma_f32_16x16x32_bf16 v[152:155],a[64:67],v[12:15],v[152:155]
v_mfma_f32_16x16x32_bf16 v[156:159],a[68:71],v[12:15],v[156:159]
v_mfma_f32_16x16x32_bf16 v[152:155],a[72:75],v[12:15],v[152:155]
v_mfma_f32_16x16x32_bf16 v[156:159],a[76:79],v[12:15],v[156:159]
v_mfma_f32_16x16x32_bf16 v[152:155],a[80:83],v[12:15],v[152:155]
v_mfma_f32_16x16x32_bf16 v[156:159],a[84:87],v[12:15],v[156:159]
v_mfma_f32_16x16x32_bf16 v[152:155],a[88:91],v[12:15],v[152:155]
v_mfma_f32_16x16x32_bf16 v[156:159],a[92:95],v[12:15],v[156:159]
v_mfma_f32_16x16x32_bf16 v[152:155],a[96:99],v[12:15],v[152:155]
v_mfma_f32_16x16x32_bf16 v[156:159],a[100:103],v[12:15],v[156:159]
v_mfma_f32_16x16x32_bf16 v[152:155],a[104:107],v[12:15],v[152:155]
v_mfma_f32_16x16x32_bf16 v[156:159],a[108:111],v[12:15],v[156:159]
v_mfma_f32_16x16x32_bf16 v[152:155],a[112:115],v[12:15],v[152:155]
v_mfma_f32_16x16x32_bf16 v[156:159],a[116:119],v[12:15],v[156:159]
v_mfma_f32_16x16x32_bf16 v[152:155],a[120:123],v[12:15],v[152:155]
v_mfma_f32_16x16x32_bf16 v[156:159],a[124:127],v[12:15],v[156:159]
v_mfma_f32_16x16x32_bf16 v[152:155],a[128:131],v[12:15],v[152:155]
v_mfma_f32_16x16x32_bf16 v[156:159],a[132:135],v[12:15],v[156:159]
v_mfma_f32_16x16x32_bf16 v[152:155],a[136:139],v[12:15],v[152:155]
v_mfma_f32_16x16x32_bf16 v[156:159],a[140:143],v[12:15],v[156:159]
v_mfma_f32_16x16x32_bf16 v[152:155],a[144:147],v[12:15],v[152:155]
v_mfma_f32_16x16x32_bf16 v[156:159],a[148:151],v[12:15],v[156:159]
v_mfma_f32_16x16x32_bf16 v[152:155],a[152:155],v[12:15],v[152:155]
v_mfma_f32_16x16x32_bf16 v[156:159],a[156:159],v[12:15],v[156:159]
v_mfma_f32_16x16x32_bf16 v[152:155],a[160:163],v[12:15],v[152:155]
v_mfma_f32_16x16x32_bf16 v[156:159],a[164:167],v[12:15],v[156:159]
v_mfma_f32_16x16x32_bf16 v[152:155],a[168:171],v[12:15],v[152:155]
v_mfma_f32_16x16x32_bf16 v[156:159],a[172:175],v[12:15],v[156:159]
v_mfma_f32_16x16x32_bf16 v[152:155],a[176:179],v[12:15],v[152:155]
v_mfma_f32_16x16x32_bf16 v[156:159],a[180:183],v[12:15],v[156:159]
v_mfma_f32_16x16x32_bf16 v[152:155],a[184:187],v[12:15],v[152:155]
v_mfma_f32_16x16x32_bf16 v[156:159],a[188:191],v[12:15],v[156:159]
v_mfma_f32_16x16x32_bf16 v[152:155],a[192:195],v[12:15],v[152:155]
v_mfma_f32_16x16x32_bf16 v[156:159],a[196:199],v[12:15],v[156:159]
v_mfma_f32_16x16x32_bf16 v[152:155],a[200:203],v[12:15],v[152:155]
v_mfma_f32_16x16x32_bf16 v[156:159],a[204:207],v[12:15],v[156:159]
v_mfma_f32_16x16x32_bf16 v[152:155],a[208:211],v[12:15],v[152:155]
v_mfma_f32_16x16x32_bf16 v[156:159],a[212:215],v[12:15],v[156:159]
v_mfma_f32_16x16x32_bf16 v[152:155],a[216:219],v[12:15],v[152:155]
v_mfma_f32_16x16x32_bf16 v[156:159],a[220:223],v[12:15],v[156:159]
v_mfma_f32_16x16x32_bf16 v[152:155],a[224:227],v[12:15],v[152:155]
v_mfma_f32_16x16x32_bf16 v[156:159],a[228:231],v[12:15],v[156:159]
v_mfma_f32_16x16x32_bf16 v[152:155],a[232:235],v[12:15],v[152:155]
v_mfma_f32_16x16x32_bf16 v[156:159],a[236:239],v[12:15],v[156:159]
v_mfma_f32_16x16x32_bf16 v[152:155],a[240:243],v[12:15],v[152:155]
v_mfma_f32_16x16x32_bf16 v[156:159],a[244:247],v[12:15],v[156:159]
v_mfma_f32_16x16x32_bf16 v[152:155],a[248:251],v[12:15],v[152:155]
v_mfma_f32_16x16x32_bf16 v[156:159],a[252:255],v[12:15],v[156:159]
s_add_u32 s71,s60,1
plp_117:
buffer_load_dword v16,v2,s[20:23],s68 offen sc1
s_waitcnt vmcnt(0)
v_cmp_gt_u32 vcc,s71,v16
s_cbranch_vccz pok_118
s_sleep 4
s_sub_u32 s90,s90,1
s_cmp_gt_i32 s90,0
s_cbranch_scc1 plp_117
pok_118:
lag_116:
s_add_u32 m0,s70,s63
s_add_u32 s62,s61,4096
buffer_load_dwordx4 v3,s[20:23],s61 offen offset:0 lds
buffer_load_dwordx4 v3,s[20:23],s61 offen offset:1024 lds
buffer_load_dwordx4 v3,s[20:23],s61 offen offset:2048 lds
buffer_load_dwordx4 v3,s[20:23],s61 offen offset:3072 lds
s_add_u32 m0,m0,4096
s_nop 0
buffer_load_dwordx4 v3,s[20:23],s62 offen offset:0 lds
buffer_load_dwordx4 v3,s[20:23],s62 offen offset:1024 lds
buffer_load_dwordx4 v3,s[20:23],s62 offen offset:2048 lds
buffer_load_dwordx4 v3,s[20:23],s62 offen offset:3072 lds
s_add_u32 s61,s61,32768
s_add_u32 s70,s70,32768
s_and_b32 s70,s70,0x1ffff
buffer_load_dword v17,off,s[20:23],s69
top_112:
s_add_u32 s71,s60,2
buffer_load_dword v16,v2,s[20:23],s68 offen sc1
v_add_u32 v4,s55,v8
v_add_u32 v5,s55,v9
v_add_u32 v6,s55,v10
v_add_u32 v7,s55,v11
s_add_u32 s55,s55,32768
s_and_b32 s55,s55,0x1ffff
s_waitcnt vmcnt(9)
ds_read_b128 v[64:67],v4 offset:0
s_waitcnt vmcnt(8)
ds_read_b128 v[68:71],v4 offset:1024
s_waitcnt vmcnt(7)
ds_read_b128 v[72:75],v4 offset:2048
s_waitcnt lgkmcnt(2)
v_mfma_f32_16x16x32_bf16 v[32:35],a[0:3],v[64:67],0
v_mfma_f32_16x16x32_bf16 v[36:39],a[4:7],v[64:67],0
v_mfma_f32_16x16x32_bf16 v[48:51],v[12:15],v[64:67],0
v_mfma_f32_16x16x32_bf16 v[52:55],v[64:67],v[64:67],0
s_waitcnt vmcnt(6)
ds_read_b128 v[76:79],v4 offset:3072
s_waitcnt lgkmcnt(2)
v_mfma_f32_16x16x32_bf16 v[32:35],a[8:11],v[68:71],v[32:35]
v_mfma_f32_16x16x32_bf16 v[36:39],a[12:15],v[68:71],v[36:39]
v_mfma_f32_16x16x32_bf16 v[48:51],v[12:15],v[68:71],v[48:51]
v_mfma_f32_16x16x32_bf16 v[52:55],v[68:71],v[68:71],v[52:55]
s_waitcnt vmcnt(5)
ds_read_b128 v[80:83],v4 offset:4096
s_waitcnt lgkmcnt(2)
v_mfma_f32_16x16x32_bf16 v[32:35],a[16:19],v[72:75],v[32:35]
v_mfma_f32_16x16x32_bf16 v[36:39],a[20:23],v[72:75],v[36:39]
v_mfma_f32_16x16x32_bf16 v[48:51],v[12:15],v[72:75],v[48:51]
v_mfma_f32_16x16x32_bf16 v[52:55],v[72:75],v[72:75],v[52:55]
s_waitcnt vmcnt(4)
ds_read_b128 v[84:87],v4 offset:5120
s_waitcnt lgkmcnt(2)
v_mfma_f32_16x16x32_bf16 v[32:35],a[24:27],v[76:79],v[32:35]
v_mfma_f32_16x16x32_bf16 v[36:39],a[28:31],v[76:79],v[36:39]
v_mfma_f32_16x16x32_bf16 v[48:51],v[12:15],v[76:79],v[48:51]
v_mfma_f32_16x16x32_bf16 v[52:55],v[76:79],v[76:79],v[52:55]
s_waitcnt vmcnt(3)
ds_read_b128 v[88:91],v4 offset:6144
s_waitcnt lgkmcnt(2)
v_mfma_f32_16x16x32_bf16 v[32:35],a[32:35],v[80:83],v[32:35]
v_mfma_f32_16x16x32_bf16 v[36:39],a[36:39],v[80:83],v[36:39]
v_mfma_f32_16x16x32_bf16 v[48:51],v[12:15],v[80:83],v[48:51]
v_mfma_f32_16x16x32_bf16 v[52:55],v[80:83],v[80:83],v[52:55]
s_waitcnt vmcnt(2)
ds_read_b128 v[92:95],v4 offset:7168
s_barrier
s_waitcnt lgkmcnt(2)
v_mfma_f32_16x16x32_bf16 v[32:35],a[40:43],v[84:87],v[32:35]
v_mfma_f32_16x16x32_bf16 v[36:39],a[44:47],v[84:87],v[36:39]
v_mfma_f32_16x16x32_bf16 v[48:51],v[12:15],v[84:87],v[48:51]
v_mfma_f32_16x16x32_bf16 v[52:55],v[84:87],v[84:87],v[52:55]
ds_read_b128 v[96:99],v5 offset:0
s_waitcnt lgkmcnt(2)
v_mfma_f32_16x16x32_bf16 v[32:35],a[48:51],v[88:91],v[32:35]
ds_read_b128 v[100:103],v5 offset:1024
ds_read_b128 v[104:107],v5 offset:2048
v_mfma_f32_16x16x32_bf16 v[36:39],a[52:55],v[88:91],v[36:39]
v_mfma_f32_16x16x32_bf16 v[48:51],v[12:15],v[88:91],v[48:51]
v_mfma_f32_16x16x32_bf16 v[52:55],v[88:91],v[88:91],v[52:55]
s_waitcnt lgkmcnt(3)
v_mfma_f32_16x16x32_bf16 v[32:35],a[56:59],v[92:95],v[32:35]
ds_read_b128 v[108:111],v5 offset:3072
ds_read_b128 v[112:115],v5 offset:4096
v_mfma_f32_16x16x32_bf16 v[36:39],a[60:63],v[92:95],v[36:39]
v_mfma_f32_16x16x32_bf16 v[48:51],v[12:15],v[92:95],v[48:51]
v_mfma_f32_16x16x32_bf16 v[52:55],v[92:95],v[92:95],v[52:55]
s_waitcnt lgkmcnt(4)
v_mfma_f32_16x16x32_bf16 v[32:35],a[64:67],v[96:99],v[32:35]
ds_read_b128 v[116:119],v5 offset:5120
ds_read_b128 v[120:123],v5 offset:6144
v_mfma_f32_16x16x32_bf16 v[36:39],a[68:71],v[96:99],v[36:39]
s_waitcnt lgkmcnt(5)
v_mfma_f32_16x16x32_bf16 v[32:35],a[72:75],v[100:103],v[32:35]
ds_read_b128 v[124:127],v5 offset:7168
v_mfma_f32_16x16x32_bf16 v[36:39],a[76:79],v[100:103],v[36:39]
s_waitcnt lgkmcnt(5)
v_mfma_f32_16x16x32_bf16 v[32:35],a[80:83],v[104:107],v[32:35]
ds_read_b128 v[64:67],v6 offset:0
v_mfma_f32_16x16x32_bf16 v[36:39],a[84:87],v[104:107],v[36:39]
s_waitcnt lgkmcnt(5)
v_mfma_f32_16x16x32_bf16 v[32:35],a[88:91],v[108:111],v[32:35]
ds_read_b128 v[68:71],v6 offset:1024
v_cndmask_b32 v49,v52,v53,s[74:75]
v_mfma_f32_16x16x32_bf16 v[36:39],a[92:95],v[108:111],v[36:39]
v_cndmask_b32 v49,v49,v54,s[76:77]
s_waitcnt lgkmcnt(5)
v_mfma_f32_16x16x32_bf16 v[32:35],a[96:99],v[112:115],v[32:35]
ds_read_b128 v[72:75],v6 offset:2048
v_cndmask_b32 v49,v49,v55,s[78:79]
v_mfma_f32_16x16x32_bf16 v[36:39],a[100:103],v[112:115],v[36:39]
ds_write_b64 v19,v[48:49]
s_waitcnt lgkmcnt(6)
v_mfma_f32_16x16x32_bf16 v[32:35],a[104:107],v[116:119],v[32:35]
ds_read_b128 v[76:79],v6 offset:3072
v_mfma_f32_16x16x32_bf16 v[36:39],a[108:111],v[116:119],v[36:39]
s_waitcnt lgkmcnt(6)
v_mfma_f32_16x16x32_bf16 v[32:35],a[112:115],v[120:123],v[32:35]
ds_read_b128 v[80:83],v6 offset:4096
v_mfma_f32_16x16x32_bf16 v[36:39],a[116:119],v[120:123],v[36:39]
s_waitcnt lgkmcnt(6)
v_mfma_f32_16x16x32_bf16 v[32:35],a[120:123],v[124:127],v[32:35]
ds_read_b128 v[84:87],v6 offset:5120
v_mfma_f32_16x16x32_bf16 v[36:39],a[124:127],v[124:127],v[36:39]
s_waitcnt lgkmcnt(6)
v_mfma_f32_16x16x32_bf16 v[32:35],a[128:131],v[64:67],v[32:35]
ds_read_b128 v[88:91],v6 offset:6144
v_mfma_f32_16x16x32_bf16 v[36:39],a[132:135],v[64:67],v[36:39]
s_waitcnt lgkmcnt(4)
s_barrier
ds_read_b64 v[56:57],v20 offset:0
ds_read_b64 v[58:59],v20 offset:512
v_mfma_f32_16x16x32_bf16 v[32:35],a[136:139],v[68:71],v[32:35]
ds_read_b128 v[92:95],v6 offset:7168
ds_read_b64 v[60:61],v20 offset:1024
ds_read_b64 v[62:63],v20 offset:1536
v_mfma_f32_16x16x32_bf16 v[36:39],a[140:143],v[68:71],v[36:39]
v_mfma_f32_16x16x32_bf16 v[32:35],a[144:147],v[72:75],v[32:35]
ds_read_b128 v[96:99],v7 offset:0
v_mfma_f32_16x16x32_bf16 v[36:39],a[148:151],v[72:75],v[36:39]
s_waitcnt lgkmcnt(9)
v_mfma_f32_16x16x32_bf16 v[32:35],a[152:155],v[76:79],v[32:35]
ds_read_b128 v[100:103],v7 offset:1024
v_mfma_f32_16x16x32_bf16 v[36:39],a[156:159],v[76:79],v[36:39]
s_waitcnt lgkmcnt(9)
v_mfma_f32_16x16x32_bf16 v[32:35],a[160:163],v[80:83],v[32:35]
ds_read_b128 v[104:107],v7 offset:2048
v_mfma_f32_16x16x32_bf16 v[36:39],a[164:167],v[80:83],v[36:39]
s_waitcnt lgkmcnt(9)
v_mfma_f32_16x16x32_bf16 v[32:35],a[168:171],v[84:87],v[32:35]
ds_read_b128 v[108:111],v7 offset:3072
s_waitcnt lgkmcnt(4)
v_mfma_f32_16x16x32_bf16 v[36:39],a[172:175],v[84:87],v[36:39]
v_add_f32 v56,v56,v58
s_waitcnt vmcnt(0)
v_mov_b32 v17,s60
s_mov_b64 exec,1
buffer_store_dword v17,off,s[20:23],s69 sc1
s_mov_b64 exec,-1
v_cmp_gt_u32 vcc,s71,v16
s_cbranch_vccnz vN_113
v_mfma_f32_16x16x32_bf16 v[32:35],a[176:179],v[88:91],v[32:35]
ds_read_b128 v[112:115],v7 offset:4096
v_add_f32 v57,v57,v59
s_add_u32 m0,s70,s63
v_mfma_f32_16x16x32_bf16 v[36:39],a[180:183],v[88:91],v[36:39]
v_add_f32 v60,v60,v62
s_add_u32 s62,s61,4096
v_mfma_f32_16x16x32_bf16 v[32:35],a[184:187],v[92:95],v[32:35]
ds_read_b128 v[116:119],v7 offset:5120
v_add_f32 v61,v61,v63
buffer_load_dwordx4 v3,s[20:23],s61 offen offset:0 lds
v_mfma_f32_16x16x32_bf16 v[36:39],a[188:191],v[92:95],v[36:39]
v_add_f32 v56,v56,v60
buffer_load_dwordx4 v3,s[20:23],s61 offen offset:1024 lds
s_waitcnt lgkmcnt(5)
v_mfma_f32_16x16x32_bf16 v[32:35],a[192:195],v[96:99],v[32:35]
ds_read_b128 v[120:123],v7 offset:6144
v_add_f32 v57,v57,v61
buffer_load_dwordx4 v3,s[20:23],s61 offen offset:2048 lds
v_mfma_f32_16x16x32_bf16 v[36:39],a[196:199],v[96:99],v[36:39]
v_mul_f32 v189,0xba800000,v56
buffer_load_dwordx4 v3,s[20:23],s61 offen offset:3072 lds
s_waitcnt lgkmcnt(5)
v_mfma_f32_16x16x32_bf16 v[32:35],a[200:203],v[100:103],v[32:35]
ds_read_b128 v[124:127],v7 offset:7168
v_mul_f32 v58,v189,v189
s_add_u32 m0,m0,4096
v_mfma_f32_16x16x32_bf16 v[36:39],a[204:207],v[100:103],v[36:39]
v_mul_f32 v57,0x3a800000,v57
buffer_load_dwordx4 v3,s[20:23],s62 offen offset:0 lds
s_waitcnt lgkmcnt(5)
v_mfma_f32_16x16x32_bf16 v[32:35],a[208:211],v[104:107],v[32:35]
v_sub_f32 v57,v57,v58
buffer_load_dwordx4 v3,s[20:23],s62 offen offset:1024 lds
v_mfma_f32_16x16x32_bf16 v[36:39],a[212:215],v[104:107],v[36:39]
v_max_f32 v57,0,v57
buffer_load_dwordx4 v3,s[20:23],s62 offen offset:2048 lds
s_waitcnt lgkmcnt(4)
v_mfma_f32_16x16x32_bf16 v[32:35],a[216:219],v[108:111],v[32:35]
v_add_f32 v57,0x3727c5ac,v57
buffer_load_dwordx4 v3,s[20:23],s62 offen offset:3072 lds
v_mfma_f32_16x16x32_bf16 v[36:39],a[220:223],v[108:111],v[36:39]
v_rsq_f32 v190,v57
s_add_u32 s61,s61,32768
s_waitcnt lgkmcnt(3)
v_mfma_f32_16x16x32_bf16 v[32:35],a[224:227],v[112:115],v[32:35]
s_add_u32 s70,s70,32768
v_mfma_f32_16x16x32_bf16 v[36:39],a[228:231],v[112:115],v[36:39]
s_and_b32 s70,s70,0x1ffff
s_waitcnt lgkmcnt(2)
v_mfma_f32_16x16x32_bf16 v[32:35],a[232:235],v[116:119],v[32:35]
v_mfma_f32_16x16x32_bf16 v[36:39],a[236:239],v[116:119],v[36:39]
s_waitcnt lgkmcnt(1)
v_mfma_f32_16x16x32_bf16 v[32:35],a[240:243],v[120:123],v[32:35]
v_mfma_f32_16x16x32_bf16 v[36:39],a[244:247],v[120:123],v[36:39]
s_waitcnt lgkmcnt(0)
v_mfma_f32_16x16x32_bf16 v[32:35],a[248:251],v[124:127],v[32:35]
v_mfma_f32_16x16x32_bf16 v[36:39],a[252:255],v[124:127],v[36:39]
s_mov_b32 s72,1
join_114:
s_nop 5
v_fma_f32 v32,v152,v189,v32
v_fma_f32 v33,v153,v189,v33
v_fma_f32 v34,v154,v189,v34
v_fma_f32 v35,v155,v189,v35
v_fma_f32 v36,v156,v189,v36
v_fma_f32 v37,v157,v189,v37
v_fma_f32 v38,v158,v189,v38
v_fma_f32 v39,v159,v189,v39
v_mul_f32 v32,v32,v190
v_mul_f32 v33,v33,v190
v_mul_f32 v34,v34,v190
v_mul_f32 v35,v35,v190
v_mul_f32 v36,v36,v190
v_mul_f32 v37,v37,v190
v_mul_f32 v38,v38,v190
v_mul_f32 v39,v39,v190
v_mul_f32 v168,v32,v32
v_mul_f32 v169,v33,v33
v_mul_f32 v170,v34,v34
v_mul_f32 v171,v35,v35
v_mul_f32 v172,v36,v36
v_mul_f32 v173,v37,v37
v_mul_f32 v174,v38,v38
v_mul_f32 v175,v39,v39
v_fma_f32 v168,v168,s81,v191
v_fma_f32 v169,v169,s81,v191
v_fma_f32 v170,v170,s81,v191
v_fma_f32 v171,v171,s81,v191
v_fma_f32 v172,v172,s81,v191
v_fma_f32 v173,v173,s81,v191
v_fma_f32 v174,v174,s81,v191
v_fma_f32 v175,v175,s81,v191
v_mul_f32 v168,v168,v32
v_mul_f32 v169,v169,v33
v_mul_f32 v170,v170,v34
v_mul_f32 v171,v171,v35
v_mul_f32 v172,v172,v36
v_mul_f32 v173,v173,v37
v_mul_f32 v174,v174,v38
v_mul_f32 v175,v175,v39
v_exp_f32 v168,v168
v_exp_f32 v169,v169
v_exp_f32 v170,v170
v_exp_f32 v171,v171
v_exp_f32 v172,v172
v_exp_f32 v173,v173
v_exp_f32 v174,v174
v_exp_f32 v175,v175
v_add_f32 v168,1.0,v168
v_add_f32 v169,1.0,v169
v_add_f32 v170,1.0,v170
v_add_f32 v171,1.0,v171
v_add_f32 v172,1.0,v172
v_add_f32 v173,1.0,v173
v_add_f32 v174,1.0,v174
v_add_f32 v175,1.0,v175
v_rcp_f32 v168,v168
v_rcp_f32 v169,v169
v_rcp_f32 v170,v170
v_rcp_f32 v171,v171
v_rcp_f32 v172,v172
v_rcp_f32 v173,v173
v_rcp_f32 v174,v174
v_rcp_f32 v175,v175
v_mul_f32 v32,v168,v32
v_mul_f32 v33,v169,v33
v_mul_f32 v34,v170,v34
v_mul_f32 v35,v171,v35
v_mul_f32 v36,v172,v36
v_mul_f32 v37,v173,v37
v_mul_f32 v38,v174,v38
v_mul_f32 v39,v175,v39
v_cvt_pk_bf16_f32 v176,v32,v33
v_cvt_pk_bf16_f32 v177,v34,v35
v_cvt_pk_bf16_f32 v178,v36,v37
v_cvt_pk_bf16_f32 v179,v38,v39
s_add_u32 s64,s66,219152384
buffer_store_dwordx4 v[176:179],v0,s[20:23],s64 offen sc1
s_add_u32 s66,s66,114688
s_add_u32 s60,s60,1
s_cmp_eq_u32 s72,0
s_cbranch_scc1 slowp_115
s_branch top_112
slowp_115:
s_waitcnt vmcnt(1)
v_cmp_gt_u32 vcc,s71,v16
s_cbranch_vccz lag_116
s_waitcnt vmcnt(0)
v_mov_b32 v17,s60
s_mov_b64 exec,1
buffer_store_dword v17,off,s[20:23],s69 sc1
s_mov_b64 exec,-1
s_cmp_ge_u32 s60,128
s_cbranch_scc1 done_106
plp_119:
buffer_load_dword v16,v2,s[20:23],s68 offen sc1
s_waitcnt vmcnt(0)
v_cmp_gt_u32 vcc,s71,v16
s_cbranch_vccz pok_120
s_sleep 4
s_sub_u32 s90,s90,1
s_cmp_gt_i32 s90,0
s_cbranch_scc1 plp_119
pok_120:
s_branch lag_116
vN_113:
buffer_load_dword v16,v2,s[20:23],s68 offen sc1
v_mfma_f32_16x16x32_bf16 v[32:35],a[176:179],v[88:91],v[32:35]
ds_read_b128 v[112:115],v7 offset:4096
v_add_f32 v57,v57,v59
v_mfma_f32_16x16x32_bf16 v[36:39],a[180:183],v[88:91],v[36:39]
v_add_f32 v60,v60,v62
v_mfma_f32_16x16x32_bf16 v[32:35],a[184:187],v[92:95],v[32:35]
ds_read_b128 v[116:119],v7 offset:5120
v_add_f32 v61,v61,v63
v_mfma_f32_16x16x32_bf16 v[36:39],a[188:191],v[92:95],v[36:39]
v_add_f32 v56,v56,v60
s_waitcnt lgkmcnt(5)
v_mfma_f32_16x16x32_bf16 v[32:35],a[192:195],v[96:99],v[32:35]
ds_read_b128 v[120:123],v7 offset:6144
v_add_f32 v57,v57,v61
v_mfma_f32_16x16x32_bf16 v[36:39],a[196:199],v[96:99],v[36:39]
v_mul_f32 v189,0xba800000,v56
s_waitcnt lgkmcnt(5)
v_mfma_f32_16x16x32_bf16 v[32:35],a[200:203],v[100:103],v[32:35]
ds_read_b128 v[124:127],v7 offset:7168
v_mul_f32 v58,v189,v189
v_mfma_f32_16x16x32_bf16 v[36:39],a[204:207],v[100:103],v[36:39]
v_mul_f32 v57,0x3a800000,v57
s_waitcnt lgkmcnt(5)
v_mfma_f32_16x16x32_bf16 v[32:35],a[208:211],v[104:107],v[32:35]
v_sub_f32 v57,v57,v58
v_mfma_f32_16x16x32_bf16 v[36:39],a[212:215],v[104:107],v[36:39]
v_max_f32 v57,0,v57
s_waitcnt lgkmcnt(4)
v_mfma_f32_16x16x32_bf16 v[32:35],a[216:219],v[108:111],v[32:35]
v_add_f32 v57,0x3727c5ac,v57
v_mfma_f32_16x16x32_bf16 v[36:39],a[220:223],v[108:111],v[36:39]
v_rsq_f32 v190,v57
s_waitcnt lgkmcnt(3)
v_mfma_f32_16x16x32_bf16 v[32:35],a[224:227],v[112:115],v[32:35]
v_mfma_f32_16x16x32_bf16 v[36:39],a[228:231],v[112:115],v[36:39]
s_waitcnt lgkmcnt(2)
v_mfma_f32_16x16x32_bf16 v[32:35],a[232:235],v[116:119],v[32:35]
v_mfma_f32_16x16x32_bf16 v[36:39],a[236:239],v[116:119],v[36:39]
s_waitcnt lgkmcnt(1)
v_mfma_f32_16x16x32_bf16 v[32:35],a[240:243],v[120:123],v[32:35]
v_mfma_f32_16x16x32_bf16 v[36:39],a[244:247],v[120:123],v[36:39]
s_waitcnt lgkmcnt(0)
v_mfma_f32_16x16x32_bf16 v[32:35],a[248:251],v[124:127],v[32:35]
v_mfma_f32_16x16x32_bf16 v[36:39],a[252:255],v[124:127],v[36:39]
s_mov_b32 s72,0
s_branch join_114
done_106:
s_endpgm
fl_w1:
v_and_b32 v21,15,v1
v_lshrrev_b32 v22,4,v1
v_lshrrev_b32 v23,2,v21
v_and_b32 v24,3,v21
s_lshl_b32 s61,s50,15
v_lshl_add_u32 v25,v22,3,v23
s_load_dwordx2 s[4:5],s[0:1],64
s_mov_b32 s52,0
s_mov_b32 s53,s59
s_mul_i32 s54,s52,2097152
s_lshl_b32 s64,s53,8
s_add_u32 s54,s54,s64
s_lshl_b32 s64,s50,6
s_add_u32 s54,s54,s64
s_waitcnt lgkmcnt(0)
s_mov_b32 s28,s4
s_and_b32 s29,s5,0xffff
s_mov_b32 s30,0x200000
s_mov_b32 s31,0x20000
v_lshrrev_b32 v26,2,v1
v_and_b32 v27,3,v1
v_mul_u32_u24 v16,2048,v26
v_lshl_add_u32 v16,v27,4,v16
v_lshlrev_b32 v17,6,v25
v_lshl_add_u32 v17,v24,4,v17
v_add_u32 v17,s61,v17
s_xor_b32 s62,s50,0
s_mul_i32 s62,s62,524288
s_add_u32 s62,s62,s54
s_add_u32 m0,s61,0
s_nop 0
buffer_load_dwordx4 v16,s[28:31],s62 offen lds
s_add_u32 s62,s62,32768
s_add_u32 m0,m0,1024
s_nop 0
buffer_load_dwordx4 v16,s[28:31],s62 offen lds
s_add_u32 s62,s62,32768
s_add_u32 m0,m0,1024
s_nop 0
buffer_load_dwordx4 v16,s[28:31],s62 offen lds
s_add_u32 s62,s62,32768
s_add_u32 m0,m0,1024
s_nop 0
buffer_load_dwordx4 v16,s[28:31],s62 offen lds
s_add_u32 s62,s62,32768
s_add_u32 m0,m0,1024
s_nop 0
buffer_load_dwordx4 v16,s[28:31],s62 offen lds
s_add_u32 s62,s62,32768
s_add_u32 m0,m0,1024
s_nop 0
buffer_load_dwordx4 v16,s[28:31],s62 offen lds
s_add_u32 s62,s62,32768
s_add_u32 m0,m0,1024
s_nop 0
buffer_load_dwordx4 v16,s[28:31],s62 offen lds
s_add_u32 s62,s62,32768
s_add_u32 m0,m0,1024
s_nop 0
buffer_load_dwordx4 v16,s[28:31],s62 offen lds
s_add_u32 s62,s62,32768
s_add_u32 m0,m0,1024
s_nop 0
buffer_load_dwordx4 v16,s[28:31],s62 offen lds
s_add_u32 s62,s62,32768
s_add_u32 m0,m0,1024
s_nop 0
buffer_load_dwordx4 v16,s[28:31],s62 offen lds
s_add_u32 s62,s62,32768
s_add_u32 m0,m0,1024
s_nop 0
buffer_load_dwordx4 v16,s[28:31],s62 offen lds
s_add_u32 s62,s62,32768
s_add_u32 m0,m0,1024
s_nop 0
buffer_load_dwordx4 v16,s[28:31],s62 offen lds
s_add_u32 s62,s62,32768
s_add_u32 m0,m0,1024
s_nop 0
buffer_load_dwordx4 v16,s[28:31],s62 offen lds
s_add_u32 s62,s62,32768
s_add_u32 m0,m0,1024
s_nop 0
buffer_load_dwordx4 v16,s[28:31],s62 offen lds
s_add_u32 s62,s62,32768
s_add_u32 m0,m0,1024
s_nop 0
buffer_load_dwordx4 v16,s[28:31],s62 offen lds
s_add_u32 s62,s62,32768
s_add_u32 m0,m0,1024
s_nop 0
buffer_load_dwordx4 v16,s[28:31],s62 offen lds
s_xor_b32 s62,s50,1
s_mul_i32 s62,s62,524288
s_add_u32 s62,s62,s54
s_add_u32 m0,s61,16384
s_nop 0
buffer_load_dwordx4 v16,s[28:31],s62 offen lds
s_add_u32 s62,s62,32768
s_add_u32 m0,m0,1024
s_nop 0
buffer_load_dwordx4 v16,s[28:31],s62 offen lds
s_add_u32 s62,s62,32768
s_add_u32 m0,m0,1024
s_nop 0
buffer_load_dwordx4 v16,s[28:31],s62 offen lds
s_add_u32 s62,s62,32768
s_add_u32 m0,m0,1024
s_nop 0
buffer_load_dwordx4 v16,s[28:31],s62 offen lds
s_add_u32 s62,s62,32768
s_add_u32 m0,m0,1024
s_nop 0
buffer_load_dwordx4 v16,s[28:31],s62 offen lds
s_add_u32 s62,s62,32768
s_add_u32 m0,m0,1024
s_nop 0
buffer_load_dwordx4 v16,s[28:31],s62 offen lds
s_add_u32 s62,s62,32768
s_add_u32 m0,m0,1024
s_nop 0
buffer_load_dwordx4 v16,s[28:31],s62 offen lds
s_add_u32 s62,s62,32768
s_add_u32 m0,m0,1024
s_nop 0
buffer_load_dwordx4 v16,s[28:31],s62 offen lds
s_add_u32 s62,s62,32768
s_add_u32 m0,m0,1024
s_nop 0
buffer_load_dwordx4 v16,s[28:31],s62 offen lds
s_add_u32 s62,s62,32768
s_add_u32 m0,m0,1024
s_nop 0
buffer_load_dwordx4 v16,s[28:31],s62 offen lds
s_add_u32 s62,s62,32768
s_add_u32 m0,m0,1024
s_nop 0
buffer_load_dwordx4 v16,s[28:31],s62 offen lds
s_add_u32 s62,s62,32768
s_add_u32 m0,m0,1024
s_nop 0
buffer_load_dwordx4 v16,s[28:31],s62 offen lds
s_add_u32 s62,s62,32768
s_add_u32 m0,m0,1024
s_nop 0
buffer_load_dwordx4 v16,s[28:31],s62 offen lds
s_add_u32 s62,s62,32768
s_add_u32 m0,m0,1024
s_nop 0
buffer_load_dwordx4 v16,s[28:31],s62 offen lds
s_add_u32 s62,s62,32768
s_add_u32 m0,m0,1024
s_nop 0
buffer_load_dwordx4 v16,s[28:31],s62 offen lds
s_add_u32 s62,s62,32768
s_add_u32 m0,m0,1024
s_nop 0
buffer_load_dwordx4 v16,s[28:31],s62 offen lds
s_waitcnt vmcnt(16)
ds_read_b64_tr_b16 a[0:1],v17 offset:0
ds_read_b64_tr_b16 a[2:3],v17 offset:256
ds_read_b64_tr_b16 a[4:5],v17 offset:8
ds_read_b64_tr_b16 a[6:7],v17 offset:264
ds_read_b64_tr_b16 a[8:9],v17 offset:2048
ds_read_b64_tr_b16 a[10:11],v17 offset:2304
ds_read_b64_tr_b16 a[12:13],v17 offset:2056
ds_read_b64_tr_b16 a[14:15],v17 offset:2312
ds_read_b64_tr_b16 a[16:17],v17 offset:4096
ds_read_b64_tr_b16 a[18:19],v17 offset:4352
ds_read_b64_tr_b16 a[20:21],v17 offset:4104
ds_read_b64_tr_b16 a[22:23],v17 offset:4360
s_waitcnt lgkmcnt(0)
ds_read_b64_tr_b16 a[24:25],v17 offset:6144
ds_read_b64_tr_b16 a[26:27],v17 offset:6400
ds_read_b64_tr_b16 a[28:29],v17 offset:6152
ds_read_b64_tr_b16 a[30:31],v17 offset:6408
ds_read_b64_tr_b16 a[32:33],v17 offset:8192
ds_read_b64_tr_b16 a[34:35],v17 offset:8448
ds_read_b64_tr_b16 a[36:37],v17 offset:8200
ds_read_b64_tr_b16 a[38:39],v17 offset:8456
ds_read_b64_tr_b16 a[40:41],v17 offset:10240
ds_read_b64_tr_b16 a[42:43],v17 offset:10496
ds_read_b64_tr_b16 a[44:45],v17 offset:10248
ds_read_b64_tr_b16 a[46:47],v17 offset:10504
s_waitcnt lgkmcnt(0)
ds_read_b64_tr_b16 a[48:49],v17 offset:12288
ds_read_b64_tr_b16 a[50:51],v17 offset:12544
ds_read_b64_tr_b16 a[52:53],v17 offset:12296
ds_read_b64_tr_b16 a[54:55],v17 offset:12552
ds_read_b64_tr_b16 a[56:57],v17 offset:14336
ds_read_b64_tr_b16 a[58:59],v17 offset:14592
ds_read_b64_tr_b16 a[60:61],v17 offset:14344
ds_read_b64_tr_b16 a[62:63],v17 offset:14600
s_waitcnt lgkmcnt(0)
s_xor_b32 s62,s50,2
s_mul_i32 s62,s62,524288
s_add_u32 s62,s62,s54
s_add_u32 m0,s61,0
s_nop 0
buffer_load_dwordx4 v16,s[28:31],s62 offen lds
s_add_u32 s62,s62,32768
s_add_u32 m0,m0,1024
s_nop 0
buffer_load_dwordx4 v16,s[28:31],s62 offen lds
s_add_u32 s62,s62,32768
s_add_u32 m0,m0,1024
s_nop 0
buffer_load_dwordx4 v16,s[28:31],s62 offen lds
s_add_u32 s62,s62,32768
s_add_u32 m0,m0,1024
s_nop 0
buffer_load_dwordx4 v16,s[28:31],s62 offen lds
s_add_u32 s62,s62,32768
s_add_u32 m0,m0,1024
s_nop 0
buffer_load_dwordx4 v16,s[28:31],s62 offen lds
s_add_u32 s62,s62,32768
s_add_u32 m0,m0,1024
s_nop 0
buffer_load_dwordx4 v16,s[28:31],s62 offen lds
s_add_u32 s62,s62,32768
s_add_u32 m0,m0,1024
s_nop 0
buffer_load_dwordx4 v16,s[28:31],s62 offen lds
s_add_u32 s62,s62,32768
s_add_u32 m0,m0,1024
s_nop 0
buffer_load_dwordx4 v16,s[28:31],s62 offen lds
s_add_u32 s62,s62,32768
s_add_u32 m0,m0,1024
s_nop 0
buffer_load_dwordx4 v16,s[28:31],s62 offen lds
s_add_u32 s62,s62,32768
s_add_u32 m0,m0,1024
s_nop 0
buffer_load_dwordx4 v16,s[28:31],s62 offen lds
s_add_u32 s62,s62,32768
s_add_u32 m0,m0,1024
s_nop 0
buffer_load_dwordx4 v16,s[28:31],s62 offen lds
s_add_u32 s62,s62,32768
s_add_u32 m0,m0,1024
s_nop 0
buffer_load_dwordx4 v16,s[28:31],s62 offen lds
s_add_u32 s62,s62,32768
s_add_u32 m0,m0,1024
s_nop 0
buffer_load_dwordx4 v16,s[28:31],s62 offen lds
s_add_u32 s62,s62,32768
s_add_u32 m0,m0,1024
s_nop 0
buffer_load_dwordx4 v16,s[28:31],s62 offen lds
s_add_u32 s62,s62,32768
s_add_u32 m0,m0,1024
s_nop 0
buffer_load_dwordx4 v16,s[28:31],s62 offen lds
s_add_u32 s62,s62,32768
s_add_u32 m0,m0,1024
s_nop 0
buffer_load_dwordx4 v16,s[28:31],s62 offen lds
s_waitcnt vmcnt(16)
ds_read_b64_tr_b16 a[64:65],v17 offset:16384
ds_read_b64_tr_b16 a[66:67],v17 offset:16640
ds_read_b64_tr_b16 a[68:69],v17 offset:16392
ds_read_b64_tr_b16 a[70:71],v17 offset:16648
ds_read_b64_tr_b16 a[72:73],v17 offset:18432
ds_read_b64_tr_b16 a[74:75],v17 offset:18688
ds_read_b64_tr_b16 a[76:77],v17 offset:18440
ds_read_b64_tr_b16 a[78:79],v17 offset:18696
ds_read_b64_tr_b16 a[80:81],v17 offset:20480
ds_read_b64_tr_b16 a[82:83],v17 offset:20736
ds_read_b64_tr_b16 a[84:85],v17 offset:20488
ds_read_b64_tr_b16 a[86:87],v17 offset:20744
s_waitcnt lgkmcnt(0)
ds_read_b64_tr_b16 a[88:89],v17 offset:22528
ds_read_b64_tr_b16 a[90:91],v17 offset:22784
ds_read_b64_tr_b16 a[92:93],v17 offset:22536
ds_read_b64_tr_b16 a[94:95],v17 offset:22792
ds_read_b64_tr_b16 a[96:97],v17 offset:24576
ds_read_b64_tr_b16 a[98:99],v17 offset:24832
ds_read_b64_tr_b16 a[100:101],v17 offset:24584
ds_read_b64_tr_b16 a[102:103],v17 offset:24840
ds_read_b64_tr_b16 a[104:105],v17 offset:26624
ds_read_b64_tr_b16 a[106:107],v17 offset:26880
ds_read_b64_tr_b16 a[108:109],v17 offset:26632
ds_read_b64_tr_b16 a[110:111],v17 offset:26888
s_waitcnt lgkmcnt(0)
ds_read_b64_tr_b16 a[112:113],v17 offset:28672
ds_read_b64_tr_b16 a[114:115],v17 offset:28928
ds_read_b64_tr_b16 a[116:117],v17 offset:28680
ds_read_b64_tr_b16 a[118:119],v17 offset:28936
ds_read_b64_tr_b16 a[120:121],v17 offset:30720
ds_read_b64_tr_b16 a[122:123],v17 offset:30976
ds_read_b64_tr_b16 a[124:125],v17 offset:30728
ds_read_b64_tr_b16 a[126:127],v17 offset:30984
s_waitcnt lgkmcnt(0)
s_xor_b32 s62,s50,3
s_mul_i32 s62,s62,524288
s_add_u32 s62,s62,s54
s_add_u32 m0,s61,16384
s_nop 0
buffer_load_dwordx4 v16,s[28:31],s62 offen lds
s_add_u32 s62,s62,32768
s_add_u32 m0,m0,1024
s_nop 0
buffer_load_dwordx4 v16,s[28:31],s62 offen lds
s_add_u32 s62,s62,32768
s_add_u32 m0,m0,1024
s_nop 0
buffer_load_dwordx4 v16,s[28:31],s62 offen lds
s_add_u32 s62,s62,32768
s_add_u32 m0,m0,1024
s_nop 0
buffer_load_dwordx4 v16,s[28:31],s62 offen lds
s_add_u32 s62,s62,32768
s_add_u32 m0,m0,1024
s_nop 0
buffer_load_dwordx4 v16,s[28:31],s62 offen lds
s_add_u32 s62,s62,32768
s_add_u32 m0,m0,1024
s_nop 0
buffer_load_dwordx4 v16,s[28:31],s62 offen lds
s_add_u32 s62,s62,32768
s_add_u32 m0,m0,1024
s_nop 0
buffer_load_dwordx4 v16,s[28:31],s62 offen lds
s_add_u32 s62,s62,32768
s_add_u32 m0,m0,1024
s_nop 0
buffer_load_dwordx4 v16,s[28:31],s62 offen lds
s_add_u32 s62,s62,32768
s_add_u32 m0,m0,1024
s_nop 0
buffer_load_dwordx4 v16,s[28:31],s62 offen lds
s_add_u32 s62,s62,32768
s_add_u32 m0,m0,1024
s_nop 0
buffer_load_dwordx4 v16,s[28:31],s62 offen lds
s_add_u32 s62,s62,32768
s_add_u32 m0,m0,1024
s_nop 0
buffer_load_dwordx4 v16,s[28:31],s62 offen lds
s_add_u32 s62,s62,32768
s_add_u32 m0,m0,1024
s_nop 0
buffer_load_dwordx4 v16,s[28:31],s62 offen lds
s_add_u32 s62,s62,32768
s_add_u32 m0,m0,1024
s_nop 0
buffer_load_dwordx4 v16,s[28:31],s62 offen lds
s_add_u32 s62,s62,32768
s_add_u32 m0,m0,1024
s_nop 0
buffer_load_dwordx4 v16,s[28:31],s62 offen lds
s_add_u32 s62,s62,32768
s_add_u32 m0,m0,1024
s_nop 0
buffer_load_dwordx4 v16,s[28:31],s62 offen lds
s_add_u32 s62,s62,32768
s_add_u32 m0,m0,1024
s_nop 0
buffer_load_dwordx4 v16,s[28:31],s62 offen lds
s_waitcnt vmcnt(16)
ds_read_b64_tr_b16 a[128:129],v17 offset:0
ds_read_b64_tr_b16 a[130:131],v17 offset:256
ds_read_b64_tr_b16 a[132:133],v17 offset:8
ds_read_b64_tr_b16 a[134:135],v17 offset:264
ds_read_b64_tr_b16 a[136:137],v17 offset:2048
ds_read_b64_tr_b16 a[138:139],v17 offset:2304
ds_read_b64_tr_b16 a[140:141],v17 offset:2056
ds_read_b64_tr_b16 a[142:143],v17 offset:2312
ds_read_b64_tr_b16 a[144:145],v17 offset:4096
ds_read_b64_tr_b16 a[146:147],v17 offset:4352
ds_read_b64_tr_b16 a[148:149],v17 offset:4104
ds_read_b64_tr_b16 a[150:151],v17 offset:4360
s_waitcnt lgkmcnt(0)
ds_read_b64_tr_b16 a[152:153],v17 offset:6144
ds_read_b64_tr_b16 a[154:155],v17 offset:6400
ds_read_b64_tr_b16 a[156:157],v17 offset:6152
ds_read_b64_tr_b16 a[158:159],v17 offset:6408
ds_read_b64_tr_b16 a[160:161],v17 offset:8192
ds_read_b64_tr_b16 a[162:163],v17 offset:8448
ds_read_b64_tr_b16 a[164:165],v17 offset:8200
ds_read_b64_tr_b16 a[166:167],v17 offset:8456
ds_read_b64_tr_b16 a[168:169],v17 offset:10240
ds_read_b64_tr_b16 a[170:171],v17 offset:10496
ds_read_b64_tr_b16 a[172:173],v17 offset:10248
ds_read_b64_tr_b16 a[174:175],v17 offset:10504
s_waitcnt lgkmcnt(0)
ds_read_b64_tr_b16 a[176:177],v17 offset:12288
ds_read_b64_tr_b16 a[178:179],v17 offset:12544
ds_read_b64_tr_b16 a[180:181],v17 offset:12296
ds_read_b64_tr_b16 a[182:183],v17 offset:12552
ds_read_b64_tr_b16 a[184:185],v17 offset:14336
ds_read_b64_tr_b16 a[186:187],v17 offset:14592
ds_read_b64_tr_b16 a[188:189],v17 offset:14344
ds_read_b64_tr_b16 a[190:191],v17 offset:14600
s_waitcnt lgkmcnt(0)
s_waitcnt vmcnt(0)
ds_read_b64_tr_b16 a[192:193],v17 offset:16384
ds_read_b64_tr_b16 a[194:195],v17 offset:16640
ds_read_b64_tr_b16 a[196:197],v17 offset:16392
ds_read_b64_tr_b16 a[198:199],v17 offset:16648
ds_read_b64_tr_b16 a[200:201],v17 offset:18432
ds_read_b64_tr_b16 a[202:203],v17 offset:18688
ds_read_b64_tr_b16 a[204:205],v17 offset:18440
ds_read_b64_tr_b16 a[206:207],v17 offset:18696
ds_read_b64_tr_b16 a[208:209],v17 offset:20480
ds_read_b64_tr_b16 a[210:211],v17 offset:20736
ds_read_b64_tr_b16 a[212:213],v17 offset:20488
ds_read_b64_tr_b16 a[214:215],v17 offset:20744
s_waitcnt lgkmcnt(0)
ds_read_b64_tr_b16 a[216:217],v17 offset:22528
ds_read_b64_tr_b16 a[218:219],v17 offset:22784
ds_read_b64_tr_b16 a[220:221],v17 offset:22536
ds_read_b64_tr_b16 a[222:223],v17 offset:22792
ds_read_b64_tr_b16 a[224:225],v17 offset:24576
ds_read_b64_tr_b16 a[226:227],v17 offset:24832
ds_read_b64_tr_b16 a[228:229],v17 offset:24584
ds_read_b64_tr_b16 a[230:231],v17 offset:24840
ds_read_b64_tr_b16 a[232:233],v17 offset:26624
ds_read_b64_tr_b16 a[234:235],v17 offset:26880
ds_read_b64_tr_b16 a[236:237],v17 offset:26632
ds_read_b64_tr_b16 a[238:239],v17 offset:26888
s_waitcnt lgkmcnt(0)
ds_read_b64_tr_b16 a[240:241],v17 offset:28672
ds_read_b64_tr_b16 a[242:243],v17 offset:28928
ds_read_b64_tr_b16 a[244:245],v17 offset:28680
ds_read_b64_tr_b16 a[246:247],v17 offset:28936
ds_read_b64_tr_b16 a[248:249],v17 offset:30720
ds_read_b64_tr_b16 a[250:251],v17 offset:30976
ds_read_b64_tr_b16 a[252:253],v17 offset:30728
ds_read_b64_tr_b16 a[254:255],v17 offset:30984
s_waitcnt lgkmcnt(0)
s_mov_b32 s67,0
s_cmp_eq_u32 s56,1
s_cbranch_scc1 vok_122
v_mbcnt_lo_u32_b32 v16,-1,0
v_and_b32 v16,7,v16
v_lshlrev_b32 v16,7,v16
s_mov_b32 s64,138510336
vpoll_123:
buffer_load_dword v17,v16,s[20:23],s64 offen sc1
s_waitcnt vmcnt(0)
v_readlane_b32 s92,v17,0
v_readlane_b32 s93,v17,1
v_readlane_b32 s94,v17,2
v_readlane_b32 s95,v17,3
v_readlane_b32 s96,v17,4
v_readlane_b32 s97,v17,5
v_readlane_b32 s98,v17,6
v_readlane_b32 s99,v17,7
s_add_u32 s65,s92,s93
s_add_u32 s65,s65,s94
s_add_u32 s65,s65,s95
s_add_u32 s65,s65,s96
s_add_u32 s65,s65,s97
s_add_u32 s65,s65,s98
s_add_u32 s65,s65,s99
s_cmp_ge_u32 s65,256
s_cbranch_scc1 vgot_124
s_sleep 4
s_sub_u32 s90,s90,1
s_cmp_gt_i32 s90,0
s_cbranch_scc1 vpoll_123
vgot_124:
s_min_u32 s65,s92,s93
s_min_u32 s65,s65,s94
s_min_u32 s65,s65,s95
s_min_u32 s65,s65,s96
s_min_u32 s65,s65,s97
s_min_u32 s65,s65,s98
s_min_u32 s65,s65,s99
s_cmp_lt_u32 s65,32
s_cbranch_scc1 fl_slow
s_mov_b32 s56,0
vok_122:
s_barrier
v_lshlrev_b32 v0,4,v1
s_mov_b32 s60,0
s_mov_b32 s70,0
s_mov_b32 s55,0
s_lshl_b32 s63,s50,13
v_mov_b32 v3,v0
s_mov_b32 s73,0xffff0000
s_lshl_b32 s64,s52,2
s_add_u32 s64,s64,s50
s_mul_i32 s61,s64,8192
s_add_u32 s61,s61,205520896
s_lshl_b32 s82,s64,8
s_add_u32 s82,s82,138548224
s_mov_b32 s68,s82
s_lshl_b32 s83,s53,2
s_add_u32 s83,s83,s50
s_xor_b32 s64,s50,0
s_lshl_b32 s64,s64,13
v_add_u32 v8,s64,v0
s_xor_b32 s64,s50,1
s_lshl_b32 s64,s64,13
v_add_u32 v9,s64,v0
s_xor_b32 s64,s50,2
s_lshl_b32 s64,s64,13
v_add_u32 v10,s64,v0
s_xor_b32 s64,s50,3
s_lshl_b32 s64,s64,13
v_add_u32 v11,s64,v0
v_min_u32 v2,3,v1
v_lshlrev_b32 v2,2,v2
s_lshl_b32 s66,s83,10
s_lshr_b32 s65,s83,3
s_lshl_b32 s65,s65,8
s_and_b32 s64,s83,7
s_lshl_b32 s64,s64,2
s_add_u32 s69,s64,s65
s_add_u32 s69,s69,138549248
s_lshl_b32 s64,s50,9
s_add_u32 s64,s64,131072
v_lshlrev_b32 v26,3,v1
v_add_u32 v19,s64,v26
v_lshl_add_u32 v26,v23,4,v21
v_lshlrev_b32 v26,3,v26
v_add_u32 v20,131072,v26
s_mov_b32 s74,0x22222222
s_mov_b32 s75,0x22222222
s_mov_b32 s76,0x44444444
s_mov_b32 s77,0x44444444
s_mov_b32 s78,0x88888888
s_mov_b32 s79,0x88888888
s_mov_b32 s80,0xc0135761
s_mov_b32 s81,0xbdd2d3e8
v_mov_b32 v191,s80
v_mov_b32 v12,0x3f803f80
v_mov_b32 v13,0x3f803f80
v_mov_b32 v14,0x3f803f80
v_mov_b32 v15,0x3f803f80
s_nop 1
v_mfma_f32_16x16x32_bf16 v[152:155],a[0:3],v[12:15],0
v_mfma_f32_16x16x32_bf16 v[156:159],a[4:7],v[12:15],0
v_mfma_f32_16x16x32_bf16 v[152:155],a[8:11],v[12:15],v[152:155]
v_mfma_f32_16x16x32_bf16 v[156:159],a[12:15],v[12:15],v[156:159]
v_mfma_f32_16x16x32_bf16 v[152:155],a[16:19],v[12:15],v[152:155]
v_mfma_f32_16x16x32_bf16 v[156:159],a[20:23],v[12:15],v[156:159]
v_mfma_f32_16x16x32_bf16 v[152:155],a[24:27],v[12:15],v[152:155]
v_mfma_f32_16x16x32_bf16 v[156:159],a[28:31],v[12:15],v[156:159]
v_mfma_f32_16x16x32_bf16 v[152:155],a[32:35],v[12:15],v[152:155]
v_mfma_f32_16x16x32_bf16 v[156:159],a[36:39],v[12:15],v[156:159]
v_mfma_f32_16x16x32_bf16 v[152:155],a[40:43],v[12:15],v[152:155]
v_mfma_f32_16x16x32_bf16 v[156:159],a[44:47],v[12:15],v[156:159]
v_mfma_f32_16x16x32_bf16 v[152:155],a[48:51],v[12:15],v[152:155]
v_mfma_f32_16x16x32_bf16 v[156:159],a[52:55],v[12:15],v[156:159]
v_mfma_f32_16x16x32_bf16 v[152:155],a[56:59],v[12:15],v[152:155]
v_mfma_f32_16x16x32_bf16 v[156:159],a[60:63],v[12:15],v[156:159]
v_mfma_f32_16x16x32_bf16 v[152:155],a[64:67],v[12:15],v[152:155]
v_mfma_f32_16x16x32_bf16 v[156:159],a[68:71],v[12:15],v[156:159]
v_mfma_f32_16x16x32_bf16 v[152:155],a[72:75],v[12:15],v[152:155]
v_mfma_f32_16x16x32_bf16 v[156:159],a[76:79],v[12:15],v[156:159]
v_mfma_f32_16x16x32_bf16 v[152:155],a[80:83],v[12:15],v[152:155]
v_mfma_f32_16x16x32_bf16 v[156:159],a[84:87],v[12:15],v[156:159]
v_mfma_f32_16x16x32_bf16 v[152:155],a[88:91],v[12:15],v[152:155]
v_mfma_f32_16x16x32_bf16 v[156:159],a[92:95],v[12:15],v[156:159]
v_mfma_f32_16x16x32_bf16 v[152:155],a[96:99],v[12:15],v[152:155]
v_mfma_f32_16x16x32_bf16 v[156:159],a[100:103],v[12:15],v[156:159]
v_mfma_f32_16x16x32_bf16 v[152:155],a[104:107],v[12:15],v[152:155]
v_mfma_f32_16x16x32_bf16 v[156:159],a[108:111],v[12:15],v[156:159]
v_mfma_f32_16x16x32_bf16 v[152:155],a[112:115],v[12:15],v[152:155]
v_mfma_f32_16x16x32_bf16 v[156:159],a[116:119],v[12:15],v[156:159]
v_mfma_f32_16x16x32_bf16 v[152:155],a[120:123],v[12:15],v[152:155]
v_mfma_f32_16x16x32_bf16 v[156:159],a[124:127],v[12:15],v[156:159]
v_mfma_f32_16x16x32_bf16 v[152:155],a[128:131],v[12:15],v[152:155]
v_mfma_f32_16x16x32_bf16 v[156:159],a[132:135],v[12:15],v[156:159]
v_mfma_f32_16x16x32_bf16 v[152:155],a[136:139],v[12:15],v[152:155]
v_mfma_f32_16x16x32_bf16 v[156:159],a[140:143],v[12:15],v[156:159]
v_mfma_f32_16x16x32_bf16 v[152:155],a[144:147],v[12:15],v[152:155]
v_mfma_f32_16x16x32_bf16 v[156:159],a[148:151],v[12:15],v[156:159]
v_mfma_f32_16x16x32_bf16 v[152:155],a[152:155],v[12:15],v[152:155]
v_mfma_f32_16x16x32_bf16 v[156:159],a[156:159],v[12:15],v[156:159]
v_mfma_f32_16x16x32_bf16 v[152:155],a[160:163],v[12:15],v[152:155]
v_mfma_f32_16x16x32_bf16 v[156:159],a[164:167],v[12:15],v[156:159]
v_mfma_f32_16x16x32_bf16 v[152:155],a[168:171],v[12:15],v[152:155]
v_mfma_f32_16x16x32_bf16 v[156:159],a[172:175],v[12:15],v[156:159]
v_mfma_f32_16x16x32_bf16 v[152:155],a[176:179],v[12:15],v[152:155]
v_mfma_f32_16x16x32_bf16 v[156:159],a[180:183],v[12:15],v[156:159]
v_mfma_f32_16x16x32_bf16 v[152:155],a[184:187],v[12:15],v[152:155]
v_mfma_f32_16x16x32_bf16 v[156:159],a[188:191],v[12:15],v[156:159]
v_mfma_f32_16x16x32_bf16 v[152:155],a[192:195],v[12:15],v[152:155]
v_mfma_f32_16x16x32_bf16 v[156:159],a[196:199],v[12:15],v[156:159]
v_mfma_f32_16x16x32_bf16 v[152:155],a[200:203],v[12:15],v[152:155]
v_mfma_f32_16x16x32_bf16 v[156:159],a[204:207],v[12:15],v[156:159]
v_mfma_f32_16x16x32_bf16 v[152:155],a[208:211],v[12:15],v[152:155]
v_mfma_f32_16x16x32_bf16 v[156:159],a[212:215],v[12:15],v[156:159]
v_mfma_f32_16x16x32_bf16 v[152:155],a[216:219],v[12:15],v[152:155]
v_mfma_f32_16x16x32_bf16 v[156:159],a[220:223],v[12:15],v[156:159]
v_mfma_f32_16x16x32_bf16 v[152:155],a[224:227],v[12:15],v[152:155]
v_mfma_f32_16x16x32_bf16 v[156:159],a[228:231],v[12:15],v[156:159]
v_mfma_f32_16x16x32_bf16 v[152:155],a[232:235],v[12:15],v[152:155]
v_mfma_f32_16x16x32_bf16 v[156:159],a[236:239],v[12:15],v[156:159]
v_mfma_f32_16x16x32_bf16 v[152:155],a[240:243],v[12:15],v[152:155]
v_mfma_f32_16x16x32_bf16 v[156:159],a[244:247],v[12:15],v[156:159]
v_mfma_f32_16x16x32_bf16 v[152:155],a[248:251],v[12:15],v[152:155]
v_mfma_f32_16x16x32_bf16 v[156:159],a[252:255],v[12:15],v[156:159]
s_add_u32 s71,s60,1
plp_132:
buffer_load_dword v16,v2,s[20:23],s68 offen sc1
s_waitcnt vmcnt(0)
v_cmp_gt_u32 vcc,s71,v16
s_cbranch_vccz pok_133
s_sleep 4
s_sub_u32 s90,s90,1
s_cmp_gt_i32 s90,0
s_cbranch_scc1 plp_132
pok_133:
lag_131:
s_add_u32 m0,s70,s63
s_add_u32 s62,s61,4096
buffer_load_dwordx4 v3,s[20:23],s61 offen offset:0 lds
buffer_load_dwordx4 v3,s[20:23],s61 offen offset:1024 lds
buffer_load_dwordx4 v3,s[20:23],s61 offen offset:2048 lds
buffer_load_dwordx4 v3,s[20:23],s61 offen offset:3072 lds
s_add_u32 m0,m0,4096
s_nop 0
buffer_load_dwordx4 v3,s[20:23],s62 offen offset:0 lds
buffer_load_dwordx4 v3,s[20:23],s62 offen offset:1024 lds
buffer_load_dwordx4 v3,s[20:23],s62 offen offset:2048 lds
buffer_load_dwordx4 v3,s[20:23],s62 offen offset:3072 lds
s_add_u32 s61,s61,32768
s_add_u32 s70,s70,32768
s_and_b32 s70,s70,0x1ffff
buffer_load_dword v17,off,s[20:23],s69
top_127:
s_add_u32 s71,s60,2
buffer_load_dword v16,v2,s[20:23],s68 offen sc1
v_add_u32 v4,s55,v8
v_add_u32 v5,s55,v9
v_add_u32 v6,s55,v10
v_add_u32 v7,s55,v11
s_add_u32 s55,s55,32768
s_and_b32 s55,s55,0x1ffff
s_waitcnt vmcnt(9)
ds_read_b128 v[64:67],v4 offset:0
s_waitcnt vmcnt(8)
ds_read_b128 v[68:71],v4 offset:1024
s_waitcnt vmcnt(7)
ds_read_b128 v[72:75],v4 offset:2048
s_waitcnt lgkmcnt(2)
v_mfma_f32_16x16x32_bf16 v[32:35],a[0:3],v[64:67],0
v_mfma_f32_16x16x32_bf16 v[36:39],a[4:7],v[64:67],0
v_mfma_f32_16x16x32_bf16 v[48:51],v[12:15],v[64:67],0
v_mfma_f32_16x16x32_bf16 v[52:55],v[64:67],v[64:67],0
s_waitcnt vmcnt(6)
ds_read_b128 v[76:79],v4 offset:3072
s_waitcnt lgkmcnt(2)
v_mfma_f32_16x16x32_bf16 v[32:35],a[8:11],v[68:71],v[32:35]
v_mfma_f32_16x16x32_bf16 v[36:39],a[12:15],v[68:71],v[36:39]
v_mfma_f32_16x16x32_bf16 v[48:51],v[12:15],v[68:71],v[48:51]
v_mfma_f32_16x16x32_bf16 v[52:55],v[68:71],v[68:71],v[52:55]
s_waitcnt vmcnt(5)
ds_read_b128 v[80:83],v4 offset:4096
s_waitcnt lgkmcnt(2)
v_mfma_f32_16x16x32_bf16 v[32:35],a[16:19],v[72:75],v[32:35]
v_mfma_f32_16x16x32_bf16 v[36:39],a[20:23],v[72:75],v[36:39]
v_mfma_f32_16x16x32_bf16 v[48:51],v[12:15],v[72:75],v[48:51]
v_mfma_f32_16x16x32_bf16 v[52:55],v[72:75],v[72:75],v[52:55]
s_waitcnt vmcnt(4)
ds_read_b128 v[84:87],v4 offset:5120
s_waitcnt lgkmcnt(2)
v_mfma_f32_16x16x32_bf16 v[32:35],a[24:27],v[76:79],v[32:35]
v_mfma_f32_16x16x32_bf16 v[36:39],a[28:31],v[76:79],v[36:39]
v_mfma_f32_16x16x32_bf16 v[48:51],v[12:15],v[76:79],v[48:51]
v_mfma_f32_16x16x32_bf16 v[52:55],v[76:79],v[76:79],v[52:55]
s_waitcnt vmcnt(3)
ds_read_b128 v[88:91],v4 offset:6144
s_waitcnt lgkmcnt(2)
v_mfma_f32_16x16x32_bf16 v[32:35],a[32:35],v[80:83],v[32:35]
v_mfma_f32_16x16x32_bf16 v[36:39],a[36:39],v[80:83],v[36:39]
v_mfma_f32_16x16x32_bf16 v[48:51],v[12:15],v[80:83],v[48:51]
v_mfma_f32_16x16x32_bf16 v[52:55],v[80:83],v[80:83],v[52:55]
s_waitcnt vmcnt(2)
ds_read_b128 v[92:95],v4 offset:7168
s_barrier
s_waitcnt lgkmcnt(2)
v_mfma_f32_16x16x32_bf16 v[32:35],a[40:43],v[84:87],v[32:35]
v_mfma_f32_16x16x32_bf16 v[36:39],a[44:47],v[84:87],v[36:39]
v_mfma_f32_16x16x32_bf16 v[48:51],v[12:15],v[84:87],v[48:51]
v_mfma_f32_16x16x32_bf16 v[52:55],v[84:87],v[84:87],v[52:55]
ds_read_b128 v[96:99],v5 offset:0
s_waitcnt lgkmcnt(2)
v_mfma_f32_16x16x32_bf16 v[32:35],a[48:51],v[88:91],v[32:35]
ds_read_b128 v[100:103],v5 offset:1024
ds_read_b128 v[104:107],v5 offset:2048
v_mfma_f32_16x16x32_bf16 v[36:39],a[52:55],v[88:91],v[36:39]
v_mfma_f32_16x16x32_bf16 v[48:51],v[12:15],v[88:91],v[48:51]
v_mfma_f32_16x16x32_bf16 v[52:55],v[88:91],v[88:91],v[52:55]
s_waitcnt lgkmcnt(3)
v_mfma_f32_16x16x32_bf16 v[32:35],a[56:59],v[92:95],v[32:35]
ds_read_b128 v[108:111],v5 offset:3072
ds_read_b128 v[112:115],v5 offset:4096
v_mfma_f32_16x16x32_bf16 v[36:39],a[60:63],v[92:95],v[36:39]
v_mfma_f32_16x16x32_bf16 v[48:51],v[12:15],v[92:95],v[48:51]
v_mfma_f32_16x16x32_bf16 v[52:55],v[92:95],v[92:95],v[52:55]
s_waitcnt lgkmcnt(4)
v_mfma_f32_16x16x32_bf16 v[32:35],a[64:67],v[96:99],v[32:35]
ds_read_b128 v[116:119],v5 offset:5120
ds_read_b128 v[120:123],v5 offset:6144
v_mfma_f32_16x16x32_bf16 v[36:39],a[68:71],v[96:99],v[36:39]
s_waitcnt lgkmcnt(5)
v_mfma_f32_16x16x32_bf16 v[32:35],a[72:75],v[100:103],v[32:35]
ds_read_b128 v[124:127],v5 offset:7168
v_mfma_f32_16x16x32_bf16 v[36:39],a[76:79],v[100:103],v[36:39]
s_waitcnt lgkmcnt(5)
v_mfma_f32_16x16x32_bf16 v[32:35],a[80:83],v[104:107],v[32:35]
ds_read_b128 v[64:67],v6 offset:0
v_mfma_f32_16x16x32_bf16 v[36:39],a[84:87],v[104:107],v[36:39]
s_waitcnt lgkmcnt(5)
v_mfma_f32_16x16x32_bf16 v[32:35],a[88:91],v[108:111],v[32:35]
ds_read_b128 v[68:71],v6 offset:1024
v_cndmask_b32 v49,v52,v53,s[74:75]
v_mfma_f32_16x16x32_bf16 v[36:39],a[92:95],v[108:111],v[36:39]
v_cndmask_b32 v49,v49,v54,s[76:77]
s_waitcnt lgkmcnt(5)
v_mfma_f32_16x16x32_bf16 v[32:35],a[96:99],v[112:115],v[32:35]
ds_read_b128 v[72:75],v6 offset:2048
v_cndmask_b32 v49,v49,v55,s[78:79]
v_mfma_f32_16x16x32_bf16 v[36:39],a[100:103],v[112:115],v[36:39]
ds_write_b64 v19,v[48:49]
s_waitcnt lgkmcnt(6)
v_mfma_f32_16x16x32_bf16 v[32:35],a[104:107],v[116:119],v[32:35]
ds_read_b128 v[76:79],v6 offset:3072
v_mfma_f32_16x16x32_bf16 v[36:39],a[108:111],v[116:119],v[36:39]
s_waitcnt lgkmcnt(6)
v_mfma_f32_16x16x32_bf16 v[32:35],a[112:115],v[120:123],v[32:35]
ds_read_b128 v[80:83],v6 offset:4096
v_mfma_f32_16x16x32_bf16 v[36:39],a[116:119],v[120:123],v[36:39]
s_waitcnt lgkmcnt(6)
v_mfma_f32_16x16x32_bf16 v[32:35],a[120:123],v[124:127],v[32:35]
ds_read_b128 v[84:87],v6 offset:5120
v_mfma_f32_16x16x32_bf16 v[36:39],a[124:127],v[124:127],v[36:39]
s_waitcnt lgkmcnt(6)
v_mfma_f32_16x16x32_bf16 v[32:35],a[128:131],v[64:67],v[32:35]
ds_read_b128 v[88:91],v6 offset:6144
v_mfma_f32_16x16x32_bf16 v[36:39],a[132:135],v[64:67],v[36:39]
s_waitcnt lgkmcnt(4)
s_barrier
ds_read_b64 v[56:57],v20 offset:0
ds_read_b64 v[58:59],v20 offset:512
v_mfma_f32_16x16x32_bf16 v[32:35],a[136:139],v[68:71],v[32:35]
ds_read_b128 v[92:95],v6 offset:7168
ds_read_b64 v[60:61],v20 offset:1024
ds_read_b64 v[62:63],v20 offset:1536
v_mfma_f32_16x16x32_bf16 v[36:39],a[140:143],v[68:71],v[36:39]
v_mfma_f32_16x16x32_bf16 v[32:35],a[144:147],v[72:75],v[32:35]
ds_read_b128 v[96:99],v7 offset:0
v_mfma_f32_16x16x32_bf16 v[36:39],a[148:151],v[72:75],v[36:39]
s_waitcnt lgkmcnt(9)
v_mfma_f32_16x16x32_bf16 v[32:35],a[152:155],v[76:79],v[32:35]
ds_read_b128 v[100:103],v7 offset:1024
v_mfma_f32_16x16x32_bf16 v[36:39],a[156:159],v[76:79],v[36:39]
s_waitcnt lgkmcnt(9)
v_mfma_f32_16x16x32_bf16 v[32:35],a[160:163],v[80:83],v[32:35]
ds_read_b128 v[104:107],v7 offset:2048
v_mfma_f32_16x16x32_bf16 v[36:39],a[164:167],v[80:83],v[36:39]
s_waitcnt lgkmcnt(9)
v_mfma_f32_16x16x32_bf16 v[32:35],a[168:171],v[84:87],v[32:35]
ds_read_b128 v[108:111],v7 offset:3072
s_waitcnt lgkmcnt(4)
v_mfma_f32_16x16x32_bf16 v[36:39],a[172:175],v[84:87],v[36:39]
v_add_f32 v56,v56,v58
s_waitcnt vmcnt(0)
v_mov_b32 v17,s60
s_mov_b64 exec,1
buffer_store_dword v17,off,s[20:23],s69 sc1
s_mov_b64 exec,-1
v_cmp_gt_u32 vcc,s71,v16
s_cbranch_vccnz vN_128
v_mfma_f32_16x16x32_bf16 v[32:35],a[176:179],v[88:91],v[32:35]
ds_read_b128 v[112:115],v7 offset:4096
v_add_f32 v57,v57,v59
s_add_u32 m0,s70,s63
v_mfma_f32_16x16x32_bf16 v[36:39],a[180:183],v[88:91],v[36:39]
v_add_f32 v60,v60,v62
s_add_u32 s62,s61,4096
v_mfma_f32_16x16x32_bf16 v[32:35],a[184:187],v[92:95],v[32:35]
ds_read_b128 v[116:119],v7 offset:5120
v_add_f32 v61,v61,v63
buffer_load_dwordx4 v3,s[20:23],s61 offen offset:0 lds
v_mfma_f32_16x16x32_bf16 v[36:39],a[188:191],v[92:95],v[36:39]
v_add_f32 v56,v56,v60
buffer_load_dwordx4 v3,s[20:23],s61 offen offset:1024 lds
s_waitcnt lgkmcnt(5)
v_mfma_f32_16x16x32_bf16 v[32:35],a[192:195],v[96:99],v[32:35]
ds_read_b128 v[120:123],v7 offset:6144
v_add_f32 v57,v57,v61
buffer_load_dwordx4 v3,s[20:23],s61 offen offset:2048 lds
v_mfma_f32_16x16x32_bf16 v[36:39],a[196:199],v[96:99],v[36:39]
v_mul_f32 v189,0xba800000,v56
buffer_load_dwordx4 v3,s[20:23],s61 offen offset:3072 lds
s_waitcnt lgkmcnt(5)
v_mfma_f32_16x16x32_bf16 v[32:35],a[200:203],v[100:103],v[32:35]
ds_read_b128 v[124:127],v7 offset:7168
v_mul_f32 v58,v189,v189
s_add_u32 m0,m0,4096
v_mfma_f32_16x16x32_bf16 v[36:39],a[204:207],v[100:103],v[36:39]
v_mul_f32 v57,0x3a800000,v57
buffer_load_dwordx4 v3,s[20:23],s62 offen offset:0 lds
s_waitcnt lgkmcnt(5)
v_mfma_f32_16x16x32_bf16 v[32:35],a[208:211],v[104:107],v[32:35]
v_sub_f32 v57,v57,v58
buffer_load_dwordx4 v3,s[20:23],s62 offen offset:1024 lds
v_mfma_f32_16x16x32_bf16 v[36:39],a[212:215],v[104:107],v[36:39]
v_max_f32 v57,0,v57
buffer_load_dwordx4 v3,s[20:23],s62 offen offset:2048 lds
s_waitcnt lgkmcnt(4)
v_mfma_f32_16x16x32_bf16 v[32:35],a[216:219],v[108:111],v[32:35]
v_add_f32 v57,0x3727c5ac,v57
buffer_load_dwordx4 v3,s[20:23],s62 offen offset:3072 lds
v_mfma_f32_16x16x32_bf16 v[36:39],a[220:223],v[108:111],v[36:39]
v_rsq_f32 v190,v57
s_add_u32 s61,s61,32768
s_waitcnt lgkmcnt(3)
v_mfma_f32_16x16x32_bf16 v[32:35],a[224:227],v[112:115],v[32:35]
s_add_u32 s70,s70,32768
v_mfma_f32_16x16x32_bf16 v[36:39],a[228:231],v[112:115],v[36:39]
s_and_b32 s70,s70,0x1ffff
s_waitcnt lgkmcnt(2)
v_mfma_f32_16x16x32_bf16 v[32:35],a[232:235],v[116:119],v[32:35]
v_mfma_f32_16x16x32_bf16 v[36:39],a[236:239],v[116:119],v[36:39]
s_waitcnt lgkmcnt(1)
v_mfma_f32_16x16x32_bf16 v[32:35],a[240:243],v[120:123],v[32:35]
v_mfma_f32_16x16x32_bf16 v[36:39],a[244:247],v[120:123],v[36:39]
s_waitcnt lgkmcnt(0)
v_mfma_f32_16x16x32_bf16 v[32:35],a[248:251],v[124:127],v[32:35]
v_mfma_f32_16x16x32_bf16 v[36:39],a[252:255],v[124:127],v[36:39]
s_mov_b32 s72,1
join_129:
s_nop 5
v_fma_f32 v32,v152,v189,v32
v_fma_f32 v33,v153,v189,v33
v_fma_f32 v34,v154,v189,v34
v_fma_f32 v35,v155,v189,v35
v_fma_f32 v36,v156,v189,v36
v_fma_f32 v37,v157,v189,v37
v_fma_f32 v38,v158,v189,v38
v_fma_f32 v39,v159,v189,v39
v_mul_f32 v32,v32,v190
v_mul_f32 v33,v33,v190
v_mul_f32 v34,v34,v190
v_mul_f32 v35,v35,v190
v_mul_f32 v36,v36,v190
v_mul_f32 v37,v37,v190
v_mul_f32 v38,v38,v190
v_mul_f32 v39,v39,v190
v_mul_f32 v168,v32,v32
v_mul_f32 v169,v33,v33
v_mul_f32 v170,v34,v34
v_mul_f32 v171,v35,v35
v_mul_f32 v172,v36,v36
v_mul_f32 v173,v37,v37
v_mul_f32 v174,v38,v38
v_mul_f32 v175,v39,v39
v_fma_f32 v168,v168,s81,v191
v_fma_f32 v169,v169,s81,v191
v_fma_f32 v170,v170,s81,v191
v_fma_f32 v171,v171,s81,v191
v_fma_f32 v172,v172,s81,v191
v_fma_f32 v173,v173,s81,v191
v_fma_f32 v174,v174,s81,v191
v_fma_f32 v175,v175,s81,v191
v_mul_f32 v168,v168,v32
v_mul_f32 v169,v169,v33
v_mul_f32 v170,v170,v34
v_mul_f32 v171,v171,v35
v_mul_f32 v172,v172,v36
v_mul_f32 v173,v173,v37
v_mul_f32 v174,v174,v38
v_mul_f32 v175,v175,v39
v_exp_f32 v168,v168
v_exp_f32 v169,v169
v_exp_f32 v170,v170
v_exp_f32 v171,v171
v_exp_f32 v172,v172
v_exp_f32 v173,v173
v_exp_f32 v174,v174
v_exp_f32 v175,v175
v_add_f32 v168,1.0,v168
v_add_f32 v169,1.0,v169
v_add_f32 v170,1.0,v170
v_add_f32 v171,1.0,v171
v_add_f32 v172,1.0,v172
v_add_f32 v173,1.0,v173
v_add_f32 v174,1.0,v174
v_add_f32 v175,1.0,v175
v_rcp_f32 v168,v168
v_rcp_f32 v169,v169
v_rcp_f32 v170,v170
v_rcp_f32 v171,v171
v_rcp_f32 v172,v172
v_rcp_f32 v173,v173
v_rcp_f32 v174,v174
v_rcp_f32 v175,v175
v_mul_f32 v32,v168,v32
v_mul_f32 v33,v169,v33
v_mul_f32 v34,v170,v34
v_mul_f32 v35,v171,v35
v_mul_f32 v36,v172,v36
v_mul_f32 v37,v173,v37
v_mul_f32 v38,v174,v38
v_mul_f32 v39,v175,v39
v_cvt_pk_bf16_f32 v176,v32,v33
v_cvt_pk_bf16_f32 v177,v34,v35
v_cvt_pk_bf16_f32 v178,v36,v37
v_cvt_pk_bf16_f32 v179,v38,v39
s_add_u32 s64,s66,209747968
buffer_store_dwordx4 v[176:179],v0,s[20:23],s64 offen sc1
s_add_u32 s66,s66,32768
s_add_u32 s60,s60,1
s_cmp_eq_u32 s72,0
s_cbranch_scc1 slowp_130
s_branch top_127
slowp_130:
s_waitcnt vmcnt(1)
v_cmp_gt_u32 vcc,s71,v16
s_cbranch_vccz lag_131
s_waitcnt vmcnt(0)
v_mov_b32 v17,s60
s_mov_b64 exec,1
buffer_store_dword v17,off,s[20:23],s69 sc1
s_mov_b64 exec,-1
s_cmp_ge_u32 s60,128
s_cbranch_scc1 done_121
plp_134:
buffer_load_dword v16,v2,s[20:23],s68 offen sc1
s_waitcnt vmcnt(0)
v_cmp_gt_u32 vcc,s71,v16
s_cbranch_vccz pok_135
s_sleep 4
s_sub_u32 s90,s90,1
s_cmp_gt_i32 s90,0
s_cbranch_scc1 plp_134
pok_135:
s_branch lag_131
vN_128:
buffer_load_dword v16,v2,s[20:23],s68 offen sc1
v_mfma_f32_16x16x32_bf16 v[32:35],a[176:179],v[88:91],v[32:35]
ds_read_b128 v[112:115],v7 offset:4096
v_add_f32 v57,v57,v59
v_mfma_f32_16x16x32_bf16 v[36:39],a[180:183],v[88:91],v[36:39]
v_add_f32 v60,v60,v62
v_mfma_f32_16x16x32_bf16 v[32:35],a[184:187],v[92:95],v[32:35]
ds_read_b128 v[116:119],v7 offset:5120
v_add_f32 v61,v61,v63
v_mfma_f32_16x16x32_bf16 v[36:39],a[188:191],v[92:95],v[36:39]
v_add_f32 v56,v56,v60
s_waitcnt lgkmcnt(5)
v_mfma_f32_16x16x32_bf16 v[32:35],a[192:195],v[96:99],v[32:35]
ds_read_b128 v[120:123],v7 offset:6144
v_add_f32 v57,v57,v61
v_mfma_f32_16x16x32_bf16 v[36:39],a[196:199],v[96:99],v[36:39]
v_mul_f32 v189,0xba800000,v56
s_waitcnt lgkmcnt(5)
v_mfma_f32_16x16x32_bf16 v[32:35],a[200:203],v[100:103],v[32:35]
ds_read_b128 v[124:127],v7 offset:7168
v_mul_f32 v58,v189,v189
v_mfma_f32_16x16x32_bf16 v[36:39],a[204:207],v[100:103],v[36:39]
v_mul_f32 v57,0x3a800000,v57
s_waitcnt lgkmcnt(5)
v_mfma_f32_16x16x32_bf16 v[32:35],a[208:211],v[104:107],v[32:35]
v_sub_f32 v57,v57,v58
v_mfma_f32_16x16x32_bf16 v[36:39],a[212:215],v[104:107],v[36:39]
v_max_f32 v57,0,v57
s_waitcnt lgkmcnt(4)
v_mfma_f32_16x16x32_bf16 v[32:35],a[216:219],v[108:111],v[32:35]
v_add_f32 v57,0x3727c5ac,v57
v_mfma_f32_16x16x32_bf16 v[36:39],a[220:223],v[108:111],v[36:39]
v_rsq_f32 v190,v57
s_waitcnt lgkmcnt(3)
v_mfma_f32_16x16x32_bf16 v[32:35],a[224:227],v[112:115],v[32:35]
v_mfma_f32_16x16x32_bf16 v[36:39],a[228:231],v[112:115],v[36:39]
s_waitcnt lgkmcnt(2)
v_mfma_f32_16x16x32_bf16 v[32:35],a[232:235],v[116:119],v[32:35]
v_mfma_f32_16x16x32_bf16 v[36:39],a[236:239],v[116:119],v[36:39]
s_waitcnt lgkmcnt(1)
v_mfma_f32_16x16x32_bf16 v[32:35],a[240:243],v[120:123],v[32:35]
v_mfma_f32_16x16x32_bf16 v[36:39],a[244:247],v[120:123],v[36:39]
s_waitcnt lgkmcnt(0)
v_mfma_f32_16x16x32_bf16 v[32:35],a[248:251],v[124:127],v[32:35]
v_mfma_f32_16x16x32_bf16 v[36:39],a[252:255],v[124:127],v[36:39]
s_mov_b32 s72,0
s_branch join_129
done_121:
s_endpgm
fl_w2:
v_and_b32 v21,15,v1
v_lshrrev_b32 v22,4,v1
v_lshrrev_b32 v23,2,v21
v_and_b32 v24,3,v21
s_lshl_b32 s61,s50,15
v_lshl_add_u32 v25,v22,3,v23
s_load_dwordx2 s[4:5],s[0:1],72
s_mov_b32 s52,0
s_mov_b32 s53,s59
s_mul_i32 s54,s52,2097152
s_lshl_b32 s64,s53,8
s_add_u32 s54,s54,s64
s_lshl_b32 s64,s50,6
s_add_u32 s54,s54,s64
s_waitcnt lgkmcnt(0)
s_mov_b32 s28,s4
s_and_b32 s29,s5,0xffff
s_mov_b32 s30,0x200000
s_mov_b32 s31,0x20000
v_lshrrev_b32 v26,2,v1
v_and_b32 v27,3,v1
v_mul_u32_u24 v16,2048,v26
v_lshl_add_u32 v16,v27,4,v16
v_lshlrev_b32 v17,6,v25
v_lshl_add_u32 v17,v24,4,v17
v_add_u32 v17,s61,v17
s_xor_b32 s62,s50,0
s_mul_i32 s62,s62,524288
s_add_u32 s62,s62,s54
s_add_u32 m0,s61,0
s_nop 0
buffer_load_dwordx4 v16,s[28:31],s62 offen lds
s_add_u32 s62,s62,32768
s_add_u32 m0,m0,1024
s_nop 0
buffer_load_dwordx4 v16,s[28:31],s62 offen lds
s_add_u32 s62,s62,32768
s_add_u32 m0,m0,1024
s_nop 0
buffer_load_dwordx4 v16,s[28:31],s62 offen lds
s_add_u32 s62,s62,32768
s_add_u32 m0,m0,1024
s_nop 0
buffer_load_dwordx4 v16,s[28:31],s62 offen lds
s_add_u32 s62,s62,32768
s_add_u32 m0,m0,1024
s_nop 0
buffer_load_dwordx4 v16,s[28:31],s62 offen lds
s_add_u32 s62,s62,32768
s_add_u32 m0,m0,1024
s_nop 0
buffer_load_dwordx4 v16,s[28:31],s62 offen lds
s_add_u32 s62,s62,32768
s_add_u32 m0,m0,1024
s_nop 0
buffer_load_dwordx4 v16,s[28:31],s62 offen lds
s_add_u32 s62,s62,32768
s_add_u32 m0,m0,1024
s_nop 0
buffer_load_dwordx4 v16,s[28:31],s62 offen lds
s_add_u32 s62,s62,32768
s_add_u32 m0,m0,1024
s_nop 0
buffer_load_dwordx4 v16,s[28:31],s62 offen lds
s_add_u32 s62,s62,32768
s_add_u32 m0,m0,1024
s_nop 0
buffer_load_dwordx4 v16,s[28:31],s62 offen lds
s_add_u32 s62,s62,32768
s_add_u32 m0,m0,1024
s_nop 0
buffer_load_dwordx4 v16,s[28:31],s62 offen lds
s_add_u32 s62,s62,32768
s_add_u32 m0,m0,1024
s_nop 0
buffer_load_dwordx4 v16,s[28:31],s62 offen lds
s_add_u32 s62,s62,32768
s_add_u32 m0,m0,1024
s_nop 0
buffer_load_dwordx4 v16,s[28:31],s62 offen lds
s_add_u32 s62,s62,32768
s_add_u32 m0,m0,1024
s_nop 0
buffer_load_dwordx4 v16,s[28:31],s62 offen lds
s_add_u32 s62,s62,32768
s_add_u32 m0,m0,1024
s_nop 0
buffer_load_dwordx4 v16,s[28:31],s62 offen lds
s_add_u32 s62,s62,32768
s_add_u32 m0,m0,1024
s_nop 0
buffer_load_dwordx4 v16,s[28:31],s62 offen lds
s_xor_b32 s62,s50,1
s_mul_i32 s62,s62,524288
s_add_u32 s62,s62,s54
s_add_u32 m0,s61,16384
s_nop 0
buffer_load_dwordx4 v16,s[28:31],s62 offen lds
s_add_u32 s62,s62,32768
s_add_u32 m0,m0,1024
s_nop 0
buffer_load_dwordx4 v16,s[28:31],s62 offen lds
s_add_u32 s62,s62,32768
s_add_u32 m0,m0,1024
s_nop 0
buffer_load_dwordx4 v16,s[28:31],s62 offen lds
s_add_u32 s62,s62,32768
s_add_u32 m0,m0,1024
s_nop 0
buffer_load_dwordx4 v16,s[28:31],s62 offen lds
s_add_u32 s62,s62,32768
s_add_u32 m0,m0,1024
s_nop 0
buffer_load_dwordx4 v16,s[28:31],s62 offen lds
s_add_u32 s62,s62,32768
s_add_u32 m0,m0,1024
s_nop 0
buffer_load_dwordx4 v16,s[28:31],s62 offen lds
s_add_u32 s62,s62,32768
s_add_u32 m0,m0,1024
s_nop 0
buffer_load_dwordx4 v16,s[28:31],s62 offen lds
s_add_u32 s62,s62,32768
s_add_u32 m0,m0,1024
s_nop 0
buffer_load_dwordx4 v16,s[28:31],s62 offen lds
s_add_u32 s62,s62,32768
s_add_u32 m0,m0,1024
s_nop 0
buffer_load_dwordx4 v16,s[28:31],s62 offen lds
s_add_u32 s62,s62,32768
s_add_u32 m0,m0,1024
s_nop 0
buffer_load_dwordx4 v16,s[28:31],s62 offen lds
s_add_u32 s62,s62,32768
s_add_u32 m0,m0,1024
s_nop 0
buffer_load_dwordx4 v16,s[28:31],s62 offen lds
s_add_u32 s62,s62,32768
s_add_u32 m0,m0,1024
s_nop 0
buffer_load_dwordx4 v16,s[28:31],s62 offen lds
s_add_u32 s62,s62,32768
s_add_u32 m0,m0,1024
s_nop 0
buffer_load_dwordx4 v16,s[28:31],s62 offen lds
s_add_u32 s62,s62,32768
s_add_u32 m0,m0,1024
s_nop 0
buffer_load_dwordx4 v16,s[28:31],s62 offen lds
s_add_u32 s62,s62,32768
s_add_u32 m0,m0,1024
s_nop 0
buffer_load_dwordx4 v16,s[28:31],s62 offen lds
s_add_u32 s62,s62,32768
s_add_u32 m0,m0,1024
s_nop 0
buffer_load_dwordx4 v16,s[28:31],s62 offen lds
s_waitcnt vmcnt(16)
ds_read_b64_tr_b16 a[0:1],v17 offset:0
ds_read_b64_tr_b16 a[2:3],v17 offset:256
ds_read_b64_tr_b16 a[4:5],v17 offset:8
ds_read_b64_tr_b16 a[6:7],v17 offset:264
ds_read_b64_tr_b16 a[8:9],v17 offset:2048
ds_read_b64_tr_b16 a[10:11],v17 offset:2304
ds_read_b64_tr_b16 a[12:13],v17 offset:2056
ds_read_b64_tr_b16 a[14:15],v17 offset:2312
ds_read_b64_tr_b16 a[16:17],v17 offset:4096
ds_read_b64_tr_b16 a[18:19],v17 offset:4352
ds_read_b64_tr_b16 a[20:21],v17 offset:4104
ds_read_b64_tr_b16 a[22:23],v17 offset:4360
s_waitcnt lgkmcnt(0)
ds_read_b64_tr_b16 a[24:25],v17 offset:6144
ds_read_b64_tr_b16 a[26:27],v17 offset:6400
ds_read_b64_tr_b16 a[28:29],v17 offset:6152
ds_read_b64_tr_b16 a[30:31],v17 offset:6408
ds_read_b64_tr_b16 a[32:33],v17 offset:8192
ds_read_b64_tr_b16 a[34:35],v17 offset:8448
ds_read_b64_tr_b16 a[36:37],v17 offset:8200
ds_read_b64_tr_b16 a[38:39],v17 offset:8456
ds_read_b64_tr_b16 a[40:41],v17 offset:10240
ds_read_b64_tr_b16 a[42:43],v17 offset:10496
ds_read_b64_tr_b16 a[44:45],v17 offset:10248
ds_read_b64_tr_b16 a[46:47],v17 offset:10504
s_waitcnt lgkmcnt(0)
ds_read_b64_tr_b16 a[48:49],v17 offset:12288
ds_read_b64_tr_b16 a[50:51],v17 offset:12544
ds_read_b64_tr_b16 a[52:53],v17 offset:12296
ds_read_b64_tr_b16 a[54:55],v17 offset:12552
ds_read_b64_tr_b16 a[56:57],v17 offset:14336
ds_read_b64_tr_b16 a[58:59],v17 offset:14592
ds_read_b64_tr_b16 a[60:61],v17 offset:14344
ds_read_b64_tr_b16 a[62:63],v17 offset:14600
s_waitcnt lgkmcnt(0)
s_xor_b32 s62,s50,2
s_mul_i32 s62,s62,524288
s_add_u32 s62,s62,s54
s_add_u32 m0,s61,0
s_nop 0
buffer_load_dwordx4 v16,s[28:31],s62 offen lds
s_add_u32 s62,s62,32768
s_add_u32 m0,m0,1024
s_nop 0
buffer_load_dwordx4 v16,s[28:31],s62 offen lds
s_add_u32 s62,s62,32768
s_add_u32 m0,m0,1024
s_nop 0
buffer_load_dwordx4 v16,s[28:31],s62 offen lds
s_add_u32 s62,s62,32768
s_add_u32 m0,m0,1024
s_nop 0
buffer_load_dwordx4 v16,s[28:31],s62 offen lds
s_add_u32 s62,s62,32768
s_add_u32 m0,m0,1024
s_nop 0
buffer_load_dwordx4 v16,s[28:31],s62 offen lds
s_add_u32 s62,s62,32768
s_add_u32 m0,m0,1024
s_nop 0
buffer_load_dwordx4 v16,s[28:31],s62 offen lds
s_add_u32 s62,s62,32768
s_add_u32 m0,m0,1024
s_nop 0
buffer_load_dwordx4 v16,s[28:31],s62 offen lds
s_add_u32 s62,s62,32768
s_add_u32 m0,m0,1024
s_nop 0
buffer_load_dwordx4 v16,s[28:31],s62 offen lds
s_add_u32 s62,s62,32768
s_add_u32 m0,m0,1024
s_nop 0
buffer_load_dwordx4 v16,s[28:31],s62 offen lds
s_add_u32 s62,s62,32768
s_add_u32 m0,m0,1024
s_nop 0
buffer_load_dwordx4 v16,s[28:31],s62 offen lds
s_add_u32 s62,s62,32768
s_add_u32 m0,m0,1024
s_nop 0
buffer_load_dwordx4 v16,s[28:31],s62 offen lds
s_add_u32 s62,s62,32768
s_add_u32 m0,m0,1024
s_nop 0
buffer_load_dwordx4 v16,s[28:31],s62 offen lds
s_add_u32 s62,s62,32768
s_add_u32 m0,m0,1024
s_nop 0
buffer_load_dwordx4 v16,s[28:31],s62 offen lds
s_add_u32 s62,s62,32768
s_add_u32 m0,m0,1024
s_nop 0
buffer_load_dwordx4 v16,s[28:31],s62 offen lds
s_add_u32 s62,s62,32768
s_add_u32 m0,m0,1024
s_nop 0
buffer_load_dwordx4 v16,s[28:31],s62 offen lds
s_add_u32 s62,s62,32768
s_add_u32 m0,m0,1024
s_nop 0
buffer_load_dwordx4 v16,s[28:31],s62 offen lds
s_waitcnt vmcnt(16)
ds_read_b64_tr_b16 a[64:65],v17 offset:16384
ds_read_b64_tr_b16 a[66:67],v17 offset:16640
ds_read_b64_tr_b16 a[68:69],v17 offset:16392
ds_read_b64_tr_b16 a[70:71],v17 offset:16648
ds_read_b64_tr_b16 a[72:73],v17 offset:18432
ds_read_b64_tr_b16 a[74:75],v17 offset:18688
ds_read_b64_tr_b16 a[76:77],v17 offset:18440
ds_read_b64_tr_b16 a[78:79],v17 offset:18696
ds_read_b64_tr_b16 a[80:81],v17 offset:20480
ds_read_b64_tr_b16 a[82:83],v17 offset:20736
ds_read_b64_tr_b16 a[84:85],v17 offset:20488
ds_read_b64_tr_b16 a[86:87],v17 offset:20744
s_waitcnt lgkmcnt(0)
ds_read_b64_tr_b16 a[88:89],v17 offset:22528
ds_read_b64_tr_b16 a[90:91],v17 offset:22784
ds_read_b64_tr_b16 a[92:93],v17 offset:22536
ds_read_b64_tr_b16 a[94:95],v17 offset:22792
ds_read_b64_tr_b16 a[96:97],v17 offset:24576
ds_read_b64_tr_b16 a[98:99],v17 offset:24832
ds_read_b64_tr_b16 a[100:101],v17 offset:24584
ds_read_b64_tr_b16 a[102:103],v17 offset:24840
ds_read_b64_tr_b16 a[104:105],v17 offset:26624
ds_read_b64_tr_b16 a[106:107],v17 offset:26880
ds_read_b64_tr_b16 a[108:109],v17 offset:26632
ds_read_b64_tr_b16 a[110:111],v17 offset:26888
s_waitcnt lgkmcnt(0)
ds_read_b64_tr_b16 a[112:113],v17 offset:28672
ds_read_b64_tr_b16 a[114:115],v17 offset:28928
ds_read_b64_tr_b16 a[116:117],v17 offset:28680
ds_read_b64_tr_b16 a[118:119],v17 offset:28936
ds_read_b64_tr_b16 a[120:121],v17 offset:30720
ds_read_b64_tr_b16 a[122:123],v17 offset:30976
ds_read_b64_tr_b16 a[124:125],v17 offset:30728
ds_read_b64_tr_b16 a[126:127],v17 offset:30984
s_waitcnt lgkmcnt(0)
s_xor_b32 s62,s50,3
s_mul_i32 s62,s62,524288
s_add_u32 s62,s62,s54
s_add_u32 m0,s61,16384
s_nop 0
buffer_load_dwordx4 v16,s[28:31],s62 offen lds
s_add_u32 s62,s62,32768
s_add_u32 m0,m0,1024
s_nop 0
buffer_load_dwordx4 v16,s[28:31],s62 offen lds
s_add_u32 s62,s62,32768
s_add_u32 m0,m0,1024
s_nop 0
buffer_load_dwordx4 v16,s[28:31],s62 offen lds
s_add_u32 s62,s62,32768
s_add_u32 m0,m0,1024
s_nop 0
buffer_load_dwordx4 v16,s[28:31],s62 offen lds
s_add_u32 s62,s62,32768
s_add_u32 m0,m0,1024
s_nop 0
buffer_load_dwordx4 v16,s[28:31],s62 offen lds
s_add_u32 s62,s62,32768
s_add_u32 m0,m0,1024
s_nop 0
buffer_load_dwordx4 v16,s[28:31],s62 offen lds
s_add_u32 s62,s62,32768
s_add_u32 m0,m0,1024
s_nop 0
buffer_load_dwordx4 v16,s[28:31],s62 offen lds
s_add_u32 s62,s62,32768
s_add_u32 m0,m0,1024
s_nop 0
buffer_load_dwordx4 v16,s[28:31],s62 offen lds
s_add_u32 s62,s62,32768
s_add_u32 m0,m0,1024
s_nop 0
buffer_load_dwordx4 v16,s[28:31],s62 offen lds
s_add_u32 s62,s62,32768
s_add_u32 m0,m0,1024
s_nop 0
buffer_load_dwordx4 v16,s[28:31],s62 offen lds
s_add_u32 s62,s62,32768
s_add_u32 m0,m0,1024
s_nop 0
buffer_load_dwordx4 v16,s[28:31],s62 offen lds
s_add_u32 s62,s62,32768
s_add_u32 m0,m0,1024
s_nop 0
buffer_load_dwordx4 v16,s[28:31],s62 offen lds
s_add_u32 s62,s62,32768
s_add_u32 m0,m0,1024
s_nop 0
buffer_load_dwordx4 v16,s[28:31],s62 offen lds
s_add_u32 s62,s62,32768
s_add_u32 m0,m0,1024
s_nop 0
buffer_load_dwordx4 v16,s[28:31],s62 offen lds
s_add_u32 s62,s62,32768
s_add_u32 m0,m0,1024
s_nop 0
buffer_load_dwordx4 v16,s[28:31],s62 offen lds
s_add_u32 s62,s62,32768
s_add_u32 m0,m0,1024
s_nop 0
buffer_load_dwordx4 v16,s[28:31],s62 offen lds
s_waitcnt vmcnt(16)
ds_read_b64_tr_b16 a[128:129],v17 offset:0
ds_read_b64_tr_b16 a[130:131],v17 offset:256
ds_read_b64_tr_b16 a[132:133],v17 offset:8
ds_read_b64_tr_b16 a[134:135],v17 offset:264
ds_read_b64_tr_b16 a[136:137],v17 offset:2048
ds_read_b64_tr_b16 a[138:139],v17 offset:2304
ds_read_b64_tr_b16 a[140:141],v17 offset:2056
ds_read_b64_tr_b16 a[142:143],v17 offset:2312
ds_read_b64_tr_b16 a[144:145],v17 offset:4096
ds_read_b64_tr_b16 a[146:147],v17 offset:4352
ds_read_b64_tr_b16 a[148:149],v17 offset:4104
ds_read_b64_tr_b16 a[150:151],v17 offset:4360
s_waitcnt lgkmcnt(0)
ds_read_b64_tr_b16 a[152:153],v17 offset:6144
ds_read_b64_tr_b16 a[154:155],v17 offset:6400
ds_read_b64_tr_b16 a[156:157],v17 offset:6152
ds_read_b64_tr_b16 a[158:159],v17 offset:6408
ds_read_b64_tr_b16 a[160:161],v17 offset:8192
ds_read_b64_tr_b16 a[162:163],v17 offset:8448
ds_read_b64_tr_b16 a[164:165],v17 offset:8200
ds_read_b64_tr_b16 a[166:167],v17 offset:8456
ds_read_b64_tr_b16 a[168:169],v17 offset:10240
ds_read_b64_tr_b16 a[170:171],v17 offset:10496
ds_read_b64_tr_b16 a[172:173],v17 offset:10248
ds_read_b64_tr_b16 a[174:175],v17 offset:10504
s_waitcnt lgkmcnt(0)
ds_read_b64_tr_b16 a[176:177],v17 offset:12288
ds_read_b64_tr_b16 a[178:179],v17 offset:12544
ds_read_b64_tr_b16 a[180:181],v17 offset:12296
ds_read_b64_tr_b16 a[182:183],v17 offset:12552
ds_read_b64_tr_b16 a[184:185],v17 offset:14336
ds_read_b64_tr_b16 a[186:187],v17 offset:14592
ds_read_b64_tr_b16 a[188:189],v17 offset:14344
ds_read_b64_tr_b16 a[190:191],v17 offset:14600
s_waitcnt lgkmcnt(0)
s_waitcnt vmcnt(0)
ds_read_b64_tr_b16 a[192:193],v17 offset:16384
ds_read_b64_tr_b16 a[194:195],v17 offset:16640
ds_read_b64_tr_b16 a[196:197],v17 offset:16392
ds_read_b64_tr_b16 a[198:199],v17 offset:16648
ds_read_b64_tr_b16 a[200:201],v17 offset:18432
ds_read_b64_tr_b16 a[202:203],v17 offset:18688
ds_read_b64_tr_b16 a[204:205],v17 offset:18440
ds_read_b64_tr_b16 a[206:207],v17 offset:18696
ds_read_b64_tr_b16 a[208:209],v17 offset:20480
ds_read_b64_tr_b16 a[210:211],v17 offset:20736
ds_read_b64_tr_b16 a[212:213],v17 offset:20488
ds_read_b64_tr_b16 a[214:215],v17 offset:20744
s_waitcnt lgkmcnt(0)
ds_read_b64_tr_b16 a[216:217],v17 offset:22528
ds_read_b64_tr_b16 a[218:219],v17 offset:22784
ds_read_b64_tr_b16 a[220:221],v17 offset:22536
ds_read_b64_tr_b16 a[222:223],v17 offset:22792
ds_read_b64_tr_b16 a[224:225],v17 offset:24576
ds_read_b64_tr_b16 a[226:227],v17 offset:24832
ds_read_b64_tr_b16 a[228:229],v17 offset:24584
ds_read_b64_tr_b16 a[230:231],v17 offset:24840
ds_read_b64_tr_b16 a[232:233],v17 offset:26624
ds_read_b64_tr_b16 a[234:235],v17 offset:26880
ds_read_b64_tr_b16 a[236:237],v17 offset:26632
ds_read_b64_tr_b16 a[238:239],v17 offset:26888
s_waitcnt lgkmcnt(0)
ds_read_b64_tr_b16 a[240:241],v17 offset:28672
ds_read_b64_tr_b16 a[242:243],v17 offset:28928
ds_read_b64_tr_b16 a[244:245],v17 offset:28680
ds_read_b64_tr_b16 a[246:247],v17 offset:28936
ds_read_b64_tr_b16 a[248:249],v17 offset:30720
ds_read_b64_tr_b16 a[250:251],v17 offset:30976
ds_read_b64_tr_b16 a[252:253],v17 offset:30728
ds_read_b64_tr_b16 a[254:255],v17 offset:30984
s_waitcnt lgkmcnt(0)
s_mov_b32 s67,0
s_cmp_eq_u32 s56,1
s_cbranch_scc1 vok_137
v_mbcnt_lo_u32_b32 v16,-1,0
v_and_b32 v16,7,v16
v_lshlrev_b32 v16,7,v16
s_mov_b32 s64,138510336
vpoll_138:
buffer_load_dword v17,v16,s[20:23],s64 offen sc1
s_waitcnt vmcnt(0)
v_readlane_b32 s92,v17,0
v_readlane_b32 s93,v17,1
v_readlane_b32 s94,v17,2
v_readlane_b32 s95,v17,3
v_readlane_b32 s96,v17,4
v_readlane_b32 s97,v17,5
v_readlane_b32 s98,v17,6
v_readlane_b32 s99,v17,7
s_add_u32 s65,s92,s93
s_add_u32 s65,s65,s94
s_add_u32 s65,s65,s95
s_add_u32 s65,s65,s96
s_add_u32 s65,s65,s97
s_add_u32 s65,s65,s98
s_add_u32 s65,s65,s99
s_cmp_ge_u32 s65,256
s_cbranch_scc1 vgot_139
s_sleep 4
s_sub_u32 s90,s90,1
s_cmp_gt_i32 s90,0
s_cbranch_scc1 vpoll_138
vgot_139:
s_min_u32 s65,s92,s93
s_min_u32 s65,s65,s94
s_min_u32 s65,s65,s95
s_min_u32 s65,s65,s96
s_min_u32 s65,s65,s97
s_min_u32 s65,s65,s98
s_min_u32 s65,s65,s99
s_cmp_lt_u32 s65,32
s_cbranch_scc1 fl_slow
s_mov_b32 s56,0
vok_137:
s_barrier
v_lshlrev_b32 v0,4,v1
s_mov_b32 s60,0
s_mov_b32 s70,0
s_mov_b32 s55,0
s_lshl_b32 s63,s50,13
v_mov_b32 v3,v0
s_mov_b32 s73,0xffff0000
s_lshl_b32 s64,s52,2
s_add_u32 s64,s64,s50
s_mul_i32 s61,s64,8192
s_add_u32 s61,s61,209747968
s_lshl_b32 s82,s64,8
s_add_u32 s82,s82,138549248
s_mov_b32 s68,s82
s_lshl_b32 s83,s53,2
s_add_u32 s83,s83,s50
s_xor_b32 s64,s50,0
s_lshl_b32 s64,s64,13
v_add_u32 v8,s64,v0
s_xor_b32 s64,s50,1
s_lshl_b32 s64,s64,13
v_add_u32 v9,s64,v0
s_xor_b32 s64,s50,2
s_lshl_b32 s64,s64,13
v_add_u32 v10,s64,v0
s_xor_b32 s64,s50,3
s_lshl_b32 s64,s64,13
v_add_u32 v11,s64,v0
v_min_u32 v2,7,v1
v_lshlrev_b32 v2,2,v2
s_lshr_b32 s64,s50,1
s_add_u32 s64,s64,1
s_sub_u32 s65,0,s64
s_bitcmp1_b32 s50,0
s_cselect_b32 s64,s64,s65
s_add_u32 s64,s64,16
v_add_u32 v26,s64,v21
v_lshrrev_b32 v27,4,v26
v_and_b32 v26,15,v26
v_lshl_add_u32 v26,v22,4,v26
v_lshlrev_b32 v26,4,v26
v_lshl_add_u32 v3,v27,15,v26
s_sub_u32 s61,s61,32768
s_lshl_b32 s66,s83,10
s_lshr_b32 s65,s83,3
s_lshl_b32 s65,s65,8
s_and_b32 s64,s83,7
s_lshl_b32 s64,s64,2
s_add_u32 s69,s64,s65
s_add_u32 s69,s69,138550272
s_add_u32 s71,s60,1
s_and_b32 s64,s50,1
s_add_u32 s71,s71,s64
s_min_u32 s71,s71,128
s_cmp_ge_u32 s60,128
s_cselect_b32 s71,-1,s71
plp_147:
buffer_load_dword v16,v2,s[20:23],s68 offen sc1
s_waitcnt vmcnt(0)
v_cmp_gt_u32 vcc,s71,v16
s_cbranch_vccz pok_148
s_sleep 4
s_sub_u32 s90,s90,1
s_cmp_gt_i32 s90,0
s_cbranch_scc1 plp_147
pok_148:
lag_146:
s_add_u32 m0,s70,s63
s_add_u32 s62,s61,4096
buffer_load_dwordx4 v3,s[20:23],s61 offen offset:0 lds
buffer_load_dwordx4 v3,s[20:23],s61 offen offset:1024 lds
buffer_load_dwordx4 v3,s[20:23],s61 offen offset:2048 lds
buffer_load_dwordx4 v3,s[20:23],s61 offen offset:3072 lds
s_add_u32 m0,m0,4096
s_nop 0
buffer_load_dwordx4 v3,s[20:23],s62 offen offset:0 lds
buffer_load_dwordx4 v3,s[20:23],s62 offen offset:1024 lds
buffer_load_dwordx4 v3,s[20:23],s62 offen offset:2048 lds
buffer_load_dwordx4 v3,s[20:23],s62 offen offset:3072 lds
s_add_u32 s61,s61,32768
s_add_u32 s70,s70,32768
s_and_b32 s70,s70,0x1ffff
buffer_load_dword v17,off,s[20:23],s69
top_142:
s_add_u32 s71,s60,2
s_and_b32 s64,s50,1
s_add_u32 s71,s71,s64
s_min_u32 s71,s71,128
s_cmp_ge_u32 s60,127
s_cselect_b32 s71,-1,s71
buffer_load_dword v16,v2,s[20:23],s68 offen sc1
s_add_u32 s64,s66,205520896
buffer_load_dwordx4 v[160:163],v0,s[20:23],s64 offen
v_add_u32 v4,s55,v8
v_add_u32 v5,s55,v9
v_add_u32 v6,s55,v10
v_add_u32 v7,s55,v11
s_add_u32 s55,s55,32768
s_and_b32 s55,s55,0x1ffff
s_waitcnt vmcnt(10)
ds_read_b128 v[64:67],v4 offset:0
s_waitcnt vmcnt(9)
ds_read_b128 v[68:71],v4 offset:1024
s_waitcnt vmcnt(8)
ds_read_b128 v[72:75],v4 offset:2048
s_waitcnt lgkmcnt(2)
v_mfma_f32_16x16x32_bf16 v[32:35],a[0:3],v[64:67],0
v_mfma_f32_16x16x32_bf16 v[36:39],a[4:7],v[64:67],0
s_waitcnt vmcnt(7)
ds_read_b128 v[76:79],v4 offset:3072
s_waitcnt lgkmcnt(2)
v_mfma_f32_16x16x32_bf16 v[32:35],a[8:11],v[68:71],v[32:35]
v_mfma_f32_16x16x32_bf16 v[36:39],a[12:15],v[68:71],v[36:39]
s_waitcnt vmcnt(6)
ds_read_b128 v[80:83],v4 offset:4096
s_waitcnt lgkmcnt(2)
v_mfma_f32_16x16x32_bf16 v[32:35],a[16:19],v[72:75],v[32:35]
v_mfma_f32_16x16x32_bf16 v[36:39],a[20:23],v[72:75],v[36:39]
s_waitcnt vmcnt(5)
ds_read_b128 v[84:87],v4 offset:5120
s_waitcnt lgkmcnt(2)
v_mfma_f32_16x16x32_bf16 v[32:35],a[24:27],v[76:79],v[32:35]
v_mfma_f32_16x16x32_bf16 v[36:39],a[28:31],v[76:79],v[36:39]
s_waitcnt vmcnt(4)
ds_read_b128 v[88:91],v4 offset:6144
s_waitcnt lgkmcnt(2)
v_mfma_f32_16x16x32_bf16 v[32:35],a[32:35],v[80:83],v[32:35]
v_mfma_f32_16x16x32_bf16 v[36:39],a[36:39],v[80:83],v[36:39]
s_waitcnt vmcnt(3)
ds_read_b128 v[92:95],v4 offset:7168
s_barrier
s_waitcnt lgkmcnt(2)
v_mfma_f32_16x16x32_bf16 v[32:35],a[40:43],v[84:87],v[32:35]
v_mfma_f32_16x16x32_bf16 v[36:39],a[44:47],v[84:87],v[36:39]
ds_read_b128 v[96:99],v5 offset:0
s_waitcnt lgkmcnt(2)
v_mfma_f32_16x16x32_bf16 v[32:35],a[48:51],v[88:91],v[32:35]
ds_read_b128 v[100:103],v5 offset:1024
ds_read_b128 v[104:107],v5 offset:2048
v_mfma_f32_16x16x32_bf16 v[36:39],a[52:55],v[88:91],v[36:39]
s_waitcnt lgkmcnt(3)
v_mfma_f32_16x16x32_bf16 v[32:35],a[56:59],v[92:95],v[32:35]
ds_read_b128 v[108:111],v5 offset:3072
ds_read_b128 v[112:115],v5 offset:4096
v_mfma_f32_16x16x32_bf16 v[36:39],a[60:63],v[92:95],v[36:39]
s_waitcnt lgkmcnt(4)
v_mfma_f32_16x16x32_bf16 v[32:35],a[64:67],v[96:99],v[32:35]
ds_read_b128 v[116:119],v5 offset:5120
ds_read_b128 v[120:123],v5 offset:6144
v_mfma_f32_16x16x32_bf16 v[36:39],a[68:71],v[96:99],v[36:39]
s_waitcnt lgkmcnt(5)
v_mfma_f32_16x16x32_bf16 v[32:35],a[72:75],v[100:103],v[32:35]
ds_read_b128 v[124:127],v5 offset:7168
v_mfma_f32_16x16x32_bf16 v[36:39],a[76:79],v[100:103],v[36:39]
s_waitcnt lgkmcnt(5)
v_mfma_f32_16x16x32_bf16 v[32:35],a[80:83],v[104:107],v[32:35]
ds_read_b128 v[64:67],v6 offset:0
v_mfma_f32_16x16x32_bf16 v[36:39],a[84:87],v[104:107],v[36:39]
s_waitcnt lgkmcnt(5)
v_mfma_f32_16x16x32_bf16 v[32:35],a[88:91],v[108:111],v[32:35]
ds_read_b128 v[68:71],v6 offset:1024
v_mfma_f32_16x16x32_bf16 v[36:39],a[92:95],v[108:111],v[36:39]
s_waitcnt lgkmcnt(5)
v_mfma_f32_16x16x32_bf16 v[32:35],a[96:99],v[112:115],v[32:35]
ds_read_b128 v[72:75],v6 offset:2048
v_mfma_f32_16x16x32_bf16 v[36:39],a[100:103],v[112:115],v[36:39]
s_waitcnt lgkmcnt(5)
v_mfma_f32_16x16x32_bf16 v[32:35],a[104:107],v[116:119],v[32:35]
ds_read_b128 v[76:79],v6 offset:3072
v_mfma_f32_16x16x32_bf16 v[36:39],a[108:111],v[116:119],v[36:39]
s_waitcnt lgkmcnt(5)
v_mfma_f32_16x16x32_bf16 v[32:35],a[112:115],v[120:123],v[32:35]
ds_read_b128 v[80:83],v6 offset:4096
v_mfma_f32_16x16x32_bf16 v[36:39],a[116:119],v[120:123],v[36:39]
s_waitcnt lgkmcnt(5)
v_mfma_f32_16x16x32_bf16 v[32:35],a[120:123],v[124:127],v[32:35]
ds_read_b128 v[84:87],v6 offset:5120
v_mfma_f32_16x16x32_bf16 v[36:39],a[124:127],v[124:127],v[36:39]
s_waitcnt lgkmcnt(5)
v_mfma_f32_16x16x32_bf16 v[32:35],a[128:131],v[64:67],v[32:35]
ds_read_b128 v[88:91],v6 offset:6144
v_mfma_f32_16x16x32_bf16 v[36:39],a[132:135],v[64:67],v[36:39]
s_waitcnt lgkmcnt(5)
v_mfma_f32_16x16x32_bf16 v[32:35],a[136:139],v[68:71],v[32:35]
ds_read_b128 v[92:95],v6 offset:7168
v_mfma_f32_16x16x32_bf16 v[36:39],a[140:143],v[68:71],v[36:39]
s_waitcnt lgkmcnt(5)
v_mfma_f32_16x16x32_bf16 v[32:35],a[144:147],v[72:75],v[32:35]
ds_read_b128 v[96:99],v7 offset:0
v_mfma_f32_16x16x32_bf16 v[36:39],a[148:151],v[72:75],v[36:39]
s_waitcnt lgkmcnt(5)
v_mfma_f32_16x16x32_bf16 v[32:35],a[152:155],v[76:79],v[32:35]
ds_read_b128 v[100:103],v7 offset:1024
v_mfma_f32_16x16x32_bf16 v[36:39],a[156:159],v[76:79],v[36:39]
s_waitcnt lgkmcnt(5)
v_mfma_f32_16x16x32_bf16 v[32:35],a[160:163],v[80:83],v[32:35]
ds_read_b128 v[104:107],v7 offset:2048
v_mfma_f32_16x16x32_bf16 v[36:39],a[164:167],v[80:83],v[36:39]
s_waitcnt lgkmcnt(5)
v_mfma_f32_16x16x32_bf16 v[32:35],a[168:171],v[84:87],v[32:35]
ds_read_b128 v[108:111],v7 offset:3072
v_mfma_f32_16x16x32_bf16 v[36:39],a[172:175],v[84:87],v[36:39]
s_waitcnt vmcnt(0)
v_mov_b32 v17,s60
s_mov_b64 exec,1
buffer_store_dword v17,off,s[20:23],s69 sc1
s_mov_b64 exec,-1
v_cmp_gt_u32 vcc,s71,v16
s_cbranch_vccnz vN_143
s_waitcnt lgkmcnt(5)
v_mfma_f32_16x16x32_bf16 v[32:35],a[176:179],v[88:91],v[32:35]
ds_read_b128 v[112:115],v7 offset:4096
s_add_u32 m0,s70,s63
v_mfma_f32_16x16x32_bf16 v[36:39],a[180:183],v[88:91],v[36:39]
s_add_u32 s62,s61,4096
s_waitcnt lgkmcnt(5)
v_mfma_f32_16x16x32_bf16 v[32:35],a[184:187],v[92:95],v[32:35]
ds_read_b128 v[116:119],v7 offset:5120
buffer_load_dwordx4 v3,s[20:23],s61 offen offset:0 lds
v_mfma_f32_16x16x32_bf16 v[36:39],a[188:191],v[92:95],v[36:39]
buffer_load_dwordx4 v3,s[20:23],s61 offen offset:1024 lds
s_waitcnt lgkmcnt(5)
v_mfma_f32_16x16x32_bf16 v[32:35],a[192:195],v[96:99],v[32:35]
ds_read_b128 v[120:123],v7 offset:6144
buffer_load_dwordx4 v3,s[20:23],s61 offen offset:2048 lds
v_mfma_f32_16x16x32_bf16 v[36:39],a[196:199],v[96:99],v[36:39]
buffer_load_dwordx4 v3,s[20:23],s61 offen offset:3072 lds
s_waitcnt lgkmcnt(5)
v_mfma_f32_16x16x32_bf16 v[32:35],a[200:203],v[100:103],v[32:35]
ds_read_b128 v[124:127],v7 offset:7168
s_add_u32 m0,m0,4096
v_mfma_f32_16x16x32_bf16 v[36:39],a[204:207],v[100:103],v[36:39]
buffer_load_dwordx4 v3,s[20:23],s62 offen offset:0 lds
s_waitcnt lgkmcnt(5)
v_mfma_f32_16x16x32_bf16 v[32:35],a[208:211],v[104:107],v[32:35]
buffer_load_dwordx4 v3,s[20:23],s62 offen offset:1024 lds
v_mfma_f32_16x16x32_bf16 v[36:39],a[212:215],v[104:107],v[36:39]
buffer_load_dwordx4 v3,s[20:23],s62 offen offset:2048 lds
s_waitcnt lgkmcnt(4)
v_mfma_f32_16x16x32_bf16 v[32:35],a[216:219],v[108:111],v[32:35]
buffer_load_dwordx4 v3,s[20:23],s62 offen offset:3072 lds
v_mfma_f32_16x16x32_bf16 v[36:39],a[220:223],v[108:111],v[36:39]
s_add_u32 s61,s61,32768
s_waitcnt lgkmcnt(3)
v_mfma_f32_16x16x32_bf16 v[32:35],a[224:227],v[112:115],v[32:35]
s_add_u32 s70,s70,32768
v_mfma_f32_16x16x32_bf16 v[36:39],a[228:231],v[112:115],v[36:39]
s_and_b32 s70,s70,0x1ffff
s_waitcnt lgkmcnt(2)
v_mfma_f32_16x16x32_bf16 v[32:35],a[232:235],v[116:119],v[32:35]
v_mfma_f32_16x16x32_bf16 v[36:39],a[236:239],v[116:119],v[36:39]
s_waitcnt lgkmcnt(1)
v_mfma_f32_16x16x32_bf16 v[32:35],a[240:243],v[120:123],v[32:35]
v_mfma_f32_16x16x32_bf16 v[36:39],a[244:247],v[120:123],v[36:39]
s_waitcnt lgkmcnt(0)
v_mfma_f32_16x16x32_bf16 v[32:35],a[248:251],v[124:127],v[32:35]
v_mfma_f32_16x16x32_bf16 v[36:39],a[252:255],v[124:127],v[36:39]
s_mov_b32 s72,1
join_144:
v_lshlrev_b32 v168,16,v160
v_and_b32 v169,s73,v160
v_lshlrev_b32 v170,16,v161
v_and_b32 v171,s73,v161
v_lshlrev_b32 v172,16,v162
v_and_b32 v173,s73,v162
v_lshlrev_b32 v174,16,v163
v_and_b32 v175,s73,v163
v_add_f32 v32,v32,v168
v_add_f32 v33,v33,v169
v_add_f32 v34,v34,v170
v_add_f32 v35,v35,v171
v_add_f32 v36,v36,v172
v_add_f32 v37,v37,v173
v_add_f32 v38,v38,v174
v_add_f32 v39,v39,v175
v_cvt_pk_bf16_f32 v176,v32,v33
v_cvt_pk_bf16_f32 v177,v34,v35
v_cvt_pk_bf16_f32 v178,v36,v37
v_cvt_pk_bf16_f32 v179,v38,v39
s_add_u32 s64,s66,214958080
buffer_store_dwordx4 v[176:179],v0,s[20:23],s64 offen sc1
s_add_u32 s66,s66,32768
s_add_u32 s60,s60,1
s_cmp_eq_u32 s72,0
s_cbranch_scc1 slowp_145
s_branch top_142
slowp_145:
s_waitcnt vmcnt(1)
v_cmp_gt_u32 vcc,s71,v16
s_cbranch_vccz lag_146
s_waitcnt vmcnt(0)
v_mov_b32 v17,s60
s_mov_b64 exec,1
buffer_store_dword v17,off,s[20:23],s69 sc1
s_mov_b64 exec,-1
s_cmp_ge_u32 s60,128
s_cbranch_scc1 done_136
plp_149:
buffer_load_dword v16,v2,s[20:23],s68 offen sc1
s_waitcnt vmcnt(0)
v_cmp_gt_u32 vcc,s71,v16
s_cbranch_vccz pok_150
s_sleep 4
s_sub_u32 s90,s90,1
s_cmp_gt_i32 s90,0
s_cbranch_scc1 plp_149
pok_150:
s_branch lag_146
vN_143:
buffer_load_dword v16,v2,s[20:23],s68 offen sc1
s_waitcnt lgkmcnt(5)
v_mfma_f32_16x16x32_bf16 v[32:35],a[176:179],v[88:91],v[32:35]
ds_read_b128 v[112:115],v7 offset:4096
v_mfma_f32_16x16x32_bf16 v[36:39],a[180:183],v[88:91],v[36:39]
s_waitcnt lgkmcnt(5)
v_mfma_f32_16x16x32_bf16 v[32:35],a[184:187],v[92:95],v[32:35]
ds_read_b128 v[116:119],v7 offset:5120
v_mfma_f32_16x16x32_bf16 v[36:39],a[188:191],v[92:95],v[36:39]
s_waitcnt lgkmcnt(5)
v_mfma_f32_16x16x32_bf16 v[32:35],a[192:195],v[96:99],v[32:35]
ds_read_b128 v[120:123],v7 offset:6144
v_mfma_f32_16x16x32_bf16 v[36:39],a[196:199],v[96:99],v[36:39]
s_waitcnt lgkmcnt(5)
v_mfma_f32_16x16x32_bf16 v[32:35],a[200:203],v[100:103],v[32:35]
ds_read_b128 v[124:127],v7 offset:7168
v_mfma_f32_16x16x32_bf16 v[36:39],a[204:207],v[100:103],v[36:39]
s_waitcnt lgkmcnt(5)
v_mfma_f32_16x16x32_bf16 v[32:35],a[208:211],v[104:107],v[32:35]
v_mfma_f32_16x16x32_bf16 v[36:39],a[212:215],v[104:107],v[36:39]
s_waitcnt lgkmcnt(4)
v_mfma_f32_16x16x32_bf16 v[32:35],a[216:219],v[108:111],v[32:35]
v_mfma_f32_16x16x32_bf16 v[36:39],a[220:223],v[108:111],v[36:39]
s_waitcnt lgkmcnt(3)
v_mfma_f32_16x16x32_bf16 v[32:35],a[224:227],v[112:115],v[32:35]
v_mfma_f32_16x16x32_bf16 v[36:39],a[228:231],v[112:115],v[36:39]
s_waitcnt lgkmcnt(2)
v_mfma_f32_16x16x32_bf16 v[32:35],a[232:235],v[116:119],v[32:35]
v_mfma_f32_16x16x32_bf16 v[36:39],a[236:239],v[116:119],v[36:39]
s_waitcnt lgkmcnt(1)
v_mfma_f32_16x16x32_bf16 v[32:35],a[240:243],v[120:123],v[32:35]
v_mfma_f32_16x16x32_bf16 v[36:39],a[244:247],v[120:123],v[36:39]
s_waitcnt lgkmcnt(0)
v_mfma_f32_16x16x32_bf16 v[32:35],a[248:251],v[124:127],v[32:35]
v_mfma_f32_16x16x32_bf16 v[36:39],a[252:255],v[124:127],v[36:39]
s_mov_b32 s72,0
s_branch join_144
done_136:
s_endpgm
fl_ln2:
s_mov_b32 s52,s59
s_mov_b32 s60,0
s_mov_b32 s73,0xffff0000
v_and_b32 v2,3,v1
v_lshrrev_b32 v3,2,v1
s_lshl_b32 s64,s52,2
v_add_u32 v4,s64,v2
s_lshl_b32 s65,s50,9
v_lshlrev_b32 v5,4,v3
v_add_u32 v5,s65,v5
v_lshl_add_u32 v8,v4,11,v5
v_lshlrev_b32 v9,1,v5
v_lshrrev_b32 v5,2,v3
v_and_b32 v3,3,v3
s_lshl_b32 s65,s50,13
v_lshlrev_b32 v5,10,v5
v_lshl_add_u32 v5,v3,8,v5
v_lshl_add_u32 v5,v4,4,v5
v_add_u32 v10,s65,v5
s_lshl_b32 s65,s50,9
v_lshlrev_b32 v5,3,v1
v_add_u32 v11,s65,v5
v_lshlrev_b32 v12,3,v2
v_and_b32 v13,7,v1
v_lshlrev_b32 v13,2,v13
s_mov_b32 s65,267403264
buffer_load_dwordx4 v[32:35],v9,s[20:23],s65 offen offset:0
buffer_load_dwordx4 v[36:39],v9,s[20:23],s65 offen offset:16
buffer_load_dwordx4 v[40:43],v9,s[20:23],s65 offen offset:512
buffer_load_dwordx4 v[44:47],v9,s[20:23],s65 offen offset:528
s_mov_b32 s66,267399168
buffer_load_dwordx4 v[48:51],v9,s[20:23],s66 offen offset:0
buffer_load_dwordx4 v[52:55],v9,s[20:23],s66 offen offset:16
buffer_load_dwordx4 v[56:59],v9,s[20:23],s66 offen offset:512
buffer_load_dwordx4 v[60:63],v9,s[20:23],s66 offen offset:528
s_waitcnt vmcnt(0)
v_add_f32 v32,1.0,v32
v_add_f32 v33,1.0,v33
v_add_f32 v34,1.0,v34
v_add_f32 v35,1.0,v35
v_add_f32 v36,1.0,v36
v_add_f32 v37,1.0,v37
v_add_f32 v38,1.0,v38
v_add_f32 v39,1.0,v39
v_add_f32 v40,1.0,v40
v_add_f32 v41,1.0,v41
v_add_f32 v42,1.0,v42
v_add_f32 v43,1.0,v43
v_add_f32 v44,1.0,v44
v_add_f32 v45,1.0,v45
v_add_f32 v46,1.0,v46
v_add_f32 v47,1.0,v47
s_add_u32 s65,s59,s50
s_cmp_lg_u32 s65,0
s_cbranch_scc1 nomeas_152
s_mov_b64 exec,1
s_mov_b32 s92,138526720
s_mov_b32 s93,138534912
s_mov_b32 s70,0x7fffffff
s_mov_b32 s71,0x7fffffff
s_memtime s[94:95]
s_waitcnt lgkmcnt(0)
buffer_store_dword v15,off,s[20:23],s92 sc1
s_waitcnt vmcnt(0)
s_memtime s[96:97]
s_waitcnt lgkmcnt(0)
s_sub_u32 s96,s96,s94
s_min_u32 s70,s70,s96
s_memtime s[94:95]
s_waitcnt lgkmcnt(0)
buffer_store_dword v15,off,s[20:23],s93 sc1
s_waitcnt vmcnt(0)
s_memtime s[96:97]
s_waitcnt lgkmcnt(0)
s_sub_u32 s96,s96,s94
s_min_u32 s71,s71,s96
s_memtime s[94:95]
s_waitcnt lgkmcnt(0)
buffer_store_dword v15,off,s[20:23],s92 sc1
s_waitcnt vmcnt(0)
s_memtime s[96:97]
s_waitcnt lgkmcnt(0)
s_sub_u32 s96,s96,s94
s_min_u32 s70,s70,s96
s_memtime s[94:95]
s_waitcnt lgkmcnt(0)
buffer_store_dword v15,off,s[20:23],s93 sc1
s_waitcnt vmcnt(0)
s_memtime s[96:97]
s_waitcnt lgkmcnt(0)
s_sub_u32 s96,s96,s94
s_min_u32 s71,s71,s96
s_memtime s[94:95]
s_waitcnt lgkmcnt(0)
buffer_store_dword v15,off,s[20:23],s92 sc1
s_waitcnt vmcnt(0)
s_memtime s[96:97]
s_waitcnt lgkmcnt(0)
s_sub_u32 s96,s96,s94
s_min_u32 s70,s70,s96
s_memtime s[94:95]
s_waitcnt lgkmcnt(0)
buffer_store_dword v15,off,s[20:23],s93 sc1
s_waitcnt vmcnt(0)
s_memtime s[96:97]
s_waitcnt lgkmcnt(0)
s_sub_u32 s96,s96,s94
s_min_u32 s71,s71,s96
s_memtime s[94:95]
s_waitcnt lgkmcnt(0)
buffer_store_dword v15,off,s[20:23],s92 sc1
s_waitcnt vmcnt(0)
s_memtime s[96:97]
s_waitcnt lgkmcnt(0)
s_sub_u32 s96,s96,s94
s_min_u32 s70,s70,s96
s_memtime s[94:95]
s_waitcnt lgkmcnt(0)
buffer_store_dword v15,off,s[20:23],s93 sc1
s_waitcnt vmcnt(0)
s_memtime s[96:97]
s_waitcnt lgkmcnt(0)
s_sub_u32 s96,s96,s94
s_min_u32 s71,s71,s96
s_memtime s[94:95]
s_waitcnt lgkmcnt(0)
buffer_store_dword v15,off,s[20:23],s92 sc1
s_waitcnt vmcnt(0)
s_memtime s[96:97]
s_waitcnt lgkmcnt(0)
s_sub_u32 s96,s96,s94
s_min_u32 s70,s70,s96
s_memtime s[94:95]
s_waitcnt lgkmcnt(0)
buffer_store_dword v15,off,s[20:23],s93 sc1
s_waitcnt vmcnt(0)
s_memtime s[96:97]
s_waitcnt lgkmcnt(0)
s_sub_u32 s96,s96,s94
s_min_u32 s71,s71,s96
s_cmp_gt_u32 s71,s70
s_cselect_b32 s65,2,1
v_mov_b32 v15,s65
s_mov_b32 s64,138510336
buffer_store_dword v15,off,s[20:23],s64 offset:1024 sc1
s_mov_b64 exec,-1
nomeas_152:
s_mov_b32 s67,0
s_cmp_eq_u32 s56,1
s_cbranch_scc1 vok_153
v_mbcnt_lo_u32_b32 v16,-1,0
v_and_b32 v16,7,v16
v_lshlrev_b32 v16,7,v16
s_mov_b32 s64,138510336
vpoll_154:
buffer_load_dword v17,v16,s[20:23],s64 offen sc1
s_waitcnt vmcnt(0)
v_readlane_b32 s92,v17,0
v_readlane_b32 s93,v17,1
v_readlane_b32 s94,v17,2
v_readlane_b32 s95,v17,3
v_readlane_b32 s96,v17,4
v_readlane_b32 s97,v17,5
v_readlane_b32 s98,v17,6
v_readlane_b32 s99,v17,7
s_add_u32 s65,s92,s93
s_add_u32 s65,s65,s94
s_add_u32 s65,s65,s95
s_add_u32 s65,s65,s96
s_add_u32 s65,s65,s97
s_add_u32 s65,s65,s98
s_add_u32 s65,s65,s99
s_cmp_ge_u32 s65,256
s_cbranch_scc1 vgot_155
s_sleep 4
s_sub_u32 s90,s90,1
s_cmp_gt_i32 s90,0
s_cbranch_scc1 vpoll_154
vgot_155:
s_min_u32 s65,s92,s93
s_min_u32 s65,s65,s94
s_min_u32 s65,s65,s95
s_min_u32 s65,s65,s96
s_min_u32 s65,s65,s97
s_min_u32 s65,s65,s98
s_min_u32 s65,s65,s99
s_cmp_lt_u32 s65,32
s_cbranch_scc1 fl_slow
s_mov_b32 s56,0
vok_153:
s_mov_b32 s63,201326592
s_mov_b32 s66,205520896
s_lshl_b32 s64,s50,8
s_add_u32 s68,s64,138547200
s_lshl_b32 s65,s59,2
s_add_u32 s69,s64,s65
s_add_u32 s69,s69,138548224
s_mov_b32 s71,1
plp_160:
buffer_load_dword v14,v13,s[20:23],s68 offen sc1
s_waitcnt vmcnt(0)
v_cmp_gt_u32 vcc,s71,v14
s_cbranch_vccz pok_161
s_sleep 4
s_sub_u32 s90,s90,1
s_cmp_gt_i32 s90,0
s_cbranch_scc1 plp_160
pok_161:
s_add_u32 s64,s63,4096
buffer_load_dwordx4 v[64:67],v10,s[20:23],s63 offen
buffer_load_dwordx4 v[68:71],v10,s[20:23],s64 offen
s_add_u32 s63,s63,32768
buffer_load_dword v15,off,s[20:23],s68
buffer_load_dword v15,off,s[20:23],s68
top0_158:
buffer_load_dword v14,v13,s[20:23],s68 offen sc1
s_add_u32 s71,s60,2
s_waitcnt vmcnt(3)
v_lshlrev_b32 v80,16,v64
v_and_b32 v81,s73,v64
v_lshlrev_b32 v82,16,v65
v_and_b32 v83,s73,v65
v_lshlrev_b32 v84,16,v66
v_and_b32 v85,s73,v66
v_lshlrev_b32 v86,16,v67
v_and_b32 v87,s73,v67
v_lshlrev_b32 v88,16,v68
v_and_b32 v89,s73,v68
v_lshlrev_b32 v90,16,v69
v_and_b32 v91,s73,v69
v_lshlrev_b32 v92,16,v70
v_and_b32 v93,s73,v70
v_lshlrev_b32 v94,16,v71
v_and_b32 v95,s73,v71
v_add_f32 v96,v80,v81
v_mul_f32 v97,v80,v80
v_add_f32 v98,v82,v83
v_mul_f32 v99,v81,v81
v_fmac_f32 v97,v82,v82
v_fmac_f32 v99,v83,v83
v_add_f32 v96,v96,v84
v_fmac_f32 v97,v84,v84
v_add_f32 v98,v98,v85
v_fmac_f32 v99,v85,v85
v_add_f32 v96,v96,v86
v_fmac_f32 v97,v86,v86
v_add_f32 v98,v98,v87
v_fmac_f32 v99,v87,v87
v_add_f32 v96,v96,v88
v_fmac_f32 v97,v88,v88
v_add_f32 v98,v98,v89
v_fmac_f32 v99,v89,v89
v_add_f32 v96,v96,v90
v_fmac_f32 v97,v90,v90
v_add_f32 v98,v98,v91
v_fmac_f32 v99,v91,v91
v_add_f32 v96,v96,v92
v_fmac_f32 v97,v92,v92
v_add_f32 v98,v98,v93
v_fmac_f32 v99,v93,v93
v_add_f32 v96,v96,v94
v_fmac_f32 v97,v94,v94
v_add_f32 v98,v98,v95
v_fmac_f32 v99,v95,v95
v_add_f32 v96,v96,v98
v_add_f32 v97,v97,v99
s_nop 0
v_add_f32_dpp v96,v96,v96 row_ror:4 row_mask:0xf bank_mask:0xf
v_add_f32_dpp v97,v97,v97 row_ror:4 row_mask:0xf bank_mask:0xf
s_nop 0
v_add_f32_dpp v96,v96,v96 row_ror:8 row_mask:0xf bank_mask:0xf
v_add_f32_dpp v97,v97,v97 row_ror:8 row_mask:0xf bank_mask:0xf
v_mov_b32 v98,v96
v_mov_b32 v99,v97
s_nop 0
v_permlane16_swap_b32 v98,v96
v_permlane16_swap_b32 v99,v97
v_add_f32 v96,v96,v98
v_add_f32 v97,v97,v99
v_mov_b32 v98,v96
v_mov_b32 v99,v97
s_nop 0
v_permlane32_swap_b32 v98,v96
v_permlane32_swap_b32 v99,v97
v_add_f32 v96,v96,v98
v_add_f32 v97,v97,v99
ds_write_b64 v11,v[96:97] offset:0
s_waitcnt lgkmcnt(0)
s_barrier
s_waitcnt vmcnt(0)
v_mov_b32 v15,s60
s_mov_b64 exec,1
buffer_store_dword v15,off,s[20:23],s69 sc1
s_mov_b64 exec,-1
v_cmp_gt_u32 vcc,s71,v14
s_mov_b32 s72,0
s_cbranch_vccnz p2_163
s_mov_b32 s72,1
s_add_u32 s64,s63,4096
buffer_load_dwordx4 v[72:75],v10,s[20:23],s63 offen
buffer_load_dwordx4 v[76:79],v10,s[20:23],s64 offen
s_add_u32 s63,s63,32768
p2_163:
ds_read_b64 v[100:101],v12 offset:0
ds_read_b64 v[102:103],v12 offset:512
ds_read_b64 v[104:105],v12 offset:1024
ds_read_b64 v[106:107],v12 offset:1536
s_waitcnt lgkmcnt(0)
v_add_f32 v100,v100,v102
v_add_f32 v101,v101,v103
v_add_f32 v104,v104,v106
v_add_f32 v105,v105,v107
v_add_f32 v100,v100,v104
v_add_f32 v101,v101,v105
v_mul_f32 v96,0xba800000,v100
v_mul_f32 v102,v96,v96
v_mul_f32 v101,0x3a800000,v101
v_sub_f32 v101,v101,v102
v_max_f32 v101,0,v101
v_add_f32 v101,0x3727c5ac,v101
v_rsq_f32 v97,v101
s_nop 0
v_mul_f32 v96,v96,v97
v_fma_f32 v80,v80,v97,v96
v_fma_f32 v81,v81,v97,v96
v_fma_f32 v82,v82,v97,v96
v_fma_f32 v83,v83,v97,v96
v_fma_f32 v84,v84,v97,v96
v_fma_f32 v85,v85,v97,v96
v_fma_f32 v86,v86,v97,v96
v_fma_f32 v87,v87,v97,v96
v_fma_f32 v88,v88,v97,v96
v_fma_f32 v89,v89,v97,v96
v_fma_f32 v90,v90,v97,v96
v_fma_f32 v91,v91,v97,v96
v_fma_f32 v92,v92,v97,v96
v_fma_f32 v93,v93,v97,v96
v_fma_f32 v94,v94,v97,v96
v_fma_f32 v95,v95,v97,v96
v_fma_f32 v80,v80,v32,v48
v_fma_f32 v81,v81,v33,v49
v_fma_f32 v82,v82,v34,v50
v_fma_f32 v83,v83,v35,v51
v_fma_f32 v84,v84,v36,v52
v_fma_f32 v85,v85,v37,v53
v_fma_f32 v86,v86,v38,v54
v_fma_f32 v87,v87,v39,v55
v_fma_f32 v88,v88,v40,v56
v_fma_f32 v89,v89,v41,v57
v_fma_f32 v90,v90,v42,v58
v_fma_f32 v91,v91,v43,v59
v_fma_f32 v92,v92,v44,v60
v_fma_f32 v93,v93,v45,v61
v_fma_f32 v94,v94,v46,v62
v_fma_f32 v95,v95,v47,v63
v_cvt_pk_bf16_f32 v112,v80,v81
v_cvt_pk_bf16_f32 v113,v82,v83
v_cvt_pk_bf16_f32 v114,v84,v85
v_cvt_pk_bf16_f32 v115,v86,v87
v_cvt_pk_bf16_f32 v116,v88,v89
v_cvt_pk_bf16_f32 v117,v90,v91
v_cvt_pk_bf16_f32 v118,v92,v93
v_cvt_pk_bf16_f32 v119,v94,v95
s_add_u32 s64,s66,4096
buffer_store_dwordx4 v[112:115],v10,s[20:23],s66 offen sc1
buffer_store_dwordx4 v[116:119],v10,s[20:23],s64 offen sc1
s_add_u32 s66,s66,32768
s_add_u32 s60,s60,1
s_cmp_eq_u32 s72,0
s_cbranch_scc1 slowp_162
top1_159:
buffer_load_dword v14,v13,s[20:23],s68 offen sc1
s_add_u32 s71,s60,2
s_waitcnt vmcnt(3)
v_lshlrev_b32 v80,16,v72
v_and_b32 v81,s73,v72
v_lshlrev_b32 v82,16,v73
v_and_b32 v83,s73,v73
v_lshlrev_b32 v84,16,v74
v_and_b32 v85,s73,v74
v_lshlrev_b32 v86,16,v75
v_and_b32 v87,s73,v75
v_lshlrev_b32 v88,16,v76
v_and_b32 v89,s73,v76
v_lshlrev_b32 v90,16,v77
v_and_b32 v91,s73,v77
v_lshlrev_b32 v92,16,v78
v_and_b32 v93,s73,v78
v_lshlrev_b32 v94,16,v79
v_and_b32 v95,s73,v79
v_add_f32 v96,v80,v81
v_mul_f32 v97,v80,v80
v_add_f32 v98,v82,v83
v_mul_f32 v99,v81,v81
v_fmac_f32 v97,v82,v82
v_fmac_f32 v99,v83,v83
v_add_f32 v96,v96,v84
v_fmac_f32 v97,v84,v84
v_add_f32 v98,v98,v85
v_fmac_f32 v99,v85,v85
v_add_f32 v96,v96,v86
v_fmac_f32 v97,v86,v86
v_add_f32 v98,v98,v87
v_fmac_f32 v99,v87,v87
v_add_f32 v96,v96,v88
v_fmac_f32 v97,v88,v88
v_add_f32 v98,v98,v89
v_fmac_f32 v99,v89,v89
v_add_f32 v96,v96,v90
v_fmac_f32 v97,v90,v90
v_add_f32 v98,v98,v91
v_fmac_f32 v99,v91,v91
v_add_f32 v96,v96,v92
v_fmac_f32 v97,v92,v92
v_add_f32 v98,v98,v93
v_fmac_f32 v99,v93,v93
v_add_f32 v96,v96,v94
v_fmac_f32 v97,v94,v94
v_add_f32 v98,v98,v95
v_fmac_f32 v99,v95,v95
v_add_f32 v96,v96,v98
v_add_f32 v97,v97,v99
s_nop 0
v_add_f32_dpp v96,v96,v96 row_ror:4 row_mask:0xf bank_mask:0xf
v_add_f32_dpp v97,v97,v97 row_ror:4 row_mask:0xf bank_mask:0xf
s_nop 0
v_add_f32_dpp v96,v96,v96 row_ror:8 row_mask:0xf bank_mask:0xf
v_add_f32_dpp v97,v97,v97 row_ror:8 row_mask:0xf bank_mask:0xf
v_mov_b32 v98,v96
v_mov_b32 v99,v97
s_nop 0
v_permlane16_swap_b32 v98,v96
v_permlane16_swap_b32 v99,v97
v_add_f32 v96,v96,v98
v_add_f32 v97,v97,v99
v_mov_b32 v98,v96
v_mov_b32 v99,v97
s_nop 0
v_permlane32_swap_b32 v98,v96
v_permlane32_swap_b32 v99,v97
v_add_f32 v96,v96,v98
v_add_f32 v97,v97,v99
ds_write_b64 v11,v[96:97] offset:2048
s_waitcnt lgkmcnt(0)
s_barrier
s_waitcnt vmcnt(0)
v_mov_b32 v15,s60
s_mov_b64 exec,1
buffer_store_dword v15,off,s[20:23],s69 sc1
s_mov_b64 exec,-1
v_cmp_gt_u32 vcc,s71,v14
s_mov_b32 s72,0
s_cbranch_vccnz p2_165
s_mov_b32 s72,1
s_add_u32 s64,s63,4096
buffer_load_dwordx4 v[64:67],v10,s[20:23],s63 offen
buffer_load_dwordx4 v[68:71],v10,s[20:23],s64 offen
s_add_u32 s63,s63,32768
p2_165:
ds_read_b64 v[100:101],v12 offset:2048
ds_read_b64 v[102:103],v12 offset:2560
ds_read_b64 v[104:105],v12 offset:3072
ds_read_b64 v[106:107],v12 offset:3584
s_waitcnt lgkmcnt(0)
v_add_f32 v100,v100,v102
v_add_f32 v101,v101,v103
v_add_f32 v104,v104,v106
v_add_f32 v105,v105,v107
v_add_f32 v100,v100,v104
v_add_f32 v101,v101,v105
v_mul_f32 v96,0xba800000,v100
v_mul_f32 v102,v96,v96
v_mul_f32 v101,0x3a800000,v101
v_sub_f32 v101,v101,v102
v_max_f32 v101,0,v101
v_add_f32 v101,0x3727c5ac,v101
v_rsq_f32 v97,v101
s_nop 0
v_mul_f32 v96,v96,v97
v_fma_f32 v80,v80,v97,v96
v_fma_f32 v81,v81,v97,v96
v_fma_f32 v82,v82,v97,v96
v_fma_f32 v83,v83,v97,v96
v_fma_f32 v84,v84,v97,v96
v_fma_f32 v85,v85,v97,v96
v_fma_f32 v86,v86,v97,v96
v_fma_f32 v87,v87,v97,v96
v_fma_f32 v88,v88,v97,v96
v_fma_f32 v89,v89,v97,v96
v_fma_f32 v90,v90,v97,v96
v_fma_f32 v91,v91,v97,v96
v_fma_f32 v92,v92,v97,v96
v_fma_f32 v93,v93,v97,v96
v_fma_f32 v94,v94,v97,v96
v_fma_f32 v95,v95,v97,v96
v_fma_f32 v80,v80,v32,v48
v_fma_f32 v81,v81,v33,v49
v_fma_f32 v82,v82,v34,v50
v_fma_f32 v83,v83,v35,v51
v_fma_f32 v84,v84,v36,v52
v_fma_f32 v85,v85,v37,v53
v_fma_f32 v86,v86,v38,v54
v_fma_f32 v87,v87,v39,v55
v_fma_f32 v88,v88,v40,v56
v_fma_f32 v89,v89,v41,v57
v_fma_f32 v90,v90,v42,v58
v_fma_f32 v91,v91,v43,v59
v_fma_f32 v92,v92,v44,v60
v_fma_f32 v93,v93,v45,v61
v_fma_f32 v94,v94,v46,v62
v_fma_f32 v95,v95,v47,v63
v_cvt_pk_bf16_f32 v112,v80,v81
v_cvt_pk_bf16_f32 v113,v82,v83
v_cvt_pk_bf16_f32 v114,v84,v85
v_cvt_pk_bf16_f32 v115,v86,v87
v_cvt_pk_bf16_f32 v116,v88,v89
v_cvt_pk_bf16_f32 v117,v90,v91
v_cvt_pk_bf16_f32 v118,v92,v93
v_cvt_pk_bf16_f32 v119,v94,v95
s_add_u32 s64,s66,4096
buffer_store_dwordx4 v[112:115],v10,s[20:23],s66 offen sc1
buffer_store_dwordx4 v[116:119],v10,s[20:23],s64 offen sc1
s_add_u32 s66,s66,32768
s_add_u32 s60,s60,1
s_cmp_eq_u32 s72,0
s_cbranch_scc1 slowp_164
s_branch top0_158
slowp_162:
buffer_load_dword v14,v13,s[20:23],s68 offen sc1
s_waitcnt vmcnt(1)
v_mov_b32 v15,s60
s_mov_b64 exec,1
buffer_store_dword v15,off,s[20:23],s69 sc1
s_mov_b64 exec,-1
s_cmp_ge_u32 s60,128
s_cbranch_scc1 done_151
s_waitcnt vmcnt(1)
v_cmp_gt_u32 vcc,s71,v14
s_cbranch_vccz go_166
plp_167:
buffer_load_dword v14,v13,s[20:23],s68 offen sc1
s_waitcnt vmcnt(0)
v_cmp_gt_u32 vcc,s71,v14
s_cbranch_vccz pok_168
s_sleep 4
s_sub_u32 s90,s90,1
s_cmp_gt_i32 s90,0
s_cbranch_scc1 plp_167
pok_168:
go_166:
s_add_u32 s64,s63,4096
buffer_load_dwordx4 v[72:75],v10,s[20:23],s63 offen
buffer_load_dwordx4 v[76:79],v10,s[20:23],s64 offen
s_add_u32 s63,s63,32768
buffer_load_dword v15,off,s[20:23],s68
buffer_load_dword v15,off,s[20:23],s68
s_branch top1_159
slowp_164:
buffer_load_dword v14,v13,s[20:23],s68 offen sc1
s_waitcnt vmcnt(1)
v_mov_b32 v15,s60
s_mov_b64 exec,1
buffer_store_dword v15,off,s[20:23],s69 sc1
s_mov_b64 exec,-1
s_cmp_ge_u32 s60,128
s_cbranch_scc1 done_151
s_waitcnt vmcnt(1)
v_cmp_gt_u32 vcc,s71,v14
s_cbranch_vccz go_169
plp_170:
buffer_load_dword v14,v13,s[20:23],s68 offen sc1
s_waitcnt vmcnt(0)
v_cmp_gt_u32 vcc,s71,v14
s_cbranch_vccz pok_171
s_sleep 4
s_sub_u32 s90,s90,1
s_cmp_gt_i32 s90,0
s_cbranch_scc1 plp_170
pok_171:
go_169:
s_add_u32 s64,s63,4096
buffer_load_dwordx4 v[64:67],v10,s[20:23],s63 offen
buffer_load_dwordx4 v[68:71],v10,s[20:23],s64 offen
s_add_u32 s63,s63,32768
buffer_load_dword v15,off,s[20:23],s68
buffer_load_dword v15,off,s[20:23],s68
s_branch top0_158
done_151:
s_endpgm
fl_att:
s_mov_b32 s67,0
s_cmp_eq_u32 s56,1
s_cbranch_scc1 vok_172
v_mbcnt_lo_u32_b32 v16,-1,0
v_and_b32 v16,7,v16
v_lshlrev_b32 v16,7,v16
s_mov_b32 s64,138510336
vpoll_173:
buffer_load_dword v17,v16,s[20:23],s64 offen sc1
s_waitcnt vmcnt(0)
v_readlane_b32 s92,v17,0
v_readlane_b32 s93,v17,1
v_readlane_b32 s94,v17,2
v_readlane_b32 s95,v17,3
v_readlane_b32 s96,v17,4
v_readlane_b32 s97,v17,5
v_readlane_b32 s98,v17,6
v_readlane_b32 s99,v17,7
s_add_u32 s65,s92,s93
s_add_u32 s65,s65,s94
s_add_u32 s65,s65,s95
s_add_u32 s65,s65,s96
s_add_u32 s65,s65,s97
s_add_u32 s65,s65,s98
s_add_u32 s65,s65,s99
s_cmp_ge_u32 s65,256
s_cbranch_scc1 vgot_174
s_sleep 4
s_sub_u32 s90,s90,1
s_cmp_gt_i32 s90,0
s_cbranch_scc1 vpoll_173
vgot_174:
s_min_u32 s65,s92,s93
s_min_u32 s65,s65,s94
s_min_u32 s65,s65,s95
s_min_u32 s65,s65,s96
s_min_u32 s65,s65,s97
s_min_u32 s65,s65,s98
s_min_u32 s65,s65,s99
s_cmp_lt_u32 s65,32
s_cbranch_scc1 fl_slow
s_mov_b32 s56,0
pp_175:
buffer_load_dword v17,off,s[20:23],s64 offset:1024 sc1
s_waitcnt vmcnt(0)
v_readfirstlane_b32 s65,v17
s_cmp_lg_u32 s65,0
s_cbranch_scc1 pg_176
s_sleep 4
s_sub_u32 s90,s90,1
s_cmp_gt_i32 s90,0
s_cbranch_scc1 pp_175
pg_176:
s_and_b32 s65,s65,2
s_lshl_b32 s67,s65,12
vok_172:
v_lshlrev_b32 v0,4,v1
v_and_b32 v21,15,v1
v_lshrrev_b32 v22,4,v1
v_and_b32 v23,7,v21
v_lshlrev_b32 v23,4,v23
v_lshl_add_u32 v3,v22,8,v23
v_and_b32 v23,31,v1
v_lshlrev_b32 v4,4,v23
v_and_b32 v23,3,v1
v_bfe_u32 v24,v1,2,1
v_lshlrev_b32 v23,14,v23
v_lshl_add_u32 v2,v24,7,v23
v_mov_b32 v7,0xff800000
s_and_b32 s54,s50,1
s_lshl_b32 s64,s54,4
v_lshlrev_b32 v23,2,v22
v_sub_u32 v23,v21,v23
v_add_u32 v23,s64,v23
v_cmp_le_i32 s[28:29],0,v23
v_cmp_le_i32 s[30:31],1,v23
v_cmp_le_i32 s[32:33],2,v23
v_cmp_le_i32 s[34:35],3,v23
v_cmp_le_i32 s[36:37],16,v23
v_cmp_le_i32 s[38:39],17,v23
v_cmp_le_i32 s[40:41],18,v23
v_cmp_le_i32 s[42:43],19,v23
s_mov_b32 s44,-1
s_mov_b32 s45,0
s_mov_b32 s80,0x3e0293ee
s_lshl_b32 s52,s59,1
s_lshr_b32 s64,s50,1
s_add_u32 s52,s52,s64
s_lshl_b32 s53,s52,15
s_lshl_b32 s68,s52,8
s_add_u32 s68,s68,s67
s_add_u32 s68,s68,138428416
s_lshl_b32 s69,s59,8
s_lshl_b32 s64,s64,2
s_add_u32 s69,s69,s64
s_lshl_b32 s64,s54,3
s_add_u32 s69,s69,s64
s_add_u32 s69,s69,138543104
s_lshl_b32 s66,s52,12
s_lshl_b32 s64,s54,17
s_add_u32 s66,s66,s64
s_add_u32 s66,s66,150994944
s_lshl_b32 s55,s54,10
s_xor_b32 s55,s55,0x2000
s_mov_b32 s60,0
s_mov_b32 s71,1
plp_177:
buffer_load_dword v5,v2,s[20:23],s68 offen sc1
s_waitcnt vmcnt(0)
v_cmp_gt_u32 vcc,s71,v5
s_cbranch_vccz pok_178
s_sleep 4
s_sub_u32 s90,s90,1
s_cmp_gt_i32 s90,0
s_cbranch_scc1 plp_177
pok_178:
s_add_u32 s64,s60,0
s_lshl_b32 s65,s64,11
s_and_b32 s65,s65,0x2000
s_xor_b32 s65,s65,s67
s_lshl_b32 s64,s64,19
s_add_u32 s64,s64,s65
s_add_u32 s92,s64,s53
s_add_u32 s93,s92,16384
s_add_u32 s94,s92,4096
s_add_u32 s95,s93,4096
s_xor_b32 s96,s92,s55
s_xor_b32 s97,s93,s55
buffer_load_dwordx4 a[0:3],v0,s[20:23],s96 offen offset:0
buffer_load_dwordx4 a[16:19],v0,s[20:23],s92 offen offset:0
buffer_load_dwordx4 a[32:35],v0,s[20:23],s92 offen offset:1024
buffer_load_dwordx4 a[4:7],v0,s[20:23],s96 offen offset:2048
buffer_load_dwordx4 a[20:23],v0,s[20:23],s92 offen offset:2048
buffer_load_dwordx4 a[36:39],v0,s[20:23],s92 offen offset:3072
buffer_load_dwordx4 a[8:11],v0,s[20:23],s97 offen offset:0
buffer_load_dwordx4 a[24:27],v0,s[20:23],s93 offen offset:0
buffer_load_dwordx4 a[40:43],v0,s[20:23],s93 offen offset:1024
buffer_load_dwordx4 a[12:15],v0,s[20:23],s97 offen offset:2048
buffer_load_dwordx4 a[28:31],v0,s[20:23],s93 offen offset:2048
buffer_load_dwordx4 a[44:47],v0,s[20:23],s93 offen offset:3072
buffer_load_dwordx4 a[48:51],v0,s[20:23],s94 offen offset:0
buffer_load_dwordx4 a[52:55],v0,s[20:23],s94 offen offset:1024
buffer_load_dwordx4 a[56:59],v0,s[20:23],s94 offen offset:2048
buffer_load_dwordx4 a[60:63],v0,s[20:23],s94 offen offset:3072
buffer_load_dwordx4 a[64:67],v0,s[20:23],s95 offen offset:0
buffer_load_dwordx4 a[68:71],v0,s[20:23],s95 offen offset:1024
buffer_load_dwordx4 a[72:75],v0,s[20:23],s95 offen offset:2048
buffer_load_dwordx4 a[76:79],v0,s[20:23],s95 offen offset:3072
s_waitcnt vmcnt(8)
top0_179:
v_mfma_f32_16x16x32_bf16 v[48:51],a[16:19],a[0:3],0
v_mfma_f32_16x16x32_bf16 v[52:55],a[32:35],a[0:3],0
v_mfma_f32_16x16x32_bf16 v[48:51],a[20:23],a[4:7],v[48:51]
v_mfma_f32_16x16x32_bf16 v[52:55],a[36:39],a[4:7],v[52:55]
v_mfma_f32_16x16x32_bf16 v[48:51],a[24:27],a[8:11],v[48:51]
v_mfma_f32_16x16x32_bf16 v[52:55],a[40:43],a[8:11],v[52:55]
v_mfma_f32_16x16x32_bf16 v[48:51],a[28:31],a[12:15],v[48:51]
v_mfma_f32_16x16x32_bf16 v[52:55],a[44:47],a[12:15],v[52:55]
s_nop 6
v_cndmask_b32 v48,v7,v48,s[28:29]
v_cndmask_b32 v49,v7,v49,s[30:31]
v_cndmask_b32 v50,v7,v50,s[32:33]
v_cndmask_b32 v51,v7,v51,s[34:35]
v_cndmask_b32 v52,v7,v52,s[36:37]
v_cndmask_b32 v53,v7,v53,s[38:39]
v_cndmask_b32 v54,v7,v54,s[40:41]
v_cndmask_b32 v55,v7,v55,s[42:43]
v_max3_f32 v72,v48,v49,v50
v_max3_f32 v72,v72,v51,v52
v_max3_f32 v72,v72,v53,v54
v_max_f32 v72,v72,v55
s_add_u32 s64,s60,0
s_lshl_b32 s65,s64,11
s_and_b32 s65,s65,0x2000
s_xor_b32 s65,s65,s67
s_lshl_b32 s64,s64,19
s_add_u32 s64,s64,s65
s_add_u32 s98,s64,s53
s_add_u32 s98,s98,67108864
s_add_u32 s99,s98,16384
s_lshr_b32 s71,s60,1
s_add_u32 s71,s71,1
plp_181:
buffer_load_dword v5,v2,s[20:23],s68 offen sc1
s_waitcnt vmcnt(0)
v_cmp_gt_u32 vcc,s71,v5
s_cbranch_vccz pok_182
s_sleep 4
s_sub_u32 s90,s90,1
s_cmp_gt_i32 s90,0
s_cbranch_scc1 plp_181
pok_182:
buffer_load_dwordx4 v[16:19],v3,s[20:23],s98 offen offset:0
buffer_load_dwordx4 v[20:23],v3,s[20:23],s98 offen offset:128
buffer_load_dwordx4 v[24:27],v3,s[20:23],s99 offen offset:0
buffer_load_dwordx4 v[28:31],v3,s[20:23],s99 offen offset:128
buffer_load_dwordx4 v[32:35],v4,s[20:23],s98 offen offset:1024
buffer_load_dwordx4 v[36:39],v4,s[20:23],s98 offen offset:1536
buffer_load_dwordx4 v[40:43],v4,s[20:23],s99 offen offset:1024
buffer_load_dwordx4 v[44:47],v4,s[20:23],s99 offen offset:1536
s_barrier
s_add_u32 s64,s60,2
s_lshl_b32 s65,s64,11
s_and_b32 s65,s65,0x2000
s_xor_b32 s65,s65,s67
s_lshl_b32 s64,s64,19
s_add_u32 s64,s64,s65
s_add_u32 s92,s64,s53
s_add_u32 s93,s92,16384
s_add_u32 s94,s92,4096
s_add_u32 s95,s93,4096
s_xor_b32 s96,s92,s55
s_xor_b32 s97,s93,s55
buffer_load_dwordx4 a[80:83],v0,s[20:23],s96 offen offset:0
buffer_load_dwordx4 a[96:99],v0,s[20:23],s92 offen offset:0
buffer_load_dwordx4 a[112:115],v0,s[20:23],s92 offen offset:1024
buffer_load_dwordx4 a[84:87],v0,s[20:23],s96 offen offset:2048
buffer_load_dwordx4 a[100:103],v0,s[20:23],s92 offen offset:2048
buffer_load_dwordx4 a[116:119],v0,s[20:23],s92 offen offset:3072
buffer_load_dwordx4 a[88:91],v0,s[20:23],s97 offen offset:0
buffer_load_dwordx4 a[104:107],v0,s[20:23],s93 offen offset:0
buffer_load_dwordx4 a[120:123],v0,s[20:23],s93 offen offset:1024
buffer_load_dwordx4 a[92:95],v0,s[20:23],s97 offen offset:2048
buffer_load_dwordx4 a[108:111],v0,s[20:23],s93 offen offset:2048
buffer_load_dwordx4 a[124:127],v0,s[20:23],s93 offen offset:3072
s_waitcnt vmcnt(16)
v_mfma_f32_16x16x32_bf16 v[56:59],v[16:19],a[0:3],0
v_mfma_f32_16x16x32_bf16 v[56:59],v[20:23],a[4:7],v[56:59]
v_mfma_f32_16x16x32_bf16 v[56:59],v[24:27],a[8:11],v[56:59]
v_mfma_f32_16x16x32_bf16 v[56:59],v[28:31],a[12:15],v[56:59]
s_nop 7
v_cndmask_b32 v56,v7,v56,s[44:45]
v_cndmask_b32 v57,v7,v57,s[44:45]
v_cndmask_b32 v58,v7,v58,s[44:45]
v_cndmask_b32 v59,v7,v59,s[44:45]
v_max3_f32 v72,v72,v56,v57
v_max3_f32 v72,v72,v58,v59
v_mov_b32 v73,v72
s_nop 1
v_permlane16_swap_b32 v73,v72
v_max_f32 v72,v72,v73
v_mov_b32 v73,v72
s_nop 1
v_permlane32_swap_b32 v73,v72
v_max_f32 v72,v72,v73
v_mul_f32 v72,s80,v72
v_fma_f32 v48,v48,s80,-v72
v_fma_f32 v49,v49,s80,-v72
v_fma_f32 v50,v50,s80,-v72
v_fma_f32 v51,v51,s80,-v72
v_fma_f32 v52,v52,s80,-v72
v_fma_f32 v53,v53,s80,-v72
v_fma_f32 v54,v54,s80,-v72
v_fma_f32 v55,v55,s80,-v72
v_fma_f32 v56,v56,s80,-v72
v_fma_f32 v57,v57,s80,-v72
v_fma_f32 v58,v58,s80,-v72
v_fma_f32 v59,v59,s80,-v72
v_exp_f32 v48,v48
v_exp_f32 v49,v49
v_exp_f32 v50,v50
v_exp_f32 v51,v51
v_exp_f32 v52,v52
v_exp_f32 v53,v53
v_exp_f32 v54,v54
v_exp_f32 v55,v55
v_exp_f32 v56,v56
v_exp_f32 v57,v57
v_exp_f32 v58,v58
v_exp_f32 v59,v59
v_add_f32 v74,v48,v49
v_add_f32 v75,v50,v51
v_add_f32 v74,v74,v52
v_add_f32 v75,v75,v53
v_add_f32 v74,v74,v54
v_add_f32 v75,v75,v55
v_add_f32 v74,v74,v56
v_add_f32 v75,v75,v57
v_add_f32 v74,v74,v58
v_add_f32 v75,v75,v59
v_add_f32 v74,v74,v75
v_mov_b32 v73,v74
s_nop 1
v_permlane16_swap_b32 v73,v74
v_add_f32 v74,v74,v73
v_mov_b32 v73,v74
s_nop 1
v_permlane32_swap_b32 v73,v74
v_add_f32 v74,v74,v73
v_rcp_f32 v75,v74
s_nop 0
v_mul_f32 v48,v48,v75
v_mul_f32 v49,v49,v75
v_mul_f32 v50,v50,v75
v_mul_f32 v51,v51,v75
v_mul_f32 v52,v52,v75
v_mul_f32 v53,v53,v75
v_mul_f32 v54,v54,v75
v_mul_f32 v55,v55,v75
v_mul_f32 v56,v56,v75
v_mul_f32 v57,v57,v75
v_mul_f32 v58,v58,v75
v_mul_f32 v59,v59,v75
v_cvt_pk_bf16_f32 v64,v48,v49
v_cvt_pk_bf16_f32 v65,v50,v51
v_cvt_pk_bf16_f32 v66,v52,v53
v_cvt_pk_bf16_f32 v67,v54,v55
v_cvt_pk_bf16_f32 v68,v56,v57
v_cvt_pk_bf16_f32 v69,v58,v59
v_mfma_f32_16x16x32_bf16 v[80:83],a[48:51],v[64:67],0
v_mfma_f32_16x16x32_bf16 v[84:87],a[52:55],v[64:67],0
v_mfma_f32_16x16x32_bf16 v[88:91],a[56:59],v[64:67],0
v_mfma_f32_16x16x32_bf16 v[92:95],a[60:63],v[64:67],0
v_mfma_f32_16x16x32_bf16 v[96:99],a[64:67],v[64:67],0
v_mfma_f32_16x16x32_bf16 v[100:103],a[68:71],v[64:67],0
v_mfma_f32_16x16x32_bf16 v[104:107],a[72:75],v[64:67],0
v_mfma_f32_16x16x32_bf16 v[108:111],a[76:79],v[64:67],0
s_waitcnt vmcnt(12)
v_mfma_f32_16x16x16_bf16 v[80:83],v[32:33],v[68:69],v[80:83]
v_mfma_f32_16x16x16_bf16 v[84:87],v[34:35],v[68:69],v[84:87]
v_mfma_f32_16x16x16_bf16 v[88:91],v[36:37],v[68:69],v[88:91]
v_mfma_f32_16x16x16_bf16 v[92:95],v[38:39],v[68:69],v[92:95]
v_mfma_f32_16x16x16_bf16 v[96:99],v[40:41],v[68:69],v[96:99]
v_mfma_f32_16x16x16_bf16 v[100:103],v[42:43],v[68:69],v[100:103]
v_mfma_f32_16x16x16_bf16 v[104:107],v[44:45],v[68:69],v[104:107]
v_mfma_f32_16x16x16_bf16 v[108:111],v[46:47],v[68:69],v[108:111]
s_nop 0
v_cvt_pk_bf16_f32 v112,v80,v81
v_cvt_pk_bf16_f32 v113,v82,v83
v_cvt_pk_bf16_f32 v114,v84,v85
v_cvt_pk_bf16_f32 v115,v86,v87
buffer_store_dwordx4 v[112:115],v0,s[20:23],s66 offen offset:0 sc1
v_cvt_pk_bf16_f32 v116,v88,v89
v_cvt_pk_bf16_f32 v117,v90,v91
v_cvt_pk_bf16_f32 v118,v92,v93
v_cvt_pk_bf16_f32 v119,v94,v95
buffer_store_dwordx4 v[116:119],v0,s[20:23],s66 offen offset:1024 sc1
v_cvt_pk_bf16_f32 v112,v96,v97
v_cvt_pk_bf16_f32 v113,v98,v99
v_cvt_pk_bf16_f32 v114,v100,v101
v_cvt_pk_bf16_f32 v115,v102,v103
buffer_store_dwordx4 v[112:115],v0,s[20:23],s66 offen offset:2048 sc1
v_cvt_pk_bf16_f32 v116,v104,v105
v_cvt_pk_bf16_f32 v117,v106,v107
v_cvt_pk_bf16_f32 v118,v108,v109
v_cvt_pk_bf16_f32 v119,v110,v111
buffer_store_dwordx4 v[116:119],v0,s[20:23],s66 offen offset:3072 sc1
s_barrier
buffer_load_dwordx4 a[128:131],v0,s[20:23],s94 offen offset:0
buffer_load_dwordx4 a[132:135],v0,s[20:23],s94 offen offset:1024
buffer_load_dwordx4 a[136:139],v0,s[20:23],s94 offen offset:2048
buffer_load_dwordx4 a[140:143],v0,s[20:23],s94 offen offset:3072
buffer_load_dwordx4 a[144:147],v0,s[20:23],s95 offen offset:0
buffer_load_dwordx4 a[148:151],v0,s[20:23],s95 offen offset:1024
buffer_load_dwordx4 a[152:155],v0,s[20:23],s95 offen offset:2048
buffer_load_dwordx4 a[156:159],v0,s[20:23],s95 offen offset:3072
s_add_u32 s66,s66,262144
s_add_u32 s60,s60,2
s_waitcnt vmcnt(8)
v_mov_b32 v6,s71
s_mov_b64 exec,1
buffer_store_dword v6,off,s[20:23],s69 sc1
s_mov_b64 exec,-1
top1_180:
v_mfma_f32_16x16x32_bf16 v[48:51],a[96:99],a[80:83],0
v_mfma_f32_16x16x32_bf16 v[52:55],a[112:115],a[80:83],0
v_mfma_f32_16x16x32_bf16 v[48:51],a[100:103],a[84:87],v[48:51]
v_mfma_f32_16x16x32_bf16 v[52:55],a[116:119],a[84:87],v[52:55]
v_mfma_f32_16x16x32_bf16 v[48:51],a[104:107],a[88:91],v[48:51]
v_mfma_f32_16x16x32_bf16 v[52:55],a[120:123],a[88:91],v[52:55]
v_mfma_f32_16x16x32_bf16 v[48:51],a[108:111],a[92:95],v[48:51]
v_mfma_f32_16x16x32_bf16 v[52:55],a[124:127],a[92:95],v[52:55]
s_nop 6
v_cndmask_b32 v48,v7,v48,s[28:29]
v_cndmask_b32 v49,v7,v49,s[30:31]
v_cndmask_b32 v50,v7,v50,s[32:33]
v_cndmask_b32 v51,v7,v51,s[34:35]
v_cndmask_b32 v52,v7,v52,s[36:37]
v_cndmask_b32 v53,v7,v53,s[38:39]
v_cndmask_b32 v54,v7,v54,s[40:41]
v_cndmask_b32 v55,v7,v55,s[42:43]
v_max3_f32 v72,v48,v49,v50
v_max3_f32 v72,v72,v51,v52
v_max3_f32 v72,v72,v53,v54
v_max_f32 v72,v72,v55
s_add_u32 s64,s60,0
s_lshl_b32 s65,s64,11
s_and_b32 s65,s65,0x2000
s_xor_b32 s65,s65,s67
s_lshl_b32 s64,s64,19
s_add_u32 s64,s64,s65
s_add_u32 s98,s64,s53
s_add_u32 s98,s98,67108864
s_add_u32 s99,s98,16384
s_lshr_b32 s71,s60,1
s_add_u32 s71,s71,1
plp_183:
buffer_load_dword v5,v2,s[20:23],s68 offen sc1
s_waitcnt vmcnt(0)
v_cmp_gt_u32 vcc,s71,v5
s_cbranch_vccz pok_184
s_sleep 4
s_sub_u32 s90,s90,1
s_cmp_gt_i32 s90,0
s_cbranch_scc1 plp_183
pok_184:
buffer_load_dwordx4 v[16:19],v3,s[20:23],s98 offen offset:0
buffer_load_dwordx4 v[20:23],v3,s[20:23],s98 offen offset:128
buffer_load_dwordx4 v[24:27],v3,s[20:23],s99 offen offset:0
buffer_load_dwordx4 v[28:31],v3,s[20:23],s99 offen offset:128
buffer_load_dwordx4 v[32:35],v4,s[20:23],s98 offen offset:1024
buffer_load_dwordx4 v[36:39],v4,s[20:23],s98 offen offset:1536
buffer_load_dwordx4 v[40:43],v4,s[20:23],s99 offen offset:1024
buffer_load_dwordx4 v[44:47],v4,s[20:23],s99 offen offset:1536
s_barrier
s_cmp_lt_u32 s60,126
s_cbranch_scc1 pf_185
s_waitcnt vmcnt(0)
s_branch j1_186
pf_185:
s_add_u32 s64,s60,2
s_lshl_b32 s65,s64,11
s_and_b32 s65,s65,0x2000
s_xor_b32 s65,s65,s67
s_lshl_b32 s64,s64,19
s_add_u32 s64,s64,s65
s_add_u32 s92,s64,s53
s_add_u32 s93,s92,16384
s_add_u32 s94,s92,4096
s_add_u32 s95,s93,4096
s_xor_b32 s96,s92,s55
s_xor_b32 s97,s93,s55
buffer_load_dwordx4 a[0:3],v0,s[20:23],s96 offen offset:0
buffer_load_dwordx4 a[16:19],v0,s[20:23],s92 offen offset:0
buffer_load_dwordx4 a[32:35],v0,s[20:23],s92 offen offset:1024
buffer_load_dwordx4 a[4:7],v0,s[20:23],s96 offen offset:2048
buffer_load_dwordx4 a[20:23],v0,s[20:23],s92 offen offset:2048
buffer_load_dwordx4 a[36:39],v0,s[20:23],s92 offen offset:3072
buffer_load_dwordx4 a[8:11],v0,s[20:23],s97 offen offset:0
buffer_load_dwordx4 a[24:27],v0,s[20:23],s93 offen offset:0
buffer_load_dwordx4 a[40:43],v0,s[20:23],s93 offen offset:1024
buffer_load_dwordx4 a[12:15],v0,s[20:23],s97 offen offset:2048
buffer_load_dwordx4 a[28:31],v0,s[20:23],s93 offen offset:2048
buffer_load_dwordx4 a[44:47],v0,s[20:23],s93 offen offset:3072
j1_186:
s_waitcnt vmcnt(16)
v_mfma_f32_16x16x32_bf16 v[56:59],v[16:19],a[80:83],0
v_mfma_f32_16x16x32_bf16 v[56:59],v[20:23],a[84:87],v[56:59]
v_mfma_f32_16x16x32_bf16 v[56:59],v[24:27],a[88:91],v[56:59]
v_mfma_f32_16x16x32_bf16 v[56:59],v[28:31],a[92:95],v[56:59]
s_nop 7
v_cndmask_b32 v56,v7,v56,s[44:45]
v_cndmask_b32 v57,v7,v57,s[44:45]
v_cndmask_b32 v58,v7,v58,s[44:45]
v_cndmask_b32 v59,v7,v59,s[44:45]
v_max3_f32 v72,v72,v56,v57
v_max3_f32 v72,v72,v58,v59
v_mov_b32 v73,v72
s_nop 1
v_permlane16_swap_b32 v73,v72
v_max_f32 v72,v72,v73
v_mov_b32 v73,v72
s_nop 1
v_permlane32_swap_b32 v73,v72
v_max_f32 v72,v72,v73
v_mul_f32 v72,s80,v72
v_fma_f32 v48,v48,s80,-v72
v_fma_f32 v49,v49,s80,-v72
v_fma_f32 v50,v50,s80,-v72
v_fma_f32 v51,v51,s80,-v72
v_fma_f32 v52,v52,s80,-v72
v_fma_f32 v53,v53,s80,-v72
v_fma_f32 v54,v54,s80,-v72
v_fma_f32 v55,v55,s80,-v72
v_fma_f32 v56,v56,s80,-v72
v_fma_f32 v57,v57,s80,-v72
v_fma_f32 v58,v58,s80,-v72
v_fma_f32 v59,v59,s80,-v72
v_exp_f32 v48,v48
v_exp_f32 v49,v49
v_exp_f32 v50,v50
v_exp_f32 v51,v51
v_exp_f32 v52,v52
v_exp_f32 v53,v53
v_exp_f32 v54,v54
v_exp_f32 v55,v55
v_exp_f32 v56,v56
v_exp_f32 v57,v57
v_exp_f32 v58,v58
v_exp_f32 v59,v59
v_add_f32 v74,v48,v49
v_add_f32 v75,v50,v51
v_add_f32 v74,v74,v52
v_add_f32 v75,v75,v53
v_add_f32 v74,v74,v54
v_add_f32 v75,v75,v55
v_add_f32 v74,v74,v56
v_add_f32 v75,v75,v57
v_add_f32 v74,v74,v58
v_add_f32 v75,v75,v59
v_add_f32 v74,v74,v75
v_mov_b32 v73,v74
s_nop 1
v_permlane16_swap_b32 v73,v74
v_add_f32 v74,v74,v73
v_mov_b32 v73,v74
s_nop 1
v_permlane32_swap_b32 v73,v74
v_add_f32 v74,v74,v73
v_rcp_f32 v75,v74
s_nop 0
v_mul_f32 v48,v48,v75
v_mul_f32 v49,v49,v75
v_mul_f32 v50,v50,v75
v_mul_f32 v51,v51,v75
v_mul_f32 v52,v52,v75
v_mul_f32 v53,v53,v75
v_mul_f32 v54,v54,v75
v_mul_f32 v55,v55,v75
v_mul_f32 v56,v56,v75
v_mul_f32 v57,v57,v75
v_mul_f32 v58,v58,v75
v_mul_f32 v59,v59,v75
v_cvt_pk_bf16_f32 v64,v48,v49
v_cvt_pk_bf16_f32 v65,v50,v51
v_cvt_pk_bf16_f32 v66,v52,v53
v_cvt_pk_bf16_f32 v67,v54,v55
v_cvt_pk_bf16_f32 v68,v56,v57
v_cvt_pk_bf16_f32 v69,v58,v59
v_mfma_f32_16x16x32_bf16 v[80:83],a[128:131],v[64:67],0
v_mfma_f32_16x16x32_bf16 v[84:87],a[132:135],v[64:67],0
v_mfma_f32_16x16x32_bf16 v[88:91],a[136:139],v[64:67],0
v_mfma_f32_16x16x32_bf16 v[92:95],a[140:143],v[64:67],0
v_mfma_f32_16x16x32_bf16 v[96:99],a[144:147],v[64:67],0
v_mfma_f32_16x16x32_bf16 v[100:103],a[148:151],v[64:67],0
v_mfma_f32_16x16x32_bf16 v[104:107],a[152:155],v[64:67],0
v_mfma_f32_16x16x32_bf16 v[108:111],a[156:159],v[64:67],0
s_waitcnt vmcnt(12)
v_mfma_f32_16x16x16_bf16 v[80:83],v[32:33],v[68:69],v[80:83]
v_mfma_f32_16x16x16_bf16 v[84:87],v[34:35],v[68:69],v[84:87]
v_mfma_f32_16x16x16_bf16 v[88:91],v[36:37],v[68:69],v[88:91]
v_mfma_f32_16x16x16_bf16 v[92:95],v[38:39],v[68:69],v[92:95]
v_mfma_f32_16x16x16_bf16 v[96:99],v[40:41],v[68:69],v[96:99]
v_mfma_f32_16x16x16_bf16 v[100:103],v[42:43],v[68:69],v[100:103]
v_mfma_f32_16x16x16_bf16 v[104:107],v[44:45],v[68:69],v[104:107]
v_mfma_f32_16x16x16_bf16 v[108:111],v[46:47],v[68:69],v[108:111]
s_nop 0
v_cvt_pk_bf16_f32 v112,v80,v81
v_cvt_pk_bf16_f32 v113,v82,v83
v_cvt_pk_bf16_f32 v114,v84,v85
v_cvt_pk_bf16_f32 v115,v86,v87
buffer_store_dwordx4 v[112:115],v0,s[20:23],s66 offen offset:0 sc1
v_cvt_pk_bf16_f32 v116,v88,v89
v_cvt_pk_bf16_f32 v117,v90,v91
v_cvt_pk_bf16_f32 v118,v92,v93
v_cvt_pk_bf16_f32 v119,v94,v95
buffer_store_dwordx4 v[116:119],v0,s[20:23],s66 offen offset:1024 sc1
v_cvt_pk_bf16_f32 v112,v96,v97
v_cvt_pk_bf16_f32 v113,v98,v99
v_cvt_pk_bf16_f32 v114,v100,v101
v_cvt_pk_bf16_f32 v115,v102,v103
buffer_store_dwordx4 v[112:115],v0,s[20:23],s66 offen offset:2048 sc1
v_cvt_pk_bf16_f32 v116,v104,v105
v_cvt_pk_bf16_f32 v117,v106,v107
v_cvt_pk_bf16_f32 v118,v108,v109
v_cvt_pk_bf16_f32 v119,v110,v111
buffer_store_dwordx4 v[116:119],v0,s[20:23],s66 offen offset:3072 sc1
s_barrier
s_cmp_lt_u32 s60,126
s_cbranch_scc1 pf_187
s_waitcnt vmcnt(0)
s_branch j1_188
pf_187:
buffer_load_dwordx4 a[48:51],v0,s[20:23],s94 offen offset:0
buffer_load_dwordx4 a[52:55],v0,s[20:23],s94 offen offset:1024
buffer_load_dwordx4 a[56:59],v0,s[20:23],s94 offen offset:2048
buffer_load_dwordx4 a[60:63],v0,s[20:23],s94 offen offset:3072
buffer_load_dwordx4 a[64:67],v0,s[20:23],s95 offen offset:0
buffer_load_dwordx4 a[68:71],v0,s[20:23],s95 offen offset:1024
buffer_load_dwordx4 a[72:75],v0,s[20:23],s95 offen offset:2048
buffer_load_dwordx4 a[76:79],v0,s[20:23],s95 offen offset:3072
j1_188:
s_add_u32 s66,s66,262144
s_add_u32 s60,s60,2
s_waitcnt vmcnt(8)
v_mov_b32 v6,s71
s_mov_b64 exec,1
buffer_store_dword v6,off,s[20:23],s69 sc1
s_mov_b64 exec,-1
s_cmp_lt_u32 s60,128
s_cbranch_scc1 top0_179
s_endpgm
fl_rec:
s_load_dwordx8 s[4:11],s[0:1],8
s_load_dwordx2 s[12:13],s[0:1],40
s_mov_b32 s57,s58
v_mov_b32 v0,v1
s_waitcnt lgkmcnt(0)
s_mov_b32 s28,s6
s_and_b32 s29,s7,0xffff
s_mov_b32 s30,0x800000
s_mov_b32 s31,0x20000
s_mov_b32 s32,s8
s_and_b32 s33,s9,0xffff
s_mov_b32 s34,0x800000
s_mov_b32 s35,0x20000
s_mov_b32 s36,s10
s_and_b32 s37,s11,0xffff
s_mov_b32 s38,0x800000
s_mov_b32 s39,0x20000
s_mov_b32 s40,s12
s_and_b32 s41,s13,0xffff
s_mov_b32 s42,0x800000
s_mov_b32 s43,0x20000
s_mov_b32 s44,s4
s_and_b32 s45,s5,0xffff
s_mov_b32 s46,0x4000
s_mov_b32 s47,0x20000
s_lshr_b32 s58,s57,5
s_and_b32 s59,s57,31
v_and_b32 v20,63,v0
v_and_b32 v21,15,v20
v_lshrrev_b32 v22,4,v20
v_lshrrev_b32 v23,3,v20
v_and_b32 v24,7,v20
v_lshlrev_b32 v16,13,v23
v_lshl_add_u32 v16,v24,4,v16
v_lshrrev_b32 v23,2,v20
v_and_b32 v24,3,v20
v_lshlrev_b32 v17,11,v23
v_lshl_add_u32 v17,v24,4,v17
s_lshl_b32 s61,s50,15
s_add_u32 s61,s61,32768
s_lshl_b32 s62,s50,21
s_lshl_b32 s64,s57,7
s_add_u32 s62,s62,s64
s_lshl_b32 s63,s58,22
s_lshl_b32 s64,s50,20
s_add_u32 s63,s63,s64
s_lshl_b32 s64,s59,6
s_add_u32 s63,s63,s64
v_lshrrev_b32 v23,1,v22
v_lshlrev_b32 v25,4,v23
v_and_b32 v23,1,v22
v_lshl_add_u32 v25,v23,2,v25
v_lshrrev_b32 v23,3,v21
v_lshl_add_u32 v25,v23,3,v25
v_bfe_u32 v23,v21,2,1
v_add_u32 v25,v25,v23
v_lshlrev_b32 v28,4,v23
v_lshrrev_b32 v23,1,v22
v_lshl_add_u32 v28,v23,3,v28
v_lshrrev_b32 v23,3,v21
v_lshl_add_u32 v28,v23,2,v28
v_and_b32 v23,1,v22
v_lshl_add_u32 v28,v23,1,v28
v_and_b32 v24,3,v21
v_lshlrev_b32 v26,7,v28
v_add_u32 v26,s61,v26
v_lshl_add_u32 v18,v24,3,v26
v_lshl_add_u32 v19,v24,4,v26
v_lshlrev_b32 v26,6,v25
v_add_u32 v26,s61,v26
v_lshl_add_u32 v27,v24,3,v26
v_lshlrev_b32 v0,4,v20
v_add_u32 v7,s61,v0
s_add_u32 s64,s62,0
s_add_u32 m0,s61,0
s_nop 0
buffer_load_dwordx4 v16,s[28:31],s64 offen lds
s_add_u32 s64,s62,65536
s_add_u32 m0,s61,1024
s_nop 0
buffer_load_dwordx4 v16,s[28:31],s64 offen lds
s_add_u32 s64,s62,131072
s_add_u32 m0,s61,2048
s_nop 0
buffer_load_dwordx4 v16,s[28:31],s64 offen lds
s_add_u32 s64,s62,196608
s_add_u32 m0,s61,3072
s_nop 0
buffer_load_dwordx4 v16,s[28:31],s64 offen lds
s_add_u32 s64,s62,262144
s_add_u32 m0,s61,4096
s_nop 0
buffer_load_dwordx4 v16,s[28:31],s64 offen lds
s_add_u32 s64,s62,327680
s_add_u32 m0,s61,5120
s_nop 0
buffer_load_dwordx4 v16,s[28:31],s64 offen lds
s_add_u32 s64,s62,393216
s_add_u32 m0,s61,6144
s_nop 0
buffer_load_dwordx4 v16,s[28:31],s64 offen lds
s_add_u32 s64,s62,458752
s_add_u32 m0,s61,7168
s_nop 0
buffer_load_dwordx4 v16,s[28:31],s64 offen lds
s_add_u32 s64,s62,524288
s_add_u32 m0,s61,8192
s_nop 0
buffer_load_dwordx4 v16,s[28:31],s64 offen lds
s_add_u32 s64,s62,589824
s_add_u32 m0,s61,9216
s_nop 0
buffer_load_dwordx4 v16,s[28:31],s64 offen lds
s_add_u32 s64,s62,655360
s_add_u32 m0,s61,10240
s_nop 0
buffer_load_dwordx4 v16,s[28:31],s64 offen lds
s_add_u32 s64,s62,720896
s_add_u32 m0,s61,11264
s_nop 0
buffer_load_dwordx4 v16,s[28:31],s64 offen lds
s_add_u32 s64,s62,786432
s_add_u32 m0,s61,12288
s_nop 0
buffer_load_dwordx4 v16,s[28:31],s64 offen lds
s_add_u32 s64,s62,851968
s_add_u32 m0,s61,13312
s_nop 0
buffer_load_dwordx4 v16,s[28:31],s64 offen lds
s_add_u32 s64,s62,917504
s_add_u32 m0,s61,14336
s_nop 0
buffer_load_dwordx4 v16,s[28:31],s64 offen lds
s_add_u32 s64,s62,983040
s_add_u32 m0,s61,15360
s_nop 0
buffer_load_dwordx4 v16,s[28:31],s64 offen lds
s_add_u32 s64,s62,1048576
s_add_u32 m0,s61,16384
s_nop 0
buffer_load_dwordx4 v16,s[28:31],s64 offen lds
s_add_u32 s64,s62,1114112
s_add_u32 m0,s61,17408
s_nop 0
buffer_load_dwordx4 v16,s[28:31],s64 offen lds
s_add_u32 s64,s62,1179648
s_add_u32 m0,s61,18432
s_nop 0
buffer_load_dwordx4 v16,s[28:31],s64 offen lds
s_add_u32 s64,s62,1245184
s_add_u32 m0,s61,19456
s_nop 0
buffer_load_dwordx4 v16,s[28:31],s64 offen lds
s_add_u32 s64,s62,1310720
s_add_u32 m0,s61,20480
s_nop 0
buffer_load_dwordx4 v16,s[28:31],s64 offen lds
s_add_u32 s64,s62,1376256
s_add_u32 m0,s61,21504
s_nop 0
buffer_load_dwordx4 v16,s[28:31],s64 offen lds
s_add_u32 s64,s62,1441792
s_add_u32 m0,s61,22528
s_nop 0
buffer_load_dwordx4 v16,s[28:31],s64 offen lds
s_add_u32 s64,s62,1507328
s_add_u32 m0,s61,23552
s_nop 0
buffer_load_dwordx4 v16,s[28:31],s64 offen lds
s_add_u32 s64,s62,1572864
s_add_u32 m0,s61,24576
s_nop 0
buffer_load_dwordx4 v16,s[28:31],s64 offen lds
s_add_u32 s64,s62,1638400
s_add_u32 m0,s61,25600
s_nop 0
buffer_load_dwordx4 v16,s[28:31],s64 offen lds
s_add_u32 s64,s62,1703936
s_add_u32 m0,s61,26624
s_nop 0
buffer_load_dwordx4 v16,s[28:31],s64 offen lds
s_add_u32 s64,s62,1769472
s_add_u32 m0,s61,27648
s_nop 0
buffer_load_dwordx4 v16,s[28:31],s64 offen lds
s_add_u32 s64,s62,1835008
s_add_u32 m0,s61,28672
s_nop 0
buffer_load_dwordx4 v16,s[28:31],s64 offen lds
s_add_u32 s64,s62,1900544
s_add_u32 m0,s61,29696
s_nop 0
buffer_load_dwordx4 v16,s[28:31],s64 offen lds
s_add_u32 s64,s62,1966080
s_add_u32 m0,s61,30720
s_nop 0
buffer_load_dwordx4 v16,s[28:31],s64 offen lds
s_add_u32 s64,s62,2031616
s_add_u32 m0,s61,31744
s_nop 0
buffer_load_dwordx4 v16,s[28:31],s64 offen lds
s_waitcnt vmcnt(16)
ds_read_b64_tr_b16 a[0:1],v18 offset:0
ds_read_b64_tr_b16 a[2:3],v18 offset:128
ds_read_b64_tr_b16 a[4:5],v18 offset:4096
ds_read_b64_tr_b16 a[6:7],v18 offset:4224
ds_read_b64_tr_b16 a[8:9],v18 offset:32
ds_read_b64_tr_b16 a[10:11],v18 offset:160
ds_read_b64_tr_b16 a[12:13],v18 offset:4128
ds_read_b64_tr_b16 a[14:15],v18 offset:4256
ds_read_b64_tr_b16 a[16:17],v18 offset:64
ds_read_b64_tr_b16 a[18:19],v18 offset:192
ds_read_b64_tr_b16 a[20:21],v18 offset:4160
ds_read_b64_tr_b16 a[22:23],v18 offset:4288
ds_read_b64_tr_b16 a[24:25],v18 offset:96
ds_read_b64_tr_b16 a[26:27],v18 offset:224
ds_read_b64_tr_b16 a[28:29],v18 offset:4192
ds_read_b64_tr_b16 a[30:31],v18 offset:4320
s_waitcnt lgkmcnt(0)
ds_read_b64_tr_b16 a[64:65],v18 offset:8192
ds_read_b64_tr_b16 a[66:67],v18 offset:8320
ds_read_b64_tr_b16 a[68:69],v18 offset:12288
ds_read_b64_tr_b16 a[70:71],v18 offset:12416
ds_read_b64_tr_b16 a[72:73],v18 offset:8224
ds_read_b64_tr_b16 a[74:75],v18 offset:8352
ds_read_b64_tr_b16 a[76:77],v18 offset:12320
ds_read_b64_tr_b16 a[78:79],v18 offset:12448
ds_read_b64_tr_b16 a[80:81],v18 offset:8256
ds_read_b64_tr_b16 a[82:83],v18 offset:8384
ds_read_b64_tr_b16 a[84:85],v18 offset:12352
ds_read_b64_tr_b16 a[86:87],v18 offset:12480
ds_read_b64_tr_b16 a[88:89],v18 offset:8288
ds_read_b64_tr_b16 a[90:91],v18 offset:8416
ds_read_b64_tr_b16 a[92:93],v18 offset:12384
ds_read_b64_tr_b16 a[94:95],v18 offset:12512
s_waitcnt lgkmcnt(0)
s_add_u32 s64,s62,0
s_add_u32 m0,s61,0
s_nop 0
buffer_load_dwordx4 v16,s[32:35],s64 offen lds
s_add_u32 s64,s62,65536
s_add_u32 m0,s61,1024
s_nop 0
buffer_load_dwordx4 v16,s[32:35],s64 offen lds
s_add_u32 s64,s62,131072
s_add_u32 m0,s61,2048
s_nop 0
buffer_load_dwordx4 v16,s[32:35],s64 offen lds
s_add_u32 s64,s62,196608
s_add_u32 m0,s61,3072
s_nop 0
buffer_load_dwordx4 v16,s[32:35],s64 offen lds
s_add_u32 s64,s62,262144
s_add_u32 m0,s61,4096
s_nop 0
buffer_load_dwordx4 v16,s[32:35],s64 offen lds
s_add_u32 s64,s62,327680
s_add_u32 m0,s61,5120
s_nop 0
buffer_load_dwordx4 v16,s[32:35],s64 offen lds
s_add_u32 s64,s62,393216
s_add_u32 m0,s61,6144
s_nop 0
buffer_load_dwordx4 v16,s[32:35],s64 offen lds
s_add_u32 s64,s62,458752
s_add_u32 m0,s61,7168
s_nop 0
buffer_load_dwordx4 v16,s[32:35],s64 offen lds
s_add_u32 s64,s62,524288
s_add_u32 m0,s61,8192
s_nop 0
buffer_load_dwordx4 v16,s[32:35],s64 offen lds
s_add_u32 s64,s62,589824
s_add_u32 m0,s61,9216
s_nop 0
buffer_load_dwordx4 v16,s[32:35],s64 offen lds
s_add_u32 s64,s62,655360
s_add_u32 m0,s61,10240
s_nop 0
buffer_load_dwordx4 v16,s[32:35],s64 offen lds
s_add_u32 s64,s62,720896
s_add_u32 m0,s61,11264
s_nop 0
buffer_load_dwordx4 v16,s[32:35],s64 offen lds
s_add_u32 s64,s62,786432
s_add_u32 m0,s61,12288
s_nop 0
buffer_load_dwordx4 v16,s[32:35],s64 offen lds
s_add_u32 s64,s62,851968
s_add_u32 m0,s61,13312
s_nop 0
buffer_load_dwordx4 v16,s[32:35],s64 offen lds
s_add_u32 s64,s62,917504
s_add_u32 m0,s61,14336
s_nop 0
buffer_load_dwordx4 v16,s[32:35],s64 offen lds
s_add_u32 s64,s62,983040
s_add_u32 m0,s61,15360
s_nop 0
buffer_load_dwordx4 v16,s[32:35],s64 offen lds
s_waitcnt vmcnt(16)
ds_read_b64_tr_b16 a[128:129],v18 offset:16384
ds_read_b64_tr_b16 a[130:131],v18 offset:16512
ds_read_b64_tr_b16 a[132:133],v18 offset:20480
ds_read_b64_tr_b16 a[134:135],v18 offset:20608
ds_read_b64_tr_b16 a[136:137],v18 offset:16416
ds_read_b64_tr_b16 a[138:139],v18 offset:16544
ds_read_b64_tr_b16 a[140:141],v18 offset:20512
ds_read_b64_tr_b16 a[142:143],v18 offset:20640
ds_read_b64_tr_b16 a[144:145],v18 offset:16448
ds_read_b64_tr_b16 a[146:147],v18 offset:16576
ds_read_b64_tr_b16 a[148:149],v18 offset:20544
ds_read_b64_tr_b16 a[150:151],v18 offset:20672
ds_read_b64_tr_b16 a[152:153],v18 offset:16480
ds_read_b64_tr_b16 a[154:155],v18 offset:16608
ds_read_b64_tr_b16 a[156:157],v18 offset:20576
ds_read_b64_tr_b16 a[158:159],v18 offset:20704
s_waitcnt lgkmcnt(0)
ds_read_b64_tr_b16 a[192:193],v18 offset:24576
ds_read_b64_tr_b16 a[194:195],v18 offset:24704
ds_read_b64_tr_b16 a[196:197],v18 offset:28672
ds_read_b64_tr_b16 a[198:199],v18 offset:28800
ds_read_b64_tr_b16 a[200:201],v18 offset:24608
ds_read_b64_tr_b16 a[202:203],v18 offset:24736
ds_read_b64_tr_b16 a[204:205],v18 offset:28704
ds_read_b64_tr_b16 a[206:207],v18 offset:28832
ds_read_b64_tr_b16 a[208:209],v18 offset:24640
ds_read_b64_tr_b16 a[210:211],v18 offset:24768
ds_read_b64_tr_b16 a[212:213],v18 offset:28736
ds_read_b64_tr_b16 a[214:215],v18 offset:28864
ds_read_b64_tr_b16 a[216:217],v18 offset:24672
ds_read_b64_tr_b16 a[218:219],v18 offset:24800
ds_read_b64_tr_b16 a[220:221],v18 offset:28768
ds_read_b64_tr_b16 a[222:223],v18 offset:28896
s_waitcnt lgkmcnt(0)
s_add_u32 s64,s62,1048576
s_add_u32 m0,s61,16384
s_nop 0
buffer_load_dwordx4 v16,s[32:35],s64 offen lds
s_add_u32 s64,s62,1114112
s_add_u32 m0,s61,17408
s_nop 0
buffer_load_dwordx4 v16,s[32:35],s64 offen lds
s_add_u32 s64,s62,1179648
s_add_u32 m0,s61,18432
s_nop 0
buffer_load_dwordx4 v16,s[32:35],s64 offen lds
s_add_u32 s64,s62,1245184
s_add_u32 m0,s61,19456
s_nop 0
buffer_load_dwordx4 v16,s[32:35],s64 offen lds
s_add_u32 s64,s62,1310720
s_add_u32 m0,s61,20480
s_nop 0
buffer_load_dwordx4 v16,s[32:35],s64 offen lds
s_add_u32 s64,s62,1376256
s_add_u32 m0,s61,21504
s_nop 0
buffer_load_dwordx4 v16,s[32:35],s64 offen lds
s_add_u32 s64,s62,1441792
s_add_u32 m0,s61,22528
s_nop 0
buffer_load_dwordx4 v16,s[32:35],s64 offen lds
s_add_u32 s64,s62,1507328
s_add_u32 m0,s61,23552
s_nop 0
buffer_load_dwordx4 v16,s[32:35],s64 offen lds
s_add_u32 s64,s62,1572864
s_add_u32 m0,s61,24576
s_nop 0
buffer_load_dwordx4 v16,s[32:35],s64 offen lds
s_add_u32 s64,s62,1638400
s_add_u32 m0,s61,25600
s_nop 0
buffer_load_dwordx4 v16,s[32:35],s64 offen lds
s_add_u32 s64,s62,1703936
s_add_u32 m0,s61,26624
s_nop 0
buffer_load_dwordx4 v16,s[32:35],s64 offen lds
s_add_u32 s64,s62,1769472
s_add_u32 m0,s61,27648
s_nop 0
buffer_load_dwordx4 v16,s[32:35],s64 offen lds
s_add_u32 s64,s62,1835008
s_add_u32 m0,s61,28672
s_nop 0
buffer_load_dwordx4 v16,s[32:35],s64 offen lds
s_add_u32 s64,s62,1900544
s_add_u32 m0,s61,29696
s_nop 0
buffer_load_dwordx4 v16,s[32:35],s64 offen lds
s_add_u32 s64,s62,1966080
s_add_u32 m0,s61,30720
s_nop 0
buffer_load_dwordx4 v16,s[32:35],s64 offen lds
s_add_u32 s64,s62,2031616
s_add_u32 m0,s61,31744
s_nop 0
buffer_load_dwordx4 v16,s[32:35],s64 offen lds
s_waitcnt vmcnt(16)
ds_read_b64_tr_b16 a[32:33],v18 offset:0
ds_read_b64_tr_b16 a[34:35],v18 offset:128
ds_read_b64_tr_b16 a[36:37],v18 offset:4096
ds_read_b64_tr_b16 a[38:39],v18 offset:4224
ds_read_b64_tr_b16 a[40:41],v18 offset:32
ds_read_b64_tr_b16 a[42:43],v18 offset:160
ds_read_b64_tr_b16 a[44:45],v18 offset:4128
ds_read_b64_tr_b16 a[46:47],v18 offset:4256
ds_read_b64_tr_b16 a[48:49],v18 offset:64
ds_read_b64_tr_b16 a[50:51],v18 offset:192
ds_read_b64_tr_b16 a[52:53],v18 offset:4160
ds_read_b64_tr_b16 a[54:55],v18 offset:4288
ds_read_b64_tr_b16 a[56:57],v18 offset:96
ds_read_b64_tr_b16 a[58:59],v18 offset:224
ds_read_b64_tr_b16 a[60:61],v18 offset:4192
ds_read_b64_tr_b16 a[62:63],v18 offset:4320
s_waitcnt lgkmcnt(0)
ds_read_b64_tr_b16 a[96:97],v18 offset:8192
ds_read_b64_tr_b16 a[98:99],v18 offset:8320
ds_read_b64_tr_b16 a[100:101],v18 offset:12288
ds_read_b64_tr_b16 a[102:103],v18 offset:12416
ds_read_b64_tr_b16 a[104:105],v18 offset:8224
ds_read_b64_tr_b16 a[106:107],v18 offset:8352
ds_read_b64_tr_b16 a[108:109],v18 offset:12320
ds_read_b64_tr_b16 a[110:111],v18 offset:12448
ds_read_b64_tr_b16 a[112:113],v18 offset:8256
ds_read_b64_tr_b16 a[114:115],v18 offset:8384
ds_read_b64_tr_b16 a[116:117],v18 offset:12352
ds_read_b64_tr_b16 a[118:119],v18 offset:12480
ds_read_b64_tr_b16 a[120:121],v18 offset:8288
ds_read_b64_tr_b16 a[122:123],v18 offset:8416
ds_read_b64_tr_b16 a[124:125],v18 offset:12384
ds_read_b64_tr_b16 a[126:127],v18 offset:12512
s_waitcnt lgkmcnt(0)
s_add_u32 s64,s63,0
s_add_u32 m0,s61,0
s_nop 0
buffer_load_dwordx4 v17,s[40:43],s64 offen lds
s_add_u32 s64,s63,32768
s_add_u32 m0,s61,1024
s_nop 0
buffer_load_dwordx4 v17,s[40:43],s64 offen lds
s_add_u32 s64,s63,65536
s_add_u32 m0,s61,2048
s_nop 0
buffer_load_dwordx4 v17,s[40:43],s64 offen lds
s_add_u32 s64,s63,98304
s_add_u32 m0,s61,3072
s_nop 0
buffer_load_dwordx4 v17,s[40:43],s64 offen lds
s_add_u32 s64,s63,131072
s_add_u32 m0,s61,4096
s_nop 0
buffer_load_dwordx4 v17,s[40:43],s64 offen lds
s_add_u32 s64,s63,163840
s_add_u32 m0,s61,5120
s_nop 0
buffer_load_dwordx4 v17,s[40:43],s64 offen lds
s_add_u32 s64,s63,196608
s_add_u32 m0,s61,6144
s_nop 0
buffer_load_dwordx4 v17,s[40:43],s64 offen lds
s_add_u32 s64,s63,229376
s_add_u32 m0,s61,7168
s_nop 0
buffer_load_dwordx4 v17,s[40:43],s64 offen lds
s_add_u32 s64,s63,262144
s_add_u32 m0,s61,8192
s_nop 0
buffer_load_dwordx4 v17,s[40:43],s64 offen lds
s_add_u32 s64,s63,294912
s_add_u32 m0,s61,9216
s_nop 0
buffer_load_dwordx4 v17,s[40:43],s64 offen lds
s_add_u32 s64,s63,327680
s_add_u32 m0,s61,10240
s_nop 0
buffer_load_dwordx4 v17,s[40:43],s64 offen lds
s_add_u32 s64,s63,360448
s_add_u32 m0,s61,11264
s_nop 0
buffer_load_dwordx4 v17,s[40:43],s64 offen lds
s_add_u32 s64,s63,393216
s_add_u32 m0,s61,12288
s_nop 0
buffer_load_dwordx4 v17,s[40:43],s64 offen lds
s_add_u32 s64,s63,425984
s_add_u32 m0,s61,13312
s_nop 0
buffer_load_dwordx4 v17,s[40:43],s64 offen lds
s_add_u32 s64,s63,458752
s_add_u32 m0,s61,14336
s_nop 0
buffer_load_dwordx4 v17,s[40:43],s64 offen lds
s_add_u32 s64,s63,491520
s_add_u32 m0,s61,15360
s_nop 0
buffer_load_dwordx4 v17,s[40:43],s64 offen lds
s_waitcnt vmcnt(16)
ds_read_b64_tr_b16 a[160:161],v18 offset:16384
ds_read_b64_tr_b16 a[162:163],v18 offset:16512
ds_read_b64_tr_b16 a[164:165],v18 offset:20480
ds_read_b64_tr_b16 a[166:167],v18 offset:20608
ds_read_b64_tr_b16 a[168:169],v18 offset:16416
ds_read_b64_tr_b16 a[170:171],v18 offset:16544
ds_read_b64_tr_b16 a[172:173],v18 offset:20512
ds_read_b64_tr_b16 a[174:175],v18 offset:20640
ds_read_b64_tr_b16 a[176:177],v18 offset:16448
ds_read_b64_tr_b16 a[178:179],v18 offset:16576
ds_read_b64_tr_b16 a[180:181],v18 offset:20544
ds_read_b64_tr_b16 a[182:183],v18 offset:20672
ds_read_b64_tr_b16 a[184:185],v18 offset:16480
ds_read_b64_tr_b16 a[186:187],v18 offset:16608
ds_read_b64_tr_b16 a[188:189],v18 offset:20576
ds_read_b64_tr_b16 a[190:191],v18 offset:20704
s_waitcnt lgkmcnt(0)
ds_read_b64_tr_b16 a[224:225],v18 offset:24576
ds_read_b64_tr_b16 a[226:227],v18 offset:24704
ds_read_b64_tr_b16 a[228:229],v18 offset:28672
ds_read_b64_tr_b16 a[230:231],v18 offset:28800
ds_read_b64_tr_b16 a[232:233],v18 offset:24608
ds_read_b64_tr_b16 a[234:235],v18 offset:24736
ds_read_b64_tr_b16 a[236:237],v18 offset:28704
ds_read_b64_tr_b16 a[238:239],v18 offset:28832
ds_read_b64_tr_b16 a[240:241],v18 offset:24640
ds_read_b64_tr_b16 a[242:243],v18 offset:24768
ds_read_b64_tr_b16 a[244:245],v18 offset:28736
ds_read_b64_tr_b16 a[246:247],v18 offset:28864
ds_read_b64_tr_b16 a[248:249],v18 offset:24672
ds_read_b64_tr_b16 a[250:251],v18 offset:24800
ds_read_b64_tr_b16 a[252:253],v18 offset:28768
ds_read_b64_tr_b16 a[254:255],v18 offset:28896
s_waitcnt lgkmcnt(0)
s_add_u32 s64,s63,524288
s_add_u32 m0,s61,16384
s_nop 0
buffer_load_dwordx4 v17,s[40:43],s64 offen lds
s_add_u32 s64,s63,557056
s_add_u32 m0,s61,17408
s_nop 0
buffer_load_dwordx4 v17,s[40:43],s64 offen lds
s_add_u32 s64,s63,589824
s_add_u32 m0,s61,18432
s_nop 0
buffer_load_dwordx4 v17,s[40:43],s64 offen lds
s_add_u32 s64,s63,622592
s_add_u32 m0,s61,19456
s_nop 0
buffer_load_dwordx4 v17,s[40:43],s64 offen lds
s_add_u32 s64,s63,655360
s_add_u32 m0,s61,20480
s_nop 0
buffer_load_dwordx4 v17,s[40:43],s64 offen lds
s_add_u32 s64,s63,688128
s_add_u32 m0,s61,21504
s_nop 0
buffer_load_dwordx4 v17,s[40:43],s64 offen lds
s_add_u32 s64,s63,720896
s_add_u32 m0,s61,22528
s_nop 0
buffer_load_dwordx4 v17,s[40:43],s64 offen lds
s_add_u32 s64,s63,753664
s_add_u32 m0,s61,23552
s_nop 0
buffer_load_dwordx4 v17,s[40:43],s64 offen lds
s_add_u32 s64,s63,786432
s_add_u32 m0,s61,24576
s_nop 0
buffer_load_dwordx4 v17,s[40:43],s64 offen lds
s_add_u32 s64,s63,819200
s_add_u32 m0,s61,25600
s_nop 0
buffer_load_dwordx4 v17,s[40:43],s64 offen lds
s_add_u32 s64,s63,851968
s_add_u32 m0,s61,26624
s_nop 0
buffer_load_dwordx4 v17,s[40:43],s64 offen lds
s_add_u32 s64,s63,884736
s_add_u32 m0,s61,27648
s_nop 0
buffer_load_dwordx4 v17,s[40:43],s64 offen lds
s_add_u32 s64,s63,917504
s_add_u32 m0,s61,28672
s_nop 0
buffer_load_dwordx4 v17,s[40:43],s64 offen lds
s_add_u32 s64,s63,950272
s_add_u32 m0,s61,29696
s_nop 0
buffer_load_dwordx4 v17,s[40:43],s64 offen lds
s_add_u32 s64,s63,983040
s_add_u32 m0,s61,30720
s_nop 0
buffer_load_dwordx4 v17,s[40:43],s64 offen lds
s_add_u32 s64,s63,1015808
s_add_u32 m0,s61,31744
s_nop 0
buffer_load_dwordx4 v17,s[40:43],s64 offen lds
s_waitcnt vmcnt(16)
ds_read_b64_tr_b16 v[48:49],v27 offset:0
ds_read_b64_tr_b16 v[50:51],v27 offset:128
ds_read_b64_tr_b16 v[52:53],v27 offset:2048
ds_read_b64_tr_b16 v[54:55],v27 offset:2176
ds_read_b64_tr_b16 v[56:57],v27 offset:32
ds_read_b64_tr_b16 v[58:59],v27 offset:160
ds_read_b64_tr_b16 v[60:61],v27 offset:2080
ds_read_b64_tr_b16 v[62:63],v27 offset:2208
ds_read_b64_tr_b16 v[64:65],v27 offset:4096
ds_read_b64_tr_b16 v[66:67],v27 offset:4224
ds_read_b64_tr_b16 v[68:69],v27 offset:6144
ds_read_b64_tr_b16 v[70:71],v27 offset:6272
ds_read_b64_tr_b16 v[72:73],v27 offset:4128
ds_read_b64_tr_b16 v[74:75],v27 offset:4256
ds_read_b64_tr_b16 v[76:77],v27 offset:6176
ds_read_b64_tr_b16 v[78:79],v27 offset:6304
s_waitcnt lgkmcnt(0)
ds_read_b64_tr_b16 v[80:81],v27 offset:8192
ds_read_b64_tr_b16 v[82:83],v27 offset:8320
ds_read_b64_tr_b16 v[84:85],v27 offset:10240
ds_read_b64_tr_b16 v[86:87],v27 offset:10368
ds_read_b64_tr_b16 v[88:89],v27 offset:8224
ds_read_b64_tr_b16 v[90:91],v27 offset:8352
ds_read_b64_tr_b16 v[92:93],v27 offset:10272
ds_read_b64_tr_b16 v[94:95],v27 offset:10400
ds_read_b64_tr_b16 v[128:129],v27 offset:12288
ds_read_b64_tr_b16 v[130:131],v27 offset:12416
ds_read_b64_tr_b16 v[132:133],v27 offset:14336
ds_read_b64_tr_b16 v[134:135],v27 offset:14464
ds_read_b64_tr_b16 v[136:137],v27 offset:12320
ds_read_b64_tr_b16 v[138:139],v27 offset:12448
ds_read_b64_tr_b16 v[140:141],v27 offset:14368
ds_read_b64_tr_b16 v[142:143],v27 offset:14496
s_waitcnt lgkmcnt(0)
s_add_u32 s64,s62,0
s_add_u32 m0,s61,0
s_nop 0
buffer_load_dwordx4 v16,s[36:39],s64 offen lds
s_add_u32 s64,s62,65536
s_add_u32 m0,s61,1024
s_nop 0
buffer_load_dwordx4 v16,s[36:39],s64 offen lds
s_add_u32 s64,s62,131072
s_add_u32 m0,s61,2048
s_nop 0
buffer_load_dwordx4 v16,s[36:39],s64 offen lds
s_add_u32 s64,s62,196608
s_add_u32 m0,s61,3072
s_nop 0
buffer_load_dwordx4 v16,s[36:39],s64 offen lds
s_add_u32 s64,s62,262144
s_add_u32 m0,s61,4096
s_nop 0
buffer_load_dwordx4 v16,s[36:39],s64 offen lds
s_add_u32 s64,s62,327680
s_add_u32 m0,s61,5120
s_nop 0
buffer_load_dwordx4 v16,s[36:39],s64 offen lds
s_add_u32 s64,s62,393216
s_add_u32 m0,s61,6144
s_nop 0
buffer_load_dwordx4 v16,s[36:39],s64 offen lds
s_add_u32 s64,s62,458752
s_add_u32 m0,s61,7168
s_nop 0
buffer_load_dwordx4 v16,s[36:39],s64 offen lds
s_add_u32 s64,s62,524288
s_add_u32 m0,s61,8192
s_nop 0
buffer_load_dwordx4 v16,s[36:39],s64 offen lds
s_add_u32 s64,s62,589824
s_add_u32 m0,s61,9216
s_nop 0
buffer_load_dwordx4 v16,s[36:39],s64 offen lds
s_add_u32 s64,s62,655360
s_add_u32 m0,s61,10240
s_nop 0
buffer_load_dwordx4 v16,s[36:39],s64 offen lds
s_add_u32 s64,s62,720896
s_add_u32 m0,s61,11264
s_nop 0
buffer_load_dwordx4 v16,s[36:39],s64 offen lds
s_add_u32 s64,s62,786432
s_add_u32 m0,s61,12288
s_nop 0
buffer_load_dwordx4 v16,s[36:39],s64 offen lds
s_add_u32 s64,s62,851968
s_add_u32 m0,s61,13312
s_nop 0
buffer_load_dwordx4 v16,s[36:39],s64 offen lds
s_add_u32 s64,s62,917504
s_add_u32 m0,s61,14336
s_nop 0
buffer_load_dwordx4 v16,s[36:39],s64 offen lds
s_add_u32 s64,s62,983040
s_add_u32 m0,s61,15360
s_nop 0
buffer_load_dwordx4 v16,s[36:39],s64 offen lds
s_waitcnt vmcnt(16)
ds_read_b64_tr_b16 v[144:145],v27 offset:16384
ds_read_b64_tr_b16 v[146:147],v27 offset:16512
ds_read_b64_tr_b16 v[148:149],v27 offset:18432
ds_read_b64_tr_b16 v[150:151],v27 offset:18560
ds_read_b64_tr_b16 v[152:153],v27 offset:16416
ds_read_b64_tr_b16 v[154:155],v27 offset:16544
ds_read_b64_tr_b16 v[156:157],v27 offset:18464
ds_read_b64_tr_b16 v[158:159],v27 offset:18592
ds_read_b64_tr_b16 v[160:161],v27 offset:20480
ds_read_b64_tr_b16 v[162:163],v27 offset:20608
ds_read_b64_tr_b16 v[164:165],v27 offset:22528
ds_read_b64_tr_b16 v[166:167],v27 offset:22656
ds_read_b64_tr_b16 v[168:169],v27 offset:20512
ds_read_b64_tr_b16 v[170:171],v27 offset:20640
ds_read_b64_tr_b16 v[172:173],v27 offset:22560
ds_read_b64_tr_b16 v[174:175],v27 offset:22688
s_waitcnt lgkmcnt(0)
ds_read_b64_tr_b16 v[176:177],v27 offset:24576
ds_read_b64_tr_b16 v[178:179],v27 offset:24704
ds_read_b64_tr_b16 v[180:181],v27 offset:26624
ds_read_b64_tr_b16 v[182:183],v27 offset:26752
ds_read_b64_tr_b16 v[184:185],v27 offset:24608
ds_read_b64_tr_b16 v[186:187],v27 offset:24736
ds_read_b64_tr_b16 v[188:189],v27 offset:26656
ds_read_b64_tr_b16 v[190:191],v27 offset:26784
ds_read_b64_tr_b16 v[192:193],v27 offset:28672
ds_read_b64_tr_b16 v[194:195],v27 offset:28800
ds_read_b64_tr_b16 v[196:197],v27 offset:30720
ds_read_b64_tr_b16 v[198:199],v27 offset:30848
ds_read_b64_tr_b16 v[200:201],v27 offset:28704
ds_read_b64_tr_b16 v[202:203],v27 offset:28832
ds_read_b64_tr_b16 v[204:205],v27 offset:30752
ds_read_b64_tr_b16 v[206:207],v27 offset:30880
s_waitcnt lgkmcnt(0)
s_add_u32 s64,s62,1048576
s_add_u32 m0,s61,16384
s_nop 0
buffer_load_dwordx4 v16,s[36:39],s64 offen lds
s_add_u32 s64,s62,1114112
s_add_u32 m0,s61,17408
s_nop 0
buffer_load_dwordx4 v16,s[36:39],s64 offen lds
s_add_u32 s64,s62,1179648
s_add_u32 m0,s61,18432
s_nop 0
buffer_load_dwordx4 v16,s[36:39],s64 offen lds
s_add_u32 s64,s62,1245184
s_add_u32 m0,s61,19456
s_nop 0
buffer_load_dwordx4 v16,s[36:39],s64 offen lds
s_add_u32 s64,s62,1310720
s_add_u32 m0,s61,20480
s_nop 0
buffer_load_dwordx4 v16,s[36:39],s64 offen lds
s_add_u32 s64,s62,1376256
s_add_u32 m0,s61,21504
s_nop 0
buffer_load_dwordx4 v16,s[36:39],s64 offen lds
s_add_u32 s64,s62,1441792
s_add_u32 m0,s61,22528
s_nop 0
buffer_load_dwordx4 v16,s[36:39],s64 offen lds
s_add_u32 s64,s62,1507328
s_add_u32 m0,s61,23552
s_nop 0
buffer_load_dwordx4 v16,s[36:39],s64 offen lds
s_add_u32 s64,s62,1572864
s_add_u32 m0,s61,24576
s_nop 0
buffer_load_dwordx4 v16,s[36:39],s64 offen lds
s_add_u32 s64,s62,1638400
s_add_u32 m0,s61,25600
s_nop 0
buffer_load_dwordx4 v16,s[36:39],s64 offen lds
s_add_u32 s64,s62,1703936
s_add_u32 m0,s61,26624
s_nop 0
buffer_load_dwordx4 v16,s[36:39],s64 offen lds
s_add_u32 s64,s62,1769472
s_add_u32 m0,s61,27648
s_nop 0
buffer_load_dwordx4 v16,s[36:39],s64 offen lds
s_add_u32 s64,s62,1835008
s_add_u32 m0,s61,28672
s_nop 0
buffer_load_dwordx4 v16,s[36:39],s64 offen lds
s_add_u32 s64,s62,1900544
s_add_u32 m0,s61,29696
s_nop 0
buffer_load_dwordx4 v16,s[36:39],s64 offen lds
s_add_u32 s64,s62,1966080
s_add_u32 m0,s61,30720
s_nop 0
buffer_load_dwordx4 v16,s[36:39],s64 offen lds
s_add_u32 s64,s62,2031616
s_add_u32 m0,s61,31744
s_nop 0
buffer_load_dwordx4 v16,s[36:39],s64 offen lds
s_waitcnt vmcnt(16)
ds_read_b64_tr_b16 v[208:209],v19 offset:0
ds_read_b64_tr_b16 v[210:211],v19 offset:128
ds_read_b64_tr_b16 v[212:213],v19 offset:4096
ds_read_b64_tr_b16 v[214:215],v19 offset:4224
ds_read_b64_tr_b16 v[216:217],v19 offset:8
ds_read_b64_tr_b16 v[218:219],v19 offset:136
ds_read_b64_tr_b16 v[220:221],v19 offset:4104
ds_read_b64_tr_b16 v[222:223],v19 offset:4232
ds_read_b64_tr_b16 v[224:225],v19 offset:64
ds_read_b64_tr_b16 v[226:227],v19 offset:192
ds_read_b64_tr_b16 v[228:229],v19 offset:4160
ds_read_b64_tr_b16 v[230:231],v19 offset:4288
ds_read_b64_tr_b16 v[232:233],v19 offset:72
ds_read_b64_tr_b16 v[234:235],v19 offset:200
ds_read_b64_tr_b16 v[236:237],v19 offset:4168
ds_read_b64_tr_b16 v[238:239],v19 offset:4296
s_waitcnt lgkmcnt(0)
ds_read_b64_tr_b16 v[240:241],v19 offset:8192
ds_read_b64_tr_b16 v[242:243],v19 offset:8320
ds_read_b64_tr_b16 v[244:245],v19 offset:12288
ds_read_b64_tr_b16 v[246:247],v19 offset:12416
ds_read_b64_tr_b16 v[248:249],v19 offset:8200
ds_read_b64_tr_b16 v[250:251],v19 offset:8328
ds_read_b64_tr_b16 v[252:253],v19 offset:12296
ds_read_b64_tr_b16 v[254:255],v19 offset:12424
ds_read_b64_tr_b16 v[96:97],v19 offset:8256
ds_read_b64_tr_b16 v[98:99],v19 offset:8384
ds_read_b64_tr_b16 v[100:101],v19 offset:12352
ds_read_b64_tr_b16 v[102:103],v19 offset:12480
ds_read_b64_tr_b16 v[104:105],v19 offset:8264
ds_read_b64_tr_b16 v[106:107],v19 offset:8392
ds_read_b64_tr_b16 v[108:109],v19 offset:12360
ds_read_b64_tr_b16 v[110:111],v19 offset:12488
s_waitcnt lgkmcnt(0)
s_waitcnt vmcnt(0)
ds_write_b128 v7,v[96:99] offset:0
ds_write_b128 v7,v[100:103] offset:1024
ds_write_b128 v7,v[104:107] offset:2048
ds_write_b128 v7,v[108:111] offset:3072
s_waitcnt lgkmcnt(0)
ds_read_b64_tr_b16 v[96:97],v19 offset:16384
ds_read_b64_tr_b16 v[98:99],v19 offset:16512
ds_read_b64_tr_b16 v[100:101],v19 offset:20480
ds_read_b64_tr_b16 v[102:103],v19 offset:20608
ds_read_b64_tr_b16 v[104:105],v19 offset:16392
ds_read_b64_tr_b16 v[106:107],v19 offset:16520
ds_read_b64_tr_b16 v[108:109],v19 offset:20488
ds_read_b64_tr_b16 v[110:111],v19 offset:20616
s_waitcnt lgkmcnt(0)
ds_write_b128 v7,v[96:99] offset:4096
ds_write_b128 v7,v[100:103] offset:5120
ds_write_b128 v7,v[104:107] offset:6144
ds_write_b128 v7,v[108:111] offset:7168
s_waitcnt lgkmcnt(0)
ds_read_b64_tr_b16 v[96:97],v19 offset:16448
ds_read_b64_tr_b16 v[98:99],v19 offset:16576
ds_read_b64_tr_b16 v[100:101],v19 offset:20544
ds_read_b64_tr_b16 v[102:103],v19 offset:20672
ds_read_b64_tr_b16 v[104:105],v19 offset:16456
ds_read_b64_tr_b16 v[106:107],v19 offset:16584
ds_read_b64_tr_b16 v[108:109],v19 offset:20552
ds_read_b64_tr_b16 v[110:111],v19 offset:20680
s_waitcnt lgkmcnt(0)
ds_write_b128 v7,v[96:99] offset:8192
ds_write_b128 v7,v[100:103] offset:9216
ds_write_b128 v7,v[104:107] offset:10240
ds_write_b128 v7,v[108:111] offset:11264
s_waitcnt lgkmcnt(0)
ds_read_b64_tr_b16 v[96:97],v19 offset:24576
ds_read_b64_tr_b16 v[98:99],v19 offset:24704
ds_read_b64_tr_b16 v[100:101],v19 offset:28672
ds_read_b64_tr_b16 v[102:103],v19 offset:28800
ds_read_b64_tr_b16 v[104:105],v19 offset:24584
ds_read_b64_tr_b16 v[106:107],v19 offset:24712
ds_read_b64_tr_b16 v[108:109],v19 offset:28680
ds_read_b64_tr_b16 v[110:111],v19 offset:28808
s_waitcnt lgkmcnt(0)
ds_write_b128 v7,v[96:99] offset:12288
ds_write_b128 v7,v[100:103] offset:13312
ds_write_b128 v7,v[104:107] offset:14336
ds_write_b128 v7,v[108:111] offset:15360
s_waitcnt lgkmcnt(0)
ds_read_b64_tr_b16 v[112:113],v19 offset:24640
ds_read_b64_tr_b16 v[114:115],v19 offset:24768
ds_read_b64_tr_b16 v[116:117],v19 offset:28736
ds_read_b64_tr_b16 v[118:119],v19 offset:28864
ds_read_b64_tr_b16 v[120:121],v19 offset:24648
ds_read_b64_tr_b16 v[122:123],v19 offset:24776
ds_read_b64_tr_b16 v[124:125],v19 offset:28744
ds_read_b64_tr_b16 v[126:127],v19 offset:28872
s_waitcnt lgkmcnt(0)
ds_write_b128 v7,v[112:115] offset:16384
ds_write_b128 v7,v[116:119] offset:17408
ds_write_b128 v7,v[120:123] offset:18432
ds_write_b128 v7,v[124:127] offset:19456
ds_write_b128 v7,v[48:51] offset:20480
ds_write_b128 v7,v[52:55] offset:21504
ds_write_b128 v7,v[56:59] offset:22528
ds_write_b128 v7,v[60:63] offset:23552
ds_write_b128 v7,v[64:67] offset:24576
ds_write_b128 v7,v[68:71] offset:25600
ds_write_b128 v7,v[72:75] offset:26624
ds_write_b128 v7,v[76:79] offset:27648
ds_write_b128 v7,v[80:83] offset:28672
ds_write_b128 v7,v[84:87] offset:29696
ds_write_b128 v7,v[88:91] offset:30720
ds_write_b128 v7,v[92:95] offset:31744
s_waitcnt lgkmcnt(0)
v_and_b32 v23,1,v21
v_mov_b32 v1,0x4444
v_mov_b32 v24,0xeeee
v_cmp_eq_u32 vcc,1,v23
s_nop 1
v_cndmask_b32 v1,v1,v24,vcc
v_lshlrev_b32 v23,1,v22
v_sub_u32 v23,v21,v23
v_mov_b32 v5,0
v_mov_b32 v24,0x3f80
v_cmp_eq_u32 vcc,0,v23
s_nop 1
v_cndmask_b32 v5,v5,v24,vcc
v_mov_b32 v24,0x3f800000
v_cmp_eq_u32 vcc,1,v23
s_nop 1
v_cndmask_b32 v5,v5,v24,vcc
s_and_b32 s64,s50,1
s_lshl_b32 s64,s64,11
v_lshl_add_u32 v127,v20,2,s64
v_and_b32 v23,7,v21
v_lshrrev_b32 v24,3,v21
v_lshlrev_b32 v25,8,v24
v_lshl_add_u32 v25,v22,6,v25
v_lshl_add_u32 v4,v23,2,v25
v_lshrrev_b32 v25,1,v22
v_lshl_add_u32 v25,v25,3,v23
v_lshlrev_b32 v25,5,v25
v_and_b32 v26,1,v22
v_lshl_add_u32 v6,v26,4,v25
v_lshl_add_u32 v27,v22,3,v23
v_lshlrev_b32 v27,4,v27
s_mov_b32 s80,0x3e0293ee
s_mov_b32 s81,0xfffffffe
s_mov_b32 s84,0x00ff00ff
s_mov_b32 s85,0x00ff00ff
s_mov_b32 s86,-1
s_mov_b32 s87,0
s_cmp_gt_u32 s50,1
s_cselect_b32 s82,0xff00ff00,-1
s_cselect_b32 s83,0xff00ff00,0
s_lshl_b32 m0,s50,8
s_cmp_gt_u32 s50,1
s_cbranch_scc1 w23_100189
v_lshl_add_u32 v2,v24,9,v27
v_lshrrev_b32 v25,1,v22
v_lshl_add_u32 v25,v25,3,v23
v_lshlrev_b32 v25,4,v25
v_lshl_add_u32 v26,v26,1,v24
v_lshl_add_u32 v3,v26,2,v25
v_add_u32 v3,1024 + 256,v3
v_cndmask_b32 v6,2.0,v6,s[84:85]
v_mov_b32 v8,0x3f803f80
v_mov_b32 v9,0x3f803f80
v_mov_b32 v10,0x3f803f80
v_mov_b32 v11,0x3f803f80
v_mov_b32 v12,0x3f803f80
v_mov_b32 v13,0
v_mov_b32 v14,0
v_mov_b32 v15,0
s_branch jn_100190
w23_100189:
s_sub_u32 s64,s50,2
s_mul_i32 s64,s64,4160
v_lshrrev_b32 v25,1,v22
v_mul_u32_u24 v25,2080,v25
v_and_b32 v28,1,v23
v_mul_u32_u24 v28,1040,v28
v_add_u32 v25,v25,v28
v_lshrrev_b32 v28,1,v23
v_lshl_add_u32 v25,v28,6,v25
v_lshl_add_u32 v25,v26,5,v25
v_mul_u32_u24 v28,8448,v24
v_add3_u32 v2,v25,v28,s64
v_cndmask_b32 v3,2.0,v27,s[84:85]
v_mov_b32 v8,-1
v_mov_b32 v9,-1
v_mov_b32 v10,-1
v_mov_b32 v11,-1
jn_100190:
s_mov_b32 s67,0
s_cmp_eq_u32 s56,1
s_cbranch_scc1 vok_100193
v_mbcnt_lo_u32_b32 v16,-1,0
v_and_b32 v16,7,v16
v_lshlrev_b32 v16,7,v16
s_mov_b32 s64,138510336
vpoll_100194:
buffer_load_dword v17,v16,s[20:23],s64 offen sc1
s_waitcnt vmcnt(0)
v_readlane_b32 s92,v17,0
v_readlane_b32 s93,v17,1
v_readlane_b32 s94,v17,2
v_readlane_b32 s95,v17,3
v_readlane_b32 s96,v17,4
v_readlane_b32 s97,v17,5
v_readlane_b32 s98,v17,6
v_readlane_b32 s99,v17,7
s_add_u32 s65,s92,s93
s_add_u32 s65,s65,s94
s_add_u32 s65,s65,s95
s_add_u32 s65,s65,s96
s_add_u32 s65,s65,s97
s_add_u32 s65,s65,s98
s_add_u32 s65,s65,s99
s_cmp_ge_u32 s65,256
s_cbranch_scc1 vgot_100195
s_sleep 4
s_sub_u32 s90,s90,1
s_cmp_gt_i32 s90,0
s_cbranch_scc1 vpoll_100194
vgot_100195:
s_min_u32 s65,s92,s93
s_min_u32 s65,s65,s94
s_min_u32 s65,s65,s95
s_min_u32 s65,s65,s96
s_min_u32 s65,s65,s97
s_min_u32 s65,s65,s98
s_min_u32 s65,s65,s99
s_cmp_lt_u32 s65,32
s_cbranch_scc1 fl_slow
s_mov_b32 s56,0
pp_100196:
buffer_load_dword v17,off,s[20:23],s64 offset:1024 sc1
s_waitcnt vmcnt(0)
v_readfirstlane_b32 s65,v17
s_cmp_lg_u32 s65,0
s_cbranch_scc1 pg_100197
s_sleep 4
s_sub_u32 s90,s90,1
s_cmp_gt_i32 s90,0
s_cbranch_scc1 pp_100196
pg_100197:
s_and_b32 s65,s65,2
s_lshl_b32 s67,s65,12
vok_100193:
s_lshl_b32 s64,s58,14
s_lshl_b32 s65,s50,12
s_add_u32 s70,s64,s65
s_add_u32 s70,s70,134217728
s_lshl_b32 s65,s59,9
s_add_u32 s71,s64,s65
s_add_u32 s71,s71,134217728
s_xor_b32 s64,s58,1
s_lshl_b32 s64,s64,15
s_lshr_b32 s65,s50,1
s_lshl_b32 s65,s65,14
s_add_u32 s64,s64,s65
s_and_b32 s65,s50,1
s_lshl_b32 s65,s65,12
s_add_u32 s64,s64,s65
s_add_u32 s72,s64,s67
s_add_u32 s72,s72,142606336
s_lshl_b32 s64,s58,15
s_lshr_b32 s65,s59,4
s_lshl_b32 s65,s65,14
s_add_u32 s64,s64,s65
s_and_b32 s65,s59,15
s_lshl_b32 s65,s65,9
s_add_u32 s64,s64,s65
s_add_u32 s73,s64,s67
s_add_u32 s73,s73,142606336
s_cmp_eq_u32 s50,1
s_cselect_b32 s54,2048 - 256,0
s_sub_u32 s71,s71,s54
s_lshl_b32 s64,s58,15
s_lshl_b32 s65,s50,13
s_add_u32 s74,s64,s65
s_add_u32 s74,s74,134250496
s_lshl_b32 s64,s57,10
s_and_b32 s65,s50,1
s_lshl_b32 s65,s65,9
s_cmp_gt_u32 s50,1
s_cselect_b32 s65,0,s65
s_add_u32 s75,s64,s65
s_add_u32 s75,s75,134250496
s_lshl_b32 s64,s57,12
s_and_b32 s65,s64,0xffffe000
s_cmp_eq_u32 s50,3
s_cselect_b32 s66,1536,0
s_add_u32 s64,s64,s66
s_cmp_gt_u32 s50,1
s_cselect_b32 s76,s64,s65
s_add_u32 s76,s76,134479872
s_lshl_b32 s64,s57,14
s_and_b32 s65,s50,1
s_lshl_b32 s66,s65,11
s_add_u32 s77,s64,s66
s_cmp_gt_u32 s50,1
s_cselect_b32 s66,0,4096
s_add_u32 s77,s77,s66
s_add_u32 s77,s77,0
s_lshl_b32 s66,s65,9
s_add_u32 s66,s66,1024 + 128
s_lshl_b32 s65,s65,7
s_cmp_gt_u32 s50,1
s_cselect_b32 s65,s65,s66
s_add_u32 s78,s64,s65
s_add_u32 s78,s78,67108736
s_lshl_b32 s64,s57,6
s_add_u32 s68,s64,s67
s_add_u32 s69,s68,s64
s_add_u32 s69,s69,138428416
s_lshl_b32 s64,s50,14
s_add_u32 s69,s69,s64
s_and_b32 s64,s50,1
s_lshl_b32 s64,s64,11
s_sub_u32 s69,s69,s64
s_add_u32 s68,s68,138412032
s_mov_b32 s79,0
s_mov_b32 s91,0
s_mov_b32 s90,100000
s_barrier
s_cmp_eq_u32 s56,1
s_cbranch_scc1 recslow_100191
s_mov_b32 s55,0
s_cmp_lg_u32 s50,0
s_cbranch_scc1 np0_100200
v_mov_b32 v120,0
v_mov_b32 v121,0
s_cmp_lg_u32 s58,0
s_cbranch_scc1 z1_100201
v_lshrrev_b32 v124,6,v127
v_lshlrev_b32 v124,12,v124
v_bfe_u32 v125,v127,1,5
v_add_u32 v124,v124,v125
s_lshl_b32 s64,s59,6
buffer_load_ushort v120,v124,s[44:47],s64 offen
buffer_load_ushort v122,v124,s[44:47],s64 offen offset:32
buffer_load_ushort v121,v124,s[44:47],s64 offen offset:2048
buffer_load_ushort v123,v124,s[44:47],s64 offen offset:2080
s_waitcnt vmcnt(0)
v_lshl_or_b32 v120,v122,16,v120
v_lshl_or_b32 v121,v123,16,v121
v_min_u32 v120,s81,v120
v_min_u32 v121,s81,v121
z1_100201:
buffer_store_dword v120,v4,s[20:23],s71 offen
buffer_store_dword v121,v4,s[20:23],s71 offen offset:32
buffer_store_dword v120,v4,s[20:23],s73 offen sc1
buffer_store_dword v121,v4,s[20:23],s73 offen offset:32 sc1
np0_100200:
v_lshrrev_b32 v124,2,v0
v_bfe_u32 v125,v124,5,1
v_mul_u32_u24 v125,2048,v125
s_and_b32 s64,s50,1
s_lshl_b32 s64,s64,5
v_add3_u32 v4,v124,v125,s64
s_add_u32 s64,s79,0
s_cmp_gt_u32 s91,s64
s_cbranch_scc0 flp_100204
fok_100203:
s_add_u32 s64,s79,0
s_lshl_b32 s65,s64,12
s_and_b32 s65,s65,0x2000
s_xor_b32 s65,s65,s67
s_lshl_b32 s64,s64,20
s_add_u32 s65,s65,s64
s_add_u32 s99,s65,s77
buffer_load_dwordx4 v[104:107],v0,s[20:23],s99 offen
buffer_load_dwordx4 v[108:111],v0,s[20:23],s99 offen offset:1024
s_waitcnt vmcnt(0)
s_mov_b32 s92,s70
s_mov_b32 s93,s72
s_mov_b32 s94,s76
s_add_u32 s95,s94,4096
s_mov_b32 s96,s74
s_add_u32 s97,s96,4096
s_mov_b32 s98,s75
s_barrier
v_mov_b32 v96,v104
v_mov_b32 v97,v105
v_mov_b32 v98,v106
v_mov_b32 v99,v107
v_mov_b32 v100,v108
v_mov_b32 v101,v109
v_mov_b32 v102,v110
v_mov_b32 v103,v111
v_mov_b32 v48,0
v_mov_b32 v49,0
v_mov_b32 v50,0
v_mov_b32 v51,0
v_mov_b32 v52,0
v_mov_b32 v53,0
v_mov_b32 v54,0
v_mov_b32 v55,0
v_mov_b32 v56,0
v_mov_b32 v57,0
v_mov_b32 v58,0
v_mov_b32 v59,0
v_mov_b32 v60,0
v_mov_b32 v61,0
v_mov_b32 v62,0
v_mov_b32 v63,0
v_mov_b32 v64,0
v_mov_b32 v65,0
v_mov_b32 v66,0
v_mov_b32 v67,0
v_mov_b32 v68,0
v_mov_b32 v69,0
v_mov_b32 v70,0
v_mov_b32 v71,0
v_mov_b32 v72,0
v_mov_b32 v73,0
v_mov_b32 v74,0
v_mov_b32 v75,0
v_mov_b32 v76,0
v_mov_b32 v77,0
v_mov_b32 v78,0
v_mov_b32 v79,0
v_mov_b32 v80,0
v_mov_b32 v81,0
v_mov_b32 v82,0
v_mov_b32 v83,0
v_mov_b32 v84,0
v_mov_b32 v85,0
v_mov_b32 v86,0
v_mov_b32 v87,0
v_mov_b32 v88,0
v_mov_b32 v89,0
v_mov_b32 v90,0
v_mov_b32 v91,0
v_mov_b32 v92,0
v_mov_b32 v93,0
v_mov_b32 v94,0
v_mov_b32 v95,0
s_cmp_gt_u32 s50,1
s_cbranch_scc0 loop0_100202x
loop_100198:
v_mov_b32 v125,0
s_nop 1
v_mfma_f32_16x16x1_4b_f32 v[48:63],v125,v125,0
v_mfma_f32_16x16x1_4b_f32 v[64:79],v125,v125,0
v_mfma_f32_16x16x1_4b_f32 v[80:95],v125,v125,0
s_nop 15
s_nop 15
s_nop 15
s_nop 15
buffer_load_dwordx4 v[16:19],v0,s[20:23],s92 offen offset:0 sc1
s_nop 7
buffer_load_dwordx4 v[20:23],v0,s[20:23],s92 offen offset:1024 sc1
s_nop 7
buffer_load_dwordx4 v[24:27],v0,s[20:23],s92 offen offset:2048 sc1
s_nop 7
buffer_load_dwordx4 v[28:31],v0,s[20:23],s92 offen offset:3072 sc1
v_mov_b32 v96,v104
v_mov_b32 v97,v105
v_mov_b32 v98,v106
v_mov_b32 v99,v107
v_mov_b32 v100,v108
v_mov_b32 v101,v109
v_mov_b32 v102,v110
v_mov_b32 v103,v111
s_branch ja_100205
loop0_100202x:
v_mov_b32 v125,0
s_nop 1
v_mfma_f32_16x16x1_4b_f32 v[48:63],v125,v125,0
v_mfma_f32_16x16x1_4b_f32 v[64:79],v125,v125,0
v_mfma_f32_16x16x1_4b_f32 v[80:95],v125,v125,0
s_nop 15
s_nop 11
buffer_load_dwordx4 v[16:19],v0,s[20:23],s92 offen offset:0 sc1
s_nop 7
buffer_load_dwordx4 v[20:23],v0,s[20:23],s92 offen offset:1024 sc1
s_nop 7
buffer_load_dwordx4 v[24:27],v0,s[20:23],s92 offen offset:2048 sc1
s_nop 7
buffer_load_dwordx4 v[28:31],v0,s[20:23],s92 offen offset:3072 sc1
ja_100205:
s_max_u32 s66,s79,1
s_sub_u32 s66,s66,1
v_mov_b32 v126,s66
v_cndmask_b32 v120,2.0,v0,s[82:83]
v_cndmask_b32 v121,2.0,v127,s[86:87]
s_add_u32 s64,s66,0
s_lshl_b32 s65,s64,12
s_and_b32 s65,s65,0x2000
s_xor_b32 s65,s65,s67
s_lshl_b32 s64,s64,20
s_add_u32 s65,s65,s64
s_add_u32 s101,s65,s78
s_cmp_eq_u32 s79,63
s_cbranch_scc1 last_100199
s_add_u32 s64,s79,1
s_cmp_gt_u32 s91,s64
s_cbranch_scc0 flp_100207
fok_100206:
s_add_u32 s64,s79,1
s_lshl_b32 s65,s64,12
s_and_b32 s65,s65,0x2000
s_xor_b32 s65,s65,s67
s_lshl_b32 s64,s64,20
s_add_u32 s65,s65,s64
s_add_u32 s99,s65,s77
s_waitcnt vmcnt(3)
v_max3_u32 v124,v16,v17,v18
v_max_u32 v124,v124,v19
v_cmp_eq_u32 vcc,-1,v124
s_cbranch_vccnz flb_100232
seg_100208:
segb_100216:
v_smfmac_f32_16x16x64_bf16 v[48:51],v[16:19],a[0:7],v1
buffer_load_dword v125,off,s[20:23],s92 sc1
v_smfmac_f32_16x16x64_bf16 v[52:55],v[16:19],a[8:15],v1
buffer_load_dwordx4 v[32:35],v0,s[20:23],s93 offen offset:0 sc1
v_smfmac_f32_16x16x64_bf16 v[56:59],v[16:19],a[16:23],v1
s_waitcnt vmcnt(4)
v_max3_u32 v124,v20,v21,v22
v_smfmac_f32_16x16x64_bf16 v[60:63],v[16:19],a[24:31],v1
v_max_u32 v124,v124,v23
v_smfmac_f32_16x16x64_bf16 v[64:67],v[16:19],a[32:39],v1
v_cmp_eq_u32 vcc,-1,v124
v_smfmac_f32_16x16x64_bf16 v[68:71],v[16:19],a[40:47],v1
v_smfmac_f32_16x16x64_bf16 v[72:75],v[16:19],a[48:55],v1
s_cbranch_vccnz fl_100225
seg_100209:
v_smfmac_f32_16x16x64_bf16 v[76:79],v[16:19],a[56:63],v1
segb_100217:
v_smfmac_f32_16x16x64_bf16 v[48:51],v[20:23],a[64:71],v1
buffer_load_dword v125,off,s[20:23],s92 sc1
v_smfmac_f32_16x16x64_bf16 v[52:55],v[20:23],a[72:79],v1
buffer_load_dwordx4 v[36:39],v0,s[20:23],s93 offen offset:1024 sc1
v_smfmac_f32_16x16x64_bf16 v[56:59],v[20:23],a[80:87],v1
s_waitcnt vmcnt(5)
v_max3_u32 v124,v24,v25,v26
v_smfmac_f32_16x16x64_bf16 v[60:63],v[20:23],a[88:95],v1
v_max_u32 v124,v124,v27
v_smfmac_f32_16x16x64_bf16 v[64:67],v[20:23],a[96:103],v1
v_cmp_eq_u32 vcc,-1,v124
v_smfmac_f32_16x16x64_bf16 v[68:71],v[20:23],a[104:111],v1
v_smfmac_f32_16x16x64_bf16 v[72:75],v[20:23],a[112:119],v1
s_cbranch_vccnz fl_100226
seg_100210:
v_smfmac_f32_16x16x64_bf16 v[76:79],v[20:23],a[120:127],v1
segb_100218:
v_smfmac_f32_16x16x64_bf16 v[48:51],v[24:27],a[128:135],v1
buffer_load_dword v125,off,s[20:23],s92 sc1
v_smfmac_f32_16x16x64_bf16 v[52:55],v[24:27],a[136:143],v1
buffer_load_dwordx4 v[40:43],v0,s[20:23],s93 offen offset:2048 sc1
v_smfmac_f32_16x16x64_bf16 v[56:59],v[24:27],a[144:151],v1
buffer_load_dwordx4 v[44:47],v0,s[20:23],s93 offen offset:3072 sc1
s_waitcnt vmcnt(7)
v_max3_u32 v124,v28,v29,v30
v_smfmac_f32_16x16x64_bf16 v[60:63],v[24:27],a[152:159],v1
v_max_u32 v124,v124,v31
v_smfmac_f32_16x16x64_bf16 v[64:67],v[24:27],a[160:167],v1
v_cmp_eq_u32 vcc,-1,v124
v_smfmac_f32_16x16x64_bf16 v[68:71],v[24:27],a[168:175],v1
v_smfmac_f32_16x16x64_bf16 v[72:75],v[24:27],a[176:183],v1
s_cbranch_vccnz fl_100227
seg_100211:
v_smfmac_f32_16x16x64_bf16 v[76:79],v[24:27],a[184:191],v1
segb_100219:
v_smfmac_f32_16x16x64_bf16 v[48:51],v[28:31],a[192:199],v1
buffer_load_dword v125,off,s[20:23],s92 sc1
v_smfmac_f32_16x16x64_bf16 v[52:55],v[28:31],a[200:207],v1
v_smfmac_f32_16x16x64_bf16 v[56:59],v[28:31],a[208:215],v1
s_waitcnt vmcnt(6)
v_max3_u32 v124,v32,v33,v34
v_smfmac_f32_16x16x64_bf16 v[60:63],v[28:31],a[216:223],v1
v_max_u32 v124,v124,v35
v_smfmac_f32_16x16x64_bf16 v[64:67],v[28:31],a[224:231],v1
v_cmp_eq_u32 vcc,-1,v124
v_smfmac_f32_16x16x64_bf16 v[68:71],v[28:31],a[232:239],v1
v_smfmac_f32_16x16x64_bf16 v[72:75],v[28:31],a[240:247],v1
s_cbranch_vccnz fl_100228
seg_100212:
v_smfmac_f32_16x16x64_bf16 v[76:79],v[28:31],a[248:255],v1
segb_100220:
v_smfmac_f32_16x16x64_bf16 v[48:51],v[32:35],a[0:7],v1
buffer_load_dword v125,off,s[20:23],s92 sc1
v_smfmac_f32_16x16x64_bf16 v[52:55],v[32:35],a[8:15],v1
buffer_store_dwordx4 v[112:115],v120,s[20:23],s101 offen sc1
v_smfmac_f32_16x16x64_bf16 v[56:59],v[32:35],a[16:23],v1
buffer_store_dword v126,v121,s[20:23],s69 offen sc1
s_waitcnt vmcnt(7)
v_max3_u32 v124,v36,v37,v38
v_smfmac_f32_16x16x64_bf16 v[60:63],v[32:35],a[24:31],v1
v_max_u32 v124,v124,v39
v_smfmac_f32_16x16x64_bf16 v[64:67],v[32:35],a[32:39],v1
v_cmp_eq_u32 vcc,-1,v124
v_smfmac_f32_16x16x64_bf16 v[68:71],v[32:35],a[40:47],v1
v_smfmac_f32_16x16x64_bf16 v[72:75],v[32:35],a[48:55],v1
s_cbranch_vccnz fl_100229
seg_100213:
v_smfmac_f32_16x16x64_bf16 v[76:79],v[32:35],a[56:63],v1
segb_100221:
v_smfmac_f32_16x16x64_bf16 v[48:51],v[36:39],a[64:71],v1
buffer_load_dword v125,off,s[20:23],s92 sc1
s_waitcnt vmcnt(5)
v_max3_u32 v124,v40,v41,v42
v_smfmac_f32_16x16x64_bf16 v[52:55],v[36:39],a[72:79],v1
v_max3_u32 v124,v124,v43,v44
v_smfmac_f32_16x16x64_bf16 v[56:59],v[36:39],a[80:87],v1
v_max3_u32 v124,v124,v45,v46
v_smfmac_f32_16x16x64_bf16 v[60:63],v[36:39],a[88:95],v1
v_max_u32 v124,v124,v47
v_smfmac_f32_16x16x64_bf16 v[64:67],v[36:39],a[96:103],v1
v_cmp_eq_u32 vcc,-1,v124
v_smfmac_f32_16x16x64_bf16 v[68:71],v[36:39],a[104:111],v1
v_smfmac_f32_16x16x64_bf16 v[72:75],v[36:39],a[112:119],v1
s_cbranch_vccnz fl_100230
seg_100214:
v_smfmac_f32_16x16x64_bf16 v[76:79],v[36:39],a[120:127],v1
segb_100222:
v_smfmac_f32_16x16x64_bf16 v[48:51],v[40:43],a[128:135],v1
buffer_load_dwordx4 v[104:107],v0,s[20:23],s99 offen
buffer_load_dwordx4 v[108:111],v0,s[20:23],s99 offen offset:1024
v_smfmac_f32_16x16x64_bf16 v[52:55],v[40:43],a[136:143],v1
buffer_load_dword v126,off,s[20:23],s68 sc1
s_add_u32 s64,s79,2
v_smfmac_f32_16x16x64_bf16 v[48:51],v[44:47],a[192:199],v1
s_and_b32 s64,s64,3
s_lshl_b32 s100,s64,19
v_smfmac_f32_16x16x64_bf16 v[52:55],v[44:47],a[200:207],v1
v_smfmac_f32_16x16x64_bf16 v[56:59],v[40:43],a[144:151],v1
v_add_f32 v48,v48,v49
v_smfmac_f32_16x16x64_bf16 v[60:63],v[40:43],a[152:159],v1
ds_write_addtid_b32 v48 offset:0
v_add_f32 v50,v50,v51
v_smfmac_f32_16x16x64_bf16 v[56:59],v[44:47],a[208:215],v1
ds_write_addtid_b32 v50 offset:1040
v_add_f32 v52,v52,v53
v_smfmac_f32_16x16x64_bf16 v[60:63],v[44:47],a[216:223],v1
ds_write_addtid_b32 v52 offset:2080
v_add_f32 v54,v54,v55
v_smfmac_f32_16x16x64_bf16 v[64:67],v[40:43],a[160:167],v1
ds_write_addtid_b32 v54 offset:3120
v_add_f32 v56,v56,v57
v_smfmac_f32_16x16x64_bf16 v[68:71],v[40:43],a[168:175],v1
ds_write_addtid_b32 v56 offset:4160
v_add_f32 v58,v58,v59
v_smfmac_f32_16x16x64_bf16 v[64:67],v[44:47],a[224:231],v1
ds_write_addtid_b32 v58 offset:5200
v_add_f32 v60,v60,v61
v_smfmac_f32_16x16x64_bf16 v[68:71],v[44:47],a[232:239],v1
ds_write_addtid_b32 v60 offset:6240
v_add_f32 v62,v62,v63
v_smfmac_f32_16x16x64_bf16 v[72:75],v[40:43],a[176:183],v1
ds_write_addtid_b32 v62 offset:7280
v_add_f32 v64,v64,v65
v_smfmac_f32_16x16x64_bf16 v[76:79],v[40:43],a[184:191],v1
ds_write_addtid_b32 v64 offset:8448
v_add_f32 v66,v66,v67
v_smfmac_f32_16x16x64_bf16 v[72:75],v[44:47],a[240:247],v1
ds_write_addtid_b32 v66 offset:9488
v_add_f32 v68,v68,v69
v_smfmac_f32_16x16x64_bf16 v[76:79],v[44:47],a[248:255],v1
ds_write_addtid_b32 v68 offset:10528
v_add_f32 v70,v70,v71
v_smfmac_f32_16x16x64_bf16 v[80:83],v[16:19],v[208:215],v1
ds_write_addtid_b32 v70 offset:11568
v_add_f32 v72,v72,v73
v_smfmac_f32_16x16x64_bf16 v[80:83],v[32:35],v[208:215],v1
ds_write_addtid_b32 v72 offset:12608
v_add_f32 v74,v74,v75
ds_write_addtid_b32 v74 offset:13648
v_add_f32 v76,v76,v77
v_add_f32 v78,v78,v79
ds_write_addtid_b32 v76 offset:14688
ds_write_addtid_b32 v78 offset:15728
doneA_100241:
s_waitcnt lgkmcnt(0)
s_barrier
s_cmp_gt_u32 s50,1
s_cbranch_scc1 w23_100242
v_smfmac_f32_16x16x64_bf16 v[84:87],v[16:19],v[216:223],v1
v_smfmac_f32_16x16x64_bf16 v[84:87],v[32:35],v[216:223],v1
v_smfmac_f32_16x16x64_bf16 v[88:91],v[16:19],v[224:231],v1
v_smfmac_f32_16x16x64_bf16 v[88:91],v[32:35],v[224:231],v1
v_smfmac_f32_16x16x64_bf16 v[92:95],v[16:19],v[232:239],v1
ds_read_b128 v[48:51],v7 offset:0
ds_read_b128 v[52:55],v7 offset:1024
v_smfmac_f32_16x16x64_bf16 v[92:95],v[32:35],v[232:239],v1
ds_read_b128 v[56:59],v7 offset:2048
ds_read_b128 v[60:63],v7 offset:3072
v_smfmac_f32_16x16x64_bf16 v[80:83],v[20:23],v[240:247],v1
ds_read_b128 v[64:67],v7 offset:4096
ds_read_b128 v[68:71],v7 offset:5120
v_smfmac_f32_16x16x64_bf16 v[80:83],v[36:39],v[240:247],v1
ds_read_b128 v[72:75],v7 offset:6144
ds_read_b128 v[76:79],v7 offset:7168
v_smfmac_f32_16x16x64_bf16 v[84:87],v[20:23],v[248:255],v1
v_smfmac_f32_16x16x64_bf16 v[84:87],v[36:39],v[248:255],v1
s_waitcnt lgkmcnt(6)
v_smfmac_f32_16x16x64_bf16 v[88:91],v[20:23],v[48:55],v1
v_smfmac_f32_16x16x64_bf16 v[88:91],v[36:39],v[48:55],v1
ds_read_b128 v[48:51],v7 offset:8192
ds_read_b128 v[52:55],v7 offset:9216
s_waitcnt lgkmcnt(6)
v_smfmac_f32_16x16x64_bf16 v[92:95],v[20:23],v[56:63],v1
v_smfmac_f32_16x16x64_bf16 v[92:95],v[36:39],v[56:63],v1
ds_read_b128 v[56:59],v7 offset:10240
ds_read_b128 v[60:63],v7 offset:11264
s_waitcnt lgkmcnt(6)
v_smfmac_f32_16x16x64_bf16 v[80:83],v[24:27],v[64:71],v1
v_smfmac_f32_16x16x64_bf16 v[80:83],v[40:43],v[64:71],v1
ds_read_b128 v[64:67],v7 offset:12288
ds_read_b128 v[68:71],v7 offset:13312
s_waitcnt lgkmcnt(6)
v_smfmac_f32_16x16x64_bf16 v[84:87],v[24:27],v[72:79],v1
v_smfmac_f32_16x16x64_bf16 v[84:87],v[40:43],v[72:79],v1
ds_read_b128 v[72:75],v7 offset:14336
ds_read_b128 v[76:79],v7 offset:15360
s_waitcnt lgkmcnt(6)
v_smfmac_f32_16x16x64_bf16 v[88:91],v[24:27],v[48:55],v1
v_smfmac_f32_16x16x64_bf16 v[88:91],v[40:43],v[48:55],v1
ds_read_b128 v[48:51],v7 offset:16384
ds_read_b128 v[52:55],v7 offset:17408
s_waitcnt lgkmcnt(6)
v_smfmac_f32_16x16x64_bf16 v[92:95],v[24:27],v[56:63],v1
v_smfmac_f32_16x16x64_bf16 v[92:95],v[40:43],v[56:63],v1
ds_read_b128 v[56:59],v7 offset:18432
ds_read_b128 v[60:63],v7 offset:19456
s_waitcnt lgkmcnt(6)
v_smfmac_f32_16x16x64_bf16 v[80:83],v[28:31],v[64:71],v1
v_smfmac_f32_16x16x64_bf16 v[80:83],v[44:47],v[64:71],v1
s_waitcnt lgkmcnt(4)
v_smfmac_f32_16x16x64_bf16 v[84:87],v[28:31],v[72:79],v1
v_smfmac_f32_16x16x64_bf16 v[84:87],v[44:47],v[72:79],v1
s_waitcnt lgkmcnt(2)
v_smfmac_f32_16x16x64_bf16 v[88:91],v[28:31],v[48:55],v1
v_add_f32 v80,v80,v81
v_smfmac_f32_16x16x64_bf16 v[88:91],v[44:47],v[48:55],v1
v_add_f32 v82,v82,v83
s_waitcnt lgkmcnt(0)
v_smfmac_f32_16x16x64_bf16 v[92:95],v[28:31],v[56:63],v1
v_cvt_pk_bf16_f32 v80,v80,v82
v_smfmac_f32_16x16x64_bf16 v[92:95],v[44:47],v[56:63],v1
ds_write_addtid_b32 v80 offset:16896
v_add_f32 v84,v84,v85
buffer_load_dwordx4 v[16:19],v2,s[20:23],s94 offen offset:0 sc1
buffer_load_dwordx4 v[32:35],v2,s[20:23],s94 offen offset:1536 sc1
buffer_load_dwordx4 v[20:23],v2,s[20:23],s95 offen offset:0 sc1
buffer_load_dwordx4 v[36:39],v2,s[20:23],s95 offen offset:1536 sc1
buffer_load_dword v120,v3,s[20:23],s94 offen offset:0 sc1
buffer_load_dword v121,v3,s[20:23],s94 offen offset:1536 sc1
buffer_load_dword v122,v3,s[20:23],s95 offen offset:0 sc1
buffer_load_dword v123,v3,s[20:23],s95 offen offset:1536 sc1
v_add_f32 v86,v86,v87
v_cvt_pk_bf16_f32 v84,v84,v86
v_add_f32 v88,v88,v89
v_add_f32 v90,v90,v91
v_cvt_pk_bf16_f32 v88,v88,v90
v_add_f32 v92,v92,v93
v_add_f32 v94,v94,v95
v_cvt_pk_bf16_f32 v92,v92,v94
ds_write_addtid_b32 v84 offset:17920
ds_write_addtid_b32 v88 offset:18944
ds_write_addtid_b32 v92 offset:19968
sp_100245:
s_waitcnt vmcnt(6)
v_pk_add_f32 v[16:17],v[16:17],v[32:33]
v_pk_add_f32 v[18:19],v[18:19],v[34:35]
s_waitcnt vmcnt(4)
v_pk_add_f32 v[20:21],v[20:21],v[36:37]
v_pk_add_f32 v[22:23],v[22:23],v[38:39]
v_pk_add_f32 v[16:17],v[16:17],v[20:21]
v_pk_add_f32 v[18:19],v[18:19],v[22:23]
v_max3_f32 v124,v16,v17,v18
v_pk_add_f32 v[20:21],v[16:17],v[18:19]
s_waitcnt vmcnt(0)
v_pk_add_f32 v[120:121],v[120:121],v[122:123]
v_add_f32 v120,v120,v121
v_max3_f32 v124,v124,v19,v120
v_add_f32 v20,v20,v120
v_cmp_u_f32 vcc,v20,v21
v_max_f32_dpp v124,v124,v124 row_ror:8 row_mask:0xf bank_mask:0xf
v_mov_b32 v125,v124
s_cbranch_vccnz srt_100247
sok_100246:
s_nop 0
v_permlane16_swap_b32 v125,v124
v_max_f32 v124,v124,v125
v_mov_b32 v125,v124
s_nop 1
v_permlane32_swap_b32 v125,v124
v_max_f32 v124,v124,v125
v_mul_f32 v124,s80,v124
v_fma_f32 v16,v16,s80,-v124
v_fma_f32 v17,v17,s80,-v124
v_fma_f32 v18,v18,s80,-v124
v_fma_f32 v19,v19,s80,-v124
v_fma_f32 v120,v120,s80,-v124
s_waitcnt lgkmcnt(0)
s_barrier
ds_read2st64_b32 v[112:113],v127 offset0:66 offset1:67
ds_read2st64_b32 v[114:115],v127 offset0:68 offset1:69
ds_read2st64_b32 v[116:117],v127 offset0:70 offset1:71
ds_read2st64_b32 v[118:119],v127 offset0:72 offset1:73
v_exp_f32 v16,v16
v_exp_f32 v17,v17
v_exp_f32 v18,v18
v_exp_f32 v19,v19
v_cvt_pk_bf16_f32 v48,v16,v17
v_cvt_pk_bf16_f32 v49,v18,v19
v_exp_f32 v120,v120
v_mov_b32_dpp v50,v48 row_ror:8 row_mask:0xf bank_mask:0xf
v_mov_b32_dpp v51,v49 row_ror:8 row_mask:0xf bank_mask:0xf
v_mov_b32_dpp v121,v120 row_ror:8 row_mask:0xf bank_mask:0xf
v_cvt_pk_bf16_f32 v52,v120,v121
v_mfma_f32_16x16x32_bf16 v[64:67],v[8:11],v[48:51],0
v_mov_b32 v53,v52
v_mfma_f32_16x16x32_bf16 v[56:59],v[96:99],v[48:51],0
v_mov_b32 v54,v52
v_mov_b32 v55,v52
v_mfma_f32_16x16x32_bf16 v[60:63],v[100:103],v[48:51],0
v_mfma_f32_16x16x32_bf16 v[64:67],v[12:15],v[52:55],v[64:67]
s_waitcnt lgkmcnt(0)
v_mfma_f32_16x16x32_bf16 v[56:59],v[112:115],v[52:55],v[56:59]
v_mfma_f32_16x16x32_bf16 v[60:63],v[116:119],v[52:55],v[60:63]
s_nop 0
v_rcp_f32 v66,v64
s_nop 2
v_pk_mul_f32 v[56:57],v[56:57],v[66:67] op_sel_hi:[1,0]
v_pk_mul_f32 v[58:59],v[58:59],v[66:67] op_sel_hi:[1,0]
s_nop 0
v_pk_mul_f32 v[60:61],v[60:61],v[66:67] op_sel_hi:[1,0]
v_pk_mul_f32 v[62:63],v[62:63],v[66:67] op_sel_hi:[1,0]
v_cvt_pk_bf16_f32 v120,v56,v57
v_cvt_pk_bf16_f32 v121,v58,v59
v_cvt_pk_bf16_f32 v122,v60,v61
v_cvt_pk_bf16_f32 v123,v62,v63
buffer_store_dwordx4 v[120:123],v6,s[20:23],s98 offen
s_barrier
ds_read_b128 v[48:51],v7 offset:20480
ds_read_b128 v[52:55],v7 offset:21504
ds_read_b128 v[56:59],v7 offset:22528
ds_read_b128 v[60:63],v7 offset:23552
ds_read_b128 v[64:67],v7 offset:24576
ds_read_b128 v[68:71],v7 offset:25600
ds_read_b128 v[72:75],v7 offset:26624
ds_read_b128 v[76:79],v7 offset:27648
ds_read_b128 v[80:83],v7 offset:28672
ds_read_b128 v[84:87],v7 offset:29696
ds_read_b128 v[88:91],v7 offset:30720
ds_read_b128 v[92:95],v7 offset:31744
v_mov_b32 v96,0
v_mov_b32 v97,0
v_mov_b32 v98,0
v_mov_b32 v99,0
v_mov_b32 v100,0
v_mov_b32 v101,0
v_mov_b32 v102,0
v_mov_b32 v103,0
s_nop 11
buffer_load_dwordx4 v[16:19],v0,s[20:23],s96 offen offset:0 sc1
v_mov_b32 v120,v5
v_mov_b32 v121,v5
v_mov_b32 v122,v5
v_mov_b32 v123,v5
s_nop 1
v_mfma_f32_16x16x32_bf16 v[112:115],v[120:123],v[112:115],0
buffer_load_dwordx4 v[20:23],v0,s[20:23],s96 offen offset:1024 sc1
v_mfma_f32_16x16x32_bf16 v[116:119],v[120:123],v[116:119],0
s_add_u32 s79,s79,1
s_and_b32 s64,s79,3
s_lshl_b32 s64,s64,19
s_lshl_b32 s65,s79,8
buffer_load_dwordx4 v[24:27],v0,s[20:23],s96 offen offset:2048 sc1
s_and_b32 s65,s65,0x2000
s_lshl_b32 s66,s79,16
s_xor_b32 s88,s73,s65
s_add_u32 s88,s88,s66
s_sub_u32 s88,s88,s54
s_add_u32 s89,s71,s64
s_add_u32 s92,s70,s64
s_xor_b32 s93,s72,s65
buffer_load_dwordx4 v[28:31],v0,s[20:23],s96 offen offset:3072 sc1
s_add_u32 s93,s93,s66
s_add_u32 s94,s76,s64
s_add_u32 s95,s94,4096
s_add_u32 s98,s75,s64
s_add_u32 s60,s74,s64
v_cvt_pk_bf16_f32 v112,v112,v113
v_cvt_pk_bf16_f32 v113,v114,v115
v_cvt_pk_bf16_f32 v114,v116,v117
buffer_load_dwordx4 v[32:35],v0,s[20:23],s97 offen offset:0 sc1
v_cvt_pk_bf16_f32 v115,v118,v119
s_nop 6
buffer_load_dwordx4 v[36:39],v0,s[20:23],s97 offen offset:1024 sc1
s_nop 7
buffer_load_dwordx4 v[40:43],v0,s[20:23],s97 offen offset:2048 sc1
s_nop 7
buffer_load_dwordx4 v[44:47],v0,s[20:23],s97 offen offset:3072 sc1
s_branch ogo_100243
w23_100242:
ds_read_b128 v[48:51],v2 offset:0
ds_read_b128 v[52:55],v2 offset:256
ds_read_b128 v[56:59],v2 offset:512
ds_read_b128 v[60:63],v2 offset:768
ds_read_b128 v[64:67],v2 offset:16
ds_read_b128 v[68:71],v2 offset:272
ds_read_b128 v[72:75],v2 offset:528
ds_read_b128 v[76:79],v2 offset:784
s_waitcnt lgkmcnt(6)
v_pk_add_f32 v[48:49],v[48:49],v[52:53]
v_pk_add_f32 v[50:51],v[50:51],v[54:55]
s_waitcnt lgkmcnt(4)
v_pk_add_f32 v[56:57],v[56:57],v[60:61]
v_pk_add_f32 v[58:59],v[58:59],v[62:63]
v_pk_add_f32 v[48:49],v[48:49],v[56:57]
v_pk_add_f32 v[50:51],v[50:51],v[58:59]
v_cvt_pk_bf16_f32 v112,v48,v49
v_cvt_pk_bf16_f32 v113,v50,v51
s_waitcnt lgkmcnt(2)
v_pk_add_f32 v[64:65],v[64:65],v[68:69]
v_pk_add_f32 v[66:67],v[66:67],v[70:71]
s_waitcnt lgkmcnt(0)
v_pk_add_f32 v[72:73],v[72:73],v[76:77]
v_pk_add_f32 v[74:75],v[74:75],v[78:79]
v_pk_add_f32 v[64:65],v[64:65],v[72:73]
v_pk_add_f32 v[66:67],v[66:67],v[74:75]
v_cvt_pk_bf16_f32 v114,v64,v65
v_cvt_pk_bf16_f32 v115,v66,v67
s_nop 1
v_mfma_f32_16x16x32_bf16 v[116:119],v[96:99],v[112:115],0
v_mfma_f32_16x16x32_bf16 v[120:123],v[100:103],v[112:115],0
v_mfma_f32_16x16x32_bf16 v[12:15],v[112:115],v[112:115],0
ds_read_b128 v[48:51],v7 offset:0
ds_read_b128 v[52:55],v7 offset:1024
ds_read_b128 v[56:59],v7 offset:2048
ds_read_b128 v[60:63],v7 offset:3072
ds_read_b128 v[64:67],v7 offset:4096
buffer_store_dwordx4 v[116:119],v3,s[20:23],s94 offen
buffer_store_dwordx4 v[120:123],v3,s[20:23],s94 offen offset:512
s_nop 0
buffer_store_dwordx4 v[12:15],v3,s[20:23],s94 offen offset:1024
ds_read_b128 v[68:71],v7 offset:5120
ds_read_b128 v[72:75],v7 offset:6144
ds_read_b128 v[76:79],v7 offset:7168
v_smfmac_f32_16x16x64_bf16 v[84:87],v[16:19],v[216:223],v1
v_smfmac_f32_16x16x64_bf16 v[84:87],v[32:35],v[216:223],v1
v_smfmac_f32_16x16x64_bf16 v[88:91],v[16:19],v[224:231],v1
v_smfmac_f32_16x16x64_bf16 v[88:91],v[32:35],v[224:231],v1
v_smfmac_f32_16x16x64_bf16 v[92:95],v[16:19],v[232:239],v1
v_smfmac_f32_16x16x64_bf16 v[92:95],v[32:35],v[232:239],v1
v_smfmac_f32_16x16x64_bf16 v[80:83],v[20:23],v[240:247],v1
v_smfmac_f32_16x16x64_bf16 v[80:83],v[36:39],v[240:247],v1
v_smfmac_f32_16x16x64_bf16 v[84:87],v[20:23],v[248:255],v1
v_smfmac_f32_16x16x64_bf16 v[84:87],v[36:39],v[248:255],v1
s_waitcnt lgkmcnt(6)
v_smfmac_f32_16x16x64_bf16 v[88:91],v[20:23],v[48:55],v1
v_smfmac_f32_16x16x64_bf16 v[88:91],v[36:39],v[48:55],v1
ds_read_b128 v[48:51],v7 offset:8192
ds_read_b128 v[52:55],v7 offset:9216
s_waitcnt lgkmcnt(6)
v_smfmac_f32_16x16x64_bf16 v[92:95],v[20:23],v[56:63],v1
v_smfmac_f32_16x16x64_bf16 v[92:95],v[36:39],v[56:63],v1
ds_read_b128 v[56:59],v7 offset:10240
ds_read_b128 v[60:63],v7 offset:11264
s_waitcnt lgkmcnt(6)
v_smfmac_f32_16x16x64_bf16 v[80:83],v[24:27],v[64:71],v1
v_smfmac_f32_16x16x64_bf16 v[80:83],v[40:43],v[64:71],v1
ds_read_b128 v[64:67],v7 offset:12288
ds_read_b128 v[68:71],v7 offset:13312
s_waitcnt lgkmcnt(6)
v_smfmac_f32_16x16x64_bf16 v[84:87],v[24:27],v[72:79],v1
v_smfmac_f32_16x16x64_bf16 v[84:87],v[40:43],v[72:79],v1
ds_read_b128 v[72:75],v7 offset:14336
ds_read_b128 v[76:79],v7 offset:15360
s_waitcnt lgkmcnt(6)
v_smfmac_f32_16x16x64_bf16 v[88:91],v[24:27],v[48:55],v1
v_smfmac_f32_16x16x64_bf16 v[88:91],v[40:43],v[48:55],v1
ds_read_b128 v[48:51],v7 offset:16384
ds_read_b128 v[52:55],v7 offset:17408
s_waitcnt lgkmcnt(6)
v_smfmac_f32_16x16x64_bf16 v[92:95],v[24:27],v[56:63],v1
v_smfmac_f32_16x16x64_bf16 v[92:95],v[40:43],v[56:63],v1
ds_read_b128 v[56:59],v7 offset:18432
ds_read_b128 v[60:63],v7 offset:19456
s_waitcnt lgkmcnt(6)
v_smfmac_f32_16x16x64_bf16 v[80:83],v[28:31],v[64:71],v1
v_smfmac_f32_16x16x64_bf16 v[80:83],v[44:47],v[64:71],v1
s_waitcnt lgkmcnt(4)
v_smfmac_f32_16x16x64_bf16 v[84:87],v[28:31],v[72:79],v1
v_smfmac_f32_16x16x64_bf16 v[84:87],v[44:47],v[72:79],v1
s_waitcnt lgkmcnt(2)
v_smfmac_f32_16x16x64_bf16 v[88:91],v[28:31],v[48:55],v1
v_add_f32 v80,v80,v81
v_smfmac_f32_16x16x64_bf16 v[88:91],v[44:47],v[48:55],v1
v_add_f32 v82,v82,v83
s_waitcnt lgkmcnt(0)
v_smfmac_f32_16x16x64_bf16 v[92:95],v[28:31],v[56:63],v1
v_cvt_pk_bf16_f32 v80,v80,v82
v_smfmac_f32_16x16x64_bf16 v[92:95],v[44:47],v[56:63],v1
ds_write_addtid_b32 v80 offset:16896
v_add_f32 v84,v84,v85
v_add_f32 v86,v86,v87
v_cvt_pk_bf16_f32 v84,v84,v86
v_add_f32 v88,v88,v89
v_add_f32 v90,v90,v91
v_cvt_pk_bf16_f32 v88,v88,v90
s_nop 0
v_add_f32 v92,v92,v93
v_add_f32 v94,v94,v95
v_cvt_pk_bf16_f32 v92,v92,v94
ds_write_addtid_b32 v84 offset:17920
ds_write_addtid_b32 v88 offset:18944
ds_write_addtid_b32 v92 offset:19968
s_waitcnt lgkmcnt(0)
s_barrier
ds_read_b128 v[48:51],v7 offset:20480
ds_read_b128 v[52:55],v7 offset:21504
ds_read_b128 v[56:59],v7 offset:22528
ds_read_b128 v[60:63],v7 offset:23552
ds_read_b128 v[64:67],v7 offset:24576
ds_read_b128 v[68:71],v7 offset:25600
ds_read_b128 v[72:75],v7 offset:26624
ds_read_b128 v[76:79],v7 offset:27648
ds_read_b128 v[80:83],v7 offset:28672
ds_read_b128 v[84:87],v7 offset:29696
ds_read_b128 v[88:91],v7 offset:30720
ds_read_b128 v[92:95],v7 offset:31744
s_add_u32 s65,s76,s100
s_add_u32 s66,s75,s100
s_add_u32 s64,s71,s100
s_cmp_eq_u32 s50,2
s_cselect_b32 s66,s66,s64
buffer_store_dwordx4 v[8:11],v0,s[20:23],s65 offen
s_cmp_eq_u32 s50,2
s_cselect_b32 exec_hi,-1,0
buffer_store_dwordx4 v[8:11],v0,s[20:23],s66 offen
s_mov_b32 exec_hi,0
buffer_store_dwordx4 v[8:11],v0,s[20:23],s65 offen offset:1024
s_mov_b64 exec,-1
v_mov_b32 v96,0
v_mov_b32 v97,0
v_mov_b32 v98,0
v_mov_b32 v99,0
v_mov_b32 v100,0
v_mov_b32 v101,0
v_mov_b32 v102,0
v_mov_b32 v103,0
s_barrier
s_nop 15
s_nop 15
s_nop 7
buffer_load_dwordx4 v[16:19],v0,s[20:23],s96 offen offset:0 sc1
s_add_u32 s79,s79,1
s_and_b32 s64,s79,3
s_lshl_b32 s64,s64,19
s_lshl_b32 s65,s79,8
s_and_b32 s65,s65,0x2000
s_lshl_b32 s66,s79,16
s_xor_b32 s88,s73,s65
s_add_u32 s88,s88,s66
buffer_load_dwordx4 v[20:23],v0,s[20:23],s96 offen offset:1024 sc1
s_sub_u32 s88,s88,s54
s_add_u32 s89,s71,s64
s_add_u32 s92,s70,s64
s_xor_b32 s93,s72,s65
s_add_u32 s93,s93,s66
s_add_u32 s94,s76,s64
s_add_u32 s95,s94,4096
s_add_u32 s98,s75,s64
buffer_load_dwordx4 v[24:27],v0,s[20:23],s96 offen offset:2048 sc1
s_add_u32 s60,s74,s64
s_nop 6
buffer_load_dwordx4 v[28:31],v0,s[20:23],s96 offen offset:3072 sc1
s_nop 7
buffer_load_dwordx4 v[32:35],v0,s[20:23],s97 offen offset:0 sc1
s_nop 7
buffer_load_dwordx4 v[36:39],v0,s[20:23],s97 offen offset:1024 sc1
s_nop 7
buffer_load_dwordx4 v[40:43],v0,s[20:23],s97 offen offset:2048 sc1
s_nop 7
buffer_load_dwordx4 v[44:47],v0,s[20:23],s97 offen offset:3072 sc1
ogo_100243:
s_waitcnt lgkmcnt(0)
s_waitcnt vmcnt(6)
v_max3_u32 v124,v16,v17,v18
v_max3_u32 v124,v124,v19,v20
v_max3_u32 v124,v124,v21,v22
v_max_u32 v124,v124,v23
v_cmp_eq_u32 vcc,-1,v124
s_cbranch_vccnz of_100248
v_smfmac_f32_16x16x64_bf16 v[96:99],v[16:19],v[48:55],v1
v_smfmac_f32_16x16x64_bf16 v[100:103],v[16:19],v[56:63],v1
v_smfmac_f32_16x16x64_bf16 v[96:99],v[20:23],v[64:71],v1
v_smfmac_f32_16x16x64_bf16 v[100:103],v[20:23],v[72:79],v1
v_readfirstlane_b32 s91,v126
s_waitcnt vmcnt(4)
v_max3_u32 v124,v24,v25,v26
v_max3_u32 v124,v124,v27,v28
v_max3_u32 v124,v124,v29,v30
v_max_u32 v124,v124,v31
v_cmp_eq_u32 vcc,-1,v124
s_cbranch_vccnz of_100249
v_smfmac_f32_16x16x64_bf16 v[96:99],v[24:27],v[80:87],v1
v_smfmac_f32_16x16x64_bf16 v[100:103],v[24:27],v[88:95],v1
v_smfmac_f32_16x16x64_bf16 v[96:99],v[28:31],v[128:135],v1
v_smfmac_f32_16x16x64_bf16 v[100:103],v[28:31],v[136:143],v1
s_waitcnt vmcnt(2)
v_max3_u32 v124,v32,v33,v34
v_max3_u32 v124,v124,v35,v36
v_max3_u32 v124,v124,v37,v38
v_max_u32 v124,v124,v39
v_cmp_eq_u32 vcc,-1,v124
s_cbranch_vccnz of_100250
v_smfmac_f32_16x16x64_bf16 v[96:99],v[32:35],v[144:151],v1
v_smfmac_f32_16x16x64_bf16 v[100:103],v[32:35],v[152:159],v1
v_smfmac_f32_16x16x64_bf16 v[96:99],v[36:39],v[160:167],v1
v_smfmac_f32_16x16x64_bf16 v[100:103],v[36:39],v[168:175],v1
s_waitcnt vmcnt(1)
v_max3_u32 v124,v40,v41,v42
v_max_u32 v124,v124,v43
v_cmp_eq_u32 vcc,-1,v124
s_cbranch_vccnz of_100251
v_smfmac_f32_16x16x64_bf16 v[96:99],v[40:43],v[176:183],v1
v_smfmac_f32_16x16x64_bf16 v[100:103],v[40:43],v[184:191],v1
s_waitcnt vmcnt(0)
v_max3_u32 v124,v44,v45,v46
v_max_u32 v124,v124,v47
v_cmp_eq_u32 vcc,-1,v124
s_cbranch_vccnz of_100252
v_smfmac_f32_16x16x64_bf16 v[96:99],v[44:47],v[192:199],v1
v_smfmac_f32_16x16x64_bf16 v[100:103],v[44:47],v[200:207],v1
oback_100259:
s_nop 4
v_add_f32 v96,v96,v97
v_add_f32 v98,v98,v99
s_nop 0
v_add_f32 v100,v100,v101
v_add_f32 v102,v102,v103
ds_write_addtid_b32 v96 offset:20992
ds_write_addtid_b32 v98 offset:23072
ds_write_addtid_b32 v100 offset:22016
ds_write_addtid_b32 v102 offset:24096
s_mov_b32 s96,s60
s_add_u32 s97,s60,4096
s_cmp_gt_u32 s50,1
s_waitcnt lgkmcnt(0)
s_barrier
s_cbranch_scc1 loop_100198
ds_read2st64_b32 v[48:49],v4 offset0:82 offset1:86
ds_read2st64_b32 v[50:51],v4 offset0:83 offset1:87
ds_read2st64_b32 v[52:53],v4 offset0:84 offset1:88
ds_read2st64_b32 v[54:55],v4 offset0:85 offset1:89
v_mov_b32 v96,v104
v_mov_b32 v97,v105
v_mov_b32 v98,v106
v_mov_b32 v99,v107
v_mov_b32 v100,v108
v_mov_b32 v101,v109
v_mov_b32 v102,v110
v_mov_b32 v103,v111
s_waitcnt lgkmcnt(2)
v_pk_add_f32 v[48:49],v[48:49],v[50:51]
s_waitcnt lgkmcnt(0)
v_pk_add_f32 v[52:53],v[52:53],v[54:55]
v_pk_add_f32 v[48:49],v[48:49],v[52:53]
v_cvt_pk_bf16_f32 v124,v48,v49
buffer_store_dword v124,v127,s[20:23],s89 offen
s_nop 7
buffer_store_dword v124,v127,s[20:23],s88 offen sc1
s_branch loop0_100202x
last_100199:
s_waitcnt vmcnt(3)
v_max3_u32 v124,v16,v17,v18
v_max_u32 v124,v124,v19
v_cmp_eq_u32 vcc,-1,v124
s_cbranch_vccnz flb_100284
seg_100260:
segb_100268:
v_smfmac_f32_16x16x64_bf16 v[64:67],v[16:19],a[32:39],v1
buffer_load_dword v125,off,s[20:23],s92 sc1
buffer_load_dwordx4 v[32:35],v0,s[20:23],s93 offen offset:0 sc1
s_waitcnt vmcnt(4)
v_max3_u32 v124,v20,v21,v22
v_smfmac_f32_16x16x64_bf16 v[68:71],v[16:19],a[40:47],v1
v_max_u32 v124,v124,v23
v_cmp_eq_u32 vcc,-1,v124
v_smfmac_f32_16x16x64_bf16 v[72:75],v[16:19],a[48:55],v1
v_smfmac_f32_16x16x64_bf16 v[76:79],v[16:19],a[56:63],v1
s_cbranch_vccnz fl_100277
seg_100261:
segb_100269:
v_smfmac_f32_16x16x64_bf16 v[64:67],v[20:23],a[96:103],v1
buffer_load_dword v125,off,s[20:23],s92 sc1
buffer_load_dwordx4 v[36:39],v0,s[20:23],s93 offen offset:1024 sc1
s_waitcnt vmcnt(5)
v_max3_u32 v124,v24,v25,v26
v_smfmac_f32_16x16x64_bf16 v[68:71],v[20:23],a[104:111],v1
v_max_u32 v124,v124,v27
v_cmp_eq_u32 vcc,-1,v124
v_smfmac_f32_16x16x64_bf16 v[72:75],v[20:23],a[112:119],v1
v_smfmac_f32_16x16x64_bf16 v[76:79],v[20:23],a[120:127],v1
s_cbranch_vccnz fl_100278
seg_100262:
segb_100270:
v_smfmac_f32_16x16x64_bf16 v[64:67],v[24:27],a[160:167],v1
buffer_load_dword v125,off,s[20:23],s92 sc1
buffer_load_dwordx4 v[40:43],v0,s[20:23],s93 offen offset:2048 sc1
buffer_load_dwordx4 v[44:47],v0,s[20:23],s93 offen offset:3072 sc1
s_waitcnt vmcnt(7)
v_max3_u32 v124,v28,v29,v30
v_smfmac_f32_16x16x64_bf16 v[68:71],v[24:27],a[168:175],v1
v_max_u32 v124,v124,v31
v_cmp_eq_u32 vcc,-1,v124
v_smfmac_f32_16x16x64_bf16 v[72:75],v[24:27],a[176:183],v1
v_smfmac_f32_16x16x64_bf16 v[76:79],v[24:27],a[184:191],v1
s_cbranch_vccnz fl_100279
seg_100263:
segb_100271:
v_smfmac_f32_16x16x64_bf16 v[64:67],v[28:31],a[224:231],v1
buffer_load_dword v125,off,s[20:23],s92 sc1
s_waitcnt vmcnt(6)
v_max3_u32 v124,v32,v33,v34
v_smfmac_f32_16x16x64_bf16 v[68:71],v[28:31],a[232:239],v1
v_max_u32 v124,v124,v35
v_cmp_eq_u32 vcc,-1,v124
v_smfmac_f32_16x16x64_bf16 v[72:75],v[28:31],a[240:247],v1
v_smfmac_f32_16x16x64_bf16 v[76:79],v[28:31],a[248:255],v1
s_cbranch_vccnz fl_100280
seg_100264:
segb_100272:
v_smfmac_f32_16x16x64_bf16 v[64:67],v[32:35],a[32:39],v1
buffer_load_dword v125,off,s[20:23],s92 sc1
buffer_store_dwordx4 v[112:115],v120,s[20:23],s101 offen sc1
buffer_store_dword v126,v121,s[20:23],s69 offen sc1
s_waitcnt vmcnt(7)
v_max3_u32 v124,v36,v37,v38
v_smfmac_f32_16x16x64_bf16 v[68:71],v[32:35],a[40:47],v1
v_max_u32 v124,v124,v39
v_cmp_eq_u32 vcc,-1,v124
v_smfmac_f32_16x16x64_bf16 v[72:75],v[32:35],a[48:55],v1
v_smfmac_f32_16x16x64_bf16 v[76:79],v[32:35],a[56:63],v1
s_cbranch_vccnz fl_100281
seg_100265:
segb_100273:
v_smfmac_f32_16x16x64_bf16 v[64:67],v[36:39],a[96:103],v1
buffer_load_dword v125,off,s[20:23],s92 sc1
s_waitcnt vmcnt(5)
v_max3_u32 v124,v40,v41,v42
v_smfmac_f32_16x16x64_bf16 v[68:71],v[36:39],a[104:111],v1
v_max3_u32 v124,v124,v43,v44
v_max3_u32 v124,v124,v45,v46
v_max_u32 v124,v124,v47
v_cmp_eq_u32 vcc,-1,v124
v_smfmac_f32_16x16x64_bf16 v[72:75],v[36:39],a[112:119],v1
v_smfmac_f32_16x16x64_bf16 v[76:79],v[36:39],a[120:127],v1
s_cbranch_vccnz fl_100282
seg_100266:
segb_100274:
v_smfmac_f32_16x16x64_bf16 v[64:67],v[40:43],a[160:167],v1
v_smfmac_f32_16x16x64_bf16 v[68:71],v[40:43],a[168:175],v1
v_smfmac_f32_16x16x64_bf16 v[64:67],v[44:47],a[224:231],v1
v_smfmac_f32_16x16x64_bf16 v[68:71],v[44:47],a[232:239],v1
v_smfmac_f32_16x16x64_bf16 v[72:75],v[40:43],a[176:183],v1
s_nop 1
v_add_f32 v64,v64,v65
v_smfmac_f32_16x16x64_bf16 v[76:79],v[40:43],a[184:191],v1
ds_write_addtid_b32 v64 offset:8448
v_add_f32 v66,v66,v67
v_smfmac_f32_16x16x64_bf16 v[72:75],v[44:47],a[240:247],v1
ds_write_addtid_b32 v66 offset:9488
v_add_f32 v68,v68,v69
v_smfmac_f32_16x16x64_bf16 v[76:79],v[44:47],a[248:255],v1
ds_write_addtid_b32 v68 offset:10528
v_add_f32 v70,v70,v71
v_smfmac_f32_16x16x64_bf16 v[80:83],v[16:19],v[208:215],v1
ds_write_addtid_b32 v70 offset:11568
v_add_f32 v72,v72,v73
v_smfmac_f32_16x16x64_bf16 v[80:83],v[32:35],v[208:215],v1
ds_write_addtid_b32 v72 offset:12608
v_add_f32 v74,v74,v75
v_smfmac_f32_16x16x64_bf16 v[84:87],v[16:19],v[216:223],v1
ds_write_addtid_b32 v74 offset:13648
v_add_f32 v76,v76,v77
v_smfmac_f32_16x16x64_bf16 v[84:87],v[32:35],v[216:223],v1
ds_write_addtid_b32 v76 offset:14688
v_add_f32 v78,v78,v79
v_smfmac_f32_16x16x64_bf16 v[88:91],v[16:19],v[224:231],v1
ds_write_addtid_b32 v78 offset:15728
v_smfmac_f32_16x16x64_bf16 v[88:91],v[32:35],v[224:231],v1
v_smfmac_f32_16x16x64_bf16 v[92:95],v[16:19],v[232:239],v1
v_smfmac_f32_16x16x64_bf16 v[92:95],v[32:35],v[232:239],v1
doneA_100293:
s_waitcnt vmcnt(0) lgkmcnt(0)
s_add_u32 s64,s79,0
s_lshl_b32 s65,s64,12
s_and_b32 s65,s65,0x2000
s_xor_b32 s65,s65,s67
s_lshl_b32 s64,s64,20
s_add_u32 s65,s65,s64
s_add_u32 s101,s65,s78
v_smfmac_f32_16x16x64_bf16 v[80:83],v[20:23],v[240:247],v1
ds_read_b128 v[48:51],v7 offset:0
ds_read_b128 v[52:55],v7 offset:1024
v_smfmac_f32_16x16x64_bf16 v[80:83],v[36:39],v[240:247],v1
ds_read_b128 v[56:59],v7 offset:2048
ds_read_b128 v[60:63],v7 offset:3072
v_smfmac_f32_16x16x64_bf16 v[84:87],v[20:23],v[248:255],v1
ds_read_b128 v[64:67],v7 offset:4096
ds_read_b128 v[68:71],v7 offset:5120
v_smfmac_f32_16x16x64_bf16 v[84:87],v[36:39],v[248:255],v1
ds_read_b128 v[72:75],v7 offset:6144
ds_read_b128 v[76:79],v7 offset:7168
s_waitcnt lgkmcnt(6)
v_smfmac_f32_16x16x64_bf16 v[88:91],v[20:23],v[48:55],v1
v_smfmac_f32_16x16x64_bf16 v[88:91],v[36:39],v[48:55],v1
ds_read_b128 v[48:51],v7 offset:8192
ds_read_b128 v[52:55],v7 offset:9216
s_waitcnt lgkmcnt(6)
v_smfmac_f32_16x16x64_bf16 v[92:95],v[20:23],v[56:63],v1
v_smfmac_f32_16x16x64_bf16 v[92:95],v[36:39],v[56:63],v1
ds_read_b128 v[56:59],v7 offset:10240
ds_read_b128 v[60:63],v7 offset:11264
s_waitcnt lgkmcnt(6)
v_smfmac_f32_16x16x64_bf16 v[80:83],v[24:27],v[64:71],v1
v_smfmac_f32_16x16x64_bf16 v[80:83],v[40:43],v[64:71],v1
ds_read_b128 v[64:67],v7 offset:12288
ds_read_b128 v[68:71],v7 offset:13312
s_waitcnt lgkmcnt(6)
v_smfmac_f32_16x16x64_bf16 v[84:87],v[24:27],v[72:79],v1
v_smfmac_f32_16x16x64_bf16 v[84:87],v[40:43],v[72:79],v1
ds_read_b128 v[72:75],v7 offset:14336
ds_read_b128 v[76:79],v7 offset:15360
s_waitcnt lgkmcnt(6)
v_smfmac_f32_16x16x64_bf16 v[88:91],v[24:27],v[48:55],v1
v_smfmac_f32_16x16x64_bf16 v[88:91],v[40:43],v[48:55],v1
ds_read_b128 v[48:51],v7 offset:16384
ds_read_b128 v[52:55],v7 offset:17408
s_waitcnt lgkmcnt(6)
v_smfmac_f32_16x16x64_bf16 v[92:95],v[24:27],v[56:63],v1
v_smfmac_f32_16x16x64_bf16 v[92:95],v[40:43],v[56:63],v1
ds_read_b128 v[56:59],v7 offset:18432
ds_read_b128 v[60:63],v7 offset:19456
s_waitcnt lgkmcnt(6)
v_smfmac_f32_16x16x64_bf16 v[80:83],v[28:31],v[64:71],v1
v_smfmac_f32_16x16x64_bf16 v[80:83],v[44:47],v[64:71],v1
s_waitcnt lgkmcnt(4)
v_smfmac_f32_16x16x64_bf16 v[84:87],v[28:31],v[72:79],v1
v_smfmac_f32_16x16x64_bf16 v[84:87],v[44:47],v[72:79],v1
s_waitcnt lgkmcnt(2)
v_smfmac_f32_16x16x64_bf16 v[88:91],v[28:31],v[48:55],v1
v_add_f32 v80,v80,v81
v_smfmac_f32_16x16x64_bf16 v[88:91],v[44:47],v[48:55],v1
v_add_f32 v82,v82,v83
s_waitcnt lgkmcnt(0)
v_smfmac_f32_16x16x64_bf16 v[92:95],v[28:31],v[56:63],v1
v_cvt_pk_bf16_f32 v80,v80,v82
v_smfmac_f32_16x16x64_bf16 v[92:95],v[44:47],v[56:63],v1
ds_write_addtid_b32 v80 offset:16896
v_add_f32 v84,v84,v85
v_add_f32 v86,v86,v87
v_cvt_pk_bf16_f32 v84,v84,v86
v_add_f32 v88,v88,v89
v_add_f32 v90,v90,v91
v_cvt_pk_bf16_f32 v88,v88,v90
s_nop 0
v_add_f32 v92,v92,v93
v_add_f32 v94,v94,v95
v_cvt_pk_bf16_f32 v92,v92,v94
ds_write_addtid_b32 v84 offset:17920
ds_write_addtid_b32 v88 offset:18944
ds_write_addtid_b32 v92 offset:19968
s_waitcnt lgkmcnt(0)
s_barrier
s_cmp_gt_u32 s50,1
s_cbranch_scc1 l23_100294
ds_read2st64_b32 v[112:113],v127 offset0:66 offset1:67
ds_read2st64_b32 v[114:115],v127 offset0:68 offset1:69
ds_read2st64_b32 v[116:117],v127 offset0:70 offset1:71
ds_read2st64_b32 v[118:119],v127 offset0:72 offset1:73
s_waitcnt lgkmcnt(0)
v_mov_b32 v120,v5
v_mov_b32 v121,v5
v_mov_b32 v122,v5
v_mov_b32 v123,v5
s_nop 1
v_mfma_f32_16x16x32_bf16 v[112:115],v[120:123],v[112:115],0
v_mfma_f32_16x16x32_bf16 v[116:119],v[120:123],v[116:119],0
s_nop 4
v_cvt_pk_bf16_f32 v112,v112,v113
v_cvt_pk_bf16_f32 v113,v114,v115
s_nop 0
v_cvt_pk_bf16_f32 v114,v116,v117
v_cvt_pk_bf16_f32 v115,v118,v119
s_branch lj_100295
l23_100294:
ds_read_b128 v[48:51],v2 offset:0
ds_read_b128 v[52:55],v2 offset:256
ds_read_b128 v[56:59],v2 offset:512
ds_read_b128 v[60:63],v2 offset:768
ds_read_b128 v[64:67],v2 offset:16
ds_read_b128 v[68:71],v2 offset:272
ds_read_b128 v[72:75],v2 offset:528
ds_read_b128 v[76:79],v2 offset:784
s_waitcnt lgkmcnt(6)
v_pk_add_f32 v[48:49],v[48:49],v[52:53]
v_pk_add_f32 v[50:51],v[50:51],v[54:55]
s_waitcnt lgkmcnt(4)
v_pk_add_f32 v[56:57],v[56:57],v[60:61]
v_pk_add_f32 v[58:59],v[58:59],v[62:63]
v_pk_add_f32 v[48:49],v[48:49],v[56:57]
v_pk_add_f32 v[50:51],v[50:51],v[58:59]
v_cvt_pk_bf16_f32 v112,v48,v49
v_cvt_pk_bf16_f32 v113,v50,v51
s_waitcnt lgkmcnt(2)
v_pk_add_f32 v[64:65],v[64:65],v[68:69]
v_pk_add_f32 v[66:67],v[66:67],v[70:71]
s_waitcnt lgkmcnt(0)
v_pk_add_f32 v[72:73],v[72:73],v[76:77]
v_pk_add_f32 v[74:75],v[74:75],v[78:79]
v_pk_add_f32 v[64:65],v[64:65],v[72:73]
v_pk_add_f32 v[66:67],v[66:67],v[74:75]
v_cvt_pk_bf16_f32 v114,v64,v65
v_cvt_pk_bf16_f32 v115,v66,v67
lj_100295:
v_cndmask_b32 v120,2.0,v0,s[82:83]
v_cndmask_b32 v121,2.0,v127,s[86:87]
buffer_store_dwordx4 v[112:115],v120,s[20:23],s101 offen sc1
s_waitcnt vmcnt(0)
s_barrier
v_mov_b32 v126,64
buffer_store_dword v126,v121,s[20:23],s69 offen sc1
s_branch recfin_100192
flp_100204:
buffer_load_dword v124,off,s[20:23],s68 sc1
s_waitcnt vmcnt(0)
v_readfirstlane_b32 s91,v124
s_cmp_gt_u32 s91,s64
s_cbranch_scc1 fok_100203
s_sleep 2
s_sub_u32 s90,s90,1
s_cmp_gt_i32 s90,0
s_cbranch_scc1 flp_100204
s_branch fok_100203
flp_100207:
buffer_load_dword v124,off,s[20:23],s68 sc1
s_waitcnt vmcnt(0)
v_readfirstlane_b32 s91,v124
s_cmp_gt_u32 s91,s64
s_cbranch_scc1 fok_100206
s_sleep 2
s_sub_u32 s90,s90,1
s_cmp_gt_i32 s90,0
s_cbranch_scc1 flp_100207
s_branch fok_100206
fl_100224:
flb_100232:
buffer_load_dwordx4 v[16:19],v0,s[20:23],s92 offen offset:0 sc1
s_mov_b32 s55,1
buffer_load_dwordx4 v[32:35],v0,s[20:23],s93 offen offset:0 sc1
s_waitcnt vmcnt(4)
v_max3_u32 v124,v20,v21,v22
v_max_u32 v124,v124,v23
v_cmp_eq_u32 vcc,-1,v124
s_cbranch_vccnz dfl_100296
v_smfmac_f32_16x16x64_bf16 v[48:51],v[20:23],a[64:71],v1
buffer_load_dword v125,off,s[20:23],s92 sc1
v_smfmac_f32_16x16x64_bf16 v[52:55],v[20:23],a[72:79],v1
buffer_load_dwordx4 v[36:39],v0,s[20:23],s93 offen offset:1024 sc1
v_smfmac_f32_16x16x64_bf16 v[56:59],v[20:23],a[80:87],v1
s_waitcnt vmcnt(5)
v_max3_u32 v124,v24,v25,v26
v_smfmac_f32_16x16x64_bf16 v[60:63],v[20:23],a[88:95],v1
v_max_u32 v124,v124,v27
v_smfmac_f32_16x16x64_bf16 v[64:67],v[20:23],a[96:103],v1
v_cmp_eq_u32 vcc,-1,v124
v_smfmac_f32_16x16x64_bf16 v[68:71],v[20:23],a[104:111],v1
v_smfmac_f32_16x16x64_bf16 v[72:75],v[20:23],a[112:119],v1
v_smfmac_f32_16x16x64_bf16 v[76:79],v[20:23],a[120:127],v1
s_cbranch_vccnz dfl_100297
v_smfmac_f32_16x16x64_bf16 v[48:51],v[24:27],a[128:135],v1
buffer_load_dword v125,off,s[20:23],s92 sc1
v_smfmac_f32_16x16x64_bf16 v[52:55],v[24:27],a[136:143],v1
buffer_load_dwordx4 v[40:43],v0,s[20:23],s93 offen offset:2048 sc1
v_smfmac_f32_16x16x64_bf16 v[56:59],v[24:27],a[144:151],v1
buffer_load_dwordx4 v[44:47],v0,s[20:23],s93 offen offset:3072 sc1
s_waitcnt vmcnt(7)
v_max3_u32 v124,v28,v29,v30
v_smfmac_f32_16x16x64_bf16 v[60:63],v[24:27],a[152:159],v1
v_max_u32 v124,v124,v31
v_smfmac_f32_16x16x64_bf16 v[64:67],v[24:27],a[160:167],v1
v_cmp_eq_u32 vcc,-1,v124
v_smfmac_f32_16x16x64_bf16 v[68:71],v[24:27],a[168:175],v1
v_smfmac_f32_16x16x64_bf16 v[72:75],v[24:27],a[176:183],v1
v_smfmac_f32_16x16x64_bf16 v[76:79],v[24:27],a[184:191],v1
s_cbranch_vccnz dfl_100298
v_smfmac_f32_16x16x64_bf16 v[48:51],v[28:31],a[192:199],v1
buffer_load_dword v125,off,s[20:23],s92 sc1
v_smfmac_f32_16x16x64_bf16 v[52:55],v[28:31],a[200:207],v1
v_smfmac_f32_16x16x64_bf16 v[56:59],v[28:31],a[208:215],v1
s_waitcnt vmcnt(7)
v_max3_u32 v124,v16,v17,v18
v_smfmac_f32_16x16x64_bf16 v[60:63],v[28:31],a[216:223],v1
v_max_u32 v124,v124,v19
v_smfmac_f32_16x16x64_bf16 v[64:67],v[28:31],a[224:231],v1
v_cmp_eq_u32 vcc,-1,v124
v_smfmac_f32_16x16x64_bf16 v[68:71],v[28:31],a[232:239],v1
v_smfmac_f32_16x16x64_bf16 v[72:75],v[28:31],a[240:247],v1
v_smfmac_f32_16x16x64_bf16 v[76:79],v[28:31],a[248:255],v1
s_cbranch_vccnz lfb_100303
s_mov_b32 s55,0
v_smfmac_f32_16x16x64_bf16 v[48:51],v[16:19],a[0:7],v1
v_smfmac_f32_16x16x64_bf16 v[52:55],v[16:19],a[8:15],v1
v_smfmac_f32_16x16x64_bf16 v[56:59],v[16:19],a[16:23],v1
s_waitcnt vmcnt(6)
v_max3_u32 v124,v32,v33,v34
v_max_u32 v124,v124,v35
v_cmp_eq_u32 vcc,-1,v124
v_smfmac_f32_16x16x64_bf16 v[60:63],v[16:19],a[24:31],v1
v_smfmac_f32_16x16x64_bf16 v[64:67],v[16:19],a[32:39],v1
v_smfmac_f32_16x16x64_bf16 v[68:71],v[16:19],a[40:47],v1
v_smfmac_f32_16x16x64_bf16 v[72:75],v[16:19],a[48:55],v1
v_smfmac_f32_16x16x64_bf16 v[76:79],v[16:19],a[56:63],v1
s_cbranch_vccnz flb_100236
s_branch segb_100220
fl_100225:
v_smfmac_f32_16x16x64_bf16 v[76:79],v[16:19],a[56:63],v1
flb_100233:
buffer_load_dwordx4 v[20:23],v0,s[20:23],s92 offen offset:1024 sc1
s_mov_b32 s55,2
buffer_load_dwordx4 v[36:39],v0,s[20:23],s93 offen offset:1024 sc1
s_waitcnt vmcnt(5)
v_max3_u32 v124,v24,v25,v26
v_max_u32 v124,v124,v27
v_cmp_eq_u32 vcc,-1,v124
s_cbranch_vccnz dfl_100297
v_smfmac_f32_16x16x64_bf16 v[48:51],v[24:27],a[128:135],v1
buffer_load_dword v125,off,s[20:23],s92 sc1
v_smfmac_f32_16x16x64_bf16 v[52:55],v[24:27],a[136:143],v1
buffer_load_dwordx4 v[40:43],v0,s[20:23],s93 offen offset:2048 sc1
v_smfmac_f32_16x16x64_bf16 v[56:59],v[24:27],a[144:151],v1
buffer_load_dwordx4 v[44:47],v0,s[20:23],s93 offen offset:3072 sc1
s_waitcnt vmcnt(7)
v_max3_u32 v124,v28,v29,v30
v_smfmac_f32_16x16x64_bf16 v[60:63],v[24:27],a[152:159],v1
v_max_u32 v124,v124,v31
v_smfmac_f32_16x16x64_bf16 v[64:67],v[24:27],a[160:167],v1
v_cmp_eq_u32 vcc,-1,v124
v_smfmac_f32_16x16x64_bf16 v[68:71],v[24:27],a[168:175],v1
v_smfmac_f32_16x16x64_bf16 v[72:75],v[24:27],a[176:183],v1
v_smfmac_f32_16x16x64_bf16 v[76:79],v[24:27],a[184:191],v1
s_cbranch_vccnz dfl_100298
v_smfmac_f32_16x16x64_bf16 v[48:51],v[28:31],a[192:199],v1
buffer_load_dword v125,off,s[20:23],s92 sc1
v_smfmac_f32_16x16x64_bf16 v[52:55],v[28:31],a[200:207],v1
v_smfmac_f32_16x16x64_bf16 v[56:59],v[28:31],a[208:215],v1
s_waitcnt vmcnt(5)
v_max3_u32 v124,v20,v21,v22
v_smfmac_f32_16x16x64_bf16 v[60:63],v[28:31],a[216:223],v1
v_max_u32 v124,v124,v23
v_smfmac_f32_16x16x64_bf16 v[64:67],v[28:31],a[224:231],v1
v_cmp_eq_u32 vcc,-1,v124
v_smfmac_f32_16x16x64_bf16 v[68:71],v[28:31],a[232:239],v1
v_smfmac_f32_16x16x64_bf16 v[72:75],v[28:31],a[240:247],v1
v_smfmac_f32_16x16x64_bf16 v[76:79],v[28:31],a[248:255],v1
s_cbranch_vccnz lfb_100303
s_mov_b32 s55,0
v_smfmac_f32_16x16x64_bf16 v[48:51],v[20:23],a[64:71],v1
v_smfmac_f32_16x16x64_bf16 v[52:55],v[20:23],a[72:79],v1
v_smfmac_f32_16x16x64_bf16 v[56:59],v[20:23],a[80:87],v1
s_waitcnt vmcnt(6)
v_max3_u32 v124,v32,v33,v34
v_max_u32 v124,v124,v35
v_cmp_eq_u32 vcc,-1,v124
v_smfmac_f32_16x16x64_bf16 v[60:63],v[20:23],a[88:95],v1
v_smfmac_f32_16x16x64_bf16 v[64:67],v[20:23],a[96:103],v1
v_smfmac_f32_16x16x64_bf16 v[68:71],v[20:23],a[104:111],v1
v_smfmac_f32_16x16x64_bf16 v[72:75],v[20:23],a[112:119],v1
v_smfmac_f32_16x16x64_bf16 v[76:79],v[20:23],a[120:127],v1
s_cbranch_vccnz flb_100236
s_branch segb_100220
fl_100226:
v_smfmac_f32_16x16x64_bf16 v[76:79],v[20:23],a[120:127],v1
flb_100234:
buffer_load_dwordx4 v[24:27],v0,s[20:23],s92 offen offset:2048 sc1
s_mov_b32 s55,4
buffer_load_dwordx4 v[40:43],v0,s[20:23],s93 offen offset:2048 sc1
buffer_load_dwordx4 v[44:47],v0,s[20:23],s93 offen offset:3072 sc1
s_waitcnt vmcnt(7)
v_max3_u32 v124,v28,v29,v30
v_max_u32 v124,v124,v31
v_cmp_eq_u32 vcc,-1,v124
s_cbranch_vccnz dfl_100298
v_smfmac_f32_16x16x64_bf16 v[48:51],v[28:31],a[192:199],v1
buffer_load_dword v125,off,s[20:23],s92 sc1
v_smfmac_f32_16x16x64_bf16 v[52:55],v[28:31],a[200:207],v1
v_smfmac_f32_16x16x64_bf16 v[56:59],v[28:31],a[208:215],v1
s_waitcnt vmcnt(3)
v_max3_u32 v124,v24,v25,v26
v_smfmac_f32_16x16x64_bf16 v[60:63],v[28:31],a[216:223],v1
v_max_u32 v124,v124,v27
v_smfmac_f32_16x16x64_bf16 v[64:67],v[28:31],a[224:231],v1
v_cmp_eq_u32 vcc,-1,v124
v_smfmac_f32_16x16x64_bf16 v[68:71],v[28:31],a[232:239],v1
v_smfmac_f32_16x16x64_bf16 v[72:75],v[28:31],a[240:247],v1
v_smfmac_f32_16x16x64_bf16 v[76:79],v[28:31],a[248:255],v1
s_cbranch_vccnz lfb_100303
s_mov_b32 s55,0
v_smfmac_f32_16x16x64_bf16 v[48:51],v[24:27],a[128:135],v1
v_smfmac_f32_16x16x64_bf16 v[52:55],v[24:27],a[136:143],v1
v_smfmac_f32_16x16x64_bf16 v[56:59],v[24:27],a[144:151],v1
s_waitcnt vmcnt(6)
v_max3_u32 v124,v32,v33,v34
v_max_u32 v124,v124,v35
v_cmp_eq_u32 vcc,-1,v124
v_smfmac_f32_16x16x64_bf16 v[60:63],v[24:27],a[152:159],v1
v_smfmac_f32_16x16x64_bf16 v[64:67],v[24:27],a[160:167],v1
v_smfmac_f32_16x16x64_bf16 v[68:71],v[24:27],a[168:175],v1
v_smfmac_f32_16x16x64_bf16 v[72:75],v[24:27],a[176:183],v1
v_smfmac_f32_16x16x64_bf16 v[76:79],v[24:27],a[184:191],v1
s_cbranch_vccnz flb_100236
s_branch segb_100220
fl_100227:
v_smfmac_f32_16x16x64_bf16 v[76:79],v[24:27],a[184:191],v1
flb_100235:
buffer_load_dwordx4 v[28:31],v0,s[20:23],s92 offen offset:3072 sc1
s_mov_b32 s55,8
s_waitcnt vmcnt(0)
v_max3_u32 v124,v28,v29,v30
v_max_u32 v124,v124,v31
v_cmp_eq_u32 vcc,-1,v124
s_cbranch_vccnz lfb_100303
s_mov_b32 s55,0
v_smfmac_f32_16x16x64_bf16 v[48:51],v[28:31],a[192:199],v1
v_smfmac_f32_16x16x64_bf16 v[52:55],v[28:31],a[200:207],v1
v_smfmac_f32_16x16x64_bf16 v[56:59],v[28:31],a[208:215],v1
s_waitcnt vmcnt(6)
v_max3_u32 v124,v32,v33,v34
v_max_u32 v124,v124,v35
v_cmp_eq_u32 vcc,-1,v124
v_smfmac_f32_16x16x64_bf16 v[60:63],v[28:31],a[216:223],v1
v_smfmac_f32_16x16x64_bf16 v[64:67],v[28:31],a[224:231],v1
v_smfmac_f32_16x16x64_bf16 v[68:71],v[28:31],a[232:239],v1
v_smfmac_f32_16x16x64_bf16 v[72:75],v[28:31],a[240:247],v1
v_smfmac_f32_16x16x64_bf16 v[76:79],v[28:31],a[248:255],v1
s_cbranch_vccnz flb_100236
s_branch segb_100220
fl_100228:
v_smfmac_f32_16x16x64_bf16 v[76:79],v[28:31],a[248:255],v1
flb_100236:
buffer_load_dwordx4 v[32:35],v0,s[20:23],s93 offen offset:0 sc1
s_mov_b32 s55,240
buffer_store_dwordx4 v[112:115],v120,s[20:23],s101 offen sc1
buffer_store_dword v126,v121,s[20:23],s69 offen sc1
s_bitcmp1_b32 s55,5
s_cbranch_scc0 rdn_100306
s_waitcnt vmcnt(7)
v_max3_u32 v124,v36,v37,v38
v_max_u32 v124,v124,v39
v_cmp_eq_u32 vcc,-1,v124
s_cbranch_vccnz rfa_100307
buffer_load_dword v125,off,s[20:23],s92 sc1
s_bitset0_b32 s55,5
v_smfmac_f32_16x16x64_bf16 v[48:51],v[36:39],a[64:71],v1
v_smfmac_f32_16x16x64_bf16 v[52:55],v[36:39],a[72:79],v1
v_smfmac_f32_16x16x64_bf16 v[56:59],v[36:39],a[80:87],v1
v_smfmac_f32_16x16x64_bf16 v[60:63],v[36:39],a[88:95],v1
v_smfmac_f32_16x16x64_bf16 v[64:67],v[36:39],a[96:103],v1
v_smfmac_f32_16x16x64_bf16 v[68:71],v[36:39],a[104:111],v1
v_smfmac_f32_16x16x64_bf16 v[72:75],v[36:39],a[112:119],v1
v_smfmac_f32_16x16x64_bf16 v[76:79],v[36:39],a[120:127],v1
s_cmp_eq_u32 s55,0
s_cbranch_scc1 segb_100222
s_branch rnx_100308
rdn_100306:
buffer_load_dword v125,off,s[20:23],s92 sc1
s_branch rnx_100308
rfa_100307:
buffer_load_dwordx4 v[36:39],v0,s[20:23],s93 offen offset:1024 sc1
rnx_100308:
s_bitcmp1_b32 s55,6
s_cbranch_scc0 rdn_100309
s_waitcnt vmcnt(6)
v_max3_u32 v124,v40,v41,v42
v_max_u32 v124,v124,v43
v_cmp_eq_u32 vcc,-1,v124
s_cbranch_vccnz rfa_100310
buffer_load_dword v125,off,s[20:23],s92 sc1
s_bitset0_b32 s55,6
s_cmp_eq_u32 s55,0
s_cbranch_scc1 segb_100222
s_branch rnx_100311
rdn_100309:
buffer_load_dword v125,off,s[20:23],s92 sc1
s_branch rnx_100311
rfa_100310:
buffer_load_dwordx4 v[40:43],v0,s[20:23],s93 offen offset:2048 sc1
rnx_100311:
s_bitcmp1_b32 s55,7
s_cbranch_scc0 rdn_100312
s_waitcnt vmcnt(6)
v_max3_u32 v124,v44,v45,v46
v_max_u32 v124,v124,v47
v_cmp_eq_u32 vcc,-1,v124
s_cbranch_vccnz rfa_100313
buffer_load_dword v125,off,s[20:23],s92 sc1
s_bitset0_b32 s55,7
s_cmp_eq_u32 s55,0
s_cbranch_scc1 segb_100222
s_branch rnx_100314
rdn_100312:
buffer_load_dword v125,off,s[20:23],s92 sc1
s_branch rnx_100314
rfa_100313:
buffer_load_dwordx4 v[44:47],v0,s[20:23],s93 offen offset:3072 sc1
rnx_100314:
rot_100305:
s_bitcmp1_b32 s55,4
s_cbranch_scc0 rdn_100315
s_waitcnt vmcnt(3)
v_max3_u32 v124,v32,v33,v34
v_max_u32 v124,v124,v35
v_cmp_eq_u32 vcc,-1,v124
s_cbranch_vccnz rfa_100316
buffer_load_dword v125,off,s[20:23],s92 sc1
s_bitset0_b32 s55,4
v_smfmac_f32_16x16x64_bf16 v[48:51],v[32:35],a[0:7],v1
v_smfmac_f32_16x16x64_bf16 v[52:55],v[32:35],a[8:15],v1
v_smfmac_f32_16x16x64_bf16 v[56:59],v[32:35],a[16:23],v1
v_smfmac_f32_16x16x64_bf16 v[60:63],v[32:35],a[24:31],v1
v_smfmac_f32_16x16x64_bf16 v[64:67],v[32:35],a[32:39],v1
v_smfmac_f32_16x16x64_bf16 v[68:71],v[32:35],a[40:47],v1
v_smfmac_f32_16x16x64_bf16 v[72:75],v[32:35],a[48:55],v1
v_smfmac_f32_16x16x64_bf16 v[76:79],v[32:35],a[56:63],v1
s_cmp_eq_u32 s55,0
s_cbranch_scc1 segb_100222
s_branch rnx_100317
rdn_100315:
buffer_load_dword v125,off,s[20:23],s92 sc1
s_branch rnx_100317
rfa_100316:
buffer_load_dwordx4 v[32:35],v0,s[20:23],s93 offen offset:0 sc1
rnx_100317:
s_bitcmp1_b32 s55,5
s_cbranch_scc0 rdn_100318
s_waitcnt vmcnt(3)
v_max3_u32 v124,v36,v37,v38
v_max_u32 v124,v124,v39
v_cmp_eq_u32 vcc,-1,v124
s_cbranch_vccnz rfa_100319
buffer_load_dword v125,off,s[20:23],s92 sc1
s_bitset0_b32 s55,5
v_smfmac_f32_16x16x64_bf16 v[48:51],v[36:39],a[64:71],v1
v_smfmac_f32_16x16x64_bf16 v[52:55],v[36:39],a[72:79],v1
v_smfmac_f32_16x16x64_bf16 v[56:59],v[36:39],a[80:87],v1
v_smfmac_f32_16x16x64_bf16 v[60:63],v[36:39],a[88:95],v1
v_smfmac_f32_16x16x64_bf16 v[64:67],v[36:39],a[96:103],v1
v_smfmac_f32_16x16x64_bf16 v[68:71],v[36:39],a[104:111],v1
v_smfmac_f32_16x16x64_bf16 v[72:75],v[36:39],a[112:119],v1
v_smfmac_f32_16x16x64_bf16 v[76:79],v[36:39],a[120:127],v1
s_cmp_eq_u32 s55,0
s_cbranch_scc1 segb_100222
s_branch rnx_100320
rdn_100318:
buffer_load_dword v125,off,s[20:23],s92 sc1
s_branch rnx_100320
rfa_100319:
buffer_load_dwordx4 v[36:39],v0,s[20:23],s93 offen offset:1024 sc1
rnx_100320:
s_bitcmp1_b32 s55,6
s_cbranch_scc0 rdn_100321
s_waitcnt vmcnt(3)
v_max3_u32 v124,v40,v41,v42
v_max_u32 v124,v124,v43
v_cmp_eq_u32 vcc,-1,v124
s_cbranch_vccnz rfa_100322
buffer_load_dword v125,off,s[20:23],s92 sc1
s_bitset0_b32 s55,6
s_cmp_eq_u32 s55,0
s_cbranch_scc1 segb_100222
s_branch rnx_100323
rdn_100321:
buffer_load_dword v125,off,s[20:23],s92 sc1
s_branch rnx_100323
rfa_100322:
buffer_load_dwordx4 v[40:43],v0,s[20:23],s93 offen offset:2048 sc1
rnx_100323:
s_bitcmp1_b32 s55,7
s_cbranch_scc0 rdn_100324
s_waitcnt vmcnt(3)
v_max3_u32 v124,v44,v45,v46
v_max_u32 v124,v124,v47
v_cmp_eq_u32 vcc,-1,v124
s_cbranch_vccnz rfa_100325
buffer_load_dword v125,off,s[20:23],s92 sc1
s_bitset0_b32 s55,7
s_cmp_eq_u32 s55,0
s_cbranch_scc1 segb_100222
s_branch rnx_100326
rdn_100324:
buffer_load_dword v125,off,s[20:23],s92 sc1
s_branch rnx_100326
rfa_100325:
buffer_load_dwordx4 v[44:47],v0,s[20:23],s93 offen offset:3072 sc1
rnx_100326:
s_sub_u32 s90,s90,1
s_cmp_gt_i32 s90,0
s_cbranch_scc1 rot_100305
s_mov_b32 s55,0
s_branch segb_100222
fl_100229:
v_smfmac_f32_16x16x64_bf16 v[76:79],v[32:35],a[56:63],v1
flb_100237:
buffer_load_dwordx4 v[36:39],v0,s[20:23],s93 offen offset:1024 sc1
s_mov_b32 s55,224
s_bitcmp1_b32 s55,6
s_cbranch_scc0 rdn_100328
s_waitcnt vmcnt(6)
v_max3_u32 v124,v40,v41,v42
v_max_u32 v124,v124,v43
v_cmp_eq_u32 vcc,-1,v124
s_cbranch_vccnz rfa_100329
buffer_load_dword v125,off,s[20:23],s92 sc1
s_bitset0_b32 s55,6
s_cmp_eq_u32 s55,0
s_cbranch_scc1 segb_100222
s_branch rnx_100330
rdn_100328:
buffer_load_dword v125,off,s[20:23],s92 sc1
s_branch rnx_100330
rfa_100329:
buffer_load_dwordx4 v[40:43],v0,s[20:23],s93 offen offset:2048 sc1
rnx_100330:
s_bitcmp1_b32 s55,7
s_cbranch_scc0 rdn_100331
s_waitcnt vmcnt(6)
v_max3_u32 v124,v44,v45,v46
v_max_u32 v124,v124,v47
v_cmp_eq_u32 vcc,-1,v124
s_cbranch_vccnz rfa_100332
buffer_load_dword v125,off,s[20:23],s92 sc1
s_bitset0_b32 s55,7
s_cmp_eq_u32 s55,0
s_cbranch_scc1 segb_100222
s_branch rnx_100333
rdn_100331:
buffer_load_dword v125,off,s[20:23],s92 sc1
s_branch rnx_100333
rfa_100332:
buffer_load_dwordx4 v[44:47],v0,s[20:23],s93 offen offset:3072 sc1
rnx_100333:
rot_100327:
s_bitcmp1_b32 s55,5
s_cbranch_scc0 rdn_100334
s_waitcnt vmcnt(2)
v_max3_u32 v124,v36,v37,v38
v_max_u32 v124,v124,v39
v_cmp_eq_u32 vcc,-1,v124
s_cbranch_vccnz rfa_100335
buffer_load_dword v125,off,s[20:23],s92 sc1
s_bitset0_b32 s55,5
v_smfmac_f32_16x16x64_bf16 v[48:51],v[36:39],a[64:71],v1
v_smfmac_f32_16x16x64_bf16 v[52:55],v[36:39],a[72:79],v1
v_smfmac_f32_16x16x64_bf16 v[56:59],v[36:39],a[80:87],v1
v_smfmac_f32_16x16x64_bf16 v[60:63],v[36:39],a[88:95],v1
v_smfmac_f32_16x16x64_bf16 v[64:67],v[36:39],a[96:103],v1
v_smfmac_f32_16x16x64_bf16 v[68:71],v[36:39],a[104:111],v1
v_smfmac_f32_16x16x64_bf16 v[72:75],v[36:39],a[112:119],v1
v_smfmac_f32_16x16x64_bf16 v[76:79],v[36:39],a[120:127],v1
s_cmp_eq_u32 s55,0
s_cbranch_scc1 segb_100222
s_branch rnx_100336
rdn_100334:
buffer_load_dword v125,off,s[20:23],s92 sc1
s_branch rnx_100336
rfa_100335:
buffer_load_dwordx4 v[36:39],v0,s[20:23],s93 offen offset:1024 sc1
rnx_100336:
s_bitcmp1_b32 s55,6
s_cbranch_scc0 rdn_100337
s_waitcnt vmcnt(2)
v_max3_u32 v124,v40,v41,v42
v_max_u32 v124,v124,v43
v_cmp_eq_u32 vcc,-1,v124
s_cbranch_vccnz rfa_100338
buffer_load_dword v125,off,s[20:23],s92 sc1
s_bitset0_b32 s55,6
s_cmp_eq_u32 s55,0
s_cbranch_scc1 segb_100222
s_branch rnx_100339
rdn_100337:
buffer_load_dword v125,off,s[20:23],s92 sc1
s_branch rnx_100339
rfa_100338:
buffer_load_dwordx4 v[40:43],v0,s[20:23],s93 offen offset:2048 sc1
rnx_100339:
s_bitcmp1_b32 s55,7
s_cbranch_scc0 rdn_100340
s_waitcnt vmcnt(2)
v_max3_u32 v124,v44,v45,v46
v_max_u32 v124,v124,v47
v_cmp_eq_u32 vcc,-1,v124
s_cbranch_vccnz rfa_100341
buffer_load_dword v125,off,s[20:23],s92 sc1
s_bitset0_b32 s55,7
s_cmp_eq_u32 s55,0
s_cbranch_scc1 segb_100222
s_branch rnx_100342
rdn_100340:
buffer_load_dword v125,off,s[20:23],s92 sc1
s_branch rnx_100342
rfa_100341:
buffer_load_dwordx4 v[44:47],v0,s[20:23],s93 offen offset:3072 sc1
rnx_100342:
s_sub_u32 s90,s90,1
s_cmp_gt_i32 s90,0
s_cbranch_scc1 rot_100327
s_mov_b32 s55,0
s_branch segb_100222
fl_100230:
v_smfmac_f32_16x16x64_bf16 v[76:79],v[36:39],a[120:127],v1
flb_100238:
s_mov_b32 s55,192
s_bitcmp1_b32 s55,6
s_cbranch_scc0 rdn_100344
s_waitcnt vmcnt(6)
v_max3_u32 v124,v40,v41,v42
v_max_u32 v124,v124,v43
v_cmp_eq_u32 vcc,-1,v124
s_cbranch_vccnz rfa_100345
buffer_load_dword v125,off,s[20:23],s92 sc1
s_bitset0_b32 s55,6
s_cmp_eq_u32 s55,0
s_cbranch_scc1 segb_100222
s_branch rnx_100346
rdn_100344:
buffer_load_dword v125,off,s[20:23],s92 sc1
s_branch rnx_100346
rfa_100345:
buffer_load_dwordx4 v[40:43],v0,s[20:23],s93 offen offset:2048 sc1
rnx_100346:
s_bitcmp1_b32 s55,7
s_cbranch_scc0 rdn_100347
s_waitcnt vmcnt(6)
v_max3_u32 v124,v44,v45,v46
v_max_u32 v124,v124,v47
v_cmp_eq_u32 vcc,-1,v124
s_cbranch_vccnz rfa_100348
buffer_load_dword v125,off,s[20:23],s92 sc1
s_bitset0_b32 s55,7
s_cmp_eq_u32 s55,0
s_cbranch_scc1 segb_100222
s_branch rnx_100349
rdn_100347:
buffer_load_dword v125,off,s[20:23],s92 sc1
s_branch rnx_100349
rfa_100348:
buffer_load_dwordx4 v[44:47],v0,s[20:23],s93 offen offset:3072 sc1
rnx_100349:
rot_100343:
s_bitcmp1_b32 s55,6
s_cbranch_scc0 rdn_100350
s_waitcnt vmcnt(1)
v_max3_u32 v124,v40,v41,v42
v_max_u32 v124,v124,v43
v_cmp_eq_u32 vcc,-1,v124
s_cbranch_vccnz rfa_100351
buffer_load_dword v125,off,s[20:23],s92 sc1
s_bitset0_b32 s55,6
s_cmp_eq_u32 s55,0
s_cbranch_scc1 segb_100222
s_branch rnx_100352
rdn_100350:
buffer_load_dword v125,off,s[20:23],s92 sc1
s_branch rnx_100352
rfa_100351:
buffer_load_dwordx4 v[40:43],v0,s[20:23],s93 offen offset:2048 sc1
rnx_100352:
s_bitcmp1_b32 s55,7
s_cbranch_scc0 rdn_100353
s_waitcnt vmcnt(1)
v_max3_u32 v124,v44,v45,v46
v_max_u32 v124,v124,v47
v_cmp_eq_u32 vcc,-1,v124
s_cbranch_vccnz rfa_100354
buffer_load_dword v125,off,s[20:23],s92 sc1
s_bitset0_b32 s55,7
s_cmp_eq_u32 s55,0
s_cbranch_scc1 segb_100222
s_branch rnx_100355
rdn_100353:
buffer_load_dword v125,off,s[20:23],s92 sc1
s_branch rnx_100355
rfa_100354:
buffer_load_dwordx4 v[44:47],v0,s[20:23],s93 offen offset:3072 sc1
rnx_100355:
s_sub_u32 s90,s90,1
s_cmp_gt_i32 s90,0
s_cbranch_scc1 rot_100343
s_mov_b32 s55,0
s_branch segb_100222
dfl_100296:
buffer_load_dwordx4 v[20:23],v0,s[20:23],s92 offen offset:1024 sc1
s_bitset1_b32 s55,1
buffer_load_dwordx4 v[36:39],v0,s[20:23],s93 offen offset:1024 sc1
s_waitcnt vmcnt(5)
v_max3_u32 v124,v24,v25,v26
v_max_u32 v124,v124,v27
v_cmp_eq_u32 vcc,-1,v124
s_cbranch_vccnz dfl_100297
s_branch dseg_100300
dfl_100297:
buffer_load_dwordx4 v[24:27],v0,s[20:23],s92 offen offset:2048 sc1
s_bitset1_b32 s55,2
buffer_load_dwordx4 v[40:43],v0,s[20:23],s93 offen offset:2048 sc1
buffer_load_dwordx4 v[44:47],v0,s[20:23],s93 offen offset:3072 sc1
s_waitcnt vmcnt(7)
v_max3_u32 v124,v28,v29,v30
v_max_u32 v124,v124,v31
v_cmp_eq_u32 vcc,-1,v124
s_cbranch_vccnz dfl_100298
s_branch dseg_100301
dfl_100298:
buffer_load_dwordx4 v[28:31],v0,s[20:23],s92 offen offset:3072 sc1
s_bitset1_b32 s55,3
s_branch lap2_100302
dseg_100300:
v_smfmac_f32_16x16x64_bf16 v[48:51],v[24:27],a[128:135],v1
buffer_load_dword v125,off,s[20:23],s92 sc1
v_smfmac_f32_16x16x64_bf16 v[52:55],v[24:27],a[136:143],v1
buffer_load_dwordx4 v[40:43],v0,s[20:23],s93 offen offset:2048 sc1
v_smfmac_f32_16x16x64_bf16 v[56:59],v[24:27],a[144:151],v1
buffer_load_dwordx4 v[44:47],v0,s[20:23],s93 offen offset:3072 sc1
s_waitcnt vmcnt(7)
v_max3_u32 v124,v28,v29,v30
v_smfmac_f32_16x16x64_bf16 v[60:63],v[24:27],a[152:159],v1
v_max_u32 v124,v124,v31
v_smfmac_f32_16x16x64_bf16 v[64:67],v[24:27],a[160:167],v1
v_cmp_eq_u32 vcc,-1,v124
v_smfmac_f32_16x16x64_bf16 v[68:71],v[24:27],a[168:175],v1
v_smfmac_f32_16x16x64_bf16 v[72:75],v[24:27],a[176:183],v1
v_smfmac_f32_16x16x64_bf16 v[76:79],v[24:27],a[184:191],v1
s_cbranch_vccnz dfl_100298
dseg_100301:
v_smfmac_f32_16x16x64_bf16 v[48:51],v[28:31],a[192:199],v1
buffer_load_dword v125,off,s[20:23],s92 sc1
v_smfmac_f32_16x16x64_bf16 v[52:55],v[28:31],a[200:207],v1
v_smfmac_f32_16x16x64_bf16 v[56:59],v[28:31],a[208:215],v1
v_smfmac_f32_16x16x64_bf16 v[60:63],v[28:31],a[216:223],v1
v_smfmac_f32_16x16x64_bf16 v[64:67],v[28:31],a[224:231],v1
v_smfmac_f32_16x16x64_bf16 v[68:71],v[28:31],a[232:239],v1
v_smfmac_f32_16x16x64_bf16 v[72:75],v[28:31],a[240:247],v1
v_smfmac_f32_16x16x64_bf16 v[76:79],v[28:31],a[248:255],v1
lap2_100302:
s_bitcmp1_b32 s55,0
s_cbranch_scc0 l2s_100356
s_waitcnt vmcnt(7)
v_max3_u32 v124,v16,v17,v18
v_max_u32 v124,v124,v19
v_cmp_eq_u32 vcc,-1,v124
s_cbranch_vccnz l2s_100356
s_bitset0_b32 s55,0
v_smfmac_f32_16x16x64_bf16 v[48:51],v[16:19],a[0:7],v1
v_smfmac_f32_16x16x64_bf16 v[52:55],v[16:19],a[8:15],v1
v_smfmac_f32_16x16x64_bf16 v[56:59],v[16:19],a[16:23],v1
v_smfmac_f32_16x16x64_bf16 v[60:63],v[16:19],a[24:31],v1
v_smfmac_f32_16x16x64_bf16 v[64:67],v[16:19],a[32:39],v1
v_smfmac_f32_16x16x64_bf16 v[68:71],v[16:19],a[40:47],v1
v_smfmac_f32_16x16x64_bf16 v[72:75],v[16:19],a[48:55],v1
v_smfmac_f32_16x16x64_bf16 v[76:79],v[16:19],a[56:63],v1
l2s_100356:
s_bitcmp1_b32 s55,1
s_cbranch_scc0 l2s_100358
s_waitcnt vmcnt(5)
v_max3_u32 v124,v20,v21,v22
v_max_u32 v124,v124,v23
v_cmp_eq_u32 vcc,-1,v124
s_cbranch_vccnz l2s_100358
s_bitset0_b32 s55,1
v_smfmac_f32_16x16x64_bf16 v[48:51],v[20:23],a[64:71],v1
v_smfmac_f32_16x16x64_bf16 v[52:55],v[20:23],a[72:79],v1
v_smfmac_f32_16x16x64_bf16 v[56:59],v[20:23],a[80:87],v1
v_smfmac_f32_16x16x64_bf16 v[60:63],v[20:23],a[88:95],v1
v_smfmac_f32_16x16x64_bf16 v[64:67],v[20:23],a[96:103],v1
v_smfmac_f32_16x16x64_bf16 v[68:71],v[20:23],a[104:111],v1
v_smfmac_f32_16x16x64_bf16 v[72:75],v[20:23],a[112:119],v1
v_smfmac_f32_16x16x64_bf16 v[76:79],v[20:23],a[120:127],v1
l2s_100358:
s_bitcmp1_b32 s55,2
s_cbranch_scc0 l2s_100360
s_waitcnt vmcnt(3)
v_max3_u32 v124,v24,v25,v26
v_max_u32 v124,v124,v27
v_cmp_eq_u32 vcc,-1,v124
s_cbranch_vccnz l2s_100360
s_bitset0_b32 s55,2
v_smfmac_f32_16x16x64_bf16 v[48:51],v[24:27],a[128:135],v1
v_smfmac_f32_16x16x64_bf16 v[52:55],v[24:27],a[136:143],v1
v_smfmac_f32_16x16x64_bf16 v[56:59],v[24:27],a[144:151],v1
v_smfmac_f32_16x16x64_bf16 v[60:63],v[24:27],a[152:159],v1
v_smfmac_f32_16x16x64_bf16 v[64:67],v[24:27],a[160:167],v1
v_smfmac_f32_16x16x64_bf16 v[68:71],v[24:27],a[168:175],v1
v_smfmac_f32_16x16x64_bf16 v[72:75],v[24:27],a[176:183],v1
v_smfmac_f32_16x16x64_bf16 v[76:79],v[24:27],a[184:191],v1
l2s_100360:
s_bitcmp1_b32 s55,3
s_cbranch_scc0 l2s_100362
s_waitcnt vmcnt(0)
v_max3_u32 v124,v28,v29,v30
v_max_u32 v124,v124,v31
v_cmp_eq_u32 vcc,-1,v124
s_cbranch_vccnz l2s_100362
s_bitset0_b32 s55,3
v_smfmac_f32_16x16x64_bf16 v[48:51],v[28:31],a[192:199],v1
v_smfmac_f32_16x16x64_bf16 v[52:55],v[28:31],a[200:207],v1
v_smfmac_f32_16x16x64_bf16 v[56:59],v[28:31],a[208:215],v1
v_smfmac_f32_16x16x64_bf16 v[60:63],v[28:31],a[216:223],v1
v_smfmac_f32_16x16x64_bf16 v[64:67],v[28:31],a[224:231],v1
v_smfmac_f32_16x16x64_bf16 v[68:71],v[28:31],a[232:239],v1
v_smfmac_f32_16x16x64_bf16 v[72:75],v[28:31],a[240:247],v1
v_smfmac_f32_16x16x64_bf16 v[76:79],v[28:31],a[248:255],v1
l2s_100362:
s_cmp_eq_u32 s55,0
s_cbranch_scc0 lfb_100303
Ldone_100304:
s_waitcnt vmcnt(6)
v_max3_u32 v124,v32,v33,v34
v_max_u32 v124,v124,v35
v_cmp_eq_u32 vcc,-1,v124
s_cbranch_vccnz flb_100236
s_branch segb_100220
lfb_100303:
s_bitcmp1_b32 s55,0
s_cbranch_scc0 dsk_100364
buffer_load_dwordx4 v[16:19],v0,s[20:23],s92 offen offset:0 sc1
dsk_100364:
s_bitcmp1_b32 s55,1
s_cbranch_scc0 dsk_100365
buffer_load_dwordx4 v[20:23],v0,s[20:23],s92 offen offset:1024 sc1
dsk_100365:
s_bitcmp1_b32 s55,2
s_cbranch_scc0 dsk_100366
buffer_load_dwordx4 v[24:27],v0,s[20:23],s92 offen offset:2048 sc1
dsk_100366:
s_bitcmp1_b32 s55,3
s_cbranch_scc0 dsk_100367
buffer_load_dwordx4 v[28:31],v0,s[20:23],s92 offen offset:3072 sc1
dsk_100367:
s_bitcmp1_b32 s55,0
s_cbranch_scc0 dsk_100368
s_waitcnt vmcnt(2)
v_max3_u32 v124,v16,v17,v18
v_max_u32 v124,v124,v19
v_cmp_eq_u32 vcc,-1,v124
s_cbranch_vccz dgo_100369
s_nop 15
buffer_load_dwordx4 v[104:107],v0,s[20:23],s92 offen offset:0 sc1
s_nop 15
buffer_load_dwordx4 v[108:111],v0,s[20:23],s92 offen offset:0 sc1
dlp_100370:
s_waitcnt vmcnt(2)
v_max3_u32 v124,v16,v17,v18
v_max_u32 v124,v124,v19
v_cmp_eq_u32 vcc,-1,v124
s_cbranch_vccz dgo_100369
buffer_load_dwordx4 v[16:19],v0,s[20:23],s92 offen offset:0 sc1
s_waitcnt vmcnt(2)
v_max3_u32 v124,v104,v105,v106
v_max_u32 v124,v124,v107
v_cmp_eq_u32 vcc,-1,v124
s_cbranch_vccz dcp_100372
buffer_load_dwordx4 v[104:107],v0,s[20:23],s92 offen offset:0 sc1
s_waitcnt vmcnt(2)
v_max3_u32 v124,v108,v109,v110
v_max_u32 v124,v124,v111
v_cmp_eq_u32 vcc,-1,v124
s_cbranch_vccz dcp_100373
buffer_load_dwordx4 v[108:111],v0,s[20:23],s92 offen offset:0 sc1
s_sub_u32 s90,s90,1
s_cmp_gt_i32 s90,0
s_cbranch_scc1 dlp_100370
s_branch dgo_100369
dcp_100372:
v_mov_b32 v16,v104
v_mov_b32 v17,v105
v_mov_b32 v18,v106
v_mov_b32 v19,v107
s_nop 1
s_branch dgo_100369
dcp_100373:
v_mov_b32 v16,v108
v_mov_b32 v17,v109
v_mov_b32 v18,v110
v_mov_b32 v19,v111
s_nop 1
dgo_100369:
v_smfmac_f32_16x16x64_bf16 v[48:51],v[16:19],a[0:7],v1
v_smfmac_f32_16x16x64_bf16 v[52:55],v[16:19],a[8:15],v1
v_smfmac_f32_16x16x64_bf16 v[56:59],v[16:19],a[16:23],v1
v_smfmac_f32_16x16x64_bf16 v[60:63],v[16:19],a[24:31],v1
v_smfmac_f32_16x16x64_bf16 v[64:67],v[16:19],a[32:39],v1
v_smfmac_f32_16x16x64_bf16 v[68:71],v[16:19],a[40:47],v1
v_smfmac_f32_16x16x64_bf16 v[72:75],v[16:19],a[48:55],v1
v_smfmac_f32_16x16x64_bf16 v[76:79],v[16:19],a[56:63],v1
dsk_100368:
s_bitcmp1_b32 s55,1
s_cbranch_scc0 dsk_100374
s_waitcnt vmcnt(2)
v_max3_u32 v124,v20,v21,v22
v_max_u32 v124,v124,v23
v_cmp_eq_u32 vcc,-1,v124
s_cbranch_vccz dgo_100375
s_nop 15
buffer_load_dwordx4 v[104:107],v0,s[20:23],s92 offen offset:1024 sc1
s_nop 15
buffer_load_dwordx4 v[108:111],v0,s[20:23],s92 offen offset:1024 sc1
dlp_100376:
s_waitcnt vmcnt(2)
v_max3_u32 v124,v20,v21,v22
v_max_u32 v124,v124,v23
v_cmp_eq_u32 vcc,-1,v124
s_cbranch_vccz dgo_100375
buffer_load_dwordx4 v[20:23],v0,s[20:23],s92 offen offset:1024 sc1
s_waitcnt vmcnt(2)
v_max3_u32 v124,v104,v105,v106
v_max_u32 v124,v124,v107
v_cmp_eq_u32 vcc,-1,v124
s_cbranch_vccz dcp_100378
buffer_load_dwordx4 v[104:107],v0,s[20:23],s92 offen offset:1024 sc1
s_waitcnt vmcnt(2)
v_max3_u32 v124,v108,v109,v110
v_max_u32 v124,v124,v111
v_cmp_eq_u32 vcc,-1,v124
s_cbranch_vccz dcp_100379
buffer_load_dwordx4 v[108:111],v0,s[20:23],s92 offen offset:1024 sc1
s_sub_u32 s90,s90,1
s_cmp_gt_i32 s90,0
s_cbranch_scc1 dlp_100376
s_branch dgo_100375
dcp_100378:
v_mov_b32 v20,v104
v_mov_b32 v21,v105
v_mov_b32 v22,v106
v_mov_b32 v23,v107
s_nop 1
s_branch dgo_100375
dcp_100379:
v_mov_b32 v20,v108
v_mov_b32 v21,v109
v_mov_b32 v22,v110
v_mov_b32 v23,v111
s_nop 1
dgo_100375:
v_smfmac_f32_16x16x64_bf16 v[48:51],v[20:23],a[64:71],v1
v_smfmac_f32_16x16x64_bf16 v[52:55],v[20:23],a[72:79],v1
v_smfmac_f32_16x16x64_bf16 v[56:59],v[20:23],a[80:87],v1
v_smfmac_f32_16x16x64_bf16 v[60:63],v[20:23],a[88:95],v1
v_smfmac_f32_16x16x64_bf16 v[64:67],v[20:23],a[96:103],v1
v_smfmac_f32_16x16x64_bf16 v[68:71],v[20:23],a[104:111],v1
v_smfmac_f32_16x16x64_bf16 v[72:75],v[20:23],a[112:119],v1
v_smfmac_f32_16x16x64_bf16 v[76:79],v[20:23],a[120:127],v1
dsk_100374:
s_bitcmp1_b32 s55,2
s_cbranch_scc0 dsk_100380
s_waitcnt vmcnt(2)
v_max3_u32 v124,v24,v25,v26
v_max_u32 v124,v124,v27
v_cmp_eq_u32 vcc,-1,v124
s_cbranch_vccz dgo_100381
s_nop 15
buffer_load_dwordx4 v[104:107],v0,s[20:23],s92 offen offset:2048 sc1
s_nop 15
buffer_load_dwordx4 v[108:111],v0,s[20:23],s92 offen offset:2048 sc1
dlp_100382:
s_waitcnt vmcnt(2)
v_max3_u32 v124,v24,v25,v26
v_max_u32 v124,v124,v27
v_cmp_eq_u32 vcc,-1,v124
s_cbranch_vccz dgo_100381
buffer_load_dwordx4 v[24:27],v0,s[20:23],s92 offen offset:2048 sc1
s_waitcnt vmcnt(2)
v_max3_u32 v124,v104,v105,v106
v_max_u32 v124,v124,v107
v_cmp_eq_u32 vcc,-1,v124
s_cbranch_vccz dcp_100384
buffer_load_dwordx4 v[104:107],v0,s[20:23],s92 offen offset:2048 sc1
s_waitcnt vmcnt(2)
v_max3_u32 v124,v108,v109,v110
v_max_u32 v124,v124,v111
v_cmp_eq_u32 vcc,-1,v124
s_cbranch_vccz dcp_100385
buffer_load_dwordx4 v[108:111],v0,s[20:23],s92 offen offset:2048 sc1
s_sub_u32 s90,s90,1
s_cmp_gt_i32 s90,0
s_cbranch_scc1 dlp_100382
s_branch dgo_100381
dcp_100384:
v_mov_b32 v24,v104
v_mov_b32 v25,v105
v_mov_b32 v26,v106
v_mov_b32 v27,v107
s_nop 1
s_branch dgo_100381
dcp_100385:
v_mov_b32 v24,v108
v_mov_b32 v25,v109
v_mov_b32 v26,v110
v_mov_b32 v27,v111
s_nop 1
dgo_100381:
v_smfmac_f32_16x16x64_bf16 v[48:51],v[24:27],a[128:135],v1
v_smfmac_f32_16x16x64_bf16 v[52:55],v[24:27],a[136:143],v1
v_smfmac_f32_16x16x64_bf16 v[56:59],v[24:27],a[144:151],v1
v_smfmac_f32_16x16x64_bf16 v[60:63],v[24:27],a[152:159],v1
v_smfmac_f32_16x16x64_bf16 v[64:67],v[24:27],a[160:167],v1
v_smfmac_f32_16x16x64_bf16 v[68:71],v[24:27],a[168:175],v1
v_smfmac_f32_16x16x64_bf16 v[72:75],v[24:27],a[176:183],v1
v_smfmac_f32_16x16x64_bf16 v[76:79],v[24:27],a[184:191],v1
dsk_100380:
s_bitcmp1_b32 s55,3
s_cbranch_scc0 dsk_100386
s_waitcnt vmcnt(2)
v_max3_u32 v124,v28,v29,v30
v_max_u32 v124,v124,v31
v_cmp_eq_u32 vcc,-1,v124
s_cbranch_vccz dgo_100387
s_nop 15
buffer_load_dwordx4 v[104:107],v0,s[20:23],s92 offen offset:3072 sc1
s_nop 15
buffer_load_dwordx4 v[108:111],v0,s[20:23],s92 offen offset:3072 sc1
dlp_100388:
s_waitcnt vmcnt(2)
v_max3_u32 v124,v28,v29,v30
v_max_u32 v124,v124,v31
v_cmp_eq_u32 vcc,-1,v124
s_cbranch_vccz dgo_100387
buffer_load_dwordx4 v[28:31],v0,s[20:23],s92 offen offset:3072 sc1
s_waitcnt vmcnt(2)
v_max3_u32 v124,v104,v105,v106
v_max_u32 v124,v124,v107
v_cmp_eq_u32 vcc,-1,v124
s_cbranch_vccz dcp_100390
buffer_load_dwordx4 v[104:107],v0,s[20:23],s92 offen offset:3072 sc1
s_waitcnt vmcnt(2)
v_max3_u32 v124,v108,v109,v110
v_max_u32 v124,v124,v111
v_cmp_eq_u32 vcc,-1,v124
s_cbranch_vccz dcp_100391
buffer_load_dwordx4 v[108:111],v0,s[20:23],s92 offen offset:3072 sc1
s_sub_u32 s90,s90,1
s_cmp_gt_i32 s90,0
s_cbranch_scc1 dlp_100388
s_branch dgo_100387
dcp_100390:
v_mov_b32 v28,v104
v_mov_b32 v29,v105
v_mov_b32 v30,v106
v_mov_b32 v31,v107
s_nop 1
s_branch dgo_100387
dcp_100391:
v_mov_b32 v28,v108
v_mov_b32 v29,v109
v_mov_b32 v30,v110
v_mov_b32 v31,v111
s_nop 1
dgo_100387:
v_smfmac_f32_16x16x64_bf16 v[48:51],v[28:31],a[192:199],v1
v_smfmac_f32_16x16x64_bf16 v[52:55],v[28:31],a[200:207],v1
v_smfmac_f32_16x16x64_bf16 v[56:59],v[28:31],a[208:215],v1
v_smfmac_f32_16x16x64_bf16 v[60:63],v[28:31],a[216:223],v1
v_smfmac_f32_16x16x64_bf16 v[64:67],v[28:31],a[224:231],v1
v_smfmac_f32_16x16x64_bf16 v[68:71],v[28:31],a[232:239],v1
v_smfmac_f32_16x16x64_bf16 v[72:75],v[28:31],a[240:247],v1
v_smfmac_f32_16x16x64_bf16 v[76:79],v[28:31],a[248:255],v1
dsk_100386:
s_mov_b32 s55,0
s_branch Ldone_100304
slowA_100240:
buffer_load_dwordx4 v[44:47],v0,s[20:23],s93 offen offset:3072 sc1
dsk_100392:
s_bitcmp1_b32 s55,7
s_cbranch_scc0 dsk_100393
s_waitcnt vmcnt(2)
v_max3_u32 v124,v44,v45,v46
v_max_u32 v124,v124,v47
v_cmp_eq_u32 vcc,-1,v124
s_cbranch_vccz dgo_100394
s_nop 15
s_nop 3
buffer_load_dwordx4 v[104:107],v0,s[20:23],s93 offen offset:3072 sc1
s_nop 15
s_nop 3
buffer_load_dwordx4 v[108:111],v0,s[20:23],s93 offen offset:3072 sc1
dlp_100395:
s_waitcnt vmcnt(2)
v_max3_u32 v124,v44,v45,v46
v_max_u32 v124,v124,v47
v_cmp_eq_u32 vcc,-1,v124
s_cbranch_vccz dgo_100394
buffer_load_dwordx4 v[44:47],v0,s[20:23],s93 offen offset:3072 sc1
s_waitcnt vmcnt(2)
v_max3_u32 v124,v104,v105,v106
v_max_u32 v124,v124,v107
v_cmp_eq_u32 vcc,-1,v124
s_cbranch_vccz dcp_100397
buffer_load_dwordx4 v[104:107],v0,s[20:23],s93 offen offset:3072 sc1
s_waitcnt vmcnt(2)
v_max3_u32 v124,v108,v109,v110
v_max_u32 v124,v124,v111
v_cmp_eq_u32 vcc,-1,v124
s_cbranch_vccz dcp_100398
buffer_load_dwordx4 v[108:111],v0,s[20:23],s93 offen offset:3072 sc1
s_sub_u32 s90,s90,1
s_cmp_gt_i32 s90,0
s_cbranch_scc1 dlp_100395
s_branch dgo_100394
dcp_100397:
v_mov_b32 v44,v104
v_mov_b32 v45,v105
v_mov_b32 v46,v106
v_mov_b32 v47,v107
s_nop 1
s_branch dgo_100394
dcp_100398:
v_mov_b32 v44,v108
v_mov_b32 v45,v109
v_mov_b32 v46,v110
v_mov_b32 v47,v111
s_nop 1
dgo_100394:
dsk_100393:
s_mov_b32 s55,0
s_branch segb_100222
srt_100247:
s_sub_u32 s90,s90,1
s_cmp_gt_i32 s90,0
s_cbranch_scc0 sok_100246
buffer_load_dwordx4 v[16:19],v2,s[20:23],s94 offen offset:0 sc1
buffer_load_dwordx4 v[32:35],v2,s[20:23],s94 offen offset:1536 sc1
buffer_load_dwordx4 v[20:23],v2,s[20:23],s95 offen offset:0 sc1
buffer_load_dwordx4 v[36:39],v2,s[20:23],s95 offen offset:1536 sc1
buffer_load_dword v120,v3,s[20:23],s94 offen offset:0 sc1
buffer_load_dword v121,v3,s[20:23],s94 offen offset:1536 sc1
buffer_load_dword v122,v3,s[20:23],s95 offen offset:0 sc1
buffer_load_dword v123,v3,s[20:23],s95 offen offset:1536 sc1
s_branch sp_100245
of_100248:
s_mov_b32 s55,3
buffer_load_dwordx4 v[16:19],v0,s[20:23],s96 offen offset:0 sc1
buffer_load_dwordx4 v[20:23],v0,s[20:23],s96 offen offset:1024 sc1
v_readfirstlane_b32 s91,v126
s_waitcnt vmcnt(6)
v_max3_u32 v124,v24,v25,v26
v_max3_u32 v124,v124,v27,v28
v_max3_u32 v124,v124,v29,v30
v_max_u32 v124,v124,v31
v_cmp_eq_u32 vcc,-1,v124
s_cbranch_vccnz ost_100400
v_smfmac_f32_16x16x64_bf16 v[96:99],v[24:27],v[80:87],v1
buffer_load_dword v120,off,s[20:23],s96 sc1
v_smfmac_f32_16x16x64_bf16 v[100:103],v[24:27],v[88:95],v1
buffer_load_dword v120,off,s[20:23],s96 sc1
v_smfmac_f32_16x16x64_bf16 v[96:99],v[28:31],v[128:135],v1
v_smfmac_f32_16x16x64_bf16 v[100:103],v[28:31],v[136:143],v1
ort_100401:
s_waitcnt vmcnt(6)
v_max3_u32 v124,v32,v33,v34
v_max3_u32 v124,v124,v35,v36
v_max3_u32 v124,v124,v37,v38
v_max_u32 v124,v124,v39
v_cmp_eq_u32 vcc,-1,v124
s_cbranch_vccnz ost_100402
v_smfmac_f32_16x16x64_bf16 v[96:99],v[32:35],v[144:151],v1
buffer_load_dword v120,off,s[20:23],s96 sc1
v_smfmac_f32_16x16x64_bf16 v[100:103],v[32:35],v[152:159],v1
buffer_load_dword v120,off,s[20:23],s96 sc1
v_smfmac_f32_16x16x64_bf16 v[96:99],v[36:39],v[160:167],v1
v_smfmac_f32_16x16x64_bf16 v[100:103],v[36:39],v[168:175],v1
ort_100403:
s_waitcnt vmcnt(7)
v_max3_u32 v124,v40,v41,v42
v_max_u32 v124,v124,v43
v_cmp_eq_u32 vcc,-1,v124
s_cbranch_vccnz ost_100404
v_smfmac_f32_16x16x64_bf16 v[96:99],v[40:43],v[176:183],v1
buffer_load_dword v120,off,s[20:23],s96 sc1
v_smfmac_f32_16x16x64_bf16 v[100:103],v[40:43],v[184:191],v1
ort_100405:
s_waitcnt vmcnt(7)
v_max3_u32 v124,v44,v45,v46
v_max_u32 v124,v124,v47
v_cmp_eq_u32 vcc,-1,v124
s_cbranch_vccnz ost_100406
v_smfmac_f32_16x16x64_bf16 v[96:99],v[44:47],v[192:199],v1
buffer_load_dword v120,off,s[20:23],s96 sc1
v_smfmac_f32_16x16x64_bf16 v[100:103],v[44:47],v[200:207],v1
ort_100407:
s_waitcnt vmcnt(6)
v_max3_u32 v124,v16,v17,v18
v_max3_u32 v124,v124,v19,v20
v_max3_u32 v124,v124,v21,v22
v_max_u32 v124,v124,v23
v_cmp_eq_u32 vcc,-1,v124
s_cbranch_vccnz olap2_100399
s_andn2_b32 s55,s55,3
v_smfmac_f32_16x16x64_bf16 v[96:99],v[16:19],v[48:55],v1
v_smfmac_f32_16x16x64_bf16 v[100:103],v[16:19],v[56:63],v1
v_smfmac_f32_16x16x64_bf16 v[96:99],v[20:23],v[64:71],v1
v_smfmac_f32_16x16x64_bf16 v[100:103],v[20:23],v[72:79],v1
s_cbranch_scc0 oback_100259
s_branch olap2_100399
ost_100400:
buffer_load_dwordx4 v[24:27],v0,s[20:23],s96 offen offset:2048 sc1
buffer_load_dwordx4 v[28:31],v0,s[20:23],s96 offen offset:3072 sc1
s_or_b32 s55,s55,12
s_branch ort_100401
ost_100402:
buffer_load_dwordx4 v[32:35],v0,s[20:23],s97 offen offset:0 sc1
buffer_load_dwordx4 v[36:39],v0,s[20:23],s97 offen offset:1024 sc1
s_or_b32 s55,s55,48
s_branch ort_100403
ost_100404:
buffer_load_dwordx4 v[40:43],v0,s[20:23],s97 offen offset:2048 sc1
s_or_b32 s55,s55,64
s_branch ort_100405
ost_100406:
buffer_load_dwordx4 v[44:47],v0,s[20:23],s97 offen offset:3072 sc1
s_or_b32 s55,s55,128
s_branch ort_100407
of_100249:
s_mov_b32 s55,12
buffer_load_dwordx4 v[24:27],v0,s[20:23],s96 offen offset:2048 sc1
buffer_load_dwordx4 v[28:31],v0,s[20:23],s96 offen offset:3072 sc1
s_waitcnt vmcnt(4)
v_max3_u32 v124,v32,v33,v34
v_max3_u32 v124,v124,v35,v36
v_max3_u32 v124,v124,v37,v38
v_max_u32 v124,v124,v39
v_cmp_eq_u32 vcc,-1,v124
s_cbranch_vccnz ost_100409
v_smfmac_f32_16x16x64_bf16 v[96:99],v[32:35],v[144:151],v1
buffer_load_dword v120,off,s[20:23],s96 sc1
v_smfmac_f32_16x16x64_bf16 v[100:103],v[32:35],v[152:159],v1
buffer_load_dword v120,off,s[20:23],s96 sc1
v_smfmac_f32_16x16x64_bf16 v[96:99],v[36:39],v[160:167],v1
v_smfmac_f32_16x16x64_bf16 v[100:103],v[36:39],v[168:175],v1
ort_100410:
s_waitcnt vmcnt(5)
v_max3_u32 v124,v40,v41,v42
v_max_u32 v124,v124,v43
v_cmp_eq_u32 vcc,-1,v124
s_cbranch_vccnz ost_100411
v_smfmac_f32_16x16x64_bf16 v[96:99],v[40:43],v[176:183],v1
buffer_load_dword v120,off,s[20:23],s96 sc1
v_smfmac_f32_16x16x64_bf16 v[100:103],v[40:43],v[184:191],v1
ort_100412:
s_waitcnt vmcnt(5)
v_max3_u32 v124,v44,v45,v46
v_max_u32 v124,v124,v47
v_cmp_eq_u32 vcc,-1,v124
s_cbranch_vccnz ost_100413
v_smfmac_f32_16x16x64_bf16 v[96:99],v[44:47],v[192:199],v1
buffer_load_dword v120,off,s[20:23],s96 sc1
v_smfmac_f32_16x16x64_bf16 v[100:103],v[44:47],v[200:207],v1
ort_100414:
s_waitcnt vmcnt(4)
v_max3_u32 v124,v24,v25,v26
v_max3_u32 v124,v124,v27,v28
v_max3_u32 v124,v124,v29,v30
v_max_u32 v124,v124,v31
v_cmp_eq_u32 vcc,-1,v124
s_cbranch_vccnz olap2_100399
s_andn2_b32 s55,s55,12
v_smfmac_f32_16x16x64_bf16 v[96:99],v[24:27],v[80:87],v1
v_smfmac_f32_16x16x64_bf16 v[100:103],v[24:27],v[88:95],v1
v_smfmac_f32_16x16x64_bf16 v[96:99],v[28:31],v[128:135],v1
v_smfmac_f32_16x16x64_bf16 v[100:103],v[28:31],v[136:143],v1
s_cbranch_scc0 oback_100259
s_branch olap2_100399
ost_100409:
buffer_load_dwordx4 v[32:35],v0,s[20:23],s97 offen offset:0 sc1
buffer_load_dwordx4 v[36:39],v0,s[20:23],s97 offen offset:1024 sc1
s_or_b32 s55,s55,48
s_branch ort_100410
ost_100411:
buffer_load_dwordx4 v[40:43],v0,s[20:23],s97 offen offset:2048 sc1
s_or_b32 s55,s55,64
s_branch ort_100412
ost_100413:
buffer_load_dwordx4 v[44:47],v0,s[20:23],s97 offen offset:3072 sc1
s_or_b32 s55,s55,128
s_branch ort_100414
of_100250:
s_mov_b32 s55,48
buffer_load_dwordx4 v[32:35],v0,s[20:23],s97 offen offset:0 sc1
buffer_load_dwordx4 v[36:39],v0,s[20:23],s97 offen offset:1024 sc1
s_waitcnt vmcnt(3)
v_max3_u32 v124,v40,v41,v42
v_max_u32 v124,v124,v43
v_cmp_eq_u32 vcc,-1,v124
s_cbranch_vccnz ost_100416
v_smfmac_f32_16x16x64_bf16 v[96:99],v[40:43],v[176:183],v1
buffer_load_dword v120,off,s[20:23],s96 sc1
v_smfmac_f32_16x16x64_bf16 v[100:103],v[40:43],v[184:191],v1
ort_100417:
s_waitcnt vmcnt(3)
v_max3_u32 v124,v44,v45,v46
v_max_u32 v124,v124,v47
v_cmp_eq_u32 vcc,-1,v124
s_cbranch_vccnz ost_100418
v_smfmac_f32_16x16x64_bf16 v[96:99],v[44:47],v[192:199],v1
buffer_load_dword v120,off,s[20:23],s96 sc1
v_smfmac_f32_16x16x64_bf16 v[100:103],v[44:47],v[200:207],v1
ort_100419:
s_waitcnt vmcnt(2)
v_max3_u32 v124,v32,v33,v34
v_max3_u32 v124,v124,v35,v36
v_max3_u32 v124,v124,v37,v38
v_max_u32 v124,v124,v39
v_cmp_eq_u32 vcc,-1,v124
s_cbranch_vccnz olap2_100399
s_andn2_b32 s55,s55,48
v_smfmac_f32_16x16x64_bf16 v[96:99],v[32:35],v[144:151],v1
v_smfmac_f32_16x16x64_bf16 v[100:103],v[32:35],v[152:159],v1
v_smfmac_f32_16x16x64_bf16 v[96:99],v[36:39],v[160:167],v1
v_smfmac_f32_16x16x64_bf16 v[100:103],v[36:39],v[168:175],v1
s_cbranch_scc0 oback_100259
s_branch olap2_100399
ost_100416:
buffer_load_dwordx4 v[40:43],v0,s[20:23],s97 offen offset:2048 sc1
s_or_b32 s55,s55,64
s_branch ort_100417
ost_100418:
buffer_load_dwordx4 v[44:47],v0,s[20:23],s97 offen offset:3072 sc1
s_or_b32 s55,s55,128
s_branch ort_100419
of_100251:
s_mov_b32 s55,64
buffer_load_dwordx4 v[40:43],v0,s[20:23],s97 offen offset:2048 sc1
s_waitcnt vmcnt(1)
v_max3_u32 v124,v44,v45,v46
v_max_u32 v124,v124,v47
v_cmp_eq_u32 vcc,-1,v124
s_cbranch_vccnz ost_100421
v_smfmac_f32_16x16x64_bf16 v[96:99],v[44:47],v[192:199],v1
buffer_load_dword v120,off,s[20:23],s96 sc1
v_smfmac_f32_16x16x64_bf16 v[100:103],v[44:47],v[200:207],v1
ort_100422:
s_waitcnt vmcnt(1)
v_max3_u32 v124,v40,v41,v42
v_max_u32 v124,v124,v43
v_cmp_eq_u32 vcc,-1,v124
s_cbranch_vccnz olap2_100399
s_andn2_b32 s55,s55,64
v_smfmac_f32_16x16x64_bf16 v[96:99],v[40:43],v[176:183],v1
v_smfmac_f32_16x16x64_bf16 v[100:103],v[40:43],v[184:191],v1
s_cbranch_scc0 oback_100259
s_branch olap2_100399
ost_100421:
buffer_load_dwordx4 v[44:47],v0,s[20:23],s97 offen offset:3072 sc1
s_or_b32 s55,s55,128
s_branch ort_100422
of_100252:
s_mov_b32 s55,128
s_branch oslow_100258
olap2_100399:
s_bitcmp1_b32 s55,0
s_cbranch_scc0 l2s_100424
s_waitcnt vmcnt(6)
v_max3_u32 v124,v16,v17,v18
v_max3_u32 v124,v124,v19,v20
v_max3_u32 v124,v124,v21,v22
v_max_u32 v124,v124,v23
v_cmp_eq_u32 vcc,-1,v124
s_cbranch_vccnz l2s_100424
s_andn2_b32 s55,s55,3
v_smfmac_f32_16x16x64_bf16 v[96:99],v[16:19],v[48:55],v1
v_smfmac_f32_16x16x64_bf16 v[100:103],v[16:19],v[56:63],v1
v_smfmac_f32_16x16x64_bf16 v[96:99],v[20:23],v[64:71],v1
v_smfmac_f32_16x16x64_bf16 v[100:103],v[20:23],v[72:79],v1
l2s_100424:
s_bitcmp1_b32 s55,2
s_cbranch_scc0 l2s_100425
s_waitcnt vmcnt(4)
v_max3_u32 v124,v24,v25,v26
v_max3_u32 v124,v124,v27,v28
v_max3_u32 v124,v124,v29,v30
v_max_u32 v124,v124,v31
v_cmp_eq_u32 vcc,-1,v124
s_cbranch_vccnz l2s_100425
s_andn2_b32 s55,s55,12
v_smfmac_f32_16x16x64_bf16 v[96:99],v[24:27],v[80:87],v1
v_smfmac_f32_16x16x64_bf16 v[100:103],v[24:27],v[88:95],v1
v_smfmac_f32_16x16x64_bf16 v[96:99],v[28:31],v[128:135],v1
v_smfmac_f32_16x16x64_bf16 v[100:103],v[28:31],v[136:143],v1
l2s_100425:
s_bitcmp1_b32 s55,4
s_cbranch_scc0 l2s_100426
s_waitcnt vmcnt(2)
v_max3_u32 v124,v32,v33,v34
v_max3_u32 v124,v124,v35,v36
v_max3_u32 v124,v124,v37,v38
v_max_u32 v124,v124,v39
v_cmp_eq_u32 vcc,-1,v124
s_cbranch_vccnz l2s_100426
s_andn2_b32 s55,s55,48
v_smfmac_f32_16x16x64_bf16 v[96:99],v[32:35],v[144:151],v1
v_smfmac_f32_16x16x64_bf16 v[100:103],v[32:35],v[152:159],v1
v_smfmac_f32_16x16x64_bf16 v[96:99],v[36:39],v[160:167],v1
v_smfmac_f32_16x16x64_bf16 v[100:103],v[36:39],v[168:175],v1
l2s_100426:
s_bitcmp1_b32 s55,6
s_cbranch_scc0 l2s_100427
s_waitcnt vmcnt(1)
v_max3_u32 v124,v40,v41,v42
v_max_u32 v124,v124,v43
v_cmp_eq_u32 vcc,-1,v124
s_cbranch_vccnz l2s_100427
s_andn2_b32 s55,s55,64
v_smfmac_f32_16x16x64_bf16 v[96:99],v[40:43],v[176:183],v1
v_smfmac_f32_16x16x64_bf16 v[100:103],v[40:43],v[184:191],v1
l2s_100427:
s_bitcmp1_b32 s55,7
s_cbranch_scc0 l2s_100428
s_waitcnt vmcnt(0)
v_max3_u32 v124,v44,v45,v46
v_max_u32 v124,v124,v47
v_cmp_eq_u32 vcc,-1,v124
s_cbranch_vccnz l2s_100428
s_andn2_b32 s55,s55,128
v_smfmac_f32_16x16x64_bf16 v[96:99],v[44:47],v[192:199],v1
v_smfmac_f32_16x16x64_bf16 v[100:103],v[44:47],v[200:207],v1
l2s_100428:
s_cmp_eq_u32 s55,0
s_cbranch_scc1 oback_100259
oslow_100258:
s_bitcmp1_b32 s55,0
s_cbranch_scc0 dsk_100429
buffer_load_dwordx4 v[16:19],v0,s[20:23],s96 offen offset:0 sc1
dsk_100429:
s_bitcmp1_b32 s55,1
s_cbranch_scc0 dsk_100430
buffer_load_dwordx4 v[20:23],v0,s[20:23],s96 offen offset:1024 sc1
dsk_100430:
s_bitcmp1_b32 s55,2
s_cbranch_scc0 dsk_100431
buffer_load_dwordx4 v[24:27],v0,s[20:23],s96 offen offset:2048 sc1
dsk_100431:
s_bitcmp1_b32 s55,3
s_cbranch_scc0 dsk_100432
buffer_load_dwordx4 v[28:31],v0,s[20:23],s96 offen offset:3072 sc1
dsk_100432:
s_bitcmp1_b32 s55,4
s_cbranch_scc0 dsk_100433
buffer_load_dwordx4 v[32:35],v0,s[20:23],s97 offen offset:0 sc1
dsk_100433:
s_bitcmp1_b32 s55,5
s_cbranch_scc0 dsk_100434
buffer_load_dwordx4 v[36:39],v0,s[20:23],s97 offen offset:1024 sc1
dsk_100434:
s_bitcmp1_b32 s55,6
s_cbranch_scc0 dsk_100435
buffer_load_dwordx4 v[40:43],v0,s[20:23],s97 offen offset:2048 sc1
dsk_100435:
s_bitcmp1_b32 s55,7
s_cbranch_scc0 dsk_100436
buffer_load_dwordx4 v[44:47],v0,s[20:23],s97 offen offset:3072 sc1
dsk_100436:
s_bitcmp1_b32 s55,0
s_cbranch_scc0 dsk_100437
s_waitcnt vmcnt(2)
v_max3_u32 v124,v16,v17,v18
v_max_u32 v124,v124,v19
v_cmp_eq_u32 vcc,-1,v124
s_cbranch_vccz dgo_100438
s_nop 15
buffer_load_dwordx4 v[116:119],v0,s[20:23],s96 offen offset:0 sc1
s_nop 15
buffer_load_dwordx4 v[120:123],v0,s[20:23],s96 offen offset:0 sc1
dlp_100439:
s_waitcnt vmcnt(2)
v_max3_u32 v124,v16,v17,v18
v_max_u32 v124,v124,v19
v_cmp_eq_u32 vcc,-1,v124
s_cbranch_vccz dgo_100438
buffer_load_dwordx4 v[16:19],v0,s[20:23],s96 offen offset:0 sc1
s_waitcnt vmcnt(2)
v_max3_u32 v124,v116,v117,v118
v_max_u32 v124,v124,v119
v_cmp_eq_u32 vcc,-1,v124
s_cbranch_vccz dcp_100441
buffer_load_dwordx4 v[116:119],v0,s[20:23],s96 offen offset:0 sc1
s_waitcnt vmcnt(2)
v_max3_u32 v124,v120,v121,v122
v_max_u32 v124,v124,v123
v_cmp_eq_u32 vcc,-1,v124
s_cbranch_vccz dcp_100442
buffer_load_dwordx4 v[120:123],v0,s[20:23],s96 offen offset:0 sc1
s_sub_u32 s90,s90,1
s_cmp_gt_i32 s90,0
s_cbranch_scc1 dlp_100439
s_branch dgo_100438
dcp_100441:
v_mov_b32 v16,v116
v_mov_b32 v17,v117
v_mov_b32 v18,v118
v_mov_b32 v19,v119
s_nop 1
s_branch dgo_100438
dcp_100442:
v_mov_b32 v16,v120
v_mov_b32 v17,v121
v_mov_b32 v18,v122
v_mov_b32 v19,v123
s_nop 1
dgo_100438:
v_smfmac_f32_16x16x64_bf16 v[96:99],v[16:19],v[48:55],v1
v_smfmac_f32_16x16x64_bf16 v[100:103],v[16:19],v[56:63],v1
dsk_100437:
s_bitcmp1_b32 s55,1
s_cbranch_scc0 dsk_100443
s_waitcnt vmcnt(2)
v_max3_u32 v124,v20,v21,v22
v_max_u32 v124,v124,v23
v_cmp_eq_u32 vcc,-1,v124
s_cbranch_vccz dgo_100444
s_nop 15
buffer_load_dwordx4 v[116:119],v0,s[20:23],s96 offen offset:1024 sc1
s_nop 15
buffer_load_dwordx4 v[120:123],v0,s[20:23],s96 offen offset:1024 sc1
dlp_100445:
s_waitcnt vmcnt(2)
v_max3_u32 v124,v20,v21,v22
v_max_u32 v124,v124,v23
v_cmp_eq_u32 vcc,-1,v124
s_cbranch_vccz dgo_100444
buffer_load_dwordx4 v[20:23],v0,s[20:23],s96 offen offset:1024 sc1
s_waitcnt vmcnt(2)
v_max3_u32 v124,v116,v117,v118
v_max_u32 v124,v124,v119
v_cmp_eq_u32 vcc,-1,v124
s_cbranch_vccz dcp_100447
buffer_load_dwordx4 v[116:119],v0,s[20:23],s96 offen offset:1024 sc1
s_waitcnt vmcnt(2)
v_max3_u32 v124,v120,v121,v122
v_max_u32 v124,v124,v123
v_cmp_eq_u32 vcc,-1,v124
s_cbranch_vccz dcp_100448
buffer_load_dwordx4 v[120:123],v0,s[20:23],s96 offen offset:1024 sc1
s_sub_u32 s90,s90,1
s_cmp_gt_i32 s90,0
s_cbranch_scc1 dlp_100445
s_branch dgo_100444
dcp_100447:
v_mov_b32 v20,v116
v_mov_b32 v21,v117
v_mov_b32 v22,v118
v_mov_b32 v23,v119
s_nop 1
s_branch dgo_100444
dcp_100448:
v_mov_b32 v20,v120
v_mov_b32 v21,v121
v_mov_b32 v22,v122
v_mov_b32 v23,v123
s_nop 1
dgo_100444:
v_smfmac_f32_16x16x64_bf16 v[96:99],v[20:23],v[64:71],v1
v_smfmac_f32_16x16x64_bf16 v[100:103],v[20:23],v[72:79],v1
dsk_100443:
s_bitcmp1_b32 s55,2
s_cbranch_scc0 dsk_100449
s_waitcnt vmcnt(2)
v_max3_u32 v124,v24,v25,v26
v_max_u32 v124,v124,v27
v_cmp_eq_u32 vcc,-1,v124
s_cbranch_vccz dgo_100450
s_nop 15
buffer_load_dwordx4 v[116:119],v0,s[20:23],s96 offen offset:2048 sc1
s_nop 15
buffer_load_dwordx4 v[120:123],v0,s[20:23],s96 offen offset:2048 sc1
dlp_100451:
s_waitcnt vmcnt(2)
v_max3_u32 v124,v24,v25,v26
v_max_u32 v124,v124,v27
v_cmp_eq_u32 vcc,-1,v124
s_cbranch_vccz dgo_100450
buffer_load_dwordx4 v[24:27],v0,s[20:23],s96 offen offset:2048 sc1
s_waitcnt vmcnt(2)
v_max3_u32 v124,v116,v117,v118
v_max_u32 v124,v124,v119
v_cmp_eq_u32 vcc,-1,v124
s_cbranch_vccz dcp_100453
buffer_load_dwordx4 v[116:119],v0,s[20:23],s96 offen offset:2048 sc1
s_waitcnt vmcnt(2)
v_max3_u32 v124,v120,v121,v122
v_max_u32 v124,v124,v123
v_cmp_eq_u32 vcc,-1,v124
s_cbranch_vccz dcp_100454
buffer_load_dwordx4 v[120:123],v0,s[20:23],s96 offen offset:2048 sc1
s_sub_u32 s90,s90,1
s_cmp_gt_i32 s90,0
s_cbranch_scc1 dlp_100451
s_branch dgo_100450
dcp_100453:
v_mov_b32 v24,v116
v_mov_b32 v25,v117
v_mov_b32 v26,v118
v_mov_b32 v27,v119
s_nop 1
s_branch dgo_100450
dcp_100454:
v_mov_b32 v24,v120
v_mov_b32 v25,v121
v_mov_b32 v26,v122
v_mov_b32 v27,v123
s_nop 1
dgo_100450:
v_smfmac_f32_16x16x64_bf16 v[96:99],v[24:27],v[80:87],v1
v_smfmac_f32_16x16x64_bf16 v[100:103],v[24:27],v[88:95],v1
dsk_100449:
s_bitcmp1_b32 s55,3
s_cbranch_scc0 dsk_100455
s_waitcnt vmcnt(2)
v_max3_u32 v124,v28,v29,v30
v_max_u32 v124,v124,v31
v_cmp_eq_u32 vcc,-1,v124
s_cbranch_vccz dgo_100456
s_nop 15
buffer_load_dwordx4 v[116:119],v0,s[20:23],s96 offen offset:3072 sc1
s_nop 15
buffer_load_dwordx4 v[120:123],v0,s[20:23],s96 offen offset:3072 sc1
dlp_100457:
s_waitcnt vmcnt(2)
v_max3_u32 v124,v28,v29,v30
v_max_u32 v124,v124,v31
v_cmp_eq_u32 vcc,-1,v124
s_cbranch_vccz dgo_100456
buffer_load_dwordx4 v[28:31],v0,s[20:23],s96 offen offset:3072 sc1
s_waitcnt vmcnt(2)
v_max3_u32 v124,v116,v117,v118
v_max_u32 v124,v124,v119
v_cmp_eq_u32 vcc,-1,v124
s_cbranch_vccz dcp_100459
buffer_load_dwordx4 v[116:119],v0,s[20:23],s96 offen offset:3072 sc1
s_waitcnt vmcnt(2)
v_max3_u32 v124,v120,v121,v122
v_max_u32 v124,v124,v123
v_cmp_eq_u32 vcc,-1,v124
s_cbranch_vccz dcp_100460
buffer_load_dwordx4 v[120:123],v0,s[20:23],s96 offen offset:3072 sc1
s_sub_u32 s90,s90,1
s_cmp_gt_i32 s90,0
s_cbranch_scc1 dlp_100457
s_branch dgo_100456
dcp_100459:
v_mov_b32 v28,v116
v_mov_b32 v29,v117
v_mov_b32 v30,v118
v_mov_b32 v31,v119
s_nop 1
s_branch dgo_100456
dcp_100460:
v_mov_b32 v28,v120
v_mov_b32 v29,v121
v_mov_b32 v30,v122
v_mov_b32 v31,v123
s_nop 1
dgo_100456:
v_smfmac_f32_16x16x64_bf16 v[96:99],v[28:31],v[128:135],v1
v_smfmac_f32_16x16x64_bf16 v[100:103],v[28:31],v[136:143],v1
dsk_100455:
s_bitcmp1_b32 s55,4
s_cbranch_scc0 dsk_100461
s_waitcnt vmcnt(2)
v_max3_u32 v124,v32,v33,v34
v_max_u32 v124,v124,v35
v_cmp_eq_u32 vcc,-1,v124
s_cbranch_vccz dgo_100462
s_nop 15
buffer_load_dwordx4 v[116:119],v0,s[20:23],s97 offen offset:0 sc1
s_nop 15
buffer_load_dwordx4 v[120:123],v0,s[20:23],s97 offen offset:0 sc1
dlp_100463:
s_waitcnt vmcnt(2)
v_max3_u32 v124,v32,v33,v34
v_max_u32 v124,v124,v35
v_cmp_eq_u32 vcc,-1,v124
s_cbranch_vccz dgo_100462
buffer_load_dwordx4 v[32:35],v0,s[20:23],s97 offen offset:0 sc1
s_waitcnt vmcnt(2)
v_max3_u32 v124,v116,v117,v118
v_max_u32 v124,v124,v119
v_cmp_eq_u32 vcc,-1,v124
s_cbranch_vccz dcp_100465
buffer_load_dwordx4 v[116:119],v0,s[20:23],s97 offen offset:0 sc1
s_waitcnt vmcnt(2)
v_max3_u32 v124,v120,v121,v122
v_max_u32 v124,v124,v123
v_cmp_eq_u32 vcc,-1,v124
s_cbranch_vccz dcp_100466
buffer_load_dwordx4 v[120:123],v0,s[20:23],s97 offen offset:0 sc1
s_sub_u32 s90,s90,1
s_cmp_gt_i32 s90,0
s_cbranch_scc1 dlp_100463
s_branch dgo_100462
dcp_100465:
v_mov_b32 v32,v116
v_mov_b32 v33,v117
v_mov_b32 v34,v118
v_mov_b32 v35,v119
s_nop 1
s_branch dgo_100462
dcp_100466:
v_mov_b32 v32,v120
v_mov_b32 v33,v121
v_mov_b32 v34,v122
v_mov_b32 v35,v123
s_nop 1
dgo_100462:
v_smfmac_f32_16x16x64_bf16 v[96:99],v[32:35],v[144:151],v1
v_smfmac_f32_16x16x64_bf16 v[100:103],v[32:35],v[152:159],v1
dsk_100461:
s_bitcmp1_b32 s55,5
s_cbranch_scc0 dsk_100467
s_waitcnt vmcnt(2)
v_max3_u32 v124,v36,v37,v38
v_max_u32 v124,v124,v39
v_cmp_eq_u32 vcc,-1,v124
s_cbranch_vccz dgo_100468
s_nop 15
buffer_load_dwordx4 v[116:119],v0,s[20:23],s97 offen offset:1024 sc1
s_nop 15
buffer_load_dwordx4 v[120:123],v0,s[20:23],s97 offen offset:1024 sc1
dlp_100469:
s_waitcnt vmcnt(2)
v_max3_u32 v124,v36,v37,v38
v_max_u32 v124,v124,v39
v_cmp_eq_u32 vcc,-1,v124
s_cbranch_vccz dgo_100468
buffer_load_dwordx4 v[36:39],v0,s[20:23],s97 offen offset:1024 sc1
s_waitcnt vmcnt(2)
v_max3_u32 v124,v116,v117,v118
v_max_u32 v124,v124,v119
v_cmp_eq_u32 vcc,-1,v124
s_cbranch_vccz dcp_100471
buffer_load_dwordx4 v[116:119],v0,s[20:23],s97 offen offset:1024 sc1
s_waitcnt vmcnt(2)
v_max3_u32 v124,v120,v121,v122
v_max_u32 v124,v124,v123
v_cmp_eq_u32 vcc,-1,v124
s_cbranch_vccz dcp_100472
buffer_load_dwordx4 v[120:123],v0,s[20:23],s97 offen offset:1024 sc1
s_sub_u32 s90,s90,1
s_cmp_gt_i32 s90,0
s_cbranch_scc1 dlp_100469
s_branch dgo_100468
dcp_100471:
v_mov_b32 v36,v116
v_mov_b32 v37,v117
v_mov_b32 v38,v118
v_mov_b32 v39,v119
s_nop 1
s_branch dgo_100468
dcp_100472:
v_mov_b32 v36,v120
v_mov_b32 v37,v121
v_mov_b32 v38,v122
v_mov_b32 v39,v123
s_nop 1
dgo_100468:
v_smfmac_f32_16x16x64_bf16 v[96:99],v[36:39],v[160:167],v1
v_smfmac_f32_16x16x64_bf16 v[100:103],v[36:39],v[168:175],v1
dsk_100467:
s_bitcmp1_b32 s55,6
s_cbranch_scc0 dsk_100473
s_waitcnt vmcnt(2)
v_max3_u32 v124,v40,v41,v42
v_max_u32 v124,v124,v43
v_cmp_eq_u32 vcc,-1,v124
s_cbranch_vccz dgo_100474
s_nop 15
buffer_load_dwordx4 v[116:119],v0,s[20:23],s97 offen offset:2048 sc1
s_nop 15
buffer_load_dwordx4 v[120:123],v0,s[20:23],s97 offen offset:2048 sc1
dlp_100475:
s_waitcnt vmcnt(2)
v_max3_u32 v124,v40,v41,v42
v_max_u32 v124,v124,v43
v_cmp_eq_u32 vcc,-1,v124
s_cbranch_vccz dgo_100474
buffer_load_dwordx4 v[40:43],v0,s[20:23],s97 offen offset:2048 sc1
s_waitcnt vmcnt(2)
v_max3_u32 v124,v116,v117,v118
v_max_u32 v124,v124,v119
v_cmp_eq_u32 vcc,-1,v124
s_cbranch_vccz dcp_100477
buffer_load_dwordx4 v[116:119],v0,s[20:23],s97 offen offset:2048 sc1
s_waitcnt vmcnt(2)
v_max3_u32 v124,v120,v121,v122
v_max_u32 v124,v124,v123
v_cmp_eq_u32 vcc,-1,v124
s_cbranch_vccz dcp_100478
buffer_load_dwordx4 v[120:123],v0,s[20:23],s97 offen offset:2048 sc1
s_sub_u32 s90,s90,1
s_cmp_gt_i32 s90,0
s_cbranch_scc1 dlp_100475
s_branch dgo_100474
dcp_100477:
v_mov_b32 v40,v116
v_mov_b32 v41,v117
v_mov_b32 v42,v118
v_mov_b32 v43,v119
s_nop 1
s_branch dgo_100474
dcp_100478:
v_mov_b32 v40,v120
v_mov_b32 v41,v121
v_mov_b32 v42,v122
v_mov_b32 v43,v123
s_nop 1
dgo_100474:
v_smfmac_f32_16x16x64_bf16 v[96:99],v[40:43],v[176:183],v1
v_smfmac_f32_16x16x64_bf16 v[100:103],v[40:43],v[184:191],v1
dsk_100473:
s_bitcmp1_b32 s55,7
s_cbranch_scc0 dsk_100479
s_waitcnt vmcnt(2)
v_max3_u32 v124,v44,v45,v46
v_max_u32 v124,v124,v47
v_cmp_eq_u32 vcc,-1,v124
s_cbranch_vccz dgo_100480
s_nop 15
buffer_load_dwordx4 v[116:119],v0,s[20:23],s97 offen offset:3072 sc1
s_nop 15
buffer_load_dwordx4 v[120:123],v0,s[20:23],s97 offen offset:3072 sc1
dlp_100481:
s_waitcnt vmcnt(2)
v_max3_u32 v124,v44,v45,v46
v_max_u32 v124,v124,v47
v_cmp_eq_u32 vcc,-1,v124
s_cbranch_vccz dgo_100480
buffer_load_dwordx4 v[44:47],v0,s[20:23],s97 offen offset:3072 sc1
s_waitcnt vmcnt(2)
v_max3_u32 v124,v116,v117,v118
v_max_u32 v124,v124,v119
v_cmp_eq_u32 vcc,-1,v124
s_cbranch_vccz dcp_100483
buffer_load_dwordx4 v[116:119],v0,s[20:23],s97 offen offset:3072 sc1
s_waitcnt vmcnt(2)
v_max3_u32 v124,v120,v121,v122
v_max_u32 v124,v124,v123
v_cmp_eq_u32 vcc,-1,v124
s_cbranch_vccz dcp_100484
buffer_load_dwordx4 v[120:123],v0,s[20:23],s97 offen offset:3072 sc1
s_sub_u32 s90,s90,1
s_cmp_gt_i32 s90,0
s_cbranch_scc1 dlp_100481
s_branch dgo_100480
dcp_100483:
v_mov_b32 v44,v116
v_mov_b32 v45,v117
v_mov_b32 v46,v118
v_mov_b32 v47,v119
s_nop 1
s_branch dgo_100480
dcp_100484:
v_mov_b32 v44,v120
v_mov_b32 v45,v121
v_mov_b32 v46,v122
v_mov_b32 v47,v123
s_nop 1
dgo_100480:
v_smfmac_f32_16x16x64_bf16 v[96:99],v[44:47],v[192:199],v1
v_smfmac_f32_16x16x64_bf16 v[100:103],v[44:47],v[200:207],v1
dsk_100479:
s_mov_b32 s55,0
s_branch oback_100259
fl_100276:
flb_100284:
buffer_load_dwordx4 v[16:19],v0,s[20:23],s92 offen offset:0 sc1
s_mov_b32 s55,1
buffer_load_dwordx4 v[32:35],v0,s[20:23],s93 offen offset:0 sc1
s_waitcnt vmcnt(4)
v_max3_u32 v124,v20,v21,v22
v_max_u32 v124,v124,v23
v_cmp_eq_u32 vcc,-1,v124
s_cbranch_vccnz dfl_100485
v_smfmac_f32_16x16x64_bf16 v[64:67],v[20:23],a[96:103],v1
buffer_load_dword v125,off,s[20:23],s92 sc1
buffer_load_dwordx4 v[36:39],v0,s[20:23],s93 offen offset:1024 sc1
s_waitcnt vmcnt(5)
v_max3_u32 v124,v24,v25,v26
v_smfmac_f32_16x16x64_bf16 v[68:71],v[20:23],a[104:111],v1
v_max_u32 v124,v124,v27
v_cmp_eq_u32 vcc,-1,v124
v_smfmac_f32_16x16x64_bf16 v[72:75],v[20:23],a[112:119],v1
v_smfmac_f32_16x16x64_bf16 v[76:79],v[20:23],a[120:127],v1
s_cbranch_vccnz dfl_100486
v_smfmac_f32_16x16x64_bf16 v[64:67],v[24:27],a[160:167],v1
buffer_load_dword v125,off,s[20:23],s92 sc1
buffer_load_dwordx4 v[40:43],v0,s[20:23],s93 offen offset:2048 sc1
buffer_load_dwordx4 v[44:47],v0,s[20:23],s93 offen offset:3072 sc1
s_waitcnt vmcnt(7)
v_max3_u32 v124,v28,v29,v30
v_smfmac_f32_16x16x64_bf16 v[68:71],v[24:27],a[168:175],v1
v_max_u32 v124,v124,v31
v_cmp_eq_u32 vcc,-1,v124
v_smfmac_f32_16x16x64_bf16 v[72:75],v[24:27],a[176:183],v1
v_smfmac_f32_16x16x64_bf16 v[76:79],v[24:27],a[184:191],v1
s_cbranch_vccnz dfl_100487
v_smfmac_f32_16x16x64_bf16 v[64:67],v[28:31],a[224:231],v1
buffer_load_dword v125,off,s[20:23],s92 sc1
s_waitcnt vmcnt(7)
v_max3_u32 v124,v16,v17,v18
v_smfmac_f32_16x16x64_bf16 v[68:71],v[28:31],a[232:239],v1
v_max_u32 v124,v124,v19
v_cmp_eq_u32 vcc,-1,v124
v_smfmac_f32_16x16x64_bf16 v[72:75],v[28:31],a[240:247],v1
v_smfmac_f32_16x16x64_bf16 v[76:79],v[28:31],a[248:255],v1
s_cbranch_vccnz lfb_100492
s_mov_b32 s55,0
v_smfmac_f32_16x16x64_bf16 v[64:67],v[16:19],a[32:39],v1
s_waitcnt vmcnt(6)
v_max3_u32 v124,v32,v33,v34
v_max_u32 v124,v124,v35
v_cmp_eq_u32 vcc,-1,v124
v_smfmac_f32_16x16x64_bf16 v[68:71],v[16:19],a[40:47],v1
v_smfmac_f32_16x16x64_bf16 v[72:75],v[16:19],a[48:55],v1
v_smfmac_f32_16x16x64_bf16 v[76:79],v[16:19],a[56:63],v1
s_cbranch_vccnz flb_100288
s_branch segb_100272
fl_100277:
flb_100285:
buffer_load_dwordx4 v[20:23],v0,s[20:23],s92 offen offset:1024 sc1
s_mov_b32 s55,2
buffer_load_dwordx4 v[36:39],v0,s[20:23],s93 offen offset:1024 sc1
s_waitcnt vmcnt(5)
v_max3_u32 v124,v24,v25,v26
v_max_u32 v124,v124,v27
v_cmp_eq_u32 vcc,-1,v124
s_cbranch_vccnz dfl_100486
v_smfmac_f32_16x16x64_bf16 v[64:67],v[24:27],a[160:167],v1
buffer_load_dword v125,off,s[20:23],s92 sc1
buffer_load_dwordx4 v[40:43],v0,s[20:23],s93 offen offset:2048 sc1
buffer_load_dwordx4 v[44:47],v0,s[20:23],s93 offen offset:3072 sc1
s_waitcnt vmcnt(7)
v_max3_u32 v124,v28,v29,v30
v_smfmac_f32_16x16x64_bf16 v[68:71],v[24:27],a[168:175],v1
v_max_u32 v124,v124,v31
v_cmp_eq_u32 vcc,-1,v124
v_smfmac_f32_16x16x64_bf16 v[72:75],v[24:27],a[176:183],v1
v_smfmac_f32_16x16x64_bf16 v[76:79],v[24:27],a[184:191],v1
s_cbranch_vccnz dfl_100487
v_smfmac_f32_16x16x64_bf16 v[64:67],v[28:31],a[224:231],v1
buffer_load_dword v125,off,s[20:23],s92 sc1
s_waitcnt vmcnt(5)
v_max3_u32 v124,v20,v21,v22
v_smfmac_f32_16x16x64_bf16 v[68:71],v[28:31],a[232:239],v1
v_max_u32 v124,v124,v23
v_cmp_eq_u32 vcc,-1,v124
v_smfmac_f32_16x16x64_bf16 v[72:75],v[28:31],a[240:247],v1
v_smfmac_f32_16x16x64_bf16 v[76:79],v[28:31],a[248:255],v1
s_cbranch_vccnz lfb_100492
s_mov_b32 s55,0
v_smfmac_f32_16x16x64_bf16 v[64:67],v[20:23],a[96:103],v1
s_waitcnt vmcnt(6)
v_max3_u32 v124,v32,v33,v34
v_max_u32 v124,v124,v35
v_cmp_eq_u32 vcc,-1,v124
v_smfmac_f32_16x16x64_bf16 v[68:71],v[20:23],a[104:111],v1
v_smfmac_f32_16x16x64_bf16 v[72:75],v[20:23],a[112:119],v1
v_smfmac_f32_16x16x64_bf16 v[76:79],v[20:23],a[120:127],v1
s_cbranch_vccnz flb_100288
s_branch segb_100272
fl_100278:
flb_100286:
buffer_load_dwordx4 v[24:27],v0,s[20:23],s92 offen offset:2048 sc1
s_mov_b32 s55,4
buffer_load_dwordx4 v[40:43],v0,s[20:23],s93 offen offset:2048 sc1
buffer_load_dwordx4 v[44:47],v0,s[20:23],s93 offen offset:3072 sc1
s_waitcnt vmcnt(7)
v_max3_u32 v124,v28,v29,v30
v_max_u32 v124,v124,v31
v_cmp_eq_u32 vcc,-1,v124
s_cbranch_vccnz dfl_100487
v_smfmac_f32_16x16x64_bf16 v[64:67],v[28:31],a[224:231],v1
buffer_load_dword v125,off,s[20:23],s92 sc1
s_waitcnt vmcnt(3)
v_max3_u32 v124,v24,v25,v26
v_smfmac_f32_16x16x64_bf16 v[68:71],v[28:31],a[232:239],v1
v_max_u32 v124,v124,v27
v_cmp_eq_u32 vcc,-1,v124
v_smfmac_f32_16x16x64_bf16 v[72:75],v[28:31],a[240:247],v1
v_smfmac_f32_16x16x64_bf16 v[76:79],v[28:31],a[248:255],v1
s_cbranch_vccnz lfb_100492
s_mov_b32 s55,0
v_smfmac_f32_16x16x64_bf16 v[64:67],v[24:27],a[160:167],v1
s_waitcnt vmcnt(6)
v_max3_u32 v124,v32,v33,v34
v_max_u32 v124,v124,v35
v_cmp_eq_u32 vcc,-1,v124
v_smfmac_f32_16x16x64_bf16 v[68:71],v[24:27],a[168:175],v1
v_smfmac_f32_16x16x64_bf16 v[72:75],v[24:27],a[176:183],v1
v_smfmac_f32_16x16x64_bf16 v[76:79],v[24:27],a[184:191],v1
s_cbranch_vccnz flb_100288
s_branch segb_100272
fl_100279:
flb_100287:
buffer_load_dwordx4 v[28:31],v0,s[20:23],s92 offen offset:3072 sc1
s_mov_b32 s55,8
s_waitcnt vmcnt(0)
v_max3_u32 v124,v28,v29,v30
v_max_u32 v124,v124,v31
v_cmp_eq_u32 vcc,-1,v124
s_cbranch_vccnz lfb_100492
s_mov_b32 s55,0
v_smfmac_f32_16x16x64_bf16 v[64:67],v[28:31],a[224:231],v1
s_waitcnt vmcnt(6)
v_max3_u32 v124,v32,v33,v34
v_max_u32 v124,v124,v35
v_cmp_eq_u32 vcc,-1,v124
v_smfmac_f32_16x16x64_bf16 v[68:71],v[28:31],a[232:239],v1
v_smfmac_f32_16x16x64_bf16 v[72:75],v[28:31],a[240:247],v1
v_smfmac_f32_16x16x64_bf16 v[76:79],v[28:31],a[248:255],v1
s_cbranch_vccnz flb_100288
s_branch segb_100272
fl_100280:
flb_100288:
buffer_load_dwordx4 v[32:35],v0,s[20:23],s93 offen offset:0 sc1
s_mov_b32 s55,240
buffer_store_dwordx4 v[112:115],v120,s[20:23],s101 offen sc1
buffer_store_dword v126,v121,s[20:23],s69 offen sc1
s_bitcmp1_b32 s55,5
s_cbranch_scc0 rdn_100495
s_waitcnt vmcnt(7)
v_max3_u32 v124,v36,v37,v38
v_max_u32 v124,v124,v39
v_cmp_eq_u32 vcc,-1,v124
s_cbranch_vccnz rfa_100496
buffer_load_dword v125,off,s[20:23],s92 sc1
s_bitset0_b32 s55,5
v_smfmac_f32_16x16x64_bf16 v[64:67],v[36:39],a[96:103],v1
v_smfmac_f32_16x16x64_bf16 v[68:71],v[36:39],a[104:111],v1
v_smfmac_f32_16x16x64_bf16 v[72:75],v[36:39],a[112:119],v1
v_smfmac_f32_16x16x64_bf16 v[76:79],v[36:39],a[120:127],v1
s_cmp_eq_u32 s55,0
s_cbranch_scc1 segb_100274
s_branch rnx_100497
rdn_100495:
buffer_load_dword v125,off,s[20:23],s92 sc1
s_branch rnx_100497
rfa_100496:
buffer_load_dwordx4 v[36:39],v0,s[20:23],s93 offen offset:1024 sc1
rnx_100497:
s_bitcmp1_b32 s55,6
s_cbranch_scc0 rdn_100498
s_waitcnt vmcnt(6)
v_max3_u32 v124,v40,v41,v42
v_max_u32 v124,v124,v43
v_cmp_eq_u32 vcc,-1,v124
s_cbranch_vccnz rfa_100499
buffer_load_dword v125,off,s[20:23],s92 sc1
s_bitset0_b32 s55,6
s_cmp_eq_u32 s55,0
s_cbranch_scc1 segb_100274
s_branch rnx_100500
rdn_100498:
buffer_load_dword v125,off,s[20:23],s92 sc1
s_branch rnx_100500
rfa_100499:
buffer_load_dwordx4 v[40:43],v0,s[20:23],s93 offen offset:2048 sc1
rnx_100500:
s_bitcmp1_b32 s55,7
s_cbranch_scc0 rdn_100501
s_waitcnt vmcnt(6)
v_max3_u32 v124,v44,v45,v46
v_max_u32 v124,v124,v47
v_cmp_eq_u32 vcc,-1,v124
s_cbranch_vccnz rfa_100502
buffer_load_dword v125,off,s[20:23],s92 sc1
s_bitset0_b32 s55,7
s_cmp_eq_u32 s55,0
s_cbranch_scc1 segb_100274
s_branch rnx_100503
rdn_100501:
buffer_load_dword v125,off,s[20:23],s92 sc1
s_branch rnx_100503
rfa_100502:
buffer_load_dwordx4 v[44:47],v0,s[20:23],s93 offen offset:3072 sc1
rnx_100503:
rot_100494:
s_bitcmp1_b32 s55,4
s_cbranch_scc0 rdn_100504
s_waitcnt vmcnt(3)
v_max3_u32 v124,v32,v33,v34
v_max_u32 v124,v124,v35
v_cmp_eq_u32 vcc,-1,v124
s_cbranch_vccnz rfa_100505
buffer_load_dword v125,off,s[20:23],s92 sc1
s_bitset0_b32 s55,4
v_smfmac_f32_16x16x64_bf16 v[64:67],v[32:35],a[32:39],v1
v_smfmac_f32_16x16x64_bf16 v[68:71],v[32:35],a[40:47],v1
v_smfmac_f32_16x16x64_bf16 v[72:75],v[32:35],a[48:55],v1
v_smfmac_f32_16x16x64_bf16 v[76:79],v[32:35],a[56:63],v1
s_cmp_eq_u32 s55,0
s_cbranch_scc1 segb_100274
s_branch rnx_100506
rdn_100504:
buffer_load_dword v125,off,s[20:23],s92 sc1
s_branch rnx_100506
rfa_100505:
buffer_load_dwordx4 v[32:35],v0,s[20:23],s93 offen offset:0 sc1
rnx_100506:
s_bitcmp1_b32 s55,5
s_cbranch_scc0 rdn_100507
s_waitcnt vmcnt(3)
v_max3_u32 v124,v36,v37,v38
v_max_u32 v124,v124,v39
v_cmp_eq_u32 vcc,-1,v124
s_cbranch_vccnz rfa_100508
buffer_load_dword v125,off,s[20:23],s92 sc1
s_bitset0_b32 s55,5
v_smfmac_f32_16x16x64_bf16 v[64:67],v[36:39],a[96:103],v1
v_smfmac_f32_16x16x64_bf16 v[68:71],v[36:39],a[104:111],v1
v_smfmac_f32_16x16x64_bf16 v[72:75],v[36:39],a[112:119],v1
v_smfmac_f32_16x16x64_bf16 v[76:79],v[36:39],a[120:127],v1
s_cmp_eq_u32 s55,0
s_cbranch_scc1 segb_100274
s_branch rnx_100509
rdn_100507:
buffer_load_dword v125,off,s[20:23],s92 sc1
s_branch rnx_100509
rfa_100508:
buffer_load_dwordx4 v[36:39],v0,s[20:23],s93 offen offset:1024 sc1
rnx_100509:
s_bitcmp1_b32 s55,6
s_cbranch_scc0 rdn_100510
s_waitcnt vmcnt(3)
v_max3_u32 v124,v40,v41,v42
v_max_u32 v124,v124,v43
v_cmp_eq_u32 vcc,-1,v124
s_cbranch_vccnz rfa_100511
buffer_load_dword v125,off,s[20:23],s92 sc1
s_bitset0_b32 s55,6
s_cmp_eq_u32 s55,0
s_cbranch_scc1 segb_100274
s_branch rnx_100512
rdn_100510:
buffer_load_dword v125,off,s[20:23],s92 sc1
s_branch rnx_100512
rfa_100511:
buffer_load_dwordx4 v[40:43],v0,s[20:23],s93 offen offset:2048 sc1
rnx_100512:
s_bitcmp1_b32 s55,7
s_cbranch_scc0 rdn_100513
s_waitcnt vmcnt(3)
v_max3_u32 v124,v44,v45,v46
v_max_u32 v124,v124,v47
v_cmp_eq_u32 vcc,-1,v124
s_cbranch_vccnz rfa_100514
buffer_load_dword v125,off,s[20:23],s92 sc1
s_bitset0_b32 s55,7
s_cmp_eq_u32 s55,0
s_cbranch_scc1 segb_100274
s_branch rnx_100515
rdn_100513:
buffer_load_dword v125,off,s[20:23],s92 sc1
s_branch rnx_100515
rfa_100514:
buffer_load_dwordx4 v[44:47],v0,s[20:23],s93 offen offset:3072 sc1
rnx_100515:
s_sub_u32 s90,s90,1
s_cmp_gt_i32 s90,0
s_cbranch_scc1 rot_100494
s_mov_b32 s55,0
s_branch segb_100274
fl_100281:
flb_100289:
buffer_load_dwordx4 v[36:39],v0,s[20:23],s93 offen offset:1024 sc1
s_mov_b32 s55,224
s_bitcmp1_b32 s55,6
s_cbranch_scc0 rdn_100517
s_waitcnt vmcnt(6)
v_max3_u32 v124,v40,v41,v42
v_max_u32 v124,v124,v43
v_cmp_eq_u32 vcc,-1,v124
s_cbranch_vccnz rfa_100518
buffer_load_dword v125,off,s[20:23],s92 sc1
s_bitset0_b32 s55,6
s_cmp_eq_u32 s55,0
s_cbranch_scc1 segb_100274
s_branch rnx_100519
rdn_100517:
buffer_load_dword v125,off,s[20:23],s92 sc1
s_branch rnx_100519
rfa_100518:
buffer_load_dwordx4 v[40:43],v0,s[20:23],s93 offen offset:2048 sc1
rnx_100519:
s_bitcmp1_b32 s55,7
s_cbranch_scc0 rdn_100520
s_waitcnt vmcnt(6)
v_max3_u32 v124,v44,v45,v46
v_max_u32 v124,v124,v47
v_cmp_eq_u32 vcc,-1,v124
s_cbranch_vccnz rfa_100521
buffer_load_dword v125,off,s[20:23],s92 sc1
s_bitset0_b32 s55,7
s_cmp_eq_u32 s55,0
s_cbranch_scc1 segb_100274
s_branch rnx_100522
rdn_100520:
buffer_load_dword v125,off,s[20:23],s92 sc1
s_branch rnx_100522
rfa_100521:
buffer_load_dwordx4 v[44:47],v0,s[20:23],s93 offen offset:3072 sc1
rnx_100522:
rot_100516:
s_bitcmp1_b32 s55,5
s_cbranch_scc0 rdn_100523
s_waitcnt vmcnt(2)
v_max3_u32 v124,v36,v37,v38
v_max_u32 v124,v124,v39
v_cmp_eq_u32 vcc,-1,v124
s_cbranch_vccnz rfa_100524
buffer_load_dword v125,off,s[20:23],s92 sc1
s_bitset0_b32 s55,5
v_smfmac_f32_16x16x64_bf16 v[64:67],v[36:39],a[96:103],v1
v_smfmac_f32_16x16x64_bf16 v[68:71],v[36:39],a[104:111],v1
v_smfmac_f32_16x16x64_bf16 v[72:75],v[36:39],a[112:119],v1
v_smfmac_f32_16x16x64_bf16 v[76:79],v[36:39],a[120:127],v1
s_cmp_eq_u32 s55,0
s_cbranch_scc1 segb_100274
s_branch rnx_100525
rdn_100523:
buffer_load_dword v125,off,s[20:23],s92 sc1
s_branch rnx_100525
rfa_100524:
buffer_load_dwordx4 v[36:39],v0,s[20:23],s93 offen offset:1024 sc1
rnx_100525:
s_bitcmp1_b32 s55,6
s_cbranch_scc0 rdn_100526
s_waitcnt vmcnt(2)
v_max3_u32 v124,v40,v41,v42
v_max_u32 v124,v124,v43
v_cmp_eq_u32 vcc,-1,v124
s_cbranch_vccnz rfa_100527
buffer_load_dword v125,off,s[20:23],s92 sc1
s_bitset0_b32 s55,6
s_cmp_eq_u32 s55,0
s_cbranch_scc1 segb_100274
s_branch rnx_100528
rdn_100526:
buffer_load_dword v125,off,s[20:23],s92 sc1
s_branch rnx_100528
rfa_100527:
buffer_load_dwordx4 v[40:43],v0,s[20:23],s93 offen offset:2048 sc1
rnx_100528:
s_bitcmp1_b32 s55,7
s_cbranch_scc0 rdn_100529
s_waitcnt vmcnt(2)
v_max3_u32 v124,v44,v45,v46
v_max_u32 v124,v124,v47
v_cmp_eq_u32 vcc,-1,v124
s_cbranch_vccnz rfa_100530
buffer_load_dword v125,off,s[20:23],s92 sc1
s_bitset0_b32 s55,7
s_cmp_eq_u32 s55,0
s_cbranch_scc1 segb_100274
s_branch rnx_100531
rdn_100529:
buffer_load_dword v125,off,s[20:23],s92 sc1
s_branch rnx_100531
rfa_100530:
buffer_load_dwordx4 v[44:47],v0,s[20:23],s93 offen offset:3072 sc1
rnx_100531:
s_sub_u32 s90,s90,1
s_cmp_gt_i32 s90,0
s_cbranch_scc1 rot_100516
s_mov_b32 s55,0
s_branch segb_100274
fl_100282:
flb_100290:
s_mov_b32 s55,192
s_bitcmp1_b32 s55,6
s_cbranch_scc0 rdn_100533
s_waitcnt vmcnt(6)
v_max3_u32 v124,v40,v41,v42
v_max_u32 v124,v124,v43
v_cmp_eq_u32 vcc,-1,v124
s_cbranch_vccnz rfa_100534
buffer_load_dword v125,off,s[20:23],s92 sc1
s_bitset0_b32 s55,6
s_cmp_eq_u32 s55,0
s_cbranch_scc1 segb_100274
s_branch rnx_100535
rdn_100533:
buffer_load_dword v125,off,s[20:23],s92 sc1
s_branch rnx_100535
rfa_100534:
buffer_load_dwordx4 v[40:43],v0,s[20:23],s93 offen offset:2048 sc1
rnx_100535:
s_bitcmp1_b32 s55,7
s_cbranch_scc0 rdn_100536
s_waitcnt vmcnt(6)
v_max3_u32 v124,v44,v45,v46
v_max_u32 v124,v124,v47
v_cmp_eq_u32 vcc,-1,v124
s_cbranch_vccnz rfa_100537
buffer_load_dword v125,off,s[20:23],s92 sc1
s_bitset0_b32 s55,7
s_cmp_eq_u32 s55,0
s_cbranch_scc1 segb_100274
s_branch rnx_100538
rdn_100536:
buffer_load_dword v125,off,s[20:23],s92 sc1
s_branch rnx_100538
rfa_100537:
buffer_load_dwordx4 v[44:47],v0,s[20:23],s93 offen offset:3072 sc1
rnx_100538:
rot_100532:
s_bitcmp1_b32 s55,6
s_cbranch_scc0 rdn_100539
s_waitcnt vmcnt(1)
v_max3_u32 v124,v40,v41,v42
v_max_u32 v124,v124,v43
v_cmp_eq_u32 vcc,-1,v124
s_cbranch_vccnz rfa_100540
buffer_load_dword v125,off,s[20:23],s92 sc1
s_bitset0_b32 s55,6
s_cmp_eq_u32 s55,0
s_cbranch_scc1 segb_100274
s_branch rnx_100541
rdn_100539:
buffer_load_dword v125,off,s[20:23],s92 sc1
s_branch rnx_100541
rfa_100540:
buffer_load_dwordx4 v[40:43],v0,s[20:23],s93 offen offset:2048 sc1
rnx_100541:
s_bitcmp1_b32 s55,7
s_cbranch_scc0 rdn_100542
s_waitcnt vmcnt(1)
v_max3_u32 v124,v44,v45,v46
v_max_u32 v124,v124,v47
v_cmp_eq_u32 vcc,-1,v124
s_cbranch_vccnz rfa_100543
buffer_load_dword v125,off,s[20:23],s92 sc1
s_bitset0_b32 s55,7
s_cmp_eq_u32 s55,0
s_cbranch_scc1 segb_100274
s_branch rnx_100544
rdn_100542:
buffer_load_dword v125,off,s[20:23],s92 sc1
s_branch rnx_100544
rfa_100543:
buffer_load_dwordx4 v[44:47],v0,s[20:23],s93 offen offset:3072 sc1
rnx_100544:
s_sub_u32 s90,s90,1
s_cmp_gt_i32 s90,0
s_cbranch_scc1 rot_100532
s_mov_b32 s55,0
s_branch segb_100274
dfl_100485:
buffer_load_dwordx4 v[20:23],v0,s[20:23],s92 offen offset:1024 sc1
s_bitset1_b32 s55,1
buffer_load_dwordx4 v[36:39],v0,s[20:23],s93 offen offset:1024 sc1
s_waitcnt vmcnt(5)
v_max3_u32 v124,v24,v25,v26
v_max_u32 v124,v124,v27
v_cmp_eq_u32 vcc,-1,v124
s_cbranch_vccnz dfl_100486
s_branch dseg_100489
dfl_100486:
buffer_load_dwordx4 v[24:27],v0,s[20:23],s92 offen offset:2048 sc1
s_bitset1_b32 s55,2
buffer_load_dwordx4 v[40:43],v0,s[20:23],s93 offen offset:2048 sc1
buffer_load_dwordx4 v[44:47],v0,s[20:23],s93 offen offset:3072 sc1
s_waitcnt vmcnt(7)
v_max3_u32 v124,v28,v29,v30
v_max_u32 v124,v124,v31
v_cmp_eq_u32 vcc,-1,v124
s_cbranch_vccnz dfl_100487
s_branch dseg_100490
dfl_100487:
buffer_load_dwordx4 v[28:31],v0,s[20:23],s92 offen offset:3072 sc1
s_bitset1_b32 s55,3
s_branch lap2_100491
dseg_100489:
v_smfmac_f32_16x16x64_bf16 v[64:67],v[24:27],a[160:167],v1
buffer_load_dword v125,off,s[20:23],s92 sc1
buffer_load_dwordx4 v[40:43],v0,s[20:23],s93 offen offset:2048 sc1
buffer_load_dwordx4 v[44:47],v0,s[20:23],s93 offen offset:3072 sc1
s_waitcnt vmcnt(7)
v_max3_u32 v124,v28,v29,v30
v_smfmac_f32_16x16x64_bf16 v[68:71],v[24:27],a[168:175],v1
v_max_u32 v124,v124,v31
v_cmp_eq_u32 vcc,-1,v124
v_smfmac_f32_16x16x64_bf16 v[72:75],v[24:27],a[176:183],v1
v_smfmac_f32_16x16x64_bf16 v[76:79],v[24:27],a[184:191],v1
s_cbranch_vccnz dfl_100487
dseg_100490:
v_smfmac_f32_16x16x64_bf16 v[64:67],v[28:31],a[224:231],v1
buffer_load_dword v125,off,s[20:23],s92 sc1
v_smfmac_f32_16x16x64_bf16 v[68:71],v[28:31],a[232:239],v1
v_smfmac_f32_16x16x64_bf16 v[72:75],v[28:31],a[240:247],v1
v_smfmac_f32_16x16x64_bf16 v[76:79],v[28:31],a[248:255],v1
lap2_100491:
s_bitcmp1_b32 s55,0
s_cbranch_scc0 l2s_100545
s_waitcnt vmcnt(7)
v_max3_u32 v124,v16,v17,v18
v_max_u32 v124,v124,v19
v_cmp_eq_u32 vcc,-1,v124
s_cbranch_vccnz l2s_100545
s_bitset0_b32 s55,0
v_smfmac_f32_16x16x64_bf16 v[64:67],v[16:19],a[32:39],v1
v_smfmac_f32_16x16x64_bf16 v[68:71],v[16:19],a[40:47],v1
v_smfmac_f32_16x16x64_bf16 v[72:75],v[16:19],a[48:55],v1
v_smfmac_f32_16x16x64_bf16 v[76:79],v[16:19],a[56:63],v1
l2s_100545:
s_bitcmp1_b32 s55,1
s_cbranch_scc0 l2s_100547
s_waitcnt vmcnt(5)
v_max3_u32 v124,v20,v21,v22
v_max_u32 v124,v124,v23
v_cmp_eq_u32 vcc,-1,v124
s_cbranch_vccnz l2s_100547
s_bitset0_b32 s55,1
v_smfmac_f32_16x16x64_bf16 v[64:67],v[20:23],a[96:103],v1
v_smfmac_f32_16x16x64_bf16 v[68:71],v[20:23],a[104:111],v1
v_smfmac_f32_16x16x64_bf16 v[72:75],v[20:23],a[112:119],v1
v_smfmac_f32_16x16x64_bf16 v[76:79],v[20:23],a[120:127],v1
l2s_100547:
s_bitcmp1_b32 s55,2
s_cbranch_scc0 l2s_100549
s_waitcnt vmcnt(3)
v_max3_u32 v124,v24,v25,v26
v_max_u32 v124,v124,v27
v_cmp_eq_u32 vcc,-1,v124
s_cbranch_vccnz l2s_100549
s_bitset0_b32 s55,2
v_smfmac_f32_16x16x64_bf16 v[64:67],v[24:27],a[160:167],v1
v_smfmac_f32_16x16x64_bf16 v[68:71],v[24:27],a[168:175],v1
v_smfmac_f32_16x16x64_bf16 v[72:75],v[24:27],a[176:183],v1
v_smfmac_f32_16x16x64_bf16 v[76:79],v[24:27],a[184:191],v1
l2s_100549:
s_bitcmp1_b32 s55,3
s_cbranch_scc0 l2s_100551
s_waitcnt vmcnt(0)
v_max3_u32 v124,v28,v29,v30
v_max_u32 v124,v124,v31
v_cmp_eq_u32 vcc,-1,v124
s_cbranch_vccnz l2s_100551
s_bitset0_b32 s55,3
v_smfmac_f32_16x16x64_bf16 v[64:67],v[28:31],a[224:231],v1
v_smfmac_f32_16x16x64_bf16 v[68:71],v[28:31],a[232:239],v1
v_smfmac_f32_16x16x64_bf16 v[72:75],v[28:31],a[240:247],v1
v_smfmac_f32_16x16x64_bf16 v[76:79],v[28:31],a[248:255],v1
l2s_100551:
s_cmp_eq_u32 s55,0
s_cbranch_scc0 lfb_100492
Ldone_100493:
s_waitcnt vmcnt(6)
v_max3_u32 v124,v32,v33,v34
v_max_u32 v124,v124,v35
v_cmp_eq_u32 vcc,-1,v124
s_cbranch_vccnz flb_100288
s_branch segb_100272
lfb_100492:
s_bitcmp1_b32 s55,0
s_cbranch_scc0 dsk_100553
buffer_load_dwordx4 v[16:19],v0,s[20:23],s92 offen offset:0 sc1
dsk_100553:
s_bitcmp1_b32 s55,1
s_cbranch_scc0 dsk_100554
buffer_load_dwordx4 v[20:23],v0,s[20:23],s92 offen offset:1024 sc1
dsk_100554:
s_bitcmp1_b32 s55,2
s_cbranch_scc0 dsk_100555
buffer_load_dwordx4 v[24:27],v0,s[20:23],s92 offen offset:2048 sc1
dsk_100555:
s_bitcmp1_b32 s55,3
s_cbranch_scc0 dsk_100556
buffer_load_dwordx4 v[28:31],v0,s[20:23],s92 offen offset:3072 sc1
dsk_100556:
s_bitcmp1_b32 s55,0
s_cbranch_scc0 dsk_100557
s_waitcnt vmcnt(2)
v_max3_u32 v124,v16,v17,v18
v_max_u32 v124,v124,v19
v_cmp_eq_u32 vcc,-1,v124
s_cbranch_vccz dgo_100558
s_nop 15
buffer_load_dwordx4 v[104:107],v0,s[20:23],s92 offen offset:0 sc1
s_nop 15
buffer_load_dwordx4 v[108:111],v0,s[20:23],s92 offen offset:0 sc1
dlp_100559:
s_waitcnt vmcnt(2)
v_max3_u32 v124,v16,v17,v18
v_max_u32 v124,v124,v19
v_cmp_eq_u32 vcc,-1,v124
s_cbranch_vccz dgo_100558
buffer_load_dwordx4 v[16:19],v0,s[20:23],s92 offen offset:0 sc1
s_waitcnt vmcnt(2)
v_max3_u32 v124,v104,v105,v106
v_max_u32 v124,v124,v107
v_cmp_eq_u32 vcc,-1,v124
s_cbranch_vccz dcp_100561
buffer_load_dwordx4 v[104:107],v0,s[20:23],s92 offen offset:0 sc1
s_waitcnt vmcnt(2)
v_max3_u32 v124,v108,v109,v110
v_max_u32 v124,v124,v111
v_cmp_eq_u32 vcc,-1,v124
s_cbranch_vccz dcp_100562
buffer_load_dwordx4 v[108:111],v0,s[20:23],s92 offen offset:0 sc1
s_sub_u32 s90,s90,1
s_cmp_gt_i32 s90,0
s_cbranch_scc1 dlp_100559
s_branch dgo_100558
dcp_100561:
v_mov_b32 v16,v104
v_mov_b32 v17,v105
v_mov_b32 v18,v106
v_mov_b32 v19,v107
s_nop 1
s_branch dgo_100558
dcp_100562:
v_mov_b32 v16,v108
v_mov_b32 v17,v109
v_mov_b32 v18,v110
v_mov_b32 v19,v111
s_nop 1
dgo_100558:
v_smfmac_f32_16x16x64_bf16 v[64:67],v[16:19],a[32:39],v1
v_smfmac_f32_16x16x64_bf16 v[68:71],v[16:19],a[40:47],v1
v_smfmac_f32_16x16x64_bf16 v[72:75],v[16:19],a[48:55],v1
v_smfmac_f32_16x16x64_bf16 v[76:79],v[16:19],a[56:63],v1
dsk_100557:
s_bitcmp1_b32 s55,1
s_cbranch_scc0 dsk_100563
s_waitcnt vmcnt(2)
v_max3_u32 v124,v20,v21,v22
v_max_u32 v124,v124,v23
v_cmp_eq_u32 vcc,-1,v124
s_cbranch_vccz dgo_100564
s_nop 15
buffer_load_dwordx4 v[104:107],v0,s[20:23],s92 offen offset:1024 sc1
s_nop 15
buffer_load_dwordx4 v[108:111],v0,s[20:23],s92 offen offset:1024 sc1
dlp_100565:
s_waitcnt vmcnt(2)
v_max3_u32 v124,v20,v21,v22
v_max_u32 v124,v124,v23
v_cmp_eq_u32 vcc,-1,v124
s_cbranch_vccz dgo_100564
buffer_load_dwordx4 v[20:23],v0,s[20:23],s92 offen offset:1024 sc1
s_waitcnt vmcnt(2)
v_max3_u32 v124,v104,v105,v106
v_max_u32 v124,v124,v107
v_cmp_eq_u32 vcc,-1,v124
s_cbranch_vccz dcp_100567
buffer_load_dwordx4 v[104:107],v0,s[20:23],s92 offen offset:1024 sc1
s_waitcnt vmcnt(2)
v_max3_u32 v124,v108,v109,v110
v_max_u32 v124,v124,v111
v_cmp_eq_u32 vcc,-1,v124
s_cbranch_vccz dcp_100568
buffer_load_dwordx4 v[108:111],v0,s[20:23],s92 offen offset:1024 sc1
s_sub_u32 s90,s90,1
s_cmp_gt_i32 s90,0
s_cbranch_scc1 dlp_100565
s_branch dgo_100564
dcp_100567:
v_mov_b32 v20,v104
v_mov_b32 v21,v105
v_mov_b32 v22,v106
v_mov_b32 v23,v107
s_nop 1
s_branch dgo_100564
dcp_100568:
v_mov_b32 v20,v108
v_mov_b32 v21,v109
v_mov_b32 v22,v110
v_mov_b32 v23,v111
s_nop 1
dgo_100564:
v_smfmac_f32_16x16x64_bf16 v[64:67],v[20:23],a[96:103],v1
v_smfmac_f32_16x16x64_bf16 v[68:71],v[20:23],a[104:111],v1
v_smfmac_f32_16x16x64_bf16 v[72:75],v[20:23],a[112:119],v1
v_smfmac_f32_16x16x64_bf16 v[76:79],v[20:23],a[120:127],v1
dsk_100563:
s_bitcmp1_b32 s55,2
s_cbranch_scc0 dsk_100569
s_waitcnt vmcnt(2)
v_max3_u32 v124,v24,v25,v26
v_max_u32 v124,v124,v27
v_cmp_eq_u32 vcc,-1,v124
s_cbranch_vccz dgo_100570
s_nop 15
buffer_load_dwordx4 v[104:107],v0,s[20:23],s92 offen offset:2048 sc1
s_nop 15
buffer_load_dwordx4 v[108:111],v0,s[20:23],s92 offen offset:2048 sc1
dlp_100571:
s_waitcnt vmcnt(2)
v_max3_u32 v124,v24,v25,v26
v_max_u32 v124,v124,v27
v_cmp_eq_u32 vcc,-1,v124
s_cbranch_vccz dgo_100570
buffer_load_dwordx4 v[24:27],v0,s[20:23],s92 offen offset:2048 sc1
s_waitcnt vmcnt(2)
v_max3_u32 v124,v104,v105,v106
v_max_u32 v124,v124,v107
v_cmp_eq_u32 vcc,-1,v124
s_cbranch_vccz dcp_100573
buffer_load_dwordx4 v[104:107],v0,s[20:23],s92 offen offset:2048 sc1
s_waitcnt vmcnt(2)
v_max3_u32 v124,v108,v109,v110
v_max_u32 v124,v124,v111
v_cmp_eq_u32 vcc,-1,v124
s_cbranch_vccz dcp_100574
buffer_load_dwordx4 v[108:111],v0,s[20:23],s92 offen offset:2048 sc1
s_sub_u32 s90,s90,1
s_cmp_gt_i32 s90,0
s_cbranch_scc1 dlp_100571
s_branch dgo_100570
dcp_100573:
v_mov_b32 v24,v104
v_mov_b32 v25,v105
v_mov_b32 v26,v106
v_mov_b32 v27,v107
s_nop 1
s_branch dgo_100570
dcp_100574:
v_mov_b32 v24,v108
v_mov_b32 v25,v109
v_mov_b32 v26,v110
v_mov_b32 v27,v111
s_nop 1
dgo_100570:
v_smfmac_f32_16x16x64_bf16 v[64:67],v[24:27],a[160:167],v1
v_smfmac_f32_16x16x64_bf16 v[68:71],v[24:27],a[168:175],v1
v_smfmac_f32_16x16x64_bf16 v[72:75],v[24:27],a[176:183],v1
v_smfmac_f32_16x16x64_bf16 v[76:79],v[24:27],a[184:191],v1
dsk_100569:
s_bitcmp1_b32 s55,3
s_cbranch_scc0 dsk_100575
s_waitcnt vmcnt(2)
v_max3_u32 v124,v28,v29,v30
v_max_u32 v124,v124,v31
v_cmp_eq_u32 vcc,-1,v124
s_cbranch_vccz dgo_100576
s_nop 15
buffer_load_dwordx4 v[104:107],v0,s[20:23],s92 offen offset:3072 sc1
s_nop 15
buffer_load_dwordx4 v[108:111],v0,s[20:23],s92 offen offset:3072 sc1
dlp_100577:
s_waitcnt vmcnt(2)
v_max3_u32 v124,v28,v29,v30
v_max_u32 v124,v124,v31
v_cmp_eq_u32 vcc,-1,v124
s_cbranch_vccz dgo_100576
buffer_load_dwordx4 v[28:31],v0,s[20:23],s92 offen offset:3072 sc1
s_waitcnt vmcnt(2)
v_max3_u32 v124,v104,v105,v106
v_max_u32 v124,v124,v107
v_cmp_eq_u32 vcc,-1,v124
s_cbranch_vccz dcp_100579
buffer_load_dwordx4 v[104:107],v0,s[20:23],s92 offen offset:3072 sc1
s_waitcnt vmcnt(2)
v_max3_u32 v124,v108,v109,v110
v_max_u32 v124,v124,v111
v_cmp_eq_u32 vcc,-1,v124
s_cbranch_vccz dcp_100580
buffer_load_dwordx4 v[108:111],v0,s[20:23],s92 offen offset:3072 sc1
s_sub_u32 s90,s90,1
s_cmp_gt_i32 s90,0
s_cbranch_scc1 dlp_100577
s_branch dgo_100576
dcp_100579:
v_mov_b32 v28,v104
v_mov_b32 v29,v105
v_mov_b32 v30,v106
v_mov_b32 v31,v107
s_nop 1
s_branch dgo_100576
dcp_100580:
v_mov_b32 v28,v108
v_mov_b32 v29,v109
v_mov_b32 v30,v110
v_mov_b32 v31,v111
s_nop 1
dgo_100576:
v_smfmac_f32_16x16x64_bf16 v[64:67],v[28:31],a[224:231],v1
v_smfmac_f32_16x16x64_bf16 v[68:71],v[28:31],a[232:239],v1
v_smfmac_f32_16x16x64_bf16 v[72:75],v[28:31],a[240:247],v1
v_smfmac_f32_16x16x64_bf16 v[76:79],v[28:31],a[248:255],v1
dsk_100575:
s_mov_b32 s55,0
s_branch Ldone_100493
slowA_100292:
buffer_load_dwordx4 v[44:47],v0,s[20:23],s93 offen offset:3072 sc1
dsk_100581:
s_bitcmp1_b32 s55,7
s_cbranch_scc0 dsk_100582
s_waitcnt vmcnt(2)
v_max3_u32 v124,v44,v45,v46
v_max_u32 v124,v124,v47
v_cmp_eq_u32 vcc,-1,v124
s_cbranch_vccz dgo_100583
s_nop 15
s_nop 3
buffer_load_dwordx4 v[104:107],v0,s[20:23],s93 offen offset:3072 sc1
s_nop 15
s_nop 3
buffer_load_dwordx4 v[108:111],v0,s[20:23],s93 offen offset:3072 sc1
dlp_100584:
s_waitcnt vmcnt(2)
v_max3_u32 v124,v44,v45,v46
v_max_u32 v124,v124,v47
v_cmp_eq_u32 vcc,-1,v124
s_cbranch_vccz dgo_100583
buffer_load_dwordx4 v[44:47],v0,s[20:23],s93 offen offset:3072 sc1
s_waitcnt vmcnt(2)
v_max3_u32 v124,v104,v105,v106
v_max_u32 v124,v124,v107
v_cmp_eq_u32 vcc,-1,v124
s_cbranch_vccz dcp_100586
buffer_load_dwordx4 v[104:107],v0,s[20:23],s93 offen offset:3072 sc1
s_waitcnt vmcnt(2)
v_max3_u32 v124,v108,v109,v110
v_max_u32 v124,v124,v111
v_cmp_eq_u32 vcc,-1,v124
s_cbranch_vccz dcp_100587
buffer_load_dwordx4 v[108:111],v0,s[20:23],s93 offen offset:3072 sc1
s_sub_u32 s90,s90,1
s_cmp_gt_i32 s90,0
s_cbranch_scc1 dlp_100584
s_branch dgo_100583
dcp_100586:
v_mov_b32 v44,v104
v_mov_b32 v45,v105
v_mov_b32 v46,v106
v_mov_b32 v47,v107
s_nop 1
s_branch dgo_100583
dcp_100587:
v_mov_b32 v44,v108
v_mov_b32 v45,v109
v_mov_b32 v46,v110
v_mov_b32 v47,v111
s_nop 1
dgo_100583:
dsk_100582:
s_mov_b32 s55,0
s_branch segb_100274
recslow_100191:
s_mov_b32 s55,0
s_cmp_lg_u32 s50,0
s_cbranch_scc1 np0_100590
v_mov_b32 v120,0
v_mov_b32 v121,0
s_cmp_lg_u32 s58,0
s_cbranch_scc1 z1_100591
v_lshrrev_b32 v124,6,v127
v_lshlrev_b32 v124,12,v124
v_bfe_u32 v125,v127,1,5
v_add_u32 v124,v124,v125
s_lshl_b32 s64,s59,6
buffer_load_ushort v120,v124,s[44:47],s64 offen
buffer_load_ushort v122,v124,s[44:47],s64 offen offset:32
buffer_load_ushort v121,v124,s[44:47],s64 offen offset:2048
buffer_load_ushort v123,v124,s[44:47],s64 offen offset:2080
s_waitcnt vmcnt(0)
v_lshl_or_b32 v120,v122,16,v120
v_lshl_or_b32 v121,v123,16,v121
v_min_u32 v120,s81,v120
v_min_u32 v121,s81,v121
z1_100591:
buffer_store_dword v120,v4,s[20:23],s71 offen sc1
buffer_store_dword v121,v4,s[20:23],s71 offen offset:32 sc1
buffer_store_dword v120,v4,s[20:23],s73 offen sc1
buffer_store_dword v121,v4,s[20:23],s73 offen offset:32 sc1
np0_100590:
v_lshrrev_b32 v124,2,v0
v_bfe_u32 v125,v124,5,1
v_mul_u32_u24 v125,2048,v125
s_and_b32 s64,s50,1
s_lshl_b32 s64,s64,5
v_add3_u32 v4,v124,v125,s64
s_add_u32 s64,s79,0
s_cmp_gt_u32 s91,s64
s_cbranch_scc0 flp_100594
fok_100593:
s_add_u32 s64,s79,0
s_lshl_b32 s65,s64,12
s_and_b32 s65,s65,0x2000
s_xor_b32 s65,s65,s67
s_lshl_b32 s64,s64,20
s_add_u32 s65,s65,s64
s_add_u32 s99,s65,s77
buffer_load_dwordx4 v[104:107],v0,s[20:23],s99 offen
buffer_load_dwordx4 v[108:111],v0,s[20:23],s99 offen offset:1024
s_waitcnt vmcnt(0)
s_mov_b32 s92,s70
s_mov_b32 s93,s72
s_mov_b32 s94,s76
s_add_u32 s95,s94,4096
s_mov_b32 s96,s74
s_add_u32 s97,s96,4096
s_mov_b32 s98,s75
s_barrier
v_mov_b32 v96,v104
v_mov_b32 v97,v105
v_mov_b32 v98,v106
v_mov_b32 v99,v107
v_mov_b32 v100,v108
v_mov_b32 v101,v109
v_mov_b32 v102,v110
v_mov_b32 v103,v111
v_mov_b32 v48,0
v_mov_b32 v49,0
v_mov_b32 v50,0
v_mov_b32 v51,0
v_mov_b32 v52,0
v_mov_b32 v53,0
v_mov_b32 v54,0
v_mov_b32 v55,0
v_mov_b32 v56,0
v_mov_b32 v57,0
v_mov_b32 v58,0
v_mov_b32 v59,0
v_mov_b32 v60,0
v_mov_b32 v61,0
v_mov_b32 v62,0
v_mov_b32 v63,0
v_mov_b32 v64,0
v_mov_b32 v65,0
v_mov_b32 v66,0
v_mov_b32 v67,0
v_mov_b32 v68,0
v_mov_b32 v69,0
v_mov_b32 v70,0
v_mov_b32 v71,0
v_mov_b32 v72,0
v_mov_b32 v73,0
v_mov_b32 v74,0
v_mov_b32 v75,0
v_mov_b32 v76,0
v_mov_b32 v77,0
v_mov_b32 v78,0
v_mov_b32 v79,0
v_mov_b32 v80,0
v_mov_b32 v81,0
v_mov_b32 v82,0
v_mov_b32 v83,0
v_mov_b32 v84,0
v_mov_b32 v85,0
v_mov_b32 v86,0
v_mov_b32 v87,0
v_mov_b32 v88,0
v_mov_b32 v89,0
v_mov_b32 v90,0
v_mov_b32 v91,0
v_mov_b32 v92,0
v_mov_b32 v93,0
v_mov_b32 v94,0
v_mov_b32 v95,0
s_cmp_gt_u32 s50,1
s_cbranch_scc0 loop0_100592x
loop_100588:
v_mov_b32 v125,0
s_nop 1
v_mfma_f32_16x16x1_4b_f32 v[48:63],v125,v125,0
v_mfma_f32_16x16x1_4b_f32 v[64:79],v125,v125,0
v_mfma_f32_16x16x1_4b_f32 v[80:95],v125,v125,0
s_nop 15
s_nop 15
s_nop 15
s_nop 15
buffer_load_dwordx4 v[16:19],v0,s[20:23],s92 offen offset:0 sc1
s_nop 7
buffer_load_dwordx4 v[20:23],v0,s[20:23],s92 offen offset:1024 sc1
s_nop 7
buffer_load_dwordx4 v[24:27],v0,s[20:23],s92 offen offset:2048 sc1
s_nop 7
buffer_load_dwordx4 v[28:31],v0,s[20:23],s92 offen offset:3072 sc1
v_mov_b32 v96,v104
v_mov_b32 v97,v105
v_mov_b32 v98,v106
v_mov_b32 v99,v107
v_mov_b32 v100,v108
v_mov_b32 v101,v109
v_mov_b32 v102,v110
v_mov_b32 v103,v111
s_branch ja_100595
loop0_100592x:
v_mov_b32 v125,0
s_nop 1
v_mfma_f32_16x16x1_4b_f32 v[48:63],v125,v125,0
v_mfma_f32_16x16x1_4b_f32 v[64:79],v125,v125,0
v_mfma_f32_16x16x1_4b_f32 v[80:95],v125,v125,0
s_nop 15
s_nop 11
buffer_load_dwordx4 v[16:19],v0,s[20:23],s92 offen offset:0 sc1
s_nop 7
buffer_load_dwordx4 v[20:23],v0,s[20:23],s92 offen offset:1024 sc1
s_nop 7
buffer_load_dwordx4 v[24:27],v0,s[20:23],s92 offen offset:2048 sc1
s_nop 7
buffer_load_dwordx4 v[28:31],v0,s[20:23],s92 offen offset:3072 sc1
ja_100595:
s_max_u32 s66,s79,1
s_sub_u32 s66,s66,1
v_mov_b32 v126,s66
v_cndmask_b32 v120,2.0,v0,s[82:83]
v_cndmask_b32 v121,2.0,v127,s[86:87]
s_add_u32 s64,s66,0
s_lshl_b32 s65,s64,12
s_and_b32 s65,s65,0x2000
s_xor_b32 s65,s65,s67
s_lshl_b32 s64,s64,20
s_add_u32 s65,s65,s64
s_add_u32 s101,s65,s78
s_cmp_eq_u32 s79,63
s_cbranch_scc1 last_100589
s_add_u32 s64,s79,1
s_cmp_gt_u32 s91,s64
s_cbranch_scc0 flp_100597
fok_100596:
s_add_u32 s64,s79,1
s_lshl_b32 s65,s64,12
s_and_b32 s65,s65,0x2000
s_xor_b32 s65,s65,s67
s_lshl_b32 s64,s64,20
s_add_u32 s65,s65,s64
s_add_u32 s99,s65,s77
s_waitcnt vmcnt(3)
v_max3_u32 v124,v16,v17,v18
v_max_u32 v124,v124,v19
v_cmp_eq_u32 vcc,-1,v124
s_cbranch_vccnz flb_100622
seg_100598:
segb_100606:
v_smfmac_f32_16x16x64_bf16 v[48:51],v[16:19],a[0:7],v1
buffer_load_dword v125,off,s[20:23],s92 sc1
v_smfmac_f32_16x16x64_bf16 v[52:55],v[16:19],a[8:15],v1
buffer_load_dwordx4 v[32:35],v0,s[20:23],s93 offen offset:0 sc1
v_smfmac_f32_16x16x64_bf16 v[56:59],v[16:19],a[16:23],v1
s_waitcnt vmcnt(4)
v_max3_u32 v124,v20,v21,v22
v_smfmac_f32_16x16x64_bf16 v[60:63],v[16:19],a[24:31],v1
v_max_u32 v124,v124,v23
v_smfmac_f32_16x16x64_bf16 v[64:67],v[16:19],a[32:39],v1
v_cmp_eq_u32 vcc,-1,v124
v_smfmac_f32_16x16x64_bf16 v[68:71],v[16:19],a[40:47],v1
v_smfmac_f32_16x16x64_bf16 v[72:75],v[16:19],a[48:55],v1
s_cbranch_vccnz fl_100615
seg_100599:
v_smfmac_f32_16x16x64_bf16 v[76:79],v[16:19],a[56:63],v1
segb_100607:
v_smfmac_f32_16x16x64_bf16 v[48:51],v[20:23],a[64:71],v1
buffer_load_dword v125,off,s[20:23],s92 sc1
v_smfmac_f32_16x16x64_bf16 v[52:55],v[20:23],a[72:79],v1
buffer_load_dwordx4 v[36:39],v0,s[20:23],s93 offen offset:1024 sc1
v_smfmac_f32_16x16x64_bf16 v[56:59],v[20:23],a[80:87],v1
s_waitcnt vmcnt(5)
v_max3_u32 v124,v24,v25,v26
v_smfmac_f32_16x16x64_bf16 v[60:63],v[20:23],a[88:95],v1
v_max_u32 v124,v124,v27
v_smfmac_f32_16x16x64_bf16 v[64:67],v[20:23],a[96:103],v1
v_cmp_eq_u32 vcc,-1,v124
v_smfmac_f32_16x16x64_bf16 v[68:71],v[20:23],a[104:111],v1
v_smfmac_f32_16x16x64_bf16 v[72:75],v[20:23],a[112:119],v1
s_cbranch_vccnz fl_100616
seg_100600:
v_smfmac_f32_16x16x64_bf16 v[76:79],v[20:23],a[120:127],v1
segb_100608:
v_smfmac_f32_16x16x64_bf16 v[48:51],v[24:27],a[128:135],v1
buffer_load_dword v125,off,s[20:23],s92 sc1
v_smfmac_f32_16x16x64_bf16 v[52:55],v[24:27],a[136:143],v1
buffer_load_dwordx4 v[40:43],v0,s[20:23],s93 offen offset:2048 sc1
v_smfmac_f32_16x16x64_bf16 v[56:59],v[24:27],a[144:151],v1
buffer_load_dwordx4 v[44:47],v0,s[20:23],s93 offen offset:3072 sc1
s_waitcnt vmcnt(7)
v_max3_u32 v124,v28,v29,v30
v_smfmac_f32_16x16x64_bf16 v[60:63],v[24:27],a[152:159],v1
v_max_u32 v124,v124,v31
v_smfmac_f32_16x16x64_bf16 v[64:67],v[24:27],a[160:167],v1
v_cmp_eq_u32 vcc,-1,v124
v_smfmac_f32_16x16x64_bf16 v[68:71],v[24:27],a[168:175],v1
v_smfmac_f32_16x16x64_bf16 v[72:75],v[24:27],a[176:183],v1
s_cbranch_vccnz fl_100617
seg_100601:
v_smfmac_f32_16x16x64_bf16 v[76:79],v[24:27],a[184:191],v1
segb_100609:
v_smfmac_f32_16x16x64_bf16 v[48:51],v[28:31],a[192:199],v1
buffer_load_dword v125,off,s[20:23],s92 sc1
v_smfmac_f32_16x16x64_bf16 v[52:55],v[28:31],a[200:207],v1
v_smfmac_f32_16x16x64_bf16 v[56:59],v[28:31],a[208:215],v1
s_waitcnt vmcnt(6)
v_max3_u32 v124,v32,v33,v34
v_smfmac_f32_16x16x64_bf16 v[60:63],v[28:31],a[216:223],v1
v_max_u32 v124,v124,v35
v_smfmac_f32_16x16x64_bf16 v[64:67],v[28:31],a[224:231],v1
v_cmp_eq_u32 vcc,-1,v124
v_smfmac_f32_16x16x64_bf16 v[68:71],v[28:31],a[232:239],v1
v_smfmac_f32_16x16x64_bf16 v[72:75],v[28:31],a[240:247],v1
s_cbranch_vccnz fl_100618
seg_100602:
v_smfmac_f32_16x16x64_bf16 v[76:79],v[28:31],a[248:255],v1
segb_100610:
v_smfmac_f32_16x16x64_bf16 v[48:51],v[32:35],a[0:7],v1
buffer_load_dword v125,off,s[20:23],s92 sc1
v_smfmac_f32_16x16x64_bf16 v[52:55],v[32:35],a[8:15],v1
buffer_store_dwordx4 v[112:115],v120,s[20:23],s101 offen sc1
v_smfmac_f32_16x16x64_bf16 v[56:59],v[32:35],a[16:23],v1
buffer_store_dword v126,v121,s[20:23],s69 offen sc1
s_waitcnt vmcnt(7)
v_max3_u32 v124,v36,v37,v38
v_smfmac_f32_16x16x64_bf16 v[60:63],v[32:35],a[24:31],v1
v_max_u32 v124,v124,v39
v_smfmac_f32_16x16x64_bf16 v[64:67],v[32:35],a[32:39],v1
v_cmp_eq_u32 vcc,-1,v124
v_smfmac_f32_16x16x64_bf16 v[68:71],v[32:35],a[40:47],v1
v_smfmac_f32_16x16x64_bf16 v[72:75],v[32:35],a[48:55],v1
s_cbranch_vccnz fl_100619
seg_100603:
v_smfmac_f32_16x16x64_bf16 v[76:79],v[32:35],a[56:63],v1
segb_100611:
v_smfmac_f32_16x16x64_bf16 v[48:51],v[36:39],a[64:71],v1
buffer_load_dword v125,off,s[20:23],s92 sc1
s_waitcnt vmcnt(5)
v_max3_u32 v124,v40,v41,v42
v_smfmac_f32_16x16x64_bf16 v[52:55],v[36:39],a[72:79],v1
v_max3_u32 v124,v124,v43,v44
v_smfmac_f32_16x16x64_bf16 v[56:59],v[36:39],a[80:87],v1
v_max3_u32 v124,v124,v45,v46
v_smfmac_f32_16x16x64_bf16 v[60:63],v[36:39],a[88:95],v1
v_max_u32 v124,v124,v47
v_smfmac_f32_16x16x64_bf16 v[64:67],v[36:39],a[96:103],v1
v_cmp_eq_u32 vcc,-1,v124
v_smfmac_f32_16x16x64_bf16 v[68:71],v[36:39],a[104:111],v1
v_smfmac_f32_16x16x64_bf16 v[72:75],v[36:39],a[112:119],v1
s_cbranch_vccnz fl_100620
seg_100604:
v_smfmac_f32_16x16x64_bf16 v[76:79],v[36:39],a[120:127],v1
segb_100612:
v_smfmac_f32_16x16x64_bf16 v[48:51],v[40:43],a[128:135],v1
buffer_load_dwordx4 v[104:107],v0,s[20:23],s99 offen
buffer_load_dwordx4 v[108:111],v0,s[20:23],s99 offen offset:1024
v_smfmac_f32_16x16x64_bf16 v[52:55],v[40:43],a[136:143],v1
buffer_load_dword v126,off,s[20:23],s68 sc1
s_add_u32 s64,s79,2
v_smfmac_f32_16x16x64_bf16 v[48:51],v[44:47],a[192:199],v1
s_and_b32 s64,s64,3
s_lshl_b32 s100,s64,19
v_smfmac_f32_16x16x64_bf16 v[52:55],v[44:47],a[200:207],v1
v_smfmac_f32_16x16x64_bf16 v[56:59],v[40:43],a[144:151],v1
v_add_f32 v48,v48,v49
v_smfmac_f32_16x16x64_bf16 v[60:63],v[40:43],a[152:159],v1
ds_write_addtid_b32 v48 offset:0
v_add_f32 v50,v50,v51
v_smfmac_f32_16x16x64_bf16 v[56:59],v[44:47],a[208:215],v1
ds_write_addtid_b32 v50 offset:1040
v_add_f32 v52,v52,v53
v_smfmac_f32_16x16x64_bf16 v[60:63],v[44:47],a[216:223],v1
ds_write_addtid_b32 v52 offset:2080
v_add_f32 v54,v54,v55
v_smfmac_f32_16x16x64_bf16 v[64:67],v[40:43],a[160:167],v1
ds_write_addtid_b32 v54 offset:3120
v_add_f32 v56,v56,v57
v_smfmac_f32_16x16x64_bf16 v[68:71],v[40:43],a[168:175],v1
ds_write_addtid_b32 v56 offset:4160
v_add_f32 v58,v58,v59
v_smfmac_f32_16x16x64_bf16 v[64:67],v[44:47],a[224:231],v1
ds_write_addtid_b32 v58 offset:5200
v_add_f32 v60,v60,v61
v_smfmac_f32_16x16x64_bf16 v[68:71],v[44:47],a[232:239],v1
ds_write_addtid_b32 v60 offset:6240
v_add_f32 v62,v62,v63
v_smfmac_f32_16x16x64_bf16 v[72:75],v[40:43],a[176:183],v1
ds_write_addtid_b32 v62 offset:7280
v_add_f32 v64,v64,v65
v_smfmac_f32_16x16x64_bf16 v[76:79],v[40:43],a[184:191],v1
ds_write_addtid_b32 v64 offset:8448
v_add_f32 v66,v66,v67
v_smfmac_f32_16x16x64_bf16 v[72:75],v[44:47],a[240:247],v1
ds_write_addtid_b32 v66 offset:9488
v_add_f32 v68,v68,v69
v_smfmac_f32_16x16x64_bf16 v[76:79],v[44:47],a[248:255],v1
ds_write_addtid_b32 v68 offset:10528
v_add_f32 v70,v70,v71
v_smfmac_f32_16x16x64_bf16 v[80:83],v[16:19],v[208:215],v1
ds_write_addtid_b32 v70 offset:11568
v_add_f32 v72,v72,v73
v_smfmac_f32_16x16x64_bf16 v[80:83],v[32:35],v[208:215],v1
ds_write_addtid_b32 v72 offset:12608
v_add_f32 v74,v74,v75
ds_write_addtid_b32 v74 offset:13648
v_add_f32 v76,v76,v77
v_add_f32 v78,v78,v79
ds_write_addtid_b32 v76 offset:14688
ds_write_addtid_b32 v78 offset:15728
doneA_100631:
s_waitcnt lgkmcnt(0)
s_barrier
s_cmp_gt_u32 s50,1
s_cbranch_scc1 w23_100632
v_smfmac_f32_16x16x64_bf16 v[84:87],v[16:19],v[216:223],v1
v_smfmac_f32_16x16x64_bf16 v[84:87],v[32:35],v[216:223],v1
v_smfmac_f32_16x16x64_bf16 v[88:91],v[16:19],v[224:231],v1
v_smfmac_f32_16x16x64_bf16 v[88:91],v[32:35],v[224:231],v1
v_smfmac_f32_16x16x64_bf16 v[92:95],v[16:19],v[232:239],v1
ds_read_b128 v[48:51],v7 offset:0
ds_read_b128 v[52:55],v7 offset:1024
v_smfmac_f32_16x16x64_bf16 v[92:95],v[32:35],v[232:239],v1
ds_read_b128 v[56:59],v7 offset:2048
ds_read_b128 v[60:63],v7 offset:3072
v_smfmac_f32_16x16x64_bf16 v[80:83],v[20:23],v[240:247],v1
ds_read_b128 v[64:67],v7 offset:4096
ds_read_b128 v[68:71],v7 offset:5120
v_smfmac_f32_16x16x64_bf16 v[80:83],v[36:39],v[240:247],v1
ds_read_b128 v[72:75],v7 offset:6144
ds_read_b128 v[76:79],v7 offset:7168
v_smfmac_f32_16x16x64_bf16 v[84:87],v[20:23],v[248:255],v1
v_smfmac_f32_16x16x64_bf16 v[84:87],v[36:39],v[248:255],v1
s_waitcnt lgkmcnt(6)
v_smfmac_f32_16x16x64_bf16 v[88:91],v[20:23],v[48:55],v1
v_smfmac_f32_16x16x64_bf16 v[88:91],v[36:39],v[48:55],v1
ds_read_b128 v[48:51],v7 offset:8192
ds_read_b128 v[52:55],v7 offset:9216
s_waitcnt lgkmcnt(6)
v_smfmac_f32_16x16x64_bf16 v[92:95],v[20:23],v[56:63],v1
v_smfmac_f32_16x16x64_bf16 v[92:95],v[36:39],v[56:63],v1
ds_read_b128 v[56:59],v7 offset:10240
ds_read_b128 v[60:63],v7 offset:11264
s_waitcnt lgkmcnt(6)
v_smfmac_f32_16x16x64_bf16 v[80:83],v[24:27],v[64:71],v1
v_smfmac_f32_16x16x64_bf16 v[80:83],v[40:43],v[64:71],v1
ds_read_b128 v[64:67],v7 offset:12288
ds_read_b128 v[68:71],v7 offset:13312
s_waitcnt lgkmcnt(6)
v_smfmac_f32_16x16x64_bf16 v[84:87],v[24:27],v[72:79],v1
v_smfmac_f32_16x16x64_bf16 v[84:87],v[40:43],v[72:79],v1
ds_read_b128 v[72:75],v7 offset:14336
ds_read_b128 v[76:79],v7 offset:15360
s_waitcnt lgkmcnt(6)
v_smfmac_f32_16x16x64_bf16 v[88:91],v[24:27],v[48:55],v1
v_smfmac_f32_16x16x64_bf16 v[88:91],v[40:43],v[48:55],v1
ds_read_b128 v[48:51],v7 offset:16384
ds_read_b128 v[52:55],v7 offset:17408
s_waitcnt lgkmcnt(6)
v_smfmac_f32_16x16x64_bf16 v[92:95],v[24:27],v[56:63],v1
v_smfmac_f32_16x16x64_bf16 v[92:95],v[40:43],v[56:63],v1
ds_read_b128 v[56:59],v7 offset:18432
ds_read_b128 v[60:63],v7 offset:19456
s_waitcnt lgkmcnt(6)
v_smfmac_f32_16x16x64_bf16 v[80:83],v[28:31],v[64:71],v1
v_smfmac_f32_16x16x64_bf16 v[80:83],v[44:47],v[64:71],v1
s_waitcnt lgkmcnt(4)
v_smfmac_f32_16x16x64_bf16 v[84:87],v[28:31],v[72:79],v1
v_smfmac_f32_16x16x64_bf16 v[84:87],v[44:47],v[72:79],v1
s_waitcnt lgkmcnt(2)
v_smfmac_f32_16x16x64_bf16 v[88:91],v[28:31],v[48:55],v1
v_add_f32 v80,v80,v81
v_smfmac_f32_16x16x64_bf16 v[88:91],v[44:47],v[48:55],v1
v_add_f32 v82,v82,v83
s_waitcnt lgkmcnt(0)
v_smfmac_f32_16x16x64_bf16 v[92:95],v[28:31],v[56:63],v1
v_cvt_pk_bf16_f32 v80,v80,v82
v_smfmac_f32_16x16x64_bf16 v[92:95],v[44:47],v[56:63],v1
ds_write_addtid_b32 v80 offset:16896
v_add_f32 v84,v84,v85
buffer_load_dwordx4 v[16:19],v2,s[20:23],s94 offen offset:0 sc1
buffer_load_dwordx4 v[32:35],v2,s[20:23],s94 offen offset:1536 sc1
buffer_load_dwordx4 v[20:23],v2,s[20:23],s95 offen offset:0 sc1
buffer_load_dwordx4 v[36:39],v2,s[20:23],s95 offen offset:1536 sc1
buffer_load_dword v120,v3,s[20:23],s94 offen offset:0 sc1
buffer_load_dword v121,v3,s[20:23],s94 offen offset:1536 sc1
buffer_load_dword v122,v3,s[20:23],s95 offen offset:0 sc1
buffer_load_dword v123,v3,s[20:23],s95 offen offset:1536 sc1
v_add_f32 v86,v86,v87
v_cvt_pk_bf16_f32 v84,v84,v86
v_add_f32 v88,v88,v89
v_add_f32 v90,v90,v91
v_cvt_pk_bf16_f32 v88,v88,v90
v_add_f32 v92,v92,v93
v_add_f32 v94,v94,v95
v_cvt_pk_bf16_f32 v92,v92,v94
ds_write_addtid_b32 v84 offset:17920
ds_write_addtid_b32 v88 offset:18944
ds_write_addtid_b32 v92 offset:19968
sp_100635:
s_waitcnt vmcnt(6)
v_pk_add_f32 v[16:17],v[16:17],v[32:33]
v_pk_add_f32 v[18:19],v[18:19],v[34:35]
s_waitcnt vmcnt(4)
v_pk_add_f32 v[20:21],v[20:21],v[36:37]
v_pk_add_f32 v[22:23],v[22:23],v[38:39]
v_pk_add_f32 v[16:17],v[16:17],v[20:21]
v_pk_add_f32 v[18:19],v[18:19],v[22:23]
v_max3_f32 v124,v16,v17,v18
v_pk_add_f32 v[20:21],v[16:17],v[18:19]
s_waitcnt vmcnt(0)
v_pk_add_f32 v[120:121],v[120:121],v[122:123]
v_add_f32 v120,v120,v121
v_max3_f32 v124,v124,v19,v120
v_add_f32 v20,v20,v120
v_cmp_u_f32 vcc,v20,v21
v_max_f32_dpp v124,v124,v124 row_ror:8 row_mask:0xf bank_mask:0xf
v_mov_b32 v125,v124
s_cbranch_vccnz srt_100637
sok_100636:
s_nop 0
v_permlane16_swap_b32 v125,v124
v_max_f32 v124,v124,v125
v_mov_b32 v125,v124
s_nop 1
v_permlane32_swap_b32 v125,v124
v_max_f32 v124,v124,v125
v_mul_f32 v124,s80,v124
v_fma_f32 v16,v16,s80,-v124
v_fma_f32 v17,v17,s80,-v124
v_fma_f32 v18,v18,s80,-v124
v_fma_f32 v19,v19,s80,-v124
v_fma_f32 v120,v120,s80,-v124
s_waitcnt lgkmcnt(0)
s_barrier
ds_read2st64_b32 v[112:113],v127 offset0:66 offset1:67
ds_read2st64_b32 v[114:115],v127 offset0:68 offset1:69
ds_read2st64_b32 v[116:117],v127 offset0:70 offset1:71
ds_read2st64_b32 v[118:119],v127 offset0:72 offset1:73
v_exp_f32 v16,v16
v_exp_f32 v17,v17
v_exp_f32 v18,v18
v_exp_f32 v19,v19
v_cvt_pk_bf16_f32 v48,v16,v17
v_cvt_pk_bf16_f32 v49,v18,v19
v_exp_f32 v120,v120
v_mov_b32_dpp v50,v48 row_ror:8 row_mask:0xf bank_mask:0xf
v_mov_b32_dpp v51,v49 row_ror:8 row_mask:0xf bank_mask:0xf
v_mov_b32_dpp v121,v120 row_ror:8 row_mask:0xf bank_mask:0xf
v_cvt_pk_bf16_f32 v52,v120,v121
v_mfma_f32_16x16x32_bf16 v[64:67],v[8:11],v[48:51],0
v_mov_b32 v53,v52
v_mfma_f32_16x16x32_bf16 v[56:59],v[96:99],v[48:51],0
v_mov_b32 v54,v52
v_mov_b32 v55,v52
v_mfma_f32_16x16x32_bf16 v[60:63],v[100:103],v[48:51],0
v_mfma_f32_16x16x32_bf16 v[64:67],v[12:15],v[52:55],v[64:67]
s_waitcnt lgkmcnt(0)
v_mfma_f32_16x16x32_bf16 v[56:59],v[112:115],v[52:55],v[56:59]
v_mfma_f32_16x16x32_bf16 v[60:63],v[116:119],v[52:55],v[60:63]
s_nop 0
v_rcp_f32 v66,v64
s_nop 2
v_pk_mul_f32 v[56:57],v[56:57],v[66:67] op_sel_hi:[1,0]
v_pk_mul_f32 v[58:59],v[58:59],v[66:67] op_sel_hi:[1,0]
s_nop 0
v_pk_mul_f32 v[60:61],v[60:61],v[66:67] op_sel_hi:[1,0]
v_pk_mul_f32 v[62:63],v[62:63],v[66:67] op_sel_hi:[1,0]
v_cvt_pk_bf16_f32 v120,v56,v57
v_cvt_pk_bf16_f32 v121,v58,v59
v_cvt_pk_bf16_f32 v122,v60,v61
v_cvt_pk_bf16_f32 v123,v62,v63
buffer_store_dwordx4 v[120:123],v6,s[20:23],s98 offen sc1
s_barrier
ds_read_b128 v[48:51],v7 offset:20480
ds_read_b128 v[52:55],v7 offset:21504
ds_read_b128 v[56:59],v7 offset:22528
ds_read_b128 v[60:63],v7 offset:23552
ds_read_b128 v[64:67],v7 offset:24576
ds_read_b128 v[68:71],v7 offset:25600
ds_read_b128 v[72:75],v7 offset:26624
ds_read_b128 v[76:79],v7 offset:27648
ds_read_b128 v[80:83],v7 offset:28672
ds_read_b128 v[84:87],v7 offset:29696
ds_read_b128 v[88:91],v7 offset:30720
ds_read_b128 v[92:95],v7 offset:31744
v_mov_b32 v96,0
v_mov_b32 v97,0
v_mov_b32 v98,0
v_mov_b32 v99,0
v_mov_b32 v100,0
v_mov_b32 v101,0
v_mov_b32 v102,0
v_mov_b32 v103,0
s_nop 11
buffer_load_dwordx4 v[16:19],v0,s[20:23],s96 offen offset:0 sc1
v_mov_b32 v120,v5
v_mov_b32 v121,v5
v_mov_b32 v122,v5
v_mov_b32 v123,v5
s_nop 1
v_mfma_f32_16x16x32_bf16 v[112:115],v[120:123],v[112:115],0
buffer_load_dwordx4 v[20:23],v0,s[20:23],s96 offen offset:1024 sc1
v_mfma_f32_16x16x32_bf16 v[116:119],v[120:123],v[116:119],0
s_add_u32 s79,s79,1
s_and_b32 s64,s79,3
s_lshl_b32 s64,s64,19
s_lshl_b32 s65,s79,8
buffer_load_dwordx4 v[24:27],v0,s[20:23],s96 offen offset:2048 sc1
s_and_b32 s65,s65,0x2000
s_lshl_b32 s66,s79,16
s_xor_b32 s88,s73,s65
s_add_u32 s88,s88,s66
s_sub_u32 s88,s88,s54
s_add_u32 s89,s71,s64
s_add_u32 s92,s70,s64
s_xor_b32 s93,s72,s65
buffer_load_dwordx4 v[28:31],v0,s[20:23],s96 offen offset:3072 sc1
s_add_u32 s93,s93,s66
s_add_u32 s94,s76,s64
s_add_u32 s95,s94,4096
s_add_u32 s98,s75,s64
s_add_u32 s60,s74,s64
v_cvt_pk_bf16_f32 v112,v112,v113
v_cvt_pk_bf16_f32 v113,v114,v115
v_cvt_pk_bf16_f32 v114,v116,v117
buffer_load_dwordx4 v[32:35],v0,s[20:23],s97 offen offset:0 sc1
v_cvt_pk_bf16_f32 v115,v118,v119
s_nop 6
buffer_load_dwordx4 v[36:39],v0,s[20:23],s97 offen offset:1024 sc1
s_nop 7
buffer_load_dwordx4 v[40:43],v0,s[20:23],s97 offen offset:2048 sc1
s_nop 7
buffer_load_dwordx4 v[44:47],v0,s[20:23],s97 offen offset:3072 sc1
s_branch ogo_100633
w23_100632:
ds_read_b128 v[48:51],v2 offset:0
ds_read_b128 v[52:55],v2 offset:256
ds_read_b128 v[56:59],v2 offset:512
ds_read_b128 v[60:63],v2 offset:768
ds_read_b128 v[64:67],v2 offset:16
ds_read_b128 v[68:71],v2 offset:272
ds_read_b128 v[72:75],v2 offset:528
ds_read_b128 v[76:79],v2 offset:784
s_waitcnt lgkmcnt(6)
v_pk_add_f32 v[48:49],v[48:49],v[52:53]
v_pk_add_f32 v[50:51],v[50:51],v[54:55]
s_waitcnt lgkmcnt(4)
v_pk_add_f32 v[56:57],v[56:57],v[60:61]
v_pk_add_f32 v[58:59],v[58:59],v[62:63]
v_pk_add_f32 v[48:49],v[48:49],v[56:57]
v_pk_add_f32 v[50:51],v[50:51],v[58:59]
v_cvt_pk_bf16_f32 v112,v48,v49
v_cvt_pk_bf16_f32 v113,v50,v51
s_waitcnt lgkmcnt(2)
v_pk_add_f32 v[64:65],v[64:65],v[68:69]
v_pk_add_f32 v[66:67],v[66:67],v[70:71]
s_waitcnt lgkmcnt(0)
v_pk_add_f32 v[72:73],v[72:73],v[76:77]
v_pk_add_f32 v[74:75],v[74:75],v[78:79]
v_pk_add_f32 v[64:65],v[64:65],v[72:73]
v_pk_add_f32 v[66:67],v[66:67],v[74:75]
v_cvt_pk_bf16_f32 v114,v64,v65
v_cvt_pk_bf16_f32 v115,v66,v67
s_nop 1
v_mfma_f32_16x16x32_bf16 v[116:119],v[96:99],v[112:115],0
v_mfma_f32_16x16x32_bf16 v[120:123],v[100:103],v[112:115],0
v_mfma_f32_16x16x32_bf16 v[12:15],v[112:115],v[112:115],0
ds_read_b128 v[48:51],v7 offset:0
ds_read_b128 v[52:55],v7 offset:1024
ds_read_b128 v[56:59],v7 offset:2048
ds_read_b128 v[60:63],v7 offset:3072
ds_read_b128 v[64:67],v7 offset:4096
buffer_store_dwordx4 v[116:119],v3,s[20:23],s94 offen sc1
buffer_store_dwordx4 v[120:123],v3,s[20:23],s94 offen offset:512 sc1
s_nop 0
buffer_store_dwordx4 v[12:15],v3,s[20:23],s94 offen offset:1024 sc1
ds_read_b128 v[68:71],v7 offset:5120
ds_read_b128 v[72:75],v7 offset:6144
ds_read_b128 v[76:79],v7 offset:7168
v_smfmac_f32_16x16x64_bf16 v[84:87],v[16:19],v[216:223],v1
v_smfmac_f32_16x16x64_bf16 v[84:87],v[32:35],v[216:223],v1
v_smfmac_f32_16x16x64_bf16 v[88:91],v[16:19],v[224:231],v1
v_smfmac_f32_16x16x64_bf16 v[88:91],v[32:35],v[224:231],v1
v_smfmac_f32_16x16x64_bf16 v[92:95],v[16:19],v[232:239],v1
v_smfmac_f32_16x16x64_bf16 v[92:95],v[32:35],v[232:239],v1
v_smfmac_f32_16x16x64_bf16 v[80:83],v[20:23],v[240:247],v1
v_smfmac_f32_16x16x64_bf16 v[80:83],v[36:39],v[240:247],v1
v_smfmac_f32_16x16x64_bf16 v[84:87],v[20:23],v[248:255],v1
v_smfmac_f32_16x16x64_bf16 v[84:87],v[36:39],v[248:255],v1
s_waitcnt lgkmcnt(6)
v_smfmac_f32_16x16x64_bf16 v[88:91],v[20:23],v[48:55],v1
v_smfmac_f32_16x16x64_bf16 v[88:91],v[36:39],v[48:55],v1
ds_read_b128 v[48:51],v7 offset:8192
ds_read_b128 v[52:55],v7 offset:9216
s_waitcnt lgkmcnt(6)
v_smfmac_f32_16x16x64_bf16 v[92:95],v[20:23],v[56:63],v1
v_smfmac_f32_16x16x64_bf16 v[92:95],v[36:39],v[56:63],v1
ds_read_b128 v[56:59],v7 offset:10240
ds_read_b128 v[60:63],v7 offset:11264
s_waitcnt lgkmcnt(6)
v_smfmac_f32_16x16x64_bf16 v[80:83],v[24:27],v[64:71],v1
v_smfmac_f32_16x16x64_bf16 v[80:83],v[40:43],v[64:71],v1
ds_read_b128 v[64:67],v7 offset:12288
ds_read_b128 v[68:71],v7 offset:13312
s_waitcnt lgkmcnt(6)
v_smfmac_f32_16x16x64_bf16 v[84:87],v[24:27],v[72:79],v1
v_smfmac_f32_16x16x64_bf16 v[84:87],v[40:43],v[72:79],v1
ds_read_b128 v[72:75],v7 offset:14336
ds_read_b128 v[76:79],v7 offset:15360
s_waitcnt lgkmcnt(6)
v_smfmac_f32_16x16x64_bf16 v[88:91],v[24:27],v[48:55],v1
v_smfmac_f32_16x16x64_bf16 v[88:91],v[40:43],v[48:55],v1
ds_read_b128 v[48:51],v7 offset:16384
ds_read_b128 v[52:55],v7 offset:17408
s_waitcnt lgkmcnt(6)
v_smfmac_f32_16x16x64_bf16 v[92:95],v[24:27],v[56:63],v1
v_smfmac_f32_16x16x64_bf16 v[92:95],v[40:43],v[56:63],v1
ds_read_b128 v[56:59],v7 offset:18432
ds_read_b128 v[60:63],v7 offset:19456
s_waitcnt lgkmcnt(6)
v_smfmac_f32_16x16x64_bf16 v[80:83],v[28:31],v[64:71],v1
v_smfmac_f32_16x16x64_bf16 v[80:83],v[44:47],v[64:71],v1
s_waitcnt lgkmcnt(4)
v_smfmac_f32_16x16x64_bf16 v[84:87],v[28:31],v[72:79],v1
v_smfmac_f32_16x16x64_bf16 v[84:87],v[44:47],v[72:79],v1
s_waitcnt lgkmcnt(2)
v_smfmac_f32_16x16x64_bf16 v[88:91],v[28:31],v[48:55],v1
v_add_f32 v80,v80,v81
v_smfmac_f32_16x16x64_bf16 v[88:91],v[44:47],v[48:55],v1
v_add_f32 v82,v82,v83
s_waitcnt lgkmcnt(0)
v_smfmac_f32_16x16x64_bf16 v[92:95],v[28:31],v[56:63],v1
v_cvt_pk_bf16_f32 v80,v80,v82
v_smfmac_f32_16x16x64_bf16 v[92:95],v[44:47],v[56:63],v1
ds_write_addtid_b32 v80 offset:16896
v_add_f32 v84,v84,v85
v_add_f32 v86,v86,v87
v_cvt_pk_bf16_f32 v84,v84,v86
v_add_f32 v88,v88,v89
v_add_f32 v90,v90,v91
v_cvt_pk_bf16_f32 v88,v88,v90
s_nop 0
v_add_f32 v92,v92,v93
v_add_f32 v94,v94,v95
v_cvt_pk_bf16_f32 v92,v92,v94
ds_write_addtid_b32 v84 offset:17920
ds_write_addtid_b32 v88 offset:18944
ds_write_addtid_b32 v92 offset:19968
s_waitcnt lgkmcnt(0)
s_barrier
ds_read_b128 v[48:51],v7 offset:20480
ds_read_b128 v[52:55],v7 offset:21504
ds_read_b128 v[56:59],v7 offset:22528
ds_read_b128 v[60:63],v7 offset:23552
ds_read_b128 v[64:67],v7 offset:24576
ds_read_b128 v[68:71],v7 offset:25600
ds_read_b128 v[72:75],v7 offset:26624
ds_read_b128 v[76:79],v7 offset:27648
ds_read_b128 v[80:83],v7 offset:28672
ds_read_b128 v[84:87],v7 offset:29696
ds_read_b128 v[88:91],v7 offset:30720
ds_read_b128 v[92:95],v7 offset:31744
s_add_u32 s65,s76,s100
s_add_u32 s66,s75,s100
s_add_u32 s64,s71,s100
s_cmp_eq_u32 s50,2
s_cselect_b32 s66,s66,s64
buffer_store_dwordx4 v[8:11],v0,s[20:23],s65 offen sc1
s_cmp_eq_u32 s50,2
s_cselect_b32 exec_hi,-1,0
buffer_store_dwordx4 v[8:11],v0,s[20:23],s66 offen sc1
s_mov_b32 exec_hi,0
buffer_store_dwordx4 v[8:11],v0,s[20:23],s65 offen offset:1024 sc1
s_mov_b64 exec,-1
v_mov_b32 v96,0
v_mov_b32 v97,0
v_mov_b32 v98,0
v_mov_b32 v99,0
v_mov_b32 v100,0
v_mov_b32 v101,0
v_mov_b32 v102,0
v_mov_b32 v103,0
s_barrier
s_nop 15
s_nop 15
s_nop 7
buffer_load_dwordx4 v[16:19],v0,s[20:23],s96 offen offset:0 sc1
s_add_u32 s79,s79,1
s_and_b32 s64,s79,3
s_lshl_b32 s64,s64,19
s_lshl_b32 s65,s79,8
s_and_b32 s65,s65,0x2000
s_lshl_b32 s66,s79,16
s_xor_b32 s88,s73,s65
s_add_u32 s88,s88,s66
buffer_load_dwordx4 v[20:23],v0,s[20:23],s96 offen offset:1024 sc1
s_sub_u32 s88,s88,s54
s_add_u32 s89,s71,s64
s_add_u32 s92,s70,s64
s_xor_b32 s93,s72,s65
s_add_u32 s93,s93,s66
s_add_u32 s94,s76,s64
s_add_u32 s95,s94,4096
s_add_u32 s98,s75,s64
buffer_load_dwordx4 v[24:27],v0,s[20:23],s96 offen offset:2048 sc1
s_add_u32 s60,s74,s64
s_nop 6
buffer_load_dwordx4 v[28:31],v0,s[20:23],s96 offen offset:3072 sc1
s_nop 7
buffer_load_dwordx4 v[32:35],v0,s[20:23],s97 offen offset:0 sc1
s_nop 7
buffer_load_dwordx4 v[36:39],v0,s[20:23],s97 offen offset:1024 sc1
s_nop 7
buffer_load_dwordx4 v[40:43],v0,s[20:23],s97 offen offset:2048 sc1
s_nop 7
buffer_load_dwordx4 v[44:47],v0,s[20:23],s97 offen offset:3072 sc1
ogo_100633:
s_waitcnt lgkmcnt(0)
s_waitcnt vmcnt(6)
v_max3_u32 v124,v16,v17,v18
v_max3_u32 v124,v124,v19,v20
v_max3_u32 v124,v124,v21,v22
v_max_u32 v124,v124,v23
v_cmp_eq_u32 vcc,-1,v124
s_cbranch_vccnz of_100638
v_smfmac_f32_16x16x64_bf16 v[96:99],v[16:19],v[48:55],v1
v_smfmac_f32_16x16x64_bf16 v[100:103],v[16:19],v[56:63],v1
v_smfmac_f32_16x16x64_bf16 v[96:99],v[20:23],v[64:71],v1
v_smfmac_f32_16x16x64_bf16 v[100:103],v[20:23],v[72:79],v1
v_readfirstlane_b32 s91,v126
s_waitcnt vmcnt(4)
v_max3_u32 v124,v24,v25,v26
v_max3_u32 v124,v124,v27,v28
v_max3_u32 v124,v124,v29,v30
v_max_u32 v124,v124,v31
v_cmp_eq_u32 vcc,-1,v124
s_cbranch_vccnz of_100639
v_smfmac_f32_16x16x64_bf16 v[96:99],v[24:27],v[80:87],v1
v_smfmac_f32_16x16x64_bf16 v[100:103],v[24:27],v[88:95],v1
v_smfmac_f32_16x16x64_bf16 v[96:99],v[28:31],v[128:135],v1
v_smfmac_f32_16x16x64_bf16 v[100:103],v[28:31],v[136:143],v1
s_waitcnt vmcnt(2)
v_max3_u32 v124,v32,v33,v34
v_max3_u32 v124,v124,v35,v36
v_max3_u32 v124,v124,v37,v38
v_max_u32 v124,v124,v39
v_cmp_eq_u32 vcc,-1,v124
s_cbranch_vccnz of_100640
v_smfmac_f32_16x16x64_bf16 v[96:99],v[32:35],v[144:151],v1
v_smfmac_f32_16x16x64_bf16 v[100:103],v[32:35],v[152:159],v1
v_smfmac_f32_16x16x64_bf16 v[96:99],v[36:39],v[160:167],v1
v_smfmac_f32_16x16x64_bf16 v[100:103],v[36:39],v[168:175],v1
s_waitcnt vmcnt(1)
v_max3_u32 v124,v40,v41,v42
v_max_u32 v124,v124,v43
v_cmp_eq_u32 vcc,-1,v124
s_cbranch_vccnz of_100641
v_smfmac_f32_16x16x64_bf16 v[96:99],v[40:43],v[176:183],v1
v_smfmac_f32_16x16x64_bf16 v[100:103],v[40:43],v[184:191],v1
s_waitcnt vmcnt(0)
v_max3_u32 v124,v44,v45,v46
v_max_u32 v124,v124,v47
v_cmp_eq_u32 vcc,-1,v124
s_cbranch_vccnz of_100642
v_smfmac_f32_16x16x64_bf16 v[96:99],v[44:47],v[192:199],v1
v_smfmac_f32_16x16x64_bf16 v[100:103],v[44:47],v[200:207],v1
oback_100649:
s_nop 4
v_add_f32 v96,v96,v97
v_add_f32 v98,v98,v99
s_nop 0
v_add_f32 v100,v100,v101
v_add_f32 v102,v102,v103
ds_write_addtid_b32 v96 offset:20992
ds_write_addtid_b32 v98 offset:23072
ds_write_addtid_b32 v100 offset:22016
ds_write_addtid_b32 v102 offset:24096
s_mov_b32 s96,s60
s_add_u32 s97,s60,4096
s_cmp_gt_u32 s50,1
s_waitcnt lgkmcnt(0)
s_barrier
s_cbranch_scc1 loop_100588
ds_read2st64_b32 v[48:49],v4 offset0:82 offset1:86
ds_read2st64_b32 v[50:51],v4 offset0:83 offset1:87
ds_read2st64_b32 v[52:53],v4 offset0:84 offset1:88
ds_read2st64_b32 v[54:55],v4 offset0:85 offset1:89
v_mov_b32 v96,v104
v_mov_b32 v97,v105
v_mov_b32 v98,v106
v_mov_b32 v99,v107
v_mov_b32 v100,v108
v_mov_b32 v101,v109
v_mov_b32 v102,v110
v_mov_b32 v103,v111
s_waitcnt lgkmcnt(2)
v_pk_add_f32 v[48:49],v[48:49],v[50:51]
s_waitcnt lgkmcnt(0)
v_pk_add_f32 v[52:53],v[52:53],v[54:55]
v_pk_add_f32 v[48:49],v[48:49],v[52:53]
v_cvt_pk_bf16_f32 v124,v48,v49
buffer_store_dword v124,v127,s[20:23],s89 offen sc1
s_nop 7
buffer_store_dword v124,v127,s[20:23],s88 offen sc1
s_branch loop0_100592x
last_100589:
s_waitcnt vmcnt(3)
v_max3_u32 v124,v16,v17,v18
v_max_u32 v124,v124,v19
v_cmp_eq_u32 vcc,-1,v124
s_cbranch_vccnz flb_100674
seg_100650:
segb_100658:
v_smfmac_f32_16x16x64_bf16 v[64:67],v[16:19],a[32:39],v1
buffer_load_dword v125,off,s[20:23],s92 sc1
buffer_load_dwordx4 v[32:35],v0,s[20:23],s93 offen offset:0 sc1
s_waitcnt vmcnt(4)
v_max3_u32 v124,v20,v21,v22
v_smfmac_f32_16x16x64_bf16 v[68:71],v[16:19],a[40:47],v1
v_max_u32 v124,v124,v23
v_cmp_eq_u32 vcc,-1,v124
v_smfmac_f32_16x16x64_bf16 v[72:75],v[16:19],a[48:55],v1
v_smfmac_f32_16x16x64_bf16 v[76:79],v[16:19],a[56:63],v1
s_cbranch_vccnz fl_100667
seg_100651:
segb_100659:
v_smfmac_f32_16x16x64_bf16 v[64:67],v[20:23],a[96:103],v1
buffer_load_dword v125,off,s[20:23],s92 sc1
buffer_load_dwordx4 v[36:39],v0,s[20:23],s93 offen offset:1024 sc1
s_waitcnt vmcnt(5)
v_max3_u32 v124,v24,v25,v26
v_smfmac_f32_16x16x64_bf16 v[68:71],v[20:23],a[104:111],v1
v_max_u32 v124,v124,v27
v_cmp_eq_u32 vcc,-1,v124
v_smfmac_f32_16x16x64_bf16 v[72:75],v[20:23],a[112:119],v1
v_smfmac_f32_16x16x64_bf16 v[76:79],v[20:23],a[120:127],v1
s_cbranch_vccnz fl_100668
seg_100652:
segb_100660:
v_smfmac_f32_16x16x64_bf16 v[64:67],v[24:27],a[160:167],v1
buffer_load_dword v125,off,s[20:23],s92 sc1
buffer_load_dwordx4 v[40:43],v0,s[20:23],s93 offen offset:2048 sc1
buffer_load_dwordx4 v[44:47],v0,s[20:23],s93 offen offset:3072 sc1
s_waitcnt vmcnt(7)
v_max3_u32 v124,v28,v29,v30
v_smfmac_f32_16x16x64_bf16 v[68:71],v[24:27],a[168:175],v1
v_max_u32 v124,v124,v31
v_cmp_eq_u32 vcc,-1,v124
v_smfmac_f32_16x16x64_bf16 v[72:75],v[24:27],a[176:183],v1
v_smfmac_f32_16x16x64_bf16 v[76:79],v[24:27],a[184:191],v1
s_cbranch_vccnz fl_100669
seg_100653:
segb_100661:
v_smfmac_f32_16x16x64_bf16 v[64:67],v[28:31],a[224:231],v1
buffer_load_dword v125,off,s[20:23],s92 sc1
s_waitcnt vmcnt(6)
v_max3_u32 v124,v32,v33,v34
v_smfmac_f32_16x16x64_bf16 v[68:71],v[28:31],a[232:239],v1
v_max_u32 v124,v124,v35
v_cmp_eq_u32 vcc,-1,v124
v_smfmac_f32_16x16x64_bf16 v[72:75],v[28:31],a[240:247],v1
v_smfmac_f32_16x16x64_bf16 v[76:79],v[28:31],a[248:255],v1
s_cbranch_vccnz fl_100670
seg_100654:
segb_100662:
v_smfmac_f32_16x16x64_bf16 v[64:67],v[32:35],a[32:39],v1
buffer_load_dword v125,off,s[20:23],s92 sc1
buffer_store_dwordx4 v[112:115],v120,s[20:23],s101 offen sc1
buffer_store_dword v126,v121,s[20:23],s69 offen sc1
s_waitcnt vmcnt(7)
v_max3_u32 v124,v36,v37,v38
v_smfmac_f32_16x16x64_bf16 v[68:71],v[32:35],a[40:47],v1
v_max_u32 v124,v124,v39
v_cmp_eq_u32 vcc,-1,v124
v_smfmac_f32_16x16x64_bf16 v[72:75],v[32:35],a[48:55],v1
v_smfmac_f32_16x16x64_bf16 v[76:79],v[32:35],a[56:63],v1
s_cbranch_vccnz fl_100671
seg_100655:
segb_100663:
v_smfmac_f32_16x16x64_bf16 v[64:67],v[36:39],a[96:103],v1
buffer_load_dword v125,off,s[20:23],s92 sc1
s_waitcnt vmcnt(5)
v_max3_u32 v124,v40,v41,v42
v_smfmac_f32_16x16x64_bf16 v[68:71],v[36:39],a[104:111],v1
v_max3_u32 v124,v124,v43,v44
v_max3_u32 v124,v124,v45,v46
v_max_u32 v124,v124,v47
v_cmp_eq_u32 vcc,-1,v124
v_smfmac_f32_16x16x64_bf16 v[72:75],v[36:39],a[112:119],v1
v_smfmac_f32_16x16x64_bf16 v[76:79],v[36:39],a[120:127],v1
s_cbranch_vccnz fl_100672
seg_100656:
segb_100664:
v_smfmac_f32_16x16x64_bf16 v[64:67],v[40:43],a[160:167],v1
v_smfmac_f32_16x16x64_bf16 v[68:71],v[40:43],a[168:175],v1
v_smfmac_f32_16x16x64_bf16 v[64:67],v[44:47],a[224:231],v1
v_smfmac_f32_16x16x64_bf16 v[68:71],v[44:47],a[232:239],v1
v_smfmac_f32_16x16x64_bf16 v[72:75],v[40:43],a[176:183],v1
s_nop 1
v_add_f32 v64,v64,v65
v_smfmac_f32_16x16x64_bf16 v[76:79],v[40:43],a[184:191],v1
ds_write_addtid_b32 v64 offset:8448
v_add_f32 v66,v66,v67
v_smfmac_f32_16x16x64_bf16 v[72:75],v[44:47],a[240:247],v1
ds_write_addtid_b32 v66 offset:9488
v_add_f32 v68,v68,v69
v_smfmac_f32_16x16x64_bf16 v[76:79],v[44:47],a[248:255],v1
ds_write_addtid_b32 v68 offset:10528
v_add_f32 v70,v70,v71
v_smfmac_f32_16x16x64_bf16 v[80:83],v[16:19],v[208:215],v1
ds_write_addtid_b32 v70 offset:11568
v_add_f32 v72,v72,v73
v_smfmac_f32_16x16x64_bf16 v[80:83],v[32:35],v[208:215],v1
ds_write_addtid_b32 v72 offset:12608
v_add_f32 v74,v74,v75
v_smfmac_f32_16x16x64_bf16 v[84:87],v[16:19],v[216:223],v1
ds_write_addtid_b32 v74 offset:13648
v_add_f32 v76,v76,v77
v_smfmac_f32_16x16x64_bf16 v[84:87],v[32:35],v[216:223],v1
ds_write_addtid_b32 v76 offset:14688
v_add_f32 v78,v78,v79
v_smfmac_f32_16x16x64_bf16 v[88:91],v[16:19],v[224:231],v1
ds_write_addtid_b32 v78 offset:15728
v_smfmac_f32_16x16x64_bf16 v[88:91],v[32:35],v[224:231],v1
v_smfmac_f32_16x16x64_bf16 v[92:95],v[16:19],v[232:239],v1
v_smfmac_f32_16x16x64_bf16 v[92:95],v[32:35],v[232:239],v1
doneA_100683:
s_waitcnt vmcnt(0) lgkmcnt(0)
s_add_u32 s64,s79,0
s_lshl_b32 s65,s64,12
s_and_b32 s65,s65,0x2000
s_xor_b32 s65,s65,s67
s_lshl_b32 s64,s64,20
s_add_u32 s65,s65,s64
s_add_u32 s101,s65,s78
v_smfmac_f32_16x16x64_bf16 v[80:83],v[20:23],v[240:247],v1
ds_read_b128 v[48:51],v7 offset:0
ds_read_b128 v[52:55],v7 offset:1024
v_smfmac_f32_16x16x64_bf16 v[80:83],v[36:39],v[240:247],v1
ds_read_b128 v[56:59],v7 offset:2048
ds_read_b128 v[60:63],v7 offset:3072
v_smfmac_f32_16x16x64_bf16 v[84:87],v[20:23],v[248:255],v1
ds_read_b128 v[64:67],v7 offset:4096
ds_read_b128 v[68:71],v7 offset:5120
v_smfmac_f32_16x16x64_bf16 v[84:87],v[36:39],v[248:255],v1
ds_read_b128 v[72:75],v7 offset:6144
ds_read_b128 v[76:79],v7 offset:7168
s_waitcnt lgkmcnt(6)
v_smfmac_f32_16x16x64_bf16 v[88:91],v[20:23],v[48:55],v1
v_smfmac_f32_16x16x64_bf16 v[88:91],v[36:39],v[48:55],v1
ds_read_b128 v[48:51],v7 offset:8192
ds_read_b128 v[52:55],v7 offset:9216
s_waitcnt lgkmcnt(6)
v_smfmac_f32_16x16x64_bf16 v[92:95],v[20:23],v[56:63],v1
v_smfmac_f32_16x16x64_bf16 v[92:95],v[36:39],v[56:63],v1
ds_read_b128 v[56:59],v7 offset:10240
ds_read_b128 v[60:63],v7 offset:11264
s_waitcnt lgkmcnt(6)
v_smfmac_f32_16x16x64_bf16 v[80:83],v[24:27],v[64:71],v1
v_smfmac_f32_16x16x64_bf16 v[80:83],v[40:43],v[64:71],v1
ds_read_b128 v[64:67],v7 offset:12288
ds_read_b128 v[68:71],v7 offset:13312
s_waitcnt lgkmcnt(6)
v_smfmac_f32_16x16x64_bf16 v[84:87],v[24:27],v[72:79],v1
v_smfmac_f32_16x16x64_bf16 v[84:87],v[40:43],v[72:79],v1
ds_read_b128 v[72:75],v7 offset:14336
ds_read_b128 v[76:79],v7 offset:15360
s_waitcnt lgkmcnt(6)
v_smfmac_f32_16x16x64_bf16 v[88:91],v[24:27],v[48:55],v1
v_smfmac_f32_16x16x64_bf16 v[88:91],v[40:43],v[48:55],v1
ds_read_b128 v[48:51],v7 offset:16384
ds_read_b128 v[52:55],v7 offset:17408
s_waitcnt lgkmcnt(6)
v_smfmac_f32_16x16x64_bf16 v[92:95],v[24:27],v[56:63],v1
v_smfmac_f32_16x16x64_bf16 v[92:95],v[40:43],v[56:63],v1
ds_read_b128 v[56:59],v7 offset:18432
ds_read_b128 v[60:63],v7 offset:19456
s_waitcnt lgkmcnt(6)
v_smfmac_f32_16x16x64_bf16 v[80:83],v[28:31],v[64:71],v1
v_smfmac_f32_16x16x64_bf16 v[80:83],v[44:47],v[64:71],v1
s_waitcnt lgkmcnt(4)
v_smfmac_f32_16x16x64_bf16 v[84:87],v[28:31],v[72:79],v1
v_smfmac_f32_16x16x64_bf16 v[84:87],v[44:47],v[72:79],v1
s_waitcnt lgkmcnt(2)
v_smfmac_f32_16x16x64_bf16 v[88:91],v[28:31],v[48:55],v1
v_add_f32 v80,v80,v81
v_smfmac_f32_16x16x64_bf16 v[88:91],v[44:47],v[48:55],v1
v_add_f32 v82,v82,v83
s_waitcnt lgkmcnt(0)
v_smfmac_f32_16x16x64_bf16 v[92:95],v[28:31],v[56:63],v1
v_cvt_pk_bf16_f32 v80,v80,v82
v_smfmac_f32_16x16x64_bf16 v[92:95],v[44:47],v[56:63],v1
ds_write_addtid_b32 v80 offset:16896
v_add_f32 v84,v84,v85
v_add_f32 v86,v86,v87
v_cvt_pk_bf16_f32 v84,v84,v86
v_add_f32 v88,v88,v89
v_add_f32 v90,v90,v91
v_cvt_pk_bf16_f32 v88,v88,v90
s_nop 0
v_add_f32 v92,v92,v93
v_add_f32 v94,v94,v95
v_cvt_pk_bf16_f32 v92,v92,v94
ds_write_addtid_b32 v84 offset:17920
ds_write_addtid_b32 v88 offset:18944
ds_write_addtid_b32 v92 offset:19968
s_waitcnt lgkmcnt(0)
s_barrier
s_cmp_gt_u32 s50,1
s_cbranch_scc1 l23_100684
ds_read2st64_b32 v[112:113],v127 offset0:66 offset1:67
ds_read2st64_b32 v[114:115],v127 offset0:68 offset1:69
ds_read2st64_b32 v[116:117],v127 offset0:70 offset1:71
ds_read2st64_b32 v[118:119],v127 offset0:72 offset1:73
s_waitcnt lgkmcnt(0)
v_mov_b32 v120,v5
v_mov_b32 v121,v5
v_mov_b32 v122,v5
v_mov_b32 v123,v5
s_nop 1
v_mfma_f32_16x16x32_bf16 v[112:115],v[120:123],v[112:115],0
v_mfma_f32_16x16x32_bf16 v[116:119],v[120:123],v[116:119],0
s_nop 4
v_cvt_pk_bf16_f32 v112,v112,v113
v_cvt_pk_bf16_f32 v113,v114,v115
s_nop 0
v_cvt_pk_bf16_f32 v114,v116,v117
v_cvt_pk_bf16_f32 v115,v118,v119
s_branch lj_100685
l23_100684:
ds_read_b128 v[48:51],v2 offset:0
ds_read_b128 v[52:55],v2 offset:256
ds_read_b128 v[56:59],v2 offset:512
ds_read_b128 v[60:63],v2 offset:768
ds_read_b128 v[64:67],v2 offset:16
ds_read_b128 v[68:71],v2 offset:272
ds_read_b128 v[72:75],v2 offset:528
ds_read_b128 v[76:79],v2 offset:784
s_waitcnt lgkmcnt(6)
v_pk_add_f32 v[48:49],v[48:49],v[52:53]
v_pk_add_f32 v[50:51],v[50:51],v[54:55]
s_waitcnt lgkmcnt(4)
v_pk_add_f32 v[56:57],v[56:57],v[60:61]
v_pk_add_f32 v[58:59],v[58:59],v[62:63]
v_pk_add_f32 v[48:49],v[48:49],v[56:57]
v_pk_add_f32 v[50:51],v[50:51],v[58:59]
v_cvt_pk_bf16_f32 v112,v48,v49
v_cvt_pk_bf16_f32 v113,v50,v51
s_waitcnt lgkmcnt(2)
v_pk_add_f32 v[64:65],v[64:65],v[68:69]
v_pk_add_f32 v[66:67],v[66:67],v[70:71]
s_waitcnt lgkmcnt(0)
v_pk_add_f32 v[72:73],v[72:73],v[76:77]
v_pk_add_f32 v[74:75],v[74:75],v[78:79]
v_pk_add_f32 v[64:65],v[64:65],v[72:73]
v_pk_add_f32 v[66:67],v[66:67],v[74:75]
v_cvt_pk_bf16_f32 v114,v64,v65
v_cvt_pk_bf16_f32 v115,v66,v67
lj_100685:
v_cndmask_b32 v120,2.0,v0,s[82:83]
v_cndmask_b32 v121,2.0,v127,s[86:87]
buffer_store_dwordx4 v[112:115],v120,s[20:23],s101 offen sc1
s_waitcnt vmcnt(0)
s_barrier
v_mov_b32 v126,64
buffer_store_dword v126,v121,s[20:23],s69 offen sc1
s_branch recfin_100192
flp_100594:
buffer_load_dword v124,off,s[20:23],s68 sc1
s_waitcnt vmcnt(0)
v_readfirstlane_b32 s91,v124
s_cmp_gt_u32 s91,s64
s_cbranch_scc1 fok_100593
s_sleep 2
s_sub_u32 s90,s90,1
s_cmp_gt_i32 s90,0
s_cbranch_scc1 flp_100594
s_branch fok_100593
flp_100597:
buffer_load_dword v124,off,s[20:23],s68 sc1
s_waitcnt vmcnt(0)
v_readfirstlane_b32 s91,v124
s_cmp_gt_u32 s91,s64
s_cbranch_scc1 fok_100596
s_sleep 2
s_sub_u32 s90,s90,1
s_cmp_gt_i32 s90,0
s_cbranch_scc1 flp_100597
s_branch fok_100596
fl_100614:
flb_100622:
buffer_load_dwordx4 v[16:19],v0,s[20:23],s92 offen offset:0 sc1
s_mov_b32 s55,1
buffer_load_dwordx4 v[32:35],v0,s[20:23],s93 offen offset:0 sc1
s_waitcnt vmcnt(4)
v_max3_u32 v124,v20,v21,v22
v_max_u32 v124,v124,v23
v_cmp_eq_u32 vcc,-1,v124
s_cbranch_vccnz dfl_100686
v_smfmac_f32_16x16x64_bf16 v[48:51],v[20:23],a[64:71],v1
buffer_load_dword v125,off,s[20:23],s92 sc1
v_smfmac_f32_16x16x64_bf16 v[52:55],v[20:23],a[72:79],v1
buffer_load_dwordx4 v[36:39],v0,s[20:23],s93 offen offset:1024 sc1
v_smfmac_f32_16x16x64_bf16 v[56:59],v[20:23],a[80:87],v1
s_waitcnt vmcnt(5)
v_max3_u32 v124,v24,v25,v26
v_smfmac_f32_16x16x64_bf16 v[60:63],v[20:23],a[88:95],v1
v_max_u32 v124,v124,v27
v_smfmac_f32_16x16x64_bf16 v[64:67],v[20:23],a[96:103],v1
v_cmp_eq_u32 vcc,-1,v124
v_smfmac_f32_16x16x64_bf16 v[68:71],v[20:23],a[104:111],v1
v_smfmac_f32_16x16x64_bf16 v[72:75],v[20:23],a[112:119],v1
v_smfmac_f32_16x16x64_bf16 v[76:79],v[20:23],a[120:127],v1
s_cbranch_vccnz dfl_100687
v_smfmac_f32_16x16x64_bf16 v[48:51],v[24:27],a[128:135],v1
buffer_load_dword v125,off,s[20:23],s92 sc1
v_smfmac_f32_16x16x64_bf16 v[52:55],v[24:27],a[136:143],v1
buffer_load_dwordx4 v[40:43],v0,s[20:23],s93 offen offset:2048 sc1
v_smfmac_f32_16x16x64_bf16 v[56:59],v[24:27],a[144:151],v1
buffer_load_dwordx4 v[44:47],v0,s[20:23],s93 offen offset:3072 sc1
s_waitcnt vmcnt(7)
v_max3_u32 v124,v28,v29,v30
v_smfmac_f32_16x16x64_bf16 v[60:63],v[24:27],a[152:159],v1
v_max_u32 v124,v124,v31
v_smfmac_f32_16x16x64_bf16 v[64:67],v[24:27],a[160:167],v1
v_cmp_eq_u32 vcc,-1,v124
v_smfmac_f32_16x16x64_bf16 v[68:71],v[24:27],a[168:175],v1
v_smfmac_f32_16x16x64_bf16 v[72:75],v[24:27],a[176:183],v1
v_smfmac_f32_16x16x64_bf16 v[76:79],v[24:27],a[184:191],v1
s_cbranch_vccnz dfl_100688
v_smfmac_f32_16x16x64_bf16 v[48:51],v[28:31],a[192:199],v1
buffer_load_dword v125,off,s[20:23],s92 sc1
v_smfmac_f32_16x16x64_bf16 v[52:55],v[28:31],a[200:207],v1
v_smfmac_f32_16x16x64_bf16 v[56:59],v[28:31],a[208:215],v1
s_waitcnt vmcnt(7)
v_max3_u32 v124,v16,v17,v18
v_smfmac_f32_16x16x64_bf16 v[60:63],v[28:31],a[216:223],v1
v_max_u32 v124,v124,v19
v_smfmac_f32_16x16x64_bf16 v[64:67],v[28:31],a[224:231],v1
v_cmp_eq_u32 vcc,-1,v124
v_smfmac_f32_16x16x64_bf16 v[68:71],v[28:31],a[232:239],v1
v_smfmac_f32_16x16x64_bf16 v[72:75],v[28:31],a[240:247],v1
v_smfmac_f32_16x16x64_bf16 v[76:79],v[28:31],a[248:255],v1
s_cbranch_vccnz lfb_100693
s_mov_b32 s55,0
v_smfmac_f32_16x16x64_bf16 v[48:51],v[16:19],a[0:7],v1
v_smfmac_f32_16x16x64_bf16 v[52:55],v[16:19],a[8:15],v1
v_smfmac_f32_16x16x64_bf16 v[56:59],v[16:19],a[16:23],v1
s_waitcnt vmcnt(6)
v_max3_u32 v124,v32,v33,v34
v_max_u32 v124,v124,v35
v_cmp_eq_u32 vcc,-1,v124
v_smfmac_f32_16x16x64_bf16 v[60:63],v[16:19],a[24:31],v1
v_smfmac_f32_16x16x64_bf16 v[64:67],v[16:19],a[32:39],v1
v_smfmac_f32_16x16x64_bf16 v[68:71],v[16:19],a[40:47],v1
v_smfmac_f32_16x16x64_bf16 v[72:75],v[16:19],a[48:55],v1
v_smfmac_f32_16x16x64_bf16 v[76:79],v[16:19],a[56:63],v1
s_cbranch_vccnz flb_100626
s_branch segb_100610
fl_100615:
v_smfmac_f32_16x16x64_bf16 v[76:79],v[16:19],a[56:63],v1
flb_100623:
buffer_load_dwordx4 v[20:23],v0,s[20:23],s92 offen offset:1024 sc1
s_mov_b32 s55,2
buffer_load_dwordx4 v[36:39],v0,s[20:23],s93 offen offset:1024 sc1
s_waitcnt vmcnt(5)
v_max3_u32 v124,v24,v25,v26
v_max_u32 v124,v124,v27
v_cmp_eq_u32 vcc,-1,v124
s_cbranch_vccnz dfl_100687
v_smfmac_f32_16x16x64_bf16 v[48:51],v[24:27],a[128:135],v1
buffer_load_dword v125,off,s[20:23],s92 sc1
v_smfmac_f32_16x16x64_bf16 v[52:55],v[24:27],a[136:143],v1
buffer_load_dwordx4 v[40:43],v0,s[20:23],s93 offen offset:2048 sc1
v_smfmac_f32_16x16x64_bf16 v[56:59],v[24:27],a[144:151],v1
buffer_load_dwordx4 v[44:47],v0,s[20:23],s93 offen offset:3072 sc1
s_waitcnt vmcnt(7)
v_max3_u32 v124,v28,v29,v30
v_smfmac_f32_16x16x64_bf16 v[60:63],v[24:27],a[152:159],v1
v_max_u32 v124,v124,v31
v_smfmac_f32_16x16x64_bf16 v[64:67],v[24:27],a[160:167],v1
v_cmp_eq_u32 vcc,-1,v124
v_smfmac_f32_16x16x64_bf16 v[68:71],v[24:27],a[168:175],v1
v_smfmac_f32_16x16x64_bf16 v[72:75],v[24:27],a[176:183],v1
v_smfmac_f32_16x16x64_bf16 v[76:79],v[24:27],a[184:191],v1
s_cbranch_vccnz dfl_100688
v_smfmac_f32_16x16x64_bf16 v[48:51],v[28:31],a[192:199],v1
buffer_load_dword v125,off,s[20:23],s92 sc1
v_smfmac_f32_16x16x64_bf16 v[52:55],v[28:31],a[200:207],v1
v_smfmac_f32_16x16x64_bf16 v[56:59],v[28:31],a[208:215],v1
s_waitcnt vmcnt(5)
v_max3_u32 v124,v20,v21,v22
v_smfmac_f32_16x16x64_bf16 v[60:63],v[28:31],a[216:223],v1
v_max_u32 v124,v124,v23
v_smfmac_f32_16x16x64_bf16 v[64:67],v[28:31],a[224:231],v1
v_cmp_eq_u32 vcc,-1,v124
v_smfmac_f32_16x16x64_bf16 v[68:71],v[28:31],a[232:239],v1
v_smfmac_f32_16x16x64_bf16 v[72:75],v[28:31],a[240:247],v1
v_smfmac_f32_16x16x64_bf16 v[76:79],v[28:31],a[248:255],v1
s_cbranch_vccnz lfb_100693
s_mov_b32 s55,0
v_smfmac_f32_16x16x64_bf16 v[48:51],v[20:23],a[64:71],v1
v_smfmac_f32_16x16x64_bf16 v[52:55],v[20:23],a[72:79],v1
v_smfmac_f32_16x16x64_bf16 v[56:59],v[20:23],a[80:87],v1
s_waitcnt vmcnt(6)
v_max3_u32 v124,v32,v33,v34
v_max_u32 v124,v124,v35
v_cmp_eq_u32 vcc,-1,v124
v_smfmac_f32_16x16x64_bf16 v[60:63],v[20:23],a[88:95],v1
v_smfmac_f32_16x16x64_bf16 v[64:67],v[20:23],a[96:103],v1
v_smfmac_f32_16x16x64_bf16 v[68:71],v[20:23],a[104:111],v1
v_smfmac_f32_16x16x64_bf16 v[72:75],v[20:23],a[112:119],v1
v_smfmac_f32_16x16x64_bf16 v[76:79],v[20:23],a[120:127],v1
s_cbranch_vccnz flb_100626
s_branch segb_100610
fl_100616:
v_smfmac_f32_16x16x64_bf16 v[76:79],v[20:23],a[120:127],v1
flb_100624:
buffer_load_dwordx4 v[24:27],v0,s[20:23],s92 offen offset:2048 sc1
s_mov_b32 s55,4
buffer_load_dwordx4 v[40:43],v0,s[20:23],s93 offen offset:2048 sc1
buffer_load_dwordx4 v[44:47],v0,s[20:23],s93 offen offset:3072 sc1
s_waitcnt vmcnt(7)
v_max3_u32 v124,v28,v29,v30
v_max_u32 v124,v124,v31
v_cmp_eq_u32 vcc,-1,v124
s_cbranch_vccnz dfl_100688
v_smfmac_f32_16x16x64_bf16 v[48:51],v[28:31],a[192:199],v1
buffer_load_dword v125,off,s[20:23],s92 sc1
v_smfmac_f32_16x16x64_bf16 v[52:55],v[28:31],a[200:207],v1
v_smfmac_f32_16x16x64_bf16 v[56:59],v[28:31],a[208:215],v1
s_waitcnt vmcnt(3)
v_max3_u32 v124,v24,v25,v26
v_smfmac_f32_16x16x64_bf16 v[60:63],v[28:31],a[216:223],v1
v_max_u32 v124,v124,v27
v_smfmac_f32_16x16x64_bf16 v[64:67],v[28:31],a[224:231],v1
v_cmp_eq_u32 vcc,-1,v124
v_smfmac_f32_16x16x64_bf16 v[68:71],v[28:31],a[232:239],v1
v_smfmac_f32_16x16x64_bf16 v[72:75],v[28:31],a[240:247],v1
v_smfmac_f32_16x16x64_bf16 v[76:79],v[28:31],a[248:255],v1
s_cbranch_vccnz lfb_100693
s_mov_b32 s55,0
v_smfmac_f32_16x16x64_bf16 v[48:51],v[24:27],a[128:135],v1
v_smfmac_f32_16x16x64_bf16 v[52:55],v[24:27],a[136:143],v1
v_smfmac_f32_16x16x64_bf16 v[56:59],v[24:27],a[144:151],v1
s_waitcnt vmcnt(6)
v_max3_u32 v124,v32,v33,v34
v_max_u32 v124,v124,v35
v_cmp_eq_u32 vcc,-1,v124
v_smfmac_f32_16x16x64_bf16 v[60:63],v[24:27],a[152:159],v1
v_smfmac_f32_16x16x64_bf16 v[64:67],v[24:27],a[160:167],v1
v_smfmac_f32_16x16x64_bf16 v[68:71],v[24:27],a[168:175],v1
v_smfmac_f32_16x16x64_bf16 v[72:75],v[24:27],a[176:183],v1
v_smfmac_f32_16x16x64_bf16 v[76:79],v[24:27],a[184:191],v1
s_cbranch_vccnz flb_100626
s_branch segb_100610
fl_100617:
v_smfmac_f32_16x16x64_bf16 v[76:79],v[24:27],a[184:191],v1
flb_100625:
buffer_load_dwordx4 v[28:31],v0,s[20:23],s92 offen offset:3072 sc1
s_mov_b32 s55,8
s_waitcnt vmcnt(0)
v_max3_u32 v124,v28,v29,v30
v_max_u32 v124,v124,v31
v_cmp_eq_u32 vcc,-1,v124
s_cbranch_vccnz lfb_100693
s_mov_b32 s55,0
v_smfmac_f32_16x16x64_bf16 v[48:51],v[28:31],a[192:199],v1
v_smfmac_f32_16x16x64_bf16 v[52:55],v[28:31],a[200:207],v1
v_smfmac_f32_16x16x64_bf16 v[56:59],v[28:31],a[208:215],v1
s_waitcnt vmcnt(6)
v_max3_u32 v124,v32,v33,v34
v_max_u32 v124,v124,v35
v_cmp_eq_u32 vcc,-1,v124
v_smfmac_f32_16x16x64_bf16 v[60:63],v[28:31],a[216:223],v1
v_smfmac_f32_16x16x64_bf16 v[64:67],v[28:31],a[224:231],v1
v_smfmac_f32_16x16x64_bf16 v[68:71],v[28:31],a[232:239],v1
v_smfmac_f32_16x16x64_bf16 v[72:75],v[28:31],a[240:247],v1
v_smfmac_f32_16x16x64_bf16 v[76:79],v[28:31],a[248:255],v1
s_cbranch_vccnz flb_100626
s_branch segb_100610
fl_100618:
v_smfmac_f32_16x16x64_bf16 v[76:79],v[28:31],a[248:255],v1
flb_100626:
buffer_load_dwordx4 v[32:35],v0,s[20:23],s93 offen offset:0 sc1
s_mov_b32 s55,240
buffer_store_dwordx4 v[112:115],v120,s[20:23],s101 offen sc1
buffer_store_dword v126,v121,s[20:23],s69 offen sc1
s_bitcmp1_b32 s55,5
s_cbranch_scc0 rdn_100696
s_waitcnt vmcnt(7)
v_max3_u32 v124,v36,v37,v38
v_max_u32 v124,v124,v39
v_cmp_eq_u32 vcc,-1,v124
s_cbranch_vccnz rfa_100697
buffer_load_dword v125,off,s[20:23],s92 sc1
s_bitset0_b32 s55,5
v_smfmac_f32_16x16x64_bf16 v[48:51],v[36:39],a[64:71],v1
v_smfmac_f32_16x16x64_bf16 v[52:55],v[36:39],a[72:79],v1
v_smfmac_f32_16x16x64_bf16 v[56:59],v[36:39],a[80:87],v1
v_smfmac_f32_16x16x64_bf16 v[60:63],v[36:39],a[88:95],v1
v_smfmac_f32_16x16x64_bf16 v[64:67],v[36:39],a[96:103],v1
v_smfmac_f32_16x16x64_bf16 v[68:71],v[36:39],a[104:111],v1
v_smfmac_f32_16x16x64_bf16 v[72:75],v[36:39],a[112:119],v1
v_smfmac_f32_16x16x64_bf16 v[76:79],v[36:39],a[120:127],v1
s_cmp_eq_u32 s55,0
s_cbranch_scc1 segb_100612
s_branch rnx_100698
rdn_100696:
buffer_load_dword v125,off,s[20:23],s92 sc1
s_branch rnx_100698
rfa_100697:
buffer_load_dwordx4 v[36:39],v0,s[20:23],s93 offen offset:1024 sc1
rnx_100698:
s_bitcmp1_b32 s55,6
s_cbranch_scc0 rdn_100699
s_waitcnt vmcnt(6)
v_max3_u32 v124,v40,v41,v42
v_max_u32 v124,v124,v43
v_cmp_eq_u32 vcc,-1,v124
s_cbranch_vccnz rfa_100700
buffer_load_dword v125,off,s[20:23],s92 sc1
s_bitset0_b32 s55,6
s_cmp_eq_u32 s55,0
s_cbranch_scc1 segb_100612
s_branch rnx_100701
rdn_100699:
buffer_load_dword v125,off,s[20:23],s92 sc1
s_branch rnx_100701
rfa_100700:
buffer_load_dwordx4 v[40:43],v0,s[20:23],s93 offen offset:2048 sc1
rnx_100701:
s_bitcmp1_b32 s55,7
s_cbranch_scc0 rdn_100702
s_waitcnt vmcnt(6)
v_max3_u32 v124,v44,v45,v46
v_max_u32 v124,v124,v47
v_cmp_eq_u32 vcc,-1,v124
s_cbranch_vccnz rfa_100703
buffer_load_dword v125,off,s[20:23],s92 sc1
s_bitset0_b32 s55,7
s_cmp_eq_u32 s55,0
s_cbranch_scc1 segb_100612
s_branch rnx_100704
rdn_100702:
buffer_load_dword v125,off,s[20:23],s92 sc1
s_branch rnx_100704
rfa_100703:
buffer_load_dwordx4 v[44:47],v0,s[20:23],s93 offen offset:3072 sc1
rnx_100704:
rot_100695:
s_bitcmp1_b32 s55,4
s_cbranch_scc0 rdn_100705
s_waitcnt vmcnt(3)
v_max3_u32 v124,v32,v33,v34
v_max_u32 v124,v124,v35
v_cmp_eq_u32 vcc,-1,v124
s_cbranch_vccnz rfa_100706
buffer_load_dword v125,off,s[20:23],s92 sc1
s_bitset0_b32 s55,4
v_smfmac_f32_16x16x64_bf16 v[48:51],v[32:35],a[0:7],v1
v_smfmac_f32_16x16x64_bf16 v[52:55],v[32:35],a[8:15],v1
v_smfmac_f32_16x16x64_bf16 v[56:59],v[32:35],a[16:23],v1
v_smfmac_f32_16x16x64_bf16 v[60:63],v[32:35],a[24:31],v1
v_smfmac_f32_16x16x64_bf16 v[64:67],v[32:35],a[32:39],v1
v_smfmac_f32_16x16x64_bf16 v[68:71],v[32:35],a[40:47],v1
v_smfmac_f32_16x16x64_bf16 v[72:75],v[32:35],a[48:55],v1
v_smfmac_f32_16x16x64_bf16 v[76:79],v[32:35],a[56:63],v1
s_cmp_eq_u32 s55,0
s_cbranch_scc1 segb_100612
s_branch rnx_100707
rdn_100705:
buffer_load_dword v125,off,s[20:23],s92 sc1
s_branch rnx_100707
rfa_100706:
buffer_load_dwordx4 v[32:35],v0,s[20:23],s93 offen offset:0 sc1
rnx_100707:
s_bitcmp1_b32 s55,5
s_cbranch_scc0 rdn_100708
s_waitcnt vmcnt(3)
v_max3_u32 v124,v36,v37,v38
v_max_u32 v124,v124,v39
v_cmp_eq_u32 vcc,-1,v124
s_cbranch_vccnz rfa_100709
buffer_load_dword v125,off,s[20:23],s92 sc1
s_bitset0_b32 s55,5
v_smfmac_f32_16x16x64_bf16 v[48:51],v[36:39],a[64:71],v1
v_smfmac_f32_16x16x64_bf16 v[52:55],v[36:39],a[72:79],v1
v_smfmac_f32_16x16x64_bf16 v[56:59],v[36:39],a[80:87],v1
v_smfmac_f32_16x16x64_bf16 v[60:63],v[36:39],a[88:95],v1
v_smfmac_f32_16x16x64_bf16 v[64:67],v[36:39],a[96:103],v1
v_smfmac_f32_16x16x64_bf16 v[68:71],v[36:39],a[104:111],v1
v_smfmac_f32_16x16x64_bf16 v[72:75],v[36:39],a[112:119],v1
v_smfmac_f32_16x16x64_bf16 v[76:79],v[36:39],a[120:127],v1
s_cmp_eq_u32 s55,0
s_cbranch_scc1 segb_100612
s_branch rnx_100710
rdn_100708:
buffer_load_dword v125,off,s[20:23],s92 sc1
s_branch rnx_100710
rfa_100709:
buffer_load_dwordx4 v[36:39],v0,s[20:23],s93 offen offset:1024 sc1
rnx_100710:
s_bitcmp1_b32 s55,6
s_cbranch_scc0 rdn_100711
s_waitcnt vmcnt(3)
v_max3_u32 v124,v40,v41,v42
v_max_u32 v124,v124,v43
v_cmp_eq_u32 vcc,-1,v124
s_cbranch_vccnz rfa_100712
buffer_load_dword v125,off,s[20:23],s92 sc1
s_bitset0_b32 s55,6
s_cmp_eq_u32 s55,0
s_cbranch_scc1 segb_100612
s_branch rnx_100713
rdn_100711:
buffer_load_dword v125,off,s[20:23],s92 sc1
s_branch rnx_100713
rfa_100712:
buffer_load_dwordx4 v[40:43],v0,s[20:23],s93 offen offset:2048 sc1
rnx_100713:
s_bitcmp1_b32 s55,7
s_cbranch_scc0 rdn_100714
s_waitcnt vmcnt(3)
v_max3_u32 v124,v44,v45,v46
v_max_u32 v124,v124,v47
v_cmp_eq_u32 vcc,-1,v124
s_cbranch_vccnz rfa_100715
buffer_load_dword v125,off,s[20:23],s92 sc1
s_bitset0_b32 s55,7
s_cmp_eq_u32 s55,0
s_cbranch_scc1 segb_100612
s_branch rnx_100716
rdn_100714:
buffer_load_dword v125,off,s[20:23],s92 sc1
s_branch rnx_100716
rfa_100715:
buffer_load_dwordx4 v[44:47],v0,s[20:23],s93 offen offset:3072 sc1
rnx_100716:
s_sub_u32 s90,s90,1
s_cmp_gt_i32 s90,0
s_cbranch_scc1 rot_100695
s_mov_b32 s55,0
s_branch segb_100612
fl_100619:
v_smfmac_f32_16x16x64_bf16 v[76:79],v[32:35],a[56:63],v1
flb_100627:
buffer_load_dwordx4 v[36:39],v0,s[20:23],s93 offen offset:1024 sc1
s_mov_b32 s55,224
s_bitcmp1_b32 s55,6
s_cbranch_scc0 rdn_100718
s_waitcnt vmcnt(6)
v_max3_u32 v124,v40,v41,v42
v_max_u32 v124,v124,v43
v_cmp_eq_u32 vcc,-1,v124
s_cbranch_vccnz rfa_100719
buffer_load_dword v125,off,s[20:23],s92 sc1
s_bitset0_b32 s55,6
s_cmp_eq_u32 s55,0
s_cbranch_scc1 segb_100612
s_branch rnx_100720
rdn_100718:
buffer_load_dword v125,off,s[20:23],s92 sc1
s_branch rnx_100720
rfa_100719:
buffer_load_dwordx4 v[40:43],v0,s[20:23],s93 offen offset:2048 sc1
rnx_100720:
s_bitcmp1_b32 s55,7
s_cbranch_scc0 rdn_100721
s_waitcnt vmcnt(6)
v_max3_u32 v124,v44,v45,v46
v_max_u32 v124,v124,v47
v_cmp_eq_u32 vcc,-1,v124
s_cbranch_vccnz rfa_100722
buffer_load_dword v125,off,s[20:23],s92 sc1
s_bitset0_b32 s55,7
s_cmp_eq_u32 s55,0
s_cbranch_scc1 segb_100612
s_branch rnx_100723
rdn_100721:
buffer_load_dword v125,off,s[20:23],s92 sc1
s_branch rnx_100723
rfa_100722:
buffer_load_dwordx4 v[44:47],v0,s[20:23],s93 offen offset:3072 sc1
rnx_100723:
rot_100717:
s_bitcmp1_b32 s55,5
s_cbranch_scc0 rdn_100724
s_waitcnt vmcnt(2)
v_max3_u32 v124,v36,v37,v38
v_max_u32 v124,v124,v39
v_cmp_eq_u32 vcc,-1,v124
s_cbranch_vccnz rfa_100725
buffer_load_dword v125,off,s[20:23],s92 sc1
s_bitset0_b32 s55,5
v_smfmac_f32_16x16x64_bf16 v[48:51],v[36:39],a[64:71],v1
v_smfmac_f32_16x16x64_bf16 v[52:55],v[36:39],a[72:79],v1
v_smfmac_f32_16x16x64_bf16 v[56:59],v[36:39],a[80:87],v1
v_smfmac_f32_16x16x64_bf16 v[60:63],v[36:39],a[88:95],v1
v_smfmac_f32_16x16x64_bf16 v[64:67],v[36:39],a[96:103],v1
v_smfmac_f32_16x16x64_bf16 v[68:71],v[36:39],a[104:111],v1
v_smfmac_f32_16x16x64_bf16 v[72:75],v[36:39],a[112:119],v1
v_smfmac_f32_16x16x64_bf16 v[76:79],v[36:39],a[120:127],v1
s_cmp_eq_u32 s55,0
s_cbranch_scc1 segb_100612
s_branch rnx_100726
rdn_100724:
buffer_load_dword v125,off,s[20:23],s92 sc1
s_branch rnx_100726
rfa_100725:
buffer_load_dwordx4 v[36:39],v0,s[20:23],s93 offen offset:1024 sc1
rnx_100726:
s_bitcmp1_b32 s55,6
s_cbranch_scc0 rdn_100727
s_waitcnt vmcnt(2)
v_max3_u32 v124,v40,v41,v42
v_max_u32 v124,v124,v43
v_cmp_eq_u32 vcc,-1,v124
s_cbranch_vccnz rfa_100728
buffer_load_dword v125,off,s[20:23],s92 sc1
s_bitset0_b32 s55,6
s_cmp_eq_u32 s55,0
s_cbranch_scc1 segb_100612
s_branch rnx_100729
rdn_100727:
buffer_load_dword v125,off,s[20:23],s92 sc1
s_branch rnx_100729
rfa_100728:
buffer_load_dwordx4 v[40:43],v0,s[20:23],s93 offen offset:2048 sc1
rnx_100729:
s_bitcmp1_b32 s55,7
s_cbranch_scc0 rdn_100730
s_waitcnt vmcnt(2)
v_max3_u32 v124,v44,v45,v46
v_max_u32 v124,v124,v47
v_cmp_eq_u32 vcc,-1,v124
s_cbranch_vccnz rfa_100731
buffer_load_dword v125,off,s[20:23],s92 sc1
s_bitset0_b32 s55,7
s_cmp_eq_u32 s55,0
s_cbranch_scc1 segb_100612
s_branch rnx_100732
rdn_100730:
buffer_load_dword v125,off,s[20:23],s92 sc1
s_branch rnx_100732
rfa_100731:
buffer_load_dwordx4 v[44:47],v0,s[20:23],s93 offen offset:3072 sc1
rnx_100732:
s_sub_u32 s90,s90,1
s_cmp_gt_i32 s90,0
s_cbranch_scc1 rot_100717
s_mov_b32 s55,0
s_branch segb_100612
fl_100620:
v_smfmac_f32_16x16x64_bf16 v[76:79],v[36:39],a[120:127],v1
flb_100628:
s_mov_b32 s55,192
s_bitcmp1_b32 s55,6
s_cbranch_scc0 rdn_100734
s_waitcnt vmcnt(6)
v_max3_u32 v124,v40,v41,v42
v_max_u32 v124,v124,v43
v_cmp_eq_u32 vcc,-1,v124
s_cbranch_vccnz rfa_100735
buffer_load_dword v125,off,s[20:23],s92 sc1
s_bitset0_b32 s55,6
s_cmp_eq_u32 s55,0
s_cbranch_scc1 segb_100612
s_branch rnx_100736
rdn_100734:
buffer_load_dword v125,off,s[20:23],s92 sc1
s_branch rnx_100736
rfa_100735:
buffer_load_dwordx4 v[40:43],v0,s[20:23],s93 offen offset:2048 sc1
rnx_100736:
s_bitcmp1_b32 s55,7
s_cbranch_scc0 rdn_100737
s_waitcnt vmcnt(6)
v_max3_u32 v124,v44,v45,v46
v_max_u32 v124,v124,v47
v_cmp_eq_u32 vcc,-1,v124
s_cbranch_vccnz rfa_100738
buffer_load_dword v125,off,s[20:23],s92 sc1
s_bitset0_b32 s55,7
s_cmp_eq_u32 s55,0
s_cbranch_scc1 segb_100612
s_branch rnx_100739
rdn_100737:
buffer_load_dword v125,off,s[20:23],s92 sc1
s_branch rnx_100739
rfa_100738:
buffer_load_dwordx4 v[44:47],v0,s[20:23],s93 offen offset:3072 sc1
rnx_100739:
rot_100733:
s_bitcmp1_b32 s55,6
s_cbranch_scc0 rdn_100740
s_waitcnt vmcnt(1)
v_max3_u32 v124,v40,v41,v42
v_max_u32 v124,v124,v43
v_cmp_eq_u32 vcc,-1,v124
s_cbranch_vccnz rfa_100741
buffer_load_dword v125,off,s[20:23],s92 sc1
s_bitset0_b32 s55,6
s_cmp_eq_u32 s55,0
s_cbranch_scc1 segb_100612
s_branch rnx_100742
rdn_100740:
buffer_load_dword v125,off,s[20:23],s92 sc1
s_branch rnx_100742
rfa_100741:
buffer_load_dwordx4 v[40:43],v0,s[20:23],s93 offen offset:2048 sc1
rnx_100742:
s_bitcmp1_b32 s55,7
s_cbranch_scc0 rdn_100743
s_waitcnt vmcnt(1)
v_max3_u32 v124,v44,v45,v46
v_max_u32 v124,v124,v47
v_cmp_eq_u32 vcc,-1,v124
s_cbranch_vccnz rfa_100744
buffer_load_dword v125,off,s[20:23],s92 sc1
s_bitset0_b32 s55,7
s_cmp_eq_u32 s55,0
s_cbranch_scc1 segb_100612
s_branch rnx_100745
rdn_100743:
buffer_load_dword v125,off,s[20:23],s92 sc1
s_branch rnx_100745
rfa_100744:
buffer_load_dwordx4 v[44:47],v0,s[20:23],s93 offen offset:3072 sc1
rnx_100745:
s_sub_u32 s90,s90,1
s_cmp_gt_i32 s90,0
s_cbranch_scc1 rot_100733
s_mov_b32 s55,0
s_branch segb_100612
dfl_100686:
buffer_load_dwordx4 v[20:23],v0,s[20:23],s92 offen offset:1024 sc1
s_bitset1_b32 s55,1
buffer_load_dwordx4 v[36:39],v0,s[20:23],s93 offen offset:1024 sc1
s_waitcnt vmcnt(5)
v_max3_u32 v124,v24,v25,v26
v_max_u32 v124,v124,v27
v_cmp_eq_u32 vcc,-1,v124
s_cbranch_vccnz dfl_100687
s_branch dseg_100690
dfl_100687:
buffer_load_dwordx4 v[24:27],v0,s[20:23],s92 offen offset:2048 sc1
s_bitset1_b32 s55,2
buffer_load_dwordx4 v[40:43],v0,s[20:23],s93 offen offset:2048 sc1
buffer_load_dwordx4 v[44:47],v0,s[20:23],s93 offen offset:3072 sc1
s_waitcnt vmcnt(7)
v_max3_u32 v124,v28,v29,v30
v_max_u32 v124,v124,v31
v_cmp_eq_u32 vcc,-1,v124
s_cbranch_vccnz dfl_100688
s_branch dseg_100691
dfl_100688:
buffer_load_dwordx4 v[28:31],v0,s[20:23],s92 offen offset:3072 sc1
s_bitset1_b32 s55,3
s_branch lap2_100692
dseg_100690:
v_smfmac_f32_16x16x64_bf16 v[48:51],v[24:27],a[128:135],v1
buffer_load_dword v125,off,s[20:23],s92 sc1
v_smfmac_f32_16x16x64_bf16 v[52:55],v[24:27],a[136:143],v1
buffer_load_dwordx4 v[40:43],v0,s[20:23],s93 offen offset:2048 sc1
v_smfmac_f32_16x16x64_bf16 v[56:59],v[24:27],a[144:151],v1
buffer_load_dwordx4 v[44:47],v0,s[20:23],s93 offen offset:3072 sc1
s_waitcnt vmcnt(7)
v_max3_u32 v124,v28,v29,v30
v_smfmac_f32_16x16x64_bf16 v[60:63],v[24:27],a[152:159],v1
v_max_u32 v124,v124,v31
v_smfmac_f32_16x16x64_bf16 v[64:67],v[24:27],a[160:167],v1
v_cmp_eq_u32 vcc,-1,v124
v_smfmac_f32_16x16x64_bf16 v[68:71],v[24:27],a[168:175],v1
v_smfmac_f32_16x16x64_bf16 v[72:75],v[24:27],a[176:183],v1
v_smfmac_f32_16x16x64_bf16 v[76:79],v[24:27],a[184:191],v1
s_cbranch_vccnz dfl_100688
dseg_100691:
v_smfmac_f32_16x16x64_bf16 v[48:51],v[28:31],a[192:199],v1
buffer_load_dword v125,off,s[20:23],s92 sc1
v_smfmac_f32_16x16x64_bf16 v[52:55],v[28:31],a[200:207],v1
v_smfmac_f32_16x16x64_bf16 v[56:59],v[28:31],a[208:215],v1
v_smfmac_f32_16x16x64_bf16 v[60:63],v[28:31],a[216:223],v1
v_smfmac_f32_16x16x64_bf16 v[64:67],v[28:31],a[224:231],v1
v_smfmac_f32_16x16x64_bf16 v[68:71],v[28:31],a[232:239],v1
v_smfmac_f32_16x16x64_bf16 v[72:75],v[28:31],a[240:247],v1
v_smfmac_f32_16x16x64_bf16 v[76:79],v[28:31],a[248:255],v1
lap2_100692:
s_bitcmp1_b32 s55,0
s_cbranch_scc0 l2s_100746
s_waitcnt vmcnt(7)
v_max3_u32 v124,v16,v17,v18
v_max_u32 v124,v124,v19
v_cmp_eq_u32 vcc,-1,v124
s_cbranch_vccnz l2s_100746
s_bitset0_b32 s55,0
v_smfmac_f32_16x16x64_bf16 v[48:51],v[16:19],a[0:7],v1
v_smfmac_f32_16x16x64_bf16 v[52:55],v[16:19],a[8:15],v1
v_smfmac_f32_16x16x64_bf16 v[56:59],v[16:19],a[16:23],v1
v_smfmac_f32_16x16x64_bf16 v[60:63],v[16:19],a[24:31],v1
v_smfmac_f32_16x16x64_bf16 v[64:67],v[16:19],a[32:39],v1
v_smfmac_f32_16x16x64_bf16 v[68:71],v[16:19],a[40:47],v1
v_smfmac_f32_16x16x64_bf16 v[72:75],v[16:19],a[48:55],v1
v_smfmac_f32_16x16x64_bf16 v[76:79],v[16:19],a[56:63],v1
l2s_100746:
s_bitcmp1_b32 s55,1
s_cbranch_scc0 l2s_100748
s_waitcnt vmcnt(5)
v_max3_u32 v124,v20,v21,v22
v_max_u32 v124,v124,v23
v_cmp_eq_u32 vcc,-1,v124
s_cbranch_vccnz l2s_100748
s_bitset0_b32 s55,1
v_smfmac_f32_16x16x64_bf16 v[48:51],v[20:23],a[64:71],v1
v_smfmac_f32_16x16x64_bf16 v[52:55],v[20:23],a[72:79],v1
v_smfmac_f32_16x16x64_bf16 v[56:59],v[20:23],a[80:87],v1
v_smfmac_f32_16x16x64_bf16 v[60:63],v[20:23],a[88:95],v1
v_smfmac_f32_16x16x64_bf16 v[64:67],v[20:23],a[96:103],v1
v_smfmac_f32_16x16x64_bf16 v[68:71],v[20:23],a[104:111],v1
v_smfmac_f32_16x16x64_bf16 v[72:75],v[20:23],a[112:119],v1
v_smfmac_f32_16x16x64_bf16 v[76:79],v[20:23],a[120:127],v1
l2s_100748:
s_bitcmp1_b32 s55,2
s_cbranch_scc0 l2s_100750
s_waitcnt vmcnt(3)
v_max3_u32 v124,v24,v25,v26
v_max_u32 v124,v124,v27
v_cmp_eq_u32 vcc,-1,v124
s_cbranch_vccnz l2s_100750
s_bitset0_b32 s55,2
v_smfmac_f32_16x16x64_bf16 v[48:51],v[24:27],a[128:135],v1
v_smfmac_f32_16x16x64_bf16 v[52:55],v[24:27],a[136:143],v1
v_smfmac_f32_16x16x64_bf16 v[56:59],v[24:27],a[144:151],v1
v_smfmac_f32_16x16x64_bf16 v[60:63],v[24:27],a[152:159],v1
v_smfmac_f32_16x16x64_bf16 v[64:67],v[24:27],a[160:167],v1
v_smfmac_f32_16x16x64_bf16 v[68:71],v[24:27],a[168:175],v1
v_smfmac_f32_16x16x64_bf16 v[72:75],v[24:27],a[176:183],v1
v_smfmac_f32_16x16x64_bf16 v[76:79],v[24:27],a[184:191],v1
l2s_100750:
s_bitcmp1_b32 s55,3
s_cbranch_scc0 l2s_100752
s_waitcnt vmcnt(0)
v_max3_u32 v124,v28,v29,v30
v_max_u32 v124,v124,v31
v_cmp_eq_u32 vcc,-1,v124
s_cbranch_vccnz l2s_100752
s_bitset0_b32 s55,3
v_smfmac_f32_16x16x64_bf16 v[48:51],v[28:31],a[192:199],v1
v_smfmac_f32_16x16x64_bf16 v[52:55],v[28:31],a[200:207],v1
v_smfmac_f32_16x16x64_bf16 v[56:59],v[28:31],a[208:215],v1
v_smfmac_f32_16x16x64_bf16 v[60:63],v[28:31],a[216:223],v1
v_smfmac_f32_16x16x64_bf16 v[64:67],v[28:31],a[224:231],v1
v_smfmac_f32_16x16x64_bf16 v[68:71],v[28:31],a[232:239],v1
v_smfmac_f32_16x16x64_bf16 v[72:75],v[28:31],a[240:247],v1
v_smfmac_f32_16x16x64_bf16 v[76:79],v[28:31],a[248:255],v1
l2s_100752:
s_cmp_eq_u32 s55,0
s_cbranch_scc0 lfb_100693
Ldone_100694:
s_waitcnt vmcnt(6)
v_max3_u32 v124,v32,v33,v34
v_max_u32 v124,v124,v35
v_cmp_eq_u32 vcc,-1,v124
s_cbranch_vccnz flb_100626
s_branch segb_100610
lfb_100693:
s_bitcmp1_b32 s55,0
s_cbranch_scc0 dsk_100754
buffer_load_dwordx4 v[16:19],v0,s[20:23],s92 offen offset:0 sc1
dsk_100754:
s_bitcmp1_b32 s55,1
s_cbranch_scc0 dsk_100755
buffer_load_dwordx4 v[20:23],v0,s[20:23],s92 offen offset:1024 sc1
dsk_100755:
s_bitcmp1_b32 s55,2
s_cbranch_scc0 dsk_100756
buffer_load_dwordx4 v[24:27],v0,s[20:23],s92 offen offset:2048 sc1
dsk_100756:
s_bitcmp1_b32 s55,3
s_cbranch_scc0 dsk_100757
buffer_load_dwordx4 v[28:31],v0,s[20:23],s92 offen offset:3072 sc1
dsk_100757:
s_bitcmp1_b32 s55,0
s_cbranch_scc0 dsk_100758
s_waitcnt vmcnt(2)
v_max3_u32 v124,v16,v17,v18
v_max_u32 v124,v124,v19
v_cmp_eq_u32 vcc,-1,v124
s_cbranch_vccz dgo_100759
s_nop 15
buffer_load_dwordx4 v[104:107],v0,s[20:23],s92 offen offset:0 sc1
s_nop 15
buffer_load_dwordx4 v[108:111],v0,s[20:23],s92 offen offset:0 sc1
dlp_100760:
s_waitcnt vmcnt(2)
v_max3_u32 v124,v16,v17,v18
v_max_u32 v124,v124,v19
v_cmp_eq_u32 vcc,-1,v124
s_cbranch_vccz dgo_100759
buffer_load_dwordx4 v[16:19],v0,s[20:23],s92 offen offset:0 sc1
s_waitcnt vmcnt(2)
v_max3_u32 v124,v104,v105,v106
v_max_u32 v124,v124,v107
v_cmp_eq_u32 vcc,-1,v124
s_cbranch_vccz dcp_100762
buffer_load_dwordx4 v[104:107],v0,s[20:23],s92 offen offset:0 sc1
s_waitcnt vmcnt(2)
v_max3_u32 v124,v108,v109,v110
v_max_u32 v124,v124,v111
v_cmp_eq_u32 vcc,-1,v124
s_cbranch_vccz dcp_100763
buffer_load_dwordx4 v[108:111],v0,s[20:23],s92 offen offset:0 sc1
s_sub_u32 s90,s90,1
s_cmp_gt_i32 s90,0
s_cbranch_scc1 dlp_100760
s_branch dgo_100759
dcp_100762:
v_mov_b32 v16,v104
v_mov_b32 v17,v105
v_mov_b32 v18,v106
v_mov_b32 v19,v107
s_nop 1
s_branch dgo_100759
dcp_100763:
v_mov_b32 v16,v108
v_mov_b32 v17,v109
v_mov_b32 v18,v110
v_mov_b32 v19,v111
s_nop 1
dgo_100759:
v_smfmac_f32_16x16x64_bf16 v[48:51],v[16:19],a[0:7],v1
v_smfmac_f32_16x16x64_bf16 v[52:55],v[16:19],a[8:15],v1
v_smfmac_f32_16x16x64_bf16 v[56:59],v[16:19],a[16:23],v1
v_smfmac_f32_16x16x64_bf16 v[60:63],v[16:19],a[24:31],v1
v_smfmac_f32_16x16x64_bf16 v[64:67],v[16:19],a[32:39],v1
v_smfmac_f32_16x16x64_bf16 v[68:71],v[16:19],a[40:47],v1
v_smfmac_f32_16x16x64_bf16 v[72:75],v[16:19],a[48:55],v1
v_smfmac_f32_16x16x64_bf16 v[76:79],v[16:19],a[56:63],v1
dsk_100758:
s_bitcmp1_b32 s55,1
s_cbranch_scc0 dsk_100764
s_waitcnt vmcnt(2)
v_max3_u32 v124,v20,v21,v22
v_max_u32 v124,v124,v23
v_cmp_eq_u32 vcc,-1,v124
s_cbranch_vccz dgo_100765
s_nop 15
buffer_load_dwordx4 v[104:107],v0,s[20:23],s92 offen offset:1024 sc1
s_nop 15
buffer_load_dwordx4 v[108:111],v0,s[20:23],s92 offen offset:1024 sc1
dlp_100766:
s_waitcnt vmcnt(2)
v_max3_u32 v124,v20,v21,v22
v_max_u32 v124,v124,v23
v_cmp_eq_u32 vcc,-1,v124
s_cbranch_vccz dgo_100765
buffer_load_dwordx4 v[20:23],v0,s[20:23],s92 offen offset:1024 sc1
s_waitcnt vmcnt(2)
v_max3_u32 v124,v104,v105,v106
v_max_u32 v124,v124,v107
v_cmp_eq_u32 vcc,-1,v124
s_cbranch_vccz dcp_100768
buffer_load_dwordx4 v[104:107],v0,s[20:23],s92 offen offset:1024 sc1
s_waitcnt vmcnt(2)
v_max3_u32 v124,v108,v109,v110
v_max_u32 v124,v124,v111
v_cmp_eq_u32 vcc,-1,v124
s_cbranch_vccz dcp_100769
buffer_load_dwordx4 v[108:111],v0,s[20:23],s92 offen offset:1024 sc1
s_sub_u32 s90,s90,1
s_cmp_gt_i32 s90,0
s_cbranch_scc1 dlp_100766
s_branch dgo_100765
dcp_100768:
v_mov_b32 v20,v104
v_mov_b32 v21,v105
v_mov_b32 v22,v106
v_mov_b32 v23,v107
s_nop 1
s_branch dgo_100765
dcp_100769:
v_mov_b32 v20,v108
v_mov_b32 v21,v109
v_mov_b32 v22,v110
v_mov_b32 v23,v111
s_nop 1
dgo_100765:
v_smfmac_f32_16x16x64_bf16 v[48:51],v[20:23],a[64:71],v1
v_smfmac_f32_16x16x64_bf16 v[52:55],v[20:23],a[72:79],v1
v_smfmac_f32_16x16x64_bf16 v[56:59],v[20:23],a[80:87],v1
v_smfmac_f32_16x16x64_bf16 v[60:63],v[20:23],a[88:95],v1
v_smfmac_f32_16x16x64_bf16 v[64:67],v[20:23],a[96:103],v1
v_smfmac_f32_16x16x64_bf16 v[68:71],v[20:23],a[104:111],v1
v_smfmac_f32_16x16x64_bf16 v[72:75],v[20:23],a[112:119],v1
v_smfmac_f32_16x16x64_bf16 v[76:79],v[20:23],a[120:127],v1
dsk_100764:
s_bitcmp1_b32 s55,2
s_cbranch_scc0 dsk_100770
s_waitcnt vmcnt(2)
v_max3_u32 v124,v24,v25,v26
v_max_u32 v124,v124,v27
v_cmp_eq_u32 vcc,-1,v124
s_cbranch_vccz dgo_100771
s_nop 15
buffer_load_dwordx4 v[104:107],v0,s[20:23],s92 offen offset:2048 sc1
s_nop 15
buffer_load_dwordx4 v[108:111],v0,s[20:23],s92 offen offset:2048 sc1
dlp_100772:
s_waitcnt vmcnt(2)
v_max3_u32 v124,v24,v25,v26
v_max_u32 v124,v124,v27
v_cmp_eq_u32 vcc,-1,v124
s_cbranch_vccz dgo_100771
buffer_load_dwordx4 v[24:27],v0,s[20:23],s92 offen offset:2048 sc1
s_waitcnt vmcnt(2)
v_max3_u32 v124,v104,v105,v106
v_max_u32 v124,v124,v107
v_cmp_eq_u32 vcc,-1,v124
s_cbranch_vccz dcp_100774
buffer_load_dwordx4 v[104:107],v0,s[20:23],s92 offen offset:2048 sc1
s_waitcnt vmcnt(2)
v_max3_u32 v124,v108,v109,v110
v_max_u32 v124,v124,v111
v_cmp_eq_u32 vcc,-1,v124
s_cbranch_vccz dcp_100775
buffer_load_dwordx4 v[108:111],v0,s[20:23],s92 offen offset:2048 sc1
s_sub_u32 s90,s90,1
s_cmp_gt_i32 s90,0
s_cbranch_scc1 dlp_100772
s_branch dgo_100771
dcp_100774:
v_mov_b32 v24,v104
v_mov_b32 v25,v105
v_mov_b32 v26,v106
v_mov_b32 v27,v107
s_nop 1
s_branch dgo_100771
dcp_100775:
v_mov_b32 v24,v108
v_mov_b32 v25,v109
v_mov_b32 v26,v110
v_mov_b32 v27,v111
s_nop 1
dgo_100771:
v_smfmac_f32_16x16x64_bf16 v[48:51],v[24:27],a[128:135],v1
v_smfmac_f32_16x16x64_bf16 v[52:55],v[24:27],a[136:143],v1
v_smfmac_f32_16x16x64_bf16 v[56:59],v[24:27],a[144:151],v1
v_smfmac_f32_16x16x64_bf16 v[60:63],v[24:27],a[152:159],v1
v_smfmac_f32_16x16x64_bf16 v[64:67],v[24:27],a[160:167],v1
v_smfmac_f32_16x16x64_bf16 v[68:71],v[24:27],a[168:175],v1
v_smfmac_f32_16x16x64_bf16 v[72:75],v[24:27],a[176:183],v1
v_smfmac_f32_16x16x64_bf16 v[76:79],v[24:27],a[184:191],v1
dsk_100770:
s_bitcmp1_b32 s55,3
s_cbranch_scc0 dsk_100776
s_waitcnt vmcnt(2)
v_max3_u32 v124,v28,v29,v30
v_max_u32 v124,v124,v31
v_cmp_eq_u32 vcc,-1,v124
s_cbranch_vccz dgo_100777
s_nop 15
buffer_load_dwordx4 v[104:107],v0,s[20:23],s92 offen offset:3072 sc1
s_nop 15
buffer_load_dwordx4 v[108:111],v0,s[20:23],s92 offen offset:3072 sc1
dlp_100778:
s_waitcnt vmcnt(2)
v_max3_u32 v124,v28,v29,v30
v_max_u32 v124,v124,v31
v_cmp_eq_u32 vcc,-1,v124
s_cbranch_vccz dgo_100777
buffer_load_dwordx4 v[28:31],v0,s[20:23],s92 offen offset:3072 sc1
s_waitcnt vmcnt(2)
v_max3_u32 v124,v104,v105,v106
v_max_u32 v124,v124,v107
v_cmp_eq_u32 vcc,-1,v124
s_cbranch_vccz dcp_100780
buffer_load_dwordx4 v[104:107],v0,s[20:23],s92 offen offset:3072 sc1
s_waitcnt vmcnt(2)
v_max3_u32 v124,v108,v109,v110
v_max_u32 v124,v124,v111
v_cmp_eq_u32 vcc,-1,v124
s_cbranch_vccz dcp_100781
buffer_load_dwordx4 v[108:111],v0,s[20:23],s92 offen offset:3072 sc1
s_sub_u32 s90,s90,1
s_cmp_gt_i32 s90,0
s_cbranch_scc1 dlp_100778
s_branch dgo_100777
dcp_100780:
v_mov_b32 v28,v104
v_mov_b32 v29,v105
v_mov_b32 v30,v106
v_mov_b32 v31,v107
s_nop 1
s_branch dgo_100777
dcp_100781:
v_mov_b32 v28,v108
v_mov_b32 v29,v109
v_mov_b32 v30,v110
v_mov_b32 v31,v111
s_nop 1
dgo_100777:
v_smfmac_f32_16x16x64_bf16 v[48:51],v[28:31],a[192:199],v1
v_smfmac_f32_16x16x64_bf16 v[52:55],v[28:31],a[200:207],v1
v_smfmac_f32_16x16x64_bf16 v[56:59],v[28:31],a[208:215],v1
v_smfmac_f32_16x16x64_bf16 v[60:63],v[28:31],a[216:223],v1
v_smfmac_f32_16x16x64_bf16 v[64:67],v[28:31],a[224:231],v1
v_smfmac_f32_16x16x64_bf16 v[68:71],v[28:31],a[232:239],v1
v_smfmac_f32_16x16x64_bf16 v[72:75],v[28:31],a[240:247],v1
v_smfmac_f32_16x16x64_bf16 v[76:79],v[28:31],a[248:255],v1
dsk_100776:
s_mov_b32 s55,0
s_branch Ldone_100694
slowA_100630:
buffer_load_dwordx4 v[44:47],v0,s[20:23],s93 offen offset:3072 sc1
dsk_100782:
s_bitcmp1_b32 s55,7
s_cbranch_scc0 dsk_100783
s_waitcnt vmcnt(2)
v_max3_u32 v124,v44,v45,v46
v_max_u32 v124,v124,v47
v_cmp_eq_u32 vcc,-1,v124
s_cbranch_vccz dgo_100784
s_nop 15
s_nop 3
buffer_load_dwordx4 v[104:107],v0,s[20:23],s93 offen offset:3072 sc1
s_nop 15
s_nop 3
buffer_load_dwordx4 v[108:111],v0,s[20:23],s93 offen offset:3072 sc1
dlp_100785:
s_waitcnt vmcnt(2)
v_max3_u32 v124,v44,v45,v46
v_max_u32 v124,v124,v47
v_cmp_eq_u32 vcc,-1,v124
s_cbranch_vccz dgo_100784
buffer_load_dwordx4 v[44:47],v0,s[20:23],s93 offen offset:3072 sc1
s_waitcnt vmcnt(2)
v_max3_u32 v124,v104,v105,v106
v_max_u32 v124,v124,v107
v_cmp_eq_u32 vcc,-1,v124
s_cbranch_vccz dcp_100787
buffer_load_dwordx4 v[104:107],v0,s[20:23],s93 offen offset:3072 sc1
s_waitcnt vmcnt(2)
v_max3_u32 v124,v108,v109,v110
v_max_u32 v124,v124,v111
v_cmp_eq_u32 vcc,-1,v124
s_cbranch_vccz dcp_100788
buffer_load_dwordx4 v[108:111],v0,s[20:23],s93 offen offset:3072 sc1
s_sub_u32 s90,s90,1
s_cmp_gt_i32 s90,0
s_cbranch_scc1 dlp_100785
s_branch dgo_100784
dcp_100787:
v_mov_b32 v44,v104
v_mov_b32 v45,v105
v_mov_b32 v46,v106
v_mov_b32 v47,v107
s_nop 1
s_branch dgo_100784
dcp_100788:
v_mov_b32 v44,v108
v_mov_b32 v45,v109
v_mov_b32 v46,v110
v_mov_b32 v47,v111
s_nop 1
dgo_100784:
dsk_100783:
s_mov_b32 s55,0
s_branch segb_100612
srt_100637:
s_sub_u32 s90,s90,1
s_cmp_gt_i32 s90,0
s_cbranch_scc0 sok_100636
buffer_load_dwordx4 v[16:19],v2,s[20:23],s94 offen offset:0 sc1
buffer_load_dwordx4 v[32:35],v2,s[20:23],s94 offen offset:1536 sc1
buffer_load_dwordx4 v[20:23],v2,s[20:23],s95 offen offset:0 sc1
buffer_load_dwordx4 v[36:39],v2,s[20:23],s95 offen offset:1536 sc1
buffer_load_dword v120,v3,s[20:23],s94 offen offset:0 sc1
buffer_load_dword v121,v3,s[20:23],s94 offen offset:1536 sc1
buffer_load_dword v122,v3,s[20:23],s95 offen offset:0 sc1
buffer_load_dword v123,v3,s[20:23],s95 offen offset:1536 sc1
s_branch sp_100635
of_100638:
s_mov_b32 s55,3
buffer_load_dwordx4 v[16:19],v0,s[20:23],s96 offen offset:0 sc1
buffer_load_dwordx4 v[20:23],v0,s[20:23],s96 offen offset:1024 sc1
v_readfirstlane_b32 s91,v126
s_waitcnt vmcnt(6)
v_max3_u32 v124,v24,v25,v26
v_max3_u32 v124,v124,v27,v28
v_max3_u32 v124,v124,v29,v30
v_max_u32 v124,v124,v31
v_cmp_eq_u32 vcc,-1,v124
s_cbranch_vccnz ost_100790
v_smfmac_f32_16x16x64_bf16 v[96:99],v[24:27],v[80:87],v1
buffer_load_dword v120,off,s[20:23],s96 sc1
v_smfmac_f32_16x16x64_bf16 v[100:103],v[24:27],v[88:95],v1
buffer_load_dword v120,off,s[20:23],s96 sc1
v_smfmac_f32_16x16x64_bf16 v[96:99],v[28:31],v[128:135],v1
v_smfmac_f32_16x16x64_bf16 v[100:103],v[28:31],v[136:143],v1
ort_100791:
s_waitcnt vmcnt(6)
v_max3_u32 v124,v32,v33,v34
v_max3_u32 v124,v124,v35,v36
v_max3_u32 v124,v124,v37,v38
v_max_u32 v124,v124,v39
v_cmp_eq_u32 vcc,-1,v124
s_cbranch_vccnz ost_100792
v_smfmac_f32_16x16x64_bf16 v[96:99],v[32:35],v[144:151],v1
buffer_load_dword v120,off,s[20:23],s96 sc1
v_smfmac_f32_16x16x64_bf16 v[100:103],v[32:35],v[152:159],v1
buffer_load_dword v120,off,s[20:23],s96 sc1
v_smfmac_f32_16x16x64_bf16 v[96:99],v[36:39],v[160:167],v1
v_smfmac_f32_16x16x64_bf16 v[100:103],v[36:39],v[168:175],v1
ort_100793:
s_waitcnt vmcnt(7)
v_max3_u32 v124,v40,v41,v42
v_max_u32 v124,v124,v43
v_cmp_eq_u32 vcc,-1,v124
s_cbranch_vccnz ost_100794
v_smfmac_f32_16x16x64_bf16 v[96:99],v[40:43],v[176:183],v1
buffer_load_dword v120,off,s[20:23],s96 sc1
v_smfmac_f32_16x16x64_bf16 v[100:103],v[40:43],v[184:191],v1
ort_100795:
s_waitcnt vmcnt(7)
v_max3_u32 v124,v44,v45,v46
v_max_u32 v124,v124,v47
v_cmp_eq_u32 vcc,-1,v124
s_cbranch_vccnz ost_100796
v_smfmac_f32_16x16x64_bf16 v[96:99],v[44:47],v[192:199],v1
buffer_load_dword v120,off,s[20:23],s96 sc1
v_smfmac_f32_16x16x64_bf16 v[100:103],v[44:47],v[200:207],v1
ort_100797:
s_waitcnt vmcnt(6)
v_max3_u32 v124,v16,v17,v18
v_max3_u32 v124,v124,v19,v20
v_max3_u32 v124,v124,v21,v22
v_max_u32 v124,v124,v23
v_cmp_eq_u32 vcc,-1,v124
s_cbranch_vccnz olap2_100789
s_andn2_b32 s55,s55,3
v_smfmac_f32_16x16x64_bf16 v[96:99],v[16:19],v[48:55],v1
v_smfmac_f32_16x16x64_bf16 v[100:103],v[16:19],v[56:63],v1
v_smfmac_f32_16x16x64_bf16 v[96:99],v[20:23],v[64:71],v1
v_smfmac_f32_16x16x64_bf16 v[100:103],v[20:23],v[72:79],v1
s_cbranch_scc0 oback_100649
s_branch olap2_100789
ost_100790:
buffer_load_dwordx4 v[24:27],v0,s[20:23],s96 offen offset:2048 sc1
buffer_load_dwordx4 v[28:31],v0,s[20:23],s96 offen offset:3072 sc1
s_or_b32 s55,s55,12
s_branch ort_100791
ost_100792:
buffer_load_dwordx4 v[32:35],v0,s[20:23],s97 offen offset:0 sc1
buffer_load_dwordx4 v[36:39],v0,s[20:23],s97 offen offset:1024 sc1
s_or_b32 s55,s55,48
s_branch ort_100793
ost_100794:
buffer_load_dwordx4 v[40:43],v0,s[20:23],s97 offen offset:2048 sc1
s_or_b32 s55,s55,64
s_branch ort_100795
ost_100796:
buffer_load_dwordx4 v[44:47],v0,s[20:23],s97 offen offset:3072 sc1
s_or_b32 s55,s55,128
s_branch ort_100797
of_100639:
s_mov_b32 s55,12
buffer_load_dwordx4 v[24:27],v0,s[20:23],s96 offen offset:2048 sc1
buffer_load_dwordx4 v[28:31],v0,s[20:23],s96 offen offset:3072 sc1
s_waitcnt vmcnt(4)
v_max3_u32 v124,v32,v33,v34
v_max3_u32 v124,v124,v35,v36
v_max3_u32 v124,v124,v37,v38
v_max_u32 v124,v124,v39
v_cmp_eq_u32 vcc,-1,v124
s_cbranch_vccnz ost_100799
v_smfmac_f32_16x16x64_bf16 v[96:99],v[32:35],v[144:151],v1
buffer_load_dword v120,off,s[20:23],s96 sc1
v_smfmac_f32_16x16x64_bf16 v[100:103],v[32:35],v[152:159],v1
buffer_load_dword v120,off,s[20:23],s96 sc1
v_smfmac_f32_16x16x64_bf16 v[96:99],v[36:39],v[160:167],v1
v_smfmac_f32_16x16x64_bf16 v[100:103],v[36:39],v[168:175],v1
ort_100800:
s_waitcnt vmcnt(5)
v_max3_u32 v124,v40,v41,v42
v_max_u32 v124,v124,v43
v_cmp_eq_u32 vcc,-1,v124
s_cbranch_vccnz ost_100801
v_smfmac_f32_16x16x64_bf16 v[96:99],v[40:43],v[176:183],v1
buffer_load_dword v120,off,s[20:23],s96 sc1
v_smfmac_f32_16x16x64_bf16 v[100:103],v[40:43],v[184:191],v1
ort_100802:
s_waitcnt vmcnt(5)
v_max3_u32 v124,v44,v45,v46
v_max_u32 v124,v124,v47
v_cmp_eq_u32 vcc,-1,v124
s_cbranch_vccnz ost_100803
v_smfmac_f32_16x16x64_bf16 v[96:99],v[44:47],v[192:199],v1
buffer_load_dword v120,off,s[20:23],s96 sc1
v_smfmac_f32_16x16x64_bf16 v[100:103],v[44:47],v[200:207],v1
ort_100804:
s_waitcnt vmcnt(4)
v_max3_u32 v124,v24,v25,v26
v_max3_u32 v124,v124,v27,v28
v_max3_u32 v124,v124,v29,v30
v_max_u32 v124,v124,v31
v_cmp_eq_u32 vcc,-1,v124
s_cbranch_vccnz olap2_100789
s_andn2_b32 s55,s55,12
v_smfmac_f32_16x16x64_bf16 v[96:99],v[24:27],v[80:87],v1
v_smfmac_f32_16x16x64_bf16 v[100:103],v[24:27],v[88:95],v1
v_smfmac_f32_16x16x64_bf16 v[96:99],v[28:31],v[128:135],v1
v_smfmac_f32_16x16x64_bf16 v[100:103],v[28:31],v[136:143],v1
s_cbranch_scc0 oback_100649
s_branch olap2_100789
ost_100799:
buffer_load_dwordx4 v[32:35],v0,s[20:23],s97 offen offset:0 sc1
buffer_load_dwordx4 v[36:39],v0,s[20:23],s97 offen offset:1024 sc1
s_or_b32 s55,s55,48
s_branch ort_100800
ost_100801:
buffer_load_dwordx4 v[40:43],v0,s[20:23],s97 offen offset:2048 sc1
s_or_b32 s55,s55,64
s_branch ort_100802
ost_100803:
buffer_load_dwordx4 v[44:47],v0,s[20:23],s97 offen offset:3072 sc1
s_or_b32 s55,s55,128
s_branch ort_100804
of_100640:
s_mov_b32 s55,48
buffer_load_dwordx4 v[32:35],v0,s[20:23],s97 offen offset:0 sc1
buffer_load_dwordx4 v[36:39],v0,s[20:23],s97 offen offset:1024 sc1
s_waitcnt vmcnt(3)
v_max3_u32 v124,v40,v41,v42
v_max_u32 v124,v124,v43
v_cmp_eq_u32 vcc,-1,v124
s_cbranch_vccnz ost_100806
v_smfmac_f32_16x16x64_bf16 v[96:99],v[40:43],v[176:183],v1
buffer_load_dword v120,off,s[20:23],s96 sc1
v_smfmac_f32_16x16x64_bf16 v[100:103],v[40:43],v[184:191],v1
ort_100807:
s_waitcnt vmcnt(3)
v_max3_u32 v124,v44,v45,v46
v_max_u32 v124,v124,v47
v_cmp_eq_u32 vcc,-1,v124
s_cbranch_vccnz ost_100808
v_smfmac_f32_16x16x64_bf16 v[96:99],v[44:47],v[192:199],v1
buffer_load_dword v120,off,s[20:23],s96 sc1
v_smfmac_f32_16x16x64_bf16 v[100:103],v[44:47],v[200:207],v1
ort_100809:
s_waitcnt vmcnt(2)
v_max3_u32 v124,v32,v33,v34
v_max3_u32 v124,v124,v35,v36
v_max3_u32 v124,v124,v37,v38
v_max_u32 v124,v124,v39
v_cmp_eq_u32 vcc,-1,v124
s_cbranch_vccnz olap2_100789
s_andn2_b32 s55,s55,48
v_smfmac_f32_16x16x64_bf16 v[96:99],v[32:35],v[144:151],v1
v_smfmac_f32_16x16x64_bf16 v[100:103],v[32:35],v[152:159],v1
v_smfmac_f32_16x16x64_bf16 v[96:99],v[36:39],v[160:167],v1
v_smfmac_f32_16x16x64_bf16 v[100:103],v[36:39],v[168:175],v1
s_cbranch_scc0 oback_100649
s_branch olap2_100789
ost_100806:
buffer_load_dwordx4 v[40:43],v0,s[20:23],s97 offen offset:2048 sc1
s_or_b32 s55,s55,64
s_branch ort_100807
ost_100808:
buffer_load_dwordx4 v[44:47],v0,s[20:23],s97 offen offset:3072 sc1
s_or_b32 s55,s55,128
s_branch ort_100809
of_100641:
s_mov_b32 s55,64
buffer_load_dwordx4 v[40:43],v0,s[20:23],s97 offen offset:2048 sc1
s_waitcnt vmcnt(1)
v_max3_u32 v124,v44,v45,v46
v_max_u32 v124,v124,v47
v_cmp_eq_u32 vcc,-1,v124
s_cbranch_vccnz ost_100811
v_smfmac_f32_16x16x64_bf16 v[96:99],v[44:47],v[192:199],v1
buffer_load_dword v120,off,s[20:23],s96 sc1
v_smfmac_f32_16x16x64_bf16 v[100:103],v[44:47],v[200:207],v1
ort_100812:
s_waitcnt vmcnt(1)
v_max3_u32 v124,v40,v41,v42
v_max_u32 v124,v124,v43
v_cmp_eq_u32 vcc,-1,v124
s_cbranch_vccnz olap2_100789
s_andn2_b32 s55,s55,64
v_smfmac_f32_16x16x64_bf16 v[96:99],v[40:43],v[176:183],v1
v_smfmac_f32_16x16x64_bf16 v[100:103],v[40:43],v[184:191],v1
s_cbranch_scc0 oback_100649
s_branch olap2_100789
ost_100811:
buffer_load_dwordx4 v[44:47],v0,s[20:23],s97 offen offset:3072 sc1
s_or_b32 s55,s55,128
s_branch ort_100812
of_100642:
s_mov_b32 s55,128
s_branch oslow_100648
olap2_100789:
s_bitcmp1_b32 s55,0
s_cbranch_scc0 l2s_100814
s_waitcnt vmcnt(6)
v_max3_u32 v124,v16,v17,v18
v_max3_u32 v124,v124,v19,v20
v_max3_u32 v124,v124,v21,v22
v_max_u32 v124,v124,v23
v_cmp_eq_u32 vcc,-1,v124
s_cbranch_vccnz l2s_100814
s_andn2_b32 s55,s55,3
v_smfmac_f32_16x16x64_bf16 v[96:99],v[16:19],v[48:55],v1
v_smfmac_f32_16x16x64_bf16 v[100:103],v[16:19],v[56:63],v1
v_smfmac_f32_16x16x64_bf16 v[96:99],v[20:23],v[64:71],v1
v_smfmac_f32_16x16x64_bf16 v[100:103],v[20:23],v[72:79],v1
l2s_100814:
s_bitcmp1_b32 s55,2
s_cbranch_scc0 l2s_100815
s_waitcnt vmcnt(4)
v_max3_u32 v124,v24,v25,v26
v_max3_u32 v124,v124,v27,v28
v_max3_u32 v124,v124,v29,v30
v_max_u32 v124,v124,v31
v_cmp_eq_u32 vcc,-1,v124
s_cbranch_vccnz l2s_100815
s_andn2_b32 s55,s55,12
v_smfmac_f32_16x16x64_bf16 v[96:99],v[24:27],v[80:87],v1
v_smfmac_f32_16x16x64_bf16 v[100:103],v[24:27],v[88:95],v1
v_smfmac_f32_16x16x64_bf16 v[96:99],v[28:31],v[128:135],v1
v_smfmac_f32_16x16x64_bf16 v[100:103],v[28:31],v[136:143],v1
l2s_100815:
s_bitcmp1_b32 s55,4
s_cbranch_scc0 l2s_100816
s_waitcnt vmcnt(2)
v_max3_u32 v124,v32,v33,v34
v_max3_u32 v124,v124,v35,v36
v_max3_u32 v124,v124,v37,v38
v_max_u32 v124,v124,v39
v_cmp_eq_u32 vcc,-1,v124
s_cbranch_vccnz l2s_100816
s_andn2_b32 s55,s55,48
v_smfmac_f32_16x16x64_bf16 v[96:99],v[32:35],v[144:151],v1
v_smfmac_f32_16x16x64_bf16 v[100:103],v[32:35],v[152:159],v1
v_smfmac_f32_16x16x64_bf16 v[96:99],v[36:39],v[160:167],v1
v_smfmac_f32_16x16x64_bf16 v[100:103],v[36:39],v[168:175],v1
l2s_100816:
s_bitcmp1_b32 s55,6
s_cbranch_scc0 l2s_100817
s_waitcnt vmcnt(1)
v_max3_u32 v124,v40,v41,v42
v_max_u32 v124,v124,v43
v_cmp_eq_u32 vcc,-1,v124
s_cbranch_vccnz l2s_100817
s_andn2_b32 s55,s55,64
v_smfmac_f32_16x16x64_bf16 v[96:99],v[40:43],v[176:183],v1
v_smfmac_f32_16x16x64_bf16 v[100:103],v[40:43],v[184:191],v1
l2s_100817:
s_bitcmp1_b32 s55,7
s_cbranch_scc0 l2s_100818
s_waitcnt vmcnt(0)
v_max3_u32 v124,v44,v45,v46
v_max_u32 v124,v124,v47
v_cmp_eq_u32 vcc,-1,v124
s_cbranch_vccnz l2s_100818
s_andn2_b32 s55,s55,128
v_smfmac_f32_16x16x64_bf16 v[96:99],v[44:47],v[192:199],v1
v_smfmac_f32_16x16x64_bf16 v[100:103],v[44:47],v[200:207],v1
l2s_100818:
s_cmp_eq_u32 s55,0
s_cbranch_scc1 oback_100649
oslow_100648:
s_bitcmp1_b32 s55,0
s_cbranch_scc0 dsk_100819
buffer_load_dwordx4 v[16:19],v0,s[20:23],s96 offen offset:0 sc1
dsk_100819:
s_bitcmp1_b32 s55,1
s_cbranch_scc0 dsk_100820
buffer_load_dwordx4 v[20:23],v0,s[20:23],s96 offen offset:1024 sc1
dsk_100820:
s_bitcmp1_b32 s55,2
s_cbranch_scc0 dsk_100821
buffer_load_dwordx4 v[24:27],v0,s[20:23],s96 offen offset:2048 sc1
dsk_100821:
s_bitcmp1_b32 s55,3
s_cbranch_scc0 dsk_100822
buffer_load_dwordx4 v[28:31],v0,s[20:23],s96 offen offset:3072 sc1
dsk_100822:
s_bitcmp1_b32 s55,4
s_cbranch_scc0 dsk_100823
buffer_load_dwordx4 v[32:35],v0,s[20:23],s97 offen offset:0 sc1
dsk_100823:
s_bitcmp1_b32 s55,5
s_cbranch_scc0 dsk_100824
buffer_load_dwordx4 v[36:39],v0,s[20:23],s97 offen offset:1024 sc1
dsk_100824:
s_bitcmp1_b32 s55,6
s_cbranch_scc0 dsk_100825
buffer_load_dwordx4 v[40:43],v0,s[20:23],s97 offen offset:2048 sc1
dsk_100825:
s_bitcmp1_b32 s55,7
s_cbranch_scc0 dsk_100826
buffer_load_dwordx4 v[44:47],v0,s[20:23],s97 offen offset:3072 sc1
dsk_100826:
s_bitcmp1_b32 s55,0
s_cbranch_scc0 dsk_100827
s_waitcnt vmcnt(2)
v_max3_u32 v124,v16,v17,v18
v_max_u32 v124,v124,v19
v_cmp_eq_u32 vcc,-1,v124
s_cbranch_vccz dgo_100828
s_nop 15
buffer_load_dwordx4 v[116:119],v0,s[20:23],s96 offen offset:0 sc1
s_nop 15
buffer_load_dwordx4 v[120:123],v0,s[20:23],s96 offen offset:0 sc1
dlp_100829:
s_waitcnt vmcnt(2)
v_max3_u32 v124,v16,v17,v18
v_max_u32 v124,v124,v19
v_cmp_eq_u32 vcc,-1,v124
s_cbranch_vccz dgo_100828
buffer_load_dwordx4 v[16:19],v0,s[20:23],s96 offen offset:0 sc1
s_waitcnt vmcnt(2)
v_max3_u32 v124,v116,v117,v118
v_max_u32 v124,v124,v119
v_cmp_eq_u32 vcc,-1,v124
s_cbranch_vccz dcp_100831
buffer_load_dwordx4 v[116:119],v0,s[20:23],s96 offen offset:0 sc1
s_waitcnt vmcnt(2)
v_max3_u32 v124,v120,v121,v122
v_max_u32 v124,v124,v123
v_cmp_eq_u32 vcc,-1,v124
s_cbranch_vccz dcp_100832
buffer_load_dwordx4 v[120:123],v0,s[20:23],s96 offen offset:0 sc1
s_sub_u32 s90,s90,1
s_cmp_gt_i32 s90,0
s_cbranch_scc1 dlp_100829
s_branch dgo_100828
dcp_100831:
v_mov_b32 v16,v116
v_mov_b32 v17,v117
v_mov_b32 v18,v118
v_mov_b32 v19,v119
s_nop 1
s_branch dgo_100828
dcp_100832:
v_mov_b32 v16,v120
v_mov_b32 v17,v121
v_mov_b32 v18,v122
v_mov_b32 v19,v123
s_nop 1
dgo_100828:
v_smfmac_f32_16x16x64_bf16 v[96:99],v[16:19],v[48:55],v1
v_smfmac_f32_16x16x64_bf16 v[100:103],v[16:19],v[56:63],v1
dsk_100827:
s_bitcmp1_b32 s55,1
s_cbranch_scc0 dsk_100833
s_waitcnt vmcnt(2)
v_max3_u32 v124,v20,v21,v22
v_max_u32 v124,v124,v23
v_cmp_eq_u32 vcc,-1,v124
s_cbranch_vccz dgo_100834
s_nop 15
buffer_load_dwordx4 v[116:119],v0,s[20:23],s96 offen offset:1024 sc1
s_nop 15
buffer_load_dwordx4 v[120:123],v0,s[20:23],s96 offen offset:1024 sc1
dlp_100835:
s_waitcnt vmcnt(2)
v_max3_u32 v124,v20,v21,v22
v_max_u32 v124,v124,v23
v_cmp_eq_u32 vcc,-1,v124
s_cbranch_vccz dgo_100834
buffer_load_dwordx4 v[20:23],v0,s[20:23],s96 offen offset:1024 sc1
s_waitcnt vmcnt(2)
v_max3_u32 v124,v116,v117,v118
v_max_u32 v124,v124,v119
v_cmp_eq_u32 vcc,-1,v124
s_cbranch_vccz dcp_100837
buffer_load_dwordx4 v[116:119],v0,s[20:23],s96 offen offset:1024 sc1
s_waitcnt vmcnt(2)
v_max3_u32 v124,v120,v121,v122
v_max_u32 v124,v124,v123
v_cmp_eq_u32 vcc,-1,v124
s_cbranch_vccz dcp_100838
buffer_load_dwordx4 v[120:123],v0,s[20:23],s96 offen offset:1024 sc1
s_sub_u32 s90,s90,1
s_cmp_gt_i32 s90,0
s_cbranch_scc1 dlp_100835
s_branch dgo_100834
dcp_100837:
v_mov_b32 v20,v116
v_mov_b32 v21,v117
v_mov_b32 v22,v118
v_mov_b32 v23,v119
s_nop 1
s_branch dgo_100834
dcp_100838:
v_mov_b32 v20,v120
v_mov_b32 v21,v121
v_mov_b32 v22,v122
v_mov_b32 v23,v123
s_nop 1
dgo_100834:
v_smfmac_f32_16x16x64_bf16 v[96:99],v[20:23],v[64:71],v1
v_smfmac_f32_16x16x64_bf16 v[100:103],v[20:23],v[72:79],v1
dsk_100833:
s_bitcmp1_b32 s55,2
s_cbranch_scc0 dsk_100839
s_waitcnt vmcnt(2)
v_max3_u32 v124,v24,v25,v26
v_max_u32 v124,v124,v27
v_cmp_eq_u32 vcc,-1,v124
s_cbranch_vccz dgo_100840
s_nop 15
buffer_load_dwordx4 v[116:119],v0,s[20:23],s96 offen offset:2048 sc1
s_nop 15
buffer_load_dwordx4 v[120:123],v0,s[20:23],s96 offen offset:2048 sc1
dlp_100841:
s_waitcnt vmcnt(2)
v_max3_u32 v124,v24,v25,v26
v_max_u32 v124,v124,v27
v_cmp_eq_u32 vcc,-1,v124
s_cbranch_vccz dgo_100840
buffer_load_dwordx4 v[24:27],v0,s[20:23],s96 offen offset:2048 sc1
s_waitcnt vmcnt(2)
v_max3_u32 v124,v116,v117,v118
v_max_u32 v124,v124,v119
v_cmp_eq_u32 vcc,-1,v124
s_cbranch_vccz dcp_100843
buffer_load_dwordx4 v[116:119],v0,s[20:23],s96 offen offset:2048 sc1
s_waitcnt vmcnt(2)
v_max3_u32 v124,v120,v121,v122
v_max_u32 v124,v124,v123
v_cmp_eq_u32 vcc,-1,v124
s_cbranch_vccz dcp_100844
buffer_load_dwordx4 v[120:123],v0,s[20:23],s96 offen offset:2048 sc1
s_sub_u32 s90,s90,1
s_cmp_gt_i32 s90,0
s_cbranch_scc1 dlp_100841
s_branch dgo_100840
dcp_100843:
v_mov_b32 v24,v116
v_mov_b32 v25,v117
v_mov_b32 v26,v118
v_mov_b32 v27,v119
s_nop 1
s_branch dgo_100840
dcp_100844:
v_mov_b32 v24,v120
v_mov_b32 v25,v121
v_mov_b32 v26,v122
v_mov_b32 v27,v123
s_nop 1
dgo_100840:
v_smfmac_f32_16x16x64_bf16 v[96:99],v[24:27],v[80:87],v1
v_smfmac_f32_16x16x64_bf16 v[100:103],v[24:27],v[88:95],v1
dsk_100839:
s_bitcmp1_b32 s55,3
s_cbranch_scc0 dsk_100845
s_waitcnt vmcnt(2)
v_max3_u32 v124,v28,v29,v30
v_max_u32 v124,v124,v31
v_cmp_eq_u32 vcc,-1,v124
s_cbranch_vccz dgo_100846
s_nop 15
buffer_load_dwordx4 v[116:119],v0,s[20:23],s96 offen offset:3072 sc1
s_nop 15
buffer_load_dwordx4 v[120:123],v0,s[20:23],s96 offen offset:3072 sc1
dlp_100847:
s_waitcnt vmcnt(2)
v_max3_u32 v124,v28,v29,v30
v_max_u32 v124,v124,v31
v_cmp_eq_u32 vcc,-1,v124
s_cbranch_vccz dgo_100846
buffer_load_dwordx4 v[28:31],v0,s[20:23],s96 offen offset:3072 sc1
s_waitcnt vmcnt(2)
v_max3_u32 v124,v116,v117,v118
v_max_u32 v124,v124,v119
v_cmp_eq_u32 vcc,-1,v124
s_cbranch_vccz dcp_100849
buffer_load_dwordx4 v[116:119],v0,s[20:23],s96 offen offset:3072 sc1
s_waitcnt vmcnt(2)
v_max3_u32 v124,v120,v121,v122
v_max_u32 v124,v124,v123
v_cmp_eq_u32 vcc,-1,v124
s_cbranch_vccz dcp_100850
buffer_load_dwordx4 v[120:123],v0,s[20:23],s96 offen offset:3072 sc1
s_sub_u32 s90,s90,1
s_cmp_gt_i32 s90,0
s_cbranch_scc1 dlp_100847
s_branch dgo_100846
dcp_100849:
v_mov_b32 v28,v116
v_mov_b32 v29,v117
v_mov_b32 v30,v118
v_mov_b32 v31,v119
s_nop 1
s_branch dgo_100846
dcp_100850:
v_mov_b32 v28,v120
v_mov_b32 v29,v121
v_mov_b32 v30,v122
v_mov_b32 v31,v123
s_nop 1
dgo_100846:
v_smfmac_f32_16x16x64_bf16 v[96:99],v[28:31],v[128:135],v1
v_smfmac_f32_16x16x64_bf16 v[100:103],v[28:31],v[136:143],v1
dsk_100845:
s_bitcmp1_b32 s55,4
s_cbranch_scc0 dsk_100851
s_waitcnt vmcnt(2)
v_max3_u32 v124,v32,v33,v34
v_max_u32 v124,v124,v35
v_cmp_eq_u32 vcc,-1,v124
s_cbranch_vccz dgo_100852
s_nop 15
buffer_load_dwordx4 v[116:119],v0,s[20:23],s97 offen offset:0 sc1
s_nop 15
buffer_load_dwordx4 v[120:123],v0,s[20:23],s97 offen offset:0 sc1
dlp_100853:
s_waitcnt vmcnt(2)
v_max3_u32 v124,v32,v33,v34
v_max_u32 v124,v124,v35
v_cmp_eq_u32 vcc,-1,v124
s_cbranch_vccz dgo_100852
buffer_load_dwordx4 v[32:35],v0,s[20:23],s97 offen offset:0 sc1
s_waitcnt vmcnt(2)
v_max3_u32 v124,v116,v117,v118
v_max_u32 v124,v124,v119
v_cmp_eq_u32 vcc,-1,v124
s_cbranch_vccz dcp_100855
buffer_load_dwordx4 v[116:119],v0,s[20:23],s97 offen offset:0 sc1
s_waitcnt vmcnt(2)
v_max3_u32 v124,v120,v121,v122
v_max_u32 v124,v124,v123
v_cmp_eq_u32 vcc,-1,v124
s_cbranch_vccz dcp_100856
buffer_load_dwordx4 v[120:123],v0,s[20:23],s97 offen offset:0 sc1
s_sub_u32 s90,s90,1
s_cmp_gt_i32 s90,0
s_cbranch_scc1 dlp_100853
s_branch dgo_100852
dcp_100855:
v_mov_b32 v32,v116
v_mov_b32 v33,v117
v_mov_b32 v34,v118
v_mov_b32 v35,v119
s_nop 1
s_branch dgo_100852
dcp_100856:
v_mov_b32 v32,v120
v_mov_b32 v33,v121
v_mov_b32 v34,v122
v_mov_b32 v35,v123
s_nop 1
dgo_100852:
v_smfmac_f32_16x16x64_bf16 v[96:99],v[32:35],v[144:151],v1
v_smfmac_f32_16x16x64_bf16 v[100:103],v[32:35],v[152:159],v1
dsk_100851:
s_bitcmp1_b32 s55,5
s_cbranch_scc0 dsk_100857
s_waitcnt vmcnt(2)
v_max3_u32 v124,v36,v37,v38
v_max_u32 v124,v124,v39
v_cmp_eq_u32 vcc,-1,v124
s_cbranch_vccz dgo_100858
s_nop 15
buffer_load_dwordx4 v[116:119],v0,s[20:23],s97 offen offset:1024 sc1
s_nop 15
buffer_load_dwordx4 v[120:123],v0,s[20:23],s97 offen offset:1024 sc1
dlp_100859:
s_waitcnt vmcnt(2)
v_max3_u32 v124,v36,v37,v38
v_max_u32 v124,v124,v39
v_cmp_eq_u32 vcc,-1,v124
s_cbranch_vccz dgo_100858
buffer_load_dwordx4 v[36:39],v0,s[20:23],s97 offen offset:1024 sc1
s_waitcnt vmcnt(2)
v_max3_u32 v124,v116,v117,v118
v_max_u32 v124,v124,v119
v_cmp_eq_u32 vcc,-1,v124
s_cbranch_vccz dcp_100861
buffer_load_dwordx4 v[116:119],v0,s[20:23],s97 offen offset:1024 sc1
s_waitcnt vmcnt(2)
v_max3_u32 v124,v120,v121,v122
v_max_u32 v124,v124,v123
v_cmp_eq_u32 vcc,-1,v124
s_cbranch_vccz dcp_100862
buffer_load_dwordx4 v[120:123],v0,s[20:23],s97 offen offset:1024 sc1
s_sub_u32 s90,s90,1
s_cmp_gt_i32 s90,0
s_cbranch_scc1 dlp_100859
s_branch dgo_100858
dcp_100861:
v_mov_b32 v36,v116
v_mov_b32 v37,v117
v_mov_b32 v38,v118
v_mov_b32 v39,v119
s_nop 1
s_branch dgo_100858
dcp_100862:
v_mov_b32 v36,v120
v_mov_b32 v37,v121
v_mov_b32 v38,v122
v_mov_b32 v39,v123
s_nop 1
dgo_100858:
v_smfmac_f32_16x16x64_bf16 v[96:99],v[36:39],v[160:167],v1
v_smfmac_f32_16x16x64_bf16 v[100:103],v[36:39],v[168:175],v1
dsk_100857:
s_bitcmp1_b32 s55,6
s_cbranch_scc0 dsk_100863
s_waitcnt vmcnt(2)
v_max3_u32 v124,v40,v41,v42
v_max_u32 v124,v124,v43
v_cmp_eq_u32 vcc,-1,v124
s_cbranch_vccz dgo_100864
s_nop 15
buffer_load_dwordx4 v[116:119],v0,s[20:23],s97 offen offset:2048 sc1
s_nop 15
buffer_load_dwordx4 v[120:123],v0,s[20:23],s97 offen offset:2048 sc1
dlp_100865:
s_waitcnt vmcnt(2)
v_max3_u32 v124,v40,v41,v42
v_max_u32 v124,v124,v43
v_cmp_eq_u32 vcc,-1,v124
s_cbranch_vccz dgo_100864
buffer_load_dwordx4 v[40:43],v0,s[20:23],s97 offen offset:2048 sc1
s_waitcnt vmcnt(2)
v_max3_u32 v124,v116,v117,v118
v_max_u32 v124,v124,v119
v_cmp_eq_u32 vcc,-1,v124
s_cbranch_vccz dcp_100867
buffer_load_dwordx4 v[116:119],v0,s[20:23],s97 offen offset:2048 sc1
s_waitcnt vmcnt(2)
v_max3_u32 v124,v120,v121,v122
v_max_u32 v124,v124,v123
v_cmp_eq_u32 vcc,-1,v124
s_cbranch_vccz dcp_100868
buffer_load_dwordx4 v[120:123],v0,s[20:23],s97 offen offset:2048 sc1
s_sub_u32 s90,s90,1
s_cmp_gt_i32 s90,0
s_cbranch_scc1 dlp_100865
s_branch dgo_100864
dcp_100867:
v_mov_b32 v40,v116
v_mov_b32 v41,v117
v_mov_b32 v42,v118
v_mov_b32 v43,v119
s_nop 1
s_branch dgo_100864
dcp_100868:
v_mov_b32 v40,v120
v_mov_b32 v41,v121
v_mov_b32 v42,v122
v_mov_b32 v43,v123
s_nop 1
dgo_100864:
v_smfmac_f32_16x16x64_bf16 v[96:99],v[40:43],v[176:183],v1
v_smfmac_f32_16x16x64_bf16 v[100:103],v[40:43],v[184:191],v1
dsk_100863:
s_bitcmp1_b32 s55,7
s_cbranch_scc0 dsk_100869
s_waitcnt vmcnt(2)
v_max3_u32 v124,v44,v45,v46
v_max_u32 v124,v124,v47
v_cmp_eq_u32 vcc,-1,v124
s_cbranch_vccz dgo_100870
s_nop 15
buffer_load_dwordx4 v[116:119],v0,s[20:23],s97 offen offset:3072 sc1
s_nop 15
buffer_load_dwordx4 v[120:123],v0,s[20:23],s97 offen offset:3072 sc1
dlp_100871:
s_waitcnt vmcnt(2)
v_max3_u32 v124,v44,v45,v46
v_max_u32 v124,v124,v47
v_cmp_eq_u32 vcc,-1,v124
s_cbranch_vccz dgo_100870
buffer_load_dwordx4 v[44:47],v0,s[20:23],s97 offen offset:3072 sc1
s_waitcnt vmcnt(2)
v_max3_u32 v124,v116,v117,v118
v_max_u32 v124,v124,v119
v_cmp_eq_u32 vcc,-1,v124
s_cbranch_vccz dcp_100873
buffer_load_dwordx4 v[116:119],v0,s[20:23],s97 offen offset:3072 sc1
s_waitcnt vmcnt(2)
v_max3_u32 v124,v120,v121,v122
v_max_u32 v124,v124,v123
v_cmp_eq_u32 vcc,-1,v124
s_cbranch_vccz dcp_100874
buffer_load_dwordx4 v[120:123],v0,s[20:23],s97 offen offset:3072 sc1
s_sub_u32 s90,s90,1
s_cmp_gt_i32 s90,0
s_cbranch_scc1 dlp_100871
s_branch dgo_100870
dcp_100873:
v_mov_b32 v44,v116
v_mov_b32 v45,v117
v_mov_b32 v46,v118
v_mov_b32 v47,v119
s_nop 1
s_branch dgo_100870
dcp_100874:
v_mov_b32 v44,v120
v_mov_b32 v45,v121
v_mov_b32 v46,v122
v_mov_b32 v47,v123
s_nop 1
dgo_100870:
v_smfmac_f32_16x16x64_bf16 v[96:99],v[44:47],v[192:199],v1
v_smfmac_f32_16x16x64_bf16 v[100:103],v[44:47],v[200:207],v1
dsk_100869:
s_mov_b32 s55,0
s_branch oback_100649
fl_100666:
flb_100674:
buffer_load_dwordx4 v[16:19],v0,s[20:23],s92 offen offset:0 sc1
s_mov_b32 s55,1
buffer_load_dwordx4 v[32:35],v0,s[20:23],s93 offen offset:0 sc1
s_waitcnt vmcnt(4)
v_max3_u32 v124,v20,v21,v22
v_max_u32 v124,v124,v23
v_cmp_eq_u32 vcc,-1,v124
s_cbranch_vccnz dfl_100875
v_smfmac_f32_16x16x64_bf16 v[64:67],v[20:23],a[96:103],v1
buffer_load_dword v125,off,s[20:23],s92 sc1
buffer_load_dwordx4 v[36:39],v0,s[20:23],s93 offen offset:1024 sc1
s_waitcnt vmcnt(5)
v_max3_u32 v124,v24,v25,v26
v_smfmac_f32_16x16x64_bf16 v[68:71],v[20:23],a[104:111],v1
v_max_u32 v124,v124,v27
v_cmp_eq_u32 vcc,-1,v124
v_smfmac_f32_16x16x64_bf16 v[72:75],v[20:23],a[112:119],v1
v_smfmac_f32_16x16x64_bf16 v[76:79],v[20:23],a[120:127],v1
s_cbranch_vccnz dfl_100876
v_smfmac_f32_16x16x64_bf16 v[64:67],v[24:27],a[160:167],v1
buffer_load_dword v125,off,s[20:23],s92 sc1
buffer_load_dwordx4 v[40:43],v0,s[20:23],s93 offen offset:2048 sc1
buffer_load_dwordx4 v[44:47],v0,s[20:23],s93 offen offset:3072 sc1
s_waitcnt vmcnt(7)
v_max3_u32 v124,v28,v29,v30
v_smfmac_f32_16x16x64_bf16 v[68:71],v[24:27],a[168:175],v1
v_max_u32 v124,v124,v31
v_cmp_eq_u32 vcc,-1,v124
v_smfmac_f32_16x16x64_bf16 v[72:75],v[24:27],a[176:183],v1
v_smfmac_f32_16x16x64_bf16 v[76:79],v[24:27],a[184:191],v1
s_cbranch_vccnz dfl_100877
v_smfmac_f32_16x16x64_bf16 v[64:67],v[28:31],a[224:231],v1
buffer_load_dword v125,off,s[20:23],s92 sc1
s_waitcnt vmcnt(7)
v_max3_u32 v124,v16,v17,v18
v_smfmac_f32_16x16x64_bf16 v[68:71],v[28:31],a[232:239],v1
v_max_u32 v124,v124,v19
v_cmp_eq_u32 vcc,-1,v124
v_smfmac_f32_16x16x64_bf16 v[72:75],v[28:31],a[240:247],v1
v_smfmac_f32_16x16x64_bf16 v[76:79],v[28:31],a[248:255],v1
s_cbranch_vccnz lfb_100882
s_mov_b32 s55,0
v_smfmac_f32_16x16x64_bf16 v[64:67],v[16:19],a[32:39],v1
s_waitcnt vmcnt(6)
v_max3_u32 v124,v32,v33,v34
v_max_u32 v124,v124,v35
v_cmp_eq_u32 vcc,-1,v124
v_smfmac_f32_16x16x64_bf16 v[68:71],v[16:19],a[40:47],v1
v_smfmac_f32_16x16x64_bf16 v[72:75],v[16:19],a[48:55],v1
v_smfmac_f32_16x16x64_bf16 v[76:79],v[16:19],a[56:63],v1
s_cbranch_vccnz flb_100678
s_branch segb_100662
fl_100667:
flb_100675:
buffer_load_dwordx4 v[20:23],v0,s[20:23],s92 offen offset:1024 sc1
s_mov_b32 s55,2
buffer_load_dwordx4 v[36:39],v0,s[20:23],s93 offen offset:1024 sc1
s_waitcnt vmcnt(5)
v_max3_u32 v124,v24,v25,v26
v_max_u32 v124,v124,v27
v_cmp_eq_u32 vcc,-1,v124
s_cbranch_vccnz dfl_100876
v_smfmac_f32_16x16x64_bf16 v[64:67],v[24:27],a[160:167],v1
buffer_load_dword v125,off,s[20:23],s92 sc1
buffer_load_dwordx4 v[40:43],v0,s[20:23],s93 offen offset:2048 sc1
buffer_load_dwordx4 v[44:47],v0,s[20:23],s93 offen offset:3072 sc1
s_waitcnt vmcnt(7)
v_max3_u32 v124,v28,v29,v30
v_smfmac_f32_16x16x64_bf16 v[68:71],v[24:27],a[168:175],v1
v_max_u32 v124,v124,v31
v_cmp_eq_u32 vcc,-1,v124
v_smfmac_f32_16x16x64_bf16 v[72:75],v[24:27],a[176:183],v1
v_smfmac_f32_16x16x64_bf16 v[76:79],v[24:27],a[184:191],v1
s_cbranch_vccnz dfl_100877
v_smfmac_f32_16x16x64_bf16 v[64:67],v[28:31],a[224:231],v1
buffer_load_dword v125,off,s[20:23],s92 sc1
s_waitcnt vmcnt(5)
v_max3_u32 v124,v20,v21,v22
v_smfmac_f32_16x16x64_bf16 v[68:71],v[28:31],a[232:239],v1
v_max_u32 v124,v124,v23
v_cmp_eq_u32 vcc,-1,v124
v_smfmac_f32_16x16x64_bf16 v[72:75],v[28:31],a[240:247],v1
v_smfmac_f32_16x16x64_bf16 v[76:79],v[28:31],a[248:255],v1
s_cbranch_vccnz lfb_100882
s_mov_b32 s55,0
v_smfmac_f32_16x16x64_bf16 v[64:67],v[20:23],a[96:103],v1
s_waitcnt vmcnt(6)
v_max3_u32 v124,v32,v33,v34
v_max_u32 v124,v124,v35
v_cmp_eq_u32 vcc,-1,v124
v_smfmac_f32_16x16x64_bf16 v[68:71],v[20:23],a[104:111],v1
v_smfmac_f32_16x16x64_bf16 v[72:75],v[20:23],a[112:119],v1
v_smfmac_f32_16x16x64_bf16 v[76:79],v[20:23],a[120:127],v1
s_cbranch_vccnz flb_100678
s_branch segb_100662
fl_100668:
flb_100676:
buffer_load_dwordx4 v[24:27],v0,s[20:23],s92 offen offset:2048 sc1
s_mov_b32 s55,4
buffer_load_dwordx4 v[40:43],v0,s[20:23],s93 offen offset:2048 sc1
buffer_load_dwordx4 v[44:47],v0,s[20:23],s93 offen offset:3072 sc1
s_waitcnt vmcnt(7)
v_max3_u32 v124,v28,v29,v30
v_max_u32 v124,v124,v31
v_cmp_eq_u32 vcc,-1,v124
s_cbranch_vccnz dfl_100877
v_smfmac_f32_16x16x64_bf16 v[64:67],v[28:31],a[224:231],v1
buffer_load_dword v125,off,s[20:23],s92 sc1
s_waitcnt vmcnt(3)
v_max3_u32 v124,v24,v25,v26
v_smfmac_f32_16x16x64_bf16 v[68:71],v[28:31],a[232:239],v1
v_max_u32 v124,v124,v27
v_cmp_eq_u32 vcc,-1,v124
v_smfmac_f32_16x16x64_bf16 v[72:75],v[28:31],a[240:247],v1
v_smfmac_f32_16x16x64_bf16 v[76:79],v[28:31],a[248:255],v1
s_cbranch_vccnz lfb_100882
s_mov_b32 s55,0
v_smfmac_f32_16x16x64_bf16 v[64:67],v[24:27],a[160:167],v1
s_waitcnt vmcnt(6)
v_max3_u32 v124,v32,v33,v34
v_max_u32 v124,v124,v35
v_cmp_eq_u32 vcc,-1,v124
v_smfmac_f32_16x16x64_bf16 v[68:71],v[24:27],a[168:175],v1
v_smfmac_f32_16x16x64_bf16 v[72:75],v[24:27],a[176:183],v1
v_smfmac_f32_16x16x64_bf16 v[76:79],v[24:27],a[184:191],v1
s_cbranch_vccnz flb_100678
s_branch segb_100662
fl_100669:
flb_100677:
buffer_load_dwordx4 v[28:31],v0,s[20:23],s92 offen offset:3072 sc1
s_mov_b32 s55,8
s_waitcnt vmcnt(0)
v_max3_u32 v124,v28,v29,v30
v_max_u32 v124,v124,v31
v_cmp_eq_u32 vcc,-1,v124
s_cbranch_vccnz lfb_100882
s_mov_b32 s55,0
v_smfmac_f32_16x16x64_bf16 v[64:67],v[28:31],a[224:231],v1
s_waitcnt vmcnt(6)
v_max3_u32 v124,v32,v33,v34
v_max_u32 v124,v124,v35
v_cmp_eq_u32 vcc,-1,v124
v_smfmac_f32_16x16x64_bf16 v[68:71],v[28:31],a[232:239],v1
v_smfmac_f32_16x16x64_bf16 v[72:75],v[28:31],a[240:247],v1
v_smfmac_f32_16x16x64_bf16 v[76:79],v[28:31],a[248:255],v1
s_cbranch_vccnz flb_100678
s_branch segb_100662
fl_100670:
flb_100678:
buffer_load_dwordx4 v[32:35],v0,s[20:23],s93 offen offset:0 sc1
s_mov_b32 s55,240
buffer_store_dwordx4 v[112:115],v120,s[20:23],s101 offen sc1
buffer_store_dword v126,v121,s[20:23],s69 offen sc1
s_bitcmp1_b32 s55,5
s_cbranch_scc0 rdn_100885
s_waitcnt vmcnt(7)
v_max3_u32 v124,v36,v37,v38
v_max_u32 v124,v124,v39
v_cmp_eq_u32 vcc,-1,v124
s_cbranch_vccnz rfa_100886
buffer_load_dword v125,off,s[20:23],s92 sc1
s_bitset0_b32 s55,5
v_smfmac_f32_16x16x64_bf16 v[64:67],v[36:39],a[96:103],v1
v_smfmac_f32_16x16x64_bf16 v[68:71],v[36:39],a[104:111],v1
v_smfmac_f32_16x16x64_bf16 v[72:75],v[36:39],a[112:119],v1
v_smfmac_f32_16x16x64_bf16 v[76:79],v[36:39],a[120:127],v1
s_cmp_eq_u32 s55,0
s_cbranch_scc1 segb_100664
s_branch rnx_100887
rdn_100885:
buffer_load_dword v125,off,s[20:23],s92 sc1
s_branch rnx_100887
rfa_100886:
buffer_load_dwordx4 v[36:39],v0,s[20:23],s93 offen offset:1024 sc1
rnx_100887:
s_bitcmp1_b32 s55,6
s_cbranch_scc0 rdn_100888
s_waitcnt vmcnt(6)
v_max3_u32 v124,v40,v41,v42
v_max_u32 v124,v124,v43
v_cmp_eq_u32 vcc,-1,v124
s_cbranch_vccnz rfa_100889
buffer_load_dword v125,off,s[20:23],s92 sc1
s_bitset0_b32 s55,6
s_cmp_eq_u32 s55,0
s_cbranch_scc1 segb_100664
s_branch rnx_100890
rdn_100888:
buffer_load_dword v125,off,s[20:23],s92 sc1
s_branch rnx_100890
rfa_100889:
buffer_load_dwordx4 v[40:43],v0,s[20:23],s93 offen offset:2048 sc1
rnx_100890:
s_bitcmp1_b32 s55,7
s_cbranch_scc0 rdn_100891
s_waitcnt vmcnt(6)
v_max3_u32 v124,v44,v45,v46
v_max_u32 v124,v124,v47
v_cmp_eq_u32 vcc,-1,v124
s_cbranch_vccnz rfa_100892
buffer_load_dword v125,off,s[20:23],s92 sc1
s_bitset0_b32 s55,7
s_cmp_eq_u32 s55,0
s_cbranch_scc1 segb_100664
s_branch rnx_100893
rdn_100891:
buffer_load_dword v125,off,s[20:23],s92 sc1
s_branch rnx_100893
rfa_100892:
buffer_load_dwordx4 v[44:47],v0,s[20:23],s93 offen offset:3072 sc1
rnx_100893:
rot_100884:
s_bitcmp1_b32 s55,4
s_cbranch_scc0 rdn_100894
s_waitcnt vmcnt(3)
v_max3_u32 v124,v32,v33,v34
v_max_u32 v124,v124,v35
v_cmp_eq_u32 vcc,-1,v124
s_cbranch_vccnz rfa_100895
buffer_load_dword v125,off,s[20:23],s92 sc1
s_bitset0_b32 s55,4
v_smfmac_f32_16x16x64_bf16 v[64:67],v[32:35],a[32:39],v1
v_smfmac_f32_16x16x64_bf16 v[68:71],v[32:35],a[40:47],v1
v_smfmac_f32_16x16x64_bf16 v[72:75],v[32:35],a[48:55],v1
v_smfmac_f32_16x16x64_bf16 v[76:79],v[32:35],a[56:63],v1
s_cmp_eq_u32 s55,0
s_cbranch_scc1 segb_100664
s_branch rnx_100896
rdn_100894:
buffer_load_dword v125,off,s[20:23],s92 sc1
s_branch rnx_100896
rfa_100895:
buffer_load_dwordx4 v[32:35],v0,s[20:23],s93 offen offset:0 sc1
rnx_100896:
s_bitcmp1_b32 s55,5
s_cbranch_scc0 rdn_100897
s_waitcnt vmcnt(3)
v_max3_u32 v124,v36,v37,v38
v_max_u32 v124,v124,v39
v_cmp_eq_u32 vcc,-1,v124
s_cbranch_vccnz rfa_100898
buffer_load_dword v125,off,s[20:23],s92 sc1
s_bitset0_b32 s55,5
v_smfmac_f32_16x16x64_bf16 v[64:67],v[36:39],a[96:103],v1
v_smfmac_f32_16x16x64_bf16 v[68:71],v[36:39],a[104:111],v1
v_smfmac_f32_16x16x64_bf16 v[72:75],v[36:39],a[112:119],v1
v_smfmac_f32_16x16x64_bf16 v[76:79],v[36:39],a[120:127],v1
s_cmp_eq_u32 s55,0
s_cbranch_scc1 segb_100664
s_branch rnx_100899
rdn_100897:
buffer_load_dword v125,off,s[20:23],s92 sc1
s_branch rnx_100899
rfa_100898:
buffer_load_dwordx4 v[36:39],v0,s[20:23],s93 offen offset:1024 sc1
rnx_100899:
s_bitcmp1_b32 s55,6
s_cbranch_scc0 rdn_100900
s_waitcnt vmcnt(3)
v_max3_u32 v124,v40,v41,v42
v_max_u32 v124,v124,v43
v_cmp_eq_u32 vcc,-1,v124
s_cbranch_vccnz rfa_100901
buffer_load_dword v125,off,s[20:23],s92 sc1
s_bitset0_b32 s55,6
s_cmp_eq_u32 s55,0
s_cbranch_scc1 segb_100664
s_branch rnx_100902
rdn_100900:
buffer_load_dword v125,off,s[20:23],s92 sc1
s_branch rnx_100902
rfa_100901:
buffer_load_dwordx4 v[40:43],v0,s[20:23],s93 offen offset:2048 sc1
rnx_100902:
s_bitcmp1_b32 s55,7
s_cbranch_scc0 rdn_100903
s_waitcnt vmcnt(3)
v_max3_u32 v124,v44,v45,v46
v_max_u32 v124,v124,v47
v_cmp_eq_u32 vcc,-1,v124
s_cbranch_vccnz rfa_100904
buffer_load_dword v125,off,s[20:23],s92 sc1
s_bitset0_b32 s55,7
s_cmp_eq_u32 s55,0
s_cbranch_scc1 segb_100664
s_branch rnx_100905
rdn_100903:
buffer_load_dword v125,off,s[20:23],s92 sc1
s_branch rnx_100905
rfa_100904:
buffer_load_dwordx4 v[44:47],v0,s[20:23],s93 offen offset:3072 sc1
rnx_100905:
s_sub_u32 s90,s90,1
s_cmp_gt_i32 s90,0
s_cbranch_scc1 rot_100884
s_mov_b32 s55,0
s_branch segb_100664
fl_100671:
flb_100679:
buffer_load_dwordx4 v[36:39],v0,s[20:23],s93 offen offset:1024 sc1
s_mov_b32 s55,224
s_bitcmp1_b32 s55,6
s_cbranch_scc0 rdn_100907
s_waitcnt vmcnt(6)
v_max3_u32 v124,v40,v41,v42
v_max_u32 v124,v124,v43
v_cmp_eq_u32 vcc,-1,v124
s_cbranch_vccnz rfa_100908
buffer_load_dword v125,off,s[20:23],s92 sc1
s_bitset0_b32 s55,6
s_cmp_eq_u32 s55,0
s_cbranch_scc1 segb_100664
s_branch rnx_100909
rdn_100907:
buffer_load_dword v125,off,s[20:23],s92 sc1
s_branch rnx_100909
rfa_100908:
buffer_load_dwordx4 v[40:43],v0,s[20:23],s93 offen offset:2048 sc1
rnx_100909:
s_bitcmp1_b32 s55,7
s_cbranch_scc0 rdn_100910
s_waitcnt vmcnt(6)
v_max3_u32 v124,v44,v45,v46
v_max_u32 v124,v124,v47
v_cmp_eq_u32 vcc,-1,v124
s_cbranch_vccnz rfa_100911
buffer_load_dword v125,off,s[20:23],s92 sc1
s_bitset0_b32 s55,7
s_cmp_eq_u32 s55,0
s_cbranch_scc1 segb_100664
s_branch rnx_100912
rdn_100910:
buffer_load_dword v125,off,s[20:23],s92 sc1
s_branch rnx_100912
rfa_100911:
buffer_load_dwordx4 v[44:47],v0,s[20:23],s93 offen offset:3072 sc1
rnx_100912:
rot_100906:
s_bitcmp1_b32 s55,5
s_cbranch_scc0 rdn_100913
s_waitcnt vmcnt(2)
v_max3_u32 v124,v36,v37,v38
v_max_u32 v124,v124,v39
v_cmp_eq_u32 vcc,-1,v124
s_cbranch_vccnz rfa_100914
buffer_load_dword v125,off,s[20:23],s92 sc1
s_bitset0_b32 s55,5
v_smfmac_f32_16x16x64_bf16 v[64:67],v[36:39],a[96:103],v1
v_smfmac_f32_16x16x64_bf16 v[68:71],v[36:39],a[104:111],v1
v_smfmac_f32_16x16x64_bf16 v[72:75],v[36:39],a[112:119],v1
v_smfmac_f32_16x16x64_bf16 v[76:79],v[36:39],a[120:127],v1
s_cmp_eq_u32 s55,0
s_cbranch_scc1 segb_100664
s_branch rnx_100915
rdn_100913:
buffer_load_dword v125,off,s[20:23],s92 sc1
s_branch rnx_100915
rfa_100914:
buffer_load_dwordx4 v[36:39],v0,s[20:23],s93 offen offset:1024 sc1
rnx_100915:
s_bitcmp1_b32 s55,6
s_cbranch_scc0 rdn_100916
s_waitcnt vmcnt(2)
v_max3_u32 v124,v40,v41,v42
v_max_u32 v124,v124,v43
v_cmp_eq_u32 vcc,-1,v124
s_cbranch_vccnz rfa_100917
buffer_load_dword v125,off,s[20:23],s92 sc1
s_bitset0_b32 s55,6
s_cmp_eq_u32 s55,0
s_cbranch_scc1 segb_100664
s_branch rnx_100918
rdn_100916:
buffer_load_dword v125,off,s[20:23],s92 sc1
s_branch rnx_100918
rfa_100917:
buffer_load_dwordx4 v[40:43],v0,s[20:23],s93 offen offset:2048 sc1
rnx_100918:
s_bitcmp1_b32 s55,7
s_cbranch_scc0 rdn_100919
s_waitcnt vmcnt(2)
v_max3_u32 v124,v44,v45,v46
v_max_u32 v124,v124,v47
v_cmp_eq_u32 vcc,-1,v124
s_cbranch_vccnz rfa_100920
buffer_load_dword v125,off,s[20:23],s92 sc1
s_bitset0_b32 s55,7
s_cmp_eq_u32 s55,0
s_cbranch_scc1 segb_100664
s_branch rnx_100921
rdn_100919:
buffer_load_dword v125,off,s[20:23],s92 sc1
s_branch rnx_100921
rfa_100920:
buffer_load_dwordx4 v[44:47],v0,s[20:23],s93 offen offset:3072 sc1
rnx_100921:
s_sub_u32 s90,s90,1
s_cmp_gt_i32 s90,0
s_cbranch_scc1 rot_100906
s_mov_b32 s55,0
s_branch segb_100664
fl_100672:
flb_100680:
s_mov_b32 s55,192
s_bitcmp1_b32 s55,6
s_cbranch_scc0 rdn_100923
s_waitcnt vmcnt(6)
v_max3_u32 v124,v40,v41,v42
v_max_u32 v124,v124,v43
v_cmp_eq_u32 vcc,-1,v124
s_cbranch_vccnz rfa_100924
buffer_load_dword v125,off,s[20:23],s92 sc1
s_bitset0_b32 s55,6
s_cmp_eq_u32 s55,0
s_cbranch_scc1 segb_100664
s_branch rnx_100925
rdn_100923:
buffer_load_dword v125,off,s[20:23],s92 sc1
s_branch rnx_100925
rfa_100924:
buffer_load_dwordx4 v[40:43],v0,s[20:23],s93 offen offset:2048 sc1
rnx_100925:
s_bitcmp1_b32 s55,7
s_cbranch_scc0 rdn_100926
s_waitcnt vmcnt(6)
v_max3_u32 v124,v44,v45,v46
v_max_u32 v124,v124,v47
v_cmp_eq_u32 vcc,-1,v124
s_cbranch_vccnz rfa_100927
buffer_load_dword v125,off,s[20:23],s92 sc1
s_bitset0_b32 s55,7
s_cmp_eq_u32 s55,0
s_cbranch_scc1 segb_100664
s_branch rnx_100928
rdn_100926:
buffer_load_dword v125,off,s[20:23],s92 sc1
s_branch rnx_100928
rfa_100927:
buffer_load_dwordx4 v[44:47],v0,s[20:23],s93 offen offset:3072 sc1
rnx_100928:
rot_100922:
s_bitcmp1_b32 s55,6
s_cbranch_scc0 rdn_100929
s_waitcnt vmcnt(1)
v_max3_u32 v124,v40,v41,v42
v_max_u32 v124,v124,v43
v_cmp_eq_u32 vcc,-1,v124
s_cbranch_vccnz rfa_100930
buffer_load_dword v125,off,s[20:23],s92 sc1
s_bitset0_b32 s55,6
s_cmp_eq_u32 s55,0
s_cbranch_scc1 segb_100664
s_branch rnx_100931
rdn_100929:
buffer_load_dword v125,off,s[20:23],s92 sc1
s_branch rnx_100931
rfa_100930:
buffer_load_dwordx4 v[40:43],v0,s[20:23],s93 offen offset:2048 sc1
rnx_100931:
s_bitcmp1_b32 s55,7
s_cbranch_scc0 rdn_100932
s_waitcnt vmcnt(1)
v_max3_u32 v124,v44,v45,v46
v_max_u32 v124,v124,v47
v_cmp_eq_u32 vcc,-1,v124
s_cbranch_vccnz rfa_100933
buffer_load_dword v125,off,s[20:23],s92 sc1
s_bitset0_b32 s55,7
s_cmp_eq_u32 s55,0
s_cbranch_scc1 segb_100664
s_branch rnx_100934
rdn_100932:
buffer_load_dword v125,off,s[20:23],s92 sc1
s_branch rnx_100934
rfa_100933:
buffer_load_dwordx4 v[44:47],v0,s[20:23],s93 offen offset:3072 sc1
rnx_100934:
s_sub_u32 s90,s90,1
s_cmp_gt_i32 s90,0
s_cbranch_scc1 rot_100922
s_mov_b32 s55,0
s_branch segb_100664
dfl_100875:
buffer_load_dwordx4 v[20:23],v0,s[20:23],s92 offen offset:1024 sc1
s_bitset1_b32 s55,1
buffer_load_dwordx4 v[36:39],v0,s[20:23],s93 offen offset:1024 sc1
s_waitcnt vmcnt(5)
v_max3_u32 v124,v24,v25,v26
v_max_u32 v124,v124,v27
v_cmp_eq_u32 vcc,-1,v124
s_cbranch_vccnz dfl_100876
s_branch dseg_100879
dfl_100876:
buffer_load_dwordx4 v[24:27],v0,s[20:23],s92 offen offset:2048 sc1
s_bitset1_b32 s55,2
buffer_load_dwordx4 v[40:43],v0,s[20:23],s93 offen offset:2048 sc1
buffer_load_dwordx4 v[44:47],v0,s[20:23],s93 offen offset:3072 sc1
s_waitcnt vmcnt(7)
v_max3_u32 v124,v28,v29,v30
v_max_u32 v124,v124,v31
v_cmp_eq_u32 vcc,-1,v124
s_cbranch_vccnz dfl_100877
s_branch dseg_100880
dfl_100877:
buffer_load_dwordx4 v[28:31],v0,s[20:23],s92 offen offset:3072 sc1
s_bitset1_b32 s55,3
s_branch lap2_100881
dseg_100879:
v_smfmac_f32_16x16x64_bf16 v[64:67],v[24:27],a[160:167],v1
buffer_load_dword v125,off,s[20:23],s92 sc1
buffer_load_dwordx4 v[40:43],v0,s[20:23],s93 offen offset:2048 sc1
buffer_load_dwordx4 v[44:47],v0,s[20:23],s93 offen offset:3072 sc1
s_waitcnt vmcnt(7)
v_max3_u32 v124,v28,v29,v30
v_smfmac_f32_16x16x64_bf16 v[68:71],v[24:27],a[168:175],v1
v_max_u32 v124,v124,v31
v_cmp_eq_u32 vcc,-1,v124
v_smfmac_f32_16x16x64_bf16 v[72:75],v[24:27],a[176:183],v1
v_smfmac_f32_16x16x64_bf16 v[76:79],v[24:27],a[184:191],v1
s_cbranch_vccnz dfl_100877
dseg_100880:
v_smfmac_f32_16x16x64_bf16 v[64:67],v[28:31],a[224:231],v1
buffer_load_dword v125,off,s[20:23],s92 sc1
v_smfmac_f32_16x16x64_bf16 v[68:71],v[28:31],a[232:239],v1
v_smfmac_f32_16x16x64_bf16 v[72:75],v[28:31],a[240:247],v1
v_smfmac_f32_16x16x64_bf16 v[76:79],v[28:31],a[248:255],v1
lap2_100881:
s_bitcmp1_b32 s55,0
s_cbranch_scc0 l2s_100935
s_waitcnt vmcnt(7)
v_max3_u32 v124,v16,v17,v18
v_max_u32 v124,v124,v19
v_cmp_eq_u32 vcc,-1,v124
s_cbranch_vccnz l2s_100935
s_bitset0_b32 s55,0
v_smfmac_f32_16x16x64_bf16 v[64:67],v[16:19],a[32:39],v1
v_smfmac_f32_16x16x64_bf16 v[68:71],v[16:19],a[40:47],v1
v_smfmac_f32_16x16x64_bf16 v[72:75],v[16:19],a[48:55],v1
v_smfmac_f32_16x16x64_bf16 v[76:79],v[16:19],a[56:63],v1
l2s_100935:
s_bitcmp1_b32 s55,1
s_cbranch_scc0 l2s_100937
s_waitcnt vmcnt(5)
v_max3_u32 v124,v20,v21,v22
v_max_u32 v124,v124,v23
v_cmp_eq_u32 vcc,-1,v124
s_cbranch_vccnz l2s_100937
s_bitset0_b32 s55,1
v_smfmac_f32_16x16x64_bf16 v[64:67],v[20:23],a[96:103],v1
v_smfmac_f32_16x16x64_bf16 v[68:71],v[20:23],a[104:111],v1
v_smfmac_f32_16x16x64_bf16 v[72:75],v[20:23],a[112:119],v1
v_smfmac_f32_16x16x64_bf16 v[76:79],v[20:23],a[120:127],v1
l2s_100937:
s_bitcmp1_b32 s55,2
s_cbranch_scc0 l2s_100939
s_waitcnt vmcnt(3)
v_max3_u32 v124,v24,v25,v26
v_max_u32 v124,v124,v27
v_cmp_eq_u32 vcc,-1,v124
s_cbranch_vccnz l2s_100939
s_bitset0_b32 s55,2
v_smfmac_f32_16x16x64_bf16 v[64:67],v[24:27],a[160:167],v1
v_smfmac_f32_16x16x64_bf16 v[68:71],v[24:27],a[168:175],v1
v_smfmac_f32_16x16x64_bf16 v[72:75],v[24:27],a[176:183],v1
v_smfmac_f32_16x16x64_bf16 v[76:79],v[24:27],a[184:191],v1
l2s_100939:
s_bitcmp1_b32 s55,3
s_cbranch_scc0 l2s_100941
s_waitcnt vmcnt(0)
v_max3_u32 v124,v28,v29,v30
v_max_u32 v124,v124,v31
v_cmp_eq_u32 vcc,-1,v124
s_cbranch_vccnz l2s_100941
s_bitset0_b32 s55,3
v_smfmac_f32_16x16x64_bf16 v[64:67],v[28:31],a[224:231],v1
v_smfmac_f32_16x16x64_bf16 v[68:71],v[28:31],a[232:239],v1
v_smfmac_f32_16x16x64_bf16 v[72:75],v[28:31],a[240:247],v1
v_smfmac_f32_16x16x64_bf16 v[76:79],v[28:31],a[248:255],v1
l2s_100941:
s_cmp_eq_u32 s55,0
s_cbranch_scc0 lfb_100882
Ldone_100883:
s_waitcnt vmcnt(6)
v_max3_u32 v124,v32,v33,v34
v_max_u32 v124,v124,v35
v_cmp_eq_u32 vcc,-1,v124
s_cbranch_vccnz flb_100678
s_branch segb_100662
lfb_100882:
s_bitcmp1_b32 s55,0
s_cbranch_scc0 dsk_100943
buffer_load_dwordx4 v[16:19],v0,s[20:23],s92 offen offset:0 sc1
dsk_100943:
s_bitcmp1_b32 s55,1
s_cbranch_scc0 dsk_100944
buffer_load_dwordx4 v[20:23],v0,s[20:23],s92 offen offset:1024 sc1
dsk_100944:
s_bitcmp1_b32 s55,2
s_cbranch_scc0 dsk_100945
buffer_load_dwordx4 v[24:27],v0,s[20:23],s92 offen offset:2048 sc1
dsk_100945:
s_bitcmp1_b32 s55,3
s_cbranch_scc0 dsk_100946
buffer_load_dwordx4 v[28:31],v0,s[20:23],s92 offen offset:3072 sc1
dsk_100946:
s_bitcmp1_b32 s55,0
s_cbranch_scc0 dsk_100947
s_waitcnt vmcnt(2)
v_max3_u32 v124,v16,v17,v18
v_max_u32 v124,v124,v19
v_cmp_eq_u32 vcc,-1,v124
s_cbranch_vccz dgo_100948
s_nop 15
buffer_load_dwordx4 v[104:107],v0,s[20:23],s92 offen offset:0 sc1
s_nop 15
buffer_load_dwordx4 v[108:111],v0,s[20:23],s92 offen offset:0 sc1
dlp_100949:
s_waitcnt vmcnt(2)
v_max3_u32 v124,v16,v17,v18
v_max_u32 v124,v124,v19
v_cmp_eq_u32 vcc,-1,v124
s_cbranch_vccz dgo_100948
buffer_load_dwordx4 v[16:19],v0,s[20:23],s92 offen offset:0 sc1
s_waitcnt vmcnt(2)
v_max3_u32 v124,v104,v105,v106
v_max_u32 v124,v124,v107
v_cmp_eq_u32 vcc,-1,v124
s_cbranch_vccz dcp_100951
buffer_load_dwordx4 v[104:107],v0,s[20:23],s92 offen offset:0 sc1
s_waitcnt vmcnt(2)
v_max3_u32 v124,v108,v109,v110
v_max_u32 v124,v124,v111
v_cmp_eq_u32 vcc,-1,v124
s_cbranch_vccz dcp_100952
buffer_load_dwordx4 v[108:111],v0,s[20:23],s92 offen offset:0 sc1
s_sub_u32 s90,s90,1
s_cmp_gt_i32 s90,0
s_cbranch_scc1 dlp_100949
s_branch dgo_100948
dcp_100951:
v_mov_b32 v16,v104
v_mov_b32 v17,v105
v_mov_b32 v18,v106
v_mov_b32 v19,v107
s_nop 1
s_branch dgo_100948
dcp_100952:
v_mov_b32 v16,v108
v_mov_b32 v17,v109
v_mov_b32 v18,v110
v_mov_b32 v19,v111
s_nop 1
dgo_100948:
v_smfmac_f32_16x16x64_bf16 v[64:67],v[16:19],a[32:39],v1
v_smfmac_f32_16x16x64_bf16 v[68:71],v[16:19],a[40:47],v1
v_smfmac_f32_16x16x64_bf16 v[72:75],v[16:19],a[48:55],v1
v_smfmac_f32_16x16x64_bf16 v[76:79],v[16:19],a[56:63],v1
dsk_100947:
s_bitcmp1_b32 s55,1
s_cbranch_scc0 dsk_100953
s_waitcnt vmcnt(2)
v_max3_u32 v124,v20,v21,v22
v_max_u32 v124,v124,v23
v_cmp_eq_u32 vcc,-1,v124
s_cbranch_vccz dgo_100954
s_nop 15
buffer_load_dwordx4 v[104:107],v0,s[20:23],s92 offen offset:1024 sc1
s_nop 15
buffer_load_dwordx4 v[108:111],v0,s[20:23],s92 offen offset:1024 sc1
dlp_100955:
s_waitcnt vmcnt(2)
v_max3_u32 v124,v20,v21,v22
v_max_u32 v124,v124,v23
v_cmp_eq_u32 vcc,-1,v124
s_cbranch_vccz dgo_100954
buffer_load_dwordx4 v[20:23],v0,s[20:23],s92 offen offset:1024 sc1
s_waitcnt vmcnt(2)
v_max3_u32 v124,v104,v105,v106
v_max_u32 v124,v124,v107
v_cmp_eq_u32 vcc,-1,v124
s_cbranch_vccz dcp_100957
buffer_load_dwordx4 v[104:107],v0,s[20:23],s92 offen offset:1024 sc1
s_waitcnt vmcnt(2)
v_max3_u32 v124,v108,v109,v110
v_max_u32 v124,v124,v111
v_cmp_eq_u32 vcc,-1,v124
s_cbranch_vccz dcp_100958
buffer_load_dwordx4 v[108:111],v0,s[20:23],s92 offen offset:1024 sc1
s_sub_u32 s90,s90,1
s_cmp_gt_i32 s90,0
s_cbranch_scc1 dlp_100955
s_branch dgo_100954
dcp_100957:
v_mov_b32 v20,v104
v_mov_b32 v21,v105
v_mov_b32 v22,v106
v_mov_b32 v23,v107
s_nop 1
s_branch dgo_100954
dcp_100958:
v_mov_b32 v20,v108
v_mov_b32 v21,v109
v_mov_b32 v22,v110
v_mov_b32 v23,v111
s_nop 1
dgo_100954:
v_smfmac_f32_16x16x64_bf16 v[64:67],v[20:23],a[96:103],v1
v_smfmac_f32_16x16x64_bf16 v[68:71],v[20:23],a[104:111],v1
v_smfmac_f32_16x16x64_bf16 v[72:75],v[20:23],a[112:119],v1
v_smfmac_f32_16x16x64_bf16 v[76:79],v[20:23],a[120:127],v1
dsk_100953:
s_bitcmp1_b32 s55,2
s_cbranch_scc0 dsk_100959
s_waitcnt vmcnt(2)
v_max3_u32 v124,v24,v25,v26
v_max_u32 v124,v124,v27
v_cmp_eq_u32 vcc,-1,v124
s_cbranch_vccz dgo_100960
s_nop 15
buffer_load_dwordx4 v[104:107],v0,s[20:23],s92 offen offset:2048 sc1
s_nop 15
buffer_load_dwordx4 v[108:111],v0,s[20:23],s92 offen offset:2048 sc1
dlp_100961:
s_waitcnt vmcnt(2)
v_max3_u32 v124,v24,v25,v26
v_max_u32 v124,v124,v27
v_cmp_eq_u32 vcc,-1,v124
s_cbranch_vccz dgo_100960
buffer_load_dwordx4 v[24:27],v0,s[20:23],s92 offen offset:2048 sc1
s_waitcnt vmcnt(2)
v_max3_u32 v124,v104,v105,v106
v_max_u32 v124,v124,v107
v_cmp_eq_u32 vcc,-1,v124
s_cbranch_vccz dcp_100963
buffer_load_dwordx4 v[104:107],v0,s[20:23],s92 offen offset:2048 sc1
s_waitcnt vmcnt(2)
v_max3_u32 v124,v108,v109,v110
v_max_u32 v124,v124,v111
v_cmp_eq_u32 vcc,-1,v124
s_cbranch_vccz dcp_100964
buffer_load_dwordx4 v[108:111],v0,s[20:23],s92 offen offset:2048 sc1
s_sub_u32 s90,s90,1
s_cmp_gt_i32 s90,0
s_cbranch_scc1 dlp_100961
s_branch dgo_100960
dcp_100963:
v_mov_b32 v24,v104
v_mov_b32 v25,v105
v_mov_b32 v26,v106
v_mov_b32 v27,v107
s_nop 1
s_branch dgo_100960
dcp_100964:
v_mov_b32 v24,v108
v_mov_b32 v25,v109
v_mov_b32 v26,v110
v_mov_b32 v27,v111
s_nop 1
dgo_100960:
v_smfmac_f32_16x16x64_bf16 v[64:67],v[24:27],a[160:167],v1
v_smfmac_f32_16x16x64_bf16 v[68:71],v[24:27],a[168:175],v1
v_smfmac_f32_16x16x64_bf16 v[72:75],v[24:27],a[176:183],v1
v_smfmac_f32_16x16x64_bf16 v[76:79],v[24:27],a[184:191],v1
dsk_100959:
s_bitcmp1_b32 s55,3
s_cbranch_scc0 dsk_100965
s_waitcnt vmcnt(2)
v_max3_u32 v124,v28,v29,v30
v_max_u32 v124,v124,v31
v_cmp_eq_u32 vcc,-1,v124
s_cbranch_vccz dgo_100966
s_nop 15
buffer_load_dwordx4 v[104:107],v0,s[20:23],s92 offen offset:3072 sc1
s_nop 15
buffer_load_dwordx4 v[108:111],v0,s[20:23],s92 offen offset:3072 sc1
dlp_100967:
s_waitcnt vmcnt(2)
v_max3_u32 v124,v28,v29,v30
v_max_u32 v124,v124,v31
v_cmp_eq_u32 vcc,-1,v124
s_cbranch_vccz dgo_100966
buffer_load_dwordx4 v[28:31],v0,s[20:23],s92 offen offset:3072 sc1
s_waitcnt vmcnt(2)
v_max3_u32 v124,v104,v105,v106
v_max_u32 v124,v124,v107
v_cmp_eq_u32 vcc,-1,v124
s_cbranch_vccz dcp_100969
buffer_load_dwordx4 v[104:107],v0,s[20:23],s92 offen offset:3072 sc1
s_waitcnt vmcnt(2)
v_max3_u32 v124,v108,v109,v110
v_max_u32 v124,v124,v111
v_cmp_eq_u32 vcc,-1,v124
s_cbranch_vccz dcp_100970
buffer_load_dwordx4 v[108:111],v0,s[20:23],s92 offen offset:3072 sc1
s_sub_u32 s90,s90,1
s_cmp_gt_i32 s90,0
s_cbranch_scc1 dlp_100967
s_branch dgo_100966
dcp_100969:
v_mov_b32 v28,v104
v_mov_b32 v29,v105
v_mov_b32 v30,v106
v_mov_b32 v31,v107
s_nop 1
s_branch dgo_100966
dcp_100970:
v_mov_b32 v28,v108
v_mov_b32 v29,v109
v_mov_b32 v30,v110
v_mov_b32 v31,v111
s_nop 1
dgo_100966:
v_smfmac_f32_16x16x64_bf16 v[64:67],v[28:31],a[224:231],v1
v_smfmac_f32_16x16x64_bf16 v[68:71],v[28:31],a[232:239],v1
v_smfmac_f32_16x16x64_bf16 v[72:75],v[28:31],a[240:247],v1
v_smfmac_f32_16x16x64_bf16 v[76:79],v[28:31],a[248:255],v1
dsk_100965:
s_mov_b32 s55,0
s_branch Ldone_100883
slowA_100682:
buffer_load_dwordx4 v[44:47],v0,s[20:23],s93 offen offset:3072 sc1
dsk_100971:
s_bitcmp1_b32 s55,7
s_cbranch_scc0 dsk_100972
s_waitcnt vmcnt(2)
v_max3_u32 v124,v44,v45,v46
v_max_u32 v124,v124,v47
v_cmp_eq_u32 vcc,-1,v124
s_cbranch_vccz dgo_100973
s_nop 15
s_nop 3
buffer_load_dwordx4 v[104:107],v0,s[20:23],s93 offen offset:3072 sc1
s_nop 15
s_nop 3
buffer_load_dwordx4 v[108:111],v0,s[20:23],s93 offen offset:3072 sc1
dlp_100974:
s_waitcnt vmcnt(2)
v_max3_u32 v124,v44,v45,v46
v_max_u32 v124,v124,v47
v_cmp_eq_u32 vcc,-1,v124
s_cbranch_vccz dgo_100973
buffer_load_dwordx4 v[44:47],v0,s[20:23],s93 offen offset:3072 sc1
s_waitcnt vmcnt(2)
v_max3_u32 v124,v104,v105,v106
v_max_u32 v124,v124,v107
v_cmp_eq_u32 vcc,-1,v124
s_cbranch_vccz dcp_100976
buffer_load_dwordx4 v[104:107],v0,s[20:23],s93 offen offset:3072 sc1
s_waitcnt vmcnt(2)
v_max3_u32 v124,v108,v109,v110
v_max_u32 v124,v124,v111
v_cmp_eq_u32 vcc,-1,v124
s_cbranch_vccz dcp_100977
buffer_load_dwordx4 v[108:111],v0,s[20:23],s93 offen offset:3072 sc1
s_sub_u32 s90,s90,1
s_cmp_gt_i32 s90,0
s_cbranch_scc1 dlp_100974
s_branch dgo_100973
dcp_100976:
v_mov_b32 v44,v104
v_mov_b32 v45,v105
v_mov_b32 v46,v106
v_mov_b32 v47,v107
s_nop 1
s_branch dgo_100973
dcp_100977:
v_mov_b32 v44,v108
v_mov_b32 v45,v109
v_mov_b32 v46,v110
v_mov_b32 v47,v111
s_nop 1
dgo_100973:
dsk_100972:
s_mov_b32 s55,0
s_branch segb_100664
recfin_100192:
s_endpgm
.section .rodata,"a"
.p2align 6
.amdhsa_kernel init_kernel
  .amdhsa_next_free_vgpr 48
  .amdhsa_next_free_sgpr 48
  .amdhsa_accum_offset 48
  .amdhsa_group_segment_fixed_size 0
  .amdhsa_kernarg_size 136
  .amdhsa_user_sgpr_count 2
  .amdhsa_user_sgpr_kernarg_segment_ptr 1
  .amdhsa_system_sgpr_workgroup_id_x 1
.end_amdhsa_kernel
.p2align 6
.amdhsa_kernel ln1_kernel
  .amdhsa_next_free_vgpr 96
  .amdhsa_next_free_sgpr 80
  .amdhsa_accum_offset 96
  .amdhsa_group_segment_fixed_size 0
  .amdhsa_kernarg_size 136
  .amdhsa_user_sgpr_count 2
  .amdhsa_user_sgpr_kernarg_segment_ptr 1
  .amdhsa_system_sgpr_workgroup_id_x 1
.end_amdhsa_kernel
.p2align 6
.amdhsa_kernel flow_kernel
  .amdhsa_next_free_vgpr 512
  .amdhsa_next_free_sgpr 102
  .amdhsa_accum_offset 256
  .amdhsa_group_segment_fixed_size 0
  .amdhsa_kernarg_size 136
  .amdhsa_user_sgpr_count 2
  .amdhsa_user_sgpr_kernarg_segment_ptr 1
  .amdhsa_system_sgpr_workgroup_id_x 1
.end_amdhsa_kernel
```

```asm
; @launch kernel=init_kernel grid=(256,1,1) block=(1024,1,1) lds=32768
; @launch kernel=ln1_kernel grid=(512,1,1) block=(256,1,1) lds=2048
; @launch kernel=flow_kernel grid=(256,1,1) block=(256,1,1) lds=163840
.amdgcn_target "amdgcn-amd-amdhsa--gfx950"
.text
.globl init_kernel
.p2align 8
.type init_kernel,@function
init_kernel:
s_cmp_ge_u32 s2,256
s_cbranch_scc1 done_1
s_load_dwordx4 s[4:7],s[0:1],96
s_load_dwordx2 s[8:9],s[0:1],128
v_and_b32 v1,3,v0
v_lshrrev_b32 v2,2,v0
v_mul_u32_u24 v3,12288,v2
v_lshl_add_u32 v3,v1,4,v3
s_lshl_b32 s24,s2,6
v_lshlrev_b32 v4,1,v2
v_mov_b32 v40,-1
v_mov_b32 v41,-1
v_mov_b32 v42,-1
v_mov_b32 v43,-1
v_lshlrev_b32 v44,4,v0
s_lshl_b32 s28,s2,14
s_add_u32 s28,s28,142606336
s_waitcnt lgkmcnt(0)
s_mov_b32 s12,s4
s_and_b32 s13,s5,0xffff
s_mov_b32 s14,0x800
s_mov_b32 s15,0x20000
s_mov_b32 s16,s6
s_and_b32 s17,s7,0xffff
s_mov_b32 s18,0xc00000
s_mov_b32 s19,0x20000
s_mov_b32 s20,s8
s_and_b32 s21,s9,0xffff
s_mov_b32 s22,0x10000000
s_mov_b32 s23,0x20000
buffer_store_dwordx4 v[40:43],v44,s[20:23],s28 offen
s_cmp_ge_u32 s2,192
s_cbranch_scc1 nz_2
s_add_u32 s25,s24,0
buffer_load_dwordx4 v[16:19],v3,s[16:19],s25 offen
buffer_load_ushort v8,v4,s[12:15],0 offen offset:0
s_add_u32 s25,s24,3145728
buffer_load_dwordx4 v[20:23],v3,s[16:19],s25 offen
buffer_load_ushort v9,v4,s[12:15],0 offen offset:512
s_add_u32 s25,s24,6291456
buffer_load_dwordx4 v[24:27],v3,s[16:19],s25 offen
buffer_load_ushort v10,v4,s[12:15],0 offen offset:1024
s_add_u32 s25,s24,9437184
buffer_load_dwordx4 v[28:31],v3,s[16:19],s25 offen
buffer_load_ushort v11,v4,s[12:15],0 offen offset:1536
v_mov_b32 v32,0
v_mov_b32 v33,0
v_mov_b32 v34,0
v_mov_b32 v35,0
v_mov_b32 v36,0
v_mov_b32 v37,0
v_mov_b32 v38,0
v_mov_b32 v39,0
s_mov_b32 s26,0xbfb8aa3b
s_mov_b32 s27,0xffff0000
s_waitcnt vmcnt(0)
v_lshlrev_b32 v8,16,v8
v_mul_f32 v5,s26,v8
v_exp_f32 v5,v5
s_nop 0
v_add_f32 v5,1.0,v5
v_rcp_f32 v5,v5
s_nop 0
v_mul_f32 v5,v5,v8
v_cvt_pk_bf16_f32 v5,v5,v5
v_and_b32 v8,s27,v5
v_lshlrev_b32 v6,16,v16
v_and_b32 v7,s27,v16
v_fmac_f32 v32,v6,v8
v_fmac_f32 v33,v7,v8
v_lshlrev_b32 v6,16,v17
v_and_b32 v7,s27,v17
v_fmac_f32 v34,v6,v8
v_fmac_f32 v35,v7,v8
v_lshlrev_b32 v6,16,v18
v_and_b32 v7,s27,v18
v_fmac_f32 v36,v6,v8
v_fmac_f32 v37,v7,v8
v_lshlrev_b32 v6,16,v19
v_and_b32 v7,s27,v19
v_fmac_f32 v38,v6,v8
v_fmac_f32 v39,v7,v8
v_lshlrev_b32 v9,16,v9
v_mul_f32 v5,s26,v9
v_exp_f32 v5,v5
s_nop 0
v_add_f32 v5,1.0,v5
v_rcp_f32 v5,v5
s_nop 0
v_mul_f32 v5,v5,v9
v_cvt_pk_bf16_f32 v5,v5,v5
v_and_b32 v9,s27,v5
v_lshlrev_b32 v6,16,v20
v_and_b32 v7,s27,v20
v_fmac_f32 v32,v6,v9
v_fmac_f32 v33,v7,v9
v_lshlrev_b32 v6,16,v21
v_and_b32 v7,s27,v21
v_fmac_f32 v34,v6,v9
v_fmac_f32 v35,v7,v9
v_lshlrev_b32 v6,16,v22
v_and_b32 v7,s27,v22
v_fmac_f32 v36,v6,v9
v_fmac_f32 v37,v7,v9
v_lshlrev_b32 v6,16,v23
v_and_b32 v7,s27,v23
v_fmac_f32 v38,v6,v9
v_fmac_f32 v39,v7,v9
v_lshlrev_b32 v10,16,v10
v_mul_f32 v5,s26,v10
v_exp_f32 v5,v5
s_nop 0
v_add_f32 v5,1.0,v5
v_rcp_f32 v5,v5
s_nop 0
v_mul_f32 v5,v5,v10
v_cvt_pk_bf16_f32 v5,v5,v5
v_and_b32 v10,s27,v5
v_lshlrev_b32 v6,16,v24
v_and_b32 v7,s27,v24
v_fmac_f32 v32,v6,v10
v_fmac_f32 v33,v7,v10
v_lshlrev_b32 v6,16,v25
v_and_b32 v7,s27,v25
v_fmac_f32 v34,v6,v10
v_fmac_f32 v35,v7,v10
v_lshlrev_b32 v6,16,v26
v_and_b32 v7,s27,v26
v_fmac_f32 v36,v6,v10
v_fmac_f32 v37,v7,v10
v_lshlrev_b32 v6,16,v27
v_and_b32 v7,s27,v27
v_fmac_f32 v38,v6,v10
v_fmac_f32 v39,v7,v10
v_lshlrev_b32 v11,16,v11
v_mul_f32 v5,s26,v11
v_exp_f32 v5,v5
s_nop 0
v_add_f32 v5,1.0,v5
v_rcp_f32 v5,v5
s_nop 0
v_mul_f32 v5,v5,v11
v_cvt_pk_bf16_f32 v5,v5,v5
v_and_b32 v11,s27,v5
v_lshlrev_b32 v6,16,v28
v_and_b32 v7,s27,v28
v_fmac_f32 v32,v6,v11
v_fmac_f32 v33,v7,v11
v_lshlrev_b32 v6,16,v29
v_and_b32 v7,s27,v29
v_fmac_f32 v34,v6,v11
v_fmac_f32 v35,v7,v11
v_lshlrev_b32 v6,16,v30
v_and_b32 v7,s27,v30
v_fmac_f32 v36,v6,v11
v_fmac_f32 v37,v7,v11
v_lshlrev_b32 v6,16,v31
v_and_b32 v7,s27,v31
v_fmac_f32 v38,v6,v11
v_fmac_f32 v39,v7,v11
v_lshlrev_b32 v5,5,v0
ds_write_b128 v5,v[32:35]
ds_write_b128 v5,v[36:39] offset:16
v_and_b32 v1,31,v0
v_lshrrev_b32 v2,5,v0
v_lshlrev_b32 v3,10,v2
v_lshl_add_u32 v3,v1,2,v3
s_waitcnt lgkmcnt(0)
s_barrier
ds_read_b32 v8,v3 offset:0
ds_read_b32 v9,v3 offset:128
ds_read_b32 v10,v3 offset:256
ds_read_b32 v11,v3 offset:384
ds_read_b32 v12,v3 offset:512
ds_read_b32 v13,v3 offset:640
ds_read_b32 v14,v3 offset:768
ds_read_b32 v15,v3 offset:896
s_waitcnt lgkmcnt(0)
v_add_f32 v8,v8,v9
v_add_f32 v10,v10,v11
v_add_f32 v12,v12,v13
v_add_f32 v14,v14,v15
v_add_f32 v8,v8,v10
v_add_f32 v12,v12,v14
v_add_f32 v8,v8,v12
s_barrier
v_lshlrev_b32 v5,2,v0
ds_write_b32 v5,v8
v_and_b32 v2,3,v2
v_lshlrev_b32 v3,10,v2
v_lshl_add_u32 v3,v1,2,v3
s_waitcnt lgkmcnt(0)
s_barrier
ds_read_b32 v8,v3 offset:0
ds_read_b32 v9,v3 offset:128
ds_read_b32 v10,v3 offset:256
ds_read_b32 v11,v3 offset:384
ds_read_b32 v12,v3 offset:512
ds_read_b32 v13,v3 offset:640
ds_read_b32 v14,v3 offset:768
ds_read_b32 v15,v3 offset:896
s_waitcnt lgkmcnt(0)
v_add_f32 v8,v8,v9
v_add_f32 v10,v10,v11
v_add_f32 v12,v12,v13
v_add_f32 v14,v14,v15
v_add_f32 v8,v8,v10
v_add_f32 v12,v12,v14
v_add_f32 v8,v8,v12
s_barrier
ds_write_b32 v5,v8
v_lshlrev_b32 v3,2,v1
s_waitcnt lgkmcnt(0)
s_barrier
ds_read_b32 v8,v3 offset:0
ds_read_b32 v9,v3 offset:128
ds_read_b32 v10,v3 offset:256
ds_read_b32 v11,v3 offset:384
s_waitcnt lgkmcnt(0)
v_add_f32 v8,v8,v9
v_add_f32 v10,v10,v11
v_add_f32 v8,v8,v10
v_cvt_pk_bf16_f32 v8,v8,v8
v_and_b32 v8,s27,v8
s_lshl_b32 s24,s2,7
s_add_u32 s24,s24,267386880
v_cmp_gt_u32 vcc,32,v0
s_and_saveexec_b64 s[36:37],vcc
s_cbranch_execz done_1
buffer_store_dword v8,v3,s[20:23],s24 offen
s_branch done_1
nz_2:
s_sub_u32 s3,s2,192
s_lshl_b32 s28,s3,15
s_add_u32 s28,s28,134217728
buffer_store_dwordx4 v[40:43],v44,s[20:23],s28 offen
s_add_u32 s28,s28,16384
buffer_store_dwordx4 v[40:43],v44,s[20:23],s28 offen
s_add_u32 s28,s28,33554432
buffer_store_dwordx4 v[40:43],v44,s[20:23],s28 offen
s_sub_u32 s28,s28,16384
buffer_store_dwordx4 v[40:43],v44,s[20:23],s28 offen
v_mov_b32 v12,0
v_mov_b32 v13,0
v_mov_b32 v14,0
v_mov_b32 v15,0
s_cmp_ge_u32 s3,20
s_cbranch_scc1 done_1
s_lshl_b32 s28,s3,14
s_add_u32 s28,s28,138412032
s_cmp_lt_u32 s3,16
s_cbranch_scc1 n2_3
s_and_b32 s28,s3,1
s_lshl_b32 s28,s28,14
s_add_u32 s28,s28,209715200
s_cmp_lt_u32 s3,18
s_cselect_b32 s29,0,4227072
s_add_u32 s28,s28,s29
n2_3:
buffer_store_dwordx4 v[12:15],v44,s[20:23],s28 offen
done_1:
s_endpgm
.globl ln1_kernel
.p2align 8
.type ln1_kernel,@function
ln1_kernel:
s_cmp_ge_u32 s2,512
s_cbranch_scc1 done_4
s_load_dwordx2 s[4:5],s[0:1],0
s_load_dwordx2 s[8:9],s[0:1],128
v_and_b32 v1,63,v0
v_lshrrev_b32 v2,6,v0
s_and_b32 s40,s2,3
s_lshr_b32 s41,s2,2
s_lshl_b32 s41,s41,15
v_readfirstlane_b32 s50,v2
s_mov_b32 s73,0xffff0000
v_and_b32 v2,3,v1
v_lshrrev_b32 v3,2,v1
s_lshl_b32 s64,s40,2
v_add_u32 v4,s64,v2
s_lshl_b32 s65,s50,9
v_lshlrev_b32 v5,4,v3
v_add_u32 v5,s65,v5
v_lshl_add_u32 v8,v4,11,v5
v_lshlrev_b32 v9,1,v5
v_lshrrev_b32 v5,2,v3
v_and_b32 v3,3,v3
s_lshl_b32 s65,s50,13
v_lshlrev_b32 v5,10,v5
v_lshl_add_u32 v5,v3,8,v5
v_lshl_add_u32 v5,v4,4,v5
v_add_u32 v10,s65,v5
s_lshl_b32 s65,s50,9
v_lshlrev_b32 v5,3,v1
v_add_u32 v11,s65,v5
v_lshlrev_b32 v12,3,v2
s_waitcnt lgkmcnt(0)
s_mov_b32 s28,s4
s_and_b32 s29,s5,0xffff
s_mov_b32 s30,0x400000
s_mov_b32 s31,0x20000
s_mov_b32 s20,s8
s_and_b32 s21,s9,0xffff
s_mov_b32 s22,0x10000000
s_mov_b32 s23,0x20000
buffer_load_dwordx4 v[16:19],v8,s[28:31],s41 offen offset:0
buffer_load_dwordx4 v[20:23],v8,s[28:31],s41 offen offset:256
s_mov_b32 s64,267390976
buffer_load_dwordx4 v[48:51],v9,s[20:23],s64 offen offset:0
buffer_load_dwordx4 v[52:55],v9,s[20:23],s64 offen offset:16
buffer_load_dwordx4 v[56:59],v9,s[20:23],s64 offen offset:512
buffer_load_dwordx4 v[60:63],v9,s[20:23],s64 offen offset:528
s_mov_b32 s65,267386880
buffer_load_dwordx4 v[64:67],v9,s[20:23],s65 offen offset:0
buffer_load_dwordx4 v[68:71],v9,s[20:23],s65 offen offset:16
buffer_load_dwordx4 v[72:75],v9,s[20:23],s65 offen offset:512
buffer_load_dwordx4 v[76:79],v9,s[20:23],s65 offen offset:528
s_waitcnt vmcnt(8)
v_lshlrev_b32 v32,16,v16
v_and_b32 v33,s73,v16
v_lshlrev_b32 v34,16,v17
v_and_b32 v35,s73,v17
v_lshlrev_b32 v36,16,v18
v_and_b32 v37,s73,v18
v_lshlrev_b32 v38,16,v19
v_and_b32 v39,s73,v19
v_lshlrev_b32 v40,16,v20
v_and_b32 v41,s73,v20
v_lshlrev_b32 v42,16,v21
v_and_b32 v43,s73,v21
v_lshlrev_b32 v44,16,v22
v_and_b32 v45,s73,v22
v_lshlrev_b32 v46,16,v23
v_and_b32 v47,s73,v23
s_waitcnt vmcnt(0)
v_add_f32 v48,1.0,v48
v_add_f32 v49,1.0,v49
v_add_f32 v50,1.0,v50
v_add_f32 v51,1.0,v51
v_add_f32 v52,1.0,v52
v_add_f32 v53,1.0,v53
v_add_f32 v54,1.0,v54
v_add_f32 v55,1.0,v55
v_add_f32 v56,1.0,v56
v_add_f32 v57,1.0,v57
v_add_f32 v58,1.0,v58
v_add_f32 v59,1.0,v59
v_add_f32 v60,1.0,v60
v_add_f32 v61,1.0,v61
v_add_f32 v62,1.0,v62
v_add_f32 v63,1.0,v63
v_add_f32 v80,v32,v33
v_mul_f32 v81,v32,v32
v_add_f32 v82,v34,v35
v_mul_f32 v83,v33,v33
v_fmac_f32 v81,v34,v34
v_fmac_f32 v83,v35,v35
v_add_f32 v80,v80,v36
v_fmac_f32 v81,v36,v36
v_add_f32 v82,v82,v37
v_fmac_f32 v83,v37,v37
v_add_f32 v80,v80,v38
v_fmac_f32 v81,v38,v38
v_add_f32 v82,v82,v39
v_fmac_f32 v83,v39,v39
v_add_f32 v80,v80,v40
v_fmac_f32 v81,v40,v40
v_add_f32 v82,v82,v41
v_fmac_f32 v83,v41,v41
v_add_f32 v80,v80,v42
v_fmac_f32 v81,v42,v42
v_add_f32 v82,v82,v43
v_fmac_f32 v83,v43,v43
v_add_f32 v80,v80,v44
v_fmac_f32 v81,v44,v44
v_add_f32 v82,v82,v45
v_fmac_f32 v83,v45,v45
v_add_f32 v80,v80,v46
v_fmac_f32 v81,v46,v46
v_add_f32 v82,v82,v47
v_fmac_f32 v83,v47,v47
v_add_f32 v80,v80,v82
v_add_f32 v81,v81,v83
s_nop 0
v_add_f32_dpp v80,v80,v80 row_ror:4 row_mask:0xf bank_mask:0xf
v_add_f32_dpp v81,v81,v81 row_ror:4 row_mask:0xf bank_mask:0xf
s_nop 0
v_add_f32_dpp v80,v80,v80 row_ror:8 row_mask:0xf bank_mask:0xf
v_add_f32_dpp v81,v81,v81 row_ror:8 row_mask:0xf bank_mask:0xf
v_mov_b32 v82,v80
v_mov_b32 v83,v81
s_nop 0
v_permlane16_swap_b32 v82,v80
v_permlane16_swap_b32 v83,v81
v_add_f32 v80,v80,v82
v_add_f32 v81,v81,v83
v_mov_b32 v82,v80
v_mov_b32 v83,v81
s_nop 0
v_permlane32_swap_b32 v82,v80
v_permlane32_swap_b32 v83,v81
v_add_f32 v80,v80,v82
v_add_f32 v81,v81,v83
ds_write_b64 v11,v[80:81] offset:0
s_waitcnt lgkmcnt(0)
s_barrier
ds_read_b64 v[84:85],v12 offset:0
ds_read_b64 v[86:87],v12 offset:512
ds_read_b64 v[88:89],v12 offset:1024
ds_read_b64 v[90:91],v12 offset:1536
s_waitcnt lgkmcnt(0)
v_add_f32 v84,v84,v86
v_add_f32 v85,v85,v87
v_add_f32 v88,v88,v90
v_add_f32 v89,v89,v91
v_add_f32 v84,v84,v88
v_add_f32 v85,v85,v89
v_mul_f32 v80,0xba800000,v84
v_mul_f32 v86,v80,v80
v_mul_f32 v85,0x3a800000,v85
v_sub_f32 v85,v85,v86
v_max_f32 v85,0,v85
v_add_f32 v85,0x3727c5ac,v85
v_rsq_f32 v81,v85
s_nop 0
v_mul_f32 v80,v80,v81
v_fma_f32 v32,v32,v81,v80
v_fma_f32 v33,v33,v81,v80
v_fma_f32 v34,v34,v81,v80
v_fma_f32 v35,v35,v81,v80
v_fma_f32 v36,v36,v81,v80
v_fma_f32 v37,v37,v81,v80
v_fma_f32 v38,v38,v81,v80
v_fma_f32 v39,v39,v81,v80
v_fma_f32 v40,v40,v81,v80
v_fma_f32 v41,v41,v81,v80
v_fma_f32 v42,v42,v81,v80
v_fma_f32 v43,v43,v81,v80
v_fma_f32 v44,v44,v81,v80
v_fma_f32 v45,v45,v81,v80
v_fma_f32 v46,v46,v81,v80
v_fma_f32 v47,v47,v81,v80
v_fma_f32 v32,v32,v48,v64
v_fma_f32 v33,v33,v49,v65
v_fma_f32 v34,v34,v50,v66
v_fma_f32 v35,v35,v51,v67
v_fma_f32 v36,v36,v52,v68
v_fma_f32 v37,v37,v53,v69
v_fma_f32 v38,v38,v54,v70
v_fma_f32 v39,v39,v55,v71
v_fma_f32 v40,v40,v56,v72
v_fma_f32 v41,v41,v57,v73
v_fma_f32 v42,v42,v58,v74
v_fma_f32 v43,v43,v59,v75
v_fma_f32 v44,v44,v60,v76
v_fma_f32 v45,v45,v61,v77
v_fma_f32 v46,v46,v62,v78
v_fma_f32 v47,v47,v63,v79
v_cvt_pk_bf16_f32 v16,v32,v33
v_cvt_pk_bf16_f32 v17,v34,v35
v_cvt_pk_bf16_f32 v18,v36,v37
v_cvt_pk_bf16_f32 v19,v38,v39
v_cvt_pk_bf16_f32 v20,v40,v41
v_cvt_pk_bf16_f32 v21,v42,v43
v_cvt_pk_bf16_f32 v22,v44,v45
v_cvt_pk_bf16_f32 v23,v46,v47
s_add_u32 s41,s41,146800640
s_add_u32 s42,s41,4096
buffer_store_dwordx4 v[16:19],v10,s[20:23],s41 offen
buffer_store_dwordx4 v[20:23],v10,s[20:23],s42 offen
done_4:
s_endpgm
.globl flow_kernel
.p2align 8
.type flow_kernel,@function
flow_kernel:
s_cmp_ge_u32 s2,256
s_cbranch_scc1 done_5
s_load_dwordx2 s[18:19],s[0:1],128
s_getreg_b32 s51,hwreg(HW_REG_XCC_ID)
v_lshrrev_b32 v2,6,v0
v_and_b32 v1,63,v0
s_and_b32 s51,s51,7
v_readfirstlane_b32 s50,v2
s_mov_b32 s90,40000
v_mov_b32 v4,163824
s_waitcnt lgkmcnt(0)
s_mov_b32 s20,s18
s_and_b32 s21,s19,0xffff
s_mov_b32 s22,0x10000000
s_mov_b32 s23,0x20000
s_cmp_lg_u32 s50,0
s_cbranch_scc1 norole_6
s_mov_b64 exec,1
v_mov_b32 v3,1
s_lshl_b32 s52,s51,7
s_add_u32 s52,s52,138510336
buffer_atomic_add v3,off,s[20:23],s52 sc0 sc1
s_waitcnt vmcnt(0)
ds_write_b32 v4,v3
s_waitcnt lgkmcnt(0)
s_mov_b64 exec,-1
norole_6:
s_barrier
ds_read_b32 v3,v4
s_waitcnt lgkmcnt(0)
v_readfirstlane_b32 s49,v3
s_mov_b32 s56,2
s_lshl_b32 s58,s51,5
s_add_u32 s58,s58,s49
s_cmp_ge_u32 s49,32
s_cbranch_scc1 fl_bad
fl_disp:
v_mbcnt_lo_u32_b32 v1,-1,0
v_mbcnt_hi_u32_b32 v1,-1,v1
s_sub_u32 s59,s58,248
s_cbranch_scc1 nx_7
s_branch fl_w2
nx_7:
s_sub_u32 s59,s58,240
s_cbranch_scc1 nx_8
s_branch fl_w1
nx_8:
s_sub_u32 s59,s58,224
s_cbranch_scc1 nx_9
s_branch fl_att
nx_9:
s_sub_u32 s59,s58,220
s_cbranch_scc1 nx_10
s_branch fl_ln2
nx_10:
s_sub_u32 s59,s58,192
s_cbranch_scc1 nx_11
s_branch fl_w3
nx_11:
s_sub_u32 s59,s58,160
s_cbranch_scc1 nx_12
s_branch fl_w4
nx_12:
s_sub_u32 s59,s58,128
s_cbranch_scc1 nx_13
s_branch fl_wo
nx_13:
s_sub_u32 s59,s58,64
s_cbranch_scc1 nx_14
s_branch fl_qkv
nx_14:
s_branch fl_rec
fl_bad:
s_mov_b32 s67,0
s_cmp_eq_u32 s56,1
s_cbranch_scc1 vok_15
v_mbcnt_lo_u32_b32 v16,-1,0
v_and_b32 v16,7,v16
v_lshlrev_b32 v16,7,v16
s_mov_b32 s64,138510336
vpoll_16:
buffer_load_dword v17,v16,s[20:23],s64 offen sc1
s_waitcnt vmcnt(0)
v_readlane_b32 s92,v17,0
v_readlane_b32 s93,v17,1
v_readlane_b32 s94,v17,2
v_readlane_b32 s95,v17,3
v_readlane_b32 s96,v17,4
v_readlane_b32 s97,v17,5
v_readlane_b32 s98,v17,6
v_readlane_b32 s99,v17,7
s_add_u32 s65,s92,s93
s_add_u32 s65,s65,s94
s_add_u32 s65,s65,s95
s_add_u32 s65,s65,s96
s_add_u32 s65,s65,s97
s_add_u32 s65,s65,s98
s_add_u32 s65,s65,s99
s_cmp_ge_u32 s65,256
s_cbranch_scc1 vgot_17
s_sleep 4
s_sub_u32 s90,s90,1
s_cmp_gt_i32 s90,0
s_cbranch_scc1 vpoll_16
vgot_17:
s_min_u32 s65,s92,s93
s_min_u32 s65,s65,s94
s_min_u32 s65,s65,s95
s_min_u32 s65,s65,s96
s_min_u32 s65,s65,s97
s_min_u32 s65,s65,s98
s_min_u32 s65,s65,s99
s_cmp_lt_u32 s65,32
s_cbranch_scc1 fl_slow
s_mov_b32 s56,0
vok_15:
fl_slow:
s_mov_b32 s58,s49
s_cmp_gt_u32 s51,0
s_cselect_b32 s65,s92,0
s_add_u32 s58,s58,s65
s_cmp_gt_u32 s51,1
s_cselect_b32 s65,s93,0
s_add_u32 s58,s58,s65
s_cmp_gt_u32 s51,2
s_cselect_b32 s65,s94,0
s_add_u32 s58,s58,s65
s_cmp_gt_u32 s51,3
s_cselect_b32 s65,s95,0
s_add_u32 s58,s58,s65
s_cmp_gt_u32 s51,4
s_cselect_b32 s65,s96,0
s_add_u32 s58,s58,s65
s_cmp_gt_u32 s51,5
s_cselect_b32 s65,s97,0
s_add_u32 s58,s58,s65
s_cmp_gt_u32 s51,6
s_cselect_b32 s65,s98,0
s_add_u32 s58,s58,s65
s_mov_b32 s56,1
s_waitcnt vmcnt(0) lgkmcnt(0)
s_barrier
s_cmp_lt_u32 s58,256
s_cbranch_scc1 fl_disp
done_5:
s_endpgm
fl_qkv:
v_and_b32 v21,15,v1
v_lshrrev_b32 v22,4,v1
v_lshrrev_b32 v23,2,v21
v_and_b32 v24,3,v21
s_lshl_b32 s61,s50,15
v_lshl_add_u32 v25,v22,3,v23
s_load_dwordx4 s[4:7],s[0:1],16
s_load_dwordx2 s[8:9],s[0:1],32
s_lshl_b32 s52,s59,7
s_and_b32 s64,s50,1
s_lshl_b32 s65,s64,6
s_add_u32 s53,s52,s65
s_lshr_b32 s65,s50,1
s_lshl_b32 s65,s65,6
s_add_u32 s52,s52,s65
s_lshl_b32 s54,s64,3
s_waitcnt lgkmcnt(0)
s_cmp_gt_u32 s50,1
s_cselect_b64 s[10:11],s[4:5],s[6:7]
s_mov_b32 s28,s10
s_and_b32 s29,s11,0xffff
s_mov_b32 s30,0x800000
s_mov_b32 s31,0x20000
s_mov_b32 s32,s8
s_and_b32 s33,s9,0xffff
s_mov_b32 s34,0x800000
s_mov_b32 s35,0x20000
v_lshrrev_b32 v26,2,v1
v_and_b32 v27,3,v1
v_mul_u32_u24 v16,8192,v26
v_lshl_add_u32 v16,v27,4,v16
v_lshlrev_b32 v17,6,v25
v_lshl_add_u32 v17,v24,4,v17
v_add_u32 v17,s61,v17
s_add_u32 s62,s53,0
s_add_u32 m0,s61,0
s_nop 0
buffer_load_dwordx4 v16,s[28:31],s62 offen lds
s_add_u32 s62,s62,131072
s_add_u32 m0,m0,1024
s_nop 0
buffer_load_dwordx4 v16,s[28:31],s62 offen lds
s_add_u32 s62,s62,131072
s_add_u32 m0,m0,1024
s_nop 0
buffer_load_dwordx4 v16,s[28:31],s62 offen lds
s_add_u32 s62,s62,131072
s_add_u32 m0,m0,1024
s_nop 0
buffer_load_dwordx4 v16,s[28:31],s62 offen lds
s_add_u32 s62,s62,131072
s_add_u32 m0,m0,1024
s_nop 0
buffer_load_dwordx4 v16,s[28:31],s62 offen lds
s_add_u32 s62,s62,131072
s_add_u32 m0,m0,1024
s_nop 0
buffer_load_dwordx4 v16,s[28:31],s62 offen lds
s_add_u32 s62,s62,131072
s_add_u32 m0,m0,1024
s_nop 0
buffer_load_dwordx4 v16,s[28:31],s62 offen lds
s_add_u32 s62,s62,131072
s_add_u32 m0,m0,1024
s_nop 0
buffer_load_dwordx4 v16,s[28:31],s62 offen lds
s_add_u32 s62,s62,131072
s_add_u32 m0,m0,1024
s_nop 0
buffer_load_dwordx4 v16,s[28:31],s62 offen lds
s_add_u32 s62,s62,131072
s_add_u32 m0,m0,1024
s_nop 0
buffer_load_dwordx4 v16,s[28:31],s62 offen lds
s_add_u32 s62,s62,131072
s_add_u32 m0,m0,1024
s_nop 0
buffer_load_dwordx4 v16,s[28:31],s62 offen lds
s_add_u32 s62,s62,131072
s_add_u32 m0,m0,1024
s_nop 0
buffer_load_dwordx4 v16,s[28:31],s62 offen lds
s_add_u32 s62,s62,131072
s_add_u32 m0,m0,1024
s_nop 0
buffer_load_dwordx4 v16,s[28:31],s62 offen lds
s_add_u32 s62,s62,131072
s_add_u32 m0,m0,1024
s_nop 0
buffer_load_dwordx4 v16,s[28:31],s62 offen lds
s_add_u32 s62,s62,131072
s_add_u32 m0,m0,1024
s_nop 0
buffer_load_dwordx4 v16,s[28:31],s62 offen lds
s_add_u32 s62,s62,131072
s_add_u32 m0,m0,1024
s_nop 0
buffer_load_dwordx4 v16,s[28:31],s62 offen lds
s_add_u32 s62,s52,0
s_add_u32 m0,s61,16384
s_nop 0
buffer_load_dwordx4 v16,s[32:35],s62 offen lds
s_add_u32 s62,s62,131072
s_add_u32 m0,m0,1024
s_nop 0
buffer_load_dwordx4 v16,s[32:35],s62 offen lds
s_add_u32 s62,s62,131072
s_add_u32 m0,m0,1024
s_nop 0
buffer_load_dwordx4 v16,s[32:35],s62 offen lds
s_add_u32 s62,s62,131072
s_add_u32 m0,m0,1024
s_nop 0
buffer_load_dwordx4 v16,s[32:35],s62 offen lds
s_add_u32 s62,s62,131072
s_add_u32 m0,m0,1024
s_nop 0
buffer_load_dwordx4 v16,s[32:35],s62 offen lds
s_add_u32 s62,s62,131072
s_add_u32 m0,m0,1024
s_nop 0
buffer_load_dwordx4 v16,s[32:35],s62 offen lds
s_add_u32 s62,s62,131072
s_add_u32 m0,m0,1024
s_nop 0
buffer_load_dwordx4 v16,s[32:35],s62 offen lds
s_add_u32 s62,s62,131072
s_add_u32 m0,m0,1024
s_nop 0
buffer_load_dwordx4 v16,s[32:35],s62 offen lds
s_add_u32 s62,s62,131072
s_add_u32 m0,m0,1024
s_nop 0
buffer_load_dwordx4 v16,s[32:35],s62 offen lds
s_add_u32 s62,s62,131072
s_add_u32 m0,m0,1024
s_nop 0
buffer_load_dwordx4 v16,s[32:35],s62 offen lds
s_add_u32 s62,s62,131072
s_add_u32 m0,m0,1024
s_nop 0
buffer_load_dwordx4 v16,s[32:35],s62 offen lds
s_add_u32 s62,s62,131072
s_add_u32 m0,m0,1024
s_nop 0
buffer_load_dwordx4 v16,s[32:35],s62 offen lds
s_add_u32 s62,s62,131072
s_add_u32 m0,m0,1024
s_nop 0
buffer_load_dwordx4 v16,s[32:35],s62 offen lds
s_add_u32 s62,s62,131072
s_add_u32 m0,m0,1024
s_nop 0
buffer_load_dwordx4 v16,s[32:35],s62 offen lds
s_add_u32 s62,s62,131072
s_add_u32 m0,m0,1024
s_nop 0
buffer_load_dwordx4 v16,s[32:35],s62 offen lds
s_add_u32 s62,s62,131072
s_add_u32 m0,m0,1024
s_nop 0
buffer_load_dwordx4 v16,s[32:35],s62 offen lds
s_waitcnt vmcnt(16)
ds_read_b64_tr_b16 a[0:1],v17 offset:0
ds_read_b64_tr_b16 a[2:3],v17 offset:256
ds_read_b64_tr_b16 a[4:5],v17 offset:8
ds_read_b64_tr_b16 a[6:7],v17 offset:264
ds_read_b64_tr_b16 a[12:13],v17 offset:2048
ds_read_b64_tr_b16 a[14:15],v17 offset:2304
ds_read_b64_tr_b16 a[16:17],v17 offset:2056
ds_read_b64_tr_b16 a[18:19],v17 offset:2312
ds_read_b64_tr_b16 a[24:25],v17 offset:4096
ds_read_b64_tr_b16 a[26:27],v17 offset:4352
ds_read_b64_tr_b16 a[28:29],v17 offset:4104
ds_read_b64_tr_b16 a[30:31],v17 offset:4360
s_waitcnt lgkmcnt(0)
ds_read_b64_tr_b16 a[36:37],v17 offset:6144
ds_read_b64_tr_b16 a[38:39],v17 offset:6400
ds_read_b64_tr_b16 a[40:41],v17 offset:6152
ds_read_b64_tr_b16 a[42:43],v17 offset:6408
ds_read_b64_tr_b16 a[48:49],v17 offset:8192
ds_read_b64_tr_b16 a[50:51],v17 offset:8448
ds_read_b64_tr_b16 a[52:53],v17 offset:8200
ds_read_b64_tr_b16 a[54:55],v17 offset:8456
ds_read_b64_tr_b16 a[60:61],v17 offset:10240
ds_read_b64_tr_b16 a[62:63],v17 offset:10496
ds_read_b64_tr_b16 a[64:65],v17 offset:10248
ds_read_b64_tr_b16 a[66:67],v17 offset:10504
s_waitcnt lgkmcnt(0)
ds_read_b64_tr_b16 a[72:73],v17 offset:12288
ds_read_b64_tr_b16 a[74:75],v17 offset:12544
ds_read_b64_tr_b16 a[76:77],v17 offset:12296
ds_read_b64_tr_b16 a[78:79],v17 offset:12552
ds_read_b64_tr_b16 a[84:85],v17 offset:14336
ds_read_b64_tr_b16 a[86:87],v17 offset:14592
ds_read_b64_tr_b16 a[88:89],v17 offset:14344
ds_read_b64_tr_b16 a[90:91],v17 offset:14600
s_waitcnt lgkmcnt(0)
s_add_u32 s62,s53,2097152
s_add_u32 m0,s61,0
s_nop 0
buffer_load_dwordx4 v16,s[28:31],s62 offen lds
s_add_u32 s62,s62,131072
s_add_u32 m0,m0,1024
s_nop 0
buffer_load_dwordx4 v16,s[28:31],s62 offen lds
s_add_u32 s62,s62,131072
s_add_u32 m0,m0,1024
s_nop 0
buffer_load_dwordx4 v16,s[28:31],s62 offen lds
s_add_u32 s62,s62,131072
s_add_u32 m0,m0,1024
s_nop 0
buffer_load_dwordx4 v16,s[28:31],s62 offen lds
s_add_u32 s62,s62,131072
s_add_u32 m0,m0,1024
s_nop 0
buffer_load_dwordx4 v16,s[28:31],s62 offen lds
s_add_u32 s62,s62,131072
s_add_u32 m0,m0,1024
s_nop 0
buffer_load_dwordx4 v16,s[28:31],s62 offen lds
s_add_u32 s62,s62,131072
s_add_u32 m0,m0,1024
s_nop 0
buffer_load_dwordx4 v16,s[28:31],s62 offen lds
s_add_u32 s62,s62,131072
s_add_u32 m0,m0,1024
s_nop 0
buffer_load_dwordx4 v16,s[28:31],s62 offen lds
s_add_u32 s62,s62,131072
s_add_u32 m0,m0,1024
s_nop 0
buffer_load_dwordx4 v16,s[28:31],s62 offen lds
s_add_u32 s62,s62,131072
s_add_u32 m0,m0,1024
s_nop 0
buffer_load_dwordx4 v16,s[28:31],s62 offen lds
s_add_u32 s62,s62,131072
s_add_u32 m0,m0,1024
s_nop 0
buffer_load_dwordx4 v16,s[28:31],s62 offen lds
s_add_u32 s62,s62,131072
s_add_u32 m0,m0,1024
s_nop 0
buffer_load_dwordx4 v16,s[28:31],s62 offen lds
s_add_u32 s62,s62,131072
s_add_u32 m0,m0,1024
s_nop 0
buffer_load_dwordx4 v16,s[28:31],s62 offen lds
s_add_u32 s62,s62,131072
s_add_u32 m0,m0,1024
s_nop 0
buffer_load_dwordx4 v16,s[28:31],s62 offen lds
s_add_u32 s62,s62,131072
s_add_u32 m0,m0,1024
s_nop 0
buffer_load_dwordx4 v16,s[28:31],s62 offen lds
s_add_u32 s62,s62,131072
s_add_u32 m0,m0,1024
s_nop 0
buffer_load_dwordx4 v16,s[28:31],s62 offen lds
s_waitcnt vmcnt(16)
v_add_u32 v18,s54,v17
ds_read_b64_tr_b16 a[8:9],v18 offset:16384
ds_read_b64_tr_b16 a[10:11],v18 offset:16640
ds_read_b64_tr_b16 a[20:21],v18 offset:18432
ds_read_b64_tr_b16 a[22:23],v18 offset:18688
ds_read_b64_tr_b16 a[32:33],v18 offset:20480
ds_read_b64_tr_b16 a[34:35],v18 offset:20736
ds_read_b64_tr_b16 a[44:45],v18 offset:22528
ds_read_b64_tr_b16 a[46:47],v18 offset:22784
ds_read_b64_tr_b16 a[56:57],v18 offset:24576
ds_read_b64_tr_b16 a[58:59],v18 offset:24832
ds_read_b64_tr_b16 a[68:69],v18 offset:26624
ds_read_b64_tr_b16 a[70:71],v18 offset:26880
s_waitcnt lgkmcnt(0)
ds_read_b64_tr_b16 a[80:81],v18 offset:28672
ds_read_b64_tr_b16 a[82:83],v18 offset:28928
ds_read_b64_tr_b16 a[92:93],v18 offset:30720
ds_read_b64_tr_b16 a[94:95],v18 offset:30976
s_waitcnt lgkmcnt(0)
s_add_u32 s62,s52,2097152
s_add_u32 m0,s61,16384
s_nop 0
buffer_load_dwordx4 v16,s[32:35],s62 offen lds
s_add_u32 s62,s62,131072
s_add_u32 m0,m0,1024
s_nop 0
buffer_load_dwordx4 v16,s[32:35],s62 offen lds
s_add_u32 s62,s62,131072
s_add_u32 m0,m0,1024
s_nop 0
buffer_load_dwordx4 v16,s[32:35],s62 offen lds
s_add_u32 s62,s62,131072
s_add_u32 m0,m0,1024
s_nop 0
buffer_load_dwordx4 v16,s[32:35],s62 offen lds
s_add_u32 s62,s62,131072
s_add_u32 m0,m0,1024
s_nop 0
buffer_load_dwordx4 v16,s[32:35],s62 offen lds
s_add_u32 s62,s62,131072
s_add_u32 m0,m0,1024
s_nop 0
buffer_load_dwordx4 v16,s[32:35],s62 offen lds
s_add_u32 s62,s62,131072
s_add_u32 m0,m0,1024
s_nop 0
buffer_load_dwordx4 v16,s[32:35],s62 offen lds
s_add_u32 s62,s62,131072
s_add_u32 m0,m0,1024
s_nop 0
buffer_load_dwordx4 v16,s[32:35],s62 offen lds
s_add_u32 s62,s62,131072
s_add_u32 m0,m0,1024
s_nop 0
buffer_load_dwordx4 v16,s[32:35],s62 offen lds
s_add_u32 s62,s62,131072
s_add_u32 m0,m0,1024
s_nop 0
buffer_load_dwordx4 v16,s[32:35],s62 offen lds
s_add_u32 s62,s62,131072
s_add_u32 m0,m0,1024
s_nop 0
buffer_load_dwordx4 v16,s[32:35],s62 offen lds
s_add_u32 s62,s62,131072
s_add_u32 m0,m0,1024
s_nop 0
buffer_load_dwordx4 v16,s[32:35],s62 offen lds
s_add_u32 s62,s62,131072
s_add_u32 m0,m0,1024
s_nop 0
buffer_load_dwordx4 v16,s[32:35],s62 offen lds
s_add_u32 s62,s62,131072
s_add_u32 m0,m0,1024
s_nop 0
buffer_load_dwordx4 v16,s[32:35],s62 offen lds
s_add_u32 s62,s62,131072
s_add_u32 m0,m0,1024
s_nop 0
buffer_load_dwordx4 v16,s[32:35],s62 offen lds
s_add_u32 s62,s62,131072
s_add_u32 m0,m0,1024
s_nop 0
buffer_load_dwordx4 v16,s[32:35],s62 offen lds
s_waitcnt vmcnt(16)
ds_read_b64_tr_b16 a[96:97],v17 offset:0
ds_read_b64_tr_b16 a[98:99],v17 offset:256
ds_read_b64_tr_b16 a[100:101],v17 offset:8
ds_read_b64_tr_b16 a[102:103],v17 offset:264
ds_read_b64_tr_b16 a[108:109],v17 offset:2048
ds_read_b64_tr_b16 a[110:111],v17 offset:2304
ds_read_b64_tr_b16 a[112:113],v17 offset:2056
ds_read_b64_tr_b16 a[114:115],v17 offset:2312
ds_read_b64_tr_b16 a[120:121],v17 offset:4096
ds_read_b64_tr_b16 a[122:123],v17 offset:4352
ds_read_b64_tr_b16 a[124:125],v17 offset:4104
ds_read_b64_tr_b16 a[126:127],v17 offset:4360
s_waitcnt lgkmcnt(0)
ds_read_b64_tr_b16 a[132:133],v17 offset:6144
ds_read_b64_tr_b16 a[134:135],v17 offset:6400
ds_read_b64_tr_b16 a[136:137],v17 offset:6152
ds_read_b64_tr_b16 a[138:139],v17 offset:6408
ds_read_b64_tr_b16 a[144:145],v17 offset:8192
ds_read_b64_tr_b16 a[146:147],v17 offset:8448
ds_read_b64_tr_b16 a[148:149],v17 offset:8200
ds_read_b64_tr_b16 a[150:151],v17 offset:8456
ds_read_b64_tr_b16 a[156:157],v17 offset:10240
ds_read_b64_tr_b16 a[158:159],v17 offset:10496
ds_read_b64_tr_b16 a[160:161],v17 offset:10248
ds_read_b64_tr_b16 a[162:163],v17 offset:10504
s_waitcnt lgkmcnt(0)
ds_read_b64_tr_b16 a[168:169],v17 offset:12288
ds_read_b64_tr_b16 a[170:171],v17 offset:12544
ds_read_b64_tr_b16 a[172:173],v17 offset:12296
ds_read_b64_tr_b16 a[174:175],v17 offset:12552
ds_read_b64_tr_b16 a[180:181],v17 offset:14336
ds_read_b64_tr_b16 a[182:183],v17 offset:14592
ds_read_b64_tr_b16 a[184:185],v17 offset:14344
ds_read_b64_tr_b16 a[186:187],v17 offset:14600
s_waitcnt lgkmcnt(0)
s_add_u32 s62,s53,4194304
s_add_u32 m0,s61,0
s_nop 0
buffer_load_dwordx4 v16,s[28:31],s62 offen lds
s_add_u32 s62,s62,131072
s_add_u32 m0,m0,1024
s_nop 0
buffer_load_dwordx4 v16,s[28:31],s62 offen lds
s_add_u32 s62,s62,131072
s_add_u32 m0,m0,1024
s_nop 0
buffer_load_dwordx4 v16,s[28:31],s62 offen lds
s_add_u32 s62,s62,131072
s_add_u32 m0,m0,1024
s_nop 0
buffer_load_dwordx4 v16,s[28:31],s62 offen lds
s_add_u32 s62,s62,131072
s_add_u32 m0,m0,1024
s_nop 0
buffer_load_dwordx4 v16,s[28:31],s62 offen lds
s_add_u32 s62,s62,131072
s_add_u32 m0,m0,1024
s_nop 0
buffer_load_dwordx4 v16,s[28:31],s62 offen lds
s_add_u32 s62,s62,131072
s_add_u32 m0,m0,1024
s_nop 0
buffer_load_dwordx4 v16,s[28:31],s62 offen lds
s_add_u32 s62,s62,131072
s_add_u32 m0,m0,1024
s_nop 0
buffer_load_dwordx4 v16,s[28:31],s62 offen lds
s_add_u32 s62,s62,131072
s_add_u32 m0,m0,1024
s_nop 0
buffer_load_dwordx4 v16,s[28:31],s62 offen lds
s_add_u32 s62,s62,131072
s_add_u32 m0,m0,1024
s_nop 0
buffer_load_dwordx4 v16,s[28:31],s62 offen lds
s_add_u32 s62,s62,131072
s_add_u32 m0,m0,1024
s_nop 0
buffer_load_dwordx4 v16,s[28:31],s62 offen lds
s_add_u32 s62,s62,131072
s_add_u32 m0,m0,1024
s_nop 0
buffer_load_dwordx4 v16,s[28:31],s62 offen lds
s_add_u32 s62,s62,131072
s_add_u32 m0,m0,1024
s_nop 0
buffer_load_dwordx4 v16,s[28:31],s62 offen lds
s_add_u32 s62,s62,131072
s_add_u32 m0,m0,1024
s_nop 0
buffer_load_dwordx4 v16,s[28:31],s62 offen lds
s_add_u32 s62,s62,131072
s_add_u32 m0,m0,1024
s_nop 0
buffer_load_dwordx4 v16,s[28:31],s62 offen lds
s_add_u32 s62,s62,131072
s_add_u32 m0,m0,1024
s_nop 0
buffer_load_dwordx4 v16,s[28:31],s62 offen lds
s_waitcnt vmcnt(16)
ds_read_b64_tr_b16 a[104:105],v18 offset:16384
ds_read_b64_tr_b16 a[106:107],v18 offset:16640
ds_read_b64_tr_b16 a[116:117],v18 offset:18432
ds_read_b64_tr_b16 a[118:119],v18 offset:18688
ds_read_b64_tr_b16 a[128:129],v18 offset:20480
ds_read_b64_tr_b16 a[130:131],v18 offset:20736
ds_read_b64_tr_b16 a[140:141],v18 offset:22528
ds_read_b64_tr_b16 a[142:143],v18 offset:22784
ds_read_b64_tr_b16 a[152:153],v18 offset:24576
ds_read_b64_tr_b16 a[154:155],v18 offset:24832
ds_read_b64_tr_b16 a[164:165],v18 offset:26624
ds_read_b64_tr_b16 a[166:167],v18 offset:26880
s_waitcnt lgkmcnt(0)
ds_read_b64_tr_b16 a[176:177],v18 offset:28672
ds_read_b64_tr_b16 a[178:179],v18 offset:28928
ds_read_b64_tr_b16 a[188:189],v18 offset:30720
ds_read_b64_tr_b16 a[190:191],v18 offset:30976
s_waitcnt lgkmcnt(0)
s_add_u32 s62,s52,4194304
s_add_u32 m0,s61,16384
s_nop 0
buffer_load_dwordx4 v16,s[32:35],s62 offen lds
s_add_u32 s62,s62,131072
s_add_u32 m0,m0,1024
s_nop 0
buffer_load_dwordx4 v16,s[32:35],s62 offen lds
s_add_u32 s62,s62,131072
s_add_u32 m0,m0,1024
s_nop 0
buffer_load_dwordx4 v16,s[32:35],s62 offen lds
s_add_u32 s62,s62,131072
s_add_u32 m0,m0,1024
s_nop 0
buffer_load_dwordx4 v16,s[32:35],s62 offen lds
s_add_u32 s62,s62,131072
s_add_u32 m0,m0,1024
s_nop 0
buffer_load_dwordx4 v16,s[32:35],s62 offen lds
s_add_u32 s62,s62,131072
s_add_u32 m0,m0,1024
s_nop 0
buffer_load_dwordx4 v16,s[32:35],s62 offen lds
s_add_u32 s62,s62,131072
s_add_u32 m0,m0,1024
s_nop 0
buffer_load_dwordx4 v16,s[32:35],s62 offen lds
s_add_u32 s62,s62,131072
s_add_u32 m0,m0,1024
s_nop 0
buffer_load_dwordx4 v16,s[32:35],s62 offen lds
s_add_u32 s62,s62,131072
s_add_u32 m0,m0,1024
s_nop 0
buffer_load_dwordx4 v16,s[32:35],s62 offen lds
s_add_u32 s62,s62,131072
s_add_u32 m0,m0,1024
s_nop 0
buffer_load_dwordx4 v16,s[32:35],s62 offen lds
s_add_u32 s62,s62,131072
s_add_u32 m0,m0,1024
s_nop 0
buffer_load_dwordx4 v16,s[32:35],s62 offen lds
s_add_u32 s62,s62,131072
s_add_u32 m0,m0,1024
s_nop 0
buffer_load_dwordx4 v16,s[32:35],s62 offen lds
s_add_u32 s62,s62,131072
s_add_u32 m0,m0,1024
s_nop 0
buffer_load_dwordx4 v16,s[32:35],s62 offen lds
s_add_u32 s62,s62,131072
s_add_u32 m0,m0,1024
s_nop 0
buffer_load_dwordx4 v16,s[32:35],s62 offen lds
s_add_u32 s62,s62,131072
s_add_u32 m0,m0,1024
s_nop 0
buffer_load_dwordx4 v16,s[32:35],s62 offen lds
s_add_u32 s62,s62,131072
s_add_u32 m0,m0,1024
s_nop 0
buffer_load_dwordx4 v16,s[32:35],s62 offen lds
s_waitcnt vmcnt(16)
ds_read_b64_tr_b16 a[192:193],v17 offset:0
ds_read_b64_tr_b16 a[194:195],v17 offset:256
ds_read_b64_tr_b16 a[196:197],v17 offset:8
ds_read_b64_tr_b16 a[198:199],v17 offset:264
ds_read_b64_tr_b16 a[204:205],v17 offset:2048
ds_read_b64_tr_b16 a[206:207],v17 offset:2304
ds_read_b64_tr_b16 a[208:209],v17 offset:2056
ds_read_b64_tr_b16 a[210:211],v17 offset:2312
ds_read_b64_tr_b16 a[216:217],v17 offset:4096
ds_read_b64_tr_b16 a[218:219],v17 offset:4352
ds_read_b64_tr_b16 a[220:221],v17 offset:4104
ds_read_b64_tr_b16 a[222:223],v17 offset:4360
s_waitcnt lgkmcnt(0)
ds_read_b64_tr_b16 a[228:229],v17 offset:6144
ds_read_b64_tr_b16 a[230:231],v17 offset:6400
ds_read_b64_tr_b16 a[232:233],v17 offset:6152
ds_read_b64_tr_b16 a[234:235],v17 offset:6408
ds_read_b64_tr_b16 a[240:241],v17 offset:8192
ds_read_b64_tr_b16 a[242:243],v17 offset:8448
ds_read_b64_tr_b16 a[244:245],v17 offset:8200
ds_read_b64_tr_b16 a[246:247],v17 offset:8456
ds_read_b64_tr_b16 a[252:253],v17 offset:10240
ds_read_b64_tr_b16 a[254:255],v17 offset:10496
ds_read_b64_tr_b16 v[128:129],v17 offset:10248
ds_read_b64_tr_b16 v[130:131],v17 offset:10504
s_waitcnt lgkmcnt(0)
ds_read_b64_tr_b16 v[136:137],v17 offset:12288
ds_read_b64_tr_b16 v[138:139],v17 offset:12544
ds_read_b64_tr_b16 v[140:141],v17 offset:12296
ds_read_b64_tr_b16 v[142:143],v17 offset:12552
ds_read_b64_tr_b16 v[148:149],v17 offset:14336
ds_read_b64_tr_b16 v[150:151],v17 offset:14592
ds_read_b64_tr_b16 v[152:153],v17 offset:14344
ds_read_b64_tr_b16 v[154:155],v17 offset:14600
s_waitcnt lgkmcnt(0)
s_add_u32 s62,s53,6291456
s_add_u32 m0,s61,0
s_nop 0
buffer_load_dwordx4 v16,s[28:31],s62 offen lds
s_add_u32 s62,s62,131072
s_add_u32 m0,m0,1024
s_nop 0
buffer_load_dwordx4 v16,s[28:31],s62 offen lds
s_add_u32 s62,s62,131072
s_add_u32 m0,m0,1024
s_nop 0
buffer_load_dwordx4 v16,s[28:31],s62 offen lds
s_add_u32 s62,s62,131072
s_add_u32 m0,m0,1024
s_nop 0
buffer_load_dwordx4 v16,s[28:31],s62 offen lds
s_add_u32 s62,s62,131072
s_add_u32 m0,m0,1024
s_nop 0
buffer_load_dwordx4 v16,s[28:31],s62 offen lds
s_add_u32 s62,s62,131072
s_add_u32 m0,m0,1024
s_nop 0
buffer_load_dwordx4 v16,s[28:31],s62 offen lds
s_add_u32 s62,s62,131072
s_add_u32 m0,m0,1024
s_nop 0
buffer_load_dwordx4 v16,s[28:31],s62 offen lds
s_add_u32 s62,s62,131072
s_add_u32 m0,m0,1024
s_nop 0
buffer_load_dwordx4 v16,s[28:31],s62 offen lds
s_add_u32 s62,s62,131072
s_add_u32 m0,m0,1024
s_nop 0
buffer_load_dwordx4 v16,s[28:31],s62 offen lds
s_add_u32 s62,s62,131072
s_add_u32 m0,m0,1024
s_nop 0
buffer_load_dwordx4 v16,s[28:31],s62 offen lds
s_add_u32 s62,s62,131072
s_add_u32 m0,m0,1024
s_nop 0
buffer_load_dwordx4 v16,s[28:31],s62 offen lds
s_add_u32 s62,s62,131072
s_add_u32 m0,m0,1024
s_nop 0
buffer_load_dwordx4 v16,s[28:31],s62 offen lds
s_add_u32 s62,s62,131072
s_add_u32 m0,m0,1024
s_nop 0
buffer_load_dwordx4 v16,s[28:31],s62 offen lds
s_add_u32 s62,s62,131072
s_add_u32 m0,m0,1024
s_nop 0
buffer_load_dwordx4 v16,s[28:31],s62 offen lds
s_add_u32 s62,s62,131072
s_add_u32 m0,m0,1024
s_nop 0
buffer_load_dwordx4 v16,s[28:31],s62 offen lds
s_add_u32 s62,s62,131072
s_add_u32 m0,m0,1024
s_nop 0
buffer_load_dwordx4 v16,s[28:31],s62 offen lds
s_waitcnt vmcnt(16)
ds_read_b64_tr_b16 a[200:201],v18 offset:16384
ds_read_b64_tr_b16 a[202:203],v18 offset:16640
ds_read_b64_tr_b16 a[212:213],v18 offset:18432
ds_read_b64_tr_b16 a[214:215],v18 offset:18688
ds_read_b64_tr_b16 a[224:225],v18 offset:20480
ds_read_b64_tr_b16 a[226:227],v18 offset:20736
ds_read_b64_tr_b16 a[236:237],v18 offset:22528
ds_read_b64_tr_b16 a[238:239],v18 offset:22784
ds_read_b64_tr_b16 a[248:249],v18 offset:24576
ds_read_b64_tr_b16 a[250:251],v18 offset:24832
ds_read_b64_tr_b16 v[132:133],v18 offset:26624
ds_read_b64_tr_b16 v[134:135],v18 offset:26880
s_waitcnt lgkmcnt(0)
ds_read_b64_tr_b16 v[144:145],v18 offset:28672
ds_read_b64_tr_b16 v[146:147],v18 offset:28928
ds_read_b64_tr_b16 v[156:157],v18 offset:30720
ds_read_b64_tr_b16 v[158:159],v18 offset:30976
s_waitcnt lgkmcnt(0)
s_add_u32 s62,s52,6291456
s_add_u32 m0,s61,16384
s_nop 0
buffer_load_dwordx4 v16,s[32:35],s62 offen lds
s_add_u32 s62,s62,131072
s_add_u32 m0,m0,1024
s_nop 0
buffer_load_dwordx4 v16,s[32:35],s62 offen lds
s_add_u32 s62,s62,131072
s_add_u32 m0,m0,1024
s_nop 0
buffer_load_dwordx4 v16,s[32:35],s62 offen lds
s_add_u32 s62,s62,131072
s_add_u32 m0,m0,1024
s_nop 0
buffer_load_dwordx4 v16,s[32:35],s62 offen lds
s_add_u32 s62,s62,131072
s_add_u32 m0,m0,1024
s_nop 0
buffer_load_dwordx4 v16,s[32:35],s62 offen lds
s_add_u32 s62,s62,131072
s_add_u32 m0,m0,1024
s_nop 0
buffer_load_dwordx4 v16,s[32:35],s62 offen lds
s_add_u32 s62,s62,131072
s_add_u32 m0,m0,1024
s_nop 0
buffer_load_dwordx4 v16,s[32:35],s62 offen lds
s_add_u32 s62,s62,131072
s_add_u32 m0,m0,1024
s_nop 0
buffer_load_dwordx4 v16,s[32:35],s62 offen lds
s_add_u32 s62,s62,131072
s_add_u32 m0,m0,1024
s_nop 0
buffer_load_dwordx4 v16,s[32:35],s62 offen lds
s_add_u32 s62,s62,131072
s_add_u32 m0,m0,1024
s_nop 0
buffer_load_dwordx4 v16,s[32:35],s62 offen lds
s_add_u32 s62,s62,131072
s_add_u32 m0,m0,1024
s_nop 0
buffer_load_dwordx4 v16,s[32:35],s62 offen lds
s_add_u32 s62,s62,131072
s_add_u32 m0,m0,1024
s_nop 0
buffer_load_dwordx4 v16,s[32:35],s62 offen lds
s_add_u32 s62,s62,131072
s_add_u32 m0,m0,1024
s_nop 0
buffer_load_dwordx4 v16,s[32:35],s62 offen lds
s_add_u32 s62,s62,131072
s_add_u32 m0,m0,1024
s_nop 0
buffer_load_dwordx4 v16,s[32:35],s62 offen lds
s_add_u32 s62,s62,131072
s_add_u32 m0,m0,1024
s_nop 0
buffer_load_dwordx4 v16,s[32:35],s62 offen lds
s_add_u32 s62,s62,131072
s_add_u32 m0,m0,1024
s_nop 0
buffer_load_dwordx4 v16,s[32:35],s62 offen lds
s_waitcnt vmcnt(16)
ds_read_b64_tr_b16 v[160:161],v17 offset:0
ds_read_b64_tr_b16 v[162:163],v17 offset:256
ds_read_b64_tr_b16 v[164:165],v17 offset:8
ds_read_b64_tr_b16 v[166:167],v17 offset:264
ds_read_b64_tr_b16 v[172:173],v17 offset:2048
ds_read_b64_tr_b16 v[174:175],v17 offset:2304
ds_read_b64_tr_b16 v[176:177],v17 offset:2056
ds_read_b64_tr_b16 v[178:179],v17 offset:2312
ds_read_b64_tr_b16 v[184:185],v17 offset:4096
ds_read_b64_tr_b16 v[186:187],v17 offset:4352
ds_read_b64_tr_b16 v[188:189],v17 offset:4104
ds_read_b64_tr_b16 v[190:191],v17 offset:4360
s_waitcnt lgkmcnt(0)
ds_read_b64_tr_b16 v[196:197],v17 offset:6144
ds_read_b64_tr_b16 v[198:199],v17 offset:6400
ds_read_b64_tr_b16 v[200:201],v17 offset:6152
ds_read_b64_tr_b16 v[202:203],v17 offset:6408
ds_read_b64_tr_b16 v[208:209],v17 offset:8192
ds_read_b64_tr_b16 v[210:211],v17 offset:8448
ds_read_b64_tr_b16 v[212:213],v17 offset:8200
ds_read_b64_tr_b16 v[214:215],v17 offset:8456
ds_read_b64_tr_b16 v[220:221],v17 offset:10240
ds_read_b64_tr_b16 v[222:223],v17 offset:10496
ds_read_b64_tr_b16 v[224:225],v17 offset:10248
ds_read_b64_tr_b16 v[226:227],v17 offset:10504
s_waitcnt lgkmcnt(0)
ds_read_b64_tr_b16 v[232:233],v17 offset:12288
ds_read_b64_tr_b16 v[234:235],v17 offset:12544
ds_read_b64_tr_b16 v[236:237],v17 offset:12296
ds_read_b64_tr_b16 v[238:239],v17 offset:12552
ds_read_b64_tr_b16 v[244:245],v17 offset:14336
ds_read_b64_tr_b16 v[246:247],v17 offset:14592
ds_read_b64_tr_b16 v[248:249],v17 offset:14344
ds_read_b64_tr_b16 v[250:251],v17 offset:14600
s_waitcnt lgkmcnt(0)
s_waitcnt vmcnt(0)
ds_read_b64_tr_b16 v[168:169],v18 offset:16384
ds_read_b64_tr_b16 v[170:171],v18 offset:16640
ds_read_b64_tr_b16 v[180:181],v18 offset:18432
ds_read_b64_tr_b16 v[182:183],v18 offset:18688
ds_read_b64_tr_b16 v[192:193],v18 offset:20480
ds_read_b64_tr_b16 v[194:195],v18 offset:20736
ds_read_b64_tr_b16 v[204:205],v18 offset:22528
ds_read_b64_tr_b16 v[206:207],v18 offset:22784
ds_read_b64_tr_b16 v[216:217],v18 offset:24576
ds_read_b64_tr_b16 v[218:219],v18 offset:24832
ds_read_b64_tr_b16 v[228:229],v18 offset:26624
ds_read_b64_tr_b16 v[230:231],v18 offset:26880
s_waitcnt lgkmcnt(0)
ds_read_b64_tr_b16 v[240:241],v18 offset:28672
ds_read_b64_tr_b16 v[242:243],v18 offset:28928
ds_read_b64_tr_b16 v[252:253],v18 offset:30720
ds_read_b64_tr_b16 v[254:255],v18 offset:30976
s_waitcnt lgkmcnt(0)
s_mov_b32 s67,0
s_cmp_eq_u32 s56,1
s_cbranch_scc1 vok_21
v_mbcnt_lo_u32_b32 v16,-1,0
v_and_b32 v16,7,v16
v_lshlrev_b32 v16,7,v16
s_mov_b32 s64,138510336
vpoll_22:
buffer_load_dword v17,v16,s[20:23],s64 offen sc1
s_waitcnt vmcnt(0)
v_readlane_b32 s92,v17,0
v_readlane_b32 s93,v17,1
v_readlane_b32 s94,v17,2
v_readlane_b32 s95,v17,3
v_readlane_b32 s96,v17,4
v_readlane_b32 s97,v17,5
v_readlane_b32 s98,v17,6
v_readlane_b32 s99,v17,7
s_add_u32 s65,s92,s93
s_add_u32 s65,s65,s94
s_add_u32 s65,s65,s95
s_add_u32 s65,s65,s96
s_add_u32 s65,s65,s97
s_add_u32 s65,s65,s98
s_add_u32 s65,s65,s99
s_cmp_ge_u32 s65,256
s_cbranch_scc1 vgot_23
s_sleep 4
s_sub_u32 s90,s90,1
s_cmp_gt_i32 s90,0
s_cbranch_scc1 vpoll_22
vgot_23:
s_min_u32 s65,s92,s93
s_min_u32 s65,s65,s94
s_min_u32 s65,s65,s95
s_min_u32 s65,s65,s96
s_min_u32 s65,s65,s97
s_min_u32 s65,s65,s98
s_min_u32 s65,s65,s99
s_cmp_lt_u32 s65,32
s_cbranch_scc1 fl_slow
s_mov_b32 s56,0
pp_24:
buffer_load_dword v17,off,s[20:23],s64 offset:1024 sc1
s_waitcnt vmcnt(0)
v_readfirstlane_b32 s65,v17
s_cmp_lg_u32 s65,0
s_cbranch_scc1 pg_25
s_sleep 4
s_sub_u32 s90,s90,1
s_cmp_gt_i32 s90,0
s_cbranch_scc1 pp_24
pg_25:
s_and_b32 s65,s65,2
s_lshl_b32 s67,s65,12
vok_21:
s_barrier
v_lshlrev_b32 v0,4,v1
s_mov_b32 s60,0
s_lshl_b32 s63,s50,13
s_add_u32 s61,s63,146800640
s_mov_b32 s70,0
s_lshl_b32 s52,s59,14
s_and_b32 s64,s50,1
s_lshl_b32 s64,s64,11
s_add_u32 s53,s52,s64
s_lshl_b32 s64,s50,10
s_add_u32 s52,s52,s64
s_add_u32 s52,s52,4096
s_cmp_gt_u32 s50,1
s_cselect_b32 s54,0x2000,0
s_lshl_b32 s69,s59,6
s_add_u32 s69,s69,s67
s_add_u32 s69,s69,138412032
v_mov_b32 v4,v0
v_add_u32 v5,32768,v0
s_add_u32 m0,s70,s63
s_add_u32 s62,s61,4096
buffer_load_dwordx4 v0,s[20:23],s61 offen offset:0 lds
buffer_load_dwordx4 v0,s[20:23],s61 offen offset:1024 lds
buffer_load_dwordx4 v0,s[20:23],s61 offen offset:2048 lds
buffer_load_dwordx4 v0,s[20:23],s61 offen offset:3072 lds
s_add_u32 m0,m0,4096
s_nop 0
buffer_load_dwordx4 v0,s[20:23],s62 offen offset:0 lds
buffer_load_dwordx4 v0,s[20:23],s62 offen offset:1024 lds
buffer_load_dwordx4 v0,s[20:23],s62 offen offset:2048 lds
buffer_load_dwordx4 v0,s[20:23],s62 offen offset:3072 lds
s_add_u32 s61,s61,32768
s_add_u32 s70,s70,32768
s_and_b32 s70,s70,0x1ffff
s_add_u32 m0,s70,s63
s_add_u32 s62,s61,4096
buffer_load_dwordx4 v0,s[20:23],s61 offen offset:0 lds
buffer_load_dwordx4 v0,s[20:23],s61 offen offset:1024 lds
buffer_load_dwordx4 v0,s[20:23],s61 offen offset:2048 lds
buffer_load_dwordx4 v0,s[20:23],s61 offen offset:3072 lds
s_add_u32 m0,m0,4096
s_nop 0
buffer_load_dwordx4 v0,s[20:23],s62 offen offset:0 lds
buffer_load_dwordx4 v0,s[20:23],s62 offen offset:1024 lds
buffer_load_dwordx4 v0,s[20:23],s62 offen offset:2048 lds
buffer_load_dwordx4 v0,s[20:23],s62 offen offset:3072 lds
s_add_u32 s61,s61,32768
s_add_u32 s70,s70,32768
s_and_b32 s70,s70,0x1ffff
s_waitcnt vmcnt(8)
s_barrier
ds_read_b128 v[64:67],v4 offset:0
ds_read_b128 v[68:71],v4 offset:1024
ds_read_b128 v[72:75],v4 offset:2048
ds_read_b128 v[76:79],v4 offset:3072
ds_read_b128 v[80:83],v4 offset:4096
top_26:
s_waitcnt lgkmcnt(4)
v_mfma_f32_16x16x32_bf16 v[32:35],a[0:3],v[64:67],0
ds_read_b128 v[84:87],v4 offset:5120
v_mfma_f32_16x16x32_bf16 v[36:39],a[4:7],v[64:67],0
v_mfma_f32_16x16x32_bf16 v[40:43],v[64:67],a[8:11],0
s_waitcnt lgkmcnt(4)
v_mfma_f32_16x16x32_bf16 v[32:35],a[12:15],v[68:71],v[32:35]
ds_read_b128 v[88:91],v4 offset:6144
s_sub_u32 s66,s60,1
s_lshr_b32 s64,s66,1
v_mfma_f32_16x16x32_bf16 v[36:39],a[16:19],v[68:71],v[36:39]
s_lshl_b32 s65,s64,12
s_and_b32 s65,s65,0x2000
v_mfma_f32_16x16x32_bf16 v[40:43],v[68:71],a[20:23],v[40:43]
s_xor_b32 s65,s65,s67
s_lshl_b32 s64,s64,20
s_waitcnt lgkmcnt(4)
v_mfma_f32_16x16x32_bf16 v[32:35],a[24:27],v[72:75],v[32:35]
ds_read_b128 v[92:95],v4 offset:7168
s_add_u32 s64,s64,s65
s_add_u32 s65,s64,s52
v_mfma_f32_16x16x32_bf16 v[36:39],a[28:31],v[72:75],v[36:39]
s_xor_b32 s64,s64,s54
s_add_u32 s66,s64,s53
v_mfma_f32_16x16x32_bf16 v[40:43],v[72:75],a[32:35],v[40:43]
s_cmp_eq_u32 s60,0
s_cselect_b32 s65,138608640,s65
s_waitcnt lgkmcnt(4)
v_mfma_f32_16x16x32_bf16 v[32:35],a[36:39],v[76:79],v[32:35]
ds_read_b128 v[96:99],v4 offset:8192
s_cselect_b32 s66,138608640,s66
v_mfma_f32_16x16x32_bf16 v[36:39],a[40:43],v[76:79],v[36:39]
v_cvt_pk_bf16_f32 v60,v44,v45
v_mfma_f32_16x16x32_bf16 v[40:43],v[76:79],a[44:47],v[40:43]
v_cvt_pk_bf16_f32 v61,v46,v47
s_waitcnt lgkmcnt(4)
v_mfma_f32_16x16x32_bf16 v[32:35],a[48:51],v[80:83],v[32:35]
ds_read_b128 v[100:103],v4 offset:9216
v_cvt_pk_bf16_f32 v62,v48,v49
v_mfma_f32_16x16x32_bf16 v[36:39],a[52:55],v[80:83],v[36:39]
v_cvt_pk_bf16_f32 v63,v50,v51
v_mfma_f32_16x16x32_bf16 v[40:43],v[80:83],a[56:59],v[40:43]
v_cvt_pk_bf16_f32 v58,v52,v53
s_waitcnt lgkmcnt(4)
v_mfma_f32_16x16x32_bf16 v[32:35],a[60:63],v[84:87],v[32:35]
ds_read_b128 v[104:107],v4 offset:10240
v_cvt_pk_bf16_f32 v59,v54,v55
v_mfma_f32_16x16x32_bf16 v[36:39],a[64:67],v[84:87],v[36:39]
buffer_store_dwordx4 v[60:63],v0,s[20:23],s66 offen offset:1024 sc1
v_mfma_f32_16x16x32_bf16 v[40:43],v[84:87],a[68:71],v[40:43]
buffer_store_dwordx4 v[56:59],v0,s[20:23],s65 offen sc1
s_waitcnt lgkmcnt(4)
v_mfma_f32_16x16x32_bf16 v[32:35],a[72:75],v[88:91],v[32:35]
ds_read_b128 v[108:111],v4 offset:11264
v_mfma_f32_16x16x32_bf16 v[36:39],a[76:79],v[88:91],v[36:39]
v_mfma_f32_16x16x32_bf16 v[40:43],v[88:91],a[80:83],v[40:43]
s_waitcnt lgkmcnt(4)
v_mfma_f32_16x16x32_bf16 v[32:35],a[84:87],v[92:95],v[32:35]
ds_read_b128 v[112:115],v4 offset:12288
v_mfma_f32_16x16x32_bf16 v[36:39],a[88:91],v[92:95],v[36:39]
v_mfma_f32_16x16x32_bf16 v[40:43],v[92:95],a[92:95],v[40:43]
s_waitcnt lgkmcnt(4)
v_mfma_f32_16x16x32_bf16 v[32:35],a[96:99],v[96:99],v[32:35]
ds_read_b128 v[116:119],v4 offset:13312
v_mfma_f32_16x16x32_bf16 v[36:39],a[100:103],v[96:99],v[36:39]
v_mfma_f32_16x16x32_bf16 v[40:43],v[96:99],a[104:107],v[40:43]
s_waitcnt lgkmcnt(4)
v_mfma_f32_16x16x32_bf16 v[32:35],a[108:111],v[100:103],v[32:35]
ds_read_b128 v[120:123],v4 offset:14336
v_mfma_f32_16x16x32_bf16 v[36:39],a[112:115],v[100:103],v[36:39]
v_mfma_f32_16x16x32_bf16 v[40:43],v[100:103],a[116:119],v[40:43]
s_waitcnt lgkmcnt(4)
v_mfma_f32_16x16x32_bf16 v[32:35],a[120:123],v[104:107],v[32:35]
ds_read_b128 v[124:127],v4 offset:15360
v_mfma_f32_16x16x32_bf16 v[36:39],a[124:127],v[104:107],v[36:39]
v_mfma_f32_16x16x32_bf16 v[40:43],v[104:107],a[128:131],v[40:43]
s_waitcnt lgkmcnt(4)
v_mfma_f32_16x16x32_bf16 v[32:35],a[132:135],v[108:111],v[32:35]
ds_read_b128 v[64:67],v4 offset:16384
v_mfma_f32_16x16x32_bf16 v[36:39],a[136:139],v[108:111],v[36:39]
v_mfma_f32_16x16x32_bf16 v[40:43],v[108:111],a[140:143],v[40:43]
s_waitcnt lgkmcnt(4)
v_mfma_f32_16x16x32_bf16 v[32:35],a[144:147],v[112:115],v[32:35]
ds_read_b128 v[68:71],v4 offset:17408
v_mfma_f32_16x16x32_bf16 v[36:39],a[148:151],v[112:115],v[36:39]
v_mfma_f32_16x16x32_bf16 v[40:43],v[112:115],a[152:155],v[40:43]
s_waitcnt lgkmcnt(4)
v_mfma_f32_16x16x32_bf16 v[32:35],a[156:159],v[116:119],v[32:35]
ds_read_b128 v[72:75],v4 offset:18432
v_mfma_f32_16x16x32_bf16 v[36:39],a[160:163],v[116:119],v[36:39]
v_mfma_f32_16x16x32_bf16 v[40:43],v[116:119],a[164:167],v[40:43]
s_waitcnt lgkmcnt(4)
v_mfma_f32_16x16x32_bf16 v[32:35],a[168:171],v[120:123],v[32:35]
ds_read_b128 v[76:79],v4 offset:19456
v_mfma_f32_16x16x32_bf16 v[36:39],a[172:175],v[120:123],v[36:39]
v_mfma_f32_16x16x32_bf16 v[40:43],v[120:123],a[176:179],v[40:43]
s_waitcnt lgkmcnt(4)
v_mfma_f32_16x16x32_bf16 v[32:35],a[180:183],v[124:127],v[32:35]
ds_read_b128 v[80:83],v4 offset:20480
v_mfma_f32_16x16x32_bf16 v[36:39],a[184:187],v[124:127],v[36:39]
s_waitcnt vmcnt(2)
s_cmp_lg_u32 s60,2
s_cbranch_scc1 sk_28
s_waitcnt vmcnt(0)
sk_28:
s_cselect_b32 s64,1,s50
s_barrier
s_cmp_ge_u32 s60,126
s_cselect_b32 s61,146800640,s61
s_cmp_lg_u32 s64,0
s_cbranch_scc1 nf_27
s_lshr_b32 s64,s60,1
v_mov_b32 v6,s64
s_mov_b64 exec,1
buffer_store_dword v6,off,s[20:23],s69 sc1
s_mov_b64 exec,-1
nf_27:
v_mfma_f32_16x16x32_bf16 v[40:43],v[124:127],a[188:191],v[40:43]
s_waitcnt lgkmcnt(4)
v_mfma_f32_16x16x32_bf16 v[32:35],a[192:195],v[64:67],v[32:35]
ds_read_b128 v[84:87],v4 offset:21504
s_add_u32 m0,s70,s63
v_mfma_f32_16x16x32_bf16 v[36:39],a[196:199],v[64:67],v[36:39]
v_mfma_f32_16x16x32_bf16 v[40:43],v[64:67],a[200:203],v[40:43]
s_add_u32 s62,s61,4096
s_waitcnt lgkmcnt(4)
v_mfma_f32_16x16x32_bf16 v[32:35],a[204:207],v[68:71],v[32:35]
ds_read_b128 v[88:91],v4 offset:22528
v_mfma_f32_16x16x32_bf16 v[36:39],a[208:211],v[68:71],v[36:39]
buffer_load_dwordx4 v0,s[20:23],s61 offen offset:0 lds
v_mfma_f32_16x16x32_bf16 v[40:43],v[68:71],a[212:215],v[40:43]
s_waitcnt lgkmcnt(4)
v_mfma_f32_16x16x32_bf16 v[32:35],a[216:219],v[72:75],v[32:35]
ds_read_b128 v[92:95],v4 offset:23552
buffer_load_dwordx4 v0,s[20:23],s61 offen offset:1024 lds
v_mfma_f32_16x16x32_bf16 v[36:39],a[220:223],v[72:75],v[36:39]
v_mfma_f32_16x16x32_bf16 v[40:43],v[72:75],a[224:227],v[40:43]
buffer_load_dwordx4 v0,s[20:23],s61 offen offset:2048 lds
s_waitcnt lgkmcnt(4)
v_mfma_f32_16x16x32_bf16 v[32:35],a[228:231],v[76:79],v[32:35]
ds_read_b128 v[96:99],v4 offset:24576
v_mfma_f32_16x16x32_bf16 v[36:39],a[232:235],v[76:79],v[36:39]
buffer_load_dwordx4 v0,s[20:23],s61 offen offset:3072 lds
v_mfma_f32_16x16x32_bf16 v[40:43],v[76:79],a[236:239],v[40:43]
s_waitcnt lgkmcnt(4)
v_mfma_f32_16x16x32_bf16 v[32:35],a[240:243],v[80:83],v[32:35]
ds_read_b128 v[100:103],v4 offset:25600
s_add_u32 m0,m0,4096
v_mfma_f32_16x16x32_bf16 v[36:39],a[244:247],v[80:83],v[36:39]
v_mfma_f32_16x16x32_bf16 v[40:43],v[80:83],a[248:251],v[40:43]
buffer_load_dwordx4 v0,s[20:23],s62 offen offset:0 lds
s_waitcnt lgkmcnt(4)
v_mfma_f32_16x16x32_bf16 v[32:35],a[252:255],v[84:87],v[32:35]
ds_read_b128 v[104:107],v4 offset:26624
v_mfma_f32_16x16x32_bf16 v[36:39],v[128:131],v[84:87],v[36:39]
buffer_load_dwordx4 v0,s[20:23],s62 offen offset:1024 lds
v_mfma_f32_16x16x32_bf16 v[40:43],v[84:87],v[132:135],v[40:43]
s_waitcnt lgkmcnt(4)
v_mfma_f32_16x16x32_bf16 v[32:35],v[136:139],v[88:91],v[32:35]
ds_read_b128 v[108:111],v4 offset:27648
buffer_load_dwordx4 v0,s[20:23],s62 offen offset:2048 lds
v_mfma_f32_16x16x32_bf16 v[36:39],v[140:143],v[88:91],v[36:39]
v_mfma_f32_16x16x32_bf16 v[40:43],v[88:91],v[144:147],v[40:43]
buffer_load_dwordx4 v0,s[20:23],s62 offen offset:3072 lds
s_waitcnt lgkmcnt(4)
v_mfma_f32_16x16x32_bf16 v[32:35],v[148:151],v[92:95],v[32:35]
ds_read_b128 v[112:115],v4 offset:28672
v_mfma_f32_16x16x32_bf16 v[36:39],v[152:155],v[92:95],v[36:39]
s_add_u32 s61,s61,32768
v_mfma_f32_16x16x32_bf16 v[40:43],v[92:95],v[156:159],v[40:43]
s_waitcnt lgkmcnt(4)
v_mfma_f32_16x16x32_bf16 v[32:35],v[160:163],v[96:99],v[32:35]
ds_read_b128 v[116:119],v4 offset:29696
s_add_u32 s70,s70,32768
v_mfma_f32_16x16x32_bf16 v[36:39],v[164:167],v[96:99],v[36:39]
v_mfma_f32_16x16x32_bf16 v[40:43],v[96:99],v[168:171],v[40:43]
s_and_b32 s70,s70,0x1ffff
s_waitcnt lgkmcnt(4)
v_mfma_f32_16x16x32_bf16 v[32:35],v[172:175],v[100:103],v[32:35]
ds_read_b128 v[120:123],v4 offset:30720
v_mfma_f32_16x16x32_bf16 v[36:39],v[176:179],v[100:103],v[36:39]
v_mfma_f32_16x16x32_bf16 v[40:43],v[100:103],v[180:183],v[40:43]
s_waitcnt lgkmcnt(4)
v_mfma_f32_16x16x32_bf16 v[32:35],v[184:187],v[104:107],v[32:35]
ds_read_b128 v[124:127],v4 offset:31744
v_mfma_f32_16x16x32_bf16 v[36:39],v[188:191],v[104:107],v[36:39]
v_mfma_f32_16x16x32_bf16 v[40:43],v[104:107],v[192:195],v[40:43]
s_waitcnt lgkmcnt(4)
v_mfma_f32_16x16x32_bf16 v[32:35],v[196:199],v[108:111],v[32:35]
ds_read_b128 v[64:67],v5 offset:0
v_mfma_f32_16x16x32_bf16 v[36:39],v[200:203],v[108:111],v[36:39]
v_mfma_f32_16x16x32_bf16 v[40:43],v[108:111],v[204:207],v[40:43]
s_waitcnt lgkmcnt(4)
v_mfma_f32_16x16x32_bf16 v[32:35],v[208:211],v[112:115],v[32:35]
ds_read_b128 v[68:71],v5 offset:1024
v_mfma_f32_16x16x32_bf16 v[36:39],v[212:215],v[112:115],v[36:39]
v_mfma_f32_16x16x32_bf16 v[40:43],v[112:115],v[216:219],v[40:43]
s_waitcnt lgkmcnt(4)
v_mfma_f32_16x16x32_bf16 v[32:35],v[220:223],v[116:119],v[32:35]
ds_read_b128 v[72:75],v5 offset:2048
v_mfma_f32_16x16x32_bf16 v[36:39],v[224:227],v[116:119],v[36:39]
v_mfma_f32_16x16x32_bf16 v[40:43],v[116:119],v[228:231],v[40:43]
s_waitcnt lgkmcnt(4)
v_mfma_f32_16x16x32_bf16 v[32:35],v[232:235],v[120:123],v[32:35]
ds_read_b128 v[76:79],v5 offset:3072
v_mfma_f32_16x16x32_bf16 v[36:39],v[236:239],v[120:123],v[36:39]
v_mfma_f32_16x16x32_bf16 v[40:43],v[120:123],v[240:243],v[40:43]
s_waitcnt lgkmcnt(4)
v_mfma_f32_16x16x32_bf16 v[32:35],v[244:247],v[124:127],v[32:35]
ds_read_b128 v[80:83],v5 offset:4096
v_mfma_f32_16x16x32_bf16 v[36:39],v[248:251],v[124:127],v[36:39]
v_mfma_f32_16x16x32_bf16 v[40:43],v[124:127],v[252:255],v[40:43]
v_mov_b32 v4,v5
v_add_u32 v5,32768,v5
v_and_b32 v5,0x1ffff,v5
s_add_u32 s60,s60,1
s_waitcnt lgkmcnt(4)
v_mfma_f32_16x16x32_bf16 v[44:47],a[0:3],v[64:67],0
ds_read_b128 v[84:87],v4 offset:5120
v_mfma_f32_16x16x32_bf16 v[48:51],a[4:7],v[64:67],0
v_mfma_f32_16x16x32_bf16 v[52:55],v[64:67],a[8:11],0
s_waitcnt lgkmcnt(4)
v_mfma_f32_16x16x32_bf16 v[44:47],a[12:15],v[68:71],v[44:47]
ds_read_b128 v[88:91],v4 offset:6144
s_sub_u32 s66,s60,1
s_lshr_b32 s64,s66,1
v_mfma_f32_16x16x32_bf16 v[48:51],a[16:19],v[68:71],v[48:51]
s_lshl_b32 s65,s64,12
s_and_b32 s65,s65,0x2000
v_mfma_f32_16x16x32_bf16 v[52:55],v[68:71],a[20:23],v[52:55]
s_xor_b32 s65,s65,s67
s_lshl_b32 s64,s64,20
s_waitcnt lgkmcnt(4)
v_mfma_f32_16x16x32_bf16 v[44:47],a[24:27],v[72:75],v[44:47]
ds_read_b128 v[92:95],v4 offset:7168
s_add_u32 s64,s64,s65
s_add_u32 s65,s64,s52
v_mfma_f32_16x16x32_bf16 v[48:51],a[28:31],v[72:75],v[48:51]
s_xor_b32 s64,s64,s54
s_add_u32 s66,s64,s53
v_mfma_f32_16x16x32_bf16 v[52:55],v[72:75],a[32:35],v[52:55]
v_cvt_pk_bf16_f32 v60,v32,v33
v_cvt_pk_bf16_f32 v61,v34,v35
s_waitcnt lgkmcnt(4)
v_mfma_f32_16x16x32_bf16 v[44:47],a[36:39],v[76:79],v[44:47]
ds_read_b128 v[96:99],v4 offset:8192
v_cvt_pk_bf16_f32 v62,v36,v37
v_mfma_f32_16x16x32_bf16 v[48:51],a[40:43],v[76:79],v[48:51]
v_cvt_pk_bf16_f32 v63,v38,v39
v_mfma_f32_16x16x32_bf16 v[52:55],v[76:79],a[44:47],v[52:55]
v_cvt_pk_bf16_f32 v56,v40,v41
s_waitcnt lgkmcnt(4)
v_mfma_f32_16x16x32_bf16 v[44:47],a[48:51],v[80:83],v[44:47]
ds_read_b128 v[100:103],v4 offset:9216
v_cvt_pk_bf16_f32 v57,v42,v43
v_mfma_f32_16x16x32_bf16 v[48:51],a[52:55],v[80:83],v[48:51]
buffer_store_dwordx4 v[60:63],v0,s[20:23],s66 offen offset:0 sc1
v_mfma_f32_16x16x32_bf16 v[52:55],v[80:83],a[56:59],v[52:55]
s_waitcnt lgkmcnt(4)
v_mfma_f32_16x16x32_bf16 v[44:47],a[60:63],v[84:87],v[44:47]
ds_read_b128 v[104:107],v4 offset:10240
v_mfma_f32_16x16x32_bf16 v[48:51],a[64:67],v[84:87],v[48:51]
v_mfma_f32_16x16x32_bf16 v[52:55],v[84:87],a[68:71],v[52:55]
s_waitcnt lgkmcnt(4)
v_mfma_f32_16x16x32_bf16 v[44:47],a[72:75],v[88:91],v[44:47]
ds_read_b128 v[108:111],v4 offset:11264
v_mfma_f32_16x16x32_bf16 v[48:51],a[76:79],v[88:91],v[48:51]
v_mfma_f32_16x16x32_bf16 v[52:55],v[88:91],a[80:83],v[52:55]
s_waitcnt lgkmcnt(4)
v_mfma_f32_16x16x32_bf16 v[44:47],a[84:87],v[92:95],v[44:47]
ds_read_b128 v[112:115],v4 offset:12288
v_mfma_f32_16x16x32_bf16 v[48:51],a[88:91],v[92:95],v[48:51]
v_mfma_f32_16x16x32_bf16 v[52:55],v[92:95],a[92:95],v[52:55]
s_waitcnt lgkmcnt(4)
v_mfma_f32_16x16x32_bf16 v[44:47],a[96:99],v[96:99],v[44:47]
ds_read_b128 v[116:119],v4 offset:13312
v_mfma_f32_16x16x32_bf16 v[48:51],a[100:103],v[96:99],v[48:51]
v_mfma_f32_16x16x32_bf16 v[52:55],v[96:99],a[104:107],v[52:55]
s_waitcnt lgkmcnt(4)
v_mfma_f32_16x16x32_bf16 v[44:47],a[108:111],v[100:103],v[44:47]
ds_read_b128 v[120:123],v4 offset:14336
v_mfma_f32_16x16x32_bf16 v[48:51],a[112:115],v[100:103],v[48:51]
v_mfma_f32_16x16x32_bf16 v[52:55],v[100:103],a[116:119],v[52:55]
s_waitcnt lgkmcnt(4)
v_mfma_f32_16x16x32_bf16 v[44:47],a[120:123],v[104:107],v[44:47]
ds_read_b128 v[124:127],v4 offset:15360
v_mfma_f32_16x16x32_bf16 v[48:51],a[124:127],v[104:107],v[48:51]
v_mfma_f32_16x16x32_bf16 v[52:55],v[104:107],a[128:131],v[52:55]
s_waitcnt lgkmcnt(4)
v_mfma_f32_16x16x32_bf16 v[44:47],a[132:135],v[108:111],v[44:47]
ds_read_b128 v[64:67],v4 offset:16384
v_mfma_f32_16x16x32_bf16 v[48:51],a[136:139],v[108:111],v[48:51]
v_mfma_f32_16x16x32_bf16 v[52:55],v[108:111],a[140:143],v[52:55]
s_waitcnt lgkmcnt(4)
v_mfma_f32_16x16x32_bf16 v[44:47],a[144:147],v[112:115],v[44:47]
ds_read_b128 v[68:71],v4 offset:17408
v_mfma_f32_16x16x32_bf16 v[48:51],a[148:151],v[112:115],v[48:51]
v_mfma_f32_16x16x32_bf16 v[52:55],v[112:115],a[152:155],v[52:55]
s_waitcnt lgkmcnt(4)
v_mfma_f32_16x16x32_bf16 v[44:47],a[156:159],v[116:119],v[44:47]
ds_read_b128 v[72:75],v4 offset:18432
v_mfma_f32_16x16x32_bf16 v[48:51],a[160:163],v[116:119],v[48:51]
v_mfma_f32_16x16x32_bf16 v[52:55],v[116:119],a[164:167],v[52:55]
s_waitcnt lgkmcnt(4)
v_mfma_f32_16x16x32_bf16 v[44:47],a[168:171],v[120:123],v[44:47]
ds_read_b128 v[76:79],v4 offset:19456
v_mfma_f32_16x16x32_bf16 v[48:51],a[172:175],v[120:123],v[48:51]
v_mfma_f32_16x16x32_bf16 v[52:55],v[120:123],a[176:179],v[52:55]
s_waitcnt lgkmcnt(4)
v_mfma_f32_16x16x32_bf16 v[44:47],a[180:183],v[124:127],v[44:47]
ds_read_b128 v[80:83],v4 offset:20480
v_mfma_f32_16x16x32_bf16 v[48:51],a[184:187],v[124:127],v[48:51]
s_waitcnt vmcnt(1)
s_mov_b32 s64,s50
s_barrier
s_cmp_ge_u32 s60,126
s_cselect_b32 s61,146800640,s61
s_cmp_lg_u32 s64,0
s_cbranch_scc1 nf_29
s_lshr_b32 s64,s60,1
v_mov_b32 v6,s64
s_mov_b64 exec,1
buffer_store_dword v6,off,s[20:23],s69 sc1
s_mov_b64 exec,-1
nf_29:
v_mfma_f32_16x16x32_bf16 v[52:55],v[124:127],a[188:191],v[52:55]
s_waitcnt lgkmcnt(4)
v_mfma_f32_16x16x32_bf16 v[44:47],a[192:195],v[64:67],v[44:47]
ds_read_b128 v[84:87],v4 offset:21504
s_add_u32 m0,s70,s63
v_mfma_f32_16x16x32_bf16 v[48:51],a[196:199],v[64:67],v[48:51]
v_mfma_f32_16x16x32_bf16 v[52:55],v[64:67],a[200:203],v[52:55]
s_add_u32 s62,s61,4096
s_waitcnt lgkmcnt(4)
v_mfma_f32_16x16x32_bf16 v[44:47],a[204:207],v[68:71],v[44:47]
ds_read_b128 v[88:91],v4 offset:22528
v_mfma_f32_16x16x32_bf16 v[48:51],a[208:211],v[68:71],v[48:51]
buffer_load_dwordx4 v0,s[20:23],s61 offen offset:0 lds
v_mfma_f32_16x16x32_bf16 v[52:55],v[68:71],a[212:215],v[52:55]
s_waitcnt lgkmcnt(4)
v_mfma_f32_16x16x32_bf16 v[44:47],a[216:219],v[72:75],v[44:47]
ds_read_b128 v[92:95],v4 offset:23552
buffer_load_dwordx4 v0,s[20:23],s61 offen offset:1024 lds
v_mfma_f32_16x16x32_bf16 v[48:51],a[220:223],v[72:75],v[48:51]
v_mfma_f32_16x16x32_bf16 v[52:55],v[72:75],a[224:227],v[52:55]
buffer_load_dwordx4 v0,s[20:23],s61 offen offset:2048 lds
s_waitcnt lgkmcnt(4)
v_mfma_f32_16x16x32_bf16 v[44:47],a[228:231],v[76:79],v[44:47]
ds_read_b128 v[96:99],v4 offset:24576
v_mfma_f32_16x16x32_bf16 v[48:51],a[232:235],v[76:79],v[48:51]
buffer_load_dwordx4 v0,s[20:23],s61 offen offset:3072 lds
v_mfma_f32_16x16x32_bf16 v[52:55],v[76:79],a[236:239],v[52:55]
s_waitcnt lgkmcnt(4)
v_mfma_f32_16x16x32_bf16 v[44:47],a[240:243],v[80:83],v[44:47]
ds_read_b128 v[100:103],v4 offset:25600
s_add_u32 m0,m0,4096
v_mfma_f32_16x16x32_bf16 v[48:51],a[244:247],v[80:83],v[48:51]
v_mfma_f32_16x16x32_bf16 v[52:55],v[80:83],a[248:251],v[52:55]
buffer_load_dwordx4 v0,s[20:23],s62 offen offset:0 lds
s_waitcnt lgkmcnt(4)
v_mfma_f32_16x16x32_bf16 v[44:47],a[252:255],v[84:87],v[44:47]
ds_read_b128 v[104:107],v4 offset:26624
v_mfma_f32_16x16x32_bf16 v[48:51],v[128:131],v[84:87],v[48:51]
buffer_load_dwordx4 v0,s[20:23],s62 offen offset:1024 lds
v_mfma_f32_16x16x32_bf16 v[52:55],v[84:87],v[132:135],v[52:55]
s_waitcnt lgkmcnt(4)
v_mfma_f32_16x16x32_bf16 v[44:47],v[136:139],v[88:91],v[44:47]
ds_read_b128 v[108:111],v4 offset:27648
buffer_load_dwordx4 v0,s[20:23],s62 offen offset:2048 lds
v_mfma_f32_16x16x32_bf16 v[48:51],v[140:143],v[88:91],v[48:51]
v_mfma_f32_16x16x32_bf16 v[52:55],v[88:91],v[144:147],v[52:55]
buffer_load_dwordx4 v0,s[20:23],s62 offen offset:3072 lds
s_waitcnt lgkmcnt(4)
v_mfma_f32_16x16x32_bf16 v[44:47],v[148:151],v[92:95],v[44:47]
ds_read_b128 v[112:115],v4 offset:28672
v_mfma_f32_16x16x32_bf16 v[48:51],v[152:155],v[92:95],v[48:51]
s_add_u32 s61,s61,32768
v_mfma_f32_16x16x32_bf16 v[52:55],v[92:95],v[156:159],v[52:55]
s_waitcnt lgkmcnt(4)
v_mfma_f32_16x16x32_bf16 v[44:47],v[160:163],v[96:99],v[44:47]
ds_read_b128 v[116:119],v4 offset:29696
s_add_u32 s70,s70,32768
v_mfma_f32_16x16x32_bf16 v[48:51],v[164:167],v[96:99],v[48:51]
v_mfma_f32_16x16x32_bf16 v[52:55],v[96:99],v[168:171],v[52:55]
s_and_b32 s70,s70,0x1ffff
s_waitcnt lgkmcnt(4)
v_mfma_f32_16x16x32_bf16 v[44:47],v[172:175],v[100:103],v[44:47]
ds_read_b128 v[120:123],v4 offset:30720
v_mfma_f32_16x16x32_bf16 v[48:51],v[176:179],v[100:103],v[48:51]
v_mfma_f32_16x16x32_bf16 v[52:55],v[100:103],v[180:183],v[52:55]
s_waitcnt lgkmcnt(4)
v_mfma_f32_16x16x32_bf16 v[44:47],v[184:187],v[104:107],v[44:47]
ds_read_b128 v[124:127],v4 offset:31744
v_mfma_f32_16x16x32_bf16 v[48:51],v[188:191],v[104:107],v[48:51]
v_mfma_f32_16x16x32_bf16 v[52:55],v[104:107],v[192:195],v[52:55]
s_waitcnt lgkmcnt(4)
v_mfma_f32_16x16x32_bf16 v[44:47],v[196:199],v[108:111],v[44:47]
ds_read_b128 v[64:67],v5 offset:0
v_mfma_f32_16x16x32_bf16 v[48:51],v[200:203],v[108:111],v[48:51]
v_mfma_f32_16x16x32_bf16 v[52:55],v[108:111],v[204:207],v[52:55]
s_waitcnt lgkmcnt(4)
v_mfma_f32_16x16x32_bf16 v[44:47],v[208:211],v[112:115],v[44:47]
ds_read_b128 v[68:71],v5 offset:1024
v_mfma_f32_16x16x32_bf16 v[48:51],v[212:215],v[112:115],v[48:51]
v_mfma_f32_16x16x32_bf16 v[52:55],v[112:115],v[216:219],v[52:55]
s_waitcnt lgkmcnt(4)
v_mfma_f32_16x16x32_bf16 v[44:47],v[220:223],v[116:119],v[44:47]
ds_read_b128 v[72:75],v5 offset:2048
v_mfma_f32_16x16x32_bf16 v[48:51],v[224:227],v[116:119],v[48:51]
v_mfma_f32_16x16x32_bf16 v[52:55],v[116:119],v[228:231],v[52:55]
s_waitcnt lgkmcnt(4)
v_mfma_f32_16x16x32_bf16 v[44:47],v[232:235],v[120:123],v[44:47]
ds_read_b128 v[76:79],v5 offset:3072
v_mfma_f32_16x16x32_bf16 v[48:51],v[236:239],v[120:123],v[48:51]
v_mfma_f32_16x16x32_bf16 v[52:55],v[120:123],v[240:243],v[52:55]
s_waitcnt lgkmcnt(4)
v_mfma_f32_16x16x32_bf16 v[44:47],v[244:247],v[124:127],v[44:47]
ds_read_b128 v[80:83],v5 offset:4096
v_mfma_f32_16x16x32_bf16 v[48:51],v[248:251],v[124:127],v[48:51]
v_mfma_f32_16x16x32_bf16 v[52:55],v[124:127],v[252:255],v[52:55]
v_mov_b32 v4,v5
v_add_u32 v5,32768,v5
v_and_b32 v5,0x1ffff,v5
s_add_u32 s60,s60,1
s_cmp_lt_u32 s60,128
s_cbranch_scc1 top_26
s_sub_u32 s66,s60,1
s_lshr_b32 s64,s66,1
s_lshl_b32 s65,s64,12
s_and_b32 s65,s65,0x2000
s_xor_b32 s65,s65,s67
s_lshl_b32 s64,s64,20
s_add_u32 s64,s64,s65
s_add_u32 s65,s64,s52
s_xor_b32 s64,s64,s54
s_add_u32 s66,s64,s53
s_cmp_eq_u32 s60,0
s_cselect_b32 s65,138608640,s65
s_cselect_b32 s66,138608640,s66
v_cvt_pk_bf16_f32 v60,v44,v45
v_cvt_pk_bf16_f32 v61,v46,v47
v_cvt_pk_bf16_f32 v62,v48,v49
v_cvt_pk_bf16_f32 v63,v50,v51
v_cvt_pk_bf16_f32 v58,v52,v53
v_cvt_pk_bf16_f32 v59,v54,v55
buffer_store_dwordx4 v[60:63],v0,s[20:23],s66 offen offset:1024 sc1
buffer_store_dwordx4 v[56:59],v0,s[20:23],s65 offen sc1
s_waitcnt vmcnt(0) lgkmcnt(0)
s_barrier
s_cmp_lg_u32 s50,0
s_cbranch_scc1 done_20
v_mov_b32 v6,64
s_mov_b64 exec,1
buffer_store_dword v6,off,s[20:23],s69 sc1
s_mov_b64 exec,-1
done_20:
s_endpgm
fl_wo:
v_and_b32 v21,15,v1
v_lshrrev_b32 v22,4,v1
v_lshrrev_b32 v23,2,v21
v_and_b32 v24,3,v21
s_lshl_b32 s61,s50,15
v_lshl_add_u32 v25,v22,3,v23
s_load_dwordx2 s[4:5],s[0:1],40
s_load_dwordx2 s[6:7],s[0:1],0
s_lshr_b32 s52,s59,3
s_and_b32 s53,s59,7
s_mul_i32 s54,s52,2097152
s_lshl_b32 s64,s53,8
s_add_u32 s54,s54,s64
s_lshl_b32 s64,s50,6
s_add_u32 s54,s54,s64
s_waitcnt lgkmcnt(0)
s_mov_b32 s28,s4
s_and_b32 s29,s5,0xffff
s_mov_b32 s30,0x800000
s_mov_b32 s31,0x20000
s_mov_b32 s24,s6
s_and_b32 s25,s7,0xffff
s_mov_b32 s26,0x400000
s_mov_b32 s27,0x20000
v_lshrrev_b32 v26,2,v1
v_and_b32 v27,3,v1
v_mul_u32_u24 v16,2048,v26
v_lshl_add_u32 v16,v27,4,v16
v_lshlrev_b32 v17,6,v25
v_lshl_add_u32 v17,v24,4,v17
v_add_u32 v17,s61,v17
s_xor_b32 s62,s50,0
s_mul_i32 s62,s62,524288
s_add_u32 s62,s62,s54
s_add_u32 m0,s61,0
s_nop 0
buffer_load_dwordx4 v16,s[28:31],s62 offen lds
s_add_u32 s62,s62,32768
s_add_u32 m0,m0,1024
s_nop 0
buffer_load_dwordx4 v16,s[28:31],s62 offen lds
s_add_u32 s62,s62,32768
s_add_u32 m0,m0,1024
s_nop 0
buffer_load_dwordx4 v16,s[28:31],s62 offen lds
s_add_u32 s62,s62,32768
s_add_u32 m0,m0,1024
s_nop 0
buffer_load_dwordx4 v16,s[28:31],s62 offen lds
s_add_u32 s62,s62,32768
s_add_u32 m0,m0,1024
s_nop 0
buffer_load_dwordx4 v16,s[28:31],s62 offen lds
s_add_u32 s62,s62,32768
s_add_u32 m0,m0,1024
s_nop 0
buffer_load_dwordx4 v16,s[28:31],s62 offen lds
s_add_u32 s62,s62,32768
s_add_u32 m0,m0,1024
s_nop 0
buffer_load_dwordx4 v16,s[28:31],s62 offen lds
s_add_u32 s62,s62,32768
s_add_u32 m0,m0,1024
s_nop 0
buffer_load_dwordx4 v16,s[28:31],s62 offen lds
s_add_u32 s62,s62,32768
s_add_u32 m0,m0,1024
s_nop 0
buffer_load_dwordx4 v16,s[28:31],s62 offen lds
s_add_u32 s62,s62,32768
s_add_u32 m0,m0,1024
s_nop 0
buffer_load_dwordx4 v16,s[28:31],s62 offen lds
s_add_u32 s62,s62,32768
s_add_u32 m0,m0,1024
s_nop 0
buffer_load_dwordx4 v16,s[28:31],s62 offen lds
s_add_u32 s62,s62,32768
s_add_u32 m0,m0,1024
s_nop 0
buffer_load_dwordx4 v16,s[28:31],s62 offen lds
s_add_u32 s62,s62,32768
s_add_u32 m0,m0,1024
s_nop 0
buffer_load_dwordx4 v16,s[28:31],s62 offen lds
s_add_u32 s62,s62,32768
s_add_u32 m0,m0,1024
s_nop 0
buffer_load_dwordx4 v16,s[28:31],s62 offen lds
s_add_u32 s62,s62,32768
s_add_u32 m0,m0,1024
s_nop 0
buffer_load_dwordx4 v16,s[28:31],s62 offen lds
s_add_u32 s62,s62,32768
s_add_u32 m0,m0,1024
s_nop 0
buffer_load_dwordx4 v16,s[28:31],s62 offen lds
s_xor_b32 s62,s50,1
s_mul_i32 s62,s62,524288
s_add_u32 s62,s62,s54
s_add_u32 m0,s61,16384
s_nop 0
buffer_load_dwordx4 v16,s[28:31],s62 offen lds
s_add_u32 s62,s62,32768
s_add_u32 m0,m0,1024
s_nop 0
buffer_load_dwordx4 v16,s[28:31],s62 offen lds
s_add_u32 s62,s62,32768
s_add_u32 m0,m0,1024
s_nop 0
buffer_load_dwordx4 v16,s[28:31],s62 offen lds
s_add_u32 s62,s62,32768
s_add_u32 m0,m0,1024
s_nop 0
buffer_load_dwordx4 v16,s[28:31],s62 offen lds
s_add_u32 s62,s62,32768
s_add_u32 m0,m0,1024
s_nop 0
buffer_load_dwordx4 v16,s[28:31],s62 offen lds
s_add_u32 s62,s62,32768
s_add_u32 m0,m0,1024
s_nop 0
buffer_load_dwordx4 v16,s[28:31],s62 offen lds
s_add_u32 s62,s62,32768
s_add_u32 m0,m0,1024
s_nop 0
buffer_load_dwordx4 v16,s[28:31],s62 offen lds
s_add_u32 s62,s62,32768
s_add_u32 m0,m0,1024
s_nop 0
buffer_load_dwordx4 v16,s[28:31],s62 offen lds
s_add_u32 s62,s62,32768
s_add_u32 m0,m0,1024
s_nop 0
buffer_load_dwordx4 v16,s[28:31],s62 offen lds
s_add_u32 s62,s62,32768
s_add_u32 m0,m0,1024
s_nop 0
buffer_load_dwordx4 v16,s[28:31],s62 offen lds
s_add_u32 s62,s62,32768
s_add_u32 m0,m0,1024
s_nop 0
buffer_load_dwordx4 v16,s[28:31],s62 offen lds
s_add_u32 s62,s62,32768
s_add_u32 m0,m0,1024
s_nop 0
buffer_load_dwordx4 v16,s[28:31],s62 offen lds
s_add_u32 s62,s62,32768
s_add_u32 m0,m0,1024
s_nop 0
buffer_load_dwordx4 v16,s[28:31],s62 offen lds
s_add_u32 s62,s62,32768
s_add_u32 m0,m0,1024
s_nop 0
buffer_load_dwordx4 v16,s[28:31],s62 offen lds
s_add_u32 s62,s62,32768
s_add_u32 m0,m0,1024
s_nop 0
buffer_load_dwordx4 v16,s[28:31],s62 offen lds
s_add_u32 s62,s62,32768
s_add_u32 m0,m0,1024
s_nop 0
buffer_load_dwordx4 v16,s[28:31],s62 offen lds
s_waitcnt vmcnt(16)
ds_read_b64_tr_b16 a[0:1],v17 offset:0
ds_read_b64_tr_b16 a[2:3],v17 offset:256
ds_read_b64_tr_b16 a[4:5],v17 offset:8
ds_read_b64_tr_b16 a[6:7],v17 offset:264
ds_read_b64_tr_b16 a[8:9],v17 offset:2048
ds_read_b64_tr_b16 a[10:11],v17 offset:2304
ds_read_b64_tr_b16 a[12:13],v17 offset:2056
ds_read_b64_tr_b16 a[14:15],v17 offset:2312
ds_read_b64_tr_b16 a[16:17],v17 offset:4096
ds_read_b64_tr_b16 a[18:19],v17 offset:4352
ds_read_b64_tr_b16 a[20:21],v17 offset:4104
ds_read_b64_tr_b16 a[22:23],v17 offset:4360
s_waitcnt lgkmcnt(0)
ds_read_b64_tr_b16 a[24:25],v17 offset:6144
ds_read_b64_tr_b16 a[26:27],v17 offset:6400
ds_read_b64_tr_b16 a[28:29],v17 offset:6152
ds_read_b64_tr_b16 a[30:31],v17 offset:6408
ds_read_b64_tr_b16 a[32:33],v17 offset:8192
ds_read_b64_tr_b16 a[34:35],v17 offset:8448
ds_read_b64_tr_b16 a[36:37],v17 offset:8200
ds_read_b64_tr_b16 a[38:39],v17 offset:8456
ds_read_b64_tr_b16 a[40:41],v17 offset:10240
ds_read_b64_tr_b16 a[42:43],v17 offset:10496
ds_read_b64_tr_b16 a[44:45],v17 offset:10248
ds_read_b64_tr_b16 a[46:47],v17 offset:10504
s_waitcnt lgkmcnt(0)
ds_read_b64_tr_b16 a[48:49],v17 offset:12288
ds_read_b64_tr_b16 a[50:51],v17 offset:12544
ds_read_b64_tr_b16 a[52:53],v17 offset:12296
ds_read_b64_tr_b16 a[54:55],v17 offset:12552
ds_read_b64_tr_b16 a[56:57],v17 offset:14336
ds_read_b64_tr_b16 a[58:59],v17 offset:14592
ds_read_b64_tr_b16 a[60:61],v17 offset:14344
ds_read_b64_tr_b16 a[62:63],v17 offset:14600
s_waitcnt lgkmcnt(0)
s_xor_b32 s62,s50,2
s_mul_i32 s62,s62,524288
s_add_u32 s62,s62,s54
s_add_u32 m0,s61,0
s_nop 0
buffer_load_dwordx4 v16,s[28:31],s62 offen lds
s_add_u32 s62,s62,32768
s_add_u32 m0,m0,1024
s_nop 0
buffer_load_dwordx4 v16,s[28:31],s62 offen lds
s_add_u32 s62,s62,32768
s_add_u32 m0,m0,1024
s_nop 0
buffer_load_dwordx4 v16,s[28:31],s62 offen lds
s_add_u32 s62,s62,32768
s_add_u32 m0,m0,1024
s_nop 0
buffer_load_dwordx4 v16,s[28:31],s62 offen lds
s_add_u32 s62,s62,32768
s_add_u32 m0,m0,1024
s_nop 0
buffer_load_dwordx4 v16,s[28:31],s62 offen lds
s_add_u32 s62,s62,32768
s_add_u32 m0,m0,1024
s_nop 0
buffer_load_dwordx4 v16,s[28:31],s62 offen lds
s_add_u32 s62,s62,32768
s_add_u32 m0,m0,1024
s_nop 0
buffer_load_dwordx4 v16,s[28:31],s62 offen lds
s_add_u32 s62,s62,32768
s_add_u32 m0,m0,1024
s_nop 0
buffer_load_dwordx4 v16,s[28:31],s62 offen lds
s_add_u32 s62,s62,32768
s_add_u32 m0,m0,1024
s_nop 0
buffer_load_dwordx4 v16,s[28:31],s62 offen lds
s_add_u32 s62,s62,32768
s_add_u32 m0,m0,1024
s_nop 0
buffer_load_dwordx4 v16,s[28:31],s62 offen lds
s_add_u32 s62,s62,32768
s_add_u32 m0,m0,1024
s_nop 0
buffer_load_dwordx4 v16,s[28:31],s62 offen lds
s_add_u32 s62,s62,32768
s_add_u32 m0,m0,1024
s_nop 0
buffer_load_dwordx4 v16,s[28:31],s62 offen lds
s_add_u32 s62,s62,32768
s_add_u32 m0,m0,1024
s_nop 0
buffer_load_dwordx4 v16,s[28:31],s62 offen lds
s_add_u32 s62,s62,32768
s_add_u32 m0,m0,1024
s_nop 0
buffer_load_dwordx4 v16,s[28:31],s62 offen lds
s_add_u32 s62,s62,32768
s_add_u32 m0,m0,1024
s_nop 0
buffer_load_dwordx4 v16,s[28:31],s62 offen lds
s_add_u32 s62,s62,32768
s_add_u32 m0,m0,1024
s_nop 0
buffer_load_dwordx4 v16,s[28:31],s62 offen lds
s_waitcnt vmcnt(16)
ds_read_b64_tr_b16 a[64:65],v17 offset:16384
ds_read_b64_tr_b16 a[66:67],v17 offset:16640
ds_read_b64_tr_b16 a[68:69],v17 offset:16392
ds_read_b64_tr_b16 a[70:71],v17 offset:16648
ds_read_b64_tr_b16 a[72:73],v17 offset:18432
ds_read_b64_tr_b16 a[74:75],v17 offset:18688
ds_read_b64_tr_b16 a[76:77],v17 offset:18440
ds_read_b64_tr_b16 a[78:79],v17 offset:18696
ds_read_b64_tr_b16 a[80:81],v17 offset:20480
ds_read_b64_tr_b16 a[82:83],v17 offset:20736
ds_read_b64_tr_b16 a[84:85],v17 offset:20488
ds_read_b64_tr_b16 a[86:87],v17 offset:20744
s_waitcnt lgkmcnt(0)
ds_read_b64_tr_b16 a[88:89],v17 offset:22528
ds_read_b64_tr_b16 a[90:91],v17 offset:22784
ds_read_b64_tr_b16 a[92:93],v17 offset:22536
ds_read_b64_tr_b16 a[94:95],v17 offset:22792
ds_read_b64_tr_b16 a[96:97],v17 offset:24576
ds_read_b64_tr_b16 a[98:99],v17 offset:24832
ds_read_b64_tr_b16 a[100:101],v17 offset:24584
ds_read_b64_tr_b16 a[102:103],v17 offset:24840
ds_read_b64_tr_b16 a[104:105],v17 offset:26624
ds_read_b64_tr_b16 a[106:107],v17 offset:26880
ds_read_b64_tr_b16 a[108:109],v17 offset:26632
ds_read_b64_tr_b16 a[110:111],v17 offset:26888
s_waitcnt lgkmcnt(0)
ds_read_b64_tr_b16 a[112:113],v17 offset:28672
ds_read_b64_tr_b16 a[114:115],v17 offset:28928
ds_read_b64_tr_b16 a[116:117],v17 offset:28680
ds_read_b64_tr_b16 a[118:119],v17 offset:28936
ds_read_b64_tr_b16 a[120:121],v17 offset:30720
ds_read_b64_tr_b16 a[122:123],v17 offset:30976
ds_read_b64_tr_b16 a[124:125],v17 offset:30728
ds_read_b64_tr_b16 a[126:127],v17 offset:30984
s_waitcnt lgkmcnt(0)
s_xor_b32 s62,s50,3
s_mul_i32 s62,s62,524288
s_add_u32 s62,s62,s54
s_add_u32 m0,s61,16384
s_nop 0
buffer_load_dwordx4 v16,s[28:31],s62 offen lds
s_add_u32 s62,s62,32768
s_add_u32 m0,m0,1024
s_nop 0
buffer_load_dwordx4 v16,s[28:31],s62 offen lds
s_add_u32 s62,s62,32768
s_add_u32 m0,m0,1024
s_nop 0
buffer_load_dwordx4 v16,s[28:31],s62 offen lds
s_add_u32 s62,s62,32768
s_add_u32 m0,m0,1024
s_nop 0
buffer_load_dwordx4 v16,s[28:31],s62 offen lds
s_add_u32 s62,s62,32768
s_add_u32 m0,m0,1024
s_nop 0
buffer_load_dwordx4 v16,s[28:31],s62 offen lds
s_add_u32 s62,s62,32768
s_add_u32 m0,m0,1024
s_nop 0
buffer_load_dwordx4 v16,s[28:31],s62 offen lds
s_add_u32 s62,s62,32768
s_add_u32 m0,m0,1024
s_nop 0
buffer_load_dwordx4 v16,s[28:31],s62 offen lds
s_add_u32 s62,s62,32768
s_add_u32 m0,m0,1024
s_nop 0
buffer_load_dwordx4 v16,s[28:31],s62 offen lds
s_add_u32 s62,s62,32768
s_add_u32 m0,m0,1024
s_nop 0
buffer_load_dwordx4 v16,s[28:31],s62 offen lds
s_add_u32 s62,s62,32768
s_add_u32 m0,m0,1024
s_nop 0
buffer_load_dwordx4 v16,s[28:31],s62 offen lds
s_add_u32 s62,s62,32768
s_add_u32 m0,m0,1024
s_nop 0
buffer_load_dwordx4 v16,s[28:31],s62 offen lds
s_add_u32 s62,s62,32768
s_add_u32 m0,m0,1024
s_nop 0
buffer_load_dwordx4 v16,s[28:31],s62 offen lds
s_add_u32 s62,s62,32768
s_add_u32 m0,m0,1024
s_nop 0
buffer_load_dwordx4 v16,s[28:31],s62 offen lds
s_add_u32 s62,s62,32768
s_add_u32 m0,m0,1024
s_nop 0
buffer_load_dwordx4 v16,s[28:31],s62 offen lds
s_add_u32 s62,s62,32768
s_add_u32 m0,m0,1024
s_nop 0
buffer_load_dwordx4 v16,s[28:31],s62 offen lds
s_add_u32 s62,s62,32768
s_add_u32 m0,m0,1024
s_nop 0
buffer_load_dwordx4 v16,s[28:31],s62 offen lds
s_waitcnt vmcnt(16)
ds_read_b64_tr_b16 a[128:129],v17 offset:0
ds_read_b64_tr_b16 a[130:131],v17 offset:256
ds_read_b64_tr_b16 a[132:133],v17 offset:8
ds_read_b64_tr_b16 a[134:135],v17 offset:264
ds_read_b64_tr_b16 a[136:137],v17 offset:2048
ds_read_b64_tr_b16 a[138:139],v17 offset:2304
ds_read_b64_tr_b16 a[140:141],v17 offset:2056
ds_read_b64_tr_b16 a[142:143],v17 offset:2312
ds_read_b64_tr_b16 a[144:145],v17 offset:4096
ds_read_b64_tr_b16 a[146:147],v17 offset:4352
ds_read_b64_tr_b16 a[148:149],v17 offset:4104
ds_read_b64_tr_b16 a[150:151],v17 offset:4360
s_waitcnt lgkmcnt(0)
ds_read_b64_tr_b16 a[152:153],v17 offset:6144
ds_read_b64_tr_b16 a[154:155],v17 offset:6400
ds_read_b64_tr_b16 a[156:157],v17 offset:6152
ds_read_b64_tr_b16 a[158:159],v17 offset:6408
ds_read_b64_tr_b16 a[160:161],v17 offset:8192
ds_read_b64_tr_b16 a[162:163],v17 offset:8448
ds_read_b64_tr_b16 a[164:165],v17 offset:8200
ds_read_b64_tr_b16 a[166:167],v17 offset:8456
ds_read_b64_tr_b16 a[168:169],v17 offset:10240
ds_read_b64_tr_b16 a[170:171],v17 offset:10496
ds_read_b64_tr_b16 a[172:173],v17 offset:10248
ds_read_b64_tr_b16 a[174:175],v17 offset:10504
s_waitcnt lgkmcnt(0)
ds_read_b64_tr_b16 a[176:177],v17 offset:12288
ds_read_b64_tr_b16 a[178:179],v17 offset:12544
ds_read_b64_tr_b16 a[180:181],v17 offset:12296
ds_read_b64_tr_b16 a[182:183],v17 offset:12552
ds_read_b64_tr_b16 a[184:185],v17 offset:14336
ds_read_b64_tr_b16 a[186:187],v17 offset:14592
ds_read_b64_tr_b16 a[188:189],v17 offset:14344
ds_read_b64_tr_b16 a[190:191],v17 offset:14600
s_waitcnt lgkmcnt(0)
s_waitcnt vmcnt(0)
ds_read_b64_tr_b16 a[192:193],v17 offset:16384
ds_read_b64_tr_b16 a[194:195],v17 offset:16640
ds_read_b64_tr_b16 a[196:197],v17 offset:16392
ds_read_b64_tr_b16 a[198:199],v17 offset:16648
ds_read_b64_tr_b16 a[200:201],v17 offset:18432
ds_read_b64_tr_b16 a[202:203],v17 offset:18688
ds_read_b64_tr_b16 a[204:205],v17 offset:18440
ds_read_b64_tr_b16 a[206:207],v17 offset:18696
ds_read_b64_tr_b16 a[208:209],v17 offset:20480
ds_read_b64_tr_b16 a[210:211],v17 offset:20736
ds_read_b64_tr_b16 a[212:213],v17 offset:20488
ds_read_b64_tr_b16 a[214:215],v17 offset:20744
s_waitcnt lgkmcnt(0)
ds_read_b64_tr_b16 a[216:217],v17 offset:22528
ds_read_b64_tr_b16 a[218:219],v17 offset:22784
ds_read_b64_tr_b16 a[220:221],v17 offset:22536
ds_read_b64_tr_b16 a[222:223],v17 offset:22792
ds_read_b64_tr_b16 a[224:225],v17 offset:24576
ds_read_b64_tr_b16 a[226:227],v17 offset:24832
ds_read_b64_tr_b16 a[228:229],v17 offset:24584
ds_read_b64_tr_b16 a[230:231],v17 offset:24840
ds_read_b64_tr_b16 a[232:233],v17 offset:26624
ds_read_b64_tr_b16 a[234:235],v17 offset:26880
ds_read_b64_tr_b16 a[236:237],v17 offset:26632
ds_read_b64_tr_b16 a[238:239],v17 offset:26888
s_waitcnt lgkmcnt(0)
ds_read_b64_tr_b16 a[240:241],v17 offset:28672
ds_read_b64_tr_b16 a[242:243],v17 offset:28928
ds_read_b64_tr_b16 a[244:245],v17 offset:28680
ds_read_b64_tr_b16 a[246:247],v17 offset:28936
ds_read_b64_tr_b16 a[248:249],v17 offset:30720
ds_read_b64_tr_b16 a[250:251],v17 offset:30976
ds_read_b64_tr_b16 a[252:253],v17 offset:30728
ds_read_b64_tr_b16 a[254:255],v17 offset:30984
s_waitcnt lgkmcnt(0)
s_mov_b32 s67,0
s_cmp_eq_u32 s56,1
s_cbranch_scc1 vok_31
v_mbcnt_lo_u32_b32 v16,-1,0
v_and_b32 v16,7,v16
v_lshlrev_b32 v16,7,v16
s_mov_b32 s64,138510336
vpoll_32:
buffer_load_dword v17,v16,s[20:23],s64 offen sc1
s_waitcnt vmcnt(0)
v_readlane_b32 s92,v17,0
v_readlane_b32 s93,v17,1
v_readlane_b32 s94,v17,2
v_readlane_b32 s95,v17,3
v_readlane_b32 s96,v17,4
v_readlane_b32 s97,v17,5
v_readlane_b32 s98,v17,6
v_readlane_b32 s99,v17,7
s_add_u32 s65,s92,s93
s_add_u32 s65,s65,s94
s_add_u32 s65,s65,s95
s_add_u32 s65,s65,s96
s_add_u32 s65,s65,s97
s_add_u32 s65,s65,s98
s_add_u32 s65,s65,s99
s_cmp_ge_u32 s65,256
s_cbranch_scc1 vgot_33
s_sleep 4
s_sub_u32 s90,s90,1
s_cmp_gt_i32 s90,0
s_cbranch_scc1 vpoll_32
vgot_33:
s_min_u32 s65,s92,s93
s_min_u32 s65,s65,s94
s_min_u32 s65,s65,s95
s_min_u32 s65,s65,s96
s_min_u32 s65,s65,s97
s_min_u32 s65,s65,s98
s_min_u32 s65,s65,s99
s_cmp_lt_u32 s65,32
s_cbranch_scc1 fl_slow
s_mov_b32 s56,0
vok_31:
s_barrier
v_lshlrev_b32 v0,4,v1
s_mov_b32 s60,0
s_mov_b32 s70,0
s_mov_b32 s55,0
s_lshl_b32 s63,s50,13
v_mov_b32 v3,v0
s_mov_b32 s73,0xffff0000
s_lshl_b32 s64,s52,2
s_add_u32 s64,s64,s50
s_mul_i32 s61,s64,8192
s_add_u32 s61,s61,150994944
s_lshl_b32 s82,s64,8
s_add_u32 s82,s82,138543104
s_mov_b32 s68,s82
s_lshl_b32 s83,s53,2
s_add_u32 s83,s83,s50
s_xor_b32 s64,s50,0
s_lshl_b32 s64,s64,13
v_add_u32 v8,s64,v0
s_xor_b32 s64,s50,1
s_lshl_b32 s64,s64,13
v_add_u32 v9,s64,v0
s_xor_b32 s64,s50,2
s_lshl_b32 s64,s64,13
v_add_u32 v10,s64,v0
s_xor_b32 s64,s50,3
s_lshl_b32 s64,s64,13
v_add_u32 v11,s64,v0
v_min_u32 v2,1,v1
v_lshlrev_b32 v2,2,v2
s_lshl_b32 s66,s83,10
s_lshr_b32 s65,s83,3
s_lshl_b32 s65,s65,8
s_and_b32 s64,s83,7
s_lshl_b32 s64,s64,2
s_add_u32 s69,s64,s65
s_add_u32 s69,s69,138547200
s_lshl_b32 s64,s53,2
s_add_u32 s64,s64,s50
s_mul_i32 s74,s64,24576
s_xor_b32 s64,s50,s52
s_sub_u32 s64,s64,1
s_max_i32 s64,s64,0
s_lshl_b32 s64,s64,11
s_add_u32 s74,s74,s64
s_add_u32 s74,s74,167772160
s_mov_b32 s75,0
s_mov_b32 s76,0
s_mov_b32 s77,0
v_lshlrev_b32 v26,11,v21
v_lshl_add_u32 v26,v22,4,v26
s_lshl_b32 s64,s83,6
v_add_u32 v18,s64,v26
v_lshlrev_b32 v26,5,v22
s_lshl_b32 s64,s83,7
s_add_u32 s64,s64,267395072
buffer_load_dwordx4 v[152:155],v26,s[20:23],s64 offen
buffer_load_dwordx4 v[156:159],v26,s[20:23],s64 offen offset:16
v_mov_b32 v204,-1
v_mov_b32 v205,-1
v_mov_b32 v206,-1
v_mov_b32 v207,-1
s_cmp_eq_u32 s50,s52
s_cbranch_scc1 lfin_36
s_add_u32 s71,s60,0
s_and_b32 s68,s71,1
s_lshl_b32 s68,s68,3
s_add_u32 s68,s68,s82
s_lshr_b32 s71,s71,1
s_add_u32 s71,s71,1
plp_42:
buffer_load_dword v16,v2,s[20:23],s68 offen sc1
s_waitcnt vmcnt(0)
v_cmp_gt_u32 vcc,s71,v16
s_cbranch_vccz pok_43
s_sleep 4
s_sub_u32 s90,s90,1
s_cmp_gt_i32 s90,0
s_cbranch_scc1 plp_42
pok_43:
lag_41:
s_add_u32 m0,s70,s63
s_add_u32 s62,s61,4096
buffer_load_dwordx4 v3,s[20:23],s61 offen offset:0 lds
buffer_load_dwordx4 v3,s[20:23],s61 offen offset:1024 lds
buffer_load_dwordx4 v3,s[20:23],s61 offen offset:2048 lds
buffer_load_dwordx4 v3,s[20:23],s61 offen offset:3072 lds
s_add_u32 m0,m0,4096
s_nop 0
buffer_load_dwordx4 v3,s[20:23],s62 offen offset:0 lds
buffer_load_dwordx4 v3,s[20:23],s62 offen offset:1024 lds
buffer_load_dwordx4 v3,s[20:23],s62 offen offset:2048 lds
buffer_load_dwordx4 v3,s[20:23],s62 offen offset:3072 lds
s_add_u32 s61,s61,131072
s_add_u32 s70,s70,32768
s_and_b32 s70,s70,0x1ffff
buffer_load_dword v17,off,s[20:23],s69
buffer_load_dword v17,off,s[20:23],s69
top_37:
s_add_u32 s71,s60,1
s_and_b32 s68,s71,1
s_lshl_b32 s68,s68,3
s_add_u32 s68,s68,s82
s_lshr_b32 s71,s71,1
s_add_u32 s71,s71,1
buffer_load_dword v16,v2,s[20:23],s68 offen sc1
v_add_u32 v4,s55,v8
v_add_u32 v5,s55,v9
v_add_u32 v6,s55,v10
v_add_u32 v7,s55,v11
s_add_u32 s55,s55,32768
s_and_b32 s55,s55,0x1ffff
s_waitcnt vmcnt(10)
ds_read_b128 v[64:67],v4 offset:0
s_waitcnt vmcnt(9)
ds_read_b128 v[68:71],v4 offset:1024
s_waitcnt vmcnt(8)
ds_read_b128 v[72:75],v4 offset:2048
s_waitcnt lgkmcnt(2)
v_mfma_f32_16x16x32_bf16 v[32:35],a[0:3],v[64:67],0
v_mfma_f32_16x16x32_bf16 v[36:39],a[4:7],v[64:67],0
s_waitcnt vmcnt(7)
ds_read_b128 v[76:79],v4 offset:3072
s_waitcnt lgkmcnt(2)
v_mfma_f32_16x16x32_bf16 v[32:35],a[8:11],v[68:71],v[32:35]
v_mfma_f32_16x16x32_bf16 v[36:39],a[12:15],v[68:71],v[36:39]
s_waitcnt vmcnt(6)
ds_read_b128 v[80:83],v4 offset:4096
s_waitcnt lgkmcnt(2)
v_mfma_f32_16x16x32_bf16 v[32:35],a[16:19],v[72:75],v[32:35]
v_mfma_f32_16x16x32_bf16 v[36:39],a[20:23],v[72:75],v[36:39]
s_waitcnt vmcnt(5)
ds_read_b128 v[84:87],v4 offset:5120
s_waitcnt lgkmcnt(2)
v_mfma_f32_16x16x32_bf16 v[32:35],a[24:27],v[76:79],v[32:35]
v_mfma_f32_16x16x32_bf16 v[36:39],a[28:31],v[76:79],v[36:39]
s_waitcnt vmcnt(4)
ds_read_b128 v[88:91],v4 offset:6144
s_waitcnt lgkmcnt(2)
v_mfma_f32_16x16x32_bf16 v[32:35],a[32:35],v[80:83],v[32:35]
v_mfma_f32_16x16x32_bf16 v[36:39],a[36:39],v[80:83],v[36:39]
s_waitcnt vmcnt(3)
ds_read_b128 v[92:95],v4 offset:7168
s_barrier
s_waitcnt lgkmcnt(2)
v_mfma_f32_16x16x32_bf16 v[32:35],a[40:43],v[84:87],v[32:35]
v_mfma_f32_16x16x32_bf16 v[36:39],a[44:47],v[84:87],v[36:39]
ds_read_b128 v[96:99],v5 offset:0
s_waitcnt lgkmcnt(2)
v_mfma_f32_16x16x32_bf16 v[32:35],a[48:51],v[88:91],v[32:35]
ds_read_b128 v[100:103],v5 offset:1024
ds_read_b128 v[104:107],v5 offset:2048
v_mfma_f32_16x16x32_bf16 v[36:39],a[52:55],v[88:91],v[36:39]
s_waitcnt lgkmcnt(3)
v_mfma_f32_16x16x32_bf16 v[32:35],a[56:59],v[92:95],v[32:35]
ds_read_b128 v[108:111],v5 offset:3072
ds_read_b128 v[112:115],v5 offset:4096
v_mfma_f32_16x16x32_bf16 v[36:39],a[60:63],v[92:95],v[36:39]
s_waitcnt lgkmcnt(4)
v_mfma_f32_16x16x32_bf16 v[32:35],a[64:67],v[96:99],v[32:35]
ds_read_b128 v[116:119],v5 offset:5120
ds_read_b128 v[120:123],v5 offset:6144
v_mfma_f32_16x16x32_bf16 v[36:39],a[68:71],v[96:99],v[36:39]
s_waitcnt lgkmcnt(5)
v_mfma_f32_16x16x32_bf16 v[32:35],a[72:75],v[100:103],v[32:35]
ds_read_b128 v[124:127],v5 offset:7168
v_mfma_f32_16x16x32_bf16 v[36:39],a[76:79],v[100:103],v[36:39]
s_waitcnt lgkmcnt(5)
v_mfma_f32_16x16x32_bf16 v[32:35],a[80:83],v[104:107],v[32:35]
ds_read_b128 v[64:67],v6 offset:0
v_mfma_f32_16x16x32_bf16 v[36:39],a[84:87],v[104:107],v[36:39]
s_waitcnt lgkmcnt(5)
v_mfma_f32_16x16x32_bf16 v[32:35],a[88:91],v[108:111],v[32:35]
ds_read_b128 v[68:71],v6 offset:1024
v_mfma_f32_16x16x32_bf16 v[36:39],a[92:95],v[108:111],v[36:39]
s_waitcnt lgkmcnt(5)
v_mfma_f32_16x16x32_bf16 v[32:35],a[96:99],v[112:115],v[32:35]
ds_read_b128 v[72:75],v6 offset:2048
v_mfma_f32_16x16x32_bf16 v[36:39],a[100:103],v[112:115],v[36:39]
s_waitcnt lgkmcnt(5)
v_mfma_f32_16x16x32_bf16 v[32:35],a[104:107],v[116:119],v[32:35]
ds_read_b128 v[76:79],v6 offset:3072
v_mfma_f32_16x16x32_bf16 v[36:39],a[108:111],v[116:119],v[36:39]
s_waitcnt lgkmcnt(5)
v_mfma_f32_16x16x32_bf16 v[32:35],a[112:115],v[120:123],v[32:35]
ds_read_b128 v[80:83],v6 offset:4096
v_mfma_f32_16x16x32_bf16 v[36:39],a[116:119],v[120:123],v[36:39]
s_waitcnt lgkmcnt(5)
v_mfma_f32_16x16x32_bf16 v[32:35],a[120:123],v[124:127],v[32:35]
ds_read_b128 v[84:87],v6 offset:5120
v_mfma_f32_16x16x32_bf16 v[36:39],a[124:127],v[124:127],v[36:39]
s_waitcnt lgkmcnt(5)
v_mfma_f32_16x16x32_bf16 v[32:35],a[128:131],v[64:67],v[32:35]
ds_read_b128 v[88:91],v6 offset:6144
v_mfma_f32_16x16x32_bf16 v[36:39],a[132:135],v[64:67],v[36:39]
s_waitcnt lgkmcnt(5)
v_mfma_f32_16x16x32_bf16 v[32:35],a[136:139],v[68:71],v[32:35]
ds_read_b128 v[92:95],v6 offset:7168
v_mfma_f32_16x16x32_bf16 v[36:39],a[140:143],v[68:71],v[36:39]
s_waitcnt lgkmcnt(5)
v_mfma_f32_16x16x32_bf16 v[32:35],a[144:147],v[72:75],v[32:35]
ds_read_b128 v[96:99],v7 offset:0
v_mfma_f32_16x16x32_bf16 v[36:39],a[148:151],v[72:75],v[36:39]
s_waitcnt lgkmcnt(5)
v_mfma_f32_16x16x32_bf16 v[32:35],a[152:155],v[76:79],v[32:35]
ds_read_b128 v[100:103],v7 offset:1024
v_mfma_f32_16x16x32_bf16 v[36:39],a[156:159],v[76:79],v[36:39]
s_waitcnt lgkmcnt(5)
v_mfma_f32_16x16x32_bf16 v[32:35],a[160:163],v[80:83],v[32:35]
ds_read_b128 v[104:107],v7 offset:2048
v_mfma_f32_16x16x32_bf16 v[36:39],a[164:167],v[80:83],v[36:39]
s_waitcnt lgkmcnt(5)
v_mfma_f32_16x16x32_bf16 v[32:35],a[168:171],v[84:87],v[32:35]
ds_read_b128 v[108:111],v7 offset:3072
v_mfma_f32_16x16x32_bf16 v[36:39],a[172:175],v[84:87],v[36:39]
s_waitcnt vmcnt(0)
v_cmp_gt_u32 vcc,s71,v16
s_cbranch_vccnz vN_38
s_waitcnt lgkmcnt(5)
v_mfma_f32_16x16x32_bf16 v[32:35],a[176:179],v[88:91],v[32:35]
ds_read_b128 v[112:115],v7 offset:4096
s_add_u32 m0,s70,s63
v_mfma_f32_16x16x32_bf16 v[36:39],a[180:183],v[88:91],v[36:39]
s_add_u32 s62,s61,4096
s_waitcnt lgkmcnt(5)
v_mfma_f32_16x16x32_bf16 v[32:35],a[184:187],v[92:95],v[32:35]
ds_read_b128 v[116:119],v7 offset:5120
buffer_load_dwordx4 v3,s[20:23],s61 offen offset:0 lds
v_mfma_f32_16x16x32_bf16 v[36:39],a[188:191],v[92:95],v[36:39]
buffer_load_dwordx4 v3,s[20:23],s61 offen offset:1024 lds
s_waitcnt lgkmcnt(5)
v_mfma_f32_16x16x32_bf16 v[32:35],a[192:195],v[96:99],v[32:35]
ds_read_b128 v[120:123],v7 offset:6144
buffer_load_dwordx4 v3,s[20:23],s61 offen offset:2048 lds
v_mfma_f32_16x16x32_bf16 v[36:39],a[196:199],v[96:99],v[36:39]
buffer_load_dwordx4 v3,s[20:23],s61 offen offset:3072 lds
s_waitcnt lgkmcnt(5)
v_mfma_f32_16x16x32_bf16 v[32:35],a[200:203],v[100:103],v[32:35]
ds_read_b128 v[124:127],v7 offset:7168
s_add_u32 m0,m0,4096
v_mfma_f32_16x16x32_bf16 v[36:39],a[204:207],v[100:103],v[36:39]
buffer_load_dwordx4 v3,s[20:23],s62 offen offset:0 lds
s_waitcnt lgkmcnt(5)
v_mfma_f32_16x16x32_bf16 v[32:35],a[208:211],v[104:107],v[32:35]
buffer_load_dwordx4 v3,s[20:23],s62 offen offset:1024 lds
v_mfma_f32_16x16x32_bf16 v[36:39],a[212:215],v[104:107],v[36:39]
buffer_load_dwordx4 v3,s[20:23],s62 offen offset:2048 lds
s_waitcnt lgkmcnt(4)
v_mfma_f32_16x16x32_bf16 v[32:35],a[216:219],v[108:111],v[32:35]
buffer_load_dwordx4 v3,s[20:23],s62 offen offset:3072 lds
v_mfma_f32_16x16x32_bf16 v[36:39],a[220:223],v[108:111],v[36:39]
s_add_u32 s61,s61,131072
s_waitcnt lgkmcnt(3)
v_mfma_f32_16x16x32_bf16 v[32:35],a[224:227],v[112:115],v[32:35]
s_add_u32 s70,s70,32768
v_mfma_f32_16x16x32_bf16 v[36:39],a[228:231],v[112:115],v[36:39]
s_and_b32 s70,s70,0x1ffff
s_waitcnt lgkmcnt(2)
v_mfma_f32_16x16x32_bf16 v[32:35],a[232:235],v[116:119],v[32:35]
v_mfma_f32_16x16x32_bf16 v[36:39],a[236:239],v[116:119],v[36:39]
s_waitcnt lgkmcnt(1)
v_mfma_f32_16x16x32_bf16 v[32:35],a[240:243],v[120:123],v[32:35]
v_mfma_f32_16x16x32_bf16 v[36:39],a[244:247],v[120:123],v[36:39]
s_waitcnt lgkmcnt(0)
v_mfma_f32_16x16x32_bf16 v[32:35],a[248:251],v[124:127],v[32:35]
v_mfma_f32_16x16x32_bf16 v[36:39],a[252:255],v[124:127],v[36:39]
s_mov_b32 s72,1
join_39:
s_add_u32 s64,s74,s75
s_cmp_eq_u32 s56,1
s_cbranch_scc1 b1_44
s_nop 2
buffer_store_dwordx4 v[32:35],v0,s[20:23],s64 offen offset:0
buffer_store_dwordx4 v[36:39],v0,s[20:23],s64 offen offset:1024
b2_45:
s_add_u32 s75,s75,6144
s_cmp_eq_u32 s75,24576
s_cselect_b32 s75,0,s75
s_add_u32 s60,s60,1
s_cmp_eq_u32 s72,0
s_cbranch_scc1 slowp_40
s_branch top_37
slowp_40:
s_waitcnt vmcnt(2)
v_cmp_gt_u32 vcc,s71,v16
s_cbranch_vccz lag_41
s_cmp_ge_u32 s60,128
s_cbranch_scc1 done_30
plp_46:
buffer_load_dword v16,v2,s[20:23],s68 offen sc1
s_waitcnt vmcnt(0)
v_cmp_gt_u32 vcc,s71,v16
s_cbranch_vccz pok_47
s_sleep 4
s_sub_u32 s90,s90,1
s_cmp_gt_i32 s90,0
s_cbranch_scc1 plp_46
pok_47:
s_branch lag_41
lfin_36:
s_add_u32 s71,s60,0
s_and_b32 s68,s71,1
s_lshl_b32 s68,s68,3
s_add_u32 s68,s68,s82
s_lshr_b32 s71,s71,1
s_add_u32 s71,s71,1
plp_53:
buffer_load_dword v16,v2,s[20:23],s68 offen sc1
s_waitcnt vmcnt(0)
v_cmp_gt_u32 vcc,s71,v16
s_cbranch_vccz pok_54
s_sleep 4
s_sub_u32 s90,s90,1
s_cmp_gt_i32 s90,0
s_cbranch_scc1 plp_53
pok_54:
lag_52:
s_add_u32 m0,s70,s63
s_add_u32 s62,s61,4096
buffer_load_dwordx4 v3,s[20:23],s61 offen offset:0 lds
buffer_load_dwordx4 v3,s[20:23],s61 offen offset:1024 lds
buffer_load_dwordx4 v3,s[20:23],s61 offen offset:2048 lds
buffer_load_dwordx4 v3,s[20:23],s61 offen offset:3072 lds
s_add_u32 m0,m0,4096
s_nop 0
buffer_load_dwordx4 v3,s[20:23],s62 offen offset:0 lds
buffer_load_dwordx4 v3,s[20:23],s62 offen offset:1024 lds
buffer_load_dwordx4 v3,s[20:23],s62 offen offset:2048 lds
buffer_load_dwordx4 v3,s[20:23],s62 offen offset:3072 lds
s_add_u32 s61,s61,131072
s_add_u32 s70,s70,32768
s_and_b32 s70,s70,0x1ffff
top_48:
s_add_u32 s71,s60,1
s_and_b32 s68,s71,1
s_lshl_b32 s68,s68,3
s_add_u32 s68,s68,s82
s_lshr_b32 s71,s71,1
s_add_u32 s71,s71,1
buffer_load_dword v16,v2,s[20:23],s68 offen sc1
s_add_u32 s64,s74,s75
s_add_u32 s65,s64,4096
buffer_load_dwordx4 v[128:131],v0,s[20:23],s64 offen offset:0 sc1
buffer_load_dwordx4 v[132:135],v0,s[20:23],s64 offen offset:1024 sc1
buffer_load_dwordx4 v[136:139],v0,s[20:23],s64 offen offset:2048 sc1
buffer_load_dwordx4 v[140:143],v0,s[20:23],s64 offen offset:3072 sc1
buffer_load_dwordx4 v[144:147],v0,s[20:23],s65 offen offset:0 sc1
buffer_load_dwordx4 v[148:151],v0,s[20:23],s65 offen offset:1024 sc1
s_and_b32 s64,s66,0xffff8000
buffer_load_dwordx4 v[160:163],v18,s[24:27],s64 offen
v_add_u32 v4,s55,v8
v_add_u32 v5,s55,v9
v_add_u32 v6,s55,v10
v_add_u32 v7,s55,v11
s_add_u32 s55,s55,32768
s_and_b32 s55,s55,0x1ffff
s_waitcnt vmcnt(15)
ds_read_b128 v[64:67],v4 offset:0
s_waitcnt vmcnt(14)
ds_read_b128 v[68:71],v4 offset:1024
s_waitcnt vmcnt(13)
ds_read_b128 v[72:75],v4 offset:2048
s_waitcnt lgkmcnt(2)
v_mfma_f32_16x16x32_bf16 v[32:35],a[0:3],v[64:67],0
v_mfma_f32_16x16x32_bf16 v[36:39],a[4:7],v[64:67],0
s_waitcnt vmcnt(12)
ds_read_b128 v[76:79],v4 offset:3072
s_waitcnt lgkmcnt(2)
v_mfma_f32_16x16x32_bf16 v[32:35],a[8:11],v[68:71],v[32:35]
v_mfma_f32_16x16x32_bf16 v[36:39],a[12:15],v[68:71],v[36:39]
s_waitcnt vmcnt(11)
ds_read_b128 v[80:83],v4 offset:4096
s_waitcnt lgkmcnt(2)
v_mfma_f32_16x16x32_bf16 v[32:35],a[16:19],v[72:75],v[32:35]
v_mfma_f32_16x16x32_bf16 v[36:39],a[20:23],v[72:75],v[36:39]
s_waitcnt vmcnt(10)
ds_read_b128 v[84:87],v4 offset:5120
s_waitcnt lgkmcnt(2)
v_mfma_f32_16x16x32_bf16 v[32:35],a[24:27],v[76:79],v[32:35]
v_mfma_f32_16x16x32_bf16 v[36:39],a[28:31],v[76:79],v[36:39]
s_waitcnt vmcnt(9)
ds_read_b128 v[88:91],v4 offset:6144
s_waitcnt lgkmcnt(2)
v_mfma_f32_16x16x32_bf16 v[32:35],a[32:35],v[80:83],v[32:35]
v_mfma_f32_16x16x32_bf16 v[36:39],a[36:39],v[80:83],v[36:39]
s_waitcnt vmcnt(8)
ds_read_b128 v[92:95],v4 offset:7168
s_barrier
s_waitcnt lgkmcnt(2)
v_mfma_f32_16x16x32_bf16 v[32:35],a[40:43],v[84:87],v[32:35]
v_mfma_f32_16x16x32_bf16 v[36:39],a[44:47],v[84:87],v[36:39]
ds_read_b128 v[96:99],v5 offset:0
s_waitcnt lgkmcnt(2)
v_mfma_f32_16x16x32_bf16 v[32:35],a[48:51],v[88:91],v[32:35]
ds_read_b128 v[100:103],v5 offset:1024
ds_read_b128 v[104:107],v5 offset:2048
v_mfma_f32_16x16x32_bf16 v[36:39],a[52:55],v[88:91],v[36:39]
s_waitcnt lgkmcnt(3)
v_mfma_f32_16x16x32_bf16 v[32:35],a[56:59],v[92:95],v[32:35]
ds_read_b128 v[108:111],v5 offset:3072
ds_read_b128 v[112:115],v5 offset:4096
v_mfma_f32_16x16x32_bf16 v[36:39],a[60:63],v[92:95],v[36:39]
s_waitcnt lgkmcnt(4)
v_mfma_f32_16x16x32_bf16 v[32:35],a[64:67],v[96:99],v[32:35]
ds_read_b128 v[116:119],v5 offset:5120
ds_read_b128 v[120:123],v5 offset:6144
v_mfma_f32_16x16x32_bf16 v[36:39],a[68:71],v[96:99],v[36:39]
s_waitcnt lgkmcnt(5)
v_mfma_f32_16x16x32_bf16 v[32:35],a[72:75],v[100:103],v[32:35]
ds_read_b128 v[124:127],v5 offset:7168
v_mfma_f32_16x16x32_bf16 v[36:39],a[76:79],v[100:103],v[36:39]
s_waitcnt lgkmcnt(5)
v_mfma_f32_16x16x32_bf16 v[32:35],a[80:83],v[104:107],v[32:35]
ds_read_b128 v[64:67],v6 offset:0
v_mfma_f32_16x16x32_bf16 v[36:39],a[84:87],v[104:107],v[36:39]
s_waitcnt lgkmcnt(5)
v_mfma_f32_16x16x32_bf16 v[32:35],a[88:91],v[108:111],v[32:35]
ds_read_b128 v[68:71],v6 offset:1024
v_mfma_f32_16x16x32_bf16 v[36:39],a[92:95],v[108:111],v[36:39]
s_waitcnt lgkmcnt(5)
v_mfma_f32_16x16x32_bf16 v[32:35],a[96:99],v[112:115],v[32:35]
ds_read_b128 v[72:75],v6 offset:2048
v_mfma_f32_16x16x32_bf16 v[36:39],a[100:103],v[112:115],v[36:39]
s_waitcnt lgkmcnt(5)
v_mfma_f32_16x16x32_bf16 v[32:35],a[104:107],v[116:119],v[32:35]
ds_read_b128 v[76:79],v6 offset:3072
v_mfma_f32_16x16x32_bf16 v[36:39],a[108:111],v[116:119],v[36:39]
s_waitcnt lgkmcnt(5)
v_mfma_f32_16x16x32_bf16 v[32:35],a[112:115],v[120:123],v[32:35]
ds_read_b128 v[80:83],v6 offset:4096
v_mfma_f32_16x16x32_bf16 v[36:39],a[116:119],v[120:123],v[36:39]
s_waitcnt lgkmcnt(5)
v_mfma_f32_16x16x32_bf16 v[32:35],a[120:123],v[124:127],v[32:35]
ds_read_b128 v[84:87],v6 offset:5120
v_mfma_f32_16x16x32_bf16 v[36:39],a[124:127],v[124:127],v[36:39]
s_waitcnt lgkmcnt(5)
v_mfma_f32_16x16x32_bf16 v[32:35],a[128:131],v[64:67],v[32:35]
ds_read_b128 v[88:91],v6 offset:6144
v_mfma_f32_16x16x32_bf16 v[36:39],a[132:135],v[64:67],v[36:39]
s_waitcnt lgkmcnt(5)
v_mfma_f32_16x16x32_bf16 v[32:35],a[136:139],v[68:71],v[32:35]
ds_read_b128 v[92:95],v6 offset:7168
v_mfma_f32_16x16x32_bf16 v[36:39],a[140:143],v[68:71],v[36:39]
s_waitcnt lgkmcnt(5)
v_mfma_f32_16x16x32_bf16 v[32:35],a[144:147],v[72:75],v[32:35]
ds_read_b128 v[96:99],v7 offset:0
v_mfma_f32_16x16x32_bf16 v[36:39],a[148:151],v[72:75],v[36:39]
s_waitcnt lgkmcnt(5)
v_mfma_f32_16x16x32_bf16 v[32:35],a[152:155],v[76:79],v[32:35]
ds_read_b128 v[100:103],v7 offset:1024
v_mfma_f32_16x16x32_bf16 v[36:39],a[156:159],v[76:79],v[36:39]
s_waitcnt lgkmcnt(5)
v_mfma_f32_16x16x32_bf16 v[32:35],a[160:163],v[80:83],v[32:35]
ds_read_b128 v[104:107],v7 offset:2048
v_mfma_f32_16x16x32_bf16 v[36:39],a[164:167],v[80:83],v[36:39]
s_waitcnt lgkmcnt(5)
v_mfma_f32_16x16x32_bf16 v[32:35],a[168:171],v[84:87],v[32:35]
ds_read_b128 v[108:111],v7 offset:3072
v_mfma_f32_16x16x32_bf16 v[36:39],a[172:175],v[84:87],v[36:39]
s_waitcnt vmcnt(0)
s_cmp_eq_u32 s77,0
s_cbranch_scc1 np_55
ck_56:
v_pk_add_f32 v[128:129],v[128:129],v[136:137]
v_pk_add_f32 v[144:145],v[144:145],v[40:41]
v_pk_add_f32 v[130:131],v[130:131],v[138:139]
v_pk_add_f32 v[146:147],v[146:147],v[42:43]
v_pk_add_f32 v[132:133],v[132:133],v[140:141]
v_pk_add_f32 v[148:149],v[148:149],v[44:45]
v_pk_add_f32 v[134:135],v[134:135],v[142:143]
v_pk_add_f32 v[150:151],v[150:151],v[46:47]
v_pk_add_f32 v[128:129],v[128:129],v[144:145]
v_pk_add_f32 v[130:131],v[130:131],v[146:147]
v_pk_add_f32 v[132:133],v[132:133],v[148:149]
v_pk_add_f32 v[134:135],v[134:135],v[150:151]
v_pk_add_f32 v[168:169],v[128:129],v[130:131]
v_pk_add_f32 v[170:171],v[132:133],v[134:135]
v_pk_add_f32 v[168:169],v[168:169],v[170:171]
v_cmp_u_f32 vcc,v168,v169
s_cbranch_vccnz rt_57
go_58:
v_lshlrev_b32 v168,16,v160
v_and_b32 v169,s73,v160
v_lshlrev_b32 v170,16,v161
v_and_b32 v171,s73,v161
v_lshlrev_b32 v172,16,v162
v_and_b32 v173,s73,v162
v_lshlrev_b32 v174,16,v163
v_and_b32 v175,s73,v163
v_fma_f32 v168,v128,v152,v168
v_fma_f32 v169,v129,v153,v169
v_fma_f32 v170,v130,v154,v170
v_fma_f32 v171,v131,v155,v171
v_fma_f32 v172,v132,v156,v172
v_fma_f32 v173,v133,v157,v173
v_fma_f32 v174,v134,v158,v174
v_fma_f32 v175,v135,v159,v175
v_cvt_pk_bf16_f32 v176,v168,v169
v_cvt_pk_bf16_f32 v177,v170,v171
v_cvt_pk_bf16_f32 v178,v172,v173
v_cvt_pk_bf16_f32 v179,v174,v175
s_add_u32 s64,s66,201326592
buffer_store_dwordx4 v[176:179],v0,s[20:23],s64 offen sc1
s_add_u32 s64,s74,s75
s_add_u32 s65,s64,4096
s_cmp_eq_u32 s56,1
s_cbranch_scc1 b1_59
buffer_store_dwordx4 v[204:207],v0,s[20:23],s64 offen offset:0
buffer_store_dwordx4 v[204:207],v0,s[20:23],s64 offen offset:1024
buffer_store_dwordx4 v[204:207],v0,s[20:23],s64 offen offset:2048
buffer_store_dwordx4 v[204:207],v0,s[20:23],s64 offen offset:3072
buffer_store_dwordx4 v[204:207],v0,s[20:23],s65 offen offset:0
buffer_store_dwordx4 v[204:207],v0,s[20:23],s65 offen offset:1024
b2_60:
s_add_u32 s66,s66,32768
s_add_u32 s75,s75,6144
s_cmp_eq_u32 s75,24576
s_cselect_b32 s75,0,s75
s_add_u32 s76,s76,1
s_mov_b32 s77,0
np_55:
v_cmp_gt_u32 vcc,s71,v16
s_cbranch_vccnz vN_49
s_waitcnt lgkmcnt(5)
v_mfma_f32_16x16x32_bf16 v[32:35],a[176:179],v[88:91],v[32:35]
ds_read_b128 v[112:115],v7 offset:4096
s_add_u32 m0,s70,s63
v_mfma_f32_16x16x32_bf16 v[36:39],a[180:183],v[88:91],v[36:39]
s_add_u32 s62,s61,4096
s_waitcnt lgkmcnt(5)
v_mfma_f32_16x16x32_bf16 v[32:35],a[184:187],v[92:95],v[32:35]
ds_read_b128 v[116:119],v7 offset:5120
buffer_load_dwordx4 v3,s[20:23],s61 offen offset:0 lds
v_mfma_f32_16x16x32_bf16 v[36:39],a[188:191],v[92:95],v[36:39]
buffer_load_dwordx4 v3,s[20:23],s61 offen offset:1024 lds
s_waitcnt lgkmcnt(5)
v_mfma_f32_16x16x32_bf16 v[32:35],a[192:195],v[96:99],v[32:35]
ds_read_b128 v[120:123],v7 offset:6144
buffer_load_dwordx4 v3,s[20:23],s61 offen offset:2048 lds
v_mfma_f32_16x16x32_bf16 v[36:39],a[196:199],v[96:99],v[36:39]
buffer_load_dwordx4 v3,s[20:23],s61 offen offset:3072 lds
s_waitcnt lgkmcnt(5)
v_mfma_f32_16x16x32_bf16 v[32:35],a[200:203],v[100:103],v[32:35]
ds_read_b128 v[124:127],v7 offset:7168
s_add_u32 m0,m0,4096
v_mfma_f32_16x16x32_bf16 v[36:39],a[204:207],v[100:103],v[36:39]
buffer_load_dwordx4 v3,s[20:23],s62 offen offset:0 lds
s_waitcnt lgkmcnt(5)
v_mfma_f32_16x16x32_bf16 v[32:35],a[208:211],v[104:107],v[32:35]
buffer_load_dwordx4 v3,s[20:23],s62 offen offset:1024 lds
v_mfma_f32_16x16x32_bf16 v[36:39],a[212:215],v[104:107],v[36:39]
buffer_load_dwordx4 v3,s[20:23],s62 offen offset:2048 lds
s_waitcnt lgkmcnt(4)
v_mfma_f32_16x16x32_bf16 v[32:35],a[216:219],v[108:111],v[32:35]
buffer_load_dwordx4 v3,s[20:23],s62 offen offset:3072 lds
v_mfma_f32_16x16x32_bf16 v[36:39],a[220:223],v[108:111],v[36:39]
s_add_u32 s61,s61,131072
s_waitcnt lgkmcnt(3)
v_mfma_f32_16x16x32_bf16 v[32:35],a[224:227],v[112:115],v[32:35]
s_add_u32 s70,s70,32768
v_mfma_f32_16x16x32_bf16 v[36:39],a[228:231],v[112:115],v[36:39]
s_and_b32 s70,s70,0x1ffff
s_waitcnt lgkmcnt(2)
v_mfma_f32_16x16x32_bf16 v[32:35],a[232:235],v[116:119],v[32:35]
v_mfma_f32_16x16x32_bf16 v[36:39],a[236:239],v[116:119],v[36:39]
s_waitcnt lgkmcnt(1)
v_mfma_f32_16x16x32_bf16 v[32:35],a[240:243],v[120:123],v[32:35]
v_mfma_f32_16x16x32_bf16 v[36:39],a[244:247],v[120:123],v[36:39]
s_waitcnt lgkmcnt(0)
v_mfma_f32_16x16x32_bf16 v[32:35],a[248:251],v[124:127],v[32:35]
v_mfma_f32_16x16x32_bf16 v[36:39],a[252:255],v[124:127],v[36:39]
s_mov_b32 s72,1
join_50:
s_nop 5
v_mov_b32 v40,v32
v_mov_b32 v41,v33
v_mov_b32 v42,v34
v_mov_b32 v43,v35
v_mov_b32 v44,v36
v_mov_b32 v45,v37
v_mov_b32 v46,v38
v_mov_b32 v47,v39
s_mov_b32 s77,1
s_add_u32 s60,s60,1
s_cmp_eq_u32 s72,0
s_cbranch_scc1 slowp_51
s_waitcnt vmcnt(14)
v_mov_b32 v17,s76
s_mov_b64 exec,1
buffer_store_dword v17,off,s[20:23],s69 sc1
s_mov_b64 exec,-1
s_branch top_48
slowp_51:
s_waitcnt vmcnt(0)
v_mov_b32 v17,s76
s_mov_b64 exec,1
buffer_store_dword v17,off,s[20:23],s69 sc1
s_mov_b64 exec,-1
v_cmp_gt_u32 vcc,s71,v16
s_cbranch_vccz lag_52
s_and_b32 s64,s66,0xffff8000
buffer_load_dwordx4 v[160:163],v18,s[24:27],s64 offen
s_add_u32 s64,s74,s75
s_add_u32 s65,s64,4096
buffer_load_dwordx4 v[128:131],v0,s[20:23],s64 offen offset:0 sc1
buffer_load_dwordx4 v[132:135],v0,s[20:23],s64 offen offset:1024 sc1
buffer_load_dwordx4 v[136:139],v0,s[20:23],s64 offen offset:2048 sc1
buffer_load_dwordx4 v[140:143],v0,s[20:23],s64 offen offset:3072 sc1
buffer_load_dwordx4 v[144:147],v0,s[20:23],s65 offen offset:0 sc1
buffer_load_dwordx4 v[148:151],v0,s[20:23],s65 offen offset:1024 sc1
s_waitcnt vmcnt(0)
ck_61:
v_pk_add_f32 v[128:129],v[128:129],v[136:137]
v_pk_add_f32 v[144:145],v[144:145],v[40:41]
v_pk_add_f32 v[130:131],v[130:131],v[138:139]
v_pk_add_f32 v[146:147],v[146:147],v[42:43]
v_pk_add_f32 v[132:133],v[132:133],v[140:141]
v_pk_add_f32 v[148:149],v[148:149],v[44:45]
v_pk_add_f32 v[134:135],v[134:135],v[142:143]
v_pk_add_f32 v[150:151],v[150:151],v[46:47]
v_pk_add_f32 v[128:129],v[128:129],v[144:145]
v_pk_add_f32 v[130:131],v[130:131],v[146:147]
v_pk_add_f32 v[132:133],v[132:133],v[148:149]
v_pk_add_f32 v[134:135],v[134:135],v[150:151]
v_pk_add_f32 v[168:169],v[128:129],v[130:131]
v_pk_add_f32 v[170:171],v[132:133],v[134:135]
v_pk_add_f32 v[168:169],v[168:169],v[170:171]
v_cmp_u_f32 vcc,v168,v169
s_cbranch_vccnz rt_62
go_63:
v_lshlrev_b32 v168,16,v160
v_and_b32 v169,s73,v160
v_lshlrev_b32 v170,16,v161
v_and_b32 v171,s73,v161
v_lshlrev_b32 v172,16,v162
v_and_b32 v173,s73,v162
v_lshlrev_b32 v174,16,v163
v_and_b32 v175,s73,v163
v_fma_f32 v168,v128,v152,v168
v_fma_f32 v169,v129,v153,v169
v_fma_f32 v170,v130,v154,v170
v_fma_f32 v171,v131,v155,v171
v_fma_f32 v172,v132,v156,v172
v_fma_f32 v173,v133,v157,v173
v_fma_f32 v174,v134,v158,v174
v_fma_f32 v175,v135,v159,v175
v_cvt_pk_bf16_f32 v176,v168,v169
v_cvt_pk_bf16_f32 v177,v170,v171
v_cvt_pk_bf16_f32 v178,v172,v173
v_cvt_pk_bf16_f32 v179,v174,v175
s_add_u32 s64,s66,201326592
buffer_store_dwordx4 v[176:179],v0,s[20:23],s64 offen sc1
s_add_u32 s64,s74,s75
s_add_u32 s65,s64,4096
s_cmp_eq_u32 s56,1
s_cbranch_scc1 b1_64
buffer_store_dwordx4 v[204:207],v0,s[20:23],s64 offen offset:0
buffer_store_dwordx4 v[204:207],v0,s[20:23],s64 offen offset:1024
buffer_store_dwordx4 v[204:207],v0,s[20:23],s64 offen offset:2048
buffer_store_dwordx4 v[204:207],v0,s[20:23],s64 offen offset:3072
buffer_store_dwordx4 v[204:207],v0,s[20:23],s65 offen offset:0
buffer_store_dwordx4 v[204:207],v0,s[20:23],s65 offen offset:1024
b2_65:
s_add_u32 s66,s66,32768
s_add_u32 s75,s75,6144
s_cmp_eq_u32 s75,24576
s_cselect_b32 s75,0,s75
s_add_u32 s76,s76,1
s_mov_b32 s77,0
s_waitcnt vmcnt(6)
v_mov_b32 v17,s76
s_mov_b64 exec,1
buffer_store_dword v17,off,s[20:23],s69 sc1
s_mov_b64 exec,-1
s_cmp_ge_u32 s60,128
s_cbranch_scc1 done_30
plp_66:
buffer_load_dword v16,v2,s[20:23],s68 offen sc1
s_waitcnt vmcnt(0)
v_cmp_gt_u32 vcc,s71,v16
s_cbranch_vccz pok_67
s_sleep 4
s_sub_u32 s90,s90,1
s_cmp_gt_i32 s90,0
s_cbranch_scc1 plp_66
pok_67:
s_branch lag_52
vN_38:
buffer_load_dword v16,v2,s[20:23],s68 offen sc1
s_waitcnt lgkmcnt(5)
v_mfma_f32_16x16x32_bf16 v[32:35],a[176:179],v[88:91],v[32:35]
ds_read_b128 v[112:115],v7 offset:4096
v_mfma_f32_16x16x32_bf16 v[36:39],a[180:183],v[88:91],v[36:39]
s_waitcnt lgkmcnt(5)
v_mfma_f32_16x16x32_bf16 v[32:35],a[184:187],v[92:95],v[32:35]
ds_read_b128 v[116:119],v7 offset:5120
v_mfma_f32_16x16x32_bf16 v[36:39],a[188:191],v[92:95],v[36:39]
s_waitcnt lgkmcnt(5)
v_mfma_f32_16x16x32_bf16 v[32:35],a[192:195],v[96:99],v[32:35]
ds_read_b128 v[120:123],v7 offset:6144
v_mfma_f32_16x16x32_bf16 v[36:39],a[196:199],v[96:99],v[36:39]
s_waitcnt lgkmcnt(5)
v_mfma_f32_16x16x32_bf16 v[32:35],a[200:203],v[100:103],v[32:35]
ds_read_b128 v[124:127],v7 offset:7168
v_mfma_f32_16x16x32_bf16 v[36:39],a[204:207],v[100:103],v[36:39]
s_waitcnt lgkmcnt(5)
v_mfma_f32_16x16x32_bf16 v[32:35],a[208:211],v[104:107],v[32:35]
v_mfma_f32_16x16x32_bf16 v[36:39],a[212:215],v[104:107],v[36:39]
s_waitcnt lgkmcnt(4)
v_mfma_f32_16x16x32_bf16 v[32:35],a[216:219],v[108:111],v[32:35]
v_mfma_f32_16x16x32_bf16 v[36:39],a[220:223],v[108:111],v[36:39]
s_waitcnt lgkmcnt(3)
v_mfma_f32_16x16x32_bf16 v[32:35],a[224:227],v[112:115],v[32:35]
v_mfma_f32_16x16x32_bf16 v[36:39],a[228:231],v[112:115],v[36:39]
s_waitcnt lgkmcnt(2)
v_mfma_f32_16x16x32_bf16 v[32:35],a[232:235],v[116:119],v[32:35]
v_mfma_f32_16x16x32_bf16 v[36:39],a[236:239],v[116:119],v[36:39]
s_waitcnt lgkmcnt(1)
v_mfma_f32_16x16x32_bf16 v[32:35],a[240:243],v[120:123],v[32:35]
v_mfma_f32_16x16x32_bf16 v[36:39],a[244:247],v[120:123],v[36:39]
s_waitcnt lgkmcnt(0)
v_mfma_f32_16x16x32_bf16 v[32:35],a[248:251],v[124:127],v[32:35]
v_mfma_f32_16x16x32_bf16 v[36:39],a[252:255],v[124:127],v[36:39]
s_mov_b32 s72,0
s_branch join_39
b1_44:
s_nop 7
buffer_store_dwordx4 v[32:35],v0,s[20:23],s64 offen offset:0 sc1
buffer_store_dwordx4 v[36:39],v0,s[20:23],s64 offen offset:1024 sc1
s_branch b2_45
rt_57:
s_sub_u32 s90,s90,1
s_cmp_gt_i32 s90,0
s_cbranch_scc0 go_58
s_add_u32 s64,s74,s75
s_add_u32 s65,s64,4096
buffer_load_dwordx4 v[128:131],v0,s[20:23],s64 offen offset:0 sc1
buffer_load_dwordx4 v[132:135],v0,s[20:23],s64 offen offset:1024 sc1
buffer_load_dwordx4 v[136:139],v0,s[20:23],s64 offen offset:2048 sc1
buffer_load_dwordx4 v[140:143],v0,s[20:23],s64 offen offset:3072 sc1
buffer_load_dwordx4 v[144:147],v0,s[20:23],s65 offen offset:0 sc1
buffer_load_dwordx4 v[148:151],v0,s[20:23],s65 offen offset:1024 sc1
s_waitcnt vmcnt(0)
s_branch ck_56
b1_59:
s_nop 7
buffer_store_dwordx4 v[204:207],v0,s[20:23],s64 offen offset:0 sc1
buffer_store_dwordx4 v[204:207],v0,s[20:23],s64 offen offset:1024 sc1
buffer_store_dwordx4 v[204:207],v0,s[20:23],s64 offen offset:2048 sc1
buffer_store_dwordx4 v[204:207],v0,s[20:23],s64 offen offset:3072 sc1
buffer_store_dwordx4 v[204:207],v0,s[20:23],s65 offen offset:0 sc1
buffer_store_dwordx4 v[204:207],v0,s[20:23],s65 offen offset:1024 sc1
s_branch b2_60
vN_49:
buffer_load_dword v16,v2,s[20:23],s68 offen sc1
s_waitcnt lgkmcnt(5)
v_mfma_f32_16x16x32_bf16 v[32:35],a[176:179],v[88:91],v[32:35]
ds_read_b128 v[112:115],v7 offset:4096
v_mfma_f32_16x16x32_bf16 v[36:39],a[180:183],v[88:91],v[36:39]
s_waitcnt lgkmcnt(5)
v_mfma_f32_16x16x32_bf16 v[32:35],a[184:187],v[92:95],v[32:35]
ds_read_b128 v[116:119],v7 offset:5120
v_mfma_f32_16x16x32_bf16 v[36:39],a[188:191],v[92:95],v[36:39]
s_waitcnt lgkmcnt(5)
v_mfma_f32_16x16x32_bf16 v[32:35],a[192:195],v[96:99],v[32:35]
ds_read_b128 v[120:123],v7 offset:6144
v_mfma_f32_16x16x32_bf16 v[36:39],a[196:199],v[96:99],v[36:39]
s_waitcnt lgkmcnt(5)
v_mfma_f32_16x16x32_bf16 v[32:35],a[200:203],v[100:103],v[32:35]
ds_read_b128 v[124:127],v7 offset:7168
v_mfma_f32_16x16x32_bf16 v[36:39],a[204:207],v[100:103],v[36:39]
s_waitcnt lgkmcnt(5)
v_mfma_f32_16x16x32_bf16 v[32:35],a[208:211],v[104:107],v[32:35]
v_mfma_f32_16x16x32_bf16 v[36:39],a[212:215],v[104:107],v[36:39]
s_waitcnt lgkmcnt(4)
v_mfma_f32_16x16x32_bf16 v[32:35],a[216:219],v[108:111],v[32:35]
v_mfma_f32_16x16x32_bf16 v[36:39],a[220:223],v[108:111],v[36:39]
s_waitcnt lgkmcnt(3)
v_mfma_f32_16x16x32_bf16 v[32:35],a[224:227],v[112:115],v[32:35]
v_mfma_f32_16x16x32_bf16 v[36:39],a[228:231],v[112:115],v[36:39]
s_waitcnt lgkmcnt(2)
v_mfma_f32_16x16x32_bf16 v[32:35],a[232:235],v[116:119],v[32:35]
v_mfma_f32_16x16x32_bf16 v[36:39],a[236:239],v[116:119],v[36:39]
s_waitcnt lgkmcnt(1)
v_mfma_f32_16x16x32_bf16 v[32:35],a[240:243],v[120:123],v[32:35]
v_mfma_f32_16x16x32_bf16 v[36:39],a[244:247],v[120:123],v[36:39]
s_waitcnt lgkmcnt(0)
v_mfma_f32_16x16x32_bf16 v[32:35],a[248:251],v[124:127],v[32:35]
v_mfma_f32_16x16x32_bf16 v[36:39],a[252:255],v[124:127],v[36:39]
s_mov_b32 s72,0
s_branch join_50
rt_62:
s_sub_u32 s90,s90,1
s_cmp_gt_i32 s90,0
s_cbranch_scc0 go_63
s_add_u32 s64,s74,s75
s_add_u32 s65,s64,4096
buffer_load_dwordx4 v[128:131],v0,s[20:23],s64 offen offset:0 sc1
buffer_load_dwordx4 v[132:135],v0,s[20:23],s64 offen offset:1024 sc1
buffer_load_dwordx4 v[136:139],v0,s[20:23],s64 offen offset:2048 sc1
buffer_load_dwordx4 v[140:143],v0,s[20:23],s64 offen offset:3072 sc1
buffer_load_dwordx4 v[144:147],v0,s[20:23],s65 offen offset:0 sc1
buffer_load_dwordx4 v[148:151],v0,s[20:23],s65 offen offset:1024 sc1
s_waitcnt vmcnt(0)
s_branch ck_61
b1_64:
s_nop 7
buffer_store_dwordx4 v[204:207],v0,s[20:23],s64 offen offset:0 sc1
buffer_store_dwordx4 v[204:207],v0,s[20:23],s64 offen offset:1024 sc1
buffer_store_dwordx4 v[204:207],v0,s[20:23],s64 offen offset:2048 sc1
buffer_store_dwordx4 v[204:207],v0,s[20:23],s64 offen offset:3072 sc1
buffer_store_dwordx4 v[204:207],v0,s[20:23],s65 offen offset:0 sc1
buffer_store_dwordx4 v[204:207],v0,s[20:23],s65 offen offset:1024 sc1
s_branch b2_65
done_30:
s_endpgm
fl_w4:
v_and_b32 v21,15,v1
v_lshrrev_b32 v22,4,v1
v_lshrrev_b32 v23,2,v21
v_and_b32 v24,3,v21
s_lshl_b32 s61,s50,15
v_lshl_add_u32 v25,v22,3,v23
s_load_dwordx2 s[4:5],s[0:1],88
s_load_dwordx2 s[6:7],s[0:1],112
s_lshr_b32 s52,s59,3
s_and_b32 s53,s59,7
s_mul_i32 s54,s52,1835008
s_lshl_b32 s64,s53,8
s_add_u32 s54,s54,s64
s_lshl_b32 s64,s50,6
s_add_u32 s54,s54,s64
s_waitcnt lgkmcnt(0)
s_mov_b32 s28,s4
s_and_b32 s29,s5,0xffff
s_mov_b32 s30,0x700000
s_mov_b32 s31,0x20000
s_mov_b32 s24,s6
s_and_b32 s25,s7,0xffff
s_mov_b32 s26,0x400000
s_mov_b32 s27,0x20000
v_lshrrev_b32 v26,2,v1
v_and_b32 v27,3,v1
v_mul_u32_u24 v16,2048,v26
v_lshl_add_u32 v16,v27,4,v16
v_lshlrev_b32 v17,6,v25
v_lshl_add_u32 v17,v24,4,v17
v_add_u32 v17,s61,v17
s_xor_b32 s62,s50,0
s_mul_i32 s62,s62,458752
s_add_u32 s62,s62,s54
s_add_u32 m0,s61,0
s_nop 0
buffer_load_dwordx4 v16,s[28:31],s62 offen lds
s_add_u32 s62,s62,32768
s_add_u32 m0,m0,1024
s_nop 0
buffer_load_dwordx4 v16,s[28:31],s62 offen lds
s_add_u32 s62,s62,32768
s_add_u32 m0,m0,1024
s_nop 0
buffer_load_dwordx4 v16,s[28:31],s62 offen lds
s_add_u32 s62,s62,32768
s_add_u32 m0,m0,1024
s_nop 0
buffer_load_dwordx4 v16,s[28:31],s62 offen lds
s_add_u32 s62,s62,32768
s_add_u32 m0,m0,1024
s_nop 0
buffer_load_dwordx4 v16,s[28:31],s62 offen lds
s_add_u32 s62,s62,32768
s_add_u32 m0,m0,1024
s_nop 0
buffer_load_dwordx4 v16,s[28:31],s62 offen lds
s_add_u32 s62,s62,32768
s_add_u32 m0,m0,1024
s_nop 0
buffer_load_dwordx4 v16,s[28:31],s62 offen lds
s_add_u32 s62,s62,32768
s_add_u32 m0,m0,1024
s_nop 0
buffer_load_dwordx4 v16,s[28:31],s62 offen lds
s_add_u32 s62,s62,32768
s_add_u32 m0,m0,1024
s_nop 0
buffer_load_dwordx4 v16,s[28:31],s62 offen lds
s_add_u32 s62,s62,32768
s_add_u32 m0,m0,1024
s_nop 0
buffer_load_dwordx4 v16,s[28:31],s62 offen lds
s_add_u32 s62,s62,32768
s_add_u32 m0,m0,1024
s_nop 0
buffer_load_dwordx4 v16,s[28:31],s62 offen lds
s_add_u32 s62,s62,32768
s_add_u32 m0,m0,1024
s_nop 0
buffer_load_dwordx4 v16,s[28:31],s62 offen lds
s_add_u32 s62,s62,32768
s_add_u32 m0,m0,1024
s_nop 0
buffer_load_dwordx4 v16,s[28:31],s62 offen lds
s_add_u32 s62,s62,32768
s_add_u32 m0,m0,1024
s_nop 0
buffer_load_dwordx4 v16,s[28:31],s62 offen lds
s_xor_b32 s62,s50,1
s_mul_i32 s62,s62,458752
s_add_u32 s62,s62,s54
s_add_u32 m0,s61,16384
s_nop 0
buffer_load_dwordx4 v16,s[28:31],s62 offen lds
s_add_u32 s62,s62,32768
s_add_u32 m0,m0,1024
s_nop 0
buffer_load_dwordx4 v16,s[28:31],s62 offen lds
s_add_u32 s62,s62,32768
s_add_u32 m0,m0,1024
s_nop 0
buffer_load_dwordx4 v16,s[28:31],s62 offen lds
s_add_u32 s62,s62,32768
s_add_u32 m0,m0,1024
s_nop 0
buffer_load_dwordx4 v16,s[28:31],s62 offen lds
s_add_u32 s62,s62,32768
s_add_u32 m0,m0,1024
s_nop 0
buffer_load_dwordx4 v16,s[28:31],s62 offen lds
s_add_u32 s62,s62,32768
s_add_u32 m0,m0,1024
s_nop 0
buffer_load_dwordx4 v16,s[28:31],s62 offen lds
s_add_u32 s62,s62,32768
s_add_u32 m0,m0,1024
s_nop 0
buffer_load_dwordx4 v16,s[28:31],s62 offen lds
s_add_u32 s62,s62,32768
s_add_u32 m0,m0,1024
s_nop 0
buffer_load_dwordx4 v16,s[28:31],s62 offen lds
s_add_u32 s62,s62,32768
s_add_u32 m0,m0,1024
s_nop 0
buffer_load_dwordx4 v16,s[28:31],s62 offen lds
s_add_u32 s62,s62,32768
s_add_u32 m0,m0,1024
s_nop 0
buffer_load_dwordx4 v16,s[28:31],s62 offen lds
s_add_u32 s62,s62,32768
s_add_u32 m0,m0,1024
s_nop 0
buffer_load_dwordx4 v16,s[28:31],s62 offen lds
s_add_u32 s62,s62,32768
s_add_u32 m0,m0,1024
s_nop 0
buffer_load_dwordx4 v16,s[28:31],s62 offen lds
s_add_u32 s62,s62,32768
s_add_u32 m0,m0,1024
s_nop 0
buffer_load_dwordx4 v16,s[28:31],s62 offen lds
s_add_u32 s62,s62,32768
s_add_u32 m0,m0,1024
s_nop 0
buffer_load_dwordx4 v16,s[28:31],s62 offen lds
s_waitcnt vmcnt(14)
ds_read_b64_tr_b16 a[0:1],v17 offset:0
ds_read_b64_tr_b16 a[2:3],v17 offset:256
ds_read_b64_tr_b16 a[4:5],v17 offset:8
ds_read_b64_tr_b16 a[6:7],v17 offset:264
ds_read_b64_tr_b16 a[8:9],v17 offset:2048
ds_read_b64_tr_b16 a[10:11],v17 offset:2304
ds_read_b64_tr_b16 a[12:13],v17 offset:2056
ds_read_b64_tr_b16 a[14:15],v17 offset:2312
ds_read_b64_tr_b16 a[16:17],v17 offset:4096
ds_read_b64_tr_b16 a[18:19],v17 offset:4352
ds_read_b64_tr_b16 a[20:21],v17 offset:4104
ds_read_b64_tr_b16 a[22:23],v17 offset:4360
s_waitcnt lgkmcnt(0)
ds_read_b64_tr_b16 a[24:25],v17 offset:6144
ds_read_b64_tr_b16 a[26:27],v17 offset:6400
ds_read_b64_tr_b16 a[28:29],v17 offset:6152
ds_read_b64_tr_b16 a[30:31],v17 offset:6408
ds_read_b64_tr_b16 a[32:33],v17 offset:8192
ds_read_b64_tr_b16 a[34:35],v17 offset:8448
ds_read_b64_tr_b16 a[36:37],v17 offset:8200
ds_read_b64_tr_b16 a[38:39],v17 offset:8456
ds_read_b64_tr_b16 a[40:41],v17 offset:10240
ds_read_b64_tr_b16 a[42:43],v17 offset:10496
ds_read_b64_tr_b16 a[44:45],v17 offset:10248
ds_read_b64_tr_b16 a[46:47],v17 offset:10504
s_waitcnt lgkmcnt(0)
ds_read_b64_tr_b16 a[48:49],v17 offset:12288
ds_read_b64_tr_b16 a[50:51],v17 offset:12544
ds_read_b64_tr_b16 a[52:53],v17 offset:12296
ds_read_b64_tr_b16 a[54:55],v17 offset:12552
s_waitcnt lgkmcnt(0)
s_xor_b32 s62,s50,2
s_mul_i32 s62,s62,458752
s_add_u32 s62,s62,s54
s_add_u32 m0,s61,0
s_nop 0
buffer_load_dwordx4 v16,s[28:31],s62 offen lds
s_add_u32 s62,s62,32768
s_add_u32 m0,m0,1024
s_nop 0
buffer_load_dwordx4 v16,s[28:31],s62 offen lds
s_add_u32 s62,s62,32768
s_add_u32 m0,m0,1024
s_nop 0
buffer_load_dwordx4 v16,s[28:31],s62 offen lds
s_add_u32 s62,s62,32768
s_add_u32 m0,m0,1024
s_nop 0
buffer_load_dwordx4 v16,s[28:31],s62 offen lds
s_add_u32 s62,s62,32768
s_add_u32 m0,m0,1024
s_nop 0
buffer_load_dwordx4 v16,s[28:31],s62 offen lds
s_add_u32 s62,s62,32768
s_add_u32 m0,m0,1024
s_nop 0
buffer_load_dwordx4 v16,s[28:31],s62 offen lds
s_add_u32 s62,s62,32768
s_add_u32 m0,m0,1024
s_nop 0
buffer_load_dwordx4 v16,s[28:31],s62 offen lds
s_add_u32 s62,s62,32768
s_add_u32 m0,m0,1024
s_nop 0
buffer_load_dwordx4 v16,s[28:31],s62 offen lds
s_add_u32 s62,s62,32768
s_add_u32 m0,m0,1024
s_nop 0
buffer_load_dwordx4 v16,s[28:31],s62 offen lds
s_add_u32 s62,s62,32768
s_add_u32 m0,m0,1024
s_nop 0
buffer_load_dwordx4 v16,s[28:31],s62 offen lds
s_add_u32 s62,s62,32768
s_add_u32 m0,m0,1024
s_nop 0
buffer_load_dwordx4 v16,s[28:31],s62 offen lds
s_add_u32 s62,s62,32768
s_add_u32 m0,m0,1024
s_nop 0
buffer_load_dwordx4 v16,s[28:31],s62 offen lds
s_add_u32 s62,s62,32768
s_add_u32 m0,m0,1024
s_nop 0
buffer_load_dwordx4 v16,s[28:31],s62 offen lds
s_add_u32 s62,s62,32768
s_add_u32 m0,m0,1024
s_nop 0
buffer_load_dwordx4 v16,s[28:31],s62 offen lds
s_waitcnt vmcnt(14)
ds_read_b64_tr_b16 a[56:57],v17 offset:16384
ds_read_b64_tr_b16 a[58:59],v17 offset:16640
ds_read_b64_tr_b16 a[60:61],v17 offset:16392
ds_read_b64_tr_b16 a[62:63],v17 offset:16648
ds_read_b64_tr_b16 a[64:65],v17 offset:18432
ds_read_b64_tr_b16 a[66:67],v17 offset:18688
ds_read_b64_tr_b16 a[68:69],v17 offset:18440
ds_read_b64_tr_b16 a[70:71],v17 offset:18696
ds_read_b64_tr_b16 a[72:73],v17 offset:20480
ds_read_b64_tr_b16 a[74:75],v17 offset:20736
ds_read_b64_tr_b16 a[76:77],v17 offset:20488
ds_read_b64_tr_b16 a[78:79],v17 offset:20744
s_waitcnt lgkmcnt(0)
ds_read_b64_tr_b16 a[80:81],v17 offset:22528
ds_read_b64_tr_b16 a[82:83],v17 offset:22784
ds_read_b64_tr_b16 a[84:85],v17 offset:22536
ds_read_b64_tr_b16 a[86:87],v17 offset:22792
ds_read_b64_tr_b16 a[88:89],v17 offset:24576
ds_read_b64_tr_b16 a[90:91],v17 offset:24832
ds_read_b64_tr_b16 a[92:93],v17 offset:24584
ds_read_b64_tr_b16 a[94:95],v17 offset:24840
ds_read_b64_tr_b16 a[96:97],v17 offset:26624
ds_read_b64_tr_b16 a[98:99],v17 offset:26880
ds_read_b64_tr_b16 a[100:101],v17 offset:26632
ds_read_b64_tr_b16 a[102:103],v17 offset:26888
s_waitcnt lgkmcnt(0)
ds_read_b64_tr_b16 a[104:105],v17 offset:28672
ds_read_b64_tr_b16 a[106:107],v17 offset:28928
ds_read_b64_tr_b16 a[108:109],v17 offset:28680
ds_read_b64_tr_b16 a[110:111],v17 offset:28936
s_waitcnt lgkmcnt(0)
s_xor_b32 s62,s50,3
s_mul_i32 s62,s62,458752
s_add_u32 s62,s62,s54
s_add_u32 m0,s61,16384
s_nop 0
buffer_load_dwordx4 v16,s[28:31],s62 offen lds
s_add_u32 s62,s62,32768
s_add_u32 m0,m0,1024
s_nop 0
buffer_load_dwordx4 v16,s[28:31],s62 offen lds
s_add_u32 s62,s62,32768
s_add_u32 m0,m0,1024
s_nop 0
buffer_load_dwordx4 v16,s[28:31],s62 offen lds
s_add_u32 s62,s62,32768
s_add_u32 m0,m0,1024
s_nop 0
buffer_load_dwordx4 v16,s[28:31],s62 offen lds
s_add_u32 s62,s62,32768
s_add_u32 m0,m0,1024
s_nop 0
buffer_load_dwordx4 v16,s[28:31],s62 offen lds
s_add_u32 s62,s62,32768
s_add_u32 m0,m0,1024
s_nop 0
buffer_load_dwordx4 v16,s[28:31],s62 offen lds
s_add_u32 s62,s62,32768
s_add_u32 m0,m0,1024
s_nop 0
buffer_load_dwordx4 v16,s[28:31],s62 offen lds
s_add_u32 s62,s62,32768
s_add_u32 m0,m0,1024
s_nop 0
buffer_load_dwordx4 v16,s[28:31],s62 offen lds
s_add_u32 s62,s62,32768
s_add_u32 m0,m0,1024
s_nop 0
buffer_load_dwordx4 v16,s[28:31],s62 offen lds
s_add_u32 s62,s62,32768
s_add_u32 m0,m0,1024
s_nop 0
buffer_load_dwordx4 v16,s[28:31],s62 offen lds
s_add_u32 s62,s62,32768
s_add_u32 m0,m0,1024
s_nop 0
buffer_load_dwordx4 v16,s[28:31],s62 offen lds
s_add_u32 s62,s62,32768
s_add_u32 m0,m0,1024
s_nop 0
buffer_load_dwordx4 v16,s[28:31],s62 offen lds
s_add_u32 s62,s62,32768
s_add_u32 m0,m0,1024
s_nop 0
buffer_load_dwordx4 v16,s[28:31],s62 offen lds
s_add_u32 s62,s62,32768
s_add_u32 m0,m0,1024
s_nop 0
buffer_load_dwordx4 v16,s[28:31],s62 offen lds
s_waitcnt vmcnt(14)
ds_read_b64_tr_b16 a[112:113],v17 offset:0
ds_read_b64_tr_b16 a[114:115],v17 offset:256
ds_read_b64_tr_b16 a[116:117],v17 offset:8
ds_read_b64_tr_b16 a[118:119],v17 offset:264
ds_read_b64_tr_b16 a[120:121],v17 offset:2048
ds_read_b64_tr_b16 a[122:123],v17 offset:2304
ds_read_b64_tr_b16 a[124:125],v17 offset:2056
ds_read_b64_tr_b16 a[126:127],v17 offset:2312
ds_read_b64_tr_b16 a[128:129],v17 offset:4096
ds_read_b64_tr_b16 a[130:131],v17 offset:4352
ds_read_b64_tr_b16 a[132:133],v17 offset:4104
ds_read_b64_tr_b16 a[134:135],v17 offset:4360
s_waitcnt lgkmcnt(0)
ds_read_b64_tr_b16 a[136:137],v17 offset:6144
ds_read_b64_tr_b16 a[138:139],v17 offset:6400
ds_read_b64_tr_b16 a[140:141],v17 offset:6152
ds_read_b64_tr_b16 a[142:143],v17 offset:6408
ds_read_b64_tr_b16 a[144:145],v17 offset:8192
ds_read_b64_tr_b16 a[146:147],v17 offset:8448
ds_read_b64_tr_b16 a[148:149],v17 offset:8200
ds_read_b64_tr_b16 a[150:151],v17 offset:8456
ds_read_b64_tr_b16 a[152:153],v17 offset:10240
ds_read_b64_tr_b16 a[154:155],v17 offset:10496
ds_read_b64_tr_b16 a[156:157],v17 offset:10248
ds_read_b64_tr_b16 a[158:159],v17 offset:10504
s_waitcnt lgkmcnt(0)
ds_read_b64_tr_b16 a[160:161],v17 offset:12288
ds_read_b64_tr_b16 a[162:163],v17 offset:12544
ds_read_b64_tr_b16 a[164:165],v17 offset:12296
ds_read_b64_tr_b16 a[166:167],v17 offset:12552
s_waitcnt lgkmcnt(0)
s_waitcnt vmcnt(0)
ds_read_b64_tr_b16 a[168:169],v17 offset:16384
ds_read_b64_tr_b16 a[170:171],v17 offset:16640
ds_read_b64_tr_b16 a[172:173],v17 offset:16392
ds_read_b64_tr_b16 a[174:175],v17 offset:16648
ds_read_b64_tr_b16 a[176:177],v17 offset:18432
ds_read_b64_tr_b16 a[178:179],v17 offset:18688
ds_read_b64_tr_b16 a[180:181],v17 offset:18440
ds_read_b64_tr_b16 a[182:183],v17 offset:18696
ds_read_b64_tr_b16 a[184:185],v17 offset:20480
ds_read_b64_tr_b16 a[186:187],v17 offset:20736
ds_read_b64_tr_b16 a[188:189],v17 offset:20488
ds_read_b64_tr_b16 a[190:191],v17 offset:20744
s_waitcnt lgkmcnt(0)
ds_read_b64_tr_b16 a[192:193],v17 offset:22528
ds_read_b64_tr_b16 a[194:195],v17 offset:22784
ds_read_b64_tr_b16 a[196:197],v17 offset:22536
ds_read_b64_tr_b16 a[198:199],v17 offset:22792
ds_read_b64_tr_b16 a[200:201],v17 offset:24576
ds_read_b64_tr_b16 a[202:203],v17 offset:24832
ds_read_b64_tr_b16 a[204:205],v17 offset:24584
ds_read_b64_tr_b16 a[206:207],v17 offset:24840
ds_read_b64_tr_b16 a[208:209],v17 offset:26624
ds_read_b64_tr_b16 a[210:211],v17 offset:26880
ds_read_b64_tr_b16 a[212:213],v17 offset:26632
ds_read_b64_tr_b16 a[214:215],v17 offset:26888
s_waitcnt lgkmcnt(0)
ds_read_b64_tr_b16 a[216:217],v17 offset:28672
ds_read_b64_tr_b16 a[218:219],v17 offset:28928
ds_read_b64_tr_b16 a[220:221],v17 offset:28680
ds_read_b64_tr_b16 a[222:223],v17 offset:28936
s_waitcnt lgkmcnt(0)
s_mov_b32 s67,0
s_cmp_eq_u32 s56,1
s_cbranch_scc1 vok_69
v_mbcnt_lo_u32_b32 v16,-1,0
v_and_b32 v16,7,v16
v_lshlrev_b32 v16,7,v16
s_mov_b32 s64,138510336
vpoll_70:
buffer_load_dword v17,v16,s[20:23],s64 offen sc1
s_waitcnt vmcnt(0)
v_readlane_b32 s92,v17,0
v_readlane_b32 s93,v17,1
v_readlane_b32 s94,v17,2
v_readlane_b32 s95,v17,3
v_readlane_b32 s96,v17,4
v_readlane_b32 s97,v17,5
v_readlane_b32 s98,v17,6
v_readlane_b32 s99,v17,7
s_add_u32 s65,s92,s93
s_add_u32 s65,s65,s94
s_add_u32 s65,s65,s95
s_add_u32 s65,s65,s96
s_add_u32 s65,s65,s97
s_add_u32 s65,s65,s98
s_add_u32 s65,s65,s99
s_cmp_ge_u32 s65,256
s_cbranch_scc1 vgot_71
s_sleep 4
s_sub_u32 s90,s90,1
s_cmp_gt_i32 s90,0
s_cbranch_scc1 vpoll_70
vgot_71:
s_min_u32 s65,s92,s93
s_min_u32 s65,s65,s94
s_min_u32 s65,s65,s95
s_min_u32 s65,s65,s96
s_min_u32 s65,s65,s97
s_min_u32 s65,s65,s98
s_min_u32 s65,s65,s99
s_cmp_lt_u32 s65,32
s_cbranch_scc1 fl_slow
s_mov_b32 s56,0
vok_69:
s_barrier
v_lshlrev_b32 v0,4,v1
s_mov_b32 s60,0
s_mov_b32 s70,0
s_mov_b32 s55,0
s_lshl_b32 s63,s50,13
v_mov_b32 v3,v0
s_mov_b32 s73,0xffff0000
s_lshl_b32 s64,s52,2
s_add_u32 s64,s64,s50
s_mul_i32 s61,s64,7168
s_add_u32 s61,s61,219152384
s_lshl_b32 s82,s64,8
s_add_u32 s82,s82,138551296
s_mov_b32 s68,s82
s_lshl_b32 s83,s53,2
s_add_u32 s83,s83,s50
s_xor_b32 s64,s50,0
s_lshl_b32 s64,s64,13
v_add_u32 v8,s64,v0
s_xor_b32 s64,s50,1
s_lshl_b32 s64,s64,13
v_add_u32 v9,s64,v0
s_xor_b32 s64,s50,2
s_lshl_b32 s64,s64,13
v_add_u32 v10,s64,v0
s_xor_b32 s64,s50,3
s_lshl_b32 s64,s64,13
v_add_u32 v11,s64,v0
v_min_u32 v2,6,v1
v_lshlrev_b32 v2,2,v2
s_lshl_b32 s66,s83,10
s_lshr_b32 s65,s83,3
s_lshl_b32 s65,s65,8
s_and_b32 s64,s83,7
s_lshl_b32 s64,s64,2
s_add_u32 s69,s64,s65
s_add_u32 s69,s69,138555392
s_lshl_b32 s64,s53,2
s_add_u32 s64,s64,s50
s_mul_i32 s74,s64,24576
s_xor_b32 s64,s50,s52
s_sub_u32 s64,s64,1
s_max_i32 s64,s64,0
s_lshl_b32 s64,s64,11
s_add_u32 s74,s74,s64
s_add_u32 s74,s74,168820736
s_mov_b32 s75,0
s_mov_b32 s76,0
s_mov_b32 s77,0
v_lshlrev_b32 v26,11,v21
v_lshl_add_u32 v26,v22,4,v26
s_lshl_b32 s64,s83,6
v_add_u32 v18,s64,v26
v_lshlrev_b32 v26,5,v22
s_lshl_b32 s64,s83,7
s_add_u32 s64,s64,267407360
buffer_load_dwordx4 v[152:155],v26,s[20:23],s64 offen
buffer_load_dwordx4 v[156:159],v26,s[20:23],s64 offen offset:16
v_mov_b32 v204,-1
v_mov_b32 v205,-1
v_mov_b32 v206,-1
v_mov_b32 v207,-1
s_cmp_eq_u32 s50,s52
s_cbranch_scc1 lfin_74
s_add_u32 s71,s60,1
plp_80:
buffer_load_dword v16,v2,s[20:23],s68 offen sc1
s_waitcnt vmcnt(0)
v_cmp_gt_u32 vcc,s71,v16
s_cbranch_vccz pok_81
s_sleep 4
s_sub_u32 s90,s90,1
s_cmp_gt_i32 s90,0
s_cbranch_scc1 plp_80
pok_81:
lag_79:
s_add_u32 m0,s70,s63
s_add_u32 s62,s61,4096
buffer_load_dwordx4 v3,s[20:23],s61 offen offset:0 lds
buffer_load_dwordx4 v3,s[20:23],s61 offen offset:1024 lds
buffer_load_dwordx4 v3,s[20:23],s61 offen offset:2048 lds
buffer_load_dwordx4 v3,s[20:23],s61 offen offset:3072 lds
s_add_u32 m0,m0,4096
s_nop 0
buffer_load_dwordx4 v3,s[20:23],s62 offen offset:0 lds
buffer_load_dwordx4 v3,s[20:23],s62 offen offset:1024 lds
buffer_load_dwordx4 v3,s[20:23],s62 offen offset:2048 lds
s_add_u32 s61,s61,114688
s_add_u32 s70,s70,32768
s_and_b32 s70,s70,0x1ffff
buffer_load_dword v17,off,s[20:23],s69
buffer_load_dword v17,off,s[20:23],s69
top_75:
s_add_u32 s71,s60,2
buffer_load_dword v16,v2,s[20:23],s68 offen sc1
v_add_u32 v4,s55,v8
v_add_u32 v5,s55,v9
v_add_u32 v6,s55,v10
v_add_u32 v7,s55,v11
s_add_u32 s55,s55,32768
s_and_b32 s55,s55,0x1ffff
s_waitcnt vmcnt(9)
ds_read_b128 v[64:67],v4 offset:0
s_waitcnt vmcnt(8)
ds_read_b128 v[68:71],v4 offset:1024
s_waitcnt vmcnt(7)
ds_read_b128 v[72:75],v4 offset:2048
s_waitcnt lgkmcnt(2)
v_mfma_f32_16x16x32_bf16 v[32:35],a[0:3],v[64:67],0
v_mfma_f32_16x16x32_bf16 v[36:39],a[4:7],v[64:67],0
s_waitcnt vmcnt(6)
ds_read_b128 v[76:79],v4 offset:3072
s_waitcnt lgkmcnt(2)
v_mfma_f32_16x16x32_bf16 v[32:35],a[8:11],v[68:71],v[32:35]
v_mfma_f32_16x16x32_bf16 v[36:39],a[12:15],v[68:71],v[36:39]
s_waitcnt vmcnt(5)
ds_read_b128 v[80:83],v4 offset:4096
s_waitcnt lgkmcnt(2)
v_mfma_f32_16x16x32_bf16 v[32:35],a[16:19],v[72:75],v[32:35]
v_mfma_f32_16x16x32_bf16 v[36:39],a[20:23],v[72:75],v[36:39]
s_waitcnt vmcnt(4)
ds_read_b128 v[84:87],v4 offset:5120
s_waitcnt lgkmcnt(2)
v_mfma_f32_16x16x32_bf16 v[32:35],a[24:27],v[76:79],v[32:35]
v_mfma_f32_16x16x32_bf16 v[36:39],a[28:31],v[76:79],v[36:39]
s_waitcnt vmcnt(3)
ds_read_b128 v[88:91],v4 offset:6144
s_barrier
s_waitcnt lgkmcnt(2)
v_mfma_f32_16x16x32_bf16 v[32:35],a[32:35],v[80:83],v[32:35]
v_mfma_f32_16x16x32_bf16 v[36:39],a[36:39],v[80:83],v[36:39]
ds_read_b128 v[92:95],v5 offset:0
s_waitcnt lgkmcnt(2)
v_mfma_f32_16x16x32_bf16 v[32:35],a[40:43],v[84:87],v[32:35]
ds_read_b128 v[96:99],v5 offset:1024
ds_read_b128 v[100:103],v5 offset:2048
v_mfma_f32_16x16x32_bf16 v[36:39],a[44:47],v[84:87],v[36:39]
s_waitcnt lgkmcnt(3)
v_mfma_f32_16x16x32_bf16 v[32:35],a[48:51],v[88:91],v[32:35]
ds_read_b128 v[104:107],v5 offset:3072
ds_read_b128 v[108:111],v5 offset:4096
v_mfma_f32_16x16x32_bf16 v[36:39],a[52:55],v[88:91],v[36:39]
s_waitcnt lgkmcnt(4)
v_mfma_f32_16x16x32_bf16 v[32:35],a[56:59],v[92:95],v[32:35]
ds_read_b128 v[112:115],v5 offset:5120
ds_read_b128 v[116:119],v5 offset:6144
v_mfma_f32_16x16x32_bf16 v[36:39],a[60:63],v[92:95],v[36:39]
s_waitcnt lgkmcnt(5)
v_mfma_f32_16x16x32_bf16 v[32:35],a[64:67],v[96:99],v[32:35]
ds_read_b128 v[120:123],v6 offset:0
v_mfma_f32_16x16x32_bf16 v[36:39],a[68:71],v[96:99],v[36:39]
s_waitcnt lgkmcnt(5)
v_mfma_f32_16x16x32_bf16 v[32:35],a[72:75],v[100:103],v[32:35]
ds_read_b128 v[124:127],v6 offset:1024
v_mfma_f32_16x16x32_bf16 v[36:39],a[76:79],v[100:103],v[36:39]
s_waitcnt lgkmcnt(5)
v_mfma_f32_16x16x32_bf16 v[32:35],a[80:83],v[104:107],v[32:35]
ds_read_b128 v[64:67],v6 offset:2048
v_mfma_f32_16x16x32_bf16 v[36:39],a[84:87],v[104:107],v[36:39]
s_waitcnt lgkmcnt(5)
v_mfma_f32_16x16x32_bf16 v[32:35],a[88:91],v[108:111],v[32:35]
ds_read_b128 v[68:71],v6 offset:3072
v_mfma_f32_16x16x32_bf16 v[36:39],a[92:95],v[108:111],v[36:39]
s_waitcnt lgkmcnt(5)
v_mfma_f32_16x16x32_bf16 v[32:35],a[96:99],v[112:115],v[32:35]
ds_read_b128 v[72:75],v6 offset:4096
v_mfma_f32_16x16x32_bf16 v[36:39],a[100:103],v[112:115],v[36:39]
s_waitcnt lgkmcnt(5)
v_mfma_f32_16x16x32_bf16 v[32:35],a[104:107],v[116:119],v[32:35]
ds_read_b128 v[76:79],v6 offset:5120
v_mfma_f32_16x16x32_bf16 v[36:39],a[108:111],v[116:119],v[36:39]
s_waitcnt lgkmcnt(5)
v_mfma_f32_16x16x32_bf16 v[32:35],a[112:115],v[120:123],v[32:35]
ds_read_b128 v[80:83],v6 offset:6144
v_mfma_f32_16x16x32_bf16 v[36:39],a[116:119],v[120:123],v[36:39]
s_waitcnt lgkmcnt(5)
v_mfma_f32_16x16x32_bf16 v[32:35],a[120:123],v[124:127],v[32:35]
ds_read_b128 v[84:87],v7 offset:0
v_mfma_f32_16x16x32_bf16 v[36:39],a[124:127],v[124:127],v[36:39]
s_waitcnt lgkmcnt(5)
v_mfma_f32_16x16x32_bf16 v[32:35],a[128:131],v[64:67],v[32:35]
ds_read_b128 v[88:91],v7 offset:1024
v_mfma_f32_16x16x32_bf16 v[36:39],a[132:135],v[64:67],v[36:39]
s_waitcnt lgkmcnt(5)
v_mfma_f32_16x16x32_bf16 v[32:35],a[136:139],v[68:71],v[32:35]
ds_read_b128 v[92:95],v7 offset:2048
v_mfma_f32_16x16x32_bf16 v[36:39],a[140:143],v[68:71],v[36:39]
s_waitcnt lgkmcnt(5)
v_mfma_f32_16x16x32_bf16 v[32:35],a[144:147],v[72:75],v[32:35]
ds_read_b128 v[96:99],v7 offset:3072
v_mfma_f32_16x16x32_bf16 v[36:39],a[148:151],v[72:75],v[36:39]
s_waitcnt vmcnt(0)
v_cmp_gt_u32 vcc,s71,v16
s_cbranch_vccnz vN_76
s_waitcnt lgkmcnt(5)
v_mfma_f32_16x16x32_bf16 v[32:35],a[152:155],v[76:79],v[32:35]
ds_read_b128 v[100:103],v7 offset:4096
s_add_u32 m0,s70,s63
v_mfma_f32_16x16x32_bf16 v[36:39],a[156:159],v[76:79],v[36:39]
s_add_u32 s62,s61,4096
s_waitcnt lgkmcnt(5)
v_mfma_f32_16x16x32_bf16 v[32:35],a[160:163],v[80:83],v[32:35]
ds_read_b128 v[104:107],v7 offset:5120
buffer_load_dwordx4 v3,s[20:23],s61 offen offset:0 lds
v_mfma_f32_16x16x32_bf16 v[36:39],a[164:167],v[80:83],v[36:39]
buffer_load_dwordx4 v3,s[20:23],s61 offen offset:1024 lds
s_waitcnt lgkmcnt(5)
v_mfma_f32_16x16x32_bf16 v[32:35],a[168:171],v[84:87],v[32:35]
ds_read_b128 v[108:111],v7 offset:6144
buffer_load_dwordx4 v3,s[20:23],s61 offen offset:2048 lds
v_mfma_f32_16x16x32_bf16 v[36:39],a[172:175],v[84:87],v[36:39]
buffer_load_dwordx4 v3,s[20:23],s61 offen offset:3072 lds
s_waitcnt lgkmcnt(5)
v_mfma_f32_16x16x32_bf16 v[32:35],a[176:179],v[88:91],v[32:35]
s_add_u32 m0,m0,4096
v_mfma_f32_16x16x32_bf16 v[36:39],a[180:183],v[88:91],v[36:39]
buffer_load_dwordx4 v3,s[20:23],s62 offen offset:0 lds
s_waitcnt lgkmcnt(4)
v_mfma_f32_16x16x32_bf16 v[32:35],a[184:187],v[92:95],v[32:35]
buffer_load_dwordx4 v3,s[20:23],s62 offen offset:1024 lds
v_mfma_f32_16x16x32_bf16 v[36:39],a[188:191],v[92:95],v[36:39]
buffer_load_dwordx4 v3,s[20:23],s62 offen offset:2048 lds
s_waitcnt lgkmcnt(3)
v_mfma_f32_16x16x32_bf16 v[32:35],a[192:195],v[96:99],v[32:35]
s_add_u32 s61,s61,114688
v_mfma_f32_16x16x32_bf16 v[36:39],a[196:199],v[96:99],v[36:39]
s_add_u32 s70,s70,32768
s_waitcnt lgkmcnt(2)
v_mfma_f32_16x16x32_bf16 v[32:35],a[200:203],v[100:103],v[32:35]
s_and_b32 s70,s70,0x1ffff
v_mfma_f32_16x16x32_bf16 v[36:39],a[204:207],v[100:103],v[36:39]
s_waitcnt lgkmcnt(1)
v_mfma_f32_16x16x32_bf16 v[32:35],a[208:211],v[104:107],v[32:35]
v_mfma_f32_16x16x32_bf16 v[36:39],a[212:215],v[104:107],v[36:39]
s_waitcnt lgkmcnt(0)
v_mfma_f32_16x16x32_bf16 v[32:35],a[216:219],v[108:111],v[32:35]
v_mfma_f32_16x16x32_bf16 v[36:39],a[220:223],v[108:111],v[36:39]
s_mov_b32 s72,1
join_77:
s_add_u32 s64,s74,s75
s_cmp_eq_u32 s56,1
s_cbranch_scc1 b1_82
s_nop 2
buffer_store_dwordx4 v[32:35],v0,s[20:23],s64 offen offset:0
buffer_store_dwordx4 v[36:39],v0,s[20:23],s64 offen offset:1024
b2_83:
s_add_u32 s75,s75,6144
s_cmp_eq_u32 s75,24576
s_cselect_b32 s75,0,s75
s_add_u32 s60,s60,1
s_cmp_eq_u32 s72,0
s_cbranch_scc1 slowp_78
s_branch top_75
slowp_78:
s_waitcnt vmcnt(2)
v_cmp_gt_u32 vcc,s71,v16
s_cbranch_vccz lag_79
s_cmp_ge_u32 s60,128
s_cbranch_scc1 done_68
plp_84:
buffer_load_dword v16,v2,s[20:23],s68 offen sc1
s_waitcnt vmcnt(0)
v_cmp_gt_u32 vcc,s71,v16
s_cbranch_vccz pok_85
s_sleep 4
s_sub_u32 s90,s90,1
s_cmp_gt_i32 s90,0
s_cbranch_scc1 plp_84
pok_85:
s_branch lag_79
lfin_74:
s_add_u32 s71,s60,1
plp_91:
buffer_load_dword v16,v2,s[20:23],s68 offen sc1
s_waitcnt vmcnt(0)
v_cmp_gt_u32 vcc,s71,v16
s_cbranch_vccz pok_92
s_sleep 4
s_sub_u32 s90,s90,1
s_cmp_gt_i32 s90,0
s_cbranch_scc1 plp_91
pok_92:
lag_90:
s_add_u32 m0,s70,s63
s_add_u32 s62,s61,4096
buffer_load_dwordx4 v3,s[20:23],s61 offen offset:0 lds
buffer_load_dwordx4 v3,s[20:23],s61 offen offset:1024 lds
buffer_load_dwordx4 v3,s[20:23],s61 offen offset:2048 lds
buffer_load_dwordx4 v3,s[20:23],s61 offen offset:3072 lds
s_add_u32 m0,m0,4096
s_nop 0
buffer_load_dwordx4 v3,s[20:23],s62 offen offset:0 lds
buffer_load_dwordx4 v3,s[20:23],s62 offen offset:1024 lds
buffer_load_dwordx4 v3,s[20:23],s62 offen offset:2048 lds
s_add_u32 s61,s61,114688
s_add_u32 s70,s70,32768
s_and_b32 s70,s70,0x1ffff
top_86:
s_add_u32 s71,s60,2
buffer_load_dword v16,v2,s[20:23],s68 offen sc1
s_add_u32 s64,s74,s75
s_add_u32 s65,s64,4096
buffer_load_dwordx4 v[128:131],v0,s[20:23],s64 offen offset:0 sc1
buffer_load_dwordx4 v[132:135],v0,s[20:23],s64 offen offset:1024 sc1
buffer_load_dwordx4 v[136:139],v0,s[20:23],s64 offen offset:2048 sc1
buffer_load_dwordx4 v[140:143],v0,s[20:23],s64 offen offset:3072 sc1
buffer_load_dwordx4 v[144:147],v0,s[20:23],s65 offen offset:0 sc1
buffer_load_dwordx4 v[148:151],v0,s[20:23],s65 offen offset:1024 sc1
s_add_u32 s64,s66,201326592
buffer_load_dwordx4 v[160:163],v0,s[20:23],s64 offen
s_add_u32 s64,s66,214958080
buffer_load_dwordx4 v[164:167],v0,s[20:23],s64 offen
v_add_u32 v4,s55,v8
v_add_u32 v5,s55,v9
v_add_u32 v6,s55,v10
v_add_u32 v7,s55,v11
s_add_u32 s55,s55,32768
s_and_b32 s55,s55,0x1ffff
s_waitcnt vmcnt(15)
ds_read_b128 v[64:67],v4 offset:0
s_waitcnt vmcnt(14)
ds_read_b128 v[68:71],v4 offset:1024
s_waitcnt vmcnt(13)
ds_read_b128 v[72:75],v4 offset:2048
s_waitcnt lgkmcnt(2)
v_mfma_f32_16x16x32_bf16 v[32:35],a[0:3],v[64:67],0
v_mfma_f32_16x16x32_bf16 v[36:39],a[4:7],v[64:67],0
s_waitcnt vmcnt(12)
ds_read_b128 v[76:79],v4 offset:3072
s_waitcnt lgkmcnt(2)
v_mfma_f32_16x16x32_bf16 v[32:35],a[8:11],v[68:71],v[32:35]
v_mfma_f32_16x16x32_bf16 v[36:39],a[12:15],v[68:71],v[36:39]
s_waitcnt vmcnt(11)
ds_read_b128 v[80:83],v4 offset:4096
s_waitcnt lgkmcnt(2)
v_mfma_f32_16x16x32_bf16 v[32:35],a[16:19],v[72:75],v[32:35]
v_mfma_f32_16x16x32_bf16 v[36:39],a[20:23],v[72:75],v[36:39]
s_waitcnt vmcnt(10)
ds_read_b128 v[84:87],v4 offset:5120
s_waitcnt lgkmcnt(2)
v_mfma_f32_16x16x32_bf16 v[32:35],a[24:27],v[76:79],v[32:35]
v_mfma_f32_16x16x32_bf16 v[36:39],a[28:31],v[76:79],v[36:39]
s_waitcnt vmcnt(9)
ds_read_b128 v[88:91],v4 offset:6144
s_barrier
s_waitcnt lgkmcnt(2)
v_mfma_f32_16x16x32_bf16 v[32:35],a[32:35],v[80:83],v[32:35]
v_mfma_f32_16x16x32_bf16 v[36:39],a[36:39],v[80:83],v[36:39]
ds_read_b128 v[92:95],v5 offset:0
s_waitcnt lgkmcnt(2)
v_mfma_f32_16x16x32_bf16 v[32:35],a[40:43],v[84:87],v[32:35]
ds_read_b128 v[96:99],v5 offset:1024
ds_read_b128 v[100:103],v5 offset:2048
v_mfma_f32_16x16x32_bf16 v[36:39],a[44:47],v[84:87],v[36:39]
s_waitcnt lgkmcnt(3)
v_mfma_f32_16x16x32_bf16 v[32:35],a[48:51],v[88:91],v[32:35]
ds_read_b128 v[104:107],v5 offset:3072
ds_read_b128 v[108:111],v5 offset:4096
v_mfma_f32_16x16x32_bf16 v[36:39],a[52:55],v[88:91],v[36:39]
s_waitcnt lgkmcnt(4)
v_mfma_f32_16x16x32_bf16 v[32:35],a[56:59],v[92:95],v[32:35]
ds_read_b128 v[112:115],v5 offset:5120
ds_read_b128 v[116:119],v5 offset:6144
v_mfma_f32_16x16x32_bf16 v[36:39],a[60:63],v[92:95],v[36:39]
s_waitcnt lgkmcnt(5)
v_mfma_f32_16x16x32_bf16 v[32:35],a[64:67],v[96:99],v[32:35]
ds_read_b128 v[120:123],v6 offset:0
v_mfma_f32_16x16x32_bf16 v[36:39],a[68:71],v[96:99],v[36:39]
s_waitcnt lgkmcnt(5)
v_mfma_f32_16x16x32_bf16 v[32:35],a[72:75],v[100:103],v[32:35]
ds_read_b128 v[124:127],v6 offset:1024
v_mfma_f32_16x16x32_bf16 v[36:39],a[76:79],v[100:103],v[36:39]
s_waitcnt lgkmcnt(5)
v_mfma_f32_16x16x32_bf16 v[32:35],a[80:83],v[104:107],v[32:35]
ds_read_b128 v[64:67],v6 offset:2048
v_mfma_f32_16x16x32_bf16 v[36:39],a[84:87],v[104:107],v[36:39]
s_waitcnt lgkmcnt(5)
v_mfma_f32_16x16x32_bf16 v[32:35],a[88:91],v[108:111],v[32:35]
ds_read_b128 v[68:71],v6 offset:3072
v_mfma_f32_16x16x32_bf16 v[36:39],a[92:95],v[108:111],v[36:39]
s_waitcnt lgkmcnt(5)
v_mfma_f32_16x16x32_bf16 v[32:35],a[96:99],v[112:115],v[32:35]
ds_read_b128 v[72:75],v6 offset:4096
v_mfma_f32_16x16x32_bf16 v[36:39],a[100:103],v[112:115],v[36:39]
s_waitcnt lgkmcnt(5)
v_mfma_f32_16x16x32_bf16 v[32:35],a[104:107],v[116:119],v[32:35]
ds_read_b128 v[76:79],v6 offset:5120
v_mfma_f32_16x16x32_bf16 v[36:39],a[108:111],v[116:119],v[36:39]
s_waitcnt lgkmcnt(5)
v_mfma_f32_16x16x32_bf16 v[32:35],a[112:115],v[120:123],v[32:35]
ds_read_b128 v[80:83],v6 offset:6144
v_mfma_f32_16x16x32_bf16 v[36:39],a[116:119],v[120:123],v[36:39]
s_waitcnt lgkmcnt(5)
v_mfma_f32_16x16x32_bf16 v[32:35],a[120:123],v[124:127],v[32:35]
ds_read_b128 v[84:87],v7 offset:0
v_mfma_f32_16x16x32_bf16 v[36:39],a[124:127],v[124:127],v[36:39]
s_waitcnt lgkmcnt(5)
v_mfma_f32_16x16x32_bf16 v[32:35],a[128:131],v[64:67],v[32:35]
ds_read_b128 v[88:91],v7 offset:1024
v_mfma_f32_16x16x32_bf16 v[36:39],a[132:135],v[64:67],v[36:39]
s_waitcnt lgkmcnt(5)
v_mfma_f32_16x16x32_bf16 v[32:35],a[136:139],v[68:71],v[32:35]
ds_read_b128 v[92:95],v7 offset:2048
v_mfma_f32_16x16x32_bf16 v[36:39],a[140:143],v[68:71],v[36:39]
s_waitcnt lgkmcnt(5)
v_mfma_f32_16x16x32_bf16 v[32:35],a[144:147],v[72:75],v[32:35]
ds_read_b128 v[96:99],v7 offset:3072
v_mfma_f32_16x16x32_bf16 v[36:39],a[148:151],v[72:75],v[36:39]
s_waitcnt vmcnt(0)
s_cmp_eq_u32 s77,0
s_cbranch_scc1 np_93
ck_94:
v_pk_add_f32 v[128:129],v[128:129],v[136:137]
v_pk_add_f32 v[144:145],v[144:145],v[40:41]
v_pk_add_f32 v[130:131],v[130:131],v[138:139]
v_pk_add_f32 v[146:147],v[146:147],v[42:43]
v_pk_add_f32 v[132:133],v[132:133],v[140:141]
v_pk_add_f32 v[148:149],v[148:149],v[44:45]
v_pk_add_f32 v[134:135],v[134:135],v[142:143]
v_pk_add_f32 v[150:151],v[150:151],v[46:47]
v_pk_add_f32 v[128:129],v[128:129],v[144:145]
v_pk_add_f32 v[130:131],v[130:131],v[146:147]
v_pk_add_f32 v[132:133],v[132:133],v[148:149]
v_pk_add_f32 v[134:135],v[134:135],v[150:151]
v_pk_add_f32 v[168:169],v[128:129],v[130:131]
v_pk_add_f32 v[170:171],v[132:133],v[134:135]
v_pk_add_f32 v[168:169],v[168:169],v[170:171]
v_cmp_u_f32 vcc,v168,v169
s_cbranch_vccnz rt_95
go_96:
v_lshlrev_b32 v168,16,v160
v_and_b32 v169,s73,v160
v_lshlrev_b32 v170,16,v161
v_and_b32 v171,s73,v161
v_lshlrev_b32 v172,16,v162
v_and_b32 v173,s73,v162
v_lshlrev_b32 v174,16,v163
v_and_b32 v175,s73,v163
v_lshlrev_b32 v176,16,v164
v_and_b32 v177,s73,v164
v_lshlrev_b32 v178,16,v165
v_and_b32 v179,s73,v165
v_lshlrev_b32 v180,16,v166
v_and_b32 v181,s73,v166
v_lshlrev_b32 v182,16,v167
v_and_b32 v183,s73,v167
v_pk_add_f32 v[128:129],v[128:129],v[176:177]
v_pk_add_f32 v[130:131],v[130:131],v[178:179]
v_pk_add_f32 v[132:133],v[132:133],v[180:181]
v_pk_add_f32 v[134:135],v[134:135],v[182:183]
v_fma_f32 v168,v128,v152,v168
v_fma_f32 v169,v129,v153,v169
v_fma_f32 v170,v130,v154,v170
v_fma_f32 v171,v131,v155,v171
v_fma_f32 v172,v132,v156,v172
v_fma_f32 v173,v133,v157,v173
v_fma_f32 v174,v134,v158,v174
v_fma_f32 v175,v135,v159,v175
v_cvt_pk_bf16_f32 v176,v168,v169
v_cvt_pk_bf16_f32 v177,v170,v171
v_cvt_pk_bf16_f32 v178,v172,v173
v_cvt_pk_bf16_f32 v179,v174,v175
s_and_b32 s64,s66,0xffff8000
buffer_store_dwordx4 v[176:179],v18,s[24:27],s64 offen
s_add_u32 s64,s74,s75
s_add_u32 s65,s64,4096
s_cmp_eq_u32 s56,1
s_cbranch_scc1 b1_97
buffer_store_dwordx4 v[204:207],v0,s[20:23],s64 offen offset:0
buffer_store_dwordx4 v[204:207],v0,s[20:23],s64 offen offset:1024
buffer_store_dwordx4 v[204:207],v0,s[20:23],s64 offen offset:2048
buffer_store_dwordx4 v[204:207],v0,s[20:23],s64 offen offset:3072
buffer_store_dwordx4 v[204:207],v0,s[20:23],s65 offen offset:0
buffer_store_dwordx4 v[204:207],v0,s[20:23],s65 offen offset:1024
b2_98:
s_add_u32 s66,s66,32768
s_add_u32 s75,s75,6144
s_cmp_eq_u32 s75,24576
s_cselect_b32 s75,0,s75
s_add_u32 s76,s76,1
s_mov_b32 s77,0
np_93:
v_cmp_gt_u32 vcc,s71,v16
s_cbranch_vccnz vN_87
s_waitcnt lgkmcnt(5)
v_mfma_f32_16x16x32_bf16 v[32:35],a[152:155],v[76:79],v[32:35]
ds_read_b128 v[100:103],v7 offset:4096
s_add_u32 m0,s70,s63
v_mfma_f32_16x16x32_bf16 v[36:39],a[156:159],v[76:79],v[36:39]
s_add_u32 s62,s61,4096
s_waitcnt lgkmcnt(5)
v_mfma_f32_16x16x32_bf16 v[32:35],a[160:163],v[80:83],v[32:35]
ds_read_b128 v[104:107],v7 offset:5120
buffer_load_dwordx4 v3,s[20:23],s61 offen offset:0 lds
v_mfma_f32_16x16x32_bf16 v[36:39],a[164:167],v[80:83],v[36:39]
buffer_load_dwordx4 v3,s[20:23],s61 offen offset:1024 lds
s_waitcnt lgkmcnt(5)
v_mfma_f32_16x16x32_bf16 v[32:35],a[168:171],v[84:87],v[32:35]
ds_read_b128 v[108:111],v7 offset:6144
buffer_load_dwordx4 v3,s[20:23],s61 offen offset:2048 lds
v_mfma_f32_16x16x32_bf16 v[36:39],a[172:175],v[84:87],v[36:39]
buffer_load_dwordx4 v3,s[20:23],s61 offen offset:3072 lds
s_waitcnt lgkmcnt(5)
v_mfma_f32_16x16x32_bf16 v[32:35],a[176:179],v[88:91],v[32:35]
s_add_u32 m0,m0,4096
v_mfma_f32_16x16x32_bf16 v[36:39],a[180:183],v[88:91],v[36:39]
buffer_load_dwordx4 v3,s[20:23],s62 offen offset:0 lds
s_waitcnt lgkmcnt(4)
v_mfma_f32_16x16x32_bf16 v[32:35],a[184:187],v[92:95],v[32:35]
buffer_load_dwordx4 v3,s[20:23],s62 offen offset:1024 lds
v_mfma_f32_16x16x32_bf16 v[36:39],a[188:191],v[92:95],v[36:39]
buffer_load_dwordx4 v3,s[20:23],s62 offen offset:2048 lds
s_waitcnt lgkmcnt(3)
v_mfma_f32_16x16x32_bf16 v[32:35],a[192:195],v[96:99],v[32:35]
s_add_u32 s61,s61,114688
v_mfma_f32_16x16x32_bf16 v[36:39],a[196:199],v[96:99],v[36:39]
s_add_u32 s70,s70,32768
s_waitcnt lgkmcnt(2)
v_mfma_f32_16x16x32_bf16 v[32:35],a[200:203],v[100:103],v[32:35]
s_and_b32 s70,s70,0x1ffff
v_mfma_f32_16x16x32_bf16 v[36:39],a[204:207],v[100:103],v[36:39]
s_waitcnt lgkmcnt(1)
v_mfma_f32_16x16x32_bf16 v[32:35],a[208:211],v[104:107],v[32:35]
v_mfma_f32_16x16x32_bf16 v[36:39],a[212:215],v[104:107],v[36:39]
s_waitcnt lgkmcnt(0)
v_mfma_f32_16x16x32_bf16 v[32:35],a[216:219],v[108:111],v[32:35]
v_mfma_f32_16x16x32_bf16 v[36:39],a[220:223],v[108:111],v[36:39]
s_mov_b32 s72,1
join_88:
s_nop 5
v_mov_b32 v40,v32
v_mov_b32 v41,v33
v_mov_b32 v42,v34
v_mov_b32 v43,v35
v_mov_b32 v44,v36
v_mov_b32 v45,v37
v_mov_b32 v46,v38
v_mov_b32 v47,v39
s_mov_b32 s77,1
s_add_u32 s60,s60,1
s_cmp_eq_u32 s72,0
s_cbranch_scc1 slowp_89
s_branch top_86
slowp_89:
s_waitcnt vmcnt(0)
v_cmp_gt_u32 vcc,s71,v16
s_cbranch_vccz lag_90
s_add_u32 s64,s66,201326592
buffer_load_dwordx4 v[160:163],v0,s[20:23],s64 offen
s_add_u32 s64,s66,214958080
buffer_load_dwordx4 v[164:167],v0,s[20:23],s64 offen
s_add_u32 s64,s74,s75
s_add_u32 s65,s64,4096
buffer_load_dwordx4 v[128:131],v0,s[20:23],s64 offen offset:0 sc1
buffer_load_dwordx4 v[132:135],v0,s[20:23],s64 offen offset:1024 sc1
buffer_load_dwordx4 v[136:139],v0,s[20:23],s64 offen offset:2048 sc1
buffer_load_dwordx4 v[140:143],v0,s[20:23],s64 offen offset:3072 sc1
buffer_load_dwordx4 v[144:147],v0,s[20:23],s65 offen offset:0 sc1
buffer_load_dwordx4 v[148:151],v0,s[20:23],s65 offen offset:1024 sc1
s_waitcnt vmcnt(0)
ck_99:
v_pk_add_f32 v[128:129],v[128:129],v[136:137]
v_pk_add_f32 v[144:145],v[144:145],v[40:41]
v_pk_add_f32 v[130:131],v[130:131],v[138:139]
v_pk_add_f32 v[146:147],v[146:147],v[42:43]
v_pk_add_f32 v[132:133],v[132:133],v[140:141]
v_pk_add_f32 v[148:149],v[148:149],v[44:45]
v_pk_add_f32 v[134:135],v[134:135],v[142:143]
v_pk_add_f32 v[150:151],v[150:151],v[46:47]
v_pk_add_f32 v[128:129],v[128:129],v[144:145]
v_pk_add_f32 v[130:131],v[130:131],v[146:147]
v_pk_add_f32 v[132:133],v[132:133],v[148:149]
v_pk_add_f32 v[134:135],v[134:135],v[150:151]
v_pk_add_f32 v[168:169],v[128:129],v[130:131]
v_pk_add_f32 v[170:171],v[132:133],v[134:135]
v_pk_add_f32 v[168:169],v[168:169],v[170:171]
v_cmp_u_f32 vcc,v168,v169
s_cbranch_vccnz rt_100
go_101:
v_lshlrev_b32 v168,16,v160
v_and_b32 v169,s73,v160
v_lshlrev_b32 v170,16,v161
v_and_b32 v171,s73,v161
v_lshlrev_b32 v172,16,v162
v_and_b32 v173,s73,v162
v_lshlrev_b32 v174,16,v163
v_and_b32 v175,s73,v163
v_lshlrev_b32 v176,16,v164
v_and_b32 v177,s73,v164
v_lshlrev_b32 v178,16,v165
v_and_b32 v179,s73,v165
v_lshlrev_b32 v180,16,v166
v_and_b32 v181,s73,v166
v_lshlrev_b32 v182,16,v167
v_and_b32 v183,s73,v167
v_pk_add_f32 v[128:129],v[128:129],v[176:177]
v_pk_add_f32 v[130:131],v[130:131],v[178:179]
v_pk_add_f32 v[132:133],v[132:133],v[180:181]
v_pk_add_f32 v[134:135],v[134:135],v[182:183]
v_fma_f32 v168,v128,v152,v168
v_fma_f32 v169,v129,v153,v169
v_fma_f32 v170,v130,v154,v170
v_fma_f32 v171,v131,v155,v171
v_fma_f32 v172,v132,v156,v172
v_fma_f32 v173,v133,v157,v173
v_fma_f32 v174,v134,v158,v174
v_fma_f32 v175,v135,v159,v175
v_cvt_pk_bf16_f32 v176,v168,v169
v_cvt_pk_bf16_f32 v177,v170,v171
v_cvt_pk_bf16_f32 v178,v172,v173
v_cvt_pk_bf16_f32 v179,v174,v175
s_and_b32 s64,s66,0xffff8000
buffer_store_dwordx4 v[176:179],v18,s[24:27],s64 offen
s_add_u32 s64,s74,s75
s_add_u32 s65,s64,4096
s_cmp_eq_u32 s56,1
s_cbranch_scc1 b1_102
buffer_store_dwordx4 v[204:207],v0,s[20:23],s64 offen offset:0
buffer_store_dwordx4 v[204:207],v0,s[20:23],s64 offen offset:1024
buffer_store_dwordx4 v[204:207],v0,s[20:23],s64 offen offset:2048
buffer_store_dwordx4 v[204:207],v0,s[20:23],s64 offen offset:3072
buffer_store_dwordx4 v[204:207],v0,s[20:23],s65 offen offset:0
buffer_store_dwordx4 v[204:207],v0,s[20:23],s65 offen offset:1024
b2_103:
s_add_u32 s66,s66,32768
s_add_u32 s75,s75,6144
s_cmp_eq_u32 s75,24576
s_cselect_b32 s75,0,s75
s_add_u32 s76,s76,1
s_mov_b32 s77,0
s_cmp_ge_u32 s60,128
s_cbranch_scc1 done_68
plp_104:
buffer_load_dword v16,v2,s[20:23],s68 offen sc1
s_waitcnt vmcnt(0)
v_cmp_gt_u32 vcc,s71,v16
s_cbranch_vccz pok_105
s_sleep 4
s_sub_u32 s90,s90,1
s_cmp_gt_i32 s90,0
s_cbranch_scc1 plp_104
pok_105:
s_branch lag_90
vN_76:
buffer_load_dword v16,v2,s[20:23],s68 offen sc1
s_waitcnt lgkmcnt(5)
v_mfma_f32_16x16x32_bf16 v[32:35],a[152:155],v[76:79],v[32:35]
ds_read_b128 v[100:103],v7 offset:4096
v_mfma_f32_16x16x32_bf16 v[36:39],a[156:159],v[76:79],v[36:39]
s_waitcnt lgkmcnt(5)
v_mfma_f32_16x16x32_bf16 v[32:35],a[160:163],v[80:83],v[32:35]
ds_read_b128 v[104:107],v7 offset:5120
v_mfma_f32_16x16x32_bf16 v[36:39],a[164:167],v[80:83],v[36:39]
s_waitcnt lgkmcnt(5)
v_mfma_f32_16x16x32_bf16 v[32:35],a[168:171],v[84:87],v[32:35]
ds_read_b128 v[108:111],v7 offset:6144
v_mfma_f32_16x16x32_bf16 v[36:39],a[172:175],v[84:87],v[36:39]
s_waitcnt lgkmcnt(5)
v_mfma_f32_16x16x32_bf16 v[32:35],a[176:179],v[88:91],v[32:35]
v_mfma_f32_16x16x32_bf16 v[36:39],a[180:183],v[88:91],v[36:39]
s_waitcnt lgkmcnt(4)
v_mfma_f32_16x16x32_bf16 v[32:35],a[184:187],v[92:95],v[32:35]
v_mfma_f32_16x16x32_bf16 v[36:39],a[188:191],v[92:95],v[36:39]
s_waitcnt lgkmcnt(3)
v_mfma_f32_16x16x32_bf16 v[32:35],a[192:195],v[96:99],v[32:35]
v_mfma_f32_16x16x32_bf16 v[36:39],a[196:199],v[96:99],v[36:39]
s_waitcnt lgkmcnt(2)
v_mfma_f32_16x16x32_bf16 v[32:35],a[200:203],v[100:103],v[32:35]
v_mfma_f32_16x16x32_bf16 v[36:39],a[204:207],v[100:103],v[36:39]
s_waitcnt lgkmcnt(1)
v_mfma_f32_16x16x32_bf16 v[32:35],a[208:211],v[104:107],v[32:35]
v_mfma_f32_16x16x32_bf16 v[36:39],a[212:215],v[104:107],v[36:39]
s_waitcnt lgkmcnt(0)
v_mfma_f32_16x16x32_bf16 v[32:35],a[216:219],v[108:111],v[32:35]
v_mfma_f32_16x16x32_bf16 v[36:39],a[220:223],v[108:111],v[36:39]
s_mov_b32 s72,0
s_branch join_77
b1_82:
s_nop 7
buffer_store_dwordx4 v[32:35],v0,s[20:23],s64 offen offset:0 sc1
buffer_store_dwordx4 v[36:39],v0,s[20:23],s64 offen offset:1024 sc1
s_branch b2_83
rt_95:
s_sub_u32 s90,s90,1
s_cmp_gt_i32 s90,0
s_cbranch_scc0 go_96
s_add_u32 s64,s74,s75
s_add_u32 s65,s64,4096
buffer_load_dwordx4 v[128:131],v0,s[20:23],s64 offen offset:0 sc1
buffer_load_dwordx4 v[132:135],v0,s[20:23],s64 offen offset:1024 sc1
buffer_load_dwordx4 v[136:139],v0,s[20:23],s64 offen offset:2048 sc1
buffer_load_dwordx4 v[140:143],v0,s[20:23],s64 offen offset:3072 sc1
buffer_load_dwordx4 v[144:147],v0,s[20:23],s65 offen offset:0 sc1
buffer_load_dwordx4 v[148:151],v0,s[20:23],s65 offen offset:1024 sc1
s_waitcnt vmcnt(0)
s_branch ck_94
b1_97:
s_nop 7
buffer_store_dwordx4 v[204:207],v0,s[20:23],s64 offen offset:0 sc1
buffer_store_dwordx4 v[204:207],v0,s[20:23],s64 offen offset:1024 sc1
buffer_store_dwordx4 v[204:207],v0,s[20:23],s64 offen offset:2048 sc1
buffer_store_dwordx4 v[204:207],v0,s[20:23],s64 offen offset:3072 sc1
buffer_store_dwordx4 v[204:207],v0,s[20:23],s65 offen offset:0 sc1
buffer_store_dwordx4 v[204:207],v0,s[20:23],s65 offen offset:1024 sc1
s_branch b2_98
vN_87:
buffer_load_dword v16,v2,s[20:23],s68 offen sc1
s_waitcnt lgkmcnt(5)
v_mfma_f32_16x16x32_bf16 v[32:35],a[152:155],v[76:79],v[32:35]
ds_read_b128 v[100:103],v7 offset:4096
v_mfma_f32_16x16x32_bf16 v[36:39],a[156:159],v[76:79],v[36:39]
s_waitcnt lgkmcnt(5)
v_mfma_f32_16x16x32_bf16 v[32:35],a[160:163],v[80:83],v[32:35]
ds_read_b128 v[104:107],v7 offset:5120
v_mfma_f32_16x16x32_bf16 v[36:39],a[164:167],v[80:83],v[36:39]
s_waitcnt lgkmcnt(5)
v_mfma_f32_16x16x32_bf16 v[32:35],a[168:171],v[84:87],v[32:35]
ds_read_b128 v[108:111],v7 offset:6144
v_mfma_f32_16x16x32_bf16 v[36:39],a[172:175],v[84:87],v[36:39]
s_waitcnt lgkmcnt(5)
v_mfma_f32_16x16x32_bf16 v[32:35],a[176:179],v[88:91],v[32:35]
v_mfma_f32_16x16x32_bf16 v[36:39],a[180:183],v[88:91],v[36:39]
s_waitcnt lgkmcnt(4)
v_mfma_f32_16x16x32_bf16 v[32:35],a[184:187],v[92:95],v[32:35]
v_mfma_f32_16x16x32_bf16 v[36:39],a[188:191],v[92:95],v[36:39]
s_waitcnt lgkmcnt(3)
v_mfma_f32_16x16x32_bf16 v[32:35],a[192:195],v[96:99],v[32:35]
v_mfma_f32_16x16x32_bf16 v[36:39],a[196:199],v[96:99],v[36:39]
s_waitcnt lgkmcnt(2)
v_mfma_f32_16x16x32_bf16 v[32:35],a[200:203],v[100:103],v[32:35]
v_mfma_f32_16x16x32_bf16 v[36:39],a[204:207],v[100:103],v[36:39]
s_waitcnt lgkmcnt(1)
v_mfma_f32_16x16x32_bf16 v[32:35],a[208:211],v[104:107],v[32:35]
v_mfma_f32_16x16x32_bf16 v[36:39],a[212:215],v[104:107],v[36:39]
s_waitcnt lgkmcnt(0)
v_mfma_f32_16x16x32_bf16 v[32:35],a[216:219],v[108:111],v[32:35]
v_mfma_f32_16x16x32_bf16 v[36:39],a[220:223],v[108:111],v[36:39]
s_mov_b32 s72,0
s_branch join_88
rt_100:
s_sub_u32 s90,s90,1
s_cmp_gt_i32 s90,0
s_cbranch_scc0 go_101
s_add_u32 s64,s74,s75
s_add_u32 s65,s64,4096
buffer_load_dwordx4 v[128:131],v0,s[20:23],s64 offen offset:0 sc1
buffer_load_dwordx4 v[132:135],v0,s[20:23],s64 offen offset:1024 sc1
buffer_load_dwordx4 v[136:139],v0,s[20:23],s64 offen offset:2048 sc1
buffer_load_dwordx4 v[140:143],v0,s[20:23],s64 offen offset:3072 sc1
buffer_load_dwordx4 v[144:147],v0,s[20:23],s65 offen offset:0 sc1
buffer_load_dwordx4 v[148:151],v0,s[20:23],s65 offen offset:1024 sc1
s_waitcnt vmcnt(0)
s_branch ck_99
b1_102:
s_nop 7
buffer_store_dwordx4 v[204:207],v0,s[20:23],s64 offen offset:0 sc1
buffer_store_dwordx4 v[204:207],v0,s[20:23],s64 offen offset:1024 sc1
buffer_store_dwordx4 v[204:207],v0,s[20:23],s64 offen offset:2048 sc1
buffer_store_dwordx4 v[204:207],v0,s[20:23],s64 offen offset:3072 sc1
buffer_store_dwordx4 v[204:207],v0,s[20:23],s65 offen offset:0 sc1
buffer_store_dwordx4 v[204:207],v0,s[20:23],s65 offen offset:1024 sc1
s_branch b2_103
done_68:
s_endpgm
fl_w3:
v_and_b32 v21,15,v1
v_lshrrev_b32 v22,4,v1
v_lshrrev_b32 v23,2,v21
v_and_b32 v24,3,v21
s_lshl_b32 s61,s50,15
v_lshl_add_u32 v25,v22,3,v23
s_load_dwordx2 s[4:5],s[0:1],80
s_mov_b32 s52,0
s_mov_b32 s53,s59
s_mul_i32 s54,s52,7340032
s_lshl_b32 s64,s53,8
s_add_u32 s54,s54,s64
s_lshl_b32 s64,s50,6
s_add_u32 s54,s54,s64
s_waitcnt lgkmcnt(0)
s_mov_b32 s28,s4
s_and_b32 s29,s5,0xffff
s_mov_b32 s30,0x700000
s_mov_b32 s31,0x20000
v_lshrrev_b32 v26,2,v1
v_and_b32 v27,3,v1
v_mul_u32_u24 v16,7168,v26
v_lshl_add_u32 v16,v27,4,v16
v_lshlrev_b32 v17,6,v25
v_lshl_add_u32 v17,v24,4,v17
v_add_u32 v17,s61,v17
s_xor_b32 s62,s50,0
s_mul_i32 s62,s62,1835008
s_add_u32 s62,s62,s54
s_add_u32 m0,s61,0
s_nop 0
buffer_load_dwordx4 v16,s[28:31],s62 offen lds
s_add_u32 s62,s62,114688
s_add_u32 m0,m0,1024
s_nop 0
buffer_load_dwordx4 v16,s[28:31],s62 offen lds
s_add_u32 s62,s62,114688
s_add_u32 m0,m0,1024
s_nop 0
buffer_load_dwordx4 v16,s[28:31],s62 offen lds
s_add_u32 s62,s62,114688
s_add_u32 m0,m0,1024
s_nop 0
buffer_load_dwordx4 v16,s[28:31],s62 offen lds
s_add_u32 s62,s62,114688
s_add_u32 m0,m0,1024
s_nop 0
buffer_load_dwordx4 v16,s[28:31],s62 offen lds
s_add_u32 s62,s62,114688
s_add_u32 m0,m0,1024
s_nop 0
buffer_load_dwordx4 v16,s[28:31],s62 offen lds
s_add_u32 s62,s62,114688
s_add_u32 m0,m0,1024
s_nop 0
buffer_load_dwordx4 v16,s[28:31],s62 offen lds
s_add_u32 s62,s62,114688
s_add_u32 m0,m0,1024
s_nop 0
buffer_load_dwordx4 v16,s[28:31],s62 offen lds
s_add_u32 s62,s62,114688
s_add_u32 m0,m0,1024
s_nop 0
buffer_load_dwordx4 v16,s[28:31],s62 offen lds
s_add_u32 s62,s62,114688
s_add_u32 m0,m0,1024
s_nop 0
buffer_load_dwordx4 v16,s[28:31],s62 offen lds
s_add_u32 s62,s62,114688
s_add_u32 m0,m0,1024
s_nop 0
buffer_load_dwordx4 v16,s[28:31],s62 offen lds
s_add_u32 s62,s62,114688
s_add_u32 m0,m0,1024
s_nop 0
buffer_load_dwordx4 v16,s[28:31],s62 offen lds
s_add_u32 s62,s62,114688
s_add_u32 m0,m0,1024
s_nop 0
buffer_load_dwordx4 v16,s[28:31],s62 offen lds
s_add_u32 s62,s62,114688
s_add_u32 m0,m0,1024
s_nop 0
buffer_load_dwordx4 v16,s[28:31],s62 offen lds
s_add_u32 s62,s62,114688
s_add_u32 m0,m0,1024
s_nop 0
buffer_load_dwordx4 v16,s[28:31],s62 offen lds
s_add_u32 s62,s62,114688
s_add_u32 m0,m0,1024
s_nop 0
buffer_load_dwordx4 v16,s[28:31],s62 offen lds
s_xor_b32 s62,s50,1
s_mul_i32 s62,s62,1835008
s_add_u32 s62,s62,s54
s_add_u32 m0,s61,16384
s_nop 0
buffer_load_dwordx4 v16,s[28:31],s62 offen lds
s_add_u32 s62,s62,114688
s_add_u32 m0,m0,1024
s_nop 0
buffer_load_dwordx4 v16,s[28:31],s62 offen lds
s_add_u32 s62,s62,114688
s_add_u32 m0,m0,1024
s_nop 0
buffer_load_dwordx4 v16,s[28:31],s62 offen lds
s_add_u32 s62,s62,114688
s_add_u32 m0,m0,1024
s_nop 0
buffer_load_dwordx4 v16,s[28:31],s62 offen lds
s_add_u32 s62,s62,114688
s_add_u32 m0,m0,1024
s_nop 0
buffer_load_dwordx4 v16,s[28:31],s62 offen lds
s_add_u32 s62,s62,114688
s_add_u32 m0,m0,1024
s_nop 0
buffer_load_dwordx4 v16,s[28:31],s62 offen lds
s_add_u32 s62,s62,114688
s_add_u32 m0,m0,1024
s_nop 0
buffer_load_dwordx4 v16,s[28:31],s62 offen lds
s_add_u32 s62,s62,114688
s_add_u32 m0,m0,1024
s_nop 0
buffer_load_dwordx4 v16,s[28:31],s62 offen lds
s_add_u32 s62,s62,114688
s_add_u32 m0,m0,1024
s_nop 0
buffer_load_dwordx4 v16,s[28:31],s62 offen lds
s_add_u32 s62,s62,114688
s_add_u32 m0,m0,1024
s_nop 0
buffer_load_dwordx4 v16,s[28:31],s62 offen lds
s_add_u32 s62,s62,114688
s_add_u32 m0,m0,1024
s_nop 0
buffer_load_dwordx4 v16,s[28:31],s62 offen lds
s_add_u32 s62,s62,114688
s_add_u32 m0,m0,1024
s_nop 0
buffer_load_dwordx4 v16,s[28:31],s62 offen lds
s_add_u32 s62,s62,114688
s_add_u32 m0,m0,1024
s_nop 0
buffer_load_dwordx4 v16,s[28:31],s62 offen lds
s_add_u32 s62,s62,114688
s_add_u32 m0,m0,1024
s_nop 0
buffer_load_dwordx4 v16,s[28:31],s62 offen lds
s_add_u32 s62,s62,114688
s_add_u32 m0,m0,1024
s_nop 0
buffer_load_dwordx4 v16,s[28:31],s62 offen lds
s_add_u32 s62,s62,114688
s_add_u32 m0,m0,1024
s_nop 0
buffer_load_dwordx4 v16,s[28:31],s62 offen lds
s_waitcnt vmcnt(16)
ds_read_b64_tr_b16 a[0:1],v17 offset:0
ds_read_b64_tr_b16 a[2:3],v17 offset:256
ds_read_b64_tr_b16 a[4:5],v17 offset:8
ds_read_b64_tr_b16 a[6:7],v17 offset:264
ds_read_b64_tr_b16 a[8:9],v17 offset:2048
ds_read_b64_tr_b16 a[10:11],v17 offset:2304
ds_read_b64_tr_b16 a[12:13],v17 offset:2056
ds_read_b64_tr_b16 a[14:15],v17 offset:2312
ds_read_b64_tr_b16 a[16:17],v17 offset:4096
ds_read_b64_tr_b16 a[18:19],v17 offset:4352
ds_read_b64_tr_b16 a[20:21],v17 offset:4104
ds_read_b64_tr_b16 a[22:23],v17 offset:4360
s_waitcnt lgkmcnt(0)
ds_read_b64_tr_b16 a[24:25],v17 offset:6144
ds_read_b64_tr_b16 a[26:27],v17 offset:6400
ds_read_b64_tr_b16 a[28:29],v17 offset:6152
ds_read_b64_tr_b16 a[30:31],v17 offset:6408
ds_read_b64_tr_b16 a[32:33],v17 offset:8192
ds_read_b64_tr_b16 a[34:35],v17 offset:8448
ds_read_b64_tr_b16 a[36:37],v17 offset:8200
ds_read_b64_tr_b16 a[38:39],v17 offset:8456
ds_read_b64_tr_b16 a[40:41],v17 offset:10240
ds_read_b64_tr_b16 a[42:43],v17 offset:10496
ds_read_b64_tr_b16 a[44:45],v17 offset:10248
ds_read_b64_tr_b16 a[46:47],v17 offset:10504
s_waitcnt lgkmcnt(0)
ds_read_b64_tr_b16 a[48:49],v17 offset:12288
ds_read_b64_tr_b16 a[50:51],v17 offset:12544
ds_read_b64_tr_b16 a[52:53],v17 offset:12296
ds_read_b64_tr_b16 a[54:55],v17 offset:12552
ds_read_b64_tr_b16 a[56:57],v17 offset:14336
ds_read_b64_tr_b16 a[58:59],v17 offset:14592
ds_read_b64_tr_b16 a[60:61],v17 offset:14344
ds_read_b64_tr_b16 a[62:63],v17 offset:14600
s_waitcnt lgkmcnt(0)
s_xor_b32 s62,s50,2
s_mul_i32 s62,s62,1835008
s_add_u32 s62,s62,s54
s_add_u32 m0,s61,0
s_nop 0
buffer_load_dwordx4 v16,s[28:31],s62 offen lds
s_add_u32 s62,s62,114688
s_add_u32 m0,m0,1024
s_nop 0
buffer_load_dwordx4 v16,s[28:31],s62 offen lds
s_add_u32 s62,s62,114688
s_add_u32 m0,m0,1024
s_nop 0
buffer_load_dwordx4 v16,s[28:31],s62 offen lds
s_add_u32 s62,s62,114688
s_add_u32 m0,m0,1024
s_nop 0
buffer_load_dwordx4 v16,s[28:31],s62 offen lds
s_add_u32 s62,s62,114688
s_add_u32 m0,m0,1024
s_nop 0
buffer_load_dwordx4 v16,s[28:31],s62 offen lds
s_add_u32 s62,s62,114688
s_add_u32 m0,m0,1024
s_nop 0
buffer_load_dwordx4 v16,s[28:31],s62 offen lds
s_add_u32 s62,s62,114688
s_add_u32 m0,m0,1024
s_nop 0
buffer_load_dwordx4 v16,s[28:31],s62 offen lds
s_add_u32 s62,s62,114688
s_add_u32 m0,m0,1024
s_nop 0
buffer_load_dwordx4 v16,s[28:31],s62 offen lds
s_add_u32 s62,s62,114688
s_add_u32 m0,m0,1024
s_nop 0
buffer_load_dwordx4 v16,s[28:31],s62 offen lds
s_add_u32 s62,s62,114688
s_add_u32 m0,m0,1024
s_nop 0
buffer_load_dwordx4 v16,s[28:31],s62 offen lds
s_add_u32 s62,s62,114688
s_add_u32 m0,m0,1024
s_nop 0
buffer_load_dwordx4 v16,s[28:31],s62 offen lds
s_add_u32 s62,s62,114688
s_add_u32 m0,m0,1024
s_nop 0
buffer_load_dwordx4 v16,s[28:31],s62 offen lds
s_add_u32 s62,s62,114688
s_add_u32 m0,m0,1024
s_nop 0
buffer_load_dwordx4 v16,s[28:31],s62 offen lds
s_add_u32 s62,s62,114688
s_add_u32 m0,m0,1024
s_nop 0
buffer_load_dwordx4 v16,s[28:31],s62 offen lds
s_add_u32 s62,s62,114688
s_add_u32 m0,m0,1024
s_nop 0
buffer_load_dwordx4 v16,s[28:31],s62 offen lds
s_add_u32 s62,s62,114688
s_add_u32 m0,m0,1024
s_nop 0
buffer_load_dwordx4 v16,s[28:31],s62 offen lds
s_waitcnt vmcnt(16)
ds_read_b64_tr_b16 a[64:65],v17 offset:16384
ds_read_b64_tr_b16 a[66:67],v17 offset:16640
ds_read_b64_tr_b16 a[68:69],v17 offset:16392
ds_read_b64_tr_b16 a[70:71],v17 offset:16648
ds_read_b64_tr_b16 a[72:73],v17 offset:18432
ds_read_b64_tr_b16 a[74:75],v17 offset:18688
ds_read_b64_tr_b16 a[76:77],v17 offset:18440
ds_read_b64_tr_b16 a[78:79],v17 offset:18696
ds_read_b64_tr_b16 a[80:81],v17 offset:20480
ds_read_b64_tr_b16 a[82:83],v17 offset:20736
ds_read_b64_tr_b16 a[84:85],v17 offset:20488
ds_read_b64_tr_b16 a[86:87],v17 offset:20744
s_waitcnt lgkmcnt(0)
ds_read_b64_tr_b16 a[88:89],v17 offset:22528
ds_read_b64_tr_b16 a[90:91],v17 offset:22784
ds_read_b64_tr_b16 a[92:93],v17 offset:22536
ds_read_b64_tr_b16 a[94:95],v17 offset:22792
ds_read_b64_tr_b16 a[96:97],v17 offset:24576
ds_read_b64_tr_b16 a[98:99],v17 offset:24832
ds_read_b64_tr_b16 a[100:101],v17 offset:24584
ds_read_b64_tr_b16 a[102:103],v17 offset:24840
ds_read_b64_tr_b16 a[104:105],v17 offset:26624
ds_read_b64_tr_b16 a[106:107],v17 offset:26880
ds_read_b64_tr_b16 a[108:109],v17 offset:26632
ds_read_b64_tr_b16 a[110:111],v17 offset:26888
s_waitcnt lgkmcnt(0)
ds_read_b64_tr_b16 a[112:113],v17 offset:28672
ds_read_b64_tr_b16 a[114:115],v17 offset:28928
ds_read_b64_tr_b16 a[116:117],v17 offset:28680
ds_read_b64_tr_b16 a[118:119],v17 offset:28936
ds_read_b64_tr_b16 a[120:121],v17 offset:30720
ds_read_b64_tr_b16 a[122:123],v17 offset:30976
ds_read_b64_tr_b16 a[124:125],v17 offset:30728
ds_read_b64_tr_b16 a[126:127],v17 offset:30984
s_waitcnt lgkmcnt(0)
s_xor_b32 s62,s50,3
s_mul_i32 s62,s62,1835008
s_add_u32 s62,s62,s54
s_add_u32 m0,s61,16384
s_nop 0
buffer_load_dwordx4 v16,s[28:31],s62 offen lds
s_add_u32 s62,s62,114688
s_add_u32 m0,m0,1024
s_nop 0
buffer_load_dwordx4 v16,s[28:31],s62 offen lds
s_add_u32 s62,s62,114688
s_add_u32 m0,m0,1024
s_nop 0
buffer_load_dwordx4 v16,s[28:31],s62 offen lds
s_add_u32 s62,s62,114688
s_add_u32 m0,m0,1024
s_nop 0
buffer_load_dwordx4 v16,s[28:31],s62 offen lds
s_add_u32 s62,s62,114688
s_add_u32 m0,m0,1024
s_nop 0
buffer_load_dwordx4 v16,s[28:31],s62 offen lds
s_add_u32 s62,s62,114688
s_add_u32 m0,m0,1024
s_nop 0
buffer_load_dwordx4 v16,s[28:31],s62 offen lds
s_add_u32 s62,s62,114688
s_add_u32 m0,m0,1024
s_nop 0
buffer_load_dwordx4 v16,s[28:31],s62 offen lds
s_add_u32 s62,s62,114688
s_add_u32 m0,m0,1024
s_nop 0
buffer_load_dwordx4 v16,s[28:31],s62 offen lds
s_add_u32 s62,s62,114688
s_add_u32 m0,m0,1024
s_nop 0
buffer_load_dwordx4 v16,s[28:31],s62 offen lds
s_add_u32 s62,s62,114688
s_add_u32 m0,m0,1024
s_nop 0
buffer_load_dwordx4 v16,s[28:31],s62 offen lds
s_add_u32 s62,s62,114688
s_add_u32 m0,m0,1024
s_nop 0
buffer_load_dwordx4 v16,s[28:31],s62 offen lds
s_add_u32 s62,s62,114688
s_add_u32 m0,m0,1024
s_nop 0
buffer_load_dwordx4 v16,s[28:31],s62 offen lds
s_add_u32 s62,s62,114688
s_add_u32 m0,m0,1024
s_nop 0
buffer_load_dwordx4 v16,s[28:31],s62 offen lds
s_add_u32 s62,s62,114688
s_add_u32 m0,m0,1024
s_nop 0
buffer_load_dwordx4 v16,s[28:31],s62 offen lds
s_add_u32 s62,s62,114688
s_add_u32 m0,m0,1024
s_nop 0
buffer_load_dwordx4 v16,s[28:31],s62 offen lds
s_add_u32 s62,s62,114688
s_add_u32 m0,m0,1024
s_nop 0
buffer_load_dwordx4 v16,s[28:31],s62 offen lds
s_waitcnt vmcnt(16)
ds_read_b64_tr_b16 a[128:129],v17 offset:0
ds_read_b64_tr_b16 a[130:131],v17 offset:256
ds_read_b64_tr_b16 a[132:133],v17 offset:8
ds_read_b64_tr_b16 a[134:135],v17 offset:264
ds_read_b64_tr_b16 a[136:137],v17 offset:2048
ds_read_b64_tr_b16 a[138:139],v17 offset:2304
ds_read_b64_tr_b16 a[140:141],v17 offset:2056
ds_read_b64_tr_b16 a[142:143],v17 offset:2312
ds_read_b64_tr_b16 a[144:145],v17 offset:4096
ds_read_b64_tr_b16 a[146:147],v17 offset:4352
ds_read_b64_tr_b16 a[148:149],v17 offset:4104
ds_read_b64_tr_b16 a[150:151],v17 offset:4360
s_waitcnt lgkmcnt(0)
ds_read_b64_tr_b16 a[152:153],v17 offset:6144
ds_read_b64_tr_b16 a[154:155],v17 offset:6400
ds_read_b64_tr_b16 a[156:157],v17 offset:6152
ds_read_b64_tr_b16 a[158:159],v17 offset:6408
ds_read_b64_tr_b16 a[160:161],v17 offset:8192
ds_read_b64_tr_b16 a[162:163],v17 offset:8448
ds_read_b64_tr_b16 a[164:165],v17 offset:8200
ds_read_b64_tr_b16 a[166:167],v17 offset:8456
ds_read_b64_tr_b16 a[168:169],v17 offset:10240
ds_read_b64_tr_b16 a[170:171],v17 offset:10496
ds_read_b64_tr_b16 a[172:173],v17 offset:10248
ds_read_b64_tr_b16 a[174:175],v17 offset:10504
s_waitcnt lgkmcnt(0)
ds_read_b64_tr_b16 a[176:177],v17 offset:12288
ds_read_b64_tr_b16 a[178:179],v17 offset:12544
ds_read_b64_tr_b16 a[180:181],v17 offset:12296
ds_read_b64_tr_b16 a[182:183],v17 offset:12552
ds_read_b64_tr_b16 a[184:185],v17 offset:14336
ds_read_b64_tr_b16 a[186:187],v17 offset:14592
ds_read_b64_tr_b16 a[188:189],v17 offset:14344
ds_read_b64_tr_b16 a[190:191],v17 offset:14600
s_waitcnt lgkmcnt(0)
s_waitcnt vmcnt(0)
ds_read_b64_tr_b16 a[192:193],v17 offset:16384
ds_read_b64_tr_b16 a[194:195],v17 offset:16640
ds_read_b64_tr_b16 a[196:197],v17 offset:16392
ds_read_b64_tr_b16 a[198:199],v17 offset:16648
ds_read_b64_tr_b16 a[200:201],v17 offset:18432
ds_read_b64_tr_b16 a[202:203],v17 offset:18688
ds_read_b64_tr_b16 a[204:205],v17 offset:18440
ds_read_b64_tr_b16 a[206:207],v17 offset:18696
ds_read_b64_tr_b16 a[208:209],v17 offset:20480
ds_read_b64_tr_b16 a[210:211],v17 offset:20736
ds_read_b64_tr_b16 a[212:213],v17 offset:20488
ds_read_b64_tr_b16 a[214:215],v17 offset:20744
s_waitcnt lgkmcnt(0)
ds_read_b64_tr_b16 a[216:217],v17 offset:22528
ds_read_b64_tr_b16 a[218:219],v17 offset:22784
ds_read_b64_tr_b16 a[220:221],v17 offset:22536
ds_read_b64_tr_b16 a[222:223],v17 offset:22792
ds_read_b64_tr_b16 a[224:225],v17 offset:24576
ds_read_b64_tr_b16 a[226:227],v17 offset:24832
ds_read_b64_tr_b16 a[228:229],v17 offset:24584
ds_read_b64_tr_b16 a[230:231],v17 offset:24840
ds_read_b64_tr_b16 a[232:233],v17 offset:26624
ds_read_b64_tr_b16 a[234:235],v17 offset:26880
ds_read_b64_tr_b16 a[236:237],v17 offset:26632
ds_read_b64_tr_b16 a[238:239],v17 offset:26888
s_waitcnt lgkmcnt(0)
ds_read_b64_tr_b16 a[240:241],v17 offset:28672
ds_read_b64_tr_b16 a[242:243],v17 offset:28928
ds_read_b64_tr_b16 a[244:245],v17 offset:28680
ds_read_b64_tr_b16 a[246:247],v17 offset:28936
ds_read_b64_tr_b16 a[248:249],v17 offset:30720
ds_read_b64_tr_b16 a[250:251],v17 offset:30976
ds_read_b64_tr_b16 a[252:253],v17 offset:30728
ds_read_b64_tr_b16 a[254:255],v17 offset:30984
s_waitcnt lgkmcnt(0)
s_mov_b32 s67,0
s_cmp_eq_u32 s56,1
s_cbranch_scc1 vok_107
v_mbcnt_lo_u32_b32 v16,-1,0
v_and_b32 v16,7,v16
v_lshlrev_b32 v16,7,v16
s_mov_b32 s64,138510336
vpoll_108:
buffer_load_dword v17,v16,s[20:23],s64 offen sc1
s_waitcnt vmcnt(0)
v_readlane_b32 s92,v17,0
v_readlane_b32 s93,v17,1
v_readlane_b32 s94,v17,2
v_readlane_b32 s95,v17,3
v_readlane_b32 s96,v17,4
v_readlane_b32 s97,v17,5
v_readlane_b32 s98,v17,6
v_readlane_b32 s99,v17,7
s_add_u32 s65,s92,s93
s_add_u32 s65,s65,s94
s_add_u32 s65,s65,s95
s_add_u32 s65,s65,s96
s_add_u32 s65,s65,s97
s_add_u32 s65,s65,s98
s_add_u32 s65,s65,s99
s_cmp_ge_u32 s65,256
s_cbranch_scc1 vgot_109
s_sleep 4
s_sub_u32 s90,s90,1
s_cmp_gt_i32 s90,0
s_cbranch_scc1 vpoll_108
vgot_109:
s_min_u32 s65,s92,s93
s_min_u32 s65,s65,s94
s_min_u32 s65,s65,s95
s_min_u32 s65,s65,s96
s_min_u32 s65,s65,s97
s_min_u32 s65,s65,s98
s_min_u32 s65,s65,s99
s_cmp_lt_u32 s65,32
s_cbranch_scc1 fl_slow
s_mov_b32 s56,0
vok_107:
s_barrier
v_lshlrev_b32 v0,4,v1
s_mov_b32 s60,0
s_mov_b32 s70,0
s_mov_b32 s55,0
s_lshl_b32 s63,s50,13
v_mov_b32 v3,v0
s_mov_b32 s73,0xffff0000
s_lshl_b32 s64,s52,2
s_add_u32 s64,s64,s50
s_mul_i32 s61,s64,8192
s_add_u32 s61,s61,214958080
s_lshl_b32 s82,s64,8
s_add_u32 s82,s82,138550272
s_mov_b32 s68,s82
s_lshl_b32 s83,s53,2
s_add_u32 s83,s83,s50
s_xor_b32 s64,s50,0
s_lshl_b32 s64,s64,13
v_add_u32 v8,s64,v0
s_xor_b32 s64,s50,1
s_lshl_b32 s64,s64,13
v_add_u32 v9,s64,v0
s_xor_b32 s64,s50,2
s_lshl_b32 s64,s64,13
v_add_u32 v10,s64,v0
s_xor_b32 s64,s50,3
s_lshl_b32 s64,s64,13
v_add_u32 v11,s64,v0
v_min_u32 v2,7,v1
v_lshlrev_b32 v2,2,v2
s_lshl_b32 s66,s83,10
s_mul_i32 s65,s83,147
s_lshr_b32 s65,s65,10
s_mul_i32 s69,s65,228
s_lshl_b32 s64,s83,2
s_add_u32 s69,s69,s64
s_add_u32 s69,s69,138551296
s_lshl_b32 s64,s50,9
s_add_u32 s64,s64,131072
v_lshlrev_b32 v26,3,v1
v_add_u32 v19,s64,v26
v_lshl_add_u32 v26,v23,4,v21
v_lshlrev_b32 v26,3,v26
v_add_u32 v20,131072,v26
s_mov_b32 s74,0x22222222
s_mov_b32 s75,0x22222222
s_mov_b32 s76,0x44444444
s_mov_b32 s77,0x44444444
s_mov_b32 s78,0x88888888
s_mov_b32 s79,0x88888888
s_mov_b32 s80,0xc0135761
s_mov_b32 s81,0xbdd2d3e8
v_mov_b32 v191,s80
v_mov_b32 v12,0x3f803f80
v_mov_b32 v13,0x3f803f80
v_mov_b32 v14,0x3f803f80
v_mov_b32 v15,0x3f803f80
s_nop 1
v_mfma_f32_16x16x32_bf16 v[152:155],a[0:3],v[12:15],0
v_mfma_f32_16x16x32_bf16 v[156:159],a[4:7],v[12:15],0
v_mfma_f32_16x16x32_bf16 v[152:155],a[8:11],v[12:15],v[152:155]
v_mfma_f32_16x16x32_bf16 v[156:159],a[12:15],v[12:15],v[156:159]
v_mfma_f32_16x16x32_bf16 v[152:155],a[16:19],v[12:15],v[152:155]
v_mfma_f32_16x16x32_bf16 v[156:159],a[20:23],v[12:15],v[156:159]
v_mfma_f32_16x16x32_bf16 v[152:155],a[24:27],v[12:15],v[152:155]
v_mfma_f32_16x16x32_bf16 v[156:159],a[28:31],v[12:15],v[156:159]
v_mfma_f32_16x16x32_bf16 v[152:155],a[32:35],v[12:15],v[152:155]
v_mfma_f32_16x16x32_bf16 v[156:159],a[36:39],v[12:15],v[156:159]
v_mfma_f32_16x16x32_bf16 v[152:155],a[40:43],v[12:15],v[152:155]
v_mfma_f32_16x16x32_bf16 v[156:159],a[44:47],v[12:15],v[156:159]
v_mfma_f32_16x16x32_bf16 v[152:155],a[48:51],v[12:15],v[152:155]
v_mfma_f32_16x16x32_bf16 v[156:159],a[52:55],v[12:15],v[156:159]
v_mfma_f32_16x16x32_bf16 v[152:155],a[56:59],v[12:15],v[152:155]
v_mfma_f32_16x16x32_bf16 v[156:159],a[60:63],v[12:15],v[156:159]
v_mfma_f32_16x16x32_bf16 v[152:155],a[64:67],v[12:15],v[152:155]
v_mfma_f32_16x16x32_bf16 v[156:159],a[68:71],v[12:15],v[156:159]
v_mfma_f32_16x16x32_bf16 v[152:155],a[72:75],v[12:15],v[152:155]
v_mfma_f32_16x16x32_bf16 v[156:159],a[76:79],v[12:15],v[156:159]
v_mfma_f32_16x16x32_bf16 v[152:155],a[80:83],v[12:15],v[152:155]
v_mfma_f32_16x16x32_bf16 v[156:159],a[84:87],v[12:15],v[156:159]
v_mfma_f32_16x16x32_bf16 v[152:155],a[88:91],v[12:15],v[152:155]
v_mfma_f32_16x16x32_bf16 v[156:159],a[92:95],v[12:15],v[156:159]
v_mfma_f32_16x16x32_bf16 v[152:155],a[96:99],v[12:15],v[152:155]
v_mfma_f32_16x16x32_bf16 v[156:159],a[100:103],v[12:15],v[156:159]
v_mfma_f32_16x16x32_bf16 v[152:155],a[104:107],v[12:15],v[152:155]
v_mfma_f32_16x16x32_bf16 v[156:159],a[108:111],v[12:15],v[156:159]
v_mfma_f32_16x16x32_bf16 v[152:155],a[112:115],v[12:15],v[152:155]
v_mfma_f32_16x16x32_bf16 v[156:159],a[116:119],v[12:15],v[156:159]
v_mfma_f32_16x16x32_bf16 v[152:155],a[120:123],v[12:15],v[152:155]
v_mfma_f32_16x16x32_bf16 v[156:159],a[124:127],v[12:15],v[156:159]
v_mfma_f32_16x16x32_bf16 v[152:155],a[128:131],v[12:15],v[152:155]
v_mfma_f32_16x16x32_bf16 v[156:159],a[132:135],v[12:15],v[156:159]
v_mfma_f32_16x16x32_bf16 v[152:155],a[136:139],v[12:15],v[152:155]
v_mfma_f32_16x16x32_bf16 v[156:159],a[140:143],v[12:15],v[156:159]
v_mfma_f32_16x16x32_bf16 v[152:155],a[144:147],v[12:15],v[152:155]
v_mfma_f32_16x16x32_bf16 v[156:159],a[148:151],v[12:15],v[156:159]
v_mfma_f32_16x16x32_bf16 v[152:155],a[152:155],v[12:15],v[152:155]
v_mfma_f32_16x16x32_bf16 v[156:159],a[156:159],v[12:15],v[156:159]
v_mfma_f32_16x16x32_bf16 v[152:155],a[160:163],v[12:15],v[152:155]
v_mfma_f32_16x16x32_bf16 v[156:159],a[164:167],v[12:15],v[156:159]
v_mfma_f32_16x16x32_bf16 v[152:155],a[168:171],v[12:15],v[152:155]
v_mfma_f32_16x16x32_bf16 v[156:159],a[172:175],v[12:15],v[156:159]
v_mfma_f32_16x16x32_bf16 v[152:155],a[176:179],v[12:15],v[152:155]
v_mfma_f32_16x16x32_bf16 v[156:159],a[180:183],v[12:15],v[156:159]
v_mfma_f32_16x16x32_bf16 v[152:155],a[184:187],v[12:15],v[152:155]
v_mfma_f32_16x16x32_bf16 v[156:159],a[188:191],v[12:15],v[156:159]
v_mfma_f32_16x16x32_bf16 v[152:155],a[192:195],v[12:15],v[152:155]
v_mfma_f32_16x16x32_bf16 v[156:159],a[196:199],v[12:15],v[156:159]
v_mfma_f32_16x16x32_bf16 v[152:155],a[200:203],v[12:15],v[152:155]
v_mfma_f32_16x16x32_bf16 v[156:159],a[204:207],v[12:15],v[156:159]
v_mfma_f32_16x16x32_bf16 v[152:155],a[208:211],v[12:15],v[152:155]
v_mfma_f32_16x16x32_bf16 v[156:159],a[212:215],v[12:15],v[156:159]
v_mfma_f32_16x16x32_bf16 v[152:155],a[216:219],v[12:15],v[152:155]
v_mfma_f32_16x16x32_bf16 v[156:159],a[220:223],v[12:15],v[156:159]
v_mfma_f32_16x16x32_bf16 v[152:155],a[224:227],v[12:15],v[152:155]
v_mfma_f32_16x16x32_bf16 v[156:159],a[228:231],v[12:15],v[156:159]
v_mfma_f32_16x16x32_bf16 v[152:155],a[232:235],v[12:15],v[152:155]
v_mfma_f32_16x16x32_bf16 v[156:159],a[236:239],v[12:15],v[156:159]
v_mfma_f32_16x16x32_bf16 v[152:155],a[240:243],v[12:15],v[152:155]
v_mfma_f32_16x16x32_bf16 v[156:159],a[244:247],v[12:15],v[156:159]
v_mfma_f32_16x16x32_bf16 v[152:155],a[248:251],v[12:15],v[152:155]
v_mfma_f32_16x16x32_bf16 v[156:159],a[252:255],v[12:15],v[156:159]
s_add_u32 s71,s60,1
plp_117:
buffer_load_dword v16,v2,s[20:23],s68 offen sc1
s_waitcnt vmcnt(0)
v_cmp_gt_u32 vcc,s71,v16
s_cbranch_vccz pok_118
s_sleep 4
s_sub_u32 s90,s90,1
s_cmp_gt_i32 s90,0
s_cbranch_scc1 plp_117
pok_118:
lag_116:
s_add_u32 m0,s70,s63
s_add_u32 s62,s61,4096
buffer_load_dwordx4 v3,s[20:23],s61 offen offset:0 lds
buffer_load_dwordx4 v3,s[20:23],s61 offen offset:1024 lds
buffer_load_dwordx4 v3,s[20:23],s61 offen offset:2048 lds
buffer_load_dwordx4 v3,s[20:23],s61 offen offset:3072 lds
s_add_u32 m0,m0,4096
s_nop 0
buffer_load_dwordx4 v3,s[20:23],s62 offen offset:0 lds
buffer_load_dwordx4 v3,s[20:23],s62 offen offset:1024 lds
buffer_load_dwordx4 v3,s[20:23],s62 offen offset:2048 lds
buffer_load_dwordx4 v3,s[20:23],s62 offen offset:3072 lds
s_add_u32 s61,s61,32768
s_add_u32 s70,s70,32768
s_and_b32 s70,s70,0x1ffff
buffer_load_dword v17,off,s[20:23],s69
top_112:
s_add_u32 s71,s60,2
buffer_load_dword v16,v2,s[20:23],s68 offen sc1
v_add_u32 v4,s55,v8
v_add_u32 v5,s55,v9
v_add_u32 v6,s55,v10
v_add_u32 v7,s55,v11
s_add_u32 s55,s55,32768
s_and_b32 s55,s55,0x1ffff
s_waitcnt vmcnt(9)
ds_read_b128 v[64:67],v4 offset:0
s_waitcnt vmcnt(8)
ds_read_b128 v[68:71],v4 offset:1024
s_waitcnt vmcnt(7)
ds_read_b128 v[72:75],v4 offset:2048
s_waitcnt lgkmcnt(2)
v_mfma_f32_16x16x32_bf16 v[32:35],a[0:3],v[64:67],0
v_mfma_f32_16x16x32_bf16 v[36:39],a[4:7],v[64:67],0
v_mfma_f32_16x16x32_bf16 v[48:51],v[12:15],v[64:67],0
v_mfma_f32_16x16x32_bf16 v[52:55],v[64:67],v[64:67],0
s_waitcnt vmcnt(6)
ds_read_b128 v[76:79],v4 offset:3072
s_waitcnt lgkmcnt(2)
v_mfma_f32_16x16x32_bf16 v[32:35],a[8:11],v[68:71],v[32:35]
v_mfma_f32_16x16x32_bf16 v[36:39],a[12:15],v[68:71],v[36:39]
v_mfma_f32_16x16x32_bf16 v[48:51],v[12:15],v[68:71],v[48:51]
v_mfma_f32_16x16x32_bf16 v[52:55],v[68:71],v[68:71],v[52:55]
s_waitcnt vmcnt(5)
ds_read_b128 v[80:83],v4 offset:4096
s_waitcnt lgkmcnt(2)
v_mfma_f32_16x16x32_bf16 v[32:35],a[16:19],v[72:75],v[32:35]
v_mfma_f32_16x16x32_bf16 v[36:39],a[20:23],v[72:75],v[36:39]
v_mfma_f32_16x16x32_bf16 v[48:51],v[12:15],v[72:75],v[48:51]
v_mfma_f32_16x16x32_bf16 v[52:55],v[72:75],v[72:75],v[52:55]
s_waitcnt vmcnt(4)
ds_read_b128 v[84:87],v4 offset:5120
s_waitcnt lgkmcnt(2)
v_mfma_f32_16x16x32_bf16 v[32:35],a[24:27],v[76:79],v[32:35]
v_mfma_f32_16x16x32_bf16 v[36:39],a[28:31],v[76:79],v[36:39]
v_mfma_f32_16x16x32_bf16 v[48:51],v[12:15],v[76:79],v[48:51]
v_mfma_f32_16x16x32_bf16 v[52:55],v[76:79],v[76:79],v[52:55]
s_waitcnt vmcnt(3)
ds_read_b128 v[88:91],v4 offset:6144
s_waitcnt lgkmcnt(2)
v_mfma_f32_16x16x32_bf16 v[32:35],a[32:35],v[80:83],v[32:35]
v_mfma_f32_16x16x32_bf16 v[36:39],a[36:39],v[80:83],v[36:39]
v_mfma_f32_16x16x32_bf16 v[48:51],v[12:15],v[80:83],v[48:51]
v_mfma_f32_16x16x32_bf16 v[52:55],v[80:83],v[80:83],v[52:55]
s_waitcnt vmcnt(2)
ds_read_b128 v[92:95],v4 offset:7168
s_barrier
s_waitcnt lgkmcnt(2)
v_mfma_f32_16x16x32_bf16 v[32:35],a[40:43],v[84:87],v[32:35]
v_mfma_f32_16x16x32_bf16 v[36:39],a[44:47],v[84:87],v[36:39]
v_mfma_f32_16x16x32_bf16 v[48:51],v[12:15],v[84:87],v[48:51]
v_mfma_f32_16x16x32_bf16 v[52:55],v[84:87],v[84:87],v[52:55]
ds_read_b128 v[96:99],v5 offset:0
s_waitcnt lgkmcnt(2)
v_mfma_f32_16x16x32_bf16 v[32:35],a[48:51],v[88:91],v[32:35]
ds_read_b128 v[100:103],v5 offset:1024
ds_read_b128 v[104:107],v5 offset:2048
v_mfma_f32_16x16x32_bf16 v[36:39],a[52:55],v[88:91],v[36:39]
v_mfma_f32_16x16x32_bf16 v[48:51],v[12:15],v[88:91],v[48:51]
v_mfma_f32_16x16x32_bf16 v[52:55],v[88:91],v[88:91],v[52:55]
s_waitcnt lgkmcnt(3)
v_mfma_f32_16x16x32_bf16 v[32:35],a[56:59],v[92:95],v[32:35]
ds_read_b128 v[108:111],v5 offset:3072
ds_read_b128 v[112:115],v5 offset:4096
v_mfma_f32_16x16x32_bf16 v[36:39],a[60:63],v[92:95],v[36:39]
v_mfma_f32_16x16x32_bf16 v[48:51],v[12:15],v[92:95],v[48:51]
v_mfma_f32_16x16x32_bf16 v[52:55],v[92:95],v[92:95],v[52:55]
s_waitcnt lgkmcnt(4)
v_mfma_f32_16x16x32_bf16 v[32:35],a[64:67],v[96:99],v[32:35]
ds_read_b128 v[116:119],v5 offset:5120
ds_read_b128 v[120:123],v5 offset:6144
v_mfma_f32_16x16x32_bf16 v[36:39],a[68:71],v[96:99],v[36:39]
s_waitcnt lgkmcnt(5)
v_mfma_f32_16x16x32_bf16 v[32:35],a[72:75],v[100:103],v[32:35]
ds_read_b128 v[124:127],v5 offset:7168
v_mfma_f32_16x16x32_bf16 v[36:39],a[76:79],v[100:103],v[36:39]
s_waitcnt lgkmcnt(5)
v_mfma_f32_16x16x32_bf16 v[32:35],a[80:83],v[104:107],v[32:35]
ds_read_b128 v[64:67],v6 offset:0
v_mfma_f32_16x16x32_bf16 v[36:39],a[84:87],v[104:107],v[36:39]
s_waitcnt lgkmcnt(5)
v_mfma_f32_16x16x32_bf16 v[32:35],a[88:91],v[108:111],v[32:35]
ds_read_b128 v[68:71],v6 offset:1024
v_cndmask_b32 v49,v52,v53,s[74:75]
v_mfma_f32_16x16x32_bf16 v[36:39],a[92:95],v[108:111],v[36:39]
v_cndmask_b32 v49,v49,v54,s[76:77]
s_waitcnt lgkmcnt(5)
v_mfma_f32_16x16x32_bf16 v[32:35],a[96:99],v[112:115],v[32:35]
ds_read_b128 v[72:75],v6 offset:2048
v_cndmask_b32 v49,v49,v55,s[78:79]
v_mfma_f32_16x16x32_bf16 v[36:39],a[100:103],v[112:115],v[36:39]
ds_write_b64 v19,v[48:49]
s_waitcnt lgkmcnt(6)
v_mfma_f32_16x16x32_bf16 v[32:35],a[104:107],v[116:119],v[32:35]
ds_read_b128 v[76:79],v6 offset:3072
v_mfma_f32_16x16x32_bf16 v[36:39],a[108:111],v[116:119],v[36:39]
s_waitcnt lgkmcnt(6)
v_mfma_f32_16x16x32_bf16 v[32:35],a[112:115],v[120:123],v[32:35]
ds_read_b128 v[80:83],v6 offset:4096
v_mfma_f32_16x16x32_bf16 v[36:39],a[116:119],v[120:123],v[36:39]
s_waitcnt lgkmcnt(6)
v_mfma_f32_16x16x32_bf16 v[32:35],a[120:123],v[124:127],v[32:35]
ds_read_b128 v[84:87],v6 offset:5120
v_mfma_f32_16x16x32_bf16 v[36:39],a[124:127],v[124:127],v[36:39]
s_waitcnt lgkmcnt(6)
v_mfma_f32_16x16x32_bf16 v[32:35],a[128:131],v[64:67],v[32:35]
ds_read_b128 v[88:91],v6 offset:6144
v_mfma_f32_16x16x32_bf16 v[36:39],a[132:135],v[64:67],v[36:39]
s_waitcnt lgkmcnt(4)
s_barrier
ds_read_b64 v[56:57],v20 offset:0
ds_read_b64 v[58:59],v20 offset:512
v_mfma_f32_16x16x32_bf16 v[32:35],a[136:139],v[68:71],v[32:35]
ds_read_b128 v[92:95],v6 offset:7168
ds_read_b64 v[60:61],v20 offset:1024
ds_read_b64 v[62:63],v20 offset:1536
v_mfma_f32_16x16x32_bf16 v[36:39],a[140:143],v[68:71],v[36:39]
v_mfma_f32_16x16x32_bf16 v[32:35],a[144:147],v[72:75],v[32:35]
ds_read_b128 v[96:99],v7 offset:0
v_mfma_f32_16x16x32_bf16 v[36:39],a[148:151],v[72:75],v[36:39]
s_waitcnt lgkmcnt(9)
v_mfma_f32_16x16x32_bf16 v[32:35],a[152:155],v[76:79],v[32:35]
ds_read_b128 v[100:103],v7 offset:1024
v_mfma_f32_16x16x32_bf16 v[36:39],a[156:159],v[76:79],v[36:39]
s_waitcnt lgkmcnt(9)
v_mfma_f32_16x16x32_bf16 v[32:35],a[160:163],v[80:83],v[32:35]
ds_read_b128 v[104:107],v7 offset:2048
v_mfma_f32_16x16x32_bf16 v[36:39],a[164:167],v[80:83],v[36:39]
s_waitcnt lgkmcnt(9)
v_mfma_f32_16x16x32_bf16 v[32:35],a[168:171],v[84:87],v[32:35]
ds_read_b128 v[108:111],v7 offset:3072
s_waitcnt lgkmcnt(4)
v_mfma_f32_16x16x32_bf16 v[36:39],a[172:175],v[84:87],v[36:39]
v_add_f32 v56,v56,v58
s_waitcnt vmcnt(0)
v_mov_b32 v17,s60
s_mov_b64 exec,1
buffer_store_dword v17,off,s[20:23],s69 sc1
s_mov_b64 exec,-1
v_cmp_gt_u32 vcc,s71,v16
s_cbranch_vccnz vN_113
v_mfma_f32_16x16x32_bf16 v[32:35],a[176:179],v[88:91],v[32:35]
ds_read_b128 v[112:115],v7 offset:4096
v_add_f32 v57,v57,v59
s_add_u32 m0,s70,s63
v_mfma_f32_16x16x32_bf16 v[36:39],a[180:183],v[88:91],v[36:39]
v_add_f32 v60,v60,v62
s_add_u32 s62,s61,4096
v_mfma_f32_16x16x32_bf16 v[32:35],a[184:187],v[92:95],v[32:35]
ds_read_b128 v[116:119],v7 offset:5120
v_add_f32 v61,v61,v63
buffer_load_dwordx4 v3,s[20:23],s61 offen offset:0 lds
v_mfma_f32_16x16x32_bf16 v[36:39],a[188:191],v[92:95],v[36:39]
v_add_f32 v56,v56,v60
buffer_load_dwordx4 v3,s[20:23],s61 offen offset:1024 lds
s_waitcnt lgkmcnt(5)
v_mfma_f32_16x16x32_bf16 v[32:35],a[192:195],v[96:99],v[32:35]
ds_read_b128 v[120:123],v7 offset:6144
v_add_f32 v57,v57,v61
buffer_load_dwordx4 v3,s[20:23],s61 offen offset:2048 lds
v_mfma_f32_16x16x32_bf16 v[36:39],a[196:199],v[96:99],v[36:39]
v_mul_f32 v189,0xba800000,v56
buffer_load_dwordx4 v3,s[20:23],s61 offen offset:3072 lds
s_waitcnt lgkmcnt(5)
v_mfma_f32_16x16x32_bf16 v[32:35],a[200:203],v[100:103],v[32:35]
ds_read_b128 v[124:127],v7 offset:7168
v_mul_f32 v58,v189,v189
s_add_u32 m0,m0,4096
v_mfma_f32_16x16x32_bf16 v[36:39],a[204:207],v[100:103],v[36:39]
v_mul_f32 v57,0x3a800000,v57
buffer_load_dwordx4 v3,s[20:23],s62 offen offset:0 lds
s_waitcnt lgkmcnt(5)
v_mfma_f32_16x16x32_bf16 v[32:35],a[208:211],v[104:107],v[32:35]
v_sub_f32 v57,v57,v58
buffer_load_dwordx4 v3,s[20:23],s62 offen offset:1024 lds
v_mfma_f32_16x16x32_bf16 v[36:39],a[212:215],v[104:107],v[36:39]
v_max_f32 v57,0,v57
buffer_load_dwordx4 v3,s[20:23],s62 offen offset:2048 lds
s_waitcnt lgkmcnt(4)
v_mfma_f32_16x16x32_bf16 v[32:35],a[216:219],v[108:111],v[32:35]
v_add_f32 v57,0x3727c5ac,v57
buffer_load_dwordx4 v3,s[20:23],s62 offen offset:3072 lds
v_mfma_f32_16x16x32_bf16 v[36:39],a[220:223],v[108:111],v[36:39]
v_rsq_f32 v190,v57
s_add_u32 s61,s61,32768
s_waitcnt lgkmcnt(3)
v_mfma_f32_16x16x32_bf16 v[32:35],a[224:227],v[112:115],v[32:35]
s_add_u32 s70,s70,32768
v_mfma_f32_16x16x32_bf16 v[36:39],a[228:231],v[112:115],v[36:39]
s_and_b32 s70,s70,0x1ffff
s_waitcnt lgkmcnt(2)
v_mfma_f32_16x16x32_bf16 v[32:35],a[232:235],v[116:119],v[32:35]
v_mfma_f32_16x16x32_bf16 v[36:39],a[236:239],v[116:119],v[36:39]
s_waitcnt lgkmcnt(1)
v_mfma_f32_16x16x32_bf16 v[32:35],a[240:243],v[120:123],v[32:35]
v_mfma_f32_16x16x32_bf16 v[36:39],a[244:247],v[120:123],v[36:39]
s_waitcnt lgkmcnt(0)
v_mfma_f32_16x16x32_bf16 v[32:35],a[248:251],v[124:127],v[32:35]
v_mfma_f32_16x16x32_bf16 v[36:39],a[252:255],v[124:127],v[36:39]
s_mov_b32 s72,1
join_114:
s_nop 5
v_fma_f32 v32,v152,v189,v32
v_fma_f32 v33,v153,v189,v33
v_fma_f32 v34,v154,v189,v34
v_fma_f32 v35,v155,v189,v35
v_fma_f32 v36,v156,v189,v36
v_fma_f32 v37,v157,v189,v37
v_fma_f32 v38,v158,v189,v38
v_fma_f32 v39,v159,v189,v39
v_mul_f32 v32,v32,v190
v_mul_f32 v33,v33,v190
v_mul_f32 v34,v34,v190
v_mul_f32 v35,v35,v190
v_mul_f32 v36,v36,v190
v_mul_f32 v37,v37,v190
v_mul_f32 v38,v38,v190
v_mul_f32 v39,v39,v190
v_mul_f32 v168,v32,v32
v_mul_f32 v169,v33,v33
v_mul_f32 v170,v34,v34
v_mul_f32 v171,v35,v35
v_mul_f32 v172,v36,v36
v_mul_f32 v173,v37,v37
v_mul_f32 v174,v38,v38
v_mul_f32 v175,v39,v39
v_fma_f32 v168,v168,s81,v191
v_fma_f32 v169,v169,s81,v191
v_fma_f32 v170,v170,s81,v191
v_fma_f32 v171,v171,s81,v191
v_fma_f32 v172,v172,s81,v191
v_fma_f32 v173,v173,s81,v191
v_fma_f32 v174,v174,s81,v191
v_fma_f32 v175,v175,s81,v191
v_mul_f32 v168,v168,v32
v_mul_f32 v169,v169,v33
v_mul_f32 v170,v170,v34
v_mul_f32 v171,v171,v35
v_mul_f32 v172,v172,v36
v_mul_f32 v173,v173,v37
v_mul_f32 v174,v174,v38
v_mul_f32 v175,v175,v39
v_exp_f32 v168,v168
v_exp_f32 v169,v169
v_exp_f32 v170,v170
v_exp_f32 v171,v171
v_exp_f32 v172,v172
v_exp_f32 v173,v173
v_exp_f32 v174,v174
v_exp_f32 v175,v175
v_add_f32 v168,1.0,v168
v_add_f32 v169,1.0,v169
v_add_f32 v170,1.0,v170
v_add_f32 v171,1.0,v171
v_add_f32 v172,1.0,v172
v_add_f32 v173,1.0,v173
v_add_f32 v174,1.0,v174
v_add_f32 v175,1.0,v175
v_rcp_f32 v168,v168
v_rcp_f32 v169,v169
v_rcp_f32 v170,v170
v_rcp_f32 v171,v171
v_rcp_f32 v172,v172
v_rcp_f32 v173,v173
v_rcp_f32 v174,v174
v_rcp_f32 v175,v175
v_mul_f32 v32,v168,v32
v_mul_f32 v33,v169,v33
v_mul_f32 v34,v170,v34
v_mul_f32 v35,v171,v35
v_mul_f32 v36,v172,v36
v_mul_f32 v37,v173,v37
v_mul_f32 v38,v174,v38
v_mul_f32 v39,v175,v39
v_cvt_pk_bf16_f32 v176,v32,v33
v_cvt_pk_bf16_f32 v177,v34,v35
v_cvt_pk_bf16_f32 v178,v36,v37
v_cvt_pk_bf16_f32 v179,v38,v39
s_add_u32 s64,s66,219152384
buffer_store_dwordx4 v[176:179],v0,s[20:23],s64 offen sc1
s_add_u32 s66,s66,114688
s_add_u32 s60,s60,1
s_cmp_eq_u32 s72,0
s_cbranch_scc1 slowp_115
s_branch top_112
slowp_115:
s_waitcnt vmcnt(1)
v_cmp_gt_u32 vcc,s71,v16
s_cbranch_vccz lag_116
s_waitcnt vmcnt(0)
v_mov_b32 v17,s60
s_mov_b64 exec,1
buffer_store_dword v17,off,s[20:23],s69 sc1
s_mov_b64 exec,-1
s_cmp_ge_u32 s60,128
s_cbranch_scc1 done_106
plp_119:
buffer_load_dword v16,v2,s[20:23],s68 offen sc1
s_waitcnt vmcnt(0)
v_cmp_gt_u32 vcc,s71,v16
s_cbranch_vccz pok_120
s_sleep 4
s_sub_u32 s90,s90,1
s_cmp_gt_i32 s90,0
s_cbranch_scc1 plp_119
pok_120:
s_branch lag_116
vN_113:
buffer_load_dword v16,v2,s[20:23],s68 offen sc1
v_mfma_f32_16x16x32_bf16 v[32:35],a[176:179],v[88:91],v[32:35]
ds_read_b128 v[112:115],v7 offset:4096
v_add_f32 v57,v57,v59
v_mfma_f32_16x16x32_bf16 v[36:39],a[180:183],v[88:91],v[36:39]
v_add_f32 v60,v60,v62
v_mfma_f32_16x16x32_bf16 v[32:35],a[184:187],v[92:95],v[32:35]
ds_read_b128 v[116:119],v7 offset:5120
v_add_f32 v61,v61,v63
v_mfma_f32_16x16x32_bf16 v[36:39],a[188:191],v[92:95],v[36:39]
v_add_f32 v56,v56,v60
s_waitcnt lgkmcnt(5)
v_mfma_f32_16x16x32_bf16 v[32:35],a[192:195],v[96:99],v[32:35]
ds_read_b128 v[120:123],v7 offset:6144
v_add_f32 v57,v57,v61
v_mfma_f32_16x16x32_bf16 v[36:39],a[196:199],v[96:99],v[36:39]
v_mul_f32 v189,0xba800000,v56
s_waitcnt lgkmcnt(5)
v_mfma_f32_16x16x32_bf16 v[32:35],a[200:203],v[100:103],v[32:35]
ds_read_b128 v[124:127],v7 offset:7168
v_mul_f32 v58,v189,v189
v_mfma_f32_16x16x32_bf16 v[36:39],a[204:207],v[100:103],v[36:39]
v_mul_f32 v57,0x3a800000,v57
s_waitcnt lgkmcnt(5)
v_mfma_f32_16x16x32_bf16 v[32:35],a[208:211],v[104:107],v[32:35]
v_sub_f32 v57,v57,v58
v_mfma_f32_16x16x32_bf16 v[36:39],a[212:215],v[104:107],v[36:39]
v_max_f32 v57,0,v57
s_waitcnt lgkmcnt(4)
v_mfma_f32_16x16x32_bf16 v[32:35],a[216:219],v[108:111],v[32:35]
v_add_f32 v57,0x3727c5ac,v57
v_mfma_f32_16x16x32_bf16 v[36:39],a[220:223],v[108:111],v[36:39]
v_rsq_f32 v190,v57
s_waitcnt lgkmcnt(3)
v_mfma_f32_16x16x32_bf16 v[32:35],a[224:227],v[112:115],v[32:35]
v_mfma_f32_16x16x32_bf16 v[36:39],a[228:231],v[112:115],v[36:39]
s_waitcnt lgkmcnt(2)
v_mfma_f32_16x16x32_bf16 v[32:35],a[232:235],v[116:119],v[32:35]
v_mfma_f32_16x16x32_bf16 v[36:39],a[236:239],v[116:119],v[36:39]
s_waitcnt lgkmcnt(1)
v_mfma_f32_16x16x32_bf16 v[32:35],a[240:243],v[120:123],v[32:35]
v_mfma_f32_16x16x32_bf16 v[36:39],a[244:247],v[120:123],v[36:39]
s_waitcnt lgkmcnt(0)
v_mfma_f32_16x16x32_bf16 v[32:35],a[248:251],v[124:127],v[32:35]
v_mfma_f32_16x16x32_bf16 v[36:39],a[252:255],v[124:127],v[36:39]
s_mov_b32 s72,0
s_branch join_114
done_106:
s_endpgm
fl_w1:
v_and_b32 v21,15,v1
v_lshrrev_b32 v22,4,v1
v_lshrrev_b32 v23,2,v21
v_and_b32 v24,3,v21
s_lshl_b32 s61,s50,15
v_lshl_add_u32 v25,v22,3,v23
s_load_dwordx2 s[4:5],s[0:1],64
s_mov_b32 s52,0
s_mov_b32 s53,s59
s_mul_i32 s54,s52,2097152
s_lshl_b32 s64,s53,8
s_add_u32 s54,s54,s64
s_lshl_b32 s64,s50,6
s_add_u32 s54,s54,s64
s_waitcnt lgkmcnt(0)
s_mov_b32 s28,s4
s_and_b32 s29,s5,0xffff
s_mov_b32 s30,0x200000
s_mov_b32 s31,0x20000
v_lshrrev_b32 v26,2,v1
v_and_b32 v27,3,v1
v_mul_u32_u24 v16,2048,v26
v_lshl_add_u32 v16,v27,4,v16
v_lshlrev_b32 v17,6,v25
v_lshl_add_u32 v17,v24,4,v17
v_add_u32 v17,s61,v17
s_xor_b32 s62,s50,0
s_mul_i32 s62,s62,524288
s_add_u32 s62,s62,s54
s_add_u32 m0,s61,0
s_nop 0
buffer_load_dwordx4 v16,s[28:31],s62 offen lds
s_add_u32 s62,s62,32768
s_add_u32 m0,m0,1024
s_nop 0
buffer_load_dwordx4 v16,s[28:31],s62 offen lds
s_add_u32 s62,s62,32768
s_add_u32 m0,m0,1024
s_nop 0
buffer_load_dwordx4 v16,s[28:31],s62 offen lds
s_add_u32 s62,s62,32768
s_add_u32 m0,m0,1024
s_nop 0
buffer_load_dwordx4 v16,s[28:31],s62 offen lds
s_add_u32 s62,s62,32768
s_add_u32 m0,m0,1024
s_nop 0
buffer_load_dwordx4 v16,s[28:31],s62 offen lds
s_add_u32 s62,s62,32768
s_add_u32 m0,m0,1024
s_nop 0
buffer_load_dwordx4 v16,s[28:31],s62 offen lds
s_add_u32 s62,s62,32768
s_add_u32 m0,m0,1024
s_nop 0
buffer_load_dwordx4 v16,s[28:31],s62 offen lds
s_add_u32 s62,s62,32768
s_add_u32 m0,m0,1024
s_nop 0
buffer_load_dwordx4 v16,s[28:31],s62 offen lds
s_add_u32 s62,s62,32768
s_add_u32 m0,m0,1024
s_nop 0
buffer_load_dwordx4 v16,s[28:31],s62 offen lds
s_add_u32 s62,s62,32768
s_add_u32 m0,m0,1024
s_nop 0
buffer_load_dwordx4 v16,s[28:31],s62 offen lds
s_add_u32 s62,s62,32768
s_add_u32 m0,m0,1024
s_nop 0
buffer_load_dwordx4 v16,s[28:31],s62 offen lds
s_add_u32 s62,s62,32768
s_add_u32 m0,m0,1024
s_nop 0
buffer_load_dwordx4 v16,s[28:31],s62 offen lds
s_add_u32 s62,s62,32768
s_add_u32 m0,m0,1024
s_nop 0
buffer_load_dwordx4 v16,s[28:31],s62 offen lds
s_add_u32 s62,s62,32768
s_add_u32 m0,m0,1024
s_nop 0
buffer_load_dwordx4 v16,s[28:31],s62 offen lds
s_add_u32 s62,s62,32768
s_add_u32 m0,m0,1024
s_nop 0
buffer_load_dwordx4 v16,s[28:31],s62 offen lds
s_add_u32 s62,s62,32768
s_add_u32 m0,m0,1024
s_nop 0
buffer_load_dwordx4 v16,s[28:31],s62 offen lds
s_xor_b32 s62,s50,1
s_mul_i32 s62,s62,524288
s_add_u32 s62,s62,s54
s_add_u32 m0,s61,16384
s_nop 0
buffer_load_dwordx4 v16,s[28:31],s62 offen lds
s_add_u32 s62,s62,32768
s_add_u32 m0,m0,1024
s_nop 0
buffer_load_dwordx4 v16,s[28:31],s62 offen lds
s_add_u32 s62,s62,32768
s_add_u32 m0,m0,1024
s_nop 0
buffer_load_dwordx4 v16,s[28:31],s62 offen lds
s_add_u32 s62,s62,32768
s_add_u32 m0,m0,1024
s_nop 0
buffer_load_dwordx4 v16,s[28:31],s62 offen lds
s_add_u32 s62,s62,32768
s_add_u32 m0,m0,1024
s_nop 0
buffer_load_dwordx4 v16,s[28:31],s62 offen lds
s_add_u32 s62,s62,32768
s_add_u32 m0,m0,1024
s_nop 0
buffer_load_dwordx4 v16,s[28:31],s62 offen lds
s_add_u32 s62,s62,32768
s_add_u32 m0,m0,1024
s_nop 0
buffer_load_dwordx4 v16,s[28:31],s62 offen lds
s_add_u32 s62,s62,32768
s_add_u32 m0,m0,1024
s_nop 0
buffer_load_dwordx4 v16,s[28:31],s62 offen lds
s_add_u32 s62,s62,32768
s_add_u32 m0,m0,1024
s_nop 0
buffer_load_dwordx4 v16,s[28:31],s62 offen lds
s_add_u32 s62,s62,32768
s_add_u32 m0,m0,1024
s_nop 0
buffer_load_dwordx4 v16,s[28:31],s62 offen lds
s_add_u32 s62,s62,32768
s_add_u32 m0,m0,1024
s_nop 0
buffer_load_dwordx4 v16,s[28:31],s62 offen lds
s_add_u32 s62,s62,32768
s_add_u32 m0,m0,1024
s_nop 0
buffer_load_dwordx4 v16,s[28:31],s62 offen lds
s_add_u32 s62,s62,32768
s_add_u32 m0,m0,1024
s_nop 0
buffer_load_dwordx4 v16,s[28:31],s62 offen lds
s_add_u32 s62,s62,32768
s_add_u32 m0,m0,1024
s_nop 0
buffer_load_dwordx4 v16,s[28:31],s62 offen lds
s_add_u32 s62,s62,32768
s_add_u32 m0,m0,1024
s_nop 0
buffer_load_dwordx4 v16,s[28:31],s62 offen lds
s_add_u32 s62,s62,32768
s_add_u32 m0,m0,1024
s_nop 0
buffer_load_dwordx4 v16,s[28:31],s62 offen lds
s_waitcnt vmcnt(16)
ds_read_b64_tr_b16 a[0:1],v17 offset:0
ds_read_b64_tr_b16 a[2:3],v17 offset:256
ds_read_b64_tr_b16 a[4:5],v17 offset:8
ds_read_b64_tr_b16 a[6:7],v17 offset:264
ds_read_b64_tr_b16 a[8:9],v17 offset:2048
ds_read_b64_tr_b16 a[10:11],v17 offset:2304
ds_read_b64_tr_b16 a[12:13],v17 offset:2056
ds_read_b64_tr_b16 a[14:15],v17 offset:2312
ds_read_b64_tr_b16 a[16:17],v17 offset:4096
ds_read_b64_tr_b16 a[18:19],v17 offset:4352
ds_read_b64_tr_b16 a[20:21],v17 offset:4104
ds_read_b64_tr_b16 a[22:23],v17 offset:4360
s_waitcnt lgkmcnt(0)
ds_read_b64_tr_b16 a[24:25],v17 offset:6144
ds_read_b64_tr_b16 a[26:27],v17 offset:6400
ds_read_b64_tr_b16 a[28:29],v17 offset:6152
ds_read_b64_tr_b16 a[30:31],v17 offset:6408
ds_read_b64_tr_b16 a[32:33],v17 offset:8192
ds_read_b64_tr_b16 a[34:35],v17 offset:8448
ds_read_b64_tr_b16 a[36:37],v17 offset:8200
ds_read_b64_tr_b16 a[38:39],v17 offset:8456
ds_read_b64_tr_b16 a[40:41],v17 offset:10240
ds_read_b64_tr_b16 a[42:43],v17 offset:10496
ds_read_b64_tr_b16 a[44:45],v17 offset:10248
ds_read_b64_tr_b16 a[46:47],v17 offset:10504
s_waitcnt lgkmcnt(0)
ds_read_b64_tr_b16 a[48:49],v17 offset:12288
ds_read_b64_tr_b16 a[50:51],v17 offset:12544
ds_read_b64_tr_b16 a[52:53],v17 offset:12296
ds_read_b64_tr_b16 a[54:55],v17 offset:12552
ds_read_b64_tr_b16 a[56:57],v17 offset:14336
ds_read_b64_tr_b16 a[58:59],v17 offset:14592
ds_read_b64_tr_b16 a[60:61],v17 offset:14344
ds_read_b64_tr_b16 a[62:63],v17 offset:14600
s_waitcnt lgkmcnt(0)
s_xor_b32 s62,s50,2
s_mul_i32 s62,s62,524288
s_add_u32 s62,s62,s54
s_add_u32 m0,s61,0
s_nop 0
buffer_load_dwordx4 v16,s[28:31],s62 offen lds
s_add_u32 s62,s62,32768
s_add_u32 m0,m0,1024
s_nop 0
buffer_load_dwordx4 v16,s[28:31],s62 offen lds
s_add_u32 s62,s62,32768
s_add_u32 m0,m0,1024
s_nop 0
buffer_load_dwordx4 v16,s[28:31],s62 offen lds
s_add_u32 s62,s62,32768
s_add_u32 m0,m0,1024
s_nop 0
buffer_load_dwordx4 v16,s[28:31],s62 offen lds
s_add_u32 s62,s62,32768
s_add_u32 m0,m0,1024
s_nop 0
buffer_load_dwordx4 v16,s[28:31],s62 offen lds
s_add_u32 s62,s62,32768
s_add_u32 m0,m0,1024
s_nop 0
buffer_load_dwordx4 v16,s[28:31],s62 offen lds
s_add_u32 s62,s62,32768
s_add_u32 m0,m0,1024
s_nop 0
buffer_load_dwordx4 v16,s[28:31],s62 offen lds
s_add_u32 s62,s62,32768
s_add_u32 m0,m0,1024
s_nop 0
buffer_load_dwordx4 v16,s[28:31],s62 offen lds
s_add_u32 s62,s62,32768
s_add_u32 m0,m0,1024
s_nop 0
buffer_load_dwordx4 v16,s[28:31],s62 offen lds
s_add_u32 s62,s62,32768
s_add_u32 m0,m0,1024
s_nop 0
buffer_load_dwordx4 v16,s[28:31],s62 offen lds
s_add_u32 s62,s62,32768
s_add_u32 m0,m0,1024
s_nop 0
buffer_load_dwordx4 v16,s[28:31],s62 offen lds
s_add_u32 s62,s62,32768
s_add_u32 m0,m0,1024
s_nop 0
buffer_load_dwordx4 v16,s[28:31],s62 offen lds
s_add_u32 s62,s62,32768
s_add_u32 m0,m0,1024
s_nop 0
buffer_load_dwordx4 v16,s[28:31],s62 offen lds
s_add_u32 s62,s62,32768
s_add_u32 m0,m0,1024
s_nop 0
buffer_load_dwordx4 v16,s[28:31],s62 offen lds
s_add_u32 s62,s62,32768
s_add_u32 m0,m0,1024
s_nop 0
buffer_load_dwordx4 v16,s[28:31],s62 offen lds
s_add_u32 s62,s62,32768
s_add_u32 m0,m0,1024
s_nop 0
buffer_load_dwordx4 v16,s[28:31],s62 offen lds
s_waitcnt vmcnt(16)
ds_read_b64_tr_b16 a[64:65],v17 offset:16384
ds_read_b64_tr_b16 a[66:67],v17 offset:16640
ds_read_b64_tr_b16 a[68:69],v17 offset:16392
ds_read_b64_tr_b16 a[70:71],v17 offset:16648
ds_read_b64_tr_b16 a[72:73],v17 offset:18432
ds_read_b64_tr_b16 a[74:75],v17 offset:18688
ds_read_b64_tr_b16 a[76:77],v17 offset:18440
ds_read_b64_tr_b16 a[78:79],v17 offset:18696
ds_read_b64_tr_b16 a[80:81],v17 offset:20480
ds_read_b64_tr_b16 a[82:83],v17 offset:20736
ds_read_b64_tr_b16 a[84:85],v17 offset:20488
ds_read_b64_tr_b16 a[86:87],v17 offset:20744
s_waitcnt lgkmcnt(0)
ds_read_b64_tr_b16 a[88:89],v17 offset:22528
ds_read_b64_tr_b16 a[90:91],v17 offset:22784
ds_read_b64_tr_b16 a[92:93],v17 offset:22536
ds_read_b64_tr_b16 a[94:95],v17 offset:22792
ds_read_b64_tr_b16 a[96:97],v17 offset:24576
ds_read_b64_tr_b16 a[98:99],v17 offset:24832
ds_read_b64_tr_b16 a[100:101],v17 offset:24584
ds_read_b64_tr_b16 a[102:103],v17 offset:24840
ds_read_b64_tr_b16 a[104:105],v17 offset:26624
ds_read_b64_tr_b16 a[106:107],v17 offset:26880
ds_read_b64_tr_b16 a[108:109],v17 offset:26632
ds_read_b64_tr_b16 a[110:111],v17 offset:26888
s_waitcnt lgkmcnt(0)
ds_read_b64_tr_b16 a[112:113],v17 offset:28672
ds_read_b64_tr_b16 a[114:115],v17 offset:28928
ds_read_b64_tr_b16 a[116:117],v17 offset:28680
ds_read_b64_tr_b16 a[118:119],v17 offset:28936
ds_read_b64_tr_b16 a[120:121],v17 offset:30720
ds_read_b64_tr_b16 a[122:123],v17 offset:30976
ds_read_b64_tr_b16 a[124:125],v17 offset:30728
ds_read_b64_tr_b16 a[126:127],v17 offset:30984
s_waitcnt lgkmcnt(0)
s_xor_b32 s62,s50,3
s_mul_i32 s62,s62,524288
s_add_u32 s62,s62,s54
s_add_u32 m0,s61,16384
s_nop 0
buffer_load_dwordx4 v16,s[28:31],s62 offen lds
s_add_u32 s62,s62,32768
s_add_u32 m0,m0,1024
s_nop 0
buffer_load_dwordx4 v16,s[28:31],s62 offen lds
s_add_u32 s62,s62,32768
s_add_u32 m0,m0,1024
s_nop 0
buffer_load_dwordx4 v16,s[28:31],s62 offen lds
s_add_u32 s62,s62,32768
s_add_u32 m0,m0,1024
s_nop 0
buffer_load_dwordx4 v16,s[28:31],s62 offen lds
s_add_u32 s62,s62,32768
s_add_u32 m0,m0,1024
s_nop 0
buffer_load_dwordx4 v16,s[28:31],s62 offen lds
s_add_u32 s62,s62,32768
s_add_u32 m0,m0,1024
s_nop 0
buffer_load_dwordx4 v16,s[28:31],s62 offen lds
s_add_u32 s62,s62,32768
s_add_u32 m0,m0,1024
s_nop 0
buffer_load_dwordx4 v16,s[28:31],s62 offen lds
s_add_u32 s62,s62,32768
s_add_u32 m0,m0,1024
s_nop 0
buffer_load_dwordx4 v16,s[28:31],s62 offen lds
s_add_u32 s62,s62,32768
s_add_u32 m0,m0,1024
s_nop 0
buffer_load_dwordx4 v16,s[28:31],s62 offen lds
s_add_u32 s62,s62,32768
s_add_u32 m0,m0,1024
s_nop 0
buffer_load_dwordx4 v16,s[28:31],s62 offen lds
s_add_u32 s62,s62,32768
s_add_u32 m0,m0,1024
s_nop 0
buffer_load_dwordx4 v16,s[28:31],s62 offen lds
s_add_u32 s62,s62,32768
s_add_u32 m0,m0,1024
s_nop 0
buffer_load_dwordx4 v16,s[28:31],s62 offen lds
s_add_u32 s62,s62,32768
s_add_u32 m0,m0,1024
s_nop 0
buffer_load_dwordx4 v16,s[28:31],s62 offen lds
s_add_u32 s62,s62,32768
s_add_u32 m0,m0,1024
s_nop 0
buffer_load_dwordx4 v16,s[28:31],s62 offen lds
s_add_u32 s62,s62,32768
s_add_u32 m0,m0,1024
s_nop 0
buffer_load_dwordx4 v16,s[28:31],s62 offen lds
s_add_u32 s62,s62,32768
s_add_u32 m0,m0,1024
s_nop 0
buffer_load_dwordx4 v16,s[28:31],s62 offen lds
s_waitcnt vmcnt(16)
ds_read_b64_tr_b16 a[128:129],v17 offset:0
ds_read_b64_tr_b16 a[130:131],v17 offset:256
ds_read_b64_tr_b16 a[132:133],v17 offset:8
ds_read_b64_tr_b16 a[134:135],v17 offset:264
ds_read_b64_tr_b16 a[136:137],v17 offset:2048
ds_read_b64_tr_b16 a[138:139],v17 offset:2304
ds_read_b64_tr_b16 a[140:141],v17 offset:2056
ds_read_b64_tr_b16 a[142:143],v17 offset:2312
ds_read_b64_tr_b16 a[144:145],v17 offset:4096
ds_read_b64_tr_b16 a[146:147],v17 offset:4352
ds_read_b64_tr_b16 a[148:149],v17 offset:4104
ds_read_b64_tr_b16 a[150:151],v17 offset:4360
s_waitcnt lgkmcnt(0)
ds_read_b64_tr_b16 a[152:153],v17 offset:6144
ds_read_b64_tr_b16 a[154:155],v17 offset:6400
ds_read_b64_tr_b16 a[156:157],v17 offset:6152
ds_read_b64_tr_b16 a[158:159],v17 offset:6408
ds_read_b64_tr_b16 a[160:161],v17 offset:8192
ds_read_b64_tr_b16 a[162:163],v17 offset:8448
ds_read_b64_tr_b16 a[164:165],v17 offset:8200
ds_read_b64_tr_b16 a[166:167],v17 offset:8456
ds_read_b64_tr_b16 a[168:169],v17 offset:10240
ds_read_b64_tr_b16 a[170:171],v17 offset:10496
ds_read_b64_tr_b16 a[172:173],v17 offset:10248
ds_read_b64_tr_b16 a[174:175],v17 offset:10504
s_waitcnt lgkmcnt(0)
ds_read_b64_tr_b16 a[176:177],v17 offset:12288
ds_read_b64_tr_b16 a[178:179],v17 offset:12544
ds_read_b64_tr_b16 a[180:181],v17 offset:12296
ds_read_b64_tr_b16 a[182:183],v17 offset:12552
ds_read_b64_tr_b16 a[184:185],v17 offset:14336
ds_read_b64_tr_b16 a[186:187],v17 offset:14592
ds_read_b64_tr_b16 a[188:189],v17 offset:14344
ds_read_b64_tr_b16 a[190:191],v17 offset:14600
s_waitcnt lgkmcnt(0)
s_waitcnt vmcnt(0)
ds_read_b64_tr_b16 a[192:193],v17 offset:16384
ds_read_b64_tr_b16 a[194:195],v17 offset:16640
ds_read_b64_tr_b16 a[196:197],v17 offset:16392
ds_read_b64_tr_b16 a[198:199],v17 offset:16648
ds_read_b64_tr_b16 a[200:201],v17 offset:18432
ds_read_b64_tr_b16 a[202:203],v17 offset:18688
ds_read_b64_tr_b16 a[204:205],v17 offset:18440
ds_read_b64_tr_b16 a[206:207],v17 offset:18696
ds_read_b64_tr_b16 a[208:209],v17 offset:20480
ds_read_b64_tr_b16 a[210:211],v17 offset:20736
ds_read_b64_tr_b16 a[212:213],v17 offset:20488
ds_read_b64_tr_b16 a[214:215],v17 offset:20744
s_waitcnt lgkmcnt(0)
ds_read_b64_tr_b16 a[216:217],v17 offset:22528
ds_read_b64_tr_b16 a[218:219],v17 offset:22784
ds_read_b64_tr_b16 a[220:221],v17 offset:22536
ds_read_b64_tr_b16 a[222:223],v17 offset:22792
ds_read_b64_tr_b16 a[224:225],v17 offset:24576
ds_read_b64_tr_b16 a[226:227],v17 offset:24832
ds_read_b64_tr_b16 a[228:229],v17 offset:24584
ds_read_b64_tr_b16 a[230:231],v17 offset:24840
ds_read_b64_tr_b16 a[232:233],v17 offset:26624
ds_read_b64_tr_b16 a[234:235],v17 offset:26880
ds_read_b64_tr_b16 a[236:237],v17 offset:26632
ds_read_b64_tr_b16 a[238:239],v17 offset:26888
s_waitcnt lgkmcnt(0)
ds_read_b64_tr_b16 a[240:241],v17 offset:28672
ds_read_b64_tr_b16 a[242:243],v17 offset:28928
ds_read_b64_tr_b16 a[244:245],v17 offset:28680
ds_read_b64_tr_b16 a[246:247],v17 offset:28936
ds_read_b64_tr_b16 a[248:249],v17 offset:30720
ds_read_b64_tr_b16 a[250:251],v17 offset:30976
ds_read_b64_tr_b16 a[252:253],v17 offset:30728
ds_read_b64_tr_b16 a[254:255],v17 offset:30984
s_waitcnt lgkmcnt(0)
s_mov_b32 s67,0
s_cmp_eq_u32 s56,1
s_cbranch_scc1 vok_122
v_mbcnt_lo_u32_b32 v16,-1,0
v_and_b32 v16,7,v16
v_lshlrev_b32 v16,7,v16
s_mov_b32 s64,138510336
vpoll_123:
buffer_load_dword v17,v16,s[20:23],s64 offen sc1
s_waitcnt vmcnt(0)
v_readlane_b32 s92,v17,0
v_readlane_b32 s93,v17,1
v_readlane_b32 s94,v17,2
v_readlane_b32 s95,v17,3
v_readlane_b32 s96,v17,4
v_readlane_b32 s97,v17,5
v_readlane_b32 s98,v17,6
v_readlane_b32 s99,v17,7
s_add_u32 s65,s92,s93
s_add_u32 s65,s65,s94
s_add_u32 s65,s65,s95
s_add_u32 s65,s65,s96
s_add_u32 s65,s65,s97
s_add_u32 s65,s65,s98
s_add_u32 s65,s65,s99
s_cmp_ge_u32 s65,256
s_cbranch_scc1 vgot_124
s_sleep 4
s_sub_u32 s90,s90,1
s_cmp_gt_i32 s90,0
s_cbranch_scc1 vpoll_123
vgot_124:
s_min_u32 s65,s92,s93
s_min_u32 s65,s65,s94
s_min_u32 s65,s65,s95
s_min_u32 s65,s65,s96
s_min_u32 s65,s65,s97
s_min_u32 s65,s65,s98
s_min_u32 s65,s65,s99
s_cmp_lt_u32 s65,32
s_cbranch_scc1 fl_slow
s_mov_b32 s56,0
vok_122:
s_barrier
v_lshlrev_b32 v0,4,v1
s_mov_b32 s60,0
s_mov_b32 s70,0
s_mov_b32 s55,0
s_lshl_b32 s63,s50,13
v_mov_b32 v3,v0
s_mov_b32 s73,0xffff0000
s_lshl_b32 s64,s52,2
s_add_u32 s64,s64,s50
s_mul_i32 s61,s64,8192
s_add_u32 s61,s61,205520896
s_lshl_b32 s82,s64,8
s_add_u32 s82,s82,138548224
s_mov_b32 s68,s82
s_lshl_b32 s83,s53,2
s_add_u32 s83,s83,s50
s_xor_b32 s64,s50,0
s_lshl_b32 s64,s64,13
v_add_u32 v8,s64,v0
s_xor_b32 s64,s50,1
s_lshl_b32 s64,s64,13
v_add_u32 v9,s64,v0
s_xor_b32 s64,s50,2
s_lshl_b32 s64,s64,13
v_add_u32 v10,s64,v0
s_xor_b32 s64,s50,3
s_lshl_b32 s64,s64,13
v_add_u32 v11,s64,v0
v_min_u32 v2,3,v1
v_lshlrev_b32 v2,2,v2
s_lshl_b32 s66,s83,10
s_lshr_b32 s65,s83,3
s_lshl_b32 s65,s65,8
s_and_b32 s64,s83,7
s_lshl_b32 s64,s64,2
s_add_u32 s69,s64,s65
s_add_u32 s69,s69,138549248
s_lshl_b32 s64,s50,9
s_add_u32 s64,s64,131072
v_lshlrev_b32 v26,3,v1
v_add_u32 v19,s64,v26
v_lshl_add_u32 v26,v23,4,v21
v_lshlrev_b32 v26,3,v26
v_add_u32 v20,131072,v26
s_mov_b32 s74,0x22222222
s_mov_b32 s75,0x22222222
s_mov_b32 s76,0x44444444
s_mov_b32 s77,0x44444444
s_mov_b32 s78,0x88888888
s_mov_b32 s79,0x88888888
s_mov_b32 s80,0xc0135761
s_mov_b32 s81,0xbdd2d3e8
v_mov_b32 v191,s80
v_mov_b32 v12,0x3f803f80
v_mov_b32 v13,0x3f803f80
v_mov_b32 v14,0x3f803f80
v_mov_b32 v15,0x3f803f80
s_nop 1
v_mfma_f32_16x16x32_bf16 v[152:155],a[0:3],v[12:15],0
v_mfma_f32_16x16x32_bf16 v[156:159],a[4:7],v[12:15],0
v_mfma_f32_16x16x32_bf16 v[152:155],a[8:11],v[12:15],v[152:155]
v_mfma_f32_16x16x32_bf16 v[156:159],a[12:15],v[12:15],v[156:159]
v_mfma_f32_16x16x32_bf16 v[152:155],a[16:19],v[12:15],v[152:155]
v_mfma_f32_16x16x32_bf16 v[156:159],a[20:23],v[12:15],v[156:159]
v_mfma_f32_16x16x32_bf16 v[152:155],a[24:27],v[12:15],v[152:155]
v_mfma_f32_16x16x32_bf16 v[156:159],a[28:31],v[12:15],v[156:159]
v_mfma_f32_16x16x32_bf16 v[152:155],a[32:35],v[12:15],v[152:155]
v_mfma_f32_16x16x32_bf16 v[156:159],a[36:39],v[12:15],v[156:159]
v_mfma_f32_16x16x32_bf16 v[152:155],a[40:43],v[12:15],v[152:155]
v_mfma_f32_16x16x32_bf16 v[156:159],a[44:47],v[12:15],v[156:159]
v_mfma_f32_16x16x32_bf16 v[152:155],a[48:51],v[12:15],v[152:155]
v_mfma_f32_16x16x32_bf16 v[156:159],a[52:55],v[12:15],v[156:159]
v_mfma_f32_16x16x32_bf16 v[152:155],a[56:59],v[12:15],v[152:155]
v_mfma_f32_16x16x32_bf16 v[156:159],a[60:63],v[12:15],v[156:159]
v_mfma_f32_16x16x32_bf16 v[152:155],a[64:67],v[12:15],v[152:155]
v_mfma_f32_16x16x32_bf16 v[156:159],a[68:71],v[12:15],v[156:159]
v_mfma_f32_16x16x32_bf16 v[152:155],a[72:75],v[12:15],v[152:155]
v_mfma_f32_16x16x32_bf16 v[156:159],a[76:79],v[12:15],v[156:159]
v_mfma_f32_16x16x32_bf16 v[152:155],a[80:83],v[12:15],v[152:155]
v_mfma_f32_16x16x32_bf16 v[156:159],a[84:87],v[12:15],v[156:159]
v_mfma_f32_16x16x32_bf16 v[152:155],a[88:91],v[12:15],v[152:155]
v_mfma_f32_16x16x32_bf16 v[156:159],a[92:95],v[12:15],v[156:159]
v_mfma_f32_16x16x32_bf16 v[152:155],a[96:99],v[12:15],v[152:155]
v_mfma_f32_16x16x32_bf16 v[156:159],a[100:103],v[12:15],v[156:159]
v_mfma_f32_16x16x32_bf16 v[152:155],a[104:107],v[12:15],v[152:155]
v_mfma_f32_16x16x32_bf16 v[156:159],a[108:111],v[12:15],v[156:159]
v_mfma_f32_16x16x32_bf16 v[152:155],a[112:115],v[12:15],v[152:155]
v_mfma_f32_16x16x32_bf16 v[156:159],a[116:119],v[12:15],v[156:159]
v_mfma_f32_16x16x32_bf16 v[152:155],a[120:123],v[12:15],v[152:155]
v_mfma_f32_16x16x32_bf16 v[156:159],a[124:127],v[12:15],v[156:159]
v_mfma_f32_16x16x32_bf16 v[152:155],a[128:131],v[12:15],v[152:155]
v_mfma_f32_16x16x32_bf16 v[156:159],a[132:135],v[12:15],v[156:159]
v_mfma_f32_16x16x32_bf16 v[152:155],a[136:139],v[12:15],v[152:155]
v_mfma_f32_16x16x32_bf16 v[156:159],a[140:143],v[12:15],v[156:159]
v_mfma_f32_16x16x32_bf16 v[152:155],a[144:147],v[12:15],v[152:155]
v_mfma_f32_16x16x32_bf16 v[156:159],a[148:151],v[12:15],v[156:159]
v_mfma_f32_16x16x32_bf16 v[152:155],a[152:155],v[12:15],v[152:155]
v_mfma_f32_16x16x32_bf16 v[156:159],a[156:159],v[12:15],v[156:159]
v_mfma_f32_16x16x32_bf16 v[152:155],a[160:163],v[12:15],v[152:155]
v_mfma_f32_16x16x32_bf16 v[156:159],a[164:167],v[12:15],v[156:159]
v_mfma_f32_16x16x32_bf16 v[152:155],a[168:171],v[12:15],v[152:155]
v_mfma_f32_16x16x32_bf16 v[156:159],a[172:175],v[12:15],v[156:159]
v_mfma_f32_16x16x32_bf16 v[152:155],a[176:179],v[12:15],v[152:155]
v_mfma_f32_16x16x32_bf16 v[156:159],a[180:183],v[12:15],v[156:159]
v_mfma_f32_16x16x32_bf16 v[152:155],a[184:187],v[12:15],v[152:155]
v_mfma_f32_16x16x32_bf16 v[156:159],a[188:191],v[12:15],v[156:159]
v_mfma_f32_16x16x32_bf16 v[152:155],a[192:195],v[12:15],v[152:155]
v_mfma_f32_16x16x32_bf16 v[156:159],a[196:199],v[12:15],v[156:159]
v_mfma_f32_16x16x32_bf16 v[152:155],a[200:203],v[12:15],v[152:155]
v_mfma_f32_16x16x32_bf16 v[156:159],a[204:207],v[12:15],v[156:159]
v_mfma_f32_16x16x32_bf16 v[152:155],a[208:211],v[12:15],v[152:155]
v_mfma_f32_16x16x32_bf16 v[156:159],a[212:215],v[12:15],v[156:159]
v_mfma_f32_16x16x32_bf16 v[152:155],a[216:219],v[12:15],v[152:155]
v_mfma_f32_16x16x32_bf16 v[156:159],a[220:223],v[12:15],v[156:159]
v_mfma_f32_16x16x32_bf16 v[152:155],a[224:227],v[12:15],v[152:155]
v_mfma_f32_16x16x32_bf16 v[156:159],a[228:231],v[12:15],v[156:159]
v_mfma_f32_16x16x32_bf16 v[152:155],a[232:235],v[12:15],v[152:155]
v_mfma_f32_16x16x32_bf16 v[156:159],a[236:239],v[12:15],v[156:159]
v_mfma_f32_16x16x32_bf16 v[152:155],a[240:243],v[12:15],v[152:155]
v_mfma_f32_16x16x32_bf16 v[156:159],a[244:247],v[12:15],v[156:159]
v_mfma_f32_16x16x32_bf16 v[152:155],a[248:251],v[12:15],v[152:155]
v_mfma_f32_16x16x32_bf16 v[156:159],a[252:255],v[12:15],v[156:159]
s_add_u32 s71,s60,1
plp_132:
buffer_load_dword v16,v2,s[20:23],s68 offen sc1
s_waitcnt vmcnt(0)
v_cmp_gt_u32 vcc,s71,v16
s_cbranch_vccz pok_133
s_sleep 4
s_sub_u32 s90,s90,1
s_cmp_gt_i32 s90,0
s_cbranch_scc1 plp_132
pok_133:
lag_131:
s_add_u32 m0,s70,s63
s_add_u32 s62,s61,4096
buffer_load_dwordx4 v3,s[20:23],s61 offen offset:0 lds
buffer_load_dwordx4 v3,s[20:23],s61 offen offset:1024 lds
buffer_load_dwordx4 v3,s[20:23],s61 offen offset:2048 lds
buffer_load_dwordx4 v3,s[20:23],s61 offen offset:3072 lds
s_add_u32 m0,m0,4096
s_nop 0
buffer_load_dwordx4 v3,s[20:23],s62 offen offset:0 lds
buffer_load_dwordx4 v3,s[20:23],s62 offen offset:1024 lds
buffer_load_dwordx4 v3,s[20:23],s62 offen offset:2048 lds
buffer_load_dwordx4 v3,s[20:23],s62 offen offset:3072 lds
s_add_u32 s61,s61,32768
s_add_u32 s70,s70,32768
s_and_b32 s70,s70,0x1ffff
buffer_load_dword v17,off,s[20:23],s69
top_127:
s_add_u32 s71,s60,2
buffer_load_dword v16,v2,s[20:23],s68 offen sc1
v_add_u32 v4,s55,v8
v_add_u32 v5,s55,v9
v_add_u32 v6,s55,v10
v_add_u32 v7,s55,v11
s_add_u32 s55,s55,32768
s_and_b32 s55,s55,0x1ffff
s_waitcnt vmcnt(9)
ds_read_b128 v[64:67],v4 offset:0
s_waitcnt vmcnt(8)
ds_read_b128 v[68:71],v4 offset:1024
s_waitcnt vmcnt(7)
ds_read_b128 v[72:75],v4 offset:2048
s_waitcnt lgkmcnt(2)
v_mfma_f32_16x16x32_bf16 v[32:35],a[0:3],v[64:67],0
v_mfma_f32_16x16x32_bf16 v[36:39],a[4:7],v[64:67],0
v_mfma_f32_16x16x32_bf16 v[48:51],v[12:15],v[64:67],0
v_mfma_f32_16x16x32_bf16 v[52:55],v[64:67],v[64:67],0
s_waitcnt vmcnt(6)
ds_read_b128 v[76:79],v4 offset:3072
s_waitcnt lgkmcnt(2)
v_mfma_f32_16x16x32_bf16 v[32:35],a[8:11],v[68:71],v[32:35]
v_mfma_f32_16x16x32_bf16 v[36:39],a[12:15],v[68:71],v[36:39]
v_mfma_f32_16x16x32_bf16 v[48:51],v[12:15],v[68:71],v[48:51]
v_mfma_f32_16x16x32_bf16 v[52:55],v[68:71],v[68:71],v[52:55]
s_waitcnt vmcnt(5)
ds_read_b128 v[80:83],v4 offset:4096
s_waitcnt lgkmcnt(2)
v_mfma_f32_16x16x32_bf16 v[32:35],a[16:19],v[72:75],v[32:35]
v_mfma_f32_16x16x32_bf16 v[36:39],a[20:23],v[72:75],v[36:39]
v_mfma_f32_16x16x32_bf16 v[48:51],v[12:15],v[72:75],v[48:51]
v_mfma_f32_16x16x32_bf16 v[52:55],v[72:75],v[72:75],v[52:55]
s_waitcnt vmcnt(4)
ds_read_b128 v[84:87],v4 offset:5120
s_waitcnt lgkmcnt(2)
v_mfma_f32_16x16x32_bf16 v[32:35],a[24:27],v[76:79],v[32:35]
v_mfma_f32_16x16x32_bf16 v[36:39],a[28:31],v[76:79],v[36:39]
v_mfma_f32_16x16x32_bf16 v[48:51],v[12:15],v[76:79],v[48:51]
v_mfma_f32_16x16x32_bf16 v[52:55],v[76:79],v[76:79],v[52:55]
s_waitcnt vmcnt(3)
ds_read_b128 v[88:91],v4 offset:6144
s_waitcnt lgkmcnt(2)
v_mfma_f32_16x16x32_bf16 v[32:35],a[32:35],v[80:83],v[32:35]
v_mfma_f32_16x16x32_bf16 v[36:39],a[36:39],v[80:83],v[36:39]
v_mfma_f32_16x16x32_bf16 v[48:51],v[12:15],v[80:83],v[48:51]
v_mfma_f32_16x16x32_bf16 v[52:55],v[80:83],v[80:83],v[52:55]
s_waitcnt vmcnt(2)
ds_read_b128 v[92:95],v4 offset:7168
s_barrier
s_waitcnt lgkmcnt(2)
v_mfma_f32_16x16x32_bf16 v[32:35],a[40:43],v[84:87],v[32:35]
v_mfma_f32_16x16x32_bf16 v[36:39],a[44:47],v[84:87],v[36:39]
v_mfma_f32_16x16x32_bf16 v[48:51],v[12:15],v[84:87],v[48:51]
v_mfma_f32_16x16x32_bf16 v[52:55],v[84:87],v[84:87],v[52:55]
ds_read_b128 v[96:99],v5 offset:0
s_waitcnt lgkmcnt(2)
v_mfma_f32_16x16x32_bf16 v[32:35],a[48:51],v[88:91],v[32:35]
ds_read_b128 v[100:103],v5 offset:1024
ds_read_b128 v[104:107],v5 offset:2048
v_mfma_f32_16x16x32_bf16 v[36:39],a[52:55],v[88:91],v[36:39]
v_mfma_f32_16x16x32_bf16 v[48:51],v[12:15],v[88:91],v[48:51]
v_mfma_f32_16x16x32_bf16 v[52:55],v[88:91],v[88:91],v[52:55]
s_waitcnt lgkmcnt(3)
v_mfma_f32_16x16x32_bf16 v[32:35],a[56:59],v[92:95],v[32:35]
ds_read_b128 v[108:111],v5 offset:3072
ds_read_b128 v[112:115],v5 offset:4096
v_mfma_f32_16x16x32_bf16 v[36:39],a[60:63],v[92:95],v[36:39]
v_mfma_f32_16x16x32_bf16 v[48:51],v[12:15],v[92:95],v[48:51]
v_mfma_f32_16x16x32_bf16 v[52:55],v[92:95],v[92:95],v[52:55]
s_waitcnt lgkmcnt(4)
v_mfma_f32_16x16x32_bf16 v[32:35],a[64:67],v[96:99],v[32:35]
ds_read_b128 v[116:119],v5 offset:5120
ds_read_b128 v[120:123],v5 offset:6144
v_mfma_f32_16x16x32_bf16 v[36:39],a[68:71],v[96:99],v[36:39]
s_waitcnt lgkmcnt(5)
v_mfma_f32_16x16x32_bf16 v[32:35],a[72:75],v[100:103],v[32:35]
ds_read_b128 v[124:127],v5 offset:7168
v_mfma_f32_16x16x32_bf16 v[36:39],a[76:79],v[100:103],v[36:39]
s_waitcnt lgkmcnt(5)
v_mfma_f32_16x16x32_bf16 v[32:35],a[80:83],v[104:107],v[32:35]
ds_read_b128 v[64:67],v6 offset:0
v_mfma_f32_16x16x32_bf16 v[36:39],a[84:87],v[104:107],v[36:39]
s_waitcnt lgkmcnt(5)
v_mfma_f32_16x16x32_bf16 v[32:35],a[88:91],v[108:111],v[32:35]
ds_read_b128 v[68:71],v6 offset:1024
v_cndmask_b32 v49,v52,v53,s[74:75]
v_mfma_f32_16x16x32_bf16 v[36:39],a[92:95],v[108:111],v[36:39]
v_cndmask_b32 v49,v49,v54,s[76:77]
s_waitcnt lgkmcnt(5)
v_mfma_f32_16x16x32_bf16 v[32:35],a[96:99],v[112:115],v[32:35]
ds_read_b128 v[72:75],v6 offset:2048
v_cndmask_b32 v49,v49,v55,s[78:79]
v_mfma_f32_16x16x32_bf16 v[36:39],a[100:103],v[112:115],v[36:39]
ds_write_b64 v19,v[48:49]
s_waitcnt lgkmcnt(6)
v_mfma_f32_16x16x32_bf16 v[32:35],a[104:107],v[116:119],v[32:35]
ds_read_b128 v[76:79],v6 offset:3072
v_mfma_f32_16x16x32_bf16 v[36:39],a[108:111],v[116:119],v[36:39]
s_waitcnt lgkmcnt(6)
v_mfma_f32_16x16x32_bf16 v[32:35],a[112:115],v[120:123],v[32:35]
ds_read_b128 v[80:83],v6 offset:4096
v_mfma_f32_16x16x32_bf16 v[36:39],a[116:119],v[120:123],v[36:39]
s_waitcnt lgkmcnt(6)
v_mfma_f32_16x16x32_bf16 v[32:35],a[120:123],v[124:127],v[32:35]
ds_read_b128 v[84:87],v6 offset:5120
v_mfma_f32_16x16x32_bf16 v[36:39],a[124:127],v[124:127],v[36:39]
s_waitcnt lgkmcnt(6)
v_mfma_f32_16x16x32_bf16 v[32:35],a[128:131],v[64:67],v[32:35]
ds_read_b128 v[88:91],v6 offset:6144
v_mfma_f32_16x16x32_bf16 v[36:39],a[132:135],v[64:67],v[36:39]
s_waitcnt lgkmcnt(4)
s_barrier
ds_read_b64 v[56:57],v20 offset:0
ds_read_b64 v[58:59],v20 offset:512
v_mfma_f32_16x16x32_bf16 v[32:35],a[136:139],v[68:71],v[32:35]
ds_read_b128 v[92:95],v6 offset:7168
ds_read_b64 v[60:61],v20 offset:1024
ds_read_b64 v[62:63],v20 offset:1536
v_mfma_f32_16x16x32_bf16 v[36:39],a[140:143],v[68:71],v[36:39]
v_mfma_f32_16x16x32_bf16 v[32:35],a[144:147],v[72:75],v[32:35]
ds_read_b128 v[96:99],v7 offset:0
v_mfma_f32_16x16x32_bf16 v[36:39],a[148:151],v[72:75],v[36:39]
s_waitcnt lgkmcnt(9)
v_mfma_f32_16x16x32_bf16 v[32:35],a[152:155],v[76:79],v[32:35]
ds_read_b128 v[100:103],v7 offset:1024
v_mfma_f32_16x16x32_bf16 v[36:39],a[156:159],v[76:79],v[36:39]
s_waitcnt lgkmcnt(9)
v_mfma_f32_16x16x32_bf16 v[32:35],a[160:163],v[80:83],v[32:35]
ds_read_b128 v[104:107],v7 offset:2048
v_mfma_f32_16x16x32_bf16 v[36:39],a[164:167],v[80:83],v[36:39]
s_waitcnt lgkmcnt(9)
v_mfma_f32_16x16x32_bf16 v[32:35],a[168:171],v[84:87],v[32:35]
ds_read_b128 v[108:111],v7 offset:3072
s_waitcnt lgkmcnt(4)
v_mfma_f32_16x16x32_bf16 v[36:39],a[172:175],v[84:87],v[36:39]
v_add_f32 v56,v56,v58
s_waitcnt vmcnt(0)
v_mov_b32 v17,s60
s_mov_b64 exec,1
buffer_store_dword v17,off,s[20:23],s69 sc1
s_mov_b64 exec,-1
v_cmp_gt_u32 vcc,s71,v16
s_cbranch_vccnz vN_128
v_mfma_f32_16x16x32_bf16 v[32:35],a[176:179],v[88:91],v[32:35]
ds_read_b128 v[112:115],v7 offset:4096
v_add_f32 v57,v57,v59
s_add_u32 m0,s70,s63
v_mfma_f32_16x16x32_bf16 v[36:39],a[180:183],v[88:91],v[36:39]
v_add_f32 v60,v60,v62
s_add_u32 s62,s61,4096
v_mfma_f32_16x16x32_bf16 v[32:35],a[184:187],v[92:95],v[32:35]
ds_read_b128 v[116:119],v7 offset:5120
v_add_f32 v61,v61,v63
buffer_load_dwordx4 v3,s[20:23],s61 offen offset:0 lds
v_mfma_f32_16x16x32_bf16 v[36:39],a[188:191],v[92:95],v[36:39]
v_add_f32 v56,v56,v60
buffer_load_dwordx4 v3,s[20:23],s61 offen offset:1024 lds
s_waitcnt lgkmcnt(5)
v_mfma_f32_16x16x32_bf16 v[32:35],a[192:195],v[96:99],v[32:35]
ds_read_b128 v[120:123],v7 offset:6144
v_add_f32 v57,v57,v61
buffer_load_dwordx4 v3,s[20:23],s61 offen offset:2048 lds
v_mfma_f32_16x16x32_bf16 v[36:39],a[196:199],v[96:99],v[36:39]
v_mul_f32 v189,0xba800000,v56
buffer_load_dwordx4 v3,s[20:23],s61 offen offset:3072 lds
s_waitcnt lgkmcnt(5)
v_mfma_f32_16x16x32_bf16 v[32:35],a[200:203],v[100:103],v[32:35]
ds_read_b128 v[124:127],v7 offset:7168
v_mul_f32 v58,v189,v189
s_add_u32 m0,m0,4096
v_mfma_f32_16x16x32_bf16 v[36:39],a[204:207],v[100:103],v[36:39]
v_mul_f32 v57,0x3a800000,v57
buffer_load_dwordx4 v3,s[20:23],s62 offen offset:0 lds
s_waitcnt lgkmcnt(5)
v_mfma_f32_16x16x32_bf16 v[32:35],a[208:211],v[104:107],v[32:35]
v_sub_f32 v57,v57,v58
buffer_load_dwordx4 v3,s[20:23],s62 offen offset:1024 lds
v_mfma_f32_16x16x32_bf16 v[36:39],a[212:215],v[104:107],v[36:39]
v_max_f32 v57,0,v57
buffer_load_dwordx4 v3,s[20:23],s62 offen offset:2048 lds
s_waitcnt lgkmcnt(4)
v_mfma_f32_16x16x32_bf16 v[32:35],a[216:219],v[108:111],v[32:35]
v_add_f32 v57,0x3727c5ac,v57
buffer_load_dwordx4 v3,s[20:23],s62 offen offset:3072 lds
v_mfma_f32_16x16x32_bf16 v[36:39],a[220:223],v[108:111],v[36:39]
v_rsq_f32 v190,v57
s_add_u32 s61,s61,32768
s_waitcnt lgkmcnt(3)
v_mfma_f32_16x16x32_bf16 v[32:35],a[224:227],v[112:115],v[32:35]
s_add_u32 s70,s70,32768
v_mfma_f32_16x16x32_bf16 v[36:39],a[228:231],v[112:115],v[36:39]
s_and_b32 s70,s70,0x1ffff
s_waitcnt lgkmcnt(2)
v_mfma_f32_16x16x32_bf16 v[32:35],a[232:235],v[116:119],v[32:35]
v_mfma_f32_16x16x32_bf16 v[36:39],a[236:239],v[116:119],v[36:39]
s_waitcnt lgkmcnt(1)
v_mfma_f32_16x16x32_bf16 v[32:35],a[240:243],v[120:123],v[32:35]
v_mfma_f32_16x16x32_bf16 v[36:39],a[244:247],v[120:123],v[36:39]
s_waitcnt lgkmcnt(0)
v_mfma_f32_16x16x32_bf16 v[32:35],a[248:251],v[124:127],v[32:35]
v_mfma_f32_16x16x32_bf16 v[36:39],a[252:255],v[124:127],v[36:39]
s_mov_b32 s72,1
join_129:
s_nop 5
v_fma_f32 v32,v152,v189,v32
v_fma_f32 v33,v153,v189,v33
v_fma_f32 v34,v154,v189,v34
v_fma_f32 v35,v155,v189,v35
v_fma_f32 v36,v156,v189,v36
v_fma_f32 v37,v157,v189,v37
v_fma_f32 v38,v158,v189,v38
v_fma_f32 v39,v159,v189,v39
v_mul_f32 v32,v32,v190
v_mul_f32 v33,v33,v190
v_mul_f32 v34,v34,v190
v_mul_f32 v35,v35,v190
v_mul_f32 v36,v36,v190
v_mul_f32 v37,v37,v190
v_mul_f32 v38,v38,v190
v_mul_f32 v39,v39,v190
v_mul_f32 v168,v32,v32
v_mul_f32 v169,v33,v33
v_mul_f32 v170,v34,v34
v_mul_f32 v171,v35,v35
v_mul_f32 v172,v36,v36
v_mul_f32 v173,v37,v37
v_mul_f32 v174,v38,v38
v_mul_f32 v175,v39,v39
v_fma_f32 v168,v168,s81,v191
v_fma_f32 v169,v169,s81,v191
v_fma_f32 v170,v170,s81,v191
v_fma_f32 v171,v171,s81,v191
v_fma_f32 v172,v172,s81,v191
v_fma_f32 v173,v173,s81,v191
v_fma_f32 v174,v174,s81,v191
v_fma_f32 v175,v175,s81,v191
v_mul_f32 v168,v168,v32
v_mul_f32 v169,v169,v33
v_mul_f32 v170,v170,v34
v_mul_f32 v171,v171,v35
v_mul_f32 v172,v172,v36
v_mul_f32 v173,v173,v37
v_mul_f32 v174,v174,v38
v_mul_f32 v175,v175,v39
v_exp_f32 v168,v168
v_exp_f32 v169,v169
v_exp_f32 v170,v170
v_exp_f32 v171,v171
v_exp_f32 v172,v172
v_exp_f32 v173,v173
v_exp_f32 v174,v174
v_exp_f32 v175,v175
v_add_f32 v168,1.0,v168
v_add_f32 v169,1.0,v169
v_add_f32 v170,1.0,v170
v_add_f32 v171,1.0,v171
v_add_f32 v172,1.0,v172
v_add_f32 v173,1.0,v173
v_add_f32 v174,1.0,v174
v_add_f32 v175,1.0,v175
v_rcp_f32 v168,v168
v_rcp_f32 v169,v169
v_rcp_f32 v170,v170
v_rcp_f32 v171,v171
v_rcp_f32 v172,v172
v_rcp_f32 v173,v173
v_rcp_f32 v174,v174
v_rcp_f32 v175,v175
v_mul_f32 v32,v168,v32
v_mul_f32 v33,v169,v33
v_mul_f32 v34,v170,v34
v_mul_f32 v35,v171,v35
v_mul_f32 v36,v172,v36
v_mul_f32 v37,v173,v37
v_mul_f32 v38,v174,v38
v_mul_f32 v39,v175,v39
v_cvt_pk_bf16_f32 v176,v32,v33
v_cvt_pk_bf16_f32 v177,v34,v35
v_cvt_pk_bf16_f32 v178,v36,v37
v_cvt_pk_bf16_f32 v179,v38,v39
s_add_u32 s64,s66,209747968
buffer_store_dwordx4 v[176:179],v0,s[20:23],s64 offen sc1
s_add_u32 s66,s66,32768
s_add_u32 s60,s60,1
s_cmp_eq_u32 s72,0
s_cbranch_scc1 slowp_130
s_branch top_127
slowp_130:
s_waitcnt vmcnt(1)
v_cmp_gt_u32 vcc,s71,v16
s_cbranch_vccz lag_131
s_waitcnt vmcnt(0)
v_mov_b32 v17,s60
s_mov_b64 exec,1
buffer_store_dword v17,off,s[20:23],s69 sc1
s_mov_b64 exec,-1
s_cmp_ge_u32 s60,128
s_cbranch_scc1 done_121
plp_134:
buffer_load_dword v16,v2,s[20:23],s68 offen sc1
s_waitcnt vmcnt(0)
v_cmp_gt_u32 vcc,s71,v16
s_cbranch_vccz pok_135
s_sleep 4
s_sub_u32 s90,s90,1
s_cmp_gt_i32 s90,0
s_cbranch_scc1 plp_134
pok_135:
s_branch lag_131
vN_128:
buffer_load_dword v16,v2,s[20:23],s68 offen sc1
v_mfma_f32_16x16x32_bf16 v[32:35],a[176:179],v[88:91],v[32:35]
ds_read_b128 v[112:115],v7 offset:4096
v_add_f32 v57,v57,v59
v_mfma_f32_16x16x32_bf16 v[36:39],a[180:183],v[88:91],v[36:39]
v_add_f32 v60,v60,v62
v_mfma_f32_16x16x32_bf16 v[32:35],a[184:187],v[92:95],v[32:35]
ds_read_b128 v[116:119],v7 offset:5120
v_add_f32 v61,v61,v63
v_mfma_f32_16x16x32_bf16 v[36:39],a[188:191],v[92:95],v[36:39]
v_add_f32 v56,v56,v60
s_waitcnt lgkmcnt(5)
v_mfma_f32_16x16x32_bf16 v[32:35],a[192:195],v[96:99],v[32:35]
ds_read_b128 v[120:123],v7 offset:6144
v_add_f32 v57,v57,v61
v_mfma_f32_16x16x32_bf16 v[36:39],a[196:199],v[96:99],v[36:39]
v_mul_f32 v189,0xba800000,v56
s_waitcnt lgkmcnt(5)
v_mfma_f32_16x16x32_bf16 v[32:35],a[200:203],v[100:103],v[32:35]
ds_read_b128 v[124:127],v7 offset:7168
v_mul_f32 v58,v189,v189
v_mfma_f32_16x16x32_bf16 v[36:39],a[204:207],v[100:103],v[36:39]
v_mul_f32 v57,0x3a800000,v57
s_waitcnt lgkmcnt(5)
v_mfma_f32_16x16x32_bf16 v[32:35],a[208:211],v[104:107],v[32:35]
v_sub_f32 v57,v57,v58
v_mfma_f32_16x16x32_bf16 v[36:39],a[212:215],v[104:107],v[36:39]
v_max_f32 v57,0,v57
s_waitcnt lgkmcnt(4)
v_mfma_f32_16x16x32_bf16 v[32:35],a[216:219],v[108:111],v[32:35]
v_add_f32 v57,0x3727c5ac,v57
v_mfma_f32_16x16x32_bf16 v[36:39],a[220:223],v[108:111],v[36:39]
v_rsq_f32 v190,v57
s_waitcnt lgkmcnt(3)
v_mfma_f32_16x16x32_bf16 v[32:35],a[224:227],v[112:115],v[32:35]
v_mfma_f32_16x16x32_bf16 v[36:39],a[228:231],v[112:115],v[36:39]
s_waitcnt lgkmcnt(2)
v_mfma_f32_16x16x32_bf16 v[32:35],a[232:235],v[116:119],v[32:35]
v_mfma_f32_16x16x32_bf16 v[36:39],a[236:239],v[116:119],v[36:39]
s_waitcnt lgkmcnt(1)
v_mfma_f32_16x16x32_bf16 v[32:35],a[240:243],v[120:123],v[32:35]
v_mfma_f32_16x16x32_bf16 v[36:39],a[244:247],v[120:123],v[36:39]
s_waitcnt lgkmcnt(0)
v_mfma_f32_16x16x32_bf16 v[32:35],a[248:251],v[124:127],v[32:35]
v_mfma_f32_16x16x32_bf16 v[36:39],a[252:255],v[124:127],v[36:39]
s_mov_b32 s72,0
s_branch join_129
done_121:
s_endpgm
fl_w2:
v_and_b32 v21,15,v1
v_lshrrev_b32 v22,4,v1
v_lshrrev_b32 v23,2,v21
v_and_b32 v24,3,v21
s_lshl_b32 s61,s50,15
v_lshl_add_u32 v25,v22,3,v23
s_load_dwordx2 s[4:5],s[0:1],72
s_mov_b32 s52,0
s_mov_b32 s53,s59
s_mul_i32 s54,s52,2097152
s_lshl_b32 s64,s53,8
s_add_u32 s54,s54,s64
s_lshl_b32 s64,s50,6
s_add_u32 s54,s54,s64
s_waitcnt lgkmcnt(0)
s_mov_b32 s28,s4
s_and_b32 s29,s5,0xffff
s_mov_b32 s30,0x200000
s_mov_b32 s31,0x20000
v_lshrrev_b32 v26,2,v1
v_and_b32 v27,3,v1
v_mul_u32_u24 v16,2048,v26
v_lshl_add_u32 v16,v27,4,v16
v_lshlrev_b32 v17,6,v25
v_lshl_add_u32 v17,v24,4,v17
v_add_u32 v17,s61,v17
s_xor_b32 s62,s50,0
s_mul_i32 s62,s62,524288
s_add_u32 s62,s62,s54
s_add_u32 m0,s61,0
s_nop 0
buffer_load_dwordx4 v16,s[28:31],s62 offen lds
s_add_u32 s62,s62,32768
s_add_u32 m0,m0,1024
s_nop 0
buffer_load_dwordx4 v16,s[28:31],s62 offen lds
s_add_u32 s62,s62,32768
s_add_u32 m0,m0,1024
s_nop 0
buffer_load_dwordx4 v16,s[28:31],s62 offen lds
s_add_u32 s62,s62,32768
s_add_u32 m0,m0,1024
s_nop 0
buffer_load_dwordx4 v16,s[28:31],s62 offen lds
s_add_u32 s62,s62,32768
s_add_u32 m0,m0,1024
s_nop 0
buffer_load_dwordx4 v16,s[28:31],s62 offen lds
s_add_u32 s62,s62,32768
s_add_u32 m0,m0,1024
s_nop 0
buffer_load_dwordx4 v16,s[28:31],s62 offen lds
s_add_u32 s62,s62,32768
s_add_u32 m0,m0,1024
s_nop 0
buffer_load_dwordx4 v16,s[28:31],s62 offen lds
s_add_u32 s62,s62,32768
s_add_u32 m0,m0,1024
s_nop 0
buffer_load_dwordx4 v16,s[28:31],s62 offen lds
s_add_u32 s62,s62,32768
s_add_u32 m0,m0,1024
s_nop 0
buffer_load_dwordx4 v16,s[28:31],s62 offen lds
s_add_u32 s62,s62,32768
s_add_u32 m0,m0,1024
s_nop 0
buffer_load_dwordx4 v16,s[28:31],s62 offen lds
s_add_u32 s62,s62,32768
s_add_u32 m0,m0,1024
s_nop 0
buffer_load_dwordx4 v16,s[28:31],s62 offen lds
s_add_u32 s62,s62,32768
s_add_u32 m0,m0,1024
s_nop 0
buffer_load_dwordx4 v16,s[28:31],s62 offen lds
s_add_u32 s62,s62,32768
s_add_u32 m0,m0,1024
s_nop 0
buffer_load_dwordx4 v16,s[28:31],s62 offen lds
s_add_u32 s62,s62,32768
s_add_u32 m0,m0,1024
s_nop 0
buffer_load_dwordx4 v16,s[28:31],s62 offen lds
s_add_u32 s62,s62,32768
s_add_u32 m0,m0,1024
s_nop 0
buffer_load_dwordx4 v16,s[28:31],s62 offen lds
s_add_u32 s62,s62,32768
s_add_u32 m0,m0,1024
s_nop 0
buffer_load_dwordx4 v16,s[28:31],s62 offen lds
s_xor_b32 s62,s50,1
s_mul_i32 s62,s62,524288
s_add_u32 s62,s62,s54
s_add_u32 m0,s61,16384
s_nop 0
buffer_load_dwordx4 v16,s[28:31],s62 offen lds
s_add_u32 s62,s62,32768
s_add_u32 m0,m0,1024
s_nop 0
buffer_load_dwordx4 v16,s[28:31],s62 offen lds
s_add_u32 s62,s62,32768
s_add_u32 m0,m0,1024
s_nop 0
buffer_load_dwordx4 v16,s[28:31],s62 offen lds
s_add_u32 s62,s62,32768
s_add_u32 m0,m0,1024
s_nop 0
buffer_load_dwordx4 v16,s[28:31],s62 offen lds
s_add_u32 s62,s62,32768
s_add_u32 m0,m0,1024
s_nop 0
buffer_load_dwordx4 v16,s[28:31],s62 offen lds
s_add_u32 s62,s62,32768
s_add_u32 m0,m0,1024
s_nop 0
buffer_load_dwordx4 v16,s[28:31],s62 offen lds
s_add_u32 s62,s62,32768
s_add_u32 m0,m0,1024
s_nop 0
buffer_load_dwordx4 v16,s[28:31],s62 offen lds
s_add_u32 s62,s62,32768
s_add_u32 m0,m0,1024
s_nop 0
buffer_load_dwordx4 v16,s[28:31],s62 offen lds
s_add_u32 s62,s62,32768
s_add_u32 m0,m0,1024
s_nop 0
buffer_load_dwordx4 v16,s[28:31],s62 offen lds
s_add_u32 s62,s62,32768
s_add_u32 m0,m0,1024
s_nop 0
buffer_load_dwordx4 v16,s[28:31],s62 offen lds
s_add_u32 s62,s62,32768
s_add_u32 m0,m0,1024
s_nop 0
buffer_load_dwordx4 v16,s[28:31],s62 offen lds
s_add_u32 s62,s62,32768
s_add_u32 m0,m0,1024
s_nop 0
buffer_load_dwordx4 v16,s[28:31],s62 offen lds
s_add_u32 s62,s62,32768
s_add_u32 m0,m0,1024
s_nop 0
buffer_load_dwordx4 v16,s[28:31],s62 offen lds
s_add_u32 s62,s62,32768
s_add_u32 m0,m0,1024
s_nop 0
buffer_load_dwordx4 v16,s[28:31],s62 offen lds
s_add_u32 s62,s62,32768
s_add_u32 m0,m0,1024
s_nop 0
buffer_load_dwordx4 v16,s[28:31],s62 offen lds
s_add_u32 s62,s62,32768
s_add_u32 m0,m0,1024
s_nop 0
buffer_load_dwordx4 v16,s[28:31],s62 offen lds
s_waitcnt vmcnt(16)
ds_read_b64_tr_b16 a[0:1],v17 offset:0
ds_read_b64_tr_b16 a[2:3],v17 offset:256
ds_read_b64_tr_b16 a[4:5],v17 offset:8
ds_read_b64_tr_b16 a[6:7],v17 offset:264
ds_read_b64_tr_b16 a[8:9],v17 offset:2048
ds_read_b64_tr_b16 a[10:11],v17 offset:2304
ds_read_b64_tr_b16 a[12:13],v17 offset:2056
ds_read_b64_tr_b16 a[14:15],v17 offset:2312
ds_read_b64_tr_b16 a[16:17],v17 offset:4096
ds_read_b64_tr_b16 a[18:19],v17 offset:4352
ds_read_b64_tr_b16 a[20:21],v17 offset:4104
ds_read_b64_tr_b16 a[22:23],v17 offset:4360
s_waitcnt lgkmcnt(0)
ds_read_b64_tr_b16 a[24:25],v17 offset:6144
ds_read_b64_tr_b16 a[26:27],v17 offset:6400
ds_read_b64_tr_b16 a[28:29],v17 offset:6152
ds_read_b64_tr_b16 a[30:31],v17 offset:6408
ds_read_b64_tr_b16 a[32:33],v17 offset:8192
ds_read_b64_tr_b16 a[34:35],v17 offset:8448
ds_read_b64_tr_b16 a[36:37],v17 offset:8200
ds_read_b64_tr_b16 a[38:39],v17 offset:8456
ds_read_b64_tr_b16 a[40:41],v17 offset:10240
ds_read_b64_tr_b16 a[42:43],v17 offset:10496
ds_read_b64_tr_b16 a[44:45],v17 offset:10248
ds_read_b64_tr_b16 a[46:47],v17 offset:10504
s_waitcnt lgkmcnt(0)
ds_read_b64_tr_b16 a[48:49],v17 offset:12288
ds_read_b64_tr_b16 a[50:51],v17 offset:12544
ds_read_b64_tr_b16 a[52:53],v17 offset:12296
ds_read_b64_tr_b16 a[54:55],v17 offset:12552
ds_read_b64_tr_b16 a[56:57],v17 offset:14336
ds_read_b64_tr_b16 a[58:59],v17 offset:14592
ds_read_b64_tr_b16 a[60:61],v17 offset:14344
ds_read_b64_tr_b16 a[62:63],v17 offset:14600
s_waitcnt lgkmcnt(0)
s_xor_b32 s62,s50,2
s_mul_i32 s62,s62,524288
s_add_u32 s62,s62,s54
s_add_u32 m0,s61,0
s_nop 0
buffer_load_dwordx4 v16,s[28:31],s62 offen lds
s_add_u32 s62,s62,32768
s_add_u32 m0,m0,1024
s_nop 0
buffer_load_dwordx4 v16,s[28:31],s62 offen lds
s_add_u32 s62,s62,32768
s_add_u32 m0,m0,1024
s_nop 0
buffer_load_dwordx4 v16,s[28:31],s62 offen lds
s_add_u32 s62,s62,32768
s_add_u32 m0,m0,1024
s_nop 0
buffer_load_dwordx4 v16,s[28:31],s62 offen lds
s_add_u32 s62,s62,32768
s_add_u32 m0,m0,1024
s_nop 0
buffer_load_dwordx4 v16,s[28:31],s62 offen lds
s_add_u32 s62,s62,32768
s_add_u32 m0,m0,1024
s_nop 0
buffer_load_dwordx4 v16,s[28:31],s62 offen lds
s_add_u32 s62,s62,32768
s_add_u32 m0,m0,1024
s_nop 0
buffer_load_dwordx4 v16,s[28:31],s62 offen lds
s_add_u32 s62,s62,32768
s_add_u32 m0,m0,1024
s_nop 0
buffer_load_dwordx4 v16,s[28:31],s62 offen lds
s_add_u32 s62,s62,32768
s_add_u32 m0,m0,1024
s_nop 0
buffer_load_dwordx4 v16,s[28:31],s62 offen lds
s_add_u32 s62,s62,32768
s_add_u32 m0,m0,1024
s_nop 0
buffer_load_dwordx4 v16,s[28:31],s62 offen lds
s_add_u32 s62,s62,32768
s_add_u32 m0,m0,1024
s_nop 0
buffer_load_dwordx4 v16,s[28:31],s62 offen lds
s_add_u32 s62,s62,32768
s_add_u32 m0,m0,1024
s_nop 0
buffer_load_dwordx4 v16,s[28:31],s62 offen lds
s_add_u32 s62,s62,32768
s_add_u32 m0,m0,1024
s_nop 0
buffer_load_dwordx4 v16,s[28:31],s62 offen lds
s_add_u32 s62,s62,32768
s_add_u32 m0,m0,1024
s_nop 0
buffer_load_dwordx4 v16,s[28:31],s62 offen lds
s_add_u32 s62,s62,32768
s_add_u32 m0,m0,1024
s_nop 0
buffer_load_dwordx4 v16,s[28:31],s62 offen lds
s_add_u32 s62,s62,32768
s_add_u32 m0,m0,1024
s_nop 0
buffer_load_dwordx4 v16,s[28:31],s62 offen lds
s_waitcnt vmcnt(16)
ds_read_b64_tr_b16 a[64:65],v17 offset:16384
ds_read_b64_tr_b16 a[66:67],v17 offset:16640
ds_read_b64_tr_b16 a[68:69],v17 offset:16392
ds_read_b64_tr_b16 a[70:71],v17 offset:16648
ds_read_b64_tr_b16 a[72:73],v17 offset:18432
ds_read_b64_tr_b16 a[74:75],v17 offset:18688
ds_read_b64_tr_b16 a[76:77],v17 offset:18440
ds_read_b64_tr_b16 a[78:79],v17 offset:18696
ds_read_b64_tr_b16 a[80:81],v17 offset:20480
ds_read_b64_tr_b16 a[82:83],v17 offset:20736
ds_read_b64_tr_b16 a[84:85],v17 offset:20488
ds_read_b64_tr_b16 a[86:87],v17 offset:20744
s_waitcnt lgkmcnt(0)
ds_read_b64_tr_b16 a[88:89],v17 offset:22528
ds_read_b64_tr_b16 a[90:91],v17 offset:22784
ds_read_b64_tr_b16 a[92:93],v17 offset:22536
ds_read_b64_tr_b16 a[94:95],v17 offset:22792
ds_read_b64_tr_b16 a[96:97],v17 offset:24576
ds_read_b64_tr_b16 a[98:99],v17 offset:24832
ds_read_b64_tr_b16 a[100:101],v17 offset:24584
ds_read_b64_tr_b16 a[102:103],v17 offset:24840
ds_read_b64_tr_b16 a[104:105],v17 offset:26624
ds_read_b64_tr_b16 a[106:107],v17 offset:26880
ds_read_b64_tr_b16 a[108:109],v17 offset:26632
ds_read_b64_tr_b16 a[110:111],v17 offset:26888
s_waitcnt lgkmcnt(0)
ds_read_b64_tr_b16 a[112:113],v17 offset:28672
ds_read_b64_tr_b16 a[114:115],v17 offset:28928
ds_read_b64_tr_b16 a[116:117],v17 offset:28680
ds_read_b64_tr_b16 a[118:119],v17 offset:28936
ds_read_b64_tr_b16 a[120:121],v17 offset:30720
ds_read_b64_tr_b16 a[122:123],v17 offset:30976
ds_read_b64_tr_b16 a[124:125],v17 offset:30728
ds_read_b64_tr_b16 a[126:127],v17 offset:30984
s_waitcnt lgkmcnt(0)
s_xor_b32 s62,s50,3
s_mul_i32 s62,s62,524288
s_add_u32 s62,s62,s54
s_add_u32 m0,s61,16384
s_nop 0
buffer_load_dwordx4 v16,s[28:31],s62 offen lds
s_add_u32 s62,s62,32768
s_add_u32 m0,m0,1024
s_nop 0
buffer_load_dwordx4 v16,s[28:31],s62 offen lds
s_add_u32 s62,s62,32768
s_add_u32 m0,m0,1024
s_nop 0
buffer_load_dwordx4 v16,s[28:31],s62 offen lds
s_add_u32 s62,s62,32768
s_add_u32 m0,m0,1024
s_nop 0
buffer_load_dwordx4 v16,s[28:31],s62 offen lds
s_add_u32 s62,s62,32768
s_add_u32 m0,m0,1024
s_nop 0
buffer_load_dwordx4 v16,s[28:31],s62 offen lds
s_add_u32 s62,s62,32768
s_add_u32 m0,m0,1024
s_nop 0
buffer_load_dwordx4 v16,s[28:31],s62 offen lds
s_add_u32 s62,s62,32768
s_add_u32 m0,m0,1024
s_nop 0
buffer_load_dwordx4 v16,s[28:31],s62 offen lds
s_add_u32 s62,s62,32768
s_add_u32 m0,m0,1024
s_nop 0
buffer_load_dwordx4 v16,s[28:31],s62 offen lds
s_add_u32 s62,s62,32768
s_add_u32 m0,m0,1024
s_nop 0
buffer_load_dwordx4 v16,s[28:31],s62 offen lds
s_add_u32 s62,s62,32768
s_add_u32 m0,m0,1024
s_nop 0
buffer_load_dwordx4 v16,s[28:31],s62 offen lds
s_add_u32 s62,s62,32768
s_add_u32 m0,m0,1024
s_nop 0
buffer_load_dwordx4 v16,s[28:31],s62 offen lds
s_add_u32 s62,s62,32768
s_add_u32 m0,m0,1024
s_nop 0
buffer_load_dwordx4 v16,s[28:31],s62 offen lds
s_add_u32 s62,s62,32768
s_add_u32 m0,m0,1024
s_nop 0
buffer_load_dwordx4 v16,s[28:31],s62 offen lds
s_add_u32 s62,s62,32768
s_add_u32 m0,m0,1024
s_nop 0
buffer_load_dwordx4 v16,s[28:31],s62 offen lds
s_add_u32 s62,s62,32768
s_add_u32 m0,m0,1024
s_nop 0
buffer_load_dwordx4 v16,s[28:31],s62 offen lds
s_add_u32 s62,s62,32768
s_add_u32 m0,m0,1024
s_nop 0
buffer_load_dwordx4 v16,s[28:31],s62 offen lds
s_waitcnt vmcnt(16)
ds_read_b64_tr_b16 a[128:129],v17 offset:0
ds_read_b64_tr_b16 a[130:131],v17 offset:256
ds_read_b64_tr_b16 a[132:133],v17 offset:8
ds_read_b64_tr_b16 a[134:135],v17 offset:264
ds_read_b64_tr_b16 a[136:137],v17 offset:2048
ds_read_b64_tr_b16 a[138:139],v17 offset:2304
ds_read_b64_tr_b16 a[140:141],v17 offset:2056
ds_read_b64_tr_b16 a[142:143],v17 offset:2312
ds_read_b64_tr_b16 a[144:145],v17 offset:4096
ds_read_b64_tr_b16 a[146:147],v17 offset:4352
ds_read_b64_tr_b16 a[148:149],v17 offset:4104
ds_read_b64_tr_b16 a[150:151],v17 offset:4360
s_waitcnt lgkmcnt(0)
ds_read_b64_tr_b16 a[152:153],v17 offset:6144
ds_read_b64_tr_b16 a[154:155],v17 offset:6400
ds_read_b64_tr_b16 a[156:157],v17 offset:6152
ds_read_b64_tr_b16 a[158:159],v17 offset:6408
ds_read_b64_tr_b16 a[160:161],v17 offset:8192
ds_read_b64_tr_b16 a[162:163],v17 offset:8448
ds_read_b64_tr_b16 a[164:165],v17 offset:8200
ds_read_b64_tr_b16 a[166:167],v17 offset:8456
ds_read_b64_tr_b16 a[168:169],v17 offset:10240
ds_read_b64_tr_b16 a[170:171],v17 offset:10496
ds_read_b64_tr_b16 a[172:173],v17 offset:10248
ds_read_b64_tr_b16 a[174:175],v17 offset:10504
s_waitcnt lgkmcnt(0)
ds_read_b64_tr_b16 a[176:177],v17 offset:12288
ds_read_b64_tr_b16 a[178:179],v17 offset:12544
ds_read_b64_tr_b16 a[180:181],v17 offset:12296
ds_read_b64_tr_b16 a[182:183],v17 offset:12552
ds_read_b64_tr_b16 a[184:185],v17 offset:14336
ds_read_b64_tr_b16 a[186:187],v17 offset:14592
ds_read_b64_tr_b16 a[188:189],v17 offset:14344
ds_read_b64_tr_b16 a[190:191],v17 offset:14600
s_waitcnt lgkmcnt(0)
s_waitcnt vmcnt(0)
ds_read_b64_tr_b16 a[192:193],v17 offset:16384
ds_read_b64_tr_b16 a[194:195],v17 offset:16640
ds_read_b64_tr_b16 a[196:197],v17 offset:16392
ds_read_b64_tr_b16 a[198:199],v17 offset:16648
ds_read_b64_tr_b16 a[200:201],v17 offset:18432
ds_read_b64_tr_b16 a[202:203],v17 offset:18688
ds_read_b64_tr_b16 a[204:205],v17 offset:18440
ds_read_b64_tr_b16 a[206:207],v17 offset:18696
ds_read_b64_tr_b16 a[208:209],v17 offset:20480
ds_read_b64_tr_b16 a[210:211],v17 offset:20736
ds_read_b64_tr_b16 a[212:213],v17 offset:20488
ds_read_b64_tr_b16 a[214:215],v17 offset:20744
s_waitcnt lgkmcnt(0)
ds_read_b64_tr_b16 a[216:217],v17 offset:22528
ds_read_b64_tr_b16 a[218:219],v17 offset:22784
ds_read_b64_tr_b16 a[220:221],v17 offset:22536
ds_read_b64_tr_b16 a[222:223],v17 offset:22792
ds_read_b64_tr_b16 a[224:225],v17 offset:24576
ds_read_b64_tr_b16 a[226:227],v17 offset:24832
ds_read_b64_tr_b16 a[228:229],v17 offset:24584
ds_read_b64_tr_b16 a[230:231],v17 offset:24840
ds_read_b64_tr_b16 a[232:233],v17 offset:26624
ds_read_b64_tr_b16 a[234:235],v17 offset:26880
ds_read_b64_tr_b16 a[236:237],v17 offset:26632
ds_read_b64_tr_b16 a[238:239],v17 offset:26888
s_waitcnt lgkmcnt(0)
ds_read_b64_tr_b16 a[240:241],v17 offset:28672
ds_read_b64_tr_b16 a[242:243],v17 offset:28928
ds_read_b64_tr_b16 a[244:245],v17 offset:28680
ds_read_b64_tr_b16 a[246:247],v17 offset:28936
ds_read_b64_tr_b16 a[248:249],v17 offset:30720
ds_read_b64_tr_b16 a[250:251],v17 offset:30976
ds_read_b64_tr_b16 a[252:253],v17 offset:30728
ds_read_b64_tr_b16 a[254:255],v17 offset:30984
s_waitcnt lgkmcnt(0)
s_mov_b32 s67,0
s_cmp_eq_u32 s56,1
s_cbranch_scc1 vok_137
v_mbcnt_lo_u32_b32 v16,-1,0
v_and_b32 v16,7,v16
v_lshlrev_b32 v16,7,v16
s_mov_b32 s64,138510336
vpoll_138:
buffer_load_dword v17,v16,s[20:23],s64 offen sc1
s_waitcnt vmcnt(0)
v_readlane_b32 s92,v17,0
v_readlane_b32 s93,v17,1
v_readlane_b32 s94,v17,2
v_readlane_b32 s95,v17,3
v_readlane_b32 s96,v17,4
v_readlane_b32 s97,v17,5
v_readlane_b32 s98,v17,6
v_readlane_b32 s99,v17,7
s_add_u32 s65,s92,s93
s_add_u32 s65,s65,s94
s_add_u32 s65,s65,s95
s_add_u32 s65,s65,s96
s_add_u32 s65,s65,s97
s_add_u32 s65,s65,s98
s_add_u32 s65,s65,s99
s_cmp_ge_u32 s65,256
s_cbranch_scc1 vgot_139
s_sleep 4
s_sub_u32 s90,s90,1
s_cmp_gt_i32 s90,0
s_cbranch_scc1 vpoll_138
vgot_139:
s_min_u32 s65,s92,s93
s_min_u32 s65,s65,s94
s_min_u32 s65,s65,s95
s_min_u32 s65,s65,s96
s_min_u32 s65,s65,s97
s_min_u32 s65,s65,s98
s_min_u32 s65,s65,s99
s_cmp_lt_u32 s65,32
s_cbranch_scc1 fl_slow
s_mov_b32 s56,0
vok_137:
s_barrier
v_lshlrev_b32 v0,4,v1
s_mov_b32 s60,0
s_mov_b32 s70,0
s_mov_b32 s55,0
s_lshl_b32 s63,s50,13
v_mov_b32 v3,v0
s_mov_b32 s73,0xffff0000
s_lshl_b32 s64,s52,2
s_add_u32 s64,s64,s50
s_mul_i32 s61,s64,8192
s_add_u32 s61,s61,209747968
s_lshl_b32 s82,s64,8
s_add_u32 s82,s82,138549248
s_mov_b32 s68,s82
s_lshl_b32 s83,s53,2
s_add_u32 s83,s83,s50
s_xor_b32 s64,s50,0
s_lshl_b32 s64,s64,13
v_add_u32 v8,s64,v0
s_xor_b32 s64,s50,1
s_lshl_b32 s64,s64,13
v_add_u32 v9,s64,v0
s_xor_b32 s64,s50,2
s_lshl_b32 s64,s64,13
v_add_u32 v10,s64,v0
s_xor_b32 s64,s50,3
s_lshl_b32 s64,s64,13
v_add_u32 v11,s64,v0
v_min_u32 v2,7,v1
v_lshlrev_b32 v2,2,v2
s_lshr_b32 s64,s50,1
s_add_u32 s64,s64,1
s_sub_u32 s65,0,s64
s_bitcmp1_b32 s50,0
s_cselect_b32 s64,s64,s65
s_add_u32 s64,s64,16
v_add_u32 v26,s64,v21
v_lshrrev_b32 v27,4,v26
v_and_b32 v26,15,v26
v_lshl_add_u32 v26,v22,4,v26
v_lshlrev_b32 v26,4,v26
v_lshl_add_u32 v3,v27,15,v26
s_sub_u32 s61,s61,32768
s_lshl_b32 s66,s83,10
s_lshr_b32 s65,s83,3
s_lshl_b32 s65,s65,8
s_and_b32 s64,s83,7
s_lshl_b32 s64,s64,2
s_add_u32 s69,s64,s65
s_add_u32 s69,s69,138550272
s_add_u32 s71,s60,1
s_and_b32 s64,s50,1
s_add_u32 s71,s71,s64
s_min_u32 s71,s71,128
s_cmp_ge_u32 s60,128
s_cselect_b32 s71,-1,s71
plp_147:
buffer_load_dword v16,v2,s[20:23],s68 offen sc1
s_waitcnt vmcnt(0)
v_cmp_gt_u32 vcc,s71,v16
s_cbranch_vccz pok_148
s_sleep 4
s_sub_u32 s90,s90,1
s_cmp_gt_i32 s90,0
s_cbranch_scc1 plp_147
pok_148:
lag_146:
s_add_u32 m0,s70,s63
s_add_u32 s62,s61,4096
buffer_load_dwordx4 v3,s[20:23],s61 offen offset:0 lds
buffer_load_dwordx4 v3,s[20:23],s61 offen offset:1024 lds
buffer_load_dwordx4 v3,s[20:23],s61 offen offset:2048 lds
buffer_load_dwordx4 v3,s[20:23],s61 offen offset:3072 lds
s_add_u32 m0,m0,4096
s_nop 0
buffer_load_dwordx4 v3,s[20:23],s62 offen offset:0 lds
buffer_load_dwordx4 v3,s[20:23],s62 offen offset:1024 lds
buffer_load_dwordx4 v3,s[20:23],s62 offen offset:2048 lds
buffer_load_dwordx4 v3,s[20:23],s62 offen offset:3072 lds
s_add_u32 s61,s61,32768
s_add_u32 s70,s70,32768
s_and_b32 s70,s70,0x1ffff
buffer_load_dword v17,off,s[20:23],s69
top_142:
s_add_u32 s71,s60,2
s_and_b32 s64,s50,1
s_add_u32 s71,s71,s64
s_min_u32 s71,s71,128
s_cmp_ge_u32 s60,127
s_cselect_b32 s71,-1,s71
buffer_load_dword v16,v2,s[20:23],s68 offen sc1
s_add_u32 s64,s66,205520896
buffer_load_dwordx4 v[160:163],v0,s[20:23],s64 offen
v_add_u32 v4,s55,v8
v_add_u32 v5,s55,v9
v_add_u32 v6,s55,v10
v_add_u32 v7,s55,v11
s_add_u32 s55,s55,32768
s_and_b32 s55,s55,0x1ffff
s_waitcnt vmcnt(10)
ds_read_b128 v[64:67],v4 offset:0
s_waitcnt vmcnt(9)
ds_read_b128 v[68:71],v4 offset:1024
s_waitcnt vmcnt(8)
ds_read_b128 v[72:75],v4 offset:2048
s_waitcnt lgkmcnt(2)
v_mfma_f32_16x16x32_bf16 v[32:35],a[0:3],v[64:67],0
v_mfma_f32_16x16x32_bf16 v[36:39],a[4:7],v[64:67],0
s_waitcnt vmcnt(7)
ds_read_b128 v[76:79],v4 offset:3072
s_waitcnt lgkmcnt(2)
v_mfma_f32_16x16x32_bf16 v[32:35],a[8:11],v[68:71],v[32:35]
v_mfma_f32_16x16x32_bf16 v[36:39],a[12:15],v[68:71],v[36:39]
s_waitcnt vmcnt(6)
ds_read_b128 v[80:83],v4 offset:4096
s_waitcnt lgkmcnt(2)
v_mfma_f32_16x16x32_bf16 v[32:35],a[16:19],v[72:75],v[32:35]
v_mfma_f32_16x16x32_bf16 v[36:39],a[20:23],v[72:75],v[36:39]
s_waitcnt vmcnt(5)
ds_read_b128 v[84:87],v4 offset:5120
s_waitcnt lgkmcnt(2)
v_mfma_f32_16x16x32_bf16 v[32:35],a[24:27],v[76:79],v[32:35]
v_mfma_f32_16x16x32_bf16 v[36:39],a[28:31],v[76:79],v[36:39]
s_waitcnt vmcnt(4)
ds_read_b128 v[88:91],v4 offset:6144
s_waitcnt lgkmcnt(2)
v_mfma_f32_16x16x32_bf16 v[32:35],a[32:35],v[80:83],v[32:35]
v_mfma_f32_16x16x32_bf16 v[36:39],a[36:39],v[80:83],v[36:39]
s_waitcnt vmcnt(3)
ds_read_b128 v[92:95],v4 offset:7168
s_barrier
s_waitcnt lgkmcnt(2)
v_mfma_f32_16x16x32_bf16 v[32:35],a[40:43],v[84:87],v[32:35]
v_mfma_f32_16x16x32_bf16 v[36:39],a[44:47],v[84:87],v[36:39]
ds_read_b128 v[96:99],v5 offset:0
s_waitcnt lgkmcnt(2)
v_mfma_f32_16x16x32_bf16 v[32:35],a[48:51],v[88:91],v[32:35]
ds_read_b128 v[100:103],v5 offset:1024
ds_read_b128 v[104:107],v5 offset:2048
v_mfma_f32_16x16x32_bf16 v[36:39],a[52:55],v[88:91],v[36:39]
s_waitcnt lgkmcnt(3)
v_mfma_f32_16x16x32_bf16 v[32:35],a[56:59],v[92:95],v[32:35]
ds_read_b128 v[108:111],v5 offset:3072
ds_read_b128 v[112:115],v5 offset:4096
v_mfma_f32_16x16x32_bf16 v[36:39],a[60:63],v[92:95],v[36:39]
s_waitcnt lgkmcnt(4)
v_mfma_f32_16x16x32_bf16 v[32:35],a[64:67],v[96:99],v[32:35]
ds_read_b128 v[116:119],v5 offset:5120
ds_read_b128 v[120:123],v5 offset:6144
v_mfma_f32_16x16x32_bf16 v[36:39],a[68:71],v[96:99],v[36:39]
s_waitcnt lgkmcnt(5)
v_mfma_f32_16x16x32_bf16 v[32:35],a[72:75],v[100:103],v[32:35]
ds_read_b128 v[124:127],v5 offset:7168
v_mfma_f32_16x16x32_bf16 v[36:39],a[76:79],v[100:103],v[36:39]
s_waitcnt lgkmcnt(5)
v_mfma_f32_16x16x32_bf16 v[32:35],a[80:83],v[104:107],v[32:35]
ds_read_b128 v[64:67],v6 offset:0
v_mfma_f32_16x16x32_bf16 v[36:39],a[84:87],v[104:107],v[36:39]
s_waitcnt lgkmcnt(5)
v_mfma_f32_16x16x32_bf16 v[32:35],a[88:91],v[108:111],v[32:35]
ds_read_b128 v[68:71],v6 offset:1024
v_mfma_f32_16x16x32_bf16 v[36:39],a[92:95],v[108:111],v[36:39]
s_waitcnt lgkmcnt(5)
v_mfma_f32_16x16x32_bf16 v[32:35],a[96:99],v[112:115],v[32:35]
ds_read_b128 v[72:75],v6 offset:2048
v_mfma_f32_16x16x32_bf16 v[36:39],a[100:103],v[112:115],v[36:39]
s_waitcnt lgkmcnt(5)
v_mfma_f32_16x16x32_bf16 v[32:35],a[104:107],v[116:119],v[32:35]
ds_read_b128 v[76:79],v6 offset:3072
v_mfma_f32_16x16x32_bf16 v[36:39],a[108:111],v[116:119],v[36:39]
s_waitcnt lgkmcnt(5)
v_mfma_f32_16x16x32_bf16 v[32:35],a[112:115],v[120:123],v[32:35]
ds_read_b128 v[80:83],v6 offset:4096
v_mfma_f32_16x16x32_bf16 v[36:39],a[116:119],v[120:123],v[36:39]
s_waitcnt lgkmcnt(5)
v_mfma_f32_16x16x32_bf16 v[32:35],a[120:123],v[124:127],v[32:35]
ds_read_b128 v[84:87],v6 offset:5120
v_mfma_f32_16x16x32_bf16 v[36:39],a[124:127],v[124:127],v[36:39]
s_waitcnt lgkmcnt(5)
v_mfma_f32_16x16x32_bf16 v[32:35],a[128:131],v[64:67],v[32:35]
ds_read_b128 v[88:91],v6 offset:6144
v_mfma_f32_16x16x32_bf16 v[36:39],a[132:135],v[64:67],v[36:39]
s_waitcnt lgkmcnt(5)
v_mfma_f32_16x16x32_bf16 v[32:35],a[136:139],v[68:71],v[32:35]
ds_read_b128 v[92:95],v6 offset:7168
v_mfma_f32_16x16x32_bf16 v[36:39],a[140:143],v[68:71],v[36:39]
s_waitcnt lgkmcnt(5)
v_mfma_f32_16x16x32_bf16 v[32:35],a[144:147],v[72:75],v[32:35]
ds_read_b128 v[96:99],v7 offset:0
v_mfma_f32_16x16x32_bf16 v[36:39],a[148:151],v[72:75],v[36:39]
s_waitcnt lgkmcnt(5)
v_mfma_f32_16x16x32_bf16 v[32:35],a[152:155],v[76:79],v[32:35]
ds_read_b128 v[100:103],v7 offset:1024
v_mfma_f32_16x16x32_bf16 v[36:39],a[156:159],v[76:79],v[36:39]
s_waitcnt lgkmcnt(5)
v_mfma_f32_16x16x32_bf16 v[32:35],a[160:163],v[80:83],v[32:35]
ds_read_b128 v[104:107],v7 offset:2048
v_mfma_f32_16x16x32_bf16 v[36:39],a[164:167],v[80:83],v[36:39]
s_waitcnt lgkmcnt(5)
v_mfma_f32_16x16x32_bf16 v[32:35],a[168:171],v[84:87],v[32:35]
ds_read_b128 v[108:111],v7 offset:3072
v_mfma_f32_16x16x32_bf16 v[36:39],a[172:175],v[84:87],v[36:39]
s_waitcnt vmcnt(0)
v_mov_b32 v17,s60
s_mov_b64 exec,1
buffer_store_dword v17,off,s[20:23],s69 sc1
s_mov_b64 exec,-1
v_cmp_gt_u32 vcc,s71,v16
s_cbranch_vccnz vN_143
s_waitcnt lgkmcnt(5)
v_mfma_f32_16x16x32_bf16 v[32:35],a[176:179],v[88:91],v[32:35]
ds_read_b128 v[112:115],v7 offset:4096
s_add_u32 m0,s70,s63
v_mfma_f32_16x16x32_bf16 v[36:39],a[180:183],v[88:91],v[36:39]
s_add_u32 s62,s61,4096
s_waitcnt lgkmcnt(5)
v_mfma_f32_16x16x32_bf16 v[32:35],a[184:187],v[92:95],v[32:35]
ds_read_b128 v[116:119],v7 offset:5120
buffer_load_dwordx4 v3,s[20:23],s61 offen offset:0 lds
v_mfma_f32_16x16x32_bf16 v[36:39],a[188:191],v[92:95],v[36:39]
buffer_load_dwordx4 v3,s[20:23],s61 offen offset:1024 lds
s_waitcnt lgkmcnt(5)
v_mfma_f32_16x16x32_bf16 v[32:35],a[192:195],v[96:99],v[32:35]
ds_read_b128 v[120:123],v7 offset:6144
buffer_load_dwordx4 v3,s[20:23],s61 offen offset:2048 lds
v_mfma_f32_16x16x32_bf16 v[36:39],a[196:199],v[96:99],v[36:39]
buffer_load_dwordx4 v3,s[20:23],s61 offen offset:3072 lds
s_waitcnt lgkmcnt(5)
v_mfma_f32_16x16x32_bf16 v[32:35],a[200:203],v[100:103],v[32:35]
ds_read_b128 v[124:127],v7 offset:7168
s_add_u32 m0,m0,4096
v_mfma_f32_16x16x32_bf16 v[36:39],a[204:207],v[100:103],v[36:39]
buffer_load_dwordx4 v3,s[20:23],s62 offen offset:0 lds
s_waitcnt lgkmcnt(5)
v_mfma_f32_16x16x32_bf16 v[32:35],a[208:211],v[104:107],v[32:35]
buffer_load_dwordx4 v3,s[20:23],s62 offen offset:1024 lds
v_mfma_f32_16x16x32_bf16 v[36:39],a[212:215],v[104:107],v[36:39]
buffer_load_dwordx4 v3,s[20:23],s62 offen offset:2048 lds
s_waitcnt lgkmcnt(4)
v_mfma_f32_16x16x32_bf16 v[32:35],a[216:219],v[108:111],v[32:35]
buffer_load_dwordx4 v3,s[20:23],s62 offen offset:3072 lds
v_mfma_f32_16x16x32_bf16 v[36:39],a[220:223],v[108:111],v[36:39]
s_add_u32 s61,s61,32768
s_waitcnt lgkmcnt(3)
v_mfma_f32_16x16x32_bf16 v[32:35],a[224:227],v[112:115],v[32:35]
s_add_u32 s70,s70,32768
v_mfma_f32_16x16x32_bf16 v[36:39],a[228:231],v[112:115],v[36:39]
s_and_b32 s70,s70,0x1ffff
s_waitcnt lgkmcnt(2)
v_mfma_f32_16x16x32_bf16 v[32:35],a[232:235],v[116:119],v[32:35]
v_mfma_f32_16x16x32_bf16 v[36:39],a[236:239],v[116:119],v[36:39]
s_waitcnt lgkmcnt(1)
v_mfma_f32_16x16x32_bf16 v[32:35],a[240:243],v[120:123],v[32:35]
v_mfma_f32_16x16x32_bf16 v[36:39],a[244:247],v[120:123],v[36:39]
s_waitcnt lgkmcnt(0)
v_mfma_f32_16x16x32_bf16 v[32:35],a[248:251],v[124:127],v[32:35]
v_mfma_f32_16x16x32_bf16 v[36:39],a[252:255],v[124:127],v[36:39]
s_mov_b32 s72,1
join_144:
v_lshlrev_b32 v168,16,v160
v_and_b32 v169,s73,v160
v_lshlrev_b32 v170,16,v161
v_and_b32 v171,s73,v161
v_lshlrev_b32 v172,16,v162
v_and_b32 v173,s73,v162
v_lshlrev_b32 v174,16,v163
v_and_b32 v175,s73,v163
v_add_f32 v32,v32,v168
v_add_f32 v33,v33,v169
v_add_f32 v34,v34,v170
v_add_f32 v35,v35,v171
v_add_f32 v36,v36,v172
v_add_f32 v37,v37,v173
v_add_f32 v38,v38,v174
v_add_f32 v39,v39,v175
v_cvt_pk_bf16_f32 v176,v32,v33
v_cvt_pk_bf16_f32 v177,v34,v35
v_cvt_pk_bf16_f32 v178,v36,v37
v_cvt_pk_bf16_f32 v179,v38,v39
s_add_u32 s64,s66,214958080
buffer_store_dwordx4 v[176:179],v0,s[20:23],s64 offen sc1
s_add_u32 s66,s66,32768
s_add_u32 s60,s60,1
s_cmp_eq_u32 s72,0
s_cbranch_scc1 slowp_145
s_branch top_142
slowp_145:
s_waitcnt vmcnt(1)
v_cmp_gt_u32 vcc,s71,v16
s_cbranch_vccz lag_146
s_waitcnt vmcnt(0)
v_mov_b32 v17,s60
s_mov_b64 exec,1
buffer_store_dword v17,off,s[20:23],s69 sc1
s_mov_b64 exec,-1
s_cmp_ge_u32 s60,128
s_cbranch_scc1 done_136
plp_149:
buffer_load_dword v16,v2,s[20:23],s68 offen sc1
s_waitcnt vmcnt(0)
v_cmp_gt_u32 vcc,s71,v16
s_cbranch_vccz pok_150
s_sleep 4
s_sub_u32 s90,s90,1
s_cmp_gt_i32 s90,0
s_cbranch_scc1 plp_149
pok_150:
s_branch lag_146
vN_143:
buffer_load_dword v16,v2,s[20:23],s68 offen sc1
s_waitcnt lgkmcnt(5)
v_mfma_f32_16x16x32_bf16 v[32:35],a[176:179],v[88:91],v[32:35]
ds_read_b128 v[112:115],v7 offset:4096
v_mfma_f32_16x16x32_bf16 v[36:39],a[180:183],v[88:91],v[36:39]
s_waitcnt lgkmcnt(5)
v_mfma_f32_16x16x32_bf16 v[32:35],a[184:187],v[92:95],v[32:35]
ds_read_b128 v[116:119],v7 offset:5120
v_mfma_f32_16x16x32_bf16 v[36:39],a[188:191],v[92:95],v[36:39]
s_waitcnt lgkmcnt(5)
v_mfma_f32_16x16x32_bf16 v[32:35],a[192:195],v[96:99],v[32:35]
ds_read_b128 v[120:123],v7 offset:6144
v_mfma_f32_16x16x32_bf16 v[36:39],a[196:199],v[96:99],v[36:39]
s_waitcnt lgkmcnt(5)
v_mfma_f32_16x16x32_bf16 v[32:35],a[200:203],v[100:103],v[32:35]
ds_read_b128 v[124:127],v7 offset:7168
v_mfma_f32_16x16x32_bf16 v[36:39],a[204:207],v[100:103],v[36:39]
s_waitcnt lgkmcnt(5)
v_mfma_f32_16x16x32_bf16 v[32:35],a[208:211],v[104:107],v[32:35]
v_mfma_f32_16x16x32_bf16 v[36:39],a[212:215],v[104:107],v[36:39]
s_waitcnt lgkmcnt(4)
v_mfma_f32_16x16x32_bf16 v[32:35],a[216:219],v[108:111],v[32:35]
v_mfma_f32_16x16x32_bf16 v[36:39],a[220:223],v[108:111],v[36:39]
s_waitcnt lgkmcnt(3)
v_mfma_f32_16x16x32_bf16 v[32:35],a[224:227],v[112:115],v[32:35]
v_mfma_f32_16x16x32_bf16 v[36:39],a[228:231],v[112:115],v[36:39]
s_waitcnt lgkmcnt(2)
v_mfma_f32_16x16x32_bf16 v[32:35],a[232:235],v[116:119],v[32:35]
v_mfma_f32_16x16x32_bf16 v[36:39],a[236:239],v[116:119],v[36:39]
s_waitcnt lgkmcnt(1)
v_mfma_f32_16x16x32_bf16 v[32:35],a[240:243],v[120:123],v[32:35]
v_mfma_f32_16x16x32_bf16 v[36:39],a[244:247],v[120:123],v[36:39]
s_waitcnt lgkmcnt(0)
v_mfma_f32_16x16x32_bf16 v[32:35],a[248:251],v[124:127],v[32:35]
v_mfma_f32_16x16x32_bf16 v[36:39],a[252:255],v[124:127],v[36:39]
s_mov_b32 s72,0
s_branch join_144
done_136:
s_endpgm
fl_ln2:
s_mov_b32 s52,s59
s_mov_b32 s60,0
s_mov_b32 s73,0xffff0000
v_and_b32 v2,3,v1
v_lshrrev_b32 v3,2,v1
s_lshl_b32 s64,s52,2
v_add_u32 v4,s64,v2
s_lshl_b32 s65,s50,9
v_lshlrev_b32 v5,4,v3
v_add_u32 v5,s65,v5
v_lshl_add_u32 v8,v4,11,v5
v_lshlrev_b32 v9,1,v5
v_lshrrev_b32 v5,2,v3
v_and_b32 v3,3,v3
s_lshl_b32 s65,s50,13
v_lshlrev_b32 v5,10,v5
v_lshl_add_u32 v5,v3,8,v5
v_lshl_add_u32 v5,v4,4,v5
v_add_u32 v10,s65,v5
s_lshl_b32 s65,s50,9
v_lshlrev_b32 v5,3,v1
v_add_u32 v11,s65,v5
v_lshlrev_b32 v12,3,v2
v_and_b32 v13,7,v1
v_lshlrev_b32 v13,2,v13
s_mov_b32 s65,267403264
buffer_load_dwordx4 v[32:35],v9,s[20:23],s65 offen offset:0
buffer_load_dwordx4 v[36:39],v9,s[20:23],s65 offen offset:16
buffer_load_dwordx4 v[40:43],v9,s[20:23],s65 offen offset:512
buffer_load_dwordx4 v[44:47],v9,s[20:23],s65 offen offset:528
s_mov_b32 s66,267399168
buffer_load_dwordx4 v[48:51],v9,s[20:23],s66 offen offset:0
buffer_load_dwordx4 v[52:55],v9,s[20:23],s66 offen offset:16
buffer_load_dwordx4 v[56:59],v9,s[20:23],s66 offen offset:512
buffer_load_dwordx4 v[60:63],v9,s[20:23],s66 offen offset:528
s_waitcnt vmcnt(0)
v_add_f32 v32,1.0,v32
v_add_f32 v33,1.0,v33
v_add_f32 v34,1.0,v34
v_add_f32 v35,1.0,v35
v_add_f32 v36,1.0,v36
v_add_f32 v37,1.0,v37
v_add_f32 v38,1.0,v38
v_add_f32 v39,1.0,v39
v_add_f32 v40,1.0,v40
v_add_f32 v41,1.0,v41
v_add_f32 v42,1.0,v42
v_add_f32 v43,1.0,v43
v_add_f32 v44,1.0,v44
v_add_f32 v45,1.0,v45
v_add_f32 v46,1.0,v46
v_add_f32 v47,1.0,v47
s_add_u32 s65,s59,s50
s_cmp_lg_u32 s65,0
s_cbranch_scc1 nomeas_152
s_mov_b64 exec,1
s_mov_b32 s92,138526720
s_mov_b32 s93,138534912
s_mov_b32 s70,0x7fffffff
s_mov_b32 s71,0x7fffffff
s_memtime s[94:95]
s_waitcnt lgkmcnt(0)
buffer_store_dword v15,off,s[20:23],s92 sc1
s_waitcnt vmcnt(0)
s_memtime s[96:97]
s_waitcnt lgkmcnt(0)
s_sub_u32 s96,s96,s94
s_min_u32 s70,s70,s96
s_memtime s[94:95]
s_waitcnt lgkmcnt(0)
buffer_store_dword v15,off,s[20:23],s93 sc1
s_waitcnt vmcnt(0)
s_memtime s[96:97]
s_waitcnt lgkmcnt(0)
s_sub_u32 s96,s96,s94
s_min_u32 s71,s71,s96
s_memtime s[94:95]
s_waitcnt lgkmcnt(0)
buffer_store_dword v15,off,s[20:23],s92 sc1
s_waitcnt vmcnt(0)
s_memtime s[96:97]
s_waitcnt lgkmcnt(0)
s_sub_u32 s96,s96,s94
s_min_u32 s70,s70,s96
s_memtime s[94:95]
s_waitcnt lgkmcnt(0)
buffer_store_dword v15,off,s[20:23],s93 sc1
s_waitcnt vmcnt(0)
s_memtime s[96:97]
s_waitcnt lgkmcnt(0)
s_sub_u32 s96,s96,s94
s_min_u32 s71,s71,s96
s_memtime s[94:95]
s_waitcnt lgkmcnt(0)
buffer_store_dword v15,off,s[20:23],s92 sc1
s_waitcnt vmcnt(0)
s_memtime s[96:97]
s_waitcnt lgkmcnt(0)
s_sub_u32 s96,s96,s94
s_min_u32 s70,s70,s96
s_memtime s[94:95]
s_waitcnt lgkmcnt(0)
buffer_store_dword v15,off,s[20:23],s93 sc1
s_waitcnt vmcnt(0)
s_memtime s[96:97]
s_waitcnt lgkmcnt(0)
s_sub_u32 s96,s96,s94
s_min_u32 s71,s71,s96
s_memtime s[94:95]
s_waitcnt lgkmcnt(0)
buffer_store_dword v15,off,s[20:23],s92 sc1
s_waitcnt vmcnt(0)
s_memtime s[96:97]
s_waitcnt lgkmcnt(0)
s_sub_u32 s96,s96,s94
s_min_u32 s70,s70,s96
s_memtime s[94:95]
s_waitcnt lgkmcnt(0)
buffer_store_dword v15,off,s[20:23],s93 sc1
s_waitcnt vmcnt(0)
s_memtime s[96:97]
s_waitcnt lgkmcnt(0)
s_sub_u32 s96,s96,s94
s_min_u32 s71,s71,s96
s_memtime s[94:95]
s_waitcnt lgkmcnt(0)
buffer_store_dword v15,off,s[20:23],s92 sc1
s_waitcnt vmcnt(0)
s_memtime s[96:97]
s_waitcnt lgkmcnt(0)
s_sub_u32 s96,s96,s94
s_min_u32 s70,s70,s96
s_memtime s[94:95]
s_waitcnt lgkmcnt(0)
buffer_store_dword v15,off,s[20:23],s93 sc1
s_waitcnt vmcnt(0)
s_memtime s[96:97]
s_waitcnt lgkmcnt(0)
s_sub_u32 s96,s96,s94
s_min_u32 s71,s71,s96
s_cmp_gt_u32 s71,s70
s_cselect_b32 s65,2,1
v_mov_b32 v15,s65
s_mov_b32 s64,138510336
buffer_store_dword v15,off,s[20:23],s64 offset:1024 sc1
s_mov_b64 exec,-1
nomeas_152:
s_mov_b32 s67,0
s_cmp_eq_u32 s56,1
s_cbranch_scc1 vok_153
v_mbcnt_lo_u32_b32 v16,-1,0
v_and_b32 v16,7,v16
v_lshlrev_b32 v16,7,v16
s_mov_b32 s64,138510336
vpoll_154:
buffer_load_dword v17,v16,s[20:23],s64 offen sc1
s_waitcnt vmcnt(0)
v_readlane_b32 s92,v17,0
v_readlane_b32 s93,v17,1
v_readlane_b32 s94,v17,2
v_readlane_b32 s95,v17,3
v_readlane_b32 s96,v17,4
v_readlane_b32 s97,v17,5
v_readlane_b32 s98,v17,6
v_readlane_b32 s99,v17,7
s_add_u32 s65,s92,s93
s_add_u32 s65,s65,s94
s_add_u32 s65,s65,s95
s_add_u32 s65,s65,s96
s_add_u32 s65,s65,s97
s_add_u32 s65,s65,s98
s_add_u32 s65,s65,s99
s_cmp_ge_u32 s65,256
s_cbranch_scc1 vgot_155
s_sleep 4
s_sub_u32 s90,s90,1
s_cmp_gt_i32 s90,0
s_cbranch_scc1 vpoll_154
vgot_155:
s_min_u32 s65,s92,s93
s_min_u32 s65,s65,s94
s_min_u32 s65,s65,s95
s_min_u32 s65,s65,s96
s_min_u32 s65,s65,s97
s_min_u32 s65,s65,s98
s_min_u32 s65,s65,s99
s_cmp_lt_u32 s65,32
s_cbranch_scc1 fl_slow
s_mov_b32 s56,0
vok_153:
s_mov_b32 s63,201326592
s_mov_b32 s66,205520896
s_lshl_b32 s64,s50,8
s_add_u32 s68,s64,138547200
s_lshl_b32 s65,s59,2
s_add_u32 s69,s64,s65
s_add_u32 s69,s69,138548224
s_mov_b32 s71,1
plp_160:
buffer_load_dword v14,v13,s[20:23],s68 offen sc1
s_waitcnt vmcnt(0)
v_cmp_gt_u32 vcc,s71,v14
s_cbranch_vccz pok_161
s_sleep 4
s_sub_u32 s90,s90,1
s_cmp_gt_i32 s90,0
s_cbranch_scc1 plp_160
pok_161:
s_add_u32 s64,s63,4096
buffer_load_dwordx4 v[64:67],v10,s[20:23],s63 offen
buffer_load_dwordx4 v[68:71],v10,s[20:23],s64 offen
s_add_u32 s63,s63,32768
buffer_load_dword v15,off,s[20:23],s68
buffer_load_dword v15,off,s[20:23],s68
top0_158:
buffer_load_dword v14,v13,s[20:23],s68 offen sc1
s_add_u32 s71,s60,2
s_waitcnt vmcnt(3)
v_lshlrev_b32 v80,16,v64
v_and_b32 v81,s73,v64
v_lshlrev_b32 v82,16,v65
v_and_b32 v83,s73,v65
v_lshlrev_b32 v84,16,v66
v_and_b32 v85,s73,v66
v_lshlrev_b32 v86,16,v67
v_and_b32 v87,s73,v67
v_lshlrev_b32 v88,16,v68
v_and_b32 v89,s73,v68
v_lshlrev_b32 v90,16,v69
v_and_b32 v91,s73,v69
v_lshlrev_b32 v92,16,v70
v_and_b32 v93,s73,v70
v_lshlrev_b32 v94,16,v71
v_and_b32 v95,s73,v71
v_add_f32 v96,v80,v81
v_mul_f32 v97,v80,v80
v_add_f32 v98,v82,v83
v_mul_f32 v99,v81,v81
v_fmac_f32 v97,v82,v82
v_fmac_f32 v99,v83,v83
v_add_f32 v96,v96,v84
v_fmac_f32 v97,v84,v84
v_add_f32 v98,v98,v85
v_fmac_f32 v99,v85,v85
v_add_f32 v96,v96,v86
v_fmac_f32 v97,v86,v86
v_add_f32 v98,v98,v87
v_fmac_f32 v99,v87,v87
v_add_f32 v96,v96,v88
v_fmac_f32 v97,v88,v88
v_add_f32 v98,v98,v89
v_fmac_f32 v99,v89,v89
v_add_f32 v96,v96,v90
v_fmac_f32 v97,v90,v90
v_add_f32 v98,v98,v91
v_fmac_f32 v99,v91,v91
v_add_f32 v96,v96,v92
v_fmac_f32 v97,v92,v92
v_add_f32 v98,v98,v93
v_fmac_f32 v99,v93,v93
v_add_f32 v96,v96,v94
v_fmac_f32 v97,v94,v94
v_add_f32 v98,v98,v95
v_fmac_f32 v99,v95,v95
v_add_f32 v96,v96,v98
v_add_f32 v97,v97,v99
s_nop 0
v_add_f32_dpp v96,v96,v96 row_ror:4 row_mask:0xf bank_mask:0xf
v_add_f32_dpp v97,v97,v97 row_ror:4 row_mask:0xf bank_mask:0xf
s_nop 0
v_add_f32_dpp v96,v96,v96 row_ror:8 row_mask:0xf bank_mask:0xf
v_add_f32_dpp v97,v97,v97 row_ror:8 row_mask:0xf bank_mask:0xf
v_mov_b32 v98,v96
v_mov_b32 v99,v97
s_nop 0
v_permlane16_swap_b32 v98,v96
v_permlane16_swap_b32 v99,v97
v_add_f32 v96,v96,v98
v_add_f32 v97,v97,v99
v_mov_b32 v98,v96
v_mov_b32 v99,v97
s_nop 0
v_permlane32_swap_b32 v98,v96
v_permlane32_swap_b32 v99,v97
v_add_f32 v96,v96,v98
v_add_f32 v97,v97,v99
ds_write_b64 v11,v[96:97] offset:0
s_waitcnt lgkmcnt(0)
s_barrier
s_waitcnt vmcnt(0)
v_mov_b32 v15,s60
s_mov_b64 exec,1
buffer_store_dword v15,off,s[20:23],s69 sc1
s_mov_b64 exec,-1
v_cmp_gt_u32 vcc,s71,v14
s_mov_b32 s72,0
s_cbranch_vccnz p2_163
s_mov_b32 s72,1
s_add_u32 s64,s63,4096
buffer_load_dwordx4 v[72:75],v10,s[20:23],s63 offen
buffer_load_dwordx4 v[76:79],v10,s[20:23],s64 offen
s_add_u32 s63,s63,32768
p2_163:
ds_read_b64 v[100:101],v12 offset:0
ds_read_b64 v[102:103],v12 offset:512
ds_read_b64 v[104:105],v12 offset:1024
ds_read_b64 v[106:107],v12 offset:1536
s_waitcnt lgkmcnt(0)
v_add_f32 v100,v100,v102
v_add_f32 v101,v101,v103
v_add_f32 v104,v104,v106
v_add_f32 v105,v105,v107
v_add_f32 v100,v100,v104
v_add_f32 v101,v101,v105
v_mul_f32 v96,0xba800000,v100
v_mul_f32 v102,v96,v96
v_mul_f32 v101,0x3a800000,v101
v_sub_f32 v101,v101,v102
v_max_f32 v101,0,v101
v_add_f32 v101,0x3727c5ac,v101
v_rsq_f32 v97,v101
s_nop 0
v_mul_f32 v96,v96,v97
v_fma_f32 v80,v80,v97,v96
v_fma_f32 v81,v81,v97,v96
v_fma_f32 v82,v82,v97,v96
v_fma_f32 v83,v83,v97,v96
v_fma_f32 v84,v84,v97,v96
v_fma_f32 v85,v85,v97,v96
v_fma_f32 v86,v86,v97,v96
v_fma_f32 v87,v87,v97,v96
v_fma_f32 v88,v88,v97,v96
v_fma_f32 v89,v89,v97,v96
v_fma_f32 v90,v90,v97,v96
v_fma_f32 v91,v91,v97,v96
v_fma_f32 v92,v92,v97,v96
v_fma_f32 v93,v93,v97,v96
v_fma_f32 v94,v94,v97,v96
v_fma_f32 v95,v95,v97,v96
v_fma_f32 v80,v80,v32,v48
v_fma_f32 v81,v81,v33,v49
v_fma_f32 v82,v82,v34,v50
v_fma_f32 v83,v83,v35,v51
v_fma_f32 v84,v84,v36,v52
v_fma_f32 v85,v85,v37,v53
v_fma_f32 v86,v86,v38,v54
v_fma_f32 v87,v87,v39,v55
v_fma_f32 v88,v88,v40,v56
v_fma_f32 v89,v89,v41,v57
v_fma_f32 v90,v90,v42,v58
v_fma_f32 v91,v91,v43,v59
v_fma_f32 v92,v92,v44,v60
v_fma_f32 v93,v93,v45,v61
v_fma_f32 v94,v94,v46,v62
v_fma_f32 v95,v95,v47,v63
v_cvt_pk_bf16_f32 v112,v80,v81
v_cvt_pk_bf16_f32 v113,v82,v83
v_cvt_pk_bf16_f32 v114,v84,v85
v_cvt_pk_bf16_f32 v115,v86,v87
v_cvt_pk_bf16_f32 v116,v88,v89
v_cvt_pk_bf16_f32 v117,v90,v91
v_cvt_pk_bf16_f32 v118,v92,v93
v_cvt_pk_bf16_f32 v119,v94,v95
s_add_u32 s64,s66,4096
buffer_store_dwordx4 v[112:115],v10,s[20:23],s66 offen sc1
buffer_store_dwordx4 v[116:119],v10,s[20:23],s64 offen sc1
s_add_u32 s66,s66,32768
s_add_u32 s60,s60,1
s_cmp_eq_u32 s72,0
s_cbranch_scc1 slowp_162
top1_159:
buffer_load_dword v14,v13,s[20:23],s68 offen sc1
s_add_u32 s71,s60,2
s_waitcnt vmcnt(3)
v_lshlrev_b32 v80,16,v72
v_and_b32 v81,s73,v72
v_lshlrev_b32 v82,16,v73
v_and_b32 v83,s73,v73
v_lshlrev_b32 v84,16,v74
v_and_b32 v85,s73,v74
v_lshlrev_b32 v86,16,v75
v_and_b32 v87,s73,v75
v_lshlrev_b32 v88,16,v76
v_and_b32 v89,s73,v76
v_lshlrev_b32 v90,16,v77
v_and_b32 v91,s73,v77
v_lshlrev_b32 v92,16,v78
v_and_b32 v93,s73,v78
v_lshlrev_b32 v94,16,v79
v_and_b32 v95,s73,v79
v_add_f32 v96,v80,v81
v_mul_f32 v97,v80,v80
v_add_f32 v98,v82,v83
v_mul_f32 v99,v81,v81
v_fmac_f32 v97,v82,v82
v_fmac_f32 v99,v83,v83
v_add_f32 v96,v96,v84
v_fmac_f32 v97,v84,v84
v_add_f32 v98,v98,v85
v_fmac_f32 v99,v85,v85
v_add_f32 v96,v96,v86
v_fmac_f32 v97,v86,v86
v_add_f32 v98,v98,v87
v_fmac_f32 v99,v87,v87
v_add_f32 v96,v96,v88
v_fmac_f32 v97,v88,v88
v_add_f32 v98,v98,v89
v_fmac_f32 v99,v89,v89
v_add_f32 v96,v96,v90
v_fmac_f32 v97,v90,v90
v_add_f32 v98,v98,v91
v_fmac_f32 v99,v91,v91
v_add_f32 v96,v96,v92
v_fmac_f32 v97,v92,v92
v_add_f32 v98,v98,v93
v_fmac_f32 v99,v93,v93
v_add_f32 v96,v96,v94
v_fmac_f32 v97,v94,v94
v_add_f32 v98,v98,v95
v_fmac_f32 v99,v95,v95
v_add_f32 v96,v96,v98
v_add_f32 v97,v97,v99
s_nop 0
v_add_f32_dpp v96,v96,v96 row_ror:4 row_mask:0xf bank_mask:0xf
v_add_f32_dpp v97,v97,v97 row_ror:4 row_mask:0xf bank_mask:0xf
s_nop 0
v_add_f32_dpp v96,v96,v96 row_ror:8 row_mask:0xf bank_mask:0xf
v_add_f32_dpp v97,v97,v97 row_ror:8 row_mask:0xf bank_mask:0xf
v_mov_b32 v98,v96
v_mov_b32 v99,v97
s_nop 0
v_permlane16_swap_b32 v98,v96
v_permlane16_swap_b32 v99,v97
v_add_f32 v96,v96,v98
v_add_f32 v97,v97,v99
v_mov_b32 v98,v96
v_mov_b32 v99,v97
s_nop 0
v_permlane32_swap_b32 v98,v96
v_permlane32_swap_b32 v99,v97
v_add_f32 v96,v96,v98
v_add_f32 v97,v97,v99
ds_write_b64 v11,v[96:97] offset:2048
s_waitcnt lgkmcnt(0)
s_barrier
s_waitcnt vmcnt(0)
v_mov_b32 v15,s60
s_mov_b64 exec,1
buffer_store_dword v15,off,s[20:23],s69 sc1
s_mov_b64 exec,-1
v_cmp_gt_u32 vcc,s71,v14
s_mov_b32 s72,0
s_cbranch_vccnz p2_165
s_mov_b32 s72,1
s_add_u32 s64,s63,4096
buffer_load_dwordx4 v[64:67],v10,s[20:23],s63 offen
buffer_load_dwordx4 v[68:71],v10,s[20:23],s64 offen
s_add_u32 s63,s63,32768
p2_165:
ds_read_b64 v[100:101],v12 offset:2048
ds_read_b64 v[102:103],v12 offset:2560
ds_read_b64 v[104:105],v12 offset:3072
ds_read_b64 v[106:107],v12 offset:3584
s_waitcnt lgkmcnt(0)
v_add_f32 v100,v100,v102
v_add_f32 v101,v101,v103
v_add_f32 v104,v104,v106
v_add_f32 v105,v105,v107
v_add_f32 v100,v100,v104
v_add_f32 v101,v101,v105
v_mul_f32 v96,0xba800000,v100
v_mul_f32 v102,v96,v96
v_mul_f32 v101,0x3a800000,v101
v_sub_f32 v101,v101,v102
v_max_f32 v101,0,v101
v_add_f32 v101,0x3727c5ac,v101
v_rsq_f32 v97,v101
s_nop 0
v_mul_f32 v96,v96,v97
v_fma_f32 v80,v80,v97,v96
v_fma_f32 v81,v81,v97,v96
v_fma_f32 v82,v82,v97,v96
v_fma_f32 v83,v83,v97,v96
v_fma_f32 v84,v84,v97,v96
v_fma_f32 v85,v85,v97,v96
v_fma_f32 v86,v86,v97,v96
v_fma_f32 v87,v87,v97,v96
v_fma_f32 v88,v88,v97,v96
v_fma_f32 v89,v89,v97,v96
v_fma_f32 v90,v90,v97,v96
v_fma_f32 v91,v91,v97,v96
v_fma_f32 v92,v92,v97,v96
v_fma_f32 v93,v93,v97,v96
v_fma_f32 v94,v94,v97,v96
v_fma_f32 v95,v95,v97,v96
v_fma_f32 v80,v80,v32,v48
v_fma_f32 v81,v81,v33,v49
v_fma_f32 v82,v82,v34,v50
v_fma_f32 v83,v83,v35,v51
v_fma_f32 v84,v84,v36,v52
v_fma_f32 v85,v85,v37,v53
v_fma_f32 v86,v86,v38,v54
v_fma_f32 v87,v87,v39,v55
v_fma_f32 v88,v88,v40,v56
v_fma_f32 v89,v89,v41,v57
v_fma_f32 v90,v90,v42,v58
v_fma_f32 v91,v91,v43,v59
v_fma_f32 v92,v92,v44,v60
v_fma_f32 v93,v93,v45,v61
v_fma_f32 v94,v94,v46,v62
v_fma_f32 v95,v95,v47,v63
v_cvt_pk_bf16_f32 v112,v80,v81
v_cvt_pk_bf16_f32 v113,v82,v83
v_cvt_pk_bf16_f32 v114,v84,v85
v_cvt_pk_bf16_f32 v115,v86,v87
v_cvt_pk_bf16_f32 v116,v88,v89
v_cvt_pk_bf16_f32 v117,v90,v91
v_cvt_pk_bf16_f32 v118,v92,v93
v_cvt_pk_bf16_f32 v119,v94,v95
s_add_u32 s64,s66,4096
buffer_store_dwordx4 v[112:115],v10,s[20:23],s66 offen sc1
buffer_store_dwordx4 v[116:119],v10,s[20:23],s64 offen sc1
s_add_u32 s66,s66,32768
s_add_u32 s60,s60,1
s_cmp_eq_u32 s72,0
s_cbranch_scc1 slowp_164
s_branch top0_158
slowp_162:
buffer_load_dword v14,v13,s[20:23],s68 offen sc1
s_waitcnt vmcnt(1)
v_mov_b32 v15,s60
s_mov_b64 exec,1
buffer_store_dword v15,off,s[20:23],s69 sc1
s_mov_b64 exec,-1
s_cmp_ge_u32 s60,128
s_cbranch_scc1 done_151
s_waitcnt vmcnt(1)
v_cmp_gt_u32 vcc,s71,v14
s_cbranch_vccz go_166
plp_167:
buffer_load_dword v14,v13,s[20:23],s68 offen sc1
s_waitcnt vmcnt(0)
v_cmp_gt_u32 vcc,s71,v14
s_cbranch_vccz pok_168
s_sleep 4
s_sub_u32 s90,s90,1
s_cmp_gt_i32 s90,0
s_cbranch_scc1 plp_167
pok_168:
go_166:
s_add_u32 s64,s63,4096
buffer_load_dwordx4 v[72:75],v10,s[20:23],s63 offen
buffer_load_dwordx4 v[76:79],v10,s[20:23],s64 offen
s_add_u32 s63,s63,32768
buffer_load_dword v15,off,s[20:23],s68
buffer_load_dword v15,off,s[20:23],s68
s_branch top1_159
slowp_164:
buffer_load_dword v14,v13,s[20:23],s68 offen sc1
s_waitcnt vmcnt(1)
v_mov_b32 v15,s60
s_mov_b64 exec,1
buffer_store_dword v15,off,s[20:23],s69 sc1
s_mov_b64 exec,-1
s_cmp_ge_u32 s60,128
s_cbranch_scc1 done_151
s_waitcnt vmcnt(1)
v_cmp_gt_u32 vcc,s71,v14
s_cbranch_vccz go_169
plp_170:
buffer_load_dword v14,v13,s[20:23],s68 offen sc1
s_waitcnt vmcnt(0)
v_cmp_gt_u32 vcc,s71,v14
s_cbranch_vccz pok_171
s_sleep 4
s_sub_u32 s90,s90,1
s_cmp_gt_i32 s90,0
s_cbranch_scc1 plp_170
pok_171:
go_169:
s_add_u32 s64,s63,4096
buffer_load_dwordx4 v[64:67],v10,s[20:23],s63 offen
buffer_load_dwordx4 v[68:71],v10,s[20:23],s64 offen
s_add_u32 s63,s63,32768
buffer_load_dword v15,off,s[20:23],s68
buffer_load_dword v15,off,s[20:23],s68
s_branch top0_158
done_151:
s_endpgm
fl_att:
s_mov_b32 s67,0
s_cmp_eq_u32 s56,1
s_cbranch_scc1 vok_172
v_mbcnt_lo_u32_b32 v16,-1,0
v_and_b32 v16,7,v16
v_lshlrev_b32 v16,7,v16
s_mov_b32 s64,138510336
vpoll_173:
buffer_load_dword v17,v16,s[20:23],s64 offen sc1
s_waitcnt vmcnt(0)
v_readlane_b32 s92,v17,0
v_readlane_b32 s93,v17,1
v_readlane_b32 s94,v17,2
v_readlane_b32 s95,v17,3
v_readlane_b32 s96,v17,4
v_readlane_b32 s97,v17,5
v_readlane_b32 s98,v17,6
v_readlane_b32 s99,v17,7
s_add_u32 s65,s92,s93
s_add_u32 s65,s65,s94
s_add_u32 s65,s65,s95
s_add_u32 s65,s65,s96
s_add_u32 s65,s65,s97
s_add_u32 s65,s65,s98
s_add_u32 s65,s65,s99
s_cmp_ge_u32 s65,256
s_cbranch_scc1 vgot_174
s_sleep 4
s_sub_u32 s90,s90,1
s_cmp_gt_i32 s90,0
s_cbranch_scc1 vpoll_173
vgot_174:
s_min_u32 s65,s92,s93
s_min_u32 s65,s65,s94
s_min_u32 s65,s65,s95
s_min_u32 s65,s65,s96
s_min_u32 s65,s65,s97
s_min_u32 s65,s65,s98
s_min_u32 s65,s65,s99
s_cmp_lt_u32 s65,32
s_cbranch_scc1 fl_slow
s_mov_b32 s56,0
pp_175:
buffer_load_dword v17,off,s[20:23],s64 offset:1024 sc1
s_waitcnt vmcnt(0)
v_readfirstlane_b32 s65,v17
s_cmp_lg_u32 s65,0
s_cbranch_scc1 pg_176
s_sleep 4
s_sub_u32 s90,s90,1
s_cmp_gt_i32 s90,0
s_cbranch_scc1 pp_175
pg_176:
s_and_b32 s65,s65,2
s_lshl_b32 s67,s65,12
vok_172:
v_lshlrev_b32 v0,4,v1
v_and_b32 v21,15,v1
v_lshrrev_b32 v22,4,v1
v_and_b32 v23,7,v21
v_lshlrev_b32 v23,4,v23
v_lshl_add_u32 v3,v22,8,v23
v_and_b32 v23,31,v1
v_lshlrev_b32 v4,4,v23
v_and_b32 v23,3,v1
v_bfe_u32 v24,v1,2,1
v_lshlrev_b32 v23,14,v23
v_lshl_add_u32 v2,v24,7,v23
v_mov_b32 v7,0xff800000
s_and_b32 s54,s50,1
s_lshl_b32 s64,s54,4
v_lshlrev_b32 v23,2,v22
v_sub_u32 v23,v21,v23
v_add_u32 v23,s64,v23
v_cmp_le_i32 s[28:29],0,v23
v_cmp_le_i32 s[30:31],1,v23
v_cmp_le_i32 s[32:33],2,v23
v_cmp_le_i32 s[34:35],3,v23
v_cmp_le_i32 s[36:37],16,v23
v_cmp_le_i32 s[38:39],17,v23
v_cmp_le_i32 s[40:41],18,v23
v_cmp_le_i32 s[42:43],19,v23
s_mov_b32 s44,-1
s_mov_b32 s45,0
s_mov_b32 s80,0x3e0293ee
s_lshl_b32 s52,s59,1
s_lshr_b32 s64,s50,1
s_add_u32 s52,s52,s64
s_lshl_b32 s53,s52,15
s_lshl_b32 s68,s52,8
s_add_u32 s68,s68,s67
s_add_u32 s68,s68,138428416
s_lshl_b32 s69,s59,8
s_lshl_b32 s64,s64,2
s_add_u32 s69,s69,s64
s_lshl_b32 s64,s54,3
s_add_u32 s69,s69,s64
s_add_u32 s69,s69,138543104
s_lshl_b32 s66,s52,12
s_lshl_b32 s64,s54,17
s_add_u32 s66,s66,s64
s_add_u32 s66,s66,150994944
s_lshl_b32 s55,s54,10
s_xor_b32 s55,s55,0x2000
s_mov_b32 s60,0
s_mov_b32 s71,1
plp_177:
buffer_load_dword v5,v2,s[20:23],s68 offen sc1
s_waitcnt vmcnt(0)
v_cmp_gt_u32 vcc,s71,v5
s_cbranch_vccz pok_178
s_sleep 4
s_sub_u32 s90,s90,1
s_cmp_gt_i32 s90,0
s_cbranch_scc1 plp_177
pok_178:
s_add_u32 s64,s60,0
s_lshl_b32 s65,s64,11
s_and_b32 s65,s65,0x2000
s_xor_b32 s65,s65,s67
s_lshl_b32 s64,s64,19
s_add_u32 s64,s64,s65
s_add_u32 s92,s64,s53
s_add_u32 s93,s92,16384
s_add_u32 s94,s92,4096
s_add_u32 s95,s93,4096
s_xor_b32 s96,s92,s55
s_xor_b32 s97,s93,s55
buffer_load_dwordx4 a[0:3],v0,s[20:23],s96 offen offset:0
buffer_load_dwordx4 a[16:19],v0,s[20:23],s92 offen offset:0
buffer_load_dwordx4 a[32:35],v0,s[20:23],s92 offen offset:1024
buffer_load_dwordx4 a[4:7],v0,s[20:23],s96 offen offset:2048
buffer_load_dwordx4 a[20:23],v0,s[20:23],s92 offen offset:2048
buffer_load_dwordx4 a[36:39],v0,s[20:23],s92 offen offset:3072
buffer_load_dwordx4 a[8:11],v0,s[20:23],s97 offen offset:0
buffer_load_dwordx4 a[24:27],v0,s[20:23],s93 offen offset:0
buffer_load_dwordx4 a[40:43],v0,s[20:23],s93 offen offset:1024
buffer_load_dwordx4 a[12:15],v0,s[20:23],s97 offen offset:2048
buffer_load_dwordx4 a[28:31],v0,s[20:23],s93 offen offset:2048
buffer_load_dwordx4 a[44:47],v0,s[20:23],s93 offen offset:3072
buffer_load_dwordx4 a[48:51],v0,s[20:23],s94 offen offset:0
buffer_load_dwordx4 a[52:55],v0,s[20:23],s94 offen offset:1024
buffer_load_dwordx4 a[56:59],v0,s[20:23],s94 offen offset:2048
buffer_load_dwordx4 a[60:63],v0,s[20:23],s94 offen offset:3072
buffer_load_dwordx4 a[64:67],v0,s[20:23],s95 offen offset:0
buffer_load_dwordx4 a[68:71],v0,s[20:23],s95 offen offset:1024
buffer_load_dwordx4 a[72:75],v0,s[20:23],s95 offen offset:2048
buffer_load_dwordx4 a[76:79],v0,s[20:23],s95 offen offset:3072
s_waitcnt vmcnt(8)
top0_179:
v_mfma_f32_16x16x32_bf16 v[48:51],a[16:19],a[0:3],0
v_mfma_f32_16x16x32_bf16 v[52:55],a[32:35],a[0:3],0
v_mfma_f32_16x16x32_bf16 v[48:51],a[20:23],a[4:7],v[48:51]
v_mfma_f32_16x16x32_bf16 v[52:55],a[36:39],a[4:7],v[52:55]
v_mfma_f32_16x16x32_bf16 v[48:51],a[24:27],a[8:11],v[48:51]
v_mfma_f32_16x16x32_bf16 v[52:55],a[40:43],a[8:11],v[52:55]
v_mfma_f32_16x16x32_bf16 v[48:51],a[28:31],a[12:15],v[48:51]
v_mfma_f32_16x16x32_bf16 v[52:55],a[44:47],a[12:15],v[52:55]
s_nop 6
v_cndmask_b32 v48,v7,v48,s[28:29]
v_cndmask_b32 v49,v7,v49,s[30:31]
v_cndmask_b32 v50,v7,v50,s[32:33]
v_cndmask_b32 v51,v7,v51,s[34:35]
v_cndmask_b32 v52,v7,v52,s[36:37]
v_cndmask_b32 v53,v7,v53,s[38:39]
v_cndmask_b32 v54,v7,v54,s[40:41]
v_cndmask_b32 v55,v7,v55,s[42:43]
v_max3_f32 v72,v48,v49,v50
v_max3_f32 v72,v72,v51,v52
v_max3_f32 v72,v72,v53,v54
v_max_f32 v72,v72,v55
s_add_u32 s64,s60,0
s_lshl_b32 s65,s64,11
s_and_b32 s65,s65,0x2000
s_xor_b32 s65,s65,s67
s_lshl_b32 s64,s64,19
s_add_u32 s64,s64,s65
s_add_u32 s98,s64,s53
s_add_u32 s98,s98,67108864
s_add_u32 s99,s98,16384
s_lshr_b32 s71,s60,1
s_add_u32 s71,s71,1
plp_181:
buffer_load_dword v5,v2,s[20:23],s68 offen sc1
s_waitcnt vmcnt(0)
v_cmp_gt_u32 vcc,s71,v5
s_cbranch_vccz pok_182
s_sleep 4
s_sub_u32 s90,s90,1
s_cmp_gt_i32 s90,0
s_cbranch_scc1 plp_181
pok_182:
buffer_load_dwordx4 v[16:19],v3,s[20:23],s98 offen offset:0
buffer_load_dwordx4 v[20:23],v3,s[20:23],s98 offen offset:128
buffer_load_dwordx4 v[24:27],v3,s[20:23],s99 offen offset:0
buffer_load_dwordx4 v[28:31],v3,s[20:23],s99 offen offset:128
buffer_load_dwordx4 v[32:35],v4,s[20:23],s98 offen offset:1024
buffer_load_dwordx4 v[36:39],v4,s[20:23],s98 offen offset:1536
buffer_load_dwordx4 v[40:43],v4,s[20:23],s99 offen offset:1024
buffer_load_dwordx4 v[44:47],v4,s[20:23],s99 offen offset:1536
s_barrier
s_add_u32 s64,s60,2
s_lshl_b32 s65,s64,11
s_and_b32 s65,s65,0x2000
s_xor_b32 s65,s65,s67
s_lshl_b32 s64,s64,19
s_add_u32 s64,s64,s65
s_add_u32 s92,s64,s53
s_add_u32 s93,s92,16384
s_add_u32 s94,s92,4096
s_add_u32 s95,s93,4096
s_xor_b32 s96,s92,s55
s_xor_b32 s97,s93,s55
buffer_load_dwordx4 a[80:83],v0,s[20:23],s96 offen offset:0
buffer_load_dwordx4 a[96:99],v0,s[20:23],s92 offen offset:0
buffer_load_dwordx4 a[112:115],v0,s[20:23],s92 offen offset:1024
buffer_load_dwordx4 a[84:87],v0,s[20:23],s96 offen offset:2048
buffer_load_dwordx4 a[100:103],v0,s[20:23],s92 offen offset:2048
buffer_load_dwordx4 a[116:119],v0,s[20:23],s92 offen offset:3072
buffer_load_dwordx4 a[88:91],v0,s[20:23],s97 offen offset:0
buffer_load_dwordx4 a[104:107],v0,s[20:23],s93 offen offset:0
buffer_load_dwordx4 a[120:123],v0,s[20:23],s93 offen offset:1024
buffer_load_dwordx4 a[92:95],v0,s[20:23],s97 offen offset:2048
buffer_load_dwordx4 a[108:111],v0,s[20:23],s93 offen offset:2048
buffer_load_dwordx4 a[124:127],v0,s[20:23],s93 offen offset:3072
s_waitcnt vmcnt(16)
v_mfma_f32_16x16x32_bf16 v[56:59],v[16:19],a[0:3],0
v_mfma_f32_16x16x32_bf16 v[56:59],v[20:23],a[4:7],v[56:59]
v_mfma_f32_16x16x32_bf16 v[56:59],v[24:27],a[8:11],v[56:59]
v_mfma_f32_16x16x32_bf16 v[56:59],v[28:31],a[12:15],v[56:59]
s_nop 7
v_cndmask_b32 v56,v7,v56,s[44:45]
v_cndmask_b32 v57,v7,v57,s[44:45]
v_cndmask_b32 v58,v7,v58,s[44:45]
v_cndmask_b32 v59,v7,v59,s[44:45]
v_max3_f32 v72,v72,v56,v57
v_max3_f32 v72,v72,v58,v59
v_mov_b32 v73,v72
s_nop 1
v_permlane16_swap_b32 v73,v72
v_max_f32 v72,v72,v73
v_mov_b32 v73,v72
s_nop 1
v_permlane32_swap_b32 v73,v72
v_max_f32 v72,v72,v73
v_mul_f32 v72,s80,v72
v_fma_f32 v48,v48,s80,-v72
v_fma_f32 v49,v49,s80,-v72
v_fma_f32 v50,v50,s80,-v72
v_fma_f32 v51,v51,s80,-v72
v_fma_f32 v52,v52,s80,-v72
v_fma_f32 v53,v53,s80,-v72
v_fma_f32 v54,v54,s80,-v72
v_fma_f32 v55,v55,s80,-v72
v_fma_f32 v56,v56,s80,-v72
v_fma_f32 v57,v57,s80,-v72
v_fma_f32 v58,v58,s80,-v72
v_fma_f32 v59,v59,s80,-v72
v_exp_f32 v48,v48
v_exp_f32 v49,v49
v_exp_f32 v50,v50
v_exp_f32 v51,v51
v_exp_f32 v52,v52
v_exp_f32 v53,v53
v_exp_f32 v54,v54
v_exp_f32 v55,v55
v_exp_f32 v56,v56
v_exp_f32 v57,v57
v_exp_f32 v58,v58
v_exp_f32 v59,v59
v_add_f32 v74,v48,v49
v_add_f32 v75,v50,v51
v_add_f32 v74,v74,v52
v_add_f32 v75,v75,v53
v_add_f32 v74,v74,v54
v_add_f32 v75,v75,v55
v_add_f32 v74,v74,v56
v_add_f32 v75,v75,v57
v_add_f32 v74,v74,v58
v_add_f32 v75,v75,v59
v_add_f32 v74,v74,v75
v_mov_b32 v73,v74
s_nop 1
v_permlane16_swap_b32 v73,v74
v_add_f32 v74,v74,v73
v_mov_b32 v73,v74
s_nop 1
v_permlane32_swap_b32 v73,v74
v_add_f32 v74,v74,v73
v_rcp_f32 v75,v74
s_nop 0
v_mul_f32 v48,v48,v75
v_mul_f32 v49,v49,v75
v_mul_f32 v50,v50,v75
v_mul_f32 v51,v51,v75
v_mul_f32 v52,v52,v75
v_mul_f32 v53,v53,v75
v_mul_f32 v54,v54,v75
v_mul_f32 v55,v55,v75
v_mul_f32 v56,v56,v75
v_mul_f32 v57,v57,v75
v_mul_f32 v58,v58,v75
v_mul_f32 v59,v59,v75
v_cvt_pk_bf16_f32 v64,v48,v49
v_cvt_pk_bf16_f32 v65,v50,v51
v_cvt_pk_bf16_f32 v66,v52,v53
v_cvt_pk_bf16_f32 v67,v54,v55
v_cvt_pk_bf16_f32 v68,v56,v57
v_cvt_pk_bf16_f32 v69,v58,v59
v_mfma_f32_16x16x32_bf16 v[80:83],a[48:51],v[64:67],0
v_mfma_f32_16x16x32_bf16 v[84:87],a[52:55],v[64:67],0
v_mfma_f32_16x16x32_bf16 v[88:91],a[56:59],v[64:67],0
v_mfma_f32_16x16x32_bf16 v[92:95],a[60:63],v[64:67],0
v_mfma_f32_16x16x32_bf16 v[96:99],a[64:67],v[64:67],0
v_mfma_f32_16x16x32_bf16 v[100:103],a[68:71],v[64:67],0
v_mfma_f32_16x16x32_bf16 v[104:107],a[72:75],v[64:67],0
v_mfma_f32_16x16x32_bf16 v[108:111],a[76:79],v[64:67],0
s_waitcnt vmcnt(12)
v_mfma_f32_16x16x16_bf16 v[80:83],v[32:33],v[68:69],v[80:83]
v_mfma_f32_16x16x16_bf16 v[84:87],v[34:35],v[68:69],v[84:87]
v_mfma_f32_16x16x16_bf16 v[88:91],v[36:37],v[68:69],v[88:91]
v_mfma_f32_16x16x16_bf16 v[92:95],v[38:39],v[68:69],v[92:95]
v_mfma_f32_16x16x16_bf16 v[96:99],v[40:41],v[68:69],v[96:99]
v_mfma_f32_16x16x16_bf16 v[100:103],v[42:43],v[68:69],v[100:103]
v_mfma_f32_16x16x16_bf16 v[104:107],v[44:45],v[68:69],v[104:107]
v_mfma_f32_16x16x16_bf16 v[108:111],v[46:47],v[68:69],v[108:111]
s_nop 0
v_cvt_pk_bf16_f32 v112,v80,v81
v_cvt_pk_bf16_f32 v113,v82,v83
v_cvt_pk_bf16_f32 v114,v84,v85
v_cvt_pk_bf16_f32 v115,v86,v87
buffer_store_dwordx4 v[112:115],v0,s[20:23],s66 offen offset:0 sc1
v_cvt_pk_bf16_f32 v116,v88,v89
v_cvt_pk_bf16_f32 v117,v90,v91
v_cvt_pk_bf16_f32 v118,v92,v93
v_cvt_pk_bf16_f32 v119,v94,v95
buffer_store_dwordx4 v[116:119],v0,s[20:23],s66 offen offset:1024 sc1
v_cvt_pk_bf16_f32 v112,v96,v97
v_cvt_pk_bf16_f32 v113,v98,v99
v_cvt_pk_bf16_f32 v114,v100,v101
v_cvt_pk_bf16_f32 v115,v102,v103
buffer_store_dwordx4 v[112:115],v0,s[20:23],s66 offen offset:2048 sc1
v_cvt_pk_bf16_f32 v116,v104,v105
v_cvt_pk_bf16_f32 v117,v106,v107
v_cvt_pk_bf16_f32 v118,v108,v109
v_cvt_pk_bf16_f32 v119,v110,v111
buffer_store_dwordx4 v[116:119],v0,s[20:23],s66 offen offset:3072 sc1
s_barrier
buffer_load_dwordx4 a[128:131],v0,s[20:23],s94 offen offset:0
buffer_load_dwordx4 a[132:135],v0,s[20:23],s94 offen offset:1024
buffer_load_dwordx4 a[136:139],v0,s[20:23],s94 offen offset:2048
buffer_load_dwordx4 a[140:143],v0,s[20:23],s94 offen offset:3072
buffer_load_dwordx4 a[144:147],v0,s[20:23],s95 offen offset:0
buffer_load_dwordx4 a[148:151],v0,s[20:23],s95 offen offset:1024
buffer_load_dwordx4 a[152:155],v0,s[20:23],s95 offen offset:2048
buffer_load_dwordx4 a[156:159],v0,s[20:23],s95 offen offset:3072
s_add_u32 s66,s66,262144
s_add_u32 s60,s60,2
s_waitcnt vmcnt(8)
v_mov_b32 v6,s71
s_mov_b64 exec,1
buffer_store_dword v6,off,s[20:23],s69 sc1
s_mov_b64 exec,-1
top1_180:
v_mfma_f32_16x16x32_bf16 v[48:51],a[96:99],a[80:83],0
v_mfma_f32_16x16x32_bf16 v[52:55],a[112:115],a[80:83],0
v_mfma_f32_16x16x32_bf16 v[48:51],a[100:103],a[84:87],v[48:51]
v_mfma_f32_16x16x32_bf16 v[52:55],a[116:119],a[84:87],v[52:55]
v_mfma_f32_16x16x32_bf16 v[48:51],a[104:107],a[88:91],v[48:51]
v_mfma_f32_16x16x32_bf16 v[52:55],a[120:123],a[88:91],v[52:55]
v_mfma_f32_16x16x32_bf16 v[48:51],a[108:111],a[92:95],v[48:51]
v_mfma_f32_16x16x32_bf16 v[52:55],a[124:127],a[92:95],v[52:55]
s_nop 6
v_cndmask_b32 v48,v7,v48,s[28:29]
v_cndmask_b32 v49,v7,v49,s[30:31]
v_cndmask_b32 v50,v7,v50,s[32:33]
v_cndmask_b32 v51,v7,v51,s[34:35]
v_cndmask_b32 v52,v7,v52,s[36:37]
v_cndmask_b32 v53,v7,v53,s[38:39]
v_cndmask_b32 v54,v7,v54,s[40:41]
v_cndmask_b32 v55,v7,v55,s[42:43]
v_max3_f32 v72,v48,v49,v50
v_max3_f32 v72,v72,v51,v52
v_max3_f32 v72,v72,v53,v54
v_max_f32 v72,v72,v55
s_add_u32 s64,s60,0
s_lshl_b32 s65,s64,11
s_and_b32 s65,s65,0x2000
s_xor_b32 s65,s65,s67
s_lshl_b32 s64,s64,19
s_add_u32 s64,s64,s65
s_add_u32 s98,s64,s53
s_add_u32 s98,s98,67108864
s_add_u32 s99,s98,16384
s_lshr_b32 s71,s60,1
s_add_u32 s71,s71,1
plp_183:
buffer_load_dword v5,v2,s[20:23],s68 offen sc1
s_waitcnt vmcnt(0)
v_cmp_gt_u32 vcc,s71,v5
s_cbranch_vccz pok_184
s_sleep 4
s_sub_u32 s90,s90,1
s_cmp_gt_i32 s90,0
s_cbranch_scc1 plp_183
pok_184:
buffer_load_dwordx4 v[16:19],v3,s[20:23],s98 offen offset:0
buffer_load_dwordx4 v[20:23],v3,s[20:23],s98 offen offset:128
buffer_load_dwordx4 v[24:27],v3,s[20:23],s99 offen offset:0
buffer_load_dwordx4 v[28:31],v3,s[20:23],s99 offen offset:128
buffer_load_dwordx4 v[32:35],v4,s[20:23],s98 offen offset:1024
buffer_load_dwordx4 v[36:39],v4,s[20:23],s98 offen offset:1536
buffer_load_dwordx4 v[40:43],v4,s[20:23],s99 offen offset:1024
buffer_load_dwordx4 v[44:47],v4,s[20:23],s99 offen offset:1536
s_barrier
s_cmp_lt_u32 s60,126
s_cbranch_scc1 pf_185
s_waitcnt vmcnt(0)
s_branch j1_186
pf_185:
s_add_u32 s64,s60,2
s_lshl_b32 s65,s64,11
s_and_b32 s65,s65,0x2000
s_xor_b32 s65,s65,s67
s_lshl_b32 s64,s64,19
s_add_u32 s64,s64,s65
s_add_u32 s92,s64,s53
s_add_u32 s93,s92,16384
s_add_u32 s94,s92,4096
s_add_u32 s95,s93,4096
s_xor_b32 s96,s92,s55
s_xor_b32 s97,s93,s55
buffer_load_dwordx4 a[0:3],v0,s[20:23],s96 offen offset:0
buffer_load_dwordx4 a[16:19],v0,s[20:23],s92 offen offset:0
buffer_load_dwordx4 a[32:35],v0,s[20:23],s92 offen offset:1024
buffer_load_dwordx4 a[4:7],v0,s[20:23],s96 offen offset:2048
buffer_load_dwordx4 a[20:23],v0,s[20:23],s92 offen offset:2048
buffer_load_dwordx4 a[36:39],v0,s[20:23],s92 offen offset:3072
buffer_load_dwordx4 a[8:11],v0,s[20:23],s97 offen offset:0
buffer_load_dwordx4 a[24:27],v0,s[20:23],s93 offen offset:0
buffer_load_dwordx4 a[40:43],v0,s[20:23],s93 offen offset:1024
buffer_load_dwordx4 a[12:15],v0,s[20:23],s97 offen offset:2048
buffer_load_dwordx4 a[28:31],v0,s[20:23],s93 offen offset:2048
buffer_load_dwordx4 a[44:47],v0,s[20:23],s93 offen offset:3072
j1_186:
s_waitcnt vmcnt(16)
v_mfma_f32_16x16x32_bf16 v[56:59],v[16:19],a[80:83],0
v_mfma_f32_16x16x32_bf16 v[56:59],v[20:23],a[84:87],v[56:59]
v_mfma_f32_16x16x32_bf16 v[56:59],v[24:27],a[88:91],v[56:59]
v_mfma_f32_16x16x32_bf16 v[56:59],v[28:31],a[92:95],v[56:59]
s_nop 7
v_cndmask_b32 v56,v7,v56,s[44:45]
v_cndmask_b32 v57,v7,v57,s[44:45]
v_cndmask_b32 v58,v7,v58,s[44:45]
v_cndmask_b32 v59,v7,v59,s[44:45]
v_max3_f32 v72,v72,v56,v57
v_max3_f32 v72,v72,v58,v59
v_mov_b32 v73,v72
s_nop 1
v_permlane16_swap_b32 v73,v72
v_max_f32 v72,v72,v73
v_mov_b32 v73,v72
s_nop 1
v_permlane32_swap_b32 v73,v72
v_max_f32 v72,v72,v73
v_mul_f32 v72,s80,v72
v_fma_f32 v48,v48,s80,-v72
v_fma_f32 v49,v49,s80,-v72
v_fma_f32 v50,v50,s80,-v72
v_fma_f32 v51,v51,s80,-v72
v_fma_f32 v52,v52,s80,-v72
v_fma_f32 v53,v53,s80,-v72
v_fma_f32 v54,v54,s80,-v72
v_fma_f32 v55,v55,s80,-v72
v_fma_f32 v56,v56,s80,-v72
v_fma_f32 v57,v57,s80,-v72
v_fma_f32 v58,v58,s80,-v72
v_fma_f32 v59,v59,s80,-v72
v_exp_f32 v48,v48
v_exp_f32 v49,v49
v_exp_f32 v50,v50
v_exp_f32 v51,v51
v_exp_f32 v52,v52
v_exp_f32 v53,v53
v_exp_f32 v54,v54
v_exp_f32 v55,v55
v_exp_f32 v56,v56
v_exp_f32 v57,v57
v_exp_f32 v58,v58
v_exp_f32 v59,v59
v_add_f32 v74,v48,v49
v_add_f32 v75,v50,v51
v_add_f32 v74,v74,v52
v_add_f32 v75,v75,v53
v_add_f32 v74,v74,v54
v_add_f32 v75,v75,v55
v_add_f32 v74,v74,v56
v_add_f32 v75,v75,v57
v_add_f32 v74,v74,v58
v_add_f32 v75,v75,v59
v_add_f32 v74,v74,v75
v_mov_b32 v73,v74
s_nop 1
v_permlane16_swap_b32 v73,v74
v_add_f32 v74,v74,v73
v_mov_b32 v73,v74
s_nop 1
v_permlane32_swap_b32 v73,v74
v_add_f32 v74,v74,v73
v_rcp_f32 v75,v74
s_nop 0
v_mul_f32 v48,v48,v75
v_mul_f32 v49,v49,v75
v_mul_f32 v50,v50,v75
v_mul_f32 v51,v51,v75
v_mul_f32 v52,v52,v75
v_mul_f32 v53,v53,v75
v_mul_f32 v54,v54,v75
v_mul_f32 v55,v55,v75
v_mul_f32 v56,v56,v75
v_mul_f32 v57,v57,v75
v_mul_f32 v58,v58,v75
v_mul_f32 v59,v59,v75
v_cvt_pk_bf16_f32 v64,v48,v49
v_cvt_pk_bf16_f32 v65,v50,v51
v_cvt_pk_bf16_f32 v66,v52,v53
v_cvt_pk_bf16_f32 v67,v54,v55
v_cvt_pk_bf16_f32 v68,v56,v57
v_cvt_pk_bf16_f32 v69,v58,v59
v_mfma_f32_16x16x32_bf16 v[80:83],a[128:131],v[64:67],0
v_mfma_f32_16x16x32_bf16 v[84:87],a[132:135],v[64:67],0
v_mfma_f32_16x16x32_bf16 v[88:91],a[136:139],v[64:67],0
v_mfma_f32_16x16x32_bf16 v[92:95],a[140:143],v[64:67],0
v_mfma_f32_16x16x32_bf16 v[96:99],a[144:147],v[64:67],0
v_mfma_f32_16x16x32_bf16 v[100:103],a[148:151],v[64:67],0
v_mfma_f32_16x16x32_bf16 v[104:107],a[152:155],v[64:67],0
v_mfma_f32_16x16x32_bf16 v[108:111],a[156:159],v[64:67],0
s_waitcnt vmcnt(12)
v_mfma_f32_16x16x16_bf16 v[80:83],v[32:33],v[68:69],v[80:83]
v_mfma_f32_16x16x16_bf16 v[84:87],v[34:35],v[68:69],v[84:87]
v_mfma_f32_16x16x16_bf16 v[88:91],v[36:37],v[68:69],v[88:91]
v_mfma_f32_16x16x16_bf16 v[92:95],v[38:39],v[68:69],v[92:95]
v_mfma_f32_16x16x16_bf16 v[96:99],v[40:41],v[68:69],v[96:99]
v_mfma_f32_16x16x16_bf16 v[100:103],v[42:43],v[68:69],v[100:103]
v_mfma_f32_16x16x16_bf16 v[104:107],v[44:45],v[68:69],v[104:107]
v_mfma_f32_16x16x16_bf16 v[108:111],v[46:47],v[68:69],v[108:111]
s_nop 0
v_cvt_pk_bf16_f32 v112,v80,v81
v_cvt_pk_bf16_f32 v113,v82,v83
v_cvt_pk_bf16_f32 v114,v84,v85
v_cvt_pk_bf16_f32 v115,v86,v87
buffer_store_dwordx4 v[112:115],v0,s[20:23],s66 offen offset:0 sc1
v_cvt_pk_bf16_f32 v116,v88,v89
v_cvt_pk_bf16_f32 v117,v90,v91
v_cvt_pk_bf16_f32 v118,v92,v93
v_cvt_pk_bf16_f32 v119,v94,v95
buffer_store_dwordx4 v[116:119],v0,s[20:23],s66 offen offset:1024 sc1
v_cvt_pk_bf16_f32 v112,v96,v97
v_cvt_pk_bf16_f32 v113,v98,v99
v_cvt_pk_bf16_f32 v114,v100,v101
v_cvt_pk_bf16_f32 v115,v102,v103
buffer_store_dwordx4 v[112:115],v0,s[20:23],s66 offen offset:2048 sc1
v_cvt_pk_bf16_f32 v116,v104,v105
v_cvt_pk_bf16_f32 v117,v106,v107
v_cvt_pk_bf16_f32 v118,v108,v109
v_cvt_pk_bf16_f32 v119,v110,v111
buffer_store_dwordx4 v[116:119],v0,s[20:23],s66 offen offset:3072 sc1
s_barrier
s_cmp_lt_u32 s60,126
s_cbranch_scc1 pf_187
s_waitcnt vmcnt(0)
s_branch j1_188
pf_187:
buffer_load_dwordx4 a[48:51],v0,s[20:23],s94 offen offset:0
buffer_load_dwordx4 a[52:55],v0,s[20:23],s94 offen offset:1024
buffer_load_dwordx4 a[56:59],v0,s[20:23],s94 offen offset:2048
buffer_load_dwordx4 a[60:63],v0,s[20:23],s94 offen offset:3072
buffer_load_dwordx4 a[64:67],v0,s[20:23],s95 offen offset:0
buffer_load_dwordx4 a[68:71],v0,s[20:23],s95 offen offset:1024
buffer_load_dwordx4 a[72:75],v0,s[20:23],s95 offen offset:2048
buffer_load_dwordx4 a[76:79],v0,s[20:23],s95 offen offset:3072
j1_188:
s_add_u32 s66,s66,262144
s_add_u32 s60,s60,2
s_waitcnt vmcnt(8)
v_mov_b32 v6,s71
s_mov_b64 exec,1
buffer_store_dword v6,off,s[20:23],s69 sc1
s_mov_b64 exec,-1
s_cmp_lt_u32 s60,128
s_cbranch_scc1 top0_179
s_endpgm
fl_rec:
s_load_dwordx8 s[4:11],s[0:1],8
s_load_dwordx2 s[12:13],s[0:1],40
s_mov_b32 s57,s58
v_mov_b32 v0,v1
s_waitcnt lgkmcnt(0)
s_mov_b32 s28,s6
s_and_b32 s29,s7,0xffff
s_mov_b32 s30,0x800000
s_mov_b32 s31,0x20000
s_mov_b32 s32,s8
s_and_b32 s33,s9,0xffff
s_mov_b32 s34,0x800000
s_mov_b32 s35,0x20000
s_mov_b32 s36,s10
s_and_b32 s37,s11,0xffff
s_mov_b32 s38,0x800000
s_mov_b32 s39,0x20000
s_mov_b32 s40,s12
s_and_b32 s41,s13,0xffff
s_mov_b32 s42,0x800000
s_mov_b32 s43,0x20000
s_mov_b32 s44,s4
s_and_b32 s45,s5,0xffff
s_mov_b32 s46,0x4000
s_mov_b32 s47,0x20000
s_lshr_b32 s58,s57,5
s_and_b32 s59,s57,31
v_and_b32 v20,63,v0
v_and_b32 v21,15,v20
v_lshrrev_b32 v22,4,v20
v_lshrrev_b32 v23,3,v20
v_and_b32 v24,7,v20
v_lshlrev_b32 v16,13,v23
v_lshl_add_u32 v16,v24,4,v16
v_lshrrev_b32 v23,2,v20
v_and_b32 v24,3,v20
v_lshlrev_b32 v17,11,v23
v_lshl_add_u32 v17,v24,4,v17
s_lshl_b32 s61,s50,15
s_add_u32 s61,s61,32768
s_lshl_b32 s62,s50,21
s_lshl_b32 s64,s57,7
s_add_u32 s62,s62,s64
s_lshl_b32 s63,s58,22
s_lshl_b32 s64,s50,20
s_add_u32 s63,s63,s64
s_lshl_b32 s64,s59,6
s_add_u32 s63,s63,s64
v_lshrrev_b32 v23,1,v22
v_lshlrev_b32 v25,4,v23
v_and_b32 v23,1,v22
v_lshl_add_u32 v25,v23,2,v25
v_lshrrev_b32 v23,3,v21
v_lshl_add_u32 v25,v23,3,v25
v_bfe_u32 v23,v21,2,1
v_add_u32 v25,v25,v23
v_lshlrev_b32 v28,4,v23
v_lshrrev_b32 v23,1,v22
v_lshl_add_u32 v28,v23,3,v28
v_lshrrev_b32 v23,3,v21
v_lshl_add_u32 v28,v23,2,v28
v_and_b32 v23,1,v22
v_lshl_add_u32 v28,v23,1,v28
v_and_b32 v24,3,v21
v_lshlrev_b32 v26,7,v28
v_add_u32 v26,s61,v26
v_lshl_add_u32 v18,v24,3,v26
v_lshl_add_u32 v19,v24,4,v26
v_lshlrev_b32 v26,6,v25
v_add_u32 v26,s61,v26
v_lshl_add_u32 v27,v24,3,v26
v_lshlrev_b32 v0,4,v20
v_add_u32 v7,s61,v0
s_add_u32 s64,s62,0
s_add_u32 m0,s61,0
s_nop 0
buffer_load_dwordx4 v16,s[28:31],s64 offen lds
s_add_u32 s64,s62,65536
s_add_u32 m0,s61,1024
s_nop 0
buffer_load_dwordx4 v16,s[28:31],s64 offen lds
s_add_u32 s64,s62,131072
s_add_u32 m0,s61,2048
s_nop 0
buffer_load_dwordx4 v16,s[28:31],s64 offen lds
s_add_u32 s64,s62,196608
s_add_u32 m0,s61,3072
s_nop 0
buffer_load_dwordx4 v16,s[28:31],s64 offen lds
s_add_u32 s64,s62,262144
s_add_u32 m0,s61,4096
s_nop 0
buffer_load_dwordx4 v16,s[28:31],s64 offen lds
s_add_u32 s64,s62,327680
s_add_u32 m0,s61,5120
s_nop 0
buffer_load_dwordx4 v16,s[28:31],s64 offen lds
s_add_u32 s64,s62,393216
s_add_u32 m0,s61,6144
s_nop 0
buffer_load_dwordx4 v16,s[28:31],s64 offen lds
s_add_u32 s64,s62,458752
s_add_u32 m0,s61,7168
s_nop 0
buffer_load_dwordx4 v16,s[28:31],s64 offen lds
s_add_u32 s64,s62,524288
s_add_u32 m0,s61,8192
s_nop 0
buffer_load_dwordx4 v16,s[28:31],s64 offen lds
s_add_u32 s64,s62,589824
s_add_u32 m0,s61,9216
s_nop 0
buffer_load_dwordx4 v16,s[28:31],s64 offen lds
s_add_u32 s64,s62,655360
s_add_u32 m0,s61,10240
s_nop 0
buffer_load_dwordx4 v16,s[28:31],s64 offen lds
s_add_u32 s64,s62,720896
s_add_u32 m0,s61,11264
s_nop 0
buffer_load_dwordx4 v16,s[28:31],s64 offen lds
s_add_u32 s64,s62,786432
s_add_u32 m0,s61,12288
s_nop 0
buffer_load_dwordx4 v16,s[28:31],s64 offen lds
s_add_u32 s64,s62,851968
s_add_u32 m0,s61,13312
s_nop 0
buffer_load_dwordx4 v16,s[28:31],s64 offen lds
s_add_u32 s64,s62,917504
s_add_u32 m0,s61,14336
s_nop 0
buffer_load_dwordx4 v16,s[28:31],s64 offen lds
s_add_u32 s64,s62,983040
s_add_u32 m0,s61,15360
s_nop 0
buffer_load_dwordx4 v16,s[28:31],s64 offen lds
s_add_u32 s64,s62,1048576
s_add_u32 m0,s61,16384
s_nop 0
buffer_load_dwordx4 v16,s[28:31],s64 offen lds
s_add_u32 s64,s62,1114112
s_add_u32 m0,s61,17408
s_nop 0
buffer_load_dwordx4 v16,s[28:31],s64 offen lds
s_add_u32 s64,s62,1179648
s_add_u32 m0,s61,18432
s_nop 0
buffer_load_dwordx4 v16,s[28:31],s64 offen lds
s_add_u32 s64,s62,1245184
s_add_u32 m0,s61,19456
s_nop 0
buffer_load_dwordx4 v16,s[28:31],s64 offen lds
s_add_u32 s64,s62,1310720
s_add_u32 m0,s61,20480
s_nop 0
buffer_load_dwordx4 v16,s[28:31],s64 offen lds
s_add_u32 s64,s62,1376256
s_add_u32 m0,s61,21504
s_nop 0
buffer_load_dwordx4 v16,s[28:31],s64 offen lds
s_add_u32 s64,s62,1441792
s_add_u32 m0,s61,22528
s_nop 0
buffer_load_dwordx4 v16,s[28:31],s64 offen lds
s_add_u32 s64,s62,1507328
s_add_u32 m0,s61,23552
s_nop 0
buffer_load_dwordx4 v16,s[28:31],s64 offen lds
s_add_u32 s64,s62,1572864
s_add_u32 m0,s61,24576
s_nop 0
buffer_load_dwordx4 v16,s[28:31],s64 offen lds
s_add_u32 s64,s62,1638400
s_add_u32 m0,s61,25600
s_nop 0
buffer_load_dwordx4 v16,s[28:31],s64 offen lds
s_add_u32 s64,s62,1703936
s_add_u32 m0,s61,26624
s_nop 0
buffer_load_dwordx4 v16,s[28:31],s64 offen lds
s_add_u32 s64,s62,1769472
s_add_u32 m0,s61,27648
s_nop 0
buffer_load_dwordx4 v16,s[28:31],s64 offen lds
s_add_u32 s64,s62,1835008
s_add_u32 m0,s61,28672
s_nop 0
buffer_load_dwordx4 v16,s[28:31],s64 offen lds
s_add_u32 s64,s62,1900544
s_add_u32 m0,s61,29696
s_nop 0
buffer_load_dwordx4 v16,s[28:31],s64 offen lds
s_add_u32 s64,s62,1966080
s_add_u32 m0,s61,30720
s_nop 0
buffer_load_dwordx4 v16,s[28:31],s64 offen lds
s_add_u32 s64,s62,2031616
s_add_u32 m0,s61,31744
s_nop 0
buffer_load_dwordx4 v16,s[28:31],s64 offen lds
s_waitcnt vmcnt(16)
ds_read_b64_tr_b16 a[0:1],v18 offset:0
ds_read_b64_tr_b16 a[2:3],v18 offset:128
ds_read_b64_tr_b16 a[4:5],v18 offset:4096
ds_read_b64_tr_b16 a[6:7],v18 offset:4224
ds_read_b64_tr_b16 a[8:9],v18 offset:32
ds_read_b64_tr_b16 a[10:11],v18 offset:160
ds_read_b64_tr_b16 a[12:13],v18 offset:4128
ds_read_b64_tr_b16 a[14:15],v18 offset:4256
ds_read_b64_tr_b16 a[16:17],v18 offset:64
ds_read_b64_tr_b16 a[18:19],v18 offset:192
ds_read_b64_tr_b16 a[20:21],v18 offset:4160
ds_read_b64_tr_b16 a[22:23],v18 offset:4288
ds_read_b64_tr_b16 a[24:25],v18 offset:96
ds_read_b64_tr_b16 a[26:27],v18 offset:224
ds_read_b64_tr_b16 a[28:29],v18 offset:4192
ds_read_b64_tr_b16 a[30:31],v18 offset:4320
s_waitcnt lgkmcnt(0)
ds_read_b64_tr_b16 a[64:65],v18 offset:8192
ds_read_b64_tr_b16 a[66:67],v18 offset:8320
ds_read_b64_tr_b16 a[68:69],v18 offset:12288
ds_read_b64_tr_b16 a[70:71],v18 offset:12416
ds_read_b64_tr_b16 a[72:73],v18 offset:8224
ds_read_b64_tr_b16 a[74:75],v18 offset:8352
ds_read_b64_tr_b16 a[76:77],v18 offset:12320
ds_read_b64_tr_b16 a[78:79],v18 offset:12448
ds_read_b64_tr_b16 a[80:81],v18 offset:8256
ds_read_b64_tr_b16 a[82:83],v18 offset:8384
ds_read_b64_tr_b16 a[84:85],v18 offset:12352
ds_read_b64_tr_b16 a[86:87],v18 offset:12480
ds_read_b64_tr_b16 a[88:89],v18 offset:8288
ds_read_b64_tr_b16 a[90:91],v18 offset:8416
ds_read_b64_tr_b16 a[92:93],v18 offset:12384
ds_read_b64_tr_b16 a[94:95],v18 offset:12512
s_waitcnt lgkmcnt(0)
s_add_u32 s64,s62,0
s_add_u32 m0,s61,0
s_nop 0
buffer_load_dwordx4 v16,s[32:35],s64 offen lds
s_add_u32 s64,s62,65536
s_add_u32 m0,s61,1024
s_nop 0
buffer_load_dwordx4 v16,s[32:35],s64 offen lds
s_add_u32 s64,s62,131072
s_add_u32 m0,s61,2048
s_nop 0
buffer_load_dwordx4 v16,s[32:35],s64 offen lds
s_add_u32 s64,s62,196608
s_add_u32 m0,s61,3072
s_nop 0
buffer_load_dwordx4 v16,s[32:35],s64 offen lds
s_add_u32 s64,s62,262144
s_add_u32 m0,s61,4096
s_nop 0
buffer_load_dwordx4 v16,s[32:35],s64 offen lds
s_add_u32 s64,s62,327680
s_add_u32 m0,s61,5120
s_nop 0
buffer_load_dwordx4 v16,s[32:35],s64 offen lds
s_add_u32 s64,s62,393216
s_add_u32 m0,s61,6144
s_nop 0
buffer_load_dwordx4 v16,s[32:35],s64 offen lds
s_add_u32 s64,s62,458752
s_add_u32 m0,s61,7168
s_nop 0
buffer_load_dwordx4 v16,s[32:35],s64 offen lds
s_add_u32 s64,s62,524288
s_add_u32 m0,s61,8192
s_nop 0
buffer_load_dwordx4 v16,s[32:35],s64 offen lds
s_add_u32 s64,s62,589824
s_add_u32 m0,s61,9216
s_nop 0
buffer_load_dwordx4 v16,s[32:35],s64 offen lds
s_add_u32 s64,s62,655360
s_add_u32 m0,s61,10240
s_nop 0
buffer_load_dwordx4 v16,s[32:35],s64 offen lds
s_add_u32 s64,s62,720896
s_add_u32 m0,s61,11264
s_nop 0
buffer_load_dwordx4 v16,s[32:35],s64 offen lds
s_add_u32 s64,s62,786432
s_add_u32 m0,s61,12288
s_nop 0
buffer_load_dwordx4 v16,s[32:35],s64 offen lds
s_add_u32 s64,s62,851968
s_add_u32 m0,s61,13312
s_nop 0
buffer_load_dwordx4 v16,s[32:35],s64 offen lds
s_add_u32 s64,s62,917504
s_add_u32 m0,s61,14336
s_nop 0
buffer_load_dwordx4 v16,s[32:35],s64 offen lds
s_add_u32 s64,s62,983040
s_add_u32 m0,s61,15360
s_nop 0
buffer_load_dwordx4 v16,s[32:35],s64 offen lds
s_waitcnt vmcnt(16)
ds_read_b64_tr_b16 a[128:129],v18 offset:16384
ds_read_b64_tr_b16 a[130:131],v18 offset:16512
ds_read_b64_tr_b16 a[132:133],v18 offset:20480
ds_read_b64_tr_b16 a[134:135],v18 offset:20608
ds_read_b64_tr_b16 a[136:137],v18 offset:16416
ds_read_b64_tr_b16 a[138:139],v18 offset:16544
ds_read_b64_tr_b16 a[140:141],v18 offset:20512
ds_read_b64_tr_b16 a[142:143],v18 offset:20640
ds_read_b64_tr_b16 a[144:145],v18 offset:16448
ds_read_b64_tr_b16 a[146:147],v18 offset:16576
ds_read_b64_tr_b16 a[148:149],v18 offset:20544
ds_read_b64_tr_b16 a[150:151],v18 offset:20672
ds_read_b64_tr_b16 a[152:153],v18 offset:16480
ds_read_b64_tr_b16 a[154:155],v18 offset:16608
ds_read_b64_tr_b16 a[156:157],v18 offset:20576
ds_read_b64_tr_b16 a[158:159],v18 offset:20704
s_waitcnt lgkmcnt(0)
ds_read_b64_tr_b16 a[192:193],v18 offset:24576
ds_read_b64_tr_b16 a[194:195],v18 offset:24704
ds_read_b64_tr_b16 a[196:197],v18 offset:28672
ds_read_b64_tr_b16 a[198:199],v18 offset:28800
ds_read_b64_tr_b16 a[200:201],v18 offset:24608
ds_read_b64_tr_b16 a[202:203],v18 offset:24736
ds_read_b64_tr_b16 a[204:205],v18 offset:28704
ds_read_b64_tr_b16 a[206:207],v18 offset:28832
ds_read_b64_tr_b16 a[208:209],v18 offset:24640
ds_read_b64_tr_b16 a[210:211],v18 offset:24768
ds_read_b64_tr_b16 a[212:213],v18 offset:28736
ds_read_b64_tr_b16 a[214:215],v18 offset:28864
ds_read_b64_tr_b16 a[216:217],v18 offset:24672
ds_read_b64_tr_b16 a[218:219],v18 offset:24800
ds_read_b64_tr_b16 a[220:221],v18 offset:28768
ds_read_b64_tr_b16 a[222:223],v18 offset:28896
s_waitcnt lgkmcnt(0)
s_add_u32 s64,s62,1048576
s_add_u32 m0,s61,16384
s_nop 0
buffer_load_dwordx4 v16,s[32:35],s64 offen lds
s_add_u32 s64,s62,1114112
s_add_u32 m0,s61,17408
s_nop 0
buffer_load_dwordx4 v16,s[32:35],s64 offen lds
s_add_u32 s64,s62,1179648
s_add_u32 m0,s61,18432
s_nop 0
buffer_load_dwordx4 v16,s[32:35],s64 offen lds
s_add_u32 s64,s62,1245184
s_add_u32 m0,s61,19456
s_nop 0
buffer_load_dwordx4 v16,s[32:35],s64 offen lds
s_add_u32 s64,s62,1310720
s_add_u32 m0,s61,20480
s_nop 0
buffer_load_dwordx4 v16,s[32:35],s64 offen lds
s_add_u32 s64,s62,1376256
s_add_u32 m0,s61,21504
s_nop 0
buffer_load_dwordx4 v16,s[32:35],s64 offen lds
s_add_u32 s64,s62,1441792
s_add_u32 m0,s61,22528
s_nop 0
buffer_load_dwordx4 v16,s[32:35],s64 offen lds
s_add_u32 s64,s62,1507328
s_add_u32 m0,s61,23552
s_nop 0
buffer_load_dwordx4 v16,s[32:35],s64 offen lds
s_add_u32 s64,s62,1572864
s_add_u32 m0,s61,24576
s_nop 0
buffer_load_dwordx4 v16,s[32:35],s64 offen lds
s_add_u32 s64,s62,1638400
s_add_u32 m0,s61,25600
s_nop 0
buffer_load_dwordx4 v16,s[32:35],s64 offen lds
s_add_u32 s64,s62,1703936
s_add_u32 m0,s61,26624
s_nop 0
buffer_load_dwordx4 v16,s[32:35],s64 offen lds
s_add_u32 s64,s62,1769472
s_add_u32 m0,s61,27648
s_nop 0
buffer_load_dwordx4 v16,s[32:35],s64 offen lds
s_add_u32 s64,s62,1835008
s_add_u32 m0,s61,28672
s_nop 0
buffer_load_dwordx4 v16,s[32:35],s64 offen lds
s_add_u32 s64,s62,1900544
s_add_u32 m0,s61,29696
s_nop 0
buffer_load_dwordx4 v16,s[32:35],s64 offen lds
s_add_u32 s64,s62,1966080
s_add_u32 m0,s61,30720
s_nop 0
buffer_load_dwordx4 v16,s[32:35],s64 offen lds
s_add_u32 s64,s62,2031616
s_add_u32 m0,s61,31744
s_nop 0
buffer_load_dwordx4 v16,s[32:35],s64 offen lds
s_waitcnt vmcnt(16)
ds_read_b64_tr_b16 a[32:33],v18 offset:0
ds_read_b64_tr_b16 a[34:35],v18 offset:128
ds_read_b64_tr_b16 a[36:37],v18 offset:4096
ds_read_b64_tr_b16 a[38:39],v18 offset:4224
ds_read_b64_tr_b16 a[40:41],v18 offset:32
ds_read_b64_tr_b16 a[42:43],v18 offset:160
ds_read_b64_tr_b16 a[44:45],v18 offset:4128
ds_read_b64_tr_b16 a[46:47],v18 offset:4256
ds_read_b64_tr_b16 a[48:49],v18 offset:64
ds_read_b64_tr_b16 a[50:51],v18 offset:192
ds_read_b64_tr_b16 a[52:53],v18 offset:4160
ds_read_b64_tr_b16 a[54:55],v18 offset:4288
ds_read_b64_tr_b16 a[56:57],v18 offset:96
ds_read_b64_tr_b16 a[58:59],v18 offset:224
ds_read_b64_tr_b16 a[60:61],v18 offset:4192
ds_read_b64_tr_b16 a[62:63],v18 offset:4320
s_waitcnt lgkmcnt(0)
ds_read_b64_tr_b16 a[96:97],v18 offset:8192
ds_read_b64_tr_b16 a[98:99],v18 offset:8320
ds_read_b64_tr_b16 a[100:101],v18 offset:12288
ds_read_b64_tr_b16 a[102:103],v18 offset:12416
ds_read_b64_tr_b16 a[104:105],v18 offset:8224
ds_read_b64_tr_b16 a[106:107],v18 offset:8352
ds_read_b64_tr_b16 a[108:109],v18 offset:12320
ds_read_b64_tr_b16 a[110:111],v18 offset:12448
ds_read_b64_tr_b16 a[112:113],v18 offset:8256
ds_read_b64_tr_b16 a[114:115],v18 offset:8384
ds_read_b64_tr_b16 a[116:117],v18 offset:12352
ds_read_b64_tr_b16 a[118:119],v18 offset:12480
ds_read_b64_tr_b16 a[120:121],v18 offset:8288
ds_read_b64_tr_b16 a[122:123],v18 offset:8416
ds_read_b64_tr_b16 a[124:125],v18 offset:12384
ds_read_b64_tr_b16 a[126:127],v18 offset:12512
s_waitcnt lgkmcnt(0)
s_add_u32 s64,s63,0
s_add_u32 m0,s61,0
s_nop 0
buffer_load_dwordx4 v17,s[40:43],s64 offen lds
s_add_u32 s64,s63,32768
s_add_u32 m0,s61,1024
s_nop 0
buffer_load_dwordx4 v17,s[40:43],s64 offen lds
s_add_u32 s64,s63,65536
s_add_u32 m0,s61,2048
s_nop 0
buffer_load_dwordx4 v17,s[40:43],s64 offen lds
s_add_u32 s64,s63,98304
s_add_u32 m0,s61,3072
s_nop 0
buffer_load_dwordx4 v17,s[40:43],s64 offen lds
s_add_u32 s64,s63,131072
s_add_u32 m0,s61,4096
s_nop 0
buffer_load_dwordx4 v17,s[40:43],s64 offen lds
s_add_u32 s64,s63,163840
s_add_u32 m0,s61,5120
s_nop 0
buffer_load_dwordx4 v17,s[40:43],s64 offen lds
s_add_u32 s64,s63,196608
s_add_u32 m0,s61,6144
s_nop 0
buffer_load_dwordx4 v17,s[40:43],s64 offen lds
s_add_u32 s64,s63,229376
s_add_u32 m0,s61,7168
s_nop 0
buffer_load_dwordx4 v17,s[40:43],s64 offen lds
s_add_u32 s64,s63,262144
s_add_u32 m0,s61,8192
s_nop 0
buffer_load_dwordx4 v17,s[40:43],s64 offen lds
s_add_u32 s64,s63,294912
s_add_u32 m0,s61,9216
s_nop 0
buffer_load_dwordx4 v17,s[40:43],s64 offen lds
s_add_u32 s64,s63,327680
s_add_u32 m0,s61,10240
s_nop 0
buffer_load_dwordx4 v17,s[40:43],s64 offen lds
s_add_u32 s64,s63,360448
s_add_u32 m0,s61,11264
s_nop 0
buffer_load_dwordx4 v17,s[40:43],s64 offen lds
s_add_u32 s64,s63,393216
s_add_u32 m0,s61,12288
s_nop 0
buffer_load_dwordx4 v17,s[40:43],s64 offen lds
s_add_u32 s64,s63,425984
s_add_u32 m0,s61,13312
s_nop 0
buffer_load_dwordx4 v17,s[40:43],s64 offen lds
s_add_u32 s64,s63,458752
s_add_u32 m0,s61,14336
s_nop 0
buffer_load_dwordx4 v17,s[40:43],s64 offen lds
s_add_u32 s64,s63,491520
s_add_u32 m0,s61,15360
s_nop 0
buffer_load_dwordx4 v17,s[40:43],s64 offen lds
s_waitcnt vmcnt(16)
ds_read_b64_tr_b16 a[160:161],v18 offset:16384
ds_read_b64_tr_b16 a[162:163],v18 offset:16512
ds_read_b64_tr_b16 a[164:165],v18 offset:20480
ds_read_b64_tr_b16 a[166:167],v18 offset:20608
ds_read_b64_tr_b16 a[168:169],v18 offset:16416
ds_read_b64_tr_b16 a[170:171],v18 offset:16544
ds_read_b64_tr_b16 a[172:173],v18 offset:20512
ds_read_b64_tr_b16 a[174:175],v18 offset:20640
ds_read_b64_tr_b16 a[176:177],v18 offset:16448
ds_read_b64_tr_b16 a[178:179],v18 offset:16576
ds_read_b64_tr_b16 a[180:181],v18 offset:20544
ds_read_b64_tr_b16 a[182:183],v18 offset:20672
ds_read_b64_tr_b16 a[184:185],v18 offset:16480
ds_read_b64_tr_b16 a[186:187],v18 offset:16608
ds_read_b64_tr_b16 a[188:189],v18 offset:20576
ds_read_b64_tr_b16 a[190:191],v18 offset:20704
s_waitcnt lgkmcnt(0)
ds_read_b64_tr_b16 a[224:225],v18 offset:24576
ds_read_b64_tr_b16 a[226:227],v18 offset:24704
ds_read_b64_tr_b16 a[228:229],v18 offset:28672
ds_read_b64_tr_b16 a[230:231],v18 offset:28800
ds_read_b64_tr_b16 a[232:233],v18 offset:24608
ds_read_b64_tr_b16 a[234:235],v18 offset:24736
ds_read_b64_tr_b16 a[236:237],v18 offset:28704
ds_read_b64_tr_b16 a[238:239],v18 offset:28832
ds_read_b64_tr_b16 a[240:241],v18 offset:24640
ds_read_b64_tr_b16 a[242:243],v18 offset:24768
ds_read_b64_tr_b16 a[244:245],v18 offset:28736
ds_read_b64_tr_b16 a[246:247],v18 offset:28864
ds_read_b64_tr_b16 a[248:249],v18 offset:24672
ds_read_b64_tr_b16 a[250:251],v18 offset:24800
ds_read_b64_tr_b16 a[252:253],v18 offset:28768
ds_read_b64_tr_b16 a[254:255],v18 offset:28896
s_waitcnt lgkmcnt(0)
s_add_u32 s64,s63,524288
s_add_u32 m0,s61,16384
s_nop 0
buffer_load_dwordx4 v17,s[40:43],s64 offen lds
s_add_u32 s64,s63,557056
s_add_u32 m0,s61,17408
s_nop 0
buffer_load_dwordx4 v17,s[40:43],s64 offen lds
s_add_u32 s64,s63,589824
s_add_u32 m0,s61,18432
s_nop 0
buffer_load_dwordx4 v17,s[40:43],s64 offen lds
s_add_u32 s64,s63,622592
s_add_u32 m0,s61,19456
s_nop 0
buffer_load_dwordx4 v17,s[40:43],s64 offen lds
s_add_u32 s64,s63,655360
s_add_u32 m0,s61,20480
s_nop 0
buffer_load_dwordx4 v17,s[40:43],s64 offen lds
s_add_u32 s64,s63,688128
s_add_u32 m0,s61,21504
s_nop 0
buffer_load_dwordx4 v17,s[40:43],s64 offen lds
s_add_u32 s64,s63,720896
s_add_u32 m0,s61,22528
s_nop 0
buffer_load_dwordx4 v17,s[40:43],s64 offen lds
s_add_u32 s64,s63,753664
s_add_u32 m0,s61,23552
s_nop 0
buffer_load_dwordx4 v17,s[40:43],s64 offen lds
s_add_u32 s64,s63,786432
s_add_u32 m0,s61,24576
s_nop 0
buffer_load_dwordx4 v17,s[40:43],s64 offen lds
s_add_u32 s64,s63,819200
s_add_u32 m0,s61,25600
s_nop 0
buffer_load_dwordx4 v17,s[40:43],s64 offen lds
s_add_u32 s64,s63,851968
s_add_u32 m0,s61,26624
s_nop 0
buffer_load_dwordx4 v17,s[40:43],s64 offen lds
s_add_u32 s64,s63,884736
s_add_u32 m0,s61,27648
s_nop 0
buffer_load_dwordx4 v17,s[40:43],s64 offen lds
s_add_u32 s64,s63,917504
s_add_u32 m0,s61,28672
s_nop 0
buffer_load_dwordx4 v17,s[40:43],s64 offen lds
s_add_u32 s64,s63,950272
s_add_u32 m0,s61,29696
s_nop 0
buffer_load_dwordx4 v17,s[40:43],s64 offen lds
s_add_u32 s64,s63,983040
s_add_u32 m0,s61,30720
s_nop 0
buffer_load_dwordx4 v17,s[40:43],s64 offen lds
s_add_u32 s64,s63,1015808
s_add_u32 m0,s61,31744
s_nop 0
buffer_load_dwordx4 v17,s[40:43],s64 offen lds
s_waitcnt vmcnt(16)
ds_read_b64_tr_b16 v[48:49],v27 offset:0
ds_read_b64_tr_b16 v[50:51],v27 offset:128
ds_read_b64_tr_b16 v[52:53],v27 offset:2048
ds_read_b64_tr_b16 v[54:55],v27 offset:2176
ds_read_b64_tr_b16 v[56:57],v27 offset:32
ds_read_b64_tr_b16 v[58:59],v27 offset:160
ds_read_b64_tr_b16 v[60:61],v27 offset:2080
ds_read_b64_tr_b16 v[62:63],v27 offset:2208
ds_read_b64_tr_b16 v[64:65],v27 offset:4096
ds_read_b64_tr_b16 v[66:67],v27 offset:4224
ds_read_b64_tr_b16 v[68:69],v27 offset:6144
ds_read_b64_tr_b16 v[70:71],v27 offset:6272
ds_read_b64_tr_b16 v[72:73],v27 offset:4128
ds_read_b64_tr_b16 v[74:75],v27 offset:4256
ds_read_b64_tr_b16 v[76:77],v27 offset:6176
ds_read_b64_tr_b16 v[78:79],v27 offset:6304
s_waitcnt lgkmcnt(0)
ds_read_b64_tr_b16 v[80:81],v27 offset:8192
ds_read_b64_tr_b16 v[82:83],v27 offset:8320
ds_read_b64_tr_b16 v[84:85],v27 offset:10240
ds_read_b64_tr_b16 v[86:87],v27 offset:10368
ds_read_b64_tr_b16 v[88:89],v27 offset:8224
ds_read_b64_tr_b16 v[90:91],v27 offset:8352
ds_read_b64_tr_b16 v[92:93],v27 offset:10272
ds_read_b64_tr_b16 v[94:95],v27 offset:10400
ds_read_b64_tr_b16 v[128:129],v27 offset:12288
ds_read_b64_tr_b16 v[130:131],v27 offset:12416
ds_read_b64_tr_b16 v[132:133],v27 offset:14336
ds_read_b64_tr_b16 v[134:135],v27 offset:14464
ds_read_b64_tr_b16 v[136:137],v27 offset:12320
ds_read_b64_tr_b16 v[138:139],v27 offset:12448
ds_read_b64_tr_b16 v[140:141],v27 offset:14368
ds_read_b64_tr_b16 v[142:143],v27 offset:14496
s_waitcnt lgkmcnt(0)
s_add_u32 s64,s62,0
s_add_u32 m0,s61,0
s_nop 0
buffer_load_dwordx4 v16,s[36:39],s64 offen lds
s_add_u32 s64,s62,65536
s_add_u32 m0,s61,1024
s_nop 0
buffer_load_dwordx4 v16,s[36:39],s64 offen lds
s_add_u32 s64,s62,131072
s_add_u32 m0,s61,2048
s_nop 0
buffer_load_dwordx4 v16,s[36:39],s64 offen lds
s_add_u32 s64,s62,196608
s_add_u32 m0,s61,3072
s_nop 0
buffer_load_dwordx4 v16,s[36:39],s64 offen lds
s_add_u32 s64,s62,262144
s_add_u32 m0,s61,4096
s_nop 0
buffer_load_dwordx4 v16,s[36:39],s64 offen lds
s_add_u32 s64,s62,327680
s_add_u32 m0,s61,5120
s_nop 0
buffer_load_dwordx4 v16,s[36:39],s64 offen lds
s_add_u32 s64,s62,393216
s_add_u32 m0,s61,6144
s_nop 0
buffer_load_dwordx4 v16,s[36:39],s64 offen lds
s_add_u32 s64,s62,458752
s_add_u32 m0,s61,7168
s_nop 0
buffer_load_dwordx4 v16,s[36:39],s64 offen lds
s_add_u32 s64,s62,524288
s_add_u32 m0,s61,8192
s_nop 0
buffer_load_dwordx4 v16,s[36:39],s64 offen lds
s_add_u32 s64,s62,589824
s_add_u32 m0,s61,9216
s_nop 0
buffer_load_dwordx4 v16,s[36:39],s64 offen lds
s_add_u32 s64,s62,655360
s_add_u32 m0,s61,10240
s_nop 0
buffer_load_dwordx4 v16,s[36:39],s64 offen lds
s_add_u32 s64,s62,720896
s_add_u32 m0,s61,11264
s_nop 0
buffer_load_dwordx4 v16,s[36:39],s64 offen lds
s_add_u32 s64,s62,786432
s_add_u32 m0,s61,12288
s_nop 0
buffer_load_dwordx4 v16,s[36:39],s64 offen lds
s_add_u32 s64,s62,851968
s_add_u32 m0,s61,13312
s_nop 0
buffer_load_dwordx4 v16,s[36:39],s64 offen lds
s_add_u32 s64,s62,917504
s_add_u32 m0,s61,14336
s_nop 0
buffer_load_dwordx4 v16,s[36:39],s64 offen lds
s_add_u32 s64,s62,983040
s_add_u32 m0,s61,15360
s_nop 0
buffer_load_dwordx4 v16,s[36:39],s64 offen lds
s_waitcnt vmcnt(16)
ds_read_b64_tr_b16 v[144:145],v27 offset:16384
ds_read_b64_tr_b16 v[146:147],v27 offset:16512
ds_read_b64_tr_b16 v[148:149],v27 offset:18432
ds_read_b64_tr_b16 v[150:151],v27 offset:18560
ds_read_b64_tr_b16 v[152:153],v27 offset:16416
ds_read_b64_tr_b16 v[154:155],v27 offset:16544
ds_read_b64_tr_b16 v[156:157],v27 offset:18464
ds_read_b64_tr_b16 v[158:159],v27 offset:18592
ds_read_b64_tr_b16 v[160:161],v27 offset:20480
ds_read_b64_tr_b16 v[162:163],v27 offset:20608
ds_read_b64_tr_b16 v[164:165],v27 offset:22528
ds_read_b64_tr_b16 v[166:167],v27 offset:22656
ds_read_b64_tr_b16 v[168:169],v27 offset:20512
ds_read_b64_tr_b16 v[170:171],v27 offset:20640
ds_read_b64_tr_b16 v[172:173],v27 offset:22560
ds_read_b64_tr_b16 v[174:175],v27 offset:22688
s_waitcnt lgkmcnt(0)
ds_read_b64_tr_b16 v[176:177],v27 offset:24576
ds_read_b64_tr_b16 v[178:179],v27 offset:24704
ds_read_b64_tr_b16 v[180:181],v27 offset:26624
ds_read_b64_tr_b16 v[182:183],v27 offset:26752
ds_read_b64_tr_b16 v[184:185],v27 offset:24608
ds_read_b64_tr_b16 v[186:187],v27 offset:24736
ds_read_b64_tr_b16 v[188:189],v27 offset:26656
ds_read_b64_tr_b16 v[190:191],v27 offset:26784
ds_read_b64_tr_b16 v[192:193],v27 offset:28672
ds_read_b64_tr_b16 v[194:195],v27 offset:28800
ds_read_b64_tr_b16 v[196:197],v27 offset:30720
ds_read_b64_tr_b16 v[198:199],v27 offset:30848
ds_read_b64_tr_b16 v[200:201],v27 offset:28704
ds_read_b64_tr_b16 v[202:203],v27 offset:28832
ds_read_b64_tr_b16 v[204:205],v27 offset:30752
ds_read_b64_tr_b16 v[206:207],v27 offset:30880
s_waitcnt lgkmcnt(0)
s_add_u32 s64,s62,1048576
s_add_u32 m0,s61,16384
s_nop 0
buffer_load_dwordx4 v16,s[36:39],s64 offen lds
s_add_u32 s64,s62,1114112
s_add_u32 m0,s61,17408
s_nop 0
buffer_load_dwordx4 v16,s[36:39],s64 offen lds
s_add_u32 s64,s62,1179648
s_add_u32 m0,s61,18432
s_nop 0
buffer_load_dwordx4 v16,s[36:39],s64 offen lds
s_add_u32 s64,s62,1245184
s_add_u32 m0,s61,19456
s_nop 0
buffer_load_dwordx4 v16,s[36:39],s64 offen lds
s_add_u32 s64,s62,1310720
s_add_u32 m0,s61,20480
s_nop 0
buffer_load_dwordx4 v16,s[36:39],s64 offen lds
s_add_u32 s64,s62,1376256
s_add_u32 m0,s61,21504
s_nop 0
buffer_load_dwordx4 v16,s[36:39],s64 offen lds
s_add_u32 s64,s62,1441792
s_add_u32 m0,s61,22528
s_nop 0
buffer_load_dwordx4 v16,s[36:39],s64 offen lds
s_add_u32 s64,s62,1507328
s_add_u32 m0,s61,23552
s_nop 0
buffer_load_dwordx4 v16,s[36:39],s64 offen lds
s_add_u32 s64,s62,1572864
s_add_u32 m0,s61,24576
s_nop 0
buffer_load_dwordx4 v16,s[36:39],s64 offen lds
s_add_u32 s64,s62,1638400
s_add_u32 m0,s61,25600
s_nop 0
buffer_load_dwordx4 v16,s[36:39],s64 offen lds
s_add_u32 s64,s62,1703936
s_add_u32 m0,s61,26624
s_nop 0
buffer_load_dwordx4 v16,s[36:39],s64 offen lds
s_add_u32 s64,s62,1769472
s_add_u32 m0,s61,27648
s_nop 0
buffer_load_dwordx4 v16,s[36:39],s64 offen lds
s_add_u32 s64,s62,1835008
s_add_u32 m0,s61,28672
s_nop 0
buffer_load_dwordx4 v16,s[36:39],s64 offen lds
s_add_u32 s64,s62,1900544
s_add_u32 m0,s61,29696
s_nop 0
buffer_load_dwordx4 v16,s[36:39],s64 offen lds
s_add_u32 s64,s62,1966080
s_add_u32 m0,s61,30720
s_nop 0
buffer_load_dwordx4 v16,s[36:39],s64 offen lds
s_add_u32 s64,s62,2031616
s_add_u32 m0,s61,31744
s_nop 0
buffer_load_dwordx4 v16,s[36:39],s64 offen lds
s_waitcnt vmcnt(16)
ds_read_b64_tr_b16 v[208:209],v19 offset:0
ds_read_b64_tr_b16 v[210:211],v19 offset:128
ds_read_b64_tr_b16 v[212:213],v19 offset:4096
ds_read_b64_tr_b16 v[214:215],v19 offset:4224
ds_read_b64_tr_b16 v[216:217],v19 offset:8
ds_read_b64_tr_b16 v[218:219],v19 offset:136
ds_read_b64_tr_b16 v[220:221],v19 offset:4104
ds_read_b64_tr_b16 v[222:223],v19 offset:4232
ds_read_b64_tr_b16 v[224:225],v19 offset:64
ds_read_b64_tr_b16 v[226:227],v19 offset:192
ds_read_b64_tr_b16 v[228:229],v19 offset:4160
ds_read_b64_tr_b16 v[230:231],v19 offset:4288
ds_read_b64_tr_b16 v[232:233],v19 offset:72
ds_read_b64_tr_b16 v[234:235],v19 offset:200
ds_read_b64_tr_b16 v[236:237],v19 offset:4168
ds_read_b64_tr_b16 v[238:239],v19 offset:4296
s_waitcnt lgkmcnt(0)
ds_read_b64_tr_b16 v[240:241],v19 offset:8192
ds_read_b64_tr_b16 v[242:243],v19 offset:8320
ds_read_b64_tr_b16 v[244:245],v19 offset:12288
ds_read_b64_tr_b16 v[246:247],v19 offset:12416
ds_read_b64_tr_b16 v[248:249],v19 offset:8200
ds_read_b64_tr_b16 v[250:251],v19 offset:8328
ds_read_b64_tr_b16 v[252:253],v19 offset:12296
ds_read_b64_tr_b16 v[254:255],v19 offset:12424
ds_read_b64_tr_b16 v[96:97],v19 offset:8256
ds_read_b64_tr_b16 v[98:99],v19 offset:8384
ds_read_b64_tr_b16 v[100:101],v19 offset:12352
ds_read_b64_tr_b16 v[102:103],v19 offset:12480
ds_read_b64_tr_b16 v[104:105],v19 offset:8264
ds_read_b64_tr_b16 v[106:107],v19 offset:8392
ds_read_b64_tr_b16 v[108:109],v19 offset:12360
ds_read_b64_tr_b16 v[110:111],v19 offset:12488
s_waitcnt lgkmcnt(0)
s_waitcnt vmcnt(0)
ds_write_b128 v7,v[96:99] offset:0
ds_write_b128 v7,v[100:103] offset:1024
ds_write_b128 v7,v[104:107] offset:2048
ds_write_b128 v7,v[108:111] offset:3072
s_waitcnt lgkmcnt(0)
ds_read_b64_tr_b16 v[96:97],v19 offset:16384
ds_read_b64_tr_b16 v[98:99],v19 offset:16512
ds_read_b64_tr_b16 v[100:101],v19 offset:20480
ds_read_b64_tr_b16 v[102:103],v19 offset:20608
ds_read_b64_tr_b16 v[104:105],v19 offset:16392
ds_read_b64_tr_b16 v[106:107],v19 offset:16520
ds_read_b64_tr_b16 v[108:109],v19 offset:20488
ds_read_b64_tr_b16 v[110:111],v19 offset:20616
s_waitcnt lgkmcnt(0)
ds_write_b128 v7,v[96:99] offset:4096
ds_write_b128 v7,v[100:103] offset:5120
ds_write_b128 v7,v[104:107] offset:6144
ds_write_b128 v7,v[108:111] offset:7168
s_waitcnt lgkmcnt(0)
ds_read_b64_tr_b16 v[96:97],v19 offset:16448
ds_read_b64_tr_b16 v[98:99],v19 offset:16576
ds_read_b64_tr_b16 v[100:101],v19 offset:20544
ds_read_b64_tr_b16 v[102:103],v19 offset:20672
ds_read_b64_tr_b16 v[104:105],v19 offset:16456
ds_read_b64_tr_b16 v[106:107],v19 offset:16584
ds_read_b64_tr_b16 v[108:109],v19 offset:20552
ds_read_b64_tr_b16 v[110:111],v19 offset:20680
s_waitcnt lgkmcnt(0)
ds_write_b128 v7,v[96:99] offset:8192
ds_write_b128 v7,v[100:103] offset:9216
ds_write_b128 v7,v[104:107] offset:10240
ds_write_b128 v7,v[108:111] offset:11264
s_waitcnt lgkmcnt(0)
ds_read_b64_tr_b16 v[96:97],v19 offset:24576
ds_read_b64_tr_b16 v[98:99],v19 offset:24704
ds_read_b64_tr_b16 v[100:101],v19 offset:28672
ds_read_b64_tr_b16 v[102:103],v19 offset:28800
ds_read_b64_tr_b16 v[104:105],v19 offset:24584
ds_read_b64_tr_b16 v[106:107],v19 offset:24712
ds_read_b64_tr_b16 v[108:109],v19 offset:28680
ds_read_b64_tr_b16 v[110:111],v19 offset:28808
s_waitcnt lgkmcnt(0)
ds_write_b128 v7,v[96:99] offset:12288
ds_write_b128 v7,v[100:103] offset:13312
ds_write_b128 v7,v[104:107] offset:14336
ds_write_b128 v7,v[108:111] offset:15360
s_waitcnt lgkmcnt(0)
ds_read_b64_tr_b16 v[112:113],v19 offset:24640
ds_read_b64_tr_b16 v[114:115],v19 offset:24768
ds_read_b64_tr_b16 v[116:117],v19 offset:28736
ds_read_b64_tr_b16 v[118:119],v19 offset:28864
ds_read_b64_tr_b16 v[120:121],v19 offset:24648
ds_read_b64_tr_b16 v[122:123],v19 offset:24776
ds_read_b64_tr_b16 v[124:125],v19 offset:28744
ds_read_b64_tr_b16 v[126:127],v19 offset:28872
s_waitcnt lgkmcnt(0)
ds_write_b128 v7,v[112:115] offset:16384
ds_write_b128 v7,v[116:119] offset:17408
ds_write_b128 v7,v[120:123] offset:18432
ds_write_b128 v7,v[124:127] offset:19456
ds_write_b128 v7,v[48:51] offset:20480
ds_write_b128 v7,v[52:55] offset:21504
ds_write_b128 v7,v[56:59] offset:22528
ds_write_b128 v7,v[60:63] offset:23552
ds_write_b128 v7,v[64:67] offset:24576
ds_write_b128 v7,v[68:71] offset:25600
ds_write_b128 v7,v[72:75] offset:26624
ds_write_b128 v7,v[76:79] offset:27648
ds_write_b128 v7,v[80:83] offset:28672
ds_write_b128 v7,v[84:87] offset:29696
ds_write_b128 v7,v[88:91] offset:30720
ds_write_b128 v7,v[92:95] offset:31744
s_waitcnt lgkmcnt(0)
v_and_b32 v23,1,v21
v_mov_b32 v1,0x4444
v_mov_b32 v24,0xeeee
v_cmp_eq_u32 vcc,1,v23
s_nop 1
v_cndmask_b32 v1,v1,v24,vcc
v_lshlrev_b32 v23,1,v22
v_sub_u32 v23,v21,v23
v_mov_b32 v5,0
v_mov_b32 v24,0x3f80
v_cmp_eq_u32 vcc,0,v23
s_nop 1
v_cndmask_b32 v5,v5,v24,vcc
v_mov_b32 v24,0x3f800000
v_cmp_eq_u32 vcc,1,v23
s_nop 1
v_cndmask_b32 v5,v5,v24,vcc
s_and_b32 s64,s50,1
s_lshl_b32 s64,s64,11
v_lshl_add_u32 v127,v20,2,s64
v_and_b32 v23,7,v21
v_lshrrev_b32 v24,3,v21
v_lshlrev_b32 v25,8,v24
v_lshl_add_u32 v25,v22,6,v25
v_lshl_add_u32 v4,v23,2,v25
v_lshrrev_b32 v25,1,v22
v_lshl_add_u32 v25,v25,3,v23
v_lshlrev_b32 v25,5,v25
v_and_b32 v26,1,v22
v_lshl_add_u32 v6,v26,4,v25
v_lshl_add_u32 v27,v22,3,v23
v_lshlrev_b32 v27,4,v27
s_mov_b32 s80,0x3e0293ee
s_mov_b32 s81,0xfffffffe
s_mov_b32 s84,0x00ff00ff
s_mov_b32 s85,0x00ff00ff
s_mov_b32 s86,-1
s_mov_b32 s87,0
s_cmp_gt_u32 s50,1
s_cselect_b32 s82,0xff00ff00,-1
s_cselect_b32 s83,0xff00ff00,0
s_lshl_b32 m0,s50,8
s_cmp_gt_u32 s50,1
s_cbranch_scc1 w23_100189
v_lshl_add_u32 v2,v24,9,v27
v_lshrrev_b32 v25,1,v22
v_lshl_add_u32 v25,v25,3,v23
v_lshlrev_b32 v25,4,v25
v_lshl_add_u32 v26,v26,1,v24
v_lshl_add_u32 v3,v26,2,v25
v_add_u32 v3,1024 + 256,v3
v_cndmask_b32 v6,2.0,v6,s[84:85]
v_mov_b32 v8,0x3f803f80
v_mov_b32 v9,0x3f803f80
v_mov_b32 v10,0x3f803f80
v_mov_b32 v11,0x3f803f80
v_mov_b32 v12,0x3f803f80
v_mov_b32 v13,0
v_mov_b32 v14,0
v_mov_b32 v15,0
s_branch jn_100190
w23_100189:
s_sub_u32 s64,s50,2
s_mul_i32 s64,s64,4160
v_lshrrev_b32 v25,1,v22
v_mul_u32_u24 v25,2080,v25
v_and_b32 v28,1,v23
v_mul_u32_u24 v28,1040,v28
v_add_u32 v25,v25,v28
v_lshrrev_b32 v28,1,v23
v_lshl_add_u32 v25,v28,6,v25
v_lshl_add_u32 v25,v26,5,v25
v_mul_u32_u24 v28,8448,v24
v_add3_u32 v2,v25,v28,s64
v_cndmask_b32 v3,2.0,v27,s[84:85]
v_mov_b32 v8,-1
v_mov_b32 v9,-1
v_mov_b32 v10,-1
v_mov_b32 v11,-1
jn_100190:
s_mov_b32 s67,0
s_cmp_eq_u32 s56,1
s_cbranch_scc1 vok_100193
v_mbcnt_lo_u32_b32 v16,-1,0
v_and_b32 v16,7,v16
v_lshlrev_b32 v16,7,v16
s_mov_b32 s64,138510336
vpoll_100194:
buffer_load_dword v17,v16,s[20:23],s64 offen sc1
s_waitcnt vmcnt(0)
v_readlane_b32 s92,v17,0
v_readlane_b32 s93,v17,1
v_readlane_b32 s94,v17,2
v_readlane_b32 s95,v17,3
v_readlane_b32 s96,v17,4
v_readlane_b32 s97,v17,5
v_readlane_b32 s98,v17,6
v_readlane_b32 s99,v17,7
s_add_u32 s65,s92,s93
s_add_u32 s65,s65,s94
s_add_u32 s65,s65,s95
s_add_u32 s65,s65,s96
s_add_u32 s65,s65,s97
s_add_u32 s65,s65,s98
s_add_u32 s65,s65,s99
s_cmp_ge_u32 s65,256
s_cbranch_scc1 vgot_100195
s_sleep 4
s_sub_u32 s90,s90,1
s_cmp_gt_i32 s90,0
s_cbranch_scc1 vpoll_100194
vgot_100195:
s_min_u32 s65,s92,s93
s_min_u32 s65,s65,s94
s_min_u32 s65,s65,s95
s_min_u32 s65,s65,s96
s_min_u32 s65,s65,s97
s_min_u32 s65,s65,s98
s_min_u32 s65,s65,s99
s_cmp_lt_u32 s65,32
s_cbranch_scc1 fl_slow
s_mov_b32 s56,0
pp_100196:
buffer_load_dword v17,off,s[20:23],s64 offset:1024 sc1
s_waitcnt vmcnt(0)
v_readfirstlane_b32 s65,v17
s_cmp_lg_u32 s65,0
s_cbranch_scc1 pg_100197
s_sleep 4
s_sub_u32 s90,s90,1
s_cmp_gt_i32 s90,0
s_cbranch_scc1 pp_100196
pg_100197:
s_and_b32 s65,s65,2
s_lshl_b32 s67,s65,12
vok_100193:
s_lshl_b32 s64,s58,14
s_lshl_b32 s65,s50,12
s_add_u32 s70,s64,s65
s_add_u32 s70,s70,134217728
s_lshl_b32 s65,s59,9
s_add_u32 s71,s64,s65
s_add_u32 s71,s71,134217728
s_xor_b32 s64,s58,1
s_lshl_b32 s64,s64,15
s_lshr_b32 s65,s50,1
s_lshl_b32 s65,s65,14
s_add_u32 s64,s64,s65
s_and_b32 s65,s50,1
s_lshl_b32 s65,s65,12
s_add_u32 s64,s64,s65
s_add_u32 s72,s64,s67
s_add_u32 s72,s72,142606336
s_lshl_b32 s64,s58,15
s_lshr_b32 s65,s59,4
s_lshl_b32 s65,s65,14
s_add_u32 s64,s64,s65
s_and_b32 s65,s59,15
s_lshl_b32 s65,s65,9
s_add_u32 s64,s64,s65
s_add_u32 s73,s64,s67
s_add_u32 s73,s73,142606336
s_cmp_eq_u32 s50,1
s_cselect_b32 s54,2048 - 256,0
s_sub_u32 s71,s71,s54
s_lshl_b32 s64,s58,15
s_lshl_b32 s65,s50,13
s_add_u32 s74,s64,s65
s_add_u32 s74,s74,134250496
s_lshl_b32 s64,s57,10
s_and_b32 s65,s50,1
s_lshl_b32 s65,s65,9
s_cmp_gt_u32 s50,1
s_cselect_b32 s65,0,s65
s_add_u32 s75,s64,s65
s_add_u32 s75,s75,134250496
s_lshl_b32 s64,s57,12
s_and_b32 s65,s64,0xffffe000
s_cmp_eq_u32 s50,3
s_cselect_b32 s66,1536,0
s_add_u32 s64,s64,s66
s_cmp_gt_u32 s50,1
s_cselect_b32 s76,s64,s65
s_add_u32 s76,s76,134479872
s_lshl_b32 s64,s57,14
s_and_b32 s65,s50,1
s_lshl_b32 s66,s65,11
s_add_u32 s77,s64,s66
s_cmp_gt_u32 s50,1
s_cselect_b32 s66,0,4096
s_add_u32 s77,s77,s66
s_add_u32 s77,s77,0
s_lshl_b32 s66,s65,9
s_add_u32 s66,s66,1024 + 128
s_lshl_b32 s65,s65,7
s_cmp_gt_u32 s50,1
s_cselect_b32 s65,s65,s66
s_add_u32 s78,s64,s65
s_add_u32 s78,s78,67108736
s_lshl_b32 s64,s57,6
s_add_u32 s68,s64,s67
s_add_u32 s69,s68,s64
s_add_u32 s69,s69,138428416
s_lshl_b32 s64,s50,14
s_add_u32 s69,s69,s64
s_and_b32 s64,s50,1
s_lshl_b32 s64,s64,11
s_sub_u32 s69,s69,s64
s_add_u32 s68,s68,138412032
s_mov_b32 s79,0
s_mov_b32 s91,0
s_mov_b32 s90,100000
s_barrier
s_cmp_eq_u32 s56,1
s_cbranch_scc1 recslow_100191
s_mov_b32 s55,0
s_cmp_lg_u32 s50,0
s_cbranch_scc1 np0_100200
v_mov_b32 v120,0
v_mov_b32 v121,0
s_cmp_lg_u32 s58,0
s_cbranch_scc1 z1_100201
v_lshrrev_b32 v124,6,v127
v_lshlrev_b32 v124,12,v124
v_bfe_u32 v125,v127,1,5
v_add_u32 v124,v124,v125
s_lshl_b32 s64,s59,6
buffer_load_ushort v120,v124,s[44:47],s64 offen
buffer_load_ushort v122,v124,s[44:47],s64 offen offset:32
buffer_load_ushort v121,v124,s[44:47],s64 offen offset:2048
buffer_load_ushort v123,v124,s[44:47],s64 offen offset:2080
s_waitcnt vmcnt(0)
v_lshl_or_b32 v120,v122,16,v120
v_lshl_or_b32 v121,v123,16,v121
v_min_u32 v120,s81,v120
v_min_u32 v121,s81,v121
z1_100201:
buffer_store_dword v120,v4,s[20:23],s71 offen
buffer_store_dword v121,v4,s[20:23],s71 offen offset:32
buffer_store_dword v120,v4,s[20:23],s73 offen sc1
buffer_store_dword v121,v4,s[20:23],s73 offen offset:32 sc1
np0_100200:
v_lshrrev_b32 v124,2,v0
v_bfe_u32 v125,v124,5,1
v_mul_u32_u24 v125,2048,v125
s_and_b32 s64,s50,1
s_lshl_b32 s64,s64,5
v_add3_u32 v4,v124,v125,s64
s_add_u32 s64,s79,0
s_cmp_gt_u32 s91,s64
s_cbranch_scc0 flp_100204
fok_100203:
s_add_u32 s64,s79,0
s_lshl_b32 s65,s64,12
s_and_b32 s65,s65,0x2000
s_xor_b32 s65,s65,s67
s_lshl_b32 s64,s64,20
s_add_u32 s65,s65,s64
s_add_u32 s99,s65,s77
buffer_load_dwordx4 v[104:107],v0,s[20:23],s99 offen
buffer_load_dwordx4 v[108:111],v0,s[20:23],s99 offen offset:1024
s_waitcnt vmcnt(0)
s_mov_b32 s92,s70
s_mov_b32 s93,s72
s_mov_b32 s94,s76
s_add_u32 s95,s94,4096
s_mov_b32 s96,s74
s_add_u32 s97,s96,4096
s_mov_b32 s98,s75
s_barrier
v_mov_b32 v96,v104
v_mov_b32 v97,v105
v_mov_b32 v98,v106
v_mov_b32 v99,v107
v_mov_b32 v100,v108
v_mov_b32 v101,v109
v_mov_b32 v102,v110
v_mov_b32 v103,v111
v_mov_b32 v48,0
v_mov_b32 v49,0
v_mov_b32 v50,0
v_mov_b32 v51,0
v_mov_b32 v52,0
v_mov_b32 v53,0
v_mov_b32 v54,0
v_mov_b32 v55,0
v_mov_b32 v56,0
v_mov_b32 v57,0
v_mov_b32 v58,0
v_mov_b32 v59,0
v_mov_b32 v60,0
v_mov_b32 v61,0
v_mov_b32 v62,0
v_mov_b32 v63,0
v_mov_b32 v64,0
v_mov_b32 v65,0
v_mov_b32 v66,0
v_mov_b32 v67,0
v_mov_b32 v68,0
v_mov_b32 v69,0
v_mov_b32 v70,0
v_mov_b32 v71,0
v_mov_b32 v72,0
v_mov_b32 v73,0
v_mov_b32 v74,0
v_mov_b32 v75,0
v_mov_b32 v76,0
v_mov_b32 v77,0
v_mov_b32 v78,0
v_mov_b32 v79,0
v_mov_b32 v80,0
v_mov_b32 v81,0
v_mov_b32 v82,0
v_mov_b32 v83,0
v_mov_b32 v84,0
v_mov_b32 v85,0
v_mov_b32 v86,0
v_mov_b32 v87,0
v_mov_b32 v88,0
v_mov_b32 v89,0
v_mov_b32 v90,0
v_mov_b32 v91,0
v_mov_b32 v92,0
v_mov_b32 v93,0
v_mov_b32 v94,0
v_mov_b32 v95,0
s_cmp_gt_u32 s50,1
s_cbranch_scc0 loop0_100202x
loop_100198:
v_mov_b32 v125,0
s_nop 1
v_mfma_f32_16x16x1_4b_f32 v[48:63],v125,v125,0
v_mfma_f32_16x16x1_4b_f32 v[64:79],v125,v125,0
v_mfma_f32_16x16x1_4b_f32 v[80:95],v125,v125,0
s_nop 15
s_nop 15
s_nop 15
s_nop 15
buffer_load_dwordx4 v[16:19],v0,s[20:23],s92 offen offset:0 sc1
s_nop 7
buffer_load_dwordx4 v[20:23],v0,s[20:23],s92 offen offset:1024 sc1
s_nop 7
buffer_load_dwordx4 v[24:27],v0,s[20:23],s92 offen offset:2048 sc1
s_nop 7
buffer_load_dwordx4 v[28:31],v0,s[20:23],s92 offen offset:3072 sc1
v_mov_b32 v96,v104
v_mov_b32 v97,v105
v_mov_b32 v98,v106
v_mov_b32 v99,v107
v_mov_b32 v100,v108
v_mov_b32 v101,v109
v_mov_b32 v102,v110
v_mov_b32 v103,v111
s_branch ja_100205
loop0_100202x:
v_mov_b32 v125,0
s_nop 1
v_mfma_f32_16x16x1_4b_f32 v[48:63],v125,v125,0
v_mfma_f32_16x16x1_4b_f32 v[64:79],v125,v125,0
v_mfma_f32_16x16x1_4b_f32 v[80:95],v125,v125,0
s_nop 15
s_nop 11
buffer_load_dwordx4 v[16:19],v0,s[20:23],s92 offen offset:0 sc1
s_nop 7
buffer_load_dwordx4 v[20:23],v0,s[20:23],s92 offen offset:1024 sc1
s_nop 7
buffer_load_dwordx4 v[24:27],v0,s[20:23],s92 offen offset:2048 sc1
s_nop 7
buffer_load_dwordx4 v[28:31],v0,s[20:23],s92 offen offset:3072 sc1
ja_100205:
s_max_u32 s66,s79,1
s_sub_u32 s66,s66,1
v_mov_b32 v126,s66
s_add_u32 s64,s66,0
s_lshl_b32 s65,s64,12
s_and_b32 s65,s65,0x2000
s_xor_b32 s65,s65,s67
s_lshl_b32 s64,s64,20
s_add_u32 s65,s65,s64
s_add_u32 s101,s65,s78
s_cmp_eq_u32 s79,63
s_cbranch_scc1 last_100199
s_add_u32 s64,s79,1
s_cmp_gt_u32 s91,s64
s_cbranch_scc0 flp_100207
fok_100206:
s_add_u32 s64,s79,1
s_lshl_b32 s65,s64,12
s_and_b32 s65,s65,0x2000
s_xor_b32 s65,s65,s67
s_lshl_b32 s64,s64,20
s_add_u32 s65,s65,s64
s_add_u32 s99,s65,s77
s_waitcnt vmcnt(3)
v_max3_u32 v124,v16,v17,v18
v_max_u32 v124,v124,v19
v_cmp_eq_u32 vcc,-1,v124
v_cndmask_b32 v120,2.0,v0,s[82:83]
v_cndmask_b32 v121,2.0,v127,s[86:87]
s_cbranch_vccnz flb_100232
seg_100208:
segb_100216:
v_smfmac_f32_16x16x64_bf16 v[48:51],v[16:19],a[0:7],v1
buffer_load_dword v125,off,s[20:23],s92 sc1
v_smfmac_f32_16x16x64_bf16 v[52:55],v[16:19],a[8:15],v1
buffer_load_dwordx4 v[32:35],v0,s[20:23],s93 offen offset:0 sc1
v_smfmac_f32_16x16x64_bf16 v[56:59],v[16:19],a[16:23],v1
s_waitcnt vmcnt(4)
v_max3_u32 v124,v20,v21,v22
v_smfmac_f32_16x16x64_bf16 v[60:63],v[16:19],a[24:31],v1
v_max_u32 v124,v124,v23
v_smfmac_f32_16x16x64_bf16 v[64:67],v[16:19],a[32:39],v1
v_cmp_eq_u32 vcc,-1,v124
v_smfmac_f32_16x16x64_bf16 v[68:71],v[16:19],a[40:47],v1
v_smfmac_f32_16x16x64_bf16 v[72:75],v[16:19],a[48:55],v1
s_cbranch_vccnz fl_100225
seg_100209:
v_smfmac_f32_16x16x64_bf16 v[76:79],v[16:19],a[56:63],v1
segb_100217:
v_smfmac_f32_16x16x64_bf16 v[48:51],v[20:23],a[64:71],v1
buffer_load_dword v125,off,s[20:23],s92 sc1
v_smfmac_f32_16x16x64_bf16 v[52:55],v[20:23],a[72:79],v1
buffer_load_dwordx4 v[36:39],v0,s[20:23],s93 offen offset:1024 sc1
v_smfmac_f32_16x16x64_bf16 v[56:59],v[20:23],a[80:87],v1
s_waitcnt vmcnt(5)
v_max3_u32 v124,v24,v25,v26
v_smfmac_f32_16x16x64_bf16 v[60:63],v[20:23],a[88:95],v1
v_max_u32 v124,v124,v27
v_smfmac_f32_16x16x64_bf16 v[64:67],v[20:23],a[96:103],v1
v_cmp_eq_u32 vcc,-1,v124
v_smfmac_f32_16x16x64_bf16 v[68:71],v[20:23],a[104:111],v1
v_smfmac_f32_16x16x64_bf16 v[72:75],v[20:23],a[112:119],v1
s_cbranch_vccnz fl_100226
seg_100210:
v_smfmac_f32_16x16x64_bf16 v[76:79],v[20:23],a[120:127],v1
segb_100218:
v_smfmac_f32_16x16x64_bf16 v[48:51],v[24:27],a[128:135],v1
buffer_load_dword v125,off,s[20:23],s92 sc1
v_smfmac_f32_16x16x64_bf16 v[52:55],v[24:27],a[136:143],v1
buffer_load_dwordx4 v[40:43],v0,s[20:23],s93 offen offset:2048 sc1
v_smfmac_f32_16x16x64_bf16 v[56:59],v[24:27],a[144:151],v1
buffer_load_dwordx4 v[44:47],v0,s[20:23],s93 offen offset:3072 sc1
s_waitcnt vmcnt(7)
v_max3_u32 v124,v28,v29,v30
v_smfmac_f32_16x16x64_bf16 v[60:63],v[24:27],a[152:159],v1
v_max_u32 v124,v124,v31
v_smfmac_f32_16x16x64_bf16 v[64:67],v[24:27],a[160:167],v1
v_cmp_eq_u32 vcc,-1,v124
v_smfmac_f32_16x16x64_bf16 v[68:71],v[24:27],a[168:175],v1
v_smfmac_f32_16x16x64_bf16 v[72:75],v[24:27],a[176:183],v1
s_cbranch_vccnz fl_100227
seg_100211:
v_smfmac_f32_16x16x64_bf16 v[76:79],v[24:27],a[184:191],v1
segb_100219:
v_smfmac_f32_16x16x64_bf16 v[48:51],v[28:31],a[192:199],v1
buffer_load_dword v125,off,s[20:23],s92 sc1
v_smfmac_f32_16x16x64_bf16 v[52:55],v[28:31],a[200:207],v1
v_smfmac_f32_16x16x64_bf16 v[56:59],v[28:31],a[208:215],v1
s_waitcnt vmcnt(6)
v_max3_u32 v124,v32,v33,v34
v_smfmac_f32_16x16x64_bf16 v[60:63],v[28:31],a[216:223],v1
v_max_u32 v124,v124,v35
v_smfmac_f32_16x16x64_bf16 v[64:67],v[28:31],a[224:231],v1
v_cmp_eq_u32 vcc,-1,v124
v_smfmac_f32_16x16x64_bf16 v[68:71],v[28:31],a[232:239],v1
v_smfmac_f32_16x16x64_bf16 v[72:75],v[28:31],a[240:247],v1
s_cbranch_vccnz fl_100228
seg_100212:
v_smfmac_f32_16x16x64_bf16 v[76:79],v[28:31],a[248:255],v1
segb_100220:
v_smfmac_f32_16x16x64_bf16 v[48:51],v[32:35],a[0:7],v1
buffer_load_dword v125,off,s[20:23],s92 sc1
v_smfmac_f32_16x16x64_bf16 v[52:55],v[32:35],a[8:15],v1
buffer_store_dwordx4 v[112:115],v120,s[20:23],s101 offen sc1
v_smfmac_f32_16x16x64_bf16 v[56:59],v[32:35],a[16:23],v1
buffer_store_dword v126,v121,s[20:23],s69 offen sc1
s_waitcnt vmcnt(7)
v_max3_u32 v124,v36,v37,v38
v_smfmac_f32_16x16x64_bf16 v[60:63],v[32:35],a[24:31],v1
v_max_u32 v124,v124,v39
v_smfmac_f32_16x16x64_bf16 v[64:67],v[32:35],a[32:39],v1
v_cmp_eq_u32 vcc,-1,v124
v_smfmac_f32_16x16x64_bf16 v[68:71],v[32:35],a[40:47],v1
v_smfmac_f32_16x16x64_bf16 v[72:75],v[32:35],a[48:55],v1
s_cbranch_vccnz fl_100229
seg_100213:
v_smfmac_f32_16x16x64_bf16 v[76:79],v[32:35],a[56:63],v1
segb_100221:
v_smfmac_f32_16x16x64_bf16 v[48:51],v[36:39],a[64:71],v1
buffer_load_dword v125,off,s[20:23],s92 sc1
s_waitcnt vmcnt(5)
v_max3_u32 v124,v40,v41,v42
v_smfmac_f32_16x16x64_bf16 v[52:55],v[36:39],a[72:79],v1
v_max3_u32 v124,v124,v43,v44
v_smfmac_f32_16x16x64_bf16 v[56:59],v[36:39],a[80:87],v1
v_max3_u32 v124,v124,v45,v46
v_smfmac_f32_16x16x64_bf16 v[60:63],v[36:39],a[88:95],v1
v_max_u32 v124,v124,v47
v_smfmac_f32_16x16x64_bf16 v[64:67],v[36:39],a[96:103],v1
v_cmp_eq_u32 vcc,-1,v124
v_smfmac_f32_16x16x64_bf16 v[68:71],v[36:39],a[104:111],v1
v_smfmac_f32_16x16x64_bf16 v[72:75],v[36:39],a[112:119],v1
s_cbranch_vccnz fl_100230
seg_100214:
v_smfmac_f32_16x16x64_bf16 v[76:79],v[36:39],a[120:127],v1
segb_100222:
v_smfmac_f32_16x16x64_bf16 v[48:51],v[40:43],a[128:135],v1
buffer_load_dwordx4 v[104:107],v0,s[20:23],s99 offen
buffer_load_dwordx4 v[108:111],v0,s[20:23],s99 offen offset:1024
v_smfmac_f32_16x16x64_bf16 v[52:55],v[40:43],a[136:143],v1
buffer_load_dword v126,off,s[20:23],s68 sc1
s_add_u32 s64,s79,2
v_smfmac_f32_16x16x64_bf16 v[48:51],v[44:47],a[192:199],v1
s_and_b32 s64,s64,3
s_lshl_b32 s100,s64,19
v_smfmac_f32_16x16x64_bf16 v[52:55],v[44:47],a[200:207],v1
v_smfmac_f32_16x16x64_bf16 v[56:59],v[40:43],a[144:151],v1
v_add_f32 v48,v48,v49
v_smfmac_f32_16x16x64_bf16 v[60:63],v[40:43],a[152:159],v1
ds_write_addtid_b32 v48 offset:0
v_add_f32 v50,v50,v51
v_smfmac_f32_16x16x64_bf16 v[56:59],v[44:47],a[208:215],v1
ds_write_addtid_b32 v50 offset:1040
v_add_f32 v52,v52,v53
v_smfmac_f32_16x16x64_bf16 v[60:63],v[44:47],a[216:223],v1
ds_write_addtid_b32 v52 offset:2080
v_add_f32 v54,v54,v55
v_smfmac_f32_16x16x64_bf16 v[64:67],v[40:43],a[160:167],v1
ds_write_addtid_b32 v54 offset:3120
v_add_f32 v56,v56,v57
v_smfmac_f32_16x16x64_bf16 v[68:71],v[40:43],a[168:175],v1
ds_write_addtid_b32 v56 offset:4160
v_add_f32 v58,v58,v59
v_smfmac_f32_16x16x64_bf16 v[64:67],v[44:47],a[224:231],v1
ds_write_addtid_b32 v58 offset:5200
v_add_f32 v60,v60,v61
v_smfmac_f32_16x16x64_bf16 v[68:71],v[44:47],a[232:239],v1
ds_write_addtid_b32 v60 offset:6240
v_add_f32 v62,v62,v63
v_smfmac_f32_16x16x64_bf16 v[72:75],v[40:43],a[176:183],v1
ds_write_addtid_b32 v62 offset:7280
v_add_f32 v64,v64,v65
v_smfmac_f32_16x16x64_bf16 v[76:79],v[40:43],a[184:191],v1
ds_write_addtid_b32 v64 offset:8448
v_add_f32 v66,v66,v67
v_smfmac_f32_16x16x64_bf16 v[72:75],v[44:47],a[240:247],v1
ds_write_addtid_b32 v66 offset:9488
v_add_f32 v68,v68,v69
v_smfmac_f32_16x16x64_bf16 v[76:79],v[44:47],a[248:255],v1
ds_write_addtid_b32 v68 offset:10528
v_add_f32 v70,v70,v71
v_smfmac_f32_16x16x64_bf16 v[80:83],v[16:19],v[208:215],v1
ds_write_addtid_b32 v70 offset:11568
v_add_f32 v72,v72,v73
v_smfmac_f32_16x16x64_bf16 v[80:83],v[32:35],v[208:215],v1
ds_write_addtid_b32 v72 offset:12608
v_add_f32 v74,v74,v75
ds_write_addtid_b32 v74 offset:13648
v_add_f32 v76,v76,v77
v_add_f32 v78,v78,v79
ds_write_addtid_b32 v76 offset:14688
ds_write_addtid_b32 v78 offset:15728
doneA_100241:
s_waitcnt lgkmcnt(0)
s_barrier
s_cmp_gt_u32 s50,1
s_cbranch_scc1 w23_100242
v_smfmac_f32_16x16x64_bf16 v[84:87],v[16:19],v[216:223],v1
v_smfmac_f32_16x16x64_bf16 v[84:87],v[32:35],v[216:223],v1
v_smfmac_f32_16x16x64_bf16 v[88:91],v[16:19],v[224:231],v1
v_smfmac_f32_16x16x64_bf16 v[88:91],v[32:35],v[224:231],v1
v_smfmac_f32_16x16x64_bf16 v[92:95],v[16:19],v[232:239],v1
ds_read_b128 v[48:51],v7 offset:0
ds_read_b128 v[52:55],v7 offset:1024
v_smfmac_f32_16x16x64_bf16 v[92:95],v[32:35],v[232:239],v1
ds_read_b128 v[56:59],v7 offset:2048
ds_read_b128 v[60:63],v7 offset:3072
v_smfmac_f32_16x16x64_bf16 v[80:83],v[20:23],v[240:247],v1
ds_read_b128 v[64:67],v7 offset:4096
ds_read_b128 v[68:71],v7 offset:5120
v_smfmac_f32_16x16x64_bf16 v[80:83],v[36:39],v[240:247],v1
ds_read_b128 v[72:75],v7 offset:6144
ds_read_b128 v[76:79],v7 offset:7168
v_smfmac_f32_16x16x64_bf16 v[84:87],v[20:23],v[248:255],v1
v_smfmac_f32_16x16x64_bf16 v[84:87],v[36:39],v[248:255],v1
s_waitcnt lgkmcnt(6)
v_smfmac_f32_16x16x64_bf16 v[88:91],v[20:23],v[48:55],v1
v_smfmac_f32_16x16x64_bf16 v[88:91],v[36:39],v[48:55],v1
ds_read_b128 v[48:51],v7 offset:8192
ds_read_b128 v[52:55],v7 offset:9216
s_waitcnt lgkmcnt(6)
v_smfmac_f32_16x16x64_bf16 v[92:95],v[20:23],v[56:63],v1
v_smfmac_f32_16x16x64_bf16 v[92:95],v[36:39],v[56:63],v1
ds_read_b128 v[56:59],v7 offset:10240
ds_read_b128 v[60:63],v7 offset:11264
s_waitcnt lgkmcnt(6)
v_smfmac_f32_16x16x64_bf16 v[80:83],v[24:27],v[64:71],v1
v_smfmac_f32_16x16x64_bf16 v[80:83],v[40:43],v[64:71],v1
ds_read_b128 v[64:67],v7 offset:12288
ds_read_b128 v[68:71],v7 offset:13312
s_waitcnt lgkmcnt(6)
v_smfmac_f32_16x16x64_bf16 v[84:87],v[24:27],v[72:79],v1
v_smfmac_f32_16x16x64_bf16 v[84:87],v[40:43],v[72:79],v1
ds_read_b128 v[72:75],v7 offset:14336
ds_read_b128 v[76:79],v7 offset:15360
s_waitcnt lgkmcnt(6)
v_smfmac_f32_16x16x64_bf16 v[88:91],v[24:27],v[48:55],v1
v_smfmac_f32_16x16x64_bf16 v[88:91],v[40:43],v[48:55],v1
ds_read_b128 v[48:51],v7 offset:16384
ds_read_b128 v[52:55],v7 offset:17408
s_waitcnt lgkmcnt(6)
v_smfmac_f32_16x16x64_bf16 v[92:95],v[24:27],v[56:63],v1
v_smfmac_f32_16x16x64_bf16 v[92:95],v[40:43],v[56:63],v1
ds_read_b128 v[56:59],v7 offset:18432
ds_read_b128 v[60:63],v7 offset:19456
s_waitcnt lgkmcnt(6)
v_smfmac_f32_16x16x64_bf16 v[80:83],v[28:31],v[64:71],v1
v_smfmac_f32_16x16x64_bf16 v[80:83],v[44:47],v[64:71],v1
s_waitcnt lgkmcnt(4)
v_smfmac_f32_16x16x64_bf16 v[84:87],v[28:31],v[72:79],v1
v_smfmac_f32_16x16x64_bf16 v[84:87],v[44:47],v[72:79],v1
s_waitcnt lgkmcnt(2)
v_smfmac_f32_16x16x64_bf16 v[88:91],v[28:31],v[48:55],v1
v_add_f32 v80,v80,v81
v_smfmac_f32_16x16x64_bf16 v[88:91],v[44:47],v[48:55],v1
v_add_f32 v82,v82,v83
s_waitcnt lgkmcnt(0)
v_smfmac_f32_16x16x64_bf16 v[92:95],v[28:31],v[56:63],v1
v_cvt_pk_bf16_f32 v80,v80,v82
v_smfmac_f32_16x16x64_bf16 v[92:95],v[44:47],v[56:63],v1
ds_write_addtid_b32 v80 offset:16896
v_add_f32 v84,v84,v85
buffer_load_dwordx4 v[16:19],v2,s[20:23],s94 offen offset:0 sc1
buffer_load_dwordx4 v[32:35],v2,s[20:23],s94 offen offset:1536 sc1
buffer_load_dwordx4 v[20:23],v2,s[20:23],s95 offen offset:0 sc1
buffer_load_dwordx4 v[36:39],v2,s[20:23],s95 offen offset:1536 sc1
buffer_load_dword v120,v3,s[20:23],s94 offen offset:0 sc1
buffer_load_dword v121,v3,s[20:23],s94 offen offset:1536 sc1
buffer_load_dword v122,v3,s[20:23],s95 offen offset:0 sc1
buffer_load_dword v123,v3,s[20:23],s95 offen offset:1536 sc1
v_add_f32 v86,v86,v87
v_cvt_pk_bf16_f32 v84,v84,v86
v_add_f32 v88,v88,v89
v_add_f32 v90,v90,v91
v_cvt_pk_bf16_f32 v88,v88,v90
v_add_f32 v92,v92,v93
v_add_f32 v94,v94,v95
v_cvt_pk_bf16_f32 v92,v92,v94
ds_write_addtid_b32 v84 offset:17920
ds_write_addtid_b32 v88 offset:18944
ds_write_addtid_b32 v92 offset:19968
sp_100245:
s_waitcnt vmcnt(6)
v_pk_add_f32 v[16:17],v[16:17],v[32:33]
v_pk_add_f32 v[18:19],v[18:19],v[34:35]
s_waitcnt vmcnt(4)
v_pk_add_f32 v[20:21],v[20:21],v[36:37]
v_pk_add_f32 v[22:23],v[22:23],v[38:39]
v_pk_add_f32 v[16:17],v[16:17],v[20:21]
v_pk_add_f32 v[18:19],v[18:19],v[22:23]
v_max3_f32 v124,v16,v17,v18
v_pk_add_f32 v[20:21],v[16:17],v[18:19]
s_waitcnt vmcnt(0)
v_pk_add_f32 v[120:121],v[120:121],v[122:123]
v_add_f32 v120,v120,v121
v_max3_f32 v124,v124,v19,v120
v_add_f32 v20,v20,v120
v_cmp_u_f32 vcc,v20,v21
v_max_f32_dpp v124,v124,v124 row_ror:8 row_mask:0xf bank_mask:0xf
v_mov_b32 v125,v124
s_cbranch_vccnz srt_100247
sok_100246:
s_nop 0
v_permlane16_swap_b32 v125,v124
v_max_f32 v124,v124,v125
v_mov_b32 v125,v124
s_nop 1
v_permlane32_swap_b32 v125,v124
v_max_f32 v124,v124,v125
v_mul_f32 v124,s80,v124
v_fma_f32 v16,v16,s80,-v124
v_fma_f32 v17,v17,s80,-v124
v_fma_f32 v18,v18,s80,-v124
v_fma_f32 v19,v19,s80,-v124
v_fma_f32 v120,v120,s80,-v124
s_waitcnt lgkmcnt(0)
s_barrier
ds_read2st64_b32 v[112:113],v127 offset0:66 offset1:67
ds_read2st64_b32 v[114:115],v127 offset0:68 offset1:69
ds_read2st64_b32 v[116:117],v127 offset0:70 offset1:71
ds_read2st64_b32 v[118:119],v127 offset0:72 offset1:73
v_exp_f32 v16,v16
v_exp_f32 v17,v17
v_exp_f32 v18,v18
v_exp_f32 v19,v19
v_cvt_pk_bf16_f32 v48,v16,v17
v_cvt_pk_bf16_f32 v49,v18,v19
v_exp_f32 v120,v120
v_mov_b32_dpp v50,v48 row_ror:8 row_mask:0xf bank_mask:0xf
v_mov_b32_dpp v51,v49 row_ror:8 row_mask:0xf bank_mask:0xf
v_mov_b32_dpp v121,v120 row_ror:8 row_mask:0xf bank_mask:0xf
v_cvt_pk_bf16_f32 v52,v120,v121
v_mfma_f32_16x16x32_bf16 v[64:67],v[8:11],v[48:51],0
v_mov_b32 v53,v52
v_mfma_f32_16x16x32_bf16 v[56:59],v[96:99],v[48:51],0
v_mov_b32 v54,v52
v_mov_b32 v55,v52
v_mfma_f32_16x16x32_bf16 v[60:63],v[100:103],v[48:51],0
v_mfma_f32_16x16x32_bf16 v[64:67],v[12:15],v[52:55],v[64:67]
s_waitcnt lgkmcnt(0)
v_mfma_f32_16x16x32_bf16 v[56:59],v[112:115],v[52:55],v[56:59]
v_mfma_f32_16x16x32_bf16 v[60:63],v[116:119],v[52:55],v[60:63]
s_nop 0
v_rcp_f32 v66,v64
s_nop 2
v_pk_mul_f32 v[56:57],v[56:57],v[66:67] op_sel_hi:[1,0]
v_pk_mul_f32 v[58:59],v[58:59],v[66:67] op_sel_hi:[1,0]
s_nop 0
v_pk_mul_f32 v[60:61],v[60:61],v[66:67] op_sel_hi:[1,0]
v_pk_mul_f32 v[62:63],v[62:63],v[66:67] op_sel_hi:[1,0]
v_cvt_pk_bf16_f32 v120,v56,v57
v_cvt_pk_bf16_f32 v121,v58,v59
v_cvt_pk_bf16_f32 v122,v60,v61
v_cvt_pk_bf16_f32 v123,v62,v63
buffer_store_dwordx4 v[120:123],v6,s[20:23],s98 offen
s_barrier
ds_read_b128 v[48:51],v7 offset:20480
ds_read_b128 v[52:55],v7 offset:21504
ds_read_b128 v[56:59],v7 offset:22528
ds_read_b128 v[60:63],v7 offset:23552
ds_read_b128 v[64:67],v7 offset:24576
ds_read_b128 v[68:71],v7 offset:25600
ds_read_b128 v[72:75],v7 offset:26624
ds_read_b128 v[76:79],v7 offset:27648
ds_read_b128 v[80:83],v7 offset:28672
ds_read_b128 v[84:87],v7 offset:29696
ds_read_b128 v[88:91],v7 offset:30720
ds_read_b128 v[92:95],v7 offset:31744
v_mov_b32 v96,0
v_mov_b32 v97,0
v_mov_b32 v98,0
v_mov_b32 v99,0
v_mov_b32 v100,0
v_mov_b32 v101,0
v_mov_b32 v102,0
v_mov_b32 v103,0
s_nop 11
buffer_load_dwordx4 v[16:19],v0,s[20:23],s96 offen offset:0 sc1
v_mov_b32 v120,v5
v_mov_b32 v121,v5
v_mov_b32 v122,v5
v_mov_b32 v123,v5
s_nop 1
v_mfma_f32_16x16x32_bf16 v[112:115],v[120:123],v[112:115],0
buffer_load_dwordx4 v[20:23],v0,s[20:23],s96 offen offset:1024 sc1
v_mfma_f32_16x16x32_bf16 v[116:119],v[120:123],v[116:119],0
s_add_u32 s79,s79,1
s_and_b32 s64,s79,3
s_lshl_b32 s64,s64,19
s_lshl_b32 s65,s79,8
buffer_load_dwordx4 v[24:27],v0,s[20:23],s96 offen offset:2048 sc1
s_and_b32 s65,s65,0x2000
s_lshl_b32 s66,s79,16
s_xor_b32 s88,s73,s65
s_add_u32 s88,s88,s66
s_sub_u32 s88,s88,s54
s_add_u32 s89,s71,s64
s_add_u32 s92,s70,s64
s_xor_b32 s93,s72,s65
buffer_load_dwordx4 v[28:31],v0,s[20:23],s96 offen offset:3072 sc1
s_add_u32 s93,s93,s66
s_add_u32 s94,s76,s64
s_add_u32 s95,s94,4096
s_add_u32 s98,s75,s64
s_add_u32 s60,s74,s64
v_cvt_pk_bf16_f32 v112,v112,v113
v_cvt_pk_bf16_f32 v113,v114,v115
v_cvt_pk_bf16_f32 v114,v116,v117
buffer_load_dwordx4 v[32:35],v0,s[20:23],s97 offen offset:0 sc1
v_cvt_pk_bf16_f32 v115,v118,v119
s_nop 6
buffer_load_dwordx4 v[36:39],v0,s[20:23],s97 offen offset:1024 sc1
s_nop 7
buffer_load_dwordx4 v[40:43],v0,s[20:23],s97 offen offset:2048 sc1
s_nop 7
buffer_load_dwordx4 v[44:47],v0,s[20:23],s97 offen offset:3072 sc1
s_branch ogo_100243
w23_100242:
ds_read_b128 v[48:51],v2 offset:0
ds_read_b128 v[52:55],v2 offset:256
ds_read_b128 v[56:59],v2 offset:512
ds_read_b128 v[60:63],v2 offset:768
ds_read_b128 v[64:67],v2 offset:16
ds_read_b128 v[68:71],v2 offset:272
ds_read_b128 v[72:75],v2 offset:528
ds_read_b128 v[76:79],v2 offset:784
s_waitcnt lgkmcnt(6)
v_pk_add_f32 v[48:49],v[48:49],v[52:53]
v_pk_add_f32 v[50:51],v[50:51],v[54:55]
s_waitcnt lgkmcnt(4)
v_pk_add_f32 v[56:57],v[56:57],v[60:61]
v_pk_add_f32 v[58:59],v[58:59],v[62:63]
v_pk_add_f32 v[48:49],v[48:49],v[56:57]
v_pk_add_f32 v[50:51],v[50:51],v[58:59]
v_cvt_pk_bf16_f32 v112,v48,v49
v_cvt_pk_bf16_f32 v113,v50,v51
s_waitcnt lgkmcnt(2)
v_pk_add_f32 v[64:65],v[64:65],v[68:69]
v_pk_add_f32 v[66:67],v[66:67],v[70:71]
s_waitcnt lgkmcnt(0)
v_pk_add_f32 v[72:73],v[72:73],v[76:77]
v_pk_add_f32 v[74:75],v[74:75],v[78:79]
v_pk_add_f32 v[64:65],v[64:65],v[72:73]
v_pk_add_f32 v[66:67],v[66:67],v[74:75]
v_cvt_pk_bf16_f32 v114,v64,v65
v_cvt_pk_bf16_f32 v115,v66,v67
s_nop 1
v_mfma_f32_16x16x32_bf16 v[116:119],v[96:99],v[112:115],0
v_mfma_f32_16x16x32_bf16 v[120:123],v[100:103],v[112:115],0
v_mfma_f32_16x16x32_bf16 v[12:15],v[112:115],v[112:115],0
ds_read_b128 v[48:51],v7 offset:0
ds_read_b128 v[52:55],v7 offset:1024
ds_read_b128 v[56:59],v7 offset:2048
ds_read_b128 v[60:63],v7 offset:3072
ds_read_b128 v[64:67],v7 offset:4096
buffer_store_dwordx4 v[116:119],v3,s[20:23],s94 offen
buffer_store_dwordx4 v[120:123],v3,s[20:23],s94 offen offset:512
s_nop 0
buffer_store_dwordx4 v[12:15],v3,s[20:23],s94 offen offset:1024
ds_read_b128 v[68:71],v7 offset:5120
ds_read_b128 v[72:75],v7 offset:6144
ds_read_b128 v[76:79],v7 offset:7168
v_smfmac_f32_16x16x64_bf16 v[84:87],v[16:19],v[216:223],v1
v_smfmac_f32_16x16x64_bf16 v[84:87],v[32:35],v[216:223],v1
v_smfmac_f32_16x16x64_bf16 v[88:91],v[16:19],v[224:231],v1
v_smfmac_f32_16x16x64_bf16 v[88:91],v[32:35],v[224:231],v1
v_smfmac_f32_16x16x64_bf16 v[92:95],v[16:19],v[232:239],v1
v_smfmac_f32_16x16x64_bf16 v[92:95],v[32:35],v[232:239],v1
v_smfmac_f32_16x16x64_bf16 v[80:83],v[20:23],v[240:247],v1
v_smfmac_f32_16x16x64_bf16 v[80:83],v[36:39],v[240:247],v1
v_smfmac_f32_16x16x64_bf16 v[84:87],v[20:23],v[248:255],v1
v_smfmac_f32_16x16x64_bf16 v[84:87],v[36:39],v[248:255],v1
s_waitcnt lgkmcnt(6)
v_smfmac_f32_16x16x64_bf16 v[88:91],v[20:23],v[48:55],v1
v_smfmac_f32_16x16x64_bf16 v[88:91],v[36:39],v[48:55],v1
ds_read_b128 v[48:51],v7 offset:8192
ds_read_b128 v[52:55],v7 offset:9216
s_waitcnt lgkmcnt(6)
v_smfmac_f32_16x16x64_bf16 v[92:95],v[20:23],v[56:63],v1
v_smfmac_f32_16x16x64_bf16 v[92:95],v[36:39],v[56:63],v1
ds_read_b128 v[56:59],v7 offset:10240
ds_read_b128 v[60:63],v7 offset:11264
s_waitcnt lgkmcnt(6)
v_smfmac_f32_16x16x64_bf16 v[80:83],v[24:27],v[64:71],v1
v_smfmac_f32_16x16x64_bf16 v[80:83],v[40:43],v[64:71],v1
ds_read_b128 v[64:67],v7 offset:12288
ds_read_b128 v[68:71],v7 offset:13312
s_waitcnt lgkmcnt(6)
v_smfmac_f32_16x16x64_bf16 v[84:87],v[24:27],v[72:79],v1
v_smfmac_f32_16x16x64_bf16 v[84:87],v[40:43],v[72:79],v1
ds_read_b128 v[72:75],v7 offset:14336
ds_read_b128 v[76:79],v7 offset:15360
s_waitcnt lgkmcnt(6)
v_smfmac_f32_16x16x64_bf16 v[88:91],v[24:27],v[48:55],v1
v_smfmac_f32_16x16x64_bf16 v[88:91],v[40:43],v[48:55],v1
ds_read_b128 v[48:51],v7 offset:16384
ds_read_b128 v[52:55],v7 offset:17408
s_waitcnt lgkmcnt(6)
v_smfmac_f32_16x16x64_bf16 v[92:95],v[24:27],v[56:63],v1
v_smfmac_f32_16x16x64_bf16 v[92:95],v[40:43],v[56:63],v1
ds_read_b128 v[56:59],v7 offset:18432
ds_read_b128 v[60:63],v7 offset:19456
s_waitcnt lgkmcnt(6)
v_smfmac_f32_16x16x64_bf16 v[80:83],v[28:31],v[64:71],v1
v_smfmac_f32_16x16x64_bf16 v[80:83],v[44:47],v[64:71],v1
s_waitcnt lgkmcnt(4)
v_smfmac_f32_16x16x64_bf16 v[84:87],v[28:31],v[72:79],v1
v_smfmac_f32_16x16x64_bf16 v[84:87],v[44:47],v[72:79],v1
s_waitcnt lgkmcnt(2)
v_smfmac_f32_16x16x64_bf16 v[88:91],v[28:31],v[48:55],v1
v_add_f32 v80,v80,v81
v_smfmac_f32_16x16x64_bf16 v[88:91],v[44:47],v[48:55],v1
v_add_f32 v82,v82,v83
s_waitcnt lgkmcnt(0)
v_smfmac_f32_16x16x64_bf16 v[92:95],v[28:31],v[56:63],v1
v_cvt_pk_bf16_f32 v80,v80,v82
v_smfmac_f32_16x16x64_bf16 v[92:95],v[44:47],v[56:63],v1
ds_write_addtid_b32 v80 offset:16896
v_add_f32 v84,v84,v85
v_add_f32 v86,v86,v87
v_cvt_pk_bf16_f32 v84,v84,v86
v_add_f32 v88,v88,v89
v_add_f32 v90,v90,v91
v_cvt_pk_bf16_f32 v88,v88,v90
s_nop 0
v_add_f32 v92,v92,v93
v_add_f32 v94,v94,v95
v_cvt_pk_bf16_f32 v92,v92,v94
ds_write_addtid_b32 v84 offset:17920
ds_write_addtid_b32 v88 offset:18944
ds_write_addtid_b32 v92 offset:19968
s_waitcnt lgkmcnt(0)
s_barrier
ds_read_b128 v[48:51],v7 offset:20480
ds_read_b128 v[52:55],v7 offset:21504
ds_read_b128 v[56:59],v7 offset:22528
ds_read_b128 v[60:63],v7 offset:23552
ds_read_b128 v[64:67],v7 offset:24576
ds_read_b128 v[68:71],v7 offset:25600
ds_read_b128 v[72:75],v7 offset:26624
ds_read_b128 v[76:79],v7 offset:27648
ds_read_b128 v[80:83],v7 offset:28672
ds_read_b128 v[84:87],v7 offset:29696
ds_read_b128 v[88:91],v7 offset:30720
ds_read_b128 v[92:95],v7 offset:31744
s_add_u32 s65,s76,s100
s_add_u32 s66,s75,s100
s_add_u32 s64,s71,s100
s_cmp_eq_u32 s50,2
s_cselect_b32 s66,s66,s64
buffer_store_dwordx4 v[8:11],v0,s[20:23],s65 offen
s_cmp_eq_u32 s50,2
s_cselect_b32 exec_hi,-1,0
buffer_store_dwordx4 v[8:11],v0,s[20:23],s66 offen
s_mov_b32 exec_hi,0
buffer_store_dwordx4 v[8:11],v0,s[20:23],s65 offen offset:1024
s_mov_b64 exec,-1
v_mov_b32 v96,0
v_mov_b32 v97,0
v_mov_b32 v98,0
v_mov_b32 v99,0
v_mov_b32 v100,0
v_mov_b32 v101,0
v_mov_b32 v102,0
v_mov_b32 v103,0
s_barrier
s_nop 15
s_nop 15
s_nop 7
buffer_load_dwordx4 v[16:19],v0,s[20:23],s96 offen offset:0 sc1
s_add_u32 s79,s79,1
s_and_b32 s64,s79,3
s_lshl_b32 s64,s64,19
s_lshl_b32 s65,s79,8
s_and_b32 s65,s65,0x2000
s_lshl_b32 s66,s79,16
s_xor_b32 s88,s73,s65
s_add_u32 s88,s88,s66
buffer_load_dwordx4 v[20:23],v0,s[20:23],s96 offen offset:1024 sc1
s_sub_u32 s88,s88,s54
s_add_u32 s89,s71,s64
s_add_u32 s92,s70,s64
s_xor_b32 s93,s72,s65
s_add_u32 s93,s93,s66
s_add_u32 s94,s76,s64
s_add_u32 s95,s94,4096
s_add_u32 s98,s75,s64
buffer_load_dwordx4 v[24:27],v0,s[20:23],s96 offen offset:2048 sc1
s_add_u32 s60,s74,s64
s_nop 6
buffer_load_dwordx4 v[28:31],v0,s[20:23],s96 offen offset:3072 sc1
s_nop 7
buffer_load_dwordx4 v[32:35],v0,s[20:23],s97 offen offset:0 sc1
s_nop 7
buffer_load_dwordx4 v[36:39],v0,s[20:23],s97 offen offset:1024 sc1
s_nop 7
buffer_load_dwordx4 v[40:43],v0,s[20:23],s97 offen offset:2048 sc1
s_nop 7
buffer_load_dwordx4 v[44:47],v0,s[20:23],s97 offen offset:3072 sc1
ogo_100243:
s_waitcnt lgkmcnt(0)
s_waitcnt vmcnt(6)
v_max3_u32 v124,v16,v17,v18
v_max3_u32 v124,v124,v19,v20
v_max3_u32 v124,v124,v21,v22
v_max_u32 v124,v124,v23
v_cmp_eq_u32 vcc,-1,v124
s_cbranch_vccnz of_100248
v_smfmac_f32_16x16x64_bf16 v[96:99],v[16:19],v[48:55],v1
v_smfmac_f32_16x16x64_bf16 v[100:103],v[16:19],v[56:63],v1
v_smfmac_f32_16x16x64_bf16 v[96:99],v[20:23],v[64:71],v1
v_smfmac_f32_16x16x64_bf16 v[100:103],v[20:23],v[72:79],v1
v_readfirstlane_b32 s91,v126
s_waitcnt vmcnt(4)
v_max3_u32 v124,v24,v25,v26
v_max3_u32 v124,v124,v27,v28
v_max3_u32 v124,v124,v29,v30
v_max_u32 v124,v124,v31
v_cmp_eq_u32 vcc,-1,v124
s_cbranch_vccnz of_100249
v_smfmac_f32_16x16x64_bf16 v[96:99],v[24:27],v[80:87],v1
v_smfmac_f32_16x16x64_bf16 v[100:103],v[24:27],v[88:95],v1
v_smfmac_f32_16x16x64_bf16 v[96:99],v[28:31],v[128:135],v1
v_smfmac_f32_16x16x64_bf16 v[100:103],v[28:31],v[136:143],v1
s_waitcnt vmcnt(2)
v_max3_u32 v124,v32,v33,v34
v_max3_u32 v124,v124,v35,v36
v_max3_u32 v124,v124,v37,v38
v_max_u32 v124,v124,v39
v_cmp_eq_u32 vcc,-1,v124
s_cbranch_vccnz of_100250
v_smfmac_f32_16x16x64_bf16 v[96:99],v[32:35],v[144:151],v1
v_smfmac_f32_16x16x64_bf16 v[100:103],v[32:35],v[152:159],v1
v_smfmac_f32_16x16x64_bf16 v[96:99],v[36:39],v[160:167],v1
v_smfmac_f32_16x16x64_bf16 v[100:103],v[36:39],v[168:175],v1
s_waitcnt vmcnt(1)
v_max3_u32 v124,v40,v41,v42
v_max_u32 v124,v124,v43
v_cmp_eq_u32 vcc,-1,v124
s_cbranch_vccnz of_100251
v_smfmac_f32_16x16x64_bf16 v[96:99],v[40:43],v[176:183],v1
v_smfmac_f32_16x16x64_bf16 v[100:103],v[40:43],v[184:191],v1
s_waitcnt vmcnt(0)
v_max3_u32 v124,v44,v45,v46
v_max_u32 v124,v124,v47
v_cmp_eq_u32 vcc,-1,v124
s_cbranch_vccnz of_100252
v_smfmac_f32_16x16x64_bf16 v[96:99],v[44:47],v[192:199],v1
v_smfmac_f32_16x16x64_bf16 v[100:103],v[44:47],v[200:207],v1
oback_100259:
s_nop 4
v_add_f32 v96,v96,v97
v_add_f32 v98,v98,v99
s_nop 0
v_add_f32 v100,v100,v101
v_add_f32 v102,v102,v103
ds_write_addtid_b32 v96 offset:20992
ds_write_addtid_b32 v98 offset:23072
ds_write_addtid_b32 v100 offset:22016
ds_write_addtid_b32 v102 offset:24096
s_mov_b32 s96,s60
s_add_u32 s97,s60,4096
s_cmp_gt_u32 s50,1
s_waitcnt lgkmcnt(0)
s_barrier
s_cbranch_scc1 loop_100198
ds_read2st64_b32 v[48:49],v4 offset0:82 offset1:86
ds_read2st64_b32 v[50:51],v4 offset0:83 offset1:87
ds_read2st64_b32 v[52:53],v4 offset0:84 offset1:88
ds_read2st64_b32 v[54:55],v4 offset0:85 offset1:89
v_mov_b32 v96,v104
v_mov_b32 v97,v105
v_mov_b32 v98,v106
v_mov_b32 v99,v107
v_mov_b32 v100,v108
v_mov_b32 v101,v109
v_mov_b32 v102,v110
v_mov_b32 v103,v111
s_waitcnt lgkmcnt(2)
v_pk_add_f32 v[48:49],v[48:49],v[50:51]
s_waitcnt lgkmcnt(0)
v_pk_add_f32 v[52:53],v[52:53],v[54:55]
v_pk_add_f32 v[48:49],v[48:49],v[52:53]
v_cvt_pk_bf16_f32 v124,v48,v49
buffer_store_dword v124,v127,s[20:23],s89 offen
s_nop 7
buffer_store_dword v124,v127,s[20:23],s88 offen sc1
s_branch loop0_100202x
last_100199:
s_waitcnt vmcnt(3)
v_max3_u32 v124,v16,v17,v18
v_max_u32 v124,v124,v19
v_cmp_eq_u32 vcc,-1,v124
v_cndmask_b32 v120,2.0,v0,s[82:83]
v_cndmask_b32 v121,2.0,v127,s[86:87]
s_cbranch_vccnz flb_100284
seg_100260:
segb_100268:
v_smfmac_f32_16x16x64_bf16 v[64:67],v[16:19],a[32:39],v1
buffer_load_dword v125,off,s[20:23],s92 sc1
buffer_load_dwordx4 v[32:35],v0,s[20:23],s93 offen offset:0 sc1
s_waitcnt vmcnt(4)
v_max3_u32 v124,v20,v21,v22
v_smfmac_f32_16x16x64_bf16 v[68:71],v[16:19],a[40:47],v1
v_max_u32 v124,v124,v23
v_cmp_eq_u32 vcc,-1,v124
v_smfmac_f32_16x16x64_bf16 v[72:75],v[16:19],a[48:55],v1
v_smfmac_f32_16x16x64_bf16 v[76:79],v[16:19],a[56:63],v1
s_cbranch_vccnz fl_100277
seg_100261:
segb_100269:
v_smfmac_f32_16x16x64_bf16 v[64:67],v[20:23],a[96:103],v1
buffer_load_dword v125,off,s[20:23],s92 sc1
buffer_load_dwordx4 v[36:39],v0,s[20:23],s93 offen offset:1024 sc1
s_waitcnt vmcnt(5)
v_max3_u32 v124,v24,v25,v26
v_smfmac_f32_16x16x64_bf16 v[68:71],v[20:23],a[104:111],v1
v_max_u32 v124,v124,v27
v_cmp_eq_u32 vcc,-1,v124
v_smfmac_f32_16x16x64_bf16 v[72:75],v[20:23],a[112:119],v1
v_smfmac_f32_16x16x64_bf16 v[76:79],v[20:23],a[120:127],v1
s_cbranch_vccnz fl_100278
seg_100262:
segb_100270:
v_smfmac_f32_16x16x64_bf16 v[64:67],v[24:27],a[160:167],v1
buffer_load_dword v125,off,s[20:23],s92 sc1
buffer_load_dwordx4 v[40:43],v0,s[20:23],s93 offen offset:2048 sc1
buffer_load_dwordx4 v[44:47],v0,s[20:23],s93 offen offset:3072 sc1
s_waitcnt vmcnt(7)
v_max3_u32 v124,v28,v29,v30
v_smfmac_f32_16x16x64_bf16 v[68:71],v[24:27],a[168:175],v1
v_max_u32 v124,v124,v31
v_cmp_eq_u32 vcc,-1,v124
v_smfmac_f32_16x16x64_bf16 v[72:75],v[24:27],a[176:183],v1
v_smfmac_f32_16x16x64_bf16 v[76:79],v[24:27],a[184:191],v1
s_cbranch_vccnz fl_100279
seg_100263:
segb_100271:
v_smfmac_f32_16x16x64_bf16 v[64:67],v[28:31],a[224:231],v1
buffer_load_dword v125,off,s[20:23],s92 sc1
s_waitcnt vmcnt(6)
v_max3_u32 v124,v32,v33,v34
v_smfmac_f32_16x16x64_bf16 v[68:71],v[28:31],a[232:239],v1
v_max_u32 v124,v124,v35
v_cmp_eq_u32 vcc,-1,v124
v_smfmac_f32_16x16x64_bf16 v[72:75],v[28:31],a[240:247],v1
v_smfmac_f32_16x16x64_bf16 v[76:79],v[28:31],a[248:255],v1
s_cbranch_vccnz fl_100280
seg_100264:
segb_100272:
v_smfmac_f32_16x16x64_bf16 v[64:67],v[32:35],a[32:39],v1
buffer_load_dword v125,off,s[20:23],s92 sc1
buffer_store_dwordx4 v[112:115],v120,s[20:23],s101 offen sc1
buffer_store_dword v126,v121,s[20:23],s69 offen sc1
s_waitcnt vmcnt(7)
v_max3_u32 v124,v36,v37,v38
v_smfmac_f32_16x16x64_bf16 v[68:71],v[32:35],a[40:47],v1
v_max_u32 v124,v124,v39
v_cmp_eq_u32 vcc,-1,v124
v_smfmac_f32_16x16x64_bf16 v[72:75],v[32:35],a[48:55],v1
v_smfmac_f32_16x16x64_bf16 v[76:79],v[32:35],a[56:63],v1
s_cbranch_vccnz fl_100281
seg_100265:
segb_100273:
v_smfmac_f32_16x16x64_bf16 v[64:67],v[36:39],a[96:103],v1
buffer_load_dword v125,off,s[20:23],s92 sc1
s_waitcnt vmcnt(5)
v_max3_u32 v124,v40,v41,v42
v_smfmac_f32_16x16x64_bf16 v[68:71],v[36:39],a[104:111],v1
v_max3_u32 v124,v124,v43,v44
v_max3_u32 v124,v124,v45,v46
v_max_u32 v124,v124,v47
v_cmp_eq_u32 vcc,-1,v124
v_smfmac_f32_16x16x64_bf16 v[72:75],v[36:39],a[112:119],v1
v_smfmac_f32_16x16x64_bf16 v[76:79],v[36:39],a[120:127],v1
s_cbranch_vccnz fl_100282
seg_100266:
segb_100274:
v_smfmac_f32_16x16x64_bf16 v[64:67],v[40:43],a[160:167],v1
v_smfmac_f32_16x16x64_bf16 v[68:71],v[40:43],a[168:175],v1
v_smfmac_f32_16x16x64_bf16 v[64:67],v[44:47],a[224:231],v1
v_smfmac_f32_16x16x64_bf16 v[68:71],v[44:47],a[232:239],v1
v_smfmac_f32_16x16x64_bf16 v[72:75],v[40:43],a[176:183],v1
s_nop 1
v_add_f32 v64,v64,v65
v_smfmac_f32_16x16x64_bf16 v[76:79],v[40:43],a[184:191],v1
ds_write_addtid_b32 v64 offset:8448
v_add_f32 v66,v66,v67
v_smfmac_f32_16x16x64_bf16 v[72:75],v[44:47],a[240:247],v1
ds_write_addtid_b32 v66 offset:9488
v_add_f32 v68,v68,v69
v_smfmac_f32_16x16x64_bf16 v[76:79],v[44:47],a[248:255],v1
ds_write_addtid_b32 v68 offset:10528
v_add_f32 v70,v70,v71
v_smfmac_f32_16x16x64_bf16 v[80:83],v[16:19],v[208:215],v1
ds_write_addtid_b32 v70 offset:11568
v_add_f32 v72,v72,v73
v_smfmac_f32_16x16x64_bf16 v[80:83],v[32:35],v[208:215],v1
ds_write_addtid_b32 v72 offset:12608
v_add_f32 v74,v74,v75
v_smfmac_f32_16x16x64_bf16 v[84:87],v[16:19],v[216:223],v1
ds_write_addtid_b32 v74 offset:13648
v_add_f32 v76,v76,v77
v_smfmac_f32_16x16x64_bf16 v[84:87],v[32:35],v[216:223],v1
ds_write_addtid_b32 v76 offset:14688
v_add_f32 v78,v78,v79
v_smfmac_f32_16x16x64_bf16 v[88:91],v[16:19],v[224:231],v1
ds_write_addtid_b32 v78 offset:15728
v_smfmac_f32_16x16x64_bf16 v[88:91],v[32:35],v[224:231],v1
v_smfmac_f32_16x16x64_bf16 v[92:95],v[16:19],v[232:239],v1
v_smfmac_f32_16x16x64_bf16 v[92:95],v[32:35],v[232:239],v1
doneA_100293:
s_waitcnt vmcnt(0) lgkmcnt(0)
s_add_u32 s64,s79,0
s_lshl_b32 s65,s64,12
s_and_b32 s65,s65,0x2000
s_xor_b32 s65,s65,s67
s_lshl_b32 s64,s64,20
s_add_u32 s65,s65,s64
s_add_u32 s101,s65,s78
v_smfmac_f32_16x16x64_bf16 v[80:83],v[20:23],v[240:247],v1
ds_read_b128 v[48:51],v7 offset:0
ds_read_b128 v[52:55],v7 offset:1024
v_smfmac_f32_16x16x64_bf16 v[80:83],v[36:39],v[240:247],v1
ds_read_b128 v[56:59],v7 offset:2048
ds_read_b128 v[60:63],v7 offset:3072
v_smfmac_f32_16x16x64_bf16 v[84:87],v[20:23],v[248:255],v1
ds_read_b128 v[64:67],v7 offset:4096
ds_read_b128 v[68:71],v7 offset:5120
v_smfmac_f32_16x16x64_bf16 v[84:87],v[36:39],v[248:255],v1
ds_read_b128 v[72:75],v7 offset:6144
ds_read_b128 v[76:79],v7 offset:7168
s_waitcnt lgkmcnt(6)
v_smfmac_f32_16x16x64_bf16 v[88:91],v[20:23],v[48:55],v1
v_smfmac_f32_16x16x64_bf16 v[88:91],v[36:39],v[48:55],v1
ds_read_b128 v[48:51],v7 offset:8192
ds_read_b128 v[52:55],v7 offset:9216
s_waitcnt lgkmcnt(6)
v_smfmac_f32_16x16x64_bf16 v[92:95],v[20:23],v[56:63],v1
v_smfmac_f32_16x16x64_bf16 v[92:95],v[36:39],v[56:63],v1
ds_read_b128 v[56:59],v7 offset:10240
ds_read_b128 v[60:63],v7 offset:11264
s_waitcnt lgkmcnt(6)
v_smfmac_f32_16x16x64_bf16 v[80:83],v[24:27],v[64:71],v1
v_smfmac_f32_16x16x64_bf16 v[80:83],v[40:43],v[64:71],v1
ds_read_b128 v[64:67],v7 offset:12288
ds_read_b128 v[68:71],v7 offset:13312
s_waitcnt lgkmcnt(6)
v_smfmac_f32_16x16x64_bf16 v[84:87],v[24:27],v[72:79],v1
v_smfmac_f32_16x16x64_bf16 v[84:87],v[40:43],v[72:79],v1
ds_read_b128 v[72:75],v7 offset:14336
ds_read_b128 v[76:79],v7 offset:15360
s_waitcnt lgkmcnt(6)
v_smfmac_f32_16x16x64_bf16 v[88:91],v[24:27],v[48:55],v1
v_smfmac_f32_16x16x64_bf16 v[88:91],v[40:43],v[48:55],v1
ds_read_b128 v[48:51],v7 offset:16384
ds_read_b128 v[52:55],v7 offset:17408
s_waitcnt lgkmcnt(6)
v_smfmac_f32_16x16x64_bf16 v[92:95],v[24:27],v[56:63],v1
v_smfmac_f32_16x16x64_bf16 v[92:95],v[40:43],v[56:63],v1
ds_read_b128 v[56:59],v7 offset:18432
ds_read_b128 v[60:63],v7 offset:19456
s_waitcnt lgkmcnt(6)
v_smfmac_f32_16x16x64_bf16 v[80:83],v[28:31],v[64:71],v1
v_smfmac_f32_16x16x64_bf16 v[80:83],v[44:47],v[64:71],v1
s_waitcnt lgkmcnt(4)
v_smfmac_f32_16x16x64_bf16 v[84:87],v[28:31],v[72:79],v1
v_smfmac_f32_16x16x64_bf16 v[84:87],v[44:47],v[72:79],v1
s_waitcnt lgkmcnt(2)
v_smfmac_f32_16x16x64_bf16 v[88:91],v[28:31],v[48:55],v1
v_add_f32 v80,v80,v81
v_smfmac_f32_16x16x64_bf16 v[88:91],v[44:47],v[48:55],v1
v_add_f32 v82,v82,v83
s_waitcnt lgkmcnt(0)
v_smfmac_f32_16x16x64_bf16 v[92:95],v[28:31],v[56:63],v1
v_cvt_pk_bf16_f32 v80,v80,v82
v_smfmac_f32_16x16x64_bf16 v[92:95],v[44:47],v[56:63],v1
ds_write_addtid_b32 v80 offset:16896
v_add_f32 v84,v84,v85
v_add_f32 v86,v86,v87
v_cvt_pk_bf16_f32 v84,v84,v86
v_add_f32 v88,v88,v89
v_add_f32 v90,v90,v91
v_cvt_pk_bf16_f32 v88,v88,v90
s_nop 0
v_add_f32 v92,v92,v93
v_add_f32 v94,v94,v95
v_cvt_pk_bf16_f32 v92,v92,v94
ds_write_addtid_b32 v84 offset:17920
ds_write_addtid_b32 v88 offset:18944
ds_write_addtid_b32 v92 offset:19968
s_waitcnt lgkmcnt(0)
s_barrier
s_cmp_gt_u32 s50,1
s_cbranch_scc1 l23_100294
ds_read2st64_b32 v[112:113],v127 offset0:66 offset1:67
ds_read2st64_b32 v[114:115],v127 offset0:68 offset1:69
ds_read2st64_b32 v[116:117],v127 offset0:70 offset1:71
ds_read2st64_b32 v[118:119],v127 offset0:72 offset1:73
s_waitcnt lgkmcnt(0)
v_mov_b32 v120,v5
v_mov_b32 v121,v5
v_mov_b32 v122,v5
v_mov_b32 v123,v5
s_nop 1
v_mfma_f32_16x16x32_bf16 v[112:115],v[120:123],v[112:115],0
v_mfma_f32_16x16x32_bf16 v[116:119],v[120:123],v[116:119],0
s_nop 4
v_cvt_pk_bf16_f32 v112,v112,v113
v_cvt_pk_bf16_f32 v113,v114,v115
s_nop 0
v_cvt_pk_bf16_f32 v114,v116,v117
v_cvt_pk_bf16_f32 v115,v118,v119
s_branch lj_100295
l23_100294:
ds_read_b128 v[48:51],v2 offset:0
ds_read_b128 v[52:55],v2 offset:256
ds_read_b128 v[56:59],v2 offset:512
ds_read_b128 v[60:63],v2 offset:768
ds_read_b128 v[64:67],v2 offset:16
ds_read_b128 v[68:71],v2 offset:272
ds_read_b128 v[72:75],v2 offset:528
ds_read_b128 v[76:79],v2 offset:784
s_waitcnt lgkmcnt(6)
v_pk_add_f32 v[48:49],v[48:49],v[52:53]
v_pk_add_f32 v[50:51],v[50:51],v[54:55]
s_waitcnt lgkmcnt(4)
v_pk_add_f32 v[56:57],v[56:57],v[60:61]
v_pk_add_f32 v[58:59],v[58:59],v[62:63]
v_pk_add_f32 v[48:49],v[48:49],v[56:57]
v_pk_add_f32 v[50:51],v[50:51],v[58:59]
v_cvt_pk_bf16_f32 v112,v48,v49
v_cvt_pk_bf16_f32 v113,v50,v51
s_waitcnt lgkmcnt(2)
v_pk_add_f32 v[64:65],v[64:65],v[68:69]
v_pk_add_f32 v[66:67],v[66:67],v[70:71]
s_waitcnt lgkmcnt(0)
v_pk_add_f32 v[72:73],v[72:73],v[76:77]
v_pk_add_f32 v[74:75],v[74:75],v[78:79]
v_pk_add_f32 v[64:65],v[64:65],v[72:73]
v_pk_add_f32 v[66:67],v[66:67],v[74:75]
v_cvt_pk_bf16_f32 v114,v64,v65
v_cvt_pk_bf16_f32 v115,v66,v67
lj_100295:
v_cndmask_b32 v120,2.0,v0,s[82:83]
v_cndmask_b32 v121,2.0,v127,s[86:87]
buffer_store_dwordx4 v[112:115],v120,s[20:23],s101 offen sc1
s_waitcnt vmcnt(0)
s_barrier
v_mov_b32 v126,64
buffer_store_dword v126,v121,s[20:23],s69 offen sc1
s_branch recfin_100192
flp_100204:
buffer_load_dword v124,off,s[20:23],s68 sc1
s_waitcnt vmcnt(0)
v_readfirstlane_b32 s91,v124
s_cmp_gt_u32 s91,s64
s_cbranch_scc1 fok_100203
s_sleep 2
s_sub_u32 s90,s90,1
s_cmp_gt_i32 s90,0
s_cbranch_scc1 flp_100204
s_branch fok_100203
flp_100207:
buffer_load_dword v124,off,s[20:23],s68 sc1
s_waitcnt vmcnt(0)
v_readfirstlane_b32 s91,v124
s_cmp_gt_u32 s91,s64
s_cbranch_scc1 fok_100206
s_sleep 2
s_sub_u32 s90,s90,1
s_cmp_gt_i32 s90,0
s_cbranch_scc1 flp_100207
s_branch fok_100206
fl_100224:
flb_100232:
buffer_load_dwordx4 v[16:19],v0,s[20:23],s92 offen offset:0 sc1
s_mov_b32 s55,1
buffer_load_dwordx4 v[32:35],v0,s[20:23],s93 offen offset:0 sc1
s_waitcnt vmcnt(4)
v_max3_u32 v124,v20,v21,v22
v_max_u32 v124,v124,v23
v_cmp_eq_u32 vcc,-1,v124
s_cbranch_vccnz dfl_100296
v_smfmac_f32_16x16x64_bf16 v[48:51],v[20:23],a[64:71],v1
buffer_load_dword v125,off,s[20:23],s92 sc1
v_smfmac_f32_16x16x64_bf16 v[52:55],v[20:23],a[72:79],v1
buffer_load_dwordx4 v[36:39],v0,s[20:23],s93 offen offset:1024 sc1
v_smfmac_f32_16x16x64_bf16 v[56:59],v[20:23],a[80:87],v1
s_waitcnt vmcnt(5)
v_max3_u32 v124,v24,v25,v26
v_smfmac_f32_16x16x64_bf16 v[60:63],v[20:23],a[88:95],v1
v_max_u32 v124,v124,v27
v_smfmac_f32_16x16x64_bf16 v[64:67],v[20:23],a[96:103],v1
v_cmp_eq_u32 vcc,-1,v124
v_smfmac_f32_16x16x64_bf16 v[68:71],v[20:23],a[104:111],v1
v_smfmac_f32_16x16x64_bf16 v[72:75],v[20:23],a[112:119],v1
v_smfmac_f32_16x16x64_bf16 v[76:79],v[20:23],a[120:127],v1
s_cbranch_vccnz dfl_100297
v_smfmac_f32_16x16x64_bf16 v[48:51],v[24:27],a[128:135],v1
buffer_load_dword v125,off,s[20:23],s92 sc1
v_smfmac_f32_16x16x64_bf16 v[52:55],v[24:27],a[136:143],v1
buffer_load_dwordx4 v[40:43],v0,s[20:23],s93 offen offset:2048 sc1
v_smfmac_f32_16x16x64_bf16 v[56:59],v[24:27],a[144:151],v1
buffer_load_dwordx4 v[44:47],v0,s[20:23],s93 offen offset:3072 sc1
s_waitcnt vmcnt(7)
v_max3_u32 v124,v28,v29,v30
v_smfmac_f32_16x16x64_bf16 v[60:63],v[24:27],a[152:159],v1
v_max_u32 v124,v124,v31
v_smfmac_f32_16x16x64_bf16 v[64:67],v[24:27],a[160:167],v1
v_cmp_eq_u32 vcc,-1,v124
v_smfmac_f32_16x16x64_bf16 v[68:71],v[24:27],a[168:175],v1
v_smfmac_f32_16x16x64_bf16 v[72:75],v[24:27],a[176:183],v1
v_smfmac_f32_16x16x64_bf16 v[76:79],v[24:27],a[184:191],v1
s_cbranch_vccnz dfl_100298
v_smfmac_f32_16x16x64_bf16 v[48:51],v[28:31],a[192:199],v1
buffer_load_dword v125,off,s[20:23],s92 sc1
v_smfmac_f32_16x16x64_bf16 v[52:55],v[28:31],a[200:207],v1
v_smfmac_f32_16x16x64_bf16 v[56:59],v[28:31],a[208:215],v1
s_waitcnt vmcnt(7)
v_max3_u32 v124,v16,v17,v18
v_smfmac_f32_16x16x64_bf16 v[60:63],v[28:31],a[216:223],v1
v_max_u32 v124,v124,v19
v_smfmac_f32_16x16x64_bf16 v[64:67],v[28:31],a[224:231],v1
v_cmp_eq_u32 vcc,-1,v124
v_smfmac_f32_16x16x64_bf16 v[68:71],v[28:31],a[232:239],v1
v_smfmac_f32_16x16x64_bf16 v[72:75],v[28:31],a[240:247],v1
v_smfmac_f32_16x16x64_bf16 v[76:79],v[28:31],a[248:255],v1
s_cbranch_vccnz lfb_100303
s_mov_b32 s55,0
v_smfmac_f32_16x16x64_bf16 v[48:51],v[16:19],a[0:7],v1
v_smfmac_f32_16x16x64_bf16 v[52:55],v[16:19],a[8:15],v1
v_smfmac_f32_16x16x64_bf16 v[56:59],v[16:19],a[16:23],v1
s_waitcnt vmcnt(6)
v_max3_u32 v124,v32,v33,v34
v_max_u32 v124,v124,v35
v_cmp_eq_u32 vcc,-1,v124
v_smfmac_f32_16x16x64_bf16 v[60:63],v[16:19],a[24:31],v1
v_smfmac_f32_16x16x64_bf16 v[64:67],v[16:19],a[32:39],v1
v_smfmac_f32_16x16x64_bf16 v[68:71],v[16:19],a[40:47],v1
v_smfmac_f32_16x16x64_bf16 v[72:75],v[16:19],a[48:55],v1
v_smfmac_f32_16x16x64_bf16 v[76:79],v[16:19],a[56:63],v1
s_cbranch_vccnz flb_100236
s_branch segb_100220
fl_100225:
v_smfmac_f32_16x16x64_bf16 v[76:79],v[16:19],a[56:63],v1
flb_100233:
buffer_load_dwordx4 v[20:23],v0,s[20:23],s92 offen offset:1024 sc1
s_mov_b32 s55,2
buffer_load_dwordx4 v[36:39],v0,s[20:23],s93 offen offset:1024 sc1
s_waitcnt vmcnt(5)
v_max3_u32 v124,v24,v25,v26
v_max_u32 v124,v124,v27
v_cmp_eq_u32 vcc,-1,v124
s_cbranch_vccnz dfl_100297
v_smfmac_f32_16x16x64_bf16 v[48:51],v[24:27],a[128:135],v1
buffer_load_dword v125,off,s[20:23],s92 sc1
v_smfmac_f32_16x16x64_bf16 v[52:55],v[24:27],a[136:143],v1
buffer_load_dwordx4 v[40:43],v0,s[20:23],s93 offen offset:2048 sc1
v_smfmac_f32_16x16x64_bf16 v[56:59],v[24:27],a[144:151],v1
buffer_load_dwordx4 v[44:47],v0,s[20:23],s93 offen offset:3072 sc1
s_waitcnt vmcnt(7)
v_max3_u32 v124,v28,v29,v30
v_smfmac_f32_16x16x64_bf16 v[60:63],v[24:27],a[152:159],v1
v_max_u32 v124,v124,v31
v_smfmac_f32_16x16x64_bf16 v[64:67],v[24:27],a[160:167],v1
v_cmp_eq_u32 vcc,-1,v124
v_smfmac_f32_16x16x64_bf16 v[68:71],v[24:27],a[168:175],v1
v_smfmac_f32_16x16x64_bf16 v[72:75],v[24:27],a[176:183],v1
v_smfmac_f32_16x16x64_bf16 v[76:79],v[24:27],a[184:191],v1
s_cbranch_vccnz dfl_100298
v_smfmac_f32_16x16x64_bf16 v[48:51],v[28:31],a[192:199],v1
buffer_load_dword v125,off,s[20:23],s92 sc1
v_smfmac_f32_16x16x64_bf16 v[52:55],v[28:31],a[200:207],v1
v_smfmac_f32_16x16x64_bf16 v[56:59],v[28:31],a[208:215],v1
s_waitcnt vmcnt(5)
v_max3_u32 v124,v20,v21,v22
v_smfmac_f32_16x16x64_bf16 v[60:63],v[28:31],a[216:223],v1
v_max_u32 v124,v124,v23
v_smfmac_f32_16x16x64_bf16 v[64:67],v[28:31],a[224:231],v1
v_cmp_eq_u32 vcc,-1,v124
v_smfmac_f32_16x16x64_bf16 v[68:71],v[28:31],a[232:239],v1
v_smfmac_f32_16x16x64_bf16 v[72:75],v[28:31],a[240:247],v1
v_smfmac_f32_16x16x64_bf16 v[76:79],v[28:31],a[248:255],v1
s_cbranch_vccnz lfb_100303
s_mov_b32 s55,0
v_smfmac_f32_16x16x64_bf16 v[48:51],v[20:23],a[64:71],v1
v_smfmac_f32_16x16x64_bf16 v[52:55],v[20:23],a[72:79],v1
v_smfmac_f32_16x16x64_bf16 v[56:59],v[20:23],a[80:87],v1
s_waitcnt vmcnt(6)
v_max3_u32 v124,v32,v33,v34
v_max_u32 v124,v124,v35
v_cmp_eq_u32 vcc,-1,v124
v_smfmac_f32_16x16x64_bf16 v[60:63],v[20:23],a[88:95],v1
v_smfmac_f32_16x16x64_bf16 v[64:67],v[20:23],a[96:103],v1
v_smfmac_f32_16x16x64_bf16 v[68:71],v[20:23],a[104:111],v1
v_smfmac_f32_16x16x64_bf16 v[72:75],v[20:23],a[112:119],v1
v_smfmac_f32_16x16x64_bf16 v[76:79],v[20:23],a[120:127],v1
s_cbranch_vccnz flb_100236
s_branch segb_100220
fl_100226:
v_smfmac_f32_16x16x64_bf16 v[76:79],v[20:23],a[120:127],v1
flb_100234:
buffer_load_dwordx4 v[24:27],v0,s[20:23],s92 offen offset:2048 sc1
s_mov_b32 s55,4
buffer_load_dwordx4 v[40:43],v0,s[20:23],s93 offen offset:2048 sc1
buffer_load_dwordx4 v[44:47],v0,s[20:23],s93 offen offset:3072 sc1
s_waitcnt vmcnt(7)
v_max3_u32 v124,v28,v29,v30
v_max_u32 v124,v124,v31
v_cmp_eq_u32 vcc,-1,v124
s_cbranch_vccnz dfl_100298
v_smfmac_f32_16x16x64_bf16 v[48:51],v[28:31],a[192:199],v1
buffer_load_dword v125,off,s[20:23],s92 sc1
v_smfmac_f32_16x16x64_bf16 v[52:55],v[28:31],a[200:207],v1
v_smfmac_f32_16x16x64_bf16 v[56:59],v[28:31],a[208:215],v1
s_waitcnt vmcnt(3)
v_max3_u32 v124,v24,v25,v26
v_smfmac_f32_16x16x64_bf16 v[60:63],v[28:31],a[216:223],v1
v_max_u32 v124,v124,v27
v_smfmac_f32_16x16x64_bf16 v[64:67],v[28:31],a[224:231],v1
v_cmp_eq_u32 vcc,-1,v124
v_smfmac_f32_16x16x64_bf16 v[68:71],v[28:31],a[232:239],v1
v_smfmac_f32_16x16x64_bf16 v[72:75],v[28:31],a[240:247],v1
v_smfmac_f32_16x16x64_bf16 v[76:79],v[28:31],a[248:255],v1
s_cbranch_vccnz lfb_100303
s_mov_b32 s55,0
v_smfmac_f32_16x16x64_bf16 v[48:51],v[24:27],a[128:135],v1
v_smfmac_f32_16x16x64_bf16 v[52:55],v[24:27],a[136:143],v1
v_smfmac_f32_16x16x64_bf16 v[56:59],v[24:27],a[144:151],v1
s_waitcnt vmcnt(6)
v_max3_u32 v124,v32,v33,v34
v_max_u32 v124,v124,v35
v_cmp_eq_u32 vcc,-1,v124
v_smfmac_f32_16x16x64_bf16 v[60:63],v[24:27],a[152:159],v1
v_smfmac_f32_16x16x64_bf16 v[64:67],v[24:27],a[160:167],v1
v_smfmac_f32_16x16x64_bf16 v[68:71],v[24:27],a[168:175],v1
v_smfmac_f32_16x16x64_bf16 v[72:75],v[24:27],a[176:183],v1
v_smfmac_f32_16x16x64_bf16 v[76:79],v[24:27],a[184:191],v1
s_cbranch_vccnz flb_100236
s_branch segb_100220
fl_100227:
v_smfmac_f32_16x16x64_bf16 v[76:79],v[24:27],a[184:191],v1
flb_100235:
buffer_load_dwordx4 v[28:31],v0,s[20:23],s92 offen offset:3072 sc1
s_mov_b32 s55,8
s_waitcnt vmcnt(0)
v_max3_u32 v124,v28,v29,v30
v_max_u32 v124,v124,v31
v_cmp_eq_u32 vcc,-1,v124
s_cbranch_vccnz lfb_100303
s_mov_b32 s55,0
v_smfmac_f32_16x16x64_bf16 v[48:51],v[28:31],a[192:199],v1
v_smfmac_f32_16x16x64_bf16 v[52:55],v[28:31],a[200:207],v1
v_smfmac_f32_16x16x64_bf16 v[56:59],v[28:31],a[208:215],v1
s_waitcnt vmcnt(6)
v_max3_u32 v124,v32,v33,v34
v_max_u32 v124,v124,v35
v_cmp_eq_u32 vcc,-1,v124
v_smfmac_f32_16x16x64_bf16 v[60:63],v[28:31],a[216:223],v1
v_smfmac_f32_16x16x64_bf16 v[64:67],v[28:31],a[224:231],v1
v_smfmac_f32_16x16x64_bf16 v[68:71],v[28:31],a[232:239],v1
v_smfmac_f32_16x16x64_bf16 v[72:75],v[28:31],a[240:247],v1
v_smfmac_f32_16x16x64_bf16 v[76:79],v[28:31],a[248:255],v1
s_cbranch_vccnz flb_100236
s_branch segb_100220
fl_100228:
v_smfmac_f32_16x16x64_bf16 v[76:79],v[28:31],a[248:255],v1
flb_100236:
buffer_load_dwordx4 v[32:35],v0,s[20:23],s93 offen offset:0 sc1
s_mov_b32 s55,240
buffer_store_dwordx4 v[112:115],v120,s[20:23],s101 offen sc1
buffer_store_dword v126,v121,s[20:23],s69 offen sc1
s_bitcmp1_b32 s55,5
s_cbranch_scc0 rdn_100306
s_waitcnt vmcnt(7)
v_max3_u32 v124,v36,v37,v38
v_max_u32 v124,v124,v39
v_cmp_eq_u32 vcc,-1,v124
s_cbranch_vccnz rfa_100307
buffer_load_dword v125,off,s[20:23],s92 sc1
s_bitset0_b32 s55,5
v_smfmac_f32_16x16x64_bf16 v[48:51],v[36:39],a[64:71],v1
v_smfmac_f32_16x16x64_bf16 v[52:55],v[36:39],a[72:79],v1
v_smfmac_f32_16x16x64_bf16 v[56:59],v[36:39],a[80:87],v1
v_smfmac_f32_16x16x64_bf16 v[60:63],v[36:39],a[88:95],v1
v_smfmac_f32_16x16x64_bf16 v[64:67],v[36:39],a[96:103],v1
v_smfmac_f32_16x16x64_bf16 v[68:71],v[36:39],a[104:111],v1
v_smfmac_f32_16x16x64_bf16 v[72:75],v[36:39],a[112:119],v1
v_smfmac_f32_16x16x64_bf16 v[76:79],v[36:39],a[120:127],v1
s_cmp_eq_u32 s55,0
s_cbranch_scc1 segb_100222
s_branch rnx_100308
rdn_100306:
buffer_load_dword v125,off,s[20:23],s92 sc1
s_branch rnx_100308
rfa_100307:
buffer_load_dwordx4 v[36:39],v0,s[20:23],s93 offen offset:1024 sc1
rnx_100308:
s_bitcmp1_b32 s55,6
s_cbranch_scc0 rdn_100309
s_waitcnt vmcnt(6)
v_max3_u32 v124,v40,v41,v42
v_max_u32 v124,v124,v43
v_cmp_eq_u32 vcc,-1,v124
s_cbranch_vccnz rfa_100310
buffer_load_dword v125,off,s[20:23],s92 sc1
s_bitset0_b32 s55,6
s_cmp_eq_u32 s55,0
s_cbranch_scc1 segb_100222
s_branch rnx_100311
rdn_100309:
buffer_load_dword v125,off,s[20:23],s92 sc1
s_branch rnx_100311
rfa_100310:
buffer_load_dwordx4 v[40:43],v0,s[20:23],s93 offen offset:2048 sc1
rnx_100311:
s_bitcmp1_b32 s55,7
s_cbranch_scc0 rdn_100312
s_waitcnt vmcnt(6)
v_max3_u32 v124,v44,v45,v46
v_max_u32 v124,v124,v47
v_cmp_eq_u32 vcc,-1,v124
s_cbranch_vccnz rfa_100313
buffer_load_dword v125,off,s[20:23],s92 sc1
s_bitset0_b32 s55,7
s_cmp_eq_u32 s55,0
s_cbranch_scc1 segb_100222
s_branch rnx_100314
rdn_100312:
buffer_load_dword v125,off,s[20:23],s92 sc1
s_branch rnx_100314
rfa_100313:
buffer_load_dwordx4 v[44:47],v0,s[20:23],s93 offen offset:3072 sc1
rnx_100314:
rot_100305:
s_bitcmp1_b32 s55,4
s_cbranch_scc0 rdn_100315
s_waitcnt vmcnt(3)
v_max3_u32 v124,v32,v33,v34
v_max_u32 v124,v124,v35
v_cmp_eq_u32 vcc,-1,v124
s_cbranch_vccnz rfa_100316
buffer_load_dword v125,off,s[20:23],s92 sc1
s_bitset0_b32 s55,4
v_smfmac_f32_16x16x64_bf16 v[48:51],v[32:35],a[0:7],v1
v_smfmac_f32_16x16x64_bf16 v[52:55],v[32:35],a[8:15],v1
v_smfmac_f32_16x16x64_bf16 v[56:59],v[32:35],a[16:23],v1
v_smfmac_f32_16x16x64_bf16 v[60:63],v[32:35],a[24:31],v1
v_smfmac_f32_16x16x64_bf16 v[64:67],v[32:35],a[32:39],v1
v_smfmac_f32_16x16x64_bf16 v[68:71],v[32:35],a[40:47],v1
v_smfmac_f32_16x16x64_bf16 v[72:75],v[32:35],a[48:55],v1
v_smfmac_f32_16x16x64_bf16 v[76:79],v[32:35],a[56:63],v1
s_cmp_eq_u32 s55,0
s_cbranch_scc1 segb_100222
s_branch rnx_100317
rdn_100315:
buffer_load_dword v125,off,s[20:23],s92 sc1
s_branch rnx_100317
rfa_100316:
buffer_load_dwordx4 v[32:35],v0,s[20:23],s93 offen offset:0 sc1
rnx_100317:
s_bitcmp1_b32 s55,5
s_cbranch_scc0 rdn_100318
s_waitcnt vmcnt(3)
v_max3_u32 v124,v36,v37,v38
v_max_u32 v124,v124,v39
v_cmp_eq_u32 vcc,-1,v124
s_cbranch_vccnz rfa_100319
buffer_load_dword v125,off,s[20:23],s92 sc1
s_bitset0_b32 s55,5
v_smfmac_f32_16x16x64_bf16 v[48:51],v[36:39],a[64:71],v1
v_smfmac_f32_16x16x64_bf16 v[52:55],v[36:39],a[72:79],v1
v_smfmac_f32_16x16x64_bf16 v[56:59],v[36:39],a[80:87],v1
v_smfmac_f32_16x16x64_bf16 v[60:63],v[36:39],a[88:95],v1
v_smfmac_f32_16x16x64_bf16 v[64:67],v[36:39],a[96:103],v1
v_smfmac_f32_16x16x64_bf16 v[68:71],v[36:39],a[104:111],v1
v_smfmac_f32_16x16x64_bf16 v[72:75],v[36:39],a[112:119],v1
v_smfmac_f32_16x16x64_bf16 v[76:79],v[36:39],a[120:127],v1
s_cmp_eq_u32 s55,0
s_cbranch_scc1 segb_100222
s_branch rnx_100320
rdn_100318:
buffer_load_dword v125,off,s[20:23],s92 sc1
s_branch rnx_100320
rfa_100319:
buffer_load_dwordx4 v[36:39],v0,s[20:23],s93 offen offset:1024 sc1
rnx_100320:
s_bitcmp1_b32 s55,6
s_cbranch_scc0 rdn_100321
s_waitcnt vmcnt(3)
v_max3_u32 v124,v40,v41,v42
v_max_u32 v124,v124,v43
v_cmp_eq_u32 vcc,-1,v124
s_cbranch_vccnz rfa_100322
buffer_load_dword v125,off,s[20:23],s92 sc1
s_bitset0_b32 s55,6
s_cmp_eq_u32 s55,0
s_cbranch_scc1 segb_100222
s_branch rnx_100323
rdn_100321:
buffer_load_dword v125,off,s[20:23],s92 sc1
s_branch rnx_100323
rfa_100322:
buffer_load_dwordx4 v[40:43],v0,s[20:23],s93 offen offset:2048 sc1
rnx_100323:
s_bitcmp1_b32 s55,7
s_cbranch_scc0 rdn_100324
s_waitcnt vmcnt(3)
v_max3_u32 v124,v44,v45,v46
v_max_u32 v124,v124,v47
v_cmp_eq_u32 vcc,-1,v124
s_cbranch_vccnz rfa_100325
buffer_load_dword v125,off,s[20:23],s92 sc1
s_bitset0_b32 s55,7
s_cmp_eq_u32 s55,0
s_cbranch_scc1 segb_100222
s_branch rnx_100326
rdn_100324:
buffer_load_dword v125,off,s[20:23],s92 sc1
s_branch rnx_100326
rfa_100325:
buffer_load_dwordx4 v[44:47],v0,s[20:23],s93 offen offset:3072 sc1
rnx_100326:
s_sub_u32 s90,s90,1
s_cmp_gt_i32 s90,0
s_cbranch_scc1 rot_100305
s_mov_b32 s55,0
s_branch segb_100222
fl_100229:
v_smfmac_f32_16x16x64_bf16 v[76:79],v[32:35],a[56:63],v1
flb_100237:
buffer_load_dwordx4 v[36:39],v0,s[20:23],s93 offen offset:1024 sc1
s_mov_b32 s55,224
s_bitcmp1_b32 s55,6
s_cbranch_scc0 rdn_100328
s_waitcnt vmcnt(6)
v_max3_u32 v124,v40,v41,v42
v_max_u32 v124,v124,v43
v_cmp_eq_u32 vcc,-1,v124
s_cbranch_vccnz rfa_100329
buffer_load_dword v125,off,s[20:23],s92 sc1
s_bitset0_b32 s55,6
s_cmp_eq_u32 s55,0
s_cbranch_scc1 segb_100222
s_branch rnx_100330
rdn_100328:
buffer_load_dword v125,off,s[20:23],s92 sc1
s_branch rnx_100330
rfa_100329:
buffer_load_dwordx4 v[40:43],v0,s[20:23],s93 offen offset:2048 sc1
rnx_100330:
s_bitcmp1_b32 s55,7
s_cbranch_scc0 rdn_100331
s_waitcnt vmcnt(6)
v_max3_u32 v124,v44,v45,v46
v_max_u32 v124,v124,v47
v_cmp_eq_u32 vcc,-1,v124
s_cbranch_vccnz rfa_100332
buffer_load_dword v125,off,s[20:23],s92 sc1
s_bitset0_b32 s55,7
s_cmp_eq_u32 s55,0
s_cbranch_scc1 segb_100222
s_branch rnx_100333
rdn_100331:
buffer_load_dword v125,off,s[20:23],s92 sc1
s_branch rnx_100333
rfa_100332:
buffer_load_dwordx4 v[44:47],v0,s[20:23],s93 offen offset:3072 sc1
rnx_100333:
rot_100327:
s_bitcmp1_b32 s55,5
s_cbranch_scc0 rdn_100334
s_waitcnt vmcnt(2)
v_max3_u32 v124,v36,v37,v38
v_max_u32 v124,v124,v39
v_cmp_eq_u32 vcc,-1,v124
s_cbranch_vccnz rfa_100335
buffer_load_dword v125,off,s[20:23],s92 sc1
s_bitset0_b32 s55,5
v_smfmac_f32_16x16x64_bf16 v[48:51],v[36:39],a[64:71],v1
v_smfmac_f32_16x16x64_bf16 v[52:55],v[36:39],a[72:79],v1
v_smfmac_f32_16x16x64_bf16 v[56:59],v[36:39],a[80:87],v1
v_smfmac_f32_16x16x64_bf16 v[60:63],v[36:39],a[88:95],v1
v_smfmac_f32_16x16x64_bf16 v[64:67],v[36:39],a[96:103],v1
v_smfmac_f32_16x16x64_bf16 v[68:71],v[36:39],a[104:111],v1
v_smfmac_f32_16x16x64_bf16 v[72:75],v[36:39],a[112:119],v1
v_smfmac_f32_16x16x64_bf16 v[76:79],v[36:39],a[120:127],v1
s_cmp_eq_u32 s55,0
s_cbranch_scc1 segb_100222
s_branch rnx_100336
rdn_100334:
buffer_load_dword v125,off,s[20:23],s92 sc1
s_branch rnx_100336
rfa_100335:
buffer_load_dwordx4 v[36:39],v0,s[20:23],s93 offen offset:1024 sc1
rnx_100336:
s_bitcmp1_b32 s55,6
s_cbranch_scc0 rdn_100337
s_waitcnt vmcnt(2)
v_max3_u32 v124,v40,v41,v42
v_max_u32 v124,v124,v43
v_cmp_eq_u32 vcc,-1,v124
s_cbranch_vccnz rfa_100338
buffer_load_dword v125,off,s[20:23],s92 sc1
s_bitset0_b32 s55,6
s_cmp_eq_u32 s55,0
s_cbranch_scc1 segb_100222
s_branch rnx_100339
rdn_100337:
buffer_load_dword v125,off,s[20:23],s92 sc1
s_branch rnx_100339
rfa_100338:
buffer_load_dwordx4 v[40:43],v0,s[20:23],s93 offen offset:2048 sc1
rnx_100339:
s_bitcmp1_b32 s55,7
s_cbranch_scc0 rdn_100340
s_waitcnt vmcnt(2)
v_max3_u32 v124,v44,v45,v46
v_max_u32 v124,v124,v47
v_cmp_eq_u32 vcc,-1,v124
s_cbranch_vccnz rfa_100341
buffer_load_dword v125,off,s[20:23],s92 sc1
s_bitset0_b32 s55,7
s_cmp_eq_u32 s55,0
s_cbranch_scc1 segb_100222
s_branch rnx_100342
rdn_100340:
buffer_load_dword v125,off,s[20:23],s92 sc1
s_branch rnx_100342
rfa_100341:
buffer_load_dwordx4 v[44:47],v0,s[20:23],s93 offen offset:3072 sc1
rnx_100342:
s_sub_u32 s90,s90,1
s_cmp_gt_i32 s90,0
s_cbranch_scc1 rot_100327
s_mov_b32 s55,0
s_branch segb_100222
fl_100230:
v_smfmac_f32_16x16x64_bf16 v[76:79],v[36:39],a[120:127],v1
flb_100238:
s_mov_b32 s55,192
s_bitcmp1_b32 s55,6
s_cbranch_scc0 rdn_100344
s_waitcnt vmcnt(6)
v_max3_u32 v124,v40,v41,v42
v_max_u32 v124,v124,v43
v_cmp_eq_u32 vcc,-1,v124
s_cbranch_vccnz rfa_100345
buffer_load_dword v125,off,s[20:23],s92 sc1
s_bitset0_b32 s55,6
s_cmp_eq_u32 s55,0
s_cbranch_scc1 segb_100222
s_branch rnx_100346
rdn_100344:
buffer_load_dword v125,off,s[20:23],s92 sc1
s_branch rnx_100346
rfa_100345:
buffer_load_dwordx4 v[40:43],v0,s[20:23],s93 offen offset:2048 sc1
rnx_100346:
s_bitcmp1_b32 s55,7
s_cbranch_scc0 rdn_100347
s_waitcnt vmcnt(6)
v_max3_u32 v124,v44,v45,v46
v_max_u32 v124,v124,v47
v_cmp_eq_u32 vcc,-1,v124
s_cbranch_vccnz rfa_100348
buffer_load_dword v125,off,s[20:23],s92 sc1
s_bitset0_b32 s55,7
s_cmp_eq_u32 s55,0
s_cbranch_scc1 segb_100222
s_branch rnx_100349
rdn_100347:
buffer_load_dword v125,off,s[20:23],s92 sc1
s_branch rnx_100349
rfa_100348:
buffer_load_dwordx4 v[44:47],v0,s[20:23],s93 offen offset:3072 sc1
rnx_100349:
rot_100343:
s_bitcmp1_b32 s55,6
s_cbranch_scc0 rdn_100350
s_waitcnt vmcnt(1)
v_max3_u32 v124,v40,v41,v42
v_max_u32 v124,v124,v43
v_cmp_eq_u32 vcc,-1,v124
s_cbranch_vccnz rfa_100351
buffer_load_dword v125,off,s[20:23],s92 sc1
s_bitset0_b32 s55,6
s_cmp_eq_u32 s55,0
s_cbranch_scc1 segb_100222
s_branch rnx_100352
rdn_100350:
buffer_load_dword v125,off,s[20:23],s92 sc1
s_branch rnx_100352
rfa_100351:
buffer_load_dwordx4 v[40:43],v0,s[20:23],s93 offen offset:2048 sc1
rnx_100352:
s_bitcmp1_b32 s55,7
s_cbranch_scc0 rdn_100353
s_waitcnt vmcnt(1)
v_max3_u32 v124,v44,v45,v46
v_max_u32 v124,v124,v47
v_cmp_eq_u32 vcc,-1,v124
s_cbranch_vccnz rfa_100354
buffer_load_dword v125,off,s[20:23],s92 sc1
s_bitset0_b32 s55,7
s_cmp_eq_u32 s55,0
s_cbranch_scc1 segb_100222
s_branch rnx_100355
rdn_100353:
buffer_load_dword v125,off,s[20:23],s92 sc1
s_branch rnx_100355
rfa_100354:
buffer_load_dwordx4 v[44:47],v0,s[20:23],s93 offen offset:3072 sc1
rnx_100355:
s_sub_u32 s90,s90,1
s_cmp_gt_i32 s90,0
s_cbranch_scc1 rot_100343
s_mov_b32 s55,0
s_branch segb_100222
dfl_100296:
buffer_load_dwordx4 v[20:23],v0,s[20:23],s92 offen offset:1024 sc1
s_bitset1_b32 s55,1
buffer_load_dwordx4 v[36:39],v0,s[20:23],s93 offen offset:1024 sc1
s_waitcnt vmcnt(5)
v_max3_u32 v124,v24,v25,v26
v_max_u32 v124,v124,v27
v_cmp_eq_u32 vcc,-1,v124
s_cbranch_vccnz dfl_100297
s_branch dseg_100300
dfl_100297:
buffer_load_dwordx4 v[24:27],v0,s[20:23],s92 offen offset:2048 sc1
s_bitset1_b32 s55,2
buffer_load_dwordx4 v[40:43],v0,s[20:23],s93 offen offset:2048 sc1
buffer_load_dwordx4 v[44:47],v0,s[20:23],s93 offen offset:3072 sc1
s_waitcnt vmcnt(7)
v_max3_u32 v124,v28,v29,v30
v_max_u32 v124,v124,v31
v_cmp_eq_u32 vcc,-1,v124
s_cbranch_vccnz dfl_100298
s_branch dseg_100301
dfl_100298:
buffer_load_dwordx4 v[28:31],v0,s[20:23],s92 offen offset:3072 sc1
s_bitset1_b32 s55,3
s_branch lap2_100302
dseg_100300:
v_smfmac_f32_16x16x64_bf16 v[48:51],v[24:27],a[128:135],v1
buffer_load_dword v125,off,s[20:23],s92 sc1
v_smfmac_f32_16x16x64_bf16 v[52:55],v[24:27],a[136:143],v1
buffer_load_dwordx4 v[40:43],v0,s[20:23],s93 offen offset:2048 sc1
v_smfmac_f32_16x16x64_bf16 v[56:59],v[24:27],a[144:151],v1
buffer_load_dwordx4 v[44:47],v0,s[20:23],s93 offen offset:3072 sc1
s_waitcnt vmcnt(7)
v_max3_u32 v124,v28,v29,v30
v_smfmac_f32_16x16x64_bf16 v[60:63],v[24:27],a[152:159],v1
v_max_u32 v124,v124,v31
v_smfmac_f32_16x16x64_bf16 v[64:67],v[24:27],a[160:167],v1
v_cmp_eq_u32 vcc,-1,v124
v_smfmac_f32_16x16x64_bf16 v[68:71],v[24:27],a[168:175],v1
v_smfmac_f32_16x16x64_bf16 v[72:75],v[24:27],a[176:183],v1
v_smfmac_f32_16x16x64_bf16 v[76:79],v[24:27],a[184:191],v1
s_cbranch_vccnz dfl_100298
dseg_100301:
v_smfmac_f32_16x16x64_bf16 v[48:51],v[28:31],a[192:199],v1
buffer_load_dword v125,off,s[20:23],s92 sc1
v_smfmac_f32_16x16x64_bf16 v[52:55],v[28:31],a[200:207],v1
v_smfmac_f32_16x16x64_bf16 v[56:59],v[28:31],a[208:215],v1
v_smfmac_f32_16x16x64_bf16 v[60:63],v[28:31],a[216:223],v1
v_smfmac_f32_16x16x64_bf16 v[64:67],v[28:31],a[224:231],v1
v_smfmac_f32_16x16x64_bf16 v[68:71],v[28:31],a[232:239],v1
v_smfmac_f32_16x16x64_bf16 v[72:75],v[28:31],a[240:247],v1
v_smfmac_f32_16x16x64_bf16 v[76:79],v[28:31],a[248:255],v1
lap2_100302:
s_bitcmp1_b32 s55,0
s_cbranch_scc0 l2s_100356
s_waitcnt vmcnt(7)
v_max3_u32 v124,v16,v17,v18
v_max_u32 v124,v124,v19
v_cmp_eq_u32 vcc,-1,v124
s_cbranch_vccnz l2s_100356
s_bitset0_b32 s55,0
v_smfmac_f32_16x16x64_bf16 v[48:51],v[16:19],a[0:7],v1
v_smfmac_f32_16x16x64_bf16 v[52:55],v[16:19],a[8:15],v1
v_smfmac_f32_16x16x64_bf16 v[56:59],v[16:19],a[16:23],v1
v_smfmac_f32_16x16x64_bf16 v[60:63],v[16:19],a[24:31],v1
v_smfmac_f32_16x16x64_bf16 v[64:67],v[16:19],a[32:39],v1
v_smfmac_f32_16x16x64_bf16 v[68:71],v[16:19],a[40:47],v1
v_smfmac_f32_16x16x64_bf16 v[72:75],v[16:19],a[48:55],v1
v_smfmac_f32_16x16x64_bf16 v[76:79],v[16:19],a[56:63],v1
l2s_100356:
s_bitcmp1_b32 s55,1
s_cbranch_scc0 l2s_100358
s_waitcnt vmcnt(5)
v_max3_u32 v124,v20,v21,v22
v_max_u32 v124,v124,v23
v_cmp_eq_u32 vcc,-1,v124
s_cbranch_vccnz l2s_100358
s_bitset0_b32 s55,1
v_smfmac_f32_16x16x64_bf16 v[48:51],v[20:23],a[64:71],v1
v_smfmac_f32_16x16x64_bf16 v[52:55],v[20:23],a[72:79],v1
v_smfmac_f32_16x16x64_bf16 v[56:59],v[20:23],a[80:87],v1
v_smfmac_f32_16x16x64_bf16 v[60:63],v[20:23],a[88:95],v1
v_smfmac_f32_16x16x64_bf16 v[64:67],v[20:23],a[96:103],v1
v_smfmac_f32_16x16x64_bf16 v[68:71],v[20:23],a[104:111],v1
v_smfmac_f32_16x16x64_bf16 v[72:75],v[20:23],a[112:119],v1
v_smfmac_f32_16x16x64_bf16 v[76:79],v[20:23],a[120:127],v1
l2s_100358:
s_bitcmp1_b32 s55,2
s_cbranch_scc0 l2s_100360
s_waitcnt vmcnt(3)
v_max3_u32 v124,v24,v25,v26
v_max_u32 v124,v124,v27
v_cmp_eq_u32 vcc,-1,v124
s_cbranch_vccnz l2s_100360
s_bitset0_b32 s55,2
v_smfmac_f32_16x16x64_bf16 v[48:51],v[24:27],a[128:135],v1
v_smfmac_f32_16x16x64_bf16 v[52:55],v[24:27],a[136:143],v1
v_smfmac_f32_16x16x64_bf16 v[56:59],v[24:27],a[144:151],v1
v_smfmac_f32_16x16x64_bf16 v[60:63],v[24:27],a[152:159],v1
v_smfmac_f32_16x16x64_bf16 v[64:67],v[24:27],a[160:167],v1
v_smfmac_f32_16x16x64_bf16 v[68:71],v[24:27],a[168:175],v1
v_smfmac_f32_16x16x64_bf16 v[72:75],v[24:27],a[176:183],v1
v_smfmac_f32_16x16x64_bf16 v[76:79],v[24:27],a[184:191],v1
l2s_100360:
s_bitcmp1_b32 s55,3
s_cbranch_scc0 l2s_100362
s_waitcnt vmcnt(0)
v_max3_u32 v124,v28,v29,v30
v_max_u32 v124,v124,v31
v_cmp_eq_u32 vcc,-1,v124
s_cbranch_vccnz l2s_100362
s_bitset0_b32 s55,3
v_smfmac_f32_16x16x64_bf16 v[48:51],v[28:31],a[192:199],v1
v_smfmac_f32_16x16x64_bf16 v[52:55],v[28:31],a[200:207],v1
v_smfmac_f32_16x16x64_bf16 v[56:59],v[28:31],a[208:215],v1
v_smfmac_f32_16x16x64_bf16 v[60:63],v[28:31],a[216:223],v1
v_smfmac_f32_16x16x64_bf16 v[64:67],v[28:31],a[224:231],v1
v_smfmac_f32_16x16x64_bf16 v[68:71],v[28:31],a[232:239],v1
v_smfmac_f32_16x16x64_bf16 v[72:75],v[28:31],a[240:247],v1
v_smfmac_f32_16x16x64_bf16 v[76:79],v[28:31],a[248:255],v1
l2s_100362:
s_cmp_eq_u32 s55,0
s_cbranch_scc0 lfb_100303
Ldone_100304:
s_waitcnt vmcnt(6)
v_max3_u32 v124,v32,v33,v34
v_max_u32 v124,v124,v35
v_cmp_eq_u32 vcc,-1,v124
s_cbranch_vccnz flb_100236
s_branch segb_100220
lfb_100303:
s_bitcmp1_b32 s55,0
s_cbranch_scc0 dsk_100364
buffer_load_dwordx4 v[16:19],v0,s[20:23],s92 offen offset:0 sc1
dsk_100364:
s_bitcmp1_b32 s55,1
s_cbranch_scc0 dsk_100365
buffer_load_dwordx4 v[20:23],v0,s[20:23],s92 offen offset:1024 sc1
dsk_100365:
s_bitcmp1_b32 s55,2
s_cbranch_scc0 dsk_100366
buffer_load_dwordx4 v[24:27],v0,s[20:23],s92 offen offset:2048 sc1
dsk_100366:
s_bitcmp1_b32 s55,3
s_cbranch_scc0 dsk_100367
buffer_load_dwordx4 v[28:31],v0,s[20:23],s92 offen offset:3072 sc1
dsk_100367:
s_bitcmp1_b32 s55,0
s_cbranch_scc0 dsk_100368
s_waitcnt vmcnt(2)
v_max3_u32 v124,v16,v17,v18
v_max_u32 v124,v124,v19
v_cmp_eq_u32 vcc,-1,v124
s_cbranch_vccz dgo_100369
s_nop 15
buffer_load_dwordx4 v[104:107],v0,s[20:23],s92 offen offset:0 sc1
s_nop 15
buffer_load_dwordx4 v[108:111],v0,s[20:23],s92 offen offset:0 sc1
dlp_100370:
s_waitcnt vmcnt(2)
v_max3_u32 v124,v16,v17,v18
v_max_u32 v124,v124,v19
v_cmp_eq_u32 vcc,-1,v124
s_cbranch_vccz dgo_100369
buffer_load_dwordx4 v[16:19],v0,s[20:23],s92 offen offset:0 sc1
s_waitcnt vmcnt(2)
v_max3_u32 v124,v104,v105,v106
v_max_u32 v124,v124,v107
v_cmp_eq_u32 vcc,-1,v124
s_cbranch_vccz dcp_100372
buffer_load_dwordx4 v[104:107],v0,s[20:23],s92 offen offset:0 sc1
s_waitcnt vmcnt(2)
v_max3_u32 v124,v108,v109,v110
v_max_u32 v124,v124,v111
v_cmp_eq_u32 vcc,-1,v124
s_cbranch_vccz dcp_100373
buffer_load_dwordx4 v[108:111],v0,s[20:23],s92 offen offset:0 sc1
s_sub_u32 s90,s90,1
s_cmp_gt_i32 s90,0
s_cbranch_scc1 dlp_100370
s_branch dgo_100369
dcp_100372:
v_mov_b32 v16,v104
v_mov_b32 v17,v105
v_mov_b32 v18,v106
v_mov_b32 v19,v107
s_nop 1
s_branch dgo_100369
dcp_100373:
v_mov_b32 v16,v108
v_mov_b32 v17,v109
v_mov_b32 v18,v110
v_mov_b32 v19,v111
s_nop 1
dgo_100369:
v_smfmac_f32_16x16x64_bf16 v[48:51],v[16:19],a[0:7],v1
v_smfmac_f32_16x16x64_bf16 v[52:55],v[16:19],a[8:15],v1
v_smfmac_f32_16x16x64_bf16 v[56:59],v[16:19],a[16:23],v1
v_smfmac_f32_16x16x64_bf16 v[60:63],v[16:19],a[24:31],v1
v_smfmac_f32_16x16x64_bf16 v[64:67],v[16:19],a[32:39],v1
v_smfmac_f32_16x16x64_bf16 v[68:71],v[16:19],a[40:47],v1
v_smfmac_f32_16x16x64_bf16 v[72:75],v[16:19],a[48:55],v1
v_smfmac_f32_16x16x64_bf16 v[76:79],v[16:19],a[56:63],v1
dsk_100368:
s_bitcmp1_b32 s55,1
s_cbranch_scc0 dsk_100374
s_waitcnt vmcnt(2)
v_max3_u32 v124,v20,v21,v22
v_max_u32 v124,v124,v23
v_cmp_eq_u32 vcc,-1,v124
s_cbranch_vccz dgo_100375
s_nop 15
buffer_load_dwordx4 v[104:107],v0,s[20:23],s92 offen offset:1024 sc1
s_nop 15
buffer_load_dwordx4 v[108:111],v0,s[20:23],s92 offen offset:1024 sc1
dlp_100376:
s_waitcnt vmcnt(2)
v_max3_u32 v124,v20,v21,v22
v_max_u32 v124,v124,v23
v_cmp_eq_u32 vcc,-1,v124
s_cbranch_vccz dgo_100375
buffer_load_dwordx4 v[20:23],v0,s[20:23],s92 offen offset:1024 sc1
s_waitcnt vmcnt(2)
v_max3_u32 v124,v104,v105,v106
v_max_u32 v124,v124,v107
v_cmp_eq_u32 vcc,-1,v124
s_cbranch_vccz dcp_100378
buffer_load_dwordx4 v[104:107],v0,s[20:23],s92 offen offset:1024 sc1
s_waitcnt vmcnt(2)
v_max3_u32 v124,v108,v109,v110
v_max_u32 v124,v124,v111
v_cmp_eq_u32 vcc,-1,v124
s_cbranch_vccz dcp_100379
buffer_load_dwordx4 v[108:111],v0,s[20:23],s92 offen offset:1024 sc1
s_sub_u32 s90,s90,1
s_cmp_gt_i32 s90,0
s_cbranch_scc1 dlp_100376
s_branch dgo_100375
dcp_100378:
v_mov_b32 v20,v104
v_mov_b32 v21,v105
v_mov_b32 v22,v106
v_mov_b32 v23,v107
s_nop 1
s_branch dgo_100375
dcp_100379:
v_mov_b32 v20,v108
v_mov_b32 v21,v109
v_mov_b32 v22,v110
v_mov_b32 v23,v111
s_nop 1
dgo_100375:
v_smfmac_f32_16x16x64_bf16 v[48:51],v[20:23],a[64:71],v1
v_smfmac_f32_16x16x64_bf16 v[52:55],v[20:23],a[72:79],v1
v_smfmac_f32_16x16x64_bf16 v[56:59],v[20:23],a[80:87],v1
v_smfmac_f32_16x16x64_bf16 v[60:63],v[20:23],a[88:95],v1
v_smfmac_f32_16x16x64_bf16 v[64:67],v[20:23],a[96:103],v1
v_smfmac_f32_16x16x64_bf16 v[68:71],v[20:23],a[104:111],v1
v_smfmac_f32_16x16x64_bf16 v[72:75],v[20:23],a[112:119],v1
v_smfmac_f32_16x16x64_bf16 v[76:79],v[20:23],a[120:127],v1
dsk_100374:
s_bitcmp1_b32 s55,2
s_cbranch_scc0 dsk_100380
s_waitcnt vmcnt(2)
v_max3_u32 v124,v24,v25,v26
v_max_u32 v124,v124,v27
v_cmp_eq_u32 vcc,-1,v124
s_cbranch_vccz dgo_100381
s_nop 15
buffer_load_dwordx4 v[104:107],v0,s[20:23],s92 offen offset:2048 sc1
s_nop 15
buffer_load_dwordx4 v[108:111],v0,s[20:23],s92 offen offset:2048 sc1
dlp_100382:
s_waitcnt vmcnt(2)
v_max3_u32 v124,v24,v25,v26
v_max_u32 v124,v124,v27
v_cmp_eq_u32 vcc,-1,v124
s_cbranch_vccz dgo_100381
buffer_load_dwordx4 v[24:27],v0,s[20:23],s92 offen offset:2048 sc1
s_waitcnt vmcnt(2)
v_max3_u32 v124,v104,v105,v106
v_max_u32 v124,v124,v107
v_cmp_eq_u32 vcc,-1,v124
s_cbranch_vccz dcp_100384
buffer_load_dwordx4 v[104:107],v0,s[20:23],s92 offen offset:2048 sc1
s_waitcnt vmcnt(2)
v_max3_u32 v124,v108,v109,v110
v_max_u32 v124,v124,v111
v_cmp_eq_u32 vcc,-1,v124
s_cbranch_vccz dcp_100385
buffer_load_dwordx4 v[108:111],v0,s[20:23],s92 offen offset:2048 sc1
s_sub_u32 s90,s90,1
s_cmp_gt_i32 s90,0
s_cbranch_scc1 dlp_100382
s_branch dgo_100381
dcp_100384:
v_mov_b32 v24,v104
v_mov_b32 v25,v105
v_mov_b32 v26,v106
v_mov_b32 v27,v107
s_nop 1
s_branch dgo_100381
dcp_100385:
v_mov_b32 v24,v108
v_mov_b32 v25,v109
v_mov_b32 v26,v110
v_mov_b32 v27,v111
s_nop 1
dgo_100381:
v_smfmac_f32_16x16x64_bf16 v[48:51],v[24:27],a[128:135],v1
v_smfmac_f32_16x16x64_bf16 v[52:55],v[24:27],a[136:143],v1
v_smfmac_f32_16x16x64_bf16 v[56:59],v[24:27],a[144:151],v1
v_smfmac_f32_16x16x64_bf16 v[60:63],v[24:27],a[152:159],v1
v_smfmac_f32_16x16x64_bf16 v[64:67],v[24:27],a[160:167],v1
v_smfmac_f32_16x16x64_bf16 v[68:71],v[24:27],a[168:175],v1
v_smfmac_f32_16x16x64_bf16 v[72:75],v[24:27],a[176:183],v1
v_smfmac_f32_16x16x64_bf16 v[76:79],v[24:27],a[184:191],v1
dsk_100380:
s_bitcmp1_b32 s55,3
s_cbranch_scc0 dsk_100386
s_waitcnt vmcnt(2)
v_max3_u32 v124,v28,v29,v30
v_max_u32 v124,v124,v31
v_cmp_eq_u32 vcc,-1,v124
s_cbranch_vccz dgo_100387
s_nop 15
buffer_load_dwordx4 v[104:107],v0,s[20:23],s92 offen offset:3072 sc1
s_nop 15
buffer_load_dwordx4 v[108:111],v0,s[20:23],s92 offen offset:3072 sc1
dlp_100388:
s_waitcnt vmcnt(2)
v_max3_u32 v124,v28,v29,v30
v_max_u32 v124,v124,v31
v_cmp_eq_u32 vcc,-1,v124
s_cbranch_vccz dgo_100387
buffer_load_dwordx4 v[28:31],v0,s[20:23],s92 offen offset:3072 sc1
s_waitcnt vmcnt(2)
v_max3_u32 v124,v104,v105,v106
v_max_u32 v124,v124,v107
v_cmp_eq_u32 vcc,-1,v124
s_cbranch_vccz dcp_100390
buffer_load_dwordx4 v[104:107],v0,s[20:23],s92 offen offset:3072 sc1
s_waitcnt vmcnt(2)
v_max3_u32 v124,v108,v109,v110
v_max_u32 v124,v124,v111
v_cmp_eq_u32 vcc,-1,v124
s_cbranch_vccz dcp_100391
buffer_load_dwordx4 v[108:111],v0,s[20:23],s92 offen offset:3072 sc1
s_sub_u32 s90,s90,1
s_cmp_gt_i32 s90,0
s_cbranch_scc1 dlp_100388
s_branch dgo_100387
dcp_100390:
v_mov_b32 v28,v104
v_mov_b32 v29,v105
v_mov_b32 v30,v106
v_mov_b32 v31,v107
s_nop 1
s_branch dgo_100387
dcp_100391:
v_mov_b32 v28,v108
v_mov_b32 v29,v109
v_mov_b32 v30,v110
v_mov_b32 v31,v111
s_nop 1
dgo_100387:
v_smfmac_f32_16x16x64_bf16 v[48:51],v[28:31],a[192:199],v1
v_smfmac_f32_16x16x64_bf16 v[52:55],v[28:31],a[200:207],v1
v_smfmac_f32_16x16x64_bf16 v[56:59],v[28:31],a[208:215],v1
v_smfmac_f32_16x16x64_bf16 v[60:63],v[28:31],a[216:223],v1
v_smfmac_f32_16x16x64_bf16 v[64:67],v[28:31],a[224:231],v1
v_smfmac_f32_16x16x64_bf16 v[68:71],v[28:31],a[232:239],v1
v_smfmac_f32_16x16x64_bf16 v[72:75],v[28:31],a[240:247],v1
v_smfmac_f32_16x16x64_bf16 v[76:79],v[28:31],a[248:255],v1
dsk_100386:
s_mov_b32 s55,0
s_branch Ldone_100304
slowA_100240:
buffer_load_dwordx4 v[44:47],v0,s[20:23],s93 offen offset:3072 sc1
dsk_100392:
s_bitcmp1_b32 s55,7
s_cbranch_scc0 dsk_100393
s_waitcnt vmcnt(2)
v_max3_u32 v124,v44,v45,v46
v_max_u32 v124,v124,v47
v_cmp_eq_u32 vcc,-1,v124
s_cbranch_vccz dgo_100394
s_nop 15
s_nop 3
buffer_load_dwordx4 v[104:107],v0,s[20:23],s93 offen offset:3072 sc1
s_nop 15
s_nop 3
buffer_load_dwordx4 v[108:111],v0,s[20:23],s93 offen offset:3072 sc1
dlp_100395:
s_waitcnt vmcnt(2)
v_max3_u32 v124,v44,v45,v46
v_max_u32 v124,v124,v47
v_cmp_eq_u32 vcc,-1,v124
s_cbranch_vccz dgo_100394
buffer_load_dwordx4 v[44:47],v0,s[20:23],s93 offen offset:3072 sc1
s_waitcnt vmcnt(2)
v_max3_u32 v124,v104,v105,v106
v_max_u32 v124,v124,v107
v_cmp_eq_u32 vcc,-1,v124
s_cbranch_vccz dcp_100397
buffer_load_dwordx4 v[104:107],v0,s[20:23],s93 offen offset:3072 sc1
s_waitcnt vmcnt(2)
v_max3_u32 v124,v108,v109,v110
v_max_u32 v124,v124,v111
v_cmp_eq_u32 vcc,-1,v124
s_cbranch_vccz dcp_100398
buffer_load_dwordx4 v[108:111],v0,s[20:23],s93 offen offset:3072 sc1
s_sub_u32 s90,s90,1
s_cmp_gt_i32 s90,0
s_cbranch_scc1 dlp_100395
s_branch dgo_100394
dcp_100397:
v_mov_b32 v44,v104
v_mov_b32 v45,v105
v_mov_b32 v46,v106
v_mov_b32 v47,v107
s_nop 1
s_branch dgo_100394
dcp_100398:
v_mov_b32 v44,v108
v_mov_b32 v45,v109
v_mov_b32 v46,v110
v_mov_b32 v47,v111
s_nop 1
dgo_100394:
dsk_100393:
s_mov_b32 s55,0
s_branch segb_100222
srt_100247:
s_sub_u32 s90,s90,1
s_cmp_gt_i32 s90,0
s_cbranch_scc0 sok_100246
buffer_load_dwordx4 v[16:19],v2,s[20:23],s94 offen offset:0 sc1
buffer_load_dwordx4 v[32:35],v2,s[20:23],s94 offen offset:1536 sc1
buffer_load_dwordx4 v[20:23],v2,s[20:23],s95 offen offset:0 sc1
buffer_load_dwordx4 v[36:39],v2,s[20:23],s95 offen offset:1536 sc1
buffer_load_dword v120,v3,s[20:23],s94 offen offset:0 sc1
buffer_load_dword v121,v3,s[20:23],s94 offen offset:1536 sc1
buffer_load_dword v122,v3,s[20:23],s95 offen offset:0 sc1
buffer_load_dword v123,v3,s[20:23],s95 offen offset:1536 sc1
s_branch sp_100245
of_100248:
s_mov_b32 s55,3
buffer_load_dwordx4 v[16:19],v0,s[20:23],s96 offen offset:0 sc1
buffer_load_dwordx4 v[20:23],v0,s[20:23],s96 offen offset:1024 sc1
v_readfirstlane_b32 s91,v126
s_waitcnt vmcnt(6)
v_max3_u32 v124,v24,v25,v26
v_max3_u32 v124,v124,v27,v28
v_max3_u32 v124,v124,v29,v30
v_max_u32 v124,v124,v31
v_cmp_eq_u32 vcc,-1,v124
s_cbranch_vccnz ost_100400
v_smfmac_f32_16x16x64_bf16 v[96:99],v[24:27],v[80:87],v1
buffer_load_dword v120,off,s[20:23],s96 sc1
v_smfmac_f32_16x16x64_bf16 v[100:103],v[24:27],v[88:95],v1
buffer_load_dword v120,off,s[20:23],s96 sc1
v_smfmac_f32_16x16x64_bf16 v[96:99],v[28:31],v[128:135],v1
v_smfmac_f32_16x16x64_bf16 v[100:103],v[28:31],v[136:143],v1
ort_100401:
s_waitcnt vmcnt(6)
v_max3_u32 v124,v32,v33,v34
v_max3_u32 v124,v124,v35,v36
v_max3_u32 v124,v124,v37,v38
v_max_u32 v124,v124,v39
v_cmp_eq_u32 vcc,-1,v124
s_cbranch_vccnz ost_100402
v_smfmac_f32_16x16x64_bf16 v[96:99],v[32:35],v[144:151],v1
buffer_load_dword v120,off,s[20:23],s96 sc1
v_smfmac_f32_16x16x64_bf16 v[100:103],v[32:35],v[152:159],v1
buffer_load_dword v120,off,s[20:23],s96 sc1
v_smfmac_f32_16x16x64_bf16 v[96:99],v[36:39],v[160:167],v1
v_smfmac_f32_16x16x64_bf16 v[100:103],v[36:39],v[168:175],v1
ort_100403:
s_waitcnt vmcnt(7)
v_max3_u32 v124,v40,v41,v42
v_max_u32 v124,v124,v43
v_cmp_eq_u32 vcc,-1,v124
s_cbranch_vccnz ost_100404
v_smfmac_f32_16x16x64_bf16 v[96:99],v[40:43],v[176:183],v1
buffer_load_dword v120,off,s[20:23],s96 sc1
v_smfmac_f32_16x16x64_bf16 v[100:103],v[40:43],v[184:191],v1
ort_100405:
s_waitcnt vmcnt(7)
v_max3_u32 v124,v44,v45,v46
v_max_u32 v124,v124,v47
v_cmp_eq_u32 vcc,-1,v124
s_cbranch_vccnz ost_100406
v_smfmac_f32_16x16x64_bf16 v[96:99],v[44:47],v[192:199],v1
buffer_load_dword v120,off,s[20:23],s96 sc1
v_smfmac_f32_16x16x64_bf16 v[100:103],v[44:47],v[200:207],v1
ort_100407:
s_waitcnt vmcnt(6)
v_max3_u32 v124,v16,v17,v18
v_max3_u32 v124,v124,v19,v20
v_max3_u32 v124,v124,v21,v22
v_max_u32 v124,v124,v23
v_cmp_eq_u32 vcc,-1,v124
s_cbranch_vccnz olap2_100399
s_andn2_b32 s55,s55,3
v_smfmac_f32_16x16x64_bf16 v[96:99],v[16:19],v[48:55],v1
v_smfmac_f32_16x16x64_bf16 v[100:103],v[16:19],v[56:63],v1
v_smfmac_f32_16x16x64_bf16 v[96:99],v[20:23],v[64:71],v1
v_smfmac_f32_16x16x64_bf16 v[100:103],v[20:23],v[72:79],v1
s_cbranch_scc0 oback_100259
s_branch olap2_100399
ost_100400:
buffer_load_dwordx4 v[24:27],v0,s[20:23],s96 offen offset:2048 sc1
buffer_load_dwordx4 v[28:31],v0,s[20:23],s96 offen offset:3072 sc1
s_or_b32 s55,s55,12
s_branch ort_100401
ost_100402:
buffer_load_dwordx4 v[32:35],v0,s[20:23],s97 offen offset:0 sc1
buffer_load_dwordx4 v[36:39],v0,s[20:23],s97 offen offset:1024 sc1
s_or_b32 s55,s55,48
s_branch ort_100403
ost_100404:
buffer_load_dwordx4 v[40:43],v0,s[20:23],s97 offen offset:2048 sc1
s_or_b32 s55,s55,64
s_branch ort_100405
ost_100406:
buffer_load_dwordx4 v[44:47],v0,s[20:23],s97 offen offset:3072 sc1
s_or_b32 s55,s55,128
s_branch ort_100407
of_100249:
s_mov_b32 s55,12
buffer_load_dwordx4 v[24:27],v0,s[20:23],s96 offen offset:2048 sc1
buffer_load_dwordx4 v[28:31],v0,s[20:23],s96 offen offset:3072 sc1
s_waitcnt vmcnt(4)
v_max3_u32 v124,v32,v33,v34
v_max3_u32 v124,v124,v35,v36
v_max3_u32 v124,v124,v37,v38
v_max_u32 v124,v124,v39
v_cmp_eq_u32 vcc,-1,v124
s_cbranch_vccnz ost_100409
v_smfmac_f32_16x16x64_bf16 v[96:99],v[32:35],v[144:151],v1
buffer_load_dword v120,off,s[20:23],s96 sc1
v_smfmac_f32_16x16x64_bf16 v[100:103],v[32:35],v[152:159],v1
buffer_load_dword v120,off,s[20:23],s96 sc1
v_smfmac_f32_16x16x64_bf16 v[96:99],v[36:39],v[160:167],v1
v_smfmac_f32_16x16x64_bf16 v[100:103],v[36:39],v[168:175],v1
ort_100410:
s_waitcnt vmcnt(5)
v_max3_u32 v124,v40,v41,v42
v_max_u32 v124,v124,v43
v_cmp_eq_u32 vcc,-1,v124
s_cbranch_vccnz ost_100411
v_smfmac_f32_16x16x64_bf16 v[96:99],v[40:43],v[176:183],v1
buffer_load_dword v120,off,s[20:23],s96 sc1
v_smfmac_f32_16x16x64_bf16 v[100:103],v[40:43],v[184:191],v1
ort_100412:
s_waitcnt vmcnt(5)
v_max3_u32 v124,v44,v45,v46
v_max_u32 v124,v124,v47
v_cmp_eq_u32 vcc,-1,v124
s_cbranch_vccnz ost_100413
v_smfmac_f32_16x16x64_bf16 v[96:99],v[44:47],v[192:199],v1
buffer_load_dword v120,off,s[20:23],s96 sc1
v_smfmac_f32_16x16x64_bf16 v[100:103],v[44:47],v[200:207],v1
ort_100414:
s_waitcnt vmcnt(4)
v_max3_u32 v124,v24,v25,v26
v_max3_u32 v124,v124,v27,v28
v_max3_u32 v124,v124,v29,v30
v_max_u32 v124,v124,v31
v_cmp_eq_u32 vcc,-1,v124
s_cbranch_vccnz olap2_100399
s_andn2_b32 s55,s55,12
v_smfmac_f32_16x16x64_bf16 v[96:99],v[24:27],v[80:87],v1
v_smfmac_f32_16x16x64_bf16 v[100:103],v[24:27],v[88:95],v1
v_smfmac_f32_16x16x64_bf16 v[96:99],v[28:31],v[128:135],v1
v_smfmac_f32_16x16x64_bf16 v[100:103],v[28:31],v[136:143],v1
s_cbranch_scc0 oback_100259
s_branch olap2_100399
ost_100409:
buffer_load_dwordx4 v[32:35],v0,s[20:23],s97 offen offset:0 sc1
buffer_load_dwordx4 v[36:39],v0,s[20:23],s97 offen offset:1024 sc1
s_or_b32 s55,s55,48
s_branch ort_100410
ost_100411:
buffer_load_dwordx4 v[40:43],v0,s[20:23],s97 offen offset:2048 sc1
s_or_b32 s55,s55,64
s_branch ort_100412
ost_100413:
buffer_load_dwordx4 v[44:47],v0,s[20:23],s97 offen offset:3072 sc1
s_or_b32 s55,s55,128
s_branch ort_100414
of_100250:
s_mov_b32 s55,48
buffer_load_dwordx4 v[32:35],v0,s[20:23],s97 offen offset:0 sc1
buffer_load_dwordx4 v[36:39],v0,s[20:23],s97 offen offset:1024 sc1
s_waitcnt vmcnt(3)
v_max3_u32 v124,v40,v41,v42
v_max_u32 v124,v124,v43
v_cmp_eq_u32 vcc,-1,v124
s_cbranch_vccnz ost_100416
v_smfmac_f32_16x16x64_bf16 v[96:99],v[40:43],v[176:183],v1
buffer_load_dword v120,off,s[20:23],s96 sc1
v_smfmac_f32_16x16x64_bf16 v[100:103],v[40:43],v[184:191],v1
ort_100417:
s_waitcnt vmcnt(3)
v_max3_u32 v124,v44,v45,v46
v_max_u32 v124,v124,v47
v_cmp_eq_u32 vcc,-1,v124
s_cbranch_vccnz ost_100418
v_smfmac_f32_16x16x64_bf16 v[96:99],v[44:47],v[192:199],v1
buffer_load_dword v120,off,s[20:23],s96 sc1
v_smfmac_f32_16x16x64_bf16 v[100:103],v[44:47],v[200:207],v1
ort_100419:
s_waitcnt vmcnt(2)
v_max3_u32 v124,v32,v33,v34
v_max3_u32 v124,v124,v35,v36
v_max3_u32 v124,v124,v37,v38
v_max_u32 v124,v124,v39
v_cmp_eq_u32 vcc,-1,v124
s_cbranch_vccnz olap2_100399
s_andn2_b32 s55,s55,48
v_smfmac_f32_16x16x64_bf16 v[96:99],v[32:35],v[144:151],v1
v_smfmac_f32_16x16x64_bf16 v[100:103],v[32:35],v[152:159],v1
v_smfmac_f32_16x16x64_bf16 v[96:99],v[36:39],v[160:167],v1
v_smfmac_f32_16x16x64_bf16 v[100:103],v[36:39],v[168:175],v1
s_cbranch_scc0 oback_100259
s_branch olap2_100399
ost_100416:
buffer_load_dwordx4 v[40:43],v0,s[20:23],s97 offen offset:2048 sc1
s_or_b32 s55,s55,64
s_branch ort_100417
ost_100418:
buffer_load_dwordx4 v[44:47],v0,s[20:23],s97 offen offset:3072 sc1
s_or_b32 s55,s55,128
s_branch ort_100419
of_100251:
s_mov_b32 s55,64
buffer_load_dwordx4 v[40:43],v0,s[20:23],s97 offen offset:2048 sc1
s_waitcnt vmcnt(1)
v_max3_u32 v124,v44,v45,v46
v_max_u32 v124,v124,v47
v_cmp_eq_u32 vcc,-1,v124
s_cbranch_vccnz ost_100421
v_smfmac_f32_16x16x64_bf16 v[96:99],v[44:47],v[192:199],v1
buffer_load_dword v120,off,s[20:23],s96 sc1
v_smfmac_f32_16x16x64_bf16 v[100:103],v[44:47],v[200:207],v1
ort_100422:
s_waitcnt vmcnt(1)
v_max3_u32 v124,v40,v41,v42
v_max_u32 v124,v124,v43
v_cmp_eq_u32 vcc,-1,v124
s_cbranch_vccnz olap2_100399
s_andn2_b32 s55,s55,64
v_smfmac_f32_16x16x64_bf16 v[96:99],v[40:43],v[176:183],v1
v_smfmac_f32_16x16x64_bf16 v[100:103],v[40:43],v[184:191],v1
s_cbranch_scc0 oback_100259
s_branch olap2_100399
ost_100421:
buffer_load_dwordx4 v[44:47],v0,s[20:23],s97 offen offset:3072 sc1
s_or_b32 s55,s55,128
s_branch ort_100422
of_100252:
s_mov_b32 s55,128
s_branch oslow_100258
olap2_100399:
s_bitcmp1_b32 s55,0
s_cbranch_scc0 l2s_100424
s_waitcnt vmcnt(6)
v_max3_u32 v124,v16,v17,v18
v_max3_u32 v124,v124,v19,v20
v_max3_u32 v124,v124,v21,v22
v_max_u32 v124,v124,v23
v_cmp_eq_u32 vcc,-1,v124
s_cbranch_vccnz l2s_100424
s_andn2_b32 s55,s55,3
v_smfmac_f32_16x16x64_bf16 v[96:99],v[16:19],v[48:55],v1
v_smfmac_f32_16x16x64_bf16 v[100:103],v[16:19],v[56:63],v1
v_smfmac_f32_16x16x64_bf16 v[96:99],v[20:23],v[64:71],v1
v_smfmac_f32_16x16x64_bf16 v[100:103],v[20:23],v[72:79],v1
l2s_100424:
s_bitcmp1_b32 s55,2
s_cbranch_scc0 l2s_100425
s_waitcnt vmcnt(4)
v_max3_u32 v124,v24,v25,v26
v_max3_u32 v124,v124,v27,v28
v_max3_u32 v124,v124,v29,v30
v_max_u32 v124,v124,v31
v_cmp_eq_u32 vcc,-1,v124
s_cbranch_vccnz l2s_100425
s_andn2_b32 s55,s55,12
v_smfmac_f32_16x16x64_bf16 v[96:99],v[24:27],v[80:87],v1
v_smfmac_f32_16x16x64_bf16 v[100:103],v[24:27],v[88:95],v1
v_smfmac_f32_16x16x64_bf16 v[96:99],v[28:31],v[128:135],v1
v_smfmac_f32_16x16x64_bf16 v[100:103],v[28:31],v[136:143],v1
l2s_100425:
s_bitcmp1_b32 s55,4
s_cbranch_scc0 l2s_100426
s_waitcnt vmcnt(2)
v_max3_u32 v124,v32,v33,v34
v_max3_u32 v124,v124,v35,v36
v_max3_u32 v124,v124,v37,v38
v_max_u32 v124,v124,v39
v_cmp_eq_u32 vcc,-1,v124
s_cbranch_vccnz l2s_100426
s_andn2_b32 s55,s55,48
v_smfmac_f32_16x16x64_bf16 v[96:99],v[32:35],v[144:151],v1
v_smfmac_f32_16x16x64_bf16 v[100:103],v[32:35],v[152:159],v1
v_smfmac_f32_16x16x64_bf16 v[96:99],v[36:39],v[160:167],v1
v_smfmac_f32_16x16x64_bf16 v[100:103],v[36:39],v[168:175],v1
l2s_100426:
s_bitcmp1_b32 s55,6
s_cbranch_scc0 l2s_100427
s_waitcnt vmcnt(1)
v_max3_u32 v124,v40,v41,v42
v_max_u32 v124,v124,v43
v_cmp_eq_u32 vcc,-1,v124
s_cbranch_vccnz l2s_100427
s_andn2_b32 s55,s55,64
v_smfmac_f32_16x16x64_bf16 v[96:99],v[40:43],v[176:183],v1
v_smfmac_f32_16x16x64_bf16 v[100:103],v[40:43],v[184:191],v1
l2s_100427:
s_bitcmp1_b32 s55,7
s_cbranch_scc0 l2s_100428
s_waitcnt vmcnt(0)
v_max3_u32 v124,v44,v45,v46
v_max_u32 v124,v124,v47
v_cmp_eq_u32 vcc,-1,v124
s_cbranch_vccnz l2s_100428
s_andn2_b32 s55,s55,128
v_smfmac_f32_16x16x64_bf16 v[96:99],v[44:47],v[192:199],v1
v_smfmac_f32_16x16x64_bf16 v[100:103],v[44:47],v[200:207],v1
l2s_100428:
s_cmp_eq_u32 s55,0
s_cbranch_scc1 oback_100259
oslow_100258:
s_bitcmp1_b32 s55,0
s_cbranch_scc0 dsk_100429
buffer_load_dwordx4 v[16:19],v0,s[20:23],s96 offen offset:0 sc1
dsk_100429:
s_bitcmp1_b32 s55,1
s_cbranch_scc0 dsk_100430
buffer_load_dwordx4 v[20:23],v0,s[20:23],s96 offen offset:1024 sc1
dsk_100430:
s_bitcmp1_b32 s55,2
s_cbranch_scc0 dsk_100431
buffer_load_dwordx4 v[24:27],v0,s[20:23],s96 offen offset:2048 sc1
dsk_100431:
s_bitcmp1_b32 s55,3
s_cbranch_scc0 dsk_100432
buffer_load_dwordx4 v[28:31],v0,s[20:23],s96 offen offset:3072 sc1
dsk_100432:
s_bitcmp1_b32 s55,4
s_cbranch_scc0 dsk_100433
buffer_load_dwordx4 v[32:35],v0,s[20:23],s97 offen offset:0 sc1
dsk_100433:
s_bitcmp1_b32 s55,5
s_cbranch_scc0 dsk_100434
buffer_load_dwordx4 v[36:39],v0,s[20:23],s97 offen offset:1024 sc1
dsk_100434:
s_bitcmp1_b32 s55,6
s_cbranch_scc0 dsk_100435
buffer_load_dwordx4 v[40:43],v0,s[20:23],s97 offen offset:2048 sc1
dsk_100435:
s_bitcmp1_b32 s55,7
s_cbranch_scc0 dsk_100436
buffer_load_dwordx4 v[44:47],v0,s[20:23],s97 offen offset:3072 sc1
dsk_100436:
s_bitcmp1_b32 s55,0
s_cbranch_scc0 dsk_100437
s_waitcnt vmcnt(2)
v_max3_u32 v124,v16,v17,v18
v_max_u32 v124,v124,v19
v_cmp_eq_u32 vcc,-1,v124
s_cbranch_vccz dgo_100438
s_nop 15
buffer_load_dwordx4 v[116:119],v0,s[20:23],s96 offen offset:0 sc1
s_nop 15
buffer_load_dwordx4 v[120:123],v0,s[20:23],s96 offen offset:0 sc1
dlp_100439:
s_waitcnt vmcnt(2)
v_max3_u32 v124,v16,v17,v18
v_max_u32 v124,v124,v19
v_cmp_eq_u32 vcc,-1,v124
s_cbranch_vccz dgo_100438
buffer_load_dwordx4 v[16:19],v0,s[20:23],s96 offen offset:0 sc1
s_waitcnt vmcnt(2)
v_max3_u32 v124,v116,v117,v118
v_max_u32 v124,v124,v119
v_cmp_eq_u32 vcc,-1,v124
s_cbranch_vccz dcp_100441
buffer_load_dwordx4 v[116:119],v0,s[20:23],s96 offen offset:0 sc1
s_waitcnt vmcnt(2)
v_max3_u32 v124,v120,v121,v122
v_max_u32 v124,v124,v123
v_cmp_eq_u32 vcc,-1,v124
s_cbranch_vccz dcp_100442
buffer_load_dwordx4 v[120:123],v0,s[20:23],s96 offen offset:0 sc1
s_sub_u32 s90,s90,1
s_cmp_gt_i32 s90,0
s_cbranch_scc1 dlp_100439
s_branch dgo_100438
dcp_100441:
v_mov_b32 v16,v116
v_mov_b32 v17,v117
v_mov_b32 v18,v118
v_mov_b32 v19,v119
s_nop 1
s_branch dgo_100438
dcp_100442:
v_mov_b32 v16,v120
v_mov_b32 v17,v121
v_mov_b32 v18,v122
v_mov_b32 v19,v123
s_nop 1
dgo_100438:
v_smfmac_f32_16x16x64_bf16 v[96:99],v[16:19],v[48:55],v1
v_smfmac_f32_16x16x64_bf16 v[100:103],v[16:19],v[56:63],v1
dsk_100437:
s_bitcmp1_b32 s55,1
s_cbranch_scc0 dsk_100443
s_waitcnt vmcnt(2)
v_max3_u32 v124,v20,v21,v22
v_max_u32 v124,v124,v23
v_cmp_eq_u32 vcc,-1,v124
s_cbranch_vccz dgo_100444
s_nop 15
buffer_load_dwordx4 v[116:119],v0,s[20:23],s96 offen offset:1024 sc1
s_nop 15
buffer_load_dwordx4 v[120:123],v0,s[20:23],s96 offen offset:1024 sc1
dlp_100445:
s_waitcnt vmcnt(2)
v_max3_u32 v124,v20,v21,v22
v_max_u32 v124,v124,v23
v_cmp_eq_u32 vcc,-1,v124
s_cbranch_vccz dgo_100444
buffer_load_dwordx4 v[20:23],v0,s[20:23],s96 offen offset:1024 sc1
s_waitcnt vmcnt(2)
v_max3_u32 v124,v116,v117,v118
v_max_u32 v124,v124,v119
v_cmp_eq_u32 vcc,-1,v124
s_cbranch_vccz dcp_100447
buffer_load_dwordx4 v[116:119],v0,s[20:23],s96 offen offset:1024 sc1
s_waitcnt vmcnt(2)
v_max3_u32 v124,v120,v121,v122
v_max_u32 v124,v124,v123
v_cmp_eq_u32 vcc,-1,v124
s_cbranch_vccz dcp_100448
buffer_load_dwordx4 v[120:123],v0,s[20:23],s96 offen offset:1024 sc1
s_sub_u32 s90,s90,1
s_cmp_gt_i32 s90,0
s_cbranch_scc1 dlp_100445
s_branch dgo_100444
dcp_100447:
v_mov_b32 v20,v116
v_mov_b32 v21,v117
v_mov_b32 v22,v118
v_mov_b32 v23,v119
s_nop 1
s_branch dgo_100444
dcp_100448:
v_mov_b32 v20,v120
v_mov_b32 v21,v121
v_mov_b32 v22,v122
v_mov_b32 v23,v123
s_nop 1
dgo_100444:
v_smfmac_f32_16x16x64_bf16 v[96:99],v[20:23],v[64:71],v1
v_smfmac_f32_16x16x64_bf16 v[100:103],v[20:23],v[72:79],v1
dsk_100443:
s_bitcmp1_b32 s55,2
s_cbranch_scc0 dsk_100449
s_waitcnt vmcnt(2)
v_max3_u32 v124,v24,v25,v26
v_max_u32 v124,v124,v27
v_cmp_eq_u32 vcc,-1,v124
s_cbranch_vccz dgo_100450
s_nop 15
buffer_load_dwordx4 v[116:119],v0,s[20:23],s96 offen offset:2048 sc1
s_nop 15
buffer_load_dwordx4 v[120:123],v0,s[20:23],s96 offen offset:2048 sc1
dlp_100451:
s_waitcnt vmcnt(2)
v_max3_u32 v124,v24,v25,v26
v_max_u32 v124,v124,v27
v_cmp_eq_u32 vcc,-1,v124
s_cbranch_vccz dgo_100450
buffer_load_dwordx4 v[24:27],v0,s[20:23],s96 offen offset:2048 sc1
s_waitcnt vmcnt(2)
v_max3_u32 v124,v116,v117,v118
v_max_u32 v124,v124,v119
v_cmp_eq_u32 vcc,-1,v124
s_cbranch_vccz dcp_100453
buffer_load_dwordx4 v[116:119],v0,s[20:23],s96 offen offset:2048 sc1
s_waitcnt vmcnt(2)
v_max3_u32 v124,v120,v121,v122
v_max_u32 v124,v124,v123
v_cmp_eq_u32 vcc,-1,v124
s_cbranch_vccz dcp_100454
buffer_load_dwordx4 v[120:123],v0,s[20:23],s96 offen offset:2048 sc1
s_sub_u32 s90,s90,1
s_cmp_gt_i32 s90,0
s_cbranch_scc1 dlp_100451
s_branch dgo_100450
dcp_100453:
v_mov_b32 v24,v116
v_mov_b32 v25,v117
v_mov_b32 v26,v118
v_mov_b32 v27,v119
s_nop 1
s_branch dgo_100450
dcp_100454:
v_mov_b32 v24,v120
v_mov_b32 v25,v121
v_mov_b32 v26,v122
v_mov_b32 v27,v123
s_nop 1
dgo_100450:
v_smfmac_f32_16x16x64_bf16 v[96:99],v[24:27],v[80:87],v1
v_smfmac_f32_16x16x64_bf16 v[100:103],v[24:27],v[88:95],v1
dsk_100449:
s_bitcmp1_b32 s55,3
s_cbranch_scc0 dsk_100455
s_waitcnt vmcnt(2)
v_max3_u32 v124,v28,v29,v30
v_max_u32 v124,v124,v31
v_cmp_eq_u32 vcc,-1,v124
s_cbranch_vccz dgo_100456
s_nop 15
buffer_load_dwordx4 v[116:119],v0,s[20:23],s96 offen offset:3072 sc1
s_nop 15
buffer_load_dwordx4 v[120:123],v0,s[20:23],s96 offen offset:3072 sc1
dlp_100457:
s_waitcnt vmcnt(2)
v_max3_u32 v124,v28,v29,v30
v_max_u32 v124,v124,v31
v_cmp_eq_u32 vcc,-1,v124
s_cbranch_vccz dgo_100456
buffer_load_dwordx4 v[28:31],v0,s[20:23],s96 offen offset:3072 sc1
s_waitcnt vmcnt(2)
v_max3_u32 v124,v116,v117,v118
v_max_u32 v124,v124,v119
v_cmp_eq_u32 vcc,-1,v124
s_cbranch_vccz dcp_100459
buffer_load_dwordx4 v[116:119],v0,s[20:23],s96 offen offset:3072 sc1
s_waitcnt vmcnt(2)
v_max3_u32 v124,v120,v121,v122
v_max_u32 v124,v124,v123
v_cmp_eq_u32 vcc,-1,v124
s_cbranch_vccz dcp_100460
buffer_load_dwordx4 v[120:123],v0,s[20:23],s96 offen offset:3072 sc1
s_sub_u32 s90,s90,1
s_cmp_gt_i32 s90,0
s_cbranch_scc1 dlp_100457
s_branch dgo_100456
dcp_100459:
v_mov_b32 v28,v116
v_mov_b32 v29,v117
v_mov_b32 v30,v118
v_mov_b32 v31,v119
s_nop 1
s_branch dgo_100456
dcp_100460:
v_mov_b32 v28,v120
v_mov_b32 v29,v121
v_mov_b32 v30,v122
v_mov_b32 v31,v123
s_nop 1
dgo_100456:
v_smfmac_f32_16x16x64_bf16 v[96:99],v[28:31],v[128:135],v1
v_smfmac_f32_16x16x64_bf16 v[100:103],v[28:31],v[136:143],v1
dsk_100455:
s_bitcmp1_b32 s55,4
s_cbranch_scc0 dsk_100461
s_waitcnt vmcnt(2)
v_max3_u32 v124,v32,v33,v34
v_max_u32 v124,v124,v35
v_cmp_eq_u32 vcc,-1,v124
s_cbranch_vccz dgo_100462
s_nop 15
buffer_load_dwordx4 v[116:119],v0,s[20:23],s97 offen offset:0 sc1
s_nop 15
buffer_load_dwordx4 v[120:123],v0,s[20:23],s97 offen offset:0 sc1
dlp_100463:
s_waitcnt vmcnt(2)
v_max3_u32 v124,v32,v33,v34
v_max_u32 v124,v124,v35
v_cmp_eq_u32 vcc,-1,v124
s_cbranch_vccz dgo_100462
buffer_load_dwordx4 v[32:35],v0,s[20:23],s97 offen offset:0 sc1
s_waitcnt vmcnt(2)
v_max3_u32 v124,v116,v117,v118
v_max_u32 v124,v124,v119
v_cmp_eq_u32 vcc,-1,v124
s_cbranch_vccz dcp_100465
buffer_load_dwordx4 v[116:119],v0,s[20:23],s97 offen offset:0 sc1
s_waitcnt vmcnt(2)
v_max3_u32 v124,v120,v121,v122
v_max_u32 v124,v124,v123
v_cmp_eq_u32 vcc,-1,v124
s_cbranch_vccz dcp_100466
buffer_load_dwordx4 v[120:123],v0,s[20:23],s97 offen offset:0 sc1
s_sub_u32 s90,s90,1
s_cmp_gt_i32 s90,0
s_cbranch_scc1 dlp_100463
s_branch dgo_100462
dcp_100465:
v_mov_b32 v32,v116
v_mov_b32 v33,v117
v_mov_b32 v34,v118
v_mov_b32 v35,v119
s_nop 1
s_branch dgo_100462
dcp_100466:
v_mov_b32 v32,v120
v_mov_b32 v33,v121
v_mov_b32 v34,v122
v_mov_b32 v35,v123
s_nop 1
dgo_100462:
v_smfmac_f32_16x16x64_bf16 v[96:99],v[32:35],v[144:151],v1
v_smfmac_f32_16x16x64_bf16 v[100:103],v[32:35],v[152:159],v1
dsk_100461:
s_bitcmp1_b32 s55,5
s_cbranch_scc0 dsk_100467
s_waitcnt vmcnt(2)
v_max3_u32 v124,v36,v37,v38
v_max_u32 v124,v124,v39
v_cmp_eq_u32 vcc,-1,v124
s_cbranch_vccz dgo_100468
s_nop 15
buffer_load_dwordx4 v[116:119],v0,s[20:23],s97 offen offset:1024 sc1
s_nop 15
buffer_load_dwordx4 v[120:123],v0,s[20:23],s97 offen offset:1024 sc1
dlp_100469:
s_waitcnt vmcnt(2)
v_max3_u32 v124,v36,v37,v38
v_max_u32 v124,v124,v39
v_cmp_eq_u32 vcc,-1,v124
s_cbranch_vccz dgo_100468
buffer_load_dwordx4 v[36:39],v0,s[20:23],s97 offen offset:1024 sc1
s_waitcnt vmcnt(2)
v_max3_u32 v124,v116,v117,v118
v_max_u32 v124,v124,v119
v_cmp_eq_u32 vcc,-1,v124
s_cbranch_vccz dcp_100471
buffer_load_dwordx4 v[116:119],v0,s[20:23],s97 offen offset:1024 sc1
s_waitcnt vmcnt(2)
v_max3_u32 v124,v120,v121,v122
v_max_u32 v124,v124,v123
v_cmp_eq_u32 vcc,-1,v124
s_cbranch_vccz dcp_100472
buffer_load_dwordx4 v[120:123],v0,s[20:23],s97 offen offset:1024 sc1
s_sub_u32 s90,s90,1
s_cmp_gt_i32 s90,0
s_cbranch_scc1 dlp_100469
s_branch dgo_100468
dcp_100471:
v_mov_b32 v36,v116
v_mov_b32 v37,v117
v_mov_b32 v38,v118
v_mov_b32 v39,v119
s_nop 1
s_branch dgo_100468
dcp_100472:
v_mov_b32 v36,v120
v_mov_b32 v37,v121
v_mov_b32 v38,v122
v_mov_b32 v39,v123
s_nop 1
dgo_100468:
v_smfmac_f32_16x16x64_bf16 v[96:99],v[36:39],v[160:167],v1
v_smfmac_f32_16x16x64_bf16 v[100:103],v[36:39],v[168:175],v1
dsk_100467:
s_bitcmp1_b32 s55,6
s_cbranch_scc0 dsk_100473
s_waitcnt vmcnt(2)
v_max3_u32 v124,v40,v41,v42
v_max_u32 v124,v124,v43
v_cmp_eq_u32 vcc,-1,v124
s_cbranch_vccz dgo_100474
s_nop 15
buffer_load_dwordx4 v[116:119],v0,s[20:23],s97 offen offset:2048 sc1
s_nop 15
buffer_load_dwordx4 v[120:123],v0,s[20:23],s97 offen offset:2048 sc1
dlp_100475:
s_waitcnt vmcnt(2)
v_max3_u32 v124,v40,v41,v42
v_max_u32 v124,v124,v43
v_cmp_eq_u32 vcc,-1,v124
s_cbranch_vccz dgo_100474
buffer_load_dwordx4 v[40:43],v0,s[20:23],s97 offen offset:2048 sc1
s_waitcnt vmcnt(2)
v_max3_u32 v124,v116,v117,v118
v_max_u32 v124,v124,v119
v_cmp_eq_u32 vcc,-1,v124
s_cbranch_vccz dcp_100477
buffer_load_dwordx4 v[116:119],v0,s[20:23],s97 offen offset:2048 sc1
s_waitcnt vmcnt(2)
v_max3_u32 v124,v120,v121,v122
v_max_u32 v124,v124,v123
v_cmp_eq_u32 vcc,-1,v124
s_cbranch_vccz dcp_100478
buffer_load_dwordx4 v[120:123],v0,s[20:23],s97 offen offset:2048 sc1
s_sub_u32 s90,s90,1
s_cmp_gt_i32 s90,0
s_cbranch_scc1 dlp_100475
s_branch dgo_100474
dcp_100477:
v_mov_b32 v40,v116
v_mov_b32 v41,v117
v_mov_b32 v42,v118
v_mov_b32 v43,v119
s_nop 1
s_branch dgo_100474
dcp_100478:
v_mov_b32 v40,v120
v_mov_b32 v41,v121
v_mov_b32 v42,v122
v_mov_b32 v43,v123
s_nop 1
dgo_100474:
v_smfmac_f32_16x16x64_bf16 v[96:99],v[40:43],v[176:183],v1
v_smfmac_f32_16x16x64_bf16 v[100:103],v[40:43],v[184:191],v1
dsk_100473:
s_bitcmp1_b32 s55,7
s_cbranch_scc0 dsk_100479
s_waitcnt vmcnt(2)
v_max3_u32 v124,v44,v45,v46
v_max_u32 v124,v124,v47
v_cmp_eq_u32 vcc,-1,v124
s_cbranch_vccz dgo_100480
s_nop 15
buffer_load_dwordx4 v[116:119],v0,s[20:23],s97 offen offset:3072 sc1
s_nop 15
buffer_load_dwordx4 v[120:123],v0,s[20:23],s97 offen offset:3072 sc1
dlp_100481:
s_waitcnt vmcnt(2)
v_max3_u32 v124,v44,v45,v46
v_max_u32 v124,v124,v47
v_cmp_eq_u32 vcc,-1,v124
s_cbranch_vccz dgo_100480
buffer_load_dwordx4 v[44:47],v0,s[20:23],s97 offen offset:3072 sc1
s_waitcnt vmcnt(2)
v_max3_u32 v124,v116,v117,v118
v_max_u32 v124,v124,v119
v_cmp_eq_u32 vcc,-1,v124
s_cbranch_vccz dcp_100483
buffer_load_dwordx4 v[116:119],v0,s[20:23],s97 offen offset:3072 sc1
s_waitcnt vmcnt(2)
v_max3_u32 v124,v120,v121,v122
v_max_u32 v124,v124,v123
v_cmp_eq_u32 vcc,-1,v124
s_cbranch_vccz dcp_100484
buffer_load_dwordx4 v[120:123],v0,s[20:23],s97 offen offset:3072 sc1
s_sub_u32 s90,s90,1
s_cmp_gt_i32 s90,0
s_cbranch_scc1 dlp_100481
s_branch dgo_100480
dcp_100483:
v_mov_b32 v44,v116
v_mov_b32 v45,v117
v_mov_b32 v46,v118
v_mov_b32 v47,v119
s_nop 1
s_branch dgo_100480
dcp_100484:
v_mov_b32 v44,v120
v_mov_b32 v45,v121
v_mov_b32 v46,v122
v_mov_b32 v47,v123
s_nop 1
dgo_100480:
v_smfmac_f32_16x16x64_bf16 v[96:99],v[44:47],v[192:199],v1
v_smfmac_f32_16x16x64_bf16 v[100:103],v[44:47],v[200:207],v1
dsk_100479:
s_mov_b32 s55,0
s_branch oback_100259
fl_100276:
flb_100284:
buffer_load_dwordx4 v[16:19],v0,s[20:23],s92 offen offset:0 sc1
s_mov_b32 s55,1
buffer_load_dwordx4 v[32:35],v0,s[20:23],s93 offen offset:0 sc1
s_waitcnt vmcnt(4)
v_max3_u32 v124,v20,v21,v22
v_max_u32 v124,v124,v23
v_cmp_eq_u32 vcc,-1,v124
s_cbranch_vccnz dfl_100485
v_smfmac_f32_16x16x64_bf16 v[64:67],v[20:23],a[96:103],v1
buffer_load_dword v125,off,s[20:23],s92 sc1
buffer_load_dwordx4 v[36:39],v0,s[20:23],s93 offen offset:1024 sc1
s_waitcnt vmcnt(5)
v_max3_u32 v124,v24,v25,v26
v_smfmac_f32_16x16x64_bf16 v[68:71],v[20:23],a[104:111],v1
v_max_u32 v124,v124,v27
v_cmp_eq_u32 vcc,-1,v124
v_smfmac_f32_16x16x64_bf16 v[72:75],v[20:23],a[112:119],v1
v_smfmac_f32_16x16x64_bf16 v[76:79],v[20:23],a[120:127],v1
s_cbranch_vccnz dfl_100486
v_smfmac_f32_16x16x64_bf16 v[64:67],v[24:27],a[160:167],v1
buffer_load_dword v125,off,s[20:23],s92 sc1
buffer_load_dwordx4 v[40:43],v0,s[20:23],s93 offen offset:2048 sc1
buffer_load_dwordx4 v[44:47],v0,s[20:23],s93 offen offset:3072 sc1
s_waitcnt vmcnt(7)
v_max3_u32 v124,v28,v29,v30
v_smfmac_f32_16x16x64_bf16 v[68:71],v[24:27],a[168:175],v1
v_max_u32 v124,v124,v31
v_cmp_eq_u32 vcc,-1,v124
v_smfmac_f32_16x16x64_bf16 v[72:75],v[24:27],a[176:183],v1
v_smfmac_f32_16x16x64_bf16 v[76:79],v[24:27],a[184:191],v1
s_cbranch_vccnz dfl_100487
v_smfmac_f32_16x16x64_bf16 v[64:67],v[28:31],a[224:231],v1
buffer_load_dword v125,off,s[20:23],s92 sc1
s_waitcnt vmcnt(7)
v_max3_u32 v124,v16,v17,v18
v_smfmac_f32_16x16x64_bf16 v[68:71],v[28:31],a[232:239],v1
v_max_u32 v124,v124,v19
v_cmp_eq_u32 vcc,-1,v124
v_smfmac_f32_16x16x64_bf16 v[72:75],v[28:31],a[240:247],v1
v_smfmac_f32_16x16x64_bf16 v[76:79],v[28:31],a[248:255],v1
s_cbranch_vccnz lfb_100492
s_mov_b32 s55,0
v_smfmac_f32_16x16x64_bf16 v[64:67],v[16:19],a[32:39],v1
s_waitcnt vmcnt(6)
v_max3_u32 v124,v32,v33,v34
v_max_u32 v124,v124,v35
v_cmp_eq_u32 vcc,-1,v124
v_smfmac_f32_16x16x64_bf16 v[68:71],v[16:19],a[40:47],v1
v_smfmac_f32_16x16x64_bf16 v[72:75],v[16:19],a[48:55],v1
v_smfmac_f32_16x16x64_bf16 v[76:79],v[16:19],a[56:63],v1
s_cbranch_vccnz flb_100288
s_branch segb_100272
fl_100277:
flb_100285:
buffer_load_dwordx4 v[20:23],v0,s[20:23],s92 offen offset:1024 sc1
s_mov_b32 s55,2
buffer_load_dwordx4 v[36:39],v0,s[20:23],s93 offen offset:1024 sc1
s_waitcnt vmcnt(5)
v_max3_u32 v124,v24,v25,v26
v_max_u32 v124,v124,v27
v_cmp_eq_u32 vcc,-1,v124
s_cbranch_vccnz dfl_100486
v_smfmac_f32_16x16x64_bf16 v[64:67],v[24:27],a[160:167],v1
buffer_load_dword v125,off,s[20:23],s92 sc1
buffer_load_dwordx4 v[40:43],v0,s[20:23],s93 offen offset:2048 sc1
buffer_load_dwordx4 v[44:47],v0,s[20:23],s93 offen offset:3072 sc1
s_waitcnt vmcnt(7)
v_max3_u32 v124,v28,v29,v30
v_smfmac_f32_16x16x64_bf16 v[68:71],v[24:27],a[168:175],v1
v_max_u32 v124,v124,v31
v_cmp_eq_u32 vcc,-1,v124
v_smfmac_f32_16x16x64_bf16 v[72:75],v[24:27],a[176:183],v1
v_smfmac_f32_16x16x64_bf16 v[76:79],v[24:27],a[184:191],v1
s_cbranch_vccnz dfl_100487
v_smfmac_f32_16x16x64_bf16 v[64:67],v[28:31],a[224:231],v1
buffer_load_dword v125,off,s[20:23],s92 sc1
s_waitcnt vmcnt(5)
v_max3_u32 v124,v20,v21,v22
v_smfmac_f32_16x16x64_bf16 v[68:71],v[28:31],a[232:239],v1
v_max_u32 v124,v124,v23
v_cmp_eq_u32 vcc,-1,v124
v_smfmac_f32_16x16x64_bf16 v[72:75],v[28:31],a[240:247],v1
v_smfmac_f32_16x16x64_bf16 v[76:79],v[28:31],a[248:255],v1
s_cbranch_vccnz lfb_100492
s_mov_b32 s55,0
v_smfmac_f32_16x16x64_bf16 v[64:67],v[20:23],a[96:103],v1
s_waitcnt vmcnt(6)
v_max3_u32 v124,v32,v33,v34
v_max_u32 v124,v124,v35
v_cmp_eq_u32 vcc,-1,v124
v_smfmac_f32_16x16x64_bf16 v[68:71],v[20:23],a[104:111],v1
v_smfmac_f32_16x16x64_bf16 v[72:75],v[20:23],a[112:119],v1
v_smfmac_f32_16x16x64_bf16 v[76:79],v[20:23],a[120:127],v1
s_cbranch_vccnz flb_100288
s_branch segb_100272
fl_100278:
flb_100286:
buffer_load_dwordx4 v[24:27],v0,s[20:23],s92 offen offset:2048 sc1
s_mov_b32 s55,4
buffer_load_dwordx4 v[40:43],v0,s[20:23],s93 offen offset:2048 sc1
buffer_load_dwordx4 v[44:47],v0,s[20:23],s93 offen offset:3072 sc1
s_waitcnt vmcnt(7)
v_max3_u32 v124,v28,v29,v30
v_max_u32 v124,v124,v31
v_cmp_eq_u32 vcc,-1,v124
s_cbranch_vccnz dfl_100487
v_smfmac_f32_16x16x64_bf16 v[64:67],v[28:31],a[224:231],v1
buffer_load_dword v125,off,s[20:23],s92 sc1
s_waitcnt vmcnt(3)
v_max3_u32 v124,v24,v25,v26
v_smfmac_f32_16x16x64_bf16 v[68:71],v[28:31],a[232:239],v1
v_max_u32 v124,v124,v27
v_cmp_eq_u32 vcc,-1,v124
v_smfmac_f32_16x16x64_bf16 v[72:75],v[28:31],a[240:247],v1
v_smfmac_f32_16x16x64_bf16 v[76:79],v[28:31],a[248:255],v1
s_cbranch_vccnz lfb_100492
s_mov_b32 s55,0
v_smfmac_f32_16x16x64_bf16 v[64:67],v[24:27],a[160:167],v1
s_waitcnt vmcnt(6)
v_max3_u32 v124,v32,v33,v34
v_max_u32 v124,v124,v35
v_cmp_eq_u32 vcc,-1,v124
v_smfmac_f32_16x16x64_bf16 v[68:71],v[24:27],a[168:175],v1
v_smfmac_f32_16x16x64_bf16 v[72:75],v[24:27],a[176:183],v1
v_smfmac_f32_16x16x64_bf16 v[76:79],v[24:27],a[184:191],v1
s_cbranch_vccnz flb_100288
s_branch segb_100272
fl_100279:
flb_100287:
buffer_load_dwordx4 v[28:31],v0,s[20:23],s92 offen offset:3072 sc1
s_mov_b32 s55,8
s_waitcnt vmcnt(0)
v_max3_u32 v124,v28,v29,v30
v_max_u32 v124,v124,v31
v_cmp_eq_u32 vcc,-1,v124
s_cbranch_vccnz lfb_100492
s_mov_b32 s55,0
v_smfmac_f32_16x16x64_bf16 v[64:67],v[28:31],a[224:231],v1
s_waitcnt vmcnt(6)
v_max3_u32 v124,v32,v33,v34
v_max_u32 v124,v124,v35
v_cmp_eq_u32 vcc,-1,v124
v_smfmac_f32_16x16x64_bf16 v[68:71],v[28:31],a[232:239],v1
v_smfmac_f32_16x16x64_bf16 v[72:75],v[28:31],a[240:247],v1
v_smfmac_f32_16x16x64_bf16 v[76:79],v[28:31],a[248:255],v1
s_cbranch_vccnz flb_100288
s_branch segb_100272
fl_100280:
flb_100288:
buffer_load_dwordx4 v[32:35],v0,s[20:23],s93 offen offset:0 sc1
s_mov_b32 s55,240
buffer_store_dwordx4 v[112:115],v120,s[20:23],s101 offen sc1
buffer_store_dword v126,v121,s[20:23],s69 offen sc1
s_bitcmp1_b32 s55,5
s_cbranch_scc0 rdn_100495
s_waitcnt vmcnt(7)
v_max3_u32 v124,v36,v37,v38
v_max_u32 v124,v124,v39
v_cmp_eq_u32 vcc,-1,v124
s_cbranch_vccnz rfa_100496
buffer_load_dword v125,off,s[20:23],s92 sc1
s_bitset0_b32 s55,5
v_smfmac_f32_16x16x64_bf16 v[64:67],v[36:39],a[96:103],v1
v_smfmac_f32_16x16x64_bf16 v[68:71],v[36:39],a[104:111],v1
v_smfmac_f32_16x16x64_bf16 v[72:75],v[36:39],a[112:119],v1
v_smfmac_f32_16x16x64_bf16 v[76:79],v[36:39],a[120:127],v1
s_cmp_eq_u32 s55,0
s_cbranch_scc1 segb_100274
s_branch rnx_100497
rdn_100495:
buffer_load_dword v125,off,s[20:23],s92 sc1
s_branch rnx_100497
rfa_100496:
buffer_load_dwordx4 v[36:39],v0,s[20:23],s93 offen offset:1024 sc1
rnx_100497:
s_bitcmp1_b32 s55,6
s_cbranch_scc0 rdn_100498
s_waitcnt vmcnt(6)
v_max3_u32 v124,v40,v41,v42
v_max_u32 v124,v124,v43
v_cmp_eq_u32 vcc,-1,v124
s_cbranch_vccnz rfa_100499
buffer_load_dword v125,off,s[20:23],s92 sc1
s_bitset0_b32 s55,6
s_cmp_eq_u32 s55,0
s_cbranch_scc1 segb_100274
s_branch rnx_100500
rdn_100498:
buffer_load_dword v125,off,s[20:23],s92 sc1
s_branch rnx_100500
rfa_100499:
buffer_load_dwordx4 v[40:43],v0,s[20:23],s93 offen offset:2048 sc1
rnx_100500:
s_bitcmp1_b32 s55,7
s_cbranch_scc0 rdn_100501
s_waitcnt vmcnt(6)
v_max3_u32 v124,v44,v45,v46
v_max_u32 v124,v124,v47
v_cmp_eq_u32 vcc,-1,v124
s_cbranch_vccnz rfa_100502
buffer_load_dword v125,off,s[20:23],s92 sc1
s_bitset0_b32 s55,7
s_cmp_eq_u32 s55,0
s_cbranch_scc1 segb_100274
s_branch rnx_100503
rdn_100501:
buffer_load_dword v125,off,s[20:23],s92 sc1
s_branch rnx_100503
rfa_100502:
buffer_load_dwordx4 v[44:47],v0,s[20:23],s93 offen offset:3072 sc1
rnx_100503:
rot_100494:
s_bitcmp1_b32 s55,4
s_cbranch_scc0 rdn_100504
s_waitcnt vmcnt(3)
v_max3_u32 v124,v32,v33,v34
v_max_u32 v124,v124,v35
v_cmp_eq_u32 vcc,-1,v124
s_cbranch_vccnz rfa_100505
buffer_load_dword v125,off,s[20:23],s92 sc1
s_bitset0_b32 s55,4
v_smfmac_f32_16x16x64_bf16 v[64:67],v[32:35],a[32:39],v1
v_smfmac_f32_16x16x64_bf16 v[68:71],v[32:35],a[40:47],v1
v_smfmac_f32_16x16x64_bf16 v[72:75],v[32:35],a[48:55],v1
v_smfmac_f32_16x16x64_bf16 v[76:79],v[32:35],a[56:63],v1
s_cmp_eq_u32 s55,0
s_cbranch_scc1 segb_100274
s_branch rnx_100506
rdn_100504:
buffer_load_dword v125,off,s[20:23],s92 sc1
s_branch rnx_100506
rfa_100505:
buffer_load_dwordx4 v[32:35],v0,s[20:23],s93 offen offset:0 sc1
rnx_100506:
s_bitcmp1_b32 s55,5
s_cbranch_scc0 rdn_100507
s_waitcnt vmcnt(3)
v_max3_u32 v124,v36,v37,v38
v_max_u32 v124,v124,v39
v_cmp_eq_u32 vcc,-1,v124
s_cbranch_vccnz rfa_100508
buffer_load_dword v125,off,s[20:23],s92 sc1
s_bitset0_b32 s55,5
v_smfmac_f32_16x16x64_bf16 v[64:67],v[36:39],a[96:103],v1
v_smfmac_f32_16x16x64_bf16 v[68:71],v[36:39],a[104:111],v1
v_smfmac_f32_16x16x64_bf16 v[72:75],v[36:39],a[112:119],v1
v_smfmac_f32_16x16x64_bf16 v[76:79],v[36:39],a[120:127],v1
s_cmp_eq_u32 s55,0
s_cbranch_scc1 segb_100274
s_branch rnx_100509
rdn_100507:
buffer_load_dword v125,off,s[20:23],s92 sc1
s_branch rnx_100509
rfa_100508:
buffer_load_dwordx4 v[36:39],v0,s[20:23],s93 offen offset:1024 sc1
rnx_100509:
s_bitcmp1_b32 s55,6
s_cbranch_scc0 rdn_100510
s_waitcnt vmcnt(3)
v_max3_u32 v124,v40,v41,v42
v_max_u32 v124,v124,v43
v_cmp_eq_u32 vcc,-1,v124
s_cbranch_vccnz rfa_100511
buffer_load_dword v125,off,s[20:23],s92 sc1
s_bitset0_b32 s55,6
s_cmp_eq_u32 s55,0
s_cbranch_scc1 segb_100274
s_branch rnx_100512
rdn_100510:
buffer_load_dword v125,off,s[20:23],s92 sc1
s_branch rnx_100512
rfa_100511:
buffer_load_dwordx4 v[40:43],v0,s[20:23],s93 offen offset:2048 sc1
rnx_100512:
s_bitcmp1_b32 s55,7
s_cbranch_scc0 rdn_100513
s_waitcnt vmcnt(3)
v_max3_u32 v124,v44,v45,v46
v_max_u32 v124,v124,v47
v_cmp_eq_u32 vcc,-1,v124
s_cbranch_vccnz rfa_100514
buffer_load_dword v125,off,s[20:23],s92 sc1
s_bitset0_b32 s55,7
s_cmp_eq_u32 s55,0
s_cbranch_scc1 segb_100274
s_branch rnx_100515
rdn_100513:
buffer_load_dword v125,off,s[20:23],s92 sc1
s_branch rnx_100515
rfa_100514:
buffer_load_dwordx4 v[44:47],v0,s[20:23],s93 offen offset:3072 sc1
rnx_100515:
s_sub_u32 s90,s90,1
s_cmp_gt_i32 s90,0
s_cbranch_scc1 rot_100494
s_mov_b32 s55,0
s_branch segb_100274
fl_100281:
flb_100289:
buffer_load_dwordx4 v[36:39],v0,s[20:23],s93 offen offset:1024 sc1
s_mov_b32 s55,224
s_bitcmp1_b32 s55,6
s_cbranch_scc0 rdn_100517
s_waitcnt vmcnt(6)
v_max3_u32 v124,v40,v41,v42
v_max_u32 v124,v124,v43
v_cmp_eq_u32 vcc,-1,v124
s_cbranch_vccnz rfa_100518
buffer_load_dword v125,off,s[20:23],s92 sc1
s_bitset0_b32 s55,6
s_cmp_eq_u32 s55,0
s_cbranch_scc1 segb_100274
s_branch rnx_100519
rdn_100517:
buffer_load_dword v125,off,s[20:23],s92 sc1
s_branch rnx_100519
rfa_100518:
buffer_load_dwordx4 v[40:43],v0,s[20:23],s93 offen offset:2048 sc1
rnx_100519:
s_bitcmp1_b32 s55,7
s_cbranch_scc0 rdn_100520
s_waitcnt vmcnt(6)
v_max3_u32 v124,v44,v45,v46
v_max_u32 v124,v124,v47
v_cmp_eq_u32 vcc,-1,v124
s_cbranch_vccnz rfa_100521
buffer_load_dword v125,off,s[20:23],s92 sc1
s_bitset0_b32 s55,7
s_cmp_eq_u32 s55,0
s_cbranch_scc1 segb_100274
s_branch rnx_100522
rdn_100520:
buffer_load_dword v125,off,s[20:23],s92 sc1
s_branch rnx_100522
rfa_100521:
buffer_load_dwordx4 v[44:47],v0,s[20:23],s93 offen offset:3072 sc1
rnx_100522:
rot_100516:
s_bitcmp1_b32 s55,5
s_cbranch_scc0 rdn_100523
s_waitcnt vmcnt(2)
v_max3_u32 v124,v36,v37,v38
v_max_u32 v124,v124,v39
v_cmp_eq_u32 vcc,-1,v124
s_cbranch_vccnz rfa_100524
buffer_load_dword v125,off,s[20:23],s92 sc1
s_bitset0_b32 s55,5
v_smfmac_f32_16x16x64_bf16 v[64:67],v[36:39],a[96:103],v1
v_smfmac_f32_16x16x64_bf16 v[68:71],v[36:39],a[104:111],v1
v_smfmac_f32_16x16x64_bf16 v[72:75],v[36:39],a[112:119],v1
v_smfmac_f32_16x16x64_bf16 v[76:79],v[36:39],a[120:127],v1
s_cmp_eq_u32 s55,0
s_cbranch_scc1 segb_100274
s_branch rnx_100525
rdn_100523:
buffer_load_dword v125,off,s[20:23],s92 sc1
s_branch rnx_100525
rfa_100524:
buffer_load_dwordx4 v[36:39],v0,s[20:23],s93 offen offset:1024 sc1
rnx_100525:
s_bitcmp1_b32 s55,6
s_cbranch_scc0 rdn_100526
s_waitcnt vmcnt(2)
v_max3_u32 v124,v40,v41,v42
v_max_u32 v124,v124,v43
v_cmp_eq_u32 vcc,-1,v124
s_cbranch_vccnz rfa_100527
buffer_load_dword v125,off,s[20:23],s92 sc1
s_bitset0_b32 s55,6
s_cmp_eq_u32 s55,0
s_cbranch_scc1 segb_100274
s_branch rnx_100528
rdn_100526:
buffer_load_dword v125,off,s[20:23],s92 sc1
s_branch rnx_100528
rfa_100527:
buffer_load_dwordx4 v[40:43],v0,s[20:23],s93 offen offset:2048 sc1
rnx_100528:
s_bitcmp1_b32 s55,7
s_cbranch_scc0 rdn_100529
s_waitcnt vmcnt(2)
v_max3_u32 v124,v44,v45,v46
v_max_u32 v124,v124,v47
v_cmp_eq_u32 vcc,-1,v124
s_cbranch_vccnz rfa_100530
buffer_load_dword v125,off,s[20:23],s92 sc1
s_bitset0_b32 s55,7
s_cmp_eq_u32 s55,0
s_cbranch_scc1 segb_100274
s_branch rnx_100531
rdn_100529:
buffer_load_dword v125,off,s[20:23],s92 sc1
s_branch rnx_100531
rfa_100530:
buffer_load_dwordx4 v[44:47],v0,s[20:23],s93 offen offset:3072 sc1
rnx_100531:
s_sub_u32 s90,s90,1
s_cmp_gt_i32 s90,0
s_cbranch_scc1 rot_100516
s_mov_b32 s55,0
s_branch segb_100274
fl_100282:
flb_100290:
s_mov_b32 s55,192
s_bitcmp1_b32 s55,6
s_cbranch_scc0 rdn_100533
s_waitcnt vmcnt(6)
v_max3_u32 v124,v40,v41,v42
v_max_u32 v124,v124,v43
v_cmp_eq_u32 vcc,-1,v124
s_cbranch_vccnz rfa_100534
buffer_load_dword v125,off,s[20:23],s92 sc1
s_bitset0_b32 s55,6
s_cmp_eq_u32 s55,0
s_cbranch_scc1 segb_100274
s_branch rnx_100535
rdn_100533:
buffer_load_dword v125,off,s[20:23],s92 sc1
s_branch rnx_100535
rfa_100534:
buffer_load_dwordx4 v[40:43],v0,s[20:23],s93 offen offset:2048 sc1
rnx_100535:
s_bitcmp1_b32 s55,7
s_cbranch_scc0 rdn_100536
s_waitcnt vmcnt(6)
v_max3_u32 v124,v44,v45,v46
v_max_u32 v124,v124,v47
v_cmp_eq_u32 vcc,-1,v124
s_cbranch_vccnz rfa_100537
buffer_load_dword v125,off,s[20:23],s92 sc1
s_bitset0_b32 s55,7
s_cmp_eq_u32 s55,0
s_cbranch_scc1 segb_100274
s_branch rnx_100538
rdn_100536:
buffer_load_dword v125,off,s[20:23],s92 sc1
s_branch rnx_100538
rfa_100537:
buffer_load_dwordx4 v[44:47],v0,s[20:23],s93 offen offset:3072 sc1
rnx_100538:
rot_100532:
s_bitcmp1_b32 s55,6
s_cbranch_scc0 rdn_100539
s_waitcnt vmcnt(1)
v_max3_u32 v124,v40,v41,v42
v_max_u32 v124,v124,v43
v_cmp_eq_u32 vcc,-1,v124
s_cbranch_vccnz rfa_100540
buffer_load_dword v125,off,s[20:23],s92 sc1
s_bitset0_b32 s55,6
s_cmp_eq_u32 s55,0
s_cbranch_scc1 segb_100274
s_branch rnx_100541
rdn_100539:
buffer_load_dword v125,off,s[20:23],s92 sc1
s_branch rnx_100541
rfa_100540:
buffer_load_dwordx4 v[40:43],v0,s[20:23],s93 offen offset:2048 sc1
rnx_100541:
s_bitcmp1_b32 s55,7
s_cbranch_scc0 rdn_100542
s_waitcnt vmcnt(1)
v_max3_u32 v124,v44,v45,v46
v_max_u32 v124,v124,v47
v_cmp_eq_u32 vcc,-1,v124
s_cbranch_vccnz rfa_100543
buffer_load_dword v125,off,s[20:23],s92 sc1
s_bitset0_b32 s55,7
s_cmp_eq_u32 s55,0
s_cbranch_scc1 segb_100274
s_branch rnx_100544
rdn_100542:
buffer_load_dword v125,off,s[20:23],s92 sc1
s_branch rnx_100544
rfa_100543:
buffer_load_dwordx4 v[44:47],v0,s[20:23],s93 offen offset:3072 sc1
rnx_100544:
s_sub_u32 s90,s90,1
s_cmp_gt_i32 s90,0
s_cbranch_scc1 rot_100532
s_mov_b32 s55,0
s_branch segb_100274
dfl_100485:
buffer_load_dwordx4 v[20:23],v0,s[20:23],s92 offen offset:1024 sc1
s_bitset1_b32 s55,1
buffer_load_dwordx4 v[36:39],v0,s[20:23],s93 offen offset:1024 sc1
s_waitcnt vmcnt(5)
v_max3_u32 v124,v24,v25,v26
v_max_u32 v124,v124,v27
v_cmp_eq_u32 vcc,-1,v124
s_cbranch_vccnz dfl_100486
s_branch dseg_100489
dfl_100486:
buffer_load_dwordx4 v[24:27],v0,s[20:23],s92 offen offset:2048 sc1
s_bitset1_b32 s55,2
buffer_load_dwordx4 v[40:43],v0,s[20:23],s93 offen offset:2048 sc1
buffer_load_dwordx4 v[44:47],v0,s[20:23],s93 offen offset:3072 sc1
s_waitcnt vmcnt(7)
v_max3_u32 v124,v28,v29,v30
v_max_u32 v124,v124,v31
v_cmp_eq_u32 vcc,-1,v124
s_cbranch_vccnz dfl_100487
s_branch dseg_100490
dfl_100487:
buffer_load_dwordx4 v[28:31],v0,s[20:23],s92 offen offset:3072 sc1
s_bitset1_b32 s55,3
s_branch lap2_100491
dseg_100489:
v_smfmac_f32_16x16x64_bf16 v[64:67],v[24:27],a[160:167],v1
buffer_load_dword v125,off,s[20:23],s92 sc1
buffer_load_dwordx4 v[40:43],v0,s[20:23],s93 offen offset:2048 sc1
buffer_load_dwordx4 v[44:47],v0,s[20:23],s93 offen offset:3072 sc1
s_waitcnt vmcnt(7)
v_max3_u32 v124,v28,v29,v30
v_smfmac_f32_16x16x64_bf16 v[68:71],v[24:27],a[168:175],v1
v_max_u32 v124,v124,v31
v_cmp_eq_u32 vcc,-1,v124
v_smfmac_f32_16x16x64_bf16 v[72:75],v[24:27],a[176:183],v1
v_smfmac_f32_16x16x64_bf16 v[76:79],v[24:27],a[184:191],v1
s_cbranch_vccnz dfl_100487
dseg_100490:
v_smfmac_f32_16x16x64_bf16 v[64:67],v[28:31],a[224:231],v1
buffer_load_dword v125,off,s[20:23],s92 sc1
v_smfmac_f32_16x16x64_bf16 v[68:71],v[28:31],a[232:239],v1
v_smfmac_f32_16x16x64_bf16 v[72:75],v[28:31],a[240:247],v1
v_smfmac_f32_16x16x64_bf16 v[76:79],v[28:31],a[248:255],v1
lap2_100491:
s_bitcmp1_b32 s55,0
s_cbranch_scc0 l2s_100545
s_waitcnt vmcnt(7)
v_max3_u32 v124,v16,v17,v18
v_max_u32 v124,v124,v19
v_cmp_eq_u32 vcc,-1,v124
s_cbranch_vccnz l2s_100545
s_bitset0_b32 s55,0
v_smfmac_f32_16x16x64_bf16 v[64:67],v[16:19],a[32:39],v1
v_smfmac_f32_16x16x64_bf16 v[68:71],v[16:19],a[40:47],v1
v_smfmac_f32_16x16x64_bf16 v[72:75],v[16:19],a[48:55],v1
v_smfmac_f32_16x16x64_bf16 v[76:79],v[16:19],a[56:63],v1
l2s_100545:
s_bitcmp1_b32 s55,1
s_cbranch_scc0 l2s_100547
s_waitcnt vmcnt(5)
v_max3_u32 v124,v20,v21,v22
v_max_u32 v124,v124,v23
v_cmp_eq_u32 vcc,-1,v124
s_cbranch_vccnz l2s_100547
s_bitset0_b32 s55,1
v_smfmac_f32_16x16x64_bf16 v[64:67],v[20:23],a[96:103],v1
v_smfmac_f32_16x16x64_bf16 v[68:71],v[20:23],a[104:111],v1
v_smfmac_f32_16x16x64_bf16 v[72:75],v[20:23],a[112:119],v1
v_smfmac_f32_16x16x64_bf16 v[76:79],v[20:23],a[120:127],v1
l2s_100547:
s_bitcmp1_b32 s55,2
s_cbranch_scc0 l2s_100549
s_waitcnt vmcnt(3)
v_max3_u32 v124,v24,v25,v26
v_max_u32 v124,v124,v27
v_cmp_eq_u32 vcc,-1,v124
s_cbranch_vccnz l2s_100549
s_bitset0_b32 s55,2
v_smfmac_f32_16x16x64_bf16 v[64:67],v[24:27],a[160:167],v1
v_smfmac_f32_16x16x64_bf16 v[68:71],v[24:27],a[168:175],v1
v_smfmac_f32_16x16x64_bf16 v[72:75],v[24:27],a[176:183],v1
v_smfmac_f32_16x16x64_bf16 v[76:79],v[24:27],a[184:191],v1
l2s_100549:
s_bitcmp1_b32 s55,3
s_cbranch_scc0 l2s_100551
s_waitcnt vmcnt(0)
v_max3_u32 v124,v28,v29,v30
v_max_u32 v124,v124,v31
v_cmp_eq_u32 vcc,-1,v124
s_cbranch_vccnz l2s_100551
s_bitset0_b32 s55,3
v_smfmac_f32_16x16x64_bf16 v[64:67],v[28:31],a[224:231],v1
v_smfmac_f32_16x16x64_bf16 v[68:71],v[28:31],a[232:239],v1
v_smfmac_f32_16x16x64_bf16 v[72:75],v[28:31],a[240:247],v1
v_smfmac_f32_16x16x64_bf16 v[76:79],v[28:31],a[248:255],v1
l2s_100551:
s_cmp_eq_u32 s55,0
s_cbranch_scc0 lfb_100492
Ldone_100493:
s_waitcnt vmcnt(6)
v_max3_u32 v124,v32,v33,v34
v_max_u32 v124,v124,v35
v_cmp_eq_u32 vcc,-1,v124
s_cbranch_vccnz flb_100288
s_branch segb_100272
lfb_100492:
s_bitcmp1_b32 s55,0
s_cbranch_scc0 dsk_100553
buffer_load_dwordx4 v[16:19],v0,s[20:23],s92 offen offset:0 sc1
dsk_100553:
s_bitcmp1_b32 s55,1
s_cbranch_scc0 dsk_100554
buffer_load_dwordx4 v[20:23],v0,s[20:23],s92 offen offset:1024 sc1
dsk_100554:
s_bitcmp1_b32 s55,2
s_cbranch_scc0 dsk_100555
buffer_load_dwordx4 v[24:27],v0,s[20:23],s92 offen offset:2048 sc1
dsk_100555:
s_bitcmp1_b32 s55,3
s_cbranch_scc0 dsk_100556
buffer_load_dwordx4 v[28:31],v0,s[20:23],s92 offen offset:3072 sc1
dsk_100556:
s_bitcmp1_b32 s55,0
s_cbranch_scc0 dsk_100557
s_waitcnt vmcnt(2)
v_max3_u32 v124,v16,v17,v18
v_max_u32 v124,v124,v19
v_cmp_eq_u32 vcc,-1,v124
s_cbranch_vccz dgo_100558
s_nop 15
buffer_load_dwordx4 v[104:107],v0,s[20:23],s92 offen offset:0 sc1
s_nop 15
buffer_load_dwordx4 v[108:111],v0,s[20:23],s92 offen offset:0 sc1
dlp_100559:
s_waitcnt vmcnt(2)
v_max3_u32 v124,v16,v17,v18
v_max_u32 v124,v124,v19
v_cmp_eq_u32 vcc,-1,v124
s_cbranch_vccz dgo_100558
buffer_load_dwordx4 v[16:19],v0,s[20:23],s92 offen offset:0 sc1
s_waitcnt vmcnt(2)
v_max3_u32 v124,v104,v105,v106
v_max_u32 v124,v124,v107
v_cmp_eq_u32 vcc,-1,v124
s_cbranch_vccz dcp_100561
buffer_load_dwordx4 v[104:107],v0,s[20:23],s92 offen offset:0 sc1
s_waitcnt vmcnt(2)
v_max3_u32 v124,v108,v109,v110
v_max_u32 v124,v124,v111
v_cmp_eq_u32 vcc,-1,v124
s_cbranch_vccz dcp_100562
buffer_load_dwordx4 v[108:111],v0,s[20:23],s92 offen offset:0 sc1
s_sub_u32 s90,s90,1
s_cmp_gt_i32 s90,0
s_cbranch_scc1 dlp_100559
s_branch dgo_100558
dcp_100561:
v_mov_b32 v16,v104
v_mov_b32 v17,v105
v_mov_b32 v18,v106
v_mov_b32 v19,v107
s_nop 1
s_branch dgo_100558
dcp_100562:
v_mov_b32 v16,v108
v_mov_b32 v17,v109
v_mov_b32 v18,v110
v_mov_b32 v19,v111
s_nop 1
dgo_100558:
v_smfmac_f32_16x16x64_bf16 v[64:67],v[16:19],a[32:39],v1
v_smfmac_f32_16x16x64_bf16 v[68:71],v[16:19],a[40:47],v1
v_smfmac_f32_16x16x64_bf16 v[72:75],v[16:19],a[48:55],v1
v_smfmac_f32_16x16x64_bf16 v[76:79],v[16:19],a[56:63],v1
dsk_100557:
s_bitcmp1_b32 s55,1
s_cbranch_scc0 dsk_100563
s_waitcnt vmcnt(2)
v_max3_u32 v124,v20,v21,v22
v_max_u32 v124,v124,v23
v_cmp_eq_u32 vcc,-1,v124
s_cbranch_vccz dgo_100564
s_nop 15
buffer_load_dwordx4 v[104:107],v0,s[20:23],s92 offen offset:1024 sc1
s_nop 15
buffer_load_dwordx4 v[108:111],v0,s[20:23],s92 offen offset:1024 sc1
dlp_100565:
s_waitcnt vmcnt(2)
v_max3_u32 v124,v20,v21,v22
v_max_u32 v124,v124,v23
v_cmp_eq_u32 vcc,-1,v124
s_cbranch_vccz dgo_100564
buffer_load_dwordx4 v[20:23],v0,s[20:23],s92 offen offset:1024 sc1
s_waitcnt vmcnt(2)
v_max3_u32 v124,v104,v105,v106
v_max_u32 v124,v124,v107
v_cmp_eq_u32 vcc,-1,v124
s_cbranch_vccz dcp_100567
buffer_load_dwordx4 v[104:107],v0,s[20:23],s92 offen offset:1024 sc1
s_waitcnt vmcnt(2)
v_max3_u32 v124,v108,v109,v110
v_max_u32 v124,v124,v111
v_cmp_eq_u32 vcc,-1,v124
s_cbranch_vccz dcp_100568
buffer_load_dwordx4 v[108:111],v0,s[20:23],s92 offen offset:1024 sc1
s_sub_u32 s90,s90,1
s_cmp_gt_i32 s90,0
s_cbranch_scc1 dlp_100565
s_branch dgo_100564
dcp_100567:
v_mov_b32 v20,v104
v_mov_b32 v21,v105
v_mov_b32 v22,v106
v_mov_b32 v23,v107
s_nop 1
s_branch dgo_100564
dcp_100568:
v_mov_b32 v20,v108
v_mov_b32 v21,v109
v_mov_b32 v22,v110
v_mov_b32 v23,v111
s_nop 1
dgo_100564:
v_smfmac_f32_16x16x64_bf16 v[64:67],v[20:23],a[96:103],v1
v_smfmac_f32_16x16x64_bf16 v[68:71],v[20:23],a[104:111],v1
v_smfmac_f32_16x16x64_bf16 v[72:75],v[20:23],a[112:119],v1
v_smfmac_f32_16x16x64_bf16 v[76:79],v[20:23],a[120:127],v1
dsk_100563:
s_bitcmp1_b32 s55,2
s_cbranch_scc0 dsk_100569
s_waitcnt vmcnt(2)
v_max3_u32 v124,v24,v25,v26
v_max_u32 v124,v124,v27
v_cmp_eq_u32 vcc,-1,v124
s_cbranch_vccz dgo_100570
s_nop 15
buffer_load_dwordx4 v[104:107],v0,s[20:23],s92 offen offset:2048 sc1
s_nop 15
buffer_load_dwordx4 v[108:111],v0,s[20:23],s92 offen offset:2048 sc1
dlp_100571:
s_waitcnt vmcnt(2)
v_max3_u32 v124,v24,v25,v26
v_max_u32 v124,v124,v27
v_cmp_eq_u32 vcc,-1,v124
s_cbranch_vccz dgo_100570
buffer_load_dwordx4 v[24:27],v0,s[20:23],s92 offen offset:2048 sc1
s_waitcnt vmcnt(2)
v_max3_u32 v124,v104,v105,v106
v_max_u32 v124,v124,v107
v_cmp_eq_u32 vcc,-1,v124
s_cbranch_vccz dcp_100573
buffer_load_dwordx4 v[104:107],v0,s[20:23],s92 offen offset:2048 sc1
s_waitcnt vmcnt(2)
v_max3_u32 v124,v108,v109,v110
v_max_u32 v124,v124,v111
v_cmp_eq_u32 vcc,-1,v124
s_cbranch_vccz dcp_100574
buffer_load_dwordx4 v[108:111],v0,s[20:23],s92 offen offset:2048 sc1
s_sub_u32 s90,s90,1
s_cmp_gt_i32 s90,0
s_cbranch_scc1 dlp_100571
s_branch dgo_100570
dcp_100573:
v_mov_b32 v24,v104
v_mov_b32 v25,v105
v_mov_b32 v26,v106
v_mov_b32 v27,v107
s_nop 1
s_branch dgo_100570
dcp_100574:
v_mov_b32 v24,v108
v_mov_b32 v25,v109
v_mov_b32 v26,v110
v_mov_b32 v27,v111
s_nop 1
dgo_100570:
v_smfmac_f32_16x16x64_bf16 v[64:67],v[24:27],a[160:167],v1
v_smfmac_f32_16x16x64_bf16 v[68:71],v[24:27],a[168:175],v1
v_smfmac_f32_16x16x64_bf16 v[72:75],v[24:27],a[176:183],v1
v_smfmac_f32_16x16x64_bf16 v[76:79],v[24:27],a[184:191],v1
dsk_100569:
s_bitcmp1_b32 s55,3
s_cbranch_scc0 dsk_100575
s_waitcnt vmcnt(2)
v_max3_u32 v124,v28,v29,v30
v_max_u32 v124,v124,v31
v_cmp_eq_u32 vcc,-1,v124
s_cbranch_vccz dgo_100576
s_nop 15
buffer_load_dwordx4 v[104:107],v0,s[20:23],s92 offen offset:3072 sc1
s_nop 15
buffer_load_dwordx4 v[108:111],v0,s[20:23],s92 offen offset:3072 sc1
dlp_100577:
s_waitcnt vmcnt(2)
v_max3_u32 v124,v28,v29,v30
v_max_u32 v124,v124,v31
v_cmp_eq_u32 vcc,-1,v124
s_cbranch_vccz dgo_100576
buffer_load_dwordx4 v[28:31],v0,s[20:23],s92 offen offset:3072 sc1
s_waitcnt vmcnt(2)
v_max3_u32 v124,v104,v105,v106
v_max_u32 v124,v124,v107
v_cmp_eq_u32 vcc,-1,v124
s_cbranch_vccz dcp_100579
buffer_load_dwordx4 v[104:107],v0,s[20:23],s92 offen offset:3072 sc1
s_waitcnt vmcnt(2)
v_max3_u32 v124,v108,v109,v110
v_max_u32 v124,v124,v111
v_cmp_eq_u32 vcc,-1,v124
s_cbranch_vccz dcp_100580
buffer_load_dwordx4 v[108:111],v0,s[20:23],s92 offen offset:3072 sc1
s_sub_u32 s90,s90,1
s_cmp_gt_i32 s90,0
s_cbranch_scc1 dlp_100577
s_branch dgo_100576
dcp_100579:
v_mov_b32 v28,v104
v_mov_b32 v29,v105
v_mov_b32 v30,v106
v_mov_b32 v31,v107
s_nop 1
s_branch dgo_100576
dcp_100580:
v_mov_b32 v28,v108
v_mov_b32 v29,v109
v_mov_b32 v30,v110
v_mov_b32 v31,v111
s_nop 1
dgo_100576:
v_smfmac_f32_16x16x64_bf16 v[64:67],v[28:31],a[224:231],v1
v_smfmac_f32_16x16x64_bf16 v[68:71],v[28:31],a[232:239],v1
v_smfmac_f32_16x16x64_bf16 v[72:75],v[28:31],a[240:247],v1
v_smfmac_f32_16x16x64_bf16 v[76:79],v[28:31],a[248:255],v1
dsk_100575:
s_mov_b32 s55,0
s_branch Ldone_100493
slowA_100292:
buffer_load_dwordx4 v[44:47],v0,s[20:23],s93 offen offset:3072 sc1
dsk_100581:
s_bitcmp1_b32 s55,7
s_cbranch_scc0 dsk_100582
s_waitcnt vmcnt(2)
v_max3_u32 v124,v44,v45,v46
v_max_u32 v124,v124,v47
v_cmp_eq_u32 vcc,-1,v124
s_cbranch_vccz dgo_100583
s_nop 15
s_nop 3
buffer_load_dwordx4 v[104:107],v0,s[20:23],s93 offen offset:3072 sc1
s_nop 15
s_nop 3
buffer_load_dwordx4 v[108:111],v0,s[20:23],s93 offen offset:3072 sc1
dlp_100584:
s_waitcnt vmcnt(2)
v_max3_u32 v124,v44,v45,v46
v_max_u32 v124,v124,v47
v_cmp_eq_u32 vcc,-1,v124
s_cbranch_vccz dgo_100583
buffer_load_dwordx4 v[44:47],v0,s[20:23],s93 offen offset:3072 sc1
s_waitcnt vmcnt(2)
v_max3_u32 v124,v104,v105,v106
v_max_u32 v124,v124,v107
v_cmp_eq_u32 vcc,-1,v124
s_cbranch_vccz dcp_100586
buffer_load_dwordx4 v[104:107],v0,s[20:23],s93 offen offset:3072 sc1
s_waitcnt vmcnt(2)
v_max3_u32 v124,v108,v109,v110
v_max_u32 v124,v124,v111
v_cmp_eq_u32 vcc,-1,v124
s_cbranch_vccz dcp_100587
buffer_load_dwordx4 v[108:111],v0,s[20:23],s93 offen offset:3072 sc1
s_sub_u32 s90,s90,1
s_cmp_gt_i32 s90,0
s_cbranch_scc1 dlp_100584
s_branch dgo_100583
dcp_100586:
v_mov_b32 v44,v104
v_mov_b32 v45,v105
v_mov_b32 v46,v106
v_mov_b32 v47,v107
s_nop 1
s_branch dgo_100583
dcp_100587:
v_mov_b32 v44,v108
v_mov_b32 v45,v109
v_mov_b32 v46,v110
v_mov_b32 v47,v111
s_nop 1
dgo_100583:
dsk_100582:
s_mov_b32 s55,0
s_branch segb_100274
recslow_100191:
s_mov_b32 s55,0
s_cmp_lg_u32 s50,0
s_cbranch_scc1 np0_100590
v_mov_b32 v120,0
v_mov_b32 v121,0
s_cmp_lg_u32 s58,0
s_cbranch_scc1 z1_100591
v_lshrrev_b32 v124,6,v127
v_lshlrev_b32 v124,12,v124
v_bfe_u32 v125,v127,1,5
v_add_u32 v124,v124,v125
s_lshl_b32 s64,s59,6
buffer_load_ushort v120,v124,s[44:47],s64 offen
buffer_load_ushort v122,v124,s[44:47],s64 offen offset:32
buffer_load_ushort v121,v124,s[44:47],s64 offen offset:2048
buffer_load_ushort v123,v124,s[44:47],s64 offen offset:2080
s_waitcnt vmcnt(0)
v_lshl_or_b32 v120,v122,16,v120
v_lshl_or_b32 v121,v123,16,v121
v_min_u32 v120,s81,v120
v_min_u32 v121,s81,v121
z1_100591:
buffer_store_dword v120,v4,s[20:23],s71 offen sc1
buffer_store_dword v121,v4,s[20:23],s71 offen offset:32 sc1
buffer_store_dword v120,v4,s[20:23],s73 offen sc1
buffer_store_dword v121,v4,s[20:23],s73 offen offset:32 sc1
np0_100590:
v_lshrrev_b32 v124,2,v0
v_bfe_u32 v125,v124,5,1
v_mul_u32_u24 v125,2048,v125
s_and_b32 s64,s50,1
s_lshl_b32 s64,s64,5
v_add3_u32 v4,v124,v125,s64
s_add_u32 s64,s79,0
s_cmp_gt_u32 s91,s64
s_cbranch_scc0 flp_100594
fok_100593:
s_add_u32 s64,s79,0
s_lshl_b32 s65,s64,12
s_and_b32 s65,s65,0x2000
s_xor_b32 s65,s65,s67
s_lshl_b32 s64,s64,20
s_add_u32 s65,s65,s64
s_add_u32 s99,s65,s77
buffer_load_dwordx4 v[104:107],v0,s[20:23],s99 offen
buffer_load_dwordx4 v[108:111],v0,s[20:23],s99 offen offset:1024
s_waitcnt vmcnt(0)
s_mov_b32 s92,s70
s_mov_b32 s93,s72
s_mov_b32 s94,s76
s_add_u32 s95,s94,4096
s_mov_b32 s96,s74
s_add_u32 s97,s96,4096
s_mov_b32 s98,s75
s_barrier
v_mov_b32 v96,v104
v_mov_b32 v97,v105
v_mov_b32 v98,v106
v_mov_b32 v99,v107
v_mov_b32 v100,v108
v_mov_b32 v101,v109
v_mov_b32 v102,v110
v_mov_b32 v103,v111
v_mov_b32 v48,0
v_mov_b32 v49,0
v_mov_b32 v50,0
v_mov_b32 v51,0
v_mov_b32 v52,0
v_mov_b32 v53,0
v_mov_b32 v54,0
v_mov_b32 v55,0
v_mov_b32 v56,0
v_mov_b32 v57,0
v_mov_b32 v58,0
v_mov_b32 v59,0
v_mov_b32 v60,0
v_mov_b32 v61,0
v_mov_b32 v62,0
v_mov_b32 v63,0
v_mov_b32 v64,0
v_mov_b32 v65,0
v_mov_b32 v66,0
v_mov_b32 v67,0
v_mov_b32 v68,0
v_mov_b32 v69,0
v_mov_b32 v70,0
v_mov_b32 v71,0
v_mov_b32 v72,0
v_mov_b32 v73,0
v_mov_b32 v74,0
v_mov_b32 v75,0
v_mov_b32 v76,0
v_mov_b32 v77,0
v_mov_b32 v78,0
v_mov_b32 v79,0
v_mov_b32 v80,0
v_mov_b32 v81,0
v_mov_b32 v82,0
v_mov_b32 v83,0
v_mov_b32 v84,0
v_mov_b32 v85,0
v_mov_b32 v86,0
v_mov_b32 v87,0
v_mov_b32 v88,0
v_mov_b32 v89,0
v_mov_b32 v90,0
v_mov_b32 v91,0
v_mov_b32 v92,0
v_mov_b32 v93,0
v_mov_b32 v94,0
v_mov_b32 v95,0
s_cmp_gt_u32 s50,1
s_cbranch_scc0 loop0_100592x
loop_100588:
v_mov_b32 v125,0
s_nop 1
v_mfma_f32_16x16x1_4b_f32 v[48:63],v125,v125,0
v_mfma_f32_16x16x1_4b_f32 v[64:79],v125,v125,0
v_mfma_f32_16x16x1_4b_f32 v[80:95],v125,v125,0
s_nop 15
s_nop 15
s_nop 15
s_nop 15
buffer_load_dwordx4 v[16:19],v0,s[20:23],s92 offen offset:0 sc1
s_nop 7
buffer_load_dwordx4 v[20:23],v0,s[20:23],s92 offen offset:1024 sc1
s_nop 7
buffer_load_dwordx4 v[24:27],v0,s[20:23],s92 offen offset:2048 sc1
s_nop 7
buffer_load_dwordx4 v[28:31],v0,s[20:23],s92 offen offset:3072 sc1
v_mov_b32 v96,v104
v_mov_b32 v97,v105
v_mov_b32 v98,v106
v_mov_b32 v99,v107
v_mov_b32 v100,v108
v_mov_b32 v101,v109
v_mov_b32 v102,v110
v_mov_b32 v103,v111
s_branch ja_100595
loop0_100592x:
v_mov_b32 v125,0
s_nop 1
v_mfma_f32_16x16x1_4b_f32 v[48:63],v125,v125,0
v_mfma_f32_16x16x1_4b_f32 v[64:79],v125,v125,0
v_mfma_f32_16x16x1_4b_f32 v[80:95],v125,v125,0
s_nop 15
s_nop 11
buffer_load_dwordx4 v[16:19],v0,s[20:23],s92 offen offset:0 sc1
s_nop 7
buffer_load_dwordx4 v[20:23],v0,s[20:23],s92 offen offset:1024 sc1
s_nop 7
buffer_load_dwordx4 v[24:27],v0,s[20:23],s92 offen offset:2048 sc1
s_nop 7
buffer_load_dwordx4 v[28:31],v0,s[20:23],s92 offen offset:3072 sc1
ja_100595:
s_max_u32 s66,s79,1
s_sub_u32 s66,s66,1
v_mov_b32 v126,s66
s_add_u32 s64,s66,0
s_lshl_b32 s65,s64,12
s_and_b32 s65,s65,0x2000
s_xor_b32 s65,s65,s67
s_lshl_b32 s64,s64,20
s_add_u32 s65,s65,s64
s_add_u32 s101,s65,s78
s_cmp_eq_u32 s79,63
s_cbranch_scc1 last_100589
s_add_u32 s64,s79,1
s_cmp_gt_u32 s91,s64
s_cbranch_scc0 flp_100597
fok_100596:
s_add_u32 s64,s79,1
s_lshl_b32 s65,s64,12
s_and_b32 s65,s65,0x2000
s_xor_b32 s65,s65,s67
s_lshl_b32 s64,s64,20
s_add_u32 s65,s65,s64
s_add_u32 s99,s65,s77
s_waitcnt vmcnt(3)
v_max3_u32 v124,v16,v17,v18
v_max_u32 v124,v124,v19
v_cmp_eq_u32 vcc,-1,v124
v_cndmask_b32 v120,2.0,v0,s[82:83]
v_cndmask_b32 v121,2.0,v127,s[86:87]
s_cbranch_vccnz flb_100622
seg_100598:
segb_100606:
v_smfmac_f32_16x16x64_bf16 v[48:51],v[16:19],a[0:7],v1
buffer_load_dword v125,off,s[20:23],s92 sc1
v_smfmac_f32_16x16x64_bf16 v[52:55],v[16:19],a[8:15],v1
buffer_load_dwordx4 v[32:35],v0,s[20:23],s93 offen offset:0 sc1
v_smfmac_f32_16x16x64_bf16 v[56:59],v[16:19],a[16:23],v1
s_waitcnt vmcnt(4)
v_max3_u32 v124,v20,v21,v22
v_smfmac_f32_16x16x64_bf16 v[60:63],v[16:19],a[24:31],v1
v_max_u32 v124,v124,v23
v_smfmac_f32_16x16x64_bf16 v[64:67],v[16:19],a[32:39],v1
v_cmp_eq_u32 vcc,-1,v124
v_smfmac_f32_16x16x64_bf16 v[68:71],v[16:19],a[40:47],v1
v_smfmac_f32_16x16x64_bf16 v[72:75],v[16:19],a[48:55],v1
s_cbranch_vccnz fl_100615
seg_100599:
v_smfmac_f32_16x16x64_bf16 v[76:79],v[16:19],a[56:63],v1
segb_100607:
v_smfmac_f32_16x16x64_bf16 v[48:51],v[20:23],a[64:71],v1
buffer_load_dword v125,off,s[20:23],s92 sc1
v_smfmac_f32_16x16x64_bf16 v[52:55],v[20:23],a[72:79],v1
buffer_load_dwordx4 v[36:39],v0,s[20:23],s93 offen offset:1024 sc1
v_smfmac_f32_16x16x64_bf16 v[56:59],v[20:23],a[80:87],v1
s_waitcnt vmcnt(5)
v_max3_u32 v124,v24,v25,v26
v_smfmac_f32_16x16x64_bf16 v[60:63],v[20:23],a[88:95],v1
v_max_u32 v124,v124,v27
v_smfmac_f32_16x16x64_bf16 v[64:67],v[20:23],a[96:103],v1
v_cmp_eq_u32 vcc,-1,v124
v_smfmac_f32_16x16x64_bf16 v[68:71],v[20:23],a[104:111],v1
v_smfmac_f32_16x16x64_bf16 v[72:75],v[20:23],a[112:119],v1
s_cbranch_vccnz fl_100616
seg_100600:
v_smfmac_f32_16x16x64_bf16 v[76:79],v[20:23],a[120:127],v1
segb_100608:
v_smfmac_f32_16x16x64_bf16 v[48:51],v[24:27],a[128:135],v1
buffer_load_dword v125,off,s[20:23],s92 sc1
v_smfmac_f32_16x16x64_bf16 v[52:55],v[24:27],a[136:143],v1
buffer_load_dwordx4 v[40:43],v0,s[20:23],s93 offen offset:2048 sc1
v_smfmac_f32_16x16x64_bf16 v[56:59],v[24:27],a[144:151],v1
buffer_load_dwordx4 v[44:47],v0,s[20:23],s93 offen offset:3072 sc1
s_waitcnt vmcnt(7)
v_max3_u32 v124,v28,v29,v30
v_smfmac_f32_16x16x64_bf16 v[60:63],v[24:27],a[152:159],v1
v_max_u32 v124,v124,v31
v_smfmac_f32_16x16x64_bf16 v[64:67],v[24:27],a[160:167],v1
v_cmp_eq_u32 vcc,-1,v124
v_smfmac_f32_16x16x64_bf16 v[68:71],v[24:27],a[168:175],v1
v_smfmac_f32_16x16x64_bf16 v[72:75],v[24:27],a[176:183],v1
s_cbranch_vccnz fl_100617
seg_100601:
v_smfmac_f32_16x16x64_bf16 v[76:79],v[24:27],a[184:191],v1
segb_100609:
v_smfmac_f32_16x16x64_bf16 v[48:51],v[28:31],a[192:199],v1
buffer_load_dword v125,off,s[20:23],s92 sc1
v_smfmac_f32_16x16x64_bf16 v[52:55],v[28:31],a[200:207],v1
v_smfmac_f32_16x16x64_bf16 v[56:59],v[28:31],a[208:215],v1
s_waitcnt vmcnt(6)
v_max3_u32 v124,v32,v33,v34
v_smfmac_f32_16x16x64_bf16 v[60:63],v[28:31],a[216:223],v1
v_max_u32 v124,v124,v35
v_smfmac_f32_16x16x64_bf16 v[64:67],v[28:31],a[224:231],v1
v_cmp_eq_u32 vcc,-1,v124
v_smfmac_f32_16x16x64_bf16 v[68:71],v[28:31],a[232:239],v1
v_smfmac_f32_16x16x64_bf16 v[72:75],v[28:31],a[240:247],v1
s_cbranch_vccnz fl_100618
seg_100602:
v_smfmac_f32_16x16x64_bf16 v[76:79],v[28:31],a[248:255],v1
segb_100610:
v_smfmac_f32_16x16x64_bf16 v[48:51],v[32:35],a[0:7],v1
buffer_load_dword v125,off,s[20:23],s92 sc1
v_smfmac_f32_16x16x64_bf16 v[52:55],v[32:35],a[8:15],v1
buffer_store_dwordx4 v[112:115],v120,s[20:23],s101 offen sc1
v_smfmac_f32_16x16x64_bf16 v[56:59],v[32:35],a[16:23],v1
buffer_store_dword v126,v121,s[20:23],s69 offen sc1
s_waitcnt vmcnt(7)
v_max3_u32 v124,v36,v37,v38
v_smfmac_f32_16x16x64_bf16 v[60:63],v[32:35],a[24:31],v1
v_max_u32 v124,v124,v39
v_smfmac_f32_16x16x64_bf16 v[64:67],v[32:35],a[32:39],v1
v_cmp_eq_u32 vcc,-1,v124
v_smfmac_f32_16x16x64_bf16 v[68:71],v[32:35],a[40:47],v1
v_smfmac_f32_16x16x64_bf16 v[72:75],v[32:35],a[48:55],v1
s_cbranch_vccnz fl_100619
seg_100603:
v_smfmac_f32_16x16x64_bf16 v[76:79],v[32:35],a[56:63],v1
segb_100611:
v_smfmac_f32_16x16x64_bf16 v[48:51],v[36:39],a[64:71],v1
buffer_load_dword v125,off,s[20:23],s92 sc1
s_waitcnt vmcnt(5)
v_max3_u32 v124,v40,v41,v42
v_smfmac_f32_16x16x64_bf16 v[52:55],v[36:39],a[72:79],v1
v_max3_u32 v124,v124,v43,v44
v_smfmac_f32_16x16x64_bf16 v[56:59],v[36:39],a[80:87],v1
v_max3_u32 v124,v124,v45,v46
v_smfmac_f32_16x16x64_bf16 v[60:63],v[36:39],a[88:95],v1
v_max_u32 v124,v124,v47
v_smfmac_f32_16x16x64_bf16 v[64:67],v[36:39],a[96:103],v1
v_cmp_eq_u32 vcc,-1,v124
v_smfmac_f32_16x16x64_bf16 v[68:71],v[36:39],a[104:111],v1
v_smfmac_f32_16x16x64_bf16 v[72:75],v[36:39],a[112:119],v1
s_cbranch_vccnz fl_100620
seg_100604:
v_smfmac_f32_16x16x64_bf16 v[76:79],v[36:39],a[120:127],v1
segb_100612:
v_smfmac_f32_16x16x64_bf16 v[48:51],v[40:43],a[128:135],v1
buffer_load_dwordx4 v[104:107],v0,s[20:23],s99 offen
buffer_load_dwordx4 v[108:111],v0,s[20:23],s99 offen offset:1024
v_smfmac_f32_16x16x64_bf16 v[52:55],v[40:43],a[136:143],v1
buffer_load_dword v126,off,s[20:23],s68 sc1
s_add_u32 s64,s79,2
v_smfmac_f32_16x16x64_bf16 v[48:51],v[44:47],a[192:199],v1
s_and_b32 s64,s64,3
s_lshl_b32 s100,s64,19
v_smfmac_f32_16x16x64_bf16 v[52:55],v[44:47],a[200:207],v1
v_smfmac_f32_16x16x64_bf16 v[56:59],v[40:43],a[144:151],v1
v_add_f32 v48,v48,v49
v_smfmac_f32_16x16x64_bf16 v[60:63],v[40:43],a[152:159],v1
ds_write_addtid_b32 v48 offset:0
v_add_f32 v50,v50,v51
v_smfmac_f32_16x16x64_bf16 v[56:59],v[44:47],a[208:215],v1
ds_write_addtid_b32 v50 offset:1040
v_add_f32 v52,v52,v53
v_smfmac_f32_16x16x64_bf16 v[60:63],v[44:47],a[216:223],v1
ds_write_addtid_b32 v52 offset:2080
v_add_f32 v54,v54,v55
v_smfmac_f32_16x16x64_bf16 v[64:67],v[40:43],a[160:167],v1
ds_write_addtid_b32 v54 offset:3120
v_add_f32 v56,v56,v57
v_smfmac_f32_16x16x64_bf16 v[68:71],v[40:43],a[168:175],v1
ds_write_addtid_b32 v56 offset:4160
v_add_f32 v58,v58,v59
v_smfmac_f32_16x16x64_bf16 v[64:67],v[44:47],a[224:231],v1
ds_write_addtid_b32 v58 offset:5200
v_add_f32 v60,v60,v61
v_smfmac_f32_16x16x64_bf16 v[68:71],v[44:47],a[232:239],v1
ds_write_addtid_b32 v60 offset:6240
v_add_f32 v62,v62,v63
v_smfmac_f32_16x16x64_bf16 v[72:75],v[40:43],a[176:183],v1
ds_write_addtid_b32 v62 offset:7280
v_add_f32 v64,v64,v65
v_smfmac_f32_16x16x64_bf16 v[76:79],v[40:43],a[184:191],v1
ds_write_addtid_b32 v64 offset:8448
v_add_f32 v66,v66,v67
v_smfmac_f32_16x16x64_bf16 v[72:75],v[44:47],a[240:247],v1
ds_write_addtid_b32 v66 offset:9488
v_add_f32 v68,v68,v69
v_smfmac_f32_16x16x64_bf16 v[76:79],v[44:47],a[248:255],v1
ds_write_addtid_b32 v68 offset:10528
v_add_f32 v70,v70,v71
v_smfmac_f32_16x16x64_bf16 v[80:83],v[16:19],v[208:215],v1
ds_write_addtid_b32 v70 offset:11568
v_add_f32 v72,v72,v73
v_smfmac_f32_16x16x64_bf16 v[80:83],v[32:35],v[208:215],v1
ds_write_addtid_b32 v72 offset:12608
v_add_f32 v74,v74,v75
ds_write_addtid_b32 v74 offset:13648
v_add_f32 v76,v76,v77
v_add_f32 v78,v78,v79
ds_write_addtid_b32 v76 offset:14688
ds_write_addtid_b32 v78 offset:15728
doneA_100631:
s_waitcnt lgkmcnt(0)
s_barrier
s_cmp_gt_u32 s50,1
s_cbranch_scc1 w23_100632
v_smfmac_f32_16x16x64_bf16 v[84:87],v[16:19],v[216:223],v1
v_smfmac_f32_16x16x64_bf16 v[84:87],v[32:35],v[216:223],v1
v_smfmac_f32_16x16x64_bf16 v[88:91],v[16:19],v[224:231],v1
v_smfmac_f32_16x16x64_bf16 v[88:91],v[32:35],v[224:231],v1
v_smfmac_f32_16x16x64_bf16 v[92:95],v[16:19],v[232:239],v1
ds_read_b128 v[48:51],v7 offset:0
ds_read_b128 v[52:55],v7 offset:1024
v_smfmac_f32_16x16x64_bf16 v[92:95],v[32:35],v[232:239],v1
ds_read_b128 v[56:59],v7 offset:2048
ds_read_b128 v[60:63],v7 offset:3072
v_smfmac_f32_16x16x64_bf16 v[80:83],v[20:23],v[240:247],v1
ds_read_b128 v[64:67],v7 offset:4096
ds_read_b128 v[68:71],v7 offset:5120
v_smfmac_f32_16x16x64_bf16 v[80:83],v[36:39],v[240:247],v1
ds_read_b128 v[72:75],v7 offset:6144
ds_read_b128 v[76:79],v7 offset:7168
v_smfmac_f32_16x16x64_bf16 v[84:87],v[20:23],v[248:255],v1
v_smfmac_f32_16x16x64_bf16 v[84:87],v[36:39],v[248:255],v1
s_waitcnt lgkmcnt(6)
v_smfmac_f32_16x16x64_bf16 v[88:91],v[20:23],v[48:55],v1
v_smfmac_f32_16x16x64_bf16 v[88:91],v[36:39],v[48:55],v1
ds_read_b128 v[48:51],v7 offset:8192
ds_read_b128 v[52:55],v7 offset:9216
s_waitcnt lgkmcnt(6)
v_smfmac_f32_16x16x64_bf16 v[92:95],v[20:23],v[56:63],v1
v_smfmac_f32_16x16x64_bf16 v[92:95],v[36:39],v[56:63],v1
ds_read_b128 v[56:59],v7 offset:10240
ds_read_b128 v[60:63],v7 offset:11264
s_waitcnt lgkmcnt(6)
v_smfmac_f32_16x16x64_bf16 v[80:83],v[24:27],v[64:71],v1
v_smfmac_f32_16x16x64_bf16 v[80:83],v[40:43],v[64:71],v1
ds_read_b128 v[64:67],v7 offset:12288
ds_read_b128 v[68:71],v7 offset:13312
s_waitcnt lgkmcnt(6)
v_smfmac_f32_16x16x64_bf16 v[84:87],v[24:27],v[72:79],v1
v_smfmac_f32_16x16x64_bf16 v[84:87],v[40:43],v[72:79],v1
ds_read_b128 v[72:75],v7 offset:14336
ds_read_b128 v[76:79],v7 offset:15360
s_waitcnt lgkmcnt(6)
v_smfmac_f32_16x16x64_bf16 v[88:91],v[24:27],v[48:55],v1
v_smfmac_f32_16x16x64_bf16 v[88:91],v[40:43],v[48:55],v1
ds_read_b128 v[48:51],v7 offset:16384
ds_read_b128 v[52:55],v7 offset:17408
s_waitcnt lgkmcnt(6)
v_smfmac_f32_16x16x64_bf16 v[92:95],v[24:27],v[56:63],v1
v_smfmac_f32_16x16x64_bf16 v[92:95],v[40:43],v[56:63],v1
ds_read_b128 v[56:59],v7 offset:18432
ds_read_b128 v[60:63],v7 offset:19456
s_waitcnt lgkmcnt(6)
v_smfmac_f32_16x16x64_bf16 v[80:83],v[28:31],v[64:71],v1
v_smfmac_f32_16x16x64_bf16 v[80:83],v[44:47],v[64:71],v1
s_waitcnt lgkmcnt(4)
v_smfmac_f32_16x16x64_bf16 v[84:87],v[28:31],v[72:79],v1
v_smfmac_f32_16x16x64_bf16 v[84:87],v[44:47],v[72:79],v1
s_waitcnt lgkmcnt(2)
v_smfmac_f32_16x16x64_bf16 v[88:91],v[28:31],v[48:55],v1
v_add_f32 v80,v80,v81
v_smfmac_f32_16x16x64_bf16 v[88:91],v[44:47],v[48:55],v1
v_add_f32 v82,v82,v83
s_waitcnt lgkmcnt(0)
v_smfmac_f32_16x16x64_bf16 v[92:95],v[28:31],v[56:63],v1
v_cvt_pk_bf16_f32 v80,v80,v82
v_smfmac_f32_16x16x64_bf16 v[92:95],v[44:47],v[56:63],v1
ds_write_addtid_b32 v80 offset:16896
v_add_f32 v84,v84,v85
buffer_load_dwordx4 v[16:19],v2,s[20:23],s94 offen offset:0 sc1
buffer_load_dwordx4 v[32:35],v2,s[20:23],s94 offen offset:1536 sc1
buffer_load_dwordx4 v[20:23],v2,s[20:23],s95 offen offset:0 sc1
buffer_load_dwordx4 v[36:39],v2,s[20:23],s95 offen offset:1536 sc1
buffer_load_dword v120,v3,s[20:23],s94 offen offset:0 sc1
buffer_load_dword v121,v3,s[20:23],s94 offen offset:1536 sc1
buffer_load_dword v122,v3,s[20:23],s95 offen offset:0 sc1
buffer_load_dword v123,v3,s[20:23],s95 offen offset:1536 sc1
v_add_f32 v86,v86,v87
v_cvt_pk_bf16_f32 v84,v84,v86
v_add_f32 v88,v88,v89
v_add_f32 v90,v90,v91
v_cvt_pk_bf16_f32 v88,v88,v90
v_add_f32 v92,v92,v93
v_add_f32 v94,v94,v95
v_cvt_pk_bf16_f32 v92,v92,v94
ds_write_addtid_b32 v84 offset:17920
ds_write_addtid_b32 v88 offset:18944
ds_write_addtid_b32 v92 offset:19968
sp_100635:
s_waitcnt vmcnt(6)
v_pk_add_f32 v[16:17],v[16:17],v[32:33]
v_pk_add_f32 v[18:19],v[18:19],v[34:35]
s_waitcnt vmcnt(4)
v_pk_add_f32 v[20:21],v[20:21],v[36:37]
v_pk_add_f32 v[22:23],v[22:23],v[38:39]
v_pk_add_f32 v[16:17],v[16:17],v[20:21]
v_pk_add_f32 v[18:19],v[18:19],v[22:23]
v_max3_f32 v124,v16,v17,v18
v_pk_add_f32 v[20:21],v[16:17],v[18:19]
s_waitcnt vmcnt(0)
v_pk_add_f32 v[120:121],v[120:121],v[122:123]
v_add_f32 v120,v120,v121
v_max3_f32 v124,v124,v19,v120
v_add_f32 v20,v20,v120
v_cmp_u_f32 vcc,v20,v21
v_max_f32_dpp v124,v124,v124 row_ror:8 row_mask:0xf bank_mask:0xf
v_mov_b32 v125,v124
s_cbranch_vccnz srt_100637
sok_100636:
s_nop 0
v_permlane16_swap_b32 v125,v124
v_max_f32 v124,v124,v125
v_mov_b32 v125,v124
s_nop 1
v_permlane32_swap_b32 v125,v124
v_max_f32 v124,v124,v125
v_mul_f32 v124,s80,v124
v_fma_f32 v16,v16,s80,-v124
v_fma_f32 v17,v17,s80,-v124
v_fma_f32 v18,v18,s80,-v124
v_fma_f32 v19,v19,s80,-v124
v_fma_f32 v120,v120,s80,-v124
s_waitcnt lgkmcnt(0)
s_barrier
ds_read2st64_b32 v[112:113],v127 offset0:66 offset1:67
ds_read2st64_b32 v[114:115],v127 offset0:68 offset1:69
ds_read2st64_b32 v[116:117],v127 offset0:70 offset1:71
ds_read2st64_b32 v[118:119],v127 offset0:72 offset1:73
v_exp_f32 v16,v16
v_exp_f32 v17,v17
v_exp_f32 v18,v18
v_exp_f32 v19,v19
v_cvt_pk_bf16_f32 v48,v16,v17
v_cvt_pk_bf16_f32 v49,v18,v19
v_exp_f32 v120,v120
v_mov_b32_dpp v50,v48 row_ror:8 row_mask:0xf bank_mask:0xf
v_mov_b32_dpp v51,v49 row_ror:8 row_mask:0xf bank_mask:0xf
v_mov_b32_dpp v121,v120 row_ror:8 row_mask:0xf bank_mask:0xf
v_cvt_pk_bf16_f32 v52,v120,v121
v_mfma_f32_16x16x32_bf16 v[64:67],v[8:11],v[48:51],0
v_mov_b32 v53,v52
v_mfma_f32_16x16x32_bf16 v[56:59],v[96:99],v[48:51],0
v_mov_b32 v54,v52
v_mov_b32 v55,v52
v_mfma_f32_16x16x32_bf16 v[60:63],v[100:103],v[48:51],0
v_mfma_f32_16x16x32_bf16 v[64:67],v[12:15],v[52:55],v[64:67]
s_waitcnt lgkmcnt(0)
v_mfma_f32_16x16x32_bf16 v[56:59],v[112:115],v[52:55],v[56:59]
v_mfma_f32_16x16x32_bf16 v[60:63],v[116:119],v[52:55],v[60:63]
s_nop 0
v_rcp_f32 v66,v64
s_nop 2
v_pk_mul_f32 v[56:57],v[56:57],v[66:67] op_sel_hi:[1,0]
v_pk_mul_f32 v[58:59],v[58:59],v[66:67] op_sel_hi:[1,0]
s_nop 0
v_pk_mul_f32 v[60:61],v[60:61],v[66:67] op_sel_hi:[1,0]
v_pk_mul_f32 v[62:63],v[62:63],v[66:67] op_sel_hi:[1,0]
v_cvt_pk_bf16_f32 v120,v56,v57
v_cvt_pk_bf16_f32 v121,v58,v59
v_cvt_pk_bf16_f32 v122,v60,v61
v_cvt_pk_bf16_f32 v123,v62,v63
buffer_store_dwordx4 v[120:123],v6,s[20:23],s98 offen sc1
s_barrier
ds_read_b128 v[48:51],v7 offset:20480
ds_read_b128 v[52:55],v7 offset:21504
ds_read_b128 v[56:59],v7 offset:22528
ds_read_b128 v[60:63],v7 offset:23552
ds_read_b128 v[64:67],v7 offset:24576
ds_read_b128 v[68:71],v7 offset:25600
ds_read_b128 v[72:75],v7 offset:26624
ds_read_b128 v[76:79],v7 offset:27648
ds_read_b128 v[80:83],v7 offset:28672
ds_read_b128 v[84:87],v7 offset:29696
ds_read_b128 v[88:91],v7 offset:30720
ds_read_b128 v[92:95],v7 offset:31744
v_mov_b32 v96,0
v_mov_b32 v97,0
v_mov_b32 v98,0
v_mov_b32 v99,0
v_mov_b32 v100,0
v_mov_b32 v101,0
v_mov_b32 v102,0
v_mov_b32 v103,0
s_nop 11
buffer_load_dwordx4 v[16:19],v0,s[20:23],s96 offen offset:0 sc1
v_mov_b32 v120,v5
v_mov_b32 v121,v5
v_mov_b32 v122,v5
v_mov_b32 v123,v5
s_nop 1
v_mfma_f32_16x16x32_bf16 v[112:115],v[120:123],v[112:115],0
buffer_load_dwordx4 v[20:23],v0,s[20:23],s96 offen offset:1024 sc1
v_mfma_f32_16x16x32_bf16 v[116:119],v[120:123],v[116:119],0
s_add_u32 s79,s79,1
s_and_b32 s64,s79,3
s_lshl_b32 s64,s64,19
s_lshl_b32 s65,s79,8
buffer_load_dwordx4 v[24:27],v0,s[20:23],s96 offen offset:2048 sc1
s_and_b32 s65,s65,0x2000
s_lshl_b32 s66,s79,16
s_xor_b32 s88,s73,s65
s_add_u32 s88,s88,s66
s_sub_u32 s88,s88,s54
s_add_u32 s89,s71,s64
s_add_u32 s92,s70,s64
s_xor_b32 s93,s72,s65
buffer_load_dwordx4 v[28:31],v0,s[20:23],s96 offen offset:3072 sc1
s_add_u32 s93,s93,s66
s_add_u32 s94,s76,s64
s_add_u32 s95,s94,4096
s_add_u32 s98,s75,s64
s_add_u32 s60,s74,s64
v_cvt_pk_bf16_f32 v112,v112,v113
v_cvt_pk_bf16_f32 v113,v114,v115
v_cvt_pk_bf16_f32 v114,v116,v117
buffer_load_dwordx4 v[32:35],v0,s[20:23],s97 offen offset:0 sc1
v_cvt_pk_bf16_f32 v115,v118,v119
s_nop 6
buffer_load_dwordx4 v[36:39],v0,s[20:23],s97 offen offset:1024 sc1
s_nop 7
buffer_load_dwordx4 v[40:43],v0,s[20:23],s97 offen offset:2048 sc1
s_nop 7
buffer_load_dwordx4 v[44:47],v0,s[20:23],s97 offen offset:3072 sc1
s_branch ogo_100633
w23_100632:
ds_read_b128 v[48:51],v2 offset:0
ds_read_b128 v[52:55],v2 offset:256
ds_read_b128 v[56:59],v2 offset:512
ds_read_b128 v[60:63],v2 offset:768
ds_read_b128 v[64:67],v2 offset:16
ds_read_b128 v[68:71],v2 offset:272
ds_read_b128 v[72:75],v2 offset:528
ds_read_b128 v[76:79],v2 offset:784
s_waitcnt lgkmcnt(6)
v_pk_add_f32 v[48:49],v[48:49],v[52:53]
v_pk_add_f32 v[50:51],v[50:51],v[54:55]
s_waitcnt lgkmcnt(4)
v_pk_add_f32 v[56:57],v[56:57],v[60:61]
v_pk_add_f32 v[58:59],v[58:59],v[62:63]
v_pk_add_f32 v[48:49],v[48:49],v[56:57]
v_pk_add_f32 v[50:51],v[50:51],v[58:59]
v_cvt_pk_bf16_f32 v112,v48,v49
v_cvt_pk_bf16_f32 v113,v50,v51
s_waitcnt lgkmcnt(2)
v_pk_add_f32 v[64:65],v[64:65],v[68:69]
v_pk_add_f32 v[66:67],v[66:67],v[70:71]
s_waitcnt lgkmcnt(0)
v_pk_add_f32 v[72:73],v[72:73],v[76:77]
v_pk_add_f32 v[74:75],v[74:75],v[78:79]
v_pk_add_f32 v[64:65],v[64:65],v[72:73]
v_pk_add_f32 v[66:67],v[66:67],v[74:75]
v_cvt_pk_bf16_f32 v114,v64,v65
v_cvt_pk_bf16_f32 v115,v66,v67
s_nop 1
v_mfma_f32_16x16x32_bf16 v[116:119],v[96:99],v[112:115],0
v_mfma_f32_16x16x32_bf16 v[120:123],v[100:103],v[112:115],0
v_mfma_f32_16x16x32_bf16 v[12:15],v[112:115],v[112:115],0
ds_read_b128 v[48:51],v7 offset:0
ds_read_b128 v[52:55],v7 offset:1024
ds_read_b128 v[56:59],v7 offset:2048
ds_read_b128 v[60:63],v7 offset:3072
ds_read_b128 v[64:67],v7 offset:4096
buffer_store_dwordx4 v[116:119],v3,s[20:23],s94 offen sc1
buffer_store_dwordx4 v[120:123],v3,s[20:23],s94 offen offset:512 sc1
s_nop 0
buffer_store_dwordx4 v[12:15],v3,s[20:23],s94 offen offset:1024 sc1
ds_read_b128 v[68:71],v7 offset:5120
ds_read_b128 v[72:75],v7 offset:6144
ds_read_b128 v[76:79],v7 offset:7168
v_smfmac_f32_16x16x64_bf16 v[84:87],v[16:19],v[216:223],v1
v_smfmac_f32_16x16x64_bf16 v[84:87],v[32:35],v[216:223],v1
v_smfmac_f32_16x16x64_bf16 v[88:91],v[16:19],v[224:231],v1
v_smfmac_f32_16x16x64_bf16 v[88:91],v[32:35],v[224:231],v1
v_smfmac_f32_16x16x64_bf16 v[92:95],v[16:19],v[232:239],v1
v_smfmac_f32_16x16x64_bf16 v[92:95],v[32:35],v[232:239],v1
v_smfmac_f32_16x16x64_bf16 v[80:83],v[20:23],v[240:247],v1
v_smfmac_f32_16x16x64_bf16 v[80:83],v[36:39],v[240:247],v1
v_smfmac_f32_16x16x64_bf16 v[84:87],v[20:23],v[248:255],v1
v_smfmac_f32_16x16x64_bf16 v[84:87],v[36:39],v[248:255],v1
s_waitcnt lgkmcnt(6)
v_smfmac_f32_16x16x64_bf16 v[88:91],v[20:23],v[48:55],v1
v_smfmac_f32_16x16x64_bf16 v[88:91],v[36:39],v[48:55],v1
ds_read_b128 v[48:51],v7 offset:8192
ds_read_b128 v[52:55],v7 offset:9216
s_waitcnt lgkmcnt(6)
v_smfmac_f32_16x16x64_bf16 v[92:95],v[20:23],v[56:63],v1
v_smfmac_f32_16x16x64_bf16 v[92:95],v[36:39],v[56:63],v1
ds_read_b128 v[56:59],v7 offset:10240
ds_read_b128 v[60:63],v7 offset:11264
s_waitcnt lgkmcnt(6)
v_smfmac_f32_16x16x64_bf16 v[80:83],v[24:27],v[64:71],v1
v_smfmac_f32_16x16x64_bf16 v[80:83],v[40:43],v[64:71],v1
ds_read_b128 v[64:67],v7 offset:12288
ds_read_b128 v[68:71],v7 offset:13312
s_waitcnt lgkmcnt(6)
v_smfmac_f32_16x16x64_bf16 v[84:87],v[24:27],v[72:79],v1
v_smfmac_f32_16x16x64_bf16 v[84:87],v[40:43],v[72:79],v1
ds_read_b128 v[72:75],v7 offset:14336
ds_read_b128 v[76:79],v7 offset:15360
s_waitcnt lgkmcnt(6)
v_smfmac_f32_16x16x64_bf16 v[88:91],v[24:27],v[48:55],v1
v_smfmac_f32_16x16x64_bf16 v[88:91],v[40:43],v[48:55],v1
ds_read_b128 v[48:51],v7 offset:16384
ds_read_b128 v[52:55],v7 offset:17408
s_waitcnt lgkmcnt(6)
v_smfmac_f32_16x16x64_bf16 v[92:95],v[24:27],v[56:63],v1
v_smfmac_f32_16x16x64_bf16 v[92:95],v[40:43],v[56:63],v1
ds_read_b128 v[56:59],v7 offset:18432
ds_read_b128 v[60:63],v7 offset:19456
s_waitcnt lgkmcnt(6)
v_smfmac_f32_16x16x64_bf16 v[80:83],v[28:31],v[64:71],v1
v_smfmac_f32_16x16x64_bf16 v[80:83],v[44:47],v[64:71],v1
s_waitcnt lgkmcnt(4)
v_smfmac_f32_16x16x64_bf16 v[84:87],v[28:31],v[72:79],v1
v_smfmac_f32_16x16x64_bf16 v[84:87],v[44:47],v[72:79],v1
s_waitcnt lgkmcnt(2)
v_smfmac_f32_16x16x64_bf16 v[88:91],v[28:31],v[48:55],v1
v_add_f32 v80,v80,v81
v_smfmac_f32_16x16x64_bf16 v[88:91],v[44:47],v[48:55],v1
v_add_f32 v82,v82,v83
s_waitcnt lgkmcnt(0)
v_smfmac_f32_16x16x64_bf16 v[92:95],v[28:31],v[56:63],v1
v_cvt_pk_bf16_f32 v80,v80,v82
v_smfmac_f32_16x16x64_bf16 v[92:95],v[44:47],v[56:63],v1
ds_write_addtid_b32 v80 offset:16896
v_add_f32 v84,v84,v85
v_add_f32 v86,v86,v87
v_cvt_pk_bf16_f32 v84,v84,v86
v_add_f32 v88,v88,v89
v_add_f32 v90,v90,v91
v_cvt_pk_bf16_f32 v88,v88,v90
s_nop 0
v_add_f32 v92,v92,v93
v_add_f32 v94,v94,v95
v_cvt_pk_bf16_f32 v92,v92,v94
ds_write_addtid_b32 v84 offset:17920
ds_write_addtid_b32 v88 offset:18944
ds_write_addtid_b32 v92 offset:19968
s_waitcnt lgkmcnt(0)
s_barrier
ds_read_b128 v[48:51],v7 offset:20480
ds_read_b128 v[52:55],v7 offset:21504
ds_read_b128 v[56:59],v7 offset:22528
ds_read_b128 v[60:63],v7 offset:23552
ds_read_b128 v[64:67],v7 offset:24576
ds_read_b128 v[68:71],v7 offset:25600
ds_read_b128 v[72:75],v7 offset:26624
ds_read_b128 v[76:79],v7 offset:27648
ds_read_b128 v[80:83],v7 offset:28672
ds_read_b128 v[84:87],v7 offset:29696
ds_read_b128 v[88:91],v7 offset:30720
ds_read_b128 v[92:95],v7 offset:31744
s_add_u32 s65,s76,s100
s_add_u32 s66,s75,s100
s_add_u32 s64,s71,s100
s_cmp_eq_u32 s50,2
s_cselect_b32 s66,s66,s64
buffer_store_dwordx4 v[8:11],v0,s[20:23],s65 offen sc1
s_cmp_eq_u32 s50,2
s_cselect_b32 exec_hi,-1,0
buffer_store_dwordx4 v[8:11],v0,s[20:23],s66 offen sc1
s_mov_b32 exec_hi,0
buffer_store_dwordx4 v[8:11],v0,s[20:23],s65 offen offset:1024 sc1
s_mov_b64 exec,-1
v_mov_b32 v96,0
v_mov_b32 v97,0
v_mov_b32 v98,0
v_mov_b32 v99,0
v_mov_b32 v100,0
v_mov_b32 v101,0
v_mov_b32 v102,0
v_mov_b32 v103,0
s_barrier
s_nop 15
s_nop 15
s_nop 7
buffer_load_dwordx4 v[16:19],v0,s[20:23],s96 offen offset:0 sc1
s_add_u32 s79,s79,1
s_and_b32 s64,s79,3
s_lshl_b32 s64,s64,19
s_lshl_b32 s65,s79,8
s_and_b32 s65,s65,0x2000
s_lshl_b32 s66,s79,16
s_xor_b32 s88,s73,s65
s_add_u32 s88,s88,s66
buffer_load_dwordx4 v[20:23],v0,s[20:23],s96 offen offset:1024 sc1
s_sub_u32 s88,s88,s54
s_add_u32 s89,s71,s64
s_add_u32 s92,s70,s64
s_xor_b32 s93,s72,s65
s_add_u32 s93,s93,s66
s_add_u32 s94,s76,s64
s_add_u32 s95,s94,4096
s_add_u32 s98,s75,s64
buffer_load_dwordx4 v[24:27],v0,s[20:23],s96 offen offset:2048 sc1
s_add_u32 s60,s74,s64
s_nop 6
buffer_load_dwordx4 v[28:31],v0,s[20:23],s96 offen offset:3072 sc1
s_nop 7
buffer_load_dwordx4 v[32:35],v0,s[20:23],s97 offen offset:0 sc1
s_nop 7
buffer_load_dwordx4 v[36:39],v0,s[20:23],s97 offen offset:1024 sc1
s_nop 7
buffer_load_dwordx4 v[40:43],v0,s[20:23],s97 offen offset:2048 sc1
s_nop 7
buffer_load_dwordx4 v[44:47],v0,s[20:23],s97 offen offset:3072 sc1
ogo_100633:
s_waitcnt lgkmcnt(0)
s_waitcnt vmcnt(6)
v_max3_u32 v124,v16,v17,v18
v_max3_u32 v124,v124,v19,v20
v_max3_u32 v124,v124,v21,v22
v_max_u32 v124,v124,v23
v_cmp_eq_u32 vcc,-1,v124
s_cbranch_vccnz of_100638
v_smfmac_f32_16x16x64_bf16 v[96:99],v[16:19],v[48:55],v1
v_smfmac_f32_16x16x64_bf16 v[100:103],v[16:19],v[56:63],v1
v_smfmac_f32_16x16x64_bf16 v[96:99],v[20:23],v[64:71],v1
v_smfmac_f32_16x16x64_bf16 v[100:103],v[20:23],v[72:79],v1
v_readfirstlane_b32 s91,v126
s_waitcnt vmcnt(4)
v_max3_u32 v124,v24,v25,v26
v_max3_u32 v124,v124,v27,v28
v_max3_u32 v124,v124,v29,v30
v_max_u32 v124,v124,v31
v_cmp_eq_u32 vcc,-1,v124
s_cbranch_vccnz of_100639
v_smfmac_f32_16x16x64_bf16 v[96:99],v[24:27],v[80:87],v1
v_smfmac_f32_16x16x64_bf16 v[100:103],v[24:27],v[88:95],v1
v_smfmac_f32_16x16x64_bf16 v[96:99],v[28:31],v[128:135],v1
v_smfmac_f32_16x16x64_bf16 v[100:103],v[28:31],v[136:143],v1
s_waitcnt vmcnt(2)
v_max3_u32 v124,v32,v33,v34
v_max3_u32 v124,v124,v35,v36
v_max3_u32 v124,v124,v37,v38
v_max_u32 v124,v124,v39
v_cmp_eq_u32 vcc,-1,v124
s_cbranch_vccnz of_100640
v_smfmac_f32_16x16x64_bf16 v[96:99],v[32:35],v[144:151],v1
v_smfmac_f32_16x16x64_bf16 v[100:103],v[32:35],v[152:159],v1
v_smfmac_f32_16x16x64_bf16 v[96:99],v[36:39],v[160:167],v1
v_smfmac_f32_16x16x64_bf16 v[100:103],v[36:39],v[168:175],v1
s_waitcnt vmcnt(1)
v_max3_u32 v124,v40,v41,v42
v_max_u32 v124,v124,v43
v_cmp_eq_u32 vcc,-1,v124
s_cbranch_vccnz of_100641
v_smfmac_f32_16x16x64_bf16 v[96:99],v[40:43],v[176:183],v1
v_smfmac_f32_16x16x64_bf16 v[100:103],v[40:43],v[184:191],v1
s_waitcnt vmcnt(0)
v_max3_u32 v124,v44,v45,v46
v_max_u32 v124,v124,v47
v_cmp_eq_u32 vcc,-1,v124
s_cbranch_vccnz of_100642
v_smfmac_f32_16x16x64_bf16 v[96:99],v[44:47],v[192:199],v1
v_smfmac_f32_16x16x64_bf16 v[100:103],v[44:47],v[200:207],v1
oback_100649:
s_nop 4
v_add_f32 v96,v96,v97
v_add_f32 v98,v98,v99
s_nop 0
v_add_f32 v100,v100,v101
v_add_f32 v102,v102,v103
ds_write_addtid_b32 v96 offset:20992
ds_write_addtid_b32 v98 offset:23072
ds_write_addtid_b32 v100 offset:22016
ds_write_addtid_b32 v102 offset:24096
s_mov_b32 s96,s60
s_add_u32 s97,s60,4096
s_cmp_gt_u32 s50,1
s_waitcnt lgkmcnt(0)
s_barrier
s_cbranch_scc1 loop_100588
ds_read2st64_b32 v[48:49],v4 offset0:82 offset1:86
ds_read2st64_b32 v[50:51],v4 offset0:83 offset1:87
ds_read2st64_b32 v[52:53],v4 offset0:84 offset1:88
ds_read2st64_b32 v[54:55],v4 offset0:85 offset1:89
v_mov_b32 v96,v104
v_mov_b32 v97,v105
v_mov_b32 v98,v106
v_mov_b32 v99,v107
v_mov_b32 v100,v108
v_mov_b32 v101,v109
v_mov_b32 v102,v110
v_mov_b32 v103,v111
s_waitcnt lgkmcnt(2)
v_pk_add_f32 v[48:49],v[48:49],v[50:51]
s_waitcnt lgkmcnt(0)
v_pk_add_f32 v[52:53],v[52:53],v[54:55]
v_pk_add_f32 v[48:49],v[48:49],v[52:53]
v_cvt_pk_bf16_f32 v124,v48,v49
buffer_store_dword v124,v127,s[20:23],s89 offen sc1
s_nop 7
buffer_store_dword v124,v127,s[20:23],s88 offen sc1
s_branch loop0_100592x
last_100589:
s_waitcnt vmcnt(3)
v_max3_u32 v124,v16,v17,v18
v_max_u32 v124,v124,v19
v_cmp_eq_u32 vcc,-1,v124
v_cndmask_b32 v120,2.0,v0,s[82:83]
v_cndmask_b32 v121,2.0,v127,s[86:87]
s_cbranch_vccnz flb_100674
seg_100650:
segb_100658:
v_smfmac_f32_16x16x64_bf16 v[64:67],v[16:19],a[32:39],v1
buffer_load_dword v125,off,s[20:23],s92 sc1
buffer_load_dwordx4 v[32:35],v0,s[20:23],s93 offen offset:0 sc1
s_waitcnt vmcnt(4)
v_max3_u32 v124,v20,v21,v22
v_smfmac_f32_16x16x64_bf16 v[68:71],v[16:19],a[40:47],v1
v_max_u32 v124,v124,v23
v_cmp_eq_u32 vcc,-1,v124
v_smfmac_f32_16x16x64_bf16 v[72:75],v[16:19],a[48:55],v1
v_smfmac_f32_16x16x64_bf16 v[76:79],v[16:19],a[56:63],v1
s_cbranch_vccnz fl_100667
seg_100651:
segb_100659:
v_smfmac_f32_16x16x64_bf16 v[64:67],v[20:23],a[96:103],v1
buffer_load_dword v125,off,s[20:23],s92 sc1
buffer_load_dwordx4 v[36:39],v0,s[20:23],s93 offen offset:1024 sc1
s_waitcnt vmcnt(5)
v_max3_u32 v124,v24,v25,v26
v_smfmac_f32_16x16x64_bf16 v[68:71],v[20:23],a[104:111],v1
v_max_u32 v124,v124,v27
v_cmp_eq_u32 vcc,-1,v124
v_smfmac_f32_16x16x64_bf16 v[72:75],v[20:23],a[112:119],v1
v_smfmac_f32_16x16x64_bf16 v[76:79],v[20:23],a[120:127],v1
s_cbranch_vccnz fl_100668
seg_100652:
segb_100660:
v_smfmac_f32_16x16x64_bf16 v[64:67],v[24:27],a[160:167],v1
buffer_load_dword v125,off,s[20:23],s92 sc1
buffer_load_dwordx4 v[40:43],v0,s[20:23],s93 offen offset:2048 sc1
buffer_load_dwordx4 v[44:47],v0,s[20:23],s93 offen offset:3072 sc1
s_waitcnt vmcnt(7)
v_max3_u32 v124,v28,v29,v30
v_smfmac_f32_16x16x64_bf16 v[68:71],v[24:27],a[168:175],v1
v_max_u32 v124,v124,v31
v_cmp_eq_u32 vcc,-1,v124
v_smfmac_f32_16x16x64_bf16 v[72:75],v[24:27],a[176:183],v1
v_smfmac_f32_16x16x64_bf16 v[76:79],v[24:27],a[184:191],v1
s_cbranch_vccnz fl_100669
seg_100653:
segb_100661:
v_smfmac_f32_16x16x64_bf16 v[64:67],v[28:31],a[224:231],v1
buffer_load_dword v125,off,s[20:23],s92 sc1
s_waitcnt vmcnt(6)
v_max3_u32 v124,v32,v33,v34
v_smfmac_f32_16x16x64_bf16 v[68:71],v[28:31],a[232:239],v1
v_max_u32 v124,v124,v35
v_cmp_eq_u32 vcc,-1,v124
v_smfmac_f32_16x16x64_bf16 v[72:75],v[28:31],a[240:247],v1
v_smfmac_f32_16x16x64_bf16 v[76:79],v[28:31],a[248:255],v1
s_cbranch_vccnz fl_100670
seg_100654:
segb_100662:
v_smfmac_f32_16x16x64_bf16 v[64:67],v[32:35],a[32:39],v1
buffer_load_dword v125,off,s[20:23],s92 sc1
buffer_store_dwordx4 v[112:115],v120,s[20:23],s101 offen sc1
buffer_store_dword v126,v121,s[20:23],s69 offen sc1
s_waitcnt vmcnt(7)
v_max3_u32 v124,v36,v37,v38
v_smfmac_f32_16x16x64_bf16 v[68:71],v[32:35],a[40:47],v1
v_max_u32 v124,v124,v39
v_cmp_eq_u32 vcc,-1,v124
v_smfmac_f32_16x16x64_bf16 v[72:75],v[32:35],a[48:55],v1
v_smfmac_f32_16x16x64_bf16 v[76:79],v[32:35],a[56:63],v1
s_cbranch_vccnz fl_100671
seg_100655:
segb_100663:
v_smfmac_f32_16x16x64_bf16 v[64:67],v[36:39],a[96:103],v1
buffer_load_dword v125,off,s[20:23],s92 sc1
s_waitcnt vmcnt(5)
v_max3_u32 v124,v40,v41,v42
v_smfmac_f32_16x16x64_bf16 v[68:71],v[36:39],a[104:111],v1
v_max3_u32 v124,v124,v43,v44
v_max3_u32 v124,v124,v45,v46
v_max_u32 v124,v124,v47
v_cmp_eq_u32 vcc,-1,v124
v_smfmac_f32_16x16x64_bf16 v[72:75],v[36:39],a[112:119],v1
v_smfmac_f32_16x16x64_bf16 v[76:79],v[36:39],a[120:127],v1
s_cbranch_vccnz fl_100672
seg_100656:
segb_100664:
v_smfmac_f32_16x16x64_bf16 v[64:67],v[40:43],a[160:167],v1
v_smfmac_f32_16x16x64_bf16 v[68:71],v[40:43],a[168:175],v1
v_smfmac_f32_16x16x64_bf16 v[64:67],v[44:47],a[224:231],v1
v_smfmac_f32_16x16x64_bf16 v[68:71],v[44:47],a[232:239],v1
v_smfmac_f32_16x16x64_bf16 v[72:75],v[40:43],a[176:183],v1
s_nop 1
v_add_f32 v64,v64,v65
v_smfmac_f32_16x16x64_bf16 v[76:79],v[40:43],a[184:191],v1
ds_write_addtid_b32 v64 offset:8448
v_add_f32 v66,v66,v67
v_smfmac_f32_16x16x64_bf16 v[72:75],v[44:47],a[240:247],v1
ds_write_addtid_b32 v66 offset:9488
v_add_f32 v68,v68,v69
v_smfmac_f32_16x16x64_bf16 v[76:79],v[44:47],a[248:255],v1
ds_write_addtid_b32 v68 offset:10528
v_add_f32 v70,v70,v71
v_smfmac_f32_16x16x64_bf16 v[80:83],v[16:19],v[208:215],v1
ds_write_addtid_b32 v70 offset:11568
v_add_f32 v72,v72,v73
v_smfmac_f32_16x16x64_bf16 v[80:83],v[32:35],v[208:215],v1
ds_write_addtid_b32 v72 offset:12608
v_add_f32 v74,v74,v75
v_smfmac_f32_16x16x64_bf16 v[84:87],v[16:19],v[216:223],v1
ds_write_addtid_b32 v74 offset:13648
v_add_f32 v76,v76,v77
v_smfmac_f32_16x16x64_bf16 v[84:87],v[32:35],v[216:223],v1
ds_write_addtid_b32 v76 offset:14688
v_add_f32 v78,v78,v79
v_smfmac_f32_16x16x64_bf16 v[88:91],v[16:19],v[224:231],v1
ds_write_addtid_b32 v78 offset:15728
v_smfmac_f32_16x16x64_bf16 v[88:91],v[32:35],v[224:231],v1
v_smfmac_f32_16x16x64_bf16 v[92:95],v[16:19],v[232:239],v1
v_smfmac_f32_16x16x64_bf16 v[92:95],v[32:35],v[232:239],v1
doneA_100683:
s_waitcnt vmcnt(0) lgkmcnt(0)
s_add_u32 s64,s79,0
s_lshl_b32 s65,s64,12
s_and_b32 s65,s65,0x2000
s_xor_b32 s65,s65,s67
s_lshl_b32 s64,s64,20
s_add_u32 s65,s65,s64
s_add_u32 s101,s65,s78
v_smfmac_f32_16x16x64_bf16 v[80:83],v[20:23],v[240:247],v1
ds_read_b128 v[48:51],v7 offset:0
ds_read_b128 v[52:55],v7 offset:1024
v_smfmac_f32_16x16x64_bf16 v[80:83],v[36:39],v[240:247],v1
ds_read_b128 v[56:59],v7 offset:2048
ds_read_b128 v[60:63],v7 offset:3072
v_smfmac_f32_16x16x64_bf16 v[84:87],v[20:23],v[248:255],v1
ds_read_b128 v[64:67],v7 offset:4096
ds_read_b128 v[68:71],v7 offset:5120
v_smfmac_f32_16x16x64_bf16 v[84:87],v[36:39],v[248:255],v1
ds_read_b128 v[72:75],v7 offset:6144
ds_read_b128 v[76:79],v7 offset:7168
s_waitcnt lgkmcnt(6)
v_smfmac_f32_16x16x64_bf16 v[88:91],v[20:23],v[48:55],v1
v_smfmac_f32_16x16x64_bf16 v[88:91],v[36:39],v[48:55],v1
ds_read_b128 v[48:51],v7 offset:8192
ds_read_b128 v[52:55],v7 offset:9216
s_waitcnt lgkmcnt(6)
v_smfmac_f32_16x16x64_bf16 v[92:95],v[20:23],v[56:63],v1
v_smfmac_f32_16x16x64_bf16 v[92:95],v[36:39],v[56:63],v1
ds_read_b128 v[56:59],v7 offset:10240
ds_read_b128 v[60:63],v7 offset:11264
s_waitcnt lgkmcnt(6)
v_smfmac_f32_16x16x64_bf16 v[80:83],v[24:27],v[64:71],v1
v_smfmac_f32_16x16x64_bf16 v[80:83],v[40:43],v[64:71],v1
ds_read_b128 v[64:67],v7 offset:12288
ds_read_b128 v[68:71],v7 offset:13312
s_waitcnt lgkmcnt(6)
v_smfmac_f32_16x16x64_bf16 v[84:87],v[24:27],v[72:79],v1
v_smfmac_f32_16x16x64_bf16 v[84:87],v[40:43],v[72:79],v1
ds_read_b128 v[72:75],v7 offset:14336
ds_read_b128 v[76:79],v7 offset:15360
s_waitcnt lgkmcnt(6)
v_smfmac_f32_16x16x64_bf16 v[88:91],v[24:27],v[48:55],v1
v_smfmac_f32_16x16x64_bf16 v[88:91],v[40:43],v[48:55],v1
ds_read_b128 v[48:51],v7 offset:16384
ds_read_b128 v[52:55],v7 offset:17408
s_waitcnt lgkmcnt(6)
v_smfmac_f32_16x16x64_bf16 v[92:95],v[24:27],v[56:63],v1
v_smfmac_f32_16x16x64_bf16 v[92:95],v[40:43],v[56:63],v1
ds_read_b128 v[56:59],v7 offset:18432
ds_read_b128 v[60:63],v7 offset:19456
s_waitcnt lgkmcnt(6)
v_smfmac_f32_16x16x64_bf16 v[80:83],v[28:31],v[64:71],v1
v_smfmac_f32_16x16x64_bf16 v[80:83],v[44:47],v[64:71],v1
s_waitcnt lgkmcnt(4)
v_smfmac_f32_16x16x64_bf16 v[84:87],v[28:31],v[72:79],v1
v_smfmac_f32_16x16x64_bf16 v[84:87],v[44:47],v[72:79],v1
s_waitcnt lgkmcnt(2)
v_smfmac_f32_16x16x64_bf16 v[88:91],v[28:31],v[48:55],v1
v_add_f32 v80,v80,v81
v_smfmac_f32_16x16x64_bf16 v[88:91],v[44:47],v[48:55],v1
v_add_f32 v82,v82,v83
s_waitcnt lgkmcnt(0)
v_smfmac_f32_16x16x64_bf16 v[92:95],v[28:31],v[56:63],v1
v_cvt_pk_bf16_f32 v80,v80,v82
v_smfmac_f32_16x16x64_bf16 v[92:95],v[44:47],v[56:63],v1
ds_write_addtid_b32 v80 offset:16896
v_add_f32 v84,v84,v85
v_add_f32 v86,v86,v87
v_cvt_pk_bf16_f32 v84,v84,v86
v_add_f32 v88,v88,v89
v_add_f32 v90,v90,v91
v_cvt_pk_bf16_f32 v88,v88,v90
s_nop 0
v_add_f32 v92,v92,v93
v_add_f32 v94,v94,v95
v_cvt_pk_bf16_f32 v92,v92,v94
ds_write_addtid_b32 v84 offset:17920
ds_write_addtid_b32 v88 offset:18944
ds_write_addtid_b32 v92 offset:19968
s_waitcnt lgkmcnt(0)
s_barrier
s_cmp_gt_u32 s50,1
s_cbranch_scc1 l23_100684
ds_read2st64_b32 v[112:113],v127 offset0:66 offset1:67
ds_read2st64_b32 v[114:115],v127 offset0:68 offset1:69
ds_read2st64_b32 v[116:117],v127 offset0:70 offset1:71
ds_read2st64_b32 v[118:119],v127 offset0:72 offset1:73
s_waitcnt lgkmcnt(0)
v_mov_b32 v120,v5
v_mov_b32 v121,v5
v_mov_b32 v122,v5
v_mov_b32 v123,v5
s_nop 1
v_mfma_f32_16x16x32_bf16 v[112:115],v[120:123],v[112:115],0
v_mfma_f32_16x16x32_bf16 v[116:119],v[120:123],v[116:119],0
s_nop 4
v_cvt_pk_bf16_f32 v112,v112,v113
v_cvt_pk_bf16_f32 v113,v114,v115
s_nop 0
v_cvt_pk_bf16_f32 v114,v116,v117
v_cvt_pk_bf16_f32 v115,v118,v119
s_branch lj_100685
l23_100684:
ds_read_b128 v[48:51],v2 offset:0
ds_read_b128 v[52:55],v2 offset:256
ds_read_b128 v[56:59],v2 offset:512
ds_read_b128 v[60:63],v2 offset:768
ds_read_b128 v[64:67],v2 offset:16
ds_read_b128 v[68:71],v2 offset:272
ds_read_b128 v[72:75],v2 offset:528
ds_read_b128 v[76:79],v2 offset:784
s_waitcnt lgkmcnt(6)
v_pk_add_f32 v[48:49],v[48:49],v[52:53]
v_pk_add_f32 v[50:51],v[50:51],v[54:55]
s_waitcnt lgkmcnt(4)
v_pk_add_f32 v[56:57],v[56:57],v[60:61]
v_pk_add_f32 v[58:59],v[58:59],v[62:63]
v_pk_add_f32 v[48:49],v[48:49],v[56:57]
v_pk_add_f32 v[50:51],v[50:51],v[58:59]
v_cvt_pk_bf16_f32 v112,v48,v49
v_cvt_pk_bf16_f32 v113,v50,v51
s_waitcnt lgkmcnt(2)
v_pk_add_f32 v[64:65],v[64:65],v[68:69]
v_pk_add_f32 v[66:67],v[66:67],v[70:71]
s_waitcnt lgkmcnt(0)
v_pk_add_f32 v[72:73],v[72:73],v[76:77]
v_pk_add_f32 v[74:75],v[74:75],v[78:79]
v_pk_add_f32 v[64:65],v[64:65],v[72:73]
v_pk_add_f32 v[66:67],v[66:67],v[74:75]
v_cvt_pk_bf16_f32 v114,v64,v65
v_cvt_pk_bf16_f32 v115,v66,v67
lj_100685:
v_cndmask_b32 v120,2.0,v0,s[82:83]
v_cndmask_b32 v121,2.0,v127,s[86:87]
buffer_store_dwordx4 v[112:115],v120,s[20:23],s101 offen sc1
s_waitcnt vmcnt(0)
s_barrier
v_mov_b32 v126,64
buffer_store_dword v126,v121,s[20:23],s69 offen sc1
s_branch recfin_100192
flp_100594:
buffer_load_dword v124,off,s[20:23],s68 sc1
s_waitcnt vmcnt(0)
v_readfirstlane_b32 s91,v124
s_cmp_gt_u32 s91,s64
s_cbranch_scc1 fok_100593
s_sleep 2
s_sub_u32 s90,s90,1
s_cmp_gt_i32 s90,0
s_cbranch_scc1 flp_100594
s_branch fok_100593
flp_100597:
buffer_load_dword v124,off,s[20:23],s68 sc1
s_waitcnt vmcnt(0)
v_readfirstlane_b32 s91,v124
s_cmp_gt_u32 s91,s64
s_cbranch_scc1 fok_100596
s_sleep 2
s_sub_u32 s90,s90,1
s_cmp_gt_i32 s90,0
s_cbranch_scc1 flp_100597
s_branch fok_100596
fl_100614:
flb_100622:
buffer_load_dwordx4 v[16:19],v0,s[20:23],s92 offen offset:0 sc1
s_mov_b32 s55,1
buffer_load_dwordx4 v[32:35],v0,s[20:23],s93 offen offset:0 sc1
s_waitcnt vmcnt(4)
v_max3_u32 v124,v20,v21,v22
v_max_u32 v124,v124,v23
v_cmp_eq_u32 vcc,-1,v124
s_cbranch_vccnz dfl_100686
v_smfmac_f32_16x16x64_bf16 v[48:51],v[20:23],a[64:71],v1
buffer_load_dword v125,off,s[20:23],s92 sc1
v_smfmac_f32_16x16x64_bf16 v[52:55],v[20:23],a[72:79],v1
buffer_load_dwordx4 v[36:39],v0,s[20:23],s93 offen offset:1024 sc1
v_smfmac_f32_16x16x64_bf16 v[56:59],v[20:23],a[80:87],v1
s_waitcnt vmcnt(5)
v_max3_u32 v124,v24,v25,v26
v_smfmac_f32_16x16x64_bf16 v[60:63],v[20:23],a[88:95],v1
v_max_u32 v124,v124,v27
v_smfmac_f32_16x16x64_bf16 v[64:67],v[20:23],a[96:103],v1
v_cmp_eq_u32 vcc,-1,v124
v_smfmac_f32_16x16x64_bf16 v[68:71],v[20:23],a[104:111],v1
v_smfmac_f32_16x16x64_bf16 v[72:75],v[20:23],a[112:119],v1
v_smfmac_f32_16x16x64_bf16 v[76:79],v[20:23],a[120:127],v1
s_cbranch_vccnz dfl_100687
v_smfmac_f32_16x16x64_bf16 v[48:51],v[24:27],a[128:135],v1
buffer_load_dword v125,off,s[20:23],s92 sc1
v_smfmac_f32_16x16x64_bf16 v[52:55],v[24:27],a[136:143],v1
buffer_load_dwordx4 v[40:43],v0,s[20:23],s93 offen offset:2048 sc1
v_smfmac_f32_16x16x64_bf16 v[56:59],v[24:27],a[144:151],v1
buffer_load_dwordx4 v[44:47],v0,s[20:23],s93 offen offset:3072 sc1
s_waitcnt vmcnt(7)
v_max3_u32 v124,v28,v29,v30
v_smfmac_f32_16x16x64_bf16 v[60:63],v[24:27],a[152:159],v1
v_max_u32 v124,v124,v31
v_smfmac_f32_16x16x64_bf16 v[64:67],v[24:27],a[160:167],v1
v_cmp_eq_u32 vcc,-1,v124
v_smfmac_f32_16x16x64_bf16 v[68:71],v[24:27],a[168:175],v1
v_smfmac_f32_16x16x64_bf16 v[72:75],v[24:27],a[176:183],v1
v_smfmac_f32_16x16x64_bf16 v[76:79],v[24:27],a[184:191],v1
s_cbranch_vccnz dfl_100688
v_smfmac_f32_16x16x64_bf16 v[48:51],v[28:31],a[192:199],v1
buffer_load_dword v125,off,s[20:23],s92 sc1
v_smfmac_f32_16x16x64_bf16 v[52:55],v[28:31],a[200:207],v1
v_smfmac_f32_16x16x64_bf16 v[56:59],v[28:31],a[208:215],v1
s_waitcnt vmcnt(7)
v_max3_u32 v124,v16,v17,v18
v_smfmac_f32_16x16x64_bf16 v[60:63],v[28:31],a[216:223],v1
v_max_u32 v124,v124,v19
v_smfmac_f32_16x16x64_bf16 v[64:67],v[28:31],a[224:231],v1
v_cmp_eq_u32 vcc,-1,v124
v_smfmac_f32_16x16x64_bf16 v[68:71],v[28:31],a[232:239],v1
v_smfmac_f32_16x16x64_bf16 v[72:75],v[28:31],a[240:247],v1
v_smfmac_f32_16x16x64_bf16 v[76:79],v[28:31],a[248:255],v1
s_cbranch_vccnz lfb_100693
s_mov_b32 s55,0
v_smfmac_f32_16x16x64_bf16 v[48:51],v[16:19],a[0:7],v1
v_smfmac_f32_16x16x64_bf16 v[52:55],v[16:19],a[8:15],v1
v_smfmac_f32_16x16x64_bf16 v[56:59],v[16:19],a[16:23],v1
s_waitcnt vmcnt(6)
v_max3_u32 v124,v32,v33,v34
v_max_u32 v124,v124,v35
v_cmp_eq_u32 vcc,-1,v124
v_smfmac_f32_16x16x64_bf16 v[60:63],v[16:19],a[24:31],v1
v_smfmac_f32_16x16x64_bf16 v[64:67],v[16:19],a[32:39],v1
v_smfmac_f32_16x16x64_bf16 v[68:71],v[16:19],a[40:47],v1
v_smfmac_f32_16x16x64_bf16 v[72:75],v[16:19],a[48:55],v1
v_smfmac_f32_16x16x64_bf16 v[76:79],v[16:19],a[56:63],v1
s_cbranch_vccnz flb_100626
s_branch segb_100610
fl_100615:
v_smfmac_f32_16x16x64_bf16 v[76:79],v[16:19],a[56:63],v1
flb_100623:
buffer_load_dwordx4 v[20:23],v0,s[20:23],s92 offen offset:1024 sc1
s_mov_b32 s55,2
buffer_load_dwordx4 v[36:39],v0,s[20:23],s93 offen offset:1024 sc1
s_waitcnt vmcnt(5)
v_max3_u32 v124,v24,v25,v26
v_max_u32 v124,v124,v27
v_cmp_eq_u32 vcc,-1,v124
s_cbranch_vccnz dfl_100687
v_smfmac_f32_16x16x64_bf16 v[48:51],v[24:27],a[128:135],v1
buffer_load_dword v125,off,s[20:23],s92 sc1
v_smfmac_f32_16x16x64_bf16 v[52:55],v[24:27],a[136:143],v1
buffer_load_dwordx4 v[40:43],v0,s[20:23],s93 offen offset:2048 sc1
v_smfmac_f32_16x16x64_bf16 v[56:59],v[24:27],a[144:151],v1
buffer_load_dwordx4 v[44:47],v0,s[20:23],s93 offen offset:3072 sc1
s_waitcnt vmcnt(7)
v_max3_u32 v124,v28,v29,v30
v_smfmac_f32_16x16x64_bf16 v[60:63],v[24:27],a[152:159],v1
v_max_u32 v124,v124,v31
v_smfmac_f32_16x16x64_bf16 v[64:67],v[24:27],a[160:167],v1
v_cmp_eq_u32 vcc,-1,v124
v_smfmac_f32_16x16x64_bf16 v[68:71],v[24:27],a[168:175],v1
v_smfmac_f32_16x16x64_bf16 v[72:75],v[24:27],a[176:183],v1
v_smfmac_f32_16x16x64_bf16 v[76:79],v[24:27],a[184:191],v1
s_cbranch_vccnz dfl_100688
v_smfmac_f32_16x16x64_bf16 v[48:51],v[28:31],a[192:199],v1
buffer_load_dword v125,off,s[20:23],s92 sc1
v_smfmac_f32_16x16x64_bf16 v[52:55],v[28:31],a[200:207],v1
v_smfmac_f32_16x16x64_bf16 v[56:59],v[28:31],a[208:215],v1
s_waitcnt vmcnt(5)
v_max3_u32 v124,v20,v21,v22
v_smfmac_f32_16x16x64_bf16 v[60:63],v[28:31],a[216:223],v1
v_max_u32 v124,v124,v23
v_smfmac_f32_16x16x64_bf16 v[64:67],v[28:31],a[224:231],v1
v_cmp_eq_u32 vcc,-1,v124
v_smfmac_f32_16x16x64_bf16 v[68:71],v[28:31],a[232:239],v1
v_smfmac_f32_16x16x64_bf16 v[72:75],v[28:31],a[240:247],v1
v_smfmac_f32_16x16x64_bf16 v[76:79],v[28:31],a[248:255],v1
s_cbranch_vccnz lfb_100693
s_mov_b32 s55,0
v_smfmac_f32_16x16x64_bf16 v[48:51],v[20:23],a[64:71],v1
v_smfmac_f32_16x16x64_bf16 v[52:55],v[20:23],a[72:79],v1
v_smfmac_f32_16x16x64_bf16 v[56:59],v[20:23],a[80:87],v1
s_waitcnt vmcnt(6)
v_max3_u32 v124,v32,v33,v34
v_max_u32 v124,v124,v35
v_cmp_eq_u32 vcc,-1,v124
v_smfmac_f32_16x16x64_bf16 v[60:63],v[20:23],a[88:95],v1
v_smfmac_f32_16x16x64_bf16 v[64:67],v[20:23],a[96:103],v1
v_smfmac_f32_16x16x64_bf16 v[68:71],v[20:23],a[104:111],v1
v_smfmac_f32_16x16x64_bf16 v[72:75],v[20:23],a[112:119],v1
v_smfmac_f32_16x16x64_bf16 v[76:79],v[20:23],a[120:127],v1
s_cbranch_vccnz flb_100626
s_branch segb_100610
fl_100616:
v_smfmac_f32_16x16x64_bf16 v[76:79],v[20:23],a[120:127],v1
flb_100624:
buffer_load_dwordx4 v[24:27],v0,s[20:23],s92 offen offset:2048 sc1
s_mov_b32 s55,4
buffer_load_dwordx4 v[40:43],v0,s[20:23],s93 offen offset:2048 sc1
buffer_load_dwordx4 v[44:47],v0,s[20:23],s93 offen offset:3072 sc1
s_waitcnt vmcnt(7)
v_max3_u32 v124,v28,v29,v30
v_max_u32 v124,v124,v31
v_cmp_eq_u32 vcc,-1,v124
s_cbranch_vccnz dfl_100688
v_smfmac_f32_16x16x64_bf16 v[48:51],v[28:31],a[192:199],v1
buffer_load_dword v125,off,s[20:23],s92 sc1
v_smfmac_f32_16x16x64_bf16 v[52:55],v[28:31],a[200:207],v1
v_smfmac_f32_16x16x64_bf16 v[56:59],v[28:31],a[208:215],v1
s_waitcnt vmcnt(3)
v_max3_u32 v124,v24,v25,v26
v_smfmac_f32_16x16x64_bf16 v[60:63],v[28:31],a[216:223],v1
v_max_u32 v124,v124,v27
v_smfmac_f32_16x16x64_bf16 v[64:67],v[28:31],a[224:231],v1
v_cmp_eq_u32 vcc,-1,v124
v_smfmac_f32_16x16x64_bf16 v[68:71],v[28:31],a[232:239],v1
v_smfmac_f32_16x16x64_bf16 v[72:75],v[28:31],a[240:247],v1
v_smfmac_f32_16x16x64_bf16 v[76:79],v[28:31],a[248:255],v1
s_cbranch_vccnz lfb_100693
s_mov_b32 s55,0
v_smfmac_f32_16x16x64_bf16 v[48:51],v[24:27],a[128:135],v1
v_smfmac_f32_16x16x64_bf16 v[52:55],v[24:27],a[136:143],v1
v_smfmac_f32_16x16x64_bf16 v[56:59],v[24:27],a[144:151],v1
s_waitcnt vmcnt(6)
v_max3_u32 v124,v32,v33,v34
v_max_u32 v124,v124,v35
v_cmp_eq_u32 vcc,-1,v124
v_smfmac_f32_16x16x64_bf16 v[60:63],v[24:27],a[152:159],v1
v_smfmac_f32_16x16x64_bf16 v[64:67],v[24:27],a[160:167],v1
v_smfmac_f32_16x16x64_bf16 v[68:71],v[24:27],a[168:175],v1
v_smfmac_f32_16x16x64_bf16 v[72:75],v[24:27],a[176:183],v1
v_smfmac_f32_16x16x64_bf16 v[76:79],v[24:27],a[184:191],v1
s_cbranch_vccnz flb_100626
s_branch segb_100610
fl_100617:
v_smfmac_f32_16x16x64_bf16 v[76:79],v[24:27],a[184:191],v1
flb_100625:
buffer_load_dwordx4 v[28:31],v0,s[20:23],s92 offen offset:3072 sc1
s_mov_b32 s55,8
s_waitcnt vmcnt(0)
v_max3_u32 v124,v28,v29,v30
v_max_u32 v124,v124,v31
v_cmp_eq_u32 vcc,-1,v124
s_cbranch_vccnz lfb_100693
s_mov_b32 s55,0
v_smfmac_f32_16x16x64_bf16 v[48:51],v[28:31],a[192:199],v1
v_smfmac_f32_16x16x64_bf16 v[52:55],v[28:31],a[200:207],v1
v_smfmac_f32_16x16x64_bf16 v[56:59],v[28:31],a[208:215],v1
s_waitcnt vmcnt(6)
v_max3_u32 v124,v32,v33,v34
v_max_u32 v124,v124,v35
v_cmp_eq_u32 vcc,-1,v124
v_smfmac_f32_16x16x64_bf16 v[60:63],v[28:31],a[216:223],v1
v_smfmac_f32_16x16x64_bf16 v[64:67],v[28:31],a[224:231],v1
v_smfmac_f32_16x16x64_bf16 v[68:71],v[28:31],a[232:239],v1
v_smfmac_f32_16x16x64_bf16 v[72:75],v[28:31],a[240:247],v1
v_smfmac_f32_16x16x64_bf16 v[76:79],v[28:31],a[248:255],v1
s_cbranch_vccnz flb_100626
s_branch segb_100610
fl_100618:
v_smfmac_f32_16x16x64_bf16 v[76:79],v[28:31],a[248:255],v1
flb_100626:
buffer_load_dwordx4 v[32:35],v0,s[20:23],s93 offen offset:0 sc1
s_mov_b32 s55,240
buffer_store_dwordx4 v[112:115],v120,s[20:23],s101 offen sc1
buffer_store_dword v126,v121,s[20:23],s69 offen sc1
s_bitcmp1_b32 s55,5
s_cbranch_scc0 rdn_100696
s_waitcnt vmcnt(7)
v_max3_u32 v124,v36,v37,v38
v_max_u32 v124,v124,v39
v_cmp_eq_u32 vcc,-1,v124
s_cbranch_vccnz rfa_100697
buffer_load_dword v125,off,s[20:23],s92 sc1
s_bitset0_b32 s55,5
v_smfmac_f32_16x16x64_bf16 v[48:51],v[36:39],a[64:71],v1
v_smfmac_f32_16x16x64_bf16 v[52:55],v[36:39],a[72:79],v1
v_smfmac_f32_16x16x64_bf16 v[56:59],v[36:39],a[80:87],v1
v_smfmac_f32_16x16x64_bf16 v[60:63],v[36:39],a[88:95],v1
v_smfmac_f32_16x16x64_bf16 v[64:67],v[36:39],a[96:103],v1
v_smfmac_f32_16x16x64_bf16 v[68:71],v[36:39],a[104:111],v1
v_smfmac_f32_16x16x64_bf16 v[72:75],v[36:39],a[112:119],v1
v_smfmac_f32_16x16x64_bf16 v[76:79],v[36:39],a[120:127],v1
s_cmp_eq_u32 s55,0
s_cbranch_scc1 segb_100612
s_branch rnx_100698
rdn_100696:
buffer_load_dword v125,off,s[20:23],s92 sc1
s_branch rnx_100698
rfa_100697:
buffer_load_dwordx4 v[36:39],v0,s[20:23],s93 offen offset:1024 sc1
rnx_100698:
s_bitcmp1_b32 s55,6
s_cbranch_scc0 rdn_100699
s_waitcnt vmcnt(6)
v_max3_u32 v124,v40,v41,v42
v_max_u32 v124,v124,v43
v_cmp_eq_u32 vcc,-1,v124
s_cbranch_vccnz rfa_100700
buffer_load_dword v125,off,s[20:23],s92 sc1
s_bitset0_b32 s55,6
s_cmp_eq_u32 s55,0
s_cbranch_scc1 segb_100612
s_branch rnx_100701
rdn_100699:
buffer_load_dword v125,off,s[20:23],s92 sc1
s_branch rnx_100701
rfa_100700:
buffer_load_dwordx4 v[40:43],v0,s[20:23],s93 offen offset:2048 sc1
rnx_100701:
s_bitcmp1_b32 s55,7
s_cbranch_scc0 rdn_100702
s_waitcnt vmcnt(6)
v_max3_u32 v124,v44,v45,v46
v_max_u32 v124,v124,v47
v_cmp_eq_u32 vcc,-1,v124
s_cbranch_vccnz rfa_100703
buffer_load_dword v125,off,s[20:23],s92 sc1
s_bitset0_b32 s55,7
s_cmp_eq_u32 s55,0
s_cbranch_scc1 segb_100612
s_branch rnx_100704
rdn_100702:
buffer_load_dword v125,off,s[20:23],s92 sc1
s_branch rnx_100704
rfa_100703:
buffer_load_dwordx4 v[44:47],v0,s[20:23],s93 offen offset:3072 sc1
rnx_100704:
rot_100695:
s_bitcmp1_b32 s55,4
s_cbranch_scc0 rdn_100705
s_waitcnt vmcnt(3)
v_max3_u32 v124,v32,v33,v34
v_max_u32 v124,v124,v35
v_cmp_eq_u32 vcc,-1,v124
s_cbranch_vccnz rfa_100706
buffer_load_dword v125,off,s[20:23],s92 sc1
s_bitset0_b32 s55,4
v_smfmac_f32_16x16x64_bf16 v[48:51],v[32:35],a[0:7],v1
v_smfmac_f32_16x16x64_bf16 v[52:55],v[32:35],a[8:15],v1
v_smfmac_f32_16x16x64_bf16 v[56:59],v[32:35],a[16:23],v1
v_smfmac_f32_16x16x64_bf16 v[60:63],v[32:35],a[24:31],v1
v_smfmac_f32_16x16x64_bf16 v[64:67],v[32:35],a[32:39],v1
v_smfmac_f32_16x16x64_bf16 v[68:71],v[32:35],a[40:47],v1
v_smfmac_f32_16x16x64_bf16 v[72:75],v[32:35],a[48:55],v1
v_smfmac_f32_16x16x64_bf16 v[76:79],v[32:35],a[56:63],v1
s_cmp_eq_u32 s55,0
s_cbranch_scc1 segb_100612
s_branch rnx_100707
rdn_100705:
buffer_load_dword v125,off,s[20:23],s92 sc1
s_branch rnx_100707
rfa_100706:
buffer_load_dwordx4 v[32:35],v0,s[20:23],s93 offen offset:0 sc1
rnx_100707:
s_bitcmp1_b32 s55,5
s_cbranch_scc0 rdn_100708
s_waitcnt vmcnt(3)
v_max3_u32 v124,v36,v37,v38
v_max_u32 v124,v124,v39
v_cmp_eq_u32 vcc,-1,v124
s_cbranch_vccnz rfa_100709
buffer_load_dword v125,off,s[20:23],s92 sc1
s_bitset0_b32 s55,5
v_smfmac_f32_16x16x64_bf16 v[48:51],v[36:39],a[64:71],v1
v_smfmac_f32_16x16x64_bf16 v[52:55],v[36:39],a[72:79],v1
v_smfmac_f32_16x16x64_bf16 v[56:59],v[36:39],a[80:87],v1
v_smfmac_f32_16x16x64_bf16 v[60:63],v[36:39],a[88:95],v1
v_smfmac_f32_16x16x64_bf16 v[64:67],v[36:39],a[96:103],v1
v_smfmac_f32_16x16x64_bf16 v[68:71],v[36:39],a[104:111],v1
v_smfmac_f32_16x16x64_bf16 v[72:75],v[36:39],a[112:119],v1
v_smfmac_f32_16x16x64_bf16 v[76:79],v[36:39],a[120:127],v1
s_cmp_eq_u32 s55,0
s_cbranch_scc1 segb_100612
s_branch rnx_100710
rdn_100708:
buffer_load_dword v125,off,s[20:23],s92 sc1
s_branch rnx_100710
rfa_100709:
buffer_load_dwordx4 v[36:39],v0,s[20:23],s93 offen offset:1024 sc1
rnx_100710:
s_bitcmp1_b32 s55,6
s_cbranch_scc0 rdn_100711
s_waitcnt vmcnt(3)
v_max3_u32 v124,v40,v41,v42
v_max_u32 v124,v124,v43
v_cmp_eq_u32 vcc,-1,v124
s_cbranch_vccnz rfa_100712
buffer_load_dword v125,off,s[20:23],s92 sc1
s_bitset0_b32 s55,6
s_cmp_eq_u32 s55,0
s_cbranch_scc1 segb_100612
s_branch rnx_100713
rdn_100711:
buffer_load_dword v125,off,s[20:23],s92 sc1
s_branch rnx_100713
rfa_100712:
buffer_load_dwordx4 v[40:43],v0,s[20:23],s93 offen offset:2048 sc1
rnx_100713:
s_bitcmp1_b32 s55,7
s_cbranch_scc0 rdn_100714
s_waitcnt vmcnt(3)
v_max3_u32 v124,v44,v45,v46
v_max_u32 v124,v124,v47
v_cmp_eq_u32 vcc,-1,v124
s_cbranch_vccnz rfa_100715
buffer_load_dword v125,off,s[20:23],s92 sc1
s_bitset0_b32 s55,7
s_cmp_eq_u32 s55,0
s_cbranch_scc1 segb_100612
s_branch rnx_100716
rdn_100714:
buffer_load_dword v125,off,s[20:23],s92 sc1
s_branch rnx_100716
rfa_100715:
buffer_load_dwordx4 v[44:47],v0,s[20:23],s93 offen offset:3072 sc1
rnx_100716:
s_sub_u32 s90,s90,1
s_cmp_gt_i32 s90,0
s_cbranch_scc1 rot_100695
s_mov_b32 s55,0
s_branch segb_100612
fl_100619:
v_smfmac_f32_16x16x64_bf16 v[76:79],v[32:35],a[56:63],v1
flb_100627:
buffer_load_dwordx4 v[36:39],v0,s[20:23],s93 offen offset:1024 sc1
s_mov_b32 s55,224
s_bitcmp1_b32 s55,6
s_cbranch_scc0 rdn_100718
s_waitcnt vmcnt(6)
v_max3_u32 v124,v40,v41,v42
v_max_u32 v124,v124,v43
v_cmp_eq_u32 vcc,-1,v124
s_cbranch_vccnz rfa_100719
buffer_load_dword v125,off,s[20:23],s92 sc1
s_bitset0_b32 s55,6
s_cmp_eq_u32 s55,0
s_cbranch_scc1 segb_100612
s_branch rnx_100720
rdn_100718:
buffer_load_dword v125,off,s[20:23],s92 sc1
s_branch rnx_100720
rfa_100719:
buffer_load_dwordx4 v[40:43],v0,s[20:23],s93 offen offset:2048 sc1
rnx_100720:
s_bitcmp1_b32 s55,7
s_cbranch_scc0 rdn_100721
s_waitcnt vmcnt(6)
v_max3_u32 v124,v44,v45,v46
v_max_u32 v124,v124,v47
v_cmp_eq_u32 vcc,-1,v124
s_cbranch_vccnz rfa_100722
buffer_load_dword v125,off,s[20:23],s92 sc1
s_bitset0_b32 s55,7
s_cmp_eq_u32 s55,0
s_cbranch_scc1 segb_100612
s_branch rnx_100723
rdn_100721:
buffer_load_dword v125,off,s[20:23],s92 sc1
s_branch rnx_100723
rfa_100722:
buffer_load_dwordx4 v[44:47],v0,s[20:23],s93 offen offset:3072 sc1
rnx_100723:
rot_100717:
s_bitcmp1_b32 s55,5
s_cbranch_scc0 rdn_100724
s_waitcnt vmcnt(2)
v_max3_u32 v124,v36,v37,v38
v_max_u32 v124,v124,v39
v_cmp_eq_u32 vcc,-1,v124
s_cbranch_vccnz rfa_100725
buffer_load_dword v125,off,s[20:23],s92 sc1
s_bitset0_b32 s55,5
v_smfmac_f32_16x16x64_bf16 v[48:51],v[36:39],a[64:71],v1
v_smfmac_f32_16x16x64_bf16 v[52:55],v[36:39],a[72:79],v1
v_smfmac_f32_16x16x64_bf16 v[56:59],v[36:39],a[80:87],v1
v_smfmac_f32_16x16x64_bf16 v[60:63],v[36:39],a[88:95],v1
v_smfmac_f32_16x16x64_bf16 v[64:67],v[36:39],a[96:103],v1
v_smfmac_f32_16x16x64_bf16 v[68:71],v[36:39],a[104:111],v1
v_smfmac_f32_16x16x64_bf16 v[72:75],v[36:39],a[112:119],v1
v_smfmac_f32_16x16x64_bf16 v[76:79],v[36:39],a[120:127],v1
s_cmp_eq_u32 s55,0
s_cbranch_scc1 segb_100612
s_branch rnx_100726
rdn_100724:
buffer_load_dword v125,off,s[20:23],s92 sc1
s_branch rnx_100726
rfa_100725:
buffer_load_dwordx4 v[36:39],v0,s[20:23],s93 offen offset:1024 sc1
rnx_100726:
s_bitcmp1_b32 s55,6
s_cbranch_scc0 rdn_100727
s_waitcnt vmcnt(2)
v_max3_u32 v124,v40,v41,v42
v_max_u32 v124,v124,v43
v_cmp_eq_u32 vcc,-1,v124
s_cbranch_vccnz rfa_100728
buffer_load_dword v125,off,s[20:23],s92 sc1
s_bitset0_b32 s55,6
s_cmp_eq_u32 s55,0
s_cbranch_scc1 segb_100612
s_branch rnx_100729
rdn_100727:
buffer_load_dword v125,off,s[20:23],s92 sc1
s_branch rnx_100729
rfa_100728:
buffer_load_dwordx4 v[40:43],v0,s[20:23],s93 offen offset:2048 sc1
rnx_100729:
s_bitcmp1_b32 s55,7
s_cbranch_scc0 rdn_100730
s_waitcnt vmcnt(2)
v_max3_u32 v124,v44,v45,v46
v_max_u32 v124,v124,v47
v_cmp_eq_u32 vcc,-1,v124
s_cbranch_vccnz rfa_100731
buffer_load_dword v125,off,s[20:23],s92 sc1
s_bitset0_b32 s55,7
s_cmp_eq_u32 s55,0
s_cbranch_scc1 segb_100612
s_branch rnx_100732
rdn_100730:
buffer_load_dword v125,off,s[20:23],s92 sc1
s_branch rnx_100732
rfa_100731:
buffer_load_dwordx4 v[44:47],v0,s[20:23],s93 offen offset:3072 sc1
rnx_100732:
s_sub_u32 s90,s90,1
s_cmp_gt_i32 s90,0
s_cbranch_scc1 rot_100717
s_mov_b32 s55,0
s_branch segb_100612
fl_100620:
v_smfmac_f32_16x16x64_bf16 v[76:79],v[36:39],a[120:127],v1
flb_100628:
s_mov_b32 s55,192
s_bitcmp1_b32 s55,6
s_cbranch_scc0 rdn_100734
s_waitcnt vmcnt(6)
v_max3_u32 v124,v40,v41,v42
v_max_u32 v124,v124,v43
v_cmp_eq_u32 vcc,-1,v124
s_cbranch_vccnz rfa_100735
buffer_load_dword v125,off,s[20:23],s92 sc1
s_bitset0_b32 s55,6
s_cmp_eq_u32 s55,0
s_cbranch_scc1 segb_100612
s_branch rnx_100736
rdn_100734:
buffer_load_dword v125,off,s[20:23],s92 sc1
s_branch rnx_100736
rfa_100735:
buffer_load_dwordx4 v[40:43],v0,s[20:23],s93 offen offset:2048 sc1
rnx_100736:
s_bitcmp1_b32 s55,7
s_cbranch_scc0 rdn_100737
s_waitcnt vmcnt(6)
v_max3_u32 v124,v44,v45,v46
v_max_u32 v124,v124,v47
v_cmp_eq_u32 vcc,-1,v124
s_cbranch_vccnz rfa_100738
buffer_load_dword v125,off,s[20:23],s92 sc1
s_bitset0_b32 s55,7
s_cmp_eq_u32 s55,0
s_cbranch_scc1 segb_100612
s_branch rnx_100739
rdn_100737:
buffer_load_dword v125,off,s[20:23],s92 sc1
s_branch rnx_100739
rfa_100738:
buffer_load_dwordx4 v[44:47],v0,s[20:23],s93 offen offset:3072 sc1
rnx_100739:
rot_100733:
s_bitcmp1_b32 s55,6
s_cbranch_scc0 rdn_100740
s_waitcnt vmcnt(1)
v_max3_u32 v124,v40,v41,v42
v_max_u32 v124,v124,v43
v_cmp_eq_u32 vcc,-1,v124
s_cbranch_vccnz rfa_100741
buffer_load_dword v125,off,s[20:23],s92 sc1
s_bitset0_b32 s55,6
s_cmp_eq_u32 s55,0
s_cbranch_scc1 segb_100612
s_branch rnx_100742
rdn_100740:
buffer_load_dword v125,off,s[20:23],s92 sc1
s_branch rnx_100742
rfa_100741:
buffer_load_dwordx4 v[40:43],v0,s[20:23],s93 offen offset:2048 sc1
rnx_100742:
s_bitcmp1_b32 s55,7
s_cbranch_scc0 rdn_100743
s_waitcnt vmcnt(1)
v_max3_u32 v124,v44,v45,v46
v_max_u32 v124,v124,v47
v_cmp_eq_u32 vcc,-1,v124
s_cbranch_vccnz rfa_100744
buffer_load_dword v125,off,s[20:23],s92 sc1
s_bitset0_b32 s55,7
s_cmp_eq_u32 s55,0
s_cbranch_scc1 segb_100612
s_branch rnx_100745
rdn_100743:
buffer_load_dword v125,off,s[20:23],s92 sc1
s_branch rnx_100745
rfa_100744:
buffer_load_dwordx4 v[44:47],v0,s[20:23],s93 offen offset:3072 sc1
rnx_100745:
s_sub_u32 s90,s90,1
s_cmp_gt_i32 s90,0
s_cbranch_scc1 rot_100733
s_mov_b32 s55,0
s_branch segb_100612
dfl_100686:
buffer_load_dwordx4 v[20:23],v0,s[20:23],s92 offen offset:1024 sc1
s_bitset1_b32 s55,1
buffer_load_dwordx4 v[36:39],v0,s[20:23],s93 offen offset:1024 sc1
s_waitcnt vmcnt(5)
v_max3_u32 v124,v24,v25,v26
v_max_u32 v124,v124,v27
v_cmp_eq_u32 vcc,-1,v124
s_cbranch_vccnz dfl_100687
s_branch dseg_100690
dfl_100687:
buffer_load_dwordx4 v[24:27],v0,s[20:23],s92 offen offset:2048 sc1
s_bitset1_b32 s55,2
buffer_load_dwordx4 v[40:43],v0,s[20:23],s93 offen offset:2048 sc1
buffer_load_dwordx4 v[44:47],v0,s[20:23],s93 offen offset:3072 sc1
s_waitcnt vmcnt(7)
v_max3_u32 v124,v28,v29,v30
v_max_u32 v124,v124,v31
v_cmp_eq_u32 vcc,-1,v124
s_cbranch_vccnz dfl_100688
s_branch dseg_100691
dfl_100688:
buffer_load_dwordx4 v[28:31],v0,s[20:23],s92 offen offset:3072 sc1
s_bitset1_b32 s55,3
s_branch lap2_100692
dseg_100690:
v_smfmac_f32_16x16x64_bf16 v[48:51],v[24:27],a[128:135],v1
buffer_load_dword v125,off,s[20:23],s92 sc1
v_smfmac_f32_16x16x64_bf16 v[52:55],v[24:27],a[136:143],v1
buffer_load_dwordx4 v[40:43],v0,s[20:23],s93 offen offset:2048 sc1
v_smfmac_f32_16x16x64_bf16 v[56:59],v[24:27],a[144:151],v1
buffer_load_dwordx4 v[44:47],v0,s[20:23],s93 offen offset:3072 sc1
s_waitcnt vmcnt(7)
v_max3_u32 v124,v28,v29,v30
v_smfmac_f32_16x16x64_bf16 v[60:63],v[24:27],a[152:159],v1
v_max_u32 v124,v124,v31
v_smfmac_f32_16x16x64_bf16 v[64:67],v[24:27],a[160:167],v1
v_cmp_eq_u32 vcc,-1,v124
v_smfmac_f32_16x16x64_bf16 v[68:71],v[24:27],a[168:175],v1
v_smfmac_f32_16x16x64_bf16 v[72:75],v[24:27],a[176:183],v1
v_smfmac_f32_16x16x64_bf16 v[76:79],v[24:27],a[184:191],v1
s_cbranch_vccnz dfl_100688
dseg_100691:
v_smfmac_f32_16x16x64_bf16 v[48:51],v[28:31],a[192:199],v1
buffer_load_dword v125,off,s[20:23],s92 sc1
v_smfmac_f32_16x16x64_bf16 v[52:55],v[28:31],a[200:207],v1
v_smfmac_f32_16x16x64_bf16 v[56:59],v[28:31],a[208:215],v1
v_smfmac_f32_16x16x64_bf16 v[60:63],v[28:31],a[216:223],v1
v_smfmac_f32_16x16x64_bf16 v[64:67],v[28:31],a[224:231],v1
v_smfmac_f32_16x16x64_bf16 v[68:71],v[28:31],a[232:239],v1
v_smfmac_f32_16x16x64_bf16 v[72:75],v[28:31],a[240:247],v1
v_smfmac_f32_16x16x64_bf16 v[76:79],v[28:31],a[248:255],v1
lap2_100692:
s_bitcmp1_b32 s55,0
s_cbranch_scc0 l2s_100746
s_waitcnt vmcnt(7)
v_max3_u32 v124,v16,v17,v18
v_max_u32 v124,v124,v19
v_cmp_eq_u32 vcc,-1,v124
s_cbranch_vccnz l2s_100746
s_bitset0_b32 s55,0
v_smfmac_f32_16x16x64_bf16 v[48:51],v[16:19],a[0:7],v1
v_smfmac_f32_16x16x64_bf16 v[52:55],v[16:19],a[8:15],v1
v_smfmac_f32_16x16x64_bf16 v[56:59],v[16:19],a[16:23],v1
v_smfmac_f32_16x16x64_bf16 v[60:63],v[16:19],a[24:31],v1
v_smfmac_f32_16x16x64_bf16 v[64:67],v[16:19],a[32:39],v1
v_smfmac_f32_16x16x64_bf16 v[68:71],v[16:19],a[40:47],v1
v_smfmac_f32_16x16x64_bf16 v[72:75],v[16:19],a[48:55],v1
v_smfmac_f32_16x16x64_bf16 v[76:79],v[16:19],a[56:63],v1
l2s_100746:
s_bitcmp1_b32 s55,1
s_cbranch_scc0 l2s_100748
s_waitcnt vmcnt(5)
v_max3_u32 v124,v20,v21,v22
v_max_u32 v124,v124,v23
v_cmp_eq_u32 vcc,-1,v124
s_cbranch_vccnz l2s_100748
s_bitset0_b32 s55,1
v_smfmac_f32_16x16x64_bf16 v[48:51],v[20:23],a[64:71],v1
v_smfmac_f32_16x16x64_bf16 v[52:55],v[20:23],a[72:79],v1
v_smfmac_f32_16x16x64_bf16 v[56:59],v[20:23],a[80:87],v1
v_smfmac_f32_16x16x64_bf16 v[60:63],v[20:23],a[88:95],v1
v_smfmac_f32_16x16x64_bf16 v[64:67],v[20:23],a[96:103],v1
v_smfmac_f32_16x16x64_bf16 v[68:71],v[20:23],a[104:111],v1
v_smfmac_f32_16x16x64_bf16 v[72:75],v[20:23],a[112:119],v1
v_smfmac_f32_16x16x64_bf16 v[76:79],v[20:23],a[120:127],v1
l2s_100748:
s_bitcmp1_b32 s55,2
s_cbranch_scc0 l2s_100750
s_waitcnt vmcnt(3)
v_max3_u32 v124,v24,v25,v26
v_max_u32 v124,v124,v27
v_cmp_eq_u32 vcc,-1,v124
s_cbranch_vccnz l2s_100750
s_bitset0_b32 s55,2
v_smfmac_f32_16x16x64_bf16 v[48:51],v[24:27],a[128:135],v1
v_smfmac_f32_16x16x64_bf16 v[52:55],v[24:27],a[136:143],v1
v_smfmac_f32_16x16x64_bf16 v[56:59],v[24:27],a[144:151],v1
v_smfmac_f32_16x16x64_bf16 v[60:63],v[24:27],a[152:159],v1
v_smfmac_f32_16x16x64_bf16 v[64:67],v[24:27],a[160:167],v1
v_smfmac_f32_16x16x64_bf16 v[68:71],v[24:27],a[168:175],v1
v_smfmac_f32_16x16x64_bf16 v[72:75],v[24:27],a[176:183],v1
v_smfmac_f32_16x16x64_bf16 v[76:79],v[24:27],a[184:191],v1
l2s_100750:
s_bitcmp1_b32 s55,3
s_cbranch_scc0 l2s_100752
s_waitcnt vmcnt(0)
v_max3_u32 v124,v28,v29,v30
v_max_u32 v124,v124,v31
v_cmp_eq_u32 vcc,-1,v124
s_cbranch_vccnz l2s_100752
s_bitset0_b32 s55,3
v_smfmac_f32_16x16x64_bf16 v[48:51],v[28:31],a[192:199],v1
v_smfmac_f32_16x16x64_bf16 v[52:55],v[28:31],a[200:207],v1
v_smfmac_f32_16x16x64_bf16 v[56:59],v[28:31],a[208:215],v1
v_smfmac_f32_16x16x64_bf16 v[60:63],v[28:31],a[216:223],v1
v_smfmac_f32_16x16x64_bf16 v[64:67],v[28:31],a[224:231],v1
v_smfmac_f32_16x16x64_bf16 v[68:71],v[28:31],a[232:239],v1
v_smfmac_f32_16x16x64_bf16 v[72:75],v[28:31],a[240:247],v1
v_smfmac_f32_16x16x64_bf16 v[76:79],v[28:31],a[248:255],v1
l2s_100752:
s_cmp_eq_u32 s55,0
s_cbranch_scc0 lfb_100693
Ldone_100694:
s_waitcnt vmcnt(6)
v_max3_u32 v124,v32,v33,v34
v_max_u32 v124,v124,v35
v_cmp_eq_u32 vcc,-1,v124
s_cbranch_vccnz flb_100626
s_branch segb_100610
lfb_100693:
s_bitcmp1_b32 s55,0
s_cbranch_scc0 dsk_100754
buffer_load_dwordx4 v[16:19],v0,s[20:23],s92 offen offset:0 sc1
dsk_100754:
s_bitcmp1_b32 s55,1
s_cbranch_scc0 dsk_100755
buffer_load_dwordx4 v[20:23],v0,s[20:23],s92 offen offset:1024 sc1
dsk_100755:
s_bitcmp1_b32 s55,2
s_cbranch_scc0 dsk_100756
buffer_load_dwordx4 v[24:27],v0,s[20:23],s92 offen offset:2048 sc1
dsk_100756:
s_bitcmp1_b32 s55,3
s_cbranch_scc0 dsk_100757
buffer_load_dwordx4 v[28:31],v0,s[20:23],s92 offen offset:3072 sc1
dsk_100757:
s_bitcmp1_b32 s55,0
s_cbranch_scc0 dsk_100758
s_waitcnt vmcnt(2)
v_max3_u32 v124,v16,v17,v18
v_max_u32 v124,v124,v19
v_cmp_eq_u32 vcc,-1,v124
s_cbranch_vccz dgo_100759
s_nop 15
buffer_load_dwordx4 v[104:107],v0,s[20:23],s92 offen offset:0 sc1
s_nop 15
buffer_load_dwordx4 v[108:111],v0,s[20:23],s92 offen offset:0 sc1
dlp_100760:
s_waitcnt vmcnt(2)
v_max3_u32 v124,v16,v17,v18
v_max_u32 v124,v124,v19
v_cmp_eq_u32 vcc,-1,v124
s_cbranch_vccz dgo_100759
buffer_load_dwordx4 v[16:19],v0,s[20:23],s92 offen offset:0 sc1
s_waitcnt vmcnt(2)
v_max3_u32 v124,v104,v105,v106
v_max_u32 v124,v124,v107
v_cmp_eq_u32 vcc,-1,v124
s_cbranch_vccz dcp_100762
buffer_load_dwordx4 v[104:107],v0,s[20:23],s92 offen offset:0 sc1
s_waitcnt vmcnt(2)
v_max3_u32 v124,v108,v109,v110
v_max_u32 v124,v124,v111
v_cmp_eq_u32 vcc,-1,v124
s_cbranch_vccz dcp_100763
buffer_load_dwordx4 v[108:111],v0,s[20:23],s92 offen offset:0 sc1
s_sub_u32 s90,s90,1
s_cmp_gt_i32 s90,0
s_cbranch_scc1 dlp_100760
s_branch dgo_100759
dcp_100762:
v_mov_b32 v16,v104
v_mov_b32 v17,v105
v_mov_b32 v18,v106
v_mov_b32 v19,v107
s_nop 1
s_branch dgo_100759
dcp_100763:
v_mov_b32 v16,v108
v_mov_b32 v17,v109
v_mov_b32 v18,v110
v_mov_b32 v19,v111
s_nop 1
dgo_100759:
v_smfmac_f32_16x16x64_bf16 v[48:51],v[16:19],a[0:7],v1
v_smfmac_f32_16x16x64_bf16 v[52:55],v[16:19],a[8:15],v1
v_smfmac_f32_16x16x64_bf16 v[56:59],v[16:19],a[16:23],v1
v_smfmac_f32_16x16x64_bf16 v[60:63],v[16:19],a[24:31],v1
v_smfmac_f32_16x16x64_bf16 v[64:67],v[16:19],a[32:39],v1
v_smfmac_f32_16x16x64_bf16 v[68:71],v[16:19],a[40:47],v1
v_smfmac_f32_16x16x64_bf16 v[72:75],v[16:19],a[48:55],v1
v_smfmac_f32_16x16x64_bf16 v[76:79],v[16:19],a[56:63],v1
dsk_100758:
s_bitcmp1_b32 s55,1
s_cbranch_scc0 dsk_100764
s_waitcnt vmcnt(2)
v_max3_u32 v124,v20,v21,v22
v_max_u32 v124,v124,v23
v_cmp_eq_u32 vcc,-1,v124
s_cbranch_vccz dgo_100765
s_nop 15
buffer_load_dwordx4 v[104:107],v0,s[20:23],s92 offen offset:1024 sc1
s_nop 15
buffer_load_dwordx4 v[108:111],v0,s[20:23],s92 offen offset:1024 sc1
dlp_100766:
s_waitcnt vmcnt(2)
v_max3_u32 v124,v20,v21,v22
v_max_u32 v124,v124,v23
v_cmp_eq_u32 vcc,-1,v124
s_cbranch_vccz dgo_100765
buffer_load_dwordx4 v[20:23],v0,s[20:23],s92 offen offset:1024 sc1
s_waitcnt vmcnt(2)
v_max3_u32 v124,v104,v105,v106
v_max_u32 v124,v124,v107
v_cmp_eq_u32 vcc,-1,v124
s_cbranch_vccz dcp_100768
buffer_load_dwordx4 v[104:107],v0,s[20:23],s92 offen offset:1024 sc1
s_waitcnt vmcnt(2)
v_max3_u32 v124,v108,v109,v110
v_max_u32 v124,v124,v111
v_cmp_eq_u32 vcc,-1,v124
s_cbranch_vccz dcp_100769
buffer_load_dwordx4 v[108:111],v0,s[20:23],s92 offen offset:1024 sc1
s_sub_u32 s90,s90,1
s_cmp_gt_i32 s90,0
s_cbranch_scc1 dlp_100766
s_branch dgo_100765
dcp_100768:
v_mov_b32 v20,v104
v_mov_b32 v21,v105
v_mov_b32 v22,v106
v_mov_b32 v23,v107
s_nop 1
s_branch dgo_100765
dcp_100769:
v_mov_b32 v20,v108
v_mov_b32 v21,v109
v_mov_b32 v22,v110
v_mov_b32 v23,v111
s_nop 1
dgo_100765:
v_smfmac_f32_16x16x64_bf16 v[48:51],v[20:23],a[64:71],v1
v_smfmac_f32_16x16x64_bf16 v[52:55],v[20:23],a[72:79],v1
v_smfmac_f32_16x16x64_bf16 v[56:59],v[20:23],a[80:87],v1
v_smfmac_f32_16x16x64_bf16 v[60:63],v[20:23],a[88:95],v1
v_smfmac_f32_16x16x64_bf16 v[64:67],v[20:23],a[96:103],v1
v_smfmac_f32_16x16x64_bf16 v[68:71],v[20:23],a[104:111],v1
v_smfmac_f32_16x16x64_bf16 v[72:75],v[20:23],a[112:119],v1
v_smfmac_f32_16x16x64_bf16 v[76:79],v[20:23],a[120:127],v1
dsk_100764:
s_bitcmp1_b32 s55,2
s_cbranch_scc0 dsk_100770
s_waitcnt vmcnt(2)
v_max3_u32 v124,v24,v25,v26
v_max_u32 v124,v124,v27
v_cmp_eq_u32 vcc,-1,v124
s_cbranch_vccz dgo_100771
s_nop 15
buffer_load_dwordx4 v[104:107],v0,s[20:23],s92 offen offset:2048 sc1
s_nop 15
buffer_load_dwordx4 v[108:111],v0,s[20:23],s92 offen offset:2048 sc1
dlp_100772:
s_waitcnt vmcnt(2)
v_max3_u32 v124,v24,v25,v26
v_max_u32 v124,v124,v27
v_cmp_eq_u32 vcc,-1,v124
s_cbranch_vccz dgo_100771
buffer_load_dwordx4 v[24:27],v0,s[20:23],s92 offen offset:2048 sc1
s_waitcnt vmcnt(2)
v_max3_u32 v124,v104,v105,v106
v_max_u32 v124,v124,v107
v_cmp_eq_u32 vcc,-1,v124
s_cbranch_vccz dcp_100774
buffer_load_dwordx4 v[104:107],v0,s[20:23],s92 offen offset:2048 sc1
s_waitcnt vmcnt(2)
v_max3_u32 v124,v108,v109,v110
v_max_u32 v124,v124,v111
v_cmp_eq_u32 vcc,-1,v124
s_cbranch_vccz dcp_100775
buffer_load_dwordx4 v[108:111],v0,s[20:23],s92 offen offset:2048 sc1
s_sub_u32 s90,s90,1
s_cmp_gt_i32 s90,0
s_cbranch_scc1 dlp_100772
s_branch dgo_100771
dcp_100774:
v_mov_b32 v24,v104
v_mov_b32 v25,v105
v_mov_b32 v26,v106
v_mov_b32 v27,v107
s_nop 1
s_branch dgo_100771
dcp_100775:
v_mov_b32 v24,v108
v_mov_b32 v25,v109
v_mov_b32 v26,v110
v_mov_b32 v27,v111
s_nop 1
dgo_100771:
v_smfmac_f32_16x16x64_bf16 v[48:51],v[24:27],a[128:135],v1
v_smfmac_f32_16x16x64_bf16 v[52:55],v[24:27],a[136:143],v1
v_smfmac_f32_16x16x64_bf16 v[56:59],v[24:27],a[144:151],v1
v_smfmac_f32_16x16x64_bf16 v[60:63],v[24:27],a[152:159],v1
v_smfmac_f32_16x16x64_bf16 v[64:67],v[24:27],a[160:167],v1
v_smfmac_f32_16x16x64_bf16 v[68:71],v[24:27],a[168:175],v1
v_smfmac_f32_16x16x64_bf16 v[72:75],v[24:27],a[176:183],v1
v_smfmac_f32_16x16x64_bf16 v[76:79],v[24:27],a[184:191],v1
dsk_100770:
s_bitcmp1_b32 s55,3
s_cbranch_scc0 dsk_100776
s_waitcnt vmcnt(2)
v_max3_u32 v124,v28,v29,v30
v_max_u32 v124,v124,v31
v_cmp_eq_u32 vcc,-1,v124
s_cbranch_vccz dgo_100777
s_nop 15
buffer_load_dwordx4 v[104:107],v0,s[20:23],s92 offen offset:3072 sc1
s_nop 15
buffer_load_dwordx4 v[108:111],v0,s[20:23],s92 offen offset:3072 sc1
dlp_100778:
s_waitcnt vmcnt(2)
v_max3_u32 v124,v28,v29,v30
v_max_u32 v124,v124,v31
v_cmp_eq_u32 vcc,-1,v124
s_cbranch_vccz dgo_100777
buffer_load_dwordx4 v[28:31],v0,s[20:23],s92 offen offset:3072 sc1
s_waitcnt vmcnt(2)
v_max3_u32 v124,v104,v105,v106
v_max_u32 v124,v124,v107
v_cmp_eq_u32 vcc,-1,v124
s_cbranch_vccz dcp_100780
buffer_load_dwordx4 v[104:107],v0,s[20:23],s92 offen offset:3072 sc1
s_waitcnt vmcnt(2)
v_max3_u32 v124,v108,v109,v110
v_max_u32 v124,v124,v111
v_cmp_eq_u32 vcc,-1,v124
s_cbranch_vccz dcp_100781
buffer_load_dwordx4 v[108:111],v0,s[20:23],s92 offen offset:3072 sc1
s_sub_u32 s90,s90,1
s_cmp_gt_i32 s90,0
s_cbranch_scc1 dlp_100778
s_branch dgo_100777
dcp_100780:
v_mov_b32 v28,v104
v_mov_b32 v29,v105
v_mov_b32 v30,v106
v_mov_b32 v31,v107
s_nop 1
s_branch dgo_100777
dcp_100781:
v_mov_b32 v28,v108
v_mov_b32 v29,v109
v_mov_b32 v30,v110
v_mov_b32 v31,v111
s_nop 1
dgo_100777:
v_smfmac_f32_16x16x64_bf16 v[48:51],v[28:31],a[192:199],v1
v_smfmac_f32_16x16x64_bf16 v[52:55],v[28:31],a[200:207],v1
v_smfmac_f32_16x16x64_bf16 v[56:59],v[28:31],a[208:215],v1
v_smfmac_f32_16x16x64_bf16 v[60:63],v[28:31],a[216:223],v1
v_smfmac_f32_16x16x64_bf16 v[64:67],v[28:31],a[224:231],v1
v_smfmac_f32_16x16x64_bf16 v[68:71],v[28:31],a[232:239],v1
v_smfmac_f32_16x16x64_bf16 v[72:75],v[28:31],a[240:247],v1
v_smfmac_f32_16x16x64_bf16 v[76:79],v[28:31],a[248:255],v1
dsk_100776:
s_mov_b32 s55,0
s_branch Ldone_100694
slowA_100630:
buffer_load_dwordx4 v[44:47],v0,s[20:23],s93 offen offset:3072 sc1
dsk_100782:
s_bitcmp1_b32 s55,7
s_cbranch_scc0 dsk_100783
s_waitcnt vmcnt(2)
v_max3_u32 v124,v44,v45,v46
v_max_u32 v124,v124,v47
v_cmp_eq_u32 vcc,-1,v124
s_cbranch_vccz dgo_100784
s_nop 15
s_nop 3
buffer_load_dwordx4 v[104:107],v0,s[20:23],s93 offen offset:3072 sc1
s_nop 15
s_nop 3
buffer_load_dwordx4 v[108:111],v0,s[20:23],s93 offen offset:3072 sc1
dlp_100785:
s_waitcnt vmcnt(2)
v_max3_u32 v124,v44,v45,v46
v_max_u32 v124,v124,v47
v_cmp_eq_u32 vcc,-1,v124
s_cbranch_vccz dgo_100784
buffer_load_dwordx4 v[44:47],v0,s[20:23],s93 offen offset:3072 sc1
s_waitcnt vmcnt(2)
v_max3_u32 v124,v104,v105,v106
v_max_u32 v124,v124,v107
v_cmp_eq_u32 vcc,-1,v124
s_cbranch_vccz dcp_100787
buffer_load_dwordx4 v[104:107],v0,s[20:23],s93 offen offset:3072 sc1
s_waitcnt vmcnt(2)
v_max3_u32 v124,v108,v109,v110
v_max_u32 v124,v124,v111
v_cmp_eq_u32 vcc,-1,v124
s_cbranch_vccz dcp_100788
buffer_load_dwordx4 v[108:111],v0,s[20:23],s93 offen offset:3072 sc1
s_sub_u32 s90,s90,1
s_cmp_gt_i32 s90,0
s_cbranch_scc1 dlp_100785
s_branch dgo_100784
dcp_100787:
v_mov_b32 v44,v104
v_mov_b32 v45,v105
v_mov_b32 v46,v106
v_mov_b32 v47,v107
s_nop 1
s_branch dgo_100784
dcp_100788:
v_mov_b32 v44,v108
v_mov_b32 v45,v109
v_mov_b32 v46,v110
v_mov_b32 v47,v111
s_nop 1
dgo_100784:
dsk_100783:
s_mov_b32 s55,0
s_branch segb_100612
srt_100637:
s_sub_u32 s90,s90,1
s_cmp_gt_i32 s90,0
s_cbranch_scc0 sok_100636
buffer_load_dwordx4 v[16:19],v2,s[20:23],s94 offen offset:0 sc1
buffer_load_dwordx4 v[32:35],v2,s[20:23],s94 offen offset:1536 sc1
buffer_load_dwordx4 v[20:23],v2,s[20:23],s95 offen offset:0 sc1
buffer_load_dwordx4 v[36:39],v2,s[20:23],s95 offen offset:1536 sc1
buffer_load_dword v120,v3,s[20:23],s94 offen offset:0 sc1
buffer_load_dword v121,v3,s[20:23],s94 offen offset:1536 sc1
buffer_load_dword v122,v3,s[20:23],s95 offen offset:0 sc1
buffer_load_dword v123,v3,s[20:23],s95 offen offset:1536 sc1
s_branch sp_100635
of_100638:
s_mov_b32 s55,3
buffer_load_dwordx4 v[16:19],v0,s[20:23],s96 offen offset:0 sc1
buffer_load_dwordx4 v[20:23],v0,s[20:23],s96 offen offset:1024 sc1
v_readfirstlane_b32 s91,v126
s_waitcnt vmcnt(6)
v_max3_u32 v124,v24,v25,v26
v_max3_u32 v124,v124,v27,v28
v_max3_u32 v124,v124,v29,v30
v_max_u32 v124,v124,v31
v_cmp_eq_u32 vcc,-1,v124
s_cbranch_vccnz ost_100790
v_smfmac_f32_16x16x64_bf16 v[96:99],v[24:27],v[80:87],v1
buffer_load_dword v120,off,s[20:23],s96 sc1
v_smfmac_f32_16x16x64_bf16 v[100:103],v[24:27],v[88:95],v1
buffer_load_dword v120,off,s[20:23],s96 sc1
v_smfmac_f32_16x16x64_bf16 v[96:99],v[28:31],v[128:135],v1
v_smfmac_f32_16x16x64_bf16 v[100:103],v[28:31],v[136:143],v1
ort_100791:
s_waitcnt vmcnt(6)
v_max3_u32 v124,v32,v33,v34
v_max3_u32 v124,v124,v35,v36
v_max3_u32 v124,v124,v37,v38
v_max_u32 v124,v124,v39
v_cmp_eq_u32 vcc,-1,v124
s_cbranch_vccnz ost_100792
v_smfmac_f32_16x16x64_bf16 v[96:99],v[32:35],v[144:151],v1
buffer_load_dword v120,off,s[20:23],s96 sc1
v_smfmac_f32_16x16x64_bf16 v[100:103],v[32:35],v[152:159],v1
buffer_load_dword v120,off,s[20:23],s96 sc1
v_smfmac_f32_16x16x64_bf16 v[96:99],v[36:39],v[160:167],v1
v_smfmac_f32_16x16x64_bf16 v[100:103],v[36:39],v[168:175],v1
ort_100793:
s_waitcnt vmcnt(7)
v_max3_u32 v124,v40,v41,v42
v_max_u32 v124,v124,v43
v_cmp_eq_u32 vcc,-1,v124
s_cbranch_vccnz ost_100794
v_smfmac_f32_16x16x64_bf16 v[96:99],v[40:43],v[176:183],v1
buffer_load_dword v120,off,s[20:23],s96 sc1
v_smfmac_f32_16x16x64_bf16 v[100:103],v[40:43],v[184:191],v1
ort_100795:
s_waitcnt vmcnt(7)
v_max3_u32 v124,v44,v45,v46
v_max_u32 v124,v124,v47
v_cmp_eq_u32 vcc,-1,v124
s_cbranch_vccnz ost_100796
v_smfmac_f32_16x16x64_bf16 v[96:99],v[44:47],v[192:199],v1
buffer_load_dword v120,off,s[20:23],s96 sc1
v_smfmac_f32_16x16x64_bf16 v[100:103],v[44:47],v[200:207],v1
ort_100797:
s_waitcnt vmcnt(6)
v_max3_u32 v124,v16,v17,v18
v_max3_u32 v124,v124,v19,v20
v_max3_u32 v124,v124,v21,v22
v_max_u32 v124,v124,v23
v_cmp_eq_u32 vcc,-1,v124
s_cbranch_vccnz olap2_100789
s_andn2_b32 s55,s55,3
v_smfmac_f32_16x16x64_bf16 v[96:99],v[16:19],v[48:55],v1
v_smfmac_f32_16x16x64_bf16 v[100:103],v[16:19],v[56:63],v1
v_smfmac_f32_16x16x64_bf16 v[96:99],v[20:23],v[64:71],v1
v_smfmac_f32_16x16x64_bf16 v[100:103],v[20:23],v[72:79],v1
s_cbranch_scc0 oback_100649
s_branch olap2_100789
ost_100790:
buffer_load_dwordx4 v[24:27],v0,s[20:23],s96 offen offset:2048 sc1
buffer_load_dwordx4 v[28:31],v0,s[20:23],s96 offen offset:3072 sc1
s_or_b32 s55,s55,12
s_branch ort_100791
ost_100792:
buffer_load_dwordx4 v[32:35],v0,s[20:23],s97 offen offset:0 sc1
buffer_load_dwordx4 v[36:39],v0,s[20:23],s97 offen offset:1024 sc1
s_or_b32 s55,s55,48
s_branch ort_100793
ost_100794:
buffer_load_dwordx4 v[40:43],v0,s[20:23],s97 offen offset:2048 sc1
s_or_b32 s55,s55,64
s_branch ort_100795
ost_100796:
buffer_load_dwordx4 v[44:47],v0,s[20:23],s97 offen offset:3072 sc1
s_or_b32 s55,s55,128
s_branch ort_100797
of_100639:
s_mov_b32 s55,12
buffer_load_dwordx4 v[24:27],v0,s[20:23],s96 offen offset:2048 sc1
buffer_load_dwordx4 v[28:31],v0,s[20:23],s96 offen offset:3072 sc1
s_waitcnt vmcnt(4)
v_max3_u32 v124,v32,v33,v34
v_max3_u32 v124,v124,v35,v36
v_max3_u32 v124,v124,v37,v38
v_max_u32 v124,v124,v39
v_cmp_eq_u32 vcc,-1,v124
s_cbranch_vccnz ost_100799
v_smfmac_f32_16x16x64_bf16 v[96:99],v[32:35],v[144:151],v1
buffer_load_dword v120,off,s[20:23],s96 sc1
v_smfmac_f32_16x16x64_bf16 v[100:103],v[32:35],v[152:159],v1
buffer_load_dword v120,off,s[20:23],s96 sc1
v_smfmac_f32_16x16x64_bf16 v[96:99],v[36:39],v[160:167],v1
v_smfmac_f32_16x16x64_bf16 v[100:103],v[36:39],v[168:175],v1
ort_100800:
s_waitcnt vmcnt(5)
v_max3_u32 v124,v40,v41,v42
v_max_u32 v124,v124,v43
v_cmp_eq_u32 vcc,-1,v124
s_cbranch_vccnz ost_100801
v_smfmac_f32_16x16x64_bf16 v[96:99],v[40:43],v[176:183],v1
buffer_load_dword v120,off,s[20:23],s96 sc1
v_smfmac_f32_16x16x64_bf16 v[100:103],v[40:43],v[184:191],v1
ort_100802:
s_waitcnt vmcnt(5)
v_max3_u32 v124,v44,v45,v46
v_max_u32 v124,v124,v47
v_cmp_eq_u32 vcc,-1,v124
s_cbranch_vccnz ost_100803
v_smfmac_f32_16x16x64_bf16 v[96:99],v[44:47],v[192:199],v1
buffer_load_dword v120,off,s[20:23],s96 sc1
v_smfmac_f32_16x16x64_bf16 v[100:103],v[44:47],v[200:207],v1
ort_100804:
s_waitcnt vmcnt(4)
v_max3_u32 v124,v24,v25,v26
v_max3_u32 v124,v124,v27,v28
v_max3_u32 v124,v124,v29,v30
v_max_u32 v124,v124,v31
v_cmp_eq_u32 vcc,-1,v124
s_cbranch_vccnz olap2_100789
s_andn2_b32 s55,s55,12
v_smfmac_f32_16x16x64_bf16 v[96:99],v[24:27],v[80:87],v1
v_smfmac_f32_16x16x64_bf16 v[100:103],v[24:27],v[88:95],v1
v_smfmac_f32_16x16x64_bf16 v[96:99],v[28:31],v[128:135],v1
v_smfmac_f32_16x16x64_bf16 v[100:103],v[28:31],v[136:143],v1
s_cbranch_scc0 oback_100649
s_branch olap2_100789
ost_100799:
buffer_load_dwordx4 v[32:35],v0,s[20:23],s97 offen offset:0 sc1
buffer_load_dwordx4 v[36:39],v0,s[20:23],s97 offen offset:1024 sc1
s_or_b32 s55,s55,48
s_branch ort_100800
ost_100801:
buffer_load_dwordx4 v[40:43],v0,s[20:23],s97 offen offset:2048 sc1
s_or_b32 s55,s55,64
s_branch ort_100802
ost_100803:
buffer_load_dwordx4 v[44:47],v0,s[20:23],s97 offen offset:3072 sc1
s_or_b32 s55,s55,128
s_branch ort_100804
of_100640:
s_mov_b32 s55,48
buffer_load_dwordx4 v[32:35],v0,s[20:23],s97 offen offset:0 sc1
buffer_load_dwordx4 v[36:39],v0,s[20:23],s97 offen offset:1024 sc1
s_waitcnt vmcnt(3)
v_max3_u32 v124,v40,v41,v42
v_max_u32 v124,v124,v43
v_cmp_eq_u32 vcc,-1,v124
s_cbranch_vccnz ost_100806
v_smfmac_f32_16x16x64_bf16 v[96:99],v[40:43],v[176:183],v1
buffer_load_dword v120,off,s[20:23],s96 sc1
v_smfmac_f32_16x16x64_bf16 v[100:103],v[40:43],v[184:191],v1
ort_100807:
s_waitcnt vmcnt(3)
v_max3_u32 v124,v44,v45,v46
v_max_u32 v124,v124,v47
v_cmp_eq_u32 vcc,-1,v124
s_cbranch_vccnz ost_100808
v_smfmac_f32_16x16x64_bf16 v[96:99],v[44:47],v[192:199],v1
buffer_load_dword v120,off,s[20:23],s96 sc1
v_smfmac_f32_16x16x64_bf16 v[100:103],v[44:47],v[200:207],v1
ort_100809:
s_waitcnt vmcnt(2)
v_max3_u32 v124,v32,v33,v34
v_max3_u32 v124,v124,v35,v36
v_max3_u32 v124,v124,v37,v38
v_max_u32 v124,v124,v39
v_cmp_eq_u32 vcc,-1,v124
s_cbranch_vccnz olap2_100789
s_andn2_b32 s55,s55,48
v_smfmac_f32_16x16x64_bf16 v[96:99],v[32:35],v[144:151],v1
v_smfmac_f32_16x16x64_bf16 v[100:103],v[32:35],v[152:159],v1
v_smfmac_f32_16x16x64_bf16 v[96:99],v[36:39],v[160:167],v1
v_smfmac_f32_16x16x64_bf16 v[100:103],v[36:39],v[168:175],v1
s_cbranch_scc0 oback_100649
s_branch olap2_100789
ost_100806:
buffer_load_dwordx4 v[40:43],v0,s[20:23],s97 offen offset:2048 sc1
s_or_b32 s55,s55,64
s_branch ort_100807
ost_100808:
buffer_load_dwordx4 v[44:47],v0,s[20:23],s97 offen offset:3072 sc1
s_or_b32 s55,s55,128
s_branch ort_100809
of_100641:
s_mov_b32 s55,64
buffer_load_dwordx4 v[40:43],v0,s[20:23],s97 offen offset:2048 sc1
s_waitcnt vmcnt(1)
v_max3_u32 v124,v44,v45,v46
v_max_u32 v124,v124,v47
v_cmp_eq_u32 vcc,-1,v124
s_cbranch_vccnz ost_100811
v_smfmac_f32_16x16x64_bf16 v[96:99],v[44:47],v[192:199],v1
buffer_load_dword v120,off,s[20:23],s96 sc1
v_smfmac_f32_16x16x64_bf16 v[100:103],v[44:47],v[200:207],v1
ort_100812:
s_waitcnt vmcnt(1)
v_max3_u32 v124,v40,v41,v42
v_max_u32 v124,v124,v43
v_cmp_eq_u32 vcc,-1,v124
s_cbranch_vccnz olap2_100789
s_andn2_b32 s55,s55,64
v_smfmac_f32_16x16x64_bf16 v[96:99],v[40:43],v[176:183],v1
v_smfmac_f32_16x16x64_bf16 v[100:103],v[40:43],v[184:191],v1
s_cbranch_scc0 oback_100649
s_branch olap2_100789
ost_100811:
buffer_load_dwordx4 v[44:47],v0,s[20:23],s97 offen offset:3072 sc1
s_or_b32 s55,s55,128
s_branch ort_100812
of_100642:
s_mov_b32 s55,128
s_branch oslow_100648
olap2_100789:
s_bitcmp1_b32 s55,0
s_cbranch_scc0 l2s_100814
s_waitcnt vmcnt(6)
v_max3_u32 v124,v16,v17,v18
v_max3_u32 v124,v124,v19,v20
v_max3_u32 v124,v124,v21,v22
v_max_u32 v124,v124,v23
v_cmp_eq_u32 vcc,-1,v124
s_cbranch_vccnz l2s_100814
s_andn2_b32 s55,s55,3
v_smfmac_f32_16x16x64_bf16 v[96:99],v[16:19],v[48:55],v1
v_smfmac_f32_16x16x64_bf16 v[100:103],v[16:19],v[56:63],v1
v_smfmac_f32_16x16x64_bf16 v[96:99],v[20:23],v[64:71],v1
v_smfmac_f32_16x16x64_bf16 v[100:103],v[20:23],v[72:79],v1
l2s_100814:
s_bitcmp1_b32 s55,2
s_cbranch_scc0 l2s_100815
s_waitcnt vmcnt(4)
v_max3_u32 v124,v24,v25,v26
v_max3_u32 v124,v124,v27,v28
v_max3_u32 v124,v124,v29,v30
v_max_u32 v124,v124,v31
v_cmp_eq_u32 vcc,-1,v124
s_cbranch_vccnz l2s_100815
s_andn2_b32 s55,s55,12
v_smfmac_f32_16x16x64_bf16 v[96:99],v[24:27],v[80:87],v1
v_smfmac_f32_16x16x64_bf16 v[100:103],v[24:27],v[88:95],v1
v_smfmac_f32_16x16x64_bf16 v[96:99],v[28:31],v[128:135],v1
v_smfmac_f32_16x16x64_bf16 v[100:103],v[28:31],v[136:143],v1
l2s_100815:
s_bitcmp1_b32 s55,4
s_cbranch_scc0 l2s_100816
s_waitcnt vmcnt(2)
v_max3_u32 v124,v32,v33,v34
v_max3_u32 v124,v124,v35,v36
v_max3_u32 v124,v124,v37,v38
v_max_u32 v124,v124,v39
v_cmp_eq_u32 vcc,-1,v124
s_cbranch_vccnz l2s_100816
s_andn2_b32 s55,s55,48
v_smfmac_f32_16x16x64_bf16 v[96:99],v[32:35],v[144:151],v1
v_smfmac_f32_16x16x64_bf16 v[100:103],v[32:35],v[152:159],v1
v_smfmac_f32_16x16x64_bf16 v[96:99],v[36:39],v[160:167],v1
v_smfmac_f32_16x16x64_bf16 v[100:103],v[36:39],v[168:175],v1
l2s_100816:
s_bitcmp1_b32 s55,6
s_cbranch_scc0 l2s_100817
s_waitcnt vmcnt(1)
v_max3_u32 v124,v40,v41,v42
v_max_u32 v124,v124,v43
v_cmp_eq_u32 vcc,-1,v124
s_cbranch_vccnz l2s_100817
s_andn2_b32 s55,s55,64
v_smfmac_f32_16x16x64_bf16 v[96:99],v[40:43],v[176:183],v1
v_smfmac_f32_16x16x64_bf16 v[100:103],v[40:43],v[184:191],v1
l2s_100817:
s_bitcmp1_b32 s55,7
s_cbranch_scc0 l2s_100818
s_waitcnt vmcnt(0)
v_max3_u32 v124,v44,v45,v46
v_max_u32 v124,v124,v47
v_cmp_eq_u32 vcc,-1,v124
s_cbranch_vccnz l2s_100818
s_andn2_b32 s55,s55,128
v_smfmac_f32_16x16x64_bf16 v[96:99],v[44:47],v[192:199],v1
v_smfmac_f32_16x16x64_bf16 v[100:103],v[44:47],v[200:207],v1
l2s_100818:
s_cmp_eq_u32 s55,0
s_cbranch_scc1 oback_100649
oslow_100648:
s_bitcmp1_b32 s55,0
s_cbranch_scc0 dsk_100819
buffer_load_dwordx4 v[16:19],v0,s[20:23],s96 offen offset:0 sc1
dsk_100819:
s_bitcmp1_b32 s55,1
s_cbranch_scc0 dsk_100820
buffer_load_dwordx4 v[20:23],v0,s[20:23],s96 offen offset:1024 sc1
dsk_100820:
s_bitcmp1_b32 s55,2
s_cbranch_scc0 dsk_100821
buffer_load_dwordx4 v[24:27],v0,s[20:23],s96 offen offset:2048 sc1
dsk_100821:
s_bitcmp1_b32 s55,3
s_cbranch_scc0 dsk_100822
buffer_load_dwordx4 v[28:31],v0,s[20:23],s96 offen offset:3072 sc1
dsk_100822:
s_bitcmp1_b32 s55,4
s_cbranch_scc0 dsk_100823
buffer_load_dwordx4 v[32:35],v0,s[20:23],s97 offen offset:0 sc1
dsk_100823:
s_bitcmp1_b32 s55,5
s_cbranch_scc0 dsk_100824
buffer_load_dwordx4 v[36:39],v0,s[20:23],s97 offen offset:1024 sc1
dsk_100824:
s_bitcmp1_b32 s55,6
s_cbranch_scc0 dsk_100825
buffer_load_dwordx4 v[40:43],v0,s[20:23],s97 offen offset:2048 sc1
dsk_100825:
s_bitcmp1_b32 s55,7
s_cbranch_scc0 dsk_100826
buffer_load_dwordx4 v[44:47],v0,s[20:23],s97 offen offset:3072 sc1
dsk_100826:
s_bitcmp1_b32 s55,0
s_cbranch_scc0 dsk_100827
s_waitcnt vmcnt(2)
v_max3_u32 v124,v16,v17,v18
v_max_u32 v124,v124,v19
v_cmp_eq_u32 vcc,-1,v124
s_cbranch_vccz dgo_100828
s_nop 15
buffer_load_dwordx4 v[116:119],v0,s[20:23],s96 offen offset:0 sc1
s_nop 15
buffer_load_dwordx4 v[120:123],v0,s[20:23],s96 offen offset:0 sc1
dlp_100829:
s_waitcnt vmcnt(2)
v_max3_u32 v124,v16,v17,v18
v_max_u32 v124,v124,v19
v_cmp_eq_u32 vcc,-1,v124
s_cbranch_vccz dgo_100828
buffer_load_dwordx4 v[16:19],v0,s[20:23],s96 offen offset:0 sc1
s_waitcnt vmcnt(2)
v_max3_u32 v124,v116,v117,v118
v_max_u32 v124,v124,v119
v_cmp_eq_u32 vcc,-1,v124
s_cbranch_vccz dcp_100831
buffer_load_dwordx4 v[116:119],v0,s[20:23],s96 offen offset:0 sc1
s_waitcnt vmcnt(2)
v_max3_u32 v124,v120,v121,v122
v_max_u32 v124,v124,v123
v_cmp_eq_u32 vcc,-1,v124
s_cbranch_vccz dcp_100832
buffer_load_dwordx4 v[120:123],v0,s[20:23],s96 offen offset:0 sc1
s_sub_u32 s90,s90,1
s_cmp_gt_i32 s90,0
s_cbranch_scc1 dlp_100829
s_branch dgo_100828
dcp_100831:
v_mov_b32 v16,v116
v_mov_b32 v17,v117
v_mov_b32 v18,v118
v_mov_b32 v19,v119
s_nop 1
s_branch dgo_100828
dcp_100832:
v_mov_b32 v16,v120
v_mov_b32 v17,v121
v_mov_b32 v18,v122
v_mov_b32 v19,v123
s_nop 1
dgo_100828:
v_smfmac_f32_16x16x64_bf16 v[96:99],v[16:19],v[48:55],v1
v_smfmac_f32_16x16x64_bf16 v[100:103],v[16:19],v[56:63],v1
dsk_100827:
s_bitcmp1_b32 s55,1
s_cbranch_scc0 dsk_100833
s_waitcnt vmcnt(2)
v_max3_u32 v124,v20,v21,v22
v_max_u32 v124,v124,v23
v_cmp_eq_u32 vcc,-1,v124
s_cbranch_vccz dgo_100834
s_nop 15
buffer_load_dwordx4 v[116:119],v0,s[20:23],s96 offen offset:1024 sc1
s_nop 15
buffer_load_dwordx4 v[120:123],v0,s[20:23],s96 offen offset:1024 sc1
dlp_100835:
s_waitcnt vmcnt(2)
v_max3_u32 v124,v20,v21,v22
v_max_u32 v124,v124,v23
v_cmp_eq_u32 vcc,-1,v124
s_cbranch_vccz dgo_100834
buffer_load_dwordx4 v[20:23],v0,s[20:23],s96 offen offset:1024 sc1
s_waitcnt vmcnt(2)
v_max3_u32 v124,v116,v117,v118
v_max_u32 v124,v124,v119
v_cmp_eq_u32 vcc,-1,v124
s_cbranch_vccz dcp_100837
buffer_load_dwordx4 v[116:119],v0,s[20:23],s96 offen offset:1024 sc1
s_waitcnt vmcnt(2)
v_max3_u32 v124,v120,v121,v122
v_max_u32 v124,v124,v123
v_cmp_eq_u32 vcc,-1,v124
s_cbranch_vccz dcp_100838
buffer_load_dwordx4 v[120:123],v0,s[20:23],s96 offen offset:1024 sc1
s_sub_u32 s90,s90,1
s_cmp_gt_i32 s90,0
s_cbranch_scc1 dlp_100835
s_branch dgo_100834
dcp_100837:
v_mov_b32 v20,v116
v_mov_b32 v21,v117
v_mov_b32 v22,v118
v_mov_b32 v23,v119
s_nop 1
s_branch dgo_100834
dcp_100838:
v_mov_b32 v20,v120
v_mov_b32 v21,v121
v_mov_b32 v22,v122
v_mov_b32 v23,v123
s_nop 1
dgo_100834:
v_smfmac_f32_16x16x64_bf16 v[96:99],v[20:23],v[64:71],v1
v_smfmac_f32_16x16x64_bf16 v[100:103],v[20:23],v[72:79],v1
dsk_100833:
s_bitcmp1_b32 s55,2
s_cbranch_scc0 dsk_100839
s_waitcnt vmcnt(2)
v_max3_u32 v124,v24,v25,v26
v_max_u32 v124,v124,v27
v_cmp_eq_u32 vcc,-1,v124
s_cbranch_vccz dgo_100840
s_nop 15
buffer_load_dwordx4 v[116:119],v0,s[20:23],s96 offen offset:2048 sc1
s_nop 15
buffer_load_dwordx4 v[120:123],v0,s[20:23],s96 offen offset:2048 sc1
dlp_100841:
s_waitcnt vmcnt(2)
v_max3_u32 v124,v24,v25,v26
v_max_u32 v124,v124,v27
v_cmp_eq_u32 vcc,-1,v124
s_cbranch_vccz dgo_100840
buffer_load_dwordx4 v[24:27],v0,s[20:23],s96 offen offset:2048 sc1
s_waitcnt vmcnt(2)
v_max3_u32 v124,v116,v117,v118
v_max_u32 v124,v124,v119
v_cmp_eq_u32 vcc,-1,v124
s_cbranch_vccz dcp_100843
buffer_load_dwordx4 v[116:119],v0,s[20:23],s96 offen offset:2048 sc1
s_waitcnt vmcnt(2)
v_max3_u32 v124,v120,v121,v122
v_max_u32 v124,v124,v123
v_cmp_eq_u32 vcc,-1,v124
s_cbranch_vccz dcp_100844
buffer_load_dwordx4 v[120:123],v0,s[20:23],s96 offen offset:2048 sc1
s_sub_u32 s90,s90,1
s_cmp_gt_i32 s90,0
s_cbranch_scc1 dlp_100841
s_branch dgo_100840
dcp_100843:
v_mov_b32 v24,v116
v_mov_b32 v25,v117
v_mov_b32 v26,v118
v_mov_b32 v27,v119
s_nop 1
s_branch dgo_100840
dcp_100844:
v_mov_b32 v24,v120
v_mov_b32 v25,v121
v_mov_b32 v26,v122
v_mov_b32 v27,v123
s_nop 1
dgo_100840:
v_smfmac_f32_16x16x64_bf16 v[96:99],v[24:27],v[80:87],v1
v_smfmac_f32_16x16x64_bf16 v[100:103],v[24:27],v[88:95],v1
dsk_100839:
s_bitcmp1_b32 s55,3
s_cbranch_scc0 dsk_100845
s_waitcnt vmcnt(2)
v_max3_u32 v124,v28,v29,v30
v_max_u32 v124,v124,v31
v_cmp_eq_u32 vcc,-1,v124
s_cbranch_vccz dgo_100846
s_nop 15
buffer_load_dwordx4 v[116:119],v0,s[20:23],s96 offen offset:3072 sc1
s_nop 15
buffer_load_dwordx4 v[120:123],v0,s[20:23],s96 offen offset:3072 sc1
dlp_100847:
s_waitcnt vmcnt(2)
v_max3_u32 v124,v28,v29,v30
v_max_u32 v124,v124,v31
v_cmp_eq_u32 vcc,-1,v124
s_cbranch_vccz dgo_100846
buffer_load_dwordx4 v[28:31],v0,s[20:23],s96 offen offset:3072 sc1
s_waitcnt vmcnt(2)
v_max3_u32 v124,v116,v117,v118
v_max_u32 v124,v124,v119
v_cmp_eq_u32 vcc,-1,v124
s_cbranch_vccz dcp_100849
buffer_load_dwordx4 v[116:119],v0,s[20:23],s96 offen offset:3072 sc1
s_waitcnt vmcnt(2)
v_max3_u32 v124,v120,v121,v122
v_max_u32 v124,v124,v123
v_cmp_eq_u32 vcc,-1,v124
s_cbranch_vccz dcp_100850
buffer_load_dwordx4 v[120:123],v0,s[20:23],s96 offen offset:3072 sc1
s_sub_u32 s90,s90,1
s_cmp_gt_i32 s90,0
s_cbranch_scc1 dlp_100847
s_branch dgo_100846
dcp_100849:
v_mov_b32 v28,v116
v_mov_b32 v29,v117
v_mov_b32 v30,v118
v_mov_b32 v31,v119
s_nop 1
s_branch dgo_100846
dcp_100850:
v_mov_b32 v28,v120
v_mov_b32 v29,v121
v_mov_b32 v30,v122
v_mov_b32 v31,v123
s_nop 1
dgo_100846:
v_smfmac_f32_16x16x64_bf16 v[96:99],v[28:31],v[128:135],v1
v_smfmac_f32_16x16x64_bf16 v[100:103],v[28:31],v[136:143],v1
dsk_100845:
s_bitcmp1_b32 s55,4
s_cbranch_scc0 dsk_100851
s_waitcnt vmcnt(2)
v_max3_u32 v124,v32,v33,v34
v_max_u32 v124,v124,v35
v_cmp_eq_u32 vcc,-1,v124
s_cbranch_vccz dgo_100852
s_nop 15
buffer_load_dwordx4 v[116:119],v0,s[20:23],s97 offen offset:0 sc1
s_nop 15
buffer_load_dwordx4 v[120:123],v0,s[20:23],s97 offen offset:0 sc1
dlp_100853:
s_waitcnt vmcnt(2)
v_max3_u32 v124,v32,v33,v34
v_max_u32 v124,v124,v35
v_cmp_eq_u32 vcc,-1,v124
s_cbranch_vccz dgo_100852
buffer_load_dwordx4 v[32:35],v0,s[20:23],s97 offen offset:0 sc1
s_waitcnt vmcnt(2)
v_max3_u32 v124,v116,v117,v118
v_max_u32 v124,v124,v119
v_cmp_eq_u32 vcc,-1,v124
s_cbranch_vccz dcp_100855
buffer_load_dwordx4 v[116:119],v0,s[20:23],s97 offen offset:0 sc1
s_waitcnt vmcnt(2)
v_max3_u32 v124,v120,v121,v122
v_max_u32 v124,v124,v123
v_cmp_eq_u32 vcc,-1,v124
s_cbranch_vccz dcp_100856
buffer_load_dwordx4 v[120:123],v0,s[20:23],s97 offen offset:0 sc1
s_sub_u32 s90,s90,1
s_cmp_gt_i32 s90,0
s_cbranch_scc1 dlp_100853
s_branch dgo_100852
dcp_100855:
v_mov_b32 v32,v116
v_mov_b32 v33,v117
v_mov_b32 v34,v118
v_mov_b32 v35,v119
s_nop 1
s_branch dgo_100852
dcp_100856:
v_mov_b32 v32,v120
v_mov_b32 v33,v121
v_mov_b32 v34,v122
v_mov_b32 v35,v123
s_nop 1
dgo_100852:
v_smfmac_f32_16x16x64_bf16 v[96:99],v[32:35],v[144:151],v1
v_smfmac_f32_16x16x64_bf16 v[100:103],v[32:35],v[152:159],v1
dsk_100851:
s_bitcmp1_b32 s55,5
s_cbranch_scc0 dsk_100857
s_waitcnt vmcnt(2)
v_max3_u32 v124,v36,v37,v38
v_max_u32 v124,v124,v39
v_cmp_eq_u32 vcc,-1,v124
s_cbranch_vccz dgo_100858
s_nop 15
buffer_load_dwordx4 v[116:119],v0,s[20:23],s97 offen offset:1024 sc1
s_nop 15
buffer_load_dwordx4 v[120:123],v0,s[20:23],s97 offen offset:1024 sc1
dlp_100859:
s_waitcnt vmcnt(2)
v_max3_u32 v124,v36,v37,v38
v_max_u32 v124,v124,v39
v_cmp_eq_u32 vcc,-1,v124
s_cbranch_vccz dgo_100858
buffer_load_dwordx4 v[36:39],v0,s[20:23],s97 offen offset:1024 sc1
s_waitcnt vmcnt(2)
v_max3_u32 v124,v116,v117,v118
v_max_u32 v124,v124,v119
v_cmp_eq_u32 vcc,-1,v124
s_cbranch_vccz dcp_100861
buffer_load_dwordx4 v[116:119],v0,s[20:23],s97 offen offset:1024 sc1
s_waitcnt vmcnt(2)
v_max3_u32 v124,v120,v121,v122
v_max_u32 v124,v124,v123
v_cmp_eq_u32 vcc,-1,v124
s_cbranch_vccz dcp_100862
buffer_load_dwordx4 v[120:123],v0,s[20:23],s97 offen offset:1024 sc1
s_sub_u32 s90,s90,1
s_cmp_gt_i32 s90,0
s_cbranch_scc1 dlp_100859
s_branch dgo_100858
dcp_100861:
v_mov_b32 v36,v116
v_mov_b32 v37,v117
v_mov_b32 v38,v118
v_mov_b32 v39,v119
s_nop 1
s_branch dgo_100858
dcp_100862:
v_mov_b32 v36,v120
v_mov_b32 v37,v121
v_mov_b32 v38,v122
v_mov_b32 v39,v123
s_nop 1
dgo_100858:
v_smfmac_f32_16x16x64_bf16 v[96:99],v[36:39],v[160:167],v1
v_smfmac_f32_16x16x64_bf16 v[100:103],v[36:39],v[168:175],v1
dsk_100857:
s_bitcmp1_b32 s55,6
s_cbranch_scc0 dsk_100863
s_waitcnt vmcnt(2)
v_max3_u32 v124,v40,v41,v42
v_max_u32 v124,v124,v43
v_cmp_eq_u32 vcc,-1,v124
s_cbranch_vccz dgo_100864
s_nop 15
buffer_load_dwordx4 v[116:119],v0,s[20:23],s97 offen offset:2048 sc1
s_nop 15
buffer_load_dwordx4 v[120:123],v0,s[20:23],s97 offen offset:2048 sc1
dlp_100865:
s_waitcnt vmcnt(2)
v_max3_u32 v124,v40,v41,v42
v_max_u32 v124,v124,v43
v_cmp_eq_u32 vcc,-1,v124
s_cbranch_vccz dgo_100864
buffer_load_dwordx4 v[40:43],v0,s[20:23],s97 offen offset:2048 sc1
s_waitcnt vmcnt(2)
v_max3_u32 v124,v116,v117,v118
v_max_u32 v124,v124,v119
v_cmp_eq_u32 vcc,-1,v124
s_cbranch_vccz dcp_100867
buffer_load_dwordx4 v[116:119],v0,s[20:23],s97 offen offset:2048 sc1
s_waitcnt vmcnt(2)
v_max3_u32 v124,v120,v121,v122
v_max_u32 v124,v124,v123
v_cmp_eq_u32 vcc,-1,v124
s_cbranch_vccz dcp_100868
buffer_load_dwordx4 v[120:123],v0,s[20:23],s97 offen offset:2048 sc1
s_sub_u32 s90,s90,1
s_cmp_gt_i32 s90,0
s_cbranch_scc1 dlp_100865
s_branch dgo_100864
dcp_100867:
v_mov_b32 v40,v116
v_mov_b32 v41,v117
v_mov_b32 v42,v118
v_mov_b32 v43,v119
s_nop 1
s_branch dgo_100864
dcp_100868:
v_mov_b32 v40,v120
v_mov_b32 v41,v121
v_mov_b32 v42,v122
v_mov_b32 v43,v123
s_nop 1
dgo_100864:
v_smfmac_f32_16x16x64_bf16 v[96:99],v[40:43],v[176:183],v1
v_smfmac_f32_16x16x64_bf16 v[100:103],v[40:43],v[184:191],v1
dsk_100863:
s_bitcmp1_b32 s55,7
s_cbranch_scc0 dsk_100869
s_waitcnt vmcnt(2)
v_max3_u32 v124,v44,v45,v46
v_max_u32 v124,v124,v47
v_cmp_eq_u32 vcc,-1,v124
s_cbranch_vccz dgo_100870
s_nop 15
buffer_load_dwordx4 v[116:119],v0,s[20:23],s97 offen offset:3072 sc1
s_nop 15
buffer_load_dwordx4 v[120:123],v0,s[20:23],s97 offen offset:3072 sc1
dlp_100871:
s_waitcnt vmcnt(2)
v_max3_u32 v124,v44,v45,v46
v_max_u32 v124,v124,v47
v_cmp_eq_u32 vcc,-1,v124
s_cbranch_vccz dgo_100870
buffer_load_dwordx4 v[44:47],v0,s[20:23],s97 offen offset:3072 sc1
s_waitcnt vmcnt(2)
v_max3_u32 v124,v116,v117,v118
v_max_u32 v124,v124,v119
v_cmp_eq_u32 vcc,-1,v124
s_cbranch_vccz dcp_100873
buffer_load_dwordx4 v[116:119],v0,s[20:23],s97 offen offset:3072 sc1
s_waitcnt vmcnt(2)
v_max3_u32 v124,v120,v121,v122
v_max_u32 v124,v124,v123
v_cmp_eq_u32 vcc,-1,v124
s_cbranch_vccz dcp_100874
buffer_load_dwordx4 v[120:123],v0,s[20:23],s97 offen offset:3072 sc1
s_sub_u32 s90,s90,1
s_cmp_gt_i32 s90,0
s_cbranch_scc1 dlp_100871
s_branch dgo_100870
dcp_100873:
v_mov_b32 v44,v116
v_mov_b32 v45,v117
v_mov_b32 v46,v118
v_mov_b32 v47,v119
s_nop 1
s_branch dgo_100870
dcp_100874:
v_mov_b32 v44,v120
v_mov_b32 v45,v121
v_mov_b32 v46,v122
v_mov_b32 v47,v123
s_nop 1
dgo_100870:
v_smfmac_f32_16x16x64_bf16 v[96:99],v[44:47],v[192:199],v1
v_smfmac_f32_16x16x64_bf16 v[100:103],v[44:47],v[200:207],v1
dsk_100869:
s_mov_b32 s55,0
s_branch oback_100649
fl_100666:
flb_100674:
buffer_load_dwordx4 v[16:19],v0,s[20:23],s92 offen offset:0 sc1
s_mov_b32 s55,1
buffer_load_dwordx4 v[32:35],v0,s[20:23],s93 offen offset:0 sc1
s_waitcnt vmcnt(4)
v_max3_u32 v124,v20,v21,v22
v_max_u32 v124,v124,v23
v_cmp_eq_u32 vcc,-1,v124
s_cbranch_vccnz dfl_100875
v_smfmac_f32_16x16x64_bf16 v[64:67],v[20:23],a[96:103],v1
buffer_load_dword v125,off,s[20:23],s92 sc1
buffer_load_dwordx4 v[36:39],v0,s[20:23],s93 offen offset:1024 sc1
s_waitcnt vmcnt(5)
v_max3_u32 v124,v24,v25,v26
v_smfmac_f32_16x16x64_bf16 v[68:71],v[20:23],a[104:111],v1
v_max_u32 v124,v124,v27
v_cmp_eq_u32 vcc,-1,v124
v_smfmac_f32_16x16x64_bf16 v[72:75],v[20:23],a[112:119],v1
v_smfmac_f32_16x16x64_bf16 v[76:79],v[20:23],a[120:127],v1
s_cbranch_vccnz dfl_100876
v_smfmac_f32_16x16x64_bf16 v[64:67],v[24:27],a[160:167],v1
buffer_load_dword v125,off,s[20:23],s92 sc1
buffer_load_dwordx4 v[40:43],v0,s[20:23],s93 offen offset:2048 sc1
buffer_load_dwordx4 v[44:47],v0,s[20:23],s93 offen offset:3072 sc1
s_waitcnt vmcnt(7)
v_max3_u32 v124,v28,v29,v30
v_smfmac_f32_16x16x64_bf16 v[68:71],v[24:27],a[168:175],v1
v_max_u32 v124,v124,v31
v_cmp_eq_u32 vcc,-1,v124
v_smfmac_f32_16x16x64_bf16 v[72:75],v[24:27],a[176:183],v1
v_smfmac_f32_16x16x64_bf16 v[76:79],v[24:27],a[184:191],v1
s_cbranch_vccnz dfl_100877
v_smfmac_f32_16x16x64_bf16 v[64:67],v[28:31],a[224:231],v1
buffer_load_dword v125,off,s[20:23],s92 sc1
s_waitcnt vmcnt(7)
v_max3_u32 v124,v16,v17,v18
v_smfmac_f32_16x16x64_bf16 v[68:71],v[28:31],a[232:239],v1
v_max_u32 v124,v124,v19
v_cmp_eq_u32 vcc,-1,v124
v_smfmac_f32_16x16x64_bf16 v[72:75],v[28:31],a[240:247],v1
v_smfmac_f32_16x16x64_bf16 v[76:79],v[28:31],a[248:255],v1
s_cbranch_vccnz lfb_100882
s_mov_b32 s55,0
v_smfmac_f32_16x16x64_bf16 v[64:67],v[16:19],a[32:39],v1
s_waitcnt vmcnt(6)
v_max3_u32 v124,v32,v33,v34
v_max_u32 v124,v124,v35
v_cmp_eq_u32 vcc,-1,v124
v_smfmac_f32_16x16x64_bf16 v[68:71],v[16:19],a[40:47],v1
v_smfmac_f32_16x16x64_bf16 v[72:75],v[16:19],a[48:55],v1
v_smfmac_f32_16x16x64_bf16 v[76:79],v[16:19],a[56:63],v1
s_cbranch_vccnz flb_100678
s_branch segb_100662
fl_100667:
flb_100675:
buffer_load_dwordx4 v[20:23],v0,s[20:23],s92 offen offset:1024 sc1
s_mov_b32 s55,2
buffer_load_dwordx4 v[36:39],v0,s[20:23],s93 offen offset:1024 sc1
s_waitcnt vmcnt(5)
v_max3_u32 v124,v24,v25,v26
v_max_u32 v124,v124,v27
v_cmp_eq_u32 vcc,-1,v124
s_cbranch_vccnz dfl_100876
v_smfmac_f32_16x16x64_bf16 v[64:67],v[24:27],a[160:167],v1
buffer_load_dword v125,off,s[20:23],s92 sc1
buffer_load_dwordx4 v[40:43],v0,s[20:23],s93 offen offset:2048 sc1
buffer_load_dwordx4 v[44:47],v0,s[20:23],s93 offen offset:3072 sc1
s_waitcnt vmcnt(7)
v_max3_u32 v124,v28,v29,v30
v_smfmac_f32_16x16x64_bf16 v[68:71],v[24:27],a[168:175],v1
v_max_u32 v124,v124,v31
v_cmp_eq_u32 vcc,-1,v124
v_smfmac_f32_16x16x64_bf16 v[72:75],v[24:27],a[176:183],v1
v_smfmac_f32_16x16x64_bf16 v[76:79],v[24:27],a[184:191],v1
s_cbranch_vccnz dfl_100877
v_smfmac_f32_16x16x64_bf16 v[64:67],v[28:31],a[224:231],v1
buffer_load_dword v125,off,s[20:23],s92 sc1
s_waitcnt vmcnt(5)
v_max3_u32 v124,v20,v21,v22
v_smfmac_f32_16x16x64_bf16 v[68:71],v[28:31],a[232:239],v1
v_max_u32 v124,v124,v23
v_cmp_eq_u32 vcc,-1,v124
v_smfmac_f32_16x16x64_bf16 v[72:75],v[28:31],a[240:247],v1
v_smfmac_f32_16x16x64_bf16 v[76:79],v[28:31],a[248:255],v1
s_cbranch_vccnz lfb_100882
s_mov_b32 s55,0
v_smfmac_f32_16x16x64_bf16 v[64:67],v[20:23],a[96:103],v1
s_waitcnt vmcnt(6)
v_max3_u32 v124,v32,v33,v34
v_max_u32 v124,v124,v35
v_cmp_eq_u32 vcc,-1,v124
v_smfmac_f32_16x16x64_bf16 v[68:71],v[20:23],a[104:111],v1
v_smfmac_f32_16x16x64_bf16 v[72:75],v[20:23],a[112:119],v1
v_smfmac_f32_16x16x64_bf16 v[76:79],v[20:23],a[120:127],v1
s_cbranch_vccnz flb_100678
s_branch segb_100662
fl_100668:
flb_100676:
buffer_load_dwordx4 v[24:27],v0,s[20:23],s92 offen offset:2048 sc1
s_mov_b32 s55,4
buffer_load_dwordx4 v[40:43],v0,s[20:23],s93 offen offset:2048 sc1
buffer_load_dwordx4 v[44:47],v0,s[20:23],s93 offen offset:3072 sc1
s_waitcnt vmcnt(7)
v_max3_u32 v124,v28,v29,v30
v_max_u32 v124,v124,v31
v_cmp_eq_u32 vcc,-1,v124
s_cbranch_vccnz dfl_100877
v_smfmac_f32_16x16x64_bf16 v[64:67],v[28:31],a[224:231],v1
buffer_load_dword v125,off,s[20:23],s92 sc1
s_waitcnt vmcnt(3)
v_max3_u32 v124,v24,v25,v26
v_smfmac_f32_16x16x64_bf16 v[68:71],v[28:31],a[232:239],v1
v_max_u32 v124,v124,v27
v_cmp_eq_u32 vcc,-1,v124
v_smfmac_f32_16x16x64_bf16 v[72:75],v[28:31],a[240:247],v1
v_smfmac_f32_16x16x64_bf16 v[76:79],v[28:31],a[248:255],v1
s_cbranch_vccnz lfb_100882
s_mov_b32 s55,0
v_smfmac_f32_16x16x64_bf16 v[64:67],v[24:27],a[160:167],v1
s_waitcnt vmcnt(6)
v_max3_u32 v124,v32,v33,v34
v_max_u32 v124,v124,v35
v_cmp_eq_u32 vcc,-1,v124
v_smfmac_f32_16x16x64_bf16 v[68:71],v[24:27],a[168:175],v1
v_smfmac_f32_16x16x64_bf16 v[72:75],v[24:27],a[176:183],v1
v_smfmac_f32_16x16x64_bf16 v[76:79],v[24:27],a[184:191],v1
s_cbranch_vccnz flb_100678
s_branch segb_100662
fl_100669:
flb_100677:
buffer_load_dwordx4 v[28:31],v0,s[20:23],s92 offen offset:3072 sc1
s_mov_b32 s55,8
s_waitcnt vmcnt(0)
v_max3_u32 v124,v28,v29,v30
v_max_u32 v124,v124,v31
v_cmp_eq_u32 vcc,-1,v124
s_cbranch_vccnz lfb_100882
s_mov_b32 s55,0
v_smfmac_f32_16x16x64_bf16 v[64:67],v[28:31],a[224:231],v1
s_waitcnt vmcnt(6)
v_max3_u32 v124,v32,v33,v34
v_max_u32 v124,v124,v35
v_cmp_eq_u32 vcc,-1,v124
v_smfmac_f32_16x16x64_bf16 v[68:71],v[28:31],a[232:239],v1
v_smfmac_f32_16x16x64_bf16 v[72:75],v[28:31],a[240:247],v1
v_smfmac_f32_16x16x64_bf16 v[76:79],v[28:31],a[248:255],v1
s_cbranch_vccnz flb_100678
s_branch segb_100662
fl_100670:
flb_100678:
buffer_load_dwordx4 v[32:35],v0,s[20:23],s93 offen offset:0 sc1
s_mov_b32 s55,240
buffer_store_dwordx4 v[112:115],v120,s[20:23],s101 offen sc1
buffer_store_dword v126,v121,s[20:23],s69 offen sc1
s_bitcmp1_b32 s55,5
s_cbranch_scc0 rdn_100885
s_waitcnt vmcnt(7)
v_max3_u32 v124,v36,v37,v38
v_max_u32 v124,v124,v39
v_cmp_eq_u32 vcc,-1,v124
s_cbranch_vccnz rfa_100886
buffer_load_dword v125,off,s[20:23],s92 sc1
s_bitset0_b32 s55,5
v_smfmac_f32_16x16x64_bf16 v[64:67],v[36:39],a[96:103],v1
v_smfmac_f32_16x16x64_bf16 v[68:71],v[36:39],a[104:111],v1
v_smfmac_f32_16x16x64_bf16 v[72:75],v[36:39],a[112:119],v1
v_smfmac_f32_16x16x64_bf16 v[76:79],v[36:39],a[120:127],v1
s_cmp_eq_u32 s55,0
s_cbranch_scc1 segb_100664
s_branch rnx_100887
rdn_100885:
buffer_load_dword v125,off,s[20:23],s92 sc1
s_branch rnx_100887
rfa_100886:
buffer_load_dwordx4 v[36:39],v0,s[20:23],s93 offen offset:1024 sc1
rnx_100887:
s_bitcmp1_b32 s55,6
s_cbranch_scc0 rdn_100888
s_waitcnt vmcnt(6)
v_max3_u32 v124,v40,v41,v42
v_max_u32 v124,v124,v43
v_cmp_eq_u32 vcc,-1,v124
s_cbranch_vccnz rfa_100889
buffer_load_dword v125,off,s[20:23],s92 sc1
s_bitset0_b32 s55,6
s_cmp_eq_u32 s55,0
s_cbranch_scc1 segb_100664
s_branch rnx_100890
rdn_100888:
buffer_load_dword v125,off,s[20:23],s92 sc1
s_branch rnx_100890
rfa_100889:
buffer_load_dwordx4 v[40:43],v0,s[20:23],s93 offen offset:2048 sc1
rnx_100890:
s_bitcmp1_b32 s55,7
s_cbranch_scc0 rdn_100891
s_waitcnt vmcnt(6)
v_max3_u32 v124,v44,v45,v46
v_max_u32 v124,v124,v47
v_cmp_eq_u32 vcc,-1,v124
s_cbranch_vccnz rfa_100892
buffer_load_dword v125,off,s[20:23],s92 sc1
s_bitset0_b32 s55,7
s_cmp_eq_u32 s55,0
s_cbranch_scc1 segb_100664
s_branch rnx_100893
rdn_100891:
buffer_load_dword v125,off,s[20:23],s92 sc1
s_branch rnx_100893
rfa_100892:
buffer_load_dwordx4 v[44:47],v0,s[20:23],s93 offen offset:3072 sc1
rnx_100893:
rot_100884:
s_bitcmp1_b32 s55,4
s_cbranch_scc0 rdn_100894
s_waitcnt vmcnt(3)
v_max3_u32 v124,v32,v33,v34
v_max_u32 v124,v124,v35
v_cmp_eq_u32 vcc,-1,v124
s_cbranch_vccnz rfa_100895
buffer_load_dword v125,off,s[20:23],s92 sc1
s_bitset0_b32 s55,4
v_smfmac_f32_16x16x64_bf16 v[64:67],v[32:35],a[32:39],v1
v_smfmac_f32_16x16x64_bf16 v[68:71],v[32:35],a[40:47],v1
v_smfmac_f32_16x16x64_bf16 v[72:75],v[32:35],a[48:55],v1
v_smfmac_f32_16x16x64_bf16 v[76:79],v[32:35],a[56:63],v1
s_cmp_eq_u32 s55,0
s_cbranch_scc1 segb_100664
s_branch rnx_100896
rdn_100894:
buffer_load_dword v125,off,s[20:23],s92 sc1
s_branch rnx_100896
rfa_100895:
buffer_load_dwordx4 v[32:35],v0,s[20:23],s93 offen offset:0 sc1
rnx_100896:
s_bitcmp1_b32 s55,5
s_cbranch_scc0 rdn_100897
s_waitcnt vmcnt(3)
v_max3_u32 v124,v36,v37,v38
v_max_u32 v124,v124,v39
v_cmp_eq_u32 vcc,-1,v124
s_cbranch_vccnz rfa_100898
buffer_load_dword v125,off,s[20:23],s92 sc1
s_bitset0_b32 s55,5
v_smfmac_f32_16x16x64_bf16 v[64:67],v[36:39],a[96:103],v1
v_smfmac_f32_16x16x64_bf16 v[68:71],v[36:39],a[104:111],v1
v_smfmac_f32_16x16x64_bf16 v[72:75],v[36:39],a[112:119],v1
v_smfmac_f32_16x16x64_bf16 v[76:79],v[36:39],a[120:127],v1
s_cmp_eq_u32 s55,0
s_cbranch_scc1 segb_100664
s_branch rnx_100899
rdn_100897:
buffer_load_dword v125,off,s[20:23],s92 sc1
s_branch rnx_100899
rfa_100898:
buffer_load_dwordx4 v[36:39],v0,s[20:23],s93 offen offset:1024 sc1
rnx_100899:
s_bitcmp1_b32 s55,6
s_cbranch_scc0 rdn_100900
s_waitcnt vmcnt(3)
v_max3_u32 v124,v40,v41,v42
v_max_u32 v124,v124,v43
v_cmp_eq_u32 vcc,-1,v124
s_cbranch_vccnz rfa_100901
buffer_load_dword v125,off,s[20:23],s92 sc1
s_bitset0_b32 s55,6
s_cmp_eq_u32 s55,0
s_cbranch_scc1 segb_100664
s_branch rnx_100902
rdn_100900:
buffer_load_dword v125,off,s[20:23],s92 sc1
s_branch rnx_100902
rfa_100901:
buffer_load_dwordx4 v[40:43],v0,s[20:23],s93 offen offset:2048 sc1
rnx_100902:
s_bitcmp1_b32 s55,7
s_cbranch_scc0 rdn_100903
s_waitcnt vmcnt(3)
v_max3_u32 v124,v44,v45,v46
v_max_u32 v124,v124,v47
v_cmp_eq_u32 vcc,-1,v124
s_cbranch_vccnz rfa_100904
buffer_load_dword v125,off,s[20:23],s92 sc1
s_bitset0_b32 s55,7
s_cmp_eq_u32 s55,0
s_cbranch_scc1 segb_100664
s_branch rnx_100905
rdn_100903:
buffer_load_dword v125,off,s[20:23],s92 sc1
s_branch rnx_100905
rfa_100904:
buffer_load_dwordx4 v[44:47],v0,s[20:23],s93 offen offset:3072 sc1
rnx_100905:
s_sub_u32 s90,s90,1
s_cmp_gt_i32 s90,0
s_cbranch_scc1 rot_100884
s_mov_b32 s55,0
s_branch segb_100664
fl_100671:
flb_100679:
buffer_load_dwordx4 v[36:39],v0,s[20:23],s93 offen offset:1024 sc1
s_mov_b32 s55,224
s_bitcmp1_b32 s55,6
s_cbranch_scc0 rdn_100907
s_waitcnt vmcnt(6)
v_max3_u32 v124,v40,v41,v42
v_max_u32 v124,v124,v43
v_cmp_eq_u32 vcc,-1,v124
s_cbranch_vccnz rfa_100908
buffer_load_dword v125,off,s[20:23],s92 sc1
s_bitset0_b32 s55,6
s_cmp_eq_u32 s55,0
s_cbranch_scc1 segb_100664
s_branch rnx_100909
rdn_100907:
buffer_load_dword v125,off,s[20:23],s92 sc1
s_branch rnx_100909
rfa_100908:
buffer_load_dwordx4 v[40:43],v0,s[20:23],s93 offen offset:2048 sc1
rnx_100909:
s_bitcmp1_b32 s55,7
s_cbranch_scc0 rdn_100910
s_waitcnt vmcnt(6)
v_max3_u32 v124,v44,v45,v46
v_max_u32 v124,v124,v47
v_cmp_eq_u32 vcc,-1,v124
s_cbranch_vccnz rfa_100911
buffer_load_dword v125,off,s[20:23],s92 sc1
s_bitset0_b32 s55,7
s_cmp_eq_u32 s55,0
s_cbranch_scc1 segb_100664
s_branch rnx_100912
rdn_100910:
buffer_load_dword v125,off,s[20:23],s92 sc1
s_branch rnx_100912
rfa_100911:
buffer_load_dwordx4 v[44:47],v0,s[20:23],s93 offen offset:3072 sc1
rnx_100912:
rot_100906:
s_bitcmp1_b32 s55,5
s_cbranch_scc0 rdn_100913
s_waitcnt vmcnt(2)
v_max3_u32 v124,v36,v37,v38
v_max_u32 v124,v124,v39
v_cmp_eq_u32 vcc,-1,v124
s_cbranch_vccnz rfa_100914
buffer_load_dword v125,off,s[20:23],s92 sc1
s_bitset0_b32 s55,5
v_smfmac_f32_16x16x64_bf16 v[64:67],v[36:39],a[96:103],v1
v_smfmac_f32_16x16x64_bf16 v[68:71],v[36:39],a[104:111],v1
v_smfmac_f32_16x16x64_bf16 v[72:75],v[36:39],a[112:119],v1
v_smfmac_f32_16x16x64_bf16 v[76:79],v[36:39],a[120:127],v1
s_cmp_eq_u32 s55,0
s_cbranch_scc1 segb_100664
s_branch rnx_100915
rdn_100913:
buffer_load_dword v125,off,s[20:23],s92 sc1
s_branch rnx_100915
rfa_100914:
buffer_load_dwordx4 v[36:39],v0,s[20:23],s93 offen offset:1024 sc1
rnx_100915:
s_bitcmp1_b32 s55,6
s_cbranch_scc0 rdn_100916
s_waitcnt vmcnt(2)
v_max3_u32 v124,v40,v41,v42
v_max_u32 v124,v124,v43
v_cmp_eq_u32 vcc,-1,v124
s_cbranch_vccnz rfa_100917
buffer_load_dword v125,off,s[20:23],s92 sc1
s_bitset0_b32 s55,6
s_cmp_eq_u32 s55,0
s_cbranch_scc1 segb_100664
s_branch rnx_100918
rdn_100916:
buffer_load_dword v125,off,s[20:23],s92 sc1
s_branch rnx_100918
rfa_100917:
buffer_load_dwordx4 v[40:43],v0,s[20:23],s93 offen offset:2048 sc1
rnx_100918:
s_bitcmp1_b32 s55,7
s_cbranch_scc0 rdn_100919
s_waitcnt vmcnt(2)
v_max3_u32 v124,v44,v45,v46
v_max_u32 v124,v124,v47
v_cmp_eq_u32 vcc,-1,v124
s_cbranch_vccnz rfa_100920
buffer_load_dword v125,off,s[20:23],s92 sc1
s_bitset0_b32 s55,7
s_cmp_eq_u32 s55,0
s_cbranch_scc1 segb_100664
s_branch rnx_100921
rdn_100919:
buffer_load_dword v125,off,s[20:23],s92 sc1
s_branch rnx_100921
rfa_100920:
buffer_load_dwordx4 v[44:47],v0,s[20:23],s93 offen offset:3072 sc1
rnx_100921:
s_sub_u32 s90,s90,1
s_cmp_gt_i32 s90,0
s_cbranch_scc1 rot_100906
s_mov_b32 s55,0
s_branch segb_100664
fl_100672:
flb_100680:
s_mov_b32 s55,192
s_bitcmp1_b32 s55,6
s_cbranch_scc0 rdn_100923
s_waitcnt vmcnt(6)
v_max3_u32 v124,v40,v41,v42
v_max_u32 v124,v124,v43
v_cmp_eq_u32 vcc,-1,v124
s_cbranch_vccnz rfa_100924
buffer_load_dword v125,off,s[20:23],s92 sc1
s_bitset0_b32 s55,6
s_cmp_eq_u32 s55,0
s_cbranch_scc1 segb_100664
s_branch rnx_100925
rdn_100923:
buffer_load_dword v125,off,s[20:23],s92 sc1
s_branch rnx_100925
rfa_100924:
buffer_load_dwordx4 v[40:43],v0,s[20:23],s93 offen offset:2048 sc1
rnx_100925:
s_bitcmp1_b32 s55,7
s_cbranch_scc0 rdn_100926
s_waitcnt vmcnt(6)
v_max3_u32 v124,v44,v45,v46
v_max_u32 v124,v124,v47
v_cmp_eq_u32 vcc,-1,v124
s_cbranch_vccnz rfa_100927
buffer_load_dword v125,off,s[20:23],s92 sc1
s_bitset0_b32 s55,7
s_cmp_eq_u32 s55,0
s_cbranch_scc1 segb_100664
s_branch rnx_100928
rdn_100926:
buffer_load_dword v125,off,s[20:23],s92 sc1
s_branch rnx_100928
rfa_100927:
buffer_load_dwordx4 v[44:47],v0,s[20:23],s93 offen offset:3072 sc1
rnx_100928:
rot_100922:
s_bitcmp1_b32 s55,6
s_cbranch_scc0 rdn_100929
s_waitcnt vmcnt(1)
v_max3_u32 v124,v40,v41,v42
v_max_u32 v124,v124,v43
v_cmp_eq_u32 vcc,-1,v124
s_cbranch_vccnz rfa_100930
buffer_load_dword v125,off,s[20:23],s92 sc1
s_bitset0_b32 s55,6
s_cmp_eq_u32 s55,0
s_cbranch_scc1 segb_100664
s_branch rnx_100931
rdn_100929:
buffer_load_dword v125,off,s[20:23],s92 sc1
s_branch rnx_100931
rfa_100930:
buffer_load_dwordx4 v[40:43],v0,s[20:23],s93 offen offset:2048 sc1
rnx_100931:
s_bitcmp1_b32 s55,7
s_cbranch_scc0 rdn_100932
s_waitcnt vmcnt(1)
v_max3_u32 v124,v44,v45,v46
v_max_u32 v124,v124,v47
v_cmp_eq_u32 vcc,-1,v124
s_cbranch_vccnz rfa_100933
buffer_load_dword v125,off,s[20:23],s92 sc1
s_bitset0_b32 s55,7
s_cmp_eq_u32 s55,0
s_cbranch_scc1 segb_100664
s_branch rnx_100934
rdn_100932:
buffer_load_dword v125,off,s[20:23],s92 sc1
s_branch rnx_100934
rfa_100933:
buffer_load_dwordx4 v[44:47],v0,s[20:23],s93 offen offset:3072 sc1
rnx_100934:
s_sub_u32 s90,s90,1
s_cmp_gt_i32 s90,0
s_cbranch_scc1 rot_100922
s_mov_b32 s55,0
s_branch segb_100664
dfl_100875:
buffer_load_dwordx4 v[20:23],v0,s[20:23],s92 offen offset:1024 sc1
s_bitset1_b32 s55,1
buffer_load_dwordx4 v[36:39],v0,s[20:23],s93 offen offset:1024 sc1
s_waitcnt vmcnt(5)
v_max3_u32 v124,v24,v25,v26
v_max_u32 v124,v124,v27
v_cmp_eq_u32 vcc,-1,v124
s_cbranch_vccnz dfl_100876
s_branch dseg_100879
dfl_100876:
buffer_load_dwordx4 v[24:27],v0,s[20:23],s92 offen offset:2048 sc1
s_bitset1_b32 s55,2
buffer_load_dwordx4 v[40:43],v0,s[20:23],s93 offen offset:2048 sc1
buffer_load_dwordx4 v[44:47],v0,s[20:23],s93 offen offset:3072 sc1
s_waitcnt vmcnt(7)
v_max3_u32 v124,v28,v29,v30
v_max_u32 v124,v124,v31
v_cmp_eq_u32 vcc,-1,v124
s_cbranch_vccnz dfl_100877
s_branch dseg_100880
dfl_100877:
buffer_load_dwordx4 v[28:31],v0,s[20:23],s92 offen offset:3072 sc1
s_bitset1_b32 s55,3
s_branch lap2_100881
dseg_100879:
v_smfmac_f32_16x16x64_bf16 v[64:67],v[24:27],a[160:167],v1
buffer_load_dword v125,off,s[20:23],s92 sc1
buffer_load_dwordx4 v[40:43],v0,s[20:23],s93 offen offset:2048 sc1
buffer_load_dwordx4 v[44:47],v0,s[20:23],s93 offen offset:3072 sc1
s_waitcnt vmcnt(7)
v_max3_u32 v124,v28,v29,v30
v_smfmac_f32_16x16x64_bf16 v[68:71],v[24:27],a[168:175],v1
v_max_u32 v124,v124,v31
v_cmp_eq_u32 vcc,-1,v124
v_smfmac_f32_16x16x64_bf16 v[72:75],v[24:27],a[176:183],v1
v_smfmac_f32_16x16x64_bf16 v[76:79],v[24:27],a[184:191],v1
s_cbranch_vccnz dfl_100877
dseg_100880:
v_smfmac_f32_16x16x64_bf16 v[64:67],v[28:31],a[224:231],v1
buffer_load_dword v125,off,s[20:23],s92 sc1
v_smfmac_f32_16x16x64_bf16 v[68:71],v[28:31],a[232:239],v1
v_smfmac_f32_16x16x64_bf16 v[72:75],v[28:31],a[240:247],v1
v_smfmac_f32_16x16x64_bf16 v[76:79],v[28:31],a[248:255],v1
lap2_100881:
s_bitcmp1_b32 s55,0
s_cbranch_scc0 l2s_100935
s_waitcnt vmcnt(7)
v_max3_u32 v124,v16,v17,v18
v_max_u32 v124,v124,v19
v_cmp_eq_u32 vcc,-1,v124
s_cbranch_vccnz l2s_100935
s_bitset0_b32 s55,0
v_smfmac_f32_16x16x64_bf16 v[64:67],v[16:19],a[32:39],v1
v_smfmac_f32_16x16x64_bf16 v[68:71],v[16:19],a[40:47],v1
v_smfmac_f32_16x16x64_bf16 v[72:75],v[16:19],a[48:55],v1
v_smfmac_f32_16x16x64_bf16 v[76:79],v[16:19],a[56:63],v1
l2s_100935:
s_bitcmp1_b32 s55,1
s_cbranch_scc0 l2s_100937
s_waitcnt vmcnt(5)
v_max3_u32 v124,v20,v21,v22
v_max_u32 v124,v124,v23
v_cmp_eq_u32 vcc,-1,v124
s_cbranch_vccnz l2s_100937
s_bitset0_b32 s55,1
v_smfmac_f32_16x16x64_bf16 v[64:67],v[20:23],a[96:103],v1
v_smfmac_f32_16x16x64_bf16 v[68:71],v[20:23],a[104:111],v1
v_smfmac_f32_16x16x64_bf16 v[72:75],v[20:23],a[112:119],v1
v_smfmac_f32_16x16x64_bf16 v[76:79],v[20:23],a[120:127],v1
l2s_100937:
s_bitcmp1_b32 s55,2
s_cbranch_scc0 l2s_100939
s_waitcnt vmcnt(3)
v_max3_u32 v124,v24,v25,v26
v_max_u32 v124,v124,v27
v_cmp_eq_u32 vcc,-1,v124
s_cbranch_vccnz l2s_100939
s_bitset0_b32 s55,2
v_smfmac_f32_16x16x64_bf16 v[64:67],v[24:27],a[160:167],v1
v_smfmac_f32_16x16x64_bf16 v[68:71],v[24:27],a[168:175],v1
v_smfmac_f32_16x16x64_bf16 v[72:75],v[24:27],a[176:183],v1
v_smfmac_f32_16x16x64_bf16 v[76:79],v[24:27],a[184:191],v1
l2s_100939:
s_bitcmp1_b32 s55,3
s_cbranch_scc0 l2s_100941
s_waitcnt vmcnt(0)
v_max3_u32 v124,v28,v29,v30
v_max_u32 v124,v124,v31
v_cmp_eq_u32 vcc,-1,v124
s_cbranch_vccnz l2s_100941
s_bitset0_b32 s55,3
v_smfmac_f32_16x16x64_bf16 v[64:67],v[28:31],a[224:231],v1
v_smfmac_f32_16x16x64_bf16 v[68:71],v[28:31],a[232:239],v1
v_smfmac_f32_16x16x64_bf16 v[72:75],v[28:31],a[240:247],v1
v_smfmac_f32_16x16x64_bf16 v[76:79],v[28:31],a[248:255],v1
l2s_100941:
s_cmp_eq_u32 s55,0
s_cbranch_scc0 lfb_100882
Ldone_100883:
s_waitcnt vmcnt(6)
v_max3_u32 v124,v32,v33,v34
v_max_u32 v124,v124,v35
v_cmp_eq_u32 vcc,-1,v124
s_cbranch_vccnz flb_100678
s_branch segb_100662
lfb_100882:
s_bitcmp1_b32 s55,0
s_cbranch_scc0 dsk_100943
buffer_load_dwordx4 v[16:19],v0,s[20:23],s92 offen offset:0 sc1
dsk_100943:
s_bitcmp1_b32 s55,1
s_cbranch_scc0 dsk_100944
buffer_load_dwordx4 v[20:23],v0,s[20:23],s92 offen offset:1024 sc1
dsk_100944:
s_bitcmp1_b32 s55,2
s_cbranch_scc0 dsk_100945
buffer_load_dwordx4 v[24:27],v0,s[20:23],s92 offen offset:2048 sc1
dsk_100945:
s_bitcmp1_b32 s55,3
s_cbranch_scc0 dsk_100946
buffer_load_dwordx4 v[28:31],v0,s[20:23],s92 offen offset:3072 sc1
dsk_100946:
s_bitcmp1_b32 s55,0
s_cbranch_scc0 dsk_100947
s_waitcnt vmcnt(2)
v_max3_u32 v124,v16,v17,v18
v_max_u32 v124,v124,v19
v_cmp_eq_u32 vcc,-1,v124
s_cbranch_vccz dgo_100948
s_nop 15
buffer_load_dwordx4 v[104:107],v0,s[20:23],s92 offen offset:0 sc1
s_nop 15
buffer_load_dwordx4 v[108:111],v0,s[20:23],s92 offen offset:0 sc1
dlp_100949:
s_waitcnt vmcnt(2)
v_max3_u32 v124,v16,v17,v18
v_max_u32 v124,v124,v19
v_cmp_eq_u32 vcc,-1,v124
s_cbranch_vccz dgo_100948
buffer_load_dwordx4 v[16:19],v0,s[20:23],s92 offen offset:0 sc1
s_waitcnt vmcnt(2)
v_max3_u32 v124,v104,v105,v106
v_max_u32 v124,v124,v107
v_cmp_eq_u32 vcc,-1,v124
s_cbranch_vccz dcp_100951
buffer_load_dwordx4 v[104:107],v0,s[20:23],s92 offen offset:0 sc1
s_waitcnt vmcnt(2)
v_max3_u32 v124,v108,v109,v110
v_max_u32 v124,v124,v111
v_cmp_eq_u32 vcc,-1,v124
s_cbranch_vccz dcp_100952
buffer_load_dwordx4 v[108:111],v0,s[20:23],s92 offen offset:0 sc1
s_sub_u32 s90,s90,1
s_cmp_gt_i32 s90,0
s_cbranch_scc1 dlp_100949
s_branch dgo_100948
dcp_100951:
v_mov_b32 v16,v104
v_mov_b32 v17,v105
v_mov_b32 v18,v106
v_mov_b32 v19,v107
s_nop 1
s_branch dgo_100948
dcp_100952:
v_mov_b32 v16,v108
v_mov_b32 v17,v109
v_mov_b32 v18,v110
v_mov_b32 v19,v111
s_nop 1
dgo_100948:
v_smfmac_f32_16x16x64_bf16 v[64:67],v[16:19],a[32:39],v1
v_smfmac_f32_16x16x64_bf16 v[68:71],v[16:19],a[40:47],v1
v_smfmac_f32_16x16x64_bf16 v[72:75],v[16:19],a[48:55],v1
v_smfmac_f32_16x16x64_bf16 v[76:79],v[16:19],a[56:63],v1
dsk_100947:
s_bitcmp1_b32 s55,1
s_cbranch_scc0 dsk_100953
s_waitcnt vmcnt(2)
v_max3_u32 v124,v20,v21,v22
v_max_u32 v124,v124,v23
v_cmp_eq_u32 vcc,-1,v124
s_cbranch_vccz dgo_100954
s_nop 15
buffer_load_dwordx4 v[104:107],v0,s[20:23],s92 offen offset:1024 sc1
s_nop 15
buffer_load_dwordx4 v[108:111],v0,s[20:23],s92 offen offset:1024 sc1
dlp_100955:
s_waitcnt vmcnt(2)
v_max3_u32 v124,v20,v21,v22
v_max_u32 v124,v124,v23
v_cmp_eq_u32 vcc,-1,v124
s_cbranch_vccz dgo_100954
buffer_load_dwordx4 v[20:23],v0,s[20:23],s92 offen offset:1024 sc1
s_waitcnt vmcnt(2)
v_max3_u32 v124,v104,v105,v106
v_max_u32 v124,v124,v107
v_cmp_eq_u32 vcc,-1,v124
s_cbranch_vccz dcp_100957
buffer_load_dwordx4 v[104:107],v0,s[20:23],s92 offen offset:1024 sc1
s_waitcnt vmcnt(2)
v_max3_u32 v124,v108,v109,v110
v_max_u32 v124,v124,v111
v_cmp_eq_u32 vcc,-1,v124
s_cbranch_vccz dcp_100958
buffer_load_dwordx4 v[108:111],v0,s[20:23],s92 offen offset:1024 sc1
s_sub_u32 s90,s90,1
s_cmp_gt_i32 s90,0
s_cbranch_scc1 dlp_100955
s_branch dgo_100954
dcp_100957:
v_mov_b32 v20,v104
v_mov_b32 v21,v105
v_mov_b32 v22,v106
v_mov_b32 v23,v107
s_nop 1
s_branch dgo_100954
dcp_100958:
v_mov_b32 v20,v108
v_mov_b32 v21,v109
v_mov_b32 v22,v110
v_mov_b32 v23,v111
s_nop 1
dgo_100954:
v_smfmac_f32_16x16x64_bf16 v[64:67],v[20:23],a[96:103],v1
v_smfmac_f32_16x16x64_bf16 v[68:71],v[20:23],a[104:111],v1
v_smfmac_f32_16x16x64_bf16 v[72:75],v[20:23],a[112:119],v1
v_smfmac_f32_16x16x64_bf16 v[76:79],v[20:23],a[120:127],v1
dsk_100953:
s_bitcmp1_b32 s55,2
s_cbranch_scc0 dsk_100959
s_waitcnt vmcnt(2)
v_max3_u32 v124,v24,v25,v26
v_max_u32 v124,v124,v27
v_cmp_eq_u32 vcc,-1,v124
s_cbranch_vccz dgo_100960
s_nop 15
buffer_load_dwordx4 v[104:107],v0,s[20:23],s92 offen offset:2048 sc1
s_nop 15
buffer_load_dwordx4 v[108:111],v0,s[20:23],s92 offen offset:2048 sc1
dlp_100961:
s_waitcnt vmcnt(2)
v_max3_u32 v124,v24,v25,v26
v_max_u32 v124,v124,v27
v_cmp_eq_u32 vcc,-1,v124
s_cbranch_vccz dgo_100960
buffer_load_dwordx4 v[24:27],v0,s[20:23],s92 offen offset:2048 sc1
s_waitcnt vmcnt(2)
v_max3_u32 v124,v104,v105,v106
v_max_u32 v124,v124,v107
v_cmp_eq_u32 vcc,-1,v124
s_cbranch_vccz dcp_100963
buffer_load_dwordx4 v[104:107],v0,s[20:23],s92 offen offset:2048 sc1
s_waitcnt vmcnt(2)
v_max3_u32 v124,v108,v109,v110
v_max_u32 v124,v124,v111
v_cmp_eq_u32 vcc,-1,v124
s_cbranch_vccz dcp_100964
buffer_load_dwordx4 v[108:111],v0,s[20:23],s92 offen offset:2048 sc1
s_sub_u32 s90,s90,1
s_cmp_gt_i32 s90,0
s_cbranch_scc1 dlp_100961
s_branch dgo_100960
dcp_100963:
v_mov_b32 v24,v104
v_mov_b32 v25,v105
v_mov_b32 v26,v106
v_mov_b32 v27,v107
s_nop 1
s_branch dgo_100960
dcp_100964:
v_mov_b32 v24,v108
v_mov_b32 v25,v109
v_mov_b32 v26,v110
v_mov_b32 v27,v111
s_nop 1
dgo_100960:
v_smfmac_f32_16x16x64_bf16 v[64:67],v[24:27],a[160:167],v1
v_smfmac_f32_16x16x64_bf16 v[68:71],v[24:27],a[168:175],v1
v_smfmac_f32_16x16x64_bf16 v[72:75],v[24:27],a[176:183],v1
v_smfmac_f32_16x16x64_bf16 v[76:79],v[24:27],a[184:191],v1
dsk_100959:
s_bitcmp1_b32 s55,3
s_cbranch_scc0 dsk_100965
s_waitcnt vmcnt(2)
v_max3_u32 v124,v28,v29,v30
v_max_u32 v124,v124,v31
v_cmp_eq_u32 vcc,-1,v124
s_cbranch_vccz dgo_100966
s_nop 15
buffer_load_dwordx4 v[104:107],v0,s[20:23],s92 offen offset:3072 sc1
s_nop 15
buffer_load_dwordx4 v[108:111],v0,s[20:23],s92 offen offset:3072 sc1
dlp_100967:
s_waitcnt vmcnt(2)
v_max3_u32 v124,v28,v29,v30
v_max_u32 v124,v124,v31
v_cmp_eq_u32 vcc,-1,v124
s_cbranch_vccz dgo_100966
buffer_load_dwordx4 v[28:31],v0,s[20:23],s92 offen offset:3072 sc1
s_waitcnt vmcnt(2)
v_max3_u32 v124,v104,v105,v106
v_max_u32 v124,v124,v107
v_cmp_eq_u32 vcc,-1,v124
s_cbranch_vccz dcp_100969
buffer_load_dwordx4 v[104:107],v0,s[20:23],s92 offen offset:3072 sc1
s_waitcnt vmcnt(2)
v_max3_u32 v124,v108,v109,v110
v_max_u32 v124,v124,v111
v_cmp_eq_u32 vcc,-1,v124
s_cbranch_vccz dcp_100970
buffer_load_dwordx4 v[108:111],v0,s[20:23],s92 offen offset:3072 sc1
s_sub_u32 s90,s90,1
s_cmp_gt_i32 s90,0
s_cbranch_scc1 dlp_100967
s_branch dgo_100966
dcp_100969:
v_mov_b32 v28,v104
v_mov_b32 v29,v105
v_mov_b32 v30,v106
v_mov_b32 v31,v107
s_nop 1
s_branch dgo_100966
dcp_100970:
v_mov_b32 v28,v108
v_mov_b32 v29,v109
v_mov_b32 v30,v110
v_mov_b32 v31,v111
s_nop 1
dgo_100966:
v_smfmac_f32_16x16x64_bf16 v[64:67],v[28:31],a[224:231],v1
v_smfmac_f32_16x16x64_bf16 v[68:71],v[28:31],a[232:239],v1
v_smfmac_f32_16x16x64_bf16 v[72:75],v[28:31],a[240:247],v1
v_smfmac_f32_16x16x64_bf16 v[76:79],v[28:31],a[248:255],v1
dsk_100965:
s_mov_b32 s55,0
s_branch Ldone_100883
slowA_100682:
buffer_load_dwordx4 v[44:47],v0,s[20:23],s93 offen offset:3072 sc1
dsk_100971:
s_bitcmp1_b32 s55,7
s_cbranch_scc0 dsk_100972
s_waitcnt vmcnt(2)
v_max3_u32 v124,v44,v45,v46
v_max_u32 v124,v124,v47
v_cmp_eq_u32 vcc,-1,v124
s_cbranch_vccz dgo_100973
s_nop 15
s_nop 3
buffer_load_dwordx4 v[104:107],v0,s[20:23],s93 offen offset:3072 sc1
s_nop 15
s_nop 3
buffer_load_dwordx4 v[108:111],v0,s[20:23],s93 offen offset:3072 sc1
dlp_100974:
s_waitcnt vmcnt(2)
v_max3_u32 v124,v44,v45,v46
v_max_u32 v124,v124,v47
v_cmp_eq_u32 vcc,-1,v124
s_cbranch_vccz dgo_100973
buffer_load_dwordx4 v[44:47],v0,s[20:23],s93 offen offset:3072 sc1
s_waitcnt vmcnt(2)
v_max3_u32 v124,v104,v105,v106
v_max_u32 v124,v124,v107
v_cmp_eq_u32 vcc,-1,v124
s_cbranch_vccz dcp_100976
buffer_load_dwordx4 v[104:107],v0,s[20:23],s93 offen offset:3072 sc1
s_waitcnt vmcnt(2)
v_max3_u32 v124,v108,v109,v110
v_max_u32 v124,v124,v111
v_cmp_eq_u32 vcc,-1,v124
s_cbranch_vccz dcp_100977
buffer_load_dwordx4 v[108:111],v0,s[20:23],s93 offen offset:3072 sc1
s_sub_u32 s90,s90,1
s_cmp_gt_i32 s90,0
s_cbranch_scc1 dlp_100974
s_branch dgo_100973
dcp_100976:
v_mov_b32 v44,v104
v_mov_b32 v45,v105
v_mov_b32 v46,v106
v_mov_b32 v47,v107
s_nop 1
s_branch dgo_100973
dcp_100977:
v_mov_b32 v44,v108
v_mov_b32 v45,v109
v_mov_b32 v46,v110
v_mov_b32 v47,v111
s_nop 1
dgo_100973:
dsk_100972:
s_mov_b32 s55,0
s_branch segb_100664
recfin_100192:
s_endpgm
.section .rodata,"a"
.p2align 6
.amdhsa_kernel init_kernel
  .amdhsa_next_free_vgpr 48
  .amdhsa_next_free_sgpr 48
  .amdhsa_accum_offset 48
  .amdhsa_group_segment_fixed_size 0
  .amdhsa_kernarg_size 136
  .amdhsa_user_sgpr_count 2
  .amdhsa_user_sgpr_kernarg_segment_ptr 1
  .amdhsa_system_sgpr_workgroup_id_x 1
.end_amdhsa_kernel
.p2align 6
.amdhsa_kernel ln1_kernel
  .amdhsa_next_free_vgpr 96
  .amdhsa_next_free_sgpr 80
  .amdhsa_accum_offset 96
  .amdhsa_group_segment_fixed_size 0
  .amdhsa_kernarg_size 136
  .amdhsa_user_sgpr_count 2
  .amdhsa_user_sgpr_kernarg_segment_ptr 1
  .amdhsa_system_sgpr_workgroup_id_x 1
.end_amdhsa_kernel
.p2align 6
.amdhsa_kernel flow_kernel
  .amdhsa_next_free_vgpr 512
  .amdhsa_next_free_sgpr 102
  .amdhsa_accum_offset 256
  .amdhsa_group_segment_fixed_size 0
  .amdhsa_kernarg_size 136
  .amdhsa_user_sgpr_count 2
  .amdhsa_user_sgpr_kernarg_segment_ptr 1
  .amdhsa_system_sgpr_workgroup_id_x 1
.end_amdhsa_kernel
```

```asm
; @launch kernel=flow_kernel grid=(256,1,1) block=(256,1,1) lds=163840
.amdgcn_target "amdgcn-amd-amdhsa--gfx950"
.text
.globl flow_kernel
.p2align 8
.type flow_kernel,@function
flow_kernel:
s_cmp_ge_u32 s2,256
s_cbranch_scc1 done_1
s_lshr_b32 s49,s2,3
s_load_dwordx2 s[18:19],s[0:1],128
s_load_dwordx2 s[2:3],s[0:1],120
s_load_dwordx2 s[4:5],s[0:1],0
s_getreg_b32 s51,hwreg(HW_REG_XCC_ID)
v_lshrrev_b32 v2,6,v0
v_and_b32 v1,63,v0
s_and_b32 s51,s51,7
v_readfirstlane_b32 s50,v2
s_mov_b32 s90,40000
s_mov_b32 s56,2
s_mov_b32 s88,64
s_lshl_b32 s64,s51,2
s_lshr_b32 s64,0x76325410,s64
s_and_b32 s64,s64,7
s_lshl_b32 s58,s64,5
s_add_u32 s58,s58,s49
s_waitcnt lgkmcnt(0)
s_mov_b32 s20,s18
s_and_b32 s21,s19,0xffff
s_mov_b32 s22,0x10000000
s_mov_b32 s23,0x20000
s_cmp_lg_u32 s50,0
s_cbranch_scc1 fl_disp0
s_mov_b32 s92,s2
s_and_b32 s93,s3,0xffff
s_mov_b32 s94,0x100
s_mov_b32 s95,0x20000
s_lshl_b32 s64,1,s49
v_mov_b32 v2,s64
v_mov_b32 v3,0x100
s_lshl_b32 s64,s51,3
s_mov_b64 exec,1
buffer_atomic_add_x2 v[2:3],off,s[92:95],s64 sc1
s_mov_b64 exec,-1
fl_disp0:
v_mbcnt_lo_u32_b32 v1,-1,0
v_mbcnt_hi_u32_b32 v1,-1,v1
s_sub_u32 s59,s58,64
s_cbranch_scc0 nx_3
s_branch fl_rec
nx_3:
s_cmp_lt_u32 s58,128
s_cbranch_scc0 nx_4
s_branch fl_qkv
nx_4:
s_cmp_ge_u32 s58,192
s_cbranch_scc1 fl_dutb
s_load_dwordx4 s[4:7],s[0:1],96
s_load_dwordx2 s[8:9],s[0:1],0
s_sub_u32 s59,s58,128
s_and_b32 s52,s59,15
s_lshr_b32 s53,s59,4
s_lshl_b32 s64,s50,6
v_add_u32 v14,s64,v1
v_lshrrev_b32 v2,4,v14
v_and_b32 v3,15,v14
v_mul_u32_u24 v13,196608,v2
v_lshl_add_u32 v13,v3,4,v13
s_mul_i32 s54,s53,3145728
s_lshl_b32 s64,s52,8
s_add_u32 s54,s54,s64
s_add_u32 s54,s54,0
v_lshlrev_b32 v15,1,v14
s_lshl_b32 s55,s53,9
s_mov_b32 s60,0
s_mov_b32 s73,0xffff0000
s_sub_u32 s61,s58,128
s_lshl_b32 s61,s61,15
v_lshlrev_b32 v25,6,v2
v_lshlrev_b32 v24,4,v1
v_and_b32 v2,3,v1
v_lshrrev_b32 v3,2,v1
s_lshl_b32 s64,s60,2
v_add_u32 v4,s64,v2
s_lshl_b32 s65,s50,9
v_lshlrev_b32 v5,4,v3
v_add_u32 v5,s65,v5
v_lshl_add_u32 v8,v4,11,v5
v_lshlrev_b32 v9,1,v5
v_lshrrev_b32 v5,2,v3
v_and_b32 v3,3,v3
s_lshl_b32 s65,s50,13
v_lshlrev_b32 v5,10,v5
v_lshl_add_u32 v5,v3,8,v5
v_lshl_add_u32 v5,v4,4,v5
v_add_u32 v10,s65,v5
s_lshl_b32 s65,s50,9
v_lshlrev_b32 v5,3,v1
v_add_u32 v11,s65,v5
v_lshlrev_b32 v12,3,v2
s_waitcnt lgkmcnt(0)
s_mov_b32 s24,s4
s_and_b32 s25,s5,0xffff
s_mov_b32 s26,0x800
s_mov_b32 s27,0x20000
s_mov_b32 s28,s6
s_and_b32 s29,s7,0xffff
s_mov_b32 s30,0xc00000
s_mov_b32 s31,0x20000
s_mov_b32 s32,s8
s_and_b32 s33,s9,0xffff
s_mov_b32 s34,0x400000
s_mov_b32 s35,0x20000
v_mov_b32 v28,-1
v_mov_b32 v20,0
v_mov_b32 v29,-1
v_mov_b32 v21,0
v_mov_b32 v30,-1
v_mov_b32 v22,0
v_mov_b32 v31,-1
v_mov_b32 v23,0
buffer_load_ushort v16,v15,s[24:27],s55 offen
buffer_load_dwordx4 v[96:99],v13,s[28:31],s54 offen offset:0
s_add_u32 s54,s54,12288
buffer_load_dwordx4 v[100:103],v13,s[28:31],s54 offen offset:0
s_add_u32 s54,s54,12288
buffer_load_dwordx4 v[104:107],v13,s[28:31],s54 offen offset:0
s_add_u32 s54,s54,12288
buffer_load_dwordx4 v[108:111],v13,s[28:31],s54 offen offset:0
s_add_u32 s54,s54,12288
buffer_load_dwordx4 v[112:115],v13,s[28:31],s54 offen offset:0
s_add_u32 s54,s54,12288
buffer_load_dwordx4 v[116:119],v13,s[28:31],s54 offen offset:0
s_add_u32 s54,s54,12288
buffer_load_dwordx4 v[120:123],v13,s[28:31],s54 offen offset:0
s_add_u32 s54,s54,12288
buffer_load_dwordx4 v[124:127],v13,s[28:31],s54 offen offset:0
s_add_u32 s54,s54,12288
buffer_load_dwordx4 v[128:131],v13,s[28:31],s54 offen offset:0
s_add_u32 s54,s54,12288
buffer_load_dwordx4 v[132:135],v13,s[28:31],s54 offen offset:0
s_add_u32 s54,s54,12288
buffer_load_dwordx4 v[136:139],v13,s[28:31],s54 offen offset:0
s_add_u32 s54,s54,12288
buffer_load_dwordx4 v[140:143],v13,s[28:31],s54 offen offset:0
s_add_u32 s54,s54,12288
buffer_load_dwordx4 v[144:147],v13,s[28:31],s54 offen offset:0
s_add_u32 s54,s54,12288
buffer_load_dwordx4 v[148:151],v13,s[28:31],s54 offen offset:0
s_add_u32 s54,s54,12288
buffer_load_dwordx4 v[152:155],v13,s[28:31],s54 offen offset:0
s_add_u32 s54,s54,12288
buffer_load_dwordx4 v[156:159],v13,s[28:31],s54 offen offset:0
s_add_u32 s64,s61,0
buffer_load_dwordx4 v[48:51],v8,s[32:35],s64 offen offset:0
buffer_load_dwordx4 v[52:55],v8,s[32:35],s64 offen offset:256
s_add_u32 s64,s61,8192
buffer_load_dwordx4 v[56:59],v8,s[32:35],s64 offen offset:0
buffer_load_dwordx4 v[60:63],v8,s[32:35],s64 offen offset:256
s_add_u32 s64,s61,16384
buffer_load_dwordx4 v[64:67],v8,s[32:35],s64 offen offset:0
buffer_load_dwordx4 v[68:71],v8,s[32:35],s64 offen offset:256
s_add_u32 s64,s61,24576
buffer_load_dwordx4 v[72:75],v8,s[32:35],s64 offen offset:0
buffer_load_dwordx4 v[76:79],v8,s[32:35],s64 offen offset:256
s_waitcnt vmcnt(24)
v_lshlrev_b32 v16,16,v16
v_mul_f32 v17,0xbfb8aa3b,v16
v_exp_f32 v17,v17
s_nop 0
v_add_f32 v17,1.0,v17
v_rcp_f32 v17,v17
s_nop 0
v_mul_f32 v17,v17,v16
v_cvt_pk_bf16_f32 v17,v17,v17
v_and_b32 v17,s73,v17
v_lshlrev_b32 v18,2,v14
ds_write_b32 v18,v17 offset:8192
s_waitcnt lgkmcnt(0)
s_barrier
ds_read_b128 v[32:35],v25 offset:8192
ds_read_b128 v[36:39],v25 offset:8208
ds_read_b128 v[40:43],v25 offset:8224
ds_read_b128 v[44:47],v25 offset:8240
v_mov_b32 v80,0
v_mov_b32 v81,0
v_mov_b32 v82,0
v_mov_b32 v83,0
v_mov_b32 v84,0
v_mov_b32 v85,0
v_mov_b32 v86,0
v_mov_b32 v87,0
s_waitcnt lgkmcnt(0)
s_waitcnt vmcnt(23)
v_lshlrev_b32 v16,16,v96
v_and_b32 v17,s73,v96
v_pk_fma_f32 v[80:81],v[16:17],v[32:33],v[80:81] op_sel:[0,0,0] op_sel_hi:[1,0,1]
v_lshlrev_b32 v18,16,v97
v_and_b32 v19,s73,v97
v_pk_fma_f32 v[82:83],v[18:19],v[32:33],v[82:83] op_sel:[0,0,0] op_sel_hi:[1,0,1]
v_lshlrev_b32 v16,16,v98
v_and_b32 v17,s73,v98
v_pk_fma_f32 v[84:85],v[16:17],v[32:33],v[84:85] op_sel:[0,0,0] op_sel_hi:[1,0,1]
v_lshlrev_b32 v18,16,v99
v_and_b32 v19,s73,v99
v_pk_fma_f32 v[86:87],v[18:19],v[32:33],v[86:87] op_sel:[0,0,0] op_sel_hi:[1,0,1]
s_waitcnt vmcnt(22)
v_lshlrev_b32 v16,16,v100
v_and_b32 v17,s73,v100
v_pk_fma_f32 v[80:81],v[16:17],v[32:33],v[80:81] op_sel:[0,1,0] op_sel_hi:[1,1,1]
v_lshlrev_b32 v18,16,v101
v_and_b32 v19,s73,v101
v_pk_fma_f32 v[82:83],v[18:19],v[32:33],v[82:83] op_sel:[0,1,0] op_sel_hi:[1,1,1]
v_lshlrev_b32 v16,16,v102
v_and_b32 v17,s73,v102
v_pk_fma_f32 v[84:85],v[16:17],v[32:33],v[84:85] op_sel:[0,1,0] op_sel_hi:[1,1,1]
v_lshlrev_b32 v18,16,v103
v_and_b32 v19,s73,v103
v_pk_fma_f32 v[86:87],v[18:19],v[32:33],v[86:87] op_sel:[0,1,0] op_sel_hi:[1,1,1]
s_waitcnt vmcnt(21)
v_lshlrev_b32 v16,16,v104
v_and_b32 v17,s73,v104
v_pk_fma_f32 v[80:81],v[16:17],v[34:35],v[80:81] op_sel:[0,0,0] op_sel_hi:[1,0,1]
v_lshlrev_b32 v18,16,v105
v_and_b32 v19,s73,v105
v_pk_fma_f32 v[82:83],v[18:19],v[34:35],v[82:83] op_sel:[0,0,0] op_sel_hi:[1,0,1]
v_lshlrev_b32 v16,16,v106
v_and_b32 v17,s73,v106
v_pk_fma_f32 v[84:85],v[16:17],v[34:35],v[84:85] op_sel:[0,0,0] op_sel_hi:[1,0,1]
v_lshlrev_b32 v18,16,v107
v_and_b32 v19,s73,v107
v_pk_fma_f32 v[86:87],v[18:19],v[34:35],v[86:87] op_sel:[0,0,0] op_sel_hi:[1,0,1]
s_waitcnt vmcnt(20)
v_lshlrev_b32 v16,16,v108
v_and_b32 v17,s73,v108
v_pk_fma_f32 v[80:81],v[16:17],v[34:35],v[80:81] op_sel:[0,1,0] op_sel_hi:[1,1,1]
v_lshlrev_b32 v18,16,v109
v_and_b32 v19,s73,v109
v_pk_fma_f32 v[82:83],v[18:19],v[34:35],v[82:83] op_sel:[0,1,0] op_sel_hi:[1,1,1]
v_lshlrev_b32 v16,16,v110
v_and_b32 v17,s73,v110
v_pk_fma_f32 v[84:85],v[16:17],v[34:35],v[84:85] op_sel:[0,1,0] op_sel_hi:[1,1,1]
v_lshlrev_b32 v18,16,v111
v_and_b32 v19,s73,v111
v_pk_fma_f32 v[86:87],v[18:19],v[34:35],v[86:87] op_sel:[0,1,0] op_sel_hi:[1,1,1]
s_waitcnt vmcnt(19)
v_lshlrev_b32 v16,16,v112
v_and_b32 v17,s73,v112
v_pk_fma_f32 v[80:81],v[16:17],v[36:37],v[80:81] op_sel:[0,0,0] op_sel_hi:[1,0,1]
v_lshlrev_b32 v18,16,v113
v_and_b32 v19,s73,v113
v_pk_fma_f32 v[82:83],v[18:19],v[36:37],v[82:83] op_sel:[0,0,0] op_sel_hi:[1,0,1]
v_lshlrev_b32 v16,16,v114
v_and_b32 v17,s73,v114
v_pk_fma_f32 v[84:85],v[16:17],v[36:37],v[84:85] op_sel:[0,0,0] op_sel_hi:[1,0,1]
v_lshlrev_b32 v18,16,v115
v_and_b32 v19,s73,v115
v_pk_fma_f32 v[86:87],v[18:19],v[36:37],v[86:87] op_sel:[0,0,0] op_sel_hi:[1,0,1]
s_waitcnt vmcnt(18)
v_lshlrev_b32 v16,16,v116
v_and_b32 v17,s73,v116
v_pk_fma_f32 v[80:81],v[16:17],v[36:37],v[80:81] op_sel:[0,1,0] op_sel_hi:[1,1,1]
v_lshlrev_b32 v18,16,v117
v_and_b32 v19,s73,v117
v_pk_fma_f32 v[82:83],v[18:19],v[36:37],v[82:83] op_sel:[0,1,0] op_sel_hi:[1,1,1]
v_lshlrev_b32 v16,16,v118
v_and_b32 v17,s73,v118
v_pk_fma_f32 v[84:85],v[16:17],v[36:37],v[84:85] op_sel:[0,1,0] op_sel_hi:[1,1,1]
v_lshlrev_b32 v18,16,v119
v_and_b32 v19,s73,v119
v_pk_fma_f32 v[86:87],v[18:19],v[36:37],v[86:87] op_sel:[0,1,0] op_sel_hi:[1,1,1]
s_waitcnt vmcnt(17)
v_lshlrev_b32 v16,16,v120
v_and_b32 v17,s73,v120
v_pk_fma_f32 v[80:81],v[16:17],v[38:39],v[80:81] op_sel:[0,0,0] op_sel_hi:[1,0,1]
v_lshlrev_b32 v18,16,v121
v_and_b32 v19,s73,v121
v_pk_fma_f32 v[82:83],v[18:19],v[38:39],v[82:83] op_sel:[0,0,0] op_sel_hi:[1,0,1]
v_lshlrev_b32 v16,16,v122
v_and_b32 v17,s73,v122
v_pk_fma_f32 v[84:85],v[16:17],v[38:39],v[84:85] op_sel:[0,0,0] op_sel_hi:[1,0,1]
v_lshlrev_b32 v18,16,v123
v_and_b32 v19,s73,v123
v_pk_fma_f32 v[86:87],v[18:19],v[38:39],v[86:87] op_sel:[0,0,0] op_sel_hi:[1,0,1]
s_waitcnt vmcnt(16)
v_lshlrev_b32 v16,16,v124
v_and_b32 v17,s73,v124
v_pk_fma_f32 v[80:81],v[16:17],v[38:39],v[80:81] op_sel:[0,1,0] op_sel_hi:[1,1,1]
v_lshlrev_b32 v18,16,v125
v_and_b32 v19,s73,v125
v_pk_fma_f32 v[82:83],v[18:19],v[38:39],v[82:83] op_sel:[0,1,0] op_sel_hi:[1,1,1]
v_lshlrev_b32 v16,16,v126
v_and_b32 v17,s73,v126
v_pk_fma_f32 v[84:85],v[16:17],v[38:39],v[84:85] op_sel:[0,1,0] op_sel_hi:[1,1,1]
v_lshlrev_b32 v18,16,v127
v_and_b32 v19,s73,v127
v_pk_fma_f32 v[86:87],v[18:19],v[38:39],v[86:87] op_sel:[0,1,0] op_sel_hi:[1,1,1]
s_waitcnt vmcnt(15)
v_lshlrev_b32 v16,16,v128
v_and_b32 v17,s73,v128
v_pk_fma_f32 v[80:81],v[16:17],v[40:41],v[80:81] op_sel:[0,0,0] op_sel_hi:[1,0,1]
v_lshlrev_b32 v18,16,v129
v_and_b32 v19,s73,v129
v_pk_fma_f32 v[82:83],v[18:19],v[40:41],v[82:83] op_sel:[0,0,0] op_sel_hi:[1,0,1]
v_lshlrev_b32 v16,16,v130
v_and_b32 v17,s73,v130
v_pk_fma_f32 v[84:85],v[16:17],v[40:41],v[84:85] op_sel:[0,0,0] op_sel_hi:[1,0,1]
v_lshlrev_b32 v18,16,v131
v_and_b32 v19,s73,v131
v_pk_fma_f32 v[86:87],v[18:19],v[40:41],v[86:87] op_sel:[0,0,0] op_sel_hi:[1,0,1]
s_waitcnt vmcnt(14)
v_lshlrev_b32 v16,16,v132
v_and_b32 v17,s73,v132
v_pk_fma_f32 v[80:81],v[16:17],v[40:41],v[80:81] op_sel:[0,1,0] op_sel_hi:[1,1,1]
v_lshlrev_b32 v18,16,v133
v_and_b32 v19,s73,v133
v_pk_fma_f32 v[82:83],v[18:19],v[40:41],v[82:83] op_sel:[0,1,0] op_sel_hi:[1,1,1]
v_lshlrev_b32 v16,16,v134
v_and_b32 v17,s73,v134
v_pk_fma_f32 v[84:85],v[16:17],v[40:41],v[84:85] op_sel:[0,1,0] op_sel_hi:[1,1,1]
v_lshlrev_b32 v18,16,v135
v_and_b32 v19,s73,v135
v_pk_fma_f32 v[86:87],v[18:19],v[40:41],v[86:87] op_sel:[0,1,0] op_sel_hi:[1,1,1]
s_waitcnt vmcnt(13)
v_lshlrev_b32 v16,16,v136
v_and_b32 v17,s73,v136
v_pk_fma_f32 v[80:81],v[16:17],v[42:43],v[80:81] op_sel:[0,0,0] op_sel_hi:[1,0,1]
v_lshlrev_b32 v18,16,v137
v_and_b32 v19,s73,v137
v_pk_fma_f32 v[82:83],v[18:19],v[42:43],v[82:83] op_sel:[0,0,0] op_sel_hi:[1,0,1]
v_lshlrev_b32 v16,16,v138
v_and_b32 v17,s73,v138
v_pk_fma_f32 v[84:85],v[16:17],v[42:43],v[84:85] op_sel:[0,0,0] op_sel_hi:[1,0,1]
v_lshlrev_b32 v18,16,v139
v_and_b32 v19,s73,v139
v_pk_fma_f32 v[86:87],v[18:19],v[42:43],v[86:87] op_sel:[0,0,0] op_sel_hi:[1,0,1]
s_waitcnt vmcnt(12)
v_lshlrev_b32 v16,16,v140
v_and_b32 v17,s73,v140
v_pk_fma_f32 v[80:81],v[16:17],v[42:43],v[80:81] op_sel:[0,1,0] op_sel_hi:[1,1,1]
v_lshlrev_b32 v18,16,v141
v_and_b32 v19,s73,v141
v_pk_fma_f32 v[82:83],v[18:19],v[42:43],v[82:83] op_sel:[0,1,0] op_sel_hi:[1,1,1]
v_lshlrev_b32 v16,16,v142
v_and_b32 v17,s73,v142
v_pk_fma_f32 v[84:85],v[16:17],v[42:43],v[84:85] op_sel:[0,1,0] op_sel_hi:[1,1,1]
v_lshlrev_b32 v18,16,v143
v_and_b32 v19,s73,v143
v_pk_fma_f32 v[86:87],v[18:19],v[42:43],v[86:87] op_sel:[0,1,0] op_sel_hi:[1,1,1]
s_waitcnt vmcnt(11)
v_lshlrev_b32 v16,16,v144
v_and_b32 v17,s73,v144
v_pk_fma_f32 v[80:81],v[16:17],v[44:45],v[80:81] op_sel:[0,0,0] op_sel_hi:[1,0,1]
v_lshlrev_b32 v18,16,v145
v_and_b32 v19,s73,v145
v_pk_fma_f32 v[82:83],v[18:19],v[44:45],v[82:83] op_sel:[0,0,0] op_sel_hi:[1,0,1]
v_lshlrev_b32 v16,16,v146
v_and_b32 v17,s73,v146
v_pk_fma_f32 v[84:85],v[16:17],v[44:45],v[84:85] op_sel:[0,0,0] op_sel_hi:[1,0,1]
v_lshlrev_b32 v18,16,v147
v_and_b32 v19,s73,v147
v_pk_fma_f32 v[86:87],v[18:19],v[44:45],v[86:87] op_sel:[0,0,0] op_sel_hi:[1,0,1]
s_waitcnt vmcnt(10)
v_lshlrev_b32 v16,16,v148
v_and_b32 v17,s73,v148
v_pk_fma_f32 v[80:81],v[16:17],v[44:45],v[80:81] op_sel:[0,1,0] op_sel_hi:[1,1,1]
v_lshlrev_b32 v18,16,v149
v_and_b32 v19,s73,v149
v_pk_fma_f32 v[82:83],v[18:19],v[44:45],v[82:83] op_sel:[0,1,0] op_sel_hi:[1,1,1]
v_lshlrev_b32 v16,16,v150
v_and_b32 v17,s73,v150
v_pk_fma_f32 v[84:85],v[16:17],v[44:45],v[84:85] op_sel:[0,1,0] op_sel_hi:[1,1,1]
v_lshlrev_b32 v18,16,v151
v_and_b32 v19,s73,v151
v_pk_fma_f32 v[86:87],v[18:19],v[44:45],v[86:87] op_sel:[0,1,0] op_sel_hi:[1,1,1]
s_waitcnt vmcnt(9)
v_lshlrev_b32 v16,16,v152
v_and_b32 v17,s73,v152
v_pk_fma_f32 v[80:81],v[16:17],v[46:47],v[80:81] op_sel:[0,0,0] op_sel_hi:[1,0,1]
v_lshlrev_b32 v18,16,v153
v_and_b32 v19,s73,v153
v_pk_fma_f32 v[82:83],v[18:19],v[46:47],v[82:83] op_sel:[0,0,0] op_sel_hi:[1,0,1]
v_lshlrev_b32 v16,16,v154
v_and_b32 v17,s73,v154
v_pk_fma_f32 v[84:85],v[16:17],v[46:47],v[84:85] op_sel:[0,0,0] op_sel_hi:[1,0,1]
v_lshlrev_b32 v18,16,v155
v_and_b32 v19,s73,v155
v_pk_fma_f32 v[86:87],v[18:19],v[46:47],v[86:87] op_sel:[0,0,0] op_sel_hi:[1,0,1]
s_waitcnt vmcnt(8)
v_lshlrev_b32 v16,16,v156
v_and_b32 v17,s73,v156
v_pk_fma_f32 v[80:81],v[16:17],v[46:47],v[80:81] op_sel:[0,1,0] op_sel_hi:[1,1,1]
v_lshlrev_b32 v18,16,v157
v_and_b32 v19,s73,v157
v_pk_fma_f32 v[82:83],v[18:19],v[46:47],v[82:83] op_sel:[0,1,0] op_sel_hi:[1,1,1]
v_lshlrev_b32 v16,16,v158
v_and_b32 v17,s73,v158
v_pk_fma_f32 v[84:85],v[16:17],v[46:47],v[84:85] op_sel:[0,1,0] op_sel_hi:[1,1,1]
v_lshlrev_b32 v18,16,v159
v_and_b32 v19,s73,v159
v_pk_fma_f32 v[86:87],v[18:19],v[46:47],v[86:87] op_sel:[0,1,0] op_sel_hi:[1,1,1]
v_lshlrev_b32 v18,5,v14
ds_write_b128 v18,v[80:83] offset:16384
ds_write_b128 v18,v[84:87] offset:16400
v_and_b32 v18,127,v14
v_lshlrev_b32 v18,2,v18
v_lshrrev_b32 v19,7,v14
v_mov_b32 v19,v18
s_waitcnt lgkmcnt(0)
s_barrier
ds_read_b32 v32,v19 offset:16384
ds_read_b32 v33,v19 offset:16896
ds_read_b32 v34,v19 offset:17408
ds_read_b32 v35,v19 offset:17920
ds_read_b32 v36,v19 offset:18432
ds_read_b32 v37,v19 offset:18944
ds_read_b32 v38,v19 offset:19456
ds_read_b32 v39,v19 offset:19968
ds_read_b32 v40,v19 offset:20480
ds_read_b32 v41,v19 offset:20992
ds_read_b32 v42,v19 offset:21504
ds_read_b32 v43,v19 offset:22016
s_waitcnt lgkmcnt(4)
ds_read_b32 v44,v19 offset:22528
ds_read_b32 v45,v19 offset:23040
ds_read_b32 v46,v19 offset:23552
ds_read_b32 v47,v19 offset:24064
s_waitcnt lgkmcnt(0)
v_pk_add_f32 v[32:33],v[32:33],v[40:41]
v_pk_add_f32 v[34:35],v[34:35],v[42:43]
v_pk_add_f32 v[36:37],v[36:37],v[44:45]
v_pk_add_f32 v[38:39],v[38:39],v[46:47]
v_pk_add_f32 v[32:33],v[32:33],v[36:37]
v_pk_add_f32 v[34:35],v[34:35],v[38:39]
v_pk_add_f32 v[32:33],v[32:33],v[34:35]
v_add_f32 v32,v32,v33
s_mul_i32 s64,s53,24576
s_lshl_b32 s65,s52,9
s_add_u32 s64,s64,s65
s_add_u32 s64,s64,267386880
buffer_store_dword v32,v18,s[20:23],s64 offen sc1
s_waitcnt vmcnt(0)
s_barrier
s_cmp_lg_u32 s50,0
s_cbranch_scc1 sig_5
s_mov_b32 s92,s2
s_and_b32 s93,s3,0xffff
s_mov_b32 s94,0x100
s_mov_b32 s95,0x20000
s_add_u32 s64,s88,0
v_mov_b32 v16,1
s_mov_b64 exec,1
buffer_atomic_add v16,off,s[92:95],s64 sc1
s_mov_b64 exec,-1
sig_5:
v_lshlrev_b32 v128,16,v48
v_and_b32 v129,s73,v48
v_lshlrev_b32 v130,16,v49
v_and_b32 v131,s73,v49
v_lshlrev_b32 v132,16,v50
v_and_b32 v133,s73,v50
v_lshlrev_b32 v134,16,v51
v_and_b32 v135,s73,v51
v_lshlrev_b32 v136,16,v52
v_and_b32 v137,s73,v52
v_lshlrev_b32 v138,16,v53
v_and_b32 v139,s73,v53
v_lshlrev_b32 v140,16,v54
v_and_b32 v141,s73,v54
v_lshlrev_b32 v142,16,v55
v_and_b32 v143,s73,v55
v_lshlrev_b32 v144,16,v56
v_and_b32 v145,s73,v56
v_lshlrev_b32 v146,16,v57
v_and_b32 v147,s73,v57
v_lshlrev_b32 v148,16,v58
v_and_b32 v149,s73,v58
v_lshlrev_b32 v150,16,v59
v_and_b32 v151,s73,v59
v_lshlrev_b32 v152,16,v60
v_and_b32 v153,s73,v60
v_lshlrev_b32 v154,16,v61
v_and_b32 v155,s73,v61
v_lshlrev_b32 v156,16,v62
v_and_b32 v157,s73,v62
v_lshlrev_b32 v158,16,v63
v_and_b32 v159,s73,v63
v_lshlrev_b32 v160,16,v64
v_and_b32 v161,s73,v64
v_lshlrev_b32 v162,16,v65
v_and_b32 v163,s73,v65
v_lshlrev_b32 v164,16,v66
v_and_b32 v165,s73,v66
v_lshlrev_b32 v166,16,v67
v_and_b32 v167,s73,v67
v_lshlrev_b32 v168,16,v68
v_and_b32 v169,s73,v68
v_lshlrev_b32 v170,16,v69
v_and_b32 v171,s73,v69
v_lshlrev_b32 v172,16,v70
v_and_b32 v173,s73,v70
v_lshlrev_b32 v174,16,v71
v_and_b32 v175,s73,v71
v_lshlrev_b32 v176,16,v72
v_and_b32 v177,s73,v72
v_lshlrev_b32 v178,16,v73
v_and_b32 v179,s73,v73
v_lshlrev_b32 v180,16,v74
v_and_b32 v181,s73,v74
v_lshlrev_b32 v182,16,v75
v_and_b32 v183,s73,v75
v_lshlrev_b32 v184,16,v76
v_and_b32 v185,s73,v76
v_lshlrev_b32 v186,16,v77
v_and_b32 v187,s73,v77
v_lshlrev_b32 v188,16,v78
v_and_b32 v189,s73,v78
v_lshlrev_b32 v190,16,v79
v_and_b32 v191,s73,v79
v_add_f32 v208,v128,v129
v_mul_f32 v209,v128,v128
v_add_f32 v210,v130,v131
v_mul_f32 v211,v129,v129
v_fmac_f32 v209,v130,v130
v_fmac_f32 v211,v131,v131
v_add_f32 v208,v208,v132
v_fmac_f32 v209,v132,v132
v_add_f32 v210,v210,v133
v_fmac_f32 v211,v133,v133
v_add_f32 v208,v208,v134
v_fmac_f32 v209,v134,v134
v_add_f32 v210,v210,v135
v_fmac_f32 v211,v135,v135
v_add_f32 v208,v208,v136
v_fmac_f32 v209,v136,v136
v_add_f32 v210,v210,v137
v_fmac_f32 v211,v137,v137
v_add_f32 v208,v208,v138
v_fmac_f32 v209,v138,v138
v_add_f32 v210,v210,v139
v_fmac_f32 v211,v139,v139
v_add_f32 v208,v208,v140
v_fmac_f32 v209,v140,v140
v_add_f32 v210,v210,v141
v_fmac_f32 v211,v141,v141
v_add_f32 v208,v208,v142
v_fmac_f32 v209,v142,v142
v_add_f32 v210,v210,v143
v_fmac_f32 v211,v143,v143
v_add_f32 v208,v208,v210
v_add_f32 v209,v209,v211
v_add_f32 v212,v144,v145
v_mul_f32 v213,v144,v144
v_add_f32 v214,v146,v147
v_mul_f32 v215,v145,v145
v_fmac_f32 v213,v146,v146
v_fmac_f32 v215,v147,v147
v_add_f32 v212,v212,v148
v_fmac_f32 v213,v148,v148
v_add_f32 v214,v214,v149
v_fmac_f32 v215,v149,v149
v_add_f32 v212,v212,v150
v_fmac_f32 v213,v150,v150
v_add_f32 v214,v214,v151
v_fmac_f32 v215,v151,v151
v_add_f32 v212,v212,v152
v_fmac_f32 v213,v152,v152
v_add_f32 v214,v214,v153
v_fmac_f32 v215,v153,v153
v_add_f32 v212,v212,v154
v_fmac_f32 v213,v154,v154
v_add_f32 v214,v214,v155
v_fmac_f32 v215,v155,v155
v_add_f32 v212,v212,v156
v_fmac_f32 v213,v156,v156
v_add_f32 v214,v214,v157
v_fmac_f32 v215,v157,v157
v_add_f32 v212,v212,v158
v_fmac_f32 v213,v158,v158
v_add_f32 v214,v214,v159
v_fmac_f32 v215,v159,v159
v_add_f32 v212,v212,v214
v_add_f32 v213,v213,v215
v_add_f32 v216,v160,v161
v_mul_f32 v217,v160,v160
v_add_f32 v218,v162,v163
v_mul_f32 v219,v161,v161
v_fmac_f32 v217,v162,v162
v_fmac_f32 v219,v163,v163
v_add_f32 v216,v216,v164
v_fmac_f32 v217,v164,v164
v_add_f32 v218,v218,v165
v_fmac_f32 v219,v165,v165
v_add_f32 v216,v216,v166
v_fmac_f32 v217,v166,v166
v_add_f32 v218,v218,v167
v_fmac_f32 v219,v167,v167
v_add_f32 v216,v216,v168
v_fmac_f32 v217,v168,v168
v_add_f32 v218,v218,v169
v_fmac_f32 v219,v169,v169
v_add_f32 v216,v216,v170
v_fmac_f32 v217,v170,v170
v_add_f32 v218,v218,v171
v_fmac_f32 v219,v171,v171
v_add_f32 v216,v216,v172
v_fmac_f32 v217,v172,v172
v_add_f32 v218,v218,v173
v_fmac_f32 v219,v173,v173
v_add_f32 v216,v216,v174
v_fmac_f32 v217,v174,v174
v_add_f32 v218,v218,v175
v_fmac_f32 v219,v175,v175
v_add_f32 v216,v216,v218
v_add_f32 v217,v217,v219
v_add_f32 v220,v176,v177
v_mul_f32 v221,v176,v176
v_add_f32 v222,v178,v179
v_mul_f32 v223,v177,v177
v_fmac_f32 v221,v178,v178
v_fmac_f32 v223,v179,v179
v_add_f32 v220,v220,v180
v_fmac_f32 v221,v180,v180
v_add_f32 v222,v222,v181
v_fmac_f32 v223,v181,v181
v_add_f32 v220,v220,v182
v_fmac_f32 v221,v182,v182
v_add_f32 v222,v222,v183
v_fmac_f32 v223,v183,v183
v_add_f32 v220,v220,v184
v_fmac_f32 v221,v184,v184
v_add_f32 v222,v222,v185
v_fmac_f32 v223,v185,v185
v_add_f32 v220,v220,v186
v_fmac_f32 v221,v186,v186
v_add_f32 v222,v222,v187
v_fmac_f32 v223,v187,v187
v_add_f32 v220,v220,v188
v_fmac_f32 v221,v188,v188
v_add_f32 v222,v222,v189
v_fmac_f32 v223,v189,v189
v_add_f32 v220,v220,v190
v_fmac_f32 v221,v190,v190
v_add_f32 v222,v222,v191
v_fmac_f32 v223,v191,v191
v_add_f32 v220,v220,v222
v_add_f32 v221,v221,v223
v_add_f32_dpp v208,v208,v208 row_ror:4 row_mask:0xf bank_mask:0xf
v_add_f32_dpp v209,v209,v209 row_ror:4 row_mask:0xf bank_mask:0xf
v_add_f32_dpp v212,v212,v212 row_ror:4 row_mask:0xf bank_mask:0xf
v_add_f32_dpp v213,v213,v213 row_ror:4 row_mask:0xf bank_mask:0xf
v_add_f32_dpp v216,v216,v216 row_ror:4 row_mask:0xf bank_mask:0xf
v_add_f32_dpp v217,v217,v217 row_ror:4 row_mask:0xf bank_mask:0xf
v_add_f32_dpp v220,v220,v220 row_ror:4 row_mask:0xf bank_mask:0xf
v_add_f32_dpp v221,v221,v221 row_ror:4 row_mask:0xf bank_mask:0xf
v_add_f32_dpp v208,v208,v208 row_ror:8 row_mask:0xf bank_mask:0xf
v_add_f32_dpp v209,v209,v209 row_ror:8 row_mask:0xf bank_mask:0xf
v_add_f32_dpp v212,v212,v212 row_ror:8 row_mask:0xf bank_mask:0xf
v_add_f32_dpp v213,v213,v213 row_ror:8 row_mask:0xf bank_mask:0xf
v_add_f32_dpp v216,v216,v216 row_ror:8 row_mask:0xf bank_mask:0xf
v_add_f32_dpp v217,v217,v217 row_ror:8 row_mask:0xf bank_mask:0xf
v_add_f32_dpp v220,v220,v220 row_ror:8 row_mask:0xf bank_mask:0xf
v_add_f32_dpp v221,v221,v221 row_ror:8 row_mask:0xf bank_mask:0xf
v_mov_b32 v210,v208
v_mov_b32 v211,v209
s_nop 0
v_permlane16_swap_b32 v210,v208
v_permlane16_swap_b32 v211,v209
v_add_f32 v208,v208,v210
v_add_f32 v209,v209,v211
v_mov_b32 v214,v212
v_mov_b32 v215,v213
s_nop 0
v_permlane16_swap_b32 v214,v212
v_permlane16_swap_b32 v215,v213
v_add_f32 v212,v212,v214
v_add_f32 v213,v213,v215
v_mov_b32 v218,v216
v_mov_b32 v219,v217
s_nop 0
v_permlane16_swap_b32 v218,v216
v_permlane16_swap_b32 v219,v217
v_add_f32 v216,v216,v218
v_add_f32 v217,v217,v219
v_mov_b32 v222,v220
v_mov_b32 v223,v221
s_nop 0
v_permlane16_swap_b32 v222,v220
v_permlane16_swap_b32 v223,v221
v_add_f32 v220,v220,v222
v_add_f32 v221,v221,v223
v_mov_b32 v210,v208
v_mov_b32 v211,v209
s_nop 0
v_permlane32_swap_b32 v210,v208
v_permlane32_swap_b32 v211,v209
v_add_f32 v208,v208,v210
v_add_f32 v209,v209,v211
v_mov_b32 v214,v212
v_mov_b32 v215,v213
s_nop 0
v_permlane32_swap_b32 v214,v212
v_permlane32_swap_b32 v215,v213
v_add_f32 v212,v212,v214
v_add_f32 v213,v213,v215
v_mov_b32 v218,v216
v_mov_b32 v219,v217
s_nop 0
v_permlane32_swap_b32 v218,v216
v_permlane32_swap_b32 v219,v217
v_add_f32 v216,v216,v218
v_add_f32 v217,v217,v219
v_mov_b32 v222,v220
v_mov_b32 v223,v221
s_nop 0
v_permlane32_swap_b32 v222,v220
v_permlane32_swap_b32 v223,v221
v_add_f32 v220,v220,v222
v_add_f32 v221,v221,v223
ds_write_b64 v11,v[208:209] offset:32768
ds_write_b64 v11,v[212:213] offset:34816
ds_write_b64 v11,v[216:217] offset:36864
ds_write_b64 v11,v[220:221] offset:38912
s_waitcnt lgkmcnt(0)
s_barrier
ds_read_b64 v[32:33],v12 offset:32768
ds_read_b64 v[34:35],v12 offset:33280
ds_read_b64 v[36:37],v12 offset:33792
ds_read_b64 v[38:39],v12 offset:34304
s_waitcnt lgkmcnt(0)
v_add_f32 v32,v32,v34
v_add_f32 v33,v33,v35
v_add_f32 v36,v36,v38
v_add_f32 v37,v37,v39
v_add_f32 v32,v32,v36
v_add_f32 v33,v33,v37
v_mul_f32 v208,0xba800000,v32
v_mul_f32 v34,v208,v208
v_mul_f32 v33,0x3a800000,v33
v_sub_f32 v33,v33,v34
v_max_f32 v33,0,v33
v_add_f32 v33,0x3727c5ac,v33
v_rsq_f32 v209,v33
s_nop 0
v_mul_f32 v208,v208,v209
v_fma_f32 v128,v128,v209,v208
v_fma_f32 v129,v129,v209,v208
v_fma_f32 v130,v130,v209,v208
v_fma_f32 v131,v131,v209,v208
v_fma_f32 v132,v132,v209,v208
v_fma_f32 v133,v133,v209,v208
v_fma_f32 v134,v134,v209,v208
v_fma_f32 v135,v135,v209,v208
v_fma_f32 v136,v136,v209,v208
v_fma_f32 v137,v137,v209,v208
v_fma_f32 v138,v138,v209,v208
v_fma_f32 v139,v139,v209,v208
v_fma_f32 v140,v140,v209,v208
v_fma_f32 v141,v141,v209,v208
v_fma_f32 v142,v142,v209,v208
v_fma_f32 v143,v143,v209,v208
ds_read_b64 v[32:33],v12 offset:34816
ds_read_b64 v[34:35],v12 offset:35328
ds_read_b64 v[36:37],v12 offset:35840
ds_read_b64 v[38:39],v12 offset:36352
s_waitcnt lgkmcnt(0)
v_add_f32 v32,v32,v34
v_add_f32 v33,v33,v35
v_add_f32 v36,v36,v38
v_add_f32 v37,v37,v39
v_add_f32 v32,v32,v36
v_add_f32 v33,v33,v37
v_mul_f32 v208,0xba800000,v32
v_mul_f32 v34,v208,v208
v_mul_f32 v33,0x3a800000,v33
v_sub_f32 v33,v33,v34
v_max_f32 v33,0,v33
v_add_f32 v33,0x3727c5ac,v33
v_rsq_f32 v209,v33
s_nop 0
v_mul_f32 v208,v208,v209
v_fma_f32 v144,v144,v209,v208
v_fma_f32 v145,v145,v209,v208
v_fma_f32 v146,v146,v209,v208
v_fma_f32 v147,v147,v209,v208
v_fma_f32 v148,v148,v209,v208
v_fma_f32 v149,v149,v209,v208
v_fma_f32 v150,v150,v209,v208
v_fma_f32 v151,v151,v209,v208
v_fma_f32 v152,v152,v209,v208
v_fma_f32 v153,v153,v209,v208
v_fma_f32 v154,v154,v209,v208
v_fma_f32 v155,v155,v209,v208
v_fma_f32 v156,v156,v209,v208
v_fma_f32 v157,v157,v209,v208
v_fma_f32 v158,v158,v209,v208
v_fma_f32 v159,v159,v209,v208
ds_read_b64 v[32:33],v12 offset:36864
ds_read_b64 v[34:35],v12 offset:37376
ds_read_b64 v[36:37],v12 offset:37888
ds_read_b64 v[38:39],v12 offset:38400
s_waitcnt lgkmcnt(0)
v_add_f32 v32,v32,v34
v_add_f32 v33,v33,v35
v_add_f32 v36,v36,v38
v_add_f32 v37,v37,v39
v_add_f32 v32,v32,v36
v_add_f32 v33,v33,v37
v_mul_f32 v208,0xba800000,v32
v_mul_f32 v34,v208,v208
v_mul_f32 v33,0x3a800000,v33
v_sub_f32 v33,v33,v34
v_max_f32 v33,0,v33
v_add_f32 v33,0x3727c5ac,v33
v_rsq_f32 v209,v33
s_nop 0
v_mul_f32 v208,v208,v209
v_fma_f32 v160,v160,v209,v208
v_fma_f32 v161,v161,v209,v208
v_fma_f32 v162,v162,v209,v208
v_fma_f32 v163,v163,v209,v208
v_fma_f32 v164,v164,v209,v208
v_fma_f32 v165,v165,v209,v208
v_fma_f32 v166,v166,v209,v208
v_fma_f32 v167,v167,v209,v208
v_fma_f32 v168,v168,v209,v208
v_fma_f32 v169,v169,v209,v208
v_fma_f32 v170,v170,v209,v208
v_fma_f32 v171,v171,v209,v208
v_fma_f32 v172,v172,v209,v208
v_fma_f32 v173,v173,v209,v208
v_fma_f32 v174,v174,v209,v208
v_fma_f32 v175,v175,v209,v208
ds_read_b64 v[32:33],v12 offset:38912
ds_read_b64 v[34:35],v12 offset:39424
ds_read_b64 v[36:37],v12 offset:39936
ds_read_b64 v[38:39],v12 offset:40448
s_waitcnt lgkmcnt(0)
v_add_f32 v32,v32,v34
v_add_f32 v33,v33,v35
v_add_f32 v36,v36,v38
v_add_f32 v37,v37,v39
v_add_f32 v32,v32,v36
v_add_f32 v33,v33,v37
v_mul_f32 v208,0xba800000,v32
v_mul_f32 v34,v208,v208
v_mul_f32 v33,0x3a800000,v33
v_sub_f32 v33,v33,v34
v_max_f32 v33,0,v33
v_add_f32 v33,0x3727c5ac,v33
v_rsq_f32 v209,v33
s_nop 0
v_mul_f32 v208,v208,v209
v_fma_f32 v176,v176,v209,v208
v_fma_f32 v177,v177,v209,v208
v_fma_f32 v178,v178,v209,v208
v_fma_f32 v179,v179,v209,v208
v_fma_f32 v180,v180,v209,v208
v_fma_f32 v181,v181,v209,v208
v_fma_f32 v182,v182,v209,v208
v_fma_f32 v183,v183,v209,v208
v_fma_f32 v184,v184,v209,v208
v_fma_f32 v185,v185,v209,v208
v_fma_f32 v186,v186,v209,v208
v_fma_f32 v187,v187,v209,v208
v_fma_f32 v188,v188,v209,v208
v_fma_f32 v189,v189,v209,v208
v_fma_f32 v190,v190,v209,v208
v_fma_f32 v191,v191,v209,v208
s_mov_b32 s92,s2
s_and_b32 s93,s3,0xffff
s_mov_b32 s94,0x100
s_mov_b32 s95,0x20000
v_mbcnt_lo_u32_b32 v16,-1,0
v_mbcnt_hi_u32_b32 v16,-1,v16
v_mov_b32 v18,0
v_cmp_eq_u32 vcc,16,v16
s_nop 1
v_cndmask_b32 v18,v18,64,vcc
v_and_b32 v19,1,v16
v_cmp_eq_u32 vcc,1,v19
v_mov_b32 v19,8192
s_nop 0
v_cndmask_b32 v19,-1,v19,vcc
v_min_u32 v16,31,v16
v_lshlrev_b32 v16,2,v16
s_sub_u32 s66,s88,64
s_cmp_lg_u32 s50,0
s_cbranch_scc1 vot_10
vpoll_6:
buffer_load_dword v17,v16,s[92:95],s66 offen sc1
s_waitcnt vmcnt(0)
s_cmp_lg_u32 s56,2
s_cbranch_scc1 vck_7
v_cmp_eq_u32 vcc,v17,v19
s_and_b32 s64,vcc_lo,0xffff
s_cmp_eq_u32 s64,65535
s_cbranch_scc1 vck_7
s_mov_b32 s65,0
v_readlane_b32 s64,v17,1
s_lshr_b32 s64,s64,8
s_add_u32 s65,s65,s64
v_readlane_b32 s64,v17,3
s_lshr_b32 s64,s64,8
s_add_u32 s65,s65,s64
v_readlane_b32 s64,v17,5
s_lshr_b32 s64,s64,8
s_add_u32 s65,s65,s64
v_readlane_b32 s64,v17,7
s_lshr_b32 s64,s64,8
s_add_u32 s65,s65,s64
v_readlane_b32 s64,v17,9
s_lshr_b32 s64,s64,8
s_add_u32 s65,s65,s64
v_readlane_b32 s64,v17,11
s_lshr_b32 s64,s64,8
s_add_u32 s65,s65,s64
v_readlane_b32 s64,v17,13
s_lshr_b32 s64,s64,8
s_add_u32 s65,s65,s64
v_readlane_b32 s64,v17,15
s_lshr_b32 s64,s64,8
s_add_u32 s65,s65,s64
s_cmp_ge_u32 s65,256
s_cbranch_scc1 vok_9
s_branch vrt_8
vck_7:
v_cmp_gt_u32 vcc,v18,v17
s_cbranch_vccz vok_9
vrt_8:
s_sleep 8
s_sub_u32 s90,s90,1
s_cmp_gt_i32 s90,0
s_cbranch_scc1 vpoll_6
vok_9:
v_add_u32 v18,160000,v16
ds_write_b32 v18,v17
s_waitcnt lgkmcnt(0)
vot_10:
s_barrier
v_add_u32 v18,160000,v16
ds_read_b32 v17,v18
s_waitcnt lgkmcnt(0)
s_cmp_lg_u32 s56,2
s_cbranch_scc1 vfin_11
v_cmp_eq_u32 vcc,v17,v19
s_and_b32 s64,vcc_lo,0xffff
s_cmp_eq_u32 s64,65535
s_cbranch_scc1 vfin_11
s_mov_b32 s65,0
v_readlane_b32 s64,v17,1
s_lshr_b32 s64,s64,8
s_add_u32 s65,s65,s64
v_readlane_b32 s64,v17,3
s_lshr_b32 s64,s64,8
s_add_u32 s65,s65,s64
v_readlane_b32 s64,v17,5
s_lshr_b32 s64,s64,8
s_add_u32 s65,s65,s64
v_readlane_b32 s64,v17,7
s_lshr_b32 s64,s64,8
s_add_u32 s65,s65,s64
v_readlane_b32 s64,v17,9
s_lshr_b32 s64,s64,8
s_add_u32 s65,s65,s64
v_readlane_b32 s64,v17,11
s_lshr_b32 s64,s64,8
s_add_u32 s65,s65,s64
v_readlane_b32 s64,v17,13
s_lshr_b32 s64,s64,8
s_add_u32 s65,s65,s64
v_readlane_b32 s64,v17,15
s_lshr_b32 s64,s64,8
s_add_u32 s65,s65,s64
s_cmp_ge_u32 s65,256
s_cbranch_scc1 fl_fb
vfin_11:
s_and_b32 s56,s56,1
v_lshlrev_b32 v18,5,v14
s_mov_b32 s64,267386880
buffer_load_dwordx4 v[32:35],v18,s[20:23],s64 offen offset:0 sc1
buffer_load_dwordx4 v[36:39],v18,s[20:23],s64 offen offset:16 sc1
s_mov_b32 s64,267411456
buffer_load_dwordx4 v[40:43],v18,s[20:23],s64 offen offset:0 sc1
buffer_load_dwordx4 v[44:47],v18,s[20:23],s64 offen offset:16 sc1
s_mov_b32 s64,267436032
buffer_load_dwordx4 v[48:51],v18,s[20:23],s64 offen offset:0 sc1
buffer_load_dwordx4 v[52:55],v18,s[20:23],s64 offen offset:16 sc1
s_mov_b32 s64,267460608
buffer_load_dwordx4 v[56:59],v18,s[20:23],s64 offen offset:0 sc1
buffer_load_dwordx4 v[60:63],v18,s[20:23],s64 offen offset:16 sc1
s_cmp_gt_u32 s50,1
s_cselect_b32 s64,1.0,0
s_waitcnt vmcnt(0)
v_pk_add_f32 v[32:33],v[32:33],v[40:41]
v_pk_add_f32 v[48:49],v[48:49],v[56:57]
v_pk_add_f32 v[34:35],v[34:35],v[42:43]
v_pk_add_f32 v[50:51],v[50:51],v[58:59]
v_pk_add_f32 v[36:37],v[36:37],v[44:45]
v_pk_add_f32 v[52:53],v[52:53],v[60:61]
v_pk_add_f32 v[38:39],v[38:39],v[46:47]
v_pk_add_f32 v[54:55],v[54:55],v[62:63]
v_pk_add_f32 v[32:33],v[32:33],v[48:49]
v_pk_add_f32 v[34:35],v[34:35],v[50:51]
v_pk_add_f32 v[36:37],v[36:37],v[52:53]
v_pk_add_f32 v[38:39],v[38:39],v[54:55]
v_cvt_pk_bf16_f32 v40,v32,v33
v_cvt_pk_bf16_f32 v41,v34,v35
v_cvt_pk_bf16_f32 v42,v36,v37
v_cvt_pk_bf16_f32 v43,v38,v39
v_lshlrev_b32 v32,16,v40
v_and_b32 v33,s73,v40
v_lshlrev_b32 v34,16,v41
v_and_b32 v35,s73,v41
v_lshlrev_b32 v36,16,v42
v_and_b32 v37,s73,v42
v_lshlrev_b32 v38,16,v43
v_and_b32 v39,s73,v43
v_add_f32 v32,s64,v32
v_add_f32 v33,s64,v33
v_add_f32 v34,s64,v34
v_add_f32 v35,s64,v35
v_add_f32 v36,s64,v36
v_add_f32 v37,s64,v37
v_add_f32 v38,s64,v38
v_add_f32 v39,s64,v39
ds_write_b128 v18,v[32:35] offset:0
ds_write_b128 v18,v[36:39] offset:16
s_waitcnt lgkmcnt(0)
s_barrier
ds_read_b128 v[112:115],v9 offset:0
ds_read_b128 v[116:119],v9 offset:16
ds_read_b128 v[120:123],v9 offset:512
ds_read_b128 v[124:127],v9 offset:528
ds_read_b128 v[96:99],v9 offset:4096
ds_read_b128 v[100:103],v9 offset:4112
ds_read_b128 v[104:107],v9 offset:4608
ds_read_b128 v[108:111],v9 offset:4624
s_add_u32 s61,s61,146800640
s_add_u32 s62,s61,4096
s_waitcnt lgkmcnt(0)
v_fma_f32 v128,v128,v96,v112
v_fma_f32 v129,v129,v97,v113
v_fma_f32 v130,v130,v98,v114
v_fma_f32 v131,v131,v99,v115
v_fma_f32 v132,v132,v100,v116
v_fma_f32 v133,v133,v101,v117
v_fma_f32 v134,v134,v102,v118
v_fma_f32 v135,v135,v103,v119
v_fma_f32 v136,v136,v104,v120
v_fma_f32 v137,v137,v105,v121
v_fma_f32 v138,v138,v106,v122
v_fma_f32 v139,v139,v107,v123
v_fma_f32 v140,v140,v108,v124
v_fma_f32 v141,v141,v109,v125
v_fma_f32 v142,v142,v110,v126
v_fma_f32 v143,v143,v111,v127
v_cvt_pk_bf16_f32 v48,v128,v129
v_cvt_pk_bf16_f32 v49,v130,v131
v_cvt_pk_bf16_f32 v50,v132,v133
v_cvt_pk_bf16_f32 v51,v134,v135
v_cvt_pk_bf16_f32 v52,v136,v137
v_cvt_pk_bf16_f32 v53,v138,v139
v_cvt_pk_bf16_f32 v54,v140,v141
v_cvt_pk_bf16_f32 v55,v142,v143
buffer_store_dwordx4 v[48:51],v10,s[20:23],s61 offen offset:0 sc1
buffer_store_dwordx4 v[52:55],v10,s[20:23],s62 offen offset:0 sc1
v_fma_f32 v144,v144,v96,v112
v_fma_f32 v145,v145,v97,v113
v_fma_f32 v146,v146,v98,v114
v_fma_f32 v147,v147,v99,v115
v_fma_f32 v148,v148,v100,v116
v_fma_f32 v149,v149,v101,v117
v_fma_f32 v150,v150,v102,v118
v_fma_f32 v151,v151,v103,v119
v_fma_f32 v152,v152,v104,v120
v_fma_f32 v153,v153,v105,v121
v_fma_f32 v154,v154,v106,v122
v_fma_f32 v155,v155,v107,v123
v_fma_f32 v156,v156,v108,v124
v_fma_f32 v157,v157,v109,v125
v_fma_f32 v158,v158,v110,v126
v_fma_f32 v159,v159,v111,v127
v_cvt_pk_bf16_f32 v56,v144,v145
v_cvt_pk_bf16_f32 v57,v146,v147
v_cvt_pk_bf16_f32 v58,v148,v149
v_cvt_pk_bf16_f32 v59,v150,v151
v_cvt_pk_bf16_f32 v60,v152,v153
v_cvt_pk_bf16_f32 v61,v154,v155
v_cvt_pk_bf16_f32 v62,v156,v157
v_cvt_pk_bf16_f32 v63,v158,v159
buffer_store_dwordx4 v[56:59],v10,s[20:23],s61 offen offset:64 sc1
buffer_store_dwordx4 v[60:63],v10,s[20:23],s62 offen offset:64 sc1
v_fma_f32 v160,v160,v96,v112
v_fma_f32 v161,v161,v97,v113
v_fma_f32 v162,v162,v98,v114
v_fma_f32 v163,v163,v99,v115
v_fma_f32 v164,v164,v100,v116
v_fma_f32 v165,v165,v101,v117
v_fma_f32 v166,v166,v102,v118
v_fma_f32 v167,v167,v103,v119
v_fma_f32 v168,v168,v104,v120
v_fma_f32 v169,v169,v105,v121
v_fma_f32 v170,v170,v106,v122
v_fma_f32 v171,v171,v107,v123
v_fma_f32 v172,v172,v108,v124
v_fma_f32 v173,v173,v109,v125
v_fma_f32 v174,v174,v110,v126
v_fma_f32 v175,v175,v111,v127
v_cvt_pk_bf16_f32 v64,v160,v161
v_cvt_pk_bf16_f32 v65,v162,v163
v_cvt_pk_bf16_f32 v66,v164,v165
v_cvt_pk_bf16_f32 v67,v166,v167
v_cvt_pk_bf16_f32 v68,v168,v169
v_cvt_pk_bf16_f32 v69,v170,v171
v_cvt_pk_bf16_f32 v70,v172,v173
v_cvt_pk_bf16_f32 v71,v174,v175
buffer_store_dwordx4 v[64:67],v10,s[20:23],s61 offen offset:128 sc1
buffer_store_dwordx4 v[68:71],v10,s[20:23],s62 offen offset:128 sc1
v_fma_f32 v176,v176,v96,v112
v_fma_f32 v177,v177,v97,v113
v_fma_f32 v178,v178,v98,v114
v_fma_f32 v179,v179,v99,v115
v_fma_f32 v180,v180,v100,v116
v_fma_f32 v181,v181,v101,v117
v_fma_f32 v182,v182,v102,v118
v_fma_f32 v183,v183,v103,v119
v_fma_f32 v184,v184,v104,v120
v_fma_f32 v185,v185,v105,v121
v_fma_f32 v186,v186,v106,v122
v_fma_f32 v187,v187,v107,v123
v_fma_f32 v188,v188,v108,v124
v_fma_f32 v189,v189,v109,v125
v_fma_f32 v190,v190,v110,v126
v_fma_f32 v191,v191,v111,v127
v_cvt_pk_bf16_f32 v72,v176,v177
v_cvt_pk_bf16_f32 v73,v178,v179
v_cvt_pk_bf16_f32 v74,v180,v181
v_cvt_pk_bf16_f32 v75,v182,v183
v_cvt_pk_bf16_f32 v76,v184,v185
v_cvt_pk_bf16_f32 v77,v186,v187
v_cvt_pk_bf16_f32 v78,v188,v189
v_cvt_pk_bf16_f32 v79,v190,v191
buffer_store_dwordx4 v[72:75],v10,s[20:23],s61 offen offset:192 sc1
buffer_store_dwordx4 v[76:79],v10,s[20:23],s62 offen offset:192 sc1
s_waitcnt vmcnt(0)
s_barrier
s_cmp_lg_u32 s50,0
s_cbranch_scc1 sig_12
s_mov_b32 s92,s2
s_and_b32 s93,s3,0xffff
s_mov_b32 s94,0x100
s_mov_b32 s95,0x20000
s_add_u32 s64,s88,12
v_mov_b32 v16,1
s_mov_b64 exec,1
buffer_atomic_add v16,off,s[92:95],s64 sc1
s_mov_b64 exec,-1
sig_12:
s_branch fl_disp
fl_dutb:
s_load_dwordx4 s[4:7],s[0:1],96
s_load_dwordx2 s[8:9],s[0:1],0
s_cmp_lg_u32 s58,220
s_cbranch_scc1 nomeas_13
s_cmp_lg_u32 s50,0
s_cbranch_scc1 nomeas_13
s_mov_b64 exec,1
s_mov_b32 s65,1
s_cmp_eq_u32 s56,1
s_cbranch_scc1 pub_14
s_mov_b32 s66,138526720
s_mov_b32 s67,138534912
s_mov_b32 s70,0x7fffffff
s_mov_b32 s71,0x7fffffff
s_mov_b32 s72,8
mlp_15:
s_memtime s[94:95]
s_waitcnt lgkmcnt(0)
buffer_store_dword v16,off,s[20:23],s66 sc1
s_waitcnt vmcnt(0)
s_memtime s[96:97]
s_waitcnt lgkmcnt(0)
s_sub_u32 s96,s96,s94
s_min_u32 s70,s70,s96
s_memtime s[94:95]
s_waitcnt lgkmcnt(0)
buffer_store_dword v16,off,s[20:23],s67 sc1
s_waitcnt vmcnt(0)
s_memtime s[96:97]
s_waitcnt lgkmcnt(0)
s_sub_u32 s96,s96,s94
s_min_u32 s71,s71,s96
s_sub_u32 s72,s72,1
s_cmp_gt_u32 s72,0
s_cbranch_scc1 mlp_15
s_cmp_gt_u32 s71,s70
s_cselect_b32 s65,2,1
pub_14:
s_mov_b32 s92,s2
s_and_b32 s93,s3,0xffff
s_mov_b32 s94,0x100
s_mov_b32 s95,0x20000
v_mov_b32 v16,s65
s_add_u32 s64,s88,20
buffer_store_dword v16,off,s[92:95],s64 sc1
s_mov_b64 exec,-1
nomeas_13:
s_barrier
s_sub_u32 s59,s58,192
s_and_b32 s52,s59,15
s_lshr_b32 s53,s59,4
s_lshl_b32 s64,s50,6
v_add_u32 v14,s64,v1
v_lshrrev_b32 v2,4,v14
v_and_b32 v3,15,v14
v_mul_u32_u24 v13,196608,v2
v_lshl_add_u32 v13,v3,4,v13
s_mul_i32 s54,s53,3145728
s_lshl_b32 s64,s52,9
s_add_u32 s54,s54,s64
s_add_u32 s54,s54,4096
v_lshlrev_b32 v15,1,v14
s_lshl_b32 s55,s53,9
s_mov_b32 s60,0
s_mov_b32 s73,0xffff0000
s_sub_u32 s61,s58,128
s_lshl_b32 s61,s61,15
v_lshlrev_b32 v25,6,v2
v_lshlrev_b32 v24,4,v1
v_and_b32 v2,3,v1
v_lshrrev_b32 v3,2,v1
s_lshl_b32 s64,s60,2
v_add_u32 v4,s64,v2
s_lshl_b32 s65,s50,9
v_lshlrev_b32 v5,4,v3
v_add_u32 v5,s65,v5
v_lshl_add_u32 v8,v4,11,v5
v_lshlrev_b32 v9,1,v5
v_lshrrev_b32 v5,2,v3
v_and_b32 v3,3,v3
s_lshl_b32 s65,s50,13
v_lshlrev_b32 v5,10,v5
v_lshl_add_u32 v5,v3,8,v5
v_lshl_add_u32 v5,v4,4,v5
v_add_u32 v10,s65,v5
s_lshl_b32 s65,s50,9
v_lshlrev_b32 v5,3,v1
v_add_u32 v11,s65,v5
v_lshlrev_b32 v12,3,v2
s_waitcnt lgkmcnt(0)
s_mov_b32 s24,s4
s_and_b32 s25,s5,0xffff
s_mov_b32 s26,0x800
s_mov_b32 s27,0x20000
s_mov_b32 s28,s6
s_and_b32 s29,s7,0xffff
s_mov_b32 s30,0xc00000
s_mov_b32 s31,0x20000
s_mov_b32 s32,s8
s_and_b32 s33,s9,0xffff
s_mov_b32 s34,0x400000
s_mov_b32 s35,0x20000
v_mov_b32 v28,-1
v_mov_b32 v20,0
v_mov_b32 v29,-1
v_mov_b32 v21,0
v_mov_b32 v30,-1
v_mov_b32 v22,0
v_mov_b32 v31,-1
v_mov_b32 v23,0
s_cmp_eq_u32 s58,220
s_cbranch_scc1 fl2_17
s_mov_b32 s62,s59
fl1_16:
s_lshl_b32 s64,s62,2
s_add_u32 s64,s64,s50
s_mul_i32 s64,s64,2048
s_add_u32 s64,s64,142606336
buffer_store_dwordx4 v[28:31],v24,s[20:23],s64 offen offset:0 sc1
buffer_store_dwordx4 v[28:31],v24,s[20:23],s64 offen offset:1024 sc1
s_lshl_b32 s64,s62,2
s_add_u32 s64,s64,s50
s_lshr_b32 s65,s64,6
s_lshl_b32 s65,s65,19
s_and_b32 s64,s64,63
s_mul_i32 s64,s64,2048
s_add_u32 s64,s64,134217728
s_add_u32 s64,s64,s65
buffer_store_dwordx4 v[28:31],v24,s[20:23],s64 offen offset:0 sc1
buffer_store_dwordx4 v[28:31],v24,s[20:23],s64 offen offset:1024 sc1
s_lshl_b32 s64,s62,2
s_add_u32 s64,s64,s50
s_lshr_b32 s65,s64,6
s_lshl_b32 s65,s65,19
s_and_b32 s64,s64,63
s_mul_i32 s64,s64,4096
s_add_u32 s64,s64,134479872
s_add_u32 s64,s64,s65
buffer_store_dwordx4 v[28:31],v24,s[20:23],s64 offen offset:0 sc1
buffer_store_dwordx4 v[28:31],v24,s[20:23],s64 offen offset:1024 sc1
buffer_store_dwordx4 v[28:31],v24,s[20:23],s64 offen offset:2048 sc1
buffer_store_dwordx4 v[28:31],v24,s[20:23],s64 offen offset:3072 sc1
s_lshl_b32 s64,s62,2
s_add_u32 s64,s64,s50
s_mul_i32 s64,s64,1024
s_add_u32 s64,s64,138412032
buffer_store_dwordx4 v[20:23],v24,s[20:23],s64 offen offset:0 sc1
s_cmp_eq_u32 s62,29
s_mov_b32 s62,28
s_cbranch_scc1 fl1_16
fl2_17:
s_waitcnt vmcnt(0)
s_barrier
s_cmp_lg_u32 s50,0
s_cbranch_scc1 sig_18
s_mov_b32 s92,s2
s_and_b32 s93,s3,0xffff
s_mov_b32 s94,0x100
s_mov_b32 s95,0x20000
s_add_u32 s64,s88,24
s_add_u32 s65,s88,32
s_cmp_eq_u32 s58,220
s_cselect_b32 s64,s65,s64
v_mov_b32 v16,1
s_mov_b64 exec,1
buffer_atomic_add v16,off,s[92:95],s64 sc1
s_mov_b64 exec,-1
sig_18:
s_mov_b32 s92,s2
s_and_b32 s93,s3,0xffff
s_mov_b32 s94,0x100
s_mov_b32 s95,0x20000
v_mbcnt_lo_u32_b32 v16,-1,0
v_mbcnt_hi_u32_b32 v16,-1,v16
v_mov_b32 v18,0
v_cmp_eq_u32 vcc,23,v16
s_nop 1
v_cndmask_b32 v18,v18,9,vcc
v_and_b32 v19,1,v16
v_cmp_eq_u32 vcc,1,v19
v_mov_b32 v19,8192
s_nop 0
v_cndmask_b32 v19,-1,v19,vcc
v_min_u32 v16,31,v16
v_lshlrev_b32 v16,2,v16
s_sub_u32 s66,s88,64
s_cmp_lg_u32 s50,0
s_cbranch_scc1 vot_23
s_mov_b32 s64,10
pre_25:
s_sleep 32
s_sub_u32 s64,s64,1
s_cmp_gt_i32 s64,0
s_cbranch_scc1 pre_25
vpoll_19:
buffer_load_dword v17,v16,s[92:95],s66 offen sc1
s_waitcnt vmcnt(0)
s_cmp_lg_u32 s56,2
s_cbranch_scc1 vck_20
v_cmp_eq_u32 vcc,v17,v19
s_and_b32 s64,vcc_lo,0xffff
s_cmp_eq_u32 s64,65535
s_cbranch_scc1 vck_20
s_mov_b32 s65,0
v_readlane_b32 s64,v17,1
s_lshr_b32 s64,s64,8
s_add_u32 s65,s65,s64
v_readlane_b32 s64,v17,3
s_lshr_b32 s64,s64,8
s_add_u32 s65,s65,s64
v_readlane_b32 s64,v17,5
s_lshr_b32 s64,s64,8
s_add_u32 s65,s65,s64
v_readlane_b32 s64,v17,7
s_lshr_b32 s64,s64,8
s_add_u32 s65,s65,s64
v_readlane_b32 s64,v17,9
s_lshr_b32 s64,s64,8
s_add_u32 s65,s65,s64
v_readlane_b32 s64,v17,11
s_lshr_b32 s64,s64,8
s_add_u32 s65,s65,s64
v_readlane_b32 s64,v17,13
s_lshr_b32 s64,s64,8
s_add_u32 s65,s65,s64
v_readlane_b32 s64,v17,15
s_lshr_b32 s64,s64,8
s_add_u32 s65,s65,s64
s_cmp_ge_u32 s65,256
s_cbranch_scc1 vok_22
s_branch vrt_21
vck_20:
v_cmp_gt_u32 vcc,v18,v17
s_cbranch_vccz vok_22
vrt_21:
s_sleep 48
s_sub_u32 s90,s90,1
s_cmp_gt_i32 s90,0
s_cbranch_scc1 vpoll_19
vok_22:
v_add_u32 v18,160256,v16
ds_write_b32 v18,v17
s_waitcnt lgkmcnt(0)
vot_23:
s_barrier
v_add_u32 v18,160256,v16
ds_read_b32 v17,v18
s_waitcnt lgkmcnt(0)
s_cmp_lg_u32 s56,2
s_cbranch_scc1 vfin_24
v_cmp_eq_u32 vcc,v17,v19
s_and_b32 s64,vcc_lo,0xffff
s_cmp_eq_u32 s64,65535
s_cbranch_scc1 vfin_24
s_mov_b32 s65,0
v_readlane_b32 s64,v17,1
s_lshr_b32 s64,s64,8
s_add_u32 s65,s65,s64
v_readlane_b32 s64,v17,3
s_lshr_b32 s64,s64,8
s_add_u32 s65,s65,s64
v_readlane_b32 s64,v17,5
s_lshr_b32 s64,s64,8
s_add_u32 s65,s65,s64
v_readlane_b32 s64,v17,7
s_lshr_b32 s64,s64,8
s_add_u32 s65,s65,s64
v_readlane_b32 s64,v17,9
s_lshr_b32 s64,s64,8
s_add_u32 s65,s65,s64
v_readlane_b32 s64,v17,11
s_lshr_b32 s64,s64,8
s_add_u32 s65,s65,s64
v_readlane_b32 s64,v17,13
s_lshr_b32 s64,s64,8
s_add_u32 s65,s65,s64
v_readlane_b32 s64,v17,15
s_lshr_b32 s64,s64,8
s_add_u32 s65,s65,s64
s_cmp_ge_u32 s65,256
s_cbranch_scc1 fl_fb
vfin_24:
s_and_b32 s56,s56,1
buffer_load_ushort v16,v15,s[24:27],s55 offen
buffer_load_dwordx4 v[96:99],v13,s[28:31],s54 offen offset:0
buffer_load_dwordx4 v[160:163],v13,s[28:31],s54 offen offset:256
s_add_u32 s54,s54,12288
buffer_load_dwordx4 v[100:103],v13,s[28:31],s54 offen offset:0
buffer_load_dwordx4 v[164:167],v13,s[28:31],s54 offen offset:256
s_add_u32 s54,s54,12288
buffer_load_dwordx4 v[104:107],v13,s[28:31],s54 offen offset:0
buffer_load_dwordx4 v[168:171],v13,s[28:31],s54 offen offset:256
s_add_u32 s54,s54,12288
buffer_load_dwordx4 v[108:111],v13,s[28:31],s54 offen offset:0
buffer_load_dwordx4 v[172:175],v13,s[28:31],s54 offen offset:256
s_add_u32 s54,s54,12288
buffer_load_dwordx4 v[112:115],v13,s[28:31],s54 offen offset:0
buffer_load_dwordx4 v[176:179],v13,s[28:31],s54 offen offset:256
s_add_u32 s54,s54,12288
buffer_load_dwordx4 v[116:119],v13,s[28:31],s54 offen offset:0
buffer_load_dwordx4 v[180:183],v13,s[28:31],s54 offen offset:256
s_add_u32 s54,s54,12288
buffer_load_dwordx4 v[120:123],v13,s[28:31],s54 offen offset:0
buffer_load_dwordx4 v[184:187],v13,s[28:31],s54 offen offset:256
s_add_u32 s54,s54,12288
buffer_load_dwordx4 v[124:127],v13,s[28:31],s54 offen offset:0
buffer_load_dwordx4 v[188:191],v13,s[28:31],s54 offen offset:256
s_add_u32 s54,s54,12288
buffer_load_dwordx4 v[128:131],v13,s[28:31],s54 offen offset:0
buffer_load_dwordx4 v[192:195],v13,s[28:31],s54 offen offset:256
s_add_u32 s54,s54,12288
buffer_load_dwordx4 v[132:135],v13,s[28:31],s54 offen offset:0
buffer_load_dwordx4 v[196:199],v13,s[28:31],s54 offen offset:256
s_add_u32 s54,s54,12288
buffer_load_dwordx4 v[136:139],v13,s[28:31],s54 offen offset:0
buffer_load_dwordx4 v[200:203],v13,s[28:31],s54 offen offset:256
s_add_u32 s54,s54,12288
buffer_load_dwordx4 v[140:143],v13,s[28:31],s54 offen offset:0
buffer_load_dwordx4 v[204:207],v13,s[28:31],s54 offen offset:256
s_add_u32 s54,s54,12288
buffer_load_dwordx4 v[144:147],v13,s[28:31],s54 offen offset:0
buffer_load_dwordx4 v[208:211],v13,s[28:31],s54 offen offset:256
s_add_u32 s54,s54,12288
buffer_load_dwordx4 v[148:151],v13,s[28:31],s54 offen offset:0
buffer_load_dwordx4 v[212:215],v13,s[28:31],s54 offen offset:256
s_add_u32 s54,s54,12288
buffer_load_dwordx4 v[152:155],v13,s[28:31],s54 offen offset:0
buffer_load_dwordx4 v[216:219],v13,s[28:31],s54 offen offset:256
s_add_u32 s54,s54,12288
buffer_load_dwordx4 v[156:159],v13,s[28:31],s54 offen offset:0
buffer_load_dwordx4 v[220:223],v13,s[28:31],s54 offen offset:256
s_add_u32 s64,s61,0
buffer_load_dwordx4 v[48:51],v8,s[32:35],s64 offen offset:0
buffer_load_dwordx4 v[52:55],v8,s[32:35],s64 offen offset:256
s_add_u32 s64,s61,8192
buffer_load_dwordx4 v[56:59],v8,s[32:35],s64 offen offset:0
buffer_load_dwordx4 v[60:63],v8,s[32:35],s64 offen offset:256
s_add_u32 s64,s61,16384
buffer_load_dwordx4 v[64:67],v8,s[32:35],s64 offen offset:0
buffer_load_dwordx4 v[68:71],v8,s[32:35],s64 offen offset:256
s_add_u32 s64,s61,24576
buffer_load_dwordx4 v[72:75],v8,s[32:35],s64 offen offset:0
buffer_load_dwordx4 v[76:79],v8,s[32:35],s64 offen offset:256
s_waitcnt vmcnt(40)
v_lshlrev_b32 v16,16,v16
v_mul_f32 v17,0xbfb8aa3b,v16
v_exp_f32 v17,v17
s_nop 0
v_add_f32 v17,1.0,v17
v_rcp_f32 v17,v17
s_nop 0
v_mul_f32 v17,v17,v16
v_cvt_pk_bf16_f32 v17,v17,v17
v_and_b32 v17,s73,v17
v_lshlrev_b32 v18,2,v14
ds_write_b32 v18,v17 offset:8192
s_waitcnt lgkmcnt(0)
s_barrier
ds_read_b128 v[32:35],v25 offset:8192
ds_read_b128 v[36:39],v25 offset:8208
ds_read_b128 v[40:43],v25 offset:8224
ds_read_b128 v[44:47],v25 offset:8240
v_mov_b32 v80,0
v_mov_b32 v81,0
v_mov_b32 v82,0
v_mov_b32 v83,0
v_mov_b32 v84,0
v_mov_b32 v85,0
v_mov_b32 v86,0
v_mov_b32 v87,0
v_mov_b32 v88,0
v_mov_b32 v89,0
v_mov_b32 v90,0
v_mov_b32 v91,0
v_mov_b32 v92,0
v_mov_b32 v93,0
v_mov_b32 v94,0
v_mov_b32 v95,0
s_waitcnt lgkmcnt(0)
s_waitcnt vmcnt(39)
v_lshlrev_b32 v16,16,v96
v_and_b32 v17,s73,v96
v_pk_fma_f32 v[80:81],v[16:17],v[32:33],v[80:81] op_sel:[0,0,0] op_sel_hi:[1,0,1]
v_lshlrev_b32 v18,16,v97
v_and_b32 v19,s73,v97
v_pk_fma_f32 v[82:83],v[18:19],v[32:33],v[82:83] op_sel:[0,0,0] op_sel_hi:[1,0,1]
v_lshlrev_b32 v16,16,v98
v_and_b32 v17,s73,v98
v_pk_fma_f32 v[84:85],v[16:17],v[32:33],v[84:85] op_sel:[0,0,0] op_sel_hi:[1,0,1]
v_lshlrev_b32 v18,16,v99
v_and_b32 v19,s73,v99
v_pk_fma_f32 v[86:87],v[18:19],v[32:33],v[86:87] op_sel:[0,0,0] op_sel_hi:[1,0,1]
s_waitcnt vmcnt(38)
v_lshlrev_b32 v16,16,v160
v_and_b32 v17,s73,v160
v_pk_fma_f32 v[88:89],v[16:17],v[32:33],v[88:89] op_sel:[0,0,0] op_sel_hi:[1,0,1]
v_lshlrev_b32 v18,16,v161
v_and_b32 v19,s73,v161
v_pk_fma_f32 v[90:91],v[18:19],v[32:33],v[90:91] op_sel:[0,0,0] op_sel_hi:[1,0,1]
v_lshlrev_b32 v16,16,v162
v_and_b32 v17,s73,v162
v_pk_fma_f32 v[92:93],v[16:17],v[32:33],v[92:93] op_sel:[0,0,0] op_sel_hi:[1,0,1]
v_lshlrev_b32 v18,16,v163
v_and_b32 v19,s73,v163
v_pk_fma_f32 v[94:95],v[18:19],v[32:33],v[94:95] op_sel:[0,0,0] op_sel_hi:[1,0,1]
s_waitcnt vmcnt(37)
v_lshlrev_b32 v16,16,v100
v_and_b32 v17,s73,v100
v_pk_fma_f32 v[80:81],v[16:17],v[32:33],v[80:81] op_sel:[0,1,0] op_sel_hi:[1,1,1]
v_lshlrev_b32 v18,16,v101
v_and_b32 v19,s73,v101
v_pk_fma_f32 v[82:83],v[18:19],v[32:33],v[82:83] op_sel:[0,1,0] op_sel_hi:[1,1,1]
v_lshlrev_b32 v16,16,v102
v_and_b32 v17,s73,v102
v_pk_fma_f32 v[84:85],v[16:17],v[32:33],v[84:85] op_sel:[0,1,0] op_sel_hi:[1,1,1]
v_lshlrev_b32 v18,16,v103
v_and_b32 v19,s73,v103
v_pk_fma_f32 v[86:87],v[18:19],v[32:33],v[86:87] op_sel:[0,1,0] op_sel_hi:[1,1,1]
s_waitcnt vmcnt(36)
v_lshlrev_b32 v16,16,v164
v_and_b32 v17,s73,v164
v_pk_fma_f32 v[88:89],v[16:17],v[32:33],v[88:89] op_sel:[0,1,0] op_sel_hi:[1,1,1]
v_lshlrev_b32 v18,16,v165
v_and_b32 v19,s73,v165
v_pk_fma_f32 v[90:91],v[18:19],v[32:33],v[90:91] op_sel:[0,1,0] op_sel_hi:[1,1,1]
v_lshlrev_b32 v16,16,v166
v_and_b32 v17,s73,v166
v_pk_fma_f32 v[92:93],v[16:17],v[32:33],v[92:93] op_sel:[0,1,0] op_sel_hi:[1,1,1]
v_lshlrev_b32 v18,16,v167
v_and_b32 v19,s73,v167
v_pk_fma_f32 v[94:95],v[18:19],v[32:33],v[94:95] op_sel:[0,1,0] op_sel_hi:[1,1,1]
s_waitcnt vmcnt(35)
v_lshlrev_b32 v16,16,v104
v_and_b32 v17,s73,v104
v_pk_fma_f32 v[80:81],v[16:17],v[34:35],v[80:81] op_sel:[0,0,0] op_sel_hi:[1,0,1]
v_lshlrev_b32 v18,16,v105
v_and_b32 v19,s73,v105
v_pk_fma_f32 v[82:83],v[18:19],v[34:35],v[82:83] op_sel:[0,0,0] op_sel_hi:[1,0,1]
v_lshlrev_b32 v16,16,v106
v_and_b32 v17,s73,v106
v_pk_fma_f32 v[84:85],v[16:17],v[34:35],v[84:85] op_sel:[0,0,0] op_sel_hi:[1,0,1]
v_lshlrev_b32 v18,16,v107
v_and_b32 v19,s73,v107
v_pk_fma_f32 v[86:87],v[18:19],v[34:35],v[86:87] op_sel:[0,0,0] op_sel_hi:[1,0,1]
s_waitcnt vmcnt(34)
v_lshlrev_b32 v16,16,v168
v_and_b32 v17,s73,v168
v_pk_fma_f32 v[88:89],v[16:17],v[34:35],v[88:89] op_sel:[0,0,0] op_sel_hi:[1,0,1]
v_lshlrev_b32 v18,16,v169
v_and_b32 v19,s73,v169
v_pk_fma_f32 v[90:91],v[18:19],v[34:35],v[90:91] op_sel:[0,0,0] op_sel_hi:[1,0,1]
v_lshlrev_b32 v16,16,v170
v_and_b32 v17,s73,v170
v_pk_fma_f32 v[92:93],v[16:17],v[34:35],v[92:93] op_sel:[0,0,0] op_sel_hi:[1,0,1]
v_lshlrev_b32 v18,16,v171
v_and_b32 v19,s73,v171
v_pk_fma_f32 v[94:95],v[18:19],v[34:35],v[94:95] op_sel:[0,0,0] op_sel_hi:[1,0,1]
s_waitcnt vmcnt(33)
v_lshlrev_b32 v16,16,v108
v_and_b32 v17,s73,v108
v_pk_fma_f32 v[80:81],v[16:17],v[34:35],v[80:81] op_sel:[0,1,0] op_sel_hi:[1,1,1]
v_lshlrev_b32 v18,16,v109
v_and_b32 v19,s73,v109
v_pk_fma_f32 v[82:83],v[18:19],v[34:35],v[82:83] op_sel:[0,1,0] op_sel_hi:[1,1,1]
v_lshlrev_b32 v16,16,v110
v_and_b32 v17,s73,v110
v_pk_fma_f32 v[84:85],v[16:17],v[34:35],v[84:85] op_sel:[0,1,0] op_sel_hi:[1,1,1]
v_lshlrev_b32 v18,16,v111
v_and_b32 v19,s73,v111
v_pk_fma_f32 v[86:87],v[18:19],v[34:35],v[86:87] op_sel:[0,1,0] op_sel_hi:[1,1,1]
s_waitcnt vmcnt(32)
v_lshlrev_b32 v16,16,v172
v_and_b32 v17,s73,v172
v_pk_fma_f32 v[88:89],v[16:17],v[34:35],v[88:89] op_sel:[0,1,0] op_sel_hi:[1,1,1]
v_lshlrev_b32 v18,16,v173
v_and_b32 v19,s73,v173
v_pk_fma_f32 v[90:91],v[18:19],v[34:35],v[90:91] op_sel:[0,1,0] op_sel_hi:[1,1,1]
v_lshlrev_b32 v16,16,v174
v_and_b32 v17,s73,v174
v_pk_fma_f32 v[92:93],v[16:17],v[34:35],v[92:93] op_sel:[0,1,0] op_sel_hi:[1,1,1]
v_lshlrev_b32 v18,16,v175
v_and_b32 v19,s73,v175
v_pk_fma_f32 v[94:95],v[18:19],v[34:35],v[94:95] op_sel:[0,1,0] op_sel_hi:[1,1,1]
s_waitcnt vmcnt(31)
v_lshlrev_b32 v16,16,v112
v_and_b32 v17,s73,v112
v_pk_fma_f32 v[80:81],v[16:17],v[36:37],v[80:81] op_sel:[0,0,0] op_sel_hi:[1,0,1]
v_lshlrev_b32 v18,16,v113
v_and_b32 v19,s73,v113
v_pk_fma_f32 v[82:83],v[18:19],v[36:37],v[82:83] op_sel:[0,0,0] op_sel_hi:[1,0,1]
v_lshlrev_b32 v16,16,v114
v_and_b32 v17,s73,v114
v_pk_fma_f32 v[84:85],v[16:17],v[36:37],v[84:85] op_sel:[0,0,0] op_sel_hi:[1,0,1]
v_lshlrev_b32 v18,16,v115
v_and_b32 v19,s73,v115
v_pk_fma_f32 v[86:87],v[18:19],v[36:37],v[86:87] op_sel:[0,0,0] op_sel_hi:[1,0,1]
s_waitcnt vmcnt(30)
v_lshlrev_b32 v16,16,v176
v_and_b32 v17,s73,v176
v_pk_fma_f32 v[88:89],v[16:17],v[36:37],v[88:89] op_sel:[0,0,0] op_sel_hi:[1,0,1]
v_lshlrev_b32 v18,16,v177
v_and_b32 v19,s73,v177
v_pk_fma_f32 v[90:91],v[18:19],v[36:37],v[90:91] op_sel:[0,0,0] op_sel_hi:[1,0,1]
v_lshlrev_b32 v16,16,v178
v_and_b32 v17,s73,v178
v_pk_fma_f32 v[92:93],v[16:17],v[36:37],v[92:93] op_sel:[0,0,0] op_sel_hi:[1,0,1]
v_lshlrev_b32 v18,16,v179
v_and_b32 v19,s73,v179
v_pk_fma_f32 v[94:95],v[18:19],v[36:37],v[94:95] op_sel:[0,0,0] op_sel_hi:[1,0,1]
s_waitcnt vmcnt(29)
v_lshlrev_b32 v16,16,v116
v_and_b32 v17,s73,v116
v_pk_fma_f32 v[80:81],v[16:17],v[36:37],v[80:81] op_sel:[0,1,0] op_sel_hi:[1,1,1]
v_lshlrev_b32 v18,16,v117
v_and_b32 v19,s73,v117
v_pk_fma_f32 v[82:83],v[18:19],v[36:37],v[82:83] op_sel:[0,1,0] op_sel_hi:[1,1,1]
v_lshlrev_b32 v16,16,v118
v_and_b32 v17,s73,v118
v_pk_fma_f32 v[84:85],v[16:17],v[36:37],v[84:85] op_sel:[0,1,0] op_sel_hi:[1,1,1]
v_lshlrev_b32 v18,16,v119
v_and_b32 v19,s73,v119
v_pk_fma_f32 v[86:87],v[18:19],v[36:37],v[86:87] op_sel:[0,1,0] op_sel_hi:[1,1,1]
s_waitcnt vmcnt(28)
v_lshlrev_b32 v16,16,v180
v_and_b32 v17,s73,v180
v_pk_fma_f32 v[88:89],v[16:17],v[36:37],v[88:89] op_sel:[0,1,0] op_sel_hi:[1,1,1]
v_lshlrev_b32 v18,16,v181
v_and_b32 v19,s73,v181
v_pk_fma_f32 v[90:91],v[18:19],v[36:37],v[90:91] op_sel:[0,1,0] op_sel_hi:[1,1,1]
v_lshlrev_b32 v16,16,v182
v_and_b32 v17,s73,v182
v_pk_fma_f32 v[92:93],v[16:17],v[36:37],v[92:93] op_sel:[0,1,0] op_sel_hi:[1,1,1]
v_lshlrev_b32 v18,16,v183
v_and_b32 v19,s73,v183
v_pk_fma_f32 v[94:95],v[18:19],v[36:37],v[94:95] op_sel:[0,1,0] op_sel_hi:[1,1,1]
s_waitcnt vmcnt(27)
v_lshlrev_b32 v16,16,v120
v_and_b32 v17,s73,v120
v_pk_fma_f32 v[80:81],v[16:17],v[38:39],v[80:81] op_sel:[0,0,0] op_sel_hi:[1,0,1]
v_lshlrev_b32 v18,16,v121
v_and_b32 v19,s73,v121
v_pk_fma_f32 v[82:83],v[18:19],v[38:39],v[82:83] op_sel:[0,0,0] op_sel_hi:[1,0,1]
v_lshlrev_b32 v16,16,v122
v_and_b32 v17,s73,v122
v_pk_fma_f32 v[84:85],v[16:17],v[38:39],v[84:85] op_sel:[0,0,0] op_sel_hi:[1,0,1]
v_lshlrev_b32 v18,16,v123
v_and_b32 v19,s73,v123
v_pk_fma_f32 v[86:87],v[18:19],v[38:39],v[86:87] op_sel:[0,0,0] op_sel_hi:[1,0,1]
s_waitcnt vmcnt(26)
v_lshlrev_b32 v16,16,v184
v_and_b32 v17,s73,v184
v_pk_fma_f32 v[88:89],v[16:17],v[38:39],v[88:89] op_sel:[0,0,0] op_sel_hi:[1,0,1]
v_lshlrev_b32 v18,16,v185
v_and_b32 v19,s73,v185
v_pk_fma_f32 v[90:91],v[18:19],v[38:39],v[90:91] op_sel:[0,0,0] op_sel_hi:[1,0,1]
v_lshlrev_b32 v16,16,v186
v_and_b32 v17,s73,v186
v_pk_fma_f32 v[92:93],v[16:17],v[38:39],v[92:93] op_sel:[0,0,0] op_sel_hi:[1,0,1]
v_lshlrev_b32 v18,16,v187
v_and_b32 v19,s73,v187
v_pk_fma_f32 v[94:95],v[18:19],v[38:39],v[94:95] op_sel:[0,0,0] op_sel_hi:[1,0,1]
s_waitcnt vmcnt(25)
v_lshlrev_b32 v16,16,v124
v_and_b32 v17,s73,v124
v_pk_fma_f32 v[80:81],v[16:17],v[38:39],v[80:81] op_sel:[0,1,0] op_sel_hi:[1,1,1]
v_lshlrev_b32 v18,16,v125
v_and_b32 v19,s73,v125
v_pk_fma_f32 v[82:83],v[18:19],v[38:39],v[82:83] op_sel:[0,1,0] op_sel_hi:[1,1,1]
v_lshlrev_b32 v16,16,v126
v_and_b32 v17,s73,v126
v_pk_fma_f32 v[84:85],v[16:17],v[38:39],v[84:85] op_sel:[0,1,0] op_sel_hi:[1,1,1]
v_lshlrev_b32 v18,16,v127
v_and_b32 v19,s73,v127
v_pk_fma_f32 v[86:87],v[18:19],v[38:39],v[86:87] op_sel:[0,1,0] op_sel_hi:[1,1,1]
s_waitcnt vmcnt(24)
v_lshlrev_b32 v16,16,v188
v_and_b32 v17,s73,v188
v_pk_fma_f32 v[88:89],v[16:17],v[38:39],v[88:89] op_sel:[0,1,0] op_sel_hi:[1,1,1]
v_lshlrev_b32 v18,16,v189
v_and_b32 v19,s73,v189
v_pk_fma_f32 v[90:91],v[18:19],v[38:39],v[90:91] op_sel:[0,1,0] op_sel_hi:[1,1,1]
v_lshlrev_b32 v16,16,v190
v_and_b32 v17,s73,v190
v_pk_fma_f32 v[92:93],v[16:17],v[38:39],v[92:93] op_sel:[0,1,0] op_sel_hi:[1,1,1]
v_lshlrev_b32 v18,16,v191
v_and_b32 v19,s73,v191
v_pk_fma_f32 v[94:95],v[18:19],v[38:39],v[94:95] op_sel:[0,1,0] op_sel_hi:[1,1,1]
s_waitcnt vmcnt(23)
v_lshlrev_b32 v16,16,v128
v_and_b32 v17,s73,v128
v_pk_fma_f32 v[80:81],v[16:17],v[40:41],v[80:81] op_sel:[0,0,0] op_sel_hi:[1,0,1]
v_lshlrev_b32 v18,16,v129
v_and_b32 v19,s73,v129
v_pk_fma_f32 v[82:83],v[18:19],v[40:41],v[82:83] op_sel:[0,0,0] op_sel_hi:[1,0,1]
v_lshlrev_b32 v16,16,v130
v_and_b32 v17,s73,v130
v_pk_fma_f32 v[84:85],v[16:17],v[40:41],v[84:85] op_sel:[0,0,0] op_sel_hi:[1,0,1]
v_lshlrev_b32 v18,16,v131
v_and_b32 v19,s73,v131
v_pk_fma_f32 v[86:87],v[18:19],v[40:41],v[86:87] op_sel:[0,0,0] op_sel_hi:[1,0,1]
s_waitcnt vmcnt(22)
v_lshlrev_b32 v16,16,v192
v_and_b32 v17,s73,v192
v_pk_fma_f32 v[88:89],v[16:17],v[40:41],v[88:89] op_sel:[0,0,0] op_sel_hi:[1,0,1]
v_lshlrev_b32 v18,16,v193
v_and_b32 v19,s73,v193
v_pk_fma_f32 v[90:91],v[18:19],v[40:41],v[90:91] op_sel:[0,0,0] op_sel_hi:[1,0,1]
v_lshlrev_b32 v16,16,v194
v_and_b32 v17,s73,v194
v_pk_fma_f32 v[92:93],v[16:17],v[40:41],v[92:93] op_sel:[0,0,0] op_sel_hi:[1,0,1]
v_lshlrev_b32 v18,16,v195
v_and_b32 v19,s73,v195
v_pk_fma_f32 v[94:95],v[18:19],v[40:41],v[94:95] op_sel:[0,0,0] op_sel_hi:[1,0,1]
s_waitcnt vmcnt(21)
v_lshlrev_b32 v16,16,v132
v_and_b32 v17,s73,v132
v_pk_fma_f32 v[80:81],v[16:17],v[40:41],v[80:81] op_sel:[0,1,0] op_sel_hi:[1,1,1]
v_lshlrev_b32 v18,16,v133
v_and_b32 v19,s73,v133
v_pk_fma_f32 v[82:83],v[18:19],v[40:41],v[82:83] op_sel:[0,1,0] op_sel_hi:[1,1,1]
v_lshlrev_b32 v16,16,v134
v_and_b32 v17,s73,v134
v_pk_fma_f32 v[84:85],v[16:17],v[40:41],v[84:85] op_sel:[0,1,0] op_sel_hi:[1,1,1]
v_lshlrev_b32 v18,16,v135
v_and_b32 v19,s73,v135
v_pk_fma_f32 v[86:87],v[18:19],v[40:41],v[86:87] op_sel:[0,1,0] op_sel_hi:[1,1,1]
s_waitcnt vmcnt(20)
v_lshlrev_b32 v16,16,v196
v_and_b32 v17,s73,v196
v_pk_fma_f32 v[88:89],v[16:17],v[40:41],v[88:89] op_sel:[0,1,0] op_sel_hi:[1,1,1]
v_lshlrev_b32 v18,16,v197
v_and_b32 v19,s73,v197
v_pk_fma_f32 v[90:91],v[18:19],v[40:41],v[90:91] op_sel:[0,1,0] op_sel_hi:[1,1,1]
v_lshlrev_b32 v16,16,v198
v_and_b32 v17,s73,v198
v_pk_fma_f32 v[92:93],v[16:17],v[40:41],v[92:93] op_sel:[0,1,0] op_sel_hi:[1,1,1]
v_lshlrev_b32 v18,16,v199
v_and_b32 v19,s73,v199
v_pk_fma_f32 v[94:95],v[18:19],v[40:41],v[94:95] op_sel:[0,1,0] op_sel_hi:[1,1,1]
s_waitcnt vmcnt(19)
v_lshlrev_b32 v16,16,v136
v_and_b32 v17,s73,v136
v_pk_fma_f32 v[80:81],v[16:17],v[42:43],v[80:81] op_sel:[0,0,0] op_sel_hi:[1,0,1]
v_lshlrev_b32 v18,16,v137
v_and_b32 v19,s73,v137
v_pk_fma_f32 v[82:83],v[18:19],v[42:43],v[82:83] op_sel:[0,0,0] op_sel_hi:[1,0,1]
v_lshlrev_b32 v16,16,v138
v_and_b32 v17,s73,v138
v_pk_fma_f32 v[84:85],v[16:17],v[42:43],v[84:85] op_sel:[0,0,0] op_sel_hi:[1,0,1]
v_lshlrev_b32 v18,16,v139
v_and_b32 v19,s73,v139
v_pk_fma_f32 v[86:87],v[18:19],v[42:43],v[86:87] op_sel:[0,0,0] op_sel_hi:[1,0,1]
s_waitcnt vmcnt(18)
v_lshlrev_b32 v16,16,v200
v_and_b32 v17,s73,v200
v_pk_fma_f32 v[88:89],v[16:17],v[42:43],v[88:89] op_sel:[0,0,0] op_sel_hi:[1,0,1]
v_lshlrev_b32 v18,16,v201
v_and_b32 v19,s73,v201
v_pk_fma_f32 v[90:91],v[18:19],v[42:43],v[90:91] op_sel:[0,0,0] op_sel_hi:[1,0,1]
v_lshlrev_b32 v16,16,v202
v_and_b32 v17,s73,v202
v_pk_fma_f32 v[92:93],v[16:17],v[42:43],v[92:93] op_sel:[0,0,0] op_sel_hi:[1,0,1]
v_lshlrev_b32 v18,16,v203
v_and_b32 v19,s73,v203
v_pk_fma_f32 v[94:95],v[18:19],v[42:43],v[94:95] op_sel:[0,0,0] op_sel_hi:[1,0,1]
s_waitcnt vmcnt(17)
v_lshlrev_b32 v16,16,v140
v_and_b32 v17,s73,v140
v_pk_fma_f32 v[80:81],v[16:17],v[42:43],v[80:81] op_sel:[0,1,0] op_sel_hi:[1,1,1]
v_lshlrev_b32 v18,16,v141
v_and_b32 v19,s73,v141
v_pk_fma_f32 v[82:83],v[18:19],v[42:43],v[82:83] op_sel:[0,1,0] op_sel_hi:[1,1,1]
v_lshlrev_b32 v16,16,v142
v_and_b32 v17,s73,v142
v_pk_fma_f32 v[84:85],v[16:17],v[42:43],v[84:85] op_sel:[0,1,0] op_sel_hi:[1,1,1]
v_lshlrev_b32 v18,16,v143
v_and_b32 v19,s73,v143
v_pk_fma_f32 v[86:87],v[18:19],v[42:43],v[86:87] op_sel:[0,1,0] op_sel_hi:[1,1,1]
s_waitcnt vmcnt(16)
v_lshlrev_b32 v16,16,v204
v_and_b32 v17,s73,v204
v_pk_fma_f32 v[88:89],v[16:17],v[42:43],v[88:89] op_sel:[0,1,0] op_sel_hi:[1,1,1]
v_lshlrev_b32 v18,16,v205
v_and_b32 v19,s73,v205
v_pk_fma_f32 v[90:91],v[18:19],v[42:43],v[90:91] op_sel:[0,1,0] op_sel_hi:[1,1,1]
v_lshlrev_b32 v16,16,v206
v_and_b32 v17,s73,v206
v_pk_fma_f32 v[92:93],v[16:17],v[42:43],v[92:93] op_sel:[0,1,0] op_sel_hi:[1,1,1]
v_lshlrev_b32 v18,16,v207
v_and_b32 v19,s73,v207
v_pk_fma_f32 v[94:95],v[18:19],v[42:43],v[94:95] op_sel:[0,1,0] op_sel_hi:[1,1,1]
s_waitcnt vmcnt(15)
v_lshlrev_b32 v16,16,v144
v_and_b32 v17,s73,v144
v_pk_fma_f32 v[80:81],v[16:17],v[44:45],v[80:81] op_sel:[0,0,0] op_sel_hi:[1,0,1]
v_lshlrev_b32 v18,16,v145
v_and_b32 v19,s73,v145
v_pk_fma_f32 v[82:83],v[18:19],v[44:45],v[82:83] op_sel:[0,0,0] op_sel_hi:[1,0,1]
v_lshlrev_b32 v16,16,v146
v_and_b32 v17,s73,v146
v_pk_fma_f32 v[84:85],v[16:17],v[44:45],v[84:85] op_sel:[0,0,0] op_sel_hi:[1,0,1]
v_lshlrev_b32 v18,16,v147
v_and_b32 v19,s73,v147
v_pk_fma_f32 v[86:87],v[18:19],v[44:45],v[86:87] op_sel:[0,0,0] op_sel_hi:[1,0,1]
s_waitcnt vmcnt(14)
v_lshlrev_b32 v16,16,v208
v_and_b32 v17,s73,v208
v_pk_fma_f32 v[88:89],v[16:17],v[44:45],v[88:89] op_sel:[0,0,0] op_sel_hi:[1,0,1]
v_lshlrev_b32 v18,16,v209
v_and_b32 v19,s73,v209
v_pk_fma_f32 v[90:91],v[18:19],v[44:45],v[90:91] op_sel:[0,0,0] op_sel_hi:[1,0,1]
v_lshlrev_b32 v16,16,v210
v_and_b32 v17,s73,v210
v_pk_fma_f32 v[92:93],v[16:17],v[44:45],v[92:93] op_sel:[0,0,0] op_sel_hi:[1,0,1]
v_lshlrev_b32 v18,16,v211
v_and_b32 v19,s73,v211
v_pk_fma_f32 v[94:95],v[18:19],v[44:45],v[94:95] op_sel:[0,0,0] op_sel_hi:[1,0,1]
s_waitcnt vmcnt(13)
v_lshlrev_b32 v16,16,v148
v_and_b32 v17,s73,v148
v_pk_fma_f32 v[80:81],v[16:17],v[44:45],v[80:81] op_sel:[0,1,0] op_sel_hi:[1,1,1]
v_lshlrev_b32 v18,16,v149
v_and_b32 v19,s73,v149
v_pk_fma_f32 v[82:83],v[18:19],v[44:45],v[82:83] op_sel:[0,1,0] op_sel_hi:[1,1,1]
v_lshlrev_b32 v16,16,v150
v_and_b32 v17,s73,v150
v_pk_fma_f32 v[84:85],v[16:17],v[44:45],v[84:85] op_sel:[0,1,0] op_sel_hi:[1,1,1]
v_lshlrev_b32 v18,16,v151
v_and_b32 v19,s73,v151
v_pk_fma_f32 v[86:87],v[18:19],v[44:45],v[86:87] op_sel:[0,1,0] op_sel_hi:[1,1,1]
s_waitcnt vmcnt(12)
v_lshlrev_b32 v16,16,v212
v_and_b32 v17,s73,v212
v_pk_fma_f32 v[88:89],v[16:17],v[44:45],v[88:89] op_sel:[0,1,0] op_sel_hi:[1,1,1]
v_lshlrev_b32 v18,16,v213
v_and_b32 v19,s73,v213
v_pk_fma_f32 v[90:91],v[18:19],v[44:45],v[90:91] op_sel:[0,1,0] op_sel_hi:[1,1,1]
v_lshlrev_b32 v16,16,v214
v_and_b32 v17,s73,v214
v_pk_fma_f32 v[92:93],v[16:17],v[44:45],v[92:93] op_sel:[0,1,0] op_sel_hi:[1,1,1]
v_lshlrev_b32 v18,16,v215
v_and_b32 v19,s73,v215
v_pk_fma_f32 v[94:95],v[18:19],v[44:45],v[94:95] op_sel:[0,1,0] op_sel_hi:[1,1,1]
s_waitcnt vmcnt(11)
v_lshlrev_b32 v16,16,v152
v_and_b32 v17,s73,v152
v_pk_fma_f32 v[80:81],v[16:17],v[46:47],v[80:81] op_sel:[0,0,0] op_sel_hi:[1,0,1]
v_lshlrev_b32 v18,16,v153
v_and_b32 v19,s73,v153
v_pk_fma_f32 v[82:83],v[18:19],v[46:47],v[82:83] op_sel:[0,0,0] op_sel_hi:[1,0,1]
v_lshlrev_b32 v16,16,v154
v_and_b32 v17,s73,v154
v_pk_fma_f32 v[84:85],v[16:17],v[46:47],v[84:85] op_sel:[0,0,0] op_sel_hi:[1,0,1]
v_lshlrev_b32 v18,16,v155
v_and_b32 v19,s73,v155
v_pk_fma_f32 v[86:87],v[18:19],v[46:47],v[86:87] op_sel:[0,0,0] op_sel_hi:[1,0,1]
s_waitcnt vmcnt(10)
v_lshlrev_b32 v16,16,v216
v_and_b32 v17,s73,v216
v_pk_fma_f32 v[88:89],v[16:17],v[46:47],v[88:89] op_sel:[0,0,0] op_sel_hi:[1,0,1]
v_lshlrev_b32 v18,16,v217
v_and_b32 v19,s73,v217
v_pk_fma_f32 v[90:91],v[18:19],v[46:47],v[90:91] op_sel:[0,0,0] op_sel_hi:[1,0,1]
v_lshlrev_b32 v16,16,v218
v_and_b32 v17,s73,v218
v_pk_fma_f32 v[92:93],v[16:17],v[46:47],v[92:93] op_sel:[0,0,0] op_sel_hi:[1,0,1]
v_lshlrev_b32 v18,16,v219
v_and_b32 v19,s73,v219
v_pk_fma_f32 v[94:95],v[18:19],v[46:47],v[94:95] op_sel:[0,0,0] op_sel_hi:[1,0,1]
s_waitcnt vmcnt(9)
v_lshlrev_b32 v16,16,v156
v_and_b32 v17,s73,v156
v_pk_fma_f32 v[80:81],v[16:17],v[46:47],v[80:81] op_sel:[0,1,0] op_sel_hi:[1,1,1]
v_lshlrev_b32 v18,16,v157
v_and_b32 v19,s73,v157
v_pk_fma_f32 v[82:83],v[18:19],v[46:47],v[82:83] op_sel:[0,1,0] op_sel_hi:[1,1,1]
v_lshlrev_b32 v16,16,v158
v_and_b32 v17,s73,v158
v_pk_fma_f32 v[84:85],v[16:17],v[46:47],v[84:85] op_sel:[0,1,0] op_sel_hi:[1,1,1]
v_lshlrev_b32 v18,16,v159
v_and_b32 v19,s73,v159
v_pk_fma_f32 v[86:87],v[18:19],v[46:47],v[86:87] op_sel:[0,1,0] op_sel_hi:[1,1,1]
s_waitcnt vmcnt(8)
v_lshlrev_b32 v16,16,v220
v_and_b32 v17,s73,v220
v_pk_fma_f32 v[88:89],v[16:17],v[46:47],v[88:89] op_sel:[0,1,0] op_sel_hi:[1,1,1]
v_lshlrev_b32 v18,16,v221
v_and_b32 v19,s73,v221
v_pk_fma_f32 v[90:91],v[18:19],v[46:47],v[90:91] op_sel:[0,1,0] op_sel_hi:[1,1,1]
v_lshlrev_b32 v16,16,v222
v_and_b32 v17,s73,v222
v_pk_fma_f32 v[92:93],v[16:17],v[46:47],v[92:93] op_sel:[0,1,0] op_sel_hi:[1,1,1]
v_lshlrev_b32 v18,16,v223
v_and_b32 v19,s73,v223
v_pk_fma_f32 v[94:95],v[18:19],v[46:47],v[94:95] op_sel:[0,1,0] op_sel_hi:[1,1,1]
v_lshlrev_b32 v18,5,v14
ds_write_b128 v18,v[80:83] offset:16384
ds_write_b128 v18,v[84:87] offset:16400
ds_write_b128 v18,v[88:91] offset:24576
ds_write_b128 v18,v[92:95] offset:24592
v_and_b32 v18,127,v14
v_lshlrev_b32 v18,2,v18
v_lshrrev_b32 v19,7,v14
v_lshl_add_u32 v19,v19,13,v18
s_waitcnt lgkmcnt(0)
s_barrier
ds_read_b32 v32,v19 offset:16384
ds_read_b32 v33,v19 offset:16896
ds_read_b32 v34,v19 offset:17408
ds_read_b32 v35,v19 offset:17920
ds_read_b32 v36,v19 offset:18432
ds_read_b32 v37,v19 offset:18944
ds_read_b32 v38,v19 offset:19456
ds_read_b32 v39,v19 offset:19968
ds_read_b32 v40,v19 offset:20480
ds_read_b32 v41,v19 offset:20992
ds_read_b32 v42,v19 offset:21504
ds_read_b32 v43,v19 offset:22016
s_waitcnt lgkmcnt(4)
ds_read_b32 v44,v19 offset:22528
ds_read_b32 v45,v19 offset:23040
ds_read_b32 v46,v19 offset:23552
ds_read_b32 v47,v19 offset:24064
s_waitcnt lgkmcnt(0)
v_pk_add_f32 v[32:33],v[32:33],v[40:41]
v_pk_add_f32 v[34:35],v[34:35],v[42:43]
v_pk_add_f32 v[36:37],v[36:37],v[44:45]
v_pk_add_f32 v[38:39],v[38:39],v[46:47]
v_pk_add_f32 v[32:33],v[32:33],v[36:37]
v_pk_add_f32 v[34:35],v[34:35],v[38:39]
v_pk_add_f32 v[32:33],v[32:33],v[34:35]
v_add_f32 v32,v32,v33
s_mul_i32 s64,s53,24576
s_lshl_b32 s65,s52,10
s_add_u32 s64,s64,s65
s_add_u32 s64,s64,267395072
v_lshlrev_b32 v18,2,v14
buffer_store_dword v32,v18,s[20:23],s64 offen sc1
s_cmp_eq_u32 s58,220
s_cbranch_scc1 fl2_27
s_mov_b32 s62,s59
fl1_26:
s_lshl_b32 s64,s62,2
s_add_u32 s64,s64,s50
s_mul_i32 s64,s64,14336
s_add_u32 s64,s64,143130624
buffer_store_dwordx4 v[28:31],v24,s[20:23],s64 offen offset:0 sc1
buffer_store_dwordx4 v[28:31],v24,s[20:23],s64 offen offset:1024 sc1
buffer_store_dwordx4 v[28:31],v24,s[20:23],s64 offen offset:2048 sc1
buffer_store_dwordx4 v[28:31],v24,s[20:23],s64 offen offset:3072 sc1
s_add_u32 s64,s64,4096
buffer_store_dwordx4 v[28:31],v24,s[20:23],s64 offen offset:0 sc1
buffer_store_dwordx4 v[28:31],v24,s[20:23],s64 offen offset:1024 sc1
buffer_store_dwordx4 v[28:31],v24,s[20:23],s64 offen offset:2048 sc1
buffer_store_dwordx4 v[28:31],v24,s[20:23],s64 offen offset:3072 sc1
s_add_u32 s64,s64,4096
buffer_store_dwordx4 v[28:31],v24,s[20:23],s64 offen offset:0 sc1
buffer_store_dwordx4 v[28:31],v24,s[20:23],s64 offen offset:1024 sc1
buffer_store_dwordx4 v[28:31],v24,s[20:23],s64 offen offset:2048 sc1
buffer_store_dwordx4 v[28:31],v24,s[20:23],s64 offen offset:3072 sc1
s_add_u32 s64,s64,4096
buffer_store_dwordx4 v[28:31],v24,s[20:23],s64 offen offset:0 sc1
buffer_store_dwordx4 v[28:31],v24,s[20:23],s64 offen offset:1024 sc1
s_lshl_b32 s64,s62,2
s_add_u32 s64,s64,s50
s_mul_i32 s64,s64,6144
s_add_u32 s64,s64,167772160
buffer_store_dwordx4 v[28:31],v24,s[20:23],s64 offen offset:0 sc1
buffer_store_dwordx4 v[28:31],v24,s[20:23],s64 offen offset:1024 sc1
buffer_store_dwordx4 v[28:31],v24,s[20:23],s64 offen offset:2048 sc1
buffer_store_dwordx4 v[28:31],v24,s[20:23],s64 offen offset:3072 sc1
s_add_u32 s64,s64,4096
buffer_store_dwordx4 v[28:31],v24,s[20:23],s64 offen offset:0 sc1
buffer_store_dwordx4 v[28:31],v24,s[20:23],s64 offen offset:1024 sc1
s_and_b32 s64,s62,31
s_lshl_b32 s64,s64,10
s_add_u32 s64,s64,209715200
s_bitcmp1_b32 s62,5
s_cselect_b32 s65,4227072,0
s_add_u32 s64,s64,s65
buffer_store_dwordx4 v[20:23],v24,s[20:23],s64 offen sc1
s_cmp_eq_u32 s62,29
s_mov_b32 s62,28
s_cbranch_scc1 fl1_26
fl2_27:
s_waitcnt vmcnt(0)
s_barrier
s_cmp_lg_u32 s50,0
s_cbranch_scc1 sig_28
s_mov_b32 s92,s2
s_and_b32 s93,s3,0xffff
s_mov_b32 s94,0x100
s_mov_b32 s95,0x20000
s_add_u32 s64,s88,4
s_add_u32 s65,s88,8
s_cmp_eq_u32 s58,220
s_cselect_b32 s64,s65,s64
v_mov_b32 v16,1
s_mov_b64 exec,1
buffer_atomic_add v16,off,s[92:95],s64 sc1
s_mov_b64 exec,-1
sig_28:
v_lshlrev_b32 v128,16,v48
v_and_b32 v129,s73,v48
v_lshlrev_b32 v130,16,v49
v_and_b32 v131,s73,v49
v_lshlrev_b32 v132,16,v50
v_and_b32 v133,s73,v50
v_lshlrev_b32 v134,16,v51
v_and_b32 v135,s73,v51
v_lshlrev_b32 v136,16,v52
v_and_b32 v137,s73,v52
v_lshlrev_b32 v138,16,v53
v_and_b32 v139,s73,v53
v_lshlrev_b32 v140,16,v54
v_and_b32 v141,s73,v54
v_lshlrev_b32 v142,16,v55
v_and_b32 v143,s73,v55
v_lshlrev_b32 v144,16,v56
v_and_b32 v145,s73,v56
v_lshlrev_b32 v146,16,v57
v_and_b32 v147,s73,v57
v_lshlrev_b32 v148,16,v58
v_and_b32 v149,s73,v58
v_lshlrev_b32 v150,16,v59
v_and_b32 v151,s73,v59
v_lshlrev_b32 v152,16,v60
v_and_b32 v153,s73,v60
v_lshlrev_b32 v154,16,v61
v_and_b32 v155,s73,v61
v_lshlrev_b32 v156,16,v62
v_and_b32 v157,s73,v62
v_lshlrev_b32 v158,16,v63
v_and_b32 v159,s73,v63
v_lshlrev_b32 v160,16,v64
v_and_b32 v161,s73,v64
v_lshlrev_b32 v162,16,v65
v_and_b32 v163,s73,v65
v_lshlrev_b32 v164,16,v66
v_and_b32 v165,s73,v66
v_lshlrev_b32 v166,16,v67
v_and_b32 v167,s73,v67
v_lshlrev_b32 v168,16,v68
v_and_b32 v169,s73,v68
v_lshlrev_b32 v170,16,v69
v_and_b32 v171,s73,v69
v_lshlrev_b32 v172,16,v70
v_and_b32 v173,s73,v70
v_lshlrev_b32 v174,16,v71
v_and_b32 v175,s73,v71
v_lshlrev_b32 v176,16,v72
v_and_b32 v177,s73,v72
v_lshlrev_b32 v178,16,v73
v_and_b32 v179,s73,v73
v_lshlrev_b32 v180,16,v74
v_and_b32 v181,s73,v74
v_lshlrev_b32 v182,16,v75
v_and_b32 v183,s73,v75
v_lshlrev_b32 v184,16,v76
v_and_b32 v185,s73,v76
v_lshlrev_b32 v186,16,v77
v_and_b32 v187,s73,v77
v_lshlrev_b32 v188,16,v78
v_and_b32 v189,s73,v78
v_lshlrev_b32 v190,16,v79
v_and_b32 v191,s73,v79
v_add_f32 v208,v128,v129
v_mul_f32 v209,v128,v128
v_add_f32 v210,v130,v131
v_mul_f32 v211,v129,v129
v_fmac_f32 v209,v130,v130
v_fmac_f32 v211,v131,v131
v_add_f32 v208,v208,v132
v_fmac_f32 v209,v132,v132
v_add_f32 v210,v210,v133
v_fmac_f32 v211,v133,v133
v_add_f32 v208,v208,v134
v_fmac_f32 v209,v134,v134
v_add_f32 v210,v210,v135
v_fmac_f32 v211,v135,v135
v_add_f32 v208,v208,v136
v_fmac_f32 v209,v136,v136
v_add_f32 v210,v210,v137
v_fmac_f32 v211,v137,v137
v_add_f32 v208,v208,v138
v_fmac_f32 v209,v138,v138
v_add_f32 v210,v210,v139
v_fmac_f32 v211,v139,v139
v_add_f32 v208,v208,v140
v_fmac_f32 v209,v140,v140
v_add_f32 v210,v210,v141
v_fmac_f32 v211,v141,v141
v_add_f32 v208,v208,v142
v_fmac_f32 v209,v142,v142
v_add_f32 v210,v210,v143
v_fmac_f32 v211,v143,v143
v_add_f32 v208,v208,v210
v_add_f32 v209,v209,v211
v_add_f32 v212,v144,v145
v_mul_f32 v213,v144,v144
v_add_f32 v214,v146,v147
v_mul_f32 v215,v145,v145
v_fmac_f32 v213,v146,v146
v_fmac_f32 v215,v147,v147
v_add_f32 v212,v212,v148
v_fmac_f32 v213,v148,v148
v_add_f32 v214,v214,v149
v_fmac_f32 v215,v149,v149
v_add_f32 v212,v212,v150
v_fmac_f32 v213,v150,v150
v_add_f32 v214,v214,v151
v_fmac_f32 v215,v151,v151
v_add_f32 v212,v212,v152
v_fmac_f32 v213,v152,v152
v_add_f32 v214,v214,v153
v_fmac_f32 v215,v153,v153
v_add_f32 v212,v212,v154
v_fmac_f32 v213,v154,v154
v_add_f32 v214,v214,v155
v_fmac_f32 v215,v155,v155
v_add_f32 v212,v212,v156
v_fmac_f32 v213,v156,v156
v_add_f32 v214,v214,v157
v_fmac_f32 v215,v157,v157
v_add_f32 v212,v212,v158
v_fmac_f32 v213,v158,v158
v_add_f32 v214,v214,v159
v_fmac_f32 v215,v159,v159
v_add_f32 v212,v212,v214
v_add_f32 v213,v213,v215
v_add_f32 v216,v160,v161
v_mul_f32 v217,v160,v160
v_add_f32 v218,v162,v163
v_mul_f32 v219,v161,v161
v_fmac_f32 v217,v162,v162
v_fmac_f32 v219,v163,v163
v_add_f32 v216,v216,v164
v_fmac_f32 v217,v164,v164
v_add_f32 v218,v218,v165
v_fmac_f32 v219,v165,v165
v_add_f32 v216,v216,v166
v_fmac_f32 v217,v166,v166
v_add_f32 v218,v218,v167
v_fmac_f32 v219,v167,v167
v_add_f32 v216,v216,v168
v_fmac_f32 v217,v168,v168
v_add_f32 v218,v218,v169
v_fmac_f32 v219,v169,v169
v_add_f32 v216,v216,v170
v_fmac_f32 v217,v170,v170
v_add_f32 v218,v218,v171
v_fmac_f32 v219,v171,v171
v_add_f32 v216,v216,v172
v_fmac_f32 v217,v172,v172
v_add_f32 v218,v218,v173
v_fmac_f32 v219,v173,v173
v_add_f32 v216,v216,v174
v_fmac_f32 v217,v174,v174
v_add_f32 v218,v218,v175
v_fmac_f32 v219,v175,v175
v_add_f32 v216,v216,v218
v_add_f32 v217,v217,v219
v_add_f32 v220,v176,v177
v_mul_f32 v221,v176,v176
v_add_f32 v222,v178,v179
v_mul_f32 v223,v177,v177
v_fmac_f32 v221,v178,v178
v_fmac_f32 v223,v179,v179
v_add_f32 v220,v220,v180
v_fmac_f32 v221,v180,v180
v_add_f32 v222,v222,v181
v_fmac_f32 v223,v181,v181
v_add_f32 v220,v220,v182
v_fmac_f32 v221,v182,v182
v_add_f32 v222,v222,v183
v_fmac_f32 v223,v183,v183
v_add_f32 v220,v220,v184
v_fmac_f32 v221,v184,v184
v_add_f32 v222,v222,v185
v_fmac_f32 v223,v185,v185
v_add_f32 v220,v220,v186
v_fmac_f32 v221,v186,v186
v_add_f32 v222,v222,v187
v_fmac_f32 v223,v187,v187
v_add_f32 v220,v220,v188
v_fmac_f32 v221,v188,v188
v_add_f32 v222,v222,v189
v_fmac_f32 v223,v189,v189
v_add_f32 v220,v220,v190
v_fmac_f32 v221,v190,v190
v_add_f32 v222,v222,v191
v_fmac_f32 v223,v191,v191
v_add_f32 v220,v220,v222
v_add_f32 v221,v221,v223
v_add_f32_dpp v208,v208,v208 row_ror:4 row_mask:0xf bank_mask:0xf
v_add_f32_dpp v209,v209,v209 row_ror:4 row_mask:0xf bank_mask:0xf
v_add_f32_dpp v212,v212,v212 row_ror:4 row_mask:0xf bank_mask:0xf
v_add_f32_dpp v213,v213,v213 row_ror:4 row_mask:0xf bank_mask:0xf
v_add_f32_dpp v216,v216,v216 row_ror:4 row_mask:0xf bank_mask:0xf
v_add_f32_dpp v217,v217,v217 row_ror:4 row_mask:0xf bank_mask:0xf
v_add_f32_dpp v220,v220,v220 row_ror:4 row_mask:0xf bank_mask:0xf
v_add_f32_dpp v221,v221,v221 row_ror:4 row_mask:0xf bank_mask:0xf
v_add_f32_dpp v208,v208,v208 row_ror:8 row_mask:0xf bank_mask:0xf
v_add_f32_dpp v209,v209,v209 row_ror:8 row_mask:0xf bank_mask:0xf
v_add_f32_dpp v212,v212,v212 row_ror:8 row_mask:0xf bank_mask:0xf
v_add_f32_dpp v213,v213,v213 row_ror:8 row_mask:0xf bank_mask:0xf
v_add_f32_dpp v216,v216,v216 row_ror:8 row_mask:0xf bank_mask:0xf
v_add_f32_dpp v217,v217,v217 row_ror:8 row_mask:0xf bank_mask:0xf
v_add_f32_dpp v220,v220,v220 row_ror:8 row_mask:0xf bank_mask:0xf
v_add_f32_dpp v221,v221,v221 row_ror:8 row_mask:0xf bank_mask:0xf
v_mov_b32 v210,v208
v_mov_b32 v211,v209
s_nop 0
v_permlane16_swap_b32 v210,v208
v_permlane16_swap_b32 v211,v209
v_add_f32 v208,v208,v210
v_add_f32 v209,v209,v211
v_mov_b32 v214,v212
v_mov_b32 v215,v213
s_nop 0
v_permlane16_swap_b32 v214,v212
v_permlane16_swap_b32 v215,v213
v_add_f32 v212,v212,v214
v_add_f32 v213,v213,v215
v_mov_b32 v218,v216
v_mov_b32 v219,v217
s_nop 0
v_permlane16_swap_b32 v218,v216
v_permlane16_swap_b32 v219,v217
v_add_f32 v216,v216,v218
v_add_f32 v217,v217,v219
v_mov_b32 v222,v220
v_mov_b32 v223,v221
s_nop 0
v_permlane16_swap_b32 v222,v220
v_permlane16_swap_b32 v223,v221
v_add_f32 v220,v220,v222
v_add_f32 v221,v221,v223
v_mov_b32 v210,v208
v_mov_b32 v211,v209
s_nop 0
v_permlane32_swap_b32 v210,v208
v_permlane32_swap_b32 v211,v209
v_add_f32 v208,v208,v210
v_add_f32 v209,v209,v211
v_mov_b32 v214,v212
v_mov_b32 v215,v213
s_nop 0
v_permlane32_swap_b32 v214,v212
v_permlane32_swap_b32 v215,v213
v_add_f32 v212,v212,v214
v_add_f32 v213,v213,v215
v_mov_b32 v218,v216
v_mov_b32 v219,v217
s_nop 0
v_permlane32_swap_b32 v218,v216
v_permlane32_swap_b32 v219,v217
v_add_f32 v216,v216,v218
v_add_f32 v217,v217,v219
v_mov_b32 v222,v220
v_mov_b32 v223,v221
s_nop 0
v_permlane32_swap_b32 v222,v220
v_permlane32_swap_b32 v223,v221
v_add_f32 v220,v220,v222
v_add_f32 v221,v221,v223
ds_write_b64 v11,v[208:209] offset:32768
ds_write_b64 v11,v[212:213] offset:34816
ds_write_b64 v11,v[216:217] offset:36864
ds_write_b64 v11,v[220:221] offset:38912
s_waitcnt lgkmcnt(0)
s_barrier
ds_read_b64 v[32:33],v12 offset:32768
ds_read_b64 v[34:35],v12 offset:33280
ds_read_b64 v[36:37],v12 offset:33792
ds_read_b64 v[38:39],v12 offset:34304
s_waitcnt lgkmcnt(0)
v_add_f32 v32,v32,v34
v_add_f32 v33,v33,v35
v_add_f32 v36,v36,v38
v_add_f32 v37,v37,v39
v_add_f32 v32,v32,v36
v_add_f32 v33,v33,v37
v_mul_f32 v208,0xba800000,v32
v_mul_f32 v34,v208,v208
v_mul_f32 v33,0x3a800000,v33
v_sub_f32 v33,v33,v34
v_max_f32 v33,0,v33
v_add_f32 v33,0x3727c5ac,v33
v_rsq_f32 v209,v33
s_nop 0
v_mul_f32 v208,v208,v209
v_fma_f32 v128,v128,v209,v208
v_fma_f32 v129,v129,v209,v208
v_fma_f32 v130,v130,v209,v208
v_fma_f32 v131,v131,v209,v208
v_fma_f32 v132,v132,v209,v208
v_fma_f32 v133,v133,v209,v208
v_fma_f32 v134,v134,v209,v208
v_fma_f32 v135,v135,v209,v208
v_fma_f32 v136,v136,v209,v208
v_fma_f32 v137,v137,v209,v208
v_fma_f32 v138,v138,v209,v208
v_fma_f32 v139,v139,v209,v208
v_fma_f32 v140,v140,v209,v208
v_fma_f32 v141,v141,v209,v208
v_fma_f32 v142,v142,v209,v208
v_fma_f32 v143,v143,v209,v208
ds_read_b64 v[32:33],v12 offset:34816
ds_read_b64 v[34:35],v12 offset:35328
ds_read_b64 v[36:37],v12 offset:35840
ds_read_b64 v[38:39],v12 offset:36352
s_waitcnt lgkmcnt(0)
v_add_f32 v32,v32,v34
v_add_f32 v33,v33,v35
v_add_f32 v36,v36,v38
v_add_f32 v37,v37,v39
v_add_f32 v32,v32,v36
v_add_f32 v33,v33,v37
v_mul_f32 v208,0xba800000,v32
v_mul_f32 v34,v208,v208
v_mul_f32 v33,0x3a800000,v33
v_sub_f32 v33,v33,v34
v_max_f32 v33,0,v33
v_add_f32 v33,0x3727c5ac,v33
v_rsq_f32 v209,v33
s_nop 0
v_mul_f32 v208,v208,v209
v_fma_f32 v144,v144,v209,v208
v_fma_f32 v145,v145,v209,v208
v_fma_f32 v146,v146,v209,v208
v_fma_f32 v147,v147,v209,v208
v_fma_f32 v148,v148,v209,v208
v_fma_f32 v149,v149,v209,v208
v_fma_f32 v150,v150,v209,v208
v_fma_f32 v151,v151,v209,v208
v_fma_f32 v152,v152,v209,v208
v_fma_f32 v153,v153,v209,v208
v_fma_f32 v154,v154,v209,v208
v_fma_f32 v155,v155,v209,v208
v_fma_f32 v156,v156,v209,v208
v_fma_f32 v157,v157,v209,v208
v_fma_f32 v158,v158,v209,v208
v_fma_f32 v159,v159,v209,v208
ds_read_b64 v[32:33],v12 offset:36864
ds_read_b64 v[34:35],v12 offset:37376
ds_read_b64 v[36:37],v12 offset:37888
ds_read_b64 v[38:39],v12 offset:38400
s_waitcnt lgkmcnt(0)
v_add_f32 v32,v32,v34
v_add_f32 v33,v33,v35
v_add_f32 v36,v36,v38
v_add_f32 v37,v37,v39
v_add_f32 v32,v32,v36
v_add_f32 v33,v33,v37
v_mul_f32 v208,0xba800000,v32
v_mul_f32 v34,v208,v208
v_mul_f32 v33,0x3a800000,v33
v_sub_f32 v33,v33,v34
v_max_f32 v33,0,v33
v_add_f32 v33,0x3727c5ac,v33
v_rsq_f32 v209,v33
s_nop 0
v_mul_f32 v208,v208,v209
v_fma_f32 v160,v160,v209,v208
v_fma_f32 v161,v161,v209,v208
v_fma_f32 v162,v162,v209,v208
v_fma_f32 v163,v163,v209,v208
v_fma_f32 v164,v164,v209,v208
v_fma_f32 v165,v165,v209,v208
v_fma_f32 v166,v166,v209,v208
v_fma_f32 v167,v167,v209,v208
v_fma_f32 v168,v168,v209,v208
v_fma_f32 v169,v169,v209,v208
v_fma_f32 v170,v170,v209,v208
v_fma_f32 v171,v171,v209,v208
v_fma_f32 v172,v172,v209,v208
v_fma_f32 v173,v173,v209,v208
v_fma_f32 v174,v174,v209,v208
v_fma_f32 v175,v175,v209,v208
ds_read_b64 v[32:33],v12 offset:38912
ds_read_b64 v[34:35],v12 offset:39424
ds_read_b64 v[36:37],v12 offset:39936
ds_read_b64 v[38:39],v12 offset:40448
s_waitcnt lgkmcnt(0)
v_add_f32 v32,v32,v34
v_add_f32 v33,v33,v35
v_add_f32 v36,v36,v38
v_add_f32 v37,v37,v39
v_add_f32 v32,v32,v36
v_add_f32 v33,v33,v37
v_mul_f32 v208,0xba800000,v32
v_mul_f32 v34,v208,v208
v_mul_f32 v33,0x3a800000,v33
v_sub_f32 v33,v33,v34
v_max_f32 v33,0,v33
v_add_f32 v33,0x3727c5ac,v33
v_rsq_f32 v209,v33
s_nop 0
v_mul_f32 v208,v208,v209
v_fma_f32 v176,v176,v209,v208
v_fma_f32 v177,v177,v209,v208
v_fma_f32 v178,v178,v209,v208
v_fma_f32 v179,v179,v209,v208
v_fma_f32 v180,v180,v209,v208
v_fma_f32 v181,v181,v209,v208
v_fma_f32 v182,v182,v209,v208
v_fma_f32 v183,v183,v209,v208
v_fma_f32 v184,v184,v209,v208
v_fma_f32 v185,v185,v209,v208
v_fma_f32 v186,v186,v209,v208
v_fma_f32 v187,v187,v209,v208
v_fma_f32 v188,v188,v209,v208
v_fma_f32 v189,v189,v209,v208
v_fma_f32 v190,v190,v209,v208
v_fma_f32 v191,v191,v209,v208
s_mov_b32 s92,s2
s_and_b32 s93,s3,0xffff
s_mov_b32 s94,0x100
s_mov_b32 s95,0x20000
v_mbcnt_lo_u32_b32 v16,-1,0
v_mbcnt_hi_u32_b32 v16,-1,v16
v_mov_b32 v18,0
v_cmp_eq_u32 vcc,16,v16
s_nop 1
v_cndmask_b32 v18,v18,64,vcc
v_and_b32 v19,1,v16
v_cmp_eq_u32 vcc,1,v19
v_mov_b32 v19,8192
s_nop 0
v_cndmask_b32 v19,-1,v19,vcc
v_min_u32 v16,31,v16
v_lshlrev_b32 v16,2,v16
s_sub_u32 s66,s88,64
s_cmp_lg_u32 s50,0
s_cbranch_scc1 vot_33
vpoll_29:
buffer_load_dword v17,v16,s[92:95],s66 offen sc1
s_waitcnt vmcnt(0)
s_cmp_lg_u32 s56,2
s_cbranch_scc1 vck_30
v_cmp_eq_u32 vcc,v17,v19
s_and_b32 s64,vcc_lo,0xffff
s_cmp_eq_u32 s64,65535
s_cbranch_scc1 vck_30
s_mov_b32 s65,0
v_readlane_b32 s64,v17,1
s_lshr_b32 s64,s64,8
s_add_u32 s65,s65,s64
v_readlane_b32 s64,v17,3
s_lshr_b32 s64,s64,8
s_add_u32 s65,s65,s64
v_readlane_b32 s64,v17,5
s_lshr_b32 s64,s64,8
s_add_u32 s65,s65,s64
v_readlane_b32 s64,v17,7
s_lshr_b32 s64,s64,8
s_add_u32 s65,s65,s64
v_readlane_b32 s64,v17,9
s_lshr_b32 s64,s64,8
s_add_u32 s65,s65,s64
v_readlane_b32 s64,v17,11
s_lshr_b32 s64,s64,8
s_add_u32 s65,s65,s64
v_readlane_b32 s64,v17,13
s_lshr_b32 s64,s64,8
s_add_u32 s65,s65,s64
v_readlane_b32 s64,v17,15
s_lshr_b32 s64,s64,8
s_add_u32 s65,s65,s64
s_cmp_ge_u32 s65,256
s_cbranch_scc1 vok_32
s_branch vrt_31
vck_30:
v_cmp_gt_u32 vcc,v18,v17
s_cbranch_vccz vok_32
vrt_31:
s_sleep 8
s_sub_u32 s90,s90,1
s_cmp_gt_i32 s90,0
s_cbranch_scc1 vpoll_29
vok_32:
v_add_u32 v18,160512,v16
ds_write_b32 v18,v17
s_waitcnt lgkmcnt(0)
vot_33:
s_barrier
v_add_u32 v18,160512,v16
ds_read_b32 v17,v18
s_waitcnt lgkmcnt(0)
s_cmp_lg_u32 s56,2
s_cbranch_scc1 vfin_34
v_cmp_eq_u32 vcc,v17,v19
s_and_b32 s64,vcc_lo,0xffff
s_cmp_eq_u32 s64,65535
s_cbranch_scc1 vfin_34
s_mov_b32 s65,0
v_readlane_b32 s64,v17,1
s_lshr_b32 s64,s64,8
s_add_u32 s65,s65,s64
v_readlane_b32 s64,v17,3
s_lshr_b32 s64,s64,8
s_add_u32 s65,s65,s64
v_readlane_b32 s64,v17,5
s_lshr_b32 s64,s64,8
s_add_u32 s65,s65,s64
v_readlane_b32 s64,v17,7
s_lshr_b32 s64,s64,8
s_add_u32 s65,s65,s64
v_readlane_b32 s64,v17,9
s_lshr_b32 s64,s64,8
s_add_u32 s65,s65,s64
v_readlane_b32 s64,v17,11
s_lshr_b32 s64,s64,8
s_add_u32 s65,s65,s64
v_readlane_b32 s64,v17,13
s_lshr_b32 s64,s64,8
s_add_u32 s65,s65,s64
v_readlane_b32 s64,v17,15
s_lshr_b32 s64,s64,8
s_add_u32 s65,s65,s64
s_cmp_ge_u32 s65,256
s_cbranch_scc1 fl_fb
vfin_34:
s_and_b32 s56,s56,1
v_lshlrev_b32 v18,5,v14
s_mov_b32 s64,267386880
buffer_load_dwordx4 v[32:35],v18,s[20:23],s64 offen offset:0 sc1
buffer_load_dwordx4 v[36:39],v18,s[20:23],s64 offen offset:16 sc1
s_mov_b32 s64,267411456
buffer_load_dwordx4 v[40:43],v18,s[20:23],s64 offen offset:0 sc1
buffer_load_dwordx4 v[44:47],v18,s[20:23],s64 offen offset:16 sc1
s_mov_b32 s64,267436032
buffer_load_dwordx4 v[48:51],v18,s[20:23],s64 offen offset:0 sc1
buffer_load_dwordx4 v[52:55],v18,s[20:23],s64 offen offset:16 sc1
s_mov_b32 s64,267460608
buffer_load_dwordx4 v[56:59],v18,s[20:23],s64 offen offset:0 sc1
buffer_load_dwordx4 v[60:63],v18,s[20:23],s64 offen offset:16 sc1
s_cmp_gt_u32 s50,1
s_cselect_b32 s64,1.0,0
s_waitcnt vmcnt(0)
v_pk_add_f32 v[32:33],v[32:33],v[40:41]
v_pk_add_f32 v[48:49],v[48:49],v[56:57]
v_pk_add_f32 v[34:35],v[34:35],v[42:43]
v_pk_add_f32 v[50:51],v[50:51],v[58:59]
v_pk_add_f32 v[36:37],v[36:37],v[44:45]
v_pk_add_f32 v[52:53],v[52:53],v[60:61]
v_pk_add_f32 v[38:39],v[38:39],v[46:47]
v_pk_add_f32 v[54:55],v[54:55],v[62:63]
v_pk_add_f32 v[32:33],v[32:33],v[48:49]
v_pk_add_f32 v[34:35],v[34:35],v[50:51]
v_pk_add_f32 v[36:37],v[36:37],v[52:53]
v_pk_add_f32 v[38:39],v[38:39],v[54:55]
v_cvt_pk_bf16_f32 v40,v32,v33
v_cvt_pk_bf16_f32 v41,v34,v35
v_cvt_pk_bf16_f32 v42,v36,v37
v_cvt_pk_bf16_f32 v43,v38,v39
v_lshlrev_b32 v32,16,v40
v_and_b32 v33,s73,v40
v_lshlrev_b32 v34,16,v41
v_and_b32 v35,s73,v41
v_lshlrev_b32 v36,16,v42
v_and_b32 v37,s73,v42
v_lshlrev_b32 v38,16,v43
v_and_b32 v39,s73,v43
v_add_f32 v32,s64,v32
v_add_f32 v33,s64,v33
v_add_f32 v34,s64,v34
v_add_f32 v35,s64,v35
v_add_f32 v36,s64,v36
v_add_f32 v37,s64,v37
v_add_f32 v38,s64,v38
v_add_f32 v39,s64,v39
ds_write_b128 v18,v[32:35] offset:0
ds_write_b128 v18,v[36:39] offset:16
s_waitcnt lgkmcnt(0)
s_barrier
ds_read_b128 v[112:115],v9 offset:0
ds_read_b128 v[116:119],v9 offset:16
ds_read_b128 v[120:123],v9 offset:512
ds_read_b128 v[124:127],v9 offset:528
ds_read_b128 v[96:99],v9 offset:4096
ds_read_b128 v[100:103],v9 offset:4112
ds_read_b128 v[104:107],v9 offset:4608
ds_read_b128 v[108:111],v9 offset:4624
s_add_u32 s61,s61,146800640
s_add_u32 s62,s61,4096
s_waitcnt lgkmcnt(0)
v_fma_f32 v128,v128,v96,v112
v_fma_f32 v129,v129,v97,v113
v_fma_f32 v130,v130,v98,v114
v_fma_f32 v131,v131,v99,v115
v_fma_f32 v132,v132,v100,v116
v_fma_f32 v133,v133,v101,v117
v_fma_f32 v134,v134,v102,v118
v_fma_f32 v135,v135,v103,v119
v_fma_f32 v136,v136,v104,v120
v_fma_f32 v137,v137,v105,v121
v_fma_f32 v138,v138,v106,v122
v_fma_f32 v139,v139,v107,v123
v_fma_f32 v140,v140,v108,v124
v_fma_f32 v141,v141,v109,v125
v_fma_f32 v142,v142,v110,v126
v_fma_f32 v143,v143,v111,v127
v_cvt_pk_bf16_f32 v48,v128,v129
v_cvt_pk_bf16_f32 v49,v130,v131
v_cvt_pk_bf16_f32 v50,v132,v133
v_cvt_pk_bf16_f32 v51,v134,v135
v_cvt_pk_bf16_f32 v52,v136,v137
v_cvt_pk_bf16_f32 v53,v138,v139
v_cvt_pk_bf16_f32 v54,v140,v141
v_cvt_pk_bf16_f32 v55,v142,v143
buffer_store_dwordx4 v[48:51],v10,s[20:23],s61 offen offset:0 sc1
buffer_store_dwordx4 v[52:55],v10,s[20:23],s62 offen offset:0 sc1
v_fma_f32 v144,v144,v96,v112
v_fma_f32 v145,v145,v97,v113
v_fma_f32 v146,v146,v98,v114
v_fma_f32 v147,v147,v99,v115
v_fma_f32 v148,v148,v100,v116
v_fma_f32 v149,v149,v101,v117
v_fma_f32 v150,v150,v102,v118
v_fma_f32 v151,v151,v103,v119
v_fma_f32 v152,v152,v104,v120
v_fma_f32 v153,v153,v105,v121
v_fma_f32 v154,v154,v106,v122
v_fma_f32 v155,v155,v107,v123
v_fma_f32 v156,v156,v108,v124
v_fma_f32 v157,v157,v109,v125
v_fma_f32 v158,v158,v110,v126
v_fma_f32 v159,v159,v111,v127
v_cvt_pk_bf16_f32 v56,v144,v145
v_cvt_pk_bf16_f32 v57,v146,v147
v_cvt_pk_bf16_f32 v58,v148,v149
v_cvt_pk_bf16_f32 v59,v150,v151
v_cvt_pk_bf16_f32 v60,v152,v153
v_cvt_pk_bf16_f32 v61,v154,v155
v_cvt_pk_bf16_f32 v62,v156,v157
v_cvt_pk_bf16_f32 v63,v158,v159
buffer_store_dwordx4 v[56:59],v10,s[20:23],s61 offen offset:64 sc1
buffer_store_dwordx4 v[60:63],v10,s[20:23],s62 offen offset:64 sc1
v_fma_f32 v160,v160,v96,v112
v_fma_f32 v161,v161,v97,v113
v_fma_f32 v162,v162,v98,v114
v_fma_f32 v163,v163,v99,v115
v_fma_f32 v164,v164,v100,v116
v_fma_f32 v165,v165,v101,v117
v_fma_f32 v166,v166,v102,v118
v_fma_f32 v167,v167,v103,v119
v_fma_f32 v168,v168,v104,v120
v_fma_f32 v169,v169,v105,v121
v_fma_f32 v170,v170,v106,v122
v_fma_f32 v171,v171,v107,v123
v_fma_f32 v172,v172,v108,v124
v_fma_f32 v173,v173,v109,v125
v_fma_f32 v174,v174,v110,v126
v_fma_f32 v175,v175,v111,v127
v_cvt_pk_bf16_f32 v64,v160,v161
v_cvt_pk_bf16_f32 v65,v162,v163
v_cvt_pk_bf16_f32 v66,v164,v165
v_cvt_pk_bf16_f32 v67,v166,v167
v_cvt_pk_bf16_f32 v68,v168,v169
v_cvt_pk_bf16_f32 v69,v170,v171
v_cvt_pk_bf16_f32 v70,v172,v173
v_cvt_pk_bf16_f32 v71,v174,v175
buffer_store_dwordx4 v[64:67],v10,s[20:23],s61 offen offset:128 sc1
buffer_store_dwordx4 v[68:71],v10,s[20:23],s62 offen offset:128 sc1
v_fma_f32 v176,v176,v96,v112
v_fma_f32 v177,v177,v97,v113
v_fma_f32 v178,v178,v98,v114
v_fma_f32 v179,v179,v99,v115
v_fma_f32 v180,v180,v100,v116
v_fma_f32 v181,v181,v101,v117
v_fma_f32 v182,v182,v102,v118
v_fma_f32 v183,v183,v103,v119
v_fma_f32 v184,v184,v104,v120
v_fma_f32 v185,v185,v105,v121
v_fma_f32 v186,v186,v106,v122
v_fma_f32 v187,v187,v107,v123
v_fma_f32 v188,v188,v108,v124
v_fma_f32 v189,v189,v109,v125
v_fma_f32 v190,v190,v110,v126
v_fma_f32 v191,v191,v111,v127
v_cvt_pk_bf16_f32 v72,v176,v177
v_cvt_pk_bf16_f32 v73,v178,v179
v_cvt_pk_bf16_f32 v74,v180,v181
v_cvt_pk_bf16_f32 v75,v182,v183
v_cvt_pk_bf16_f32 v76,v184,v185
v_cvt_pk_bf16_f32 v77,v186,v187
v_cvt_pk_bf16_f32 v78,v188,v189
v_cvt_pk_bf16_f32 v79,v190,v191
buffer_store_dwordx4 v[72:75],v10,s[20:23],s61 offen offset:192 sc1
buffer_store_dwordx4 v[76:79],v10,s[20:23],s62 offen offset:192 sc1
s_waitcnt vmcnt(0)
s_barrier
s_cmp_lg_u32 s50,0
s_cbranch_scc1 sig_35
s_mov_b32 s92,s2
s_and_b32 s93,s3,0xffff
s_mov_b32 s94,0x100
s_mov_b32 s95,0x20000
s_add_u32 s64,s88,16
v_mov_b32 v16,1
s_mov_b64 exec,1
buffer_atomic_add v16,off,s[92:95],s64 sc1
s_mov_b64 exec,-1
sig_35:
fl_disp:
s_sub_u32 s59,s58,248
s_cbranch_scc1 nx_36
s_branch fl_w2
nx_36:
s_sub_u32 s59,s58,240
s_cbranch_scc1 nx_37
s_branch fl_w1
nx_37:
s_sub_u32 s59,s58,224
s_cbranch_scc1 nx_38
s_branch fl_att
nx_38:
s_sub_u32 s59,s58,220
s_cbranch_scc1 nx_39
s_branch fl_ln2
nx_39:
s_sub_u32 s59,s58,192
s_cbranch_scc1 nx_40
s_branch fl_w3
nx_40:
s_sub_u32 s59,s58,160
s_cbranch_scc1 nx_41
s_branch fl_w4
nx_41:
s_sub_u32 s59,s58,128
s_branch fl_wo
fl_fb:
s_mov_b32 s92,s2
s_and_b32 s93,s3,0xffff
s_mov_b32 s94,0x100
s_mov_b32 s95,0x20000
s_waitcnt vmcnt(0) lgkmcnt(0)
s_barrier
v_mov_b32 v4,0
s_cmp_lg_u32 s50,0
s_cbranch_scc1 norole_2
s_mov_b64 exec,1
v_mov_b32 v3,1
s_lshl_b32 s52,s51,2
s_add_u32 s52,s52,128
buffer_atomic_add v3,off,s[92:95],s52 sc0 sc1
s_waitcnt vmcnt(0)
ds_write_b32 v4,v3
s_waitcnt lgkmcnt(0)
s_mov_b64 exec,-1
norole_2:
s_barrier
ds_read_b32 v3,v4
v_mbcnt_lo_u32_b32 v16,-1,0
v_and_b32 v16,7,v16
v_lshlrev_b32 v16,2,v16
s_waitcnt lgkmcnt(0)
v_readfirstlane_b32 s49,v3
s_barrier
tp_42:
buffer_load_dword v17,v16,s[92:95],0 offen offset:128 sc1
s_waitcnt vmcnt(0)
v_readlane_b32 s72,v17,0
v_readlane_b32 s73,v17,1
v_readlane_b32 s74,v17,2
v_readlane_b32 s75,v17,3
v_readlane_b32 s76,v17,4
v_readlane_b32 s77,v17,5
v_readlane_b32 s78,v17,6
v_readlane_b32 s79,v17,7
s_add_u32 s65,s72,s73
s_add_u32 s65,s65,s74
s_add_u32 s65,s65,s75
s_add_u32 s65,s65,s76
s_add_u32 s65,s65,s77
s_add_u32 s65,s65,s78
s_add_u32 s65,s65,s79
s_cmp_ge_u32 s65,256
s_cbranch_scc1 tg_43
s_sleep 4
s_sub_u32 s90,s90,1
s_cmp_gt_i32 s90,0
s_cbranch_scc1 tp_42
tg_43:
s_min_u32 s65,s72,s73
s_min_u32 s65,s65,s74
s_min_u32 s65,s65,s75
s_min_u32 s65,s65,s76
s_min_u32 s65,s65,s77
s_min_u32 s65,s65,s78
s_min_u32 s65,s65,s79
s_mov_b32 s88,192
s_cmp_lt_u32 s65,32
s_cbranch_scc1 tsl_44
s_lshl_b32 s64,s51,2
s_lshr_b32 s64,0x76325410,s64
s_and_b32 s64,s64,7
s_lshl_b32 s58,s64,5
s_add_u32 s58,s58,s49
s_mov_b32 s56,0
s_branch fl_disp0
tsl_44:
s_mov_b32 s58,s49
s_cmp_gt_u32 s51,0
s_cselect_b32 s65,s72,0
s_add_u32 s58,s58,s65
s_cmp_gt_u32 s51,1
s_cselect_b32 s65,s73,0
s_add_u32 s58,s58,s65
s_cmp_gt_u32 s51,2
s_cselect_b32 s65,s74,0
s_add_u32 s58,s58,s65
s_cmp_gt_u32 s51,3
s_cselect_b32 s65,s75,0
s_add_u32 s58,s58,s65
s_cmp_gt_u32 s51,4
s_cselect_b32 s65,s76,0
s_add_u32 s58,s58,s65
s_cmp_gt_u32 s51,5
s_cselect_b32 s65,s77,0
s_add_u32 s58,s58,s65
s_cmp_gt_u32 s51,6
s_cselect_b32 s65,s78,0
s_add_u32 s58,s58,s65
s_mov_b32 s56,1
s_cmp_lt_u32 s58,256
s_cbranch_scc1 fl_disp0
done_1:
s_endpgm
fl_qkv:
v_and_b32 v21,15,v1
v_lshrrev_b32 v22,4,v1
v_lshrrev_b32 v23,2,v21
v_and_b32 v24,3,v21
s_lshl_b32 s61,s50,15
v_lshl_add_u32 v25,v22,3,v23
s_load_dwordx4 s[4:7],s[0:1],16
s_load_dwordx2 s[8:9],s[0:1],32
s_lshl_b32 s52,s59,7
s_and_b32 s64,s50,1
s_lshl_b32 s65,s64,6
s_add_u32 s53,s52,s65
s_lshr_b32 s65,s50,1
s_lshl_b32 s65,s65,6
s_add_u32 s52,s52,s65
s_lshl_b32 s54,s64,3
s_waitcnt lgkmcnt(0)
s_cmp_gt_u32 s50,1
s_cselect_b64 s[10:11],s[4:5],s[6:7]
s_mov_b32 s28,s10
s_and_b32 s29,s11,0xffff
s_mov_b32 s30,0x800000
s_mov_b32 s31,0x20000
s_mov_b32 s32,s8
s_and_b32 s33,s9,0xffff
s_mov_b32 s34,0x800000
s_mov_b32 s35,0x20000
s_and_b32 s64,s59,7
s_cmp_eq_u32 s64,3
s_cselect_b32 s65,0,0x0f
s_sub_u32 s66,s59,56
s_cmp_lt_u32 s66,7
s_cselect_b32 s66,0xf0,0
s_or_b32 vcc_lo,s65,s66
s_mov_b32 vcc_hi,0
v_and_b32 v28,3,v1
v_lshlrev_b32 v28,13,v28
v_and_b32 v29,4,v1
v_lshl_add_u32 v28,v29,7,v28
v_cndmask_b32 v28,-1,v28,vcc
s_andn2_b32 s65,s59,7
s_lshl_b32 s65,s65,7
s_add_u32 s65,s65,384
s_lshl_b32 s55,s64,16
s_add_u32 s55,s55,s65
s_and_b32 s66,s50,1
s_lshl_b32 s66,s66,15
s_add_u32 s55,s55,s66
s_lshl_b32 s66,s64,17
s_add_u32 s66,s66,s65
s_lshl_b32 s65,s50,15
s_add_u32 s66,s66,s65
v_lshrrev_b32 v26,2,v1
v_and_b32 v27,3,v1
v_mul_u32_u24 v16,8192,v26
v_lshl_add_u32 v16,v27,4,v16
v_lshlrev_b32 v17,6,v25
v_lshl_add_u32 v17,v24,4,v17
v_add_u32 v17,s61,v17
s_add_u32 s64,s55,1048576
buffer_load_dword v29,v28,s[28:31],s64 offen
s_add_u32 s64,s55,1572864
buffer_load_dword v29,v28,s[28:31],s64 offen
s_add_u32 s62,s53,0
s_add_u32 m0,s61,0
s_nop 0
buffer_load_dwordx4 v16,s[28:31],s62 offen lds
s_add_u32 s62,s62,131072
s_add_u32 m0,m0,1024
s_waitcnt vmcnt(10)
buffer_load_dwordx4 v16,s[28:31],s62 offen lds
s_add_u32 s62,s62,131072
s_add_u32 m0,m0,1024
s_add_u32 s64,s66,0
buffer_load_dword v29,v28,s[32:35],s64 offen
s_waitcnt vmcnt(10)
buffer_load_dwordx4 v16,s[28:31],s62 offen lds
s_add_u32 s62,s62,131072
s_add_u32 m0,m0,1024
s_waitcnt vmcnt(10)
buffer_load_dwordx4 v16,s[28:31],s62 offen lds
s_add_u32 s62,s62,131072
s_add_u32 m0,m0,1024
s_waitcnt vmcnt(10)
buffer_load_dwordx4 v16,s[28:31],s62 offen lds
s_add_u32 s62,s62,131072
s_add_u32 m0,m0,1024
s_waitcnt vmcnt(10)
buffer_load_dwordx4 v16,s[28:31],s62 offen lds
s_add_u32 s62,s62,131072
s_add_u32 m0,m0,1024
s_waitcnt vmcnt(10)
buffer_load_dwordx4 v16,s[28:31],s62 offen lds
s_add_u32 s62,s62,131072
s_add_u32 m0,m0,1024
s_waitcnt vmcnt(10)
buffer_load_dwordx4 v16,s[28:31],s62 offen lds
s_add_u32 s62,s62,131072
s_add_u32 m0,m0,1024
s_waitcnt vmcnt(10)
buffer_load_dwordx4 v16,s[28:31],s62 offen lds
s_add_u32 s62,s62,131072
s_add_u32 m0,m0,1024
s_waitcnt vmcnt(10)
buffer_load_dwordx4 v16,s[28:31],s62 offen lds
s_add_u32 s62,s62,131072
s_add_u32 m0,m0,1024
s_add_u32 s64,s66,1048576
buffer_load_dword v29,v28,s[32:35],s64 offen
s_waitcnt vmcnt(10)
buffer_load_dwordx4 v16,s[28:31],s62 offen lds
s_add_u32 s62,s62,131072
s_add_u32 m0,m0,1024
s_waitcnt vmcnt(10)
buffer_load_dwordx4 v16,s[28:31],s62 offen lds
s_add_u32 s62,s62,131072
s_add_u32 m0,m0,1024
s_waitcnt vmcnt(10)
buffer_load_dwordx4 v16,s[28:31],s62 offen lds
s_add_u32 s62,s62,131072
s_add_u32 m0,m0,1024
s_waitcnt vmcnt(10)
buffer_load_dwordx4 v16,s[28:31],s62 offen lds
s_add_u32 s62,s62,131072
s_add_u32 m0,m0,1024
s_waitcnt vmcnt(10)
buffer_load_dwordx4 v16,s[28:31],s62 offen lds
s_add_u32 s62,s62,131072
s_add_u32 m0,m0,1024
s_waitcnt vmcnt(10)
buffer_load_dwordx4 v16,s[28:31],s62 offen lds
s_waitcnt vmcnt(10)
s_add_u32 s62,s52,0
s_add_u32 m0,s61,16384
s_nop 0
buffer_load_dwordx4 v16,s[32:35],s62 offen lds
s_add_u32 s62,s62,131072
s_add_u32 m0,m0,1024
s_waitcnt vmcnt(10)
buffer_load_dwordx4 v16,s[32:35],s62 offen lds
s_add_u32 s62,s62,131072
s_add_u32 m0,m0,1024
s_add_u32 s64,s55,2097152
buffer_load_dword v29,v28,s[28:31],s64 offen
s_waitcnt vmcnt(10)
buffer_load_dwordx4 v16,s[32:35],s62 offen lds
s_add_u32 s62,s62,131072
s_add_u32 m0,m0,1024
s_waitcnt vmcnt(10)
buffer_load_dwordx4 v16,s[32:35],s62 offen lds
s_add_u32 s62,s62,131072
s_add_u32 m0,m0,1024
s_waitcnt vmcnt(10)
buffer_load_dwordx4 v16,s[32:35],s62 offen lds
s_add_u32 s62,s62,131072
s_add_u32 m0,m0,1024
s_waitcnt vmcnt(10)
buffer_load_dwordx4 v16,s[32:35],s62 offen lds
s_add_u32 s62,s62,131072
s_add_u32 m0,m0,1024
s_add_u32 s64,s55,2621440
buffer_load_dword v29,v28,s[28:31],s64 offen
s_waitcnt vmcnt(10)
buffer_load_dwordx4 v16,s[32:35],s62 offen lds
s_add_u32 s62,s62,131072
s_add_u32 m0,m0,1024
s_waitcnt vmcnt(10)
buffer_load_dwordx4 v16,s[32:35],s62 offen lds
s_add_u32 s62,s62,131072
s_add_u32 m0,m0,1024
s_waitcnt vmcnt(10)
buffer_load_dwordx4 v16,s[32:35],s62 offen lds
s_add_u32 s62,s62,131072
s_add_u32 m0,m0,1024
s_waitcnt vmcnt(10)
buffer_load_dwordx4 v16,s[32:35],s62 offen lds
s_add_u32 s62,s62,131072
s_add_u32 m0,m0,1024
s_add_u32 s64,s55,3145728
buffer_load_dword v29,v28,s[28:31],s64 offen
s_waitcnt vmcnt(10)
buffer_load_dwordx4 v16,s[32:35],s62 offen lds
s_add_u32 s62,s62,131072
s_add_u32 m0,m0,1024
s_waitcnt vmcnt(10)
buffer_load_dwordx4 v16,s[32:35],s62 offen lds
s_add_u32 s62,s62,131072
s_add_u32 m0,m0,1024
s_waitcnt vmcnt(10)
buffer_load_dwordx4 v16,s[32:35],s62 offen lds
s_add_u32 s62,s62,131072
s_add_u32 m0,m0,1024
s_waitcnt vmcnt(10)
buffer_load_dwordx4 v16,s[32:35],s62 offen lds
s_add_u32 s62,s62,131072
s_add_u32 m0,m0,1024
s_add_u32 s64,s55,3670016
buffer_load_dword v29,v28,s[28:31],s64 offen
s_waitcnt vmcnt(10)
buffer_load_dwordx4 v16,s[32:35],s62 offen lds
s_add_u32 s62,s62,131072
s_add_u32 m0,m0,1024
s_waitcnt vmcnt(10)
buffer_load_dwordx4 v16,s[32:35],s62 offen lds
s_waitcnt vmcnt(10)
s_waitcnt vmcnt(20)
ds_read_b64_tr_b16 a[0:1],v17 offset:0
ds_read_b64_tr_b16 a[2:3],v17 offset:256
ds_read_b64_tr_b16 a[4:5],v17 offset:8
ds_read_b64_tr_b16 a[6:7],v17 offset:264
ds_read_b64_tr_b16 a[12:13],v17 offset:2048
ds_read_b64_tr_b16 a[14:15],v17 offset:2304
ds_read_b64_tr_b16 a[16:17],v17 offset:2056
ds_read_b64_tr_b16 a[18:19],v17 offset:2312
ds_read_b64_tr_b16 a[24:25],v17 offset:4096
ds_read_b64_tr_b16 a[26:27],v17 offset:4352
ds_read_b64_tr_b16 a[28:29],v17 offset:4104
ds_read_b64_tr_b16 a[30:31],v17 offset:4360
s_waitcnt lgkmcnt(0)
ds_read_b64_tr_b16 a[36:37],v17 offset:6144
ds_read_b64_tr_b16 a[38:39],v17 offset:6400
ds_read_b64_tr_b16 a[40:41],v17 offset:6152
ds_read_b64_tr_b16 a[42:43],v17 offset:6408
ds_read_b64_tr_b16 a[48:49],v17 offset:8192
ds_read_b64_tr_b16 a[50:51],v17 offset:8448
ds_read_b64_tr_b16 a[52:53],v17 offset:8200
ds_read_b64_tr_b16 a[54:55],v17 offset:8456
ds_read_b64_tr_b16 a[60:61],v17 offset:10240
ds_read_b64_tr_b16 a[62:63],v17 offset:10496
ds_read_b64_tr_b16 a[64:65],v17 offset:10248
ds_read_b64_tr_b16 a[66:67],v17 offset:10504
s_waitcnt lgkmcnt(0)
ds_read_b64_tr_b16 a[72:73],v17 offset:12288
ds_read_b64_tr_b16 a[74:75],v17 offset:12544
ds_read_b64_tr_b16 a[76:77],v17 offset:12296
ds_read_b64_tr_b16 a[78:79],v17 offset:12552
ds_read_b64_tr_b16 a[84:85],v17 offset:14336
ds_read_b64_tr_b16 a[86:87],v17 offset:14592
ds_read_b64_tr_b16 a[88:89],v17 offset:14344
ds_read_b64_tr_b16 a[90:91],v17 offset:14600
s_waitcnt lgkmcnt(0)
s_add_u32 s62,s53,2097152
s_add_u32 m0,s61,0
s_nop 0
buffer_load_dwordx4 v16,s[28:31],s62 offen lds
s_add_u32 s62,s62,131072
s_add_u32 m0,m0,1024
s_waitcnt vmcnt(10)
buffer_load_dwordx4 v16,s[28:31],s62 offen lds
s_add_u32 s62,s62,131072
s_add_u32 m0,m0,1024
s_add_u32 s64,s66,2097152
buffer_load_dword v29,v28,s[32:35],s64 offen
s_waitcnt vmcnt(10)
buffer_load_dwordx4 v16,s[28:31],s62 offen lds
s_add_u32 s62,s62,131072
s_add_u32 m0,m0,1024
s_waitcnt vmcnt(10)
buffer_load_dwordx4 v16,s[28:31],s62 offen lds
s_add_u32 s62,s62,131072
s_add_u32 m0,m0,1024
s_waitcnt vmcnt(10)
buffer_load_dwordx4 v16,s[28:31],s62 offen lds
s_add_u32 s62,s62,131072
s_add_u32 m0,m0,1024
s_waitcnt vmcnt(10)
buffer_load_dwordx4 v16,s[28:31],s62 offen lds
s_add_u32 s62,s62,131072
s_add_u32 m0,m0,1024
s_waitcnt vmcnt(10)
buffer_load_dwordx4 v16,s[28:31],s62 offen lds
s_add_u32 s62,s62,131072
s_add_u32 m0,m0,1024
s_waitcnt vmcnt(10)
buffer_load_dwordx4 v16,s[28:31],s62 offen lds
s_add_u32 s62,s62,131072
s_add_u32 m0,m0,1024
s_waitcnt vmcnt(10)
buffer_load_dwordx4 v16,s[28:31],s62 offen lds
s_add_u32 s62,s62,131072
s_add_u32 m0,m0,1024
s_waitcnt vmcnt(10)
buffer_load_dwordx4 v16,s[28:31],s62 offen lds
s_add_u32 s62,s62,131072
s_add_u32 m0,m0,1024
s_add_u32 s64,s66,3145728
buffer_load_dword v29,v28,s[32:35],s64 offen
s_waitcnt vmcnt(10)
buffer_load_dwordx4 v16,s[28:31],s62 offen lds
s_add_u32 s62,s62,131072
s_add_u32 m0,m0,1024
s_waitcnt vmcnt(10)
buffer_load_dwordx4 v16,s[28:31],s62 offen lds
s_add_u32 s62,s62,131072
s_add_u32 m0,m0,1024
s_waitcnt vmcnt(10)
buffer_load_dwordx4 v16,s[28:31],s62 offen lds
s_add_u32 s62,s62,131072
s_add_u32 m0,m0,1024
s_waitcnt vmcnt(10)
buffer_load_dwordx4 v16,s[28:31],s62 offen lds
s_add_u32 s62,s62,131072
s_add_u32 m0,m0,1024
s_waitcnt vmcnt(10)
buffer_load_dwordx4 v16,s[28:31],s62 offen lds
s_add_u32 s62,s62,131072
s_add_u32 m0,m0,1024
s_waitcnt vmcnt(10)
buffer_load_dwordx4 v16,s[28:31],s62 offen lds
s_waitcnt vmcnt(10)
s_waitcnt vmcnt(18)
v_add_u32 v18,s54,v17
ds_read_b64_tr_b16 a[8:9],v18 offset:16384
ds_read_b64_tr_b16 a[10:11],v18 offset:16640
ds_read_b64_tr_b16 a[20:21],v18 offset:18432
ds_read_b64_tr_b16 a[22:23],v18 offset:18688
ds_read_b64_tr_b16 a[32:33],v18 offset:20480
ds_read_b64_tr_b16 a[34:35],v18 offset:20736
ds_read_b64_tr_b16 a[44:45],v18 offset:22528
ds_read_b64_tr_b16 a[46:47],v18 offset:22784
ds_read_b64_tr_b16 a[56:57],v18 offset:24576
ds_read_b64_tr_b16 a[58:59],v18 offset:24832
ds_read_b64_tr_b16 a[68:69],v18 offset:26624
ds_read_b64_tr_b16 a[70:71],v18 offset:26880
s_waitcnt lgkmcnt(0)
ds_read_b64_tr_b16 a[80:81],v18 offset:28672
ds_read_b64_tr_b16 a[82:83],v18 offset:28928
ds_read_b64_tr_b16 a[92:93],v18 offset:30720
ds_read_b64_tr_b16 a[94:95],v18 offset:30976
s_waitcnt lgkmcnt(0)
s_add_u32 s62,s52,2097152
s_add_u32 m0,s61,16384
s_nop 0
buffer_load_dwordx4 v16,s[32:35],s62 offen lds
s_add_u32 s62,s62,131072
s_add_u32 m0,m0,1024
s_waitcnt vmcnt(10)
buffer_load_dwordx4 v16,s[32:35],s62 offen lds
s_add_u32 s62,s62,131072
s_add_u32 m0,m0,1024
s_add_u32 s64,s55,4194304
buffer_load_dword v29,v28,s[28:31],s64 offen
s_waitcnt vmcnt(10)
buffer_load_dwordx4 v16,s[32:35],s62 offen lds
s_add_u32 s62,s62,131072
s_add_u32 m0,m0,1024
s_waitcnt vmcnt(10)
buffer_load_dwordx4 v16,s[32:35],s62 offen lds
s_add_u32 s62,s62,131072
s_add_u32 m0,m0,1024
s_waitcnt vmcnt(10)
buffer_load_dwordx4 v16,s[32:35],s62 offen lds
s_add_u32 s62,s62,131072
s_add_u32 m0,m0,1024
s_waitcnt vmcnt(10)
buffer_load_dwordx4 v16,s[32:35],s62 offen lds
s_add_u32 s62,s62,131072
s_add_u32 m0,m0,1024
s_add_u32 s64,s55,4718592
buffer_load_dword v29,v28,s[28:31],s64 offen
s_waitcnt vmcnt(10)
buffer_load_dwordx4 v16,s[32:35],s62 offen lds
s_add_u32 s62,s62,131072
s_add_u32 m0,m0,1024
s_waitcnt vmcnt(10)
buffer_load_dwordx4 v16,s[32:35],s62 offen lds
s_add_u32 s62,s62,131072
s_add_u32 m0,m0,1024
s_waitcnt vmcnt(10)
buffer_load_dwordx4 v16,s[32:35],s62 offen lds
s_add_u32 s62,s62,131072
s_add_u32 m0,m0,1024
s_waitcnt vmcnt(10)
buffer_load_dwordx4 v16,s[32:35],s62 offen lds
s_add_u32 s62,s62,131072
s_add_u32 m0,m0,1024
s_add_u32 s64,s55,5242880
buffer_load_dword v29,v28,s[28:31],s64 offen
s_waitcnt vmcnt(10)
buffer_load_dwordx4 v16,s[32:35],s62 offen lds
s_add_u32 s62,s62,131072
s_add_u32 m0,m0,1024
s_waitcnt vmcnt(10)
buffer_load_dwordx4 v16,s[32:35],s62 offen lds
s_add_u32 s62,s62,131072
s_add_u32 m0,m0,1024
s_waitcnt vmcnt(10)
buffer_load_dwordx4 v16,s[32:35],s62 offen lds
s_add_u32 s62,s62,131072
s_add_u32 m0,m0,1024
s_waitcnt vmcnt(10)
buffer_load_dwordx4 v16,s[32:35],s62 offen lds
s_add_u32 s62,s62,131072
s_add_u32 m0,m0,1024
s_add_u32 s64,s55,5767168
buffer_load_dword v29,v28,s[28:31],s64 offen
s_waitcnt vmcnt(10)
buffer_load_dwordx4 v16,s[32:35],s62 offen lds
s_add_u32 s62,s62,131072
s_add_u32 m0,m0,1024
s_waitcnt vmcnt(10)
buffer_load_dwordx4 v16,s[32:35],s62 offen lds
s_waitcnt vmcnt(10)
s_waitcnt vmcnt(20)
ds_read_b64_tr_b16 a[96:97],v17 offset:0
ds_read_b64_tr_b16 a[98:99],v17 offset:256
ds_read_b64_tr_b16 a[100:101],v17 offset:8
ds_read_b64_tr_b16 a[102:103],v17 offset:264
ds_read_b64_tr_b16 a[108:109],v17 offset:2048
ds_read_b64_tr_b16 a[110:111],v17 offset:2304
ds_read_b64_tr_b16 a[112:113],v17 offset:2056
ds_read_b64_tr_b16 a[114:115],v17 offset:2312
ds_read_b64_tr_b16 a[120:121],v17 offset:4096
ds_read_b64_tr_b16 a[122:123],v17 offset:4352
ds_read_b64_tr_b16 a[124:125],v17 offset:4104
ds_read_b64_tr_b16 a[126:127],v17 offset:4360
s_waitcnt lgkmcnt(0)
ds_read_b64_tr_b16 a[132:133],v17 offset:6144
ds_read_b64_tr_b16 a[134:135],v17 offset:6400
ds_read_b64_tr_b16 a[136:137],v17 offset:6152
ds_read_b64_tr_b16 a[138:139],v17 offset:6408
ds_read_b64_tr_b16 a[144:145],v17 offset:8192
ds_read_b64_tr_b16 a[146:147],v17 offset:8448
ds_read_b64_tr_b16 a[148:149],v17 offset:8200
ds_read_b64_tr_b16 a[150:151],v17 offset:8456
ds_read_b64_tr_b16 a[156:157],v17 offset:10240
ds_read_b64_tr_b16 a[158:159],v17 offset:10496
ds_read_b64_tr_b16 a[160:161],v17 offset:10248
ds_read_b64_tr_b16 a[162:163],v17 offset:10504
s_waitcnt lgkmcnt(0)
ds_read_b64_tr_b16 a[168:169],v17 offset:12288
ds_read_b64_tr_b16 a[170:171],v17 offset:12544
ds_read_b64_tr_b16 a[172:173],v17 offset:12296
ds_read_b64_tr_b16 a[174:175],v17 offset:12552
ds_read_b64_tr_b16 a[180:181],v17 offset:14336
ds_read_b64_tr_b16 a[182:183],v17 offset:14592
ds_read_b64_tr_b16 a[184:185],v17 offset:14344
ds_read_b64_tr_b16 a[186:187],v17 offset:14600
s_waitcnt lgkmcnt(0)
s_add_u32 s62,s53,4194304
s_add_u32 m0,s61,0
s_nop 0
buffer_load_dwordx4 v16,s[28:31],s62 offen lds
s_add_u32 s62,s62,131072
s_add_u32 m0,m0,1024
s_waitcnt vmcnt(10)
buffer_load_dwordx4 v16,s[28:31],s62 offen lds
s_add_u32 s62,s62,131072
s_add_u32 m0,m0,1024
s_add_u32 s64,s66,4194304
buffer_load_dword v29,v28,s[32:35],s64 offen
s_waitcnt vmcnt(10)
buffer_load_dwordx4 v16,s[28:31],s62 offen lds
s_add_u32 s62,s62,131072
s_add_u32 m0,m0,1024
s_waitcnt vmcnt(10)
buffer_load_dwordx4 v16,s[28:31],s62 offen lds
s_add_u32 s62,s62,131072
s_add_u32 m0,m0,1024
s_waitcnt vmcnt(10)
buffer_load_dwordx4 v16,s[28:31],s62 offen lds
s_add_u32 s62,s62,131072
s_add_u32 m0,m0,1024
s_waitcnt vmcnt(10)
buffer_load_dwordx4 v16,s[28:31],s62 offen lds
s_add_u32 s62,s62,131072
s_add_u32 m0,m0,1024
s_waitcnt vmcnt(10)
buffer_load_dwordx4 v16,s[28:31],s62 offen lds
s_add_u32 s62,s62,131072
s_add_u32 m0,m0,1024
s_waitcnt vmcnt(10)
buffer_load_dwordx4 v16,s[28:31],s62 offen lds
s_add_u32 s62,s62,131072
s_add_u32 m0,m0,1024
s_waitcnt vmcnt(10)
buffer_load_dwordx4 v16,s[28:31],s62 offen lds
s_add_u32 s62,s62,131072
s_add_u32 m0,m0,1024
s_waitcnt vmcnt(10)
buffer_load_dwordx4 v16,s[28:31],s62 offen lds
s_add_u32 s62,s62,131072
s_add_u32 m0,m0,1024
s_add_u32 s64,s66,5242880
buffer_load_dword v29,v28,s[32:35],s64 offen
s_waitcnt vmcnt(10)
buffer_load_dwordx4 v16,s[28:31],s62 offen lds
s_add_u32 s62,s62,131072
s_add_u32 m0,m0,1024
s_waitcnt vmcnt(10)
buffer_load_dwordx4 v16,s[28:31],s62 offen lds
s_add_u32 s62,s62,131072
s_add_u32 m0,m0,1024
s_waitcnt vmcnt(10)
buffer_load_dwordx4 v16,s[28:31],s62 offen lds
s_add_u32 s62,s62,131072
s_add_u32 m0,m0,1024
s_waitcnt vmcnt(10)
buffer_load_dwordx4 v16,s[28:31],s62 offen lds
s_add_u32 s62,s62,131072
s_add_u32 m0,m0,1024
s_waitcnt vmcnt(10)
buffer_load_dwordx4 v16,s[28:31],s62 offen lds
s_add_u32 s62,s62,131072
s_add_u32 m0,m0,1024
s_waitcnt vmcnt(10)
buffer_load_dwordx4 v16,s[28:31],s62 offen lds
s_waitcnt vmcnt(10)
s_waitcnt vmcnt(18)
ds_read_b64_tr_b16 a[104:105],v18 offset:16384
ds_read_b64_tr_b16 a[106:107],v18 offset:16640
ds_read_b64_tr_b16 a[116:117],v18 offset:18432
ds_read_b64_tr_b16 a[118:119],v18 offset:18688
ds_read_b64_tr_b16 a[128:129],v18 offset:20480
ds_read_b64_tr_b16 a[130:131],v18 offset:20736
ds_read_b64_tr_b16 a[140:141],v18 offset:22528
ds_read_b64_tr_b16 a[142:143],v18 offset:22784
ds_read_b64_tr_b16 a[152:153],v18 offset:24576
ds_read_b64_tr_b16 a[154:155],v18 offset:24832
ds_read_b64_tr_b16 a[164:165],v18 offset:26624
ds_read_b64_tr_b16 a[166:167],v18 offset:26880
s_waitcnt lgkmcnt(0)
ds_read_b64_tr_b16 a[176:177],v18 offset:28672
ds_read_b64_tr_b16 a[178:179],v18 offset:28928
ds_read_b64_tr_b16 a[188:189],v18 offset:30720
ds_read_b64_tr_b16 a[190:191],v18 offset:30976
s_waitcnt lgkmcnt(0)
s_add_u32 s62,s52,4194304
s_add_u32 m0,s61,16384
s_nop 0
buffer_load_dwordx4 v16,s[32:35],s62 offen lds
s_add_u32 s62,s62,131072
s_add_u32 m0,m0,1024
s_waitcnt vmcnt(10)
buffer_load_dwordx4 v16,s[32:35],s62 offen lds
s_add_u32 s62,s62,131072
s_add_u32 m0,m0,1024
s_add_u32 s64,s55,6291456
buffer_load_dword v29,v28,s[28:31],s64 offen
s_waitcnt vmcnt(10)
buffer_load_dwordx4 v16,s[32:35],s62 offen lds
s_add_u32 s62,s62,131072
s_add_u32 m0,m0,1024
s_waitcnt vmcnt(10)
buffer_load_dwordx4 v16,s[32:35],s62 offen lds
s_add_u32 s62,s62,131072
s_add_u32 m0,m0,1024
s_waitcnt vmcnt(10)
buffer_load_dwordx4 v16,s[32:35],s62 offen lds
s_add_u32 s62,s62,131072
s_add_u32 m0,m0,1024
s_waitcnt vmcnt(10)
buffer_load_dwordx4 v16,s[32:35],s62 offen lds
s_add_u32 s62,s62,131072
s_add_u32 m0,m0,1024
s_add_u32 s64,s55,6815744
buffer_load_dword v29,v28,s[28:31],s64 offen
s_waitcnt vmcnt(10)
buffer_load_dwordx4 v16,s[32:35],s62 offen lds
s_add_u32 s62,s62,131072
s_add_u32 m0,m0,1024
s_waitcnt vmcnt(10)
buffer_load_dwordx4 v16,s[32:35],s62 offen lds
s_add_u32 s62,s62,131072
s_add_u32 m0,m0,1024
s_waitcnt vmcnt(10)
buffer_load_dwordx4 v16,s[32:35],s62 offen lds
s_add_u32 s62,s62,131072
s_add_u32 m0,m0,1024
s_waitcnt vmcnt(10)
buffer_load_dwordx4 v16,s[32:35],s62 offen lds
s_add_u32 s62,s62,131072
s_add_u32 m0,m0,1024
s_add_u32 s64,s55,7340032
buffer_load_dword v29,v28,s[28:31],s64 offen
s_waitcnt vmcnt(10)
buffer_load_dwordx4 v16,s[32:35],s62 offen lds
s_add_u32 s62,s62,131072
s_add_u32 m0,m0,1024
s_waitcnt vmcnt(10)
buffer_load_dwordx4 v16,s[32:35],s62 offen lds
s_add_u32 s62,s62,131072
s_add_u32 m0,m0,1024
s_waitcnt vmcnt(10)
buffer_load_dwordx4 v16,s[32:35],s62 offen lds
s_add_u32 s62,s62,131072
s_add_u32 m0,m0,1024
s_waitcnt vmcnt(10)
buffer_load_dwordx4 v16,s[32:35],s62 offen lds
s_add_u32 s62,s62,131072
s_add_u32 m0,m0,1024
s_add_u32 s64,s55,7864320
buffer_load_dword v29,v28,s[28:31],s64 offen
s_waitcnt vmcnt(10)
buffer_load_dwordx4 v16,s[32:35],s62 offen lds
s_add_u32 s62,s62,131072
s_add_u32 m0,m0,1024
s_waitcnt vmcnt(10)
buffer_load_dwordx4 v16,s[32:35],s62 offen lds
s_waitcnt vmcnt(10)
s_waitcnt vmcnt(20)
ds_read_b64_tr_b16 a[192:193],v17 offset:0
ds_read_b64_tr_b16 a[194:195],v17 offset:256
ds_read_b64_tr_b16 a[196:197],v17 offset:8
ds_read_b64_tr_b16 a[198:199],v17 offset:264
ds_read_b64_tr_b16 a[204:205],v17 offset:2048
ds_read_b64_tr_b16 a[206:207],v17 offset:2304
ds_read_b64_tr_b16 a[208:209],v17 offset:2056
ds_read_b64_tr_b16 a[210:211],v17 offset:2312
ds_read_b64_tr_b16 a[216:217],v17 offset:4096
ds_read_b64_tr_b16 a[218:219],v17 offset:4352
ds_read_b64_tr_b16 a[220:221],v17 offset:4104
ds_read_b64_tr_b16 a[222:223],v17 offset:4360
s_waitcnt lgkmcnt(0)
ds_read_b64_tr_b16 a[228:229],v17 offset:6144
ds_read_b64_tr_b16 a[230:231],v17 offset:6400
ds_read_b64_tr_b16 a[232:233],v17 offset:6152
ds_read_b64_tr_b16 a[234:235],v17 offset:6408
ds_read_b64_tr_b16 a[240:241],v17 offset:8192
ds_read_b64_tr_b16 a[242:243],v17 offset:8448
ds_read_b64_tr_b16 a[244:245],v17 offset:8200
ds_read_b64_tr_b16 a[246:247],v17 offset:8456
ds_read_b64_tr_b16 a[252:253],v17 offset:10240
ds_read_b64_tr_b16 a[254:255],v17 offset:10496
ds_read_b64_tr_b16 v[128:129],v17 offset:10248
ds_read_b64_tr_b16 v[130:131],v17 offset:10504
s_waitcnt lgkmcnt(0)
ds_read_b64_tr_b16 v[136:137],v17 offset:12288
ds_read_b64_tr_b16 v[138:139],v17 offset:12544
ds_read_b64_tr_b16 v[140:141],v17 offset:12296
ds_read_b64_tr_b16 v[142:143],v17 offset:12552
ds_read_b64_tr_b16 v[148:149],v17 offset:14336
ds_read_b64_tr_b16 v[150:151],v17 offset:14592
ds_read_b64_tr_b16 v[152:153],v17 offset:14344
ds_read_b64_tr_b16 v[154:155],v17 offset:14600
s_waitcnt lgkmcnt(0)
s_add_u32 s62,s53,6291456
s_add_u32 m0,s61,0
s_nop 0
buffer_load_dwordx4 v16,s[28:31],s62 offen lds
s_add_u32 s62,s62,131072
s_add_u32 m0,m0,1024
s_waitcnt vmcnt(10)
buffer_load_dwordx4 v16,s[28:31],s62 offen lds
s_add_u32 s62,s62,131072
s_add_u32 m0,m0,1024
s_add_u32 s64,s66,6291456
buffer_load_dword v29,v28,s[32:35],s64 offen
s_waitcnt vmcnt(10)
buffer_load_dwordx4 v16,s[28:31],s62 offen lds
s_add_u32 s62,s62,131072
s_add_u32 m0,m0,1024
s_waitcnt vmcnt(10)
buffer_load_dwordx4 v16,s[28:31],s62 offen lds
s_add_u32 s62,s62,131072
s_add_u32 m0,m0,1024
s_waitcnt vmcnt(10)
buffer_load_dwordx4 v16,s[28:31],s62 offen lds
s_add_u32 s62,s62,131072
s_add_u32 m0,m0,1024
s_waitcnt vmcnt(10)
buffer_load_dwordx4 v16,s[28:31],s62 offen lds
s_add_u32 s62,s62,131072
s_add_u32 m0,m0,1024
s_waitcnt vmcnt(10)
buffer_load_dwordx4 v16,s[28:31],s62 offen lds
s_add_u32 s62,s62,131072
s_add_u32 m0,m0,1024
s_waitcnt vmcnt(10)
buffer_load_dwordx4 v16,s[28:31],s62 offen lds
s_add_u32 s62,s62,131072
s_add_u32 m0,m0,1024
s_waitcnt vmcnt(10)
buffer_load_dwordx4 v16,s[28:31],s62 offen lds
s_add_u32 s62,s62,131072
s_add_u32 m0,m0,1024
s_waitcnt vmcnt(10)
buffer_load_dwordx4 v16,s[28:31],s62 offen lds
s_add_u32 s62,s62,131072
s_add_u32 m0,m0,1024
s_add_u32 s64,s66,7340032
buffer_load_dword v29,v28,s[32:35],s64 offen
s_waitcnt vmcnt(10)
buffer_load_dwordx4 v16,s[28:31],s62 offen lds
s_add_u32 s62,s62,131072
s_add_u32 m0,m0,1024
s_waitcnt vmcnt(10)
buffer_load_dwordx4 v16,s[28:31],s62 offen lds
s_add_u32 s62,s62,131072
s_add_u32 m0,m0,1024
s_waitcnt vmcnt(10)
buffer_load_dwordx4 v16,s[28:31],s62 offen lds
s_add_u32 s62,s62,131072
s_add_u32 m0,m0,1024
s_waitcnt vmcnt(10)
buffer_load_dwordx4 v16,s[28:31],s62 offen lds
s_add_u32 s62,s62,131072
s_add_u32 m0,m0,1024
s_waitcnt vmcnt(10)
buffer_load_dwordx4 v16,s[28:31],s62 offen lds
s_add_u32 s62,s62,131072
s_add_u32 m0,m0,1024
s_waitcnt vmcnt(10)
buffer_load_dwordx4 v16,s[28:31],s62 offen lds
s_waitcnt vmcnt(10)
s_waitcnt vmcnt(18)
ds_read_b64_tr_b16 a[200:201],v18 offset:16384
ds_read_b64_tr_b16 a[202:203],v18 offset:16640
ds_read_b64_tr_b16 a[212:213],v18 offset:18432
ds_read_b64_tr_b16 a[214:215],v18 offset:18688
ds_read_b64_tr_b16 a[224:225],v18 offset:20480
ds_read_b64_tr_b16 a[226:227],v18 offset:20736
ds_read_b64_tr_b16 a[236:237],v18 offset:22528
ds_read_b64_tr_b16 a[238:239],v18 offset:22784
ds_read_b64_tr_b16 a[248:249],v18 offset:24576
ds_read_b64_tr_b16 a[250:251],v18 offset:24832
ds_read_b64_tr_b16 v[132:133],v18 offset:26624
ds_read_b64_tr_b16 v[134:135],v18 offset:26880
s_waitcnt lgkmcnt(0)
ds_read_b64_tr_b16 v[144:145],v18 offset:28672
ds_read_b64_tr_b16 v[146:147],v18 offset:28928
ds_read_b64_tr_b16 v[156:157],v18 offset:30720
ds_read_b64_tr_b16 v[158:159],v18 offset:30976
s_waitcnt lgkmcnt(0)
s_add_u32 s62,s52,6291456
s_add_u32 m0,s61,16384
s_nop 0
buffer_load_dwordx4 v16,s[32:35],s62 offen lds
s_add_u32 s62,s62,131072
s_add_u32 m0,m0,1024
s_waitcnt vmcnt(10)
buffer_load_dwordx4 v16,s[32:35],s62 offen lds
s_add_u32 s62,s62,131072
s_add_u32 m0,m0,1024
s_waitcnt vmcnt(10)
buffer_load_dwordx4 v16,s[32:35],s62 offen lds
s_add_u32 s62,s62,131072
s_add_u32 m0,m0,1024
s_waitcnt vmcnt(10)
buffer_load_dwordx4 v16,s[32:35],s62 offen lds
s_add_u32 s62,s62,131072
s_add_u32 m0,m0,1024
s_waitcnt vmcnt(10)
buffer_load_dwordx4 v16,s[32:35],s62 offen lds
s_add_u32 s62,s62,131072
s_add_u32 m0,m0,1024
s_waitcnt vmcnt(10)
buffer_load_dwordx4 v16,s[32:35],s62 offen lds
s_add_u32 s62,s62,131072
s_add_u32 m0,m0,1024
s_waitcnt vmcnt(10)
buffer_load_dwordx4 v16,s[32:35],s62 offen lds
s_add_u32 s62,s62,131072
s_add_u32 m0,m0,1024
s_waitcnt vmcnt(10)
buffer_load_dwordx4 v16,s[32:35],s62 offen lds
s_add_u32 s62,s62,131072
s_add_u32 m0,m0,1024
s_waitcnt vmcnt(10)
buffer_load_dwordx4 v16,s[32:35],s62 offen lds
s_add_u32 s62,s62,131072
s_add_u32 m0,m0,1024
s_waitcnt vmcnt(10)
buffer_load_dwordx4 v16,s[32:35],s62 offen lds
s_add_u32 s62,s62,131072
s_add_u32 m0,m0,1024
s_waitcnt vmcnt(10)
buffer_load_dwordx4 v16,s[32:35],s62 offen lds
s_add_u32 s62,s62,131072
s_add_u32 m0,m0,1024
s_waitcnt vmcnt(10)
buffer_load_dwordx4 v16,s[32:35],s62 offen lds
s_add_u32 s62,s62,131072
s_add_u32 m0,m0,1024
s_waitcnt vmcnt(10)
buffer_load_dwordx4 v16,s[32:35],s62 offen lds
s_add_u32 s62,s62,131072
s_add_u32 m0,m0,1024
s_waitcnt vmcnt(10)
buffer_load_dwordx4 v16,s[32:35],s62 offen lds
s_add_u32 s62,s62,131072
s_add_u32 m0,m0,1024
s_waitcnt vmcnt(10)
buffer_load_dwordx4 v16,s[32:35],s62 offen lds
s_add_u32 s62,s62,131072
s_add_u32 m0,m0,1024
s_waitcnt vmcnt(10)
buffer_load_dwordx4 v16,s[32:35],s62 offen lds
s_waitcnt vmcnt(10)
s_waitcnt vmcnt(16)
ds_read_b64_tr_b16 v[160:161],v17 offset:0
ds_read_b64_tr_b16 v[162:163],v17 offset:256
ds_read_b64_tr_b16 v[164:165],v17 offset:8
ds_read_b64_tr_b16 v[166:167],v17 offset:264
ds_read_b64_tr_b16 v[172:173],v17 offset:2048
ds_read_b64_tr_b16 v[174:175],v17 offset:2304
ds_read_b64_tr_b16 v[176:177],v17 offset:2056
ds_read_b64_tr_b16 v[178:179],v17 offset:2312
ds_read_b64_tr_b16 v[184:185],v17 offset:4096
ds_read_b64_tr_b16 v[186:187],v17 offset:4352
ds_read_b64_tr_b16 v[188:189],v17 offset:4104
ds_read_b64_tr_b16 v[190:191],v17 offset:4360
s_waitcnt lgkmcnt(0)
ds_read_b64_tr_b16 v[196:197],v17 offset:6144
ds_read_b64_tr_b16 v[198:199],v17 offset:6400
ds_read_b64_tr_b16 v[200:201],v17 offset:6152
ds_read_b64_tr_b16 v[202:203],v17 offset:6408
ds_read_b64_tr_b16 v[208:209],v17 offset:8192
ds_read_b64_tr_b16 v[210:211],v17 offset:8448
ds_read_b64_tr_b16 v[212:213],v17 offset:8200
ds_read_b64_tr_b16 v[214:215],v17 offset:8456
ds_read_b64_tr_b16 v[220:221],v17 offset:10240
ds_read_b64_tr_b16 v[222:223],v17 offset:10496
ds_read_b64_tr_b16 v[224:225],v17 offset:10248
ds_read_b64_tr_b16 v[226:227],v17 offset:10504
s_waitcnt lgkmcnt(0)
ds_read_b64_tr_b16 v[232:233],v17 offset:12288
ds_read_b64_tr_b16 v[234:235],v17 offset:12544
ds_read_b64_tr_b16 v[236:237],v17 offset:12296
ds_read_b64_tr_b16 v[238:239],v17 offset:12552
ds_read_b64_tr_b16 v[244:245],v17 offset:14336
ds_read_b64_tr_b16 v[246:247],v17 offset:14592
ds_read_b64_tr_b16 v[248:249],v17 offset:14344
ds_read_b64_tr_b16 v[250:251],v17 offset:14600
s_waitcnt lgkmcnt(0)
s_waitcnt vmcnt(0)
ds_read_b64_tr_b16 v[168:169],v18 offset:16384
ds_read_b64_tr_b16 v[170:171],v18 offset:16640
ds_read_b64_tr_b16 v[180:181],v18 offset:18432
ds_read_b64_tr_b16 v[182:183],v18 offset:18688
ds_read_b64_tr_b16 v[192:193],v18 offset:20480
ds_read_b64_tr_b16 v[194:195],v18 offset:20736
ds_read_b64_tr_b16 v[204:205],v18 offset:22528
ds_read_b64_tr_b16 v[206:207],v18 offset:22784
ds_read_b64_tr_b16 v[216:217],v18 offset:24576
ds_read_b64_tr_b16 v[218:219],v18 offset:24832
ds_read_b64_tr_b16 v[228:229],v18 offset:26624
ds_read_b64_tr_b16 v[230:231],v18 offset:26880
s_waitcnt lgkmcnt(0)
ds_read_b64_tr_b16 v[240:241],v18 offset:28672
ds_read_b64_tr_b16 v[242:243],v18 offset:28928
ds_read_b64_tr_b16 v[252:253],v18 offset:30720
ds_read_b64_tr_b16 v[254:255],v18 offset:30976
s_waitcnt lgkmcnt(0)
s_and_b32 s64,s59,7
s_cmp_eq_u32 s64,3
s_cbranch_scc1 sq_46
s_cmp_lg_u32 s59,63
s_cbranch_scc1 sq2_47
sq_46:
s_waitcnt vmcnt(0)
s_barrier
s_cmp_lg_u32 s50,0
s_cbranch_scc1 sig_48
s_mov_b32 s92,s2
s_and_b32 s93,s3,0xffff
s_mov_b32 s94,0x100
s_mov_b32 s95,0x20000
s_add_u32 s64,s88,28
v_mov_b32 v16,1
s_mov_b64 exec,1
buffer_atomic_add v16,off,s[92:95],s64 sc1
s_mov_b64 exec,-1
sig_48:
sq2_47:
s_mov_b32 s92,s2
s_and_b32 s93,s3,0xffff
s_mov_b32 s94,0x100
s_mov_b32 s95,0x20000
v_mbcnt_lo_u32_b32 v16,-1,0
v_mbcnt_hi_u32_b32 v16,-1,v16
v_mov_b32 v18,0
v_cmp_eq_u32 vcc,22,v16
s_nop 1
v_cndmask_b32 v18,v18,63,vcc
v_cmp_eq_u32 vcc,19,v16
s_nop 1
v_cndmask_b32 v18,v18,64,vcc
v_cmp_eq_u32 vcc,21,v16
s_nop 1
v_cndmask_b32 v18,v18,1,vcc
v_and_b32 v19,1,v16
v_cmp_eq_u32 vcc,1,v19
v_mov_b32 v19,8192
s_nop 0
v_cndmask_b32 v19,-1,v19,vcc
v_min_u32 v16,31,v16
v_lshlrev_b32 v16,2,v16
s_sub_u32 s66,s88,64
s_cmp_lg_u32 s50,0
s_cbranch_scc1 vot_53
vpoll_49:
buffer_load_dword v17,v16,s[92:95],s66 offen sc1
s_waitcnt vmcnt(0)
s_cmp_lg_u32 s56,2
s_cbranch_scc1 vck_50
v_cmp_eq_u32 vcc,v17,v19
s_and_b32 s64,vcc_lo,0xffff
s_cmp_eq_u32 s64,65535
s_cbranch_scc1 vck_50
s_mov_b32 s65,0
v_readlane_b32 s64,v17,1
s_lshr_b32 s64,s64,8
s_add_u32 s65,s65,s64
v_readlane_b32 s64,v17,3
s_lshr_b32 s64,s64,8
s_add_u32 s65,s65,s64
v_readlane_b32 s64,v17,5
s_lshr_b32 s64,s64,8
s_add_u32 s65,s65,s64
v_readlane_b32 s64,v17,7
s_lshr_b32 s64,s64,8
s_add_u32 s65,s65,s64
v_readlane_b32 s64,v17,9
s_lshr_b32 s64,s64,8
s_add_u32 s65,s65,s64
v_readlane_b32 s64,v17,11
s_lshr_b32 s64,s64,8
s_add_u32 s65,s65,s64
v_readlane_b32 s64,v17,13
s_lshr_b32 s64,s64,8
s_add_u32 s65,s65,s64
v_readlane_b32 s64,v17,15
s_lshr_b32 s64,s64,8
s_add_u32 s65,s65,s64
s_cmp_ge_u32 s65,256
s_cbranch_scc1 vok_52
s_branch vrt_51
vck_50:
v_cmp_gt_u32 vcc,v18,v17
s_cbranch_vccz vok_52
vrt_51:
s_sleep 8
s_sub_u32 s90,s90,1
s_cmp_gt_i32 s90,0
s_cbranch_scc1 vpoll_49
vok_52:
v_add_u32 v18,160768,v16
ds_write_b32 v18,v17
s_waitcnt lgkmcnt(0)
vot_53:
s_barrier
v_add_u32 v18,160768,v16
ds_read_b32 v17,v18
s_waitcnt lgkmcnt(0)
s_cmp_lg_u32 s56,2
s_cbranch_scc1 vfin_54
v_cmp_eq_u32 vcc,v17,v19
s_and_b32 s64,vcc_lo,0xffff
s_cmp_eq_u32 s64,65535
s_cbranch_scc1 vfin_54
s_mov_b32 s65,0
v_readlane_b32 s64,v17,1
s_lshr_b32 s64,s64,8
s_add_u32 s65,s65,s64
v_readlane_b32 s64,v17,3
s_lshr_b32 s64,s64,8
s_add_u32 s65,s65,s64
v_readlane_b32 s64,v17,5
s_lshr_b32 s64,s64,8
s_add_u32 s65,s65,s64
v_readlane_b32 s64,v17,7
s_lshr_b32 s64,s64,8
s_add_u32 s65,s65,s64
v_readlane_b32 s64,v17,9
s_lshr_b32 s64,s64,8
s_add_u32 s65,s65,s64
v_readlane_b32 s64,v17,11
s_lshr_b32 s64,s64,8
s_add_u32 s65,s65,s64
v_readlane_b32 s64,v17,13
s_lshr_b32 s64,s64,8
s_add_u32 s65,s65,s64
v_readlane_b32 s64,v17,15
s_lshr_b32 s64,s64,8
s_add_u32 s65,s65,s64
s_cmp_ge_u32 s65,256
s_cbranch_scc1 fl_fb
vfin_54:
s_and_b32 s56,s56,1
s_mov_b32 s67,0
v_readlane_b32 s65,v17,21
s_and_b32 s65,s65,2
s_lshl_b32 s67,s65,12
s_barrier
v_lshlrev_b32 v0,4,v1
s_mov_b32 s60,0
s_lshl_b32 s63,s50,13
s_add_u32 s61,s63,146800640
s_mov_b32 s70,0
s_lshl_b32 s52,s59,14
s_and_b32 s64,s50,1
s_lshl_b32 s64,s64,11
s_add_u32 s53,s52,s64
s_lshl_b32 s64,s50,10
s_add_u32 s52,s52,s64
s_add_u32 s52,s52,4096
s_cmp_gt_u32 s50,1
s_cselect_b32 s54,0x2000,0
s_lshl_b32 s69,s59,6
s_add_u32 s69,s69,s67
s_add_u32 s69,s69,138412032
v_mov_b32 v4,v0
v_add_u32 v5,32768,v0
s_add_u32 m0,s70,s63
s_add_u32 s62,s61,4096
buffer_load_dwordx4 v0,s[20:23],s61 offen offset:0 lds
buffer_load_dwordx4 v0,s[20:23],s61 offen offset:1024 lds
buffer_load_dwordx4 v0,s[20:23],s61 offen offset:2048 lds
buffer_load_dwordx4 v0,s[20:23],s61 offen offset:3072 lds
s_add_u32 m0,m0,4096
s_nop 0
buffer_load_dwordx4 v0,s[20:23],s62 offen offset:0 lds
buffer_load_dwordx4 v0,s[20:23],s62 offen offset:1024 lds
buffer_load_dwordx4 v0,s[20:23],s62 offen offset:2048 lds
buffer_load_dwordx4 v0,s[20:23],s62 offen offset:3072 lds
s_add_u32 s61,s61,32768
s_add_u32 s70,s70,32768
s_and_b32 s70,s70,0x1ffff
s_add_u32 m0,s70,s63
s_add_u32 s62,s61,4096
buffer_load_dwordx4 v0,s[20:23],s61 offen offset:0 lds
buffer_load_dwordx4 v0,s[20:23],s61 offen offset:1024 lds
buffer_load_dwordx4 v0,s[20:23],s61 offen offset:2048 lds
buffer_load_dwordx4 v0,s[20:23],s61 offen offset:3072 lds
s_add_u32 m0,m0,4096
s_nop 0
buffer_load_dwordx4 v0,s[20:23],s62 offen offset:0 lds
buffer_load_dwordx4 v0,s[20:23],s62 offen offset:1024 lds
buffer_load_dwordx4 v0,s[20:23],s62 offen offset:2048 lds
buffer_load_dwordx4 v0,s[20:23],s62 offen offset:3072 lds
s_add_u32 s61,s61,32768
s_add_u32 s70,s70,32768
s_and_b32 s70,s70,0x1ffff
s_waitcnt vmcnt(8)
s_barrier
ds_read_b128 v[64:67],v4 offset:0
ds_read_b128 v[68:71],v4 offset:1024
ds_read_b128 v[72:75],v4 offset:2048
ds_read_b128 v[76:79],v4 offset:3072
ds_read_b128 v[80:83],v4 offset:4096
top_55:
s_waitcnt lgkmcnt(4)
v_mfma_f32_16x16x32_bf16 v[32:35],a[0:3],v[64:67],0
ds_read_b128 v[84:87],v4 offset:5120
v_mfma_f32_16x16x32_bf16 v[36:39],a[4:7],v[64:67],0
v_mfma_f32_16x16x32_bf16 v[40:43],v[64:67],a[8:11],0
s_waitcnt lgkmcnt(4)
v_mfma_f32_16x16x32_bf16 v[32:35],a[12:15],v[68:71],v[32:35]
ds_read_b128 v[88:91],v4 offset:6144
s_sub_u32 s66,s60,1
s_lshr_b32 s64,s66,1
v_mfma_f32_16x16x32_bf16 v[36:39],a[16:19],v[68:71],v[36:39]
s_lshl_b32 s65,s64,12
s_and_b32 s65,s65,0x2000
v_mfma_f32_16x16x32_bf16 v[40:43],v[68:71],a[20:23],v[40:43]
s_xor_b32 s65,s65,s67
s_lshl_b32 s64,s64,20
s_waitcnt lgkmcnt(4)
v_mfma_f32_16x16x32_bf16 v[32:35],a[24:27],v[72:75],v[32:35]
ds_read_b128 v[92:95],v4 offset:7168
s_add_u32 s64,s64,s65
s_add_u32 s65,s64,s52
v_mfma_f32_16x16x32_bf16 v[36:39],a[28:31],v[72:75],v[36:39]
s_xor_b32 s64,s64,s54
s_add_u32 s66,s64,s53
v_mfma_f32_16x16x32_bf16 v[40:43],v[72:75],a[32:35],v[40:43]
s_cmp_eq_u32 s60,0
s_cselect_b32 s65,138608640,s65
s_waitcnt lgkmcnt(4)
v_mfma_f32_16x16x32_bf16 v[32:35],a[36:39],v[76:79],v[32:35]
ds_read_b128 v[96:99],v4 offset:8192
s_cselect_b32 s66,138608640,s66
v_mfma_f32_16x16x32_bf16 v[36:39],a[40:43],v[76:79],v[36:39]
v_cvt_pk_bf16_f32 v60,v44,v45
v_mfma_f32_16x16x32_bf16 v[40:43],v[76:79],a[44:47],v[40:43]
v_cvt_pk_bf16_f32 v61,v46,v47
s_waitcnt lgkmcnt(4)
v_mfma_f32_16x16x32_bf16 v[32:35],a[48:51],v[80:83],v[32:35]
ds_read_b128 v[100:103],v4 offset:9216
v_cvt_pk_bf16_f32 v62,v48,v49
v_mfma_f32_16x16x32_bf16 v[36:39],a[52:55],v[80:83],v[36:39]
v_cvt_pk_bf16_f32 v63,v50,v51
v_mfma_f32_16x16x32_bf16 v[40:43],v[80:83],a[56:59],v[40:43]
v_cvt_pk_bf16_f32 v58,v52,v53
s_waitcnt lgkmcnt(4)
v_mfma_f32_16x16x32_bf16 v[32:35],a[60:63],v[84:87],v[32:35]
ds_read_b128 v[104:107],v4 offset:10240
v_cvt_pk_bf16_f32 v59,v54,v55
v_mfma_f32_16x16x32_bf16 v[36:39],a[64:67],v[84:87],v[36:39]
buffer_store_dwordx4 v[60:63],v0,s[20:23],s66 offen offset:1024 sc1
v_mfma_f32_16x16x32_bf16 v[40:43],v[84:87],a[68:71],v[40:43]
buffer_store_dwordx4 v[56:59],v0,s[20:23],s65 offen sc1
s_waitcnt lgkmcnt(4)
v_mfma_f32_16x16x32_bf16 v[32:35],a[72:75],v[88:91],v[32:35]
ds_read_b128 v[108:111],v4 offset:11264
v_mfma_f32_16x16x32_bf16 v[36:39],a[76:79],v[88:91],v[36:39]
v_mfma_f32_16x16x32_bf16 v[40:43],v[88:91],a[80:83],v[40:43]
s_waitcnt lgkmcnt(4)
v_mfma_f32_16x16x32_bf16 v[32:35],a[84:87],v[92:95],v[32:35]
ds_read_b128 v[112:115],v4 offset:12288
v_mfma_f32_16x16x32_bf16 v[36:39],a[88:91],v[92:95],v[36:39]
v_mfma_f32_16x16x32_bf16 v[40:43],v[92:95],a[92:95],v[40:43]
s_waitcnt lgkmcnt(4)
v_mfma_f32_16x16x32_bf16 v[32:35],a[96:99],v[96:99],v[32:35]
ds_read_b128 v[116:119],v4 offset:13312
v_mfma_f32_16x16x32_bf16 v[36:39],a[100:103],v[96:99],v[36:39]
v_mfma_f32_16x16x32_bf16 v[40:43],v[96:99],a[104:107],v[40:43]
s_waitcnt lgkmcnt(4)
v_mfma_f32_16x16x32_bf16 v[32:35],a[108:111],v[100:103],v[32:35]
ds_read_b128 v[120:123],v4 offset:14336
v_mfma_f32_16x16x32_bf16 v[36:39],a[112:115],v[100:103],v[36:39]
v_mfma_f32_16x16x32_bf16 v[40:43],v[100:103],a[116:119],v[40:43]
s_waitcnt lgkmcnt(4)
v_mfma_f32_16x16x32_bf16 v[32:35],a[120:123],v[104:107],v[32:35]
ds_read_b128 v[124:127],v4 offset:15360
v_mfma_f32_16x16x32_bf16 v[36:39],a[124:127],v[104:107],v[36:39]
v_mfma_f32_16x16x32_bf16 v[40:43],v[104:107],a[128:131],v[40:43]
s_waitcnt lgkmcnt(4)
v_mfma_f32_16x16x32_bf16 v[32:35],a[132:135],v[108:111],v[32:35]
ds_read_b128 v[64:67],v4 offset:16384
v_mfma_f32_16x16x32_bf16 v[36:39],a[136:139],v[108:111],v[36:39]
v_mfma_f32_16x16x32_bf16 v[40:43],v[108:111],a[140:143],v[40:43]
s_waitcnt lgkmcnt(4)
v_mfma_f32_16x16x32_bf16 v[32:35],a[144:147],v[112:115],v[32:35]
ds_read_b128 v[68:71],v4 offset:17408
v_mfma_f32_16x16x32_bf16 v[36:39],a[148:151],v[112:115],v[36:39]
v_mfma_f32_16x16x32_bf16 v[40:43],v[112:115],a[152:155],v[40:43]
s_waitcnt lgkmcnt(4)
v_mfma_f32_16x16x32_bf16 v[32:35],a[156:159],v[116:119],v[32:35]
ds_read_b128 v[72:75],v4 offset:18432
v_mfma_f32_16x16x32_bf16 v[36:39],a[160:163],v[116:119],v[36:39]
v_mfma_f32_16x16x32_bf16 v[40:43],v[116:119],a[164:167],v[40:43]
s_waitcnt lgkmcnt(4)
v_mfma_f32_16x16x32_bf16 v[32:35],a[168:171],v[120:123],v[32:35]
ds_read_b128 v[76:79],v4 offset:19456
v_mfma_f32_16x16x32_bf16 v[36:39],a[172:175],v[120:123],v[36:39]
v_mfma_f32_16x16x32_bf16 v[40:43],v[120:123],a[176:179],v[40:43]
s_waitcnt lgkmcnt(4)
v_mfma_f32_16x16x32_bf16 v[32:35],a[180:183],v[124:127],v[32:35]
ds_read_b128 v[80:83],v4 offset:20480
v_mfma_f32_16x16x32_bf16 v[36:39],a[184:187],v[124:127],v[36:39]
s_waitcnt vmcnt(2)
s_cmp_eq_u32 s60,60
s_cbranch_scc1 hb_58
s_cmp_eq_u32 s60,16
s_cbranch_scc1 hc_60
hb2_59:
s_sub_u32 s64,s60,2
s_cmp_gt_u32 s64,2
s_cbranch_scc1 sk_57
s_waitcnt vmcnt(0)
sk_57:
s_cselect_b32 s64,1,s50
s_barrier
s_cmp_ge_u32 s60,126
s_cselect_b32 s61,146800640,s61
s_cmp_lg_u32 s64,0
s_cbranch_scc1 nf_56
s_lshr_b32 s64,s60,1
v_mov_b32 v6,s64
s_mov_b64 exec,1
buffer_store_dword v6,off,s[20:23],s69 sc1
s_mov_b64 exec,-1
nf_56:
v_mfma_f32_16x16x32_bf16 v[40:43],v[124:127],a[188:191],v[40:43]
s_waitcnt lgkmcnt(4)
v_mfma_f32_16x16x32_bf16 v[32:35],a[192:195],v[64:67],v[32:35]
ds_read_b128 v[84:87],v4 offset:21504
s_add_u32 m0,s70,s63
v_mfma_f32_16x16x32_bf16 v[36:39],a[196:199],v[64:67],v[36:39]
v_mfma_f32_16x16x32_bf16 v[40:43],v[64:67],a[200:203],v[40:43]
s_add_u32 s62,s61,4096
s_waitcnt lgkmcnt(4)
v_mfma_f32_16x16x32_bf16 v[32:35],a[204:207],v[68:71],v[32:35]
ds_read_b128 v[88:91],v4 offset:22528
v_mfma_f32_16x16x32_bf16 v[36:39],a[208:211],v[68:71],v[36:39]
buffer_load_dwordx4 v0,s[20:23],s61 offen offset:0 lds
v_mfma_f32_16x16x32_bf16 v[40:43],v[68:71],a[212:215],v[40:43]
s_waitcnt lgkmcnt(4)
v_mfma_f32_16x16x32_bf16 v[32:35],a[216:219],v[72:75],v[32:35]
ds_read_b128 v[92:95],v4 offset:23552
buffer_load_dwordx4 v0,s[20:23],s61 offen offset:1024 lds
v_mfma_f32_16x16x32_bf16 v[36:39],a[220:223],v[72:75],v[36:39]
v_mfma_f32_16x16x32_bf16 v[40:43],v[72:75],a[224:227],v[40:43]
buffer_load_dwordx4 v0,s[20:23],s61 offen offset:2048 lds
s_waitcnt lgkmcnt(4)
v_mfma_f32_16x16x32_bf16 v[32:35],a[228:231],v[76:79],v[32:35]
ds_read_b128 v[96:99],v4 offset:24576
v_mfma_f32_16x16x32_bf16 v[36:39],a[232:235],v[76:79],v[36:39]
buffer_load_dwordx4 v0,s[20:23],s61 offen offset:3072 lds
v_mfma_f32_16x16x32_bf16 v[40:43],v[76:79],a[236:239],v[40:43]
s_waitcnt lgkmcnt(4)
v_mfma_f32_16x16x32_bf16 v[32:35],a[240:243],v[80:83],v[32:35]
ds_read_b128 v[100:103],v4 offset:25600
s_add_u32 m0,m0,4096
v_mfma_f32_16x16x32_bf16 v[36:39],a[244:247],v[80:83],v[36:39]
v_mfma_f32_16x16x32_bf16 v[40:43],v[80:83],a[248:251],v[40:43]
buffer_load_dwordx4 v0,s[20:23],s62 offen offset:0 lds
s_waitcnt lgkmcnt(4)
v_mfma_f32_16x16x32_bf16 v[32:35],a[252:255],v[84:87],v[32:35]
ds_read_b128 v[104:107],v4 offset:26624
v_mfma_f32_16x16x32_bf16 v[36:39],v[128:131],v[84:87],v[36:39]
buffer_load_dwordx4 v0,s[20:23],s62 offen offset:1024 lds
v_mfma_f32_16x16x32_bf16 v[40:43],v[84:87],v[132:135],v[40:43]
s_waitcnt lgkmcnt(4)
v_mfma_f32_16x16x32_bf16 v[32:35],v[136:139],v[88:91],v[32:35]
ds_read_b128 v[108:111],v4 offset:27648
buffer_load_dwordx4 v0,s[20:23],s62 offen offset:2048 lds
v_mfma_f32_16x16x32_bf16 v[36:39],v[140:143],v[88:91],v[36:39]
v_mfma_f32_16x16x32_bf16 v[40:43],v[88:91],v[144:147],v[40:43]
buffer_load_dwordx4 v0,s[20:23],s62 offen offset:3072 lds
s_waitcnt lgkmcnt(4)
v_mfma_f32_16x16x32_bf16 v[32:35],v[148:151],v[92:95],v[32:35]
ds_read_b128 v[112:115],v4 offset:28672
v_mfma_f32_16x16x32_bf16 v[36:39],v[152:155],v[92:95],v[36:39]
s_add_u32 s61,s61,32768
v_mfma_f32_16x16x32_bf16 v[40:43],v[92:95],v[156:159],v[40:43]
s_waitcnt lgkmcnt(4)
v_mfma_f32_16x16x32_bf16 v[32:35],v[160:163],v[96:99],v[32:35]
ds_read_b128 v[116:119],v4 offset:29696
s_add_u32 s70,s70,32768
v_mfma_f32_16x16x32_bf16 v[36:39],v[164:167],v[96:99],v[36:39]
v_mfma_f32_16x16x32_bf16 v[40:43],v[96:99],v[168:171],v[40:43]
s_and_b32 s70,s70,0x1ffff
s_waitcnt lgkmcnt(4)
v_mfma_f32_16x16x32_bf16 v[32:35],v[172:175],v[100:103],v[32:35]
ds_read_b128 v[120:123],v4 offset:30720
v_mfma_f32_16x16x32_bf16 v[36:39],v[176:179],v[100:103],v[36:39]
v_mfma_f32_16x16x32_bf16 v[40:43],v[100:103],v[180:183],v[40:43]
s_waitcnt lgkmcnt(4)
v_mfma_f32_16x16x32_bf16 v[32:35],v[184:187],v[104:107],v[32:35]
ds_read_b128 v[124:127],v4 offset:31744
v_mfma_f32_16x16x32_bf16 v[36:39],v[188:191],v[104:107],v[36:39]
v_mfma_f32_16x16x32_bf16 v[40:43],v[104:107],v[192:195],v[40:43]
s_waitcnt lgkmcnt(4)
v_mfma_f32_16x16x32_bf16 v[32:35],v[196:199],v[108:111],v[32:35]
ds_read_b128 v[64:67],v5 offset:0
v_mfma_f32_16x16x32_bf16 v[36:39],v[200:203],v[108:111],v[36:39]
v_mfma_f32_16x16x32_bf16 v[40:43],v[108:111],v[204:207],v[40:43]
s_waitcnt lgkmcnt(4)
v_mfma_f32_16x16x32_bf16 v[32:35],v[208:211],v[112:115],v[32:35]
ds_read_b128 v[68:71],v5 offset:1024
v_mfma_f32_16x16x32_bf16 v[36:39],v[212:215],v[112:115],v[36:39]
v_mfma_f32_16x16x32_bf16 v[40:43],v[112:115],v[216:219],v[40:43]
s_waitcnt lgkmcnt(4)
v_mfma_f32_16x16x32_bf16 v[32:35],v[220:223],v[116:119],v[32:35]
ds_read_b128 v[72:75],v5 offset:2048
v_mfma_f32_16x16x32_bf16 v[36:39],v[224:227],v[116:119],v[36:39]
v_mfma_f32_16x16x32_bf16 v[40:43],v[116:119],v[228:231],v[40:43]
s_waitcnt lgkmcnt(4)
v_mfma_f32_16x16x32_bf16 v[32:35],v[232:235],v[120:123],v[32:35]
ds_read_b128 v[76:79],v5 offset:3072
v_mfma_f32_16x16x32_bf16 v[36:39],v[236:239],v[120:123],v[36:39]
v_mfma_f32_16x16x32_bf16 v[40:43],v[120:123],v[240:243],v[40:43]
s_waitcnt lgkmcnt(4)
v_mfma_f32_16x16x32_bf16 v[32:35],v[244:247],v[124:127],v[32:35]
ds_read_b128 v[80:83],v5 offset:4096
v_mfma_f32_16x16x32_bf16 v[36:39],v[248:251],v[124:127],v[36:39]
v_mfma_f32_16x16x32_bf16 v[40:43],v[124:127],v[252:255],v[40:43]
v_mov_b32 v4,v5
v_add_u32 v5,32768,v5
v_and_b32 v5,0x1ffff,v5
s_add_u32 s60,s60,1
s_waitcnt lgkmcnt(4)
v_mfma_f32_16x16x32_bf16 v[44:47],a[0:3],v[64:67],0
ds_read_b128 v[84:87],v4 offset:5120
v_mfma_f32_16x16x32_bf16 v[48:51],a[4:7],v[64:67],0
v_mfma_f32_16x16x32_bf16 v[52:55],v[64:67],a[8:11],0
s_waitcnt lgkmcnt(4)
v_mfma_f32_16x16x32_bf16 v[44:47],a[12:15],v[68:71],v[44:47]
ds_read_b128 v[88:91],v4 offset:6144
s_sub_u32 s66,s60,1
s_lshr_b32 s64,s66,1
v_mfma_f32_16x16x32_bf16 v[48:51],a[16:19],v[68:71],v[48:51]
s_lshl_b32 s65,s64,12
s_and_b32 s65,s65,0x2000
v_mfma_f32_16x16x32_bf16 v[52:55],v[68:71],a[20:23],v[52:55]
s_xor_b32 s65,s65,s67
s_lshl_b32 s64,s64,20
s_waitcnt lgkmcnt(4)
v_mfma_f32_16x16x32_bf16 v[44:47],a[24:27],v[72:75],v[44:47]
ds_read_b128 v[92:95],v4 offset:7168
s_add_u32 s64,s64,s65
s_add_u32 s65,s64,s52
v_mfma_f32_16x16x32_bf16 v[48:51],a[28:31],v[72:75],v[48:51]
s_xor_b32 s64,s64,s54
s_add_u32 s66,s64,s53
v_mfma_f32_16x16x32_bf16 v[52:55],v[72:75],a[32:35],v[52:55]
v_cvt_pk_bf16_f32 v60,v32,v33
v_cvt_pk_bf16_f32 v61,v34,v35
s_waitcnt lgkmcnt(4)
v_mfma_f32_16x16x32_bf16 v[44:47],a[36:39],v[76:79],v[44:47]
ds_read_b128 v[96:99],v4 offset:8192
v_cvt_pk_bf16_f32 v62,v36,v37
v_mfma_f32_16x16x32_bf16 v[48:51],a[40:43],v[76:79],v[48:51]
v_cvt_pk_bf16_f32 v63,v38,v39
v_mfma_f32_16x16x32_bf16 v[52:55],v[76:79],a[44:47],v[52:55]
v_cvt_pk_bf16_f32 v56,v40,v41
s_waitcnt lgkmcnt(4)
v_mfma_f32_16x16x32_bf16 v[44:47],a[48:51],v[80:83],v[44:47]
ds_read_b128 v[100:103],v4 offset:9216
v_cvt_pk_bf16_f32 v57,v42,v43
v_mfma_f32_16x16x32_bf16 v[48:51],a[52:55],v[80:83],v[48:51]
buffer_store_dwordx4 v[60:63],v0,s[20:23],s66 offen offset:0 sc1
v_mfma_f32_16x16x32_bf16 v[52:55],v[80:83],a[56:59],v[52:55]
s_waitcnt lgkmcnt(4)
v_mfma_f32_16x16x32_bf16 v[44:47],a[60:63],v[84:87],v[44:47]
ds_read_b128 v[104:107],v4 offset:10240
v_mfma_f32_16x16x32_bf16 v[48:51],a[64:67],v[84:87],v[48:51]
v_mfma_f32_16x16x32_bf16 v[52:55],v[84:87],a[68:71],v[52:55]
s_waitcnt lgkmcnt(4)
v_mfma_f32_16x16x32_bf16 v[44:47],a[72:75],v[88:91],v[44:47]
ds_read_b128 v[108:111],v4 offset:11264
v_mfma_f32_16x16x32_bf16 v[48:51],a[76:79],v[88:91],v[48:51]
v_mfma_f32_16x16x32_bf16 v[52:55],v[88:91],a[80:83],v[52:55]
s_waitcnt lgkmcnt(4)
v_mfma_f32_16x16x32_bf16 v[44:47],a[84:87],v[92:95],v[44:47]
ds_read_b128 v[112:115],v4 offset:12288
v_mfma_f32_16x16x32_bf16 v[48:51],a[88:91],v[92:95],v[48:51]
v_mfma_f32_16x16x32_bf16 v[52:55],v[92:95],a[92:95],v[52:55]
s_waitcnt lgkmcnt(4)
v_mfma_f32_16x16x32_bf16 v[44:47],a[96:99],v[96:99],v[44:47]
ds_read_b128 v[116:119],v4 offset:13312
v_mfma_f32_16x16x32_bf16 v[48:51],a[100:103],v[96:99],v[48:51]
v_mfma_f32_16x16x32_bf16 v[52:55],v[96:99],a[104:107],v[52:55]
s_waitcnt lgkmcnt(4)
v_mfma_f32_16x16x32_bf16 v[44:47],a[108:111],v[100:103],v[44:47]
ds_read_b128 v[120:123],v4 offset:14336
v_mfma_f32_16x16x32_bf16 v[48:51],a[112:115],v[100:103],v[48:51]
v_mfma_f32_16x16x32_bf16 v[52:55],v[100:103],a[116:119],v[52:55]
s_waitcnt lgkmcnt(4)
v_mfma_f32_16x16x32_bf16 v[44:47],a[120:123],v[104:107],v[44:47]
ds_read_b128 v[124:127],v4 offset:15360
v_mfma_f32_16x16x32_bf16 v[48:51],a[124:127],v[104:107],v[48:51]
v_mfma_f32_16x16x32_bf16 v[52:55],v[104:107],a[128:131],v[52:55]
s_waitcnt lgkmcnt(4)
v_mfma_f32_16x16x32_bf16 v[44:47],a[132:135],v[108:111],v[44:47]
ds_read_b128 v[64:67],v4 offset:16384
v_mfma_f32_16x16x32_bf16 v[48:51],a[136:139],v[108:111],v[48:51]
v_mfma_f32_16x16x32_bf16 v[52:55],v[108:111],a[140:143],v[52:55]
s_waitcnt lgkmcnt(4)
v_mfma_f32_16x16x32_bf16 v[44:47],a[144:147],v[112:115],v[44:47]
ds_read_b128 v[68:71],v4 offset:17408
v_mfma_f32_16x16x32_bf16 v[48:51],a[148:151],v[112:115],v[48:51]
v_mfma_f32_16x16x32_bf16 v[52:55],v[112:115],a[152:155],v[52:55]
s_waitcnt lgkmcnt(4)
v_mfma_f32_16x16x32_bf16 v[44:47],a[156:159],v[116:119],v[44:47]
ds_read_b128 v[72:75],v4 offset:18432
v_mfma_f32_16x16x32_bf16 v[48:51],a[160:163],v[116:119],v[48:51]
v_mfma_f32_16x16x32_bf16 v[52:55],v[116:119],a[164:167],v[52:55]
s_waitcnt lgkmcnt(4)
v_mfma_f32_16x16x32_bf16 v[44:47],a[168:171],v[120:123],v[44:47]
ds_read_b128 v[76:79],v4 offset:19456
v_mfma_f32_16x16x32_bf16 v[48:51],a[172:175],v[120:123],v[48:51]
v_mfma_f32_16x16x32_bf16 v[52:55],v[120:123],a[176:179],v[52:55]
s_waitcnt lgkmcnt(4)
v_mfma_f32_16x16x32_bf16 v[44:47],a[180:183],v[124:127],v[44:47]
ds_read_b128 v[80:83],v4 offset:20480
v_mfma_f32_16x16x32_bf16 v[48:51],a[184:187],v[124:127],v[48:51]
s_waitcnt vmcnt(1)
s_mov_b32 s64,s50
s_barrier
s_cmp_ge_u32 s60,126
s_cselect_b32 s61,146800640,s61
s_cmp_lg_u32 s64,0
s_cbranch_scc1 nf_61
s_lshr_b32 s64,s60,1
v_mov_b32 v6,s64
s_mov_b64 exec,1
buffer_store_dword v6,off,s[20:23],s69 sc1
s_mov_b64 exec,-1
nf_61:
v_mfma_f32_16x16x32_bf16 v[52:55],v[124:127],a[188:191],v[52:55]
s_waitcnt lgkmcnt(4)
v_mfma_f32_16x16x32_bf16 v[44:47],a[192:195],v[64:67],v[44:47]
ds_read_b128 v[84:87],v4 offset:21504
s_add_u32 m0,s70,s63
v_mfma_f32_16x16x32_bf16 v[48:51],a[196:199],v[64:67],v[48:51]
v_mfma_f32_16x16x32_bf16 v[52:55],v[64:67],a[200:203],v[52:55]
s_add_u32 s62,s61,4096
s_waitcnt lgkmcnt(4)
v_mfma_f32_16x16x32_bf16 v[44:47],a[204:207],v[68:71],v[44:47]
ds_read_b128 v[88:91],v4 offset:22528
v_mfma_f32_16x16x32_bf16 v[48:51],a[208:211],v[68:71],v[48:51]
buffer_load_dwordx4 v0,s[20:23],s61 offen offset:0 lds
v_mfma_f32_16x16x32_bf16 v[52:55],v[68:71],a[212:215],v[52:55]
s_waitcnt lgkmcnt(4)
v_mfma_f32_16x16x32_bf16 v[44:47],a[216:219],v[72:75],v[44:47]
ds_read_b128 v[92:95],v4 offset:23552
buffer_load_dwordx4 v0,s[20:23],s61 offen offset:1024 lds
v_mfma_f32_16x16x32_bf16 v[48:51],a[220:223],v[72:75],v[48:51]
v_mfma_f32_16x16x32_bf16 v[52:55],v[72:75],a[224:227],v[52:55]
buffer_load_dwordx4 v0,s[20:23],s61 offen offset:2048 lds
s_waitcnt lgkmcnt(4)
v_mfma_f32_16x16x32_bf16 v[44:47],a[228:231],v[76:79],v[44:47]
ds_read_b128 v[96:99],v4 offset:24576
v_mfma_f32_16x16x32_bf16 v[48:51],a[232:235],v[76:79],v[48:51]
buffer_load_dwordx4 v0,s[20:23],s61 offen offset:3072 lds
v_mfma_f32_16x16x32_bf16 v[52:55],v[76:79],a[236:239],v[52:55]
s_waitcnt lgkmcnt(4)
v_mfma_f32_16x16x32_bf16 v[44:47],a[240:243],v[80:83],v[44:47]
ds_read_b128 v[100:103],v4 offset:25600
s_add_u32 m0,m0,4096
v_mfma_f32_16x16x32_bf16 v[48:51],a[244:247],v[80:83],v[48:51]
v_mfma_f32_16x16x32_bf16 v[52:55],v[80:83],a[248:251],v[52:55]
buffer_load_dwordx4 v0,s[20:23],s62 offen offset:0 lds
s_waitcnt lgkmcnt(4)
v_mfma_f32_16x16x32_bf16 v[44:47],a[252:255],v[84:87],v[44:47]
ds_read_b128 v[104:107],v4 offset:26624
v_mfma_f32_16x16x32_bf16 v[48:51],v[128:131],v[84:87],v[48:51]
buffer_load_dwordx4 v0,s[20:23],s62 offen offset:1024 lds
v_mfma_f32_16x16x32_bf16 v[52:55],v[84:87],v[132:135],v[52:55]
s_waitcnt lgkmcnt(4)
v_mfma_f32_16x16x32_bf16 v[44:47],v[136:139],v[88:91],v[44:47]
ds_read_b128 v[108:111],v4 offset:27648
buffer_load_dwordx4 v0,s[20:23],s62 offen offset:2048 lds
v_mfma_f32_16x16x32_bf16 v[48:51],v[140:143],v[88:91],v[48:51]
v_mfma_f32_16x16x32_bf16 v[52:55],v[88:91],v[144:147],v[52:55]
buffer_load_dwordx4 v0,s[20:23],s62 offen offset:3072 lds
s_waitcnt lgkmcnt(4)
v_mfma_f32_16x16x32_bf16 v[44:47],v[148:151],v[92:95],v[44:47]
ds_read_b128 v[112:115],v4 offset:28672
v_mfma_f32_16x16x32_bf16 v[48:51],v[152:155],v[92:95],v[48:51]
s_add_u32 s61,s61,32768
v_mfma_f32_16x16x32_bf16 v[52:55],v[92:95],v[156:159],v[52:55]
s_waitcnt lgkmcnt(4)
v_mfma_f32_16x16x32_bf16 v[44:47],v[160:163],v[96:99],v[44:47]
ds_read_b128 v[116:119],v4 offset:29696
s_add_u32 s70,s70,32768
v_mfma_f32_16x16x32_bf16 v[48:51],v[164:167],v[96:99],v[48:51]
v_mfma_f32_16x16x32_bf16 v[52:55],v[96:99],v[168:171],v[52:55]
s_and_b32 s70,s70,0x1ffff
s_waitcnt lgkmcnt(4)
v_mfma_f32_16x16x32_bf16 v[44:47],v[172:175],v[100:103],v[44:47]
ds_read_b128 v[120:123],v4 offset:30720
v_mfma_f32_16x16x32_bf16 v[48:51],v[176:179],v[100:103],v[48:51]
v_mfma_f32_16x16x32_bf16 v[52:55],v[100:103],v[180:183],v[52:55]
s_waitcnt lgkmcnt(4)
v_mfma_f32_16x16x32_bf16 v[44:47],v[184:187],v[104:107],v[44:47]
ds_read_b128 v[124:127],v4 offset:31744
v_mfma_f32_16x16x32_bf16 v[48:51],v[188:191],v[104:107],v[48:51]
v_mfma_f32_16x16x32_bf16 v[52:55],v[104:107],v[192:195],v[52:55]
s_waitcnt lgkmcnt(4)
v_mfma_f32_16x16x32_bf16 v[44:47],v[196:199],v[108:111],v[44:47]
ds_read_b128 v[64:67],v5 offset:0
v_mfma_f32_16x16x32_bf16 v[48:51],v[200:203],v[108:111],v[48:51]
v_mfma_f32_16x16x32_bf16 v[52:55],v[108:111],v[204:207],v[52:55]
s_waitcnt lgkmcnt(4)
v_mfma_f32_16x16x32_bf16 v[44:47],v[208:211],v[112:115],v[44:47]
ds_read_b128 v[68:71],v5 offset:1024
v_mfma_f32_16x16x32_bf16 v[48:51],v[212:215],v[112:115],v[48:51]
v_mfma_f32_16x16x32_bf16 v[52:55],v[112:115],v[216:219],v[52:55]
s_waitcnt lgkmcnt(4)
v_mfma_f32_16x16x32_bf16 v[44:47],v[220:223],v[116:119],v[44:47]
ds_read_b128 v[72:75],v5 offset:2048
v_mfma_f32_16x16x32_bf16 v[48:51],v[224:227],v[116:119],v[48:51]
v_mfma_f32_16x16x32_bf16 v[52:55],v[116:119],v[228:231],v[52:55]
s_waitcnt lgkmcnt(4)
v_mfma_f32_16x16x32_bf16 v[44:47],v[232:235],v[120:123],v[44:47]
ds_read_b128 v[76:79],v5 offset:3072
v_mfma_f32_16x16x32_bf16 v[48:51],v[236:239],v[120:123],v[48:51]
v_mfma_f32_16x16x32_bf16 v[52:55],v[120:123],v[240:243],v[52:55]
s_waitcnt lgkmcnt(4)
v_mfma_f32_16x16x32_bf16 v[44:47],v[244:247],v[124:127],v[44:47]
ds_read_b128 v[80:83],v5 offset:4096
v_mfma_f32_16x16x32_bf16 v[48:51],v[248:251],v[124:127],v[48:51]
v_mfma_f32_16x16x32_bf16 v[52:55],v[124:127],v[252:255],v[52:55]
v_mov_b32 v4,v5
v_add_u32 v5,32768,v5
v_and_b32 v5,0x1ffff,v5
s_add_u32 s60,s60,1
s_cmp_lt_u32 s60,128
s_cbranch_scc1 top_55
s_sub_u32 s66,s60,1
s_lshr_b32 s64,s66,1
s_lshl_b32 s65,s64,12
s_and_b32 s65,s65,0x2000
s_xor_b32 s65,s65,s67
s_lshl_b32 s64,s64,20
s_add_u32 s64,s64,s65
s_add_u32 s65,s64,s52
s_xor_b32 s64,s64,s54
s_add_u32 s66,s64,s53
s_cmp_eq_u32 s60,0
s_cselect_b32 s65,138608640,s65
s_cselect_b32 s66,138608640,s66
v_cvt_pk_bf16_f32 v60,v44,v45
v_cvt_pk_bf16_f32 v61,v46,v47
v_cvt_pk_bf16_f32 v62,v48,v49
v_cvt_pk_bf16_f32 v63,v50,v51
v_cvt_pk_bf16_f32 v58,v52,v53
v_cvt_pk_bf16_f32 v59,v54,v55
buffer_store_dwordx4 v[60:63],v0,s[20:23],s66 offen offset:1024 sc1
buffer_store_dwordx4 v[56:59],v0,s[20:23],s65 offen sc1
s_waitcnt vmcnt(0) lgkmcnt(0)
s_barrier
s_cmp_lg_u32 s50,0
s_cbranch_scc1 done_45
v_mov_b32 v6,64
s_mov_b64 exec,1
buffer_store_dword v6,off,s[20:23],s69 sc1
s_mov_b64 exec,-1
done_45:
s_endpgm
hb_58:
s_mov_b32 s28,s2
s_and_b32 s29,s3,0xffff
s_mov_b32 s30,0x100
s_mov_b32 s31,0x20000
v_mbcnt_lo_u32_b32 v12,-1,0
v_mbcnt_hi_u32_b32 v12,-1,v12
v_mov_b32 v14,0
v_cmp_eq_u32 vcc,20,v12
s_nop 1
v_cndmask_b32 v14,v14,64,vcc
v_and_b32 v15,1,v12
v_cmp_eq_u32 vcc,1,v15
v_mov_b32 v15,8192
s_nop 0
v_cndmask_b32 v15,-1,v15,vcc
v_min_u32 v12,31,v12
v_lshlrev_b32 v12,2,v12
s_sub_u32 s66,s88,64
vpoll_62:
buffer_load_dword v13,v12,s[28:31],s66 offen sc1
s_waitcnt vmcnt(0)
vck_63:
v_cmp_gt_u32 vcc,v14,v13
s_cbranch_vccz vok_65
vrt_64:
s_sleep 8
s_sub_u32 s90,s90,1
s_cmp_gt_i32 s90,0
s_cbranch_scc1 vpoll_62
vok_65:
s_branch hb2_59
hc_60:
s_mov_b32 s28,s2
s_and_b32 s29,s3,0xffff
s_mov_b32 s30,0x100
s_mov_b32 s31,0x20000
v_mbcnt_lo_u32_b32 v12,-1,0
v_mbcnt_hi_u32_b32 v12,-1,v12
v_mov_b32 v14,0
v_cmp_eq_u32 vcc,17,v12
s_nop 1
v_cndmask_b32 v14,v14,63,vcc
v_and_b32 v15,1,v12
v_cmp_eq_u32 vcc,1,v15
v_mov_b32 v15,8192
s_nop 0
v_cndmask_b32 v15,-1,v15,vcc
v_min_u32 v12,31,v12
v_lshlrev_b32 v12,2,v12
s_sub_u32 s66,s88,64
vpoll_68:
buffer_load_dword v13,v12,s[28:31],s66 offen sc1
s_waitcnt vmcnt(0)
vck_69:
v_cmp_gt_u32 vcc,v14,v13
s_cbranch_vccz vok_71
vrt_70:
s_sleep 8
s_sub_u32 s90,s90,1
s_cmp_gt_i32 s90,0
s_cbranch_scc1 vpoll_68
vok_71:
s_branch hb2_59
fl_wo:
v_and_b32 v21,15,v1
v_lshrrev_b32 v22,4,v1
v_lshrrev_b32 v23,2,v21
v_and_b32 v24,3,v21
s_lshl_b32 s61,s50,15
v_lshl_add_u32 v25,v22,3,v23
s_load_dwordx2 s[4:5],s[0:1],40
s_load_dwordx2 s[6:7],s[0:1],0
s_lshr_b32 s52,s59,3
s_and_b32 s53,s59,7
s_mul_i32 s54,s52,2097152
s_lshl_b32 s64,s53,8
s_add_u32 s54,s54,s64
s_lshl_b32 s64,s50,6
s_add_u32 s54,s54,s64
s_waitcnt lgkmcnt(0)
s_mov_b32 s28,s4
s_and_b32 s29,s5,0xffff
s_mov_b32 s30,0x800000
s_mov_b32 s31,0x20000
s_mov_b32 s24,s6
s_and_b32 s25,s7,0xffff
s_mov_b32 s26,0x400000
s_mov_b32 s27,0x20000
v_lshrrev_b32 v26,2,v1
v_and_b32 v27,3,v1
v_mul_u32_u24 v16,2048,v26
v_lshl_add_u32 v16,v27,4,v16
v_lshlrev_b32 v17,6,v25
v_lshl_add_u32 v17,v24,4,v17
v_add_u32 v17,s61,v17
s_xor_b32 s62,s50,0
s_mul_i32 s62,s62,524288
s_add_u32 s62,s62,s54
s_add_u32 m0,s61,0
s_nop 0
buffer_load_dwordx4 v16,s[28:31],s62 offen lds
s_add_u32 s62,s62,32768
s_add_u32 m0,m0,1024
s_waitcnt vmcnt(6)
buffer_load_dwordx4 v16,s[28:31],s62 offen lds
s_add_u32 s62,s62,32768
s_add_u32 m0,m0,1024
s_waitcnt vmcnt(6)
buffer_load_dwordx4 v16,s[28:31],s62 offen lds
s_add_u32 s62,s62,32768
s_add_u32 m0,m0,1024
s_waitcnt vmcnt(6)
buffer_load_dwordx4 v16,s[28:31],s62 offen lds
s_add_u32 s62,s62,32768
s_add_u32 m0,m0,1024
s_waitcnt vmcnt(6)
buffer_load_dwordx4 v16,s[28:31],s62 offen lds
s_add_u32 s62,s62,32768
s_add_u32 m0,m0,1024
s_waitcnt vmcnt(6)
buffer_load_dwordx4 v16,s[28:31],s62 offen lds
s_add_u32 s62,s62,32768
s_add_u32 m0,m0,1024
s_waitcnt vmcnt(6)
buffer_load_dwordx4 v16,s[28:31],s62 offen lds
s_add_u32 s62,s62,32768
s_add_u32 m0,m0,1024
s_waitcnt vmcnt(6)
buffer_load_dwordx4 v16,s[28:31],s62 offen lds
s_add_u32 s62,s62,32768
s_add_u32 m0,m0,1024
s_waitcnt vmcnt(6)
buffer_load_dwordx4 v16,s[28:31],s62 offen lds
s_add_u32 s62,s62,32768
s_add_u32 m0,m0,1024
s_waitcnt vmcnt(6)
buffer_load_dwordx4 v16,s[28:31],s62 offen lds
s_add_u32 s62,s62,32768
s_add_u32 m0,m0,1024
s_waitcnt vmcnt(6)
buffer_load_dwordx4 v16,s[28:31],s62 offen lds
s_add_u32 s62,s62,32768
s_add_u32 m0,m0,1024
s_waitcnt vmcnt(6)
buffer_load_dwordx4 v16,s[28:31],s62 offen lds
s_add_u32 s62,s62,32768
s_add_u32 m0,m0,1024
s_waitcnt vmcnt(6)
buffer_load_dwordx4 v16,s[28:31],s62 offen lds
s_add_u32 s62,s62,32768
s_add_u32 m0,m0,1024
s_waitcnt vmcnt(6)
buffer_load_dwordx4 v16,s[28:31],s62 offen lds
s_add_u32 s62,s62,32768
s_add_u32 m0,m0,1024
s_waitcnt vmcnt(6)
buffer_load_dwordx4 v16,s[28:31],s62 offen lds
s_add_u32 s62,s62,32768
s_add_u32 m0,m0,1024
s_waitcnt vmcnt(6)
buffer_load_dwordx4 v16,s[28:31],s62 offen lds
s_waitcnt vmcnt(6)
s_xor_b32 s62,s50,1
s_mul_i32 s62,s62,524288
s_add_u32 s62,s62,s54
s_add_u32 m0,s61,16384
s_nop 0
buffer_load_dwordx4 v16,s[28:31],s62 offen lds
s_add_u32 s62,s62,32768
s_add_u32 m0,m0,1024
s_waitcnt vmcnt(6)
buffer_load_dwordx4 v16,s[28:31],s62 offen lds
s_add_u32 s62,s62,32768
s_add_u32 m0,m0,1024
s_waitcnt vmcnt(6)
buffer_load_dwordx4 v16,s[28:31],s62 offen lds
s_add_u32 s62,s62,32768
s_add_u32 m0,m0,1024
s_waitcnt vmcnt(6)
buffer_load_dwordx4 v16,s[28:31],s62 offen lds
s_add_u32 s62,s62,32768
s_add_u32 m0,m0,1024
s_waitcnt vmcnt(6)
buffer_load_dwordx4 v16,s[28:31],s62 offen lds
s_add_u32 s62,s62,32768
s_add_u32 m0,m0,1024
s_waitcnt vmcnt(6)
buffer_load_dwordx4 v16,s[28:31],s62 offen lds
s_add_u32 s62,s62,32768
s_add_u32 m0,m0,1024
s_waitcnt vmcnt(6)
buffer_load_dwordx4 v16,s[28:31],s62 offen lds
s_add_u32 s62,s62,32768
s_add_u32 m0,m0,1024
s_waitcnt vmcnt(6)
buffer_load_dwordx4 v16,s[28:31],s62 offen lds
s_add_u32 s62,s62,32768
s_add_u32 m0,m0,1024
s_waitcnt vmcnt(6)
buffer_load_dwordx4 v16,s[28:31],s62 offen lds
s_add_u32 s62,s62,32768
s_add_u32 m0,m0,1024
s_waitcnt vmcnt(6)
buffer_load_dwordx4 v16,s[28:31],s62 offen lds
s_add_u32 s62,s62,32768
s_add_u32 m0,m0,1024
s_waitcnt vmcnt(6)
buffer_load_dwordx4 v16,s[28:31],s62 offen lds
s_add_u32 s62,s62,32768
s_add_u32 m0,m0,1024
s_waitcnt vmcnt(6)
buffer_load_dwordx4 v16,s[28:31],s62 offen lds
s_add_u32 s62,s62,32768
s_add_u32 m0,m0,1024
s_waitcnt vmcnt(6)
buffer_load_dwordx4 v16,s[28:31],s62 offen lds
s_add_u32 s62,s62,32768
s_add_u32 m0,m0,1024
s_waitcnt vmcnt(6)
buffer_load_dwordx4 v16,s[28:31],s62 offen lds
s_add_u32 s62,s62,32768
s_add_u32 m0,m0,1024
s_waitcnt vmcnt(6)
buffer_load_dwordx4 v16,s[28:31],s62 offen lds
s_add_u32 s62,s62,32768
s_add_u32 m0,m0,1024
s_waitcnt vmcnt(6)
buffer_load_dwordx4 v16,s[28:31],s62 offen lds
s_waitcnt vmcnt(6)
s_waitcnt vmcnt(16)
ds_read_b64_tr_b16 a[0:1],v17 offset:0
ds_read_b64_tr_b16 a[2:3],v17 offset:256
ds_read_b64_tr_b16 a[4:5],v17 offset:8
ds_read_b64_tr_b16 a[6:7],v17 offset:264
ds_read_b64_tr_b16 a[8:9],v17 offset:2048
ds_read_b64_tr_b16 a[10:11],v17 offset:2304
ds_read_b64_tr_b16 a[12:13],v17 offset:2056
ds_read_b64_tr_b16 a[14:15],v17 offset:2312
ds_read_b64_tr_b16 a[16:17],v17 offset:4096
ds_read_b64_tr_b16 a[18:19],v17 offset:4352
ds_read_b64_tr_b16 a[20:21],v17 offset:4104
ds_read_b64_tr_b16 a[22:23],v17 offset:4360
s_waitcnt lgkmcnt(0)
ds_read_b64_tr_b16 a[24:25],v17 offset:6144
ds_read_b64_tr_b16 a[26:27],v17 offset:6400
ds_read_b64_tr_b16 a[28:29],v17 offset:6152
ds_read_b64_tr_b16 a[30:31],v17 offset:6408
ds_read_b64_tr_b16 a[32:33],v17 offset:8192
ds_read_b64_tr_b16 a[34:35],v17 offset:8448
ds_read_b64_tr_b16 a[36:37],v17 offset:8200
ds_read_b64_tr_b16 a[38:39],v17 offset:8456
ds_read_b64_tr_b16 a[40:41],v17 offset:10240
ds_read_b64_tr_b16 a[42:43],v17 offset:10496
ds_read_b64_tr_b16 a[44:45],v17 offset:10248
ds_read_b64_tr_b16 a[46:47],v17 offset:10504
s_waitcnt lgkmcnt(0)
ds_read_b64_tr_b16 a[48:49],v17 offset:12288
ds_read_b64_tr_b16 a[50:51],v17 offset:12544
ds_read_b64_tr_b16 a[52:53],v17 offset:12296
ds_read_b64_tr_b16 a[54:55],v17 offset:12552
ds_read_b64_tr_b16 a[56:57],v17 offset:14336
ds_read_b64_tr_b16 a[58:59],v17 offset:14592
ds_read_b64_tr_b16 a[60:61],v17 offset:14344
ds_read_b64_tr_b16 a[62:63],v17 offset:14600
s_waitcnt lgkmcnt(0)
s_xor_b32 s62,s50,2
s_mul_i32 s62,s62,524288
s_add_u32 s62,s62,s54
s_add_u32 m0,s61,0
s_nop 0
buffer_load_dwordx4 v16,s[28:31],s62 offen lds
s_add_u32 s62,s62,32768
s_add_u32 m0,m0,1024
s_waitcnt vmcnt(6)
buffer_load_dwordx4 v16,s[28:31],s62 offen lds
s_add_u32 s62,s62,32768
s_add_u32 m0,m0,1024
s_waitcnt vmcnt(6)
buffer_load_dwordx4 v16,s[28:31],s62 offen lds
s_add_u32 s62,s62,32768
s_add_u32 m0,m0,1024
s_waitcnt vmcnt(6)
buffer_load_dwordx4 v16,s[28:31],s62 offen lds
s_add_u32 s62,s62,32768
s_add_u32 m0,m0,1024
s_waitcnt vmcnt(6)
buffer_load_dwordx4 v16,s[28:31],s62 offen lds
s_add_u32 s62,s62,32768
s_add_u32 m0,m0,1024
s_waitcnt vmcnt(6)
buffer_load_dwordx4 v16,s[28:31],s62 offen lds
s_add_u32 s62,s62,32768
s_add_u32 m0,m0,1024
s_waitcnt vmcnt(6)
buffer_load_dwordx4 v16,s[28:31],s62 offen lds
s_add_u32 s62,s62,32768
s_add_u32 m0,m0,1024
s_waitcnt vmcnt(6)
buffer_load_dwordx4 v16,s[28:31],s62 offen lds
s_add_u32 s62,s62,32768
s_add_u32 m0,m0,1024
s_waitcnt vmcnt(6)
buffer_load_dwordx4 v16,s[28:31],s62 offen lds
s_add_u32 s62,s62,32768
s_add_u32 m0,m0,1024
s_waitcnt vmcnt(6)
buffer_load_dwordx4 v16,s[28:31],s62 offen lds
s_add_u32 s62,s62,32768
s_add_u32 m0,m0,1024
s_waitcnt vmcnt(6)
buffer_load_dwordx4 v16,s[28:31],s62 offen lds
s_add_u32 s62,s62,32768
s_add_u32 m0,m0,1024
s_waitcnt vmcnt(6)
buffer_load_dwordx4 v16,s[28:31],s62 offen lds
s_add_u32 s62,s62,32768
s_add_u32 m0,m0,1024
s_waitcnt vmcnt(6)
buffer_load_dwordx4 v16,s[28:31],s62 offen lds
s_add_u32 s62,s62,32768
s_add_u32 m0,m0,1024
s_waitcnt vmcnt(6)
buffer_load_dwordx4 v16,s[28:31],s62 offen lds
s_add_u32 s62,s62,32768
s_add_u32 m0,m0,1024
s_waitcnt vmcnt(6)
buffer_load_dwordx4 v16,s[28:31],s62 offen lds
s_add_u32 s62,s62,32768
s_add_u32 m0,m0,1024
s_waitcnt vmcnt(6)
buffer_load_dwordx4 v16,s[28:31],s62 offen lds
s_waitcnt vmcnt(6)
s_waitcnt vmcnt(16)
ds_read_b64_tr_b16 a[64:65],v17 offset:16384
ds_read_b64_tr_b16 a[66:67],v17 offset:16640
ds_read_b64_tr_b16 a[68:69],v17 offset:16392
ds_read_b64_tr_b16 a[70:71],v17 offset:16648
ds_read_b64_tr_b16 a[72:73],v17 offset:18432
ds_read_b64_tr_b16 a[74:75],v17 offset:18688
ds_read_b64_tr_b16 a[76:77],v17 offset:18440
ds_read_b64_tr_b16 a[78:79],v17 offset:18696
ds_read_b64_tr_b16 a[80:81],v17 offset:20480
ds_read_b64_tr_b16 a[82:83],v17 offset:20736
ds_read_b64_tr_b16 a[84:85],v17 offset:20488
ds_read_b64_tr_b16 a[86:87],v17 offset:20744
s_waitcnt lgkmcnt(0)
ds_read_b64_tr_b16 a[88:89],v17 offset:22528
ds_read_b64_tr_b16 a[90:91],v17 offset:22784
ds_read_b64_tr_b16 a[92:93],v17 offset:22536
ds_read_b64_tr_b16 a[94:95],v17 offset:22792
ds_read_b64_tr_b16 a[96:97],v17 offset:24576
ds_read_b64_tr_b16 a[98:99],v17 offset:24832
ds_read_b64_tr_b16 a[100:101],v17 offset:24584
ds_read_b64_tr_b16 a[102:103],v17 offset:24840
ds_read_b64_tr_b16 a[104:105],v17 offset:26624
ds_read_b64_tr_b16 a[106:107],v17 offset:26880
ds_read_b64_tr_b16 a[108:109],v17 offset:26632
ds_read_b64_tr_b16 a[110:111],v17 offset:26888
s_waitcnt lgkmcnt(0)
ds_read_b64_tr_b16 a[112:113],v17 offset:28672
ds_read_b64_tr_b16 a[114:115],v17 offset:28928
ds_read_b64_tr_b16 a[116:117],v17 offset:28680
ds_read_b64_tr_b16 a[118:119],v17 offset:28936
ds_read_b64_tr_b16 a[120:121],v17 offset:30720
ds_read_b64_tr_b16 a[122:123],v17 offset:30976
ds_read_b64_tr_b16 a[124:125],v17 offset:30728
ds_read_b64_tr_b16 a[126:127],v17 offset:30984
s_waitcnt lgkmcnt(0)
s_xor_b32 s62,s50,3
s_mul_i32 s62,s62,524288
s_add_u32 s62,s62,s54
s_add_u32 m0,s61,16384
s_nop 0
buffer_load_dwordx4 v16,s[28:31],s62 offen lds
s_add_u32 s62,s62,32768
s_add_u32 m0,m0,1024
s_waitcnt vmcnt(6)
buffer_load_dwordx4 v16,s[28:31],s62 offen lds
s_add_u32 s62,s62,32768
s_add_u32 m0,m0,1024
s_waitcnt vmcnt(6)
buffer_load_dwordx4 v16,s[28:31],s62 offen lds
s_add_u32 s62,s62,32768
s_add_u32 m0,m0,1024
s_waitcnt vmcnt(6)
buffer_load_dwordx4 v16,s[28:31],s62 offen lds
s_add_u32 s62,s62,32768
s_add_u32 m0,m0,1024
s_waitcnt vmcnt(6)
buffer_load_dwordx4 v16,s[28:31],s62 offen lds
s_add_u32 s62,s62,32768
s_add_u32 m0,m0,1024
s_waitcnt vmcnt(6)
buffer_load_dwordx4 v16,s[28:31],s62 offen lds
s_add_u32 s62,s62,32768
s_add_u32 m0,m0,1024
s_waitcnt vmcnt(6)
buffer_load_dwordx4 v16,s[28:31],s62 offen lds
s_add_u32 s62,s62,32768
s_add_u32 m0,m0,1024
s_waitcnt vmcnt(6)
buffer_load_dwordx4 v16,s[28:31],s62 offen lds
s_add_u32 s62,s62,32768
s_add_u32 m0,m0,1024
s_waitcnt vmcnt(6)
buffer_load_dwordx4 v16,s[28:31],s62 offen lds
s_add_u32 s62,s62,32768
s_add_u32 m0,m0,1024
s_waitcnt vmcnt(6)
buffer_load_dwordx4 v16,s[28:31],s62 offen lds
s_add_u32 s62,s62,32768
s_add_u32 m0,m0,1024
s_waitcnt vmcnt(6)
buffer_load_dwordx4 v16,s[28:31],s62 offen lds
s_add_u32 s62,s62,32768
s_add_u32 m0,m0,1024
s_waitcnt vmcnt(6)
buffer_load_dwordx4 v16,s[28:31],s62 offen lds
s_add_u32 s62,s62,32768
s_add_u32 m0,m0,1024
s_waitcnt vmcnt(6)
buffer_load_dwordx4 v16,s[28:31],s62 offen lds
s_add_u32 s62,s62,32768
s_add_u32 m0,m0,1024
s_waitcnt vmcnt(6)
buffer_load_dwordx4 v16,s[28:31],s62 offen lds
s_add_u32 s62,s62,32768
s_add_u32 m0,m0,1024
s_waitcnt vmcnt(6)
buffer_load_dwordx4 v16,s[28:31],s62 offen lds
s_add_u32 s62,s62,32768
s_add_u32 m0,m0,1024
s_waitcnt vmcnt(6)
buffer_load_dwordx4 v16,s[28:31],s62 offen lds
s_waitcnt vmcnt(6)
s_waitcnt vmcnt(16)
ds_read_b64_tr_b16 a[128:129],v17 offset:0
ds_read_b64_tr_b16 a[130:131],v17 offset:256
ds_read_b64_tr_b16 a[132:133],v17 offset:8
ds_read_b64_tr_b16 a[134:135],v17 offset:264
ds_read_b64_tr_b16 a[136:137],v17 offset:2048
ds_read_b64_tr_b16 a[138:139],v17 offset:2304
ds_read_b64_tr_b16 a[140:141],v17 offset:2056
ds_read_b64_tr_b16 a[142:143],v17 offset:2312
ds_read_b64_tr_b16 a[144:145],v17 offset:4096
ds_read_b64_tr_b16 a[146:147],v17 offset:4352
ds_read_b64_tr_b16 a[148:149],v17 offset:4104
ds_read_b64_tr_b16 a[150:151],v17 offset:4360
s_waitcnt lgkmcnt(0)
ds_read_b64_tr_b16 a[152:153],v17 offset:6144
ds_read_b64_tr_b16 a[154:155],v17 offset:6400
ds_read_b64_tr_b16 a[156:157],v17 offset:6152
ds_read_b64_tr_b16 a[158:159],v17 offset:6408
ds_read_b64_tr_b16 a[160:161],v17 offset:8192
ds_read_b64_tr_b16 a[162:163],v17 offset:8448
ds_read_b64_tr_b16 a[164:165],v17 offset:8200
ds_read_b64_tr_b16 a[166:167],v17 offset:8456
ds_read_b64_tr_b16 a[168:169],v17 offset:10240
ds_read_b64_tr_b16 a[170:171],v17 offset:10496
ds_read_b64_tr_b16 a[172:173],v17 offset:10248
ds_read_b64_tr_b16 a[174:175],v17 offset:10504
s_waitcnt lgkmcnt(0)
ds_read_b64_tr_b16 a[176:177],v17 offset:12288
ds_read_b64_tr_b16 a[178:179],v17 offset:12544
ds_read_b64_tr_b16 a[180:181],v17 offset:12296
ds_read_b64_tr_b16 a[182:183],v17 offset:12552
ds_read_b64_tr_b16 a[184:185],v17 offset:14336
ds_read_b64_tr_b16 a[186:187],v17 offset:14592
ds_read_b64_tr_b16 a[188:189],v17 offset:14344
ds_read_b64_tr_b16 a[190:191],v17 offset:14600
s_waitcnt lgkmcnt(0)
s_waitcnt vmcnt(0)
ds_read_b64_tr_b16 a[192:193],v17 offset:16384
ds_read_b64_tr_b16 a[194:195],v17 offset:16640
ds_read_b64_tr_b16 a[196:197],v17 offset:16392
ds_read_b64_tr_b16 a[198:199],v17 offset:16648
ds_read_b64_tr_b16 a[200:201],v17 offset:18432
ds_read_b64_tr_b16 a[202:203],v17 offset:18688
ds_read_b64_tr_b16 a[204:205],v17 offset:18440
ds_read_b64_tr_b16 a[206:207],v17 offset:18696
ds_read_b64_tr_b16 a[208:209],v17 offset:20480
ds_read_b64_tr_b16 a[210:211],v17 offset:20736
ds_read_b64_tr_b16 a[212:213],v17 offset:20488
ds_read_b64_tr_b16 a[214:215],v17 offset:20744
s_waitcnt lgkmcnt(0)
ds_read_b64_tr_b16 a[216:217],v17 offset:22528
ds_read_b64_tr_b16 a[218:219],v17 offset:22784
ds_read_b64_tr_b16 a[220:221],v17 offset:22536
ds_read_b64_tr_b16 a[222:223],v17 offset:22792
ds_read_b64_tr_b16 a[224:225],v17 offset:24576
ds_read_b64_tr_b16 a[226:227],v17 offset:24832
ds_read_b64_tr_b16 a[228:229],v17 offset:24584
ds_read_b64_tr_b16 a[230:231],v17 offset:24840
ds_read_b64_tr_b16 a[232:233],v17 offset:26624
ds_read_b64_tr_b16 a[234:235],v17 offset:26880
ds_read_b64_tr_b16 a[236:237],v17 offset:26632
ds_read_b64_tr_b16 a[238:239],v17 offset:26888
s_waitcnt lgkmcnt(0)
ds_read_b64_tr_b16 a[240:241],v17 offset:28672
ds_read_b64_tr_b16 a[242:243],v17 offset:28928
ds_read_b64_tr_b16 a[244:245],v17 offset:28680
ds_read_b64_tr_b16 a[246:247],v17 offset:28936
ds_read_b64_tr_b16 a[248:249],v17 offset:30720
ds_read_b64_tr_b16 a[250:251],v17 offset:30976
ds_read_b64_tr_b16 a[252:253],v17 offset:30728
ds_read_b64_tr_b16 a[254:255],v17 offset:30984
s_waitcnt lgkmcnt(0)
s_mov_b32 s92,s2
s_and_b32 s93,s3,0xffff
s_mov_b32 s94,0x100
s_mov_b32 s95,0x20000
v_mbcnt_lo_u32_b32 v16,-1,0
v_mbcnt_hi_u32_b32 v16,-1,v16
v_mov_b32 v18,0
v_cmp_eq_u32 vcc,22,v16
s_nop 1
v_cndmask_b32 v18,v18,63,vcc
v_cmp_eq_u32 vcc,17,v16
s_nop 1
v_cndmask_b32 v18,v18,63,vcc
v_cmp_eq_u32 vcc,18,v16
s_nop 1
v_cndmask_b32 v18,v18,1,vcc
v_and_b32 v19,1,v16
v_cmp_eq_u32 vcc,1,v19
v_mov_b32 v19,8192
s_nop 0
v_cndmask_b32 v19,-1,v19,vcc
v_min_u32 v16,31,v16
v_lshlrev_b32 v16,2,v16
s_sub_u32 s66,s88,64
s_cmp_lg_u32 s50,0
s_cbranch_scc1 vot_79
vpoll_75:
buffer_load_dword v17,v16,s[92:95],s66 offen sc1
s_waitcnt vmcnt(0)
s_cmp_lg_u32 s56,2
s_cbranch_scc1 vck_76
v_cmp_eq_u32 vcc,v17,v19
s_and_b32 s64,vcc_lo,0xffff
s_cmp_eq_u32 s64,65535
s_cbranch_scc1 vck_76
s_mov_b32 s65,0
v_readlane_b32 s64,v17,1
s_lshr_b32 s64,s64,8
s_add_u32 s65,s65,s64
v_readlane_b32 s64,v17,3
s_lshr_b32 s64,s64,8
s_add_u32 s65,s65,s64
v_readlane_b32 s64,v17,5
s_lshr_b32 s64,s64,8
s_add_u32 s65,s65,s64
v_readlane_b32 s64,v17,7
s_lshr_b32 s64,s64,8
s_add_u32 s65,s65,s64
v_readlane_b32 s64,v17,9
s_lshr_b32 s64,s64,8
s_add_u32 s65,s65,s64
v_readlane_b32 s64,v17,11
s_lshr_b32 s64,s64,8
s_add_u32 s65,s65,s64
v_readlane_b32 s64,v17,13
s_lshr_b32 s64,s64,8
s_add_u32 s65,s65,s64
v_readlane_b32 s64,v17,15
s_lshr_b32 s64,s64,8
s_add_u32 s65,s65,s64
s_cmp_ge_u32 s65,256
s_cbranch_scc1 vok_78
s_branch vrt_77
vck_76:
v_cmp_gt_u32 vcc,v18,v17
s_cbranch_vccz vok_78
vrt_77:
s_sleep 48
s_sub_u32 s90,s90,1
s_cmp_gt_i32 s90,0
s_cbranch_scc1 vpoll_75
vok_78:
v_add_u32 v18,161536,v16
ds_write_b32 v18,v17
s_waitcnt lgkmcnt(0)
vot_79:
s_barrier
v_add_u32 v18,161536,v16
ds_read_b32 v17,v18
s_waitcnt lgkmcnt(0)
s_cmp_lg_u32 s56,2
s_cbranch_scc1 vfin_80
v_cmp_eq_u32 vcc,v17,v19
s_and_b32 s64,vcc_lo,0xffff
s_cmp_eq_u32 s64,65535
s_cbranch_scc1 vfin_80
s_mov_b32 s65,0
v_readlane_b32 s64,v17,1
s_lshr_b32 s64,s64,8
s_add_u32 s65,s65,s64
v_readlane_b32 s64,v17,3
s_lshr_b32 s64,s64,8
s_add_u32 s65,s65,s64
v_readlane_b32 s64,v17,5
s_lshr_b32 s64,s64,8
s_add_u32 s65,s65,s64
v_readlane_b32 s64,v17,7
s_lshr_b32 s64,s64,8
s_add_u32 s65,s65,s64
v_readlane_b32 s64,v17,9
s_lshr_b32 s64,s64,8
s_add_u32 s65,s65,s64
v_readlane_b32 s64,v17,11
s_lshr_b32 s64,s64,8
s_add_u32 s65,s65,s64
v_readlane_b32 s64,v17,13
s_lshr_b32 s64,s64,8
s_add_u32 s65,s65,s64
v_readlane_b32 s64,v17,15
s_lshr_b32 s64,s64,8
s_add_u32 s65,s65,s64
s_cmp_ge_u32 s65,256
s_cbranch_scc1 fl_fb
vfin_80:
s_and_b32 s56,s56,1
s_mov_b32 s67,0
s_barrier
v_lshlrev_b32 v0,4,v1
s_mov_b32 s60,0
s_mov_b32 s70,0
s_mov_b32 s55,0
s_lshl_b32 s63,s50,13
v_mov_b32 v3,v0
s_mov_b32 s73,0xffff0000
s_lshl_b32 s64,s52,2
s_add_u32 s64,s64,s50
s_mul_i32 s61,s64,8192
s_add_u32 s61,s61,150994944
s_lshl_b32 s82,s64,8
s_add_u32 s82,s82,138543104
s_mov_b32 s68,s82
s_lshl_b32 s83,s53,2
s_add_u32 s83,s83,s50
s_xor_b32 s64,s50,0
s_lshl_b32 s64,s64,13
v_add_u32 v8,s64,v0
s_xor_b32 s64,s50,1
s_lshl_b32 s64,s64,13
v_add_u32 v9,s64,v0
s_xor_b32 s64,s50,2
s_lshl_b32 s64,s64,13
v_add_u32 v10,s64,v0
s_xor_b32 s64,s50,3
s_lshl_b32 s64,s64,13
v_add_u32 v11,s64,v0
v_min_u32 v2,1,v1
v_lshlrev_b32 v2,2,v2
s_lshl_b32 s66,s83,10
s_lshr_b32 s65,s83,3
s_lshl_b32 s65,s65,8
s_and_b32 s64,s83,7
s_lshl_b32 s64,s64,2
s_add_u32 s69,s64,s65
s_add_u32 s69,s69,138547200
s_lshl_b32 s64,s53,2
s_add_u32 s64,s64,s50
s_mul_i32 s74,s64,24576
s_xor_b32 s64,s50,s52
s_sub_u32 s64,s64,1
s_max_i32 s64,s64,0
s_lshl_b32 s64,s64,11
s_add_u32 s74,s74,s64
s_add_u32 s74,s74,167772160
s_mov_b32 s75,0
s_mov_b32 s76,0
s_mov_b32 s77,0
v_lshlrev_b32 v26,11,v21
v_lshl_add_u32 v26,v22,4,v26
s_lshl_b32 s64,s83,6
v_add_u32 v18,s64,v26
v_lshlrev_b32 v26,5,v22
s_lshl_b32 s64,s83,7
s_add_u32 s64,s64,267395072
buffer_load_dwordx4 v[152:155],v26,s[20:23],s64 offen offset:0 sc1
buffer_load_dwordx4 v[156:159],v26,s[20:23],s64 offen offset:16 sc1
s_add_u32 s64,s64,24576
buffer_load_dwordx4 v[128:131],v26,s[20:23],s64 offen offset:0 sc1
buffer_load_dwordx4 v[132:135],v26,s[20:23],s64 offen offset:16 sc1
s_add_u32 s64,s64,24576
buffer_load_dwordx4 v[136:139],v26,s[20:23],s64 offen offset:0 sc1
buffer_load_dwordx4 v[140:143],v26,s[20:23],s64 offen offset:16 sc1
s_add_u32 s64,s64,24576
buffer_load_dwordx4 v[144:147],v26,s[20:23],s64 offen offset:0 sc1
buffer_load_dwordx4 v[148:151],v26,s[20:23],s64 offen offset:16 sc1
s_add_u32 s64,s64,24576
s_waitcnt vmcnt(0)
v_pk_add_f32 v[152:153],v[152:153],v[128:129]
v_pk_add_f32 v[136:137],v[136:137],v[144:145]
v_pk_add_f32 v[154:155],v[154:155],v[130:131]
v_pk_add_f32 v[138:139],v[138:139],v[146:147]
v_pk_add_f32 v[156:157],v[156:157],v[132:133]
v_pk_add_f32 v[140:141],v[140:141],v[148:149]
v_pk_add_f32 v[158:159],v[158:159],v[134:135]
v_pk_add_f32 v[142:143],v[142:143],v[150:151]
v_pk_add_f32 v[152:153],v[152:153],v[136:137]
v_pk_add_f32 v[154:155],v[154:155],v[138:139]
v_pk_add_f32 v[156:157],v[156:157],v[140:141]
v_pk_add_f32 v[158:159],v[158:159],v[142:143]
v_cvt_pk_bf16_f32 v128,v152,v153
v_cvt_pk_bf16_f32 v129,v154,v155
v_cvt_pk_bf16_f32 v130,v156,v157
v_cvt_pk_bf16_f32 v131,v158,v159
v_lshlrev_b32 v152,16,v128
v_and_b32 v153,s73,v128
v_lshlrev_b32 v154,16,v129
v_and_b32 v155,s73,v129
v_lshlrev_b32 v156,16,v130
v_and_b32 v157,s73,v130
v_lshlrev_b32 v158,16,v131
v_and_b32 v159,s73,v131
v_mov_b32 v204,-1
v_mov_b32 v205,-1
v_mov_b32 v206,-1
v_mov_b32 v207,-1
s_cmp_eq_u32 s50,s52
s_cbranch_scc1 lfin_81
s_add_u32 s71,s60,0
s_and_b32 s68,s71,1
s_lshl_b32 s68,s68,3
s_add_u32 s68,s68,s82
s_lshr_b32 s71,s71,1
s_add_u32 s71,s71,1
plp_87:
buffer_load_dword v16,v2,s[20:23],s68 offen sc1
s_waitcnt vmcnt(0)
v_cmp_gt_u32 vcc,s71,v16
s_cbranch_vccz pok_88
s_sleep 4
s_sub_u32 s90,s90,1
s_cmp_gt_i32 s90,0
s_cbranch_scc1 plp_87
pok_88:
lag_86:
s_add_u32 m0,s70,s63
s_add_u32 s62,s61,4096
buffer_load_dwordx4 v3,s[20:23],s61 offen offset:0 lds
buffer_load_dwordx4 v3,s[20:23],s61 offen offset:1024 lds
buffer_load_dwordx4 v3,s[20:23],s61 offen offset:2048 lds
buffer_load_dwordx4 v3,s[20:23],s61 offen offset:3072 lds
s_add_u32 m0,m0,4096
s_nop 0
buffer_load_dwordx4 v3,s[20:23],s62 offen offset:0 lds
buffer_load_dwordx4 v3,s[20:23],s62 offen offset:1024 lds
buffer_load_dwordx4 v3,s[20:23],s62 offen offset:2048 lds
buffer_load_dwordx4 v3,s[20:23],s62 offen offset:3072 lds
s_add_u32 s61,s61,131072
s_add_u32 s70,s70,32768
s_and_b32 s70,s70,0x1ffff
buffer_load_dword v17,off,s[20:23],s69
buffer_load_dword v17,off,s[20:23],s69
top_82:
s_add_u32 s71,s60,1
s_and_b32 s68,s71,1
s_lshl_b32 s68,s68,3
s_add_u32 s68,s68,s82
s_lshr_b32 s71,s71,1
s_add_u32 s71,s71,1
buffer_load_dword v16,v2,s[20:23],s68 offen sc1
v_add_u32 v4,s55,v8
v_add_u32 v5,s55,v9
v_add_u32 v6,s55,v10
v_add_u32 v7,s55,v11
s_add_u32 s55,s55,32768
s_and_b32 s55,s55,0x1ffff
s_waitcnt vmcnt(10)
ds_read_b128 v[64:67],v4 offset:0
s_waitcnt vmcnt(9)
ds_read_b128 v[68:71],v4 offset:1024
s_waitcnt vmcnt(8)
ds_read_b128 v[72:75],v4 offset:2048
s_waitcnt lgkmcnt(2)
v_mfma_f32_16x16x32_bf16 v[32:35],a[0:3],v[64:67],0
v_mfma_f32_16x16x32_bf16 v[36:39],a[4:7],v[64:67],0
s_waitcnt vmcnt(7)
ds_read_b128 v[76:79],v4 offset:3072
s_waitcnt lgkmcnt(2)
v_mfma_f32_16x16x32_bf16 v[32:35],a[8:11],v[68:71],v[32:35]
v_mfma_f32_16x16x32_bf16 v[36:39],a[12:15],v[68:71],v[36:39]
s_waitcnt vmcnt(6)
ds_read_b128 v[80:83],v4 offset:4096
s_waitcnt lgkmcnt(2)
v_mfma_f32_16x16x32_bf16 v[32:35],a[16:19],v[72:75],v[32:35]
v_mfma_f32_16x16x32_bf16 v[36:39],a[20:23],v[72:75],v[36:39]
s_waitcnt vmcnt(5)
ds_read_b128 v[84:87],v4 offset:5120
s_waitcnt lgkmcnt(2)
v_mfma_f32_16x16x32_bf16 v[32:35],a[24:27],v[76:79],v[32:35]
v_mfma_f32_16x16x32_bf16 v[36:39],a[28:31],v[76:79],v[36:39]
s_waitcnt vmcnt(4)
ds_read_b128 v[88:91],v4 offset:6144
s_waitcnt lgkmcnt(2)
v_mfma_f32_16x16x32_bf16 v[32:35],a[32:35],v[80:83],v[32:35]
v_mfma_f32_16x16x32_bf16 v[36:39],a[36:39],v[80:83],v[36:39]
s_waitcnt vmcnt(3)
ds_read_b128 v[92:95],v4 offset:7168
s_barrier
s_waitcnt lgkmcnt(2)
v_mfma_f32_16x16x32_bf16 v[32:35],a[40:43],v[84:87],v[32:35]
v_mfma_f32_16x16x32_bf16 v[36:39],a[44:47],v[84:87],v[36:39]
ds_read_b128 v[96:99],v5 offset:0
s_waitcnt lgkmcnt(2)
v_mfma_f32_16x16x32_bf16 v[32:35],a[48:51],v[88:91],v[32:35]
ds_read_b128 v[100:103],v5 offset:1024
ds_read_b128 v[104:107],v5 offset:2048
v_mfma_f32_16x16x32_bf16 v[36:39],a[52:55],v[88:91],v[36:39]
s_waitcnt lgkmcnt(3)
v_mfma_f32_16x16x32_bf16 v[32:35],a[56:59],v[92:95],v[32:35]
ds_read_b128 v[108:111],v5 offset:3072
ds_read_b128 v[112:115],v5 offset:4096
v_mfma_f32_16x16x32_bf16 v[36:39],a[60:63],v[92:95],v[36:39]
s_waitcnt lgkmcnt(4)
v_mfma_f32_16x16x32_bf16 v[32:35],a[64:67],v[96:99],v[32:35]
ds_read_b128 v[116:119],v5 offset:5120
ds_read_b128 v[120:123],v5 offset:6144
v_mfma_f32_16x16x32_bf16 v[36:39],a[68:71],v[96:99],v[36:39]
s_waitcnt lgkmcnt(5)
v_mfma_f32_16x16x32_bf16 v[32:35],a[72:75],v[100:103],v[32:35]
ds_read_b128 v[124:127],v5 offset:7168
v_mfma_f32_16x16x32_bf16 v[36:39],a[76:79],v[100:103],v[36:39]
s_waitcnt lgkmcnt(5)
v_mfma_f32_16x16x32_bf16 v[32:35],a[80:83],v[104:107],v[32:35]
ds_read_b128 v[64:67],v6 offset:0
v_mfma_f32_16x16x32_bf16 v[36:39],a[84:87],v[104:107],v[36:39]
s_waitcnt lgkmcnt(5)
v_mfma_f32_16x16x32_bf16 v[32:35],a[88:91],v[108:111],v[32:35]
ds_read_b128 v[68:71],v6 offset:1024
v_mfma_f32_16x16x32_bf16 v[36:39],a[92:95],v[108:111],v[36:39]
s_waitcnt lgkmcnt(5)
v_mfma_f32_16x16x32_bf16 v[32:35],a[96:99],v[112:115],v[32:35]
ds_read_b128 v[72:75],v6 offset:2048
v_mfma_f32_16x16x32_bf16 v[36:39],a[100:103],v[112:115],v[36:39]
s_waitcnt lgkmcnt(5)
v_mfma_f32_16x16x32_bf16 v[32:35],a[104:107],v[116:119],v[32:35]
ds_read_b128 v[76:79],v6 offset:3072
v_mfma_f32_16x16x32_bf16 v[36:39],a[108:111],v[116:119],v[36:39]
s_waitcnt lgkmcnt(5)
v_mfma_f32_16x16x32_bf16 v[32:35],a[112:115],v[120:123],v[32:35]
ds_read_b128 v[80:83],v6 offset:4096
v_mfma_f32_16x16x32_bf16 v[36:39],a[116:119],v[120:123],v[36:39]
s_waitcnt lgkmcnt(5)
v_mfma_f32_16x16x32_bf16 v[32:35],a[120:123],v[124:127],v[32:35]
ds_read_b128 v[84:87],v6 offset:5120
v_mfma_f32_16x16x32_bf16 v[36:39],a[124:127],v[124:127],v[36:39]
s_waitcnt lgkmcnt(5)
v_mfma_f32_16x16x32_bf16 v[32:35],a[128:131],v[64:67],v[32:35]
ds_read_b128 v[88:91],v6 offset:6144
v_mfma_f32_16x16x32_bf16 v[36:39],a[132:135],v[64:67],v[36:39]
s_waitcnt lgkmcnt(5)
v_mfma_f32_16x16x32_bf16 v[32:35],a[136:139],v[68:71],v[32:35]
ds_read_b128 v[92:95],v6 offset:7168
v_mfma_f32_16x16x32_bf16 v[36:39],a[140:143],v[68:71],v[36:39]
s_waitcnt lgkmcnt(5)
v_mfma_f32_16x16x32_bf16 v[32:35],a[144:147],v[72:75],v[32:35]
ds_read_b128 v[96:99],v7 offset:0
v_mfma_f32_16x16x32_bf16 v[36:39],a[148:151],v[72:75],v[36:39]
s_waitcnt lgkmcnt(5)
v_mfma_f32_16x16x32_bf16 v[32:35],a[152:155],v[76:79],v[32:35]
ds_read_b128 v[100:103],v7 offset:1024
v_mfma_f32_16x16x32_bf16 v[36:39],a[156:159],v[76:79],v[36:39]
s_waitcnt lgkmcnt(5)
v_mfma_f32_16x16x32_bf16 v[32:35],a[160:163],v[80:83],v[32:35]
ds_read_b128 v[104:107],v7 offset:2048
v_mfma_f32_16x16x32_bf16 v[36:39],a[164:167],v[80:83],v[36:39]
s_waitcnt lgkmcnt(5)
v_mfma_f32_16x16x32_bf16 v[32:35],a[168:171],v[84:87],v[32:35]
ds_read_b128 v[108:111],v7 offset:3072
v_mfma_f32_16x16x32_bf16 v[36:39],a[172:175],v[84:87],v[36:39]
s_waitcnt vmcnt(0)
v_cmp_gt_u32 vcc,s71,v16
s_cbranch_vccnz vN_83
s_waitcnt lgkmcnt(5)
v_mfma_f32_16x16x32_bf16 v[32:35],a[176:179],v[88:91],v[32:35]
ds_read_b128 v[112:115],v7 offset:4096
s_add_u32 m0,s70,s63
v_mfma_f32_16x16x32_bf16 v[36:39],a[180:183],v[88:91],v[36:39]
s_add_u32 s62,s61,4096
s_waitcnt lgkmcnt(5)
v_mfma_f32_16x16x32_bf16 v[32:35],a[184:187],v[92:95],v[32:35]
ds_read_b128 v[116:119],v7 offset:5120
buffer_load_dwordx4 v3,s[20:23],s61 offen offset:0 lds
v_mfma_f32_16x16x32_bf16 v[36:39],a[188:191],v[92:95],v[36:39]
buffer_load_dwordx4 v3,s[20:23],s61 offen offset:1024 lds
s_waitcnt lgkmcnt(5)
v_mfma_f32_16x16x32_bf16 v[32:35],a[192:195],v[96:99],v[32:35]
ds_read_b128 v[120:123],v7 offset:6144
buffer_load_dwordx4 v3,s[20:23],s61 offen offset:2048 lds
v_mfma_f32_16x16x32_bf16 v[36:39],a[196:199],v[96:99],v[36:39]
buffer_load_dwordx4 v3,s[20:23],s61 offen offset:3072 lds
s_waitcnt lgkmcnt(5)
v_mfma_f32_16x16x32_bf16 v[32:35],a[200:203],v[100:103],v[32:35]
ds_read_b128 v[124:127],v7 offset:7168
s_add_u32 m0,m0,4096
v_mfma_f32_16x16x32_bf16 v[36:39],a[204:207],v[100:103],v[36:39]
buffer_load_dwordx4 v3,s[20:23],s62 offen offset:0 lds
s_waitcnt lgkmcnt(5)
v_mfma_f32_16x16x32_bf16 v[32:35],a[208:211],v[104:107],v[32:35]
buffer_load_dwordx4 v3,s[20:23],s62 offen offset:1024 lds
v_mfma_f32_16x16x32_bf16 v[36:39],a[212:215],v[104:107],v[36:39]
buffer_load_dwordx4 v3,s[20:23],s62 offen offset:2048 lds
s_waitcnt lgkmcnt(4)
v_mfma_f32_16x16x32_bf16 v[32:35],a[216:219],v[108:111],v[32:35]
buffer_load_dwordx4 v3,s[20:23],s62 offen offset:3072 lds
v_mfma_f32_16x16x32_bf16 v[36:39],a[220:223],v[108:111],v[36:39]
s_add_u32 s61,s61,131072
s_waitcnt lgkmcnt(3)
v_mfma_f32_16x16x32_bf16 v[32:35],a[224:227],v[112:115],v[32:35]
s_add_u32 s70,s70,32768
v_mfma_f32_16x16x32_bf16 v[36:39],a[228:231],v[112:115],v[36:39]
s_and_b32 s70,s70,0x1ffff
s_waitcnt lgkmcnt(2)
v_mfma_f32_16x16x32_bf16 v[32:35],a[232:235],v[116:119],v[32:35]
v_mfma_f32_16x16x32_bf16 v[36:39],a[236:239],v[116:119],v[36:39]
s_waitcnt lgkmcnt(1)
v_mfma_f32_16x16x32_bf16 v[32:35],a[240:243],v[120:123],v[32:35]
v_mfma_f32_16x16x32_bf16 v[36:39],a[244:247],v[120:123],v[36:39]
s_waitcnt lgkmcnt(0)
v_mfma_f32_16x16x32_bf16 v[32:35],a[248:251],v[124:127],v[32:35]
v_mfma_f32_16x16x32_bf16 v[36:39],a[252:255],v[124:127],v[36:39]
s_mov_b32 s72,1
join_84:
s_add_u32 s64,s74,s75
s_cmp_eq_u32 s56,1
s_cbranch_scc1 b1_89
s_nop 2
buffer_store_dwordx4 v[32:35],v0,s[20:23],s64 offen offset:0
buffer_store_dwordx4 v[36:39],v0,s[20:23],s64 offen offset:1024
b2_90:
s_add_u32 s75,s75,6144
s_cmp_eq_u32 s75,24576
s_cselect_b32 s75,0,s75
s_add_u32 s60,s60,1
s_cmp_eq_u32 s72,0
s_cbranch_scc1 slowp_85
s_branch top_82
slowp_85:
s_waitcnt vmcnt(2)
v_cmp_gt_u32 vcc,s71,v16
s_cbranch_vccz lag_86
s_cmp_ge_u32 s60,128
s_cbranch_scc1 done_74
plp_91:
buffer_load_dword v16,v2,s[20:23],s68 offen sc1
s_waitcnt vmcnt(0)
v_cmp_gt_u32 vcc,s71,v16
s_cbranch_vccz pok_92
s_sleep 4
s_sub_u32 s90,s90,1
s_cmp_gt_i32 s90,0
s_cbranch_scc1 plp_91
pok_92:
s_branch lag_86
lfin_81:
s_add_u32 s71,s60,0
s_and_b32 s68,s71,1
s_lshl_b32 s68,s68,3
s_add_u32 s68,s68,s82
s_lshr_b32 s71,s71,1
s_add_u32 s71,s71,1
plp_98:
buffer_load_dword v16,v2,s[20:23],s68 offen sc1
s_waitcnt vmcnt(0)
v_cmp_gt_u32 vcc,s71,v16
s_cbranch_vccz pok_99
s_sleep 4
s_sub_u32 s90,s90,1
s_cmp_gt_i32 s90,0
s_cbranch_scc1 plp_98
pok_99:
lag_97:
s_add_u32 m0,s70,s63
s_add_u32 s62,s61,4096
buffer_load_dwordx4 v3,s[20:23],s61 offen offset:0 lds
buffer_load_dwordx4 v3,s[20:23],s61 offen offset:1024 lds
buffer_load_dwordx4 v3,s[20:23],s61 offen offset:2048 lds
buffer_load_dwordx4 v3,s[20:23],s61 offen offset:3072 lds
s_add_u32 m0,m0,4096
s_nop 0
buffer_load_dwordx4 v3,s[20:23],s62 offen offset:0 lds
buffer_load_dwordx4 v3,s[20:23],s62 offen offset:1024 lds
buffer_load_dwordx4 v3,s[20:23],s62 offen offset:2048 lds
buffer_load_dwordx4 v3,s[20:23],s62 offen offset:3072 lds
s_add_u32 s61,s61,131072
s_add_u32 s70,s70,32768
s_and_b32 s70,s70,0x1ffff
top_93:
s_add_u32 s71,s60,1
s_and_b32 s68,s71,1
s_lshl_b32 s68,s68,3
s_add_u32 s68,s68,s82
s_lshr_b32 s71,s71,1
s_add_u32 s71,s71,1
buffer_load_dword v16,v2,s[20:23],s68 offen sc1
s_add_u32 s64,s74,s75
s_add_u32 s65,s64,4096
buffer_load_dwordx4 v[128:131],v0,s[20:23],s64 offen offset:0 sc1
buffer_load_dwordx4 v[132:135],v0,s[20:23],s64 offen offset:1024 sc1
buffer_load_dwordx4 v[136:139],v0,s[20:23],s64 offen offset:2048 sc1
buffer_load_dwordx4 v[140:143],v0,s[20:23],s64 offen offset:3072 sc1
buffer_load_dwordx4 v[144:147],v0,s[20:23],s65 offen offset:0 sc1
buffer_load_dwordx4 v[148:151],v0,s[20:23],s65 offen offset:1024 sc1
s_and_b32 s64,s66,0xffff8000
buffer_load_dwordx4 v[160:163],v18,s[24:27],s64 offen
v_add_u32 v4,s55,v8
v_add_u32 v5,s55,v9
v_add_u32 v6,s55,v10
v_add_u32 v7,s55,v11
s_add_u32 s55,s55,32768
s_and_b32 s55,s55,0x1ffff
s_waitcnt vmcnt(15)
ds_read_b128 v[64:67],v4 offset:0
s_waitcnt vmcnt(14)
ds_read_b128 v[68:71],v4 offset:1024
s_waitcnt vmcnt(13)
ds_read_b128 v[72:75],v4 offset:2048
s_waitcnt lgkmcnt(2)
v_mfma_f32_16x16x32_bf16 v[32:35],a[0:3],v[64:67],0
v_mfma_f32_16x16x32_bf16 v[36:39],a[4:7],v[64:67],0
s_waitcnt vmcnt(12)
ds_read_b128 v[76:79],v4 offset:3072
s_waitcnt lgkmcnt(2)
v_mfma_f32_16x16x32_bf16 v[32:35],a[8:11],v[68:71],v[32:35]
v_mfma_f32_16x16x32_bf16 v[36:39],a[12:15],v[68:71],v[36:39]
s_waitcnt vmcnt(11)
ds_read_b128 v[80:83],v4 offset:4096
s_waitcnt lgkmcnt(2)
v_mfma_f32_16x16x32_bf16 v[32:35],a[16:19],v[72:75],v[32:35]
v_mfma_f32_16x16x32_bf16 v[36:39],a[20:23],v[72:75],v[36:39]
s_waitcnt vmcnt(10)
ds_read_b128 v[84:87],v4 offset:5120
s_waitcnt lgkmcnt(2)
v_mfma_f32_16x16x32_bf16 v[32:35],a[24:27],v[76:79],v[32:35]
v_mfma_f32_16x16x32_bf16 v[36:39],a[28:31],v[76:79],v[36:39]
s_waitcnt vmcnt(9)
ds_read_b128 v[88:91],v4 offset:6144
s_waitcnt lgkmcnt(2)
v_mfma_f32_16x16x32_bf16 v[32:35],a[32:35],v[80:83],v[32:35]
v_mfma_f32_16x16x32_bf16 v[36:39],a[36:39],v[80:83],v[36:39]
s_waitcnt vmcnt(8)
ds_read_b128 v[92:95],v4 offset:7168
s_barrier
s_waitcnt lgkmcnt(2)
v_mfma_f32_16x16x32_bf16 v[32:35],a[40:43],v[84:87],v[32:35]
v_mfma_f32_16x16x32_bf16 v[36:39],a[44:47],v[84:87],v[36:39]
ds_read_b128 v[96:99],v5 offset:0
s_waitcnt lgkmcnt(2)
v_mfma_f32_16x16x32_bf16 v[32:35],a[48:51],v[88:91],v[32:35]
ds_read_b128 v[100:103],v5 offset:1024
ds_read_b128 v[104:107],v5 offset:2048
v_mfma_f32_16x16x32_bf16 v[36:39],a[52:55],v[88:91],v[36:39]
s_waitcnt lgkmcnt(3)
v_mfma_f32_16x16x32_bf16 v[32:35],a[56:59],v[92:95],v[32:35]
ds_read_b128 v[108:111],v5 offset:3072
ds_read_b128 v[112:115],v5 offset:4096
v_mfma_f32_16x16x32_bf16 v[36:39],a[60:63],v[92:95],v[36:39]
s_waitcnt lgkmcnt(4)
v_mfma_f32_16x16x32_bf16 v[32:35],a[64:67],v[96:99],v[32:35]
ds_read_b128 v[116:119],v5 offset:5120
ds_read_b128 v[120:123],v5 offset:6144
v_mfma_f32_16x16x32_bf16 v[36:39],a[68:71],v[96:99],v[36:39]
s_waitcnt lgkmcnt(5)
v_mfma_f32_16x16x32_bf16 v[32:35],a[72:75],v[100:103],v[32:35]
ds_read_b128 v[124:127],v5 offset:7168
v_mfma_f32_16x16x32_bf16 v[36:39],a[76:79],v[100:103],v[36:39]
s_waitcnt lgkmcnt(5)
v_mfma_f32_16x16x32_bf16 v[32:35],a[80:83],v[104:107],v[32:35]
ds_read_b128 v[64:67],v6 offset:0
v_mfma_f32_16x16x32_bf16 v[36:39],a[84:87],v[104:107],v[36:39]
s_waitcnt lgkmcnt(5)
v_mfma_f32_16x16x32_bf16 v[32:35],a[88:91],v[108:111],v[32:35]
ds_read_b128 v[68:71],v6 offset:1024
v_mfma_f32_16x16x32_bf16 v[36:39],a[92:95],v[108:111],v[36:39]
s_waitcnt lgkmcnt(5)
v_mfma_f32_16x16x32_bf16 v[32:35],a[96:99],v[112:115],v[32:35]
ds_read_b128 v[72:75],v6 offset:2048
v_mfma_f32_16x16x32_bf16 v[36:39],a[100:103],v[112:115],v[36:39]
s_waitcnt lgkmcnt(5)
v_mfma_f32_16x16x32_bf16 v[32:35],a[104:107],v[116:119],v[32:35]
ds_read_b128 v[76:79],v6 offset:3072
v_mfma_f32_16x16x32_bf16 v[36:39],a[108:111],v[116:119],v[36:39]
s_waitcnt lgkmcnt(5)
v_mfma_f32_16x16x32_bf16 v[32:35],a[112:115],v[120:123],v[32:35]
ds_read_b128 v[80:83],v6 offset:4096
v_mfma_f32_16x16x32_bf16 v[36:39],a[116:119],v[120:123],v[36:39]
s_waitcnt lgkmcnt(5)
v_mfma_f32_16x16x32_bf16 v[32:35],a[120:123],v[124:127],v[32:35]
ds_read_b128 v[84:87],v6 offset:5120
v_mfma_f32_16x16x32_bf16 v[36:39],a[124:127],v[124:127],v[36:39]
s_waitcnt lgkmcnt(5)
v_mfma_f32_16x16x32_bf16 v[32:35],a[128:131],v[64:67],v[32:35]
ds_read_b128 v[88:91],v6 offset:6144
v_mfma_f32_16x16x32_bf16 v[36:39],a[132:135],v[64:67],v[36:39]
s_waitcnt lgkmcnt(5)
v_mfma_f32_16x16x32_bf16 v[32:35],a[136:139],v[68:71],v[32:35]
ds_read_b128 v[92:95],v6 offset:7168
v_mfma_f32_16x16x32_bf16 v[36:39],a[140:143],v[68:71],v[36:39]
s_waitcnt lgkmcnt(5)
v_mfma_f32_16x16x32_bf16 v[32:35],a[144:147],v[72:75],v[32:35]
ds_read_b128 v[96:99],v7 offset:0
v_mfma_f32_16x16x32_bf16 v[36:39],a[148:151],v[72:75],v[36:39]
s_waitcnt lgkmcnt(5)
v_mfma_f32_16x16x32_bf16 v[32:35],a[152:155],v[76:79],v[32:35]
ds_read_b128 v[100:103],v7 offset:1024
v_mfma_f32_16x16x32_bf16 v[36:39],a[156:159],v[76:79],v[36:39]
s_waitcnt lgkmcnt(5)
v_mfma_f32_16x16x32_bf16 v[32:35],a[160:163],v[80:83],v[32:35]
ds_read_b128 v[104:107],v7 offset:2048
v_mfma_f32_16x16x32_bf16 v[36:39],a[164:167],v[80:83],v[36:39]
s_waitcnt lgkmcnt(5)
v_mfma_f32_16x16x32_bf16 v[32:35],a[168:171],v[84:87],v[32:35]
ds_read_b128 v[108:111],v7 offset:3072
v_mfma_f32_16x16x32_bf16 v[36:39],a[172:175],v[84:87],v[36:39]
s_waitcnt vmcnt(0)
s_cmp_eq_u32 s77,0
s_cbranch_scc1 np_100
ck_101:
v_pk_add_f32 v[128:129],v[128:129],v[136:137]
v_pk_add_f32 v[144:145],v[144:145],v[40:41]
v_pk_add_f32 v[130:131],v[130:131],v[138:139]
v_pk_add_f32 v[146:147],v[146:147],v[42:43]
v_pk_add_f32 v[132:133],v[132:133],v[140:141]
v_pk_add_f32 v[148:149],v[148:149],v[44:45]
v_pk_add_f32 v[134:135],v[134:135],v[142:143]
v_pk_add_f32 v[150:151],v[150:151],v[46:47]
v_pk_add_f32 v[128:129],v[128:129],v[144:145]
v_pk_add_f32 v[130:131],v[130:131],v[146:147]
v_pk_add_f32 v[132:133],v[132:133],v[148:149]
v_pk_add_f32 v[134:135],v[134:135],v[150:151]
v_pk_add_f32 v[168:169],v[128:129],v[130:131]
v_pk_add_f32 v[170:171],v[132:133],v[134:135]
v_pk_add_f32 v[168:169],v[168:169],v[170:171]
v_cmp_u_f32 vcc,v168,v169
s_cbranch_vccnz rt_102
go_103:
v_lshlrev_b32 v168,16,v160
v_and_b32 v169,s73,v160
v_lshlrev_b32 v170,16,v161
v_and_b32 v171,s73,v161
v_lshlrev_b32 v172,16,v162
v_and_b32 v173,s73,v162
v_lshlrev_b32 v174,16,v163
v_and_b32 v175,s73,v163
v_fma_f32 v168,v128,v152,v168
v_fma_f32 v169,v129,v153,v169
v_fma_f32 v170,v130,v154,v170
v_fma_f32 v171,v131,v155,v171
v_fma_f32 v172,v132,v156,v172
v_fma_f32 v173,v133,v157,v173
v_fma_f32 v174,v134,v158,v174
v_fma_f32 v175,v135,v159,v175
v_cvt_pk_bf16_f32 v176,v168,v169
v_cvt_pk_bf16_f32 v177,v170,v171
v_cvt_pk_bf16_f32 v178,v172,v173
v_cvt_pk_bf16_f32 v179,v174,v175
s_add_u32 s64,s66,201326592
buffer_store_dwordx4 v[176:179],v0,s[20:23],s64 offen sc1
s_add_u32 s64,s74,s75
s_add_u32 s65,s64,4096
s_cmp_eq_u32 s56,1
s_cbranch_scc1 b1_104
buffer_store_dwordx4 v[204:207],v0,s[20:23],s64 offen offset:0
buffer_store_dwordx4 v[204:207],v0,s[20:23],s64 offen offset:1024
buffer_store_dwordx4 v[204:207],v0,s[20:23],s64 offen offset:2048
buffer_store_dwordx4 v[204:207],v0,s[20:23],s64 offen offset:3072
buffer_store_dwordx4 v[204:207],v0,s[20:23],s65 offen offset:0
buffer_store_dwordx4 v[204:207],v0,s[20:23],s65 offen offset:1024
b2_105:
s_add_u32 s66,s66,32768
s_add_u32 s75,s75,6144
s_cmp_eq_u32 s75,24576
s_cselect_b32 s75,0,s75
s_add_u32 s76,s76,1
s_mov_b32 s77,0
np_100:
v_cmp_gt_u32 vcc,s71,v16
s_cbranch_vccnz vN_94
s_waitcnt lgkmcnt(5)
v_mfma_f32_16x16x32_bf16 v[32:35],a[176:179],v[88:91],v[32:35]
ds_read_b128 v[112:115],v7 offset:4096
s_add_u32 m0,s70,s63
v_mfma_f32_16x16x32_bf16 v[36:39],a[180:183],v[88:91],v[36:39]
s_add_u32 s62,s61,4096
s_waitcnt lgkmcnt(5)
v_mfma_f32_16x16x32_bf16 v[32:35],a[184:187],v[92:95],v[32:35]
ds_read_b128 v[116:119],v7 offset:5120
buffer_load_dwordx4 v3,s[20:23],s61 offen offset:0 lds
v_mfma_f32_16x16x32_bf16 v[36:39],a[188:191],v[92:95],v[36:39]
buffer_load_dwordx4 v3,s[20:23],s61 offen offset:1024 lds
s_waitcnt lgkmcnt(5)
v_mfma_f32_16x16x32_bf16 v[32:35],a[192:195],v[96:99],v[32:35]
ds_read_b128 v[120:123],v7 offset:6144
buffer_load_dwordx4 v3,s[20:23],s61 offen offset:2048 lds
v_mfma_f32_16x16x32_bf16 v[36:39],a[196:199],v[96:99],v[36:39]
buffer_load_dwordx4 v3,s[20:23],s61 offen offset:3072 lds
s_waitcnt lgkmcnt(5)
v_mfma_f32_16x16x32_bf16 v[32:35],a[200:203],v[100:103],v[32:35]
ds_read_b128 v[124:127],v7 offset:7168
s_add_u32 m0,m0,4096
v_mfma_f32_16x16x32_bf16 v[36:39],a[204:207],v[100:103],v[36:39]
buffer_load_dwordx4 v3,s[20:23],s62 offen offset:0 lds
s_waitcnt lgkmcnt(5)
v_mfma_f32_16x16x32_bf16 v[32:35],a[208:211],v[104:107],v[32:35]
buffer_load_dwordx4 v3,s[20:23],s62 offen offset:1024 lds
v_mfma_f32_16x16x32_bf16 v[36:39],a[212:215],v[104:107],v[36:39]
buffer_load_dwordx4 v3,s[20:23],s62 offen offset:2048 lds
s_waitcnt lgkmcnt(4)
v_mfma_f32_16x16x32_bf16 v[32:35],a[216:219],v[108:111],v[32:35]
buffer_load_dwordx4 v3,s[20:23],s62 offen offset:3072 lds
v_mfma_f32_16x16x32_bf16 v[36:39],a[220:223],v[108:111],v[36:39]
s_add_u32 s61,s61,131072
s_waitcnt lgkmcnt(3)
v_mfma_f32_16x16x32_bf16 v[32:35],a[224:227],v[112:115],v[32:35]
s_add_u32 s70,s70,32768
v_mfma_f32_16x16x32_bf16 v[36:39],a[228:231],v[112:115],v[36:39]
s_and_b32 s70,s70,0x1ffff
s_waitcnt lgkmcnt(2)
v_mfma_f32_16x16x32_bf16 v[32:35],a[232:235],v[116:119],v[32:35]
v_mfma_f32_16x16x32_bf16 v[36:39],a[236:239],v[116:119],v[36:39]
s_waitcnt lgkmcnt(1)
v_mfma_f32_16x16x32_bf16 v[32:35],a[240:243],v[120:123],v[32:35]
v_mfma_f32_16x16x32_bf16 v[36:39],a[244:247],v[120:123],v[36:39]
s_waitcnt lgkmcnt(0)
v_mfma_f32_16x16x32_bf16 v[32:35],a[248:251],v[124:127],v[32:35]
v_mfma_f32_16x16x32_bf16 v[36:39],a[252:255],v[124:127],v[36:39]
s_mov_b32 s72,1
join_95:
s_nop 5
v_mov_b32 v40,v32
v_mov_b32 v41,v33
v_mov_b32 v42,v34
v_mov_b32 v43,v35
v_mov_b32 v44,v36
v_mov_b32 v45,v37
v_mov_b32 v46,v38
v_mov_b32 v47,v39
s_mov_b32 s77,1
s_add_u32 s60,s60,1
s_cmp_eq_u32 s72,0
s_cbranch_scc1 slowp_96
s_waitcnt vmcnt(14)
v_mov_b32 v17,s76
s_mov_b64 exec,1
buffer_store_dword v17,off,s[20:23],s69 sc1
s_mov_b64 exec,-1
s_branch top_93
slowp_96:
s_waitcnt vmcnt(0)
v_mov_b32 v17,s76
s_mov_b64 exec,1
buffer_store_dword v17,off,s[20:23],s69 sc1
s_mov_b64 exec,-1
v_cmp_gt_u32 vcc,s71,v16
s_cbranch_vccz lag_97
s_and_b32 s64,s66,0xffff8000
buffer_load_dwordx4 v[160:163],v18,s[24:27],s64 offen
s_add_u32 s64,s74,s75
s_add_u32 s65,s64,4096
buffer_load_dwordx4 v[128:131],v0,s[20:23],s64 offen offset:0 sc1
buffer_load_dwordx4 v[132:135],v0,s[20:23],s64 offen offset:1024 sc1
buffer_load_dwordx4 v[136:139],v0,s[20:23],s64 offen offset:2048 sc1
buffer_load_dwordx4 v[140:143],v0,s[20:23],s64 offen offset:3072 sc1
buffer_load_dwordx4 v[144:147],v0,s[20:23],s65 offen offset:0 sc1
buffer_load_dwordx4 v[148:151],v0,s[20:23],s65 offen offset:1024 sc1
s_waitcnt vmcnt(0)
ck_106:
v_pk_add_f32 v[128:129],v[128:129],v[136:137]
v_pk_add_f32 v[144:145],v[144:145],v[40:41]
v_pk_add_f32 v[130:131],v[130:131],v[138:139]
v_pk_add_f32 v[146:147],v[146:147],v[42:43]
v_pk_add_f32 v[132:133],v[132:133],v[140:141]
v_pk_add_f32 v[148:149],v[148:149],v[44:45]
v_pk_add_f32 v[134:135],v[134:135],v[142:143]
v_pk_add_f32 v[150:151],v[150:151],v[46:47]
v_pk_add_f32 v[128:129],v[128:129],v[144:145]
v_pk_add_f32 v[130:131],v[130:131],v[146:147]
v_pk_add_f32 v[132:133],v[132:133],v[148:149]
v_pk_add_f32 v[134:135],v[134:135],v[150:151]
v_pk_add_f32 v[168:169],v[128:129],v[130:131]
v_pk_add_f32 v[170:171],v[132:133],v[134:135]
v_pk_add_f32 v[168:169],v[168:169],v[170:171]
v_cmp_u_f32 vcc,v168,v169
s_cbranch_vccnz rt_107
go_108:
v_lshlrev_b32 v168,16,v160
v_and_b32 v169,s73,v160
v_lshlrev_b32 v170,16,v161
v_and_b32 v171,s73,v161
v_lshlrev_b32 v172,16,v162
v_and_b32 v173,s73,v162
v_lshlrev_b32 v174,16,v163
v_and_b32 v175,s73,v163
v_fma_f32 v168,v128,v152,v168
v_fma_f32 v169,v129,v153,v169
v_fma_f32 v170,v130,v154,v170
v_fma_f32 v171,v131,v155,v171
v_fma_f32 v172,v132,v156,v172
v_fma_f32 v173,v133,v157,v173
v_fma_f32 v174,v134,v158,v174
v_fma_f32 v175,v135,v159,v175
v_cvt_pk_bf16_f32 v176,v168,v169
v_cvt_pk_bf16_f32 v177,v170,v171
v_cvt_pk_bf16_f32 v178,v172,v173
v_cvt_pk_bf16_f32 v179,v174,v175
s_add_u32 s64,s66,201326592
buffer_store_dwordx4 v[176:179],v0,s[20:23],s64 offen sc1
s_add_u32 s64,s74,s75
s_add_u32 s65,s64,4096
s_cmp_eq_u32 s56,1
s_cbranch_scc1 b1_109
buffer_store_dwordx4 v[204:207],v0,s[20:23],s64 offen offset:0
buffer_store_dwordx4 v[204:207],v0,s[20:23],s64 offen offset:1024
buffer_store_dwordx4 v[204:207],v0,s[20:23],s64 offen offset:2048
buffer_store_dwordx4 v[204:207],v0,s[20:23],s64 offen offset:3072
buffer_store_dwordx4 v[204:207],v0,s[20:23],s65 offen offset:0
buffer_store_dwordx4 v[204:207],v0,s[20:23],s65 offen offset:1024
b2_110:
s_add_u32 s66,s66,32768
s_add_u32 s75,s75,6144
s_cmp_eq_u32 s75,24576
s_cselect_b32 s75,0,s75
s_add_u32 s76,s76,1
s_mov_b32 s77,0
s_waitcnt vmcnt(6)
v_mov_b32 v17,s76
s_mov_b64 exec,1
buffer_store_dword v17,off,s[20:23],s69 sc1
s_mov_b64 exec,-1
s_cmp_ge_u32 s60,128
s_cbranch_scc1 done_74
plp_111:
buffer_load_dword v16,v2,s[20:23],s68 offen sc1
s_waitcnt vmcnt(0)
v_cmp_gt_u32 vcc,s71,v16
s_cbranch_vccz pok_112
s_sleep 4
s_sub_u32 s90,s90,1
s_cmp_gt_i32 s90,0
s_cbranch_scc1 plp_111
pok_112:
s_branch lag_97
vN_83:
buffer_load_dword v16,v2,s[20:23],s68 offen sc1
s_waitcnt lgkmcnt(5)
v_mfma_f32_16x16x32_bf16 v[32:35],a[176:179],v[88:91],v[32:35]
ds_read_b128 v[112:115],v7 offset:4096
v_mfma_f32_16x16x32_bf16 v[36:39],a[180:183],v[88:91],v[36:39]
s_waitcnt lgkmcnt(5)
v_mfma_f32_16x16x32_bf16 v[32:35],a[184:187],v[92:95],v[32:35]
ds_read_b128 v[116:119],v7 offset:5120
v_mfma_f32_16x16x32_bf16 v[36:39],a[188:191],v[92:95],v[36:39]
s_waitcnt lgkmcnt(5)
v_mfma_f32_16x16x32_bf16 v[32:35],a[192:195],v[96:99],v[32:35]
ds_read_b128 v[120:123],v7 offset:6144
v_mfma_f32_16x16x32_bf16 v[36:39],a[196:199],v[96:99],v[36:39]
s_waitcnt lgkmcnt(5)
v_mfma_f32_16x16x32_bf16 v[32:35],a[200:203],v[100:103],v[32:35]
ds_read_b128 v[124:127],v7 offset:7168
v_mfma_f32_16x16x32_bf16 v[36:39],a[204:207],v[100:103],v[36:39]
s_waitcnt lgkmcnt(5)
v_mfma_f32_16x16x32_bf16 v[32:35],a[208:211],v[104:107],v[32:35]
v_mfma_f32_16x16x32_bf16 v[36:39],a[212:215],v[104:107],v[36:39]
s_waitcnt lgkmcnt(4)
v_mfma_f32_16x16x32_bf16 v[32:35],a[216:219],v[108:111],v[32:35]
v_mfma_f32_16x16x32_bf16 v[36:39],a[220:223],v[108:111],v[36:39]
s_waitcnt lgkmcnt(3)
v_mfma_f32_16x16x32_bf16 v[32:35],a[224:227],v[112:115],v[32:35]
v_mfma_f32_16x16x32_bf16 v[36:39],a[228:231],v[112:115],v[36:39]
s_waitcnt lgkmcnt(2)
v_mfma_f32_16x16x32_bf16 v[32:35],a[232:235],v[116:119],v[32:35]
v_mfma_f32_16x16x32_bf16 v[36:39],a[236:239],v[116:119],v[36:39]
s_waitcnt lgkmcnt(1)
v_mfma_f32_16x16x32_bf16 v[32:35],a[240:243],v[120:123],v[32:35]
v_mfma_f32_16x16x32_bf16 v[36:39],a[244:247],v[120:123],v[36:39]
s_waitcnt lgkmcnt(0)
v_mfma_f32_16x16x32_bf16 v[32:35],a[248:251],v[124:127],v[32:35]
v_mfma_f32_16x16x32_bf16 v[36:39],a[252:255],v[124:127],v[36:39]
s_mov_b32 s72,0
s_branch join_84
b1_89:
s_nop 7
buffer_store_dwordx4 v[32:35],v0,s[20:23],s64 offen offset:0 sc1
buffer_store_dwordx4 v[36:39],v0,s[20:23],s64 offen offset:1024 sc1
s_branch b2_90
rt_102:
s_sub_u32 s90,s90,1
s_cmp_gt_i32 s90,0
s_cbranch_scc0 go_103
s_add_u32 s64,s74,s75
s_add_u32 s65,s64,4096
buffer_load_dwordx4 v[128:131],v0,s[20:23],s64 offen offset:0 sc1
buffer_load_dwordx4 v[132:135],v0,s[20:23],s64 offen offset:1024 sc1
buffer_load_dwordx4 v[136:139],v0,s[20:23],s64 offen offset:2048 sc1
buffer_load_dwordx4 v[140:143],v0,s[20:23],s64 offen offset:3072 sc1
buffer_load_dwordx4 v[144:147],v0,s[20:23],s65 offen offset:0 sc1
buffer_load_dwordx4 v[148:151],v0,s[20:23],s65 offen offset:1024 sc1
s_waitcnt vmcnt(0)
s_branch ck_101
b1_104:
s_nop 7
buffer_store_dwordx4 v[204:207],v0,s[20:23],s64 offen offset:0 sc1
buffer_store_dwordx4 v[204:207],v0,s[20:23],s64 offen offset:1024 sc1
buffer_store_dwordx4 v[204:207],v0,s[20:23],s64 offen offset:2048 sc1
buffer_store_dwordx4 v[204:207],v0,s[20:23],s64 offen offset:3072 sc1
buffer_store_dwordx4 v[204:207],v0,s[20:23],s65 offen offset:0 sc1
buffer_store_dwordx4 v[204:207],v0,s[20:23],s65 offen offset:1024 sc1
s_branch b2_105
vN_94:
buffer_load_dword v16,v2,s[20:23],s68 offen sc1
s_waitcnt lgkmcnt(5)
v_mfma_f32_16x16x32_bf16 v[32:35],a[176:179],v[88:91],v[32:35]
ds_read_b128 v[112:115],v7 offset:4096
v_mfma_f32_16x16x32_bf16 v[36:39],a[180:183],v[88:91],v[36:39]
s_waitcnt lgkmcnt(5)
v_mfma_f32_16x16x32_bf16 v[32:35],a[184:187],v[92:95],v[32:35]
ds_read_b128 v[116:119],v7 offset:5120
v_mfma_f32_16x16x32_bf16 v[36:39],a[188:191],v[92:95],v[36:39]
s_waitcnt lgkmcnt(5)
v_mfma_f32_16x16x32_bf16 v[32:35],a[192:195],v[96:99],v[32:35]
ds_read_b128 v[120:123],v7 offset:6144
v_mfma_f32_16x16x32_bf16 v[36:39],a[196:199],v[96:99],v[36:39]
s_waitcnt lgkmcnt(5)
v_mfma_f32_16x16x32_bf16 v[32:35],a[200:203],v[100:103],v[32:35]
ds_read_b128 v[124:127],v7 offset:7168
v_mfma_f32_16x16x32_bf16 v[36:39],a[204:207],v[100:103],v[36:39]
s_waitcnt lgkmcnt(5)
v_mfma_f32_16x16x32_bf16 v[32:35],a[208:211],v[104:107],v[32:35]
v_mfma_f32_16x16x32_bf16 v[36:39],a[212:215],v[104:107],v[36:39]
s_waitcnt lgkmcnt(4)
v_mfma_f32_16x16x32_bf16 v[32:35],a[216:219],v[108:111],v[32:35]
v_mfma_f32_16x16x32_bf16 v[36:39],a[220:223],v[108:111],v[36:39]
s_waitcnt lgkmcnt(3)
v_mfma_f32_16x16x32_bf16 v[32:35],a[224:227],v[112:115],v[32:35]
v_mfma_f32_16x16x32_bf16 v[36:39],a[228:231],v[112:115],v[36:39]
s_waitcnt lgkmcnt(2)
v_mfma_f32_16x16x32_bf16 v[32:35],a[232:235],v[116:119],v[32:35]
v_mfma_f32_16x16x32_bf16 v[36:39],a[236:239],v[116:119],v[36:39]
s_waitcnt lgkmcnt(1)
v_mfma_f32_16x16x32_bf16 v[32:35],a[240:243],v[120:123],v[32:35]
v_mfma_f32_16x16x32_bf16 v[36:39],a[244:247],v[120:123],v[36:39]
s_waitcnt lgkmcnt(0)
v_mfma_f32_16x16x32_bf16 v[32:35],a[248:251],v[124:127],v[32:35]
v_mfma_f32_16x16x32_bf16 v[36:39],a[252:255],v[124:127],v[36:39]
s_mov_b32 s72,0
s_branch join_95
rt_107:
s_sub_u32 s90,s90,1
s_cmp_gt_i32 s90,0
s_cbranch_scc0 go_108
s_add_u32 s64,s74,s75
s_add_u32 s65,s64,4096
buffer_load_dwordx4 v[128:131],v0,s[20:23],s64 offen offset:0 sc1
buffer_load_dwordx4 v[132:135],v0,s[20:23],s64 offen offset:1024 sc1
buffer_load_dwordx4 v[136:139],v0,s[20:23],s64 offen offset:2048 sc1
buffer_load_dwordx4 v[140:143],v0,s[20:23],s64 offen offset:3072 sc1
buffer_load_dwordx4 v[144:147],v0,s[20:23],s65 offen offset:0 sc1
buffer_load_dwordx4 v[148:151],v0,s[20:23],s65 offen offset:1024 sc1
s_waitcnt vmcnt(0)
s_branch ck_106
b1_109:
s_nop 7
buffer_store_dwordx4 v[204:207],v0,s[20:23],s64 offen offset:0 sc1
buffer_store_dwordx4 v[204:207],v0,s[20:23],s64 offen offset:1024 sc1
buffer_store_dwordx4 v[204:207],v0,s[20:23],s64 offen offset:2048 sc1
buffer_store_dwordx4 v[204:207],v0,s[20:23],s64 offen offset:3072 sc1
buffer_store_dwordx4 v[204:207],v0,s[20:23],s65 offen offset:0 sc1
buffer_store_dwordx4 v[204:207],v0,s[20:23],s65 offen offset:1024 sc1
s_branch b2_110
done_74:
s_endpgm
fl_w4:
v_and_b32 v21,15,v1
v_lshrrev_b32 v22,4,v1
v_lshrrev_b32 v23,2,v21
v_and_b32 v24,3,v21
s_lshl_b32 s61,s50,15
v_lshl_add_u32 v25,v22,3,v23
s_load_dwordx2 s[4:5],s[0:1],88
s_load_dwordx2 s[6:7],s[0:1],112
s_lshr_b32 s52,s59,3
s_and_b32 s53,s59,7
s_mul_i32 s54,s52,1835008
s_lshl_b32 s64,s53,8
s_add_u32 s54,s54,s64
s_lshl_b32 s64,s50,6
s_add_u32 s54,s54,s64
s_waitcnt lgkmcnt(0)
s_mov_b32 s28,s4
s_and_b32 s29,s5,0xffff
s_mov_b32 s30,0x700000
s_mov_b32 s31,0x20000
s_mov_b32 s24,s6
s_and_b32 s25,s7,0xffff
s_mov_b32 s26,0x400000
s_mov_b32 s27,0x20000
s_mov_b32 s92,s2
s_and_b32 s93,s3,0xffff
s_mov_b32 s94,0x100
s_mov_b32 s95,0x20000
v_mbcnt_lo_u32_b32 v16,-1,0
v_mbcnt_hi_u32_b32 v16,-1,v16
v_mov_b32 v18,0
v_cmp_eq_u32 vcc,17,v16
s_nop 1
v_cndmask_b32 v18,v18,63,vcc
v_and_b32 v19,1,v16
v_cmp_eq_u32 vcc,1,v19
v_mov_b32 v19,8192
s_nop 0
v_cndmask_b32 v19,-1,v19,vcc
v_min_u32 v16,31,v16
v_lshlrev_b32 v16,2,v16
s_sub_u32 s66,s88,64
s_cmp_lg_u32 s50,0
s_cbranch_scc1 vot_118
vpoll_114:
buffer_load_dword v17,v16,s[92:95],s66 offen sc1
s_waitcnt vmcnt(0)
s_cmp_lg_u32 s56,2
s_cbranch_scc1 vck_115
v_cmp_eq_u32 vcc,v17,v19
s_and_b32 s64,vcc_lo,0xffff
s_cmp_eq_u32 s64,65535
s_cbranch_scc1 vck_115
s_mov_b32 s65,0
v_readlane_b32 s64,v17,1
s_lshr_b32 s64,s64,8
s_add_u32 s65,s65,s64
v_readlane_b32 s64,v17,3
s_lshr_b32 s64,s64,8
s_add_u32 s65,s65,s64
v_readlane_b32 s64,v17,5
s_lshr_b32 s64,s64,8
s_add_u32 s65,s65,s64
v_readlane_b32 s64,v17,7
s_lshr_b32 s64,s64,8
s_add_u32 s65,s65,s64
v_readlane_b32 s64,v17,9
s_lshr_b32 s64,s64,8
s_add_u32 s65,s65,s64
v_readlane_b32 s64,v17,11
s_lshr_b32 s64,s64,8
s_add_u32 s65,s65,s64
v_readlane_b32 s64,v17,13
s_lshr_b32 s64,s64,8
s_add_u32 s65,s65,s64
v_readlane_b32 s64,v17,15
s_lshr_b32 s64,s64,8
s_add_u32 s65,s65,s64
s_cmp_ge_u32 s65,256
s_cbranch_scc1 vok_117
s_branch vrt_116
vck_115:
v_cmp_gt_u32 vcc,v18,v17
s_cbranch_vccz vok_117
vrt_116:
s_sleep 48
s_sub_u32 s90,s90,1
s_cmp_gt_i32 s90,0
s_cbranch_scc1 vpoll_114
vok_117:
v_add_u32 v18,159744,v16
ds_write_b32 v18,v17
s_waitcnt lgkmcnt(0)
vot_118:
s_barrier
v_add_u32 v18,159744,v16
ds_read_b32 v17,v18
s_waitcnt lgkmcnt(0)
s_cmp_lg_u32 s56,2
s_cbranch_scc1 vfin_119
v_cmp_eq_u32 vcc,v17,v19
s_and_b32 s64,vcc_lo,0xffff
s_cmp_eq_u32 s64,65535
s_cbranch_scc1 vfin_119
s_mov_b32 s65,0
v_readlane_b32 s64,v17,1
s_lshr_b32 s64,s64,8
s_add_u32 s65,s65,s64
v_readlane_b32 s64,v17,3
s_lshr_b32 s64,s64,8
s_add_u32 s65,s65,s64
v_readlane_b32 s64,v17,5
s_lshr_b32 s64,s64,8
s_add_u32 s65,s65,s64
v_readlane_b32 s64,v17,7
s_lshr_b32 s64,s64,8
s_add_u32 s65,s65,s64
v_readlane_b32 s64,v17,9
s_lshr_b32 s64,s64,8
s_add_u32 s65,s65,s64
v_readlane_b32 s64,v17,11
s_lshr_b32 s64,s64,8
s_add_u32 s65,s65,s64
v_readlane_b32 s64,v17,13
s_lshr_b32 s64,s64,8
s_add_u32 s65,s65,s64
v_readlane_b32 s64,v17,15
s_lshr_b32 s64,s64,8
s_add_u32 s65,s65,s64
s_cmp_ge_u32 s65,256
s_cbranch_scc1 fl_fb
vfin_119:
s_and_b32 s56,s56,1
v_lshrrev_b32 v26,2,v1
v_and_b32 v27,3,v1
v_mul_u32_u24 v16,2048,v26
v_lshl_add_u32 v16,v27,4,v16
v_lshlrev_b32 v17,6,v25
v_lshl_add_u32 v17,v24,4,v17
v_add_u32 v17,s61,v17
s_xor_b32 s62,s50,0
s_mul_i32 s62,s62,458752
s_add_u32 s62,s62,s54
s_add_u32 m0,s61,0
s_nop 0
buffer_load_dwordx4 v16,s[28:31],s62 offen lds
s_add_u32 s62,s62,32768
s_add_u32 m0,m0,1024
s_waitcnt vmcnt(6)
buffer_load_dwordx4 v16,s[28:31],s62 offen lds
s_add_u32 s62,s62,32768
s_add_u32 m0,m0,1024
s_waitcnt vmcnt(6)
buffer_load_dwordx4 v16,s[28:31],s62 offen lds
s_add_u32 s62,s62,32768
s_add_u32 m0,m0,1024
s_waitcnt vmcnt(6)
buffer_load_dwordx4 v16,s[28:31],s62 offen lds
s_add_u32 s62,s62,32768
s_add_u32 m0,m0,1024
s_waitcnt vmcnt(6)
buffer_load_dwordx4 v16,s[28:31],s62 offen lds
s_add_u32 s62,s62,32768
s_add_u32 m0,m0,1024
s_waitcnt vmcnt(6)
buffer_load_dwordx4 v16,s[28:31],s62 offen lds
s_add_u32 s62,s62,32768
s_add_u32 m0,m0,1024
s_waitcnt vmcnt(6)
buffer_load_dwordx4 v16,s[28:31],s62 offen lds
s_add_u32 s62,s62,32768
s_add_u32 m0,m0,1024
s_waitcnt vmcnt(6)
buffer_load_dwordx4 v16,s[28:31],s62 offen lds
s_add_u32 s62,s62,32768
s_add_u32 m0,m0,1024
s_waitcnt vmcnt(6)
buffer_load_dwordx4 v16,s[28:31],s62 offen lds
s_add_u32 s62,s62,32768
s_add_u32 m0,m0,1024
s_waitcnt vmcnt(6)
buffer_load_dwordx4 v16,s[28:31],s62 offen lds
s_add_u32 s62,s62,32768
s_add_u32 m0,m0,1024
s_waitcnt vmcnt(6)
buffer_load_dwordx4 v16,s[28:31],s62 offen lds
s_add_u32 s62,s62,32768
s_add_u32 m0,m0,1024
s_waitcnt vmcnt(6)
buffer_load_dwordx4 v16,s[28:31],s62 offen lds
s_add_u32 s62,s62,32768
s_add_u32 m0,m0,1024
s_waitcnt vmcnt(6)
buffer_load_dwordx4 v16,s[28:31],s62 offen lds
s_add_u32 s62,s62,32768
s_add_u32 m0,m0,1024
s_waitcnt vmcnt(6)
buffer_load_dwordx4 v16,s[28:31],s62 offen lds
s_waitcnt vmcnt(6)
s_xor_b32 s62,s50,1
s_mul_i32 s62,s62,458752
s_add_u32 s62,s62,s54
s_add_u32 m0,s61,16384
s_nop 0
buffer_load_dwordx4 v16,s[28:31],s62 offen lds
s_add_u32 s62,s62,32768
s_add_u32 m0,m0,1024
s_waitcnt vmcnt(6)
buffer_load_dwordx4 v16,s[28:31],s62 offen lds
s_add_u32 s62,s62,32768
s_add_u32 m0,m0,1024
s_waitcnt vmcnt(6)
buffer_load_dwordx4 v16,s[28:31],s62 offen lds
s_add_u32 s62,s62,32768
s_add_u32 m0,m0,1024
s_waitcnt vmcnt(6)
buffer_load_dwordx4 v16,s[28:31],s62 offen lds
s_add_u32 s62,s62,32768
s_add_u32 m0,m0,1024
s_waitcnt vmcnt(6)
buffer_load_dwordx4 v16,s[28:31],s62 offen lds
s_add_u32 s62,s62,32768
s_add_u32 m0,m0,1024
s_waitcnt vmcnt(6)
buffer_load_dwordx4 v16,s[28:31],s62 offen lds
s_add_u32 s62,s62,32768
s_add_u32 m0,m0,1024
s_waitcnt vmcnt(6)
buffer_load_dwordx4 v16,s[28:31],s62 offen lds
s_add_u32 s62,s62,32768
s_add_u32 m0,m0,1024
s_waitcnt vmcnt(6)
buffer_load_dwordx4 v16,s[28:31],s62 offen lds
s_add_u32 s62,s62,32768
s_add_u32 m0,m0,1024
s_waitcnt vmcnt(6)
buffer_load_dwordx4 v16,s[28:31],s62 offen lds
s_add_u32 s62,s62,32768
s_add_u32 m0,m0,1024
s_waitcnt vmcnt(6)
buffer_load_dwordx4 v16,s[28:31],s62 offen lds
s_add_u32 s62,s62,32768
s_add_u32 m0,m0,1024
s_waitcnt vmcnt(6)
buffer_load_dwordx4 v16,s[28:31],s62 offen lds
s_add_u32 s62,s62,32768
s_add_u32 m0,m0,1024
s_waitcnt vmcnt(6)
buffer_load_dwordx4 v16,s[28:31],s62 offen lds
s_add_u32 s62,s62,32768
s_add_u32 m0,m0,1024
s_waitcnt vmcnt(6)
buffer_load_dwordx4 v16,s[28:31],s62 offen lds
s_add_u32 s62,s62,32768
s_add_u32 m0,m0,1024
s_waitcnt vmcnt(6)
buffer_load_dwordx4 v16,s[28:31],s62 offen lds
s_waitcnt vmcnt(6)
s_waitcnt vmcnt(14)
ds_read_b64_tr_b16 a[0:1],v17 offset:0
ds_read_b64_tr_b16 a[2:3],v17 offset:256
ds_read_b64_tr_b16 a[4:5],v17 offset:8
ds_read_b64_tr_b16 a[6:7],v17 offset:264
ds_read_b64_tr_b16 a[8:9],v17 offset:2048
ds_read_b64_tr_b16 a[10:11],v17 offset:2304
ds_read_b64_tr_b16 a[12:13],v17 offset:2056
ds_read_b64_tr_b16 a[14:15],v17 offset:2312
ds_read_b64_tr_b16 a[16:17],v17 offset:4096
ds_read_b64_tr_b16 a[18:19],v17 offset:4352
ds_read_b64_tr_b16 a[20:21],v17 offset:4104
ds_read_b64_tr_b16 a[22:23],v17 offset:4360
s_waitcnt lgkmcnt(0)
ds_read_b64_tr_b16 a[24:25],v17 offset:6144
ds_read_b64_tr_b16 a[26:27],v17 offset:6400
ds_read_b64_tr_b16 a[28:29],v17 offset:6152
ds_read_b64_tr_b16 a[30:31],v17 offset:6408
ds_read_b64_tr_b16 a[32:33],v17 offset:8192
ds_read_b64_tr_b16 a[34:35],v17 offset:8448
ds_read_b64_tr_b16 a[36:37],v17 offset:8200
ds_read_b64_tr_b16 a[38:39],v17 offset:8456
ds_read_b64_tr_b16 a[40:41],v17 offset:10240
ds_read_b64_tr_b16 a[42:43],v17 offset:10496
ds_read_b64_tr_b16 a[44:45],v17 offset:10248
ds_read_b64_tr_b16 a[46:47],v17 offset:10504
s_waitcnt lgkmcnt(0)
ds_read_b64_tr_b16 a[48:49],v17 offset:12288
ds_read_b64_tr_b16 a[50:51],v17 offset:12544
ds_read_b64_tr_b16 a[52:53],v17 offset:12296
ds_read_b64_tr_b16 a[54:55],v17 offset:12552
s_waitcnt lgkmcnt(0)
s_xor_b32 s62,s50,2
s_mul_i32 s62,s62,458752
s_add_u32 s62,s62,s54
s_add_u32 m0,s61,0
s_nop 0
buffer_load_dwordx4 v16,s[28:31],s62 offen lds
s_add_u32 s62,s62,32768
s_add_u32 m0,m0,1024
s_waitcnt vmcnt(6)
buffer_load_dwordx4 v16,s[28:31],s62 offen lds
s_add_u32 s62,s62,32768
s_add_u32 m0,m0,1024
s_waitcnt vmcnt(6)
buffer_load_dwordx4 v16,s[28:31],s62 offen lds
s_add_u32 s62,s62,32768
s_add_u32 m0,m0,1024
s_waitcnt vmcnt(6)
buffer_load_dwordx4 v16,s[28:31],s62 offen lds
s_add_u32 s62,s62,32768
s_add_u32 m0,m0,1024
s_waitcnt vmcnt(6)
buffer_load_dwordx4 v16,s[28:31],s62 offen lds
s_add_u32 s62,s62,32768
s_add_u32 m0,m0,1024
s_waitcnt vmcnt(6)
buffer_load_dwordx4 v16,s[28:31],s62 offen lds
s_add_u32 s62,s62,32768
s_add_u32 m0,m0,1024
s_waitcnt vmcnt(6)
buffer_load_dwordx4 v16,s[28:31],s62 offen lds
s_add_u32 s62,s62,32768
s_add_u32 m0,m0,1024
s_waitcnt vmcnt(6)
buffer_load_dwordx4 v16,s[28:31],s62 offen lds
s_add_u32 s62,s62,32768
s_add_u32 m0,m0,1024
s_waitcnt vmcnt(6)
buffer_load_dwordx4 v16,s[28:31],s62 offen lds
s_add_u32 s62,s62,32768
s_add_u32 m0,m0,1024
s_waitcnt vmcnt(6)
buffer_load_dwordx4 v16,s[28:31],s62 offen lds
s_add_u32 s62,s62,32768
s_add_u32 m0,m0,1024
s_waitcnt vmcnt(6)
buffer_load_dwordx4 v16,s[28:31],s62 offen lds
s_add_u32 s62,s62,32768
s_add_u32 m0,m0,1024
s_waitcnt vmcnt(6)
buffer_load_dwordx4 v16,s[28:31],s62 offen lds
s_add_u32 s62,s62,32768
s_add_u32 m0,m0,1024
s_waitcnt vmcnt(6)
buffer_load_dwordx4 v16,s[28:31],s62 offen lds
s_add_u32 s62,s62,32768
s_add_u32 m0,m0,1024
s_waitcnt vmcnt(6)
buffer_load_dwordx4 v16,s[28:31],s62 offen lds
s_waitcnt vmcnt(6)
s_waitcnt vmcnt(14)
ds_read_b64_tr_b16 a[56:57],v17 offset:16384
ds_read_b64_tr_b16 a[58:59],v17 offset:16640
ds_read_b64_tr_b16 a[60:61],v17 offset:16392
ds_read_b64_tr_b16 a[62:63],v17 offset:16648
ds_read_b64_tr_b16 a[64:65],v17 offset:18432
ds_read_b64_tr_b16 a[66:67],v17 offset:18688
ds_read_b64_tr_b16 a[68:69],v17 offset:18440
ds_read_b64_tr_b16 a[70:71],v17 offset:18696
ds_read_b64_tr_b16 a[72:73],v17 offset:20480
ds_read_b64_tr_b16 a[74:75],v17 offset:20736
ds_read_b64_tr_b16 a[76:77],v17 offset:20488
ds_read_b64_tr_b16 a[78:79],v17 offset:20744
s_waitcnt lgkmcnt(0)
ds_read_b64_tr_b16 a[80:81],v17 offset:22528
ds_read_b64_tr_b16 a[82:83],v17 offset:22784
ds_read_b64_tr_b16 a[84:85],v17 offset:22536
ds_read_b64_tr_b16 a[86:87],v17 offset:22792
ds_read_b64_tr_b16 a[88:89],v17 offset:24576
ds_read_b64_tr_b16 a[90:91],v17 offset:24832
ds_read_b64_tr_b16 a[92:93],v17 offset:24584
ds_read_b64_tr_b16 a[94:95],v17 offset:24840
ds_read_b64_tr_b16 a[96:97],v17 offset:26624
ds_read_b64_tr_b16 a[98:99],v17 offset:26880
ds_read_b64_tr_b16 a[100:101],v17 offset:26632
ds_read_b64_tr_b16 a[102:103],v17 offset:26888
s_waitcnt lgkmcnt(0)
ds_read_b64_tr_b16 a[104:105],v17 offset:28672
ds_read_b64_tr_b16 a[106:107],v17 offset:28928
ds_read_b64_tr_b16 a[108:109],v17 offset:28680
ds_read_b64_tr_b16 a[110:111],v17 offset:28936
s_waitcnt lgkmcnt(0)
s_xor_b32 s62,s50,3
s_mul_i32 s62,s62,458752
s_add_u32 s62,s62,s54
s_add_u32 m0,s61,16384
s_nop 0
buffer_load_dwordx4 v16,s[28:31],s62 offen lds
s_add_u32 s62,s62,32768
s_add_u32 m0,m0,1024
s_waitcnt vmcnt(6)
buffer_load_dwordx4 v16,s[28:31],s62 offen lds
s_add_u32 s62,s62,32768
s_add_u32 m0,m0,1024
s_waitcnt vmcnt(6)
buffer_load_dwordx4 v16,s[28:31],s62 offen lds
s_add_u32 s62,s62,32768
s_add_u32 m0,m0,1024
s_waitcnt vmcnt(6)
buffer_load_dwordx4 v16,s[28:31],s62 offen lds
s_add_u32 s62,s62,32768
s_add_u32 m0,m0,1024
s_waitcnt vmcnt(6)
buffer_load_dwordx4 v16,s[28:31],s62 offen lds
s_add_u32 s62,s62,32768
s_add_u32 m0,m0,1024
s_waitcnt vmcnt(6)
buffer_load_dwordx4 v16,s[28:31],s62 offen lds
s_add_u32 s62,s62,32768
s_add_u32 m0,m0,1024
s_waitcnt vmcnt(6)
buffer_load_dwordx4 v16,s[28:31],s62 offen lds
s_add_u32 s62,s62,32768
s_add_u32 m0,m0,1024
s_waitcnt vmcnt(6)
buffer_load_dwordx4 v16,s[28:31],s62 offen lds
s_add_u32 s62,s62,32768
s_add_u32 m0,m0,1024
s_waitcnt vmcnt(6)
buffer_load_dwordx4 v16,s[28:31],s62 offen lds
s_add_u32 s62,s62,32768
s_add_u32 m0,m0,1024
s_waitcnt vmcnt(6)
buffer_load_dwordx4 v16,s[28:31],s62 offen lds
s_add_u32 s62,s62,32768
s_add_u32 m0,m0,1024
s_waitcnt vmcnt(6)
buffer_load_dwordx4 v16,s[28:31],s62 offen lds
s_add_u32 s62,s62,32768
s_add_u32 m0,m0,1024
s_waitcnt vmcnt(6)
buffer_load_dwordx4 v16,s[28:31],s62 offen lds
s_add_u32 s62,s62,32768
s_add_u32 m0,m0,1024
s_waitcnt vmcnt(6)
buffer_load_dwordx4 v16,s[28:31],s62 offen lds
s_add_u32 s62,s62,32768
s_add_u32 m0,m0,1024
s_waitcnt vmcnt(6)
buffer_load_dwordx4 v16,s[28:31],s62 offen lds
s_waitcnt vmcnt(6)
s_waitcnt vmcnt(14)
ds_read_b64_tr_b16 a[112:113],v17 offset:0
ds_read_b64_tr_b16 a[114:115],v17 offset:256
ds_read_b64_tr_b16 a[116:117],v17 offset:8
ds_read_b64_tr_b16 a[118:119],v17 offset:264
ds_read_b64_tr_b16 a[120:121],v17 offset:2048
ds_read_b64_tr_b16 a[122:123],v17 offset:2304
ds_read_b64_tr_b16 a[124:125],v17 offset:2056
ds_read_b64_tr_b16 a[126:127],v17 offset:2312
ds_read_b64_tr_b16 a[128:129],v17 offset:4096
ds_read_b64_tr_b16 a[130:131],v17 offset:4352
ds_read_b64_tr_b16 a[132:133],v17 offset:4104
ds_read_b64_tr_b16 a[134:135],v17 offset:4360
s_waitcnt lgkmcnt(0)
ds_read_b64_tr_b16 a[136:137],v17 offset:6144
ds_read_b64_tr_b16 a[138:139],v17 offset:6400
ds_read_b64_tr_b16 a[140:141],v17 offset:6152
ds_read_b64_tr_b16 a[142:143],v17 offset:6408
ds_read_b64_tr_b16 a[144:145],v17 offset:8192
ds_read_b64_tr_b16 a[146:147],v17 offset:8448
ds_read_b64_tr_b16 a[148:149],v17 offset:8200
ds_read_b64_tr_b16 a[150:151],v17 offset:8456
ds_read_b64_tr_b16 a[152:153],v17 offset:10240
ds_read_b64_tr_b16 a[154:155],v17 offset:10496
ds_read_b64_tr_b16 a[156:157],v17 offset:10248
ds_read_b64_tr_b16 a[158:159],v17 offset:10504
s_waitcnt lgkmcnt(0)
ds_read_b64_tr_b16 a[160:161],v17 offset:12288
ds_read_b64_tr_b16 a[162:163],v17 offset:12544
ds_read_b64_tr_b16 a[164:165],v17 offset:12296
ds_read_b64_tr_b16 a[166:167],v17 offset:12552
s_waitcnt lgkmcnt(0)
s_waitcnt vmcnt(0)
ds_read_b64_tr_b16 a[168:169],v17 offset:16384
ds_read_b64_tr_b16 a[170:171],v17 offset:16640
ds_read_b64_tr_b16 a[172:173],v17 offset:16392
ds_read_b64_tr_b16 a[174:175],v17 offset:16648
ds_read_b64_tr_b16 a[176:177],v17 offset:18432
ds_read_b64_tr_b16 a[178:179],v17 offset:18688
ds_read_b64_tr_b16 a[180:181],v17 offset:18440
ds_read_b64_tr_b16 a[182:183],v17 offset:18696
ds_read_b64_tr_b16 a[184:185],v17 offset:20480
ds_read_b64_tr_b16 a[186:187],v17 offset:20736
ds_read_b64_tr_b16 a[188:189],v17 offset:20488
ds_read_b64_tr_b16 a[190:191],v17 offset:20744
s_waitcnt lgkmcnt(0)
ds_read_b64_tr_b16 a[192:193],v17 offset:22528
ds_read_b64_tr_b16 a[194:195],v17 offset:22784
ds_read_b64_tr_b16 a[196:197],v17 offset:22536
ds_read_b64_tr_b16 a[198:199],v17 offset:22792
ds_read_b64_tr_b16 a[200:201],v17 offset:24576
ds_read_b64_tr_b16 a[202:203],v17 offset:24832
ds_read_b64_tr_b16 a[204:205],v17 offset:24584
ds_read_b64_tr_b16 a[206:207],v17 offset:24840
ds_read_b64_tr_b16 a[208:209],v17 offset:26624
ds_read_b64_tr_b16 a[210:211],v17 offset:26880
ds_read_b64_tr_b16 a[212:213],v17 offset:26632
ds_read_b64_tr_b16 a[214:215],v17 offset:26888
s_waitcnt lgkmcnt(0)
ds_read_b64_tr_b16 a[216:217],v17 offset:28672
ds_read_b64_tr_b16 a[218:219],v17 offset:28928
ds_read_b64_tr_b16 a[220:221],v17 offset:28680
ds_read_b64_tr_b16 a[222:223],v17 offset:28936
s_waitcnt lgkmcnt(0)
s_mov_b32 s92,s2
s_and_b32 s93,s3,0xffff
s_mov_b32 s94,0x100
s_mov_b32 s95,0x20000
v_mbcnt_lo_u32_b32 v16,-1,0
v_mbcnt_hi_u32_b32 v16,-1,v16
v_mov_b32 v18,0
v_cmp_eq_u32 vcc,22,v16
s_nop 1
v_cndmask_b32 v18,v18,63,vcc
v_cmp_eq_u32 vcc,17,v16
s_nop 1
v_cndmask_b32 v18,v18,63,vcc
v_cmp_eq_u32 vcc,18,v16
s_nop 1
v_cndmask_b32 v18,v18,1,vcc
v_and_b32 v19,1,v16
v_cmp_eq_u32 vcc,1,v19
v_mov_b32 v19,8192
s_nop 0
v_cndmask_b32 v19,-1,v19,vcc
v_min_u32 v16,31,v16
v_lshlrev_b32 v16,2,v16
s_sub_u32 s66,s88,64
s_cmp_lg_u32 s50,0
s_cbranch_scc1 vot_124
vpoll_120:
buffer_load_dword v17,v16,s[92:95],s66 offen sc1
s_waitcnt vmcnt(0)
s_cmp_lg_u32 s56,2
s_cbranch_scc1 vck_121
v_cmp_eq_u32 vcc,v17,v19
s_and_b32 s64,vcc_lo,0xffff
s_cmp_eq_u32 s64,65535
s_cbranch_scc1 vck_121
s_mov_b32 s65,0
v_readlane_b32 s64,v17,1
s_lshr_b32 s64,s64,8
s_add_u32 s65,s65,s64
v_readlane_b32 s64,v17,3
s_lshr_b32 s64,s64,8
s_add_u32 s65,s65,s64
v_readlane_b32 s64,v17,5
s_lshr_b32 s64,s64,8
s_add_u32 s65,s65,s64
v_readlane_b32 s64,v17,7
s_lshr_b32 s64,s64,8
s_add_u32 s65,s65,s64
v_readlane_b32 s64,v17,9
s_lshr_b32 s64,s64,8
s_add_u32 s65,s65,s64
v_readlane_b32 s64,v17,11
s_lshr_b32 s64,s64,8
s_add_u32 s65,s65,s64
v_readlane_b32 s64,v17,13
s_lshr_b32 s64,s64,8
s_add_u32 s65,s65,s64
v_readlane_b32 s64,v17,15
s_lshr_b32 s64,s64,8
s_add_u32 s65,s65,s64
s_cmp_ge_u32 s65,256
s_cbranch_scc1 vok_123
s_branch vrt_122
vck_121:
v_cmp_gt_u32 vcc,v18,v17
s_cbranch_vccz vok_123
vrt_122:
s_sleep 48
s_sub_u32 s90,s90,1
s_cmp_gt_i32 s90,0
s_cbranch_scc1 vpoll_120
vok_123:
v_add_u32 v18,160000,v16
ds_write_b32 v18,v17
s_waitcnt lgkmcnt(0)
vot_124:
s_barrier
v_add_u32 v18,160000,v16
ds_read_b32 v17,v18
s_waitcnt lgkmcnt(0)
s_cmp_lg_u32 s56,2
s_cbranch_scc1 vfin_125
v_cmp_eq_u32 vcc,v17,v19
s_and_b32 s64,vcc_lo,0xffff
s_cmp_eq_u32 s64,65535
s_cbranch_scc1 vfin_125
s_mov_b32 s65,0
v_readlane_b32 s64,v17,1
s_lshr_b32 s64,s64,8
s_add_u32 s65,s65,s64
v_readlane_b32 s64,v17,3
s_lshr_b32 s64,s64,8
s_add_u32 s65,s65,s64
v_readlane_b32 s64,v17,5
s_lshr_b32 s64,s64,8
s_add_u32 s65,s65,s64
v_readlane_b32 s64,v17,7
s_lshr_b32 s64,s64,8
s_add_u32 s65,s65,s64
v_readlane_b32 s64,v17,9
s_lshr_b32 s64,s64,8
s_add_u32 s65,s65,s64
v_readlane_b32 s64,v17,11
s_lshr_b32 s64,s64,8
s_add_u32 s65,s65,s64
v_readlane_b32 s64,v17,13
s_lshr_b32 s64,s64,8
s_add_u32 s65,s65,s64
v_readlane_b32 s64,v17,15
s_lshr_b32 s64,s64,8
s_add_u32 s65,s65,s64
s_cmp_ge_u32 s65,256
s_cbranch_scc1 fl_fb
vfin_125:
s_and_b32 s56,s56,1
s_mov_b32 s67,0
s_barrier
v_lshlrev_b32 v0,4,v1
s_mov_b32 s60,0
s_mov_b32 s70,0
s_mov_b32 s55,0
s_lshl_b32 s63,s50,13
v_mov_b32 v3,v0
s_mov_b32 s73,0xffff0000
s_lshl_b32 s64,s52,2
s_add_u32 s64,s64,s50
s_mul_i32 s61,s64,7168
s_add_u32 s61,s61,219152384
s_lshl_b32 s82,s64,8
s_add_u32 s82,s82,138551296
s_mov_b32 s68,s82
s_lshl_b32 s83,s53,2
s_add_u32 s83,s83,s50
s_xor_b32 s64,s50,0
s_lshl_b32 s64,s64,13
v_add_u32 v8,s64,v0
s_xor_b32 s64,s50,1
s_lshl_b32 s64,s64,13
v_add_u32 v9,s64,v0
s_xor_b32 s64,s50,2
s_lshl_b32 s64,s64,13
v_add_u32 v10,s64,v0
s_xor_b32 s64,s50,3
s_lshl_b32 s64,s64,13
v_add_u32 v11,s64,v0
v_min_u32 v2,6,v1
v_lshlrev_b32 v2,2,v2
s_lshl_b32 s66,s83,10
s_lshr_b32 s65,s83,3
s_lshl_b32 s65,s65,8
s_and_b32 s64,s83,7
s_lshl_b32 s64,s64,2
s_add_u32 s69,s64,s65
s_add_u32 s69,s69,138555392
s_lshl_b32 s64,s53,2
s_add_u32 s64,s64,s50
s_mul_i32 s74,s64,24576
s_xor_b32 s64,s50,s52
s_sub_u32 s64,s64,1
s_max_i32 s64,s64,0
s_lshl_b32 s64,s64,11
s_add_u32 s74,s74,s64
s_add_u32 s74,s74,168558592
s_mov_b32 s75,0
s_mov_b32 s76,0
s_mov_b32 s77,0
v_lshlrev_b32 v26,11,v21
v_lshl_add_u32 v26,v22,4,v26
s_lshl_b32 s64,s83,6
v_add_u32 v18,s64,v26
v_lshlrev_b32 v26,5,v22
s_lshl_b32 s64,s83,7
s_add_u32 s64,s64,267407360
buffer_load_dwordx4 v[152:155],v26,s[20:23],s64 offen offset:0 sc1
buffer_load_dwordx4 v[156:159],v26,s[20:23],s64 offen offset:16 sc1
s_add_u32 s64,s64,24576
buffer_load_dwordx4 v[128:131],v26,s[20:23],s64 offen offset:0 sc1
buffer_load_dwordx4 v[132:135],v26,s[20:23],s64 offen offset:16 sc1
s_add_u32 s64,s64,24576
buffer_load_dwordx4 v[136:139],v26,s[20:23],s64 offen offset:0 sc1
buffer_load_dwordx4 v[140:143],v26,s[20:23],s64 offen offset:16 sc1
s_add_u32 s64,s64,24576
buffer_load_dwordx4 v[144:147],v26,s[20:23],s64 offen offset:0 sc1
buffer_load_dwordx4 v[148:151],v26,s[20:23],s64 offen offset:16 sc1
s_add_u32 s64,s64,24576
s_waitcnt vmcnt(0)
v_pk_add_f32 v[152:153],v[152:153],v[128:129]
v_pk_add_f32 v[136:137],v[136:137],v[144:145]
v_pk_add_f32 v[154:155],v[154:155],v[130:131]
v_pk_add_f32 v[138:139],v[138:139],v[146:147]
v_pk_add_f32 v[156:157],v[156:157],v[132:133]
v_pk_add_f32 v[140:141],v[140:141],v[148:149]
v_pk_add_f32 v[158:159],v[158:159],v[134:135]
v_pk_add_f32 v[142:143],v[142:143],v[150:151]
v_pk_add_f32 v[152:153],v[152:153],v[136:137]
v_pk_add_f32 v[154:155],v[154:155],v[138:139]
v_pk_add_f32 v[156:157],v[156:157],v[140:141]
v_pk_add_f32 v[158:159],v[158:159],v[142:143]
v_cvt_pk_bf16_f32 v128,v152,v153
v_cvt_pk_bf16_f32 v129,v154,v155
v_cvt_pk_bf16_f32 v130,v156,v157
v_cvt_pk_bf16_f32 v131,v158,v159
v_lshlrev_b32 v152,16,v128
v_and_b32 v153,s73,v128
v_lshlrev_b32 v154,16,v129
v_and_b32 v155,s73,v129
v_lshlrev_b32 v156,16,v130
v_and_b32 v157,s73,v130
v_lshlrev_b32 v158,16,v131
v_and_b32 v159,s73,v131
v_mov_b32 v204,-1
v_mov_b32 v205,-1
v_mov_b32 v206,-1
v_mov_b32 v207,-1
s_cmp_eq_u32 s50,s52
s_cbranch_scc1 lfin_126
s_add_u32 s71,s60,1
plp_132:
buffer_load_dword v16,v2,s[20:23],s68 offen sc1
s_waitcnt vmcnt(0)
v_cmp_gt_u32 vcc,s71,v16
s_cbranch_vccz pok_133
s_sleep 4
s_sub_u32 s90,s90,1
s_cmp_gt_i32 s90,0
s_cbranch_scc1 plp_132
pok_133:
lag_131:
s_add_u32 m0,s70,s63
s_add_u32 s62,s61,4096
buffer_load_dwordx4 v3,s[20:23],s61 offen offset:0 lds
buffer_load_dwordx4 v3,s[20:23],s61 offen offset:1024 lds
buffer_load_dwordx4 v3,s[20:23],s61 offen offset:2048 lds
buffer_load_dwordx4 v3,s[20:23],s61 offen offset:3072 lds
s_add_u32 m0,m0,4096
s_nop 0
buffer_load_dwordx4 v3,s[20:23],s62 offen offset:0 lds
buffer_load_dwordx4 v3,s[20:23],s62 offen offset:1024 lds
buffer_load_dwordx4 v3,s[20:23],s62 offen offset:2048 lds
s_add_u32 s61,s61,114688
s_add_u32 s70,s70,32768
s_and_b32 s70,s70,0x1ffff
buffer_load_dword v17,off,s[20:23],s69
buffer_load_dword v17,off,s[20:23],s69
top_127:
s_add_u32 s71,s60,2
buffer_load_dword v16,v2,s[20:23],s68 offen sc1
v_add_u32 v4,s55,v8
v_add_u32 v5,s55,v9
v_add_u32 v6,s55,v10
v_add_u32 v7,s55,v11
s_add_u32 s55,s55,32768
s_and_b32 s55,s55,0x1ffff
s_waitcnt vmcnt(9)
ds_read_b128 v[64:67],v4 offset:0
s_waitcnt vmcnt(8)
ds_read_b128 v[68:71],v4 offset:1024
s_waitcnt vmcnt(7)
ds_read_b128 v[72:75],v4 offset:2048
s_waitcnt lgkmcnt(2)
v_mfma_f32_16x16x32_bf16 v[32:35],a[0:3],v[64:67],0
v_mfma_f32_16x16x32_bf16 v[36:39],a[4:7],v[64:67],0
s_waitcnt vmcnt(6)
ds_read_b128 v[76:79],v4 offset:3072
s_waitcnt lgkmcnt(2)
v_mfma_f32_16x16x32_bf16 v[32:35],a[8:11],v[68:71],v[32:35]
v_mfma_f32_16x16x32_bf16 v[36:39],a[12:15],v[68:71],v[36:39]
s_waitcnt vmcnt(5)
ds_read_b128 v[80:83],v4 offset:4096
s_waitcnt lgkmcnt(2)
v_mfma_f32_16x16x32_bf16 v[32:35],a[16:19],v[72:75],v[32:35]
v_mfma_f32_16x16x32_bf16 v[36:39],a[20:23],v[72:75],v[36:39]
s_waitcnt vmcnt(4)
ds_read_b128 v[84:87],v4 offset:5120
s_waitcnt lgkmcnt(2)
v_mfma_f32_16x16x32_bf16 v[32:35],a[24:27],v[76:79],v[32:35]
v_mfma_f32_16x16x32_bf16 v[36:39],a[28:31],v[76:79],v[36:39]
s_waitcnt vmcnt(3)
ds_read_b128 v[88:91],v4 offset:6144
s_barrier
s_waitcnt lgkmcnt(2)
v_mfma_f32_16x16x32_bf16 v[32:35],a[32:35],v[80:83],v[32:35]
v_mfma_f32_16x16x32_bf16 v[36:39],a[36:39],v[80:83],v[36:39]
ds_read_b128 v[92:95],v5 offset:0
s_waitcnt lgkmcnt(2)
v_mfma_f32_16x16x32_bf16 v[32:35],a[40:43],v[84:87],v[32:35]
ds_read_b128 v[96:99],v5 offset:1024
ds_read_b128 v[100:103],v5 offset:2048
v_mfma_f32_16x16x32_bf16 v[36:39],a[44:47],v[84:87],v[36:39]
s_waitcnt lgkmcnt(3)
v_mfma_f32_16x16x32_bf16 v[32:35],a[48:51],v[88:91],v[32:35]
ds_read_b128 v[104:107],v5 offset:3072
ds_read_b128 v[108:111],v5 offset:4096
v_mfma_f32_16x16x32_bf16 v[36:39],a[52:55],v[88:91],v[36:39]
s_waitcnt lgkmcnt(4)
v_mfma_f32_16x16x32_bf16 v[32:35],a[56:59],v[92:95],v[32:35]
ds_read_b128 v[112:115],v5 offset:5120
ds_read_b128 v[116:119],v5 offset:6144
v_mfma_f32_16x16x32_bf16 v[36:39],a[60:63],v[92:95],v[36:39]
s_waitcnt lgkmcnt(5)
v_mfma_f32_16x16x32_bf16 v[32:35],a[64:67],v[96:99],v[32:35]
ds_read_b128 v[120:123],v6 offset:0
v_mfma_f32_16x16x32_bf16 v[36:39],a[68:71],v[96:99],v[36:39]
s_waitcnt lgkmcnt(5)
v_mfma_f32_16x16x32_bf16 v[32:35],a[72:75],v[100:103],v[32:35]
ds_read_b128 v[124:127],v6 offset:1024
v_mfma_f32_16x16x32_bf16 v[36:39],a[76:79],v[100:103],v[36:39]
s_waitcnt lgkmcnt(5)
v_mfma_f32_16x16x32_bf16 v[32:35],a[80:83],v[104:107],v[32:35]
ds_read_b128 v[64:67],v6 offset:2048
v_mfma_f32_16x16x32_bf16 v[36:39],a[84:87],v[104:107],v[36:39]
s_waitcnt lgkmcnt(5)
v_mfma_f32_16x16x32_bf16 v[32:35],a[88:91],v[108:111],v[32:35]
ds_read_b128 v[68:71],v6 offset:3072
v_mfma_f32_16x16x32_bf16 v[36:39],a[92:95],v[108:111],v[36:39]
s_waitcnt lgkmcnt(5)
v_mfma_f32_16x16x32_bf16 v[32:35],a[96:99],v[112:115],v[32:35]
ds_read_b128 v[72:75],v6 offset:4096
v_mfma_f32_16x16x32_bf16 v[36:39],a[100:103],v[112:115],v[36:39]
s_waitcnt lgkmcnt(5)
v_mfma_f32_16x16x32_bf16 v[32:35],a[104:107],v[116:119],v[32:35]
ds_read_b128 v[76:79],v6 offset:5120
v_mfma_f32_16x16x32_bf16 v[36:39],a[108:111],v[116:119],v[36:39]
s_waitcnt lgkmcnt(5)
v_mfma_f32_16x16x32_bf16 v[32:35],a[112:115],v[120:123],v[32:35]
ds_read_b128 v[80:83],v6 offset:6144
v_mfma_f32_16x16x32_bf16 v[36:39],a[116:119],v[120:123],v[36:39]
s_waitcnt lgkmcnt(5)
v_mfma_f32_16x16x32_bf16 v[32:35],a[120:123],v[124:127],v[32:35]
ds_read_b128 v[84:87],v7 offset:0
v_mfma_f32_16x16x32_bf16 v[36:39],a[124:127],v[124:127],v[36:39]
s_waitcnt lgkmcnt(5)
v_mfma_f32_16x16x32_bf16 v[32:35],a[128:131],v[64:67],v[32:35]
ds_read_b128 v[88:91],v7 offset:1024
v_mfma_f32_16x16x32_bf16 v[36:39],a[132:135],v[64:67],v[36:39]
s_waitcnt lgkmcnt(5)
v_mfma_f32_16x16x32_bf16 v[32:35],a[136:139],v[68:71],v[32:35]
ds_read_b128 v[92:95],v7 offset:2048
v_mfma_f32_16x16x32_bf16 v[36:39],a[140:143],v[68:71],v[36:39]
s_waitcnt lgkmcnt(5)
v_mfma_f32_16x16x32_bf16 v[32:35],a[144:147],v[72:75],v[32:35]
ds_read_b128 v[96:99],v7 offset:3072
v_mfma_f32_16x16x32_bf16 v[36:39],a[148:151],v[72:75],v[36:39]
s_waitcnt vmcnt(0)
v_cmp_gt_u32 vcc,s71,v16
s_cbranch_vccnz vN_128
s_waitcnt lgkmcnt(5)
v_mfma_f32_16x16x32_bf16 v[32:35],a[152:155],v[76:79],v[32:35]
ds_read_b128 v[100:103],v7 offset:4096
s_add_u32 m0,s70,s63
v_mfma_f32_16x16x32_bf16 v[36:39],a[156:159],v[76:79],v[36:39]
s_add_u32 s62,s61,4096
s_waitcnt lgkmcnt(5)
v_mfma_f32_16x16x32_bf16 v[32:35],a[160:163],v[80:83],v[32:35]
ds_read_b128 v[104:107],v7 offset:5120
buffer_load_dwordx4 v3,s[20:23],s61 offen offset:0 lds
v_mfma_f32_16x16x32_bf16 v[36:39],a[164:167],v[80:83],v[36:39]
buffer_load_dwordx4 v3,s[20:23],s61 offen offset:1024 lds
s_waitcnt lgkmcnt(5)
v_mfma_f32_16x16x32_bf16 v[32:35],a[168:171],v[84:87],v[32:35]
ds_read_b128 v[108:111],v7 offset:6144
buffer_load_dwordx4 v3,s[20:23],s61 offen offset:2048 lds
v_mfma_f32_16x16x32_bf16 v[36:39],a[172:175],v[84:87],v[36:39]
buffer_load_dwordx4 v3,s[20:23],s61 offen offset:3072 lds
s_waitcnt lgkmcnt(5)
v_mfma_f32_16x16x32_bf16 v[32:35],a[176:179],v[88:91],v[32:35]
s_add_u32 m0,m0,4096
v_mfma_f32_16x16x32_bf16 v[36:39],a[180:183],v[88:91],v[36:39]
buffer_load_dwordx4 v3,s[20:23],s62 offen offset:0 lds
s_waitcnt lgkmcnt(4)
v_mfma_f32_16x16x32_bf16 v[32:35],a[184:187],v[92:95],v[32:35]
buffer_load_dwordx4 v3,s[20:23],s62 offen offset:1024 lds
v_mfma_f32_16x16x32_bf16 v[36:39],a[188:191],v[92:95],v[36:39]
buffer_load_dwordx4 v3,s[20:23],s62 offen offset:2048 lds
s_waitcnt lgkmcnt(3)
v_mfma_f32_16x16x32_bf16 v[32:35],a[192:195],v[96:99],v[32:35]
s_add_u32 s61,s61,114688
v_mfma_f32_16x16x32_bf16 v[36:39],a[196:199],v[96:99],v[36:39]
s_add_u32 s70,s70,32768
s_waitcnt lgkmcnt(2)
v_mfma_f32_16x16x32_bf16 v[32:35],a[200:203],v[100:103],v[32:35]
s_and_b32 s70,s70,0x1ffff
v_mfma_f32_16x16x32_bf16 v[36:39],a[204:207],v[100:103],v[36:39]
s_waitcnt lgkmcnt(1)
v_mfma_f32_16x16x32_bf16 v[32:35],a[208:211],v[104:107],v[32:35]
v_mfma_f32_16x16x32_bf16 v[36:39],a[212:215],v[104:107],v[36:39]
s_waitcnt lgkmcnt(0)
v_mfma_f32_16x16x32_bf16 v[32:35],a[216:219],v[108:111],v[32:35]
v_mfma_f32_16x16x32_bf16 v[36:39],a[220:223],v[108:111],v[36:39]
s_mov_b32 s72,1
join_129:
s_add_u32 s64,s74,s75
s_cmp_eq_u32 s56,1
s_cbranch_scc1 b1_134
s_nop 2
buffer_store_dwordx4 v[32:35],v0,s[20:23],s64 offen offset:0
buffer_store_dwordx4 v[36:39],v0,s[20:23],s64 offen offset:1024
b2_135:
s_add_u32 s75,s75,6144
s_cmp_eq_u32 s75,24576
s_cselect_b32 s75,0,s75
s_add_u32 s60,s60,1
s_cmp_eq_u32 s72,0
s_cbranch_scc1 slowp_130
s_branch top_127
slowp_130:
s_waitcnt vmcnt(2)
v_cmp_gt_u32 vcc,s71,v16
s_cbranch_vccz lag_131
s_cmp_ge_u32 s60,128
s_cbranch_scc1 done_113
plp_136:
buffer_load_dword v16,v2,s[20:23],s68 offen sc1
s_waitcnt vmcnt(0)
v_cmp_gt_u32 vcc,s71,v16
s_cbranch_vccz pok_137
s_sleep 4
s_sub_u32 s90,s90,1
s_cmp_gt_i32 s90,0
s_cbranch_scc1 plp_136
pok_137:
s_branch lag_131
lfin_126:
s_add_u32 s71,s60,1
plp_143:
buffer_load_dword v16,v2,s[20:23],s68 offen sc1
s_waitcnt vmcnt(0)
v_cmp_gt_u32 vcc,s71,v16
s_cbranch_vccz pok_144
s_sleep 4
s_sub_u32 s90,s90,1
s_cmp_gt_i32 s90,0
s_cbranch_scc1 plp_143
pok_144:
lag_142:
s_add_u32 m0,s70,s63
s_add_u32 s62,s61,4096
buffer_load_dwordx4 v3,s[20:23],s61 offen offset:0 lds
buffer_load_dwordx4 v3,s[20:23],s61 offen offset:1024 lds
buffer_load_dwordx4 v3,s[20:23],s61 offen offset:2048 lds
buffer_load_dwordx4 v3,s[20:23],s61 offen offset:3072 lds
s_add_u32 m0,m0,4096
s_nop 0
buffer_load_dwordx4 v3,s[20:23],s62 offen offset:0 lds
buffer_load_dwordx4 v3,s[20:23],s62 offen offset:1024 lds
buffer_load_dwordx4 v3,s[20:23],s62 offen offset:2048 lds
s_add_u32 s61,s61,114688
s_add_u32 s70,s70,32768
s_and_b32 s70,s70,0x1ffff
top_138:
s_add_u32 s71,s60,2
buffer_load_dword v16,v2,s[20:23],s68 offen sc1
s_add_u32 s64,s74,s75
s_add_u32 s65,s64,4096
buffer_load_dwordx4 v[128:131],v0,s[20:23],s64 offen offset:0 sc1
buffer_load_dwordx4 v[132:135],v0,s[20:23],s64 offen offset:1024 sc1
buffer_load_dwordx4 v[136:139],v0,s[20:23],s64 offen offset:2048 sc1
buffer_load_dwordx4 v[140:143],v0,s[20:23],s64 offen offset:3072 sc1
buffer_load_dwordx4 v[144:147],v0,s[20:23],s65 offen offset:0 sc1
buffer_load_dwordx4 v[148:151],v0,s[20:23],s65 offen offset:1024 sc1
s_add_u32 s64,s66,201326592
buffer_load_dwordx4 v[160:163],v0,s[20:23],s64 offen
s_add_u32 s64,s66,214958080
buffer_load_dwordx4 v[164:167],v0,s[20:23],s64 offen
v_add_u32 v4,s55,v8
v_add_u32 v5,s55,v9
v_add_u32 v6,s55,v10
v_add_u32 v7,s55,v11
s_add_u32 s55,s55,32768
s_and_b32 s55,s55,0x1ffff
s_waitcnt vmcnt(15)
ds_read_b128 v[64:67],v4 offset:0
s_waitcnt vmcnt(14)
ds_read_b128 v[68:71],v4 offset:1024
s_waitcnt vmcnt(13)
ds_read_b128 v[72:75],v4 offset:2048
s_waitcnt lgkmcnt(2)
v_mfma_f32_16x16x32_bf16 v[32:35],a[0:3],v[64:67],0
v_mfma_f32_16x16x32_bf16 v[36:39],a[4:7],v[64:67],0
s_waitcnt vmcnt(12)
ds_read_b128 v[76:79],v4 offset:3072
s_waitcnt lgkmcnt(2)
v_mfma_f32_16x16x32_bf16 v[32:35],a[8:11],v[68:71],v[32:35]
v_mfma_f32_16x16x32_bf16 v[36:39],a[12:15],v[68:71],v[36:39]
s_waitcnt vmcnt(11)
ds_read_b128 v[80:83],v4 offset:4096
s_waitcnt lgkmcnt(2)
v_mfma_f32_16x16x32_bf16 v[32:35],a[16:19],v[72:75],v[32:35]
v_mfma_f32_16x16x32_bf16 v[36:39],a[20:23],v[72:75],v[36:39]
s_waitcnt vmcnt(10)
ds_read_b128 v[84:87],v4 offset:5120
s_waitcnt lgkmcnt(2)
v_mfma_f32_16x16x32_bf16 v[32:35],a[24:27],v[76:79],v[32:35]
v_mfma_f32_16x16x32_bf16 v[36:39],a[28:31],v[76:79],v[36:39]
s_waitcnt vmcnt(9)
ds_read_b128 v[88:91],v4 offset:6144
s_barrier
s_waitcnt lgkmcnt(2)
v_mfma_f32_16x16x32_bf16 v[32:35],a[32:35],v[80:83],v[32:35]
v_mfma_f32_16x16x32_bf16 v[36:39],a[36:39],v[80:83],v[36:39]
ds_read_b128 v[92:95],v5 offset:0
s_waitcnt lgkmcnt(2)
v_mfma_f32_16x16x32_bf16 v[32:35],a[40:43],v[84:87],v[32:35]
ds_read_b128 v[96:99],v5 offset:1024
ds_read_b128 v[100:103],v5 offset:2048
v_mfma_f32_16x16x32_bf16 v[36:39],a[44:47],v[84:87],v[36:39]
s_waitcnt lgkmcnt(3)
v_mfma_f32_16x16x32_bf16 v[32:35],a[48:51],v[88:91],v[32:35]
ds_read_b128 v[104:107],v5 offset:3072
ds_read_b128 v[108:111],v5 offset:4096
v_mfma_f32_16x16x32_bf16 v[36:39],a[52:55],v[88:91],v[36:39]
s_waitcnt lgkmcnt(4)
v_mfma_f32_16x16x32_bf16 v[32:35],a[56:59],v[92:95],v[32:35]
ds_read_b128 v[112:115],v5 offset:5120
ds_read_b128 v[116:119],v5 offset:6144
v_mfma_f32_16x16x32_bf16 v[36:39],a[60:63],v[92:95],v[36:39]
s_waitcnt lgkmcnt(5)
v_mfma_f32_16x16x32_bf16 v[32:35],a[64:67],v[96:99],v[32:35]
ds_read_b128 v[120:123],v6 offset:0
v_mfma_f32_16x16x32_bf16 v[36:39],a[68:71],v[96:99],v[36:39]
s_waitcnt lgkmcnt(5)
v_mfma_f32_16x16x32_bf16 v[32:35],a[72:75],v[100:103],v[32:35]
ds_read_b128 v[124:127],v6 offset:1024
v_mfma_f32_16x16x32_bf16 v[36:39],a[76:79],v[100:103],v[36:39]
s_waitcnt lgkmcnt(5)
v_mfma_f32_16x16x32_bf16 v[32:35],a[80:83],v[104:107],v[32:35]
ds_read_b128 v[64:67],v6 offset:2048
v_mfma_f32_16x16x32_bf16 v[36:39],a[84:87],v[104:107],v[36:39]
s_waitcnt lgkmcnt(5)
v_mfma_f32_16x16x32_bf16 v[32:35],a[88:91],v[108:111],v[32:35]
ds_read_b128 v[68:71],v6 offset:3072
v_mfma_f32_16x16x32_bf16 v[36:39],a[92:95],v[108:111],v[36:39]
s_waitcnt lgkmcnt(5)
v_mfma_f32_16x16x32_bf16 v[32:35],a[96:99],v[112:115],v[32:35]
ds_read_b128 v[72:75],v6 offset:4096
v_mfma_f32_16x16x32_bf16 v[36:39],a[100:103],v[112:115],v[36:39]
s_waitcnt lgkmcnt(5)
v_mfma_f32_16x16x32_bf16 v[32:35],a[104:107],v[116:119],v[32:35]
ds_read_b128 v[76:79],v6 offset:5120
v_mfma_f32_16x16x32_bf16 v[36:39],a[108:111],v[116:119],v[36:39]
s_waitcnt lgkmcnt(5)
v_mfma_f32_16x16x32_bf16 v[32:35],a[112:115],v[120:123],v[32:35]
ds_read_b128 v[80:83],v6 offset:6144
v_mfma_f32_16x16x32_bf16 v[36:39],a[116:119],v[120:123],v[36:39]
s_waitcnt lgkmcnt(5)
v_mfma_f32_16x16x32_bf16 v[32:35],a[120:123],v[124:127],v[32:35]
ds_read_b128 v[84:87],v7 offset:0
v_mfma_f32_16x16x32_bf16 v[36:39],a[124:127],v[124:127],v[36:39]
s_waitcnt lgkmcnt(5)
v_mfma_f32_16x16x32_bf16 v[32:35],a[128:131],v[64:67],v[32:35]
ds_read_b128 v[88:91],v7 offset:1024
v_mfma_f32_16x16x32_bf16 v[36:39],a[132:135],v[64:67],v[36:39]
s_waitcnt lgkmcnt(5)
v_mfma_f32_16x16x32_bf16 v[32:35],a[136:139],v[68:71],v[32:35]
ds_read_b128 v[92:95],v7 offset:2048
v_mfma_f32_16x16x32_bf16 v[36:39],a[140:143],v[68:71],v[36:39]
s_waitcnt lgkmcnt(5)
v_mfma_f32_16x16x32_bf16 v[32:35],a[144:147],v[72:75],v[32:35]
ds_read_b128 v[96:99],v7 offset:3072
v_mfma_f32_16x16x32_bf16 v[36:39],a[148:151],v[72:75],v[36:39]
s_waitcnt vmcnt(0)
s_cmp_eq_u32 s77,0
s_cbranch_scc1 np_145
ck_146:
v_pk_add_f32 v[128:129],v[128:129],v[136:137]
v_pk_add_f32 v[144:145],v[144:145],v[40:41]
v_pk_add_f32 v[130:131],v[130:131],v[138:139]
v_pk_add_f32 v[146:147],v[146:147],v[42:43]
v_pk_add_f32 v[132:133],v[132:133],v[140:141]
v_pk_add_f32 v[148:149],v[148:149],v[44:45]
v_pk_add_f32 v[134:135],v[134:135],v[142:143]
v_pk_add_f32 v[150:151],v[150:151],v[46:47]
v_pk_add_f32 v[128:129],v[128:129],v[144:145]
v_pk_add_f32 v[130:131],v[130:131],v[146:147]
v_pk_add_f32 v[132:133],v[132:133],v[148:149]
v_pk_add_f32 v[134:135],v[134:135],v[150:151]
v_pk_add_f32 v[168:169],v[128:129],v[130:131]
v_pk_add_f32 v[170:171],v[132:133],v[134:135]
v_pk_add_f32 v[168:169],v[168:169],v[170:171]
v_cmp_u_f32 vcc,v168,v169
s_cbranch_vccnz rt_147
go_148:
v_lshlrev_b32 v168,16,v160
v_and_b32 v169,s73,v160
v_lshlrev_b32 v170,16,v161
v_and_b32 v171,s73,v161
v_lshlrev_b32 v172,16,v162
v_and_b32 v173,s73,v162
v_lshlrev_b32 v174,16,v163
v_and_b32 v175,s73,v163
v_lshlrev_b32 v176,16,v164
v_and_b32 v177,s73,v164
v_lshlrev_b32 v178,16,v165
v_and_b32 v179,s73,v165
v_lshlrev_b32 v180,16,v166
v_and_b32 v181,s73,v166
v_lshlrev_b32 v182,16,v167
v_and_b32 v183,s73,v167
v_pk_add_f32 v[128:129],v[128:129],v[176:177]
v_pk_add_f32 v[130:131],v[130:131],v[178:179]
v_pk_add_f32 v[132:133],v[132:133],v[180:181]
v_pk_add_f32 v[134:135],v[134:135],v[182:183]
v_fma_f32 v168,v128,v152,v168
v_fma_f32 v169,v129,v153,v169
v_fma_f32 v170,v130,v154,v170
v_fma_f32 v171,v131,v155,v171
v_fma_f32 v172,v132,v156,v172
v_fma_f32 v173,v133,v157,v173
v_fma_f32 v174,v134,v158,v174
v_fma_f32 v175,v135,v159,v175
v_cvt_pk_bf16_f32 v176,v168,v169
v_cvt_pk_bf16_f32 v177,v170,v171
v_cvt_pk_bf16_f32 v178,v172,v173
v_cvt_pk_bf16_f32 v179,v174,v175
s_and_b32 s64,s66,0xffff8000
buffer_store_dwordx4 v[176:179],v18,s[24:27],s64 offen
s_add_u32 s64,s74,s75
s_add_u32 s65,s64,4096
s_cmp_eq_u32 s56,1
s_cbranch_scc1 b1_149
buffer_store_dwordx4 v[204:207],v0,s[20:23],s64 offen offset:0
buffer_store_dwordx4 v[204:207],v0,s[20:23],s64 offen offset:1024
buffer_store_dwordx4 v[204:207],v0,s[20:23],s64 offen offset:2048
buffer_store_dwordx4 v[204:207],v0,s[20:23],s64 offen offset:3072
buffer_store_dwordx4 v[204:207],v0,s[20:23],s65 offen offset:0
buffer_store_dwordx4 v[204:207],v0,s[20:23],s65 offen offset:1024
b2_150:
s_add_u32 s66,s66,32768
s_add_u32 s75,s75,6144
s_cmp_eq_u32 s75,24576
s_cselect_b32 s75,0,s75
s_add_u32 s76,s76,1
s_mov_b32 s77,0
np_145:
v_cmp_gt_u32 vcc,s71,v16
s_cbranch_vccnz vN_139
s_waitcnt lgkmcnt(5)
v_mfma_f32_16x16x32_bf16 v[32:35],a[152:155],v[76:79],v[32:35]
ds_read_b128 v[100:103],v7 offset:4096
s_add_u32 m0,s70,s63
v_mfma_f32_16x16x32_bf16 v[36:39],a[156:159],v[76:79],v[36:39]
s_add_u32 s62,s61,4096
s_waitcnt lgkmcnt(5)
v_mfma_f32_16x16x32_bf16 v[32:35],a[160:163],v[80:83],v[32:35]
ds_read_b128 v[104:107],v7 offset:5120
buffer_load_dwordx4 v3,s[20:23],s61 offen offset:0 lds
v_mfma_f32_16x16x32_bf16 v[36:39],a[164:167],v[80:83],v[36:39]
buffer_load_dwordx4 v3,s[20:23],s61 offen offset:1024 lds
s_waitcnt lgkmcnt(5)
v_mfma_f32_16x16x32_bf16 v[32:35],a[168:171],v[84:87],v[32:35]
ds_read_b128 v[108:111],v7 offset:6144
buffer_load_dwordx4 v3,s[20:23],s61 offen offset:2048 lds
v_mfma_f32_16x16x32_bf16 v[36:39],a[172:175],v[84:87],v[36:39]
buffer_load_dwordx4 v3,s[20:23],s61 offen offset:3072 lds
s_waitcnt lgkmcnt(5)
v_mfma_f32_16x16x32_bf16 v[32:35],a[176:179],v[88:91],v[32:35]
s_add_u32 m0,m0,4096
v_mfma_f32_16x16x32_bf16 v[36:39],a[180:183],v[88:91],v[36:39]
buffer_load_dwordx4 v3,s[20:23],s62 offen offset:0 lds
s_waitcnt lgkmcnt(4)
v_mfma_f32_16x16x32_bf16 v[32:35],a[184:187],v[92:95],v[32:35]
buffer_load_dwordx4 v3,s[20:23],s62 offen offset:1024 lds
v_mfma_f32_16x16x32_bf16 v[36:39],a[188:191],v[92:95],v[36:39]
buffer_load_dwordx4 v3,s[20:23],s62 offen offset:2048 lds
s_waitcnt lgkmcnt(3)
v_mfma_f32_16x16x32_bf16 v[32:35],a[192:195],v[96:99],v[32:35]
s_add_u32 s61,s61,114688
v_mfma_f32_16x16x32_bf16 v[36:39],a[196:199],v[96:99],v[36:39]
s_add_u32 s70,s70,32768
s_waitcnt lgkmcnt(2)
v_mfma_f32_16x16x32_bf16 v[32:35],a[200:203],v[100:103],v[32:35]
s_and_b32 s70,s70,0x1ffff
v_mfma_f32_16x16x32_bf16 v[36:39],a[204:207],v[100:103],v[36:39]
s_waitcnt lgkmcnt(1)
v_mfma_f32_16x16x32_bf16 v[32:35],a[208:211],v[104:107],v[32:35]
v_mfma_f32_16x16x32_bf16 v[36:39],a[212:215],v[104:107],v[36:39]
s_waitcnt lgkmcnt(0)
v_mfma_f32_16x16x32_bf16 v[32:35],a[216:219],v[108:111],v[32:35]
v_mfma_f32_16x16x32_bf16 v[36:39],a[220:223],v[108:111],v[36:39]
s_mov_b32 s72,1
join_140:
s_nop 5
v_mov_b32 v40,v32
v_mov_b32 v41,v33
v_mov_b32 v42,v34
v_mov_b32 v43,v35
v_mov_b32 v44,v36
v_mov_b32 v45,v37
v_mov_b32 v46,v38
v_mov_b32 v47,v39
s_mov_b32 s77,1
s_add_u32 s60,s60,1
s_cmp_eq_u32 s72,0
s_cbranch_scc1 slowp_141
s_branch top_138
slowp_141:
s_waitcnt vmcnt(0)
v_cmp_gt_u32 vcc,s71,v16
s_cbranch_vccz lag_142
s_add_u32 s64,s66,201326592
buffer_load_dwordx4 v[160:163],v0,s[20:23],s64 offen
s_add_u32 s64,s66,214958080
buffer_load_dwordx4 v[164:167],v0,s[20:23],s64 offen
s_add_u32 s64,s74,s75
s_add_u32 s65,s64,4096
buffer_load_dwordx4 v[128:131],v0,s[20:23],s64 offen offset:0 sc1
buffer_load_dwordx4 v[132:135],v0,s[20:23],s64 offen offset:1024 sc1
buffer_load_dwordx4 v[136:139],v0,s[20:23],s64 offen offset:2048 sc1
buffer_load_dwordx4 v[140:143],v0,s[20:23],s64 offen offset:3072 sc1
buffer_load_dwordx4 v[144:147],v0,s[20:23],s65 offen offset:0 sc1
buffer_load_dwordx4 v[148:151],v0,s[20:23],s65 offen offset:1024 sc1
s_waitcnt vmcnt(0)
ck_151:
v_pk_add_f32 v[128:129],v[128:129],v[136:137]
v_pk_add_f32 v[144:145],v[144:145],v[40:41]
v_pk_add_f32 v[130:131],v[130:131],v[138:139]
v_pk_add_f32 v[146:147],v[146:147],v[42:43]
v_pk_add_f32 v[132:133],v[132:133],v[140:141]
v_pk_add_f32 v[148:149],v[148:149],v[44:45]
v_pk_add_f32 v[134:135],v[134:135],v[142:143]
v_pk_add_f32 v[150:151],v[150:151],v[46:47]
v_pk_add_f32 v[128:129],v[128:129],v[144:145]
v_pk_add_f32 v[130:131],v[130:131],v[146:147]
v_pk_add_f32 v[132:133],v[132:133],v[148:149]
v_pk_add_f32 v[134:135],v[134:135],v[150:151]
v_pk_add_f32 v[168:169],v[128:129],v[130:131]
v_pk_add_f32 v[170:171],v[132:133],v[134:135]
v_pk_add_f32 v[168:169],v[168:169],v[170:171]
v_cmp_u_f32 vcc,v168,v169
s_cbranch_vccnz rt_152
go_153:
v_lshlrev_b32 v168,16,v160
v_and_b32 v169,s73,v160
v_lshlrev_b32 v170,16,v161
v_and_b32 v171,s73,v161
v_lshlrev_b32 v172,16,v162
v_and_b32 v173,s73,v162
v_lshlrev_b32 v174,16,v163
v_and_b32 v175,s73,v163
v_lshlrev_b32 v176,16,v164
v_and_b32 v177,s73,v164
v_lshlrev_b32 v178,16,v165
v_and_b32 v179,s73,v165
v_lshlrev_b32 v180,16,v166
v_and_b32 v181,s73,v166
v_lshlrev_b32 v182,16,v167
v_and_b32 v183,s73,v167
v_pk_add_f32 v[128:129],v[128:129],v[176:177]
v_pk_add_f32 v[130:131],v[130:131],v[178:179]
v_pk_add_f32 v[132:133],v[132:133],v[180:181]
v_pk_add_f32 v[134:135],v[134:135],v[182:183]
v_fma_f32 v168,v128,v152,v168
v_fma_f32 v169,v129,v153,v169
v_fma_f32 v170,v130,v154,v170
v_fma_f32 v171,v131,v155,v171
v_fma_f32 v172,v132,v156,v172
v_fma_f32 v173,v133,v157,v173
v_fma_f32 v174,v134,v158,v174
v_fma_f32 v175,v135,v159,v175
v_cvt_pk_bf16_f32 v176,v168,v169
v_cvt_pk_bf16_f32 v177,v170,v171
v_cvt_pk_bf16_f32 v178,v172,v173
v_cvt_pk_bf16_f32 v179,v174,v175
s_and_b32 s64,s66,0xffff8000
buffer_store_dwordx4 v[176:179],v18,s[24:27],s64 offen
s_add_u32 s64,s74,s75
s_add_u32 s65,s64,4096
s_cmp_eq_u32 s56,1
s_cbranch_scc1 b1_154
buffer_store_dwordx4 v[204:207],v0,s[20:23],s64 offen offset:0
buffer_store_dwordx4 v[204:207],v0,s[20:23],s64 offen offset:1024
buffer_store_dwordx4 v[204:207],v0,s[20:23],s64 offen offset:2048
buffer_store_dwordx4 v[204:207],v0,s[20:23],s64 offen offset:3072
buffer_store_dwordx4 v[204:207],v0,s[20:23],s65 offen offset:0
buffer_store_dwordx4 v[204:207],v0,s[20:23],s65 offen offset:1024
b2_155:
s_add_u32 s66,s66,32768
s_add_u32 s75,s75,6144
s_cmp_eq_u32 s75,24576
s_cselect_b32 s75,0,s75
s_add_u32 s76,s76,1
s_mov_b32 s77,0
s_cmp_ge_u32 s60,128
s_cbranch_scc1 done_113
plp_156:
buffer_load_dword v16,v2,s[20:23],s68 offen sc1
s_waitcnt vmcnt(0)
v_cmp_gt_u32 vcc,s71,v16
s_cbranch_vccz pok_157
s_sleep 4
s_sub_u32 s90,s90,1
s_cmp_gt_i32 s90,0
s_cbranch_scc1 plp_156
pok_157:
s_branch lag_142
vN_128:
buffer_load_dword v16,v2,s[20:23],s68 offen sc1
s_waitcnt lgkmcnt(5)
v_mfma_f32_16x16x32_bf16 v[32:35],a[152:155],v[76:79],v[32:35]
ds_read_b128 v[100:103],v7 offset:4096
v_mfma_f32_16x16x32_bf16 v[36:39],a[156:159],v[76:79],v[36:39]
s_waitcnt lgkmcnt(5)
v_mfma_f32_16x16x32_bf16 v[32:35],a[160:163],v[80:83],v[32:35]
ds_read_b128 v[104:107],v7 offset:5120
v_mfma_f32_16x16x32_bf16 v[36:39],a[164:167],v[80:83],v[36:39]
s_waitcnt lgkmcnt(5)
v_mfma_f32_16x16x32_bf16 v[32:35],a[168:171],v[84:87],v[32:35]
ds_read_b128 v[108:111],v7 offset:6144
v_mfma_f32_16x16x32_bf16 v[36:39],a[172:175],v[84:87],v[36:39]
s_waitcnt lgkmcnt(5)
v_mfma_f32_16x16x32_bf16 v[32:35],a[176:179],v[88:91],v[32:35]
v_mfma_f32_16x16x32_bf16 v[36:39],a[180:183],v[88:91],v[36:39]
s_waitcnt lgkmcnt(4)
v_mfma_f32_16x16x32_bf16 v[32:35],a[184:187],v[92:95],v[32:35]
v_mfma_f32_16x16x32_bf16 v[36:39],a[188:191],v[92:95],v[36:39]
s_waitcnt lgkmcnt(3)
v_mfma_f32_16x16x32_bf16 v[32:35],a[192:195],v[96:99],v[32:35]
v_mfma_f32_16x16x32_bf16 v[36:39],a[196:199],v[96:99],v[36:39]
s_waitcnt lgkmcnt(2)
v_mfma_f32_16x16x32_bf16 v[32:35],a[200:203],v[100:103],v[32:35]
v_mfma_f32_16x16x32_bf16 v[36:39],a[204:207],v[100:103],v[36:39]
s_waitcnt lgkmcnt(1)
v_mfma_f32_16x16x32_bf16 v[32:35],a[208:211],v[104:107],v[32:35]
v_mfma_f32_16x16x32_bf16 v[36:39],a[212:215],v[104:107],v[36:39]
s_waitcnt lgkmcnt(0)
v_mfma_f32_16x16x32_bf16 v[32:35],a[216:219],v[108:111],v[32:35]
v_mfma_f32_16x16x32_bf16 v[36:39],a[220:223],v[108:111],v[36:39]
s_mov_b32 s72,0
s_branch join_129
b1_134:
s_nop 7
buffer_store_dwordx4 v[32:35],v0,s[20:23],s64 offen offset:0 sc1
buffer_store_dwordx4 v[36:39],v0,s[20:23],s64 offen offset:1024 sc1
s_branch b2_135
rt_147:
s_sub_u32 s90,s90,1
s_cmp_gt_i32 s90,0
s_cbranch_scc0 go_148
s_add_u32 s64,s74,s75
s_add_u32 s65,s64,4096
buffer_load_dwordx4 v[128:131],v0,s[20:23],s64 offen offset:0 sc1
buffer_load_dwordx4 v[132:135],v0,s[20:23],s64 offen offset:1024 sc1
buffer_load_dwordx4 v[136:139],v0,s[20:23],s64 offen offset:2048 sc1
buffer_load_dwordx4 v[140:143],v0,s[20:23],s64 offen offset:3072 sc1
buffer_load_dwordx4 v[144:147],v0,s[20:23],s65 offen offset:0 sc1
buffer_load_dwordx4 v[148:151],v0,s[20:23],s65 offen offset:1024 sc1
s_waitcnt vmcnt(0)
s_branch ck_146
b1_149:
s_nop 7
buffer_store_dwordx4 v[204:207],v0,s[20:23],s64 offen offset:0 sc1
buffer_store_dwordx4 v[204:207],v0,s[20:23],s64 offen offset:1024 sc1
buffer_store_dwordx4 v[204:207],v0,s[20:23],s64 offen offset:2048 sc1
buffer_store_dwordx4 v[204:207],v0,s[20:23],s64 offen offset:3072 sc1
buffer_store_dwordx4 v[204:207],v0,s[20:23],s65 offen offset:0 sc1
buffer_store_dwordx4 v[204:207],v0,s[20:23],s65 offen offset:1024 sc1
s_branch b2_150
vN_139:
buffer_load_dword v16,v2,s[20:23],s68 offen sc1
s_waitcnt lgkmcnt(5)
v_mfma_f32_16x16x32_bf16 v[32:35],a[152:155],v[76:79],v[32:35]
ds_read_b128 v[100:103],v7 offset:4096
v_mfma_f32_16x16x32_bf16 v[36:39],a[156:159],v[76:79],v[36:39]
s_waitcnt lgkmcnt(5)
v_mfma_f32_16x16x32_bf16 v[32:35],a[160:163],v[80:83],v[32:35]
ds_read_b128 v[104:107],v7 offset:5120
v_mfma_f32_16x16x32_bf16 v[36:39],a[164:167],v[80:83],v[36:39]
s_waitcnt lgkmcnt(5)
v_mfma_f32_16x16x32_bf16 v[32:35],a[168:171],v[84:87],v[32:35]
ds_read_b128 v[108:111],v7 offset:6144
v_mfma_f32_16x16x32_bf16 v[36:39],a[172:175],v[84:87],v[36:39]
s_waitcnt lgkmcnt(5)
v_mfma_f32_16x16x32_bf16 v[32:35],a[176:179],v[88:91],v[32:35]
v_mfma_f32_16x16x32_bf16 v[36:39],a[180:183],v[88:91],v[36:39]
s_waitcnt lgkmcnt(4)
v_mfma_f32_16x16x32_bf16 v[32:35],a[184:187],v[92:95],v[32:35]
v_mfma_f32_16x16x32_bf16 v[36:39],a[188:191],v[92:95],v[36:39]
s_waitcnt lgkmcnt(3)
v_mfma_f32_16x16x32_bf16 v[32:35],a[192:195],v[96:99],v[32:35]
v_mfma_f32_16x16x32_bf16 v[36:39],a[196:199],v[96:99],v[36:39]
s_waitcnt lgkmcnt(2)
v_mfma_f32_16x16x32_bf16 v[32:35],a[200:203],v[100:103],v[32:35]
v_mfma_f32_16x16x32_bf16 v[36:39],a[204:207],v[100:103],v[36:39]
s_waitcnt lgkmcnt(1)
v_mfma_f32_16x16x32_bf16 v[32:35],a[208:211],v[104:107],v[32:35]
v_mfma_f32_16x16x32_bf16 v[36:39],a[212:215],v[104:107],v[36:39]
s_waitcnt lgkmcnt(0)
v_mfma_f32_16x16x32_bf16 v[32:35],a[216:219],v[108:111],v[32:35]
v_mfma_f32_16x16x32_bf16 v[36:39],a[220:223],v[108:111],v[36:39]
s_mov_b32 s72,0
s_branch join_140
rt_152:
s_sub_u32 s90,s90,1
s_cmp_gt_i32 s90,0
s_cbranch_scc0 go_153
s_add_u32 s64,s74,s75
s_add_u32 s65,s64,4096
buffer_load_dwordx4 v[128:131],v0,s[20:23],s64 offen offset:0 sc1
buffer_load_dwordx4 v[132:135],v0,s[20:23],s64 offen offset:1024 sc1
buffer_load_dwordx4 v[136:139],v0,s[20:23],s64 offen offset:2048 sc1
buffer_load_dwordx4 v[140:143],v0,s[20:23],s64 offen offset:3072 sc1
buffer_load_dwordx4 v[144:147],v0,s[20:23],s65 offen offset:0 sc1
buffer_load_dwordx4 v[148:151],v0,s[20:23],s65 offen offset:1024 sc1
s_waitcnt vmcnt(0)
s_branch ck_151
b1_154:
s_nop 7
buffer_store_dwordx4 v[204:207],v0,s[20:23],s64 offen offset:0 sc1
buffer_store_dwordx4 v[204:207],v0,s[20:23],s64 offen offset:1024 sc1
buffer_store_dwordx4 v[204:207],v0,s[20:23],s64 offen offset:2048 sc1
buffer_store_dwordx4 v[204:207],v0,s[20:23],s64 offen offset:3072 sc1
buffer_store_dwordx4 v[204:207],v0,s[20:23],s65 offen offset:0 sc1
buffer_store_dwordx4 v[204:207],v0,s[20:23],s65 offen offset:1024 sc1
s_branch b2_155
done_113:
s_endpgm
fl_w3:
v_and_b32 v21,15,v1
v_lshrrev_b32 v22,4,v1
v_lshrrev_b32 v23,2,v21
v_and_b32 v24,3,v21
s_lshl_b32 s61,s50,15
v_lshl_add_u32 v25,v22,3,v23
s_load_dwordx2 s[4:5],s[0:1],80
s_mov_b32 s52,0
s_mov_b32 s53,s59
s_mul_i32 s54,s52,7340032
s_lshl_b32 s64,s53,8
s_add_u32 s54,s54,s64
s_lshl_b32 s64,s50,6
s_add_u32 s54,s54,s64
s_waitcnt lgkmcnt(0)
s_mov_b32 s28,s4
s_and_b32 s29,s5,0xffff
s_mov_b32 s30,0x700000
s_mov_b32 s31,0x20000
v_lshrrev_b32 v26,2,v1
v_and_b32 v27,3,v1
v_mul_u32_u24 v16,7168,v26
v_lshl_add_u32 v16,v27,4,v16
v_lshlrev_b32 v17,6,v25
v_lshl_add_u32 v17,v24,4,v17
v_add_u32 v17,s61,v17
s_xor_b32 s62,s50,0
s_mul_i32 s62,s62,1835008
s_add_u32 s62,s62,s54
s_add_u32 m0,s61,0
s_nop 0
buffer_load_dwordx4 v16,s[28:31],s62 offen lds
s_add_u32 s62,s62,114688
s_add_u32 m0,m0,1024
s_waitcnt vmcnt(6)
buffer_load_dwordx4 v16,s[28:31],s62 offen lds
s_add_u32 s62,s62,114688
s_add_u32 m0,m0,1024
s_waitcnt vmcnt(6)
buffer_load_dwordx4 v16,s[28:31],s62 offen lds
s_add_u32 s62,s62,114688
s_add_u32 m0,m0,1024
s_waitcnt vmcnt(6)
buffer_load_dwordx4 v16,s[28:31],s62 offen lds
s_add_u32 s62,s62,114688
s_add_u32 m0,m0,1024
s_waitcnt vmcnt(6)
buffer_load_dwordx4 v16,s[28:31],s62 offen lds
s_add_u32 s62,s62,114688
s_add_u32 m0,m0,1024
s_waitcnt vmcnt(6)
buffer_load_dwordx4 v16,s[28:31],s62 offen lds
s_add_u32 s62,s62,114688
s_add_u32 m0,m0,1024
s_waitcnt vmcnt(6)
buffer_load_dwordx4 v16,s[28:31],s62 offen lds
s_add_u32 s62,s62,114688
s_add_u32 m0,m0,1024
s_waitcnt vmcnt(6)
buffer_load_dwordx4 v16,s[28:31],s62 offen lds
s_add_u32 s62,s62,114688
s_add_u32 m0,m0,1024
s_waitcnt vmcnt(6)
buffer_load_dwordx4 v16,s[28:31],s62 offen lds
s_add_u32 s62,s62,114688
s_add_u32 m0,m0,1024
s_waitcnt vmcnt(6)
buffer_load_dwordx4 v16,s[28:31],s62 offen lds
s_add_u32 s62,s62,114688
s_add_u32 m0,m0,1024
s_waitcnt vmcnt(6)
buffer_load_dwordx4 v16,s[28:31],s62 offen lds
s_add_u32 s62,s62,114688
s_add_u32 m0,m0,1024
s_waitcnt vmcnt(6)
buffer_load_dwordx4 v16,s[28:31],s62 offen lds
s_add_u32 s62,s62,114688
s_add_u32 m0,m0,1024
s_waitcnt vmcnt(6)
buffer_load_dwordx4 v16,s[28:31],s62 offen lds
s_add_u32 s62,s62,114688
s_add_u32 m0,m0,1024
s_waitcnt vmcnt(6)
buffer_load_dwordx4 v16,s[28:31],s62 offen lds
s_add_u32 s62,s62,114688
s_add_u32 m0,m0,1024
s_waitcnt vmcnt(6)
buffer_load_dwordx4 v16,s[28:31],s62 offen lds
s_add_u32 s62,s62,114688
s_add_u32 m0,m0,1024
s_waitcnt vmcnt(6)
buffer_load_dwordx4 v16,s[28:31],s62 offen lds
s_waitcnt vmcnt(6)
s_xor_b32 s62,s50,1
s_mul_i32 s62,s62,1835008
s_add_u32 s62,s62,s54
s_add_u32 m0,s61,16384
s_nop 0
buffer_load_dwordx4 v16,s[28:31],s62 offen lds
s_add_u32 s62,s62,114688
s_add_u32 m0,m0,1024
s_waitcnt vmcnt(6)
buffer_load_dwordx4 v16,s[28:31],s62 offen lds
s_add_u32 s62,s62,114688
s_add_u32 m0,m0,1024
s_waitcnt vmcnt(6)
buffer_load_dwordx4 v16,s[28:31],s62 offen lds
s_add_u32 s62,s62,114688
s_add_u32 m0,m0,1024
s_waitcnt vmcnt(6)
buffer_load_dwordx4 v16,s[28:31],s62 offen lds
s_add_u32 s62,s62,114688
s_add_u32 m0,m0,1024
s_waitcnt vmcnt(6)
buffer_load_dwordx4 v16,s[28:31],s62 offen lds
s_add_u32 s62,s62,114688
s_add_u32 m0,m0,1024
s_waitcnt vmcnt(6)
buffer_load_dwordx4 v16,s[28:31],s62 offen lds
s_add_u32 s62,s62,114688
s_add_u32 m0,m0,1024
s_waitcnt vmcnt(6)
buffer_load_dwordx4 v16,s[28:31],s62 offen lds
s_add_u32 s62,s62,114688
s_add_u32 m0,m0,1024
s_waitcnt vmcnt(6)
buffer_load_dwordx4 v16,s[28:31],s62 offen lds
s_add_u32 s62,s62,114688
s_add_u32 m0,m0,1024
s_waitcnt vmcnt(6)
buffer_load_dwordx4 v16,s[28:31],s62 offen lds
s_add_u32 s62,s62,114688
s_add_u32 m0,m0,1024
s_waitcnt vmcnt(6)
buffer_load_dwordx4 v16,s[28:31],s62 offen lds
s_add_u32 s62,s62,114688
s_add_u32 m0,m0,1024
s_waitcnt vmcnt(6)
buffer_load_dwordx4 v16,s[28:31],s62 offen lds
s_add_u32 s62,s62,114688
s_add_u32 m0,m0,1024
s_waitcnt vmcnt(6)
buffer_load_dwordx4 v16,s[28:31],s62 offen lds
s_add_u32 s62,s62,114688
s_add_u32 m0,m0,1024
s_waitcnt vmcnt(6)
buffer_load_dwordx4 v16,s[28:31],s62 offen lds
s_add_u32 s62,s62,114688
s_add_u32 m0,m0,1024
s_waitcnt vmcnt(6)
buffer_load_dwordx4 v16,s[28:31],s62 offen lds
s_add_u32 s62,s62,114688
s_add_u32 m0,m0,1024
s_waitcnt vmcnt(6)
buffer_load_dwordx4 v16,s[28:31],s62 offen lds
s_add_u32 s62,s62,114688
s_add_u32 m0,m0,1024
s_waitcnt vmcnt(6)
buffer_load_dwordx4 v16,s[28:31],s62 offen lds
s_waitcnt vmcnt(6)
s_waitcnt vmcnt(16)
ds_read_b64_tr_b16 a[0:1],v17 offset:0
ds_read_b64_tr_b16 a[2:3],v17 offset:256
ds_read_b64_tr_b16 a[4:5],v17 offset:8
ds_read_b64_tr_b16 a[6:7],v17 offset:264
ds_read_b64_tr_b16 a[8:9],v17 offset:2048
ds_read_b64_tr_b16 a[10:11],v17 offset:2304
ds_read_b64_tr_b16 a[12:13],v17 offset:2056
ds_read_b64_tr_b16 a[14:15],v17 offset:2312
ds_read_b64_tr_b16 a[16:17],v17 offset:4096
ds_read_b64_tr_b16 a[18:19],v17 offset:4352
ds_read_b64_tr_b16 a[20:21],v17 offset:4104
ds_read_b64_tr_b16 a[22:23],v17 offset:4360
s_waitcnt lgkmcnt(0)
ds_read_b64_tr_b16 a[24:25],v17 offset:6144
ds_read_b64_tr_b16 a[26:27],v17 offset:6400
ds_read_b64_tr_b16 a[28:29],v17 offset:6152
ds_read_b64_tr_b16 a[30:31],v17 offset:6408
ds_read_b64_tr_b16 a[32:33],v17 offset:8192
ds_read_b64_tr_b16 a[34:35],v17 offset:8448
ds_read_b64_tr_b16 a[36:37],v17 offset:8200
ds_read_b64_tr_b16 a[38:39],v17 offset:8456
ds_read_b64_tr_b16 a[40:41],v17 offset:10240
ds_read_b64_tr_b16 a[42:43],v17 offset:10496
ds_read_b64_tr_b16 a[44:45],v17 offset:10248
ds_read_b64_tr_b16 a[46:47],v17 offset:10504
s_waitcnt lgkmcnt(0)
ds_read_b64_tr_b16 a[48:49],v17 offset:12288
ds_read_b64_tr_b16 a[50:51],v17 offset:12544
ds_read_b64_tr_b16 a[52:53],v17 offset:12296
ds_read_b64_tr_b16 a[54:55],v17 offset:12552
ds_read_b64_tr_b16 a[56:57],v17 offset:14336
ds_read_b64_tr_b16 a[58:59],v17 offset:14592
ds_read_b64_tr_b16 a[60:61],v17 offset:14344
ds_read_b64_tr_b16 a[62:63],v17 offset:14600
s_waitcnt lgkmcnt(0)
s_xor_b32 s62,s50,2
s_mul_i32 s62,s62,1835008
s_add_u32 s62,s62,s54
s_add_u32 m0,s61,0
s_nop 0
buffer_load_dwordx4 v16,s[28:31],s62 offen lds
s_add_u32 s62,s62,114688
s_add_u32 m0,m0,1024
s_waitcnt vmcnt(6)
buffer_load_dwordx4 v16,s[28:31],s62 offen lds
s_add_u32 s62,s62,114688
s_add_u32 m0,m0,1024
s_waitcnt vmcnt(6)
buffer_load_dwordx4 v16,s[28:31],s62 offen lds
s_add_u32 s62,s62,114688
s_add_u32 m0,m0,1024
s_waitcnt vmcnt(6)
buffer_load_dwordx4 v16,s[28:31],s62 offen lds
s_add_u32 s62,s62,114688
s_add_u32 m0,m0,1024
s_waitcnt vmcnt(6)
buffer_load_dwordx4 v16,s[28:31],s62 offen lds
s_add_u32 s62,s62,114688
s_add_u32 m0,m0,1024
s_waitcnt vmcnt(6)
buffer_load_dwordx4 v16,s[28:31],s62 offen lds
s_add_u32 s62,s62,114688
s_add_u32 m0,m0,1024
s_waitcnt vmcnt(6)
buffer_load_dwordx4 v16,s[28:31],s62 offen lds
s_add_u32 s62,s62,114688
s_add_u32 m0,m0,1024
s_waitcnt vmcnt(6)
buffer_load_dwordx4 v16,s[28:31],s62 offen lds
s_add_u32 s62,s62,114688
s_add_u32 m0,m0,1024
s_waitcnt vmcnt(6)
buffer_load_dwordx4 v16,s[28:31],s62 offen lds
s_add_u32 s62,s62,114688
s_add_u32 m0,m0,1024
s_waitcnt vmcnt(6)
buffer_load_dwordx4 v16,s[28:31],s62 offen lds
s_add_u32 s62,s62,114688
s_add_u32 m0,m0,1024
s_waitcnt vmcnt(6)
buffer_load_dwordx4 v16,s[28:31],s62 offen lds
s_add_u32 s62,s62,114688
s_add_u32 m0,m0,1024
s_waitcnt vmcnt(6)
buffer_load_dwordx4 v16,s[28:31],s62 offen lds
s_add_u32 s62,s62,114688
s_add_u32 m0,m0,1024
s_waitcnt vmcnt(6)
buffer_load_dwordx4 v16,s[28:31],s62 offen lds
s_add_u32 s62,s62,114688
s_add_u32 m0,m0,1024
s_waitcnt vmcnt(6)
buffer_load_dwordx4 v16,s[28:31],s62 offen lds
s_add_u32 s62,s62,114688
s_add_u32 m0,m0,1024
s_waitcnt vmcnt(6)
buffer_load_dwordx4 v16,s[28:31],s62 offen lds
s_add_u32 s62,s62,114688
s_add_u32 m0,m0,1024
s_waitcnt vmcnt(6)
buffer_load_dwordx4 v16,s[28:31],s62 offen lds
s_waitcnt vmcnt(6)
s_waitcnt vmcnt(16)
ds_read_b64_tr_b16 a[64:65],v17 offset:16384
ds_read_b64_tr_b16 a[66:67],v17 offset:16640
ds_read_b64_tr_b16 a[68:69],v17 offset:16392
ds_read_b64_tr_b16 a[70:71],v17 offset:16648
ds_read_b64_tr_b16 a[72:73],v17 offset:18432
ds_read_b64_tr_b16 a[74:75],v17 offset:18688
ds_read_b64_tr_b16 a[76:77],v17 offset:18440
ds_read_b64_tr_b16 a[78:79],v17 offset:18696
ds_read_b64_tr_b16 a[80:81],v17 offset:20480
ds_read_b64_tr_b16 a[82:83],v17 offset:20736
ds_read_b64_tr_b16 a[84:85],v17 offset:20488
ds_read_b64_tr_b16 a[86:87],v17 offset:20744
s_waitcnt lgkmcnt(0)
ds_read_b64_tr_b16 a[88:89],v17 offset:22528
ds_read_b64_tr_b16 a[90:91],v17 offset:22784
ds_read_b64_tr_b16 a[92:93],v17 offset:22536
ds_read_b64_tr_b16 a[94:95],v17 offset:22792
ds_read_b64_tr_b16 a[96:97],v17 offset:24576
ds_read_b64_tr_b16 a[98:99],v17 offset:24832
ds_read_b64_tr_b16 a[100:101],v17 offset:24584
ds_read_b64_tr_b16 a[102:103],v17 offset:24840
ds_read_b64_tr_b16 a[104:105],v17 offset:26624
ds_read_b64_tr_b16 a[106:107],v17 offset:26880
ds_read_b64_tr_b16 a[108:109],v17 offset:26632
ds_read_b64_tr_b16 a[110:111],v17 offset:26888
s_waitcnt lgkmcnt(0)
ds_read_b64_tr_b16 a[112:113],v17 offset:28672
ds_read_b64_tr_b16 a[114:115],v17 offset:28928
ds_read_b64_tr_b16 a[116:117],v17 offset:28680
ds_read_b64_tr_b16 a[118:119],v17 offset:28936
ds_read_b64_tr_b16 a[120:121],v17 offset:30720
ds_read_b64_tr_b16 a[122:123],v17 offset:30976
ds_read_b64_tr_b16 a[124:125],v17 offset:30728
ds_read_b64_tr_b16 a[126:127],v17 offset:30984
s_waitcnt lgkmcnt(0)
s_xor_b32 s62,s50,3
s_mul_i32 s62,s62,1835008
s_add_u32 s62,s62,s54
s_add_u32 m0,s61,16384
s_nop 0
buffer_load_dwordx4 v16,s[28:31],s62 offen lds
s_add_u32 s62,s62,114688
s_add_u32 m0,m0,1024
s_waitcnt vmcnt(6)
buffer_load_dwordx4 v16,s[28:31],s62 offen lds
s_add_u32 s62,s62,114688
s_add_u32 m0,m0,1024
s_waitcnt vmcnt(6)
buffer_load_dwordx4 v16,s[28:31],s62 offen lds
s_add_u32 s62,s62,114688
s_add_u32 m0,m0,1024
s_waitcnt vmcnt(6)
buffer_load_dwordx4 v16,s[28:31],s62 offen lds
s_add_u32 s62,s62,114688
s_add_u32 m0,m0,1024
s_waitcnt vmcnt(6)
buffer_load_dwordx4 v16,s[28:31],s62 offen lds
s_add_u32 s62,s62,114688
s_add_u32 m0,m0,1024
s_waitcnt vmcnt(6)
buffer_load_dwordx4 v16,s[28:31],s62 offen lds
s_add_u32 s62,s62,114688
s_add_u32 m0,m0,1024
s_waitcnt vmcnt(6)
buffer_load_dwordx4 v16,s[28:31],s62 offen lds
s_add_u32 s62,s62,114688
s_add_u32 m0,m0,1024
s_waitcnt vmcnt(6)
buffer_load_dwordx4 v16,s[28:31],s62 offen lds
s_add_u32 s62,s62,114688
s_add_u32 m0,m0,1024
s_waitcnt vmcnt(6)
buffer_load_dwordx4 v16,s[28:31],s62 offen lds
s_add_u32 s62,s62,114688
s_add_u32 m0,m0,1024
s_waitcnt vmcnt(6)
buffer_load_dwordx4 v16,s[28:31],s62 offen lds
s_add_u32 s62,s62,114688
s_add_u32 m0,m0,1024
s_waitcnt vmcnt(6)
buffer_load_dwordx4 v16,s[28:31],s62 offen lds
s_add_u32 s62,s62,114688
s_add_u32 m0,m0,1024
s_waitcnt vmcnt(6)
buffer_load_dwordx4 v16,s[28:31],s62 offen lds
s_add_u32 s62,s62,114688
s_add_u32 m0,m0,1024
s_waitcnt vmcnt(6)
buffer_load_dwordx4 v16,s[28:31],s62 offen lds
s_add_u32 s62,s62,114688
s_add_u32 m0,m0,1024
s_waitcnt vmcnt(6)
buffer_load_dwordx4 v16,s[28:31],s62 offen lds
s_add_u32 s62,s62,114688
s_add_u32 m0,m0,1024
s_waitcnt vmcnt(6)
buffer_load_dwordx4 v16,s[28:31],s62 offen lds
s_add_u32 s62,s62,114688
s_add_u32 m0,m0,1024
s_waitcnt vmcnt(6)
buffer_load_dwordx4 v16,s[28:31],s62 offen lds
s_waitcnt vmcnt(6)
s_waitcnt vmcnt(16)
ds_read_b64_tr_b16 a[128:129],v17 offset:0
ds_read_b64_tr_b16 a[130:131],v17 offset:256
ds_read_b64_tr_b16 a[132:133],v17 offset:8
ds_read_b64_tr_b16 a[134:135],v17 offset:264
ds_read_b64_tr_b16 a[136:137],v17 offset:2048
ds_read_b64_tr_b16 a[138:139],v17 offset:2304
ds_read_b64_tr_b16 a[140:141],v17 offset:2056
ds_read_b64_tr_b16 a[142:143],v17 offset:2312
ds_read_b64_tr_b16 a[144:145],v17 offset:4096
ds_read_b64_tr_b16 a[146:147],v17 offset:4352
ds_read_b64_tr_b16 a[148:149],v17 offset:4104
ds_read_b64_tr_b16 a[150:151],v17 offset:4360
s_waitcnt lgkmcnt(0)
ds_read_b64_tr_b16 a[152:153],v17 offset:6144
ds_read_b64_tr_b16 a[154:155],v17 offset:6400
ds_read_b64_tr_b16 a[156:157],v17 offset:6152
ds_read_b64_tr_b16 a[158:159],v17 offset:6408
ds_read_b64_tr_b16 a[160:161],v17 offset:8192
ds_read_b64_tr_b16 a[162:163],v17 offset:8448
ds_read_b64_tr_b16 a[164:165],v17 offset:8200
ds_read_b64_tr_b16 a[166:167],v17 offset:8456
ds_read_b64_tr_b16 a[168:169],v17 offset:10240
ds_read_b64_tr_b16 a[170:171],v17 offset:10496
ds_read_b64_tr_b16 a[172:173],v17 offset:10248
ds_read_b64_tr_b16 a[174:175],v17 offset:10504
s_waitcnt lgkmcnt(0)
ds_read_b64_tr_b16 a[176:177],v17 offset:12288
ds_read_b64_tr_b16 a[178:179],v17 offset:12544
ds_read_b64_tr_b16 a[180:181],v17 offset:12296
ds_read_b64_tr_b16 a[182:183],v17 offset:12552
ds_read_b64_tr_b16 a[184:185],v17 offset:14336
ds_read_b64_tr_b16 a[186:187],v17 offset:14592
ds_read_b64_tr_b16 a[188:189],v17 offset:14344
ds_read_b64_tr_b16 a[190:191],v17 offset:14600
s_waitcnt lgkmcnt(0)
s_waitcnt vmcnt(0)
ds_read_b64_tr_b16 a[192:193],v17 offset:16384
ds_read_b64_tr_b16 a[194:195],v17 offset:16640
ds_read_b64_tr_b16 a[196:197],v17 offset:16392
ds_read_b64_tr_b16 a[198:199],v17 offset:16648
ds_read_b64_tr_b16 a[200:201],v17 offset:18432
ds_read_b64_tr_b16 a[202:203],v17 offset:18688
ds_read_b64_tr_b16 a[204:205],v17 offset:18440
ds_read_b64_tr_b16 a[206:207],v17 offset:18696
ds_read_b64_tr_b16 a[208:209],v17 offset:20480
ds_read_b64_tr_b16 a[210:211],v17 offset:20736
ds_read_b64_tr_b16 a[212:213],v17 offset:20488
ds_read_b64_tr_b16 a[214:215],v17 offset:20744
s_waitcnt lgkmcnt(0)
ds_read_b64_tr_b16 a[216:217],v17 offset:22528
ds_read_b64_tr_b16 a[218:219],v17 offset:22784
ds_read_b64_tr_b16 a[220:221],v17 offset:22536
ds_read_b64_tr_b16 a[222:223],v17 offset:22792
ds_read_b64_tr_b16 a[224:225],v17 offset:24576
ds_read_b64_tr_b16 a[226:227],v17 offset:24832
ds_read_b64_tr_b16 a[228:229],v17 offset:24584
ds_read_b64_tr_b16 a[230:231],v17 offset:24840
ds_read_b64_tr_b16 a[232:233],v17 offset:26624
ds_read_b64_tr_b16 a[234:235],v17 offset:26880
ds_read_b64_tr_b16 a[236:237],v17 offset:26632
ds_read_b64_tr_b16 a[238:239],v17 offset:26888
s_waitcnt lgkmcnt(0)
ds_read_b64_tr_b16 a[240:241],v17 offset:28672
ds_read_b64_tr_b16 a[242:243],v17 offset:28928
ds_read_b64_tr_b16 a[244:245],v17 offset:28680
ds_read_b64_tr_b16 a[246:247],v17 offset:28936
ds_read_b64_tr_b16 a[248:249],v17 offset:30720
ds_read_b64_tr_b16 a[250:251],v17 offset:30976
ds_read_b64_tr_b16 a[252:253],v17 offset:30728
ds_read_b64_tr_b16 a[254:255],v17 offset:30984
s_waitcnt lgkmcnt(0)
s_mov_b32 s92,s2
s_and_b32 s93,s3,0xffff
s_mov_b32 s94,0x100
s_mov_b32 s95,0x20000
v_mbcnt_lo_u32_b32 v16,-1,0
v_mbcnt_hi_u32_b32 v16,-1,v16
v_mov_b32 v18,0
v_cmp_eq_u32 vcc,22,v16
s_nop 1
v_cndmask_b32 v18,v18,63,vcc
v_cmp_eq_u32 vcc,17,v16
s_nop 1
v_cndmask_b32 v18,v18,63,vcc
v_cmp_eq_u32 vcc,18,v16
s_nop 1
v_cndmask_b32 v18,v18,1,vcc
v_and_b32 v19,1,v16
v_cmp_eq_u32 vcc,1,v19
v_mov_b32 v19,8192
s_nop 0
v_cndmask_b32 v19,-1,v19,vcc
v_min_u32 v16,31,v16
v_lshlrev_b32 v16,2,v16
s_sub_u32 s66,s88,64
s_cmp_lg_u32 s50,0
s_cbranch_scc1 vot_163
vpoll_159:
buffer_load_dword v17,v16,s[92:95],s66 offen sc1
s_waitcnt vmcnt(0)
s_cmp_lg_u32 s56,2
s_cbranch_scc1 vck_160
v_cmp_eq_u32 vcc,v17,v19
s_and_b32 s64,vcc_lo,0xffff
s_cmp_eq_u32 s64,65535
s_cbranch_scc1 vck_160
s_mov_b32 s65,0
v_readlane_b32 s64,v17,1
s_lshr_b32 s64,s64,8
s_add_u32 s65,s65,s64
v_readlane_b32 s64,v17,3
s_lshr_b32 s64,s64,8
s_add_u32 s65,s65,s64
v_readlane_b32 s64,v17,5
s_lshr_b32 s64,s64,8
s_add_u32 s65,s65,s64
v_readlane_b32 s64,v17,7
s_lshr_b32 s64,s64,8
s_add_u32 s65,s65,s64
v_readlane_b32 s64,v17,9
s_lshr_b32 s64,s64,8
s_add_u32 s65,s65,s64
v_readlane_b32 s64,v17,11
s_lshr_b32 s64,s64,8
s_add_u32 s65,s65,s64
v_readlane_b32 s64,v17,13
s_lshr_b32 s64,s64,8
s_add_u32 s65,s65,s64
v_readlane_b32 s64,v17,15
s_lshr_b32 s64,s64,8
s_add_u32 s65,s65,s64
s_cmp_ge_u32 s65,256
s_cbranch_scc1 vok_162
s_branch vrt_161
vck_160:
v_cmp_gt_u32 vcc,v18,v17
s_cbranch_vccz vok_162
vrt_161:
s_sleep 48
s_sub_u32 s90,s90,1
s_cmp_gt_i32 s90,0
s_cbranch_scc1 vpoll_159
vok_162:
v_add_u32 v18,160256,v16
ds_write_b32 v18,v17
s_waitcnt lgkmcnt(0)
vot_163:
s_barrier
v_add_u32 v18,160256,v16
ds_read_b32 v17,v18
s_waitcnt lgkmcnt(0)
s_cmp_lg_u32 s56,2
s_cbranch_scc1 vfin_164
v_cmp_eq_u32 vcc,v17,v19
s_and_b32 s64,vcc_lo,0xffff
s_cmp_eq_u32 s64,65535
s_cbranch_scc1 vfin_164
s_mov_b32 s65,0
v_readlane_b32 s64,v17,1
s_lshr_b32 s64,s64,8
s_add_u32 s65,s65,s64
v_readlane_b32 s64,v17,3
s_lshr_b32 s64,s64,8
s_add_u32 s65,s65,s64
v_readlane_b32 s64,v17,5
s_lshr_b32 s64,s64,8
s_add_u32 s65,s65,s64
v_readlane_b32 s64,v17,7
s_lshr_b32 s64,s64,8
s_add_u32 s65,s65,s64
v_readlane_b32 s64,v17,9
s_lshr_b32 s64,s64,8
s_add_u32 s65,s65,s64
v_readlane_b32 s64,v17,11
s_lshr_b32 s64,s64,8
s_add_u32 s65,s65,s64
v_readlane_b32 s64,v17,13
s_lshr_b32 s64,s64,8
s_add_u32 s65,s65,s64
v_readlane_b32 s64,v17,15
s_lshr_b32 s64,s64,8
s_add_u32 s65,s65,s64
s_cmp_ge_u32 s65,256
s_cbranch_scc1 fl_fb
vfin_164:
s_and_b32 s56,s56,1
s_mov_b32 s67,0
s_barrier
v_lshlrev_b32 v0,4,v1
s_mov_b32 s60,0
s_mov_b32 s70,0
s_mov_b32 s55,0
s_lshl_b32 s63,s50,13
v_mov_b32 v3,v0
s_mov_b32 s73,0xffff0000
s_lshl_b32 s64,s52,2
s_add_u32 s64,s64,s50
s_mul_i32 s61,s64,8192
s_add_u32 s61,s61,214958080
s_lshl_b32 s82,s64,8
s_add_u32 s82,s82,138550272
s_mov_b32 s68,s82
s_lshl_b32 s83,s53,2
s_add_u32 s83,s83,s50
s_xor_b32 s64,s50,0
s_lshl_b32 s64,s64,13
v_add_u32 v8,s64,v0
s_xor_b32 s64,s50,1
s_lshl_b32 s64,s64,13
v_add_u32 v9,s64,v0
s_xor_b32 s64,s50,2
s_lshl_b32 s64,s64,13
v_add_u32 v10,s64,v0
s_xor_b32 s64,s50,3
s_lshl_b32 s64,s64,13
v_add_u32 v11,s64,v0
v_min_u32 v2,7,v1
v_lshlrev_b32 v2,2,v2
s_lshl_b32 s66,s83,10
s_mul_i32 s65,s83,147
s_lshr_b32 s65,s65,10
s_mul_i32 s69,s65,228
s_lshl_b32 s64,s83,2
s_add_u32 s69,s69,s64
s_add_u32 s69,s69,138551296
s_lshl_b32 s64,s50,9
s_add_u32 s64,s64,131072
v_lshlrev_b32 v26,3,v1
v_add_u32 v19,s64,v26
v_lshl_add_u32 v26,v23,4,v21
v_lshlrev_b32 v26,3,v26
v_add_u32 v20,131072,v26
s_mov_b32 s74,0x22222222
s_mov_b32 s75,0x22222222
s_mov_b32 s76,0x44444444
s_mov_b32 s77,0x44444444
s_mov_b32 s78,0x88888888
s_mov_b32 s79,0x88888888
s_mov_b32 s80,0xc0135761
s_mov_b32 s81,0xbdd2d3e8
v_mov_b32 v191,s80
v_mov_b32 v12,0x3f803f80
v_mov_b32 v13,0x3f803f80
v_mov_b32 v14,0x3f803f80
v_mov_b32 v15,0x3f803f80
s_nop 1
v_mfma_f32_16x16x32_bf16 v[152:155],a[0:3],v[12:15],0
v_mfma_f32_16x16x32_bf16 v[156:159],a[4:7],v[12:15],0
v_mfma_f32_16x16x32_bf16 v[152:155],a[8:11],v[12:15],v[152:155]
v_mfma_f32_16x16x32_bf16 v[156:159],a[12:15],v[12:15],v[156:159]
v_mfma_f32_16x16x32_bf16 v[152:155],a[16:19],v[12:15],v[152:155]
v_mfma_f32_16x16x32_bf16 v[156:159],a[20:23],v[12:15],v[156:159]
v_mfma_f32_16x16x32_bf16 v[152:155],a[24:27],v[12:15],v[152:155]
v_mfma_f32_16x16x32_bf16 v[156:159],a[28:31],v[12:15],v[156:159]
v_mfma_f32_16x16x32_bf16 v[152:155],a[32:35],v[12:15],v[152:155]
v_mfma_f32_16x16x32_bf16 v[156:159],a[36:39],v[12:15],v[156:159]
v_mfma_f32_16x16x32_bf16 v[152:155],a[40:43],v[12:15],v[152:155]
v_mfma_f32_16x16x32_bf16 v[156:159],a[44:47],v[12:15],v[156:159]
v_mfma_f32_16x16x32_bf16 v[152:155],a[48:51],v[12:15],v[152:155]
v_mfma_f32_16x16x32_bf16 v[156:159],a[52:55],v[12:15],v[156:159]
v_mfma_f32_16x16x32_bf16 v[152:155],a[56:59],v[12:15],v[152:155]
v_mfma_f32_16x16x32_bf16 v[156:159],a[60:63],v[12:15],v[156:159]
v_mfma_f32_16x16x32_bf16 v[152:155],a[64:67],v[12:15],v[152:155]
v_mfma_f32_16x16x32_bf16 v[156:159],a[68:71],v[12:15],v[156:159]
v_mfma_f32_16x16x32_bf16 v[152:155],a[72:75],v[12:15],v[152:155]
v_mfma_f32_16x16x32_bf16 v[156:159],a[76:79],v[12:15],v[156:159]
v_mfma_f32_16x16x32_bf16 v[152:155],a[80:83],v[12:15],v[152:155]
v_mfma_f32_16x16x32_bf16 v[156:159],a[84:87],v[12:15],v[156:159]
v_mfma_f32_16x16x32_bf16 v[152:155],a[88:91],v[12:15],v[152:155]
v_mfma_f32_16x16x32_bf16 v[156:159],a[92:95],v[12:15],v[156:159]
v_mfma_f32_16x16x32_bf16 v[152:155],a[96:99],v[12:15],v[152:155]
v_mfma_f32_16x16x32_bf16 v[156:159],a[100:103],v[12:15],v[156:159]
v_mfma_f32_16x16x32_bf16 v[152:155],a[104:107],v[12:15],v[152:155]
v_mfma_f32_16x16x32_bf16 v[156:159],a[108:111],v[12:15],v[156:159]
v_mfma_f32_16x16x32_bf16 v[152:155],a[112:115],v[12:15],v[152:155]
v_mfma_f32_16x16x32_bf16 v[156:159],a[116:119],v[12:15],v[156:159]
v_mfma_f32_16x16x32_bf16 v[152:155],a[120:123],v[12:15],v[152:155]
v_mfma_f32_16x16x32_bf16 v[156:159],a[124:127],v[12:15],v[156:159]
v_mfma_f32_16x16x32_bf16 v[152:155],a[128:131],v[12:15],v[152:155]
v_mfma_f32_16x16x32_bf16 v[156:159],a[132:135],v[12:15],v[156:159]
v_mfma_f32_16x16x32_bf16 v[152:155],a[136:139],v[12:15],v[152:155]
v_mfma_f32_16x16x32_bf16 v[156:159],a[140:143],v[12:15],v[156:159]
v_mfma_f32_16x16x32_bf16 v[152:155],a[144:147],v[12:15],v[152:155]
v_mfma_f32_16x16x32_bf16 v[156:159],a[148:151],v[12:15],v[156:159]
v_mfma_f32_16x16x32_bf16 v[152:155],a[152:155],v[12:15],v[152:155]
v_mfma_f32_16x16x32_bf16 v[156:159],a[156:159],v[12:15],v[156:159]
v_mfma_f32_16x16x32_bf16 v[152:155],a[160:163],v[12:15],v[152:155]
v_mfma_f32_16x16x32_bf16 v[156:159],a[164:167],v[12:15],v[156:159]
v_mfma_f32_16x16x32_bf16 v[152:155],a[168:171],v[12:15],v[152:155]
v_mfma_f32_16x16x32_bf16 v[156:159],a[172:175],v[12:15],v[156:159]
v_mfma_f32_16x16x32_bf16 v[152:155],a[176:179],v[12:15],v[152:155]
v_mfma_f32_16x16x32_bf16 v[156:159],a[180:183],v[12:15],v[156:159]
v_mfma_f32_16x16x32_bf16 v[152:155],a[184:187],v[12:15],v[152:155]
v_mfma_f32_16x16x32_bf16 v[156:159],a[188:191],v[12:15],v[156:159]
v_mfma_f32_16x16x32_bf16 v[152:155],a[192:195],v[12:15],v[152:155]
v_mfma_f32_16x16x32_bf16 v[156:159],a[196:199],v[12:15],v[156:159]
v_mfma_f32_16x16x32_bf16 v[152:155],a[200:203],v[12:15],v[152:155]
v_mfma_f32_16x16x32_bf16 v[156:159],a[204:207],v[12:15],v[156:159]
v_mfma_f32_16x16x32_bf16 v[152:155],a[208:211],v[12:15],v[152:155]
v_mfma_f32_16x16x32_bf16 v[156:159],a[212:215],v[12:15],v[156:159]
v_mfma_f32_16x16x32_bf16 v[152:155],a[216:219],v[12:15],v[152:155]
v_mfma_f32_16x16x32_bf16 v[156:159],a[220:223],v[12:15],v[156:159]
v_mfma_f32_16x16x32_bf16 v[152:155],a[224:227],v[12:15],v[152:155]
v_mfma_f32_16x16x32_bf16 v[156:159],a[228:231],v[12:15],v[156:159]
v_mfma_f32_16x16x32_bf16 v[152:155],a[232:235],v[12:15],v[152:155]
v_mfma_f32_16x16x32_bf16 v[156:159],a[236:239],v[12:15],v[156:159]
v_mfma_f32_16x16x32_bf16 v[152:155],a[240:243],v[12:15],v[152:155]
v_mfma_f32_16x16x32_bf16 v[156:159],a[244:247],v[12:15],v[156:159]
v_mfma_f32_16x16x32_bf16 v[152:155],a[248:251],v[12:15],v[152:155]
v_mfma_f32_16x16x32_bf16 v[156:159],a[252:255],v[12:15],v[156:159]
s_add_u32 s71,s60,1
plp_170:
buffer_load_dword v16,v2,s[20:23],s68 offen sc1
s_waitcnt vmcnt(0)
v_cmp_gt_u32 vcc,s71,v16
s_cbranch_vccz pok_171
s_sleep 4
s_sub_u32 s90,s90,1
s_cmp_gt_i32 s90,0
s_cbranch_scc1 plp_170
pok_171:
lag_169:
s_add_u32 m0,s70,s63
s_add_u32 s62,s61,4096
buffer_load_dwordx4 v3,s[20:23],s61 offen offset:0 lds
buffer_load_dwordx4 v3,s[20:23],s61 offen offset:1024 lds
buffer_load_dwordx4 v3,s[20:23],s61 offen offset:2048 lds
buffer_load_dwordx4 v3,s[20:23],s61 offen offset:3072 lds
s_add_u32 m0,m0,4096
s_nop 0
buffer_load_dwordx4 v3,s[20:23],s62 offen offset:0 lds
buffer_load_dwordx4 v3,s[20:23],s62 offen offset:1024 lds
buffer_load_dwordx4 v3,s[20:23],s62 offen offset:2048 lds
buffer_load_dwordx4 v3,s[20:23],s62 offen offset:3072 lds
s_add_u32 s61,s61,32768
s_add_u32 s70,s70,32768
s_and_b32 s70,s70,0x1ffff
buffer_load_dword v17,off,s[20:23],s69
top_165:
s_add_u32 s71,s60,2
buffer_load_dword v16,v2,s[20:23],s68 offen sc1
v_add_u32 v4,s55,v8
v_add_u32 v5,s55,v9
v_add_u32 v6,s55,v10
v_add_u32 v7,s55,v11
s_add_u32 s55,s55,32768
s_and_b32 s55,s55,0x1ffff
s_waitcnt vmcnt(9)
ds_read_b128 v[64:67],v4 offset:0
s_waitcnt vmcnt(8)
ds_read_b128 v[68:71],v4 offset:1024
s_waitcnt vmcnt(7)
ds_read_b128 v[72:75],v4 offset:2048
s_waitcnt lgkmcnt(2)
v_mfma_f32_16x16x32_bf16 v[32:35],a[0:3],v[64:67],0
v_mfma_f32_16x16x32_bf16 v[36:39],a[4:7],v[64:67],0
v_mfma_f32_16x16x32_bf16 v[48:51],v[12:15],v[64:67],0
v_mfma_f32_16x16x32_bf16 v[52:55],v[64:67],v[64:67],0
s_waitcnt vmcnt(6)
ds_read_b128 v[76:79],v4 offset:3072
s_waitcnt lgkmcnt(2)
v_mfma_f32_16x16x32_bf16 v[32:35],a[8:11],v[68:71],v[32:35]
v_mfma_f32_16x16x32_bf16 v[36:39],a[12:15],v[68:71],v[36:39]
v_mfma_f32_16x16x32_bf16 v[48:51],v[12:15],v[68:71],v[48:51]
v_mfma_f32_16x16x32_bf16 v[52:55],v[68:71],v[68:71],v[52:55]
s_waitcnt vmcnt(5)
ds_read_b128 v[80:83],v4 offset:4096
s_waitcnt lgkmcnt(2)
v_mfma_f32_16x16x32_bf16 v[32:35],a[16:19],v[72:75],v[32:35]
v_mfma_f32_16x16x32_bf16 v[36:39],a[20:23],v[72:75],v[36:39]
v_mfma_f32_16x16x32_bf16 v[48:51],v[12:15],v[72:75],v[48:51]
v_mfma_f32_16x16x32_bf16 v[52:55],v[72:75],v[72:75],v[52:55]
s_waitcnt vmcnt(4)
ds_read_b128 v[84:87],v4 offset:5120
s_waitcnt lgkmcnt(2)
v_mfma_f32_16x16x32_bf16 v[32:35],a[24:27],v[76:79],v[32:35]
v_mfma_f32_16x16x32_bf16 v[36:39],a[28:31],v[76:79],v[36:39]
v_mfma_f32_16x16x32_bf16 v[48:51],v[12:15],v[76:79],v[48:51]
v_mfma_f32_16x16x32_bf16 v[52:55],v[76:79],v[76:79],v[52:55]
s_waitcnt vmcnt(3)
ds_read_b128 v[88:91],v4 offset:6144
s_waitcnt lgkmcnt(2)
v_mfma_f32_16x16x32_bf16 v[32:35],a[32:35],v[80:83],v[32:35]
v_mfma_f32_16x16x32_bf16 v[36:39],a[36:39],v[80:83],v[36:39]
v_mfma_f32_16x16x32_bf16 v[48:51],v[12:15],v[80:83],v[48:51]
v_mfma_f32_16x16x32_bf16 v[52:55],v[80:83],v[80:83],v[52:55]
s_waitcnt vmcnt(2)
ds_read_b128 v[92:95],v4 offset:7168
s_barrier
s_waitcnt lgkmcnt(2)
v_mfma_f32_16x16x32_bf16 v[32:35],a[40:43],v[84:87],v[32:35]
v_mfma_f32_16x16x32_bf16 v[36:39],a[44:47],v[84:87],v[36:39]
v_mfma_f32_16x16x32_bf16 v[48:51],v[12:15],v[84:87],v[48:51]
v_mfma_f32_16x16x32_bf16 v[52:55],v[84:87],v[84:87],v[52:55]
ds_read_b128 v[96:99],v5 offset:0
s_waitcnt lgkmcnt(2)
v_mfma_f32_16x16x32_bf16 v[32:35],a[48:51],v[88:91],v[32:35]
ds_read_b128 v[100:103],v5 offset:1024
ds_read_b128 v[104:107],v5 offset:2048
v_mfma_f32_16x16x32_bf16 v[36:39],a[52:55],v[88:91],v[36:39]
v_mfma_f32_16x16x32_bf16 v[48:51],v[12:15],v[88:91],v[48:51]
v_mfma_f32_16x16x32_bf16 v[52:55],v[88:91],v[88:91],v[52:55]
s_waitcnt lgkmcnt(3)
v_mfma_f32_16x16x32_bf16 v[32:35],a[56:59],v[92:95],v[32:35]
ds_read_b128 v[108:111],v5 offset:3072
ds_read_b128 v[112:115],v5 offset:4096
v_mfma_f32_16x16x32_bf16 v[36:39],a[60:63],v[92:95],v[36:39]
v_mfma_f32_16x16x32_bf16 v[48:51],v[12:15],v[92:95],v[48:51]
v_mfma_f32_16x16x32_bf16 v[52:55],v[92:95],v[92:95],v[52:55]
s_waitcnt lgkmcnt(4)
v_mfma_f32_16x16x32_bf16 v[32:35],a[64:67],v[96:99],v[32:35]
ds_read_b128 v[116:119],v5 offset:5120
ds_read_b128 v[120:123],v5 offset:6144
v_mfma_f32_16x16x32_bf16 v[36:39],a[68:71],v[96:99],v[36:39]
s_waitcnt lgkmcnt(5)
v_mfma_f32_16x16x32_bf16 v[32:35],a[72:75],v[100:103],v[32:35]
ds_read_b128 v[124:127],v5 offset:7168
v_mfma_f32_16x16x32_bf16 v[36:39],a[76:79],v[100:103],v[36:39]
s_waitcnt lgkmcnt(5)
v_mfma_f32_16x16x32_bf16 v[32:35],a[80:83],v[104:107],v[32:35]
ds_read_b128 v[64:67],v6 offset:0
v_mfma_f32_16x16x32_bf16 v[36:39],a[84:87],v[104:107],v[36:39]
s_waitcnt lgkmcnt(5)
v_mfma_f32_16x16x32_bf16 v[32:35],a[88:91],v[108:111],v[32:35]
ds_read_b128 v[68:71],v6 offset:1024
v_cndmask_b32 v49,v52,v53,s[74:75]
v_mfma_f32_16x16x32_bf16 v[36:39],a[92:95],v[108:111],v[36:39]
v_cndmask_b32 v49,v49,v54,s[76:77]
s_waitcnt lgkmcnt(5)
v_mfma_f32_16x16x32_bf16 v[32:35],a[96:99],v[112:115],v[32:35]
ds_read_b128 v[72:75],v6 offset:2048
v_cndmask_b32 v49,v49,v55,s[78:79]
v_mfma_f32_16x16x32_bf16 v[36:39],a[100:103],v[112:115],v[36:39]
ds_write_b64 v19,v[48:49]
s_waitcnt lgkmcnt(6)
v_mfma_f32_16x16x32_bf16 v[32:35],a[104:107],v[116:119],v[32:35]
ds_read_b128 v[76:79],v6 offset:3072
v_mfma_f32_16x16x32_bf16 v[36:39],a[108:111],v[116:119],v[36:39]
s_waitcnt lgkmcnt(6)
v_mfma_f32_16x16x32_bf16 v[32:35],a[112:115],v[120:123],v[32:35]
ds_read_b128 v[80:83],v6 offset:4096
v_mfma_f32_16x16x32_bf16 v[36:39],a[116:119],v[120:123],v[36:39]
s_waitcnt lgkmcnt(6)
v_mfma_f32_16x16x32_bf16 v[32:35],a[120:123],v[124:127],v[32:35]
ds_read_b128 v[84:87],v6 offset:5120
v_mfma_f32_16x16x32_bf16 v[36:39],a[124:127],v[124:127],v[36:39]
s_waitcnt lgkmcnt(6)
v_mfma_f32_16x16x32_bf16 v[32:35],a[128:131],v[64:67],v[32:35]
ds_read_b128 v[88:91],v6 offset:6144
v_mfma_f32_16x16x32_bf16 v[36:39],a[132:135],v[64:67],v[36:39]
s_waitcnt lgkmcnt(4)
s_barrier
ds_read_b64 v[56:57],v20 offset:0
ds_read_b64 v[58:59],v20 offset:512
v_mfma_f32_16x16x32_bf16 v[32:35],a[136:139],v[68:71],v[32:35]
ds_read_b128 v[92:95],v6 offset:7168
ds_read_b64 v[60:61],v20 offset:1024
ds_read_b64 v[62:63],v20 offset:1536
v_mfma_f32_16x16x32_bf16 v[36:39],a[140:143],v[68:71],v[36:39]
v_mfma_f32_16x16x32_bf16 v[32:35],a[144:147],v[72:75],v[32:35]
ds_read_b128 v[96:99],v7 offset:0
v_mfma_f32_16x16x32_bf16 v[36:39],a[148:151],v[72:75],v[36:39]
s_waitcnt lgkmcnt(9)
v_mfma_f32_16x16x32_bf16 v[32:35],a[152:155],v[76:79],v[32:35]
ds_read_b128 v[100:103],v7 offset:1024
v_mfma_f32_16x16x32_bf16 v[36:39],a[156:159],v[76:79],v[36:39]
s_waitcnt lgkmcnt(9)
v_mfma_f32_16x16x32_bf16 v[32:35],a[160:163],v[80:83],v[32:35]
ds_read_b128 v[104:107],v7 offset:2048
v_mfma_f32_16x16x32_bf16 v[36:39],a[164:167],v[80:83],v[36:39]
s_waitcnt lgkmcnt(9)
v_mfma_f32_16x16x32_bf16 v[32:35],a[168:171],v[84:87],v[32:35]
ds_read_b128 v[108:111],v7 offset:3072
s_waitcnt lgkmcnt(4)
v_mfma_f32_16x16x32_bf16 v[36:39],a[172:175],v[84:87],v[36:39]
v_add_f32 v56,v56,v58
s_waitcnt vmcnt(0)
v_mov_b32 v17,s60
s_mov_b64 exec,1
buffer_store_dword v17,off,s[20:23],s69 sc1
s_mov_b64 exec,-1
v_cmp_gt_u32 vcc,s71,v16
s_cbranch_vccnz vN_166
v_mfma_f32_16x16x32_bf16 v[32:35],a[176:179],v[88:91],v[32:35]
ds_read_b128 v[112:115],v7 offset:4096
v_add_f32 v57,v57,v59
s_add_u32 m0,s70,s63
v_mfma_f32_16x16x32_bf16 v[36:39],a[180:183],v[88:91],v[36:39]
v_add_f32 v60,v60,v62
s_add_u32 s62,s61,4096
v_mfma_f32_16x16x32_bf16 v[32:35],a[184:187],v[92:95],v[32:35]
ds_read_b128 v[116:119],v7 offset:5120
v_add_f32 v61,v61,v63
buffer_load_dwordx4 v3,s[20:23],s61 offen offset:0 lds
v_mfma_f32_16x16x32_bf16 v[36:39],a[188:191],v[92:95],v[36:39]
v_add_f32 v56,v56,v60
buffer_load_dwordx4 v3,s[20:23],s61 offen offset:1024 lds
s_waitcnt lgkmcnt(5)
v_mfma_f32_16x16x32_bf16 v[32:35],a[192:195],v[96:99],v[32:35]
ds_read_b128 v[120:123],v7 offset:6144
v_add_f32 v57,v57,v61
buffer_load_dwordx4 v3,s[20:23],s61 offen offset:2048 lds
v_mfma_f32_16x16x32_bf16 v[36:39],a[196:199],v[96:99],v[36:39]
v_mul_f32 v189,0xba800000,v56
buffer_load_dwordx4 v3,s[20:23],s61 offen offset:3072 lds
s_waitcnt lgkmcnt(5)
v_mfma_f32_16x16x32_bf16 v[32:35],a[200:203],v[100:103],v[32:35]
ds_read_b128 v[124:127],v7 offset:7168
v_mul_f32 v58,v189,v189
s_add_u32 m0,m0,4096
v_mfma_f32_16x16x32_bf16 v[36:39],a[204:207],v[100:103],v[36:39]
v_mul_f32 v57,0x3a800000,v57
buffer_load_dwordx4 v3,s[20:23],s62 offen offset:0 lds
s_waitcnt lgkmcnt(5)
v_mfma_f32_16x16x32_bf16 v[32:35],a[208:211],v[104:107],v[32:35]
v_sub_f32 v57,v57,v58
buffer_load_dwordx4 v3,s[20:23],s62 offen offset:1024 lds
v_mfma_f32_16x16x32_bf16 v[36:39],a[212:215],v[104:107],v[36:39]
v_max_f32 v57,0,v57
buffer_load_dwordx4 v3,s[20:23],s62 offen offset:2048 lds
s_waitcnt lgkmcnt(4)
v_mfma_f32_16x16x32_bf16 v[32:35],a[216:219],v[108:111],v[32:35]
v_add_f32 v57,0x3727c5ac,v57
buffer_load_dwordx4 v3,s[20:23],s62 offen offset:3072 lds
v_mfma_f32_16x16x32_bf16 v[36:39],a[220:223],v[108:111],v[36:39]
v_rsq_f32 v190,v57
s_add_u32 s61,s61,32768
s_waitcnt lgkmcnt(3)
v_mfma_f32_16x16x32_bf16 v[32:35],a[224:227],v[112:115],v[32:35]
s_add_u32 s70,s70,32768
v_mfma_f32_16x16x32_bf16 v[36:39],a[228:231],v[112:115],v[36:39]
s_and_b32 s70,s70,0x1ffff
s_waitcnt lgkmcnt(2)
v_mfma_f32_16x16x32_bf16 v[32:35],a[232:235],v[116:119],v[32:35]
v_mfma_f32_16x16x32_bf16 v[36:39],a[236:239],v[116:119],v[36:39]
s_waitcnt lgkmcnt(1)
v_mfma_f32_16x16x32_bf16 v[32:35],a[240:243],v[120:123],v[32:35]
v_mfma_f32_16x16x32_bf16 v[36:39],a[244:247],v[120:123],v[36:39]
s_waitcnt lgkmcnt(0)
v_mfma_f32_16x16x32_bf16 v[32:35],a[248:251],v[124:127],v[32:35]
v_mfma_f32_16x16x32_bf16 v[36:39],a[252:255],v[124:127],v[36:39]
s_mov_b32 s72,1
join_167:
s_nop 5
v_fma_f32 v32,v152,v189,v32
v_fma_f32 v33,v153,v189,v33
v_fma_f32 v34,v154,v189,v34
v_fma_f32 v35,v155,v189,v35
v_fma_f32 v36,v156,v189,v36
v_fma_f32 v37,v157,v189,v37
v_fma_f32 v38,v158,v189,v38
v_fma_f32 v39,v159,v189,v39
v_mul_f32 v32,v32,v190
v_mul_f32 v33,v33,v190
v_mul_f32 v34,v34,v190
v_mul_f32 v35,v35,v190
v_mul_f32 v36,v36,v190
v_mul_f32 v37,v37,v190
v_mul_f32 v38,v38,v190
v_mul_f32 v39,v39,v190
v_mul_f32 v168,v32,v32
v_mul_f32 v169,v33,v33
v_mul_f32 v170,v34,v34
v_mul_f32 v171,v35,v35
v_mul_f32 v172,v36,v36
v_mul_f32 v173,v37,v37
v_mul_f32 v174,v38,v38
v_mul_f32 v175,v39,v39
v_fma_f32 v168,v168,s81,v191
v_fma_f32 v169,v169,s81,v191
v_fma_f32 v170,v170,s81,v191
v_fma_f32 v171,v171,s81,v191
v_fma_f32 v172,v172,s81,v191
v_fma_f32 v173,v173,s81,v191
v_fma_f32 v174,v174,s81,v191
v_fma_f32 v175,v175,s81,v191
v_mul_f32 v168,v168,v32
v_mul_f32 v169,v169,v33
v_mul_f32 v170,v170,v34
v_mul_f32 v171,v171,v35
v_mul_f32 v172,v172,v36
v_mul_f32 v173,v173,v37
v_mul_f32 v174,v174,v38
v_mul_f32 v175,v175,v39
v_exp_f32 v168,v168
v_exp_f32 v169,v169
v_exp_f32 v170,v170
v_exp_f32 v171,v171
v_exp_f32 v172,v172
v_exp_f32 v173,v173
v_exp_f32 v174,v174
v_exp_f32 v175,v175
v_add_f32 v168,1.0,v168
v_add_f32 v169,1.0,v169
v_add_f32 v170,1.0,v170
v_add_f32 v171,1.0,v171
v_add_f32 v172,1.0,v172
v_add_f32 v173,1.0,v173
v_add_f32 v174,1.0,v174
v_add_f32 v175,1.0,v175
v_rcp_f32 v168,v168
v_rcp_f32 v169,v169
v_rcp_f32 v170,v170
v_rcp_f32 v171,v171
v_rcp_f32 v172,v172
v_rcp_f32 v173,v173
v_rcp_f32 v174,v174
v_rcp_f32 v175,v175
v_mul_f32 v32,v168,v32
v_mul_f32 v33,v169,v33
v_mul_f32 v34,v170,v34
v_mul_f32 v35,v171,v35
v_mul_f32 v36,v172,v36
v_mul_f32 v37,v173,v37
v_mul_f32 v38,v174,v38
v_mul_f32 v39,v175,v39
v_cvt_pk_bf16_f32 v176,v32,v33
v_cvt_pk_bf16_f32 v177,v34,v35
v_cvt_pk_bf16_f32 v178,v36,v37
v_cvt_pk_bf16_f32 v179,v38,v39
s_add_u32 s64,s66,219152384
buffer_store_dwordx4 v[176:179],v0,s[20:23],s64 offen sc1
s_add_u32 s66,s66,114688
s_add_u32 s60,s60,1
s_cmp_eq_u32 s72,0
s_cbranch_scc1 slowp_168
s_branch top_165
slowp_168:
s_waitcnt vmcnt(1)
v_cmp_gt_u32 vcc,s71,v16
s_cbranch_vccz lag_169
s_waitcnt vmcnt(0)
v_mov_b32 v17,s60
s_mov_b64 exec,1
buffer_store_dword v17,off,s[20:23],s69 sc1
s_mov_b64 exec,-1
s_cmp_ge_u32 s60,128
s_cbranch_scc1 done_158
plp_172:
buffer_load_dword v16,v2,s[20:23],s68 offen sc1
s_waitcnt vmcnt(0)
v_cmp_gt_u32 vcc,s71,v16
s_cbranch_vccz pok_173
s_sleep 4
s_sub_u32 s90,s90,1
s_cmp_gt_i32 s90,0
s_cbranch_scc1 plp_172
pok_173:
s_branch lag_169
vN_166:
buffer_load_dword v16,v2,s[20:23],s68 offen sc1
v_mfma_f32_16x16x32_bf16 v[32:35],a[176:179],v[88:91],v[32:35]
ds_read_b128 v[112:115],v7 offset:4096
v_add_f32 v57,v57,v59
v_mfma_f32_16x16x32_bf16 v[36:39],a[180:183],v[88:91],v[36:39]
v_add_f32 v60,v60,v62
v_mfma_f32_16x16x32_bf16 v[32:35],a[184:187],v[92:95],v[32:35]
ds_read_b128 v[116:119],v7 offset:5120
v_add_f32 v61,v61,v63
v_mfma_f32_16x16x32_bf16 v[36:39],a[188:191],v[92:95],v[36:39]
v_add_f32 v56,v56,v60
s_waitcnt lgkmcnt(5)
v_mfma_f32_16x16x32_bf16 v[32:35],a[192:195],v[96:99],v[32:35]
ds_read_b128 v[120:123],v7 offset:6144
v_add_f32 v57,v57,v61
v_mfma_f32_16x16x32_bf16 v[36:39],a[196:199],v[96:99],v[36:39]
v_mul_f32 v189,0xba800000,v56
s_waitcnt lgkmcnt(5)
v_mfma_f32_16x16x32_bf16 v[32:35],a[200:203],v[100:103],v[32:35]
ds_read_b128 v[124:127],v7 offset:7168
v_mul_f32 v58,v189,v189
v_mfma_f32_16x16x32_bf16 v[36:39],a[204:207],v[100:103],v[36:39]
v_mul_f32 v57,0x3a800000,v57
s_waitcnt lgkmcnt(5)
v_mfma_f32_16x16x32_bf16 v[32:35],a[208:211],v[104:107],v[32:35]
v_sub_f32 v57,v57,v58
v_mfma_f32_16x16x32_bf16 v[36:39],a[212:215],v[104:107],v[36:39]
v_max_f32 v57,0,v57
s_waitcnt lgkmcnt(4)
v_mfma_f32_16x16x32_bf16 v[32:35],a[216:219],v[108:111],v[32:35]
v_add_f32 v57,0x3727c5ac,v57
v_mfma_f32_16x16x32_bf16 v[36:39],a[220:223],v[108:111],v[36:39]
v_rsq_f32 v190,v57
s_waitcnt lgkmcnt(3)
v_mfma_f32_16x16x32_bf16 v[32:35],a[224:227],v[112:115],v[32:35]
v_mfma_f32_16x16x32_bf16 v[36:39],a[228:231],v[112:115],v[36:39]
s_waitcnt lgkmcnt(2)
v_mfma_f32_16x16x32_bf16 v[32:35],a[232:235],v[116:119],v[32:35]
v_mfma_f32_16x16x32_bf16 v[36:39],a[236:239],v[116:119],v[36:39]
s_waitcnt lgkmcnt(1)
v_mfma_f32_16x16x32_bf16 v[32:35],a[240:243],v[120:123],v[32:35]
v_mfma_f32_16x16x32_bf16 v[36:39],a[244:247],v[120:123],v[36:39]
s_waitcnt lgkmcnt(0)
v_mfma_f32_16x16x32_bf16 v[32:35],a[248:251],v[124:127],v[32:35]
v_mfma_f32_16x16x32_bf16 v[36:39],a[252:255],v[124:127],v[36:39]
s_mov_b32 s72,0
s_branch join_167
done_158:
s_endpgm
fl_w1:
v_and_b32 v21,15,v1
v_lshrrev_b32 v22,4,v1
v_lshrrev_b32 v23,2,v21
v_and_b32 v24,3,v21
s_lshl_b32 s61,s50,15
v_lshl_add_u32 v25,v22,3,v23
s_load_dwordx2 s[4:5],s[0:1],64
s_mov_b32 s52,0
s_mov_b32 s53,s59
s_mul_i32 s54,s52,2097152
s_lshl_b32 s64,s53,8
s_add_u32 s54,s54,s64
s_lshl_b32 s64,s50,6
s_add_u32 s54,s54,s64
s_waitcnt lgkmcnt(0)
s_mov_b32 s28,s4
s_and_b32 s29,s5,0xffff
s_mov_b32 s30,0x200000
s_mov_b32 s31,0x20000
v_lshrrev_b32 v26,2,v1
v_and_b32 v27,3,v1
v_mul_u32_u24 v16,2048,v26
v_lshl_add_u32 v16,v27,4,v16
v_lshlrev_b32 v17,6,v25
v_lshl_add_u32 v17,v24,4,v17
v_add_u32 v17,s61,v17
s_xor_b32 s62,s50,0
s_mul_i32 s62,s62,524288
s_add_u32 s62,s62,s54
s_add_u32 m0,s61,0
s_nop 0
buffer_load_dwordx4 v16,s[28:31],s62 offen lds
s_add_u32 s62,s62,32768
s_add_u32 m0,m0,1024
s_waitcnt vmcnt(6)
buffer_load_dwordx4 v16,s[28:31],s62 offen lds
s_add_u32 s62,s62,32768
s_add_u32 m0,m0,1024
s_waitcnt vmcnt(6)
buffer_load_dwordx4 v16,s[28:31],s62 offen lds
s_add_u32 s62,s62,32768
s_add_u32 m0,m0,1024
s_waitcnt vmcnt(6)
buffer_load_dwordx4 v16,s[28:31],s62 offen lds
s_add_u32 s62,s62,32768
s_add_u32 m0,m0,1024
s_waitcnt vmcnt(6)
buffer_load_dwordx4 v16,s[28:31],s62 offen lds
s_add_u32 s62,s62,32768
s_add_u32 m0,m0,1024
s_waitcnt vmcnt(6)
buffer_load_dwordx4 v16,s[28:31],s62 offen lds
s_add_u32 s62,s62,32768
s_add_u32 m0,m0,1024
s_waitcnt vmcnt(6)
buffer_load_dwordx4 v16,s[28:31],s62 offen lds
s_add_u32 s62,s62,32768
s_add_u32 m0,m0,1024
s_waitcnt vmcnt(6)
buffer_load_dwordx4 v16,s[28:31],s62 offen lds
s_add_u32 s62,s62,32768
s_add_u32 m0,m0,1024
s_waitcnt vmcnt(6)
buffer_load_dwordx4 v16,s[28:31],s62 offen lds
s_add_u32 s62,s62,32768
s_add_u32 m0,m0,1024
s_waitcnt vmcnt(6)
buffer_load_dwordx4 v16,s[28:31],s62 offen lds
s_add_u32 s62,s62,32768
s_add_u32 m0,m0,1024
s_waitcnt vmcnt(6)
buffer_load_dwordx4 v16,s[28:31],s62 offen lds
s_add_u32 s62,s62,32768
s_add_u32 m0,m0,1024
s_waitcnt vmcnt(6)
buffer_load_dwordx4 v16,s[28:31],s62 offen lds
s_add_u32 s62,s62,32768
s_add_u32 m0,m0,1024
s_waitcnt vmcnt(6)
buffer_load_dwordx4 v16,s[28:31],s62 offen lds
s_add_u32 s62,s62,32768
s_add_u32 m0,m0,1024
s_waitcnt vmcnt(6)
buffer_load_dwordx4 v16,s[28:31],s62 offen lds
s_add_u32 s62,s62,32768
s_add_u32 m0,m0,1024
s_waitcnt vmcnt(6)
buffer_load_dwordx4 v16,s[28:31],s62 offen lds
s_add_u32 s62,s62,32768
s_add_u32 m0,m0,1024
s_waitcnt vmcnt(6)
buffer_load_dwordx4 v16,s[28:31],s62 offen lds
s_waitcnt vmcnt(6)
s_xor_b32 s62,s50,1
s_mul_i32 s62,s62,524288
s_add_u32 s62,s62,s54
s_add_u32 m0,s61,16384
s_nop 0
buffer_load_dwordx4 v16,s[28:31],s62 offen lds
s_add_u32 s62,s62,32768
s_add_u32 m0,m0,1024
s_waitcnt vmcnt(6)
buffer_load_dwordx4 v16,s[28:31],s62 offen lds
s_add_u32 s62,s62,32768
s_add_u32 m0,m0,1024
s_waitcnt vmcnt(6)
buffer_load_dwordx4 v16,s[28:31],s62 offen lds
s_add_u32 s62,s62,32768
s_add_u32 m0,m0,1024
s_waitcnt vmcnt(6)
buffer_load_dwordx4 v16,s[28:31],s62 offen lds
s_add_u32 s62,s62,32768
s_add_u32 m0,m0,1024
s_waitcnt vmcnt(6)
buffer_load_dwordx4 v16,s[28:31],s62 offen lds
s_add_u32 s62,s62,32768
s_add_u32 m0,m0,1024
s_waitcnt vmcnt(6)
buffer_load_dwordx4 v16,s[28:31],s62 offen lds
s_add_u32 s62,s62,32768
s_add_u32 m0,m0,1024
s_waitcnt vmcnt(6)
buffer_load_dwordx4 v16,s[28:31],s62 offen lds
s_add_u32 s62,s62,32768
s_add_u32 m0,m0,1024
s_waitcnt vmcnt(6)
buffer_load_dwordx4 v16,s[28:31],s62 offen lds
s_add_u32 s62,s62,32768
s_add_u32 m0,m0,1024
s_waitcnt vmcnt(6)
buffer_load_dwordx4 v16,s[28:31],s62 offen lds
s_add_u32 s62,s62,32768
s_add_u32 m0,m0,1024
s_waitcnt vmcnt(6)
buffer_load_dwordx4 v16,s[28:31],s62 offen lds
s_add_u32 s62,s62,32768
s_add_u32 m0,m0,1024
s_waitcnt vmcnt(6)
buffer_load_dwordx4 v16,s[28:31],s62 offen lds
s_add_u32 s62,s62,32768
s_add_u32 m0,m0,1024
s_waitcnt vmcnt(6)
buffer_load_dwordx4 v16,s[28:31],s62 offen lds
s_add_u32 s62,s62,32768
s_add_u32 m0,m0,1024
s_waitcnt vmcnt(6)
buffer_load_dwordx4 v16,s[28:31],s62 offen lds
s_add_u32 s62,s62,32768
s_add_u32 m0,m0,1024
s_waitcnt vmcnt(6)
buffer_load_dwordx4 v16,s[28:31],s62 offen lds
s_add_u32 s62,s62,32768
s_add_u32 m0,m0,1024
s_waitcnt vmcnt(6)
buffer_load_dwordx4 v16,s[28:31],s62 offen lds
s_add_u32 s62,s62,32768
s_add_u32 m0,m0,1024
s_waitcnt vmcnt(6)
buffer_load_dwordx4 v16,s[28:31],s62 offen lds
s_waitcnt vmcnt(6)
s_waitcnt vmcnt(16)
ds_read_b64_tr_b16 a[0:1],v17 offset:0
ds_read_b64_tr_b16 a[2:3],v17 offset:256
ds_read_b64_tr_b16 a[4:5],v17 offset:8
ds_read_b64_tr_b16 a[6:7],v17 offset:264
ds_read_b64_tr_b16 a[8:9],v17 offset:2048
ds_read_b64_tr_b16 a[10:11],v17 offset:2304
ds_read_b64_tr_b16 a[12:13],v17 offset:2056
ds_read_b64_tr_b16 a[14:15],v17 offset:2312
ds_read_b64_tr_b16 a[16:17],v17 offset:4096
ds_read_b64_tr_b16 a[18:19],v17 offset:4352
ds_read_b64_tr_b16 a[20:21],v17 offset:4104
ds_read_b64_tr_b16 a[22:23],v17 offset:4360
s_waitcnt lgkmcnt(0)
ds_read_b64_tr_b16 a[24:25],v17 offset:6144
ds_read_b64_tr_b16 a[26:27],v17 offset:6400
ds_read_b64_tr_b16 a[28:29],v17 offset:6152
ds_read_b64_tr_b16 a[30:31],v17 offset:6408
ds_read_b64_tr_b16 a[32:33],v17 offset:8192
ds_read_b64_tr_b16 a[34:35],v17 offset:8448
ds_read_b64_tr_b16 a[36:37],v17 offset:8200
ds_read_b64_tr_b16 a[38:39],v17 offset:8456
ds_read_b64_tr_b16 a[40:41],v17 offset:10240
ds_read_b64_tr_b16 a[42:43],v17 offset:10496
ds_read_b64_tr_b16 a[44:45],v17 offset:10248
ds_read_b64_tr_b16 a[46:47],v17 offset:10504
s_waitcnt lgkmcnt(0)
ds_read_b64_tr_b16 a[48:49],v17 offset:12288
ds_read_b64_tr_b16 a[50:51],v17 offset:12544
ds_read_b64_tr_b16 a[52:53],v17 offset:12296
ds_read_b64_tr_b16 a[54:55],v17 offset:12552
ds_read_b64_tr_b16 a[56:57],v17 offset:14336
ds_read_b64_tr_b16 a[58:59],v17 offset:14592
ds_read_b64_tr_b16 a[60:61],v17 offset:14344
ds_read_b64_tr_b16 a[62:63],v17 offset:14600
s_waitcnt lgkmcnt(0)
s_xor_b32 s62,s50,2
s_mul_i32 s62,s62,524288
s_add_u32 s62,s62,s54
s_add_u32 m0,s61,0
s_nop 0
buffer_load_dwordx4 v16,s[28:31],s62 offen lds
s_add_u32 s62,s62,32768
s_add_u32 m0,m0,1024
s_waitcnt vmcnt(6)
buffer_load_dwordx4 v16,s[28:31],s62 offen lds
s_add_u32 s62,s62,32768
s_add_u32 m0,m0,1024
s_waitcnt vmcnt(6)
buffer_load_dwordx4 v16,s[28:31],s62 offen lds
s_add_u32 s62,s62,32768
s_add_u32 m0,m0,1024
s_waitcnt vmcnt(6)
buffer_load_dwordx4 v16,s[28:31],s62 offen lds
s_add_u32 s62,s62,32768
s_add_u32 m0,m0,1024
s_waitcnt vmcnt(6)
buffer_load_dwordx4 v16,s[28:31],s62 offen lds
s_add_u32 s62,s62,32768
s_add_u32 m0,m0,1024
s_waitcnt vmcnt(6)
buffer_load_dwordx4 v16,s[28:31],s62 offen lds
s_add_u32 s62,s62,32768
s_add_u32 m0,m0,1024
s_waitcnt vmcnt(6)
buffer_load_dwordx4 v16,s[28:31],s62 offen lds
s_add_u32 s62,s62,32768
s_add_u32 m0,m0,1024
s_waitcnt vmcnt(6)
buffer_load_dwordx4 v16,s[28:31],s62 offen lds
s_add_u32 s62,s62,32768
s_add_u32 m0,m0,1024
s_waitcnt vmcnt(6)
buffer_load_dwordx4 v16,s[28:31],s62 offen lds
s_add_u32 s62,s62,32768
s_add_u32 m0,m0,1024
s_waitcnt vmcnt(6)
buffer_load_dwordx4 v16,s[28:31],s62 offen lds
s_add_u32 s62,s62,32768
s_add_u32 m0,m0,1024
s_waitcnt vmcnt(6)
buffer_load_dwordx4 v16,s[28:31],s62 offen lds
s_add_u32 s62,s62,32768
s_add_u32 m0,m0,1024
s_waitcnt vmcnt(6)
buffer_load_dwordx4 v16,s[28:31],s62 offen lds
s_add_u32 s62,s62,32768
s_add_u32 m0,m0,1024
s_waitcnt vmcnt(6)
buffer_load_dwordx4 v16,s[28:31],s62 offen lds
s_add_u32 s62,s62,32768
s_add_u32 m0,m0,1024
s_waitcnt vmcnt(6)
buffer_load_dwordx4 v16,s[28:31],s62 offen lds
s_add_u32 s62,s62,32768
s_add_u32 m0,m0,1024
s_waitcnt vmcnt(6)
buffer_load_dwordx4 v16,s[28:31],s62 offen lds
s_add_u32 s62,s62,32768
s_add_u32 m0,m0,1024
s_waitcnt vmcnt(6)
buffer_load_dwordx4 v16,s[28:31],s62 offen lds
s_waitcnt vmcnt(6)
s_waitcnt vmcnt(16)
ds_read_b64_tr_b16 a[64:65],v17 offset:16384
ds_read_b64_tr_b16 a[66:67],v17 offset:16640
ds_read_b64_tr_b16 a[68:69],v17 offset:16392
ds_read_b64_tr_b16 a[70:71],v17 offset:16648
ds_read_b64_tr_b16 a[72:73],v17 offset:18432
ds_read_b64_tr_b16 a[74:75],v17 offset:18688
ds_read_b64_tr_b16 a[76:77],v17 offset:18440
ds_read_b64_tr_b16 a[78:79],v17 offset:18696
ds_read_b64_tr_b16 a[80:81],v17 offset:20480
ds_read_b64_tr_b16 a[82:83],v17 offset:20736
ds_read_b64_tr_b16 a[84:85],v17 offset:20488
ds_read_b64_tr_b16 a[86:87],v17 offset:20744
s_waitcnt lgkmcnt(0)
ds_read_b64_tr_b16 a[88:89],v17 offset:22528
ds_read_b64_tr_b16 a[90:91],v17 offset:22784
ds_read_b64_tr_b16 a[92:93],v17 offset:22536
ds_read_b64_tr_b16 a[94:95],v17 offset:22792
ds_read_b64_tr_b16 a[96:97],v17 offset:24576
ds_read_b64_tr_b16 a[98:99],v17 offset:24832
ds_read_b64_tr_b16 a[100:101],v17 offset:24584
ds_read_b64_tr_b16 a[102:103],v17 offset:24840
ds_read_b64_tr_b16 a[104:105],v17 offset:26624
ds_read_b64_tr_b16 a[106:107],v17 offset:26880
ds_read_b64_tr_b16 a[108:109],v17 offset:26632
ds_read_b64_tr_b16 a[110:111],v17 offset:26888
s_waitcnt lgkmcnt(0)
ds_read_b64_tr_b16 a[112:113],v17 offset:28672
ds_read_b64_tr_b16 a[114:115],v17 offset:28928
ds_read_b64_tr_b16 a[116:117],v17 offset:28680
ds_read_b64_tr_b16 a[118:119],v17 offset:28936
ds_read_b64_tr_b16 a[120:121],v17 offset:30720
ds_read_b64_tr_b16 a[122:123],v17 offset:30976
ds_read_b64_tr_b16 a[124:125],v17 offset:30728
ds_read_b64_tr_b16 a[126:127],v17 offset:30984
s_waitcnt lgkmcnt(0)
s_xor_b32 s62,s50,3
s_mul_i32 s62,s62,524288
s_add_u32 s62,s62,s54
s_add_u32 m0,s61,16384
s_nop 0
buffer_load_dwordx4 v16,s[28:31],s62 offen lds
s_add_u32 s62,s62,32768
s_add_u32 m0,m0,1024
s_waitcnt vmcnt(6)
buffer_load_dwordx4 v16,s[28:31],s62 offen lds
s_add_u32 s62,s62,32768
s_add_u32 m0,m0,1024
s_waitcnt vmcnt(6)
buffer_load_dwordx4 v16,s[28:31],s62 offen lds
s_add_u32 s62,s62,32768
s_add_u32 m0,m0,1024
s_waitcnt vmcnt(6)
buffer_load_dwordx4 v16,s[28:31],s62 offen lds
s_add_u32 s62,s62,32768
s_add_u32 m0,m0,1024
s_waitcnt vmcnt(6)
buffer_load_dwordx4 v16,s[28:31],s62 offen lds
s_add_u32 s62,s62,32768
s_add_u32 m0,m0,1024
s_waitcnt vmcnt(6)
buffer_load_dwordx4 v16,s[28:31],s62 offen lds
s_add_u32 s62,s62,32768
s_add_u32 m0,m0,1024
s_waitcnt vmcnt(6)
buffer_load_dwordx4 v16,s[28:31],s62 offen lds
s_add_u32 s62,s62,32768
s_add_u32 m0,m0,1024
s_waitcnt vmcnt(6)
buffer_load_dwordx4 v16,s[28:31],s62 offen lds
s_add_u32 s62,s62,32768
s_add_u32 m0,m0,1024
s_waitcnt vmcnt(6)
buffer_load_dwordx4 v16,s[28:31],s62 offen lds
s_add_u32 s62,s62,32768
s_add_u32 m0,m0,1024
s_waitcnt vmcnt(6)
buffer_load_dwordx4 v16,s[28:31],s62 offen lds
s_add_u32 s62,s62,32768
s_add_u32 m0,m0,1024
s_waitcnt vmcnt(6)
buffer_load_dwordx4 v16,s[28:31],s62 offen lds
s_add_u32 s62,s62,32768
s_add_u32 m0,m0,1024
s_waitcnt vmcnt(6)
buffer_load_dwordx4 v16,s[28:31],s62 offen lds
s_add_u32 s62,s62,32768
s_add_u32 m0,m0,1024
s_waitcnt vmcnt(6)
buffer_load_dwordx4 v16,s[28:31],s62 offen lds
s_add_u32 s62,s62,32768
s_add_u32 m0,m0,1024
s_waitcnt vmcnt(6)
buffer_load_dwordx4 v16,s[28:31],s62 offen lds
s_add_u32 s62,s62,32768
s_add_u32 m0,m0,1024
s_waitcnt vmcnt(6)
buffer_load_dwordx4 v16,s[28:31],s62 offen lds
s_add_u32 s62,s62,32768
s_add_u32 m0,m0,1024
s_waitcnt vmcnt(6)
buffer_load_dwordx4 v16,s[28:31],s62 offen lds
s_waitcnt vmcnt(6)
s_waitcnt vmcnt(16)
ds_read_b64_tr_b16 a[128:129],v17 offset:0
ds_read_b64_tr_b16 a[130:131],v17 offset:256
ds_read_b64_tr_b16 a[132:133],v17 offset:8
ds_read_b64_tr_b16 a[134:135],v17 offset:264
ds_read_b64_tr_b16 a[136:137],v17 offset:2048
ds_read_b64_tr_b16 a[138:139],v17 offset:2304
ds_read_b64_tr_b16 a[140:141],v17 offset:2056
ds_read_b64_tr_b16 a[142:143],v17 offset:2312
ds_read_b64_tr_b16 a[144:145],v17 offset:4096
ds_read_b64_tr_b16 a[146:147],v17 offset:4352
ds_read_b64_tr_b16 a[148:149],v17 offset:4104
ds_read_b64_tr_b16 a[150:151],v17 offset:4360
s_waitcnt lgkmcnt(0)
ds_read_b64_tr_b16 a[152:153],v17 offset:6144
ds_read_b64_tr_b16 a[154:155],v17 offset:6400
ds_read_b64_tr_b16 a[156:157],v17 offset:6152
ds_read_b64_tr_b16 a[158:159],v17 offset:6408
ds_read_b64_tr_b16 a[160:161],v17 offset:8192
ds_read_b64_tr_b16 a[162:163],v17 offset:8448
ds_read_b64_tr_b16 a[164:165],v17 offset:8200
ds_read_b64_tr_b16 a[166:167],v17 offset:8456
ds_read_b64_tr_b16 a[168:169],v17 offset:10240
ds_read_b64_tr_b16 a[170:171],v17 offset:10496
ds_read_b64_tr_b16 a[172:173],v17 offset:10248
ds_read_b64_tr_b16 a[174:175],v17 offset:10504
s_waitcnt lgkmcnt(0)
ds_read_b64_tr_b16 a[176:177],v17 offset:12288
ds_read_b64_tr_b16 a[178:179],v17 offset:12544
ds_read_b64_tr_b16 a[180:181],v17 offset:12296
ds_read_b64_tr_b16 a[182:183],v17 offset:12552
ds_read_b64_tr_b16 a[184:185],v17 offset:14336
ds_read_b64_tr_b16 a[186:187],v17 offset:14592
ds_read_b64_tr_b16 a[188:189],v17 offset:14344
ds_read_b64_tr_b16 a[190:191],v17 offset:14600
s_waitcnt lgkmcnt(0)
s_waitcnt vmcnt(0)
ds_read_b64_tr_b16 a[192:193],v17 offset:16384
ds_read_b64_tr_b16 a[194:195],v17 offset:16640
ds_read_b64_tr_b16 a[196:197],v17 offset:16392
ds_read_b64_tr_b16 a[198:199],v17 offset:16648
ds_read_b64_tr_b16 a[200:201],v17 offset:18432
ds_read_b64_tr_b16 a[202:203],v17 offset:18688
ds_read_b64_tr_b16 a[204:205],v17 offset:18440
ds_read_b64_tr_b16 a[206:207],v17 offset:18696
ds_read_b64_tr_b16 a[208:209],v17 offset:20480
ds_read_b64_tr_b16 a[210:211],v17 offset:20736
ds_read_b64_tr_b16 a[212:213],v17 offset:20488
ds_read_b64_tr_b16 a[214:215],v17 offset:20744
s_waitcnt lgkmcnt(0)
ds_read_b64_tr_b16 a[216:217],v17 offset:22528
ds_read_b64_tr_b16 a[218:219],v17 offset:22784
ds_read_b64_tr_b16 a[220:221],v17 offset:22536
ds_read_b64_tr_b16 a[222:223],v17 offset:22792
ds_read_b64_tr_b16 a[224:225],v17 offset:24576
ds_read_b64_tr_b16 a[226:227],v17 offset:24832
ds_read_b64_tr_b16 a[228:229],v17 offset:24584
ds_read_b64_tr_b16 a[230:231],v17 offset:24840
ds_read_b64_tr_b16 a[232:233],v17 offset:26624
ds_read_b64_tr_b16 a[234:235],v17 offset:26880
ds_read_b64_tr_b16 a[236:237],v17 offset:26632
ds_read_b64_tr_b16 a[238:239],v17 offset:26888
s_waitcnt lgkmcnt(0)
ds_read_b64_tr_b16 a[240:241],v17 offset:28672
ds_read_b64_tr_b16 a[242:243],v17 offset:28928
ds_read_b64_tr_b16 a[244:245],v17 offset:28680
ds_read_b64_tr_b16 a[246:247],v17 offset:28936
ds_read_b64_tr_b16 a[248:249],v17 offset:30720
ds_read_b64_tr_b16 a[250:251],v17 offset:30976
ds_read_b64_tr_b16 a[252:253],v17 offset:30728
ds_read_b64_tr_b16 a[254:255],v17 offset:30984
s_waitcnt lgkmcnt(0)
s_mov_b32 s92,s2
s_and_b32 s93,s3,0xffff
s_mov_b32 s94,0x100
s_mov_b32 s95,0x20000
v_mbcnt_lo_u32_b32 v16,-1,0
v_mbcnt_hi_u32_b32 v16,-1,v16
v_mov_b32 v18,0
v_cmp_eq_u32 vcc,22,v16
s_nop 1
v_cndmask_b32 v18,v18,63,vcc
v_cmp_eq_u32 vcc,17,v16
s_nop 1
v_cndmask_b32 v18,v18,63,vcc
v_cmp_eq_u32 vcc,18,v16
s_nop 1
v_cndmask_b32 v18,v18,1,vcc
v_and_b32 v19,1,v16
v_cmp_eq_u32 vcc,1,v19
v_mov_b32 v19,8192
s_nop 0
v_cndmask_b32 v19,-1,v19,vcc
v_min_u32 v16,31,v16
v_lshlrev_b32 v16,2,v16
s_sub_u32 s66,s88,64
s_cmp_lg_u32 s50,0
s_cbranch_scc1 vot_179
vpoll_175:
buffer_load_dword v17,v16,s[92:95],s66 offen sc1
s_waitcnt vmcnt(0)
s_cmp_lg_u32 s56,2
s_cbranch_scc1 vck_176
v_cmp_eq_u32 vcc,v17,v19
s_and_b32 s64,vcc_lo,0xffff
s_cmp_eq_u32 s64,65535
s_cbranch_scc1 vck_176
s_mov_b32 s65,0
v_readlane_b32 s64,v17,1
s_lshr_b32 s64,s64,8
s_add_u32 s65,s65,s64
v_readlane_b32 s64,v17,3
s_lshr_b32 s64,s64,8
s_add_u32 s65,s65,s64
v_readlane_b32 s64,v17,5
s_lshr_b32 s64,s64,8
s_add_u32 s65,s65,s64
v_readlane_b32 s64,v17,7
s_lshr_b32 s64,s64,8
s_add_u32 s65,s65,s64
v_readlane_b32 s64,v17,9
s_lshr_b32 s64,s64,8
s_add_u32 s65,s65,s64
v_readlane_b32 s64,v17,11
s_lshr_b32 s64,s64,8
s_add_u32 s65,s65,s64
v_readlane_b32 s64,v17,13
s_lshr_b32 s64,s64,8
s_add_u32 s65,s65,s64
v_readlane_b32 s64,v17,15
s_lshr_b32 s64,s64,8
s_add_u32 s65,s65,s64
s_cmp_ge_u32 s65,256
s_cbranch_scc1 vok_178
s_branch vrt_177
vck_176:
v_cmp_gt_u32 vcc,v18,v17
s_cbranch_vccz vok_178
vrt_177:
s_sleep 48
s_sub_u32 s90,s90,1
s_cmp_gt_i32 s90,0
s_cbranch_scc1 vpoll_175
vok_178:
v_add_u32 v18,160512,v16
ds_write_b32 v18,v17
s_waitcnt lgkmcnt(0)
vot_179:
s_barrier
v_add_u32 v18,160512,v16
ds_read_b32 v17,v18
s_waitcnt lgkmcnt(0)
s_cmp_lg_u32 s56,2
s_cbranch_scc1 vfin_180
v_cmp_eq_u32 vcc,v17,v19
s_and_b32 s64,vcc_lo,0xffff
s_cmp_eq_u32 s64,65535
s_cbranch_scc1 vfin_180
s_mov_b32 s65,0
v_readlane_b32 s64,v17,1
s_lshr_b32 s64,s64,8
s_add_u32 s65,s65,s64
v_readlane_b32 s64,v17,3
s_lshr_b32 s64,s64,8
s_add_u32 s65,s65,s64
v_readlane_b32 s64,v17,5
s_lshr_b32 s64,s64,8
s_add_u32 s65,s65,s64
v_readlane_b32 s64,v17,7
s_lshr_b32 s64,s64,8
s_add_u32 s65,s65,s64
v_readlane_b32 s64,v17,9
s_lshr_b32 s64,s64,8
s_add_u32 s65,s65,s64
v_readlane_b32 s64,v17,11
s_lshr_b32 s64,s64,8
s_add_u32 s65,s65,s64
v_readlane_b32 s64,v17,13
s_lshr_b32 s64,s64,8
s_add_u32 s65,s65,s64
v_readlane_b32 s64,v17,15
s_lshr_b32 s64,s64,8
s_add_u32 s65,s65,s64
s_cmp_ge_u32 s65,256
s_cbranch_scc1 fl_fb
vfin_180:
s_and_b32 s56,s56,1
s_mov_b32 s67,0
s_barrier
v_lshlrev_b32 v0,4,v1
s_mov_b32 s60,0
s_mov_b32 s70,0
s_mov_b32 s55,0
s_lshl_b32 s63,s50,13
v_mov_b32 v3,v0
s_mov_b32 s73,0xffff0000
s_lshl_b32 s64,s52,2
s_add_u32 s64,s64,s50
s_mul_i32 s61,s64,8192
s_add_u32 s61,s61,205520896
s_lshl_b32 s82,s64,8
s_add_u32 s82,s82,138548224
s_mov_b32 s68,s82
s_lshl_b32 s83,s53,2
s_add_u32 s83,s83,s50
s_xor_b32 s64,s50,0
s_lshl_b32 s64,s64,13
v_add_u32 v8,s64,v0
s_xor_b32 s64,s50,1
s_lshl_b32 s64,s64,13
v_add_u32 v9,s64,v0
s_xor_b32 s64,s50,2
s_lshl_b32 s64,s64,13
v_add_u32 v10,s64,v0
s_xor_b32 s64,s50,3
s_lshl_b32 s64,s64,13
v_add_u32 v11,s64,v0
v_min_u32 v2,3,v1
v_lshlrev_b32 v2,2,v2
s_lshl_b32 s66,s83,10
s_lshr_b32 s65,s83,3
s_lshl_b32 s65,s65,8
s_and_b32 s64,s83,7
s_lshl_b32 s64,s64,2
s_add_u32 s69,s64,s65
s_add_u32 s69,s69,138549248
s_lshl_b32 s64,s50,9
s_add_u32 s64,s64,131072
v_lshlrev_b32 v26,3,v1
v_add_u32 v19,s64,v26
v_lshl_add_u32 v26,v23,4,v21
v_lshlrev_b32 v26,3,v26
v_add_u32 v20,131072,v26
s_mov_b32 s74,0x22222222
s_mov_b32 s75,0x22222222
s_mov_b32 s76,0x44444444
s_mov_b32 s77,0x44444444
s_mov_b32 s78,0x88888888
s_mov_b32 s79,0x88888888
s_mov_b32 s80,0xc0135761
s_mov_b32 s81,0xbdd2d3e8
v_mov_b32 v191,s80
v_mov_b32 v12,0x3f803f80
v_mov_b32 v13,0x3f803f80
v_mov_b32 v14,0x3f803f80
v_mov_b32 v15,0x3f803f80
s_nop 1
v_mfma_f32_16x16x32_bf16 v[152:155],a[0:3],v[12:15],0
v_mfma_f32_16x16x32_bf16 v[156:159],a[4:7],v[12:15],0
v_mfma_f32_16x16x32_bf16 v[152:155],a[8:11],v[12:15],v[152:155]
v_mfma_f32_16x16x32_bf16 v[156:159],a[12:15],v[12:15],v[156:159]
v_mfma_f32_16x16x32_bf16 v[152:155],a[16:19],v[12:15],v[152:155]
v_mfma_f32_16x16x32_bf16 v[156:159],a[20:23],v[12:15],v[156:159]
v_mfma_f32_16x16x32_bf16 v[152:155],a[24:27],v[12:15],v[152:155]
v_mfma_f32_16x16x32_bf16 v[156:159],a[28:31],v[12:15],v[156:159]
v_mfma_f32_16x16x32_bf16 v[152:155],a[32:35],v[12:15],v[152:155]
v_mfma_f32_16x16x32_bf16 v[156:159],a[36:39],v[12:15],v[156:159]
v_mfma_f32_16x16x32_bf16 v[152:155],a[40:43],v[12:15],v[152:155]
v_mfma_f32_16x16x32_bf16 v[156:159],a[44:47],v[12:15],v[156:159]
v_mfma_f32_16x16x32_bf16 v[152:155],a[48:51],v[12:15],v[152:155]
v_mfma_f32_16x16x32_bf16 v[156:159],a[52:55],v[12:15],v[156:159]
v_mfma_f32_16x16x32_bf16 v[152:155],a[56:59],v[12:15],v[152:155]
v_mfma_f32_16x16x32_bf16 v[156:159],a[60:63],v[12:15],v[156:159]
v_mfma_f32_16x16x32_bf16 v[152:155],a[64:67],v[12:15],v[152:155]
v_mfma_f32_16x16x32_bf16 v[156:159],a[68:71],v[12:15],v[156:159]
v_mfma_f32_16x16x32_bf16 v[152:155],a[72:75],v[12:15],v[152:155]
v_mfma_f32_16x16x32_bf16 v[156:159],a[76:79],v[12:15],v[156:159]
v_mfma_f32_16x16x32_bf16 v[152:155],a[80:83],v[12:15],v[152:155]
v_mfma_f32_16x16x32_bf16 v[156:159],a[84:87],v[12:15],v[156:159]
v_mfma_f32_16x16x32_bf16 v[152:155],a[88:91],v[12:15],v[152:155]
v_mfma_f32_16x16x32_bf16 v[156:159],a[92:95],v[12:15],v[156:159]
v_mfma_f32_16x16x32_bf16 v[152:155],a[96:99],v[12:15],v[152:155]
v_mfma_f32_16x16x32_bf16 v[156:159],a[100:103],v[12:15],v[156:159]
v_mfma_f32_16x16x32_bf16 v[152:155],a[104:107],v[12:15],v[152:155]
v_mfma_f32_16x16x32_bf16 v[156:159],a[108:111],v[12:15],v[156:159]
v_mfma_f32_16x16x32_bf16 v[152:155],a[112:115],v[12:15],v[152:155]
v_mfma_f32_16x16x32_bf16 v[156:159],a[116:119],v[12:15],v[156:159]
v_mfma_f32_16x16x32_bf16 v[152:155],a[120:123],v[12:15],v[152:155]
v_mfma_f32_16x16x32_bf16 v[156:159],a[124:127],v[12:15],v[156:159]
v_mfma_f32_16x16x32_bf16 v[152:155],a[128:131],v[12:15],v[152:155]
v_mfma_f32_16x16x32_bf16 v[156:159],a[132:135],v[12:15],v[156:159]
v_mfma_f32_16x16x32_bf16 v[152:155],a[136:139],v[12:15],v[152:155]
v_mfma_f32_16x16x32_bf16 v[156:159],a[140:143],v[12:15],v[156:159]
v_mfma_f32_16x16x32_bf16 v[152:155],a[144:147],v[12:15],v[152:155]
v_mfma_f32_16x16x32_bf16 v[156:159],a[148:151],v[12:15],v[156:159]
v_mfma_f32_16x16x32_bf16 v[152:155],a[152:155],v[12:15],v[152:155]
v_mfma_f32_16x16x32_bf16 v[156:159],a[156:159],v[12:15],v[156:159]
v_mfma_f32_16x16x32_bf16 v[152:155],a[160:163],v[12:15],v[152:155]
v_mfma_f32_16x16x32_bf16 v[156:159],a[164:167],v[12:15],v[156:159]
v_mfma_f32_16x16x32_bf16 v[152:155],a[168:171],v[12:15],v[152:155]
v_mfma_f32_16x16x32_bf16 v[156:159],a[172:175],v[12:15],v[156:159]
v_mfma_f32_16x16x32_bf16 v[152:155],a[176:179],v[12:15],v[152:155]
v_mfma_f32_16x16x32_bf16 v[156:159],a[180:183],v[12:15],v[156:159]
v_mfma_f32_16x16x32_bf16 v[152:155],a[184:187],v[12:15],v[152:155]
v_mfma_f32_16x16x32_bf16 v[156:159],a[188:191],v[12:15],v[156:159]
v_mfma_f32_16x16x32_bf16 v[152:155],a[192:195],v[12:15],v[152:155]
v_mfma_f32_16x16x32_bf16 v[156:159],a[196:199],v[12:15],v[156:159]
v_mfma_f32_16x16x32_bf16 v[152:155],a[200:203],v[12:15],v[152:155]
v_mfma_f32_16x16x32_bf16 v[156:159],a[204:207],v[12:15],v[156:159]
v_mfma_f32_16x16x32_bf16 v[152:155],a[208:211],v[12:15],v[152:155]
v_mfma_f32_16x16x32_bf16 v[156:159],a[212:215],v[12:15],v[156:159]
v_mfma_f32_16x16x32_bf16 v[152:155],a[216:219],v[12:15],v[152:155]
v_mfma_f32_16x16x32_bf16 v[156:159],a[220:223],v[12:15],v[156:159]
v_mfma_f32_16x16x32_bf16 v[152:155],a[224:227],v[12:15],v[152:155]
v_mfma_f32_16x16x32_bf16 v[156:159],a[228:231],v[12:15],v[156:159]
v_mfma_f32_16x16x32_bf16 v[152:155],a[232:235],v[12:15],v[152:155]
v_mfma_f32_16x16x32_bf16 v[156:159],a[236:239],v[12:15],v[156:159]
v_mfma_f32_16x16x32_bf16 v[152:155],a[240:243],v[12:15],v[152:155]
v_mfma_f32_16x16x32_bf16 v[156:159],a[244:247],v[12:15],v[156:159]
v_mfma_f32_16x16x32_bf16 v[152:155],a[248:251],v[12:15],v[152:155]
v_mfma_f32_16x16x32_bf16 v[156:159],a[252:255],v[12:15],v[156:159]
s_add_u32 s71,s60,1
plp_186:
buffer_load_dword v16,v2,s[20:23],s68 offen sc1
s_waitcnt vmcnt(0)
v_cmp_gt_u32 vcc,s71,v16
s_cbranch_vccz pok_187
s_sleep 4
s_sub_u32 s90,s90,1
s_cmp_gt_i32 s90,0
s_cbranch_scc1 plp_186
pok_187:
lag_185:
s_add_u32 m0,s70,s63
s_add_u32 s62,s61,4096
buffer_load_dwordx4 v3,s[20:23],s61 offen offset:0 lds
buffer_load_dwordx4 v3,s[20:23],s61 offen offset:1024 lds
buffer_load_dwordx4 v3,s[20:23],s61 offen offset:2048 lds
buffer_load_dwordx4 v3,s[20:23],s61 offen offset:3072 lds
s_add_u32 m0,m0,4096
s_nop 0
buffer_load_dwordx4 v3,s[20:23],s62 offen offset:0 lds
buffer_load_dwordx4 v3,s[20:23],s62 offen offset:1024 lds
buffer_load_dwordx4 v3,s[20:23],s62 offen offset:2048 lds
buffer_load_dwordx4 v3,s[20:23],s62 offen offset:3072 lds
s_add_u32 s61,s61,32768
s_add_u32 s70,s70,32768
s_and_b32 s70,s70,0x1ffff
buffer_load_dword v17,off,s[20:23],s69
top_181:
s_add_u32 s71,s60,2
buffer_load_dword v16,v2,s[20:23],s68 offen sc1
v_add_u32 v4,s55,v8
v_add_u32 v5,s55,v9
v_add_u32 v6,s55,v10
v_add_u32 v7,s55,v11
s_add_u32 s55,s55,32768
s_and_b32 s55,s55,0x1ffff
s_waitcnt vmcnt(9)
ds_read_b128 v[64:67],v4 offset:0
s_waitcnt vmcnt(8)
ds_read_b128 v[68:71],v4 offset:1024
s_waitcnt vmcnt(7)
ds_read_b128 v[72:75],v4 offset:2048
s_waitcnt lgkmcnt(2)
v_mfma_f32_16x16x32_bf16 v[32:35],a[0:3],v[64:67],0
v_mfma_f32_16x16x32_bf16 v[36:39],a[4:7],v[64:67],0
v_mfma_f32_16x16x32_bf16 v[48:51],v[12:15],v[64:67],0
v_mfma_f32_16x16x32_bf16 v[52:55],v[64:67],v[64:67],0
s_waitcnt vmcnt(6)
ds_read_b128 v[76:79],v4 offset:3072
s_waitcnt lgkmcnt(2)
v_mfma_f32_16x16x32_bf16 v[32:35],a[8:11],v[68:71],v[32:35]
v_mfma_f32_16x16x32_bf16 v[36:39],a[12:15],v[68:71],v[36:39]
v_mfma_f32_16x16x32_bf16 v[48:51],v[12:15],v[68:71],v[48:51]
v_mfma_f32_16x16x32_bf16 v[52:55],v[68:71],v[68:71],v[52:55]
s_waitcnt vmcnt(5)
ds_read_b128 v[80:83],v4 offset:4096
s_waitcnt lgkmcnt(2)
v_mfma_f32_16x16x32_bf16 v[32:35],a[16:19],v[72:75],v[32:35]
v_mfma_f32_16x16x32_bf16 v[36:39],a[20:23],v[72:75],v[36:39]
v_mfma_f32_16x16x32_bf16 v[48:51],v[12:15],v[72:75],v[48:51]
v_mfma_f32_16x16x32_bf16 v[52:55],v[72:75],v[72:75],v[52:55]
s_waitcnt vmcnt(4)
ds_read_b128 v[84:87],v4 offset:5120
s_waitcnt lgkmcnt(2)
v_mfma_f32_16x16x32_bf16 v[32:35],a[24:27],v[76:79],v[32:35]
v_mfma_f32_16x16x32_bf16 v[36:39],a[28:31],v[76:79],v[36:39]
v_mfma_f32_16x16x32_bf16 v[48:51],v[12:15],v[76:79],v[48:51]
v_mfma_f32_16x16x32_bf16 v[52:55],v[76:79],v[76:79],v[52:55]
s_waitcnt vmcnt(3)
ds_read_b128 v[88:91],v4 offset:6144
s_waitcnt lgkmcnt(2)
v_mfma_f32_16x16x32_bf16 v[32:35],a[32:35],v[80:83],v[32:35]
v_mfma_f32_16x16x32_bf16 v[36:39],a[36:39],v[80:83],v[36:39]
v_mfma_f32_16x16x32_bf16 v[48:51],v[12:15],v[80:83],v[48:51]
v_mfma_f32_16x16x32_bf16 v[52:55],v[80:83],v[80:83],v[52:55]
s_waitcnt vmcnt(2)
ds_read_b128 v[92:95],v4 offset:7168
s_barrier
s_waitcnt lgkmcnt(2)
v_mfma_f32_16x16x32_bf16 v[32:35],a[40:43],v[84:87],v[32:35]
v_mfma_f32_16x16x32_bf16 v[36:39],a[44:47],v[84:87],v[36:39]
v_mfma_f32_16x16x32_bf16 v[48:51],v[12:15],v[84:87],v[48:51]
v_mfma_f32_16x16x32_bf16 v[52:55],v[84:87],v[84:87],v[52:55]
ds_read_b128 v[96:99],v5 offset:0
s_waitcnt lgkmcnt(2)
v_mfma_f32_16x16x32_bf16 v[32:35],a[48:51],v[88:91],v[32:35]
ds_read_b128 v[100:103],v5 offset:1024
ds_read_b128 v[104:107],v5 offset:2048
v_mfma_f32_16x16x32_bf16 v[36:39],a[52:55],v[88:91],v[36:39]
v_mfma_f32_16x16x32_bf16 v[48:51],v[12:15],v[88:91],v[48:51]
v_mfma_f32_16x16x32_bf16 v[52:55],v[88:91],v[88:91],v[52:55]
s_waitcnt lgkmcnt(3)
v_mfma_f32_16x16x32_bf16 v[32:35],a[56:59],v[92:95],v[32:35]
ds_read_b128 v[108:111],v5 offset:3072
ds_read_b128 v[112:115],v5 offset:4096
v_mfma_f32_16x16x32_bf16 v[36:39],a[60:63],v[92:95],v[36:39]
v_mfma_f32_16x16x32_bf16 v[48:51],v[12:15],v[92:95],v[48:51]
v_mfma_f32_16x16x32_bf16 v[52:55],v[92:95],v[92:95],v[52:55]
s_waitcnt lgkmcnt(4)
v_mfma_f32_16x16x32_bf16 v[32:35],a[64:67],v[96:99],v[32:35]
ds_read_b128 v[116:119],v5 offset:5120
ds_read_b128 v[120:123],v5 offset:6144
v_mfma_f32_16x16x32_bf16 v[36:39],a[68:71],v[96:99],v[36:39]
s_waitcnt lgkmcnt(5)
v_mfma_f32_16x16x32_bf16 v[32:35],a[72:75],v[100:103],v[32:35]
ds_read_b128 v[124:127],v5 offset:7168
v_mfma_f32_16x16x32_bf16 v[36:39],a[76:79],v[100:103],v[36:39]
s_waitcnt lgkmcnt(5)
v_mfma_f32_16x16x32_bf16 v[32:35],a[80:83],v[104:107],v[32:35]
ds_read_b128 v[64:67],v6 offset:0
v_mfma_f32_16x16x32_bf16 v[36:39],a[84:87],v[104:107],v[36:39]
s_waitcnt lgkmcnt(5)
v_mfma_f32_16x16x32_bf16 v[32:35],a[88:91],v[108:111],v[32:35]
ds_read_b128 v[68:71],v6 offset:1024
v_cndmask_b32 v49,v52,v53,s[74:75]
v_mfma_f32_16x16x32_bf16 v[36:39],a[92:95],v[108:111],v[36:39]
v_cndmask_b32 v49,v49,v54,s[76:77]
s_waitcnt lgkmcnt(5)
v_mfma_f32_16x16x32_bf16 v[32:35],a[96:99],v[112:115],v[32:35]
ds_read_b128 v[72:75],v6 offset:2048
v_cndmask_b32 v49,v49,v55,s[78:79]
v_mfma_f32_16x16x32_bf16 v[36:39],a[100:103],v[112:115],v[36:39]
ds_write_b64 v19,v[48:49]
s_waitcnt lgkmcnt(6)
v_mfma_f32_16x16x32_bf16 v[32:35],a[104:107],v[116:119],v[32:35]
ds_read_b128 v[76:79],v6 offset:3072
v_mfma_f32_16x16x32_bf16 v[36:39],a[108:111],v[116:119],v[36:39]
s_waitcnt lgkmcnt(6)
v_mfma_f32_16x16x32_bf16 v[32:35],a[112:115],v[120:123],v[32:35]
ds_read_b128 v[80:83],v6 offset:4096
v_mfma_f32_16x16x32_bf16 v[36:39],a[116:119],v[120:123],v[36:39]
s_waitcnt lgkmcnt(6)
v_mfma_f32_16x16x32_bf16 v[32:35],a[120:123],v[124:127],v[32:35]
ds_read_b128 v[84:87],v6 offset:5120
v_mfma_f32_16x16x32_bf16 v[36:39],a[124:127],v[124:127],v[36:39]
s_waitcnt lgkmcnt(6)
v_mfma_f32_16x16x32_bf16 v[32:35],a[128:131],v[64:67],v[32:35]
ds_read_b128 v[88:91],v6 offset:6144
v_mfma_f32_16x16x32_bf16 v[36:39],a[132:135],v[64:67],v[36:39]
s_waitcnt lgkmcnt(4)
s_barrier
ds_read_b64 v[56:57],v20 offset:0
ds_read_b64 v[58:59],v20 offset:512
v_mfma_f32_16x16x32_bf16 v[32:35],a[136:139],v[68:71],v[32:35]
ds_read_b128 v[92:95],v6 offset:7168
ds_read_b64 v[60:61],v20 offset:1024
ds_read_b64 v[62:63],v20 offset:1536
v_mfma_f32_16x16x32_bf16 v[36:39],a[140:143],v[68:71],v[36:39]
v_mfma_f32_16x16x32_bf16 v[32:35],a[144:147],v[72:75],v[32:35]
ds_read_b128 v[96:99],v7 offset:0
v_mfma_f32_16x16x32_bf16 v[36:39],a[148:151],v[72:75],v[36:39]
s_waitcnt lgkmcnt(9)
v_mfma_f32_16x16x32_bf16 v[32:35],a[152:155],v[76:79],v[32:35]
ds_read_b128 v[100:103],v7 offset:1024
v_mfma_f32_16x16x32_bf16 v[36:39],a[156:159],v[76:79],v[36:39]
s_waitcnt lgkmcnt(9)
v_mfma_f32_16x16x32_bf16 v[32:35],a[160:163],v[80:83],v[32:35]
ds_read_b128 v[104:107],v7 offset:2048
v_mfma_f32_16x16x32_bf16 v[36:39],a[164:167],v[80:83],v[36:39]
s_waitcnt lgkmcnt(9)
v_mfma_f32_16x16x32_bf16 v[32:35],a[168:171],v[84:87],v[32:35]
ds_read_b128 v[108:111],v7 offset:3072
s_waitcnt lgkmcnt(4)
v_mfma_f32_16x16x32_bf16 v[36:39],a[172:175],v[84:87],v[36:39]
v_add_f32 v56,v56,v58
s_waitcnt vmcnt(0)
v_mov_b32 v17,s60
s_mov_b64 exec,1
buffer_store_dword v17,off,s[20:23],s69 sc1
s_mov_b64 exec,-1
v_cmp_gt_u32 vcc,s71,v16
s_cbranch_vccnz vN_182
v_mfma_f32_16x16x32_bf16 v[32:35],a[176:179],v[88:91],v[32:35]
ds_read_b128 v[112:115],v7 offset:4096
v_add_f32 v57,v57,v59
s_add_u32 m0,s70,s63
v_mfma_f32_16x16x32_bf16 v[36:39],a[180:183],v[88:91],v[36:39]
v_add_f32 v60,v60,v62
s_add_u32 s62,s61,4096
v_mfma_f32_16x16x32_bf16 v[32:35],a[184:187],v[92:95],v[32:35]
ds_read_b128 v[116:119],v7 offset:5120
v_add_f32 v61,v61,v63
buffer_load_dwordx4 v3,s[20:23],s61 offen offset:0 lds
v_mfma_f32_16x16x32_bf16 v[36:39],a[188:191],v[92:95],v[36:39]
v_add_f32 v56,v56,v60
buffer_load_dwordx4 v3,s[20:23],s61 offen offset:1024 lds
s_waitcnt lgkmcnt(5)
v_mfma_f32_16x16x32_bf16 v[32:35],a[192:195],v[96:99],v[32:35]
ds_read_b128 v[120:123],v7 offset:6144
v_add_f32 v57,v57,v61
buffer_load_dwordx4 v3,s[20:23],s61 offen offset:2048 lds
v_mfma_f32_16x16x32_bf16 v[36:39],a[196:199],v[96:99],v[36:39]
v_mul_f32 v189,0xba800000,v56
buffer_load_dwordx4 v3,s[20:23],s61 offen offset:3072 lds
s_waitcnt lgkmcnt(5)
v_mfma_f32_16x16x32_bf16 v[32:35],a[200:203],v[100:103],v[32:35]
ds_read_b128 v[124:127],v7 offset:7168
v_mul_f32 v58,v189,v189
s_add_u32 m0,m0,4096
v_mfma_f32_16x16x32_bf16 v[36:39],a[204:207],v[100:103],v[36:39]
v_mul_f32 v57,0x3a800000,v57
buffer_load_dwordx4 v3,s[20:23],s62 offen offset:0 lds
s_waitcnt lgkmcnt(5)
v_mfma_f32_16x16x32_bf16 v[32:35],a[208:211],v[104:107],v[32:35]
v_sub_f32 v57,v57,v58
buffer_load_dwordx4 v3,s[20:23],s62 offen offset:1024 lds
v_mfma_f32_16x16x32_bf16 v[36:39],a[212:215],v[104:107],v[36:39]
v_max_f32 v57,0,v57
buffer_load_dwordx4 v3,s[20:23],s62 offen offset:2048 lds
s_waitcnt lgkmcnt(4)
v_mfma_f32_16x16x32_bf16 v[32:35],a[216:219],v[108:111],v[32:35]
v_add_f32 v57,0x3727c5ac,v57
buffer_load_dwordx4 v3,s[20:23],s62 offen offset:3072 lds
v_mfma_f32_16x16x32_bf16 v[36:39],a[220:223],v[108:111],v[36:39]
v_rsq_f32 v190,v57
s_add_u32 s61,s61,32768
s_waitcnt lgkmcnt(3)
v_mfma_f32_16x16x32_bf16 v[32:35],a[224:227],v[112:115],v[32:35]
s_add_u32 s70,s70,32768
v_mfma_f32_16x16x32_bf16 v[36:39],a[228:231],v[112:115],v[36:39]
s_and_b32 s70,s70,0x1ffff
s_waitcnt lgkmcnt(2)
v_mfma_f32_16x16x32_bf16 v[32:35],a[232:235],v[116:119],v[32:35]
v_mfma_f32_16x16x32_bf16 v[36:39],a[236:239],v[116:119],v[36:39]
s_waitcnt lgkmcnt(1)
v_mfma_f32_16x16x32_bf16 v[32:35],a[240:243],v[120:123],v[32:35]
v_mfma_f32_16x16x32_bf16 v[36:39],a[244:247],v[120:123],v[36:39]
s_waitcnt lgkmcnt(0)
v_mfma_f32_16x16x32_bf16 v[32:35],a[248:251],v[124:127],v[32:35]
v_mfma_f32_16x16x32_bf16 v[36:39],a[252:255],v[124:127],v[36:39]
s_mov_b32 s72,1
join_183:
s_nop 5
v_fma_f32 v32,v152,v189,v32
v_fma_f32 v33,v153,v189,v33
v_fma_f32 v34,v154,v189,v34
v_fma_f32 v35,v155,v189,v35
v_fma_f32 v36,v156,v189,v36
v_fma_f32 v37,v157,v189,v37
v_fma_f32 v38,v158,v189,v38
v_fma_f32 v39,v159,v189,v39
v_mul_f32 v32,v32,v190
v_mul_f32 v33,v33,v190
v_mul_f32 v34,v34,v190
v_mul_f32 v35,v35,v190
v_mul_f32 v36,v36,v190
v_mul_f32 v37,v37,v190
v_mul_f32 v38,v38,v190
v_mul_f32 v39,v39,v190
v_mul_f32 v168,v32,v32
v_mul_f32 v169,v33,v33
v_mul_f32 v170,v34,v34
v_mul_f32 v171,v35,v35
v_mul_f32 v172,v36,v36
v_mul_f32 v173,v37,v37
v_mul_f32 v174,v38,v38
v_mul_f32 v175,v39,v39
v_fma_f32 v168,v168,s81,v191
v_fma_f32 v169,v169,s81,v191
v_fma_f32 v170,v170,s81,v191
v_fma_f32 v171,v171,s81,v191
v_fma_f32 v172,v172,s81,v191
v_fma_f32 v173,v173,s81,v191
v_fma_f32 v174,v174,s81,v191
v_fma_f32 v175,v175,s81,v191
v_mul_f32 v168,v168,v32
v_mul_f32 v169,v169,v33
v_mul_f32 v170,v170,v34
v_mul_f32 v171,v171,v35
v_mul_f32 v172,v172,v36
v_mul_f32 v173,v173,v37
v_mul_f32 v174,v174,v38
v_mul_f32 v175,v175,v39
v_exp_f32 v168,v168
v_exp_f32 v169,v169
v_exp_f32 v170,v170
v_exp_f32 v171,v171
v_exp_f32 v172,v172
v_exp_f32 v173,v173
v_exp_f32 v174,v174
v_exp_f32 v175,v175
v_add_f32 v168,1.0,v168
v_add_f32 v169,1.0,v169
v_add_f32 v170,1.0,v170
v_add_f32 v171,1.0,v171
v_add_f32 v172,1.0,v172
v_add_f32 v173,1.0,v173
v_add_f32 v174,1.0,v174
v_add_f32 v175,1.0,v175
v_rcp_f32 v168,v168
v_rcp_f32 v169,v169
v_rcp_f32 v170,v170
v_rcp_f32 v171,v171
v_rcp_f32 v172,v172
v_rcp_f32 v173,v173
v_rcp_f32 v174,v174
v_rcp_f32 v175,v175
v_mul_f32 v32,v168,v32
v_mul_f32 v33,v169,v33
v_mul_f32 v34,v170,v34
v_mul_f32 v35,v171,v35
v_mul_f32 v36,v172,v36
v_mul_f32 v37,v173,v37
v_mul_f32 v38,v174,v38
v_mul_f32 v39,v175,v39
v_cvt_pk_bf16_f32 v176,v32,v33
v_cvt_pk_bf16_f32 v177,v34,v35
v_cvt_pk_bf16_f32 v178,v36,v37
v_cvt_pk_bf16_f32 v179,v38,v39
s_add_u32 s64,s66,209747968
buffer_store_dwordx4 v[176:179],v0,s[20:23],s64 offen sc1
s_add_u32 s66,s66,32768
s_add_u32 s60,s60,1
s_cmp_eq_u32 s72,0
s_cbranch_scc1 slowp_184
s_branch top_181
slowp_184:
s_waitcnt vmcnt(1)
v_cmp_gt_u32 vcc,s71,v16
s_cbranch_vccz lag_185
s_waitcnt vmcnt(0)
v_mov_b32 v17,s60
s_mov_b64 exec,1
buffer_store_dword v17,off,s[20:23],s69 sc1
s_mov_b64 exec,-1
s_cmp_ge_u32 s60,128
s_cbranch_scc1 done_174
plp_188:
buffer_load_dword v16,v2,s[20:23],s68 offen sc1
s_waitcnt vmcnt(0)
v_cmp_gt_u32 vcc,s71,v16
s_cbranch_vccz pok_189
s_sleep 4
s_sub_u32 s90,s90,1
s_cmp_gt_i32 s90,0
s_cbranch_scc1 plp_188
pok_189:
s_branch lag_185
vN_182:
buffer_load_dword v16,v2,s[20:23],s68 offen sc1
v_mfma_f32_16x16x32_bf16 v[32:35],a[176:179],v[88:91],v[32:35]
ds_read_b128 v[112:115],v7 offset:4096
v_add_f32 v57,v57,v59
v_mfma_f32_16x16x32_bf16 v[36:39],a[180:183],v[88:91],v[36:39]
v_add_f32 v60,v60,v62
v_mfma_f32_16x16x32_bf16 v[32:35],a[184:187],v[92:95],v[32:35]
ds_read_b128 v[116:119],v7 offset:5120
v_add_f32 v61,v61,v63
v_mfma_f32_16x16x32_bf16 v[36:39],a[188:191],v[92:95],v[36:39]
v_add_f32 v56,v56,v60
s_waitcnt lgkmcnt(5)
v_mfma_f32_16x16x32_bf16 v[32:35],a[192:195],v[96:99],v[32:35]
ds_read_b128 v[120:123],v7 offset:6144
v_add_f32 v57,v57,v61
v_mfma_f32_16x16x32_bf16 v[36:39],a[196:199],v[96:99],v[36:39]
v_mul_f32 v189,0xba800000,v56
s_waitcnt lgkmcnt(5)
v_mfma_f32_16x16x32_bf16 v[32:35],a[200:203],v[100:103],v[32:35]
ds_read_b128 v[124:127],v7 offset:7168
v_mul_f32 v58,v189,v189
v_mfma_f32_16x16x32_bf16 v[36:39],a[204:207],v[100:103],v[36:39]
v_mul_f32 v57,0x3a800000,v57
s_waitcnt lgkmcnt(5)
v_mfma_f32_16x16x32_bf16 v[32:35],a[208:211],v[104:107],v[32:35]
v_sub_f32 v57,v57,v58
v_mfma_f32_16x16x32_bf16 v[36:39],a[212:215],v[104:107],v[36:39]
v_max_f32 v57,0,v57
s_waitcnt lgkmcnt(4)
v_mfma_f32_16x16x32_bf16 v[32:35],a[216:219],v[108:111],v[32:35]
v_add_f32 v57,0x3727c5ac,v57
v_mfma_f32_16x16x32_bf16 v[36:39],a[220:223],v[108:111],v[36:39]
v_rsq_f32 v190,v57
s_waitcnt lgkmcnt(3)
v_mfma_f32_16x16x32_bf16 v[32:35],a[224:227],v[112:115],v[32:35]
v_mfma_f32_16x16x32_bf16 v[36:39],a[228:231],v[112:115],v[36:39]
s_waitcnt lgkmcnt(2)
v_mfma_f32_16x16x32_bf16 v[32:35],a[232:235],v[116:119],v[32:35]
v_mfma_f32_16x16x32_bf16 v[36:39],a[236:239],v[116:119],v[36:39]
s_waitcnt lgkmcnt(1)
v_mfma_f32_16x16x32_bf16 v[32:35],a[240:243],v[120:123],v[32:35]
v_mfma_f32_16x16x32_bf16 v[36:39],a[244:247],v[120:123],v[36:39]
s_waitcnt lgkmcnt(0)
v_mfma_f32_16x16x32_bf16 v[32:35],a[248:251],v[124:127],v[32:35]
v_mfma_f32_16x16x32_bf16 v[36:39],a[252:255],v[124:127],v[36:39]
s_mov_b32 s72,0
s_branch join_183
done_174:
s_endpgm
fl_w2:
v_and_b32 v21,15,v1
v_lshrrev_b32 v22,4,v1
v_lshrrev_b32 v23,2,v21
v_and_b32 v24,3,v21
s_lshl_b32 s61,s50,15
v_lshl_add_u32 v25,v22,3,v23
s_load_dwordx2 s[4:5],s[0:1],72
s_mov_b32 s52,0
s_mov_b32 s53,s59
s_mul_i32 s54,s52,2097152
s_lshl_b32 s64,s53,8
s_add_u32 s54,s54,s64
s_lshl_b32 s64,s50,6
s_add_u32 s54,s54,s64
s_waitcnt lgkmcnt(0)
s_mov_b32 s28,s4
s_and_b32 s29,s5,0xffff
s_mov_b32 s30,0x200000
s_mov_b32 s31,0x20000
v_lshrrev_b32 v26,2,v1
v_and_b32 v27,3,v1
v_mul_u32_u24 v16,2048,v26
v_lshl_add_u32 v16,v27,4,v16
v_lshlrev_b32 v17,6,v25
v_lshl_add_u32 v17,v24,4,v17
v_add_u32 v17,s61,v17
s_xor_b32 s62,s50,0
s_mul_i32 s62,s62,524288
s_add_u32 s62,s62,s54
s_add_u32 m0,s61,0
s_nop 0
buffer_load_dwordx4 v16,s[28:31],s62 offen lds
s_add_u32 s62,s62,32768
s_add_u32 m0,m0,1024
s_waitcnt vmcnt(6)
buffer_load_dwordx4 v16,s[28:31],s62 offen lds
s_add_u32 s62,s62,32768
s_add_u32 m0,m0,1024
s_waitcnt vmcnt(6)
buffer_load_dwordx4 v16,s[28:31],s62 offen lds
s_add_u32 s62,s62,32768
s_add_u32 m0,m0,1024
s_waitcnt vmcnt(6)
buffer_load_dwordx4 v16,s[28:31],s62 offen lds
s_add_u32 s62,s62,32768
s_add_u32 m0,m0,1024
s_waitcnt vmcnt(6)
buffer_load_dwordx4 v16,s[28:31],s62 offen lds
s_add_u32 s62,s62,32768
s_add_u32 m0,m0,1024
s_waitcnt vmcnt(6)
buffer_load_dwordx4 v16,s[28:31],s62 offen lds
s_add_u32 s62,s62,32768
s_add_u32 m0,m0,1024
s_waitcnt vmcnt(6)
buffer_load_dwordx4 v16,s[28:31],s62 offen lds
s_add_u32 s62,s62,32768
s_add_u32 m0,m0,1024
s_waitcnt vmcnt(6)
buffer_load_dwordx4 v16,s[28:31],s62 offen lds
s_add_u32 s62,s62,32768
s_add_u32 m0,m0,1024
s_waitcnt vmcnt(6)
buffer_load_dwordx4 v16,s[28:31],s62 offen lds
s_add_u32 s62,s62,32768
s_add_u32 m0,m0,1024
s_waitcnt vmcnt(6)
buffer_load_dwordx4 v16,s[28:31],s62 offen lds
s_add_u32 s62,s62,32768
s_add_u32 m0,m0,1024
s_waitcnt vmcnt(6)
buffer_load_dwordx4 v16,s[28:31],s62 offen lds
s_add_u32 s62,s62,32768
s_add_u32 m0,m0,1024
s_waitcnt vmcnt(6)
buffer_load_dwordx4 v16,s[28:31],s62 offen lds
s_add_u32 s62,s62,32768
s_add_u32 m0,m0,1024
s_waitcnt vmcnt(6)
buffer_load_dwordx4 v16,s[28:31],s62 offen lds
s_add_u32 s62,s62,32768
s_add_u32 m0,m0,1024
s_waitcnt vmcnt(6)
buffer_load_dwordx4 v16,s[28:31],s62 offen lds
s_add_u32 s62,s62,32768
s_add_u32 m0,m0,1024
s_waitcnt vmcnt(6)
buffer_load_dwordx4 v16,s[28:31],s62 offen lds
s_add_u32 s62,s62,32768
s_add_u32 m0,m0,1024
s_waitcnt vmcnt(6)
buffer_load_dwordx4 v16,s[28:31],s62 offen lds
s_waitcnt vmcnt(6)
s_xor_b32 s62,s50,1
s_mul_i32 s62,s62,524288
s_add_u32 s62,s62,s54
s_add_u32 m0,s61,16384
s_nop 0
buffer_load_dwordx4 v16,s[28:31],s62 offen lds
s_add_u32 s62,s62,32768
s_add_u32 m0,m0,1024
s_waitcnt vmcnt(6)
buffer_load_dwordx4 v16,s[28:31],s62 offen lds
s_add_u32 s62,s62,32768
s_add_u32 m0,m0,1024
s_waitcnt vmcnt(6)
buffer_load_dwordx4 v16,s[28:31],s62 offen lds
s_add_u32 s62,s62,32768
s_add_u32 m0,m0,1024
s_waitcnt vmcnt(6)
buffer_load_dwordx4 v16,s[28:31],s62 offen lds
s_add_u32 s62,s62,32768
s_add_u32 m0,m0,1024
s_waitcnt vmcnt(6)
buffer_load_dwordx4 v16,s[28:31],s62 offen lds
s_add_u32 s62,s62,32768
s_add_u32 m0,m0,1024
s_waitcnt vmcnt(6)
buffer_load_dwordx4 v16,s[28:31],s62 offen lds
s_add_u32 s62,s62,32768
s_add_u32 m0,m0,1024
s_waitcnt vmcnt(6)
buffer_load_dwordx4 v16,s[28:31],s62 offen lds
s_add_u32 s62,s62,32768
s_add_u32 m0,m0,1024
s_waitcnt vmcnt(6)
buffer_load_dwordx4 v16,s[28:31],s62 offen lds
s_add_u32 s62,s62,32768
s_add_u32 m0,m0,1024
s_waitcnt vmcnt(6)
buffer_load_dwordx4 v16,s[28:31],s62 offen lds
s_add_u32 s62,s62,32768
s_add_u32 m0,m0,1024
s_waitcnt vmcnt(6)
buffer_load_dwordx4 v16,s[28:31],s62 offen lds
s_add_u32 s62,s62,32768
s_add_u32 m0,m0,1024
s_waitcnt vmcnt(6)
buffer_load_dwordx4 v16,s[28:31],s62 offen lds
s_add_u32 s62,s62,32768
s_add_u32 m0,m0,1024
s_waitcnt vmcnt(6)
buffer_load_dwordx4 v16,s[28:31],s62 offen lds
s_add_u32 s62,s62,32768
s_add_u32 m0,m0,1024
s_waitcnt vmcnt(6)
buffer_load_dwordx4 v16,s[28:31],s62 offen lds
s_add_u32 s62,s62,32768
s_add_u32 m0,m0,1024
s_waitcnt vmcnt(6)
buffer_load_dwordx4 v16,s[28:31],s62 offen lds
s_add_u32 s62,s62,32768
s_add_u32 m0,m0,1024
s_waitcnt vmcnt(6)
buffer_load_dwordx4 v16,s[28:31],s62 offen lds
s_add_u32 s62,s62,32768
s_add_u32 m0,m0,1024
s_waitcnt vmcnt(6)
buffer_load_dwordx4 v16,s[28:31],s62 offen lds
s_waitcnt vmcnt(6)
s_waitcnt vmcnt(16)
ds_read_b64_tr_b16 a[0:1],v17 offset:0
ds_read_b64_tr_b16 a[2:3],v17 offset:256
ds_read_b64_tr_b16 a[4:5],v17 offset:8
ds_read_b64_tr_b16 a[6:7],v17 offset:264
ds_read_b64_tr_b16 a[8:9],v17 offset:2048
ds_read_b64_tr_b16 a[10:11],v17 offset:2304
ds_read_b64_tr_b16 a[12:13],v17 offset:2056
ds_read_b64_tr_b16 a[14:15],v17 offset:2312
ds_read_b64_tr_b16 a[16:17],v17 offset:4096
ds_read_b64_tr_b16 a[18:19],v17 offset:4352
ds_read_b64_tr_b16 a[20:21],v17 offset:4104
ds_read_b64_tr_b16 a[22:23],v17 offset:4360
s_waitcnt lgkmcnt(0)
ds_read_b64_tr_b16 a[24:25],v17 offset:6144
ds_read_b64_tr_b16 a[26:27],v17 offset:6400
ds_read_b64_tr_b16 a[28:29],v17 offset:6152
ds_read_b64_tr_b16 a[30:31],v17 offset:6408
ds_read_b64_tr_b16 a[32:33],v17 offset:8192
ds_read_b64_tr_b16 a[34:35],v17 offset:8448
ds_read_b64_tr_b16 a[36:37],v17 offset:8200
ds_read_b64_tr_b16 a[38:39],v17 offset:8456
ds_read_b64_tr_b16 a[40:41],v17 offset:10240
ds_read_b64_tr_b16 a[42:43],v17 offset:10496
ds_read_b64_tr_b16 a[44:45],v17 offset:10248
ds_read_b64_tr_b16 a[46:47],v17 offset:10504
s_waitcnt lgkmcnt(0)
ds_read_b64_tr_b16 a[48:49],v17 offset:12288
ds_read_b64_tr_b16 a[50:51],v17 offset:12544
ds_read_b64_tr_b16 a[52:53],v17 offset:12296
ds_read_b64_tr_b16 a[54:55],v17 offset:12552
ds_read_b64_tr_b16 a[56:57],v17 offset:14336
ds_read_b64_tr_b16 a[58:59],v17 offset:14592
ds_read_b64_tr_b16 a[60:61],v17 offset:14344
ds_read_b64_tr_b16 a[62:63],v17 offset:14600
s_waitcnt lgkmcnt(0)
s_xor_b32 s62,s50,2
s_mul_i32 s62,s62,524288
s_add_u32 s62,s62,s54
s_add_u32 m0,s61,0
s_nop 0
buffer_load_dwordx4 v16,s[28:31],s62 offen lds
s_add_u32 s62,s62,32768
s_add_u32 m0,m0,1024
s_waitcnt vmcnt(6)
buffer_load_dwordx4 v16,s[28:31],s62 offen lds
s_add_u32 s62,s62,32768
s_add_u32 m0,m0,1024
s_waitcnt vmcnt(6)
buffer_load_dwordx4 v16,s[28:31],s62 offen lds
s_add_u32 s62,s62,32768
s_add_u32 m0,m0,1024
s_waitcnt vmcnt(6)
buffer_load_dwordx4 v16,s[28:31],s62 offen lds
s_add_u32 s62,s62,32768
s_add_u32 m0,m0,1024
s_waitcnt vmcnt(6)
buffer_load_dwordx4 v16,s[28:31],s62 offen lds
s_add_u32 s62,s62,32768
s_add_u32 m0,m0,1024
s_waitcnt vmcnt(6)
buffer_load_dwordx4 v16,s[28:31],s62 offen lds
s_add_u32 s62,s62,32768
s_add_u32 m0,m0,1024
s_waitcnt vmcnt(6)
buffer_load_dwordx4 v16,s[28:31],s62 offen lds
s_add_u32 s62,s62,32768
s_add_u32 m0,m0,1024
s_waitcnt vmcnt(6)
buffer_load_dwordx4 v16,s[28:31],s62 offen lds
s_add_u32 s62,s62,32768
s_add_u32 m0,m0,1024
s_waitcnt vmcnt(6)
buffer_load_dwordx4 v16,s[28:31],s62 offen lds
s_add_u32 s62,s62,32768
s_add_u32 m0,m0,1024
s_waitcnt vmcnt(6)
buffer_load_dwordx4 v16,s[28:31],s62 offen lds
s_add_u32 s62,s62,32768
s_add_u32 m0,m0,1024
s_waitcnt vmcnt(6)
buffer_load_dwordx4 v16,s[28:31],s62 offen lds
s_add_u32 s62,s62,32768
s_add_u32 m0,m0,1024
s_waitcnt vmcnt(6)
buffer_load_dwordx4 v16,s[28:31],s62 offen lds
s_add_u32 s62,s62,32768
s_add_u32 m0,m0,1024
s_waitcnt vmcnt(6)
buffer_load_dwordx4 v16,s[28:31],s62 offen lds
s_add_u32 s62,s62,32768
s_add_u32 m0,m0,1024
s_waitcnt vmcnt(6)
buffer_load_dwordx4 v16,s[28:31],s62 offen lds
s_add_u32 s62,s62,32768
s_add_u32 m0,m0,1024
s_waitcnt vmcnt(6)
buffer_load_dwordx4 v16,s[28:31],s62 offen lds
s_add_u32 s62,s62,32768
s_add_u32 m0,m0,1024
s_waitcnt vmcnt(6)
buffer_load_dwordx4 v16,s[28:31],s62 offen lds
s_waitcnt vmcnt(6)
s_waitcnt vmcnt(16)
ds_read_b64_tr_b16 a[64:65],v17 offset:16384
ds_read_b64_tr_b16 a[66:67],v17 offset:16640
ds_read_b64_tr_b16 a[68:69],v17 offset:16392
ds_read_b64_tr_b16 a[70:71],v17 offset:16648
ds_read_b64_tr_b16 a[72:73],v17 offset:18432
ds_read_b64_tr_b16 a[74:75],v17 offset:18688
ds_read_b64_tr_b16 a[76:77],v17 offset:18440
ds_read_b64_tr_b16 a[78:79],v17 offset:18696
ds_read_b64_tr_b16 a[80:81],v17 offset:20480
ds_read_b64_tr_b16 a[82:83],v17 offset:20736
ds_read_b64_tr_b16 a[84:85],v17 offset:20488
ds_read_b64_tr_b16 a[86:87],v17 offset:20744
s_waitcnt lgkmcnt(0)
ds_read_b64_tr_b16 a[88:89],v17 offset:22528
ds_read_b64_tr_b16 a[90:91],v17 offset:22784
ds_read_b64_tr_b16 a[92:93],v17 offset:22536
ds_read_b64_tr_b16 a[94:95],v17 offset:22792
ds_read_b64_tr_b16 a[96:97],v17 offset:24576
ds_read_b64_tr_b16 a[98:99],v17 offset:24832
ds_read_b64_tr_b16 a[100:101],v17 offset:24584
ds_read_b64_tr_b16 a[102:103],v17 offset:24840
ds_read_b64_tr_b16 a[104:105],v17 offset:26624
ds_read_b64_tr_b16 a[106:107],v17 offset:26880
ds_read_b64_tr_b16 a[108:109],v17 offset:26632
ds_read_b64_tr_b16 a[110:111],v17 offset:26888
s_waitcnt lgkmcnt(0)
ds_read_b64_tr_b16 a[112:113],v17 offset:28672
ds_read_b64_tr_b16 a[114:115],v17 offset:28928
ds_read_b64_tr_b16 a[116:117],v17 offset:28680
ds_read_b64_tr_b16 a[118:119],v17 offset:28936
ds_read_b64_tr_b16 a[120:121],v17 offset:30720
ds_read_b64_tr_b16 a[122:123],v17 offset:30976
ds_read_b64_tr_b16 a[124:125],v17 offset:30728
ds_read_b64_tr_b16 a[126:127],v17 offset:30984
s_waitcnt lgkmcnt(0)
s_xor_b32 s62,s50,3
s_mul_i32 s62,s62,524288
s_add_u32 s62,s62,s54
s_add_u32 m0,s61,16384
s_nop 0
buffer_load_dwordx4 v16,s[28:31],s62 offen lds
s_add_u32 s62,s62,32768
s_add_u32 m0,m0,1024
s_waitcnt vmcnt(6)
buffer_load_dwordx4 v16,s[28:31],s62 offen lds
s_add_u32 s62,s62,32768
s_add_u32 m0,m0,1024
s_waitcnt vmcnt(6)
buffer_load_dwordx4 v16,s[28:31],s62 offen lds
s_add_u32 s62,s62,32768
s_add_u32 m0,m0,1024
s_waitcnt vmcnt(6)
buffer_load_dwordx4 v16,s[28:31],s62 offen lds
s_add_u32 s62,s62,32768
s_add_u32 m0,m0,1024
s_waitcnt vmcnt(6)
buffer_load_dwordx4 v16,s[28:31],s62 offen lds
s_add_u32 s62,s62,32768
s_add_u32 m0,m0,1024
s_waitcnt vmcnt(6)
buffer_load_dwordx4 v16,s[28:31],s62 offen lds
s_add_u32 s62,s62,32768
s_add_u32 m0,m0,1024
s_waitcnt vmcnt(6)
buffer_load_dwordx4 v16,s[28:31],s62 offen lds
s_add_u32 s62,s62,32768
s_add_u32 m0,m0,1024
s_waitcnt vmcnt(6)
buffer_load_dwordx4 v16,s[28:31],s62 offen lds
s_add_u32 s62,s62,32768
s_add_u32 m0,m0,1024
s_waitcnt vmcnt(6)
buffer_load_dwordx4 v16,s[28:31],s62 offen lds
s_add_u32 s62,s62,32768
s_add_u32 m0,m0,1024
s_waitcnt vmcnt(6)
buffer_load_dwordx4 v16,s[28:31],s62 offen lds
s_add_u32 s62,s62,32768
s_add_u32 m0,m0,1024
s_waitcnt vmcnt(6)
buffer_load_dwordx4 v16,s[28:31],s62 offen lds
s_add_u32 s62,s62,32768
s_add_u32 m0,m0,1024
s_waitcnt vmcnt(6)
buffer_load_dwordx4 v16,s[28:31],s62 offen lds
s_add_u32 s62,s62,32768
s_add_u32 m0,m0,1024
s_waitcnt vmcnt(6)
buffer_load_dwordx4 v16,s[28:31],s62 offen lds
s_add_u32 s62,s62,32768
s_add_u32 m0,m0,1024
s_waitcnt vmcnt(6)
buffer_load_dwordx4 v16,s[28:31],s62 offen lds
s_add_u32 s62,s62,32768
s_add_u32 m0,m0,1024
s_waitcnt vmcnt(6)
buffer_load_dwordx4 v16,s[28:31],s62 offen lds
s_add_u32 s62,s62,32768
s_add_u32 m0,m0,1024
s_waitcnt vmcnt(6)
buffer_load_dwordx4 v16,s[28:31],s62 offen lds
s_waitcnt vmcnt(6)
s_waitcnt vmcnt(16)
ds_read_b64_tr_b16 a[128:129],v17 offset:0
ds_read_b64_tr_b16 a[130:131],v17 offset:256
ds_read_b64_tr_b16 a[132:133],v17 offset:8
ds_read_b64_tr_b16 a[134:135],v17 offset:264
ds_read_b64_tr_b16 a[136:137],v17 offset:2048
ds_read_b64_tr_b16 a[138:139],v17 offset:2304
ds_read_b64_tr_b16 a[140:141],v17 offset:2056
ds_read_b64_tr_b16 a[142:143],v17 offset:2312
ds_read_b64_tr_b16 a[144:145],v17 offset:4096
ds_read_b64_tr_b16 a[146:147],v17 offset:4352
ds_read_b64_tr_b16 a[148:149],v17 offset:4104
ds_read_b64_tr_b16 a[150:151],v17 offset:4360
s_waitcnt lgkmcnt(0)
ds_read_b64_tr_b16 a[152:153],v17 offset:6144
ds_read_b64_tr_b16 a[154:155],v17 offset:6400
ds_read_b64_tr_b16 a[156:157],v17 offset:6152
ds_read_b64_tr_b16 a[158:159],v17 offset:6408
ds_read_b64_tr_b16 a[160:161],v17 offset:8192
ds_read_b64_tr_b16 a[162:163],v17 offset:8448
ds_read_b64_tr_b16 a[164:165],v17 offset:8200
ds_read_b64_tr_b16 a[166:167],v17 offset:8456
ds_read_b64_tr_b16 a[168:169],v17 offset:10240
ds_read_b64_tr_b16 a[170:171],v17 offset:10496
ds_read_b64_tr_b16 a[172:173],v17 offset:10248
ds_read_b64_tr_b16 a[174:175],v17 offset:10504
s_waitcnt lgkmcnt(0)
ds_read_b64_tr_b16 a[176:177],v17 offset:12288
ds_read_b64_tr_b16 a[178:179],v17 offset:12544
ds_read_b64_tr_b16 a[180:181],v17 offset:12296
ds_read_b64_tr_b16 a[182:183],v17 offset:12552
ds_read_b64_tr_b16 a[184:185],v17 offset:14336
ds_read_b64_tr_b16 a[186:187],v17 offset:14592
ds_read_b64_tr_b16 a[188:189],v17 offset:14344
ds_read_b64_tr_b16 a[190:191],v17 offset:14600
s_waitcnt lgkmcnt(0)
s_waitcnt vmcnt(0)
ds_read_b64_tr_b16 a[192:193],v17 offset:16384
ds_read_b64_tr_b16 a[194:195],v17 offset:16640
ds_read_b64_tr_b16 a[196:197],v17 offset:16392
ds_read_b64_tr_b16 a[198:199],v17 offset:16648
ds_read_b64_tr_b16 a[200:201],v17 offset:18432
ds_read_b64_tr_b16 a[202:203],v17 offset:18688
ds_read_b64_tr_b16 a[204:205],v17 offset:18440
ds_read_b64_tr_b16 a[206:207],v17 offset:18696
ds_read_b64_tr_b16 a[208:209],v17 offset:20480
ds_read_b64_tr_b16 a[210:211],v17 offset:20736
ds_read_b64_tr_b16 a[212:213],v17 offset:20488
ds_read_b64_tr_b16 a[214:215],v17 offset:20744
s_waitcnt lgkmcnt(0)
ds_read_b64_tr_b16 a[216:217],v17 offset:22528
ds_read_b64_tr_b16 a[218:219],v17 offset:22784
ds_read_b64_tr_b16 a[220:221],v17 offset:22536
ds_read_b64_tr_b16 a[222:223],v17 offset:22792
ds_read_b64_tr_b16 a[224:225],v17 offset:24576
ds_read_b64_tr_b16 a[226:227],v17 offset:24832
ds_read_b64_tr_b16 a[228:229],v17 offset:24584
ds_read_b64_tr_b16 a[230:231],v17 offset:24840
ds_read_b64_tr_b16 a[232:233],v17 offset:26624
ds_read_b64_tr_b16 a[234:235],v17 offset:26880
ds_read_b64_tr_b16 a[236:237],v17 offset:26632
ds_read_b64_tr_b16 a[238:239],v17 offset:26888
s_waitcnt lgkmcnt(0)
ds_read_b64_tr_b16 a[240:241],v17 offset:28672
ds_read_b64_tr_b16 a[242:243],v17 offset:28928
ds_read_b64_tr_b16 a[244:245],v17 offset:28680
ds_read_b64_tr_b16 a[246:247],v17 offset:28936
ds_read_b64_tr_b16 a[248:249],v17 offset:30720
ds_read_b64_tr_b16 a[250:251],v17 offset:30976
ds_read_b64_tr_b16 a[252:253],v17 offset:30728
ds_read_b64_tr_b16 a[254:255],v17 offset:30984
s_waitcnt lgkmcnt(0)
s_mov_b32 s92,s2
s_and_b32 s93,s3,0xffff
s_mov_b32 s94,0x100
s_mov_b32 s95,0x20000
v_mbcnt_lo_u32_b32 v16,-1,0
v_mbcnt_hi_u32_b32 v16,-1,v16
v_mov_b32 v18,0
v_cmp_eq_u32 vcc,22,v16
s_nop 1
v_cndmask_b32 v18,v18,63,vcc
v_cmp_eq_u32 vcc,17,v16
s_nop 1
v_cndmask_b32 v18,v18,63,vcc
v_cmp_eq_u32 vcc,18,v16
s_nop 1
v_cndmask_b32 v18,v18,1,vcc
v_and_b32 v19,1,v16
v_cmp_eq_u32 vcc,1,v19
v_mov_b32 v19,8192
s_nop 0
v_cndmask_b32 v19,-1,v19,vcc
v_min_u32 v16,31,v16
v_lshlrev_b32 v16,2,v16
s_sub_u32 s66,s88,64
s_cmp_lg_u32 s50,0
s_cbranch_scc1 vot_195
vpoll_191:
buffer_load_dword v17,v16,s[92:95],s66 offen sc1
s_waitcnt vmcnt(0)
s_cmp_lg_u32 s56,2
s_cbranch_scc1 vck_192
v_cmp_eq_u32 vcc,v17,v19
s_and_b32 s64,vcc_lo,0xffff
s_cmp_eq_u32 s64,65535
s_cbranch_scc1 vck_192
s_mov_b32 s65,0
v_readlane_b32 s64,v17,1
s_lshr_b32 s64,s64,8
s_add_u32 s65,s65,s64
v_readlane_b32 s64,v17,3
s_lshr_b32 s64,s64,8
s_add_u32 s65,s65,s64
v_readlane_b32 s64,v17,5
s_lshr_b32 s64,s64,8
s_add_u32 s65,s65,s64
v_readlane_b32 s64,v17,7
s_lshr_b32 s64,s64,8
s_add_u32 s65,s65,s64
v_readlane_b32 s64,v17,9
s_lshr_b32 s64,s64,8
s_add_u32 s65,s65,s64
v_readlane_b32 s64,v17,11
s_lshr_b32 s64,s64,8
s_add_u32 s65,s65,s64
v_readlane_b32 s64,v17,13
s_lshr_b32 s64,s64,8
s_add_u32 s65,s65,s64
v_readlane_b32 s64,v17,15
s_lshr_b32 s64,s64,8
s_add_u32 s65,s65,s64
s_cmp_ge_u32 s65,256
s_cbranch_scc1 vok_194
s_branch vrt_193
vck_192:
v_cmp_gt_u32 vcc,v18,v17
s_cbranch_vccz vok_194
vrt_193:
s_sleep 48
s_sub_u32 s90,s90,1
s_cmp_gt_i32 s90,0
s_cbranch_scc1 vpoll_191
vok_194:
v_add_u32 v18,160768,v16
ds_write_b32 v18,v17
s_waitcnt lgkmcnt(0)
vot_195:
s_barrier
v_add_u32 v18,160768,v16
ds_read_b32 v17,v18
s_waitcnt lgkmcnt(0)
s_cmp_lg_u32 s56,2
s_cbranch_scc1 vfin_196
v_cmp_eq_u32 vcc,v17,v19
s_and_b32 s64,vcc_lo,0xffff
s_cmp_eq_u32 s64,65535
s_cbranch_scc1 vfin_196
s_mov_b32 s65,0
v_readlane_b32 s64,v17,1
s_lshr_b32 s64,s64,8
s_add_u32 s65,s65,s64
v_readlane_b32 s64,v17,3
s_lshr_b32 s64,s64,8
s_add_u32 s65,s65,s64
v_readlane_b32 s64,v17,5
s_lshr_b32 s64,s64,8
s_add_u32 s65,s65,s64
v_readlane_b32 s64,v17,7
s_lshr_b32 s64,s64,8
s_add_u32 s65,s65,s64
v_readlane_b32 s64,v17,9
s_lshr_b32 s64,s64,8
s_add_u32 s65,s65,s64
v_readlane_b32 s64,v17,11
s_lshr_b32 s64,s64,8
s_add_u32 s65,s65,s64
v_readlane_b32 s64,v17,13
s_lshr_b32 s64,s64,8
s_add_u32 s65,s65,s64
v_readlane_b32 s64,v17,15
s_lshr_b32 s64,s64,8
s_add_u32 s65,s65,s64
s_cmp_ge_u32 s65,256
s_cbranch_scc1 fl_fb
vfin_196:
s_and_b32 s56,s56,1
s_mov_b32 s67,0
s_barrier
v_lshlrev_b32 v0,4,v1
s_mov_b32 s60,0
s_mov_b32 s70,0
s_mov_b32 s55,0
s_lshl_b32 s63,s50,13
v_mov_b32 v3,v0
s_mov_b32 s73,0xffff0000
s_lshl_b32 s64,s52,2
s_add_u32 s64,s64,s50
s_mul_i32 s61,s64,8192
s_add_u32 s61,s61,209747968
s_lshl_b32 s82,s64,8
s_add_u32 s82,s82,138549248
s_mov_b32 s68,s82
s_lshl_b32 s83,s53,2
s_add_u32 s83,s83,s50
s_xor_b32 s64,s50,0
s_lshl_b32 s64,s64,13
v_add_u32 v8,s64,v0
s_xor_b32 s64,s50,1
s_lshl_b32 s64,s64,13
v_add_u32 v9,s64,v0
s_xor_b32 s64,s50,2
s_lshl_b32 s64,s64,13
v_add_u32 v10,s64,v0
s_xor_b32 s64,s50,3
s_lshl_b32 s64,s64,13
v_add_u32 v11,s64,v0
v_min_u32 v2,7,v1
v_lshlrev_b32 v2,2,v2
s_lshr_b32 s64,s50,1
s_add_u32 s64,s64,1
s_sub_u32 s65,0,s64
s_bitcmp1_b32 s50,0
s_cselect_b32 s64,s64,s65
s_add_u32 s64,s64,16
v_add_u32 v26,s64,v21
v_lshrrev_b32 v27,4,v26
v_and_b32 v26,15,v26
v_lshl_add_u32 v26,v22,4,v26
v_lshlrev_b32 v26,4,v26
v_lshl_add_u32 v3,v27,15,v26
s_sub_u32 s61,s61,32768
s_lshl_b32 s66,s83,10
s_lshr_b32 s65,s83,3
s_lshl_b32 s65,s65,8
s_and_b32 s64,s83,7
s_lshl_b32 s64,s64,2
s_add_u32 s69,s64,s65
s_add_u32 s69,s69,138550272
s_add_u32 s71,s60,1
s_and_b32 s64,s50,1
s_add_u32 s71,s71,s64
s_min_u32 s71,s71,128
s_cmp_ge_u32 s60,128
s_cselect_b32 s71,-1,s71
plp_202:
buffer_load_dword v16,v2,s[20:23],s68 offen sc1
s_waitcnt vmcnt(0)
v_cmp_gt_u32 vcc,s71,v16
s_cbranch_vccz pok_203
s_sleep 4
s_sub_u32 s90,s90,1
s_cmp_gt_i32 s90,0
s_cbranch_scc1 plp_202
pok_203:
lag_201:
s_add_u32 m0,s70,s63
s_add_u32 s62,s61,4096
buffer_load_dwordx4 v3,s[20:23],s61 offen offset:0 lds
buffer_load_dwordx4 v3,s[20:23],s61 offen offset:1024 lds
buffer_load_dwordx4 v3,s[20:23],s61 offen offset:2048 lds
buffer_load_dwordx4 v3,s[20:23],s61 offen offset:3072 lds
s_add_u32 m0,m0,4096
s_nop 0
buffer_load_dwordx4 v3,s[20:23],s62 offen offset:0 lds
buffer_load_dwordx4 v3,s[20:23],s62 offen offset:1024 lds
buffer_load_dwordx4 v3,s[20:23],s62 offen offset:2048 lds
buffer_load_dwordx4 v3,s[20:23],s62 offen offset:3072 lds
s_add_u32 s61,s61,32768
s_add_u32 s70,s70,32768
s_and_b32 s70,s70,0x1ffff
buffer_load_dword v17,off,s[20:23],s69
top_197:
s_add_u32 s71,s60,2
s_and_b32 s64,s50,1
s_add_u32 s71,s71,s64
s_min_u32 s71,s71,128
s_cmp_ge_u32 s60,127
s_cselect_b32 s71,-1,s71
buffer_load_dword v16,v2,s[20:23],s68 offen sc1
s_add_u32 s64,s66,205520896
buffer_load_dwordx4 v[160:163],v0,s[20:23],s64 offen
v_add_u32 v4,s55,v8
v_add_u32 v5,s55,v9
v_add_u32 v6,s55,v10
v_add_u32 v7,s55,v11
s_add_u32 s55,s55,32768
s_and_b32 s55,s55,0x1ffff
s_waitcnt vmcnt(10)
ds_read_b128 v[64:67],v4 offset:0
s_waitcnt vmcnt(9)
ds_read_b128 v[68:71],v4 offset:1024
s_waitcnt vmcnt(8)
ds_read_b128 v[72:75],v4 offset:2048
s_waitcnt lgkmcnt(2)
v_mfma_f32_16x16x32_bf16 v[32:35],a[0:3],v[64:67],0
v_mfma_f32_16x16x32_bf16 v[36:39],a[4:7],v[64:67],0
s_waitcnt vmcnt(7)
ds_read_b128 v[76:79],v4 offset:3072
s_waitcnt lgkmcnt(2)
v_mfma_f32_16x16x32_bf16 v[32:35],a[8:11],v[68:71],v[32:35]
v_mfma_f32_16x16x32_bf16 v[36:39],a[12:15],v[68:71],v[36:39]
s_waitcnt vmcnt(6)
ds_read_b128 v[80:83],v4 offset:4096
s_waitcnt lgkmcnt(2)
v_mfma_f32_16x16x32_bf16 v[32:35],a[16:19],v[72:75],v[32:35]
v_mfma_f32_16x16x32_bf16 v[36:39],a[20:23],v[72:75],v[36:39]
s_waitcnt vmcnt(5)
ds_read_b128 v[84:87],v4 offset:5120
s_waitcnt lgkmcnt(2)
v_mfma_f32_16x16x32_bf16 v[32:35],a[24:27],v[76:79],v[32:35]
v_mfma_f32_16x16x32_bf16 v[36:39],a[28:31],v[76:79],v[36:39]
s_waitcnt vmcnt(4)
ds_read_b128 v[88:91],v4 offset:6144
s_waitcnt lgkmcnt(2)
v_mfma_f32_16x16x32_bf16 v[32:35],a[32:35],v[80:83],v[32:35]
v_mfma_f32_16x16x32_bf16 v[36:39],a[36:39],v[80:83],v[36:39]
s_waitcnt vmcnt(3)
ds_read_b128 v[92:95],v4 offset:7168
s_barrier
s_waitcnt lgkmcnt(2)
v_mfma_f32_16x16x32_bf16 v[32:35],a[40:43],v[84:87],v[32:35]
v_mfma_f32_16x16x32_bf16 v[36:39],a[44:47],v[84:87],v[36:39]
ds_read_b128 v[96:99],v5 offset:0
s_waitcnt lgkmcnt(2)
v_mfma_f32_16x16x32_bf16 v[32:35],a[48:51],v[88:91],v[32:35]
ds_read_b128 v[100:103],v5 offset:1024
ds_read_b128 v[104:107],v5 offset:2048
v_mfma_f32_16x16x32_bf16 v[36:39],a[52:55],v[88:91],v[36:39]
s_waitcnt lgkmcnt(3)
v_mfma_f32_16x16x32_bf16 v[32:35],a[56:59],v[92:95],v[32:35]
ds_read_b128 v[108:111],v5 offset:3072
ds_read_b128 v[112:115],v5 offset:4096
v_mfma_f32_16x16x32_bf16 v[36:39],a[60:63],v[92:95],v[36:39]
s_waitcnt lgkmcnt(4)
v_mfma_f32_16x16x32_bf16 v[32:35],a[64:67],v[96:99],v[32:35]
ds_read_b128 v[116:119],v5 offset:5120
ds_read_b128 v[120:123],v5 offset:6144
v_mfma_f32_16x16x32_bf16 v[36:39],a[68:71],v[96:99],v[36:39]
s_waitcnt lgkmcnt(5)
v_mfma_f32_16x16x32_bf16 v[32:35],a[72:75],v[100:103],v[32:35]
ds_read_b128 v[124:127],v5 offset:7168
v_mfma_f32_16x16x32_bf16 v[36:39],a[76:79],v[100:103],v[36:39]
s_waitcnt lgkmcnt(5)
v_mfma_f32_16x16x32_bf16 v[32:35],a[80:83],v[104:107],v[32:35]
ds_read_b128 v[64:67],v6 offset:0
v_mfma_f32_16x16x32_bf16 v[36:39],a[84:87],v[104:107],v[36:39]
s_waitcnt lgkmcnt(5)
v_mfma_f32_16x16x32_bf16 v[32:35],a[88:91],v[108:111],v[32:35]
ds_read_b128 v[68:71],v6 offset:1024
v_mfma_f32_16x16x32_bf16 v[36:39],a[92:95],v[108:111],v[36:39]
s_waitcnt lgkmcnt(5)
v_mfma_f32_16x16x32_bf16 v[32:35],a[96:99],v[112:115],v[32:35]
ds_read_b128 v[72:75],v6 offset:2048
v_mfma_f32_16x16x32_bf16 v[36:39],a[100:103],v[112:115],v[36:39]
s_waitcnt lgkmcnt(5)
v_mfma_f32_16x16x32_bf16 v[32:35],a[104:107],v[116:119],v[32:35]
ds_read_b128 v[76:79],v6 offset:3072
v_mfma_f32_16x16x32_bf16 v[36:39],a[108:111],v[116:119],v[36:39]
s_waitcnt lgkmcnt(5)
v_mfma_f32_16x16x32_bf16 v[32:35],a[112:115],v[120:123],v[32:35]
ds_read_b128 v[80:83],v6 offset:4096
v_mfma_f32_16x16x32_bf16 v[36:39],a[116:119],v[120:123],v[36:39]
s_waitcnt lgkmcnt(5)
v_mfma_f32_16x16x32_bf16 v[32:35],a[120:123],v[124:127],v[32:35]
ds_read_b128 v[84:87],v6 offset:5120
v_mfma_f32_16x16x32_bf16 v[36:39],a[124:127],v[124:127],v[36:39]
s_waitcnt lgkmcnt(5)
v_mfma_f32_16x16x32_bf16 v[32:35],a[128:131],v[64:67],v[32:35]
ds_read_b128 v[88:91],v6 offset:6144
v_mfma_f32_16x16x32_bf16 v[36:39],a[132:135],v[64:67],v[36:39]
s_waitcnt lgkmcnt(5)
v_mfma_f32_16x16x32_bf16 v[32:35],a[136:139],v[68:71],v[32:35]
ds_read_b128 v[92:95],v6 offset:7168
v_mfma_f32_16x16x32_bf16 v[36:39],a[140:143],v[68:71],v[36:39]
s_waitcnt lgkmcnt(5)
v_mfma_f32_16x16x32_bf16 v[32:35],a[144:147],v[72:75],v[32:35]
ds_read_b128 v[96:99],v7 offset:0
v_mfma_f32_16x16x32_bf16 v[36:39],a[148:151],v[72:75],v[36:39]
s_waitcnt lgkmcnt(5)
v_mfma_f32_16x16x32_bf16 v[32:35],a[152:155],v[76:79],v[32:35]
ds_read_b128 v[100:103],v7 offset:1024
v_mfma_f32_16x16x32_bf16 v[36:39],a[156:159],v[76:79],v[36:39]
s_waitcnt lgkmcnt(5)
v_mfma_f32_16x16x32_bf16 v[32:35],a[160:163],v[80:83],v[32:35]
ds_read_b128 v[104:107],v7 offset:2048
v_mfma_f32_16x16x32_bf16 v[36:39],a[164:167],v[80:83],v[36:39]
s_waitcnt lgkmcnt(5)
v_mfma_f32_16x16x32_bf16 v[32:35],a[168:171],v[84:87],v[32:35]
ds_read_b128 v[108:111],v7 offset:3072
v_mfma_f32_16x16x32_bf16 v[36:39],a[172:175],v[84:87],v[36:39]
s_waitcnt vmcnt(0)
v_mov_b32 v17,s60
s_mov_b64 exec,1
buffer_store_dword v17,off,s[20:23],s69 sc1
s_mov_b64 exec,-1
v_cmp_gt_u32 vcc,s71,v16
s_cbranch_vccnz vN_198
s_waitcnt lgkmcnt(5)
v_mfma_f32_16x16x32_bf16 v[32:35],a[176:179],v[88:91],v[32:35]
ds_read_b128 v[112:115],v7 offset:4096
s_add_u32 m0,s70,s63
v_mfma_f32_16x16x32_bf16 v[36:39],a[180:183],v[88:91],v[36:39]
s_add_u32 s62,s61,4096
s_waitcnt lgkmcnt(5)
v_mfma_f32_16x16x32_bf16 v[32:35],a[184:187],v[92:95],v[32:35]
ds_read_b128 v[116:119],v7 offset:5120
buffer_load_dwordx4 v3,s[20:23],s61 offen offset:0 lds
v_mfma_f32_16x16x32_bf16 v[36:39],a[188:191],v[92:95],v[36:39]
buffer_load_dwordx4 v3,s[20:23],s61 offen offset:1024 lds
s_waitcnt lgkmcnt(5)
v_mfma_f32_16x16x32_bf16 v[32:35],a[192:195],v[96:99],v[32:35]
ds_read_b128 v[120:123],v7 offset:6144
buffer_load_dwordx4 v3,s[20:23],s61 offen offset:2048 lds
v_mfma_f32_16x16x32_bf16 v[36:39],a[196:199],v[96:99],v[36:39]
buffer_load_dwordx4 v3,s[20:23],s61 offen offset:3072 lds
s_waitcnt lgkmcnt(5)
v_mfma_f32_16x16x32_bf16 v[32:35],a[200:203],v[100:103],v[32:35]
ds_read_b128 v[124:127],v7 offset:7168
s_add_u32 m0,m0,4096
v_mfma_f32_16x16x32_bf16 v[36:39],a[204:207],v[100:103],v[36:39]
buffer_load_dwordx4 v3,s[20:23],s62 offen offset:0 lds
s_waitcnt lgkmcnt(5)
v_mfma_f32_16x16x32_bf16 v[32:35],a[208:211],v[104:107],v[32:35]
buffer_load_dwordx4 v3,s[20:23],s62 offen offset:1024 lds
v_mfma_f32_16x16x32_bf16 v[36:39],a[212:215],v[104:107],v[36:39]
buffer_load_dwordx4 v3,s[20:23],s62 offen offset:2048 lds
s_waitcnt lgkmcnt(4)
v_mfma_f32_16x16x32_bf16 v[32:35],a[216:219],v[108:111],v[32:35]
buffer_load_dwordx4 v3,s[20:23],s62 offen offset:3072 lds
v_mfma_f32_16x16x32_bf16 v[36:39],a[220:223],v[108:111],v[36:39]
s_add_u32 s61,s61,32768
s_waitcnt lgkmcnt(3)
v_mfma_f32_16x16x32_bf16 v[32:35],a[224:227],v[112:115],v[32:35]
s_add_u32 s70,s70,32768
v_mfma_f32_16x16x32_bf16 v[36:39],a[228:231],v[112:115],v[36:39]
s_and_b32 s70,s70,0x1ffff
s_waitcnt lgkmcnt(2)
v_mfma_f32_16x16x32_bf16 v[32:35],a[232:235],v[116:119],v[32:35]
v_mfma_f32_16x16x32_bf16 v[36:39],a[236:239],v[116:119],v[36:39]
s_waitcnt lgkmcnt(1)
v_mfma_f32_16x16x32_bf16 v[32:35],a[240:243],v[120:123],v[32:35]
v_mfma_f32_16x16x32_bf16 v[36:39],a[244:247],v[120:123],v[36:39]
s_waitcnt lgkmcnt(0)
v_mfma_f32_16x16x32_bf16 v[32:35],a[248:251],v[124:127],v[32:35]
v_mfma_f32_16x16x32_bf16 v[36:39],a[252:255],v[124:127],v[36:39]
s_mov_b32 s72,1
join_199:
v_lshlrev_b32 v168,16,v160
v_and_b32 v169,s73,v160
v_lshlrev_b32 v170,16,v161
v_and_b32 v171,s73,v161
v_lshlrev_b32 v172,16,v162
v_and_b32 v173,s73,v162
v_lshlrev_b32 v174,16,v163
v_and_b32 v175,s73,v163
v_add_f32 v32,v32,v168
v_add_f32 v33,v33,v169
v_add_f32 v34,v34,v170
v_add_f32 v35,v35,v171
v_add_f32 v36,v36,v172
v_add_f32 v37,v37,v173
v_add_f32 v38,v38,v174
v_add_f32 v39,v39,v175
v_cvt_pk_bf16_f32 v176,v32,v33
v_cvt_pk_bf16_f32 v177,v34,v35
v_cvt_pk_bf16_f32 v178,v36,v37
v_cvt_pk_bf16_f32 v179,v38,v39
s_add_u32 s64,s66,214958080
buffer_store_dwordx4 v[176:179],v0,s[20:23],s64 offen sc1
s_add_u32 s66,s66,32768
s_add_u32 s60,s60,1
s_cmp_eq_u32 s72,0
s_cbranch_scc1 slowp_200
s_branch top_197
slowp_200:
s_waitcnt vmcnt(1)
v_cmp_gt_u32 vcc,s71,v16
s_cbranch_vccz lag_201
s_waitcnt vmcnt(0)
v_mov_b32 v17,s60
s_mov_b64 exec,1
buffer_store_dword v17,off,s[20:23],s69 sc1
s_mov_b64 exec,-1
s_cmp_ge_u32 s60,128
s_cbranch_scc1 done_190
plp_204:
buffer_load_dword v16,v2,s[20:23],s68 offen sc1
s_waitcnt vmcnt(0)
v_cmp_gt_u32 vcc,s71,v16
s_cbranch_vccz pok_205
s_sleep 4
s_sub_u32 s90,s90,1
s_cmp_gt_i32 s90,0
s_cbranch_scc1 plp_204
pok_205:
s_branch lag_201
vN_198:
buffer_load_dword v16,v2,s[20:23],s68 offen sc1
s_waitcnt lgkmcnt(5)
v_mfma_f32_16x16x32_bf16 v[32:35],a[176:179],v[88:91],v[32:35]
ds_read_b128 v[112:115],v7 offset:4096
v_mfma_f32_16x16x32_bf16 v[36:39],a[180:183],v[88:91],v[36:39]
s_waitcnt lgkmcnt(5)
v_mfma_f32_16x16x32_bf16 v[32:35],a[184:187],v[92:95],v[32:35]
ds_read_b128 v[116:119],v7 offset:5120
v_mfma_f32_16x16x32_bf16 v[36:39],a[188:191],v[92:95],v[36:39]
s_waitcnt lgkmcnt(5)
v_mfma_f32_16x16x32_bf16 v[32:35],a[192:195],v[96:99],v[32:35]
ds_read_b128 v[120:123],v7 offset:6144
v_mfma_f32_16x16x32_bf16 v[36:39],a[196:199],v[96:99],v[36:39]
s_waitcnt lgkmcnt(5)
v_mfma_f32_16x16x32_bf16 v[32:35],a[200:203],v[100:103],v[32:35]
ds_read_b128 v[124:127],v7 offset:7168
v_mfma_f32_16x16x32_bf16 v[36:39],a[204:207],v[100:103],v[36:39]
s_waitcnt lgkmcnt(5)
v_mfma_f32_16x16x32_bf16 v[32:35],a[208:211],v[104:107],v[32:35]
v_mfma_f32_16x16x32_bf16 v[36:39],a[212:215],v[104:107],v[36:39]
s_waitcnt lgkmcnt(4)
v_mfma_f32_16x16x32_bf16 v[32:35],a[216:219],v[108:111],v[32:35]
v_mfma_f32_16x16x32_bf16 v[36:39],a[220:223],v[108:111],v[36:39]
s_waitcnt lgkmcnt(3)
v_mfma_f32_16x16x32_bf16 v[32:35],a[224:227],v[112:115],v[32:35]
v_mfma_f32_16x16x32_bf16 v[36:39],a[228:231],v[112:115],v[36:39]
s_waitcnt lgkmcnt(2)
v_mfma_f32_16x16x32_bf16 v[32:35],a[232:235],v[116:119],v[32:35]
v_mfma_f32_16x16x32_bf16 v[36:39],a[236:239],v[116:119],v[36:39]
s_waitcnt lgkmcnt(1)
v_mfma_f32_16x16x32_bf16 v[32:35],a[240:243],v[120:123],v[32:35]
v_mfma_f32_16x16x32_bf16 v[36:39],a[244:247],v[120:123],v[36:39]
s_waitcnt lgkmcnt(0)
v_mfma_f32_16x16x32_bf16 v[32:35],a[248:251],v[124:127],v[32:35]
v_mfma_f32_16x16x32_bf16 v[36:39],a[252:255],v[124:127],v[36:39]
s_mov_b32 s72,0
s_branch join_199
done_190:
s_endpgm
fl_ln2:
s_mov_b32 s52,s59
s_mov_b32 s60,0
s_mov_b32 s73,0xffff0000
v_and_b32 v2,3,v1
v_lshrrev_b32 v3,2,v1
s_lshl_b32 s64,s52,2
v_add_u32 v4,s64,v2
s_lshl_b32 s65,s50,9
v_lshlrev_b32 v5,4,v3
v_add_u32 v5,s65,v5
v_lshl_add_u32 v8,v4,11,v5
v_lshlrev_b32 v9,1,v5
v_lshrrev_b32 v5,2,v3
v_and_b32 v3,3,v3
s_lshl_b32 s65,s50,13
v_lshlrev_b32 v5,10,v5
v_lshl_add_u32 v5,v3,8,v5
v_lshl_add_u32 v5,v4,4,v5
v_add_u32 v10,s65,v5
s_lshl_b32 s65,s50,9
v_lshlrev_b32 v5,3,v1
v_add_u32 v11,s65,v5
v_lshlrev_b32 v12,3,v2
v_and_b32 v13,7,v1
v_lshlrev_b32 v13,2,v13
s_mov_b32 s92,s2
s_and_b32 s93,s3,0xffff
s_mov_b32 s94,0x100
s_mov_b32 s95,0x20000
v_mbcnt_lo_u32_b32 v16,-1,0
v_mbcnt_hi_u32_b32 v16,-1,v16
v_mov_b32 v18,0
v_cmp_eq_u32 vcc,22,v16
s_nop 1
v_cndmask_b32 v18,v18,63,vcc
v_cmp_eq_u32 vcc,17,v16
s_nop 1
v_cndmask_b32 v18,v18,63,vcc
v_cmp_eq_u32 vcc,18,v16
s_nop 1
v_cndmask_b32 v18,v18,1,vcc
v_and_b32 v19,1,v16
v_cmp_eq_u32 vcc,1,v19
v_mov_b32 v19,8192
s_nop 0
v_cndmask_b32 v19,-1,v19,vcc
v_min_u32 v16,31,v16
v_lshlrev_b32 v16,2,v16
s_sub_u32 s66,s88,64
s_cmp_lg_u32 s50,0
s_cbranch_scc1 vot_211
vpoll_207:
buffer_load_dword v17,v16,s[92:95],s66 offen sc1
s_waitcnt vmcnt(0)
s_cmp_lg_u32 s56,2
s_cbranch_scc1 vck_208
v_cmp_eq_u32 vcc,v17,v19
s_and_b32 s64,vcc_lo,0xffff
s_cmp_eq_u32 s64,65535
s_cbranch_scc1 vck_208
s_mov_b32 s65,0
v_readlane_b32 s64,v17,1
s_lshr_b32 s64,s64,8
s_add_u32 s65,s65,s64
v_readlane_b32 s64,v17,3
s_lshr_b32 s64,s64,8
s_add_u32 s65,s65,s64
v_readlane_b32 s64,v17,5
s_lshr_b32 s64,s64,8
s_add_u32 s65,s65,s64
v_readlane_b32 s64,v17,7
s_lshr_b32 s64,s64,8
s_add_u32 s65,s65,s64
v_readlane_b32 s64,v17,9
s_lshr_b32 s64,s64,8
s_add_u32 s65,s65,s64
v_readlane_b32 s64,v17,11
s_lshr_b32 s64,s64,8
s_add_u32 s65,s65,s64
v_readlane_b32 s64,v17,13
s_lshr_b32 s64,s64,8
s_add_u32 s65,s65,s64
v_readlane_b32 s64,v17,15
s_lshr_b32 s64,s64,8
s_add_u32 s65,s65,s64
s_cmp_ge_u32 s65,256
s_cbranch_scc1 vok_210
s_branch vrt_209
vck_208:
v_cmp_gt_u32 vcc,v18,v17
s_cbranch_vccz vok_210
vrt_209:
s_sleep 48
s_sub_u32 s90,s90,1
s_cmp_gt_i32 s90,0
s_cbranch_scc1 vpoll_207
vok_210:
v_add_u32 v18,161024,v16
ds_write_b32 v18,v17
s_waitcnt lgkmcnt(0)
vot_211:
s_barrier
v_add_u32 v18,161024,v16
ds_read_b32 v17,v18
s_waitcnt lgkmcnt(0)
s_cmp_lg_u32 s56,2
s_cbranch_scc1 vfin_212
v_cmp_eq_u32 vcc,v17,v19
s_and_b32 s64,vcc_lo,0xffff
s_cmp_eq_u32 s64,65535
s_cbranch_scc1 vfin_212
s_mov_b32 s65,0
v_readlane_b32 s64,v17,1
s_lshr_b32 s64,s64,8
s_add_u32 s65,s65,s64
v_readlane_b32 s64,v17,3
s_lshr_b32 s64,s64,8
s_add_u32 s65,s65,s64
v_readlane_b32 s64,v17,5
s_lshr_b32 s64,s64,8
s_add_u32 s65,s65,s64
v_readlane_b32 s64,v17,7
s_lshr_b32 s64,s64,8
s_add_u32 s65,s65,s64
v_readlane_b32 s64,v17,9
s_lshr_b32 s64,s64,8
s_add_u32 s65,s65,s64
v_readlane_b32 s64,v17,11
s_lshr_b32 s64,s64,8
s_add_u32 s65,s65,s64
v_readlane_b32 s64,v17,13
s_lshr_b32 s64,s64,8
s_add_u32 s65,s65,s64
v_readlane_b32 s64,v17,15
s_lshr_b32 s64,s64,8
s_add_u32 s65,s65,s64
s_cmp_ge_u32 s65,256
s_cbranch_scc1 fl_fb
vfin_212:
s_and_b32 s56,s56,1
s_mov_b32 s67,0
s_mov_b32 s64,267403264
buffer_load_dwordx4 v[32:35],v9,s[20:23],s64 offen offset:0 sc1
buffer_load_dwordx4 v[36:39],v9,s[20:23],s64 offen offset:16 sc1
buffer_load_dwordx4 v[40:43],v9,s[20:23],s64 offen offset:512 sc1
buffer_load_dwordx4 v[44:47],v9,s[20:23],s64 offen offset:528 sc1
s_mov_b32 s64,267427840
buffer_load_dwordx4 v[64:67],v9,s[20:23],s64 offen offset:0 sc1
buffer_load_dwordx4 v[68:71],v9,s[20:23],s64 offen offset:16 sc1
buffer_load_dwordx4 v[72:75],v9,s[20:23],s64 offen offset:512 sc1
buffer_load_dwordx4 v[76:79],v9,s[20:23],s64 offen offset:528 sc1
s_mov_b32 s64,267452416
buffer_load_dwordx4 v[80:83],v9,s[20:23],s64 offen offset:0 sc1
buffer_load_dwordx4 v[84:87],v9,s[20:23],s64 offen offset:16 sc1
buffer_load_dwordx4 v[88:91],v9,s[20:23],s64 offen offset:512 sc1
buffer_load_dwordx4 v[92:95],v9,s[20:23],s64 offen offset:528 sc1
s_mov_b32 s64,267476992
buffer_load_dwordx4 v[96:99],v9,s[20:23],s64 offen offset:0 sc1
buffer_load_dwordx4 v[100:103],v9,s[20:23],s64 offen offset:16 sc1
buffer_load_dwordx4 v[104:107],v9,s[20:23],s64 offen offset:512 sc1
buffer_load_dwordx4 v[108:111],v9,s[20:23],s64 offen offset:528 sc1
s_waitcnt vmcnt(0)
v_pk_add_f32 v[32:33],v[32:33],v[64:65]
v_pk_add_f32 v[80:81],v[80:81],v[96:97]
v_pk_add_f32 v[34:35],v[34:35],v[66:67]
v_pk_add_f32 v[82:83],v[82:83],v[98:99]
v_pk_add_f32 v[36:37],v[36:37],v[68:69]
v_pk_add_f32 v[84:85],v[84:85],v[100:101]
v_pk_add_f32 v[38:39],v[38:39],v[70:71]
v_pk_add_f32 v[86:87],v[86:87],v[102:103]
v_pk_add_f32 v[40:41],v[40:41],v[72:73]
v_pk_add_f32 v[88:89],v[88:89],v[104:105]
v_pk_add_f32 v[42:43],v[42:43],v[74:75]
v_pk_add_f32 v[90:91],v[90:91],v[106:107]
v_pk_add_f32 v[44:45],v[44:45],v[76:77]
v_pk_add_f32 v[92:93],v[92:93],v[108:109]
v_pk_add_f32 v[46:47],v[46:47],v[78:79]
v_pk_add_f32 v[94:95],v[94:95],v[110:111]
v_pk_add_f32 v[32:33],v[32:33],v[80:81]
v_pk_add_f32 v[34:35],v[34:35],v[82:83]
v_pk_add_f32 v[36:37],v[36:37],v[84:85]
v_pk_add_f32 v[38:39],v[38:39],v[86:87]
v_pk_add_f32 v[40:41],v[40:41],v[88:89]
v_pk_add_f32 v[42:43],v[42:43],v[90:91]
v_pk_add_f32 v[44:45],v[44:45],v[92:93]
v_pk_add_f32 v[46:47],v[46:47],v[94:95]
v_cvt_pk_bf16_f32 v64,v32,v33
v_cvt_pk_bf16_f32 v65,v34,v35
v_cvt_pk_bf16_f32 v66,v36,v37
v_cvt_pk_bf16_f32 v67,v38,v39
v_cvt_pk_bf16_f32 v68,v40,v41
v_cvt_pk_bf16_f32 v69,v42,v43
v_cvt_pk_bf16_f32 v70,v44,v45
v_cvt_pk_bf16_f32 v71,v46,v47
v_lshlrev_b32 v32,16,v64
v_and_b32 v33,s73,v64
v_lshlrev_b32 v34,16,v65
v_and_b32 v35,s73,v65
v_lshlrev_b32 v36,16,v66
v_and_b32 v37,s73,v66
v_lshlrev_b32 v38,16,v67
v_and_b32 v39,s73,v67
v_lshlrev_b32 v40,16,v68
v_and_b32 v41,s73,v68
v_lshlrev_b32 v42,16,v69
v_and_b32 v43,s73,v69
v_lshlrev_b32 v44,16,v70
v_and_b32 v45,s73,v70
v_lshlrev_b32 v46,16,v71
v_and_b32 v47,s73,v71
v_add_f32 v32,1.0,v32
v_add_f32 v33,1.0,v33
v_add_f32 v34,1.0,v34
v_add_f32 v35,1.0,v35
v_add_f32 v36,1.0,v36
v_add_f32 v37,1.0,v37
v_add_f32 v38,1.0,v38
v_add_f32 v39,1.0,v39
v_add_f32 v40,1.0,v40
v_add_f32 v41,1.0,v41
v_add_f32 v42,1.0,v42
v_add_f32 v43,1.0,v43
v_add_f32 v44,1.0,v44
v_add_f32 v45,1.0,v45
v_add_f32 v46,1.0,v46
v_add_f32 v47,1.0,v47
s_mov_b32 s64,267399168
buffer_load_dwordx4 v[48:51],v9,s[20:23],s64 offen offset:0 sc1
buffer_load_dwordx4 v[52:55],v9,s[20:23],s64 offen offset:16 sc1
buffer_load_dwordx4 v[56:59],v9,s[20:23],s64 offen offset:512 sc1
buffer_load_dwordx4 v[60:63],v9,s[20:23],s64 offen offset:528 sc1
s_mov_b32 s64,267423744
buffer_load_dwordx4 v[64:67],v9,s[20:23],s64 offen offset:0 sc1
buffer_load_dwordx4 v[68:71],v9,s[20:23],s64 offen offset:16 sc1
buffer_load_dwordx4 v[72:75],v9,s[20:23],s64 offen offset:512 sc1
buffer_load_dwordx4 v[76:79],v9,s[20:23],s64 offen offset:528 sc1
s_mov_b32 s64,267448320
buffer_load_dwordx4 v[80:83],v9,s[20:23],s64 offen offset:0 sc1
buffer_load_dwordx4 v[84:87],v9,s[20:23],s64 offen offset:16 sc1
buffer_load_dwordx4 v[88:91],v9,s[20:23],s64 offen offset:512 sc1
buffer_load_dwordx4 v[92:95],v9,s[20:23],s64 offen offset:528 sc1
s_mov_b32 s64,267472896
buffer_load_dwordx4 v[96:99],v9,s[20:23],s64 offen offset:0 sc1
buffer_load_dwordx4 v[100:103],v9,s[20:23],s64 offen offset:16 sc1
buffer_load_dwordx4 v[104:107],v9,s[20:23],s64 offen offset:512 sc1
buffer_load_dwordx4 v[108:111],v9,s[20:23],s64 offen offset:528 sc1
s_waitcnt vmcnt(0)
v_pk_add_f32 v[48:49],v[48:49],v[64:65]
v_pk_add_f32 v[80:81],v[80:81],v[96:97]
v_pk_add_f32 v[50:51],v[50:51],v[66:67]
v_pk_add_f32 v[82:83],v[82:83],v[98:99]
v_pk_add_f32 v[52:53],v[52:53],v[68:69]
v_pk_add_f32 v[84:85],v[84:85],v[100:101]
v_pk_add_f32 v[54:55],v[54:55],v[70:71]
v_pk_add_f32 v[86:87],v[86:87],v[102:103]
v_pk_add_f32 v[56:57],v[56:57],v[72:73]
v_pk_add_f32 v[88:89],v[88:89],v[104:105]
v_pk_add_f32 v[58:59],v[58:59],v[74:75]
v_pk_add_f32 v[90:91],v[90:91],v[106:107]
v_pk_add_f32 v[60:61],v[60:61],v[76:77]
v_pk_add_f32 v[92:93],v[92:93],v[108:109]
v_pk_add_f32 v[62:63],v[62:63],v[78:79]
v_pk_add_f32 v[94:95],v[94:95],v[110:111]
v_pk_add_f32 v[48:49],v[48:49],v[80:81]
v_pk_add_f32 v[50:51],v[50:51],v[82:83]
v_pk_add_f32 v[52:53],v[52:53],v[84:85]
v_pk_add_f32 v[54:55],v[54:55],v[86:87]
v_pk_add_f32 v[56:57],v[56:57],v[88:89]
v_pk_add_f32 v[58:59],v[58:59],v[90:91]
v_pk_add_f32 v[60:61],v[60:61],v[92:93]
v_pk_add_f32 v[62:63],v[62:63],v[94:95]
v_cvt_pk_bf16_f32 v64,v48,v49
v_cvt_pk_bf16_f32 v65,v50,v51
v_cvt_pk_bf16_f32 v66,v52,v53
v_cvt_pk_bf16_f32 v67,v54,v55
v_cvt_pk_bf16_f32 v68,v56,v57
v_cvt_pk_bf16_f32 v69,v58,v59
v_cvt_pk_bf16_f32 v70,v60,v61
v_cvt_pk_bf16_f32 v71,v62,v63
v_lshlrev_b32 v48,16,v64
v_and_b32 v49,s73,v64
v_lshlrev_b32 v50,16,v65
v_and_b32 v51,s73,v65
v_lshlrev_b32 v52,16,v66
v_and_b32 v53,s73,v66
v_lshlrev_b32 v54,16,v67
v_and_b32 v55,s73,v67
v_lshlrev_b32 v56,16,v68
v_and_b32 v57,s73,v68
v_lshlrev_b32 v58,16,v69
v_and_b32 v59,s73,v69
v_lshlrev_b32 v60,16,v70
v_and_b32 v61,s73,v70
v_lshlrev_b32 v62,16,v71
v_and_b32 v63,s73,v71
s_mov_b32 s63,201326592
s_mov_b32 s66,205520896
s_lshl_b32 s64,s50,8
s_add_u32 s68,s64,138547200
s_lshl_b32 s65,s59,2
s_add_u32 s69,s64,s65
s_add_u32 s69,s69,138548224
s_mov_b32 s71,1
plp_215:
buffer_load_dword v14,v13,s[20:23],s68 offen sc1
s_waitcnt vmcnt(0)
v_cmp_gt_u32 vcc,s71,v14
s_cbranch_vccz pok_216
s_sleep 4
s_sub_u32 s90,s90,1
s_cmp_gt_i32 s90,0
s_cbranch_scc1 plp_215
pok_216:
s_add_u32 s64,s63,4096
buffer_load_dwordx4 v[64:67],v10,s[20:23],s63 offen
buffer_load_dwordx4 v[68:71],v10,s[20:23],s64 offen
s_add_u32 s63,s63,32768
buffer_load_dword v15,off,s[20:23],s68
buffer_load_dword v15,off,s[20:23],s68
top0_213:
buffer_load_dword v14,v13,s[20:23],s68 offen sc1
s_add_u32 s71,s60,2
s_waitcnt vmcnt(3)
v_lshlrev_b32 v80,16,v64
v_and_b32 v81,s73,v64
v_lshlrev_b32 v82,16,v65
v_and_b32 v83,s73,v65
v_lshlrev_b32 v84,16,v66
v_and_b32 v85,s73,v66
v_lshlrev_b32 v86,16,v67
v_and_b32 v87,s73,v67
v_lshlrev_b32 v88,16,v68
v_and_b32 v89,s73,v68
v_lshlrev_b32 v90,16,v69
v_and_b32 v91,s73,v69
v_lshlrev_b32 v92,16,v70
v_and_b32 v93,s73,v70
v_lshlrev_b32 v94,16,v71
v_and_b32 v95,s73,v71
v_add_f32 v96,v80,v81
v_mul_f32 v97,v80,v80
v_add_f32 v98,v82,v83
v_mul_f32 v99,v81,v81
v_fmac_f32 v97,v82,v82
v_fmac_f32 v99,v83,v83
v_add_f32 v96,v96,v84
v_fmac_f32 v97,v84,v84
v_add_f32 v98,v98,v85
v_fmac_f32 v99,v85,v85
v_add_f32 v96,v96,v86
v_fmac_f32 v97,v86,v86
v_add_f32 v98,v98,v87
v_fmac_f32 v99,v87,v87
v_add_f32 v96,v96,v88
v_fmac_f32 v97,v88,v88
v_add_f32 v98,v98,v89
v_fmac_f32 v99,v89,v89
v_add_f32 v96,v96,v90
v_fmac_f32 v97,v90,v90
v_add_f32 v98,v98,v91
v_fmac_f32 v99,v91,v91
v_add_f32 v96,v96,v92
v_fmac_f32 v97,v92,v92
v_add_f32 v98,v98,v93
v_fmac_f32 v99,v93,v93
v_add_f32 v96,v96,v94
v_fmac_f32 v97,v94,v94
v_add_f32 v98,v98,v95
v_fmac_f32 v99,v95,v95
v_add_f32 v96,v96,v98
v_add_f32 v97,v97,v99
s_nop 0
v_add_f32_dpp v96,v96,v96 row_ror:4 row_mask:0xf bank_mask:0xf
v_add_f32_dpp v97,v97,v97 row_ror:4 row_mask:0xf bank_mask:0xf
s_nop 0
v_add_f32_dpp v96,v96,v96 row_ror:8 row_mask:0xf bank_mask:0xf
v_add_f32_dpp v97,v97,v97 row_ror:8 row_mask:0xf bank_mask:0xf
v_mov_b32 v98,v96
v_mov_b32 v99,v97
s_nop 0
v_permlane16_swap_b32 v98,v96
v_permlane16_swap_b32 v99,v97
v_add_f32 v96,v96,v98
v_add_f32 v97,v97,v99
v_mov_b32 v98,v96
v_mov_b32 v99,v97
s_nop 0
v_permlane32_swap_b32 v98,v96
v_permlane32_swap_b32 v99,v97
v_add_f32 v96,v96,v98
v_add_f32 v97,v97,v99
ds_write_b64 v11,v[96:97] offset:0
s_waitcnt lgkmcnt(0)
s_barrier
s_waitcnt vmcnt(0)
v_mov_b32 v15,s60
s_mov_b64 exec,1
buffer_store_dword v15,off,s[20:23],s69 sc1
s_mov_b64 exec,-1
v_cmp_gt_u32 vcc,s71,v14
s_mov_b32 s72,0
s_cbranch_vccnz p2_218
s_mov_b32 s72,1
s_add_u32 s64,s63,4096
buffer_load_dwordx4 v[72:75],v10,s[20:23],s63 offen
buffer_load_dwordx4 v[76:79],v10,s[20:23],s64 offen
s_add_u32 s63,s63,32768
p2_218:
ds_read_b64 v[100:101],v12 offset:0
ds_read_b64 v[102:103],v12 offset:512
ds_read_b64 v[104:105],v12 offset:1024
ds_read_b64 v[106:107],v12 offset:1536
s_waitcnt lgkmcnt(0)
v_add_f32 v100,v100,v102
v_add_f32 v101,v101,v103
v_add_f32 v104,v104,v106
v_add_f32 v105,v105,v107
v_add_f32 v100,v100,v104
v_add_f32 v101,v101,v105
v_mul_f32 v96,0xba800000,v100
v_mul_f32 v102,v96,v96
v_mul_f32 v101,0x3a800000,v101
v_sub_f32 v101,v101,v102
v_max_f32 v101,0,v101
v_add_f32 v101,0x3727c5ac,v101
v_rsq_f32 v97,v101
s_nop 0
v_mul_f32 v96,v96,v97
v_fma_f32 v80,v80,v97,v96
v_fma_f32 v81,v81,v97,v96
v_fma_f32 v82,v82,v97,v96
v_fma_f32 v83,v83,v97,v96
v_fma_f32 v84,v84,v97,v96
v_fma_f32 v85,v85,v97,v96
v_fma_f32 v86,v86,v97,v96
v_fma_f32 v87,v87,v97,v96
v_fma_f32 v88,v88,v97,v96
v_fma_f32 v89,v89,v97,v96
v_fma_f32 v90,v90,v97,v96
v_fma_f32 v91,v91,v97,v96
v_fma_f32 v92,v92,v97,v96
v_fma_f32 v93,v93,v97,v96
v_fma_f32 v94,v94,v97,v96
v_fma_f32 v95,v95,v97,v96
v_fma_f32 v80,v80,v32,v48
v_fma_f32 v81,v81,v33,v49
v_fma_f32 v82,v82,v34,v50
v_fma_f32 v83,v83,v35,v51
v_fma_f32 v84,v84,v36,v52
v_fma_f32 v85,v85,v37,v53
v_fma_f32 v86,v86,v38,v54
v_fma_f32 v87,v87,v39,v55
v_fma_f32 v88,v88,v40,v56
v_fma_f32 v89,v89,v41,v57
v_fma_f32 v90,v90,v42,v58
v_fma_f32 v91,v91,v43,v59
v_fma_f32 v92,v92,v44,v60
v_fma_f32 v93,v93,v45,v61
v_fma_f32 v94,v94,v46,v62
v_fma_f32 v95,v95,v47,v63
v_cvt_pk_bf16_f32 v112,v80,v81
v_cvt_pk_bf16_f32 v113,v82,v83
v_cvt_pk_bf16_f32 v114,v84,v85
v_cvt_pk_bf16_f32 v115,v86,v87
v_cvt_pk_bf16_f32 v116,v88,v89
v_cvt_pk_bf16_f32 v117,v90,v91
v_cvt_pk_bf16_f32 v118,v92,v93
v_cvt_pk_bf16_f32 v119,v94,v95
s_add_u32 s64,s66,4096
buffer_store_dwordx4 v[112:115],v10,s[20:23],s66 offen sc1
buffer_store_dwordx4 v[116:119],v10,s[20:23],s64 offen sc1
s_add_u32 s66,s66,32768
s_add_u32 s60,s60,1
s_cmp_eq_u32 s72,0
s_cbranch_scc1 slowp_217
top1_214:
buffer_load_dword v14,v13,s[20:23],s68 offen sc1
s_add_u32 s71,s60,2
s_waitcnt vmcnt(3)
v_lshlrev_b32 v80,16,v72
v_and_b32 v81,s73,v72
v_lshlrev_b32 v82,16,v73
v_and_b32 v83,s73,v73
v_lshlrev_b32 v84,16,v74
v_and_b32 v85,s73,v74
v_lshlrev_b32 v86,16,v75
v_and_b32 v87,s73,v75
v_lshlrev_b32 v88,16,v76
v_and_b32 v89,s73,v76
v_lshlrev_b32 v90,16,v77
v_and_b32 v91,s73,v77
v_lshlrev_b32 v92,16,v78
v_and_b32 v93,s73,v78
v_lshlrev_b32 v94,16,v79
v_and_b32 v95,s73,v79
v_add_f32 v96,v80,v81
v_mul_f32 v97,v80,v80
v_add_f32 v98,v82,v83
v_mul_f32 v99,v81,v81
v_fmac_f32 v97,v82,v82
v_fmac_f32 v99,v83,v83
v_add_f32 v96,v96,v84
v_fmac_f32 v97,v84,v84
v_add_f32 v98,v98,v85
v_fmac_f32 v99,v85,v85
v_add_f32 v96,v96,v86
v_fmac_f32 v97,v86,v86
v_add_f32 v98,v98,v87
v_fmac_f32 v99,v87,v87
v_add_f32 v96,v96,v88
v_fmac_f32 v97,v88,v88
v_add_f32 v98,v98,v89
v_fmac_f32 v99,v89,v89
v_add_f32 v96,v96,v90
v_fmac_f32 v97,v90,v90
v_add_f32 v98,v98,v91
v_fmac_f32 v99,v91,v91
v_add_f32 v96,v96,v92
v_fmac_f32 v97,v92,v92
v_add_f32 v98,v98,v93
v_fmac_f32 v99,v93,v93
v_add_f32 v96,v96,v94
v_fmac_f32 v97,v94,v94
v_add_f32 v98,v98,v95
v_fmac_f32 v99,v95,v95
v_add_f32 v96,v96,v98
v_add_f32 v97,v97,v99
s_nop 0
v_add_f32_dpp v96,v96,v96 row_ror:4 row_mask:0xf bank_mask:0xf
v_add_f32_dpp v97,v97,v97 row_ror:4 row_mask:0xf bank_mask:0xf
s_nop 0
v_add_f32_dpp v96,v96,v96 row_ror:8 row_mask:0xf bank_mask:0xf
v_add_f32_dpp v97,v97,v97 row_ror:8 row_mask:0xf bank_mask:0xf
v_mov_b32 v98,v96
v_mov_b32 v99,v97
s_nop 0
v_permlane16_swap_b32 v98,v96
v_permlane16_swap_b32 v99,v97
v_add_f32 v96,v96,v98
v_add_f32 v97,v97,v99
v_mov_b32 v98,v96
v_mov_b32 v99,v97
s_nop 0
v_permlane32_swap_b32 v98,v96
v_permlane32_swap_b32 v99,v97
v_add_f32 v96,v96,v98
v_add_f32 v97,v97,v99
ds_write_b64 v11,v[96:97] offset:2048
s_waitcnt lgkmcnt(0)
s_barrier
s_waitcnt vmcnt(0)
v_mov_b32 v15,s60
s_mov_b64 exec,1
buffer_store_dword v15,off,s[20:23],s69 sc1
s_mov_b64 exec,-1
v_cmp_gt_u32 vcc,s71,v14
s_mov_b32 s72,0
s_cbranch_vccnz p2_220
s_mov_b32 s72,1
s_add_u32 s64,s63,4096
buffer_load_dwordx4 v[64:67],v10,s[20:23],s63 offen
buffer_load_dwordx4 v[68:71],v10,s[20:23],s64 offen
s_add_u32 s63,s63,32768
p2_220:
ds_read_b64 v[100:101],v12 offset:2048
ds_read_b64 v[102:103],v12 offset:2560
ds_read_b64 v[104:105],v12 offset:3072
ds_read_b64 v[106:107],v12 offset:3584
s_waitcnt lgkmcnt(0)
v_add_f32 v100,v100,v102
v_add_f32 v101,v101,v103
v_add_f32 v104,v104,v106
v_add_f32 v105,v105,v107
v_add_f32 v100,v100,v104
v_add_f32 v101,v101,v105
v_mul_f32 v96,0xba800000,v100
v_mul_f32 v102,v96,v96
v_mul_f32 v101,0x3a800000,v101
v_sub_f32 v101,v101,v102
v_max_f32 v101,0,v101
v_add_f32 v101,0x3727c5ac,v101
v_rsq_f32 v97,v101
s_nop 0
v_mul_f32 v96,v96,v97
v_fma_f32 v80,v80,v97,v96
v_fma_f32 v81,v81,v97,v96
v_fma_f32 v82,v82,v97,v96
v_fma_f32 v83,v83,v97,v96
v_fma_f32 v84,v84,v97,v96
v_fma_f32 v85,v85,v97,v96
v_fma_f32 v86,v86,v97,v96
v_fma_f32 v87,v87,v97,v96
v_fma_f32 v88,v88,v97,v96
v_fma_f32 v89,v89,v97,v96
v_fma_f32 v90,v90,v97,v96
v_fma_f32 v91,v91,v97,v96
v_fma_f32 v92,v92,v97,v96
v_fma_f32 v93,v93,v97,v96
v_fma_f32 v94,v94,v97,v96
v_fma_f32 v95,v95,v97,v96
v_fma_f32 v80,v80,v32,v48
v_fma_f32 v81,v81,v33,v49
v_fma_f32 v82,v82,v34,v50
v_fma_f32 v83,v83,v35,v51
v_fma_f32 v84,v84,v36,v52
v_fma_f32 v85,v85,v37,v53
v_fma_f32 v86,v86,v38,v54
v_fma_f32 v87,v87,v39,v55
v_fma_f32 v88,v88,v40,v56
v_fma_f32 v89,v89,v41,v57
v_fma_f32 v90,v90,v42,v58
v_fma_f32 v91,v91,v43,v59
v_fma_f32 v92,v92,v44,v60
v_fma_f32 v93,v93,v45,v61
v_fma_f32 v94,v94,v46,v62
v_fma_f32 v95,v95,v47,v63
v_cvt_pk_bf16_f32 v112,v80,v81
v_cvt_pk_bf16_f32 v113,v82,v83
v_cvt_pk_bf16_f32 v114,v84,v85
v_cvt_pk_bf16_f32 v115,v86,v87
v_cvt_pk_bf16_f32 v116,v88,v89
v_cvt_pk_bf16_f32 v117,v90,v91
v_cvt_pk_bf16_f32 v118,v92,v93
v_cvt_pk_bf16_f32 v119,v94,v95
s_add_u32 s64,s66,4096
buffer_store_dwordx4 v[112:115],v10,s[20:23],s66 offen sc1
buffer_store_dwordx4 v[116:119],v10,s[20:23],s64 offen sc1
s_add_u32 s66,s66,32768
s_add_u32 s60,s60,1
s_cmp_eq_u32 s72,0
s_cbranch_scc1 slowp_219
s_branch top0_213
slowp_217:
buffer_load_dword v14,v13,s[20:23],s68 offen sc1
s_waitcnt vmcnt(1)
v_mov_b32 v15,s60
s_mov_b64 exec,1
buffer_store_dword v15,off,s[20:23],s69 sc1
s_mov_b64 exec,-1
s_cmp_ge_u32 s60,128
s_cbranch_scc1 done_206
s_waitcnt vmcnt(1)
v_cmp_gt_u32 vcc,s71,v14
s_cbranch_vccz go_221
plp_222:
buffer_load_dword v14,v13,s[20:23],s68 offen sc1
s_waitcnt vmcnt(0)
v_cmp_gt_u32 vcc,s71,v14
s_cbranch_vccz pok_223
s_sleep 4
s_sub_u32 s90,s90,1
s_cmp_gt_i32 s90,0
s_cbranch_scc1 plp_222
pok_223:
go_221:
s_add_u32 s64,s63,4096
buffer_load_dwordx4 v[72:75],v10,s[20:23],s63 offen
buffer_load_dwordx4 v[76:79],v10,s[20:23],s64 offen
s_add_u32 s63,s63,32768
buffer_load_dword v15,off,s[20:23],s68
buffer_load_dword v15,off,s[20:23],s68
s_branch top1_214
slowp_219:
buffer_load_dword v14,v13,s[20:23],s68 offen sc1
s_waitcnt vmcnt(1)
v_mov_b32 v15,s60
s_mov_b64 exec,1
buffer_store_dword v15,off,s[20:23],s69 sc1
s_mov_b64 exec,-1
s_cmp_ge_u32 s60,128
s_cbranch_scc1 done_206
s_waitcnt vmcnt(1)
v_cmp_gt_u32 vcc,s71,v14
s_cbranch_vccz go_224
plp_225:
buffer_load_dword v14,v13,s[20:23],s68 offen sc1
s_waitcnt vmcnt(0)
v_cmp_gt_u32 vcc,s71,v14
s_cbranch_vccz pok_226
s_sleep 4
s_sub_u32 s90,s90,1
s_cmp_gt_i32 s90,0
s_cbranch_scc1 plp_225
pok_226:
go_224:
s_add_u32 s64,s63,4096
buffer_load_dwordx4 v[64:67],v10,s[20:23],s63 offen
buffer_load_dwordx4 v[68:71],v10,s[20:23],s64 offen
s_add_u32 s63,s63,32768
buffer_load_dword v15,off,s[20:23],s68
buffer_load_dword v15,off,s[20:23],s68
s_branch top0_213
done_206:
s_endpgm
fl_att:
s_mov_b32 s92,s2
s_and_b32 s93,s3,0xffff
s_mov_b32 s94,0x100
s_mov_b32 s95,0x20000
v_mbcnt_lo_u32_b32 v16,-1,0
v_mbcnt_hi_u32_b32 v16,-1,v16
v_mov_b32 v18,0
v_cmp_eq_u32 vcc,22,v16
s_nop 1
v_cndmask_b32 v18,v18,63,vcc
v_cmp_eq_u32 vcc,21,v16
s_nop 1
v_cndmask_b32 v18,v18,1,vcc
v_and_b32 v19,1,v16
v_cmp_eq_u32 vcc,1,v19
v_mov_b32 v19,8192
s_nop 0
v_cndmask_b32 v19,-1,v19,vcc
v_min_u32 v16,31,v16
v_lshlrev_b32 v16,2,v16
s_sub_u32 s66,s88,64
s_cmp_lg_u32 s50,0
s_cbranch_scc1 vot_231
vpoll_227:
buffer_load_dword v17,v16,s[92:95],s66 offen sc1
s_waitcnt vmcnt(0)
s_cmp_lg_u32 s56,2
s_cbranch_scc1 vck_228
v_cmp_eq_u32 vcc,v17,v19
s_and_b32 s64,vcc_lo,0xffff
s_cmp_eq_u32 s64,65535
s_cbranch_scc1 vck_228
s_mov_b32 s65,0
v_readlane_b32 s64,v17,1
s_lshr_b32 s64,s64,8
s_add_u32 s65,s65,s64
v_readlane_b32 s64,v17,3
s_lshr_b32 s64,s64,8
s_add_u32 s65,s65,s64
v_readlane_b32 s64,v17,5
s_lshr_b32 s64,s64,8
s_add_u32 s65,s65,s64
v_readlane_b32 s64,v17,7
s_lshr_b32 s64,s64,8
s_add_u32 s65,s65,s64
v_readlane_b32 s64,v17,9
s_lshr_b32 s64,s64,8
s_add_u32 s65,s65,s64
v_readlane_b32 s64,v17,11
s_lshr_b32 s64,s64,8
s_add_u32 s65,s65,s64
v_readlane_b32 s64,v17,13
s_lshr_b32 s64,s64,8
s_add_u32 s65,s65,s64
v_readlane_b32 s64,v17,15
s_lshr_b32 s64,s64,8
s_add_u32 s65,s65,s64
s_cmp_ge_u32 s65,256
s_cbranch_scc1 vok_230
s_branch vrt_229
vck_228:
v_cmp_gt_u32 vcc,v18,v17
s_cbranch_vccz vok_230
vrt_229:
s_sleep 8
s_sub_u32 s90,s90,1
s_cmp_gt_i32 s90,0
s_cbranch_scc1 vpoll_227
vok_230:
v_add_u32 v18,161280,v16
ds_write_b32 v18,v17
s_waitcnt lgkmcnt(0)
vot_231:
s_barrier
v_add_u32 v18,161280,v16
ds_read_b32 v17,v18
s_waitcnt lgkmcnt(0)
s_cmp_lg_u32 s56,2
s_cbranch_scc1 vfin_232
v_cmp_eq_u32 vcc,v17,v19
s_and_b32 s64,vcc_lo,0xffff
s_cmp_eq_u32 s64,65535
s_cbranch_scc1 vfin_232
s_mov_b32 s65,0
v_readlane_b32 s64,v17,1
s_lshr_b32 s64,s64,8
s_add_u32 s65,s65,s64
v_readlane_b32 s64,v17,3
s_lshr_b32 s64,s64,8
s_add_u32 s65,s65,s64
v_readlane_b32 s64,v17,5
s_lshr_b32 s64,s64,8
s_add_u32 s65,s65,s64
v_readlane_b32 s64,v17,7
s_lshr_b32 s64,s64,8
s_add_u32 s65,s65,s64
v_readlane_b32 s64,v17,9
s_lshr_b32 s64,s64,8
s_add_u32 s65,s65,s64
v_readlane_b32 s64,v17,11
s_lshr_b32 s64,s64,8
s_add_u32 s65,s65,s64
v_readlane_b32 s64,v17,13
s_lshr_b32 s64,s64,8
s_add_u32 s65,s65,s64
v_readlane_b32 s64,v17,15
s_lshr_b32 s64,s64,8
s_add_u32 s65,s65,s64
s_cmp_ge_u32 s65,256
s_cbranch_scc1 fl_fb
vfin_232:
s_and_b32 s56,s56,1
s_mov_b32 s67,0
v_readlane_b32 s65,v17,21
s_and_b32 s65,s65,2
s_lshl_b32 s67,s65,12
v_lshlrev_b32 v0,4,v1
v_and_b32 v21,15,v1
v_lshrrev_b32 v22,4,v1
v_and_b32 v23,7,v21
v_lshlrev_b32 v23,4,v23
v_lshl_add_u32 v3,v22,8,v23
v_and_b32 v23,31,v1
v_lshlrev_b32 v4,4,v23
v_and_b32 v23,3,v1
v_bfe_u32 v24,v1,2,1
v_lshlrev_b32 v23,14,v23
v_lshl_add_u32 v2,v24,7,v23
v_mov_b32 v7,0xff800000
s_and_b32 s54,s50,1
s_lshl_b32 s64,s54,4
v_lshlrev_b32 v23,2,v22
v_sub_u32 v23,v21,v23
v_add_u32 v23,s64,v23
v_cmp_le_i32 s[28:29],0,v23
v_cmp_le_i32 s[30:31],1,v23
v_cmp_le_i32 s[32:33],2,v23
v_cmp_le_i32 s[34:35],3,v23
v_cmp_le_i32 s[36:37],16,v23
v_cmp_le_i32 s[38:39],17,v23
v_cmp_le_i32 s[40:41],18,v23
v_cmp_le_i32 s[42:43],19,v23
s_mov_b32 s44,-1
s_mov_b32 s45,0
s_mov_b32 s80,0x3e0293ee
s_lshl_b32 s52,s59,1
s_lshr_b32 s64,s50,1
s_add_u32 s52,s52,s64
s_lshl_b32 s53,s52,15
s_lshl_b32 s68,s52,8
s_add_u32 s68,s68,s67
s_add_u32 s68,s68,138428416
s_lshl_b32 s69,s59,8
s_lshl_b32 s64,s64,2
s_add_u32 s69,s69,s64
s_lshl_b32 s64,s54,3
s_add_u32 s69,s69,s64
s_add_u32 s69,s69,138543104
s_lshl_b32 s66,s52,12
s_lshl_b32 s64,s54,17
s_add_u32 s66,s66,s64
s_add_u32 s66,s66,150994944
s_lshl_b32 s55,s54,10
s_xor_b32 s55,s55,0x2000
s_mov_b32 s60,0
s_mov_b32 s71,1
plp_233:
buffer_load_dword v5,v2,s[20:23],s68 offen sc1
s_waitcnt vmcnt(0)
v_cmp_gt_u32 vcc,s71,v5
s_cbranch_vccz pok_234
s_sleep 4
s_sub_u32 s90,s90,1
s_cmp_gt_i32 s90,0
s_cbranch_scc1 plp_233
pok_234:
s_add_u32 s64,s60,0
s_lshl_b32 s65,s64,11
s_and_b32 s65,s65,0x2000
s_xor_b32 s65,s65,s67
s_lshl_b32 s64,s64,19
s_add_u32 s64,s64,s65
s_add_u32 s92,s64,s53
s_add_u32 s93,s92,16384
s_add_u32 s94,s92,4096
s_add_u32 s95,s93,4096
s_xor_b32 s96,s92,s55
s_xor_b32 s97,s93,s55
buffer_load_dwordx4 a[0:3],v0,s[20:23],s96 offen offset:0
buffer_load_dwordx4 a[16:19],v0,s[20:23],s92 offen offset:0
buffer_load_dwordx4 a[32:35],v0,s[20:23],s92 offen offset:1024
buffer_load_dwordx4 a[4:7],v0,s[20:23],s96 offen offset:2048
buffer_load_dwordx4 a[20:23],v0,s[20:23],s92 offen offset:2048
buffer_load_dwordx4 a[36:39],v0,s[20:23],s92 offen offset:3072
buffer_load_dwordx4 a[8:11],v0,s[20:23],s97 offen offset:0
buffer_load_dwordx4 a[24:27],v0,s[20:23],s93 offen offset:0
buffer_load_dwordx4 a[40:43],v0,s[20:23],s93 offen offset:1024
buffer_load_dwordx4 a[12:15],v0,s[20:23],s97 offen offset:2048
buffer_load_dwordx4 a[28:31],v0,s[20:23],s93 offen offset:2048
buffer_load_dwordx4 a[44:47],v0,s[20:23],s93 offen offset:3072
buffer_load_dwordx4 a[48:51],v0,s[20:23],s94 offen offset:0
buffer_load_dwordx4 a[52:55],v0,s[20:23],s94 offen offset:1024
buffer_load_dwordx4 a[56:59],v0,s[20:23],s94 offen offset:2048
buffer_load_dwordx4 a[60:63],v0,s[20:23],s94 offen offset:3072
buffer_load_dwordx4 a[64:67],v0,s[20:23],s95 offen offset:0
buffer_load_dwordx4 a[68:71],v0,s[20:23],s95 offen offset:1024
buffer_load_dwordx4 a[72:75],v0,s[20:23],s95 offen offset:2048
buffer_load_dwordx4 a[76:79],v0,s[20:23],s95 offen offset:3072
s_waitcnt vmcnt(8)
top0_235:
v_mfma_f32_16x16x32_bf16 v[48:51],a[16:19],a[0:3],0
v_mfma_f32_16x16x32_bf16 v[52:55],a[32:35],a[0:3],0
v_mfma_f32_16x16x32_bf16 v[48:51],a[20:23],a[4:7],v[48:51]
v_mfma_f32_16x16x32_bf16 v[52:55],a[36:39],a[4:7],v[52:55]
v_mfma_f32_16x16x32_bf16 v[48:51],a[24:27],a[8:11],v[48:51]
v_mfma_f32_16x16x32_bf16 v[52:55],a[40:43],a[8:11],v[52:55]
v_mfma_f32_16x16x32_bf16 v[48:51],a[28:31],a[12:15],v[48:51]
v_mfma_f32_16x16x32_bf16 v[52:55],a[44:47],a[12:15],v[52:55]
s_nop 6
v_cndmask_b32 v48,v7,v48,s[28:29]
v_cndmask_b32 v49,v7,v49,s[30:31]
v_cndmask_b32 v50,v7,v50,s[32:33]
v_cndmask_b32 v51,v7,v51,s[34:35]
v_cndmask_b32 v52,v7,v52,s[36:37]
v_cndmask_b32 v53,v7,v53,s[38:39]
v_cndmask_b32 v54,v7,v54,s[40:41]
v_cndmask_b32 v55,v7,v55,s[42:43]
v_max3_f32 v72,v48,v49,v50
v_max3_f32 v72,v72,v51,v52
v_max3_f32 v72,v72,v53,v54
v_max_f32 v72,v72,v55
s_add_u32 s64,s60,0
s_lshl_b32 s65,s64,11
s_and_b32 s65,s65,0x2000
s_xor_b32 s65,s65,s67
s_lshl_b32 s64,s64,19
s_add_u32 s64,s64,s65
s_add_u32 s98,s64,s53
s_add_u32 s98,s98,67108864
s_add_u32 s99,s98,16384
s_lshr_b32 s71,s60,1
s_add_u32 s71,s71,1
plp_237:
buffer_load_dword v5,v2,s[20:23],s68 offen sc1
s_waitcnt vmcnt(0)
v_cmp_gt_u32 vcc,s71,v5
s_cbranch_vccz pok_238
s_sleep 4
s_sub_u32 s90,s90,1
s_cmp_gt_i32 s90,0
s_cbranch_scc1 plp_237
pok_238:
buffer_load_dwordx4 v[16:19],v3,s[20:23],s98 offen offset:0
buffer_load_dwordx4 v[20:23],v3,s[20:23],s98 offen offset:128
buffer_load_dwordx4 v[24:27],v3,s[20:23],s99 offen offset:0
buffer_load_dwordx4 v[28:31],v3,s[20:23],s99 offen offset:128
buffer_load_dwordx4 v[32:35],v4,s[20:23],s98 offen offset:1024
buffer_load_dwordx4 v[36:39],v4,s[20:23],s98 offen offset:1536
buffer_load_dwordx4 v[40:43],v4,s[20:23],s99 offen offset:1024
buffer_load_dwordx4 v[44:47],v4,s[20:23],s99 offen offset:1536
s_barrier
s_add_u32 s64,s60,2
s_lshl_b32 s65,s64,11
s_and_b32 s65,s65,0x2000
s_xor_b32 s65,s65,s67
s_lshl_b32 s64,s64,19
s_add_u32 s64,s64,s65
s_add_u32 s92,s64,s53
s_add_u32 s93,s92,16384
s_add_u32 s94,s92,4096
s_add_u32 s95,s93,4096
s_xor_b32 s96,s92,s55
s_xor_b32 s97,s93,s55
buffer_load_dwordx4 a[80:83],v0,s[20:23],s96 offen offset:0
buffer_load_dwordx4 a[96:99],v0,s[20:23],s92 offen offset:0
buffer_load_dwordx4 a[112:115],v0,s[20:23],s92 offen offset:1024
buffer_load_dwordx4 a[84:87],v0,s[20:23],s96 offen offset:2048
buffer_load_dwordx4 a[100:103],v0,s[20:23],s92 offen offset:2048
buffer_load_dwordx4 a[116:119],v0,s[20:23],s92 offen offset:3072
buffer_load_dwordx4 a[88:91],v0,s[20:23],s97 offen offset:0
buffer_load_dwordx4 a[104:107],v0,s[20:23],s93 offen offset:0
buffer_load_dwordx4 a[120:123],v0,s[20:23],s93 offen offset:1024
buffer_load_dwordx4 a[92:95],v0,s[20:23],s97 offen offset:2048
buffer_load_dwordx4 a[108:111],v0,s[20:23],s93 offen offset:2048
buffer_load_dwordx4 a[124:127],v0,s[20:23],s93 offen offset:3072
s_waitcnt vmcnt(16)
v_mfma_f32_16x16x32_bf16 v[56:59],v[16:19],a[0:3],0
v_mfma_f32_16x16x32_bf16 v[56:59],v[20:23],a[4:7],v[56:59]
v_mfma_f32_16x16x32_bf16 v[56:59],v[24:27],a[8:11],v[56:59]
v_mfma_f32_16x16x32_bf16 v[56:59],v[28:31],a[12:15],v[56:59]
s_nop 7
v_cndmask_b32 v56,v7,v56,s[44:45]
v_cndmask_b32 v57,v7,v57,s[44:45]
v_cndmask_b32 v58,v7,v58,s[44:45]
v_cndmask_b32 v59,v7,v59,s[44:45]
v_max3_f32 v72,v72,v56,v57
v_max3_f32 v72,v72,v58,v59
v_mov_b32 v73,v72
s_nop 1
v_permlane16_swap_b32 v73,v72
v_max_f32 v72,v72,v73
v_mov_b32 v73,v72
s_nop 1
v_permlane32_swap_b32 v73,v72
v_max_f32 v72,v72,v73
v_mul_f32 v72,s80,v72
v_fma_f32 v48,v48,s80,-v72
v_fma_f32 v49,v49,s80,-v72
v_fma_f32 v50,v50,s80,-v72
v_fma_f32 v51,v51,s80,-v72
v_fma_f32 v52,v52,s80,-v72
v_fma_f32 v53,v53,s80,-v72
v_fma_f32 v54,v54,s80,-v72
v_fma_f32 v55,v55,s80,-v72
v_fma_f32 v56,v56,s80,-v72
v_fma_f32 v57,v57,s80,-v72
v_fma_f32 v58,v58,s80,-v72
v_fma_f32 v59,v59,s80,-v72
v_exp_f32 v48,v48
v_exp_f32 v49,v49
v_exp_f32 v50,v50
v_exp_f32 v51,v51
v_exp_f32 v52,v52
v_exp_f32 v53,v53
v_exp_f32 v54,v54
v_exp_f32 v55,v55
v_exp_f32 v56,v56
v_exp_f32 v57,v57
v_exp_f32 v58,v58
v_exp_f32 v59,v59
v_add_f32 v74,v48,v49
v_add_f32 v75,v50,v51
v_add_f32 v74,v74,v52
v_add_f32 v75,v75,v53
v_add_f32 v74,v74,v54
v_add_f32 v75,v75,v55
v_add_f32 v74,v74,v56
v_add_f32 v75,v75,v57
v_add_f32 v74,v74,v58
v_add_f32 v75,v75,v59
v_add_f32 v74,v74,v75
v_mov_b32 v73,v74
s_nop 1
v_permlane16_swap_b32 v73,v74
v_add_f32 v74,v74,v73
v_mov_b32 v73,v74
s_nop 1
v_permlane32_swap_b32 v73,v74
v_add_f32 v74,v74,v73
v_rcp_f32 v75,v74
s_nop 0
v_mul_f32 v48,v48,v75
v_mul_f32 v49,v49,v75
v_mul_f32 v50,v50,v75
v_mul_f32 v51,v51,v75
v_mul_f32 v52,v52,v75
v_mul_f32 v53,v53,v75
v_mul_f32 v54,v54,v75
v_mul_f32 v55,v55,v75
v_mul_f32 v56,v56,v75
v_mul_f32 v57,v57,v75
v_mul_f32 v58,v58,v75
v_mul_f32 v59,v59,v75
v_cvt_pk_bf16_f32 v64,v48,v49
v_cvt_pk_bf16_f32 v65,v50,v51
v_cvt_pk_bf16_f32 v66,v52,v53
v_cvt_pk_bf16_f32 v67,v54,v55
v_cvt_pk_bf16_f32 v68,v56,v57
v_cvt_pk_bf16_f32 v69,v58,v59
v_mfma_f32_16x16x32_bf16 v[80:83],a[48:51],v[64:67],0
v_mfma_f32_16x16x32_bf16 v[84:87],a[52:55],v[64:67],0
v_mfma_f32_16x16x32_bf16 v[88:91],a[56:59],v[64:67],0
v_mfma_f32_16x16x32_bf16 v[92:95],a[60:63],v[64:67],0
v_mfma_f32_16x16x32_bf16 v[96:99],a[64:67],v[64:67],0
v_mfma_f32_16x16x32_bf16 v[100:103],a[68:71],v[64:67],0
v_mfma_f32_16x16x32_bf16 v[104:107],a[72:75],v[64:67],0
v_mfma_f32_16x16x32_bf16 v[108:111],a[76:79],v[64:67],0
s_waitcnt vmcnt(12)
v_mfma_f32_16x16x16_bf16 v[80:83],v[32:33],v[68:69],v[80:83]
v_mfma_f32_16x16x16_bf16 v[84:87],v[34:35],v[68:69],v[84:87]
v_mfma_f32_16x16x16_bf16 v[88:91],v[36:37],v[68:69],v[88:91]
v_mfma_f32_16x16x16_bf16 v[92:95],v[38:39],v[68:69],v[92:95]
v_mfma_f32_16x16x16_bf16 v[96:99],v[40:41],v[68:69],v[96:99]
v_mfma_f32_16x16x16_bf16 v[100:103],v[42:43],v[68:69],v[100:103]
v_mfma_f32_16x16x16_bf16 v[104:107],v[44:45],v[68:69],v[104:107]
v_mfma_f32_16x16x16_bf16 v[108:111],v[46:47],v[68:69],v[108:111]
s_nop 0
v_cvt_pk_bf16_f32 v112,v80,v81
v_cvt_pk_bf16_f32 v113,v82,v83
v_cvt_pk_bf16_f32 v114,v84,v85
v_cvt_pk_bf16_f32 v115,v86,v87
buffer_store_dwordx4 v[112:115],v0,s[20:23],s66 offen offset:0 sc1
v_cvt_pk_bf16_f32 v116,v88,v89
v_cvt_pk_bf16_f32 v117,v90,v91
v_cvt_pk_bf16_f32 v118,v92,v93
v_cvt_pk_bf16_f32 v119,v94,v95
buffer_store_dwordx4 v[116:119],v0,s[20:23],s66 offen offset:1024 sc1
v_cvt_pk_bf16_f32 v112,v96,v97
v_cvt_pk_bf16_f32 v113,v98,v99
v_cvt_pk_bf16_f32 v114,v100,v101
v_cvt_pk_bf16_f32 v115,v102,v103
buffer_store_dwordx4 v[112:115],v0,s[20:23],s66 offen offset:2048 sc1
v_cvt_pk_bf16_f32 v116,v104,v105
v_cvt_pk_bf16_f32 v117,v106,v107
v_cvt_pk_bf16_f32 v118,v108,v109
v_cvt_pk_bf16_f32 v119,v110,v111
buffer_store_dwordx4 v[116:119],v0,s[20:23],s66 offen offset:3072 sc1
s_barrier
buffer_load_dwordx4 a[128:131],v0,s[20:23],s94 offen offset:0
buffer_load_dwordx4 a[132:135],v0,s[20:23],s94 offen offset:1024
buffer_load_dwordx4 a[136:139],v0,s[20:23],s94 offen offset:2048
buffer_load_dwordx4 a[140:143],v0,s[20:23],s94 offen offset:3072
buffer_load_dwordx4 a[144:147],v0,s[20:23],s95 offen offset:0
buffer_load_dwordx4 a[148:151],v0,s[20:23],s95 offen offset:1024
buffer_load_dwordx4 a[152:155],v0,s[20:23],s95 offen offset:2048
buffer_load_dwordx4 a[156:159],v0,s[20:23],s95 offen offset:3072
s_add_u32 s66,s66,262144
s_add_u32 s60,s60,2
s_waitcnt vmcnt(8)
v_mov_b32 v6,s71
s_mov_b64 exec,1
buffer_store_dword v6,off,s[20:23],s69 sc1
s_mov_b64 exec,-1
top1_236:
v_mfma_f32_16x16x32_bf16 v[48:51],a[96:99],a[80:83],0
v_mfma_f32_16x16x32_bf16 v[52:55],a[112:115],a[80:83],0
v_mfma_f32_16x16x32_bf16 v[48:51],a[100:103],a[84:87],v[48:51]
v_mfma_f32_16x16x32_bf16 v[52:55],a[116:119],a[84:87],v[52:55]
v_mfma_f32_16x16x32_bf16 v[48:51],a[104:107],a[88:91],v[48:51]
v_mfma_f32_16x16x32_bf16 v[52:55],a[120:123],a[88:91],v[52:55]
v_mfma_f32_16x16x32_bf16 v[48:51],a[108:111],a[92:95],v[48:51]
v_mfma_f32_16x16x32_bf16 v[52:55],a[124:127],a[92:95],v[52:55]
s_nop 6
v_cndmask_b32 v48,v7,v48,s[28:29]
v_cndmask_b32 v49,v7,v49,s[30:31]
v_cndmask_b32 v50,v7,v50,s[32:33]
v_cndmask_b32 v51,v7,v51,s[34:35]
v_cndmask_b32 v52,v7,v52,s[36:37]
v_cndmask_b32 v53,v7,v53,s[38:39]
v_cndmask_b32 v54,v7,v54,s[40:41]
v_cndmask_b32 v55,v7,v55,s[42:43]
v_max3_f32 v72,v48,v49,v50
v_max3_f32 v72,v72,v51,v52
v_max3_f32 v72,v72,v53,v54
v_max_f32 v72,v72,v55
s_add_u32 s64,s60,0
s_lshl_b32 s65,s64,11
s_and_b32 s65,s65,0x2000
s_xor_b32 s65,s65,s67
s_lshl_b32 s64,s64,19
s_add_u32 s64,s64,s65
s_add_u32 s98,s64,s53
s_add_u32 s98,s98,67108864
s_add_u32 s99,s98,16384
s_lshr_b32 s71,s60,1
s_add_u32 s71,s71,1
plp_239:
buffer_load_dword v5,v2,s[20:23],s68 offen sc1
s_waitcnt vmcnt(0)
v_cmp_gt_u32 vcc,s71,v5
s_cbranch_vccz pok_240
s_sleep 4
s_sub_u32 s90,s90,1
s_cmp_gt_i32 s90,0
s_cbranch_scc1 plp_239
pok_240:
buffer_load_dwordx4 v[16:19],v3,s[20:23],s98 offen offset:0
buffer_load_dwordx4 v[20:23],v3,s[20:23],s98 offen offset:128
buffer_load_dwordx4 v[24:27],v3,s[20:23],s99 offen offset:0
buffer_load_dwordx4 v[28:31],v3,s[20:23],s99 offen offset:128
buffer_load_dwordx4 v[32:35],v4,s[20:23],s98 offen offset:1024
buffer_load_dwordx4 v[36:39],v4,s[20:23],s98 offen offset:1536
buffer_load_dwordx4 v[40:43],v4,s[20:23],s99 offen offset:1024
buffer_load_dwordx4 v[44:47],v4,s[20:23],s99 offen offset:1536
s_barrier
s_cmp_lt_u32 s60,126
s_cbranch_scc1 pf_241
s_waitcnt vmcnt(0)
s_branch j1_242
pf_241:
s_add_u32 s64,s60,2
s_lshl_b32 s65,s64,11
s_and_b32 s65,s65,0x2000
s_xor_b32 s65,s65,s67
s_lshl_b32 s64,s64,19
s_add_u32 s64,s64,s65
s_add_u32 s92,s64,s53
s_add_u32 s93,s92,16384
s_add_u32 s94,s92,4096
s_add_u32 s95,s93,4096
s_xor_b32 s96,s92,s55
s_xor_b32 s97,s93,s55
buffer_load_dwordx4 a[0:3],v0,s[20:23],s96 offen offset:0
buffer_load_dwordx4 a[16:19],v0,s[20:23],s92 offen offset:0
buffer_load_dwordx4 a[32:35],v0,s[20:23],s92 offen offset:1024
buffer_load_dwordx4 a[4:7],v0,s[20:23],s96 offen offset:2048
buffer_load_dwordx4 a[20:23],v0,s[20:23],s92 offen offset:2048
buffer_load_dwordx4 a[36:39],v0,s[20:23],s92 offen offset:3072
buffer_load_dwordx4 a[8:11],v0,s[20:23],s97 offen offset:0
buffer_load_dwordx4 a[24:27],v0,s[20:23],s93 offen offset:0
buffer_load_dwordx4 a[40:43],v0,s[20:23],s93 offen offset:1024
buffer_load_dwordx4 a[12:15],v0,s[20:23],s97 offen offset:2048
buffer_load_dwordx4 a[28:31],v0,s[20:23],s93 offen offset:2048
buffer_load_dwordx4 a[44:47],v0,s[20:23],s93 offen offset:3072
j1_242:
s_waitcnt vmcnt(16)
v_mfma_f32_16x16x32_bf16 v[56:59],v[16:19],a[80:83],0
v_mfma_f32_16x16x32_bf16 v[56:59],v[20:23],a[84:87],v[56:59]
v_mfma_f32_16x16x32_bf16 v[56:59],v[24:27],a[88:91],v[56:59]
v_mfma_f32_16x16x32_bf16 v[56:59],v[28:31],a[92:95],v[56:59]
s_nop 7
v_cndmask_b32 v56,v7,v56,s[44:45]
v_cndmask_b32 v57,v7,v57,s[44:45]
v_cndmask_b32 v58,v7,v58,s[44:45]
v_cndmask_b32 v59,v7,v59,s[44:45]
v_max3_f32 v72,v72,v56,v57
v_max3_f32 v72,v72,v58,v59
v_mov_b32 v73,v72
s_nop 1
v_permlane16_swap_b32 v73,v72
v_max_f32 v72,v72,v73
v_mov_b32 v73,v72
s_nop 1
v_permlane32_swap_b32 v73,v72
v_max_f32 v72,v72,v73
v_mul_f32 v72,s80,v72
v_fma_f32 v48,v48,s80,-v72
v_fma_f32 v49,v49,s80,-v72
v_fma_f32 v50,v50,s80,-v72
v_fma_f32 v51,v51,s80,-v72
v_fma_f32 v52,v52,s80,-v72
v_fma_f32 v53,v53,s80,-v72
v_fma_f32 v54,v54,s80,-v72
v_fma_f32 v55,v55,s80,-v72
v_fma_f32 v56,v56,s80,-v72
v_fma_f32 v57,v57,s80,-v72
v_fma_f32 v58,v58,s80,-v72
v_fma_f32 v59,v59,s80,-v72
v_exp_f32 v48,v48
v_exp_f32 v49,v49
v_exp_f32 v50,v50
v_exp_f32 v51,v51
v_exp_f32 v52,v52
v_exp_f32 v53,v53
v_exp_f32 v54,v54
v_exp_f32 v55,v55
v_exp_f32 v56,v56
v_exp_f32 v57,v57
v_exp_f32 v58,v58
v_exp_f32 v59,v59
v_add_f32 v74,v48,v49
v_add_f32 v75,v50,v51
v_add_f32 v74,v74,v52
v_add_f32 v75,v75,v53
v_add_f32 v74,v74,v54
v_add_f32 v75,v75,v55
v_add_f32 v74,v74,v56
v_add_f32 v75,v75,v57
v_add_f32 v74,v74,v58
v_add_f32 v75,v75,v59
v_add_f32 v74,v74,v75
v_mov_b32 v73,v74
s_nop 1
v_permlane16_swap_b32 v73,v74
v_add_f32 v74,v74,v73
v_mov_b32 v73,v74
s_nop 1
v_permlane32_swap_b32 v73,v74
v_add_f32 v74,v74,v73
v_rcp_f32 v75,v74
s_nop 0
v_mul_f32 v48,v48,v75
v_mul_f32 v49,v49,v75
v_mul_f32 v50,v50,v75
v_mul_f32 v51,v51,v75
v_mul_f32 v52,v52,v75
v_mul_f32 v53,v53,v75
v_mul_f32 v54,v54,v75
v_mul_f32 v55,v55,v75
v_mul_f32 v56,v56,v75
v_mul_f32 v57,v57,v75
v_mul_f32 v58,v58,v75
v_mul_f32 v59,v59,v75
v_cvt_pk_bf16_f32 v64,v48,v49
v_cvt_pk_bf16_f32 v65,v50,v51
v_cvt_pk_bf16_f32 v66,v52,v53
v_cvt_pk_bf16_f32 v67,v54,v55
v_cvt_pk_bf16_f32 v68,v56,v57
v_cvt_pk_bf16_f32 v69,v58,v59
v_mfma_f32_16x16x32_bf16 v[80:83],a[128:131],v[64:67],0
v_mfma_f32_16x16x32_bf16 v[84:87],a[132:135],v[64:67],0
v_mfma_f32_16x16x32_bf16 v[88:91],a[136:139],v[64:67],0
v_mfma_f32_16x16x32_bf16 v[92:95],a[140:143],v[64:67],0
v_mfma_f32_16x16x32_bf16 v[96:99],a[144:147],v[64:67],0
v_mfma_f32_16x16x32_bf16 v[100:103],a[148:151],v[64:67],0
v_mfma_f32_16x16x32_bf16 v[104:107],a[152:155],v[64:67],0
v_mfma_f32_16x16x32_bf16 v[108:111],a[156:159],v[64:67],0
s_waitcnt vmcnt(12)
v_mfma_f32_16x16x16_bf16 v[80:83],v[32:33],v[68:69],v[80:83]
v_mfma_f32_16x16x16_bf16 v[84:87],v[34:35],v[68:69],v[84:87]
v_mfma_f32_16x16x16_bf16 v[88:91],v[36:37],v[68:69],v[88:91]
v_mfma_f32_16x16x16_bf16 v[92:95],v[38:39],v[68:69],v[92:95]
v_mfma_f32_16x16x16_bf16 v[96:99],v[40:41],v[68:69],v[96:99]
v_mfma_f32_16x16x16_bf16 v[100:103],v[42:43],v[68:69],v[100:103]
v_mfma_f32_16x16x16_bf16 v[104:107],v[44:45],v[68:69],v[104:107]
v_mfma_f32_16x16x16_bf16 v[108:111],v[46:47],v[68:69],v[108:111]
s_nop 0
v_cvt_pk_bf16_f32 v112,v80,v81
v_cvt_pk_bf16_f32 v113,v82,v83
v_cvt_pk_bf16_f32 v114,v84,v85
v_cvt_pk_bf16_f32 v115,v86,v87
buffer_store_dwordx4 v[112:115],v0,s[20:23],s66 offen offset:0 sc1
v_cvt_pk_bf16_f32 v116,v88,v89
v_cvt_pk_bf16_f32 v117,v90,v91
v_cvt_pk_bf16_f32 v118,v92,v93
v_cvt_pk_bf16_f32 v119,v94,v95
buffer_store_dwordx4 v[116:119],v0,s[20:23],s66 offen offset:1024 sc1
v_cvt_pk_bf16_f32 v112,v96,v97
v_cvt_pk_bf16_f32 v113,v98,v99
v_cvt_pk_bf16_f32 v114,v100,v101
v_cvt_pk_bf16_f32 v115,v102,v103
buffer_store_dwordx4 v[112:115],v0,s[20:23],s66 offen offset:2048 sc1
v_cvt_pk_bf16_f32 v116,v104,v105
v_cvt_pk_bf16_f32 v117,v106,v107
v_cvt_pk_bf16_f32 v118,v108,v109
v_cvt_pk_bf16_f32 v119,v110,v111
buffer_store_dwordx4 v[116:119],v0,s[20:23],s66 offen offset:3072 sc1
s_barrier
s_cmp_lt_u32 s60,126
s_cbranch_scc1 pf_243
s_waitcnt vmcnt(0)
s_branch j1_244
pf_243:
buffer_load_dwordx4 a[48:51],v0,s[20:23],s94 offen offset:0
buffer_load_dwordx4 a[52:55],v0,s[20:23],s94 offen offset:1024
buffer_load_dwordx4 a[56:59],v0,s[20:23],s94 offen offset:2048
buffer_load_dwordx4 a[60:63],v0,s[20:23],s94 offen offset:3072
buffer_load_dwordx4 a[64:67],v0,s[20:23],s95 offen offset:0
buffer_load_dwordx4 a[68:71],v0,s[20:23],s95 offen offset:1024
buffer_load_dwordx4 a[72:75],v0,s[20:23],s95 offen offset:2048
buffer_load_dwordx4 a[76:79],v0,s[20:23],s95 offen offset:3072
j1_244:
s_add_u32 s66,s66,262144
s_add_u32 s60,s60,2
s_waitcnt vmcnt(8)
v_mov_b32 v6,s71
s_mov_b64 exec,1
buffer_store_dword v6,off,s[20:23],s69 sc1
s_mov_b64 exec,-1
s_cmp_lt_u32 s60,128
s_cbranch_scc1 top0_235
s_endpgm
fl_rec:
s_load_dwordx8 s[4:11],s[0:1],8
s_load_dwordx2 s[12:13],s[0:1],40
s_mov_b32 s57,s58
v_mov_b32 v0,v1
s_waitcnt lgkmcnt(0)
s_mov_b32 s28,s6
s_and_b32 s29,s7,0xffff
s_mov_b32 s30,0x800000
s_mov_b32 s31,0x20000
s_mov_b32 s32,s8
s_and_b32 s33,s9,0xffff
s_mov_b32 s34,0x800000
s_mov_b32 s35,0x20000
s_mov_b32 s36,s10
s_and_b32 s37,s11,0xffff
s_mov_b32 s38,0x800000
s_mov_b32 s39,0x20000
s_mov_b32 s40,s12
s_and_b32 s41,s13,0xffff
s_mov_b32 s42,0x800000
s_mov_b32 s43,0x20000
s_mov_b32 s44,s4
s_and_b32 s45,s5,0xffff
s_mov_b32 s46,0x4000
s_mov_b32 s47,0x20000
s_lshr_b32 s58,s57,5
s_and_b32 s59,s57,31
v_and_b32 v20,63,v0
v_and_b32 v21,15,v20
v_lshrrev_b32 v22,4,v20
v_lshrrev_b32 v23,3,v20
v_and_b32 v24,7,v20
v_lshlrev_b32 v16,13,v23
v_lshl_add_u32 v16,v24,4,v16
v_lshrrev_b32 v23,2,v20
v_and_b32 v24,3,v20
v_lshlrev_b32 v17,11,v23
v_lshl_add_u32 v17,v24,4,v17
s_lshl_b32 s61,s50,15
s_add_u32 s61,s61,32768
s_lshl_b32 s62,s50,21
s_lshl_b32 s64,s57,7
s_add_u32 s62,s62,s64
s_lshl_b32 s63,s58,22
s_lshl_b32 s64,s50,20
s_add_u32 s63,s63,s64
s_lshl_b32 s64,s59,6
s_add_u32 s63,s63,s64
v_lshrrev_b32 v23,1,v22
v_lshlrev_b32 v25,4,v23
v_and_b32 v23,1,v22
v_lshl_add_u32 v25,v23,2,v25
v_lshrrev_b32 v23,3,v21
v_lshl_add_u32 v25,v23,3,v25
v_bfe_u32 v23,v21,2,1
v_add_u32 v25,v25,v23
v_lshlrev_b32 v28,4,v23
v_lshrrev_b32 v23,1,v22
v_lshl_add_u32 v28,v23,3,v28
v_lshrrev_b32 v23,3,v21
v_lshl_add_u32 v28,v23,2,v28
v_and_b32 v23,1,v22
v_lshl_add_u32 v28,v23,1,v28
v_and_b32 v24,3,v21
v_lshlrev_b32 v26,7,v28
v_add_u32 v26,s61,v26
v_lshl_add_u32 v18,v24,3,v26
v_lshl_add_u32 v19,v24,4,v26
v_lshlrev_b32 v26,6,v25
v_add_u32 v26,s61,v26
v_lshl_add_u32 v27,v24,3,v26
v_lshlrev_b32 v0,4,v20
v_add_u32 v7,s61,v0
s_and_b32 s64,s57,7
s_cmp_eq_u32 s64,3
s_cselect_b32 s65,0,0x0f
s_sub_u32 s66,s57,56
s_cmp_lt_u32 s66,7
s_cselect_b32 s66,0xf0,0
s_or_b32 vcc_lo,s65,s66
s_mov_b32 vcc_hi,0
v_and_b32 v29,3,v20
v_lshlrev_b32 v29,13,v29
v_and_b32 v30,4,v20
v_lshl_add_u32 v29,v30,7,v29
v_cndmask_b32 v29,-1,v29,vcc
s_lshl_b32 s64,s64,15
s_lshl_b32 s65,s50,21
s_add_u32 s64,s64,s65
s_andn2_b32 s65,s57,7
s_lshl_b32 s65,s65,7
s_add_u32 s64,s64,s65
s_add_u32 s68,s64,384
s_lshl_b32 s64,s58,22
s_lshl_b32 s65,s50,20
s_add_u32 s64,s64,s65
s_and_b32 s66,s59,15
s_lshl_b32 s65,s66,13
s_add_u32 s64,s64,s65
s_lshr_b32 s65,s59,4
s_lshl_b32 s65,s65,10
s_add_u32 s69,s64,s65
s_add_u32 s69,s69,384
s_lshr_b32 s66,s66,1
s_cmp_eq_u32 s66,3
s_cselect_b32 s65,0,4
v_lshlrev_b32 v30,11,v20
v_cmp_gt_u32 vcc,s65,v20
s_nop 1
v_cndmask_b32 v30,-1,v30,vcc
s_add_u32 s64,s68,524288
buffer_load_dword v31,v29,s[28:31],s64 offen
s_add_u32 s64,s68,786432
buffer_load_dword v31,v29,s[28:31],s64 offen
s_add_u32 s64,s62,0
s_add_u32 m0,s61,0
s_nop 0
buffer_load_dwordx4 v16,s[28:31],s64 offen lds
s_waitcnt vmcnt(10)
s_add_u32 s64,s62,65536
s_add_u32 m0,s61,1024
s_nop 0
buffer_load_dwordx4 v16,s[28:31],s64 offen lds
s_add_u32 s64,s68,1048576
buffer_load_dword v31,v29,s[28:31],s64 offen
s_waitcnt vmcnt(10)
s_add_u32 s64,s62,131072
s_add_u32 m0,s61,2048
s_nop 0
buffer_load_dwordx4 v16,s[28:31],s64 offen lds
s_waitcnt vmcnt(10)
s_add_u32 s64,s62,196608
s_add_u32 m0,s61,3072
s_nop 0
buffer_load_dwordx4 v16,s[28:31],s64 offen lds
s_waitcnt vmcnt(10)
s_add_u32 s64,s62,262144
s_add_u32 m0,s61,4096
s_nop 0
buffer_load_dwordx4 v16,s[28:31],s64 offen lds
s_waitcnt vmcnt(10)
s_add_u32 s64,s62,327680
s_add_u32 m0,s61,5120
s_nop 0
buffer_load_dwordx4 v16,s[28:31],s64 offen lds
s_add_u32 s64,s68,1310720
buffer_load_dword v31,v29,s[28:31],s64 offen
s_waitcnt vmcnt(10)
s_add_u32 s64,s62,393216
s_add_u32 m0,s61,6144
s_nop 0
buffer_load_dwordx4 v16,s[28:31],s64 offen lds
s_waitcnt vmcnt(10)
s_add_u32 s64,s62,458752
s_add_u32 m0,s61,7168
s_nop 0
buffer_load_dwordx4 v16,s[28:31],s64 offen lds
s_waitcnt vmcnt(10)
s_add_u32 s64,s62,524288
s_add_u32 m0,s61,8192
s_nop 0
buffer_load_dwordx4 v16,s[28:31],s64 offen lds
s_waitcnt vmcnt(10)
s_add_u32 s64,s62,589824
s_add_u32 m0,s61,9216
s_nop 0
buffer_load_dwordx4 v16,s[28:31],s64 offen lds
s_add_u32 s64,s68,1572864
buffer_load_dword v31,v29,s[28:31],s64 offen
s_waitcnt vmcnt(10)
s_add_u32 s64,s62,655360
s_add_u32 m0,s61,10240
s_nop 0
buffer_load_dwordx4 v16,s[28:31],s64 offen lds
s_waitcnt vmcnt(10)
s_add_u32 s64,s62,720896
s_add_u32 m0,s61,11264
s_nop 0
buffer_load_dwordx4 v16,s[28:31],s64 offen lds
s_waitcnt vmcnt(10)
s_add_u32 s64,s62,786432
s_add_u32 m0,s61,12288
s_nop 0
buffer_load_dwordx4 v16,s[28:31],s64 offen lds
s_waitcnt vmcnt(10)
s_add_u32 s64,s62,851968
s_add_u32 m0,s61,13312
s_nop 0
buffer_load_dwordx4 v16,s[28:31],s64 offen lds
s_add_u32 s64,s68,1835008
buffer_load_dword v31,v29,s[28:31],s64 offen
s_waitcnt vmcnt(10)
s_add_u32 s64,s62,917504
s_add_u32 m0,s61,14336
s_nop 0
buffer_load_dwordx4 v16,s[28:31],s64 offen lds
s_waitcnt vmcnt(10)
s_add_u32 s64,s62,983040
s_add_u32 m0,s61,15360
s_nop 0
buffer_load_dwordx4 v16,s[28:31],s64 offen lds
s_add_u32 s64,s62,1048576
s_add_u32 m0,s61,16384
s_nop 0
buffer_load_dwordx4 v16,s[28:31],s64 offen lds
s_waitcnt vmcnt(10)
s_add_u32 s64,s62,1114112
s_add_u32 m0,s61,17408
s_nop 0
buffer_load_dwordx4 v16,s[28:31],s64 offen lds
s_add_u32 s64,s68,0
buffer_load_dword v31,v29,s[32:35],s64 offen
s_waitcnt vmcnt(10)
s_add_u32 s64,s62,1179648
s_add_u32 m0,s61,18432
s_nop 0
buffer_load_dwordx4 v16,s[28:31],s64 offen lds
s_waitcnt vmcnt(10)
s_add_u32 s64,s62,1245184
s_add_u32 m0,s61,19456
s_nop 0
buffer_load_dwordx4 v16,s[28:31],s64 offen lds
s_waitcnt vmcnt(10)
s_add_u32 s64,s62,1310720
s_add_u32 m0,s61,20480
s_nop 0
buffer_load_dwordx4 v16,s[28:31],s64 offen lds
s_waitcnt vmcnt(10)
s_add_u32 s64,s62,1376256
s_add_u32 m0,s61,21504
s_nop 0
buffer_load_dwordx4 v16,s[28:31],s64 offen lds
s_add_u32 s64,s68,262144
buffer_load_dword v31,v29,s[32:35],s64 offen
s_waitcnt vmcnt(10)
s_add_u32 s64,s62,1441792
s_add_u32 m0,s61,22528
s_nop 0
buffer_load_dwordx4 v16,s[28:31],s64 offen lds
s_waitcnt vmcnt(10)
s_add_u32 s64,s62,1507328
s_add_u32 m0,s61,23552
s_nop 0
buffer_load_dwordx4 v16,s[28:31],s64 offen lds
s_waitcnt vmcnt(10)
s_add_u32 s64,s62,1572864
s_add_u32 m0,s61,24576
s_nop 0
buffer_load_dwordx4 v16,s[28:31],s64 offen lds
s_waitcnt vmcnt(10)
s_add_u32 s64,s62,1638400
s_add_u32 m0,s61,25600
s_nop 0
buffer_load_dwordx4 v16,s[28:31],s64 offen lds
s_add_u32 s64,s68,524288
buffer_load_dword v31,v29,s[32:35],s64 offen
s_waitcnt vmcnt(10)
s_add_u32 s64,s62,1703936
s_add_u32 m0,s61,26624
s_nop 0
buffer_load_dwordx4 v16,s[28:31],s64 offen lds
s_waitcnt vmcnt(10)
s_add_u32 s64,s62,1769472
s_add_u32 m0,s61,27648
s_nop 0
buffer_load_dwordx4 v16,s[28:31],s64 offen lds
s_waitcnt vmcnt(10)
s_add_u32 s64,s62,1835008
s_add_u32 m0,s61,28672
s_nop 0
buffer_load_dwordx4 v16,s[28:31],s64 offen lds
s_waitcnt vmcnt(10)
s_add_u32 s64,s62,1900544
s_add_u32 m0,s61,29696
s_nop 0
buffer_load_dwordx4 v16,s[28:31],s64 offen lds
s_add_u32 s64,s68,786432
buffer_load_dword v31,v29,s[32:35],s64 offen
s_waitcnt vmcnt(10)
s_add_u32 s64,s62,1966080
s_add_u32 m0,s61,30720
s_nop 0
buffer_load_dwordx4 v16,s[28:31],s64 offen lds
s_waitcnt vmcnt(10)
s_add_u32 s64,s62,2031616
s_add_u32 m0,s61,31744
s_nop 0
buffer_load_dwordx4 v16,s[28:31],s64 offen lds
s_waitcnt vmcnt(20)
ds_read_b64_tr_b16 a[0:1],v18 offset:0
ds_read_b64_tr_b16 a[2:3],v18 offset:128
ds_read_b64_tr_b16 a[4:5],v18 offset:4096
ds_read_b64_tr_b16 a[6:7],v18 offset:4224
ds_read_b64_tr_b16 a[8:9],v18 offset:32
ds_read_b64_tr_b16 a[10:11],v18 offset:160
ds_read_b64_tr_b16 a[12:13],v18 offset:4128
ds_read_b64_tr_b16 a[14:15],v18 offset:4256
ds_read_b64_tr_b16 a[16:17],v18 offset:64
ds_read_b64_tr_b16 a[18:19],v18 offset:192
ds_read_b64_tr_b16 a[20:21],v18 offset:4160
ds_read_b64_tr_b16 a[22:23],v18 offset:4288
ds_read_b64_tr_b16 a[24:25],v18 offset:96
ds_read_b64_tr_b16 a[26:27],v18 offset:224
ds_read_b64_tr_b16 a[28:29],v18 offset:4192
ds_read_b64_tr_b16 a[30:31],v18 offset:4320
s_waitcnt lgkmcnt(0)
ds_read_b64_tr_b16 a[64:65],v18 offset:8192
ds_read_b64_tr_b16 a[66:67],v18 offset:8320
ds_read_b64_tr_b16 a[68:69],v18 offset:12288
ds_read_b64_tr_b16 a[70:71],v18 offset:12416
ds_read_b64_tr_b16 a[72:73],v18 offset:8224
ds_read_b64_tr_b16 a[74:75],v18 offset:8352
ds_read_b64_tr_b16 a[76:77],v18 offset:12320
ds_read_b64_tr_b16 a[78:79],v18 offset:12448
ds_read_b64_tr_b16 a[80:81],v18 offset:8256
ds_read_b64_tr_b16 a[82:83],v18 offset:8384
ds_read_b64_tr_b16 a[84:85],v18 offset:12352
ds_read_b64_tr_b16 a[86:87],v18 offset:12480
ds_read_b64_tr_b16 a[88:89],v18 offset:8288
ds_read_b64_tr_b16 a[90:91],v18 offset:8416
ds_read_b64_tr_b16 a[92:93],v18 offset:12384
ds_read_b64_tr_b16 a[94:95],v18 offset:12512
s_waitcnt lgkmcnt(0)
s_add_u32 s64,s62,0
s_add_u32 m0,s61,0
s_nop 0
buffer_load_dwordx4 v16,s[32:35],s64 offen lds
s_waitcnt vmcnt(10)
s_add_u32 s64,s62,65536
s_add_u32 m0,s61,1024
s_nop 0
buffer_load_dwordx4 v16,s[32:35],s64 offen lds
s_add_u32 s64,s68,1048576
buffer_load_dword v31,v29,s[32:35],s64 offen
s_waitcnt vmcnt(10)
s_add_u32 s64,s62,131072
s_add_u32 m0,s61,2048
s_nop 0
buffer_load_dwordx4 v16,s[32:35],s64 offen lds
s_waitcnt vmcnt(10)
s_add_u32 s64,s62,196608
s_add_u32 m0,s61,3072
s_nop 0
buffer_load_dwordx4 v16,s[32:35],s64 offen lds
s_waitcnt vmcnt(10)
s_add_u32 s64,s62,262144
s_add_u32 m0,s61,4096
s_nop 0
buffer_load_dwordx4 v16,s[32:35],s64 offen lds
s_waitcnt vmcnt(10)
s_add_u32 s64,s62,327680
s_add_u32 m0,s61,5120
s_nop 0
buffer_load_dwordx4 v16,s[32:35],s64 offen lds
s_add_u32 s64,s68,1310720
buffer_load_dword v31,v29,s[32:35],s64 offen
s_waitcnt vmcnt(10)
s_add_u32 s64,s62,393216
s_add_u32 m0,s61,6144
s_nop 0
buffer_load_dwordx4 v16,s[32:35],s64 offen lds
s_waitcnt vmcnt(10)
s_add_u32 s64,s62,458752
s_add_u32 m0,s61,7168
s_nop 0
buffer_load_dwordx4 v16,s[32:35],s64 offen lds
s_waitcnt vmcnt(10)
s_add_u32 s64,s62,524288
s_add_u32 m0,s61,8192
s_nop 0
buffer_load_dwordx4 v16,s[32:35],s64 offen lds
s_waitcnt vmcnt(10)
s_add_u32 s64,s62,589824
s_add_u32 m0,s61,9216
s_nop 0
buffer_load_dwordx4 v16,s[32:35],s64 offen lds
s_add_u32 s64,s68,1572864
buffer_load_dword v31,v29,s[32:35],s64 offen
s_waitcnt vmcnt(10)
s_add_u32 s64,s62,655360
s_add_u32 m0,s61,10240
s_nop 0
buffer_load_dwordx4 v16,s[32:35],s64 offen lds
s_waitcnt vmcnt(10)
s_add_u32 s64,s62,720896
s_add_u32 m0,s61,11264
s_nop 0
buffer_load_dwordx4 v16,s[32:35],s64 offen lds
s_waitcnt vmcnt(10)
s_add_u32 s64,s62,786432
s_add_u32 m0,s61,12288
s_nop 0
buffer_load_dwordx4 v16,s[32:35],s64 offen lds
s_waitcnt vmcnt(10)
s_add_u32 s64,s62,851968
s_add_u32 m0,s61,13312
s_nop 0
buffer_load_dwordx4 v16,s[32:35],s64 offen lds
s_add_u32 s64,s68,1835008
buffer_load_dword v31,v29,s[32:35],s64 offen
s_waitcnt vmcnt(10)
s_add_u32 s64,s62,917504
s_add_u32 m0,s61,14336
s_nop 0
buffer_load_dwordx4 v16,s[32:35],s64 offen lds
s_waitcnt vmcnt(10)
s_add_u32 s64,s62,983040
s_add_u32 m0,s61,15360
s_nop 0
buffer_load_dwordx4 v16,s[32:35],s64 offen lds
s_waitcnt vmcnt(20)
ds_read_b64_tr_b16 a[128:129],v18 offset:16384
ds_read_b64_tr_b16 a[130:131],v18 offset:16512
ds_read_b64_tr_b16 a[132:133],v18 offset:20480
ds_read_b64_tr_b16 a[134:135],v18 offset:20608
ds_read_b64_tr_b16 a[136:137],v18 offset:16416
ds_read_b64_tr_b16 a[138:139],v18 offset:16544
ds_read_b64_tr_b16 a[140:141],v18 offset:20512
ds_read_b64_tr_b16 a[142:143],v18 offset:20640
ds_read_b64_tr_b16 a[144:145],v18 offset:16448
ds_read_b64_tr_b16 a[146:147],v18 offset:16576
ds_read_b64_tr_b16 a[148:149],v18 offset:20544
ds_read_b64_tr_b16 a[150:151],v18 offset:20672
ds_read_b64_tr_b16 a[152:153],v18 offset:16480
ds_read_b64_tr_b16 a[154:155],v18 offset:16608
ds_read_b64_tr_b16 a[156:157],v18 offset:20576
ds_read_b64_tr_b16 a[158:159],v18 offset:20704
s_waitcnt lgkmcnt(0)
ds_read_b64_tr_b16 a[192:193],v18 offset:24576
ds_read_b64_tr_b16 a[194:195],v18 offset:24704
ds_read_b64_tr_b16 a[196:197],v18 offset:28672
ds_read_b64_tr_b16 a[198:199],v18 offset:28800
ds_read_b64_tr_b16 a[200:201],v18 offset:24608
ds_read_b64_tr_b16 a[202:203],v18 offset:24736
ds_read_b64_tr_b16 a[204:205],v18 offset:28704
ds_read_b64_tr_b16 a[206:207],v18 offset:28832
ds_read_b64_tr_b16 a[208:209],v18 offset:24640
ds_read_b64_tr_b16 a[210:211],v18 offset:24768
ds_read_b64_tr_b16 a[212:213],v18 offset:28736
ds_read_b64_tr_b16 a[214:215],v18 offset:28864
ds_read_b64_tr_b16 a[216:217],v18 offset:24672
ds_read_b64_tr_b16 a[218:219],v18 offset:24800
ds_read_b64_tr_b16 a[220:221],v18 offset:28768
ds_read_b64_tr_b16 a[222:223],v18 offset:28896
s_waitcnt lgkmcnt(0)
s_add_u32 s64,s62,1048576
s_add_u32 m0,s61,16384
s_nop 0
buffer_load_dwordx4 v16,s[32:35],s64 offen lds
s_waitcnt vmcnt(10)
s_add_u32 s64,s62,1114112
s_add_u32 m0,s61,17408
s_nop 0
buffer_load_dwordx4 v16,s[32:35],s64 offen lds
s_add_u32 s64,s69,0
buffer_load_dword v31,v30,s[40:43],s64 offen
s_waitcnt vmcnt(10)
s_add_u32 s64,s62,1179648
s_add_u32 m0,s61,18432
s_nop 0
buffer_load_dwordx4 v16,s[32:35],s64 offen lds
s_waitcnt vmcnt(10)
s_add_u32 s64,s62,1245184
s_add_u32 m0,s61,19456
s_nop 0
buffer_load_dwordx4 v16,s[32:35],s64 offen lds
s_waitcnt vmcnt(10)
s_add_u32 s64,s62,1310720
s_add_u32 m0,s61,20480
s_nop 0
buffer_load_dwordx4 v16,s[32:35],s64 offen lds
s_waitcnt vmcnt(10)
s_add_u32 s64,s62,1376256
s_add_u32 m0,s61,21504
s_nop 0
buffer_load_dwordx4 v16,s[32:35],s64 offen lds
s_add_u32 s64,s69,131072
buffer_load_dword v31,v30,s[40:43],s64 offen
s_waitcnt vmcnt(10)
s_add_u32 s64,s62,1441792
s_add_u32 m0,s61,22528
s_nop 0
buffer_load_dwordx4 v16,s[32:35],s64 offen lds
s_waitcnt vmcnt(10)
s_add_u32 s64,s62,1507328
s_add_u32 m0,s61,23552
s_nop 0
buffer_load_dwordx4 v16,s[32:35],s64 offen lds
s_waitcnt vmcnt(10)
s_add_u32 s64,s62,1572864
s_add_u32 m0,s61,24576
s_nop 0
buffer_load_dwordx4 v16,s[32:35],s64 offen lds
s_waitcnt vmcnt(10)
s_add_u32 s64,s62,1638400
s_add_u32 m0,s61,25600
s_nop 0
buffer_load_dwordx4 v16,s[32:35],s64 offen lds
s_add_u32 s64,s69,262144
buffer_load_dword v31,v30,s[40:43],s64 offen
s_waitcnt vmcnt(10)
s_add_u32 s64,s62,1703936
s_add_u32 m0,s61,26624
s_nop 0
buffer_load_dwordx4 v16,s[32:35],s64 offen lds
s_waitcnt vmcnt(10)
s_add_u32 s64,s62,1769472
s_add_u32 m0,s61,27648
s_nop 0
buffer_load_dwordx4 v16,s[32:35],s64 offen lds
s_waitcnt vmcnt(10)
s_add_u32 s64,s62,1835008
s_add_u32 m0,s61,28672
s_nop 0
buffer_load_dwordx4 v16,s[32:35],s64 offen lds
s_waitcnt vmcnt(10)
s_add_u32 s64,s62,1900544
s_add_u32 m0,s61,29696
s_nop 0
buffer_load_dwordx4 v16,s[32:35],s64 offen lds
s_add_u32 s64,s69,393216
buffer_load_dword v31,v30,s[40:43],s64 offen
s_waitcnt vmcnt(10)
s_add_u32 s64,s62,1966080
s_add_u32 m0,s61,30720
s_nop 0
buffer_load_dwordx4 v16,s[32:35],s64 offen lds
s_waitcnt vmcnt(10)
s_add_u32 s64,s62,2031616
s_add_u32 m0,s61,31744
s_nop 0
buffer_load_dwordx4 v16,s[32:35],s64 offen lds
s_waitcnt vmcnt(20)
ds_read_b64_tr_b16 a[32:33],v18 offset:0
ds_read_b64_tr_b16 a[34:35],v18 offset:128
ds_read_b64_tr_b16 a[36:37],v18 offset:4096
ds_read_b64_tr_b16 a[38:39],v18 offset:4224
ds_read_b64_tr_b16 a[40:41],v18 offset:32
ds_read_b64_tr_b16 a[42:43],v18 offset:160
ds_read_b64_tr_b16 a[44:45],v18 offset:4128
ds_read_b64_tr_b16 a[46:47],v18 offset:4256
ds_read_b64_tr_b16 a[48:49],v18 offset:64
ds_read_b64_tr_b16 a[50:51],v18 offset:192
ds_read_b64_tr_b16 a[52:53],v18 offset:4160
ds_read_b64_tr_b16 a[54:55],v18 offset:4288
ds_read_b64_tr_b16 a[56:57],v18 offset:96
ds_read_b64_tr_b16 a[58:59],v18 offset:224
ds_read_b64_tr_b16 a[60:61],v18 offset:4192
ds_read_b64_tr_b16 a[62:63],v18 offset:4320
s_waitcnt lgkmcnt(0)
ds_read_b64_tr_b16 a[96:97],v18 offset:8192
ds_read_b64_tr_b16 a[98:99],v18 offset:8320
ds_read_b64_tr_b16 a[100:101],v18 offset:12288
ds_read_b64_tr_b16 a[102:103],v18 offset:12416
ds_read_b64_tr_b16 a[104:105],v18 offset:8224
ds_read_b64_tr_b16 a[106:107],v18 offset:8352
ds_read_b64_tr_b16 a[108:109],v18 offset:12320
ds_read_b64_tr_b16 a[110:111],v18 offset:12448
ds_read_b64_tr_b16 a[112:113],v18 offset:8256
ds_read_b64_tr_b16 a[114:115],v18 offset:8384
ds_read_b64_tr_b16 a[116:117],v18 offset:12352
ds_read_b64_tr_b16 a[118:119],v18 offset:12480
ds_read_b64_tr_b16 a[120:121],v18 offset:8288
ds_read_b64_tr_b16 a[122:123],v18 offset:8416
ds_read_b64_tr_b16 a[124:125],v18 offset:12384
ds_read_b64_tr_b16 a[126:127],v18 offset:12512
s_waitcnt lgkmcnt(0)
s_add_u32 s64,s63,0
s_add_u32 m0,s61,0
s_nop 0
buffer_load_dwordx4 v17,s[40:43],s64 offen lds
s_waitcnt vmcnt(10)
s_add_u32 s64,s63,32768
s_add_u32 m0,s61,1024
s_nop 0
buffer_load_dwordx4 v17,s[40:43],s64 offen lds
s_add_u32 s64,s69,524288
buffer_load_dword v31,v30,s[40:43],s64 offen
s_waitcnt vmcnt(10)
s_add_u32 s64,s63,65536
s_add_u32 m0,s61,2048
s_nop 0
buffer_load_dwordx4 v17,s[40:43],s64 offen lds
s_waitcnt vmcnt(10)
s_add_u32 s64,s63,98304
s_add_u32 m0,s61,3072
s_nop 0
buffer_load_dwordx4 v17,s[40:43],s64 offen lds
s_waitcnt vmcnt(10)
s_add_u32 s64,s63,131072
s_add_u32 m0,s61,4096
s_nop 0
buffer_load_dwordx4 v17,s[40:43],s64 offen lds
s_waitcnt vmcnt(10)
s_add_u32 s64,s63,163840
s_add_u32 m0,s61,5120
s_nop 0
buffer_load_dwordx4 v17,s[40:43],s64 offen lds
s_add_u32 s64,s69,655360
buffer_load_dword v31,v30,s[40:43],s64 offen
s_waitcnt vmcnt(10)
s_add_u32 s64,s63,196608
s_add_u32 m0,s61,6144
s_nop 0
buffer_load_dwordx4 v17,s[40:43],s64 offen lds
s_waitcnt vmcnt(10)
s_add_u32 s64,s63,229376
s_add_u32 m0,s61,7168
s_nop 0
buffer_load_dwordx4 v17,s[40:43],s64 offen lds
s_waitcnt vmcnt(10)
s_add_u32 s64,s63,262144
s_add_u32 m0,s61,8192
s_nop 0
buffer_load_dwordx4 v17,s[40:43],s64 offen lds
s_waitcnt vmcnt(10)
s_add_u32 s64,s63,294912
s_add_u32 m0,s61,9216
s_nop 0
buffer_load_dwordx4 v17,s[40:43],s64 offen lds
s_add_u32 s64,s69,786432
buffer_load_dword v31,v30,s[40:43],s64 offen
s_waitcnt vmcnt(10)
s_add_u32 s64,s63,327680
s_add_u32 m0,s61,10240
s_nop 0
buffer_load_dwordx4 v17,s[40:43],s64 offen lds
s_waitcnt vmcnt(10)
s_add_u32 s64,s63,360448
s_add_u32 m0,s61,11264
s_nop 0
buffer_load_dwordx4 v17,s[40:43],s64 offen lds
s_waitcnt vmcnt(10)
s_add_u32 s64,s63,393216
s_add_u32 m0,s61,12288
s_nop 0
buffer_load_dwordx4 v17,s[40:43],s64 offen lds
s_waitcnt vmcnt(10)
s_add_u32 s64,s63,425984
s_add_u32 m0,s61,13312
s_nop 0
buffer_load_dwordx4 v17,s[40:43],s64 offen lds
s_add_u32 s64,s69,917504
buffer_load_dword v31,v30,s[40:43],s64 offen
s_waitcnt vmcnt(10)
s_add_u32 s64,s63,458752
s_add_u32 m0,s61,14336
s_nop 0
buffer_load_dwordx4 v17,s[40:43],s64 offen lds
s_waitcnt vmcnt(10)
s_add_u32 s64,s63,491520
s_add_u32 m0,s61,15360
s_nop 0
buffer_load_dwordx4 v17,s[40:43],s64 offen lds
s_waitcnt vmcnt(20)
ds_read_b64_tr_b16 a[160:161],v18 offset:16384
ds_read_b64_tr_b16 a[162:163],v18 offset:16512
ds_read_b64_tr_b16 a[164:165],v18 offset:20480
ds_read_b64_tr_b16 a[166:167],v18 offset:20608
ds_read_b64_tr_b16 a[168:169],v18 offset:16416
ds_read_b64_tr_b16 a[170:171],v18 offset:16544
ds_read_b64_tr_b16 a[172:173],v18 offset:20512
ds_read_b64_tr_b16 a[174:175],v18 offset:20640
ds_read_b64_tr_b16 a[176:177],v18 offset:16448
ds_read_b64_tr_b16 a[178:179],v18 offset:16576
ds_read_b64_tr_b16 a[180:181],v18 offset:20544
ds_read_b64_tr_b16 a[182:183],v18 offset:20672
ds_read_b64_tr_b16 a[184:185],v18 offset:16480
ds_read_b64_tr_b16 a[186:187],v18 offset:16608
ds_read_b64_tr_b16 a[188:189],v18 offset:20576
ds_read_b64_tr_b16 a[190:191],v18 offset:20704
s_waitcnt lgkmcnt(0)
ds_read_b64_tr_b16 a[224:225],v18 offset:24576
ds_read_b64_tr_b16 a[226:227],v18 offset:24704
ds_read_b64_tr_b16 a[228:229],v18 offset:28672
ds_read_b64_tr_b16 a[230:231],v18 offset:28800
ds_read_b64_tr_b16 a[232:233],v18 offset:24608
ds_read_b64_tr_b16 a[234:235],v18 offset:24736
ds_read_b64_tr_b16 a[236:237],v18 offset:28704
ds_read_b64_tr_b16 a[238:239],v18 offset:28832
ds_read_b64_tr_b16 a[240:241],v18 offset:24640
ds_read_b64_tr_b16 a[242:243],v18 offset:24768
ds_read_b64_tr_b16 a[244:245],v18 offset:28736
ds_read_b64_tr_b16 a[246:247],v18 offset:28864
ds_read_b64_tr_b16 a[248:249],v18 offset:24672
ds_read_b64_tr_b16 a[250:251],v18 offset:24800
ds_read_b64_tr_b16 a[252:253],v18 offset:28768
ds_read_b64_tr_b16 a[254:255],v18 offset:28896
s_waitcnt lgkmcnt(0)
s_add_u32 s64,s63,524288
s_add_u32 m0,s61,16384
s_nop 0
buffer_load_dwordx4 v17,s[40:43],s64 offen lds
s_waitcnt vmcnt(10)
s_add_u32 s64,s63,557056
s_add_u32 m0,s61,17408
s_nop 0
buffer_load_dwordx4 v17,s[40:43],s64 offen lds
s_add_u32 s64,s68,0
buffer_load_dword v31,v29,s[36:39],s64 offen
s_waitcnt vmcnt(10)
s_add_u32 s64,s63,589824
s_add_u32 m0,s61,18432
s_nop 0
buffer_load_dwordx4 v17,s[40:43],s64 offen lds
s_waitcnt vmcnt(10)
s_add_u32 s64,s63,622592
s_add_u32 m0,s61,19456
s_nop 0
buffer_load_dwordx4 v17,s[40:43],s64 offen lds
s_waitcnt vmcnt(10)
s_add_u32 s64,s63,655360
s_add_u32 m0,s61,20480
s_nop 0
buffer_load_dwordx4 v17,s[40:43],s64 offen lds
s_waitcnt vmcnt(10)
s_add_u32 s64,s63,688128
s_add_u32 m0,s61,21504
s_nop 0
buffer_load_dwordx4 v17,s[40:43],s64 offen lds
s_add_u32 s64,s68,262144
buffer_load_dword v31,v29,s[36:39],s64 offen
s_waitcnt vmcnt(10)
s_add_u32 s64,s63,720896
s_add_u32 m0,s61,22528
s_nop 0
buffer_load_dwordx4 v17,s[40:43],s64 offen lds
s_waitcnt vmcnt(10)
s_add_u32 s64,s63,753664
s_add_u32 m0,s61,23552
s_nop 0
buffer_load_dwordx4 v17,s[40:43],s64 offen lds
s_waitcnt vmcnt(10)
s_add_u32 s64,s63,786432
s_add_u32 m0,s61,24576
s_nop 0
buffer_load_dwordx4 v17,s[40:43],s64 offen lds
s_waitcnt vmcnt(10)
s_add_u32 s64,s63,819200
s_add_u32 m0,s61,25600
s_nop 0
buffer_load_dwordx4 v17,s[40:43],s64 offen lds
s_add_u32 s64,s68,524288
buffer_load_dword v31,v29,s[36:39],s64 offen
s_waitcnt vmcnt(10)
s_add_u32 s64,s63,851968
s_add_u32 m0,s61,26624
s_nop 0
buffer_load_dwordx4 v17,s[40:43],s64 offen lds
s_waitcnt vmcnt(10)
s_add_u32 s64,s63,884736
s_add_u32 m0,s61,27648
s_nop 0
buffer_load_dwordx4 v17,s[40:43],s64 offen lds
s_waitcnt vmcnt(10)
s_add_u32 s64,s63,917504
s_add_u32 m0,s61,28672
s_nop 0
buffer_load_dwordx4 v17,s[40:43],s64 offen lds
s_waitcnt vmcnt(10)
s_add_u32 s64,s63,950272
s_add_u32 m0,s61,29696
s_nop 0
buffer_load_dwordx4 v17,s[40:43],s64 offen lds
s_add_u32 s64,s68,786432
buffer_load_dword v31,v29,s[36:39],s64 offen
s_waitcnt vmcnt(10)
s_add_u32 s64,s63,983040
s_add_u32 m0,s61,30720
s_nop 0
buffer_load_dwordx4 v17,s[40:43],s64 offen lds
s_waitcnt vmcnt(10)
s_add_u32 s64,s63,1015808
s_add_u32 m0,s61,31744
s_nop 0
buffer_load_dwordx4 v17,s[40:43],s64 offen lds
s_waitcnt vmcnt(20)
ds_read_b64_tr_b16 v[48:49],v27 offset:0
ds_read_b64_tr_b16 v[50:51],v27 offset:128
ds_read_b64_tr_b16 v[52:53],v27 offset:2048
ds_read_b64_tr_b16 v[54:55],v27 offset:2176
ds_read_b64_tr_b16 v[56:57],v27 offset:32
ds_read_b64_tr_b16 v[58:59],v27 offset:160
ds_read_b64_tr_b16 v[60:61],v27 offset:2080
ds_read_b64_tr_b16 v[62:63],v27 offset:2208
ds_read_b64_tr_b16 v[64:65],v27 offset:4096
ds_read_b64_tr_b16 v[66:67],v27 offset:4224
ds_read_b64_tr_b16 v[68:69],v27 offset:6144
ds_read_b64_tr_b16 v[70:71],v27 offset:6272
ds_read_b64_tr_b16 v[72:73],v27 offset:4128
ds_read_b64_tr_b16 v[74:75],v27 offset:4256
ds_read_b64_tr_b16 v[76:77],v27 offset:6176
ds_read_b64_tr_b16 v[78:79],v27 offset:6304
s_waitcnt lgkmcnt(0)
ds_read_b64_tr_b16 v[80:81],v27 offset:8192
ds_read_b64_tr_b16 v[82:83],v27 offset:8320
ds_read_b64_tr_b16 v[84:85],v27 offset:10240
ds_read_b64_tr_b16 v[86:87],v27 offset:10368
ds_read_b64_tr_b16 v[88:89],v27 offset:8224
ds_read_b64_tr_b16 v[90:91],v27 offset:8352
ds_read_b64_tr_b16 v[92:93],v27 offset:10272
ds_read_b64_tr_b16 v[94:95],v27 offset:10400
ds_read_b64_tr_b16 v[128:129],v27 offset:12288
ds_read_b64_tr_b16 v[130:131],v27 offset:12416
ds_read_b64_tr_b16 v[132:133],v27 offset:14336
ds_read_b64_tr_b16 v[134:135],v27 offset:14464
ds_read_b64_tr_b16 v[136:137],v27 offset:12320
ds_read_b64_tr_b16 v[138:139],v27 offset:12448
ds_read_b64_tr_b16 v[140:141],v27 offset:14368
ds_read_b64_tr_b16 v[142:143],v27 offset:14496
s_waitcnt lgkmcnt(0)
s_add_u32 s64,s62,0
s_add_u32 m0,s61,0
s_nop 0
buffer_load_dwordx4 v16,s[36:39],s64 offen lds
s_waitcnt vmcnt(10)
s_add_u32 s64,s62,65536
s_add_u32 m0,s61,1024
s_nop 0
buffer_load_dwordx4 v16,s[36:39],s64 offen lds
s_add_u32 s64,s68,1048576
buffer_load_dword v31,v29,s[36:39],s64 offen
s_waitcnt vmcnt(10)
s_add_u32 s64,s62,131072
s_add_u32 m0,s61,2048
s_nop 0
buffer_load_dwordx4 v16,s[36:39],s64 offen lds
s_waitcnt vmcnt(10)
s_add_u32 s64,s62,196608
s_add_u32 m0,s61,3072
s_nop 0
buffer_load_dwordx4 v16,s[36:39],s64 offen lds
s_waitcnt vmcnt(10)
s_add_u32 s64,s62,262144
s_add_u32 m0,s61,4096
s_nop 0
buffer_load_dwordx4 v16,s[36:39],s64 offen lds
s_waitcnt vmcnt(10)
s_add_u32 s64,s62,327680
s_add_u32 m0,s61,5120
s_nop 0
buffer_load_dwordx4 v16,s[36:39],s64 offen lds
s_add_u32 s64,s68,1310720
buffer_load_dword v31,v29,s[36:39],s64 offen
s_waitcnt vmcnt(10)
s_add_u32 s64,s62,393216
s_add_u32 m0,s61,6144
s_nop 0
buffer_load_dwordx4 v16,s[36:39],s64 offen lds
s_waitcnt vmcnt(10)
s_add_u32 s64,s62,458752
s_add_u32 m0,s61,7168
s_nop 0
buffer_load_dwordx4 v16,s[36:39],s64 offen lds
s_waitcnt vmcnt(10)
s_add_u32 s64,s62,524288
s_add_u32 m0,s61,8192
s_nop 0
buffer_load_dwordx4 v16,s[36:39],s64 offen lds
s_waitcnt vmcnt(10)
s_add_u32 s64,s62,589824
s_add_u32 m0,s61,9216
s_nop 0
buffer_load_dwordx4 v16,s[36:39],s64 offen lds
s_add_u32 s64,s68,1572864
buffer_load_dword v31,v29,s[36:39],s64 offen
s_waitcnt vmcnt(10)
s_add_u32 s64,s62,655360
s_add_u32 m0,s61,10240
s_nop 0
buffer_load_dwordx4 v16,s[36:39],s64 offen lds
s_waitcnt vmcnt(10)
s_add_u32 s64,s62,720896
s_add_u32 m0,s61,11264
s_nop 0
buffer_load_dwordx4 v16,s[36:39],s64 offen lds
s_waitcnt vmcnt(10)
s_add_u32 s64,s62,786432
s_add_u32 m0,s61,12288
s_nop 0
buffer_load_dwordx4 v16,s[36:39],s64 offen lds
s_waitcnt vmcnt(10)
s_add_u32 s64,s62,851968
s_add_u32 m0,s61,13312
s_nop 0
buffer_load_dwordx4 v16,s[36:39],s64 offen lds
s_add_u32 s64,s68,1835008
buffer_load_dword v31,v29,s[36:39],s64 offen
s_waitcnt vmcnt(10)
s_add_u32 s64,s62,917504
s_add_u32 m0,s61,14336
s_nop 0
buffer_load_dwordx4 v16,s[36:39],s64 offen lds
s_waitcnt vmcnt(10)
s_add_u32 s64,s62,983040
s_add_u32 m0,s61,15360
s_nop 0
buffer_load_dwordx4 v16,s[36:39],s64 offen lds
s_waitcnt vmcnt(20)
ds_read_b64_tr_b16 v[144:145],v27 offset:16384
ds_read_b64_tr_b16 v[146:147],v27 offset:16512
ds_read_b64_tr_b16 v[148:149],v27 offset:18432
ds_read_b64_tr_b16 v[150:151],v27 offset:18560
ds_read_b64_tr_b16 v[152:153],v27 offset:16416
ds_read_b64_tr_b16 v[154:155],v27 offset:16544
ds_read_b64_tr_b16 v[156:157],v27 offset:18464
ds_read_b64_tr_b16 v[158:159],v27 offset:18592
ds_read_b64_tr_b16 v[160:161],v27 offset:20480
ds_read_b64_tr_b16 v[162:163],v27 offset:20608
ds_read_b64_tr_b16 v[164:165],v27 offset:22528
ds_read_b64_tr_b16 v[166:167],v27 offset:22656
ds_read_b64_tr_b16 v[168:169],v27 offset:20512
ds_read_b64_tr_b16 v[170:171],v27 offset:20640
ds_read_b64_tr_b16 v[172:173],v27 offset:22560
ds_read_b64_tr_b16 v[174:175],v27 offset:22688
s_waitcnt lgkmcnt(0)
ds_read_b64_tr_b16 v[176:177],v27 offset:24576
ds_read_b64_tr_b16 v[178:179],v27 offset:24704
ds_read_b64_tr_b16 v[180:181],v27 offset:26624
ds_read_b64_tr_b16 v[182:183],v27 offset:26752
ds_read_b64_tr_b16 v[184:185],v27 offset:24608
ds_read_b64_tr_b16 v[186:187],v27 offset:24736
ds_read_b64_tr_b16 v[188:189],v27 offset:26656
ds_read_b64_tr_b16 v[190:191],v27 offset:26784
ds_read_b64_tr_b16 v[192:193],v27 offset:28672
ds_read_b64_tr_b16 v[194:195],v27 offset:28800
ds_read_b64_tr_b16 v[196:197],v27 offset:30720
ds_read_b64_tr_b16 v[198:199],v27 offset:30848
ds_read_b64_tr_b16 v[200:201],v27 offset:28704
ds_read_b64_tr_b16 v[202:203],v27 offset:28832
ds_read_b64_tr_b16 v[204:205],v27 offset:30752
ds_read_b64_tr_b16 v[206:207],v27 offset:30880
s_waitcnt lgkmcnt(0)
s_add_u32 s64,s62,1048576
s_add_u32 m0,s61,16384
s_nop 0
buffer_load_dwordx4 v16,s[36:39],s64 offen lds
s_waitcnt vmcnt(10)
s_add_u32 s64,s62,1114112
s_add_u32 m0,s61,17408
s_nop 0
buffer_load_dwordx4 v16,s[36:39],s64 offen lds
s_waitcnt vmcnt(10)
s_add_u32 s64,s62,1179648
s_add_u32 m0,s61,18432
s_nop 0
buffer_load_dwordx4 v16,s[36:39],s64 offen lds
s_waitcnt vmcnt(10)
s_add_u32 s64,s62,1245184
s_add_u32 m0,s61,19456
s_nop 0
buffer_load_dwordx4 v16,s[36:39],s64 offen lds
s_waitcnt vmcnt(10)
s_add_u32 s64,s62,1310720
s_add_u32 m0,s61,20480
s_nop 0
buffer_load_dwordx4 v16,s[36:39],s64 offen lds
s_waitcnt vmcnt(10)
s_add_u32 s64,s62,1376256
s_add_u32 m0,s61,21504
s_nop 0
buffer_load_dwordx4 v16,s[36:39],s64 offen lds
s_waitcnt vmcnt(10)
s_add_u32 s64,s62,1441792
s_add_u32 m0,s61,22528
s_nop 0
buffer_load_dwordx4 v16,s[36:39],s64 offen lds
s_waitcnt vmcnt(10)
s_add_u32 s64,s62,1507328
s_add_u32 m0,s61,23552
s_nop 0
buffer_load_dwordx4 v16,s[36:39],s64 offen lds
s_waitcnt vmcnt(10)
s_add_u32 s64,s62,1572864
s_add_u32 m0,s61,24576
s_nop 0
buffer_load_dwordx4 v16,s[36:39],s64 offen lds
s_waitcnt vmcnt(10)
s_add_u32 s64,s62,1638400
s_add_u32 m0,s61,25600
s_nop 0
buffer_load_dwordx4 v16,s[36:39],s64 offen lds
s_waitcnt vmcnt(10)
s_add_u32 s64,s62,1703936
s_add_u32 m0,s61,26624
s_nop 0
buffer_load_dwordx4 v16,s[36:39],s64 offen lds
s_waitcnt vmcnt(10)
s_add_u32 s64,s62,1769472
s_add_u32 m0,s61,27648
s_nop 0
buffer_load_dwordx4 v16,s[36:39],s64 offen lds
s_waitcnt vmcnt(10)
s_add_u32 s64,s62,1835008
s_add_u32 m0,s61,28672
s_nop 0
buffer_load_dwordx4 v16,s[36:39],s64 offen lds
s_waitcnt vmcnt(10)
s_add_u32 s64,s62,1900544
s_add_u32 m0,s61,29696
s_nop 0
buffer_load_dwordx4 v16,s[36:39],s64 offen lds
s_waitcnt vmcnt(10)
s_add_u32 s64,s62,1966080
s_add_u32 m0,s61,30720
s_nop 0
buffer_load_dwordx4 v16,s[36:39],s64 offen lds
s_waitcnt vmcnt(10)
s_add_u32 s64,s62,2031616
s_add_u32 m0,s61,31744
s_nop 0
buffer_load_dwordx4 v16,s[36:39],s64 offen lds
s_waitcnt vmcnt(16)
ds_read_b64_tr_b16 v[208:209],v19 offset:0
ds_read_b64_tr_b16 v[210:211],v19 offset:128
ds_read_b64_tr_b16 v[212:213],v19 offset:4096
ds_read_b64_tr_b16 v[214:215],v19 offset:4224
ds_read_b64_tr_b16 v[216:217],v19 offset:8
ds_read_b64_tr_b16 v[218:219],v19 offset:136
ds_read_b64_tr_b16 v[220:221],v19 offset:4104
ds_read_b64_tr_b16 v[222:223],v19 offset:4232
ds_read_b64_tr_b16 v[224:225],v19 offset:64
ds_read_b64_tr_b16 v[226:227],v19 offset:192
ds_read_b64_tr_b16 v[228:229],v19 offset:4160
ds_read_b64_tr_b16 v[230:231],v19 offset:4288
ds_read_b64_tr_b16 v[232:233],v19 offset:72
ds_read_b64_tr_b16 v[234:235],v19 offset:200
ds_read_b64_tr_b16 v[236:237],v19 offset:4168
ds_read_b64_tr_b16 v[238:239],v19 offset:4296
s_waitcnt lgkmcnt(0)
ds_read_b64_tr_b16 v[240:241],v19 offset:8192
ds_read_b64_tr_b16 v[242:243],v19 offset:8320
ds_read_b64_tr_b16 v[244:245],v19 offset:12288
ds_read_b64_tr_b16 v[246:247],v19 offset:12416
ds_read_b64_tr_b16 v[248:249],v19 offset:8200
ds_read_b64_tr_b16 v[250:251],v19 offset:8328
ds_read_b64_tr_b16 v[252:253],v19 offset:12296
ds_read_b64_tr_b16 v[254:255],v19 offset:12424
ds_read_b64_tr_b16 v[96:97],v19 offset:8256
ds_read_b64_tr_b16 v[98:99],v19 offset:8384
ds_read_b64_tr_b16 v[100:101],v19 offset:12352
ds_read_b64_tr_b16 v[102:103],v19 offset:12480
ds_read_b64_tr_b16 v[104:105],v19 offset:8264
ds_read_b64_tr_b16 v[106:107],v19 offset:8392
ds_read_b64_tr_b16 v[108:109],v19 offset:12360
ds_read_b64_tr_b16 v[110:111],v19 offset:12488
s_waitcnt lgkmcnt(0)
s_waitcnt vmcnt(0)
ds_write_b128 v7,v[96:99] offset:0
ds_write_b128 v7,v[100:103] offset:1024
ds_write_b128 v7,v[104:107] offset:2048
ds_write_b128 v7,v[108:111] offset:3072
s_waitcnt lgkmcnt(0)
ds_read_b64_tr_b16 v[96:97],v19 offset:16384
ds_read_b64_tr_b16 v[98:99],v19 offset:16512
ds_read_b64_tr_b16 v[100:101],v19 offset:20480
ds_read_b64_tr_b16 v[102:103],v19 offset:20608
ds_read_b64_tr_b16 v[104:105],v19 offset:16392
ds_read_b64_tr_b16 v[106:107],v19 offset:16520
ds_read_b64_tr_b16 v[108:109],v19 offset:20488
ds_read_b64_tr_b16 v[110:111],v19 offset:20616
s_waitcnt lgkmcnt(0)
ds_write_b128 v7,v[96:99] offset:4096
ds_write_b128 v7,v[100:103] offset:5120
ds_write_b128 v7,v[104:107] offset:6144
ds_write_b128 v7,v[108:111] offset:7168
s_waitcnt lgkmcnt(0)
ds_read_b64_tr_b16 v[96:97],v19 offset:16448
ds_read_b64_tr_b16 v[98:99],v19 offset:16576
ds_read_b64_tr_b16 v[100:101],v19 offset:20544
ds_read_b64_tr_b16 v[102:103],v19 offset:20672
ds_read_b64_tr_b16 v[104:105],v19 offset:16456
ds_read_b64_tr_b16 v[106:107],v19 offset:16584
ds_read_b64_tr_b16 v[108:109],v19 offset:20552
ds_read_b64_tr_b16 v[110:111],v19 offset:20680
s_waitcnt lgkmcnt(0)
ds_write_b128 v7,v[96:99] offset:8192
ds_write_b128 v7,v[100:103] offset:9216
ds_write_b128 v7,v[104:107] offset:10240
ds_write_b128 v7,v[108:111] offset:11264
s_waitcnt lgkmcnt(0)
ds_read_b64_tr_b16 v[96:97],v19 offset:24576
ds_read_b64_tr_b16 v[98:99],v19 offset:24704
ds_read_b64_tr_b16 v[100:101],v19 offset:28672
ds_read_b64_tr_b16 v[102:103],v19 offset:28800
ds_read_b64_tr_b16 v[104:105],v19 offset:24584
ds_read_b64_tr_b16 v[106:107],v19 offset:24712
ds_read_b64_tr_b16 v[108:109],v19 offset:28680
ds_read_b64_tr_b16 v[110:111],v19 offset:28808
s_waitcnt lgkmcnt(0)
ds_write_b128 v7,v[96:99] offset:12288
ds_write_b128 v7,v[100:103] offset:13312
ds_write_b128 v7,v[104:107] offset:14336
ds_write_b128 v7,v[108:111] offset:15360
s_waitcnt lgkmcnt(0)
ds_read_b64_tr_b16 v[112:113],v19 offset:24640
ds_read_b64_tr_b16 v[114:115],v19 offset:24768
ds_read_b64_tr_b16 v[116:117],v19 offset:28736
ds_read_b64_tr_b16 v[118:119],v19 offset:28864
ds_read_b64_tr_b16 v[120:121],v19 offset:24648
ds_read_b64_tr_b16 v[122:123],v19 offset:24776
ds_read_b64_tr_b16 v[124:125],v19 offset:28744
ds_read_b64_tr_b16 v[126:127],v19 offset:28872
s_waitcnt lgkmcnt(0)
ds_write_b128 v7,v[112:115] offset:16384
ds_write_b128 v7,v[116:119] offset:17408
ds_write_b128 v7,v[120:123] offset:18432
ds_write_b128 v7,v[124:127] offset:19456
ds_write_b128 v7,v[48:51] offset:20480
ds_write_b128 v7,v[52:55] offset:21504
ds_write_b128 v7,v[56:59] offset:22528
ds_write_b128 v7,v[60:63] offset:23552
ds_write_b128 v7,v[64:67] offset:24576
ds_write_b128 v7,v[68:71] offset:25600
ds_write_b128 v7,v[72:75] offset:26624
ds_write_b128 v7,v[76:79] offset:27648
ds_write_b128 v7,v[80:83] offset:28672
ds_write_b128 v7,v[84:87] offset:29696
ds_write_b128 v7,v[88:91] offset:30720
ds_write_b128 v7,v[92:95] offset:31744
s_waitcnt lgkmcnt(0)
v_and_b32 v23,1,v21
v_mov_b32 v1,0x4444
v_mov_b32 v24,0xeeee
v_cmp_eq_u32 vcc,1,v23
s_nop 1
v_cndmask_b32 v1,v1,v24,vcc
v_lshlrev_b32 v23,1,v22
v_sub_u32 v23,v21,v23
v_mov_b32 v5,0
v_mov_b32 v24,0x3f80
v_cmp_eq_u32 vcc,0,v23
s_nop 1
v_cndmask_b32 v5,v5,v24,vcc
v_mov_b32 v24,0x3f800000
v_cmp_eq_u32 vcc,1,v23
s_nop 1
v_cndmask_b32 v5,v5,v24,vcc
s_and_b32 s64,s50,1
s_lshl_b32 s64,s64,11
v_lshl_add_u32 v127,v20,2,s64
v_and_b32 v23,7,v21
v_lshrrev_b32 v24,3,v21
v_lshlrev_b32 v25,8,v24
v_lshl_add_u32 v25,v22,6,v25
v_lshl_add_u32 v4,v23,2,v25
v_lshrrev_b32 v25,1,v22
v_lshl_add_u32 v25,v25,3,v23
v_lshlrev_b32 v25,5,v25
v_and_b32 v26,1,v22
v_lshl_add_u32 v6,v26,4,v25
v_lshl_add_u32 v27,v22,3,v23
v_lshlrev_b32 v27,4,v27
s_mov_b32 s80,0x3e0293ee
s_mov_b32 s81,0xfffffffe
s_mov_b32 s84,0x00ff00ff
s_mov_b32 s85,0x00ff00ff
s_mov_b32 s86,-1
s_mov_b32 s87,0
s_cmp_gt_u32 s50,1
s_cselect_b32 s82,0xff00ff00,-1
s_cselect_b32 s83,0xff00ff00,0
s_lshl_b32 m0,s50,8
s_cmp_gt_u32 s50,1
s_cbranch_scc1 w23_100245
v_lshl_add_u32 v2,v24,9,v27
v_lshrrev_b32 v25,1,v22
v_lshl_add_u32 v25,v25,3,v23
v_lshlrev_b32 v25,4,v25
v_lshl_add_u32 v26,v26,1,v24
v_lshl_add_u32 v3,v26,2,v25
v_add_u32 v3,1024 + 256,v3
v_cndmask_b32 v6,2.0,v6,s[84:85]
v_mov_b32 v8,0x3f803f80
v_mov_b32 v9,0x3f803f80
v_mov_b32 v10,0x3f803f80
v_mov_b32 v11,0x3f803f80
v_mov_b32 v12,0x3f803f80
v_mov_b32 v13,0
v_mov_b32 v14,0
v_mov_b32 v15,0
s_branch jn_100246
w23_100245:
s_sub_u32 s64,s50,2
s_mul_i32 s64,s64,4160
v_lshrrev_b32 v25,1,v22
v_mul_u32_u24 v25,2080,v25
v_and_b32 v28,1,v23
v_mul_u32_u24 v28,1040,v28
v_add_u32 v25,v25,v28
v_lshrrev_b32 v28,1,v23
v_lshl_add_u32 v25,v28,6,v25
v_lshl_add_u32 v25,v26,5,v25
v_mul_u32_u24 v28,8448,v24
v_add3_u32 v2,v25,v28,s64
v_cndmask_b32 v3,2.0,v27,s[84:85]
v_mov_b32 v8,-1
v_mov_b32 v9,-1
v_mov_b32 v10,-1
v_mov_b32 v11,-1
jn_100246:
s_mov_b32 s92,s2
s_and_b32 s93,s3,0xffff
s_mov_b32 s94,0x100
s_mov_b32 s95,0x20000
v_mbcnt_lo_u32_b32 v16,-1,0
v_mbcnt_hi_u32_b32 v16,-1,v16
v_mov_b32 v18,0
v_cmp_eq_u32 vcc,22,v16
s_nop 1
v_cndmask_b32 v18,v18,63,vcc
v_cmp_eq_u32 vcc,21,v16
s_nop 1
v_cndmask_b32 v18,v18,1,vcc
v_and_b32 v19,1,v16
v_cmp_eq_u32 vcc,1,v19
v_mov_b32 v19,8192
s_nop 0
v_cndmask_b32 v19,-1,v19,vcc
v_min_u32 v16,31,v16
v_lshlrev_b32 v16,2,v16
s_sub_u32 s66,s88,64
s_cmp_lg_u32 s50,0
s_cbranch_scc1 vot_100253
vpoll_100249:
buffer_load_dword v17,v16,s[92:95],s66 offen sc1
s_waitcnt vmcnt(0)
s_cmp_lg_u32 s56,2
s_cbranch_scc1 vck_100250
v_cmp_eq_u32 vcc,v17,v19
s_and_b32 s64,vcc_lo,0xffff
s_cmp_eq_u32 s64,65535
s_cbranch_scc1 vck_100250
s_mov_b32 s65,0
v_readlane_b32 s64,v17,1
s_lshr_b32 s64,s64,8
s_add_u32 s65,s65,s64
v_readlane_b32 s64,v17,3
s_lshr_b32 s64,s64,8
s_add_u32 s65,s65,s64
v_readlane_b32 s64,v17,5
s_lshr_b32 s64,s64,8
s_add_u32 s65,s65,s64
v_readlane_b32 s64,v17,7
s_lshr_b32 s64,s64,8
s_add_u32 s65,s65,s64
v_readlane_b32 s64,v17,9
s_lshr_b32 s64,s64,8
s_add_u32 s65,s65,s64
v_readlane_b32 s64,v17,11
s_lshr_b32 s64,s64,8
s_add_u32 s65,s65,s64
v_readlane_b32 s64,v17,13
s_lshr_b32 s64,s64,8
s_add_u32 s65,s65,s64
v_readlane_b32 s64,v17,15
s_lshr_b32 s64,s64,8
s_add_u32 s65,s65,s64
s_cmp_ge_u32 s65,256
s_cbranch_scc1 vok_100252
s_branch vrt_100251
vck_100250:
v_cmp_gt_u32 vcc,v18,v17
s_cbranch_vccz vok_100252
vrt_100251:
s_sleep 8
s_sub_u32 s90,s90,1
s_cmp_gt_i32 s90,0
s_cbranch_scc1 vpoll_100249
vok_100252:
ds_write_b32 v16,v17 offset:1792
s_waitcnt lgkmcnt(0)
vot_100253:
s_barrier
v_add_u32 v18,1792,v16
ds_read_b32 v17,v18
s_waitcnt lgkmcnt(0)
s_cmp_lg_u32 s56,2
s_cbranch_scc1 vfin_100254
v_cmp_eq_u32 vcc,v17,v19
s_and_b32 s64,vcc_lo,0xffff
s_cmp_eq_u32 s64,65535
s_cbranch_scc1 vfin_100254
s_mov_b32 s65,0
v_readlane_b32 s64,v17,1
s_lshr_b32 s64,s64,8
s_add_u32 s65,s65,s64
v_readlane_b32 s64,v17,3
s_lshr_b32 s64,s64,8
s_add_u32 s65,s65,s64
v_readlane_b32 s64,v17,5
s_lshr_b32 s64,s64,8
s_add_u32 s65,s65,s64
v_readlane_b32 s64,v17,7
s_lshr_b32 s64,s64,8
s_add_u32 s65,s65,s64
v_readlane_b32 s64,v17,9
s_lshr_b32 s64,s64,8
s_add_u32 s65,s65,s64
v_readlane_b32 s64,v17,11
s_lshr_b32 s64,s64,8
s_add_u32 s65,s65,s64
v_readlane_b32 s64,v17,13
s_lshr_b32 s64,s64,8
s_add_u32 s65,s65,s64
v_readlane_b32 s64,v17,15
s_lshr_b32 s64,s64,8
s_add_u32 s65,s65,s64
s_cmp_ge_u32 s65,256
s_cbranch_scc1 fl_fb
vfin_100254:
s_and_b32 s56,s56,1
s_mov_b32 s67,0
v_readlane_b32 s65,v17,21
s_and_b32 s65,s65,2
s_lshl_b32 s67,s65,12
s_lshl_b32 s64,s58,14
s_lshl_b32 s65,s50,12
s_add_u32 s70,s64,s65
s_add_u32 s70,s70,134217728
s_lshl_b32 s65,s59,9
s_add_u32 s71,s64,s65
s_add_u32 s71,s71,134217728
s_xor_b32 s64,s58,1
s_lshl_b32 s64,s64,15
s_lshr_b32 s65,s50,1
s_lshl_b32 s65,s65,14
s_add_u32 s64,s64,s65
s_and_b32 s65,s50,1
s_lshl_b32 s65,s65,12
s_add_u32 s64,s64,s65
s_add_u32 s72,s64,s67
s_add_u32 s72,s72,142606336
s_lshl_b32 s64,s58,15
s_lshr_b32 s65,s59,4
s_lshl_b32 s65,s65,14
s_add_u32 s64,s64,s65
s_and_b32 s65,s59,15
s_lshl_b32 s65,s65,9
s_add_u32 s64,s64,s65
s_add_u32 s73,s64,s67
s_add_u32 s73,s73,142606336
s_cmp_eq_u32 s50,1
s_cselect_b32 s54,2048 - 256,0
s_sub_u32 s71,s71,s54
s_lshl_b32 s64,s58,15
s_lshl_b32 s65,s50,13
s_add_u32 s74,s64,s65
s_add_u32 s74,s74,134250496
s_lshl_b32 s64,s57,10
s_and_b32 s65,s50,1
s_lshl_b32 s65,s65,9
s_cmp_gt_u32 s50,1
s_cselect_b32 s65,0,s65
s_add_u32 s75,s64,s65
s_add_u32 s75,s75,134250496
s_lshl_b32 s64,s57,12
s_and_b32 s65,s64,0xffffe000
s_cmp_eq_u32 s50,3
s_cselect_b32 s66,1536,0
s_add_u32 s64,s64,s66
s_cmp_gt_u32 s50,1
s_cselect_b32 s76,s64,s65
s_add_u32 s76,s76,134479872
s_lshl_b32 s64,s57,14
s_and_b32 s65,s50,1
s_lshl_b32 s66,s65,11
s_add_u32 s77,s64,s66
s_cmp_gt_u32 s50,1
s_cselect_b32 s66,0,4096
s_add_u32 s77,s77,s66
s_add_u32 s77,s77,0
s_lshl_b32 s66,s65,9
s_add_u32 s66,s66,1024 + 128
s_lshl_b32 s65,s65,7
s_cmp_gt_u32 s50,1
s_cselect_b32 s65,s65,s66
s_add_u32 s78,s64,s65
s_add_u32 s78,s78,67108736
s_lshl_b32 s64,s57,6
s_add_u32 s68,s64,s67
s_add_u32 s69,s68,s64
s_add_u32 s69,s69,138428416
s_lshl_b32 s64,s50,14
s_add_u32 s69,s69,s64
s_and_b32 s64,s50,1
s_lshl_b32 s64,s64,11
s_sub_u32 s69,s69,s64
s_add_u32 s68,s68,138412032
s_mov_b32 s79,0
s_mov_b32 s91,0
s_mov_b32 s90,100000
s_barrier
s_cmp_eq_u32 s56,1
s_cbranch_scc1 recslow_100247
s_mov_b32 s55,0
s_cmp_lg_u32 s50,0
s_cbranch_scc1 np0_100257
v_mov_b32 v120,0
v_mov_b32 v121,0
s_cmp_lg_u32 s58,0
s_cbranch_scc1 z1_100258
v_lshrrev_b32 v124,6,v127
v_lshlrev_b32 v124,12,v124
v_bfe_u32 v125,v127,1,5
v_add_u32 v124,v124,v125
s_lshl_b32 s64,s59,6
buffer_load_ushort v120,v124,s[44:47],s64 offen
buffer_load_ushort v122,v124,s[44:47],s64 offen offset:32
buffer_load_ushort v121,v124,s[44:47],s64 offen offset:2048
buffer_load_ushort v123,v124,s[44:47],s64 offen offset:2080
s_waitcnt vmcnt(0)
v_lshl_or_b32 v120,v122,16,v120
v_lshl_or_b32 v121,v123,16,v121
v_min_u32 v120,s81,v120
v_min_u32 v121,s81,v121
z1_100258:
buffer_store_dword v120,v4,s[20:23],s71 offen
buffer_store_dword v121,v4,s[20:23],s71 offen offset:32
buffer_store_dword v120,v4,s[20:23],s73 offen sc1
buffer_store_dword v121,v4,s[20:23],s73 offen offset:32 sc1
np0_100257:
v_lshrrev_b32 v124,2,v0
v_bfe_u32 v125,v124,5,1
v_mul_u32_u24 v125,2048,v125
s_and_b32 s64,s50,1
s_lshl_b32 s64,s64,5
v_add3_u32 v4,v124,v125,s64
s_add_u32 s64,s79,0
s_cmp_gt_u32 s91,s64
s_cbranch_scc0 flp_100261
fok_100260:
s_add_u32 s64,s79,0
s_lshl_b32 s65,s64,12
s_and_b32 s65,s65,0x2000
s_xor_b32 s65,s65,s67
s_lshl_b32 s64,s64,20
s_add_u32 s65,s65,s64
s_add_u32 s99,s65,s77
buffer_load_dwordx4 v[104:107],v0,s[20:23],s99 offen
buffer_load_dwordx4 v[108:111],v0,s[20:23],s99 offen offset:1024
s_waitcnt vmcnt(0)
s_mov_b32 s92,s70
s_mov_b32 s93,s72
s_mov_b32 s94,s76
s_add_u32 s95,s94,4096
s_mov_b32 s96,s74
s_add_u32 s97,s96,4096
s_mov_b32 s98,s75
s_barrier
v_mov_b32 v96,v104
v_mov_b32 v97,v105
v_mov_b32 v98,v106
v_mov_b32 v99,v107
v_mov_b32 v100,v108
v_mov_b32 v101,v109
v_mov_b32 v102,v110
v_mov_b32 v103,v111
v_mov_b32 v48,0
v_mov_b32 v49,0
v_mov_b32 v50,0
v_mov_b32 v51,0
v_mov_b32 v52,0
v_mov_b32 v53,0
v_mov_b32 v54,0
v_mov_b32 v55,0
v_mov_b32 v56,0
v_mov_b32 v57,0
v_mov_b32 v58,0
v_mov_b32 v59,0
v_mov_b32 v60,0
v_mov_b32 v61,0
v_mov_b32 v62,0
v_mov_b32 v63,0
v_mov_b32 v64,0
v_mov_b32 v65,0
v_mov_b32 v66,0
v_mov_b32 v67,0
v_mov_b32 v68,0
v_mov_b32 v69,0
v_mov_b32 v70,0
v_mov_b32 v71,0
v_mov_b32 v72,0
v_mov_b32 v73,0
v_mov_b32 v74,0
v_mov_b32 v75,0
v_mov_b32 v76,0
v_mov_b32 v77,0
v_mov_b32 v78,0
v_mov_b32 v79,0
v_mov_b32 v80,0
v_mov_b32 v81,0
v_mov_b32 v82,0
v_mov_b32 v83,0
v_mov_b32 v84,0
v_mov_b32 v85,0
v_mov_b32 v86,0
v_mov_b32 v87,0
v_mov_b32 v88,0
v_mov_b32 v89,0
v_mov_b32 v90,0
v_mov_b32 v91,0
v_mov_b32 v92,0
v_mov_b32 v93,0
v_mov_b32 v94,0
v_mov_b32 v95,0
s_cmp_gt_u32 s50,1
s_cbranch_scc0 loop0_100259x
loop_100255:
v_mov_b32 v125,0
s_nop 1
v_mfma_f32_16x16x1_4b_f32 v[48:63],v125,v125,0
v_mfma_f32_16x16x1_4b_f32 v[64:79],v125,v125,0
v_mfma_f32_16x16x1_4b_f32 v[80:95],v125,v125,0
s_nop 15
s_nop 15
s_nop 15
s_nop 15
buffer_load_dwordx4 v[16:19],v0,s[20:23],s92 offen offset:0 sc1
s_nop 7
buffer_load_dwordx4 v[20:23],v0,s[20:23],s92 offen offset:1024 sc1
s_nop 7
buffer_load_dwordx4 v[24:27],v0,s[20:23],s92 offen offset:2048 sc1
s_nop 7
buffer_load_dwordx4 v[28:31],v0,s[20:23],s92 offen offset:3072 sc1
v_mov_b32 v96,v104
v_mov_b32 v97,v105
v_mov_b32 v98,v106
v_mov_b32 v99,v107
v_mov_b32 v100,v108
v_mov_b32 v101,v109
v_mov_b32 v102,v110
v_mov_b32 v103,v111
s_branch ja_100262
loop0_100259x:
v_mov_b32 v125,0
s_nop 1
v_mfma_f32_16x16x1_4b_f32 v[48:63],v125,v125,0
v_mfma_f32_16x16x1_4b_f32 v[64:79],v125,v125,0
v_mfma_f32_16x16x1_4b_f32 v[80:95],v125,v125,0
s_nop 15
s_nop 11
buffer_load_dwordx4 v[16:19],v0,s[20:23],s92 offen offset:0 sc1
s_nop 7
buffer_load_dwordx4 v[20:23],v0,s[20:23],s92 offen offset:1024 sc1
s_nop 7
buffer_load_dwordx4 v[24:27],v0,s[20:23],s92 offen offset:2048 sc1
s_nop 7
buffer_load_dwordx4 v[28:31],v0,s[20:23],s92 offen offset:3072 sc1
ja_100262:
s_max_u32 s66,s79,1
s_sub_u32 s66,s66,1
v_mov_b32 v126,s66
s_add_u32 s64,s66,0
s_lshl_b32 s65,s64,12
s_and_b32 s65,s65,0x2000
s_xor_b32 s65,s65,s67
s_lshl_b32 s64,s64,20
s_add_u32 s65,s65,s64
s_add_u32 s101,s65,s78
s_cmp_eq_u32 s79,63
s_cbranch_scc1 last_100256
s_add_u32 s64,s79,1
s_lshl_b32 s65,s64,12
s_and_b32 s65,s65,0x2000
s_xor_b32 s65,s65,s67
s_lshl_b32 s64,s64,20
s_add_u32 s65,s65,s64
s_add_u32 s99,s65,s77
s_waitcnt vmcnt(3)
v_max3_u32 v124,v16,v17,v18
v_max_u32 v124,v124,v19
v_cmp_eq_u32 vcc,-1,v124
v_cndmask_b32 v120,2.0,v0,s[82:83]
v_cndmask_b32 v121,2.0,v127,s[86:87]
s_cbranch_vccnz flb_100289
seg_100265:
segb_100273:
v_smfmac_f32_16x16x64_bf16 v[48:51],v[16:19],a[0:7],v1
buffer_load_dword v125,off,s[20:23],s92 sc1
v_smfmac_f32_16x16x64_bf16 v[52:55],v[16:19],a[8:15],v1
buffer_load_dwordx4 v[32:35],v0,s[20:23],s93 offen offset:0 sc1
v_smfmac_f32_16x16x64_bf16 v[56:59],v[16:19],a[16:23],v1
s_waitcnt vmcnt(4)
v_max3_u32 v124,v20,v21,v22
v_smfmac_f32_16x16x64_bf16 v[60:63],v[16:19],a[24:31],v1
v_max_u32 v124,v124,v23
v_smfmac_f32_16x16x64_bf16 v[64:67],v[16:19],a[32:39],v1
v_cmp_eq_u32 vcc,-1,v124
v_smfmac_f32_16x16x64_bf16 v[68:71],v[16:19],a[40:47],v1
v_smfmac_f32_16x16x64_bf16 v[72:75],v[16:19],a[48:55],v1
s_cbranch_vccnz fl_100282
seg_100266:
v_smfmac_f32_16x16x64_bf16 v[76:79],v[16:19],a[56:63],v1
segb_100274:
v_smfmac_f32_16x16x64_bf16 v[48:51],v[20:23],a[64:71],v1
buffer_load_dword v125,off,s[20:23],s92 sc1
v_smfmac_f32_16x16x64_bf16 v[52:55],v[20:23],a[72:79],v1
buffer_load_dwordx4 v[36:39],v0,s[20:23],s93 offen offset:1024 sc1
v_smfmac_f32_16x16x64_bf16 v[56:59],v[20:23],a[80:87],v1
s_waitcnt vmcnt(5)
v_max3_u32 v124,v24,v25,v26
v_smfmac_f32_16x16x64_bf16 v[60:63],v[20:23],a[88:95],v1
v_max_u32 v124,v124,v27
v_smfmac_f32_16x16x64_bf16 v[64:67],v[20:23],a[96:103],v1
v_cmp_eq_u32 vcc,-1,v124
v_smfmac_f32_16x16x64_bf16 v[68:71],v[20:23],a[104:111],v1
v_smfmac_f32_16x16x64_bf16 v[72:75],v[20:23],a[112:119],v1
s_cbranch_vccnz fl_100283
seg_100267:
v_smfmac_f32_16x16x64_bf16 v[76:79],v[20:23],a[120:127],v1
segb_100275:
v_smfmac_f32_16x16x64_bf16 v[48:51],v[24:27],a[128:135],v1
buffer_load_dword v125,off,s[20:23],s92 sc1
v_smfmac_f32_16x16x64_bf16 v[52:55],v[24:27],a[136:143],v1
buffer_load_dwordx4 v[40:43],v0,s[20:23],s93 offen offset:2048 sc1
v_smfmac_f32_16x16x64_bf16 v[56:59],v[24:27],a[144:151],v1
buffer_load_dwordx4 v[44:47],v0,s[20:23],s93 offen offset:3072 sc1
s_waitcnt vmcnt(7)
v_max3_u32 v124,v28,v29,v30
v_smfmac_f32_16x16x64_bf16 v[60:63],v[24:27],a[152:159],v1
v_max_u32 v124,v124,v31
v_smfmac_f32_16x16x64_bf16 v[64:67],v[24:27],a[160:167],v1
v_cmp_eq_u32 vcc,-1,v124
v_smfmac_f32_16x16x64_bf16 v[68:71],v[24:27],a[168:175],v1
v_smfmac_f32_16x16x64_bf16 v[72:75],v[24:27],a[176:183],v1
s_cbranch_vccnz fl_100284
seg_100268:
v_smfmac_f32_16x16x64_bf16 v[76:79],v[24:27],a[184:191],v1
segb_100276:
v_smfmac_f32_16x16x64_bf16 v[48:51],v[28:31],a[192:199],v1
buffer_load_dword v125,off,s[20:23],s92 sc1
v_smfmac_f32_16x16x64_bf16 v[52:55],v[28:31],a[200:207],v1
v_smfmac_f32_16x16x64_bf16 v[56:59],v[28:31],a[208:215],v1
s_waitcnt vmcnt(6)
v_max3_u32 v124,v32,v33,v34
v_smfmac_f32_16x16x64_bf16 v[60:63],v[28:31],a[216:223],v1
v_max_u32 v124,v124,v35
v_smfmac_f32_16x16x64_bf16 v[64:67],v[28:31],a[224:231],v1
v_cmp_eq_u32 vcc,-1,v124
v_smfmac_f32_16x16x64_bf16 v[68:71],v[28:31],a[232:239],v1
v_smfmac_f32_16x16x64_bf16 v[72:75],v[28:31],a[240:247],v1
s_cbranch_vccnz fl_100285
seg_100269:
v_smfmac_f32_16x16x64_bf16 v[76:79],v[28:31],a[248:255],v1
segb_100277:
v_smfmac_f32_16x16x64_bf16 v[48:51],v[32:35],a[0:7],v1
buffer_load_dword v125,off,s[20:23],s92 sc1
v_smfmac_f32_16x16x64_bf16 v[52:55],v[32:35],a[8:15],v1
buffer_store_dwordx4 v[112:115],v120,s[20:23],s101 offen sc1
v_smfmac_f32_16x16x64_bf16 v[56:59],v[32:35],a[16:23],v1
buffer_store_dword v126,v121,s[20:23],s69 offen sc1
s_waitcnt vmcnt(7)
v_max3_u32 v124,v36,v37,v38
v_smfmac_f32_16x16x64_bf16 v[60:63],v[32:35],a[24:31],v1
v_max_u32 v124,v124,v39
v_smfmac_f32_16x16x64_bf16 v[64:67],v[32:35],a[32:39],v1
v_cmp_eq_u32 vcc,-1,v124
v_smfmac_f32_16x16x64_bf16 v[68:71],v[32:35],a[40:47],v1
v_smfmac_f32_16x16x64_bf16 v[72:75],v[32:35],a[48:55],v1
s_cbranch_vccnz fl_100286
seg_100270:
v_smfmac_f32_16x16x64_bf16 v[76:79],v[32:35],a[56:63],v1
segb_100278:
v_smfmac_f32_16x16x64_bf16 v[48:51],v[36:39],a[64:71],v1
buffer_load_dword v125,off,s[20:23],s92 sc1
s_waitcnt vmcnt(5)
v_max3_u32 v124,v40,v41,v42
v_smfmac_f32_16x16x64_bf16 v[52:55],v[36:39],a[72:79],v1
v_max3_u32 v124,v124,v43,v44
v_smfmac_f32_16x16x64_bf16 v[56:59],v[36:39],a[80:87],v1
v_max3_u32 v124,v124,v45,v46
v_smfmac_f32_16x16x64_bf16 v[60:63],v[36:39],a[88:95],v1
v_max_u32 v124,v124,v47
v_smfmac_f32_16x16x64_bf16 v[64:67],v[36:39],a[96:103],v1
v_cmp_eq_u32 vcc,-1,v124
v_smfmac_f32_16x16x64_bf16 v[68:71],v[36:39],a[104:111],v1
v_smfmac_f32_16x16x64_bf16 v[72:75],v[36:39],a[112:119],v1
s_cbranch_vccnz fl_100287
seg_100271:
v_smfmac_f32_16x16x64_bf16 v[76:79],v[36:39],a[120:127],v1
segb_100279:
v_smfmac_f32_16x16x64_bf16 v[48:51],v[40:43],a[128:135],v1
s_add_u32 s64,s79,1
s_cmp_gt_u32 s91,s64
s_cbranch_scc0 flp_100264
fok_100263:
v_smfmac_f32_16x16x64_bf16 v[52:55],v[40:43],a[136:143],v1
buffer_load_dwordx4 v[104:107],v0,s[20:23],s99 offen
buffer_load_dwordx4 v[108:111],v0,s[20:23],s99 offen offset:1024
v_smfmac_f32_16x16x64_bf16 v[48:51],v[44:47],a[192:199],v1
buffer_load_dword v126,off,s[20:23],s68 sc1
s_add_u32 s64,s79,2
v_smfmac_f32_16x16x64_bf16 v[52:55],v[44:47],a[200:207],v1
s_and_b32 s64,s64,3
s_lshl_b32 s100,s64,19
s_nop 0
v_add_f32 v48,v48,v49
v_smfmac_f32_16x16x64_bf16 v[56:59],v[40:43],a[144:151],v1
ds_write_addtid_b32 v48 offset:0
v_add_f32 v50,v50,v51
v_smfmac_f32_16x16x64_bf16 v[60:63],v[40:43],a[152:159],v1
ds_write_addtid_b32 v50 offset:1040
v_add_f32 v52,v52,v53
v_smfmac_f32_16x16x64_bf16 v[56:59],v[44:47],a[208:215],v1
ds_write_addtid_b32 v52 offset:2080
v_add_f32 v54,v54,v55
v_smfmac_f32_16x16x64_bf16 v[60:63],v[44:47],a[216:223],v1
ds_write_addtid_b32 v54 offset:3120
s_nop 1
v_add_f32 v56,v56,v57
v_smfmac_f32_16x16x64_bf16 v[64:67],v[40:43],a[160:167],v1
ds_write_addtid_b32 v56 offset:4160
v_add_f32 v58,v58,v59
v_smfmac_f32_16x16x64_bf16 v[68:71],v[40:43],a[168:175],v1
ds_write_addtid_b32 v58 offset:5200
v_add_f32 v60,v60,v61
v_smfmac_f32_16x16x64_bf16 v[64:67],v[44:47],a[224:231],v1
ds_write_addtid_b32 v60 offset:6240
v_add_f32 v62,v62,v63
v_smfmac_f32_16x16x64_bf16 v[68:71],v[44:47],a[232:239],v1
ds_write_addtid_b32 v62 offset:7280
s_nop 1
v_add_f32 v64,v64,v65
v_smfmac_f32_16x16x64_bf16 v[72:75],v[40:43],a[176:183],v1
ds_write_addtid_b32 v64 offset:8448
v_add_f32 v66,v66,v67
v_smfmac_f32_16x16x64_bf16 v[76:79],v[40:43],a[184:191],v1
ds_write_addtid_b32 v66 offset:9488
v_add_f32 v68,v68,v69
v_smfmac_f32_16x16x64_bf16 v[72:75],v[44:47],a[240:247],v1
ds_write_addtid_b32 v68 offset:10528
v_add_f32 v70,v70,v71
v_smfmac_f32_16x16x64_bf16 v[76:79],v[44:47],a[248:255],v1
ds_write_addtid_b32 v70 offset:11568
s_nop 1
v_add_f32 v72,v72,v73
v_smfmac_f32_16x16x64_bf16 v[80:83],v[16:19],v[208:215],v1
ds_write_addtid_b32 v72 offset:12608
v_add_f32 v74,v74,v75
v_smfmac_f32_16x16x64_bf16 v[80:83],v[32:35],v[208:215],v1
ds_write_addtid_b32 v74 offset:13648
v_add_f32 v76,v76,v77
ds_write_addtid_b32 v76 offset:14688
v_add_f32 v78,v78,v79
ds_write_addtid_b32 v78 offset:15728
doneA_100298:
s_waitcnt lgkmcnt(0)
s_barrier
s_cmp_gt_u32 s50,1
s_cbranch_scc1 w23_100299
v_smfmac_f32_16x16x64_bf16 v[84:87],v[16:19],v[216:223],v1
v_smfmac_f32_16x16x64_bf16 v[84:87],v[32:35],v[216:223],v1
v_smfmac_f32_16x16x64_bf16 v[88:91],v[16:19],v[224:231],v1
v_smfmac_f32_16x16x64_bf16 v[88:91],v[32:35],v[224:231],v1
v_smfmac_f32_16x16x64_bf16 v[92:95],v[16:19],v[232:239],v1
ds_read_b128 v[48:51],v7 offset:0
ds_read_b128 v[52:55],v7 offset:1024
v_smfmac_f32_16x16x64_bf16 v[92:95],v[32:35],v[232:239],v1
ds_read_b128 v[56:59],v7 offset:2048
ds_read_b128 v[60:63],v7 offset:3072
v_smfmac_f32_16x16x64_bf16 v[80:83],v[20:23],v[240:247],v1
ds_read_b128 v[64:67],v7 offset:4096
ds_read_b128 v[68:71],v7 offset:5120
v_smfmac_f32_16x16x64_bf16 v[80:83],v[36:39],v[240:247],v1
ds_read_b128 v[72:75],v7 offset:6144
ds_read_b128 v[76:79],v7 offset:7168
v_smfmac_f32_16x16x64_bf16 v[84:87],v[20:23],v[248:255],v1
v_smfmac_f32_16x16x64_bf16 v[84:87],v[36:39],v[248:255],v1
s_waitcnt lgkmcnt(6)
v_smfmac_f32_16x16x64_bf16 v[88:91],v[20:23],v[48:55],v1
v_smfmac_f32_16x16x64_bf16 v[88:91],v[36:39],v[48:55],v1
ds_read_b128 v[48:51],v7 offset:8192
ds_read_b128 v[52:55],v7 offset:9216
s_waitcnt lgkmcnt(6)
v_smfmac_f32_16x16x64_bf16 v[92:95],v[20:23],v[56:63],v1
v_smfmac_f32_16x16x64_bf16 v[92:95],v[36:39],v[56:63],v1
ds_read_b128 v[56:59],v7 offset:10240
ds_read_b128 v[60:63],v7 offset:11264
s_waitcnt lgkmcnt(6)
v_smfmac_f32_16x16x64_bf16 v[80:83],v[24:27],v[64:71],v1
v_smfmac_f32_16x16x64_bf16 v[80:83],v[40:43],v[64:71],v1
ds_read_b128 v[64:67],v7 offset:12288
ds_read_b128 v[68:71],v7 offset:13312
s_waitcnt lgkmcnt(6)
v_smfmac_f32_16x16x64_bf16 v[84:87],v[24:27],v[72:79],v1
v_smfmac_f32_16x16x64_bf16 v[84:87],v[40:43],v[72:79],v1
ds_read_b128 v[72:75],v7 offset:14336
ds_read_b128 v[76:79],v7 offset:15360
s_waitcnt lgkmcnt(6)
v_smfmac_f32_16x16x64_bf16 v[88:91],v[24:27],v[48:55],v1
v_smfmac_f32_16x16x64_bf16 v[88:91],v[40:43],v[48:55],v1
ds_read_b128 v[48:51],v7 offset:16384
ds_read_b128 v[52:55],v7 offset:17408
s_waitcnt lgkmcnt(6)
v_smfmac_f32_16x16x64_bf16 v[92:95],v[24:27],v[56:63],v1
v_smfmac_f32_16x16x64_bf16 v[92:95],v[40:43],v[56:63],v1
ds_read_b128 v[56:59],v7 offset:18432
ds_read_b128 v[60:63],v7 offset:19456
s_waitcnt lgkmcnt(6)
v_smfmac_f32_16x16x64_bf16 v[80:83],v[28:31],v[64:71],v1
v_smfmac_f32_16x16x64_bf16 v[80:83],v[44:47],v[64:71],v1
s_waitcnt lgkmcnt(4)
v_smfmac_f32_16x16x64_bf16 v[84:87],v[28:31],v[72:79],v1
v_smfmac_f32_16x16x64_bf16 v[84:87],v[44:47],v[72:79],v1
s_waitcnt lgkmcnt(2)
v_smfmac_f32_16x16x64_bf16 v[88:91],v[28:31],v[48:55],v1
v_add_f32 v80,v80,v81
v_smfmac_f32_16x16x64_bf16 v[88:91],v[44:47],v[48:55],v1
v_add_f32 v82,v82,v83
s_waitcnt lgkmcnt(0)
v_smfmac_f32_16x16x64_bf16 v[92:95],v[28:31],v[56:63],v1
v_cvt_pk_bf16_f32 v80,v80,v82
v_smfmac_f32_16x16x64_bf16 v[92:95],v[44:47],v[56:63],v1
ds_write_addtid_b32 v80 offset:16896
v_add_f32 v84,v84,v85
buffer_load_dwordx4 v[16:19],v2,s[20:23],s94 offen offset:0 sc1
buffer_load_dwordx4 v[32:35],v2,s[20:23],s94 offen offset:1536 sc1
buffer_load_dwordx4 v[20:23],v2,s[20:23],s95 offen offset:0 sc1
buffer_load_dwordx4 v[36:39],v2,s[20:23],s95 offen offset:1536 sc1
buffer_load_dword v120,v3,s[20:23],s94 offen offset:0 sc1
buffer_load_dword v121,v3,s[20:23],s94 offen offset:1536 sc1
buffer_load_dword v122,v3,s[20:23],s95 offen offset:0 sc1
buffer_load_dword v123,v3,s[20:23],s95 offen offset:1536 sc1
v_add_f32 v86,v86,v87
v_cvt_pk_bf16_f32 v84,v84,v86
v_add_f32 v88,v88,v89
v_add_f32 v90,v90,v91
v_cvt_pk_bf16_f32 v88,v88,v90
v_add_f32 v92,v92,v93
v_add_f32 v94,v94,v95
v_cvt_pk_bf16_f32 v92,v92,v94
ds_write_addtid_b32 v84 offset:17920
ds_write_addtid_b32 v88 offset:18944
ds_write_addtid_b32 v92 offset:19968
sp_100302:
s_waitcnt vmcnt(6)
v_pk_add_f32 v[16:17],v[16:17],v[32:33]
v_pk_add_f32 v[18:19],v[18:19],v[34:35]
s_waitcnt vmcnt(4)
v_pk_add_f32 v[20:21],v[20:21],v[36:37]
v_pk_add_f32 v[22:23],v[22:23],v[38:39]
v_pk_add_f32 v[16:17],v[16:17],v[20:21]
v_pk_add_f32 v[18:19],v[18:19],v[22:23]
v_max3_f32 v124,v16,v17,v18
v_pk_add_f32 v[20:21],v[16:17],v[18:19]
s_waitcnt vmcnt(0)
v_pk_add_f32 v[120:121],v[120:121],v[122:123]
v_add_f32 v120,v120,v121
v_max3_f32 v124,v124,v19,v120
v_add_f32 v20,v20,v120
v_cmp_u_f32 vcc,v20,v21
v_max_f32_dpp v124,v124,v124 row_ror:8 row_mask:0xf bank_mask:0xf
v_mov_b32 v125,v124
s_cbranch_vccnz srt_100304
sok_100303:
s_nop 0
v_permlane16_swap_b32 v125,v124
v_max_f32 v124,v124,v125
v_mov_b32 v125,v124
s_nop 1
v_permlane32_swap_b32 v125,v124
v_max_f32 v124,v124,v125
v_mul_f32 v124,s80,v124
v_fma_f32 v16,v16,s80,-v124
v_fma_f32 v17,v17,s80,-v124
v_fma_f32 v18,v18,s80,-v124
v_fma_f32 v19,v19,s80,-v124
v_fma_f32 v120,v120,s80,-v124
s_waitcnt lgkmcnt(0)
s_barrier
ds_read2st64_b32 v[112:113],v127 offset0:66 offset1:67
ds_read2st64_b32 v[114:115],v127 offset0:68 offset1:69
ds_read2st64_b32 v[116:117],v127 offset0:70 offset1:71
ds_read2st64_b32 v[118:119],v127 offset0:72 offset1:73
v_exp_f32 v16,v16
v_exp_f32 v17,v17
v_exp_f32 v18,v18
v_exp_f32 v19,v19
v_cvt_pk_bf16_f32 v48,v16,v17
v_cvt_pk_bf16_f32 v49,v18,v19
v_exp_f32 v120,v120
v_mov_b32_dpp v50,v48 row_ror:8 row_mask:0xf bank_mask:0xf
v_mov_b32_dpp v51,v49 row_ror:8 row_mask:0xf bank_mask:0xf
v_mov_b32_dpp v121,v120 row_ror:8 row_mask:0xf bank_mask:0xf
v_cvt_pk_bf16_f32 v52,v120,v121
v_mfma_f32_16x16x32_bf16 v[64:67],v[8:11],v[48:51],0
v_mov_b32 v53,v52
v_mfma_f32_16x16x32_bf16 v[56:59],v[96:99],v[48:51],0
v_mov_b32 v54,v52
v_mov_b32 v55,v52
v_mfma_f32_16x16x32_bf16 v[60:63],v[100:103],v[48:51],0
v_mfma_f32_16x16x32_bf16 v[64:67],v[12:15],v[52:55],v[64:67]
s_waitcnt lgkmcnt(0)
v_mfma_f32_16x16x32_bf16 v[56:59],v[112:115],v[52:55],v[56:59]
v_mfma_f32_16x16x32_bf16 v[60:63],v[116:119],v[52:55],v[60:63]
s_nop 0
v_rcp_f32 v66,v64
s_nop 2
v_pk_mul_f32 v[56:57],v[56:57],v[66:67] op_sel_hi:[1,0]
v_pk_mul_f32 v[58:59],v[58:59],v[66:67] op_sel_hi:[1,0]
s_nop 0
v_pk_mul_f32 v[60:61],v[60:61],v[66:67] op_sel_hi:[1,0]
v_pk_mul_f32 v[62:63],v[62:63],v[66:67] op_sel_hi:[1,0]
v_cvt_pk_bf16_f32 v120,v56,v57
v_cvt_pk_bf16_f32 v121,v58,v59
v_cvt_pk_bf16_f32 v122,v60,v61
v_cvt_pk_bf16_f32 v123,v62,v63
buffer_store_dwordx4 v[120:123],v6,s[20:23],s98 offen
s_barrier
ds_read_b128 v[48:51],v7 offset:20480
ds_read_b128 v[52:55],v7 offset:21504
ds_read_b128 v[56:59],v7 offset:22528
ds_read_b128 v[60:63],v7 offset:23552
ds_read_b128 v[64:67],v7 offset:24576
ds_read_b128 v[68:71],v7 offset:25600
ds_read_b128 v[72:75],v7 offset:26624
ds_read_b128 v[76:79],v7 offset:27648
ds_read_b128 v[80:83],v7 offset:28672
ds_read_b128 v[84:87],v7 offset:29696
ds_read_b128 v[88:91],v7 offset:30720
ds_read_b128 v[92:95],v7 offset:31744
v_mov_b32 v96,0
v_mov_b32 v97,0
v_mov_b32 v98,0
v_mov_b32 v99,0
v_mov_b32 v100,0
v_mov_b32 v101,0
v_mov_b32 v102,0
v_mov_b32 v103,0
s_nop 11
buffer_load_dwordx4 v[16:19],v0,s[20:23],s96 offen offset:0 sc1
v_mov_b32 v120,v5
v_mov_b32 v121,v5
v_mov_b32 v122,v5
v_mov_b32 v123,v5
s_nop 1
v_mfma_f32_16x16x32_bf16 v[112:115],v[120:123],v[112:115],0
buffer_load_dwordx4 v[20:23],v0,s[20:23],s96 offen offset:1024 sc1
v_mfma_f32_16x16x32_bf16 v[116:119],v[120:123],v[116:119],0
s_add_u32 s79,s79,1
s_and_b32 s64,s79,3
s_lshl_b32 s64,s64,19
s_lshl_b32 s65,s79,8
buffer_load_dwordx4 v[24:27],v0,s[20:23],s96 offen offset:2048 sc1
s_and_b32 s65,s65,0x2000
s_lshl_b32 s66,s79,16
s_xor_b32 s88,s73,s65
s_add_u32 s88,s88,s66
s_sub_u32 s88,s88,s54
s_add_u32 s89,s71,s64
s_add_u32 s92,s70,s64
s_xor_b32 s93,s72,s65
buffer_load_dwordx4 v[28:31],v0,s[20:23],s96 offen offset:3072 sc1
s_add_u32 s93,s93,s66
s_add_u32 s94,s76,s64
s_add_u32 s95,s94,4096
s_add_u32 s98,s75,s64
s_add_u32 s60,s74,s64
v_cvt_pk_bf16_f32 v112,v112,v113
v_cvt_pk_bf16_f32 v113,v114,v115
v_cvt_pk_bf16_f32 v114,v116,v117
buffer_load_dwordx4 v[32:35],v0,s[20:23],s97 offen offset:0 sc1
v_cvt_pk_bf16_f32 v115,v118,v119
s_nop 6
buffer_load_dwordx4 v[36:39],v0,s[20:23],s97 offen offset:1024 sc1
s_nop 7
buffer_load_dwordx4 v[40:43],v0,s[20:23],s97 offen offset:2048 sc1
s_nop 7
buffer_load_dwordx4 v[44:47],v0,s[20:23],s97 offen offset:3072 sc1
s_branch ogo_100300
w23_100299:
ds_read_b128 v[48:51],v2 offset:0
ds_read_b128 v[52:55],v2 offset:256
ds_read_b128 v[56:59],v2 offset:512
ds_read_b128 v[60:63],v2 offset:768
ds_read_b128 v[64:67],v2 offset:16
ds_read_b128 v[68:71],v2 offset:272
ds_read_b128 v[72:75],v2 offset:528
ds_read_b128 v[76:79],v2 offset:784
s_waitcnt lgkmcnt(6)
v_pk_add_f32 v[48:49],v[48:49],v[52:53]
v_pk_add_f32 v[50:51],v[50:51],v[54:55]
s_waitcnt lgkmcnt(4)
v_pk_add_f32 v[56:57],v[56:57],v[60:61]
v_pk_add_f32 v[58:59],v[58:59],v[62:63]
v_pk_add_f32 v[48:49],v[48:49],v[56:57]
v_pk_add_f32 v[50:51],v[50:51],v[58:59]
v_cvt_pk_bf16_f32 v112,v48,v49
v_cvt_pk_bf16_f32 v113,v50,v51
s_waitcnt lgkmcnt(2)
v_pk_add_f32 v[64:65],v[64:65],v[68:69]
v_pk_add_f32 v[66:67],v[66:67],v[70:71]
s_waitcnt lgkmcnt(0)
v_pk_add_f32 v[72:73],v[72:73],v[76:77]
v_pk_add_f32 v[74:75],v[74:75],v[78:79]
v_pk_add_f32 v[64:65],v[64:65],v[72:73]
v_pk_add_f32 v[66:67],v[66:67],v[74:75]
v_cvt_pk_bf16_f32 v114,v64,v65
v_cvt_pk_bf16_f32 v115,v66,v67
s_nop 1
v_mfma_f32_16x16x32_bf16 v[116:119],v[96:99],v[112:115],0
v_mfma_f32_16x16x32_bf16 v[120:123],v[100:103],v[112:115],0
v_mfma_f32_16x16x32_bf16 v[12:15],v[112:115],v[112:115],0
ds_read_b128 v[48:51],v7 offset:0
ds_read_b128 v[52:55],v7 offset:1024
ds_read_b128 v[56:59],v7 offset:2048
ds_read_b128 v[60:63],v7 offset:3072
ds_read_b128 v[64:67],v7 offset:4096
buffer_store_dwordx4 v[116:119],v3,s[20:23],s94 offen
buffer_store_dwordx4 v[120:123],v3,s[20:23],s94 offen offset:512
s_nop 0
buffer_store_dwordx4 v[12:15],v3,s[20:23],s94 offen offset:1024
ds_read_b128 v[68:71],v7 offset:5120
ds_read_b128 v[72:75],v7 offset:6144
ds_read_b128 v[76:79],v7 offset:7168
v_smfmac_f32_16x16x64_bf16 v[84:87],v[16:19],v[216:223],v1
v_smfmac_f32_16x16x64_bf16 v[84:87],v[32:35],v[216:223],v1
v_smfmac_f32_16x16x64_bf16 v[88:91],v[16:19],v[224:231],v1
v_smfmac_f32_16x16x64_bf16 v[88:91],v[32:35],v[224:231],v1
v_smfmac_f32_16x16x64_bf16 v[92:95],v[16:19],v[232:239],v1
v_smfmac_f32_16x16x64_bf16 v[92:95],v[32:35],v[232:239],v1
v_smfmac_f32_16x16x64_bf16 v[80:83],v[20:23],v[240:247],v1
v_smfmac_f32_16x16x64_bf16 v[80:83],v[36:39],v[240:247],v1
v_smfmac_f32_16x16x64_bf16 v[84:87],v[20:23],v[248:255],v1
v_smfmac_f32_16x16x64_bf16 v[84:87],v[36:39],v[248:255],v1
s_waitcnt lgkmcnt(6)
v_smfmac_f32_16x16x64_bf16 v[88:91],v[20:23],v[48:55],v1
v_smfmac_f32_16x16x64_bf16 v[88:91],v[36:39],v[48:55],v1
ds_read_b128 v[48:51],v7 offset:8192
ds_read_b128 v[52:55],v7 offset:9216
s_waitcnt lgkmcnt(6)
v_smfmac_f32_16x16x64_bf16 v[92:95],v[20:23],v[56:63],v1
v_smfmac_f32_16x16x64_bf16 v[92:95],v[36:39],v[56:63],v1
ds_read_b128 v[56:59],v7 offset:10240
ds_read_b128 v[60:63],v7 offset:11264
s_waitcnt lgkmcnt(6)
v_smfmac_f32_16x16x64_bf16 v[80:83],v[24:27],v[64:71],v1
v_smfmac_f32_16x16x64_bf16 v[80:83],v[40:43],v[64:71],v1
ds_read_b128 v[64:67],v7 offset:12288
ds_read_b128 v[68:71],v7 offset:13312
s_waitcnt lgkmcnt(6)
v_smfmac_f32_16x16x64_bf16 v[84:87],v[24:27],v[72:79],v1
v_smfmac_f32_16x16x64_bf16 v[84:87],v[40:43],v[72:79],v1
ds_read_b128 v[72:75],v7 offset:14336
ds_read_b128 v[76:79],v7 offset:15360
s_waitcnt lgkmcnt(6)
v_smfmac_f32_16x16x64_bf16 v[88:91],v[24:27],v[48:55],v1
v_smfmac_f32_16x16x64_bf16 v[88:91],v[40:43],v[48:55],v1
ds_read_b128 v[48:51],v7 offset:16384
ds_read_b128 v[52:55],v7 offset:17408
s_waitcnt lgkmcnt(6)
v_smfmac_f32_16x16x64_bf16 v[92:95],v[24:27],v[56:63],v1
v_smfmac_f32_16x16x64_bf16 v[92:95],v[40:43],v[56:63],v1
ds_read_b128 v[56:59],v7 offset:18432
ds_read_b128 v[60:63],v7 offset:19456
s_waitcnt lgkmcnt(6)
v_smfmac_f32_16x16x64_bf16 v[80:83],v[28:31],v[64:71],v1
v_smfmac_f32_16x16x64_bf16 v[80:83],v[44:47],v[64:71],v1
s_waitcnt lgkmcnt(4)
v_smfmac_f32_16x16x64_bf16 v[84:87],v[28:31],v[72:79],v1
v_smfmac_f32_16x16x64_bf16 v[84:87],v[44:47],v[72:79],v1
s_waitcnt lgkmcnt(2)
v_smfmac_f32_16x16x64_bf16 v[88:91],v[28:31],v[48:55],v1
v_add_f32 v80,v80,v81
v_smfmac_f32_16x16x64_bf16 v[88:91],v[44:47],v[48:55],v1
v_add_f32 v82,v82,v83
s_waitcnt lgkmcnt(0)
v_smfmac_f32_16x16x64_bf16 v[92:95],v[28:31],v[56:63],v1
v_cvt_pk_bf16_f32 v80,v80,v82
v_smfmac_f32_16x16x64_bf16 v[92:95],v[44:47],v[56:63],v1
ds_write_addtid_b32 v80 offset:16896
v_add_f32 v84,v84,v85
v_add_f32 v86,v86,v87
v_cvt_pk_bf16_f32 v84,v84,v86
v_add_f32 v88,v88,v89
v_add_f32 v90,v90,v91
v_cvt_pk_bf16_f32 v88,v88,v90
s_nop 0
v_add_f32 v92,v92,v93
v_add_f32 v94,v94,v95
v_cvt_pk_bf16_f32 v92,v92,v94
ds_write_addtid_b32 v84 offset:17920
ds_write_addtid_b32 v88 offset:18944
ds_write_addtid_b32 v92 offset:19968
s_waitcnt lgkmcnt(0)
s_barrier
ds_read_b128 v[48:51],v7 offset:20480
ds_read_b128 v[52:55],v7 offset:21504
ds_read_b128 v[56:59],v7 offset:22528
ds_read_b128 v[60:63],v7 offset:23552
ds_read_b128 v[64:67],v7 offset:24576
ds_read_b128 v[68:71],v7 offset:25600
ds_read_b128 v[72:75],v7 offset:26624
ds_read_b128 v[76:79],v7 offset:27648
ds_read_b128 v[80:83],v7 offset:28672
ds_read_b128 v[84:87],v7 offset:29696
ds_read_b128 v[88:91],v7 offset:30720
ds_read_b128 v[92:95],v7 offset:31744
s_add_u32 s65,s76,s100
s_add_u32 s66,s75,s100
s_add_u32 s64,s71,s100
s_cmp_eq_u32 s50,2
s_cselect_b32 s66,s66,s64
buffer_store_dwordx4 v[8:11],v0,s[20:23],s65 offen
s_cmp_eq_u32 s50,2
s_cselect_b32 exec_hi,-1,0
buffer_store_dwordx4 v[8:11],v0,s[20:23],s66 offen
s_mov_b32 exec_hi,0
buffer_store_dwordx4 v[8:11],v0,s[20:23],s65 offen offset:1024
s_mov_b64 exec,-1
v_mov_b32 v96,0
v_mov_b32 v97,0
v_mov_b32 v98,0
v_mov_b32 v99,0
v_mov_b32 v100,0
v_mov_b32 v101,0
v_mov_b32 v102,0
v_mov_b32 v103,0
s_barrier
s_nop 15
s_nop 15
s_nop 7
buffer_load_dwordx4 v[16:19],v0,s[20:23],s96 offen offset:0 sc1
s_add_u32 s79,s79,1
s_and_b32 s64,s79,3
s_lshl_b32 s64,s64,19
s_lshl_b32 s65,s79,8
s_and_b32 s65,s65,0x2000
s_lshl_b32 s66,s79,16
s_xor_b32 s88,s73,s65
s_add_u32 s88,s88,s66
buffer_load_dwordx4 v[20:23],v0,s[20:23],s96 offen offset:1024 sc1
s_sub_u32 s88,s88,s54
s_add_u32 s89,s71,s64
s_add_u32 s92,s70,s64
s_xor_b32 s93,s72,s65
s_add_u32 s93,s93,s66
s_add_u32 s94,s76,s64
s_add_u32 s95,s94,4096
s_add_u32 s98,s75,s64
buffer_load_dwordx4 v[24:27],v0,s[20:23],s96 offen offset:2048 sc1
s_add_u32 s60,s74,s64
s_nop 6
buffer_load_dwordx4 v[28:31],v0,s[20:23],s96 offen offset:3072 sc1
s_nop 7
buffer_load_dwordx4 v[32:35],v0,s[20:23],s97 offen offset:0 sc1
s_nop 7
buffer_load_dwordx4 v[36:39],v0,s[20:23],s97 offen offset:1024 sc1
s_nop 7
buffer_load_dwordx4 v[40:43],v0,s[20:23],s97 offen offset:2048 sc1
s_nop 7
buffer_load_dwordx4 v[44:47],v0,s[20:23],s97 offen offset:3072 sc1
ogo_100300:
s_waitcnt lgkmcnt(0)
s_waitcnt vmcnt(6)
v_max3_u32 v124,v16,v17,v18
v_max3_u32 v124,v124,v19,v20
v_max3_u32 v124,v124,v21,v22
v_max_u32 v124,v124,v23
v_cmp_eq_u32 vcc,-1,v124
s_cbranch_vccnz of_100305
v_smfmac_f32_16x16x64_bf16 v[96:99],v[16:19],v[48:55],v1
v_smfmac_f32_16x16x64_bf16 v[100:103],v[16:19],v[56:63],v1
v_smfmac_f32_16x16x64_bf16 v[96:99],v[20:23],v[64:71],v1
v_smfmac_f32_16x16x64_bf16 v[100:103],v[20:23],v[72:79],v1
v_readfirstlane_b32 s91,v126
s_waitcnt vmcnt(4)
v_max3_u32 v124,v24,v25,v26
v_max3_u32 v124,v124,v27,v28
v_max3_u32 v124,v124,v29,v30
v_max_u32 v124,v124,v31
v_cmp_eq_u32 vcc,-1,v124
s_cbranch_vccnz of_100306
v_smfmac_f32_16x16x64_bf16 v[96:99],v[24:27],v[80:87],v1
v_smfmac_f32_16x16x64_bf16 v[100:103],v[24:27],v[88:95],v1
v_smfmac_f32_16x16x64_bf16 v[96:99],v[28:31],v[128:135],v1
v_smfmac_f32_16x16x64_bf16 v[100:103],v[28:31],v[136:143],v1
s_waitcnt vmcnt(2)
v_max3_u32 v124,v32,v33,v34
v_max3_u32 v124,v124,v35,v36
v_max3_u32 v124,v124,v37,v38
v_max_u32 v124,v124,v39
v_cmp_eq_u32 vcc,-1,v124
s_cbranch_vccnz of_100307
v_smfmac_f32_16x16x64_bf16 v[96:99],v[32:35],v[144:151],v1
v_smfmac_f32_16x16x64_bf16 v[100:103],v[32:35],v[152:159],v1
v_smfmac_f32_16x16x64_bf16 v[96:99],v[36:39],v[160:167],v1
v_smfmac_f32_16x16x64_bf16 v[100:103],v[36:39],v[168:175],v1
s_waitcnt vmcnt(1)
v_max3_u32 v124,v40,v41,v42
v_max_u32 v124,v124,v43
v_cmp_eq_u32 vcc,-1,v124
s_cbranch_vccnz of_100308
v_smfmac_f32_16x16x64_bf16 v[96:99],v[40:43],v[176:183],v1
v_smfmac_f32_16x16x64_bf16 v[100:103],v[40:43],v[184:191],v1
s_waitcnt vmcnt(0)
v_max3_u32 v124,v44,v45,v46
v_max_u32 v124,v124,v47
v_cmp_eq_u32 vcc,-1,v124
s_cbranch_vccnz of_100309
v_smfmac_f32_16x16x64_bf16 v[96:99],v[44:47],v[192:199],v1
v_smfmac_f32_16x16x64_bf16 v[100:103],v[44:47],v[200:207],v1
oback_100316:
s_nop 4
v_add_f32 v96,v96,v97
v_add_f32 v98,v98,v99
s_nop 0
v_add_f32 v100,v100,v101
v_add_f32 v102,v102,v103
ds_write_addtid_b32 v96 offset:20992
ds_write_addtid_b32 v98 offset:23072
ds_write_addtid_b32 v100 offset:22016
ds_write_addtid_b32 v102 offset:24096
s_mov_b32 s96,s60
s_add_u32 s97,s60,4096
s_cmp_gt_u32 s50,1
s_waitcnt lgkmcnt(0)
s_barrier
s_cbranch_scc1 loop_100255
ds_read2st64_b32 v[48:49],v4 offset0:82 offset1:86
ds_read2st64_b32 v[50:51],v4 offset0:83 offset1:87
ds_read2st64_b32 v[52:53],v4 offset0:84 offset1:88
ds_read2st64_b32 v[54:55],v4 offset0:85 offset1:89
v_mov_b32 v96,v104
v_mov_b32 v97,v105
v_mov_b32 v98,v106
v_mov_b32 v99,v107
v_mov_b32 v100,v108
v_mov_b32 v101,v109
v_mov_b32 v102,v110
v_mov_b32 v103,v111
s_waitcnt lgkmcnt(2)
v_pk_add_f32 v[48:49],v[48:49],v[50:51]
s_waitcnt lgkmcnt(0)
v_pk_add_f32 v[52:53],v[52:53],v[54:55]
v_pk_add_f32 v[48:49],v[48:49],v[52:53]
v_cvt_pk_bf16_f32 v124,v48,v49
buffer_store_dword v124,v127,s[20:23],s89 offen
s_nop 7
buffer_store_dword v124,v127,s[20:23],s88 offen sc1
s_branch loop0_100259x
last_100256:
s_waitcnt vmcnt(3)
v_max3_u32 v124,v16,v17,v18
v_max_u32 v124,v124,v19
v_cmp_eq_u32 vcc,-1,v124
v_cndmask_b32 v120,2.0,v0,s[82:83]
v_cndmask_b32 v121,2.0,v127,s[86:87]
s_cbranch_vccnz flb_100341
seg_100317:
segb_100325:
v_smfmac_f32_16x16x64_bf16 v[64:67],v[16:19],a[32:39],v1
buffer_load_dword v125,off,s[20:23],s92 sc1
buffer_load_dwordx4 v[32:35],v0,s[20:23],s93 offen offset:0 sc1
s_waitcnt vmcnt(4)
v_max3_u32 v124,v20,v21,v22
v_smfmac_f32_16x16x64_bf16 v[68:71],v[16:19],a[40:47],v1
v_max_u32 v124,v124,v23
v_cmp_eq_u32 vcc,-1,v124
v_smfmac_f32_16x16x64_bf16 v[72:75],v[16:19],a[48:55],v1
v_smfmac_f32_16x16x64_bf16 v[76:79],v[16:19],a[56:63],v1
s_cbranch_vccnz fl_100334
seg_100318:
segb_100326:
v_smfmac_f32_16x16x64_bf16 v[64:67],v[20:23],a[96:103],v1
buffer_load_dword v125,off,s[20:23],s92 sc1
buffer_load_dwordx4 v[36:39],v0,s[20:23],s93 offen offset:1024 sc1
s_waitcnt vmcnt(5)
v_max3_u32 v124,v24,v25,v26
v_smfmac_f32_16x16x64_bf16 v[68:71],v[20:23],a[104:111],v1
v_max_u32 v124,v124,v27
v_cmp_eq_u32 vcc,-1,v124
v_smfmac_f32_16x16x64_bf16 v[72:75],v[20:23],a[112:119],v1
v_smfmac_f32_16x16x64_bf16 v[76:79],v[20:23],a[120:127],v1
s_cbranch_vccnz fl_100335
seg_100319:
segb_100327:
v_smfmac_f32_16x16x64_bf16 v[64:67],v[24:27],a[160:167],v1
buffer_load_dword v125,off,s[20:23],s92 sc1
buffer_load_dwordx4 v[40:43],v0,s[20:23],s93 offen offset:2048 sc1
buffer_load_dwordx4 v[44:47],v0,s[20:23],s93 offen offset:3072 sc1
s_waitcnt vmcnt(7)
v_max3_u32 v124,v28,v29,v30
v_smfmac_f32_16x16x64_bf16 v[68:71],v[24:27],a[168:175],v1
v_max_u32 v124,v124,v31
v_cmp_eq_u32 vcc,-1,v124
v_smfmac_f32_16x16x64_bf16 v[72:75],v[24:27],a[176:183],v1
v_smfmac_f32_16x16x64_bf16 v[76:79],v[24:27],a[184:191],v1
s_cbranch_vccnz fl_100336
seg_100320:
segb_100328:
v_smfmac_f32_16x16x64_bf16 v[64:67],v[28:31],a[224:231],v1
buffer_load_dword v125,off,s[20:23],s92 sc1
s_waitcnt vmcnt(6)
v_max3_u32 v124,v32,v33,v34
v_smfmac_f32_16x16x64_bf16 v[68:71],v[28:31],a[232:239],v1
v_max_u32 v124,v124,v35
v_cmp_eq_u32 vcc,-1,v124
v_smfmac_f32_16x16x64_bf16 v[72:75],v[28:31],a[240:247],v1
v_smfmac_f32_16x16x64_bf16 v[76:79],v[28:31],a[248:255],v1
s_cbranch_vccnz fl_100337
seg_100321:
segb_100329:
v_smfmac_f32_16x16x64_bf16 v[64:67],v[32:35],a[32:39],v1
buffer_load_dword v125,off,s[20:23],s92 sc1
buffer_store_dwordx4 v[112:115],v120,s[20:23],s101 offen sc1
buffer_store_dword v126,v121,s[20:23],s69 offen sc1
s_waitcnt vmcnt(7)
v_max3_u32 v124,v36,v37,v38
v_smfmac_f32_16x16x64_bf16 v[68:71],v[32:35],a[40:47],v1
v_max_u32 v124,v124,v39
v_cmp_eq_u32 vcc,-1,v124
v_smfmac_f32_16x16x64_bf16 v[72:75],v[32:35],a[48:55],v1
v_smfmac_f32_16x16x64_bf16 v[76:79],v[32:35],a[56:63],v1
s_cbranch_vccnz fl_100338
seg_100322:
segb_100330:
v_smfmac_f32_16x16x64_bf16 v[64:67],v[36:39],a[96:103],v1
buffer_load_dword v125,off,s[20:23],s92 sc1
s_waitcnt vmcnt(5)
v_max3_u32 v124,v40,v41,v42
v_smfmac_f32_16x16x64_bf16 v[68:71],v[36:39],a[104:111],v1
v_max3_u32 v124,v124,v43,v44
v_max3_u32 v124,v124,v45,v46
v_max_u32 v124,v124,v47
v_cmp_eq_u32 vcc,-1,v124
v_smfmac_f32_16x16x64_bf16 v[72:75],v[36:39],a[112:119],v1
v_smfmac_f32_16x16x64_bf16 v[76:79],v[36:39],a[120:127],v1
s_cbranch_vccnz fl_100339
seg_100323:
segb_100331:
v_smfmac_f32_16x16x64_bf16 v[64:67],v[40:43],a[160:167],v1
v_smfmac_f32_16x16x64_bf16 v[68:71],v[40:43],a[168:175],v1
v_smfmac_f32_16x16x64_bf16 v[64:67],v[44:47],a[224:231],v1
v_smfmac_f32_16x16x64_bf16 v[68:71],v[44:47],a[232:239],v1
v_smfmac_f32_16x16x64_bf16 v[72:75],v[40:43],a[176:183],v1
s_nop 1
v_add_f32 v64,v64,v65
v_smfmac_f32_16x16x64_bf16 v[76:79],v[40:43],a[184:191],v1
ds_write_addtid_b32 v64 offset:8448
v_add_f32 v66,v66,v67
v_smfmac_f32_16x16x64_bf16 v[72:75],v[44:47],a[240:247],v1
ds_write_addtid_b32 v66 offset:9488
v_add_f32 v68,v68,v69
v_smfmac_f32_16x16x64_bf16 v[76:79],v[44:47],a[248:255],v1
ds_write_addtid_b32 v68 offset:10528
v_add_f32 v70,v70,v71
v_smfmac_f32_16x16x64_bf16 v[80:83],v[16:19],v[208:215],v1
ds_write_addtid_b32 v70 offset:11568
v_add_f32 v72,v72,v73
v_smfmac_f32_16x16x64_bf16 v[80:83],v[32:35],v[208:215],v1
ds_write_addtid_b32 v72 offset:12608
v_add_f32 v74,v74,v75
v_smfmac_f32_16x16x64_bf16 v[84:87],v[16:19],v[216:223],v1
ds_write_addtid_b32 v74 offset:13648
v_add_f32 v76,v76,v77
v_smfmac_f32_16x16x64_bf16 v[84:87],v[32:35],v[216:223],v1
ds_write_addtid_b32 v76 offset:14688
v_add_f32 v78,v78,v79
v_smfmac_f32_16x16x64_bf16 v[88:91],v[16:19],v[224:231],v1
ds_write_addtid_b32 v78 offset:15728
v_smfmac_f32_16x16x64_bf16 v[88:91],v[32:35],v[224:231],v1
v_smfmac_f32_16x16x64_bf16 v[92:95],v[16:19],v[232:239],v1
v_smfmac_f32_16x16x64_bf16 v[92:95],v[32:35],v[232:239],v1
doneA_100350:
s_waitcnt vmcnt(0) lgkmcnt(0)
s_add_u32 s64,s79,0
s_lshl_b32 s65,s64,12
s_and_b32 s65,s65,0x2000
s_xor_b32 s65,s65,s67
s_lshl_b32 s64,s64,20
s_add_u32 s65,s65,s64
s_add_u32 s101,s65,s78
v_smfmac_f32_16x16x64_bf16 v[80:83],v[20:23],v[240:247],v1
ds_read_b128 v[48:51],v7 offset:0
ds_read_b128 v[52:55],v7 offset:1024
v_smfmac_f32_16x16x64_bf16 v[80:83],v[36:39],v[240:247],v1
ds_read_b128 v[56:59],v7 offset:2048
ds_read_b128 v[60:63],v7 offset:3072
v_smfmac_f32_16x16x64_bf16 v[84:87],v[20:23],v[248:255],v1
ds_read_b128 v[64:67],v7 offset:4096
ds_read_b128 v[68:71],v7 offset:5120
v_smfmac_f32_16x16x64_bf16 v[84:87],v[36:39],v[248:255],v1
ds_read_b128 v[72:75],v7 offset:6144
ds_read_b128 v[76:79],v7 offset:7168
s_waitcnt lgkmcnt(6)
v_smfmac_f32_16x16x64_bf16 v[88:91],v[20:23],v[48:55],v1
v_smfmac_f32_16x16x64_bf16 v[88:91],v[36:39],v[48:55],v1
ds_read_b128 v[48:51],v7 offset:8192
ds_read_b128 v[52:55],v7 offset:9216
s_waitcnt lgkmcnt(6)
v_smfmac_f32_16x16x64_bf16 v[92:95],v[20:23],v[56:63],v1
v_smfmac_f32_16x16x64_bf16 v[92:95],v[36:39],v[56:63],v1
ds_read_b128 v[56:59],v7 offset:10240
ds_read_b128 v[60:63],v7 offset:11264
s_waitcnt lgkmcnt(6)
v_smfmac_f32_16x16x64_bf16 v[80:83],v[24:27],v[64:71],v1
v_smfmac_f32_16x16x64_bf16 v[80:83],v[40:43],v[64:71],v1
ds_read_b128 v[64:67],v7 offset:12288
ds_read_b128 v[68:71],v7 offset:13312
s_waitcnt lgkmcnt(6)
v_smfmac_f32_16x16x64_bf16 v[84:87],v[24:27],v[72:79],v1
v_smfmac_f32_16x16x64_bf16 v[84:87],v[40:43],v[72:79],v1
ds_read_b128 v[72:75],v7 offset:14336
ds_read_b128 v[76:79],v7 offset:15360
s_waitcnt lgkmcnt(6)
v_smfmac_f32_16x16x64_bf16 v[88:91],v[24:27],v[48:55],v1
v_smfmac_f32_16x16x64_bf16 v[88:91],v[40:43],v[48:55],v1
ds_read_b128 v[48:51],v7 offset:16384
ds_read_b128 v[52:55],v7 offset:17408
s_waitcnt lgkmcnt(6)
v_smfmac_f32_16x16x64_bf16 v[92:95],v[24:27],v[56:63],v1
v_smfmac_f32_16x16x64_bf16 v[92:95],v[40:43],v[56:63],v1
ds_read_b128 v[56:59],v7 offset:18432
ds_read_b128 v[60:63],v7 offset:19456
s_waitcnt lgkmcnt(6)
v_smfmac_f32_16x16x64_bf16 v[80:83],v[28:31],v[64:71],v1
v_smfmac_f32_16x16x64_bf16 v[80:83],v[44:47],v[64:71],v1
s_waitcnt lgkmcnt(4)
v_smfmac_f32_16x16x64_bf16 v[84:87],v[28:31],v[72:79],v1
v_smfmac_f32_16x16x64_bf16 v[84:87],v[44:47],v[72:79],v1
s_waitcnt lgkmcnt(2)
v_smfmac_f32_16x16x64_bf16 v[88:91],v[28:31],v[48:55],v1
v_add_f32 v80,v80,v81
v_smfmac_f32_16x16x64_bf16 v[88:91],v[44:47],v[48:55],v1
v_add_f32 v82,v82,v83
s_waitcnt lgkmcnt(0)
v_smfmac_f32_16x16x64_bf16 v[92:95],v[28:31],v[56:63],v1
v_cvt_pk_bf16_f32 v80,v80,v82
v_smfmac_f32_16x16x64_bf16 v[92:95],v[44:47],v[56:63],v1
ds_write_addtid_b32 v80 offset:16896
v_add_f32 v84,v84,v85
v_add_f32 v86,v86,v87
v_cvt_pk_bf16_f32 v84,v84,v86
v_add_f32 v88,v88,v89
v_add_f32 v90,v90,v91
v_cvt_pk_bf16_f32 v88,v88,v90
s_nop 0
v_add_f32 v92,v92,v93
v_add_f32 v94,v94,v95
v_cvt_pk_bf16_f32 v92,v92,v94
ds_write_addtid_b32 v84 offset:17920
ds_write_addtid_b32 v88 offset:18944
ds_write_addtid_b32 v92 offset:19968
s_waitcnt lgkmcnt(0)
s_barrier
s_cmp_gt_u32 s50,1
s_cbranch_scc1 l23_100351
ds_read2st64_b32 v[112:113],v127 offset0:66 offset1:67
ds_read2st64_b32 v[114:115],v127 offset0:68 offset1:69
ds_read2st64_b32 v[116:117],v127 offset0:70 offset1:71
ds_read2st64_b32 v[118:119],v127 offset0:72 offset1:73
s_waitcnt lgkmcnt(0)
v_mov_b32 v120,v5
v_mov_b32 v121,v5
v_mov_b32 v122,v5
v_mov_b32 v123,v5
s_nop 1
v_mfma_f32_16x16x32_bf16 v[112:115],v[120:123],v[112:115],0
v_mfma_f32_16x16x32_bf16 v[116:119],v[120:123],v[116:119],0
s_nop 4
v_cvt_pk_bf16_f32 v112,v112,v113
v_cvt_pk_bf16_f32 v113,v114,v115
s_nop 0
v_cvt_pk_bf16_f32 v114,v116,v117
v_cvt_pk_bf16_f32 v115,v118,v119
s_branch lj_100352
l23_100351:
ds_read_b128 v[48:51],v2 offset:0
ds_read_b128 v[52:55],v2 offset:256
ds_read_b128 v[56:59],v2 offset:512
ds_read_b128 v[60:63],v2 offset:768
ds_read_b128 v[64:67],v2 offset:16
ds_read_b128 v[68:71],v2 offset:272
ds_read_b128 v[72:75],v2 offset:528
ds_read_b128 v[76:79],v2 offset:784
s_waitcnt lgkmcnt(6)
v_pk_add_f32 v[48:49],v[48:49],v[52:53]
v_pk_add_f32 v[50:51],v[50:51],v[54:55]
s_waitcnt lgkmcnt(4)
v_pk_add_f32 v[56:57],v[56:57],v[60:61]
v_pk_add_f32 v[58:59],v[58:59],v[62:63]
v_pk_add_f32 v[48:49],v[48:49],v[56:57]
v_pk_add_f32 v[50:51],v[50:51],v[58:59]
v_cvt_pk_bf16_f32 v112,v48,v49
v_cvt_pk_bf16_f32 v113,v50,v51
s_waitcnt lgkmcnt(2)
v_pk_add_f32 v[64:65],v[64:65],v[68:69]
v_pk_add_f32 v[66:67],v[66:67],v[70:71]
s_waitcnt lgkmcnt(0)
v_pk_add_f32 v[72:73],v[72:73],v[76:77]
v_pk_add_f32 v[74:75],v[74:75],v[78:79]
v_pk_add_f32 v[64:65],v[64:65],v[72:73]
v_pk_add_f32 v[66:67],v[66:67],v[74:75]
v_cvt_pk_bf16_f32 v114,v64,v65
v_cvt_pk_bf16_f32 v115,v66,v67
lj_100352:
v_cndmask_b32 v120,2.0,v0,s[82:83]
v_cndmask_b32 v121,2.0,v127,s[86:87]
buffer_store_dwordx4 v[112:115],v120,s[20:23],s101 offen sc1
s_waitcnt vmcnt(0)
s_barrier
v_mov_b32 v126,64
buffer_store_dword v126,v121,s[20:23],s69 offen sc1
s_branch recfin_100248
flp_100261:
buffer_load_dword v124,off,s[20:23],s68 sc1
s_waitcnt vmcnt(0)
v_readfirstlane_b32 s91,v124
s_cmp_gt_u32 s91,s64
s_cbranch_scc1 fok_100260
s_sleep 2
s_sub_u32 s90,s90,1
s_cmp_gt_i32 s90,0
s_cbranch_scc1 flp_100261
s_branch fok_100260
flp_100264:
buffer_load_dword v124,off,s[20:23],s68 sc1
s_waitcnt vmcnt(0)
v_readfirstlane_b32 s91,v124
s_cmp_gt_u32 s91,s64
s_cbranch_scc1 fok_100263
s_sleep 2
s_sub_u32 s90,s90,1
s_cmp_gt_i32 s90,0
s_cbranch_scc1 flp_100264
s_branch fok_100263
fl_100281:
flb_100289:
buffer_load_dwordx4 v[16:19],v0,s[20:23],s92 offen offset:0 sc1
s_mov_b32 s55,1
buffer_load_dwordx4 v[32:35],v0,s[20:23],s93 offen offset:0 sc1
s_waitcnt vmcnt(4)
v_max3_u32 v124,v20,v21,v22
v_max_u32 v124,v124,v23
v_cmp_eq_u32 vcc,-1,v124
s_cbranch_vccnz dfl_100353
v_smfmac_f32_16x16x64_bf16 v[48:51],v[20:23],a[64:71],v1
buffer_load_dword v125,off,s[20:23],s92 sc1
v_smfmac_f32_16x16x64_bf16 v[52:55],v[20:23],a[72:79],v1
buffer_load_dwordx4 v[36:39],v0,s[20:23],s93 offen offset:1024 sc1
v_smfmac_f32_16x16x64_bf16 v[56:59],v[20:23],a[80:87],v1
s_waitcnt vmcnt(5)
v_max3_u32 v124,v24,v25,v26
v_smfmac_f32_16x16x64_bf16 v[60:63],v[20:23],a[88:95],v1
v_max_u32 v124,v124,v27
v_smfmac_f32_16x16x64_bf16 v[64:67],v[20:23],a[96:103],v1
v_cmp_eq_u32 vcc,-1,v124
v_smfmac_f32_16x16x64_bf16 v[68:71],v[20:23],a[104:111],v1
v_smfmac_f32_16x16x64_bf16 v[72:75],v[20:23],a[112:119],v1
v_smfmac_f32_16x16x64_bf16 v[76:79],v[20:23],a[120:127],v1
s_cbranch_vccnz dfl_100354
v_smfmac_f32_16x16x64_bf16 v[48:51],v[24:27],a[128:135],v1
buffer_load_dword v125,off,s[20:23],s92 sc1
v_smfmac_f32_16x16x64_bf16 v[52:55],v[24:27],a[136:143],v1
buffer_load_dwordx4 v[40:43],v0,s[20:23],s93 offen offset:2048 sc1
v_smfmac_f32_16x16x64_bf16 v[56:59],v[24:27],a[144:151],v1
buffer_load_dwordx4 v[44:47],v0,s[20:23],s93 offen offset:3072 sc1
s_waitcnt vmcnt(7)
v_max3_u32 v124,v28,v29,v30
v_smfmac_f32_16x16x64_bf16 v[60:63],v[24:27],a[152:159],v1
v_max_u32 v124,v124,v31
v_smfmac_f32_16x16x64_bf16 v[64:67],v[24:27],a[160:167],v1
v_cmp_eq_u32 vcc,-1,v124
v_smfmac_f32_16x16x64_bf16 v[68:71],v[24:27],a[168:175],v1
v_smfmac_f32_16x16x64_bf16 v[72:75],v[24:27],a[176:183],v1
v_smfmac_f32_16x16x64_bf16 v[76:79],v[24:27],a[184:191],v1
s_cbranch_vccnz dfl_100355
v_smfmac_f32_16x16x64_bf16 v[48:51],v[28:31],a[192:199],v1
buffer_load_dword v125,off,s[20:23],s92 sc1
v_smfmac_f32_16x16x64_bf16 v[52:55],v[28:31],a[200:207],v1
v_smfmac_f32_16x16x64_bf16 v[56:59],v[28:31],a[208:215],v1
s_waitcnt vmcnt(7)
v_max3_u32 v124,v16,v17,v18
v_smfmac_f32_16x16x64_bf16 v[60:63],v[28:31],a[216:223],v1
v_max_u32 v124,v124,v19
v_smfmac_f32_16x16x64_bf16 v[64:67],v[28:31],a[224:231],v1
v_cmp_eq_u32 vcc,-1,v124
v_smfmac_f32_16x16x64_bf16 v[68:71],v[28:31],a[232:239],v1
v_smfmac_f32_16x16x64_bf16 v[72:75],v[28:31],a[240:247],v1
v_smfmac_f32_16x16x64_bf16 v[76:79],v[28:31],a[248:255],v1
s_cbranch_vccnz lfb_100360
s_mov_b32 s55,0
v_smfmac_f32_16x16x64_bf16 v[48:51],v[16:19],a[0:7],v1
v_smfmac_f32_16x16x64_bf16 v[52:55],v[16:19],a[8:15],v1
v_smfmac_f32_16x16x64_bf16 v[56:59],v[16:19],a[16:23],v1
s_waitcnt vmcnt(6)
v_max3_u32 v124,v32,v33,v34
v_max_u32 v124,v124,v35
v_cmp_eq_u32 vcc,-1,v124
v_smfmac_f32_16x16x64_bf16 v[60:63],v[16:19],a[24:31],v1
v_smfmac_f32_16x16x64_bf16 v[64:67],v[16:19],a[32:39],v1
v_smfmac_f32_16x16x64_bf16 v[68:71],v[16:19],a[40:47],v1
v_smfmac_f32_16x16x64_bf16 v[72:75],v[16:19],a[48:55],v1
v_smfmac_f32_16x16x64_bf16 v[76:79],v[16:19],a[56:63],v1
s_cbranch_vccnz flb_100293
s_branch segb_100277
fl_100282:
v_smfmac_f32_16x16x64_bf16 v[76:79],v[16:19],a[56:63],v1
flb_100290:
buffer_load_dwordx4 v[20:23],v0,s[20:23],s92 offen offset:1024 sc1
s_mov_b32 s55,2
buffer_load_dwordx4 v[36:39],v0,s[20:23],s93 offen offset:1024 sc1
s_waitcnt vmcnt(5)
v_max3_u32 v124,v24,v25,v26
v_max_u32 v124,v124,v27
v_cmp_eq_u32 vcc,-1,v124
s_cbranch_vccnz dfl_100354
v_smfmac_f32_16x16x64_bf16 v[48:51],v[24:27],a[128:135],v1
buffer_load_dword v125,off,s[20:23],s92 sc1
v_smfmac_f32_16x16x64_bf16 v[52:55],v[24:27],a[136:143],v1
buffer_load_dwordx4 v[40:43],v0,s[20:23],s93 offen offset:2048 sc1
v_smfmac_f32_16x16x64_bf16 v[56:59],v[24:27],a[144:151],v1
buffer_load_dwordx4 v[44:47],v0,s[20:23],s93 offen offset:3072 sc1
s_waitcnt vmcnt(7)
v_max3_u32 v124,v28,v29,v30
v_smfmac_f32_16x16x64_bf16 v[60:63],v[24:27],a[152:159],v1
v_max_u32 v124,v124,v31
v_smfmac_f32_16x16x64_bf16 v[64:67],v[24:27],a[160:167],v1
v_cmp_eq_u32 vcc,-1,v124
v_smfmac_f32_16x16x64_bf16 v[68:71],v[24:27],a[168:175],v1
v_smfmac_f32_16x16x64_bf16 v[72:75],v[24:27],a[176:183],v1
v_smfmac_f32_16x16x64_bf16 v[76:79],v[24:27],a[184:191],v1
s_cbranch_vccnz dfl_100355
v_smfmac_f32_16x16x64_bf16 v[48:51],v[28:31],a[192:199],v1
buffer_load_dword v125,off,s[20:23],s92 sc1
v_smfmac_f32_16x16x64_bf16 v[52:55],v[28:31],a[200:207],v1
v_smfmac_f32_16x16x64_bf16 v[56:59],v[28:31],a[208:215],v1
s_waitcnt vmcnt(5)
v_max3_u32 v124,v20,v21,v22
v_smfmac_f32_16x16x64_bf16 v[60:63],v[28:31],a[216:223],v1
v_max_u32 v124,v124,v23
v_smfmac_f32_16x16x64_bf16 v[64:67],v[28:31],a[224:231],v1
v_cmp_eq_u32 vcc,-1,v124
v_smfmac_f32_16x16x64_bf16 v[68:71],v[28:31],a[232:239],v1
v_smfmac_f32_16x16x64_bf16 v[72:75],v[28:31],a[240:247],v1
v_smfmac_f32_16x16x64_bf16 v[76:79],v[28:31],a[248:255],v1
s_cbranch_vccnz lfb_100360
s_mov_b32 s55,0
v_smfmac_f32_16x16x64_bf16 v[48:51],v[20:23],a[64:71],v1
v_smfmac_f32_16x16x64_bf16 v[52:55],v[20:23],a[72:79],v1
v_smfmac_f32_16x16x64_bf16 v[56:59],v[20:23],a[80:87],v1
s_waitcnt vmcnt(6)
v_max3_u32 v124,v32,v33,v34
v_max_u32 v124,v124,v35
v_cmp_eq_u32 vcc,-1,v124
v_smfmac_f32_16x16x64_bf16 v[60:63],v[20:23],a[88:95],v1
v_smfmac_f32_16x16x64_bf16 v[64:67],v[20:23],a[96:103],v1
v_smfmac_f32_16x16x64_bf16 v[68:71],v[20:23],a[104:111],v1
v_smfmac_f32_16x16x64_bf16 v[72:75],v[20:23],a[112:119],v1
v_smfmac_f32_16x16x64_bf16 v[76:79],v[20:23],a[120:127],v1
s_cbranch_vccnz flb_100293
s_branch segb_100277
fl_100283:
v_smfmac_f32_16x16x64_bf16 v[76:79],v[20:23],a[120:127],v1
flb_100291:
buffer_load_dwordx4 v[24:27],v0,s[20:23],s92 offen offset:2048 sc1
s_mov_b32 s55,4
buffer_load_dwordx4 v[40:43],v0,s[20:23],s93 offen offset:2048 sc1
buffer_load_dwordx4 v[44:47],v0,s[20:23],s93 offen offset:3072 sc1
s_waitcnt vmcnt(7)
v_max3_u32 v124,v28,v29,v30
v_max_u32 v124,v124,v31
v_cmp_eq_u32 vcc,-1,v124
s_cbranch_vccnz dfl_100355
v_smfmac_f32_16x16x64_bf16 v[48:51],v[28:31],a[192:199],v1
buffer_load_dword v125,off,s[20:23],s92 sc1
v_smfmac_f32_16x16x64_bf16 v[52:55],v[28:31],a[200:207],v1
v_smfmac_f32_16x16x64_bf16 v[56:59],v[28:31],a[208:215],v1
s_waitcnt vmcnt(3)
v_max3_u32 v124,v24,v25,v26
v_smfmac_f32_16x16x64_bf16 v[60:63],v[28:31],a[216:223],v1
v_max_u32 v124,v124,v27
v_smfmac_f32_16x16x64_bf16 v[64:67],v[28:31],a[224:231],v1
v_cmp_eq_u32 vcc,-1,v124
v_smfmac_f32_16x16x64_bf16 v[68:71],v[28:31],a[232:239],v1
v_smfmac_f32_16x16x64_bf16 v[72:75],v[28:31],a[240:247],v1
v_smfmac_f32_16x16x64_bf16 v[76:79],v[28:31],a[248:255],v1
s_cbranch_vccnz lfb_100360
s_mov_b32 s55,0
v_smfmac_f32_16x16x64_bf16 v[48:51],v[24:27],a[128:135],v1
v_smfmac_f32_16x16x64_bf16 v[52:55],v[24:27],a[136:143],v1
v_smfmac_f32_16x16x64_bf16 v[56:59],v[24:27],a[144:151],v1
s_waitcnt vmcnt(6)
v_max3_u32 v124,v32,v33,v34
v_max_u32 v124,v124,v35
v_cmp_eq_u32 vcc,-1,v124
v_smfmac_f32_16x16x64_bf16 v[60:63],v[24:27],a[152:159],v1
v_smfmac_f32_16x16x64_bf16 v[64:67],v[24:27],a[160:167],v1
v_smfmac_f32_16x16x64_bf16 v[68:71],v[24:27],a[168:175],v1
v_smfmac_f32_16x16x64_bf16 v[72:75],v[24:27],a[176:183],v1
v_smfmac_f32_16x16x64_bf16 v[76:79],v[24:27],a[184:191],v1
s_cbranch_vccnz flb_100293
s_branch segb_100277
fl_100284:
v_smfmac_f32_16x16x64_bf16 v[76:79],v[24:27],a[184:191],v1
flb_100292:
buffer_load_dwordx4 v[28:31],v0,s[20:23],s92 offen offset:3072 sc1
s_mov_b32 s55,8
s_waitcnt vmcnt(0)
v_max3_u32 v124,v28,v29,v30
v_max_u32 v124,v124,v31
v_cmp_eq_u32 vcc,-1,v124
s_cbranch_vccnz lfb_100360
s_mov_b32 s55,0
v_smfmac_f32_16x16x64_bf16 v[48:51],v[28:31],a[192:199],v1
v_smfmac_f32_16x16x64_bf16 v[52:55],v[28:31],a[200:207],v1
v_smfmac_f32_16x16x64_bf16 v[56:59],v[28:31],a[208:215],v1
s_waitcnt vmcnt(6)
v_max3_u32 v124,v32,v33,v34
v_max_u32 v124,v124,v35
v_cmp_eq_u32 vcc,-1,v124
v_smfmac_f32_16x16x64_bf16 v[60:63],v[28:31],a[216:223],v1
v_smfmac_f32_16x16x64_bf16 v[64:67],v[28:31],a[224:231],v1
v_smfmac_f32_16x16x64_bf16 v[68:71],v[28:31],a[232:239],v1
v_smfmac_f32_16x16x64_bf16 v[72:75],v[28:31],a[240:247],v1
v_smfmac_f32_16x16x64_bf16 v[76:79],v[28:31],a[248:255],v1
s_cbranch_vccnz flb_100293
s_branch segb_100277
fl_100285:
v_smfmac_f32_16x16x64_bf16 v[76:79],v[28:31],a[248:255],v1
flb_100293:
buffer_load_dwordx4 v[32:35],v0,s[20:23],s93 offen offset:0 sc1
s_mov_b32 s55,240
buffer_store_dwordx4 v[112:115],v120,s[20:23],s101 offen sc1
buffer_store_dword v126,v121,s[20:23],s69 offen sc1
s_bitcmp1_b32 s55,5
s_cbranch_scc0 rdn_100363
s_waitcnt vmcnt(7)
v_max3_u32 v124,v36,v37,v38
v_max_u32 v124,v124,v39
v_cmp_eq_u32 vcc,-1,v124
s_cbranch_vccnz rfa_100364
buffer_load_dword v125,off,s[20:23],s92 sc1
s_bitset0_b32 s55,5
v_smfmac_f32_16x16x64_bf16 v[48:51],v[36:39],a[64:71],v1
v_smfmac_f32_16x16x64_bf16 v[52:55],v[36:39],a[72:79],v1
v_smfmac_f32_16x16x64_bf16 v[56:59],v[36:39],a[80:87],v1
v_smfmac_f32_16x16x64_bf16 v[60:63],v[36:39],a[88:95],v1
v_smfmac_f32_16x16x64_bf16 v[64:67],v[36:39],a[96:103],v1
v_smfmac_f32_16x16x64_bf16 v[68:71],v[36:39],a[104:111],v1
v_smfmac_f32_16x16x64_bf16 v[72:75],v[36:39],a[112:119],v1
v_smfmac_f32_16x16x64_bf16 v[76:79],v[36:39],a[120:127],v1
s_cmp_eq_u32 s55,0
s_cbranch_scc1 segb_100279
s_branch rnx_100365
rdn_100363:
buffer_load_dword v125,off,s[20:23],s92 sc1
s_branch rnx_100365
rfa_100364:
buffer_load_dwordx4 v[36:39],v0,s[20:23],s93 offen offset:1024 sc1
rnx_100365:
s_bitcmp1_b32 s55,6
s_cbranch_scc0 rdn_100366
s_waitcnt vmcnt(6)
v_max3_u32 v124,v40,v41,v42
v_max_u32 v124,v124,v43
v_cmp_eq_u32 vcc,-1,v124
s_cbranch_vccnz rfa_100367
buffer_load_dword v125,off,s[20:23],s92 sc1
s_bitset0_b32 s55,6
s_cmp_eq_u32 s55,0
s_cbranch_scc1 segb_100279
s_branch rnx_100368
rdn_100366:
buffer_load_dword v125,off,s[20:23],s92 sc1
s_branch rnx_100368
rfa_100367:
buffer_load_dwordx4 v[40:43],v0,s[20:23],s93 offen offset:2048 sc1
rnx_100368:
s_bitcmp1_b32 s55,7
s_cbranch_scc0 rdn_100369
s_waitcnt vmcnt(6)
v_max3_u32 v124,v44,v45,v46
v_max_u32 v124,v124,v47
v_cmp_eq_u32 vcc,-1,v124
s_cbranch_vccnz rfa_100370
buffer_load_dword v125,off,s[20:23],s92 sc1
s_bitset0_b32 s55,7
s_cmp_eq_u32 s55,0
s_cbranch_scc1 segb_100279
s_branch rnx_100371
rdn_100369:
buffer_load_dword v125,off,s[20:23],s92 sc1
s_branch rnx_100371
rfa_100370:
buffer_load_dwordx4 v[44:47],v0,s[20:23],s93 offen offset:3072 sc1
rnx_100371:
rot_100362:
s_bitcmp1_b32 s55,4
s_cbranch_scc0 rdn_100372
s_waitcnt vmcnt(3)
v_max3_u32 v124,v32,v33,v34
v_max_u32 v124,v124,v35
v_cmp_eq_u32 vcc,-1,v124
s_cbranch_vccnz rfa_100373
buffer_load_dword v125,off,s[20:23],s92 sc1
s_bitset0_b32 s55,4
v_smfmac_f32_16x16x64_bf16 v[48:51],v[32:35],a[0:7],v1
v_smfmac_f32_16x16x64_bf16 v[52:55],v[32:35],a[8:15],v1
v_smfmac_f32_16x16x64_bf16 v[56:59],v[32:35],a[16:23],v1
v_smfmac_f32_16x16x64_bf16 v[60:63],v[32:35],a[24:31],v1
v_smfmac_f32_16x16x64_bf16 v[64:67],v[32:35],a[32:39],v1
v_smfmac_f32_16x16x64_bf16 v[68:71],v[32:35],a[40:47],v1
v_smfmac_f32_16x16x64_bf16 v[72:75],v[32:35],a[48:55],v1
v_smfmac_f32_16x16x64_bf16 v[76:79],v[32:35],a[56:63],v1
s_cmp_eq_u32 s55,0
s_cbranch_scc1 segb_100279
s_branch rnx_100374
rdn_100372:
buffer_load_dword v125,off,s[20:23],s92 sc1
s_branch rnx_100374
rfa_100373:
buffer_load_dwordx4 v[32:35],v0,s[20:23],s93 offen offset:0 sc1
rnx_100374:
s_bitcmp1_b32 s55,5
s_cbranch_scc0 rdn_100375
s_waitcnt vmcnt(3)
v_max3_u32 v124,v36,v37,v38
v_max_u32 v124,v124,v39
v_cmp_eq_u32 vcc,-1,v124
s_cbranch_vccnz rfa_100376
buffer_load_dword v125,off,s[20:23],s92 sc1
s_bitset0_b32 s55,5
v_smfmac_f32_16x16x64_bf16 v[48:51],v[36:39],a[64:71],v1
v_smfmac_f32_16x16x64_bf16 v[52:55],v[36:39],a[72:79],v1
v_smfmac_f32_16x16x64_bf16 v[56:59],v[36:39],a[80:87],v1
v_smfmac_f32_16x16x64_bf16 v[60:63],v[36:39],a[88:95],v1
v_smfmac_f32_16x16x64_bf16 v[64:67],v[36:39],a[96:103],v1
v_smfmac_f32_16x16x64_bf16 v[68:71],v[36:39],a[104:111],v1
v_smfmac_f32_16x16x64_bf16 v[72:75],v[36:39],a[112:119],v1
v_smfmac_f32_16x16x64_bf16 v[76:79],v[36:39],a[120:127],v1
s_cmp_eq_u32 s55,0
s_cbranch_scc1 segb_100279
s_branch rnx_100377
rdn_100375:
buffer_load_dword v125,off,s[20:23],s92 sc1
s_branch rnx_100377
rfa_100376:
buffer_load_dwordx4 v[36:39],v0,s[20:23],s93 offen offset:1024 sc1
rnx_100377:
s_bitcmp1_b32 s55,6
s_cbranch_scc0 rdn_100378
s_waitcnt vmcnt(3)
v_max3_u32 v124,v40,v41,v42
v_max_u32 v124,v124,v43
v_cmp_eq_u32 vcc,-1,v124
s_cbranch_vccnz rfa_100379
buffer_load_dword v125,off,s[20:23],s92 sc1
s_bitset0_b32 s55,6
s_cmp_eq_u32 s55,0
s_cbranch_scc1 segb_100279
s_branch rnx_100380
rdn_100378:
buffer_load_dword v125,off,s[20:23],s92 sc1
s_branch rnx_100380
rfa_100379:
buffer_load_dwordx4 v[40:43],v0,s[20:23],s93 offen offset:2048 sc1
rnx_100380:
s_bitcmp1_b32 s55,7
s_cbranch_scc0 rdn_100381
s_waitcnt vmcnt(3)
v_max3_u32 v124,v44,v45,v46
v_max_u32 v124,v124,v47
v_cmp_eq_u32 vcc,-1,v124
s_cbranch_vccnz rfa_100382
buffer_load_dword v125,off,s[20:23],s92 sc1
s_bitset0_b32 s55,7
s_cmp_eq_u32 s55,0
s_cbranch_scc1 segb_100279
s_branch rnx_100383
rdn_100381:
buffer_load_dword v125,off,s[20:23],s92 sc1
s_branch rnx_100383
rfa_100382:
buffer_load_dwordx4 v[44:47],v0,s[20:23],s93 offen offset:3072 sc1
rnx_100383:
s_sub_u32 s90,s90,1
s_cmp_gt_i32 s90,0
s_cbranch_scc1 rot_100362
s_mov_b32 s55,0
s_branch segb_100279
fl_100286:
v_smfmac_f32_16x16x64_bf16 v[76:79],v[32:35],a[56:63],v1
flb_100294:
buffer_load_dwordx4 v[36:39],v0,s[20:23],s93 offen offset:1024 sc1
s_mov_b32 s55,224
s_bitcmp1_b32 s55,6
s_cbranch_scc0 rdn_100385
s_waitcnt vmcnt(6)
v_max3_u32 v124,v40,v41,v42
v_max_u32 v124,v124,v43
v_cmp_eq_u32 vcc,-1,v124
s_cbranch_vccnz rfa_100386
buffer_load_dword v125,off,s[20:23],s92 sc1
s_bitset0_b32 s55,6
s_cmp_eq_u32 s55,0
s_cbranch_scc1 segb_100279
s_branch rnx_100387
rdn_100385:
buffer_load_dword v125,off,s[20:23],s92 sc1
s_branch rnx_100387
rfa_100386:
buffer_load_dwordx4 v[40:43],v0,s[20:23],s93 offen offset:2048 sc1
rnx_100387:
s_bitcmp1_b32 s55,7
s_cbranch_scc0 rdn_100388
s_waitcnt vmcnt(6)
v_max3_u32 v124,v44,v45,v46
v_max_u32 v124,v124,v47
v_cmp_eq_u32 vcc,-1,v124
s_cbranch_vccnz rfa_100389
buffer_load_dword v125,off,s[20:23],s92 sc1
s_bitset0_b32 s55,7
s_cmp_eq_u32 s55,0
s_cbranch_scc1 segb_100279
s_branch rnx_100390
rdn_100388:
buffer_load_dword v125,off,s[20:23],s92 sc1
s_branch rnx_100390
rfa_100389:
buffer_load_dwordx4 v[44:47],v0,s[20:23],s93 offen offset:3072 sc1
rnx_100390:
rot_100384:
s_bitcmp1_b32 s55,5
s_cbranch_scc0 rdn_100391
s_waitcnt vmcnt(2)
v_max3_u32 v124,v36,v37,v38
v_max_u32 v124,v124,v39
v_cmp_eq_u32 vcc,-1,v124
s_cbranch_vccnz rfa_100392
buffer_load_dword v125,off,s[20:23],s92 sc1
s_bitset0_b32 s55,5
v_smfmac_f32_16x16x64_bf16 v[48:51],v[36:39],a[64:71],v1
v_smfmac_f32_16x16x64_bf16 v[52:55],v[36:39],a[72:79],v1
v_smfmac_f32_16x16x64_bf16 v[56:59],v[36:39],a[80:87],v1
v_smfmac_f32_16x16x64_bf16 v[60:63],v[36:39],a[88:95],v1
v_smfmac_f32_16x16x64_bf16 v[64:67],v[36:39],a[96:103],v1
v_smfmac_f32_16x16x64_bf16 v[68:71],v[36:39],a[104:111],v1
v_smfmac_f32_16x16x64_bf16 v[72:75],v[36:39],a[112:119],v1
v_smfmac_f32_16x16x64_bf16 v[76:79],v[36:39],a[120:127],v1
s_cmp_eq_u32 s55,0
s_cbranch_scc1 segb_100279
s_branch rnx_100393
rdn_100391:
buffer_load_dword v125,off,s[20:23],s92 sc1
s_branch rnx_100393
rfa_100392:
buffer_load_dwordx4 v[36:39],v0,s[20:23],s93 offen offset:1024 sc1
rnx_100393:
s_bitcmp1_b32 s55,6
s_cbranch_scc0 rdn_100394
s_waitcnt vmcnt(2)
v_max3_u32 v124,v40,v41,v42
v_max_u32 v124,v124,v43
v_cmp_eq_u32 vcc,-1,v124
s_cbranch_vccnz rfa_100395
buffer_load_dword v125,off,s[20:23],s92 sc1
s_bitset0_b32 s55,6
s_cmp_eq_u32 s55,0
s_cbranch_scc1 segb_100279
s_branch rnx_100396
rdn_100394:
buffer_load_dword v125,off,s[20:23],s92 sc1
s_branch rnx_100396
rfa_100395:
buffer_load_dwordx4 v[40:43],v0,s[20:23],s93 offen offset:2048 sc1
rnx_100396:
s_bitcmp1_b32 s55,7
s_cbranch_scc0 rdn_100397
s_waitcnt vmcnt(2)
v_max3_u32 v124,v44,v45,v46
v_max_u32 v124,v124,v47
v_cmp_eq_u32 vcc,-1,v124
s_cbranch_vccnz rfa_100398
buffer_load_dword v125,off,s[20:23],s92 sc1
s_bitset0_b32 s55,7
s_cmp_eq_u32 s55,0
s_cbranch_scc1 segb_100279
s_branch rnx_100399
rdn_100397:
buffer_load_dword v125,off,s[20:23],s92 sc1
s_branch rnx_100399
rfa_100398:
buffer_load_dwordx4 v[44:47],v0,s[20:23],s93 offen offset:3072 sc1
rnx_100399:
s_sub_u32 s90,s90,1
s_cmp_gt_i32 s90,0
s_cbranch_scc1 rot_100384
s_mov_b32 s55,0
s_branch segb_100279
fl_100287:
v_smfmac_f32_16x16x64_bf16 v[76:79],v[36:39],a[120:127],v1
flb_100295:
s_mov_b32 s55,192
s_bitcmp1_b32 s55,6
s_cbranch_scc0 rdn_100401
s_waitcnt vmcnt(6)
v_max3_u32 v124,v40,v41,v42
v_max_u32 v124,v124,v43
v_cmp_eq_u32 vcc,-1,v124
s_cbranch_vccnz rfa_100402
buffer_load_dword v125,off,s[20:23],s92 sc1
s_bitset0_b32 s55,6
s_cmp_eq_u32 s55,0
s_cbranch_scc1 segb_100279
s_branch rnx_100403
rdn_100401:
buffer_load_dword v125,off,s[20:23],s92 sc1
s_branch rnx_100403
rfa_100402:
buffer_load_dwordx4 v[40:43],v0,s[20:23],s93 offen offset:2048 sc1
rnx_100403:
s_bitcmp1_b32 s55,7
s_cbranch_scc0 rdn_100404
s_waitcnt vmcnt(6)
v_max3_u32 v124,v44,v45,v46
v_max_u32 v124,v124,v47
v_cmp_eq_u32 vcc,-1,v124
s_cbranch_vccnz rfa_100405
buffer_load_dword v125,off,s[20:23],s92 sc1
s_bitset0_b32 s55,7
s_cmp_eq_u32 s55,0
s_cbranch_scc1 segb_100279
s_branch rnx_100406
rdn_100404:
buffer_load_dword v125,off,s[20:23],s92 sc1
s_branch rnx_100406
rfa_100405:
buffer_load_dwordx4 v[44:47],v0,s[20:23],s93 offen offset:3072 sc1
rnx_100406:
rot_100400:
s_bitcmp1_b32 s55,6
s_cbranch_scc0 rdn_100407
s_waitcnt vmcnt(1)
v_max3_u32 v124,v40,v41,v42
v_max_u32 v124,v124,v43
v_cmp_eq_u32 vcc,-1,v124
s_cbranch_vccnz rfa_100408
buffer_load_dword v125,off,s[20:23],s92 sc1
s_bitset0_b32 s55,6
s_cmp_eq_u32 s55,0
s_cbranch_scc1 segb_100279
s_branch rnx_100409
rdn_100407:
buffer_load_dword v125,off,s[20:23],s92 sc1
s_branch rnx_100409
rfa_100408:
buffer_load_dwordx4 v[40:43],v0,s[20:23],s93 offen offset:2048 sc1
rnx_100409:
s_bitcmp1_b32 s55,7
s_cbranch_scc0 rdn_100410
s_waitcnt vmcnt(1)
v_max3_u32 v124,v44,v45,v46
v_max_u32 v124,v124,v47
v_cmp_eq_u32 vcc,-1,v124
s_cbranch_vccnz rfa_100411
buffer_load_dword v125,off,s[20:23],s92 sc1
s_bitset0_b32 s55,7
s_cmp_eq_u32 s55,0
s_cbranch_scc1 segb_100279
s_branch rnx_100412
rdn_100410:
buffer_load_dword v125,off,s[20:23],s92 sc1
s_branch rnx_100412
rfa_100411:
buffer_load_dwordx4 v[44:47],v0,s[20:23],s93 offen offset:3072 sc1
rnx_100412:
s_sub_u32 s90,s90,1
s_cmp_gt_i32 s90,0
s_cbranch_scc1 rot_100400
s_mov_b32 s55,0
s_branch segb_100279
dfl_100353:
buffer_load_dwordx4 v[20:23],v0,s[20:23],s92 offen offset:1024 sc1
s_bitset1_b32 s55,1
buffer_load_dwordx4 v[36:39],v0,s[20:23],s93 offen offset:1024 sc1
s_waitcnt vmcnt(5)
v_max3_u32 v124,v24,v25,v26
v_max_u32 v124,v124,v27
v_cmp_eq_u32 vcc,-1,v124
s_cbranch_vccnz dfl_100354
s_branch dseg_100357
dfl_100354:
buffer_load_dwordx4 v[24:27],v0,s[20:23],s92 offen offset:2048 sc1
s_bitset1_b32 s55,2
buffer_load_dwordx4 v[40:43],v0,s[20:23],s93 offen offset:2048 sc1
buffer_load_dwordx4 v[44:47],v0,s[20:23],s93 offen offset:3072 sc1
s_waitcnt vmcnt(7)
v_max3_u32 v124,v28,v29,v30
v_max_u32 v124,v124,v31
v_cmp_eq_u32 vcc,-1,v124
s_cbranch_vccnz dfl_100355
s_branch dseg_100358
dfl_100355:
buffer_load_dwordx4 v[28:31],v0,s[20:23],s92 offen offset:3072 sc1
s_bitset1_b32 s55,3
s_branch lap2_100359
dseg_100357:
v_smfmac_f32_16x16x64_bf16 v[48:51],v[24:27],a[128:135],v1
buffer_load_dword v125,off,s[20:23],s92 sc1
v_smfmac_f32_16x16x64_bf16 v[52:55],v[24:27],a[136:143],v1
buffer_load_dwordx4 v[40:43],v0,s[20:23],s93 offen offset:2048 sc1
v_smfmac_f32_16x16x64_bf16 v[56:59],v[24:27],a[144:151],v1
buffer_load_dwordx4 v[44:47],v0,s[20:23],s93 offen offset:3072 sc1
s_waitcnt vmcnt(7)
v_max3_u32 v124,v28,v29,v30
v_smfmac_f32_16x16x64_bf16 v[60:63],v[24:27],a[152:159],v1
v_max_u32 v124,v124,v31
v_smfmac_f32_16x16x64_bf16 v[64:67],v[24:27],a[160:167],v1
v_cmp_eq_u32 vcc,-1,v124
v_smfmac_f32_16x16x64_bf16 v[68:71],v[24:27],a[168:175],v1
v_smfmac_f32_16x16x64_bf16 v[72:75],v[24:27],a[176:183],v1
v_smfmac_f32_16x16x64_bf16 v[76:79],v[24:27],a[184:191],v1
s_cbranch_vccnz dfl_100355
dseg_100358:
v_smfmac_f32_16x16x64_bf16 v[48:51],v[28:31],a[192:199],v1
buffer_load_dword v125,off,s[20:23],s92 sc1
v_smfmac_f32_16x16x64_bf16 v[52:55],v[28:31],a[200:207],v1
v_smfmac_f32_16x16x64_bf16 v[56:59],v[28:31],a[208:215],v1
v_smfmac_f32_16x16x64_bf16 v[60:63],v[28:31],a[216:223],v1
v_smfmac_f32_16x16x64_bf16 v[64:67],v[28:31],a[224:231],v1
v_smfmac_f32_16x16x64_bf16 v[68:71],v[28:31],a[232:239],v1
v_smfmac_f32_16x16x64_bf16 v[72:75],v[28:31],a[240:247],v1
v_smfmac_f32_16x16x64_bf16 v[76:79],v[28:31],a[248:255],v1
lap2_100359:
s_bitcmp1_b32 s55,0
s_cbranch_scc0 l2s_100413
s_waitcnt vmcnt(7)
v_max3_u32 v124,v16,v17,v18
v_max_u32 v124,v124,v19
v_cmp_eq_u32 vcc,-1,v124
s_cbranch_vccnz l2s_100413
s_bitset0_b32 s55,0
v_smfmac_f32_16x16x64_bf16 v[48:51],v[16:19],a[0:7],v1
v_smfmac_f32_16x16x64_bf16 v[52:55],v[16:19],a[8:15],v1
v_smfmac_f32_16x16x64_bf16 v[56:59],v[16:19],a[16:23],v1
v_smfmac_f32_16x16x64_bf16 v[60:63],v[16:19],a[24:31],v1
v_smfmac_f32_16x16x64_bf16 v[64:67],v[16:19],a[32:39],v1
v_smfmac_f32_16x16x64_bf16 v[68:71],v[16:19],a[40:47],v1
v_smfmac_f32_16x16x64_bf16 v[72:75],v[16:19],a[48:55],v1
v_smfmac_f32_16x16x64_bf16 v[76:79],v[16:19],a[56:63],v1
l2s_100413:
s_bitcmp1_b32 s55,1
s_cbranch_scc0 l2s_100415
s_waitcnt vmcnt(5)
v_max3_u32 v124,v20,v21,v22
v_max_u32 v124,v124,v23
v_cmp_eq_u32 vcc,-1,v124
s_cbranch_vccnz l2s_100415
s_bitset0_b32 s55,1
v_smfmac_f32_16x16x64_bf16 v[48:51],v[20:23],a[64:71],v1
v_smfmac_f32_16x16x64_bf16 v[52:55],v[20:23],a[72:79],v1
v_smfmac_f32_16x16x64_bf16 v[56:59],v[20:23],a[80:87],v1
v_smfmac_f32_16x16x64_bf16 v[60:63],v[20:23],a[88:95],v1
v_smfmac_f32_16x16x64_bf16 v[64:67],v[20:23],a[96:103],v1
v_smfmac_f32_16x16x64_bf16 v[68:71],v[20:23],a[104:111],v1
v_smfmac_f32_16x16x64_bf16 v[72:75],v[20:23],a[112:119],v1
v_smfmac_f32_16x16x64_bf16 v[76:79],v[20:23],a[120:127],v1
l2s_100415:
s_bitcmp1_b32 s55,2
s_cbranch_scc0 l2s_100417
s_waitcnt vmcnt(3)
v_max3_u32 v124,v24,v25,v26
v_max_u32 v124,v124,v27
v_cmp_eq_u32 vcc,-1,v124
s_cbranch_vccnz l2s_100417
s_bitset0_b32 s55,2
v_smfmac_f32_16x16x64_bf16 v[48:51],v[24:27],a[128:135],v1
v_smfmac_f32_16x16x64_bf16 v[52:55],v[24:27],a[136:143],v1
v_smfmac_f32_16x16x64_bf16 v[56:59],v[24:27],a[144:151],v1
v_smfmac_f32_16x16x64_bf16 v[60:63],v[24:27],a[152:159],v1
v_smfmac_f32_16x16x64_bf16 v[64:67],v[24:27],a[160:167],v1
v_smfmac_f32_16x16x64_bf16 v[68:71],v[24:27],a[168:175],v1
v_smfmac_f32_16x16x64_bf16 v[72:75],v[24:27],a[176:183],v1
v_smfmac_f32_16x16x64_bf16 v[76:79],v[24:27],a[184:191],v1
l2s_100417:
s_bitcmp1_b32 s55,3
s_cbranch_scc0 l2s_100419
s_waitcnt vmcnt(0)
v_max3_u32 v124,v28,v29,v30
v_max_u32 v124,v124,v31
v_cmp_eq_u32 vcc,-1,v124
s_cbranch_vccnz l2s_100419
s_bitset0_b32 s55,3
v_smfmac_f32_16x16x64_bf16 v[48:51],v[28:31],a[192:199],v1
v_smfmac_f32_16x16x64_bf16 v[52:55],v[28:31],a[200:207],v1
v_smfmac_f32_16x16x64_bf16 v[56:59],v[28:31],a[208:215],v1
v_smfmac_f32_16x16x64_bf16 v[60:63],v[28:31],a[216:223],v1
v_smfmac_f32_16x16x64_bf16 v[64:67],v[28:31],a[224:231],v1
v_smfmac_f32_16x16x64_bf16 v[68:71],v[28:31],a[232:239],v1
v_smfmac_f32_16x16x64_bf16 v[72:75],v[28:31],a[240:247],v1
v_smfmac_f32_16x16x64_bf16 v[76:79],v[28:31],a[248:255],v1
l2s_100419:
s_cmp_eq_u32 s55,0
s_cbranch_scc0 lfb_100360
Ldone_100361:
s_waitcnt vmcnt(6)
v_max3_u32 v124,v32,v33,v34
v_max_u32 v124,v124,v35
v_cmp_eq_u32 vcc,-1,v124
s_cbranch_vccnz flb_100293
s_branch segb_100277
lfb_100360:
s_bitcmp1_b32 s55,0
s_cbranch_scc0 dsk_100421
buffer_load_dwordx4 v[16:19],v0,s[20:23],s92 offen offset:0 sc1
dsk_100421:
s_bitcmp1_b32 s55,1
s_cbranch_scc0 dsk_100422
buffer_load_dwordx4 v[20:23],v0,s[20:23],s92 offen offset:1024 sc1
dsk_100422:
s_bitcmp1_b32 s55,2
s_cbranch_scc0 dsk_100423
buffer_load_dwordx4 v[24:27],v0,s[20:23],s92 offen offset:2048 sc1
dsk_100423:
s_bitcmp1_b32 s55,3
s_cbranch_scc0 dsk_100424
buffer_load_dwordx4 v[28:31],v0,s[20:23],s92 offen offset:3072 sc1
dsk_100424:
s_bitcmp1_b32 s55,0
s_cbranch_scc0 dsk_100425
s_waitcnt vmcnt(2)
v_max3_u32 v124,v16,v17,v18
v_max_u32 v124,v124,v19
v_cmp_eq_u32 vcc,-1,v124
s_cbranch_vccz dgo_100426
s_nop 15
buffer_load_dwordx4 v[104:107],v0,s[20:23],s92 offen offset:0 sc1
s_nop 15
buffer_load_dwordx4 v[108:111],v0,s[20:23],s92 offen offset:0 sc1
dlp_100427:
s_waitcnt vmcnt(2)
v_max3_u32 v124,v16,v17,v18
v_max_u32 v124,v124,v19
v_cmp_eq_u32 vcc,-1,v124
s_cbranch_vccz dgo_100426
buffer_load_dwordx4 v[16:19],v0,s[20:23],s92 offen offset:0 sc1
s_waitcnt vmcnt(2)
v_max3_u32 v124,v104,v105,v106
v_max_u32 v124,v124,v107
v_cmp_eq_u32 vcc,-1,v124
s_cbranch_vccz dcp_100429
buffer_load_dwordx4 v[104:107],v0,s[20:23],s92 offen offset:0 sc1
s_waitcnt vmcnt(2)
v_max3_u32 v124,v108,v109,v110
v_max_u32 v124,v124,v111
v_cmp_eq_u32 vcc,-1,v124
s_cbranch_vccz dcp_100430
buffer_load_dwordx4 v[108:111],v0,s[20:23],s92 offen offset:0 sc1
s_sub_u32 s90,s90,1
s_cmp_gt_i32 s90,0
s_cbranch_scc1 dlp_100427
s_branch dgo_100426
dcp_100429:
v_mov_b32 v16,v104
v_mov_b32 v17,v105
v_mov_b32 v18,v106
v_mov_b32 v19,v107
s_nop 1
s_branch dgo_100426
dcp_100430:
v_mov_b32 v16,v108
v_mov_b32 v17,v109
v_mov_b32 v18,v110
v_mov_b32 v19,v111
s_nop 1
dgo_100426:
v_smfmac_f32_16x16x64_bf16 v[48:51],v[16:19],a[0:7],v1
v_smfmac_f32_16x16x64_bf16 v[52:55],v[16:19],a[8:15],v1
v_smfmac_f32_16x16x64_bf16 v[56:59],v[16:19],a[16:23],v1
v_smfmac_f32_16x16x64_bf16 v[60:63],v[16:19],a[24:31],v1
v_smfmac_f32_16x16x64_bf16 v[64:67],v[16:19],a[32:39],v1
v_smfmac_f32_16x16x64_bf16 v[68:71],v[16:19],a[40:47],v1
v_smfmac_f32_16x16x64_bf16 v[72:75],v[16:19],a[48:55],v1
v_smfmac_f32_16x16x64_bf16 v[76:79],v[16:19],a[56:63],v1
dsk_100425:
s_bitcmp1_b32 s55,1
s_cbranch_scc0 dsk_100431
s_waitcnt vmcnt(2)
v_max3_u32 v124,v20,v21,v22
v_max_u32 v124,v124,v23
v_cmp_eq_u32 vcc,-1,v124
s_cbranch_vccz dgo_100432
s_nop 15
buffer_load_dwordx4 v[104:107],v0,s[20:23],s92 offen offset:1024 sc1
s_nop 15
buffer_load_dwordx4 v[108:111],v0,s[20:23],s92 offen offset:1024 sc1
dlp_100433:
s_waitcnt vmcnt(2)
v_max3_u32 v124,v20,v21,v22
v_max_u32 v124,v124,v23
v_cmp_eq_u32 vcc,-1,v124
s_cbranch_vccz dgo_100432
buffer_load_dwordx4 v[20:23],v0,s[20:23],s92 offen offset:1024 sc1
s_waitcnt vmcnt(2)
v_max3_u32 v124,v104,v105,v106
v_max_u32 v124,v124,v107
v_cmp_eq_u32 vcc,-1,v124
s_cbranch_vccz dcp_100435
buffer_load_dwordx4 v[104:107],v0,s[20:23],s92 offen offset:1024 sc1
s_waitcnt vmcnt(2)
v_max3_u32 v124,v108,v109,v110
v_max_u32 v124,v124,v111
v_cmp_eq_u32 vcc,-1,v124
s_cbranch_vccz dcp_100436
buffer_load_dwordx4 v[108:111],v0,s[20:23],s92 offen offset:1024 sc1
s_sub_u32 s90,s90,1
s_cmp_gt_i32 s90,0
s_cbranch_scc1 dlp_100433
s_branch dgo_100432
dcp_100435:
v_mov_b32 v20,v104
v_mov_b32 v21,v105
v_mov_b32 v22,v106
v_mov_b32 v23,v107
s_nop 1
s_branch dgo_100432
dcp_100436:
v_mov_b32 v20,v108
v_mov_b32 v21,v109
v_mov_b32 v22,v110
v_mov_b32 v23,v111
s_nop 1
dgo_100432:
v_smfmac_f32_16x16x64_bf16 v[48:51],v[20:23],a[64:71],v1
v_smfmac_f32_16x16x64_bf16 v[52:55],v[20:23],a[72:79],v1
v_smfmac_f32_16x16x64_bf16 v[56:59],v[20:23],a[80:87],v1
v_smfmac_f32_16x16x64_bf16 v[60:63],v[20:23],a[88:95],v1
v_smfmac_f32_16x16x64_bf16 v[64:67],v[20:23],a[96:103],v1
v_smfmac_f32_16x16x64_bf16 v[68:71],v[20:23],a[104:111],v1
v_smfmac_f32_16x16x64_bf16 v[72:75],v[20:23],a[112:119],v1
v_smfmac_f32_16x16x64_bf16 v[76:79],v[20:23],a[120:127],v1
dsk_100431:
s_bitcmp1_b32 s55,2
s_cbranch_scc0 dsk_100437
s_waitcnt vmcnt(2)
v_max3_u32 v124,v24,v25,v26
v_max_u32 v124,v124,v27
v_cmp_eq_u32 vcc,-1,v124
s_cbranch_vccz dgo_100438
s_nop 15
buffer_load_dwordx4 v[104:107],v0,s[20:23],s92 offen offset:2048 sc1
s_nop 15
buffer_load_dwordx4 v[108:111],v0,s[20:23],s92 offen offset:2048 sc1
dlp_100439:
s_waitcnt vmcnt(2)
v_max3_u32 v124,v24,v25,v26
v_max_u32 v124,v124,v27
v_cmp_eq_u32 vcc,-1,v124
s_cbranch_vccz dgo_100438
buffer_load_dwordx4 v[24:27],v0,s[20:23],s92 offen offset:2048 sc1
s_waitcnt vmcnt(2)
v_max3_u32 v124,v104,v105,v106
v_max_u32 v124,v124,v107
v_cmp_eq_u32 vcc,-1,v124
s_cbranch_vccz dcp_100441
buffer_load_dwordx4 v[104:107],v0,s[20:23],s92 offen offset:2048 sc1
s_waitcnt vmcnt(2)
v_max3_u32 v124,v108,v109,v110
v_max_u32 v124,v124,v111
v_cmp_eq_u32 vcc,-1,v124
s_cbranch_vccz dcp_100442
buffer_load_dwordx4 v[108:111],v0,s[20:23],s92 offen offset:2048 sc1
s_sub_u32 s90,s90,1
s_cmp_gt_i32 s90,0
s_cbranch_scc1 dlp_100439
s_branch dgo_100438
dcp_100441:
v_mov_b32 v24,v104
v_mov_b32 v25,v105
v_mov_b32 v26,v106
v_mov_b32 v27,v107
s_nop 1
s_branch dgo_100438
dcp_100442:
v_mov_b32 v24,v108
v_mov_b32 v25,v109
v_mov_b32 v26,v110
v_mov_b32 v27,v111
s_nop 1
dgo_100438:
v_smfmac_f32_16x16x64_bf16 v[48:51],v[24:27],a[128:135],v1
v_smfmac_f32_16x16x64_bf16 v[52:55],v[24:27],a[136:143],v1
v_smfmac_f32_16x16x64_bf16 v[56:59],v[24:27],a[144:151],v1
v_smfmac_f32_16x16x64_bf16 v[60:63],v[24:27],a[152:159],v1
v_smfmac_f32_16x16x64_bf16 v[64:67],v[24:27],a[160:167],v1
v_smfmac_f32_16x16x64_bf16 v[68:71],v[24:27],a[168:175],v1
v_smfmac_f32_16x16x64_bf16 v[72:75],v[24:27],a[176:183],v1
v_smfmac_f32_16x16x64_bf16 v[76:79],v[24:27],a[184:191],v1
dsk_100437:
s_bitcmp1_b32 s55,3
s_cbranch_scc0 dsk_100443
s_waitcnt vmcnt(2)
v_max3_u32 v124,v28,v29,v30
v_max_u32 v124,v124,v31
v_cmp_eq_u32 vcc,-1,v124
s_cbranch_vccz dgo_100444
s_nop 15
buffer_load_dwordx4 v[104:107],v0,s[20:23],s92 offen offset:3072 sc1
s_nop 15
buffer_load_dwordx4 v[108:111],v0,s[20:23],s92 offen offset:3072 sc1
dlp_100445:
s_waitcnt vmcnt(2)
v_max3_u32 v124,v28,v29,v30
v_max_u32 v124,v124,v31
v_cmp_eq_u32 vcc,-1,v124
s_cbranch_vccz dgo_100444
buffer_load_dwordx4 v[28:31],v0,s[20:23],s92 offen offset:3072 sc1
s_waitcnt vmcnt(2)
v_max3_u32 v124,v104,v105,v106
v_max_u32 v124,v124,v107
v_cmp_eq_u32 vcc,-1,v124
s_cbranch_vccz dcp_100447
buffer_load_dwordx4 v[104:107],v0,s[20:23],s92 offen offset:3072 sc1
s_waitcnt vmcnt(2)
v_max3_u32 v124,v108,v109,v110
v_max_u32 v124,v124,v111
v_cmp_eq_u32 vcc,-1,v124
s_cbranch_vccz dcp_100448
buffer_load_dwordx4 v[108:111],v0,s[20:23],s92 offen offset:3072 sc1
s_sub_u32 s90,s90,1
s_cmp_gt_i32 s90,0
s_cbranch_scc1 dlp_100445
s_branch dgo_100444
dcp_100447:
v_mov_b32 v28,v104
v_mov_b32 v29,v105
v_mov_b32 v30,v106
v_mov_b32 v31,v107
s_nop 1
s_branch dgo_100444
dcp_100448:
v_mov_b32 v28,v108
v_mov_b32 v29,v109
v_mov_b32 v30,v110
v_mov_b32 v31,v111
s_nop 1
dgo_100444:
v_smfmac_f32_16x16x64_bf16 v[48:51],v[28:31],a[192:199],v1
v_smfmac_f32_16x16x64_bf16 v[52:55],v[28:31],a[200:207],v1
v_smfmac_f32_16x16x64_bf16 v[56:59],v[28:31],a[208:215],v1
v_smfmac_f32_16x16x64_bf16 v[60:63],v[28:31],a[216:223],v1
v_smfmac_f32_16x16x64_bf16 v[64:67],v[28:31],a[224:231],v1
v_smfmac_f32_16x16x64_bf16 v[68:71],v[28:31],a[232:239],v1
v_smfmac_f32_16x16x64_bf16 v[72:75],v[28:31],a[240:247],v1
v_smfmac_f32_16x16x64_bf16 v[76:79],v[28:31],a[248:255],v1
dsk_100443:
s_mov_b32 s55,0
s_branch Ldone_100361
slowA_100297:
buffer_load_dwordx4 v[44:47],v0,s[20:23],s93 offen offset:3072 sc1
dsk_100449:
s_bitcmp1_b32 s55,7
s_cbranch_scc0 dsk_100450
s_waitcnt vmcnt(2)
v_max3_u32 v124,v44,v45,v46
v_max_u32 v124,v124,v47
v_cmp_eq_u32 vcc,-1,v124
s_cbranch_vccz dgo_100451
s_nop 15
s_nop 3
buffer_load_dwordx4 v[104:107],v0,s[20:23],s93 offen offset:3072 sc1
s_nop 15
s_nop 3
buffer_load_dwordx4 v[108:111],v0,s[20:23],s93 offen offset:3072 sc1
dlp_100452:
s_waitcnt vmcnt(2)
v_max3_u32 v124,v44,v45,v46
v_max_u32 v124,v124,v47
v_cmp_eq_u32 vcc,-1,v124
s_cbranch_vccz dgo_100451
buffer_load_dwordx4 v[44:47],v0,s[20:23],s93 offen offset:3072 sc1
s_waitcnt vmcnt(2)
v_max3_u32 v124,v104,v105,v106
v_max_u32 v124,v124,v107
v_cmp_eq_u32 vcc,-1,v124
s_cbranch_vccz dcp_100454
buffer_load_dwordx4 v[104:107],v0,s[20:23],s93 offen offset:3072 sc1
s_waitcnt vmcnt(2)
v_max3_u32 v124,v108,v109,v110
v_max_u32 v124,v124,v111
v_cmp_eq_u32 vcc,-1,v124
s_cbranch_vccz dcp_100455
buffer_load_dwordx4 v[108:111],v0,s[20:23],s93 offen offset:3072 sc1
s_sub_u32 s90,s90,1
s_cmp_gt_i32 s90,0
s_cbranch_scc1 dlp_100452
s_branch dgo_100451
dcp_100454:
v_mov_b32 v44,v104
v_mov_b32 v45,v105
v_mov_b32 v46,v106
v_mov_b32 v47,v107
s_nop 1
s_branch dgo_100451
dcp_100455:
v_mov_b32 v44,v108
v_mov_b32 v45,v109
v_mov_b32 v46,v110
v_mov_b32 v47,v111
s_nop 1
dgo_100451:
dsk_100450:
s_mov_b32 s55,0
s_branch segb_100279
srt_100304:
s_sub_u32 s90,s90,1
s_cmp_gt_i32 s90,0
s_cbranch_scc0 sok_100303
buffer_load_dwordx4 v[16:19],v2,s[20:23],s94 offen offset:0 sc1
buffer_load_dwordx4 v[32:35],v2,s[20:23],s94 offen offset:1536 sc1
buffer_load_dwordx4 v[20:23],v2,s[20:23],s95 offen offset:0 sc1
buffer_load_dwordx4 v[36:39],v2,s[20:23],s95 offen offset:1536 sc1
buffer_load_dword v120,v3,s[20:23],s94 offen offset:0 sc1
buffer_load_dword v121,v3,s[20:23],s94 offen offset:1536 sc1
buffer_load_dword v122,v3,s[20:23],s95 offen offset:0 sc1
buffer_load_dword v123,v3,s[20:23],s95 offen offset:1536 sc1
s_branch sp_100302
of_100305:
s_mov_b32 s55,3
buffer_load_dwordx4 v[16:19],v0,s[20:23],s96 offen offset:0 sc1
buffer_load_dwordx4 v[20:23],v0,s[20:23],s96 offen offset:1024 sc1
v_readfirstlane_b32 s91,v126
s_waitcnt vmcnt(6)
v_max3_u32 v124,v24,v25,v26
v_max3_u32 v124,v124,v27,v28
v_max3_u32 v124,v124,v29,v30
v_max_u32 v124,v124,v31
v_cmp_eq_u32 vcc,-1,v124
s_cbranch_vccnz ost_100457
v_smfmac_f32_16x16x64_bf16 v[96:99],v[24:27],v[80:87],v1
buffer_load_dword v120,off,s[20:23],s96 sc1
v_smfmac_f32_16x16x64_bf16 v[100:103],v[24:27],v[88:95],v1
buffer_load_dword v120,off,s[20:23],s96 sc1
v_smfmac_f32_16x16x64_bf16 v[96:99],v[28:31],v[128:135],v1
v_smfmac_f32_16x16x64_bf16 v[100:103],v[28:31],v[136:143],v1
ort_100458:
s_waitcnt vmcnt(6)
v_max3_u32 v124,v32,v33,v34
v_max3_u32 v124,v124,v35,v36
v_max3_u32 v124,v124,v37,v38
v_max_u32 v124,v124,v39
v_cmp_eq_u32 vcc,-1,v124
s_cbranch_vccnz ost_100459
v_smfmac_f32_16x16x64_bf16 v[96:99],v[32:35],v[144:151],v1
buffer_load_dword v120,off,s[20:23],s96 sc1
v_smfmac_f32_16x16x64_bf16 v[100:103],v[32:35],v[152:159],v1
buffer_load_dword v120,off,s[20:23],s96 sc1
v_smfmac_f32_16x16x64_bf16 v[96:99],v[36:39],v[160:167],v1
v_smfmac_f32_16x16x64_bf16 v[100:103],v[36:39],v[168:175],v1
ort_100460:
s_waitcnt vmcnt(7)
v_max3_u32 v124,v40,v41,v42
v_max_u32 v124,v124,v43
v_cmp_eq_u32 vcc,-1,v124
s_cbranch_vccnz ost_100461
v_smfmac_f32_16x16x64_bf16 v[96:99],v[40:43],v[176:183],v1
buffer_load_dword v120,off,s[20:23],s96 sc1
v_smfmac_f32_16x16x64_bf16 v[100:103],v[40:43],v[184:191],v1
ort_100462:
s_waitcnt vmcnt(7)
v_max3_u32 v124,v44,v45,v46
v_max_u32 v124,v124,v47
v_cmp_eq_u32 vcc,-1,v124
s_cbranch_vccnz ost_100463
v_smfmac_f32_16x16x64_bf16 v[96:99],v[44:47],v[192:199],v1
buffer_load_dword v120,off,s[20:23],s96 sc1
v_smfmac_f32_16x16x64_bf16 v[100:103],v[44:47],v[200:207],v1
ort_100464:
s_waitcnt vmcnt(6)
v_max3_u32 v124,v16,v17,v18
v_max3_u32 v124,v124,v19,v20
v_max3_u32 v124,v124,v21,v22
v_max_u32 v124,v124,v23
v_cmp_eq_u32 vcc,-1,v124
s_cbranch_vccnz olap2_100456
s_andn2_b32 s55,s55,3
v_smfmac_f32_16x16x64_bf16 v[96:99],v[16:19],v[48:55],v1
v_smfmac_f32_16x16x64_bf16 v[100:103],v[16:19],v[56:63],v1
v_smfmac_f32_16x16x64_bf16 v[96:99],v[20:23],v[64:71],v1
v_smfmac_f32_16x16x64_bf16 v[100:103],v[20:23],v[72:79],v1
s_cbranch_scc0 oback_100316
s_branch olap2_100456
ost_100457:
buffer_load_dwordx4 v[24:27],v0,s[20:23],s96 offen offset:2048 sc1
buffer_load_dwordx4 v[28:31],v0,s[20:23],s96 offen offset:3072 sc1
s_or_b32 s55,s55,12
s_branch ort_100458
ost_100459:
buffer_load_dwordx4 v[32:35],v0,s[20:23],s97 offen offset:0 sc1
buffer_load_dwordx4 v[36:39],v0,s[20:23],s97 offen offset:1024 sc1
s_or_b32 s55,s55,48
s_branch ort_100460
ost_100461:
buffer_load_dwordx4 v[40:43],v0,s[20:23],s97 offen offset:2048 sc1
s_or_b32 s55,s55,64
s_branch ort_100462
ost_100463:
buffer_load_dwordx4 v[44:47],v0,s[20:23],s97 offen offset:3072 sc1
s_or_b32 s55,s55,128
s_branch ort_100464
of_100306:
s_mov_b32 s55,12
buffer_load_dwordx4 v[24:27],v0,s[20:23],s96 offen offset:2048 sc1
buffer_load_dwordx4 v[28:31],v0,s[20:23],s96 offen offset:3072 sc1
s_waitcnt vmcnt(4)
v_max3_u32 v124,v32,v33,v34
v_max3_u32 v124,v124,v35,v36
v_max3_u32 v124,v124,v37,v38
v_max_u32 v124,v124,v39
v_cmp_eq_u32 vcc,-1,v124
s_cbranch_vccnz ost_100466
v_smfmac_f32_16x16x64_bf16 v[96:99],v[32:35],v[144:151],v1
buffer_load_dword v120,off,s[20:23],s96 sc1
v_smfmac_f32_16x16x64_bf16 v[100:103],v[32:35],v[152:159],v1
buffer_load_dword v120,off,s[20:23],s96 sc1
v_smfmac_f32_16x16x64_bf16 v[96:99],v[36:39],v[160:167],v1
v_smfmac_f32_16x16x64_bf16 v[100:103],v[36:39],v[168:175],v1
ort_100467:
s_waitcnt vmcnt(5)
v_max3_u32 v124,v40,v41,v42
v_max_u32 v124,v124,v43
v_cmp_eq_u32 vcc,-1,v124
s_cbranch_vccnz ost_100468
v_smfmac_f32_16x16x64_bf16 v[96:99],v[40:43],v[176:183],v1
buffer_load_dword v120,off,s[20:23],s96 sc1
v_smfmac_f32_16x16x64_bf16 v[100:103],v[40:43],v[184:191],v1
ort_100469:
s_waitcnt vmcnt(5)
v_max3_u32 v124,v44,v45,v46
v_max_u32 v124,v124,v47
v_cmp_eq_u32 vcc,-1,v124
s_cbranch_vccnz ost_100470
v_smfmac_f32_16x16x64_bf16 v[96:99],v[44:47],v[192:199],v1
buffer_load_dword v120,off,s[20:23],s96 sc1
v_smfmac_f32_16x16x64_bf16 v[100:103],v[44:47],v[200:207],v1
ort_100471:
s_waitcnt vmcnt(4)
v_max3_u32 v124,v24,v25,v26
v_max3_u32 v124,v124,v27,v28
v_max3_u32 v124,v124,v29,v30
v_max_u32 v124,v124,v31
v_cmp_eq_u32 vcc,-1,v124
s_cbranch_vccnz olap2_100456
s_andn2_b32 s55,s55,12
v_smfmac_f32_16x16x64_bf16 v[96:99],v[24:27],v[80:87],v1
v_smfmac_f32_16x16x64_bf16 v[100:103],v[24:27],v[88:95],v1
v_smfmac_f32_16x16x64_bf16 v[96:99],v[28:31],v[128:135],v1
v_smfmac_f32_16x16x64_bf16 v[100:103],v[28:31],v[136:143],v1
s_cbranch_scc0 oback_100316
s_branch olap2_100456
ost_100466:
buffer_load_dwordx4 v[32:35],v0,s[20:23],s97 offen offset:0 sc1
buffer_load_dwordx4 v[36:39],v0,s[20:23],s97 offen offset:1024 sc1
s_or_b32 s55,s55,48
s_branch ort_100467
ost_100468:
buffer_load_dwordx4 v[40:43],v0,s[20:23],s97 offen offset:2048 sc1
s_or_b32 s55,s55,64
s_branch ort_100469
ost_100470:
buffer_load_dwordx4 v[44:47],v0,s[20:23],s97 offen offset:3072 sc1
s_or_b32 s55,s55,128
s_branch ort_100471
of_100307:
s_mov_b32 s55,48
buffer_load_dwordx4 v[32:35],v0,s[20:23],s97 offen offset:0 sc1
buffer_load_dwordx4 v[36:39],v0,s[20:23],s97 offen offset:1024 sc1
s_waitcnt vmcnt(3)
v_max3_u32 v124,v40,v41,v42
v_max_u32 v124,v124,v43
v_cmp_eq_u32 vcc,-1,v124
s_cbranch_vccnz ost_100473
v_smfmac_f32_16x16x64_bf16 v[96:99],v[40:43],v[176:183],v1
buffer_load_dword v120,off,s[20:23],s96 sc1
v_smfmac_f32_16x16x64_bf16 v[100:103],v[40:43],v[184:191],v1
ort_100474:
s_waitcnt vmcnt(3)
v_max3_u32 v124,v44,v45,v46
v_max_u32 v124,v124,v47
v_cmp_eq_u32 vcc,-1,v124
s_cbranch_vccnz ost_100475
v_smfmac_f32_16x16x64_bf16 v[96:99],v[44:47],v[192:199],v1
buffer_load_dword v120,off,s[20:23],s96 sc1
v_smfmac_f32_16x16x64_bf16 v[100:103],v[44:47],v[200:207],v1
ort_100476:
s_waitcnt vmcnt(2)
v_max3_u32 v124,v32,v33,v34
v_max3_u32 v124,v124,v35,v36
v_max3_u32 v124,v124,v37,v38
v_max_u32 v124,v124,v39
v_cmp_eq_u32 vcc,-1,v124
s_cbranch_vccnz olap2_100456
s_andn2_b32 s55,s55,48
v_smfmac_f32_16x16x64_bf16 v[96:99],v[32:35],v[144:151],v1
v_smfmac_f32_16x16x64_bf16 v[100:103],v[32:35],v[152:159],v1
v_smfmac_f32_16x16x64_bf16 v[96:99],v[36:39],v[160:167],v1
v_smfmac_f32_16x16x64_bf16 v[100:103],v[36:39],v[168:175],v1
s_cbranch_scc0 oback_100316
s_branch olap2_100456
ost_100473:
buffer_load_dwordx4 v[40:43],v0,s[20:23],s97 offen offset:2048 sc1
s_or_b32 s55,s55,64
s_branch ort_100474
ost_100475:
buffer_load_dwordx4 v[44:47],v0,s[20:23],s97 offen offset:3072 sc1
s_or_b32 s55,s55,128
s_branch ort_100476
of_100308:
s_mov_b32 s55,64
buffer_load_dwordx4 v[40:43],v0,s[20:23],s97 offen offset:2048 sc1
s_waitcnt vmcnt(1)
v_max3_u32 v124,v44,v45,v46
v_max_u32 v124,v124,v47
v_cmp_eq_u32 vcc,-1,v124
s_cbranch_vccnz ost_100478
v_smfmac_f32_16x16x64_bf16 v[96:99],v[44:47],v[192:199],v1
buffer_load_dword v120,off,s[20:23],s96 sc1
v_smfmac_f32_16x16x64_bf16 v[100:103],v[44:47],v[200:207],v1
ort_100479:
s_waitcnt vmcnt(1)
v_max3_u32 v124,v40,v41,v42
v_max_u32 v124,v124,v43
v_cmp_eq_u32 vcc,-1,v124
s_cbranch_vccnz olap2_100456
s_andn2_b32 s55,s55,64
v_smfmac_f32_16x16x64_bf16 v[96:99],v[40:43],v[176:183],v1
v_smfmac_f32_16x16x64_bf16 v[100:103],v[40:43],v[184:191],v1
s_cbranch_scc0 oback_100316
s_branch olap2_100456
ost_100478:
buffer_load_dwordx4 v[44:47],v0,s[20:23],s97 offen offset:3072 sc1
s_or_b32 s55,s55,128
s_branch ort_100479
of_100309:
s_mov_b32 s55,128
s_branch oslow_100315
olap2_100456:
s_bitcmp1_b32 s55,0
s_cbranch_scc0 l2s_100481
s_waitcnt vmcnt(6)
v_max3_u32 v124,v16,v17,v18
v_max3_u32 v124,v124,v19,v20
v_max3_u32 v124,v124,v21,v22
v_max_u32 v124,v124,v23
v_cmp_eq_u32 vcc,-1,v124
s_cbranch_vccnz l2s_100481
s_andn2_b32 s55,s55,3
v_smfmac_f32_16x16x64_bf16 v[96:99],v[16:19],v[48:55],v1
v_smfmac_f32_16x16x64_bf16 v[100:103],v[16:19],v[56:63],v1
v_smfmac_f32_16x16x64_bf16 v[96:99],v[20:23],v[64:71],v1
v_smfmac_f32_16x16x64_bf16 v[100:103],v[20:23],v[72:79],v1
l2s_100481:
s_bitcmp1_b32 s55,2
s_cbranch_scc0 l2s_100482
s_waitcnt vmcnt(4)
v_max3_u32 v124,v24,v25,v26
v_max3_u32 v124,v124,v27,v28
v_max3_u32 v124,v124,v29,v30
v_max_u32 v124,v124,v31
v_cmp_eq_u32 vcc,-1,v124
s_cbranch_vccnz l2s_100482
s_andn2_b32 s55,s55,12
v_smfmac_f32_16x16x64_bf16 v[96:99],v[24:27],v[80:87],v1
v_smfmac_f32_16x16x64_bf16 v[100:103],v[24:27],v[88:95],v1
v_smfmac_f32_16x16x64_bf16 v[96:99],v[28:31],v[128:135],v1
v_smfmac_f32_16x16x64_bf16 v[100:103],v[28:31],v[136:143],v1
l2s_100482:
s_bitcmp1_b32 s55,4
s_cbranch_scc0 l2s_100483
s_waitcnt vmcnt(2)
v_max3_u32 v124,v32,v33,v34
v_max3_u32 v124,v124,v35,v36
v_max3_u32 v124,v124,v37,v38
v_max_u32 v124,v124,v39
v_cmp_eq_u32 vcc,-1,v124
s_cbranch_vccnz l2s_100483
s_andn2_b32 s55,s55,48
v_smfmac_f32_16x16x64_bf16 v[96:99],v[32:35],v[144:151],v1
v_smfmac_f32_16x16x64_bf16 v[100:103],v[32:35],v[152:159],v1
v_smfmac_f32_16x16x64_bf16 v[96:99],v[36:39],v[160:167],v1
v_smfmac_f32_16x16x64_bf16 v[100:103],v[36:39],v[168:175],v1
l2s_100483:
s_bitcmp1_b32 s55,6
s_cbranch_scc0 l2s_100484
s_waitcnt vmcnt(1)
v_max3_u32 v124,v40,v41,v42
v_max_u32 v124,v124,v43
v_cmp_eq_u32 vcc,-1,v124
s_cbranch_vccnz l2s_100484
s_andn2_b32 s55,s55,64
v_smfmac_f32_16x16x64_bf16 v[96:99],v[40:43],v[176:183],v1
v_smfmac_f32_16x16x64_bf16 v[100:103],v[40:43],v[184:191],v1
l2s_100484:
s_bitcmp1_b32 s55,7
s_cbranch_scc0 l2s_100485
s_waitcnt vmcnt(0)
v_max3_u32 v124,v44,v45,v46
v_max_u32 v124,v124,v47
v_cmp_eq_u32 vcc,-1,v124
s_cbranch_vccnz l2s_100485
s_andn2_b32 s55,s55,128
v_smfmac_f32_16x16x64_bf16 v[96:99],v[44:47],v[192:199],v1
v_smfmac_f32_16x16x64_bf16 v[100:103],v[44:47],v[200:207],v1
l2s_100485:
s_cmp_eq_u32 s55,0
s_cbranch_scc1 oback_100316
oslow_100315:
s_bitcmp1_b32 s55,0
s_cbranch_scc0 dsk_100486
buffer_load_dwordx4 v[16:19],v0,s[20:23],s96 offen offset:0 sc1
dsk_100486:
s_bitcmp1_b32 s55,1
s_cbranch_scc0 dsk_100487
buffer_load_dwordx4 v[20:23],v0,s[20:23],s96 offen offset:1024 sc1
dsk_100487:
s_bitcmp1_b32 s55,2
s_cbranch_scc0 dsk_100488
buffer_load_dwordx4 v[24:27],v0,s[20:23],s96 offen offset:2048 sc1
dsk_100488:
s_bitcmp1_b32 s55,3
s_cbranch_scc0 dsk_100489
buffer_load_dwordx4 v[28:31],v0,s[20:23],s96 offen offset:3072 sc1
dsk_100489:
s_bitcmp1_b32 s55,4
s_cbranch_scc0 dsk_100490
buffer_load_dwordx4 v[32:35],v0,s[20:23],s97 offen offset:0 sc1
dsk_100490:
s_bitcmp1_b32 s55,5
s_cbranch_scc0 dsk_100491
buffer_load_dwordx4 v[36:39],v0,s[20:23],s97 offen offset:1024 sc1
dsk_100491:
s_bitcmp1_b32 s55,6
s_cbranch_scc0 dsk_100492
buffer_load_dwordx4 v[40:43],v0,s[20:23],s97 offen offset:2048 sc1
dsk_100492:
s_bitcmp1_b32 s55,7
s_cbranch_scc0 dsk_100493
buffer_load_dwordx4 v[44:47],v0,s[20:23],s97 offen offset:3072 sc1
dsk_100493:
s_bitcmp1_b32 s55,0
s_cbranch_scc0 dsk_100494
s_waitcnt vmcnt(2)
v_max3_u32 v124,v16,v17,v18
v_max_u32 v124,v124,v19
v_cmp_eq_u32 vcc,-1,v124
s_cbranch_vccz dgo_100495
s_nop 15
buffer_load_dwordx4 v[116:119],v0,s[20:23],s96 offen offset:0 sc1
s_nop 15
buffer_load_dwordx4 v[120:123],v0,s[20:23],s96 offen offset:0 sc1
dlp_100496:
s_waitcnt vmcnt(2)
v_max3_u32 v124,v16,v17,v18
v_max_u32 v124,v124,v19
v_cmp_eq_u32 vcc,-1,v124
s_cbranch_vccz dgo_100495
buffer_load_dwordx4 v[16:19],v0,s[20:23],s96 offen offset:0 sc1
s_waitcnt vmcnt(2)
v_max3_u32 v124,v116,v117,v118
v_max_u32 v124,v124,v119
v_cmp_eq_u32 vcc,-1,v124
s_cbranch_vccz dcp_100498
buffer_load_dwordx4 v[116:119],v0,s[20:23],s96 offen offset:0 sc1
s_waitcnt vmcnt(2)
v_max3_u32 v124,v120,v121,v122
v_max_u32 v124,v124,v123
v_cmp_eq_u32 vcc,-1,v124
s_cbranch_vccz dcp_100499
buffer_load_dwordx4 v[120:123],v0,s[20:23],s96 offen offset:0 sc1
s_sub_u32 s90,s90,1
s_cmp_gt_i32 s90,0
s_cbranch_scc1 dlp_100496
s_branch dgo_100495
dcp_100498:
v_mov_b32 v16,v116
v_mov_b32 v17,v117
v_mov_b32 v18,v118
v_mov_b32 v19,v119
s_nop 1
s_branch dgo_100495
dcp_100499:
v_mov_b32 v16,v120
v_mov_b32 v17,v121
v_mov_b32 v18,v122
v_mov_b32 v19,v123
s_nop 1
dgo_100495:
v_smfmac_f32_16x16x64_bf16 v[96:99],v[16:19],v[48:55],v1
v_smfmac_f32_16x16x64_bf16 v[100:103],v[16:19],v[56:63],v1
dsk_100494:
s_bitcmp1_b32 s55,1
s_cbranch_scc0 dsk_100500
s_waitcnt vmcnt(2)
v_max3_u32 v124,v20,v21,v22
v_max_u32 v124,v124,v23
v_cmp_eq_u32 vcc,-1,v124
s_cbranch_vccz dgo_100501
s_nop 15
buffer_load_dwordx4 v[116:119],v0,s[20:23],s96 offen offset:1024 sc1
s_nop 15
buffer_load_dwordx4 v[120:123],v0,s[20:23],s96 offen offset:1024 sc1
dlp_100502:
s_waitcnt vmcnt(2)
v_max3_u32 v124,v20,v21,v22
v_max_u32 v124,v124,v23
v_cmp_eq_u32 vcc,-1,v124
s_cbranch_vccz dgo_100501
buffer_load_dwordx4 v[20:23],v0,s[20:23],s96 offen offset:1024 sc1
s_waitcnt vmcnt(2)
v_max3_u32 v124,v116,v117,v118
v_max_u32 v124,v124,v119
v_cmp_eq_u32 vcc,-1,v124
s_cbranch_vccz dcp_100504
buffer_load_dwordx4 v[116:119],v0,s[20:23],s96 offen offset:1024 sc1
s_waitcnt vmcnt(2)
v_max3_u32 v124,v120,v121,v122
v_max_u32 v124,v124,v123
v_cmp_eq_u32 vcc,-1,v124
s_cbranch_vccz dcp_100505
buffer_load_dwordx4 v[120:123],v0,s[20:23],s96 offen offset:1024 sc1
s_sub_u32 s90,s90,1
s_cmp_gt_i32 s90,0
s_cbranch_scc1 dlp_100502
s_branch dgo_100501
dcp_100504:
v_mov_b32 v20,v116
v_mov_b32 v21,v117
v_mov_b32 v22,v118
v_mov_b32 v23,v119
s_nop 1
s_branch dgo_100501
dcp_100505:
v_mov_b32 v20,v120
v_mov_b32 v21,v121
v_mov_b32 v22,v122
v_mov_b32 v23,v123
s_nop 1
dgo_100501:
v_smfmac_f32_16x16x64_bf16 v[96:99],v[20:23],v[64:71],v1
v_smfmac_f32_16x16x64_bf16 v[100:103],v[20:23],v[72:79],v1
dsk_100500:
s_bitcmp1_b32 s55,2
s_cbranch_scc0 dsk_100506
s_waitcnt vmcnt(2)
v_max3_u32 v124,v24,v25,v26
v_max_u32 v124,v124,v27
v_cmp_eq_u32 vcc,-1,v124
s_cbranch_vccz dgo_100507
s_nop 15
buffer_load_dwordx4 v[116:119],v0,s[20:23],s96 offen offset:2048 sc1
s_nop 15
buffer_load_dwordx4 v[120:123],v0,s[20:23],s96 offen offset:2048 sc1
dlp_100508:
s_waitcnt vmcnt(2)
v_max3_u32 v124,v24,v25,v26
v_max_u32 v124,v124,v27
v_cmp_eq_u32 vcc,-1,v124
s_cbranch_vccz dgo_100507
buffer_load_dwordx4 v[24:27],v0,s[20:23],s96 offen offset:2048 sc1
s_waitcnt vmcnt(2)
v_max3_u32 v124,v116,v117,v118
v_max_u32 v124,v124,v119
v_cmp_eq_u32 vcc,-1,v124
s_cbranch_vccz dcp_100510
buffer_load_dwordx4 v[116:119],v0,s[20:23],s96 offen offset:2048 sc1
s_waitcnt vmcnt(2)
v_max3_u32 v124,v120,v121,v122
v_max_u32 v124,v124,v123
v_cmp_eq_u32 vcc,-1,v124
s_cbranch_vccz dcp_100511
buffer_load_dwordx4 v[120:123],v0,s[20:23],s96 offen offset:2048 sc1
s_sub_u32 s90,s90,1
s_cmp_gt_i32 s90,0
s_cbranch_scc1 dlp_100508
s_branch dgo_100507
dcp_100510:
v_mov_b32 v24,v116
v_mov_b32 v25,v117
v_mov_b32 v26,v118
v_mov_b32 v27,v119
s_nop 1
s_branch dgo_100507
dcp_100511:
v_mov_b32 v24,v120
v_mov_b32 v25,v121
v_mov_b32 v26,v122
v_mov_b32 v27,v123
s_nop 1
dgo_100507:
v_smfmac_f32_16x16x64_bf16 v[96:99],v[24:27],v[80:87],v1
v_smfmac_f32_16x16x64_bf16 v[100:103],v[24:27],v[88:95],v1
dsk_100506:
s_bitcmp1_b32 s55,3
s_cbranch_scc0 dsk_100512
s_waitcnt vmcnt(2)
v_max3_u32 v124,v28,v29,v30
v_max_u32 v124,v124,v31
v_cmp_eq_u32 vcc,-1,v124
s_cbranch_vccz dgo_100513
s_nop 15
buffer_load_dwordx4 v[116:119],v0,s[20:23],s96 offen offset:3072 sc1
s_nop 15
buffer_load_dwordx4 v[120:123],v0,s[20:23],s96 offen offset:3072 sc1
dlp_100514:
s_waitcnt vmcnt(2)
v_max3_u32 v124,v28,v29,v30
v_max_u32 v124,v124,v31
v_cmp_eq_u32 vcc,-1,v124
s_cbranch_vccz dgo_100513
buffer_load_dwordx4 v[28:31],v0,s[20:23],s96 offen offset:3072 sc1
s_waitcnt vmcnt(2)
v_max3_u32 v124,v116,v117,v118
v_max_u32 v124,v124,v119
v_cmp_eq_u32 vcc,-1,v124
s_cbranch_vccz dcp_100516
buffer_load_dwordx4 v[116:119],v0,s[20:23],s96 offen offset:3072 sc1
s_waitcnt vmcnt(2)
v_max3_u32 v124,v120,v121,v122
v_max_u32 v124,v124,v123
v_cmp_eq_u32 vcc,-1,v124
s_cbranch_vccz dcp_100517
buffer_load_dwordx4 v[120:123],v0,s[20:23],s96 offen offset:3072 sc1
s_sub_u32 s90,s90,1
s_cmp_gt_i32 s90,0
s_cbranch_scc1 dlp_100514
s_branch dgo_100513
dcp_100516:
v_mov_b32 v28,v116
v_mov_b32 v29,v117
v_mov_b32 v30,v118
v_mov_b32 v31,v119
s_nop 1
s_branch dgo_100513
dcp_100517:
v_mov_b32 v28,v120
v_mov_b32 v29,v121
v_mov_b32 v30,v122
v_mov_b32 v31,v123
s_nop 1
dgo_100513:
v_smfmac_f32_16x16x64_bf16 v[96:99],v[28:31],v[128:135],v1
v_smfmac_f32_16x16x64_bf16 v[100:103],v[28:31],v[136:143],v1
dsk_100512:
s_bitcmp1_b32 s55,4
s_cbranch_scc0 dsk_100518
s_waitcnt vmcnt(2)
v_max3_u32 v124,v32,v33,v34
v_max_u32 v124,v124,v35
v_cmp_eq_u32 vcc,-1,v124
s_cbranch_vccz dgo_100519
s_nop 15
buffer_load_dwordx4 v[116:119],v0,s[20:23],s97 offen offset:0 sc1
s_nop 15
buffer_load_dwordx4 v[120:123],v0,s[20:23],s97 offen offset:0 sc1
dlp_100520:
s_waitcnt vmcnt(2)
v_max3_u32 v124,v32,v33,v34
v_max_u32 v124,v124,v35
v_cmp_eq_u32 vcc,-1,v124
s_cbranch_vccz dgo_100519
buffer_load_dwordx4 v[32:35],v0,s[20:23],s97 offen offset:0 sc1
s_waitcnt vmcnt(2)
v_max3_u32 v124,v116,v117,v118
v_max_u32 v124,v124,v119
v_cmp_eq_u32 vcc,-1,v124
s_cbranch_vccz dcp_100522
buffer_load_dwordx4 v[116:119],v0,s[20:23],s97 offen offset:0 sc1
s_waitcnt vmcnt(2)
v_max3_u32 v124,v120,v121,v122
v_max_u32 v124,v124,v123
v_cmp_eq_u32 vcc,-1,v124
s_cbranch_vccz dcp_100523
buffer_load_dwordx4 v[120:123],v0,s[20:23],s97 offen offset:0 sc1
s_sub_u32 s90,s90,1
s_cmp_gt_i32 s90,0
s_cbranch_scc1 dlp_100520
s_branch dgo_100519
dcp_100522:
v_mov_b32 v32,v116
v_mov_b32 v33,v117
v_mov_b32 v34,v118
v_mov_b32 v35,v119
s_nop 1
s_branch dgo_100519
dcp_100523:
v_mov_b32 v32,v120
v_mov_b32 v33,v121
v_mov_b32 v34,v122
v_mov_b32 v35,v123
s_nop 1
dgo_100519:
v_smfmac_f32_16x16x64_bf16 v[96:99],v[32:35],v[144:151],v1
v_smfmac_f32_16x16x64_bf16 v[100:103],v[32:35],v[152:159],v1
dsk_100518:
s_bitcmp1_b32 s55,5
s_cbranch_scc0 dsk_100524
s_waitcnt vmcnt(2)
v_max3_u32 v124,v36,v37,v38
v_max_u32 v124,v124,v39
v_cmp_eq_u32 vcc,-1,v124
s_cbranch_vccz dgo_100525
s_nop 15
buffer_load_dwordx4 v[116:119],v0,s[20:23],s97 offen offset:1024 sc1
s_nop 15
buffer_load_dwordx4 v[120:123],v0,s[20:23],s97 offen offset:1024 sc1
dlp_100526:
s_waitcnt vmcnt(2)
v_max3_u32 v124,v36,v37,v38
v_max_u32 v124,v124,v39
v_cmp_eq_u32 vcc,-1,v124
s_cbranch_vccz dgo_100525
buffer_load_dwordx4 v[36:39],v0,s[20:23],s97 offen offset:1024 sc1
s_waitcnt vmcnt(2)
v_max3_u32 v124,v116,v117,v118
v_max_u32 v124,v124,v119
v_cmp_eq_u32 vcc,-1,v124
s_cbranch_vccz dcp_100528
buffer_load_dwordx4 v[116:119],v0,s[20:23],s97 offen offset:1024 sc1
s_waitcnt vmcnt(2)
v_max3_u32 v124,v120,v121,v122
v_max_u32 v124,v124,v123
v_cmp_eq_u32 vcc,-1,v124
s_cbranch_vccz dcp_100529
buffer_load_dwordx4 v[120:123],v0,s[20:23],s97 offen offset:1024 sc1
s_sub_u32 s90,s90,1
s_cmp_gt_i32 s90,0
s_cbranch_scc1 dlp_100526
s_branch dgo_100525
dcp_100528:
v_mov_b32 v36,v116
v_mov_b32 v37,v117
v_mov_b32 v38,v118
v_mov_b32 v39,v119
s_nop 1
s_branch dgo_100525
dcp_100529:
v_mov_b32 v36,v120
v_mov_b32 v37,v121
v_mov_b32 v38,v122
v_mov_b32 v39,v123
s_nop 1
dgo_100525:
v_smfmac_f32_16x16x64_bf16 v[96:99],v[36:39],v[160:167],v1
v_smfmac_f32_16x16x64_bf16 v[100:103],v[36:39],v[168:175],v1
dsk_100524:
s_bitcmp1_b32 s55,6
s_cbranch_scc0 dsk_100530
s_waitcnt vmcnt(2)
v_max3_u32 v124,v40,v41,v42
v_max_u32 v124,v124,v43
v_cmp_eq_u32 vcc,-1,v124
s_cbranch_vccz dgo_100531
s_nop 15
buffer_load_dwordx4 v[116:119],v0,s[20:23],s97 offen offset:2048 sc1
s_nop 15
buffer_load_dwordx4 v[120:123],v0,s[20:23],s97 offen offset:2048 sc1
dlp_100532:
s_waitcnt vmcnt(2)
v_max3_u32 v124,v40,v41,v42
v_max_u32 v124,v124,v43
v_cmp_eq_u32 vcc,-1,v124
s_cbranch_vccz dgo_100531
buffer_load_dwordx4 v[40:43],v0,s[20:23],s97 offen offset:2048 sc1
s_waitcnt vmcnt(2)
v_max3_u32 v124,v116,v117,v118
v_max_u32 v124,v124,v119
v_cmp_eq_u32 vcc,-1,v124
s_cbranch_vccz dcp_100534
buffer_load_dwordx4 v[116:119],v0,s[20:23],s97 offen offset:2048 sc1
s_waitcnt vmcnt(2)
v_max3_u32 v124,v120,v121,v122
v_max_u32 v124,v124,v123
v_cmp_eq_u32 vcc,-1,v124
s_cbranch_vccz dcp_100535
buffer_load_dwordx4 v[120:123],v0,s[20:23],s97 offen offset:2048 sc1
s_sub_u32 s90,s90,1
s_cmp_gt_i32 s90,0
s_cbranch_scc1 dlp_100532
s_branch dgo_100531
dcp_100534:
v_mov_b32 v40,v116
v_mov_b32 v41,v117
v_mov_b32 v42,v118
v_mov_b32 v43,v119
s_nop 1
s_branch dgo_100531
dcp_100535:
v_mov_b32 v40,v120
v_mov_b32 v41,v121
v_mov_b32 v42,v122
v_mov_b32 v43,v123
s_nop 1
dgo_100531:
v_smfmac_f32_16x16x64_bf16 v[96:99],v[40:43],v[176:183],v1
v_smfmac_f32_16x16x64_bf16 v[100:103],v[40:43],v[184:191],v1
dsk_100530:
s_bitcmp1_b32 s55,7
s_cbranch_scc0 dsk_100536
s_waitcnt vmcnt(2)
v_max3_u32 v124,v44,v45,v46
v_max_u32 v124,v124,v47
v_cmp_eq_u32 vcc,-1,v124
s_cbranch_vccz dgo_100537
s_nop 15
buffer_load_dwordx4 v[116:119],v0,s[20:23],s97 offen offset:3072 sc1
s_nop 15
buffer_load_dwordx4 v[120:123],v0,s[20:23],s97 offen offset:3072 sc1
dlp_100538:
s_waitcnt vmcnt(2)
v_max3_u32 v124,v44,v45,v46
v_max_u32 v124,v124,v47
v_cmp_eq_u32 vcc,-1,v124
s_cbranch_vccz dgo_100537
buffer_load_dwordx4 v[44:47],v0,s[20:23],s97 offen offset:3072 sc1
s_waitcnt vmcnt(2)
v_max3_u32 v124,v116,v117,v118
v_max_u32 v124,v124,v119
v_cmp_eq_u32 vcc,-1,v124
s_cbranch_vccz dcp_100540
buffer_load_dwordx4 v[116:119],v0,s[20:23],s97 offen offset:3072 sc1
s_waitcnt vmcnt(2)
v_max3_u32 v124,v120,v121,v122
v_max_u32 v124,v124,v123
v_cmp_eq_u32 vcc,-1,v124
s_cbranch_vccz dcp_100541
buffer_load_dwordx4 v[120:123],v0,s[20:23],s97 offen offset:3072 sc1
s_sub_u32 s90,s90,1
s_cmp_gt_i32 s90,0
s_cbranch_scc1 dlp_100538
s_branch dgo_100537
dcp_100540:
v_mov_b32 v44,v116
v_mov_b32 v45,v117
v_mov_b32 v46,v118
v_mov_b32 v47,v119
s_nop 1
s_branch dgo_100537
dcp_100541:
v_mov_b32 v44,v120
v_mov_b32 v45,v121
v_mov_b32 v46,v122
v_mov_b32 v47,v123
s_nop 1
dgo_100537:
v_smfmac_f32_16x16x64_bf16 v[96:99],v[44:47],v[192:199],v1
v_smfmac_f32_16x16x64_bf16 v[100:103],v[44:47],v[200:207],v1
dsk_100536:
s_mov_b32 s55,0
s_branch oback_100316
fl_100333:
flb_100341:
buffer_load_dwordx4 v[16:19],v0,s[20:23],s92 offen offset:0 sc1
s_mov_b32 s55,1
buffer_load_dwordx4 v[32:35],v0,s[20:23],s93 offen offset:0 sc1
s_waitcnt vmcnt(4)
v_max3_u32 v124,v20,v21,v22
v_max_u32 v124,v124,v23
v_cmp_eq_u32 vcc,-1,v124
s_cbranch_vccnz dfl_100542
v_smfmac_f32_16x16x64_bf16 v[64:67],v[20:23],a[96:103],v1
buffer_load_dword v125,off,s[20:23],s92 sc1
buffer_load_dwordx4 v[36:39],v0,s[20:23],s93 offen offset:1024 sc1
s_waitcnt vmcnt(5)
v_max3_u32 v124,v24,v25,v26
v_smfmac_f32_16x16x64_bf16 v[68:71],v[20:23],a[104:111],v1
v_max_u32 v124,v124,v27
v_cmp_eq_u32 vcc,-1,v124
v_smfmac_f32_16x16x64_bf16 v[72:75],v[20:23],a[112:119],v1
v_smfmac_f32_16x16x64_bf16 v[76:79],v[20:23],a[120:127],v1
s_cbranch_vccnz dfl_100543
v_smfmac_f32_16x16x64_bf16 v[64:67],v[24:27],a[160:167],v1
buffer_load_dword v125,off,s[20:23],s92 sc1
buffer_load_dwordx4 v[40:43],v0,s[20:23],s93 offen offset:2048 sc1
buffer_load_dwordx4 v[44:47],v0,s[20:23],s93 offen offset:3072 sc1
s_waitcnt vmcnt(7)
v_max3_u32 v124,v28,v29,v30
v_smfmac_f32_16x16x64_bf16 v[68:71],v[24:27],a[168:175],v1
v_max_u32 v124,v124,v31
v_cmp_eq_u32 vcc,-1,v124
v_smfmac_f32_16x16x64_bf16 v[72:75],v[24:27],a[176:183],v1
v_smfmac_f32_16x16x64_bf16 v[76:79],v[24:27],a[184:191],v1
s_cbranch_vccnz dfl_100544
v_smfmac_f32_16x16x64_bf16 v[64:67],v[28:31],a[224:231],v1
buffer_load_dword v125,off,s[20:23],s92 sc1
s_waitcnt vmcnt(7)
v_max3_u32 v124,v16,v17,v18
v_smfmac_f32_16x16x64_bf16 v[68:71],v[28:31],a[232:239],v1
v_max_u32 v124,v124,v19
v_cmp_eq_u32 vcc,-1,v124
v_smfmac_f32_16x16x64_bf16 v[72:75],v[28:31],a[240:247],v1
v_smfmac_f32_16x16x64_bf16 v[76:79],v[28:31],a[248:255],v1
s_cbranch_vccnz lfb_100549
s_mov_b32 s55,0
v_smfmac_f32_16x16x64_bf16 v[64:67],v[16:19],a[32:39],v1
s_waitcnt vmcnt(6)
v_max3_u32 v124,v32,v33,v34
v_max_u32 v124,v124,v35
v_cmp_eq_u32 vcc,-1,v124
v_smfmac_f32_16x16x64_bf16 v[68:71],v[16:19],a[40:47],v1
v_smfmac_f32_16x16x64_bf16 v[72:75],v[16:19],a[48:55],v1
v_smfmac_f32_16x16x64_bf16 v[76:79],v[16:19],a[56:63],v1
s_cbranch_vccnz flb_100345
s_branch segb_100329
fl_100334:
flb_100342:
buffer_load_dwordx4 v[20:23],v0,s[20:23],s92 offen offset:1024 sc1
s_mov_b32 s55,2
buffer_load_dwordx4 v[36:39],v0,s[20:23],s93 offen offset:1024 sc1
s_waitcnt vmcnt(5)
v_max3_u32 v124,v24,v25,v26
v_max_u32 v124,v124,v27
v_cmp_eq_u32 vcc,-1,v124
s_cbranch_vccnz dfl_100543
v_smfmac_f32_16x16x64_bf16 v[64:67],v[24:27],a[160:167],v1
buffer_load_dword v125,off,s[20:23],s92 sc1
buffer_load_dwordx4 v[40:43],v0,s[20:23],s93 offen offset:2048 sc1
buffer_load_dwordx4 v[44:47],v0,s[20:23],s93 offen offset:3072 sc1
s_waitcnt vmcnt(7)
v_max3_u32 v124,v28,v29,v30
v_smfmac_f32_16x16x64_bf16 v[68:71],v[24:27],a[168:175],v1
v_max_u32 v124,v124,v31
v_cmp_eq_u32 vcc,-1,v124
v_smfmac_f32_16x16x64_bf16 v[72:75],v[24:27],a[176:183],v1
v_smfmac_f32_16x16x64_bf16 v[76:79],v[24:27],a[184:191],v1
s_cbranch_vccnz dfl_100544
v_smfmac_f32_16x16x64_bf16 v[64:67],v[28:31],a[224:231],v1
buffer_load_dword v125,off,s[20:23],s92 sc1
s_waitcnt vmcnt(5)
v_max3_u32 v124,v20,v21,v22
v_smfmac_f32_16x16x64_bf16 v[68:71],v[28:31],a[232:239],v1
v_max_u32 v124,v124,v23
v_cmp_eq_u32 vcc,-1,v124
v_smfmac_f32_16x16x64_bf16 v[72:75],v[28:31],a[240:247],v1
v_smfmac_f32_16x16x64_bf16 v[76:79],v[28:31],a[248:255],v1
s_cbranch_vccnz lfb_100549
s_mov_b32 s55,0
v_smfmac_f32_16x16x64_bf16 v[64:67],v[20:23],a[96:103],v1
s_waitcnt vmcnt(6)
v_max3_u32 v124,v32,v33,v34
v_max_u32 v124,v124,v35
v_cmp_eq_u32 vcc,-1,v124
v_smfmac_f32_16x16x64_bf16 v[68:71],v[20:23],a[104:111],v1
v_smfmac_f32_16x16x64_bf16 v[72:75],v[20:23],a[112:119],v1
v_smfmac_f32_16x16x64_bf16 v[76:79],v[20:23],a[120:127],v1
s_cbranch_vccnz flb_100345
s_branch segb_100329
fl_100335:
flb_100343:
buffer_load_dwordx4 v[24:27],v0,s[20:23],s92 offen offset:2048 sc1
s_mov_b32 s55,4
buffer_load_dwordx4 v[40:43],v0,s[20:23],s93 offen offset:2048 sc1
buffer_load_dwordx4 v[44:47],v0,s[20:23],s93 offen offset:3072 sc1
s_waitcnt vmcnt(7)
v_max3_u32 v124,v28,v29,v30
v_max_u32 v124,v124,v31
v_cmp_eq_u32 vcc,-1,v124
s_cbranch_vccnz dfl_100544
v_smfmac_f32_16x16x64_bf16 v[64:67],v[28:31],a[224:231],v1
buffer_load_dword v125,off,s[20:23],s92 sc1
s_waitcnt vmcnt(3)
v_max3_u32 v124,v24,v25,v26
v_smfmac_f32_16x16x64_bf16 v[68:71],v[28:31],a[232:239],v1
v_max_u32 v124,v124,v27
v_cmp_eq_u32 vcc,-1,v124
v_smfmac_f32_16x16x64_bf16 v[72:75],v[28:31],a[240:247],v1
v_smfmac_f32_16x16x64_bf16 v[76:79],v[28:31],a[248:255],v1
s_cbranch_vccnz lfb_100549
s_mov_b32 s55,0
v_smfmac_f32_16x16x64_bf16 v[64:67],v[24:27],a[160:167],v1
s_waitcnt vmcnt(6)
v_max3_u32 v124,v32,v33,v34
v_max_u32 v124,v124,v35
v_cmp_eq_u32 vcc,-1,v124
v_smfmac_f32_16x16x64_bf16 v[68:71],v[24:27],a[168:175],v1
v_smfmac_f32_16x16x64_bf16 v[72:75],v[24:27],a[176:183],v1
v_smfmac_f32_16x16x64_bf16 v[76:79],v[24:27],a[184:191],v1
s_cbranch_vccnz flb_100345
s_branch segb_100329
fl_100336:
flb_100344:
buffer_load_dwordx4 v[28:31],v0,s[20:23],s92 offen offset:3072 sc1
s_mov_b32 s55,8
s_waitcnt vmcnt(0)
v_max3_u32 v124,v28,v29,v30
v_max_u32 v124,v124,v31
v_cmp_eq_u32 vcc,-1,v124
s_cbranch_vccnz lfb_100549
s_mov_b32 s55,0
v_smfmac_f32_16x16x64_bf16 v[64:67],v[28:31],a[224:231],v1
s_waitcnt vmcnt(6)
v_max3_u32 v124,v32,v33,v34
v_max_u32 v124,v124,v35
v_cmp_eq_u32 vcc,-1,v124
v_smfmac_f32_16x16x64_bf16 v[68:71],v[28:31],a[232:239],v1
v_smfmac_f32_16x16x64_bf16 v[72:75],v[28:31],a[240:247],v1
v_smfmac_f32_16x16x64_bf16 v[76:79],v[28:31],a[248:255],v1
s_cbranch_vccnz flb_100345
s_branch segb_100329
fl_100337:
flb_100345:
buffer_load_dwordx4 v[32:35],v0,s[20:23],s93 offen offset:0 sc1
s_mov_b32 s55,240
buffer_store_dwordx4 v[112:115],v120,s[20:23],s101 offen sc1
buffer_store_dword v126,v121,s[20:23],s69 offen sc1
s_bitcmp1_b32 s55,5
s_cbranch_scc0 rdn_100552
s_waitcnt vmcnt(7)
v_max3_u32 v124,v36,v37,v38
v_max_u32 v124,v124,v39
v_cmp_eq_u32 vcc,-1,v124
s_cbranch_vccnz rfa_100553
buffer_load_dword v125,off,s[20:23],s92 sc1
s_bitset0_b32 s55,5
v_smfmac_f32_16x16x64_bf16 v[64:67],v[36:39],a[96:103],v1
v_smfmac_f32_16x16x64_bf16 v[68:71],v[36:39],a[104:111],v1
v_smfmac_f32_16x16x64_bf16 v[72:75],v[36:39],a[112:119],v1
v_smfmac_f32_16x16x64_bf16 v[76:79],v[36:39],a[120:127],v1
s_cmp_eq_u32 s55,0
s_cbranch_scc1 segb_100331
s_branch rnx_100554
rdn_100552:
buffer_load_dword v125,off,s[20:23],s92 sc1
s_branch rnx_100554
rfa_100553:
buffer_load_dwordx4 v[36:39],v0,s[20:23],s93 offen offset:1024 sc1
rnx_100554:
s_bitcmp1_b32 s55,6
s_cbranch_scc0 rdn_100555
s_waitcnt vmcnt(6)
v_max3_u32 v124,v40,v41,v42
v_max_u32 v124,v124,v43
v_cmp_eq_u32 vcc,-1,v124
s_cbranch_vccnz rfa_100556
buffer_load_dword v125,off,s[20:23],s92 sc1
s_bitset0_b32 s55,6
s_cmp_eq_u32 s55,0
s_cbranch_scc1 segb_100331
s_branch rnx_100557
rdn_100555:
buffer_load_dword v125,off,s[20:23],s92 sc1
s_branch rnx_100557
rfa_100556:
buffer_load_dwordx4 v[40:43],v0,s[20:23],s93 offen offset:2048 sc1
rnx_100557:
s_bitcmp1_b32 s55,7
s_cbranch_scc0 rdn_100558
s_waitcnt vmcnt(6)
v_max3_u32 v124,v44,v45,v46
v_max_u32 v124,v124,v47
v_cmp_eq_u32 vcc,-1,v124
s_cbranch_vccnz rfa_100559
buffer_load_dword v125,off,s[20:23],s92 sc1
s_bitset0_b32 s55,7
s_cmp_eq_u32 s55,0
s_cbranch_scc1 segb_100331
s_branch rnx_100560
rdn_100558:
buffer_load_dword v125,off,s[20:23],s92 sc1
s_branch rnx_100560
rfa_100559:
buffer_load_dwordx4 v[44:47],v0,s[20:23],s93 offen offset:3072 sc1
rnx_100560:
rot_100551:
s_bitcmp1_b32 s55,4
s_cbranch_scc0 rdn_100561
s_waitcnt vmcnt(3)
v_max3_u32 v124,v32,v33,v34
v_max_u32 v124,v124,v35
v_cmp_eq_u32 vcc,-1,v124
s_cbranch_vccnz rfa_100562
buffer_load_dword v125,off,s[20:23],s92 sc1
s_bitset0_b32 s55,4
v_smfmac_f32_16x16x64_bf16 v[64:67],v[32:35],a[32:39],v1
v_smfmac_f32_16x16x64_bf16 v[68:71],v[32:35],a[40:47],v1
v_smfmac_f32_16x16x64_bf16 v[72:75],v[32:35],a[48:55],v1
v_smfmac_f32_16x16x64_bf16 v[76:79],v[32:35],a[56:63],v1
s_cmp_eq_u32 s55,0
s_cbranch_scc1 segb_100331
s_branch rnx_100563
rdn_100561:
buffer_load_dword v125,off,s[20:23],s92 sc1
s_branch rnx_100563
rfa_100562:
buffer_load_dwordx4 v[32:35],v0,s[20:23],s93 offen offset:0 sc1
rnx_100563:
s_bitcmp1_b32 s55,5
s_cbranch_scc0 rdn_100564
s_waitcnt vmcnt(3)
v_max3_u32 v124,v36,v37,v38
v_max_u32 v124,v124,v39
v_cmp_eq_u32 vcc,-1,v124
s_cbranch_vccnz rfa_100565
buffer_load_dword v125,off,s[20:23],s92 sc1
s_bitset0_b32 s55,5
v_smfmac_f32_16x16x64_bf16 v[64:67],v[36:39],a[96:103],v1
v_smfmac_f32_16x16x64_bf16 v[68:71],v[36:39],a[104:111],v1
v_smfmac_f32_16x16x64_bf16 v[72:75],v[36:39],a[112:119],v1
v_smfmac_f32_16x16x64_bf16 v[76:79],v[36:39],a[120:127],v1
s_cmp_eq_u32 s55,0
s_cbranch_scc1 segb_100331
s_branch rnx_100566
rdn_100564:
buffer_load_dword v125,off,s[20:23],s92 sc1
s_branch rnx_100566
rfa_100565:
buffer_load_dwordx4 v[36:39],v0,s[20:23],s93 offen offset:1024 sc1
rnx_100566:
s_bitcmp1_b32 s55,6
s_cbranch_scc0 rdn_100567
s_waitcnt vmcnt(3)
v_max3_u32 v124,v40,v41,v42
v_max_u32 v124,v124,v43
v_cmp_eq_u32 vcc,-1,v124
s_cbranch_vccnz rfa_100568
buffer_load_dword v125,off,s[20:23],s92 sc1
s_bitset0_b32 s55,6
s_cmp_eq_u32 s55,0
s_cbranch_scc1 segb_100331
s_branch rnx_100569
rdn_100567:
buffer_load_dword v125,off,s[20:23],s92 sc1
s_branch rnx_100569
rfa_100568:
buffer_load_dwordx4 v[40:43],v0,s[20:23],s93 offen offset:2048 sc1
rnx_100569:
s_bitcmp1_b32 s55,7
s_cbranch_scc0 rdn_100570
s_waitcnt vmcnt(3)
v_max3_u32 v124,v44,v45,v46
v_max_u32 v124,v124,v47
v_cmp_eq_u32 vcc,-1,v124
s_cbranch_vccnz rfa_100571
buffer_load_dword v125,off,s[20:23],s92 sc1
s_bitset0_b32 s55,7
s_cmp_eq_u32 s55,0
s_cbranch_scc1 segb_100331
s_branch rnx_100572
rdn_100570:
buffer_load_dword v125,off,s[20:23],s92 sc1
s_branch rnx_100572
rfa_100571:
buffer_load_dwordx4 v[44:47],v0,s[20:23],s93 offen offset:3072 sc1
rnx_100572:
s_sub_u32 s90,s90,1
s_cmp_gt_i32 s90,0
s_cbranch_scc1 rot_100551
s_mov_b32 s55,0
s_branch segb_100331
fl_100338:
flb_100346:
buffer_load_dwordx4 v[36:39],v0,s[20:23],s93 offen offset:1024 sc1
s_mov_b32 s55,224
s_bitcmp1_b32 s55,6
s_cbranch_scc0 rdn_100574
s_waitcnt vmcnt(6)
v_max3_u32 v124,v40,v41,v42
v_max_u32 v124,v124,v43
v_cmp_eq_u32 vcc,-1,v124
s_cbranch_vccnz rfa_100575
buffer_load_dword v125,off,s[20:23],s92 sc1
s_bitset0_b32 s55,6
s_cmp_eq_u32 s55,0
s_cbranch_scc1 segb_100331
s_branch rnx_100576
rdn_100574:
buffer_load_dword v125,off,s[20:23],s92 sc1
s_branch rnx_100576
rfa_100575:
buffer_load_dwordx4 v[40:43],v0,s[20:23],s93 offen offset:2048 sc1
rnx_100576:
s_bitcmp1_b32 s55,7
s_cbranch_scc0 rdn_100577
s_waitcnt vmcnt(6)
v_max3_u32 v124,v44,v45,v46
v_max_u32 v124,v124,v47
v_cmp_eq_u32 vcc,-1,v124
s_cbranch_vccnz rfa_100578
buffer_load_dword v125,off,s[20:23],s92 sc1
s_bitset0_b32 s55,7
s_cmp_eq_u32 s55,0
s_cbranch_scc1 segb_100331
s_branch rnx_100579
rdn_100577:
buffer_load_dword v125,off,s[20:23],s92 sc1
s_branch rnx_100579
rfa_100578:
buffer_load_dwordx4 v[44:47],v0,s[20:23],s93 offen offset:3072 sc1
rnx_100579:
rot_100573:
s_bitcmp1_b32 s55,5
s_cbranch_scc0 rdn_100580
s_waitcnt vmcnt(2)
v_max3_u32 v124,v36,v37,v38
v_max_u32 v124,v124,v39
v_cmp_eq_u32 vcc,-1,v124
s_cbranch_vccnz rfa_100581
buffer_load_dword v125,off,s[20:23],s92 sc1
s_bitset0_b32 s55,5
v_smfmac_f32_16x16x64_bf16 v[64:67],v[36:39],a[96:103],v1
v_smfmac_f32_16x16x64_bf16 v[68:71],v[36:39],a[104:111],v1
v_smfmac_f32_16x16x64_bf16 v[72:75],v[36:39],a[112:119],v1
v_smfmac_f32_16x16x64_bf16 v[76:79],v[36:39],a[120:127],v1
s_cmp_eq_u32 s55,0
s_cbranch_scc1 segb_100331
s_branch rnx_100582
rdn_100580:
buffer_load_dword v125,off,s[20:23],s92 sc1
s_branch rnx_100582
rfa_100581:
buffer_load_dwordx4 v[36:39],v0,s[20:23],s93 offen offset:1024 sc1
rnx_100582:
s_bitcmp1_b32 s55,6
s_cbranch_scc0 rdn_100583
s_waitcnt vmcnt(2)
v_max3_u32 v124,v40,v41,v42
v_max_u32 v124,v124,v43
v_cmp_eq_u32 vcc,-1,v124
s_cbranch_vccnz rfa_100584
buffer_load_dword v125,off,s[20:23],s92 sc1
s_bitset0_b32 s55,6
s_cmp_eq_u32 s55,0
s_cbranch_scc1 segb_100331
s_branch rnx_100585
rdn_100583:
buffer_load_dword v125,off,s[20:23],s92 sc1
s_branch rnx_100585
rfa_100584:
buffer_load_dwordx4 v[40:43],v0,s[20:23],s93 offen offset:2048 sc1
rnx_100585:
s_bitcmp1_b32 s55,7
s_cbranch_scc0 rdn_100586
s_waitcnt vmcnt(2)
v_max3_u32 v124,v44,v45,v46
v_max_u32 v124,v124,v47
v_cmp_eq_u32 vcc,-1,v124
s_cbranch_vccnz rfa_100587
buffer_load_dword v125,off,s[20:23],s92 sc1
s_bitset0_b32 s55,7
s_cmp_eq_u32 s55,0
s_cbranch_scc1 segb_100331
s_branch rnx_100588
rdn_100586:
buffer_load_dword v125,off,s[20:23],s92 sc1
s_branch rnx_100588
rfa_100587:
buffer_load_dwordx4 v[44:47],v0,s[20:23],s93 offen offset:3072 sc1
rnx_100588:
s_sub_u32 s90,s90,1
s_cmp_gt_i32 s90,0
s_cbranch_scc1 rot_100573
s_mov_b32 s55,0
s_branch segb_100331
fl_100339:
flb_100347:
s_mov_b32 s55,192
s_bitcmp1_b32 s55,6
s_cbranch_scc0 rdn_100590
s_waitcnt vmcnt(6)
v_max3_u32 v124,v40,v41,v42
v_max_u32 v124,v124,v43
v_cmp_eq_u32 vcc,-1,v124
s_cbranch_vccnz rfa_100591
buffer_load_dword v125,off,s[20:23],s92 sc1
s_bitset0_b32 s55,6
s_cmp_eq_u32 s55,0
s_cbranch_scc1 segb_100331
s_branch rnx_100592
rdn_100590:
buffer_load_dword v125,off,s[20:23],s92 sc1
s_branch rnx_100592
rfa_100591:
buffer_load_dwordx4 v[40:43],v0,s[20:23],s93 offen offset:2048 sc1
rnx_100592:
s_bitcmp1_b32 s55,7
s_cbranch_scc0 rdn_100593
s_waitcnt vmcnt(6)
v_max3_u32 v124,v44,v45,v46
v_max_u32 v124,v124,v47
v_cmp_eq_u32 vcc,-1,v124
s_cbranch_vccnz rfa_100594
buffer_load_dword v125,off,s[20:23],s92 sc1
s_bitset0_b32 s55,7
s_cmp_eq_u32 s55,0
s_cbranch_scc1 segb_100331
s_branch rnx_100595
rdn_100593:
buffer_load_dword v125,off,s[20:23],s92 sc1
s_branch rnx_100595
rfa_100594:
buffer_load_dwordx4 v[44:47],v0,s[20:23],s93 offen offset:3072 sc1
rnx_100595:
rot_100589:
s_bitcmp1_b32 s55,6
s_cbranch_scc0 rdn_100596
s_waitcnt vmcnt(1)
v_max3_u32 v124,v40,v41,v42
v_max_u32 v124,v124,v43
v_cmp_eq_u32 vcc,-1,v124
s_cbranch_vccnz rfa_100597
buffer_load_dword v125,off,s[20:23],s92 sc1
s_bitset0_b32 s55,6
s_cmp_eq_u32 s55,0
s_cbranch_scc1 segb_100331
s_branch rnx_100598
rdn_100596:
buffer_load_dword v125,off,s[20:23],s92 sc1
s_branch rnx_100598
rfa_100597:
buffer_load_dwordx4 v[40:43],v0,s[20:23],s93 offen offset:2048 sc1
rnx_100598:
s_bitcmp1_b32 s55,7
s_cbranch_scc0 rdn_100599
s_waitcnt vmcnt(1)
v_max3_u32 v124,v44,v45,v46
v_max_u32 v124,v124,v47
v_cmp_eq_u32 vcc,-1,v124
s_cbranch_vccnz rfa_100600
buffer_load_dword v125,off,s[20:23],s92 sc1
s_bitset0_b32 s55,7
s_cmp_eq_u32 s55,0
s_cbranch_scc1 segb_100331
s_branch rnx_100601
rdn_100599:
buffer_load_dword v125,off,s[20:23],s92 sc1
s_branch rnx_100601
rfa_100600:
buffer_load_dwordx4 v[44:47],v0,s[20:23],s93 offen offset:3072 sc1
rnx_100601:
s_sub_u32 s90,s90,1
s_cmp_gt_i32 s90,0
s_cbranch_scc1 rot_100589
s_mov_b32 s55,0
s_branch segb_100331
dfl_100542:
buffer_load_dwordx4 v[20:23],v0,s[20:23],s92 offen offset:1024 sc1
s_bitset1_b32 s55,1
buffer_load_dwordx4 v[36:39],v0,s[20:23],s93 offen offset:1024 sc1
s_waitcnt vmcnt(5)
v_max3_u32 v124,v24,v25,v26
v_max_u32 v124,v124,v27
v_cmp_eq_u32 vcc,-1,v124
s_cbranch_vccnz dfl_100543
s_branch dseg_100546
dfl_100543:
buffer_load_dwordx4 v[24:27],v0,s[20:23],s92 offen offset:2048 sc1
s_bitset1_b32 s55,2
buffer_load_dwordx4 v[40:43],v0,s[20:23],s93 offen offset:2048 sc1
buffer_load_dwordx4 v[44:47],v0,s[20:23],s93 offen offset:3072 sc1
s_waitcnt vmcnt(7)
v_max3_u32 v124,v28,v29,v30
v_max_u32 v124,v124,v31
v_cmp_eq_u32 vcc,-1,v124
s_cbranch_vccnz dfl_100544
s_branch dseg_100547
dfl_100544:
buffer_load_dwordx4 v[28:31],v0,s[20:23],s92 offen offset:3072 sc1
s_bitset1_b32 s55,3
s_branch lap2_100548
dseg_100546:
v_smfmac_f32_16x16x64_bf16 v[64:67],v[24:27],a[160:167],v1
buffer_load_dword v125,off,s[20:23],s92 sc1
buffer_load_dwordx4 v[40:43],v0,s[20:23],s93 offen offset:2048 sc1
buffer_load_dwordx4 v[44:47],v0,s[20:23],s93 offen offset:3072 sc1
s_waitcnt vmcnt(7)
v_max3_u32 v124,v28,v29,v30
v_smfmac_f32_16x16x64_bf16 v[68:71],v[24:27],a[168:175],v1
v_max_u32 v124,v124,v31
v_cmp_eq_u32 vcc,-1,v124
v_smfmac_f32_16x16x64_bf16 v[72:75],v[24:27],a[176:183],v1
v_smfmac_f32_16x16x64_bf16 v[76:79],v[24:27],a[184:191],v1
s_cbranch_vccnz dfl_100544
dseg_100547:
v_smfmac_f32_16x16x64_bf16 v[64:67],v[28:31],a[224:231],v1
buffer_load_dword v125,off,s[20:23],s92 sc1
v_smfmac_f32_16x16x64_bf16 v[68:71],v[28:31],a[232:239],v1
v_smfmac_f32_16x16x64_bf16 v[72:75],v[28:31],a[240:247],v1
v_smfmac_f32_16x16x64_bf16 v[76:79],v[28:31],a[248:255],v1
lap2_100548:
s_bitcmp1_b32 s55,0
s_cbranch_scc0 l2s_100602
s_waitcnt vmcnt(7)
v_max3_u32 v124,v16,v17,v18
v_max_u32 v124,v124,v19
v_cmp_eq_u32 vcc,-1,v124
s_cbranch_vccnz l2s_100602
s_bitset0_b32 s55,0
v_smfmac_f32_16x16x64_bf16 v[64:67],v[16:19],a[32:39],v1
v_smfmac_f32_16x16x64_bf16 v[68:71],v[16:19],a[40:47],v1
v_smfmac_f32_16x16x64_bf16 v[72:75],v[16:19],a[48:55],v1
v_smfmac_f32_16x16x64_bf16 v[76:79],v[16:19],a[56:63],v1
l2s_100602:
s_bitcmp1_b32 s55,1
s_cbranch_scc0 l2s_100604
s_waitcnt vmcnt(5)
v_max3_u32 v124,v20,v21,v22
v_max_u32 v124,v124,v23
v_cmp_eq_u32 vcc,-1,v124
s_cbranch_vccnz l2s_100604
s_bitset0_b32 s55,1
v_smfmac_f32_16x16x64_bf16 v[64:67],v[20:23],a[96:103],v1
v_smfmac_f32_16x16x64_bf16 v[68:71],v[20:23],a[104:111],v1
v_smfmac_f32_16x16x64_bf16 v[72:75],v[20:23],a[112:119],v1
v_smfmac_f32_16x16x64_bf16 v[76:79],v[20:23],a[120:127],v1
l2s_100604:
s_bitcmp1_b32 s55,2
s_cbranch_scc0 l2s_100606
s_waitcnt vmcnt(3)
v_max3_u32 v124,v24,v25,v26
v_max_u32 v124,v124,v27
v_cmp_eq_u32 vcc,-1,v124
s_cbranch_vccnz l2s_100606
s_bitset0_b32 s55,2
v_smfmac_f32_16x16x64_bf16 v[64:67],v[24:27],a[160:167],v1
v_smfmac_f32_16x16x64_bf16 v[68:71],v[24:27],a[168:175],v1
v_smfmac_f32_16x16x64_bf16 v[72:75],v[24:27],a[176:183],v1
v_smfmac_f32_16x16x64_bf16 v[76:79],v[24:27],a[184:191],v1
l2s_100606:
s_bitcmp1_b32 s55,3
s_cbranch_scc0 l2s_100608
s_waitcnt vmcnt(0)
v_max3_u32 v124,v28,v29,v30
v_max_u32 v124,v124,v31
v_cmp_eq_u32 vcc,-1,v124
s_cbranch_vccnz l2s_100608
s_bitset0_b32 s55,3
v_smfmac_f32_16x16x64_bf16 v[64:67],v[28:31],a[224:231],v1
v_smfmac_f32_16x16x64_bf16 v[68:71],v[28:31],a[232:239],v1
v_smfmac_f32_16x16x64_bf16 v[72:75],v[28:31],a[240:247],v1
v_smfmac_f32_16x16x64_bf16 v[76:79],v[28:31],a[248:255],v1
l2s_100608:
s_cmp_eq_u32 s55,0
s_cbranch_scc0 lfb_100549
Ldone_100550:
s_waitcnt vmcnt(6)
v_max3_u32 v124,v32,v33,v34
v_max_u32 v124,v124,v35
v_cmp_eq_u32 vcc,-1,v124
s_cbranch_vccnz flb_100345
s_branch segb_100329
lfb_100549:
s_bitcmp1_b32 s55,0
s_cbranch_scc0 dsk_100610
buffer_load_dwordx4 v[16:19],v0,s[20:23],s92 offen offset:0 sc1
dsk_100610:
s_bitcmp1_b32 s55,1
s_cbranch_scc0 dsk_100611
buffer_load_dwordx4 v[20:23],v0,s[20:23],s92 offen offset:1024 sc1
dsk_100611:
s_bitcmp1_b32 s55,2
s_cbranch_scc0 dsk_100612
buffer_load_dwordx4 v[24:27],v0,s[20:23],s92 offen offset:2048 sc1
dsk_100612:
s_bitcmp1_b32 s55,3
s_cbranch_scc0 dsk_100613
buffer_load_dwordx4 v[28:31],v0,s[20:23],s92 offen offset:3072 sc1
dsk_100613:
s_bitcmp1_b32 s55,0
s_cbranch_scc0 dsk_100614
s_waitcnt vmcnt(2)
v_max3_u32 v124,v16,v17,v18
v_max_u32 v124,v124,v19
v_cmp_eq_u32 vcc,-1,v124
s_cbranch_vccz dgo_100615
s_nop 15
buffer_load_dwordx4 v[104:107],v0,s[20:23],s92 offen offset:0 sc1
s_nop 15
buffer_load_dwordx4 v[108:111],v0,s[20:23],s92 offen offset:0 sc1
dlp_100616:
s_waitcnt vmcnt(2)
v_max3_u32 v124,v16,v17,v18
v_max_u32 v124,v124,v19
v_cmp_eq_u32 vcc,-1,v124
s_cbranch_vccz dgo_100615
buffer_load_dwordx4 v[16:19],v0,s[20:23],s92 offen offset:0 sc1
s_waitcnt vmcnt(2)
v_max3_u32 v124,v104,v105,v106
v_max_u32 v124,v124,v107
v_cmp_eq_u32 vcc,-1,v124
s_cbranch_vccz dcp_100618
buffer_load_dwordx4 v[104:107],v0,s[20:23],s92 offen offset:0 sc1
s_waitcnt vmcnt(2)
v_max3_u32 v124,v108,v109,v110
v_max_u32 v124,v124,v111
v_cmp_eq_u32 vcc,-1,v124
s_cbranch_vccz dcp_100619
buffer_load_dwordx4 v[108:111],v0,s[20:23],s92 offen offset:0 sc1
s_sub_u32 s90,s90,1
s_cmp_gt_i32 s90,0
s_cbranch_scc1 dlp_100616
s_branch dgo_100615
dcp_100618:
v_mov_b32 v16,v104
v_mov_b32 v17,v105
v_mov_b32 v18,v106
v_mov_b32 v19,v107
s_nop 1
s_branch dgo_100615
dcp_100619:
v_mov_b32 v16,v108
v_mov_b32 v17,v109
v_mov_b32 v18,v110
v_mov_b32 v19,v111
s_nop 1
dgo_100615:
v_smfmac_f32_16x16x64_bf16 v[64:67],v[16:19],a[32:39],v1
v_smfmac_f32_16x16x64_bf16 v[68:71],v[16:19],a[40:47],v1
v_smfmac_f32_16x16x64_bf16 v[72:75],v[16:19],a[48:55],v1
v_smfmac_f32_16x16x64_bf16 v[76:79],v[16:19],a[56:63],v1
dsk_100614:
s_bitcmp1_b32 s55,1
s_cbranch_scc0 dsk_100620
s_waitcnt vmcnt(2)
v_max3_u32 v124,v20,v21,v22
v_max_u32 v124,v124,v23
v_cmp_eq_u32 vcc,-1,v124
s_cbranch_vccz dgo_100621
s_nop 15
buffer_load_dwordx4 v[104:107],v0,s[20:23],s92 offen offset:1024 sc1
s_nop 15
buffer_load_dwordx4 v[108:111],v0,s[20:23],s92 offen offset:1024 sc1
dlp_100622:
s_waitcnt vmcnt(2)
v_max3_u32 v124,v20,v21,v22
v_max_u32 v124,v124,v23
v_cmp_eq_u32 vcc,-1,v124
s_cbranch_vccz dgo_100621
buffer_load_dwordx4 v[20:23],v0,s[20:23],s92 offen offset:1024 sc1
s_waitcnt vmcnt(2)
v_max3_u32 v124,v104,v105,v106
v_max_u32 v124,v124,v107
v_cmp_eq_u32 vcc,-1,v124
s_cbranch_vccz dcp_100624
buffer_load_dwordx4 v[104:107],v0,s[20:23],s92 offen offset:1024 sc1
s_waitcnt vmcnt(2)
v_max3_u32 v124,v108,v109,v110
v_max_u32 v124,v124,v111
v_cmp_eq_u32 vcc,-1,v124
s_cbranch_vccz dcp_100625
buffer_load_dwordx4 v[108:111],v0,s[20:23],s92 offen offset:1024 sc1
s_sub_u32 s90,s90,1
s_cmp_gt_i32 s90,0
s_cbranch_scc1 dlp_100622
s_branch dgo_100621
dcp_100624:
v_mov_b32 v20,v104
v_mov_b32 v21,v105
v_mov_b32 v22,v106
v_mov_b32 v23,v107
s_nop 1
s_branch dgo_100621
dcp_100625:
v_mov_b32 v20,v108
v_mov_b32 v21,v109
v_mov_b32 v22,v110
v_mov_b32 v23,v111
s_nop 1
dgo_100621:
v_smfmac_f32_16x16x64_bf16 v[64:67],v[20:23],a[96:103],v1
v_smfmac_f32_16x16x64_bf16 v[68:71],v[20:23],a[104:111],v1
v_smfmac_f32_16x16x64_bf16 v[72:75],v[20:23],a[112:119],v1
v_smfmac_f32_16x16x64_bf16 v[76:79],v[20:23],a[120:127],v1
dsk_100620:
s_bitcmp1_b32 s55,2
s_cbranch_scc0 dsk_100626
s_waitcnt vmcnt(2)
v_max3_u32 v124,v24,v25,v26
v_max_u32 v124,v124,v27
v_cmp_eq_u32 vcc,-1,v124
s_cbranch_vccz dgo_100627
s_nop 15
buffer_load_dwordx4 v[104:107],v0,s[20:23],s92 offen offset:2048 sc1
s_nop 15
buffer_load_dwordx4 v[108:111],v0,s[20:23],s92 offen offset:2048 sc1
dlp_100628:
s_waitcnt vmcnt(2)
v_max3_u32 v124,v24,v25,v26
v_max_u32 v124,v124,v27
v_cmp_eq_u32 vcc,-1,v124
s_cbranch_vccz dgo_100627
buffer_load_dwordx4 v[24:27],v0,s[20:23],s92 offen offset:2048 sc1
s_waitcnt vmcnt(2)
v_max3_u32 v124,v104,v105,v106
v_max_u32 v124,v124,v107
v_cmp_eq_u32 vcc,-1,v124
s_cbranch_vccz dcp_100630
buffer_load_dwordx4 v[104:107],v0,s[20:23],s92 offen offset:2048 sc1
s_waitcnt vmcnt(2)
v_max3_u32 v124,v108,v109,v110
v_max_u32 v124,v124,v111
v_cmp_eq_u32 vcc,-1,v124
s_cbranch_vccz dcp_100631
buffer_load_dwordx4 v[108:111],v0,s[20:23],s92 offen offset:2048 sc1
s_sub_u32 s90,s90,1
s_cmp_gt_i32 s90,0
s_cbranch_scc1 dlp_100628
s_branch dgo_100627
dcp_100630:
v_mov_b32 v24,v104
v_mov_b32 v25,v105
v_mov_b32 v26,v106
v_mov_b32 v27,v107
s_nop 1
s_branch dgo_100627
dcp_100631:
v_mov_b32 v24,v108
v_mov_b32 v25,v109
v_mov_b32 v26,v110
v_mov_b32 v27,v111
s_nop 1
dgo_100627:
v_smfmac_f32_16x16x64_bf16 v[64:67],v[24:27],a[160:167],v1
v_smfmac_f32_16x16x64_bf16 v[68:71],v[24:27],a[168:175],v1
v_smfmac_f32_16x16x64_bf16 v[72:75],v[24:27],a[176:183],v1
v_smfmac_f32_16x16x64_bf16 v[76:79],v[24:27],a[184:191],v1
dsk_100626:
s_bitcmp1_b32 s55,3
s_cbranch_scc0 dsk_100632
s_waitcnt vmcnt(2)
v_max3_u32 v124,v28,v29,v30
v_max_u32 v124,v124,v31
v_cmp_eq_u32 vcc,-1,v124
s_cbranch_vccz dgo_100633
s_nop 15
buffer_load_dwordx4 v[104:107],v0,s[20:23],s92 offen offset:3072 sc1
s_nop 15
buffer_load_dwordx4 v[108:111],v0,s[20:23],s92 offen offset:3072 sc1
dlp_100634:
s_waitcnt vmcnt(2)
v_max3_u32 v124,v28,v29,v30
v_max_u32 v124,v124,v31
v_cmp_eq_u32 vcc,-1,v124
s_cbranch_vccz dgo_100633
buffer_load_dwordx4 v[28:31],v0,s[20:23],s92 offen offset:3072 sc1
s_waitcnt vmcnt(2)
v_max3_u32 v124,v104,v105,v106
v_max_u32 v124,v124,v107
v_cmp_eq_u32 vcc,-1,v124
s_cbranch_vccz dcp_100636
buffer_load_dwordx4 v[104:107],v0,s[20:23],s92 offen offset:3072 sc1
s_waitcnt vmcnt(2)
v_max3_u32 v124,v108,v109,v110
v_max_u32 v124,v124,v111
v_cmp_eq_u32 vcc,-1,v124
s_cbranch_vccz dcp_100637
buffer_load_dwordx4 v[108:111],v0,s[20:23],s92 offen offset:3072 sc1
s_sub_u32 s90,s90,1
s_cmp_gt_i32 s90,0
s_cbranch_scc1 dlp_100634
s_branch dgo_100633
dcp_100636:
v_mov_b32 v28,v104
v_mov_b32 v29,v105
v_mov_b32 v30,v106
v_mov_b32 v31,v107
s_nop 1
s_branch dgo_100633
dcp_100637:
v_mov_b32 v28,v108
v_mov_b32 v29,v109
v_mov_b32 v30,v110
v_mov_b32 v31,v111
s_nop 1
dgo_100633:
v_smfmac_f32_16x16x64_bf16 v[64:67],v[28:31],a[224:231],v1
v_smfmac_f32_16x16x64_bf16 v[68:71],v[28:31],a[232:239],v1
v_smfmac_f32_16x16x64_bf16 v[72:75],v[28:31],a[240:247],v1
v_smfmac_f32_16x16x64_bf16 v[76:79],v[28:31],a[248:255],v1
dsk_100632:
s_mov_b32 s55,0
s_branch Ldone_100550
slowA_100349:
buffer_load_dwordx4 v[44:47],v0,s[20:23],s93 offen offset:3072 sc1
dsk_100638:
s_bitcmp1_b32 s55,7
s_cbranch_scc0 dsk_100639
s_waitcnt vmcnt(2)
v_max3_u32 v124,v44,v45,v46
v_max_u32 v124,v124,v47
v_cmp_eq_u32 vcc,-1,v124
s_cbranch_vccz dgo_100640
s_nop 15
s_nop 3
buffer_load_dwordx4 v[104:107],v0,s[20:23],s93 offen offset:3072 sc1
s_nop 15
s_nop 3
buffer_load_dwordx4 v[108:111],v0,s[20:23],s93 offen offset:3072 sc1
dlp_100641:
s_waitcnt vmcnt(2)
v_max3_u32 v124,v44,v45,v46
v_max_u32 v124,v124,v47
v_cmp_eq_u32 vcc,-1,v124
s_cbranch_vccz dgo_100640
buffer_load_dwordx4 v[44:47],v0,s[20:23],s93 offen offset:3072 sc1
s_waitcnt vmcnt(2)
v_max3_u32 v124,v104,v105,v106
v_max_u32 v124,v124,v107
v_cmp_eq_u32 vcc,-1,v124
s_cbranch_vccz dcp_100643
buffer_load_dwordx4 v[104:107],v0,s[20:23],s93 offen offset:3072 sc1
s_waitcnt vmcnt(2)
v_max3_u32 v124,v108,v109,v110
v_max_u32 v124,v124,v111
v_cmp_eq_u32 vcc,-1,v124
s_cbranch_vccz dcp_100644
buffer_load_dwordx4 v[108:111],v0,s[20:23],s93 offen offset:3072 sc1
s_sub_u32 s90,s90,1
s_cmp_gt_i32 s90,0
s_cbranch_scc1 dlp_100641
s_branch dgo_100640
dcp_100643:
v_mov_b32 v44,v104
v_mov_b32 v45,v105
v_mov_b32 v46,v106
v_mov_b32 v47,v107
s_nop 1
s_branch dgo_100640
dcp_100644:
v_mov_b32 v44,v108
v_mov_b32 v45,v109
v_mov_b32 v46,v110
v_mov_b32 v47,v111
s_nop 1
dgo_100640:
dsk_100639:
s_mov_b32 s55,0
s_branch segb_100331
recslow_100247:
s_mov_b32 s55,0
s_cmp_lg_u32 s50,0
s_cbranch_scc1 np0_100647
v_mov_b32 v120,0
v_mov_b32 v121,0
s_cmp_lg_u32 s58,0
s_cbranch_scc1 z1_100648
v_lshrrev_b32 v124,6,v127
v_lshlrev_b32 v124,12,v124
v_bfe_u32 v125,v127,1,5
v_add_u32 v124,v124,v125
s_lshl_b32 s64,s59,6
buffer_load_ushort v120,v124,s[44:47],s64 offen
buffer_load_ushort v122,v124,s[44:47],s64 offen offset:32
buffer_load_ushort v121,v124,s[44:47],s64 offen offset:2048
buffer_load_ushort v123,v124,s[44:47],s64 offen offset:2080
s_waitcnt vmcnt(0)
v_lshl_or_b32 v120,v122,16,v120
v_lshl_or_b32 v121,v123,16,v121
v_min_u32 v120,s81,v120
v_min_u32 v121,s81,v121
z1_100648:
buffer_store_dword v120,v4,s[20:23],s71 offen sc1
buffer_store_dword v121,v4,s[20:23],s71 offen offset:32 sc1
buffer_store_dword v120,v4,s[20:23],s73 offen sc1
buffer_store_dword v121,v4,s[20:23],s73 offen offset:32 sc1
np0_100647:
v_lshrrev_b32 v124,2,v0
v_bfe_u32 v125,v124,5,1
v_mul_u32_u24 v125,2048,v125
s_and_b32 s64,s50,1
s_lshl_b32 s64,s64,5
v_add3_u32 v4,v124,v125,s64
s_add_u32 s64,s79,0
s_cmp_gt_u32 s91,s64
s_cbranch_scc0 flp_100651
fok_100650:
s_add_u32 s64,s79,0
s_lshl_b32 s65,s64,12
s_and_b32 s65,s65,0x2000
s_xor_b32 s65,s65,s67
s_lshl_b32 s64,s64,20
s_add_u32 s65,s65,s64
s_add_u32 s99,s65,s77
buffer_load_dwordx4 v[104:107],v0,s[20:23],s99 offen
buffer_load_dwordx4 v[108:111],v0,s[20:23],s99 offen offset:1024
s_waitcnt vmcnt(0)
s_mov_b32 s92,s70
s_mov_b32 s93,s72
s_mov_b32 s94,s76
s_add_u32 s95,s94,4096
s_mov_b32 s96,s74
s_add_u32 s97,s96,4096
s_mov_b32 s98,s75
s_barrier
v_mov_b32 v96,v104
v_mov_b32 v97,v105
v_mov_b32 v98,v106
v_mov_b32 v99,v107
v_mov_b32 v100,v108
v_mov_b32 v101,v109
v_mov_b32 v102,v110
v_mov_b32 v103,v111
v_mov_b32 v48,0
v_mov_b32 v49,0
v_mov_b32 v50,0
v_mov_b32 v51,0
v_mov_b32 v52,0
v_mov_b32 v53,0
v_mov_b32 v54,0
v_mov_b32 v55,0
v_mov_b32 v56,0
v_mov_b32 v57,0
v_mov_b32 v58,0
v_mov_b32 v59,0
v_mov_b32 v60,0
v_mov_b32 v61,0
v_mov_b32 v62,0
v_mov_b32 v63,0
v_mov_b32 v64,0
v_mov_b32 v65,0
v_mov_b32 v66,0
v_mov_b32 v67,0
v_mov_b32 v68,0
v_mov_b32 v69,0
v_mov_b32 v70,0
v_mov_b32 v71,0
v_mov_b32 v72,0
v_mov_b32 v73,0
v_mov_b32 v74,0
v_mov_b32 v75,0
v_mov_b32 v76,0
v_mov_b32 v77,0
v_mov_b32 v78,0
v_mov_b32 v79,0
v_mov_b32 v80,0
v_mov_b32 v81,0
v_mov_b32 v82,0
v_mov_b32 v83,0
v_mov_b32 v84,0
v_mov_b32 v85,0
v_mov_b32 v86,0
v_mov_b32 v87,0
v_mov_b32 v88,0
v_mov_b32 v89,0
v_mov_b32 v90,0
v_mov_b32 v91,0
v_mov_b32 v92,0
v_mov_b32 v93,0
v_mov_b32 v94,0
v_mov_b32 v95,0
s_cmp_gt_u32 s50,1
s_cbranch_scc0 loop0_100649x
loop_100645:
v_mov_b32 v125,0
s_nop 1
v_mfma_f32_16x16x1_4b_f32 v[48:63],v125,v125,0
v_mfma_f32_16x16x1_4b_f32 v[64:79],v125,v125,0
v_mfma_f32_16x16x1_4b_f32 v[80:95],v125,v125,0
s_nop 15
s_nop 15
s_nop 15
s_nop 15
buffer_load_dwordx4 v[16:19],v0,s[20:23],s92 offen offset:0 sc1
s_nop 7
buffer_load_dwordx4 v[20:23],v0,s[20:23],s92 offen offset:1024 sc1
s_nop 7
buffer_load_dwordx4 v[24:27],v0,s[20:23],s92 offen offset:2048 sc1
s_nop 7
buffer_load_dwordx4 v[28:31],v0,s[20:23],s92 offen offset:3072 sc1
v_mov_b32 v96,v104
v_mov_b32 v97,v105
v_mov_b32 v98,v106
v_mov_b32 v99,v107
v_mov_b32 v100,v108
v_mov_b32 v101,v109
v_mov_b32 v102,v110
v_mov_b32 v103,v111
s_branch ja_100652
loop0_100649x:
v_mov_b32 v125,0
s_nop 1
v_mfma_f32_16x16x1_4b_f32 v[48:63],v125,v125,0
v_mfma_f32_16x16x1_4b_f32 v[64:79],v125,v125,0
v_mfma_f32_16x16x1_4b_f32 v[80:95],v125,v125,0
s_nop 15
s_nop 11
buffer_load_dwordx4 v[16:19],v0,s[20:23],s92 offen offset:0 sc1
s_nop 7
buffer_load_dwordx4 v[20:23],v0,s[20:23],s92 offen offset:1024 sc1
s_nop 7
buffer_load_dwordx4 v[24:27],v0,s[20:23],s92 offen offset:2048 sc1
s_nop 7
buffer_load_dwordx4 v[28:31],v0,s[20:23],s92 offen offset:3072 sc1
ja_100652:
s_max_u32 s66,s79,1
s_sub_u32 s66,s66,1
v_mov_b32 v126,s66
s_add_u32 s64,s66,0
s_lshl_b32 s65,s64,12
s_and_b32 s65,s65,0x2000
s_xor_b32 s65,s65,s67
s_lshl_b32 s64,s64,20
s_add_u32 s65,s65,s64
s_add_u32 s101,s65,s78
s_cmp_eq_u32 s79,63
s_cbranch_scc1 last_100646
s_add_u32 s64,s79,1
s_lshl_b32 s65,s64,12
s_and_b32 s65,s65,0x2000
s_xor_b32 s65,s65,s67
s_lshl_b32 s64,s64,20
s_add_u32 s65,s65,s64
s_add_u32 s99,s65,s77
s_waitcnt vmcnt(3)
v_max3_u32 v124,v16,v17,v18
v_max_u32 v124,v124,v19
v_cmp_eq_u32 vcc,-1,v124
v_cndmask_b32 v120,2.0,v0,s[82:83]
v_cndmask_b32 v121,2.0,v127,s[86:87]
s_cbranch_vccnz flb_100679
seg_100655:
segb_100663:
v_smfmac_f32_16x16x64_bf16 v[48:51],v[16:19],a[0:7],v1
buffer_load_dword v125,off,s[20:23],s92 sc1
v_smfmac_f32_16x16x64_bf16 v[52:55],v[16:19],a[8:15],v1
buffer_load_dwordx4 v[32:35],v0,s[20:23],s93 offen offset:0 sc1
v_smfmac_f32_16x16x64_bf16 v[56:59],v[16:19],a[16:23],v1
s_waitcnt vmcnt(4)
v_max3_u32 v124,v20,v21,v22
v_smfmac_f32_16x16x64_bf16 v[60:63],v[16:19],a[24:31],v1
v_max_u32 v124,v124,v23
v_smfmac_f32_16x16x64_bf16 v[64:67],v[16:19],a[32:39],v1
v_cmp_eq_u32 vcc,-1,v124
v_smfmac_f32_16x16x64_bf16 v[68:71],v[16:19],a[40:47],v1
v_smfmac_f32_16x16x64_bf16 v[72:75],v[16:19],a[48:55],v1
s_cbranch_vccnz fl_100672
seg_100656:
v_smfmac_f32_16x16x64_bf16 v[76:79],v[16:19],a[56:63],v1
segb_100664:
v_smfmac_f32_16x16x64_bf16 v[48:51],v[20:23],a[64:71],v1
buffer_load_dword v125,off,s[20:23],s92 sc1
v_smfmac_f32_16x16x64_bf16 v[52:55],v[20:23],a[72:79],v1
buffer_load_dwordx4 v[36:39],v0,s[20:23],s93 offen offset:1024 sc1
v_smfmac_f32_16x16x64_bf16 v[56:59],v[20:23],a[80:87],v1
s_waitcnt vmcnt(5)
v_max3_u32 v124,v24,v25,v26
v_smfmac_f32_16x16x64_bf16 v[60:63],v[20:23],a[88:95],v1
v_max_u32 v124,v124,v27
v_smfmac_f32_16x16x64_bf16 v[64:67],v[20:23],a[96:103],v1
v_cmp_eq_u32 vcc,-1,v124
v_smfmac_f32_16x16x64_bf16 v[68:71],v[20:23],a[104:111],v1
v_smfmac_f32_16x16x64_bf16 v[72:75],v[20:23],a[112:119],v1
s_cbranch_vccnz fl_100673
seg_100657:
v_smfmac_f32_16x16x64_bf16 v[76:79],v[20:23],a[120:127],v1
segb_100665:
v_smfmac_f32_16x16x64_bf16 v[48:51],v[24:27],a[128:135],v1
buffer_load_dword v125,off,s[20:23],s92 sc1
v_smfmac_f32_16x16x64_bf16 v[52:55],v[24:27],a[136:143],v1
buffer_load_dwordx4 v[40:43],v0,s[20:23],s93 offen offset:2048 sc1
v_smfmac_f32_16x16x64_bf16 v[56:59],v[24:27],a[144:151],v1
buffer_load_dwordx4 v[44:47],v0,s[20:23],s93 offen offset:3072 sc1
s_waitcnt vmcnt(7)
v_max3_u32 v124,v28,v29,v30
v_smfmac_f32_16x16x64_bf16 v[60:63],v[24:27],a[152:159],v1
v_max_u32 v124,v124,v31
v_smfmac_f32_16x16x64_bf16 v[64:67],v[24:27],a[160:167],v1
v_cmp_eq_u32 vcc,-1,v124
v_smfmac_f32_16x16x64_bf16 v[68:71],v[24:27],a[168:175],v1
v_smfmac_f32_16x16x64_bf16 v[72:75],v[24:27],a[176:183],v1
s_cbranch_vccnz fl_100674
seg_100658:
v_smfmac_f32_16x16x64_bf16 v[76:79],v[24:27],a[184:191],v1
segb_100666:
v_smfmac_f32_16x16x64_bf16 v[48:51],v[28:31],a[192:199],v1
buffer_load_dword v125,off,s[20:23],s92 sc1
v_smfmac_f32_16x16x64_bf16 v[52:55],v[28:31],a[200:207],v1
v_smfmac_f32_16x16x64_bf16 v[56:59],v[28:31],a[208:215],v1
s_waitcnt vmcnt(6)
v_max3_u32 v124,v32,v33,v34
v_smfmac_f32_16x16x64_bf16 v[60:63],v[28:31],a[216:223],v1
v_max_u32 v124,v124,v35
v_smfmac_f32_16x16x64_bf16 v[64:67],v[28:31],a[224:231],v1
v_cmp_eq_u32 vcc,-1,v124
v_smfmac_f32_16x16x64_bf16 v[68:71],v[28:31],a[232:239],v1
v_smfmac_f32_16x16x64_bf16 v[72:75],v[28:31],a[240:247],v1
s_cbranch_vccnz fl_100675
seg_100659:
v_smfmac_f32_16x16x64_bf16 v[76:79],v[28:31],a[248:255],v1
segb_100667:
v_smfmac_f32_16x16x64_bf16 v[48:51],v[32:35],a[0:7],v1
buffer_load_dword v125,off,s[20:23],s92 sc1
v_smfmac_f32_16x16x64_bf16 v[52:55],v[32:35],a[8:15],v1
buffer_store_dwordx4 v[112:115],v120,s[20:23],s101 offen sc1
v_smfmac_f32_16x16x64_bf16 v[56:59],v[32:35],a[16:23],v1
buffer_store_dword v126,v121,s[20:23],s69 offen sc1
s_waitcnt vmcnt(7)
v_max3_u32 v124,v36,v37,v38
v_smfmac_f32_16x16x64_bf16 v[60:63],v[32:35],a[24:31],v1
v_max_u32 v124,v124,v39
v_smfmac_f32_16x16x64_bf16 v[64:67],v[32:35],a[32:39],v1
v_cmp_eq_u32 vcc,-1,v124
v_smfmac_f32_16x16x64_bf16 v[68:71],v[32:35],a[40:47],v1
v_smfmac_f32_16x16x64_bf16 v[72:75],v[32:35],a[48:55],v1
s_cbranch_vccnz fl_100676
seg_100660:
v_smfmac_f32_16x16x64_bf16 v[76:79],v[32:35],a[56:63],v1
segb_100668:
v_smfmac_f32_16x16x64_bf16 v[48:51],v[36:39],a[64:71],v1
buffer_load_dword v125,off,s[20:23],s92 sc1
s_waitcnt vmcnt(5)
v_max3_u32 v124,v40,v41,v42
v_smfmac_f32_16x16x64_bf16 v[52:55],v[36:39],a[72:79],v1
v_max3_u32 v124,v124,v43,v44
v_smfmac_f32_16x16x64_bf16 v[56:59],v[36:39],a[80:87],v1
v_max3_u32 v124,v124,v45,v46
v_smfmac_f32_16x16x64_bf16 v[60:63],v[36:39],a[88:95],v1
v_max_u32 v124,v124,v47
v_smfmac_f32_16x16x64_bf16 v[64:67],v[36:39],a[96:103],v1
v_cmp_eq_u32 vcc,-1,v124
v_smfmac_f32_16x16x64_bf16 v[68:71],v[36:39],a[104:111],v1
v_smfmac_f32_16x16x64_bf16 v[72:75],v[36:39],a[112:119],v1
s_cbranch_vccnz fl_100677
seg_100661:
v_smfmac_f32_16x16x64_bf16 v[76:79],v[36:39],a[120:127],v1
segb_100669:
v_smfmac_f32_16x16x64_bf16 v[48:51],v[40:43],a[128:135],v1
s_add_u32 s64,s79,1
s_cmp_gt_u32 s91,s64
s_cbranch_scc0 flp_100654
fok_100653:
v_smfmac_f32_16x16x64_bf16 v[52:55],v[40:43],a[136:143],v1
buffer_load_dwordx4 v[104:107],v0,s[20:23],s99 offen
buffer_load_dwordx4 v[108:111],v0,s[20:23],s99 offen offset:1024
v_smfmac_f32_16x16x64_bf16 v[48:51],v[44:47],a[192:199],v1
buffer_load_dword v126,off,s[20:23],s68 sc1
s_add_u32 s64,s79,2
v_smfmac_f32_16x16x64_bf16 v[52:55],v[44:47],a[200:207],v1
s_and_b32 s64,s64,3
s_lshl_b32 s100,s64,19
s_nop 0
v_add_f32 v48,v48,v49
v_smfmac_f32_16x16x64_bf16 v[56:59],v[40:43],a[144:151],v1
ds_write_addtid_b32 v48 offset:0
v_add_f32 v50,v50,v51
v_smfmac_f32_16x16x64_bf16 v[60:63],v[40:43],a[152:159],v1
ds_write_addtid_b32 v50 offset:1040
v_add_f32 v52,v52,v53
v_smfmac_f32_16x16x64_bf16 v[56:59],v[44:47],a[208:215],v1
ds_write_addtid_b32 v52 offset:2080
v_add_f32 v54,v54,v55
v_smfmac_f32_16x16x64_bf16 v[60:63],v[44:47],a[216:223],v1
ds_write_addtid_b32 v54 offset:3120
s_nop 1
v_add_f32 v56,v56,v57
v_smfmac_f32_16x16x64_bf16 v[64:67],v[40:43],a[160:167],v1
ds_write_addtid_b32 v56 offset:4160
v_add_f32 v58,v58,v59
v_smfmac_f32_16x16x64_bf16 v[68:71],v[40:43],a[168:175],v1
ds_write_addtid_b32 v58 offset:5200
v_add_f32 v60,v60,v61
v_smfmac_f32_16x16x64_bf16 v[64:67],v[44:47],a[224:231],v1
ds_write_addtid_b32 v60 offset:6240
v_add_f32 v62,v62,v63
v_smfmac_f32_16x16x64_bf16 v[68:71],v[44:47],a[232:239],v1
ds_write_addtid_b32 v62 offset:7280
s_nop 1
v_add_f32 v64,v64,v65
v_smfmac_f32_16x16x64_bf16 v[72:75],v[40:43],a[176:183],v1
ds_write_addtid_b32 v64 offset:8448
v_add_f32 v66,v66,v67
v_smfmac_f32_16x16x64_bf16 v[76:79],v[40:43],a[184:191],v1
ds_write_addtid_b32 v66 offset:9488
v_add_f32 v68,v68,v69
v_smfmac_f32_16x16x64_bf16 v[72:75],v[44:47],a[240:247],v1
ds_write_addtid_b32 v68 offset:10528
v_add_f32 v70,v70,v71
v_smfmac_f32_16x16x64_bf16 v[76:79],v[44:47],a[248:255],v1
ds_write_addtid_b32 v70 offset:11568
s_nop 1
v_add_f32 v72,v72,v73
v_smfmac_f32_16x16x64_bf16 v[80:83],v[16:19],v[208:215],v1
ds_write_addtid_b32 v72 offset:12608
v_add_f32 v74,v74,v75
v_smfmac_f32_16x16x64_bf16 v[80:83],v[32:35],v[208:215],v1
ds_write_addtid_b32 v74 offset:13648
v_add_f32 v76,v76,v77
ds_write_addtid_b32 v76 offset:14688
v_add_f32 v78,v78,v79
ds_write_addtid_b32 v78 offset:15728
doneA_100688:
s_waitcnt lgkmcnt(0)
s_barrier
s_cmp_gt_u32 s50,1
s_cbranch_scc1 w23_100689
v_smfmac_f32_16x16x64_bf16 v[84:87],v[16:19],v[216:223],v1
v_smfmac_f32_16x16x64_bf16 v[84:87],v[32:35],v[216:223],v1
v_smfmac_f32_16x16x64_bf16 v[88:91],v[16:19],v[224:231],v1
v_smfmac_f32_16x16x64_bf16 v[88:91],v[32:35],v[224:231],v1
v_smfmac_f32_16x16x64_bf16 v[92:95],v[16:19],v[232:239],v1
ds_read_b128 v[48:51],v7 offset:0
ds_read_b128 v[52:55],v7 offset:1024
v_smfmac_f32_16x16x64_bf16 v[92:95],v[32:35],v[232:239],v1
ds_read_b128 v[56:59],v7 offset:2048
ds_read_b128 v[60:63],v7 offset:3072
v_smfmac_f32_16x16x64_bf16 v[80:83],v[20:23],v[240:247],v1
ds_read_b128 v[64:67],v7 offset:4096
ds_read_b128 v[68:71],v7 offset:5120
v_smfmac_f32_16x16x64_bf16 v[80:83],v[36:39],v[240:247],v1
ds_read_b128 v[72:75],v7 offset:6144
ds_read_b128 v[76:79],v7 offset:7168
v_smfmac_f32_16x16x64_bf16 v[84:87],v[20:23],v[248:255],v1
v_smfmac_f32_16x16x64_bf16 v[84:87],v[36:39],v[248:255],v1
s_waitcnt lgkmcnt(6)
v_smfmac_f32_16x16x64_bf16 v[88:91],v[20:23],v[48:55],v1
v_smfmac_f32_16x16x64_bf16 v[88:91],v[36:39],v[48:55],v1
ds_read_b128 v[48:51],v7 offset:8192
ds_read_b128 v[52:55],v7 offset:9216
s_waitcnt lgkmcnt(6)
v_smfmac_f32_16x16x64_bf16 v[92:95],v[20:23],v[56:63],v1
v_smfmac_f32_16x16x64_bf16 v[92:95],v[36:39],v[56:63],v1
ds_read_b128 v[56:59],v7 offset:10240
ds_read_b128 v[60:63],v7 offset:11264
s_waitcnt lgkmcnt(6)
v_smfmac_f32_16x16x64_bf16 v[80:83],v[24:27],v[64:71],v1
v_smfmac_f32_16x16x64_bf16 v[80:83],v[40:43],v[64:71],v1
ds_read_b128 v[64:67],v7 offset:12288
ds_read_b128 v[68:71],v7 offset:13312
s_waitcnt lgkmcnt(6)
v_smfmac_f32_16x16x64_bf16 v[84:87],v[24:27],v[72:79],v1
v_smfmac_f32_16x16x64_bf16 v[84:87],v[40:43],v[72:79],v1
ds_read_b128 v[72:75],v7 offset:14336
ds_read_b128 v[76:79],v7 offset:15360
s_waitcnt lgkmcnt(6)
v_smfmac_f32_16x16x64_bf16 v[88:91],v[24:27],v[48:55],v1
v_smfmac_f32_16x16x64_bf16 v[88:91],v[40:43],v[48:55],v1
ds_read_b128 v[48:51],v7 offset:16384
ds_read_b128 v[52:55],v7 offset:17408
s_waitcnt lgkmcnt(6)
v_smfmac_f32_16x16x64_bf16 v[92:95],v[24:27],v[56:63],v1
v_smfmac_f32_16x16x64_bf16 v[92:95],v[40:43],v[56:63],v1
ds_read_b128 v[56:59],v7 offset:18432
ds_read_b128 v[60:63],v7 offset:19456
s_waitcnt lgkmcnt(6)
v_smfmac_f32_16x16x64_bf16 v[80:83],v[28:31],v[64:71],v1
v_smfmac_f32_16x16x64_bf16 v[80:83],v[44:47],v[64:71],v1
s_waitcnt lgkmcnt(4)
v_smfmac_f32_16x16x64_bf16 v[84:87],v[28:31],v[72:79],v1
v_smfmac_f32_16x16x64_bf16 v[84:87],v[44:47],v[72:79],v1
s_waitcnt lgkmcnt(2)
v_smfmac_f32_16x16x64_bf16 v[88:91],v[28:31],v[48:55],v1
v_add_f32 v80,v80,v81
v_smfmac_f32_16x16x64_bf16 v[88:91],v[44:47],v[48:55],v1
v_add_f32 v82,v82,v83
s_waitcnt lgkmcnt(0)
v_smfmac_f32_16x16x64_bf16 v[92:95],v[28:31],v[56:63],v1
v_cvt_pk_bf16_f32 v80,v80,v82
v_smfmac_f32_16x16x64_bf16 v[92:95],v[44:47],v[56:63],v1
ds_write_addtid_b32 v80 offset:16896
v_add_f32 v84,v84,v85
buffer_load_dwordx4 v[16:19],v2,s[20:23],s94 offen offset:0 sc1
buffer_load_dwordx4 v[32:35],v2,s[20:23],s94 offen offset:1536 sc1
buffer_load_dwordx4 v[20:23],v2,s[20:23],s95 offen offset:0 sc1
buffer_load_dwordx4 v[36:39],v2,s[20:23],s95 offen offset:1536 sc1
buffer_load_dword v120,v3,s[20:23],s94 offen offset:0 sc1
buffer_load_dword v121,v3,s[20:23],s94 offen offset:1536 sc1
buffer_load_dword v122,v3,s[20:23],s95 offen offset:0 sc1
buffer_load_dword v123,v3,s[20:23],s95 offen offset:1536 sc1
v_add_f32 v86,v86,v87
v_cvt_pk_bf16_f32 v84,v84,v86
v_add_f32 v88,v88,v89
v_add_f32 v90,v90,v91
v_cvt_pk_bf16_f32 v88,v88,v90
v_add_f32 v92,v92,v93
v_add_f32 v94,v94,v95
v_cvt_pk_bf16_f32 v92,v92,v94
ds_write_addtid_b32 v84 offset:17920
ds_write_addtid_b32 v88 offset:18944
ds_write_addtid_b32 v92 offset:19968
sp_100692:
s_waitcnt vmcnt(6)
v_pk_add_f32 v[16:17],v[16:17],v[32:33]
v_pk_add_f32 v[18:19],v[18:19],v[34:35]
s_waitcnt vmcnt(4)
v_pk_add_f32 v[20:21],v[20:21],v[36:37]
v_pk_add_f32 v[22:23],v[22:23],v[38:39]
v_pk_add_f32 v[16:17],v[16:17],v[20:21]
v_pk_add_f32 v[18:19],v[18:19],v[22:23]
v_max3_f32 v124,v16,v17,v18
v_pk_add_f32 v[20:21],v[16:17],v[18:19]
s_waitcnt vmcnt(0)
v_pk_add_f32 v[120:121],v[120:121],v[122:123]
v_add_f32 v120,v120,v121
v_max3_f32 v124,v124,v19,v120
v_add_f32 v20,v20,v120
v_cmp_u_f32 vcc,v20,v21
v_max_f32_dpp v124,v124,v124 row_ror:8 row_mask:0xf bank_mask:0xf
v_mov_b32 v125,v124
s_cbranch_vccnz srt_100694
sok_100693:
s_nop 0
v_permlane16_swap_b32 v125,v124
v_max_f32 v124,v124,v125
v_mov_b32 v125,v124
s_nop 1
v_permlane32_swap_b32 v125,v124
v_max_f32 v124,v124,v125
v_mul_f32 v124,s80,v124
v_fma_f32 v16,v16,s80,-v124
v_fma_f32 v17,v17,s80,-v124
v_fma_f32 v18,v18,s80,-v124
v_fma_f32 v19,v19,s80,-v124
v_fma_f32 v120,v120,s80,-v124
s_waitcnt lgkmcnt(0)
s_barrier
ds_read2st64_b32 v[112:113],v127 offset0:66 offset1:67
ds_read2st64_b32 v[114:115],v127 offset0:68 offset1:69
ds_read2st64_b32 v[116:117],v127 offset0:70 offset1:71
ds_read2st64_b32 v[118:119],v127 offset0:72 offset1:73
v_exp_f32 v16,v16
v_exp_f32 v17,v17
v_exp_f32 v18,v18
v_exp_f32 v19,v19
v_cvt_pk_bf16_f32 v48,v16,v17
v_cvt_pk_bf16_f32 v49,v18,v19
v_exp_f32 v120,v120
v_mov_b32_dpp v50,v48 row_ror:8 row_mask:0xf bank_mask:0xf
v_mov_b32_dpp v51,v49 row_ror:8 row_mask:0xf bank_mask:0xf
v_mov_b32_dpp v121,v120 row_ror:8 row_mask:0xf bank_mask:0xf
v_cvt_pk_bf16_f32 v52,v120,v121
v_mfma_f32_16x16x32_bf16 v[64:67],v[8:11],v[48:51],0
v_mov_b32 v53,v52
v_mfma_f32_16x16x32_bf16 v[56:59],v[96:99],v[48:51],0
v_mov_b32 v54,v52
v_mov_b32 v55,v52
v_mfma_f32_16x16x32_bf16 v[60:63],v[100:103],v[48:51],0
v_mfma_f32_16x16x32_bf16 v[64:67],v[12:15],v[52:55],v[64:67]
s_waitcnt lgkmcnt(0)
v_mfma_f32_16x16x32_bf16 v[56:59],v[112:115],v[52:55],v[56:59]
v_mfma_f32_16x16x32_bf16 v[60:63],v[116:119],v[52:55],v[60:63]
s_nop 0
v_rcp_f32 v66,v64
s_nop 2
v_pk_mul_f32 v[56:57],v[56:57],v[66:67] op_sel_hi:[1,0]
v_pk_mul_f32 v[58:59],v[58:59],v[66:67] op_sel_hi:[1,0]
s_nop 0
v_pk_mul_f32 v[60:61],v[60:61],v[66:67] op_sel_hi:[1,0]
v_pk_mul_f32 v[62:63],v[62:63],v[66:67] op_sel_hi:[1,0]
v_cvt_pk_bf16_f32 v120,v56,v57
v_cvt_pk_bf16_f32 v121,v58,v59
v_cvt_pk_bf16_f32 v122,v60,v61
v_cvt_pk_bf16_f32 v123,v62,v63
buffer_store_dwordx4 v[120:123],v6,s[20:23],s98 offen sc1
s_barrier
ds_read_b128 v[48:51],v7 offset:20480
ds_read_b128 v[52:55],v7 offset:21504
ds_read_b128 v[56:59],v7 offset:22528
ds_read_b128 v[60:63],v7 offset:23552
ds_read_b128 v[64:67],v7 offset:24576
ds_read_b128 v[68:71],v7 offset:25600
ds_read_b128 v[72:75],v7 offset:26624
ds_read_b128 v[76:79],v7 offset:27648
ds_read_b128 v[80:83],v7 offset:28672
ds_read_b128 v[84:87],v7 offset:29696
ds_read_b128 v[88:91],v7 offset:30720
ds_read_b128 v[92:95],v7 offset:31744
v_mov_b32 v96,0
v_mov_b32 v97,0
v_mov_b32 v98,0
v_mov_b32 v99,0
v_mov_b32 v100,0
v_mov_b32 v101,0
v_mov_b32 v102,0
v_mov_b32 v103,0
s_nop 11
buffer_load_dwordx4 v[16:19],v0,s[20:23],s96 offen offset:0 sc1
v_mov_b32 v120,v5
v_mov_b32 v121,v5
v_mov_b32 v122,v5
v_mov_b32 v123,v5
s_nop 1
v_mfma_f32_16x16x32_bf16 v[112:115],v[120:123],v[112:115],0
buffer_load_dwordx4 v[20:23],v0,s[20:23],s96 offen offset:1024 sc1
v_mfma_f32_16x16x32_bf16 v[116:119],v[120:123],v[116:119],0
s_add_u32 s79,s79,1
s_and_b32 s64,s79,3
s_lshl_b32 s64,s64,19
s_lshl_b32 s65,s79,8
buffer_load_dwordx4 v[24:27],v0,s[20:23],s96 offen offset:2048 sc1
s_and_b32 s65,s65,0x2000
s_lshl_b32 s66,s79,16
s_xor_b32 s88,s73,s65
s_add_u32 s88,s88,s66
s_sub_u32 s88,s88,s54
s_add_u32 s89,s71,s64
s_add_u32 s92,s70,s64
s_xor_b32 s93,s72,s65
buffer_load_dwordx4 v[28:31],v0,s[20:23],s96 offen offset:3072 sc1
s_add_u32 s93,s93,s66
s_add_u32 s94,s76,s64
s_add_u32 s95,s94,4096
s_add_u32 s98,s75,s64
s_add_u32 s60,s74,s64
v_cvt_pk_bf16_f32 v112,v112,v113
v_cvt_pk_bf16_f32 v113,v114,v115
v_cvt_pk_bf16_f32 v114,v116,v117
buffer_load_dwordx4 v[32:35],v0,s[20:23],s97 offen offset:0 sc1
v_cvt_pk_bf16_f32 v115,v118,v119
s_nop 6
buffer_load_dwordx4 v[36:39],v0,s[20:23],s97 offen offset:1024 sc1
s_nop 7
buffer_load_dwordx4 v[40:43],v0,s[20:23],s97 offen offset:2048 sc1
s_nop 7
buffer_load_dwordx4 v[44:47],v0,s[20:23],s97 offen offset:3072 sc1
s_branch ogo_100690
w23_100689:
ds_read_b128 v[48:51],v2 offset:0
ds_read_b128 v[52:55],v2 offset:256
ds_read_b128 v[56:59],v2 offset:512
ds_read_b128 v[60:63],v2 offset:768
ds_read_b128 v[64:67],v2 offset:16
ds_read_b128 v[68:71],v2 offset:272
ds_read_b128 v[72:75],v2 offset:528
ds_read_b128 v[76:79],v2 offset:784
s_waitcnt lgkmcnt(6)
v_pk_add_f32 v[48:49],v[48:49],v[52:53]
v_pk_add_f32 v[50:51],v[50:51],v[54:55]
s_waitcnt lgkmcnt(4)
v_pk_add_f32 v[56:57],v[56:57],v[60:61]
v_pk_add_f32 v[58:59],v[58:59],v[62:63]
v_pk_add_f32 v[48:49],v[48:49],v[56:57]
v_pk_add_f32 v[50:51],v[50:51],v[58:59]
v_cvt_pk_bf16_f32 v112,v48,v49
v_cvt_pk_bf16_f32 v113,v50,v51
s_waitcnt lgkmcnt(2)
v_pk_add_f32 v[64:65],v[64:65],v[68:69]
v_pk_add_f32 v[66:67],v[66:67],v[70:71]
s_waitcnt lgkmcnt(0)
v_pk_add_f32 v[72:73],v[72:73],v[76:77]
v_pk_add_f32 v[74:75],v[74:75],v[78:79]
v_pk_add_f32 v[64:65],v[64:65],v[72:73]
v_pk_add_f32 v[66:67],v[66:67],v[74:75]
v_cvt_pk_bf16_f32 v114,v64,v65
v_cvt_pk_bf16_f32 v115,v66,v67
s_nop 1
v_mfma_f32_16x16x32_bf16 v[116:119],v[96:99],v[112:115],0
v_mfma_f32_16x16x32_bf16 v[120:123],v[100:103],v[112:115],0
v_mfma_f32_16x16x32_bf16 v[12:15],v[112:115],v[112:115],0
ds_read_b128 v[48:51],v7 offset:0
ds_read_b128 v[52:55],v7 offset:1024
ds_read_b128 v[56:59],v7 offset:2048
ds_read_b128 v[60:63],v7 offset:3072
ds_read_b128 v[64:67],v7 offset:4096
buffer_store_dwordx4 v[116:119],v3,s[20:23],s94 offen sc1
buffer_store_dwordx4 v[120:123],v3,s[20:23],s94 offen offset:512 sc1
s_nop 0
buffer_store_dwordx4 v[12:15],v3,s[20:23],s94 offen offset:1024 sc1
ds_read_b128 v[68:71],v7 offset:5120
ds_read_b128 v[72:75],v7 offset:6144
ds_read_b128 v[76:79],v7 offset:7168
v_smfmac_f32_16x16x64_bf16 v[84:87],v[16:19],v[216:223],v1
v_smfmac_f32_16x16x64_bf16 v[84:87],v[32:35],v[216:223],v1
v_smfmac_f32_16x16x64_bf16 v[88:91],v[16:19],v[224:231],v1
v_smfmac_f32_16x16x64_bf16 v[88:91],v[32:35],v[224:231],v1
v_smfmac_f32_16x16x64_bf16 v[92:95],v[16:19],v[232:239],v1
v_smfmac_f32_16x16x64_bf16 v[92:95],v[32:35],v[232:239],v1
v_smfmac_f32_16x16x64_bf16 v[80:83],v[20:23],v[240:247],v1
v_smfmac_f32_16x16x64_bf16 v[80:83],v[36:39],v[240:247],v1
v_smfmac_f32_16x16x64_bf16 v[84:87],v[20:23],v[248:255],v1
v_smfmac_f32_16x16x64_bf16 v[84:87],v[36:39],v[248:255],v1
s_waitcnt lgkmcnt(6)
v_smfmac_f32_16x16x64_bf16 v[88:91],v[20:23],v[48:55],v1
v_smfmac_f32_16x16x64_bf16 v[88:91],v[36:39],v[48:55],v1
ds_read_b128 v[48:51],v7 offset:8192
ds_read_b128 v[52:55],v7 offset:9216
s_waitcnt lgkmcnt(6)
v_smfmac_f32_16x16x64_bf16 v[92:95],v[20:23],v[56:63],v1
v_smfmac_f32_16x16x64_bf16 v[92:95],v[36:39],v[56:63],v1
ds_read_b128 v[56:59],v7 offset:10240
ds_read_b128 v[60:63],v7 offset:11264
s_waitcnt lgkmcnt(6)
v_smfmac_f32_16x16x64_bf16 v[80:83],v[24:27],v[64:71],v1
v_smfmac_f32_16x16x64_bf16 v[80:83],v[40:43],v[64:71],v1
ds_read_b128 v[64:67],v7 offset:12288
ds_read_b128 v[68:71],v7 offset:13312
s_waitcnt lgkmcnt(6)
v_smfmac_f32_16x16x64_bf16 v[84:87],v[24:27],v[72:79],v1
v_smfmac_f32_16x16x64_bf16 v[84:87],v[40:43],v[72:79],v1
ds_read_b128 v[72:75],v7 offset:14336
ds_read_b128 v[76:79],v7 offset:15360
s_waitcnt lgkmcnt(6)
v_smfmac_f32_16x16x64_bf16 v[88:91],v[24:27],v[48:55],v1
v_smfmac_f32_16x16x64_bf16 v[88:91],v[40:43],v[48:55],v1
ds_read_b128 v[48:51],v7 offset:16384
ds_read_b128 v[52:55],v7 offset:17408
s_waitcnt lgkmcnt(6)
v_smfmac_f32_16x16x64_bf16 v[92:95],v[24:27],v[56:63],v1
v_smfmac_f32_16x16x64_bf16 v[92:95],v[40:43],v[56:63],v1
ds_read_b128 v[56:59],v7 offset:18432
ds_read_b128 v[60:63],v7 offset:19456
s_waitcnt lgkmcnt(6)
v_smfmac_f32_16x16x64_bf16 v[80:83],v[28:31],v[64:71],v1
v_smfmac_f32_16x16x64_bf16 v[80:83],v[44:47],v[64:71],v1
s_waitcnt lgkmcnt(4)
v_smfmac_f32_16x16x64_bf16 v[84:87],v[28:31],v[72:79],v1
v_smfmac_f32_16x16x64_bf16 v[84:87],v[44:47],v[72:79],v1
s_waitcnt lgkmcnt(2)
v_smfmac_f32_16x16x64_bf16 v[88:91],v[28:31],v[48:55],v1
v_add_f32 v80,v80,v81
v_smfmac_f32_16x16x64_bf16 v[88:91],v[44:47],v[48:55],v1
v_add_f32 v82,v82,v83
s_waitcnt lgkmcnt(0)
v_smfmac_f32_16x16x64_bf16 v[92:95],v[28:31],v[56:63],v1
v_cvt_pk_bf16_f32 v80,v80,v82
v_smfmac_f32_16x16x64_bf16 v[92:95],v[44:47],v[56:63],v1
ds_write_addtid_b32 v80 offset:16896
v_add_f32 v84,v84,v85
v_add_f32 v86,v86,v87
v_cvt_pk_bf16_f32 v84,v84,v86
v_add_f32 v88,v88,v89
v_add_f32 v90,v90,v91
v_cvt_pk_bf16_f32 v88,v88,v90
s_nop 0
v_add_f32 v92,v92,v93
v_add_f32 v94,v94,v95
v_cvt_pk_bf16_f32 v92,v92,v94
ds_write_addtid_b32 v84 offset:17920
ds_write_addtid_b32 v88 offset:18944
ds_write_addtid_b32 v92 offset:19968
s_waitcnt lgkmcnt(0)
s_barrier
ds_read_b128 v[48:51],v7 offset:20480
ds_read_b128 v[52:55],v7 offset:21504
ds_read_b128 v[56:59],v7 offset:22528
ds_read_b128 v[60:63],v7 offset:23552
ds_read_b128 v[64:67],v7 offset:24576
ds_read_b128 v[68:71],v7 offset:25600
ds_read_b128 v[72:75],v7 offset:26624
ds_read_b128 v[76:79],v7 offset:27648
ds_read_b128 v[80:83],v7 offset:28672
ds_read_b128 v[84:87],v7 offset:29696
ds_read_b128 v[88:91],v7 offset:30720
ds_read_b128 v[92:95],v7 offset:31744
s_add_u32 s65,s76,s100
s_add_u32 s66,s75,s100
s_add_u32 s64,s71,s100
s_cmp_eq_u32 s50,2
s_cselect_b32 s66,s66,s64
buffer_store_dwordx4 v[8:11],v0,s[20:23],s65 offen sc1
s_cmp_eq_u32 s50,2
s_cselect_b32 exec_hi,-1,0
buffer_store_dwordx4 v[8:11],v0,s[20:23],s66 offen sc1
s_mov_b32 exec_hi,0
buffer_store_dwordx4 v[8:11],v0,s[20:23],s65 offen offset:1024 sc1
s_mov_b64 exec,-1
v_mov_b32 v96,0
v_mov_b32 v97,0
v_mov_b32 v98,0
v_mov_b32 v99,0
v_mov_b32 v100,0
v_mov_b32 v101,0
v_mov_b32 v102,0
v_mov_b32 v103,0
s_barrier
s_nop 15
s_nop 15
s_nop 7
buffer_load_dwordx4 v[16:19],v0,s[20:23],s96 offen offset:0 sc1
s_add_u32 s79,s79,1
s_and_b32 s64,s79,3
s_lshl_b32 s64,s64,19
s_lshl_b32 s65,s79,8
s_and_b32 s65,s65,0x2000
s_lshl_b32 s66,s79,16
s_xor_b32 s88,s73,s65
s_add_u32 s88,s88,s66
buffer_load_dwordx4 v[20:23],v0,s[20:23],s96 offen offset:1024 sc1
s_sub_u32 s88,s88,s54
s_add_u32 s89,s71,s64
s_add_u32 s92,s70,s64
s_xor_b32 s93,s72,s65
s_add_u32 s93,s93,s66
s_add_u32 s94,s76,s64
s_add_u32 s95,s94,4096
s_add_u32 s98,s75,s64
buffer_load_dwordx4 v[24:27],v0,s[20:23],s96 offen offset:2048 sc1
s_add_u32 s60,s74,s64
s_nop 6
buffer_load_dwordx4 v[28:31],v0,s[20:23],s96 offen offset:3072 sc1
s_nop 7
buffer_load_dwordx4 v[32:35],v0,s[20:23],s97 offen offset:0 sc1
s_nop 7
buffer_load_dwordx4 v[36:39],v0,s[20:23],s97 offen offset:1024 sc1
s_nop 7
buffer_load_dwordx4 v[40:43],v0,s[20:23],s97 offen offset:2048 sc1
s_nop 7
buffer_load_dwordx4 v[44:47],v0,s[20:23],s97 offen offset:3072 sc1
ogo_100690:
s_waitcnt lgkmcnt(0)
s_waitcnt vmcnt(6)
v_max3_u32 v124,v16,v17,v18
v_max3_u32 v124,v124,v19,v20
v_max3_u32 v124,v124,v21,v22
v_max_u32 v124,v124,v23
v_cmp_eq_u32 vcc,-1,v124
s_cbranch_vccnz of_100695
v_smfmac_f32_16x16x64_bf16 v[96:99],v[16:19],v[48:55],v1
v_smfmac_f32_16x16x64_bf16 v[100:103],v[16:19],v[56:63],v1
v_smfmac_f32_16x16x64_bf16 v[96:99],v[20:23],v[64:71],v1
v_smfmac_f32_16x16x64_bf16 v[100:103],v[20:23],v[72:79],v1
v_readfirstlane_b32 s91,v126
s_waitcnt vmcnt(4)
v_max3_u32 v124,v24,v25,v26
v_max3_u32 v124,v124,v27,v28
v_max3_u32 v124,v124,v29,v30
v_max_u32 v124,v124,v31
v_cmp_eq_u32 vcc,-1,v124
s_cbranch_vccnz of_100696
v_smfmac_f32_16x16x64_bf16 v[96:99],v[24:27],v[80:87],v1
v_smfmac_f32_16x16x64_bf16 v[100:103],v[24:27],v[88:95],v1
v_smfmac_f32_16x16x64_bf16 v[96:99],v[28:31],v[128:135],v1
v_smfmac_f32_16x16x64_bf16 v[100:103],v[28:31],v[136:143],v1
s_waitcnt vmcnt(2)
v_max3_u32 v124,v32,v33,v34
v_max3_u32 v124,v124,v35,v36
v_max3_u32 v124,v124,v37,v38
v_max_u32 v124,v124,v39
v_cmp_eq_u32 vcc,-1,v124
s_cbranch_vccnz of_100697
v_smfmac_f32_16x16x64_bf16 v[96:99],v[32:35],v[144:151],v1
v_smfmac_f32_16x16x64_bf16 v[100:103],v[32:35],v[152:159],v1
v_smfmac_f32_16x16x64_bf16 v[96:99],v[36:39],v[160:167],v1
v_smfmac_f32_16x16x64_bf16 v[100:103],v[36:39],v[168:175],v1
s_waitcnt vmcnt(1)
v_max3_u32 v124,v40,v41,v42
v_max_u32 v124,v124,v43
v_cmp_eq_u32 vcc,-1,v124
s_cbranch_vccnz of_100698
v_smfmac_f32_16x16x64_bf16 v[96:99],v[40:43],v[176:183],v1
v_smfmac_f32_16x16x64_bf16 v[100:103],v[40:43],v[184:191],v1
s_waitcnt vmcnt(0)
v_max3_u32 v124,v44,v45,v46
v_max_u32 v124,v124,v47
v_cmp_eq_u32 vcc,-1,v124
s_cbranch_vccnz of_100699
v_smfmac_f32_16x16x64_bf16 v[96:99],v[44:47],v[192:199],v1
v_smfmac_f32_16x16x64_bf16 v[100:103],v[44:47],v[200:207],v1
oback_100706:
s_nop 4
v_add_f32 v96,v96,v97
v_add_f32 v98,v98,v99
s_nop 0
v_add_f32 v100,v100,v101
v_add_f32 v102,v102,v103
ds_write_addtid_b32 v96 offset:20992
ds_write_addtid_b32 v98 offset:23072
ds_write_addtid_b32 v100 offset:22016
ds_write_addtid_b32 v102 offset:24096
s_mov_b32 s96,s60
s_add_u32 s97,s60,4096
s_cmp_gt_u32 s50,1
s_waitcnt lgkmcnt(0)
s_barrier
s_cbranch_scc1 loop_100645
ds_read2st64_b32 v[48:49],v4 offset0:82 offset1:86
ds_read2st64_b32 v[50:51],v4 offset0:83 offset1:87
ds_read2st64_b32 v[52:53],v4 offset0:84 offset1:88
ds_read2st64_b32 v[54:55],v4 offset0:85 offset1:89
v_mov_b32 v96,v104
v_mov_b32 v97,v105
v_mov_b32 v98,v106
v_mov_b32 v99,v107
v_mov_b32 v100,v108
v_mov_b32 v101,v109
v_mov_b32 v102,v110
v_mov_b32 v103,v111
s_waitcnt lgkmcnt(2)
v_pk_add_f32 v[48:49],v[48:49],v[50:51]
s_waitcnt lgkmcnt(0)
v_pk_add_f32 v[52:53],v[52:53],v[54:55]
v_pk_add_f32 v[48:49],v[48:49],v[52:53]
v_cvt_pk_bf16_f32 v124,v48,v49
buffer_store_dword v124,v127,s[20:23],s89 offen sc1
s_nop 7
buffer_store_dword v124,v127,s[20:23],s88 offen sc1
s_branch loop0_100649x
last_100646:
s_waitcnt vmcnt(3)
v_max3_u32 v124,v16,v17,v18
v_max_u32 v124,v124,v19
v_cmp_eq_u32 vcc,-1,v124
v_cndmask_b32 v120,2.0,v0,s[82:83]
v_cndmask_b32 v121,2.0,v127,s[86:87]
s_cbranch_vccnz flb_100731
seg_100707:
segb_100715:
v_smfmac_f32_16x16x64_bf16 v[64:67],v[16:19],a[32:39],v1
buffer_load_dword v125,off,s[20:23],s92 sc1
buffer_load_dwordx4 v[32:35],v0,s[20:23],s93 offen offset:0 sc1
s_waitcnt vmcnt(4)
v_max3_u32 v124,v20,v21,v22
v_smfmac_f32_16x16x64_bf16 v[68:71],v[16:19],a[40:47],v1
v_max_u32 v124,v124,v23
v_cmp_eq_u32 vcc,-1,v124
v_smfmac_f32_16x16x64_bf16 v[72:75],v[16:19],a[48:55],v1
v_smfmac_f32_16x16x64_bf16 v[76:79],v[16:19],a[56:63],v1
s_cbranch_vccnz fl_100724
seg_100708:
segb_100716:
v_smfmac_f32_16x16x64_bf16 v[64:67],v[20:23],a[96:103],v1
buffer_load_dword v125,off,s[20:23],s92 sc1
buffer_load_dwordx4 v[36:39],v0,s[20:23],s93 offen offset:1024 sc1
s_waitcnt vmcnt(5)
v_max3_u32 v124,v24,v25,v26
v_smfmac_f32_16x16x64_bf16 v[68:71],v[20:23],a[104:111],v1
v_max_u32 v124,v124,v27
v_cmp_eq_u32 vcc,-1,v124
v_smfmac_f32_16x16x64_bf16 v[72:75],v[20:23],a[112:119],v1
v_smfmac_f32_16x16x64_bf16 v[76:79],v[20:23],a[120:127],v1
s_cbranch_vccnz fl_100725
seg_100709:
segb_100717:
v_smfmac_f32_16x16x64_bf16 v[64:67],v[24:27],a[160:167],v1
buffer_load_dword v125,off,s[20:23],s92 sc1
buffer_load_dwordx4 v[40:43],v0,s[20:23],s93 offen offset:2048 sc1
buffer_load_dwordx4 v[44:47],v0,s[20:23],s93 offen offset:3072 sc1
s_waitcnt vmcnt(7)
v_max3_u32 v124,v28,v29,v30
v_smfmac_f32_16x16x64_bf16 v[68:71],v[24:27],a[168:175],v1
v_max_u32 v124,v124,v31
v_cmp_eq_u32 vcc,-1,v124
v_smfmac_f32_16x16x64_bf16 v[72:75],v[24:27],a[176:183],v1
v_smfmac_f32_16x16x64_bf16 v[76:79],v[24:27],a[184:191],v1
s_cbranch_vccnz fl_100726
seg_100710:
segb_100718:
v_smfmac_f32_16x16x64_bf16 v[64:67],v[28:31],a[224:231],v1
buffer_load_dword v125,off,s[20:23],s92 sc1
s_waitcnt vmcnt(6)
v_max3_u32 v124,v32,v33,v34
v_smfmac_f32_16x16x64_bf16 v[68:71],v[28:31],a[232:239],v1
v_max_u32 v124,v124,v35
v_cmp_eq_u32 vcc,-1,v124
v_smfmac_f32_16x16x64_bf16 v[72:75],v[28:31],a[240:247],v1
v_smfmac_f32_16x16x64_bf16 v[76:79],v[28:31],a[248:255],v1
s_cbranch_vccnz fl_100727
seg_100711:
segb_100719:
v_smfmac_f32_16x16x64_bf16 v[64:67],v[32:35],a[32:39],v1
buffer_load_dword v125,off,s[20:23],s92 sc1
buffer_store_dwordx4 v[112:115],v120,s[20:23],s101 offen sc1
buffer_store_dword v126,v121,s[20:23],s69 offen sc1
s_waitcnt vmcnt(7)
v_max3_u32 v124,v36,v37,v38
v_smfmac_f32_16x16x64_bf16 v[68:71],v[32:35],a[40:47],v1
v_max_u32 v124,v124,v39
v_cmp_eq_u32 vcc,-1,v124
v_smfmac_f32_16x16x64_bf16 v[72:75],v[32:35],a[48:55],v1
v_smfmac_f32_16x16x64_bf16 v[76:79],v[32:35],a[56:63],v1
s_cbranch_vccnz fl_100728
seg_100712:
segb_100720:
v_smfmac_f32_16x16x64_bf16 v[64:67],v[36:39],a[96:103],v1
buffer_load_dword v125,off,s[20:23],s92 sc1
s_waitcnt vmcnt(5)
v_max3_u32 v124,v40,v41,v42
v_smfmac_f32_16x16x64_bf16 v[68:71],v[36:39],a[104:111],v1
v_max3_u32 v124,v124,v43,v44
v_max3_u32 v124,v124,v45,v46
v_max_u32 v124,v124,v47
v_cmp_eq_u32 vcc,-1,v124
v_smfmac_f32_16x16x64_bf16 v[72:75],v[36:39],a[112:119],v1
v_smfmac_f32_16x16x64_bf16 v[76:79],v[36:39],a[120:127],v1
s_cbranch_vccnz fl_100729
seg_100713:
segb_100721:
v_smfmac_f32_16x16x64_bf16 v[64:67],v[40:43],a[160:167],v1
v_smfmac_f32_16x16x64_bf16 v[68:71],v[40:43],a[168:175],v1
v_smfmac_f32_16x16x64_bf16 v[64:67],v[44:47],a[224:231],v1
v_smfmac_f32_16x16x64_bf16 v[68:71],v[44:47],a[232:239],v1
v_smfmac_f32_16x16x64_bf16 v[72:75],v[40:43],a[176:183],v1
s_nop 1
v_add_f32 v64,v64,v65
v_smfmac_f32_16x16x64_bf16 v[76:79],v[40:43],a[184:191],v1
ds_write_addtid_b32 v64 offset:8448
v_add_f32 v66,v66,v67
v_smfmac_f32_16x16x64_bf16 v[72:75],v[44:47],a[240:247],v1
ds_write_addtid_b32 v66 offset:9488
v_add_f32 v68,v68,v69
v_smfmac_f32_16x16x64_bf16 v[76:79],v[44:47],a[248:255],v1
ds_write_addtid_b32 v68 offset:10528
v_add_f32 v70,v70,v71
v_smfmac_f32_16x16x64_bf16 v[80:83],v[16:19],v[208:215],v1
ds_write_addtid_b32 v70 offset:11568
v_add_f32 v72,v72,v73
v_smfmac_f32_16x16x64_bf16 v[80:83],v[32:35],v[208:215],v1
ds_write_addtid_b32 v72 offset:12608
v_add_f32 v74,v74,v75
v_smfmac_f32_16x16x64_bf16 v[84:87],v[16:19],v[216:223],v1
ds_write_addtid_b32 v74 offset:13648
v_add_f32 v76,v76,v77
v_smfmac_f32_16x16x64_bf16 v[84:87],v[32:35],v[216:223],v1
ds_write_addtid_b32 v76 offset:14688
v_add_f32 v78,v78,v79
v_smfmac_f32_16x16x64_bf16 v[88:91],v[16:19],v[224:231],v1
ds_write_addtid_b32 v78 offset:15728
v_smfmac_f32_16x16x64_bf16 v[88:91],v[32:35],v[224:231],v1
v_smfmac_f32_16x16x64_bf16 v[92:95],v[16:19],v[232:239],v1
v_smfmac_f32_16x16x64_bf16 v[92:95],v[32:35],v[232:239],v1
doneA_100740:
s_waitcnt vmcnt(0) lgkmcnt(0)
s_add_u32 s64,s79,0
s_lshl_b32 s65,s64,12
s_and_b32 s65,s65,0x2000
s_xor_b32 s65,s65,s67
s_lshl_b32 s64,s64,20
s_add_u32 s65,s65,s64
s_add_u32 s101,s65,s78
v_smfmac_f32_16x16x64_bf16 v[80:83],v[20:23],v[240:247],v1
ds_read_b128 v[48:51],v7 offset:0
ds_read_b128 v[52:55],v7 offset:1024
v_smfmac_f32_16x16x64_bf16 v[80:83],v[36:39],v[240:247],v1
ds_read_b128 v[56:59],v7 offset:2048
ds_read_b128 v[60:63],v7 offset:3072
v_smfmac_f32_16x16x64_bf16 v[84:87],v[20:23],v[248:255],v1
ds_read_b128 v[64:67],v7 offset:4096
ds_read_b128 v[68:71],v7 offset:5120
v_smfmac_f32_16x16x64_bf16 v[84:87],v[36:39],v[248:255],v1
ds_read_b128 v[72:75],v7 offset:6144
ds_read_b128 v[76:79],v7 offset:7168
s_waitcnt lgkmcnt(6)
v_smfmac_f32_16x16x64_bf16 v[88:91],v[20:23],v[48:55],v1
v_smfmac_f32_16x16x64_bf16 v[88:91],v[36:39],v[48:55],v1
ds_read_b128 v[48:51],v7 offset:8192
ds_read_b128 v[52:55],v7 offset:9216
s_waitcnt lgkmcnt(6)
v_smfmac_f32_16x16x64_bf16 v[92:95],v[20:23],v[56:63],v1
v_smfmac_f32_16x16x64_bf16 v[92:95],v[36:39],v[56:63],v1
ds_read_b128 v[56:59],v7 offset:10240
ds_read_b128 v[60:63],v7 offset:11264
s_waitcnt lgkmcnt(6)
v_smfmac_f32_16x16x64_bf16 v[80:83],v[24:27],v[64:71],v1
v_smfmac_f32_16x16x64_bf16 v[80:83],v[40:43],v[64:71],v1
ds_read_b128 v[64:67],v7 offset:12288
ds_read_b128 v[68:71],v7 offset:13312
s_waitcnt lgkmcnt(6)
v_smfmac_f32_16x16x64_bf16 v[84:87],v[24:27],v[72:79],v1
v_smfmac_f32_16x16x64_bf16 v[84:87],v[40:43],v[72:79],v1
ds_read_b128 v[72:75],v7 offset:14336
ds_read_b128 v[76:79],v7 offset:15360
s_waitcnt lgkmcnt(6)
v_smfmac_f32_16x16x64_bf16 v[88:91],v[24:27],v[48:55],v1
v_smfmac_f32_16x16x64_bf16 v[88:91],v[40:43],v[48:55],v1
ds_read_b128 v[48:51],v7 offset:16384
ds_read_b128 v[52:55],v7 offset:17408
s_waitcnt lgkmcnt(6)
v_smfmac_f32_16x16x64_bf16 v[92:95],v[24:27],v[56:63],v1
v_smfmac_f32_16x16x64_bf16 v[92:95],v[40:43],v[56:63],v1
ds_read_b128 v[56:59],v7 offset:18432
ds_read_b128 v[60:63],v7 offset:19456
s_waitcnt lgkmcnt(6)
v_smfmac_f32_16x16x64_bf16 v[80:83],v[28:31],v[64:71],v1
v_smfmac_f32_16x16x64_bf16 v[80:83],v[44:47],v[64:71],v1
s_waitcnt lgkmcnt(4)
v_smfmac_f32_16x16x64_bf16 v[84:87],v[28:31],v[72:79],v1
v_smfmac_f32_16x16x64_bf16 v[84:87],v[44:47],v[72:79],v1
s_waitcnt lgkmcnt(2)
v_smfmac_f32_16x16x64_bf16 v[88:91],v[28:31],v[48:55],v1
v_add_f32 v80,v80,v81
v_smfmac_f32_16x16x64_bf16 v[88:91],v[44:47],v[48:55],v1
v_add_f32 v82,v82,v83
s_waitcnt lgkmcnt(0)
v_smfmac_f32_16x16x64_bf16 v[92:95],v[28:31],v[56:63],v1
v_cvt_pk_bf16_f32 v80,v80,v82
v_smfmac_f32_16x16x64_bf16 v[92:95],v[44:47],v[56:63],v1
ds_write_addtid_b32 v80 offset:16896
v_add_f32 v84,v84,v85
v_add_f32 v86,v86,v87
v_cvt_pk_bf16_f32 v84,v84,v86
v_add_f32 v88,v88,v89
v_add_f32 v90,v90,v91
v_cvt_pk_bf16_f32 v88,v88,v90
s_nop 0
v_add_f32 v92,v92,v93
v_add_f32 v94,v94,v95
v_cvt_pk_bf16_f32 v92,v92,v94
ds_write_addtid_b32 v84 offset:17920
ds_write_addtid_b32 v88 offset:18944
ds_write_addtid_b32 v92 offset:19968
s_waitcnt lgkmcnt(0)
s_barrier
s_cmp_gt_u32 s50,1
s_cbranch_scc1 l23_100741
ds_read2st64_b32 v[112:113],v127 offset0:66 offset1:67
ds_read2st64_b32 v[114:115],v127 offset0:68 offset1:69
ds_read2st64_b32 v[116:117],v127 offset0:70 offset1:71
ds_read2st64_b32 v[118:119],v127 offset0:72 offset1:73
s_waitcnt lgkmcnt(0)
v_mov_b32 v120,v5
v_mov_b32 v121,v5
v_mov_b32 v122,v5
v_mov_b32 v123,v5
s_nop 1
v_mfma_f32_16x16x32_bf16 v[112:115],v[120:123],v[112:115],0
v_mfma_f32_16x16x32_bf16 v[116:119],v[120:123],v[116:119],0
s_nop 4
v_cvt_pk_bf16_f32 v112,v112,v113
v_cvt_pk_bf16_f32 v113,v114,v115
s_nop 0
v_cvt_pk_bf16_f32 v114,v116,v117
v_cvt_pk_bf16_f32 v115,v118,v119
s_branch lj_100742
l23_100741:
ds_read_b128 v[48:51],v2 offset:0
ds_read_b128 v[52:55],v2 offset:256
ds_read_b128 v[56:59],v2 offset:512
ds_read_b128 v[60:63],v2 offset:768
ds_read_b128 v[64:67],v2 offset:16
ds_read_b128 v[68:71],v2 offset:272
ds_read_b128 v[72:75],v2 offset:528
ds_read_b128 v[76:79],v2 offset:784
s_waitcnt lgkmcnt(6)
v_pk_add_f32 v[48:49],v[48:49],v[52:53]
v_pk_add_f32 v[50:51],v[50:51],v[54:55]
s_waitcnt lgkmcnt(4)
v_pk_add_f32 v[56:57],v[56:57],v[60:61]
v_pk_add_f32 v[58:59],v[58:59],v[62:63]
v_pk_add_f32 v[48:49],v[48:49],v[56:57]
v_pk_add_f32 v[50:51],v[50:51],v[58:59]
v_cvt_pk_bf16_f32 v112,v48,v49
v_cvt_pk_bf16_f32 v113,v50,v51
s_waitcnt lgkmcnt(2)
v_pk_add_f32 v[64:65],v[64:65],v[68:69]
v_pk_add_f32 v[66:67],v[66:67],v[70:71]
s_waitcnt lgkmcnt(0)
v_pk_add_f32 v[72:73],v[72:73],v[76:77]
v_pk_add_f32 v[74:75],v[74:75],v[78:79]
v_pk_add_f32 v[64:65],v[64:65],v[72:73]
v_pk_add_f32 v[66:67],v[66:67],v[74:75]
v_cvt_pk_bf16_f32 v114,v64,v65
v_cvt_pk_bf16_f32 v115,v66,v67
lj_100742:
v_cndmask_b32 v120,2.0,v0,s[82:83]
v_cndmask_b32 v121,2.0,v127,s[86:87]
buffer_store_dwordx4 v[112:115],v120,s[20:23],s101 offen sc1
s_waitcnt vmcnt(0)
s_barrier
v_mov_b32 v126,64
buffer_store_dword v126,v121,s[20:23],s69 offen sc1
s_branch recfin_100248
flp_100651:
buffer_load_dword v124,off,s[20:23],s68 sc1
s_waitcnt vmcnt(0)
v_readfirstlane_b32 s91,v124
s_cmp_gt_u32 s91,s64
s_cbranch_scc1 fok_100650
s_sleep 2
s_sub_u32 s90,s90,1
s_cmp_gt_i32 s90,0
s_cbranch_scc1 flp_100651
s_branch fok_100650
flp_100654:
buffer_load_dword v124,off,s[20:23],s68 sc1
s_waitcnt vmcnt(0)
v_readfirstlane_b32 s91,v124
s_cmp_gt_u32 s91,s64
s_cbranch_scc1 fok_100653
s_sleep 2
s_sub_u32 s90,s90,1
s_cmp_gt_i32 s90,0
s_cbranch_scc1 flp_100654
s_branch fok_100653
fl_100671:
flb_100679:
buffer_load_dwordx4 v[16:19],v0,s[20:23],s92 offen offset:0 sc1
s_mov_b32 s55,1
buffer_load_dwordx4 v[32:35],v0,s[20:23],s93 offen offset:0 sc1
s_waitcnt vmcnt(4)
v_max3_u32 v124,v20,v21,v22
v_max_u32 v124,v124,v23
v_cmp_eq_u32 vcc,-1,v124
s_cbranch_vccnz dfl_100743
v_smfmac_f32_16x16x64_bf16 v[48:51],v[20:23],a[64:71],v1
buffer_load_dword v125,off,s[20:23],s92 sc1
v_smfmac_f32_16x16x64_bf16 v[52:55],v[20:23],a[72:79],v1
buffer_load_dwordx4 v[36:39],v0,s[20:23],s93 offen offset:1024 sc1
v_smfmac_f32_16x16x64_bf16 v[56:59],v[20:23],a[80:87],v1
s_waitcnt vmcnt(5)
v_max3_u32 v124,v24,v25,v26
v_smfmac_f32_16x16x64_bf16 v[60:63],v[20:23],a[88:95],v1
v_max_u32 v124,v124,v27
v_smfmac_f32_16x16x64_bf16 v[64:67],v[20:23],a[96:103],v1
v_cmp_eq_u32 vcc,-1,v124
v_smfmac_f32_16x16x64_bf16 v[68:71],v[20:23],a[104:111],v1
v_smfmac_f32_16x16x64_bf16 v[72:75],v[20:23],a[112:119],v1
v_smfmac_f32_16x16x64_bf16 v[76:79],v[20:23],a[120:127],v1
s_cbranch_vccnz dfl_100744
v_smfmac_f32_16x16x64_bf16 v[48:51],v[24:27],a[128:135],v1
buffer_load_dword v125,off,s[20:23],s92 sc1
v_smfmac_f32_16x16x64_bf16 v[52:55],v[24:27],a[136:143],v1
buffer_load_dwordx4 v[40:43],v0,s[20:23],s93 offen offset:2048 sc1
v_smfmac_f32_16x16x64_bf16 v[56:59],v[24:27],a[144:151],v1
buffer_load_dwordx4 v[44:47],v0,s[20:23],s93 offen offset:3072 sc1
s_waitcnt vmcnt(7)
v_max3_u32 v124,v28,v29,v30
v_smfmac_f32_16x16x64_bf16 v[60:63],v[24:27],a[152:159],v1
v_max_u32 v124,v124,v31
v_smfmac_f32_16x16x64_bf16 v[64:67],v[24:27],a[160:167],v1
v_cmp_eq_u32 vcc,-1,v124
v_smfmac_f32_16x16x64_bf16 v[68:71],v[24:27],a[168:175],v1
v_smfmac_f32_16x16x64_bf16 v[72:75],v[24:27],a[176:183],v1
v_smfmac_f32_16x16x64_bf16 v[76:79],v[24:27],a[184:191],v1
s_cbranch_vccnz dfl_100745
v_smfmac_f32_16x16x64_bf16 v[48:51],v[28:31],a[192:199],v1
buffer_load_dword v125,off,s[20:23],s92 sc1
v_smfmac_f32_16x16x64_bf16 v[52:55],v[28:31],a[200:207],v1
v_smfmac_f32_16x16x64_bf16 v[56:59],v[28:31],a[208:215],v1
s_waitcnt vmcnt(7)
v_max3_u32 v124,v16,v17,v18
v_smfmac_f32_16x16x64_bf16 v[60:63],v[28:31],a[216:223],v1
v_max_u32 v124,v124,v19
v_smfmac_f32_16x16x64_bf16 v[64:67],v[28:31],a[224:231],v1
v_cmp_eq_u32 vcc,-1,v124
v_smfmac_f32_16x16x64_bf16 v[68:71],v[28:31],a[232:239],v1
v_smfmac_f32_16x16x64_bf16 v[72:75],v[28:31],a[240:247],v1
v_smfmac_f32_16x16x64_bf16 v[76:79],v[28:31],a[248:255],v1
s_cbranch_vccnz lfb_100750
s_mov_b32 s55,0
v_smfmac_f32_16x16x64_bf16 v[48:51],v[16:19],a[0:7],v1
v_smfmac_f32_16x16x64_bf16 v[52:55],v[16:19],a[8:15],v1
v_smfmac_f32_16x16x64_bf16 v[56:59],v[16:19],a[16:23],v1
s_waitcnt vmcnt(6)
v_max3_u32 v124,v32,v33,v34
v_max_u32 v124,v124,v35
v_cmp_eq_u32 vcc,-1,v124
v_smfmac_f32_16x16x64_bf16 v[60:63],v[16:19],a[24:31],v1
v_smfmac_f32_16x16x64_bf16 v[64:67],v[16:19],a[32:39],v1
v_smfmac_f32_16x16x64_bf16 v[68:71],v[16:19],a[40:47],v1
v_smfmac_f32_16x16x64_bf16 v[72:75],v[16:19],a[48:55],v1
v_smfmac_f32_16x16x64_bf16 v[76:79],v[16:19],a[56:63],v1
s_cbranch_vccnz flb_100683
s_branch segb_100667
fl_100672:
v_smfmac_f32_16x16x64_bf16 v[76:79],v[16:19],a[56:63],v1
flb_100680:
buffer_load_dwordx4 v[20:23],v0,s[20:23],s92 offen offset:1024 sc1
s_mov_b32 s55,2
buffer_load_dwordx4 v[36:39],v0,s[20:23],s93 offen offset:1024 sc1
s_waitcnt vmcnt(5)
v_max3_u32 v124,v24,v25,v26
v_max_u32 v124,v124,v27
v_cmp_eq_u32 vcc,-1,v124
s_cbranch_vccnz dfl_100744
v_smfmac_f32_16x16x64_bf16 v[48:51],v[24:27],a[128:135],v1
buffer_load_dword v125,off,s[20:23],s92 sc1
v_smfmac_f32_16x16x64_bf16 v[52:55],v[24:27],a[136:143],v1
buffer_load_dwordx4 v[40:43],v0,s[20:23],s93 offen offset:2048 sc1
v_smfmac_f32_16x16x64_bf16 v[56:59],v[24:27],a[144:151],v1
buffer_load_dwordx4 v[44:47],v0,s[20:23],s93 offen offset:3072 sc1
s_waitcnt vmcnt(7)
v_max3_u32 v124,v28,v29,v30
v_smfmac_f32_16x16x64_bf16 v[60:63],v[24:27],a[152:159],v1
v_max_u32 v124,v124,v31
v_smfmac_f32_16x16x64_bf16 v[64:67],v[24:27],a[160:167],v1
v_cmp_eq_u32 vcc,-1,v124
v_smfmac_f32_16x16x64_bf16 v[68:71],v[24:27],a[168:175],v1
v_smfmac_f32_16x16x64_bf16 v[72:75],v[24:27],a[176:183],v1
v_smfmac_f32_16x16x64_bf16 v[76:79],v[24:27],a[184:191],v1
s_cbranch_vccnz dfl_100745
v_smfmac_f32_16x16x64_bf16 v[48:51],v[28:31],a[192:199],v1
buffer_load_dword v125,off,s[20:23],s92 sc1
v_smfmac_f32_16x16x64_bf16 v[52:55],v[28:31],a[200:207],v1
v_smfmac_f32_16x16x64_bf16 v[56:59],v[28:31],a[208:215],v1
s_waitcnt vmcnt(5)
v_max3_u32 v124,v20,v21,v22
v_smfmac_f32_16x16x64_bf16 v[60:63],v[28:31],a[216:223],v1
v_max_u32 v124,v124,v23
v_smfmac_f32_16x16x64_bf16 v[64:67],v[28:31],a[224:231],v1
v_cmp_eq_u32 vcc,-1,v124
v_smfmac_f32_16x16x64_bf16 v[68:71],v[28:31],a[232:239],v1
v_smfmac_f32_16x16x64_bf16 v[72:75],v[28:31],a[240:247],v1
v_smfmac_f32_16x16x64_bf16 v[76:79],v[28:31],a[248:255],v1
s_cbranch_vccnz lfb_100750
s_mov_b32 s55,0
v_smfmac_f32_16x16x64_bf16 v[48:51],v[20:23],a[64:71],v1
v_smfmac_f32_16x16x64_bf16 v[52:55],v[20:23],a[72:79],v1
v_smfmac_f32_16x16x64_bf16 v[56:59],v[20:23],a[80:87],v1
s_waitcnt vmcnt(6)
v_max3_u32 v124,v32,v33,v34
v_max_u32 v124,v124,v35
v_cmp_eq_u32 vcc,-1,v124
v_smfmac_f32_16x16x64_bf16 v[60:63],v[20:23],a[88:95],v1
v_smfmac_f32_16x16x64_bf16 v[64:67],v[20:23],a[96:103],v1
v_smfmac_f32_16x16x64_bf16 v[68:71],v[20:23],a[104:111],v1
v_smfmac_f32_16x16x64_bf16 v[72:75],v[20:23],a[112:119],v1
v_smfmac_f32_16x16x64_bf16 v[76:79],v[20:23],a[120:127],v1
s_cbranch_vccnz flb_100683
s_branch segb_100667
fl_100673:
v_smfmac_f32_16x16x64_bf16 v[76:79],v[20:23],a[120:127],v1
flb_100681:
buffer_load_dwordx4 v[24:27],v0,s[20:23],s92 offen offset:2048 sc1
s_mov_b32 s55,4
buffer_load_dwordx4 v[40:43],v0,s[20:23],s93 offen offset:2048 sc1
buffer_load_dwordx4 v[44:47],v0,s[20:23],s93 offen offset:3072 sc1
s_waitcnt vmcnt(7)
v_max3_u32 v124,v28,v29,v30
v_max_u32 v124,v124,v31
v_cmp_eq_u32 vcc,-1,v124
s_cbranch_vccnz dfl_100745
v_smfmac_f32_16x16x64_bf16 v[48:51],v[28:31],a[192:199],v1
buffer_load_dword v125,off,s[20:23],s92 sc1
v_smfmac_f32_16x16x64_bf16 v[52:55],v[28:31],a[200:207],v1
v_smfmac_f32_16x16x64_bf16 v[56:59],v[28:31],a[208:215],v1
s_waitcnt vmcnt(3)
v_max3_u32 v124,v24,v25,v26
v_smfmac_f32_16x16x64_bf16 v[60:63],v[28:31],a[216:223],v1
v_max_u32 v124,v124,v27
v_smfmac_f32_16x16x64_bf16 v[64:67],v[28:31],a[224:231],v1
v_cmp_eq_u32 vcc,-1,v124
v_smfmac_f32_16x16x64_bf16 v[68:71],v[28:31],a[232:239],v1
v_smfmac_f32_16x16x64_bf16 v[72:75],v[28:31],a[240:247],v1
v_smfmac_f32_16x16x64_bf16 v[76:79],v[28:31],a[248:255],v1
s_cbranch_vccnz lfb_100750
s_mov_b32 s55,0
v_smfmac_f32_16x16x64_bf16 v[48:51],v[24:27],a[128:135],v1
v_smfmac_f32_16x16x64_bf16 v[52:55],v[24:27],a[136:143],v1
v_smfmac_f32_16x16x64_bf16 v[56:59],v[24:27],a[144:151],v1
s_waitcnt vmcnt(6)
v_max3_u32 v124,v32,v33,v34
v_max_u32 v124,v124,v35
v_cmp_eq_u32 vcc,-1,v124
v_smfmac_f32_16x16x64_bf16 v[60:63],v[24:27],a[152:159],v1
v_smfmac_f32_16x16x64_bf16 v[64:67],v[24:27],a[160:167],v1
v_smfmac_f32_16x16x64_bf16 v[68:71],v[24:27],a[168:175],v1
v_smfmac_f32_16x16x64_bf16 v[72:75],v[24:27],a[176:183],v1
v_smfmac_f32_16x16x64_bf16 v[76:79],v[24:27],a[184:191],v1
s_cbranch_vccnz flb_100683
s_branch segb_100667
fl_100674:
v_smfmac_f32_16x16x64_bf16 v[76:79],v[24:27],a[184:191],v1
flb_100682:
buffer_load_dwordx4 v[28:31],v0,s[20:23],s92 offen offset:3072 sc1
s_mov_b32 s55,8
s_waitcnt vmcnt(0)
v_max3_u32 v124,v28,v29,v30
v_max_u32 v124,v124,v31
v_cmp_eq_u32 vcc,-1,v124
s_cbranch_vccnz lfb_100750
s_mov_b32 s55,0
v_smfmac_f32_16x16x64_bf16 v[48:51],v[28:31],a[192:199],v1
v_smfmac_f32_16x16x64_bf16 v[52:55],v[28:31],a[200:207],v1
v_smfmac_f32_16x16x64_bf16 v[56:59],v[28:31],a[208:215],v1
s_waitcnt vmcnt(6)
v_max3_u32 v124,v32,v33,v34
v_max_u32 v124,v124,v35
v_cmp_eq_u32 vcc,-1,v124
v_smfmac_f32_16x16x64_bf16 v[60:63],v[28:31],a[216:223],v1
v_smfmac_f32_16x16x64_bf16 v[64:67],v[28:31],a[224:231],v1
v_smfmac_f32_16x16x64_bf16 v[68:71],v[28:31],a[232:239],v1
v_smfmac_f32_16x16x64_bf16 v[72:75],v[28:31],a[240:247],v1
v_smfmac_f32_16x16x64_bf16 v[76:79],v[28:31],a[248:255],v1
s_cbranch_vccnz flb_100683
s_branch segb_100667
fl_100675:
v_smfmac_f32_16x16x64_bf16 v[76:79],v[28:31],a[248:255],v1
flb_100683:
buffer_load_dwordx4 v[32:35],v0,s[20:23],s93 offen offset:0 sc1
s_mov_b32 s55,240
buffer_store_dwordx4 v[112:115],v120,s[20:23],s101 offen sc1
buffer_store_dword v126,v121,s[20:23],s69 offen sc1
s_bitcmp1_b32 s55,5
s_cbranch_scc0 rdn_100753
s_waitcnt vmcnt(7)
v_max3_u32 v124,v36,v37,v38
v_max_u32 v124,v124,v39
v_cmp_eq_u32 vcc,-1,v124
s_cbranch_vccnz rfa_100754
buffer_load_dword v125,off,s[20:23],s92 sc1
s_bitset0_b32 s55,5
v_smfmac_f32_16x16x64_bf16 v[48:51],v[36:39],a[64:71],v1
v_smfmac_f32_16x16x64_bf16 v[52:55],v[36:39],a[72:79],v1
v_smfmac_f32_16x16x64_bf16 v[56:59],v[36:39],a[80:87],v1
v_smfmac_f32_16x16x64_bf16 v[60:63],v[36:39],a[88:95],v1
v_smfmac_f32_16x16x64_bf16 v[64:67],v[36:39],a[96:103],v1
v_smfmac_f32_16x16x64_bf16 v[68:71],v[36:39],a[104:111],v1
v_smfmac_f32_16x16x64_bf16 v[72:75],v[36:39],a[112:119],v1
v_smfmac_f32_16x16x64_bf16 v[76:79],v[36:39],a[120:127],v1
s_cmp_eq_u32 s55,0
s_cbranch_scc1 segb_100669
s_branch rnx_100755
rdn_100753:
buffer_load_dword v125,off,s[20:23],s92 sc1
s_branch rnx_100755
rfa_100754:
buffer_load_dwordx4 v[36:39],v0,s[20:23],s93 offen offset:1024 sc1
rnx_100755:
s_bitcmp1_b32 s55,6
s_cbranch_scc0 rdn_100756
s_waitcnt vmcnt(6)
v_max3_u32 v124,v40,v41,v42
v_max_u32 v124,v124,v43
v_cmp_eq_u32 vcc,-1,v124
s_cbranch_vccnz rfa_100757
buffer_load_dword v125,off,s[20:23],s92 sc1
s_bitset0_b32 s55,6
s_cmp_eq_u32 s55,0
s_cbranch_scc1 segb_100669
s_branch rnx_100758
rdn_100756:
buffer_load_dword v125,off,s[20:23],s92 sc1
s_branch rnx_100758
rfa_100757:
buffer_load_dwordx4 v[40:43],v0,s[20:23],s93 offen offset:2048 sc1
rnx_100758:
s_bitcmp1_b32 s55,7
s_cbranch_scc0 rdn_100759
s_waitcnt vmcnt(6)
v_max3_u32 v124,v44,v45,v46
v_max_u32 v124,v124,v47
v_cmp_eq_u32 vcc,-1,v124
s_cbranch_vccnz rfa_100760
buffer_load_dword v125,off,s[20:23],s92 sc1
s_bitset0_b32 s55,7
s_cmp_eq_u32 s55,0
s_cbranch_scc1 segb_100669
s_branch rnx_100761
rdn_100759:
buffer_load_dword v125,off,s[20:23],s92 sc1
s_branch rnx_100761
rfa_100760:
buffer_load_dwordx4 v[44:47],v0,s[20:23],s93 offen offset:3072 sc1
rnx_100761:
rot_100752:
s_bitcmp1_b32 s55,4
s_cbranch_scc0 rdn_100762
s_waitcnt vmcnt(3)
v_max3_u32 v124,v32,v33,v34
v_max_u32 v124,v124,v35
v_cmp_eq_u32 vcc,-1,v124
s_cbranch_vccnz rfa_100763
buffer_load_dword v125,off,s[20:23],s92 sc1
s_bitset0_b32 s55,4
v_smfmac_f32_16x16x64_bf16 v[48:51],v[32:35],a[0:7],v1
v_smfmac_f32_16x16x64_bf16 v[52:55],v[32:35],a[8:15],v1
v_smfmac_f32_16x16x64_bf16 v[56:59],v[32:35],a[16:23],v1
v_smfmac_f32_16x16x64_bf16 v[60:63],v[32:35],a[24:31],v1
v_smfmac_f32_16x16x64_bf16 v[64:67],v[32:35],a[32:39],v1
v_smfmac_f32_16x16x64_bf16 v[68:71],v[32:35],a[40:47],v1
v_smfmac_f32_16x16x64_bf16 v[72:75],v[32:35],a[48:55],v1
v_smfmac_f32_16x16x64_bf16 v[76:79],v[32:35],a[56:63],v1
s_cmp_eq_u32 s55,0
s_cbranch_scc1 segb_100669
s_branch rnx_100764
rdn_100762:
buffer_load_dword v125,off,s[20:23],s92 sc1
s_branch rnx_100764
rfa_100763:
buffer_load_dwordx4 v[32:35],v0,s[20:23],s93 offen offset:0 sc1
rnx_100764:
s_bitcmp1_b32 s55,5
s_cbranch_scc0 rdn_100765
s_waitcnt vmcnt(3)
v_max3_u32 v124,v36,v37,v38
v_max_u32 v124,v124,v39
v_cmp_eq_u32 vcc,-1,v124
s_cbranch_vccnz rfa_100766
buffer_load_dword v125,off,s[20:23],s92 sc1
s_bitset0_b32 s55,5
v_smfmac_f32_16x16x64_bf16 v[48:51],v[36:39],a[64:71],v1
v_smfmac_f32_16x16x64_bf16 v[52:55],v[36:39],a[72:79],v1
v_smfmac_f32_16x16x64_bf16 v[56:59],v[36:39],a[80:87],v1
v_smfmac_f32_16x16x64_bf16 v[60:63],v[36:39],a[88:95],v1
v_smfmac_f32_16x16x64_bf16 v[64:67],v[36:39],a[96:103],v1
v_smfmac_f32_16x16x64_bf16 v[68:71],v[36:39],a[104:111],v1
v_smfmac_f32_16x16x64_bf16 v[72:75],v[36:39],a[112:119],v1
v_smfmac_f32_16x16x64_bf16 v[76:79],v[36:39],a[120:127],v1
s_cmp_eq_u32 s55,0
s_cbranch_scc1 segb_100669
s_branch rnx_100767
rdn_100765:
buffer_load_dword v125,off,s[20:23],s92 sc1
s_branch rnx_100767
rfa_100766:
buffer_load_dwordx4 v[36:39],v0,s[20:23],s93 offen offset:1024 sc1
rnx_100767:
s_bitcmp1_b32 s55,6
s_cbranch_scc0 rdn_100768
s_waitcnt vmcnt(3)
v_max3_u32 v124,v40,v41,v42
v_max_u32 v124,v124,v43
v_cmp_eq_u32 vcc,-1,v124
s_cbranch_vccnz rfa_100769
buffer_load_dword v125,off,s[20:23],s92 sc1
s_bitset0_b32 s55,6
s_cmp_eq_u32 s55,0
s_cbranch_scc1 segb_100669
s_branch rnx_100770
rdn_100768:
buffer_load_dword v125,off,s[20:23],s92 sc1
s_branch rnx_100770
rfa_100769:
buffer_load_dwordx4 v[40:43],v0,s[20:23],s93 offen offset:2048 sc1
rnx_100770:
s_bitcmp1_b32 s55,7
s_cbranch_scc0 rdn_100771
s_waitcnt vmcnt(3)
v_max3_u32 v124,v44,v45,v46
v_max_u32 v124,v124,v47
v_cmp_eq_u32 vcc,-1,v124
s_cbranch_vccnz rfa_100772
buffer_load_dword v125,off,s[20:23],s92 sc1
s_bitset0_b32 s55,7
s_cmp_eq_u32 s55,0
s_cbranch_scc1 segb_100669
s_branch rnx_100773
rdn_100771:
buffer_load_dword v125,off,s[20:23],s92 sc1
s_branch rnx_100773
rfa_100772:
buffer_load_dwordx4 v[44:47],v0,s[20:23],s93 offen offset:3072 sc1
rnx_100773:
s_sub_u32 s90,s90,1
s_cmp_gt_i32 s90,0
s_cbranch_scc1 rot_100752
s_mov_b32 s55,0
s_branch segb_100669
fl_100676:
v_smfmac_f32_16x16x64_bf16 v[76:79],v[32:35],a[56:63],v1
flb_100684:
buffer_load_dwordx4 v[36:39],v0,s[20:23],s93 offen offset:1024 sc1
s_mov_b32 s55,224
s_bitcmp1_b32 s55,6
s_cbranch_scc0 rdn_100775
s_waitcnt vmcnt(6)
v_max3_u32 v124,v40,v41,v42
v_max_u32 v124,v124,v43
v_cmp_eq_u32 vcc,-1,v124
s_cbranch_vccnz rfa_100776
buffer_load_dword v125,off,s[20:23],s92 sc1
s_bitset0_b32 s55,6
s_cmp_eq_u32 s55,0
s_cbranch_scc1 segb_100669
s_branch rnx_100777
rdn_100775:
buffer_load_dword v125,off,s[20:23],s92 sc1
s_branch rnx_100777
rfa_100776:
buffer_load_dwordx4 v[40:43],v0,s[20:23],s93 offen offset:2048 sc1
rnx_100777:
s_bitcmp1_b32 s55,7
s_cbranch_scc0 rdn_100778
s_waitcnt vmcnt(6)
v_max3_u32 v124,v44,v45,v46
v_max_u32 v124,v124,v47
v_cmp_eq_u32 vcc,-1,v124
s_cbranch_vccnz rfa_100779
buffer_load_dword v125,off,s[20:23],s92 sc1
s_bitset0_b32 s55,7
s_cmp_eq_u32 s55,0
s_cbranch_scc1 segb_100669
s_branch rnx_100780
rdn_100778:
buffer_load_dword v125,off,s[20:23],s92 sc1
s_branch rnx_100780
rfa_100779:
buffer_load_dwordx4 v[44:47],v0,s[20:23],s93 offen offset:3072 sc1
rnx_100780:
rot_100774:
s_bitcmp1_b32 s55,5
s_cbranch_scc0 rdn_100781
s_waitcnt vmcnt(2)
v_max3_u32 v124,v36,v37,v38
v_max_u32 v124,v124,v39
v_cmp_eq_u32 vcc,-1,v124
s_cbranch_vccnz rfa_100782
buffer_load_dword v125,off,s[20:23],s92 sc1
s_bitset0_b32 s55,5
v_smfmac_f32_16x16x64_bf16 v[48:51],v[36:39],a[64:71],v1
v_smfmac_f32_16x16x64_bf16 v[52:55],v[36:39],a[72:79],v1
v_smfmac_f32_16x16x64_bf16 v[56:59],v[36:39],a[80:87],v1
v_smfmac_f32_16x16x64_bf16 v[60:63],v[36:39],a[88:95],v1
v_smfmac_f32_16x16x64_bf16 v[64:67],v[36:39],a[96:103],v1
v_smfmac_f32_16x16x64_bf16 v[68:71],v[36:39],a[104:111],v1
v_smfmac_f32_16x16x64_bf16 v[72:75],v[36:39],a[112:119],v1
v_smfmac_f32_16x16x64_bf16 v[76:79],v[36:39],a[120:127],v1
s_cmp_eq_u32 s55,0
s_cbranch_scc1 segb_100669
s_branch rnx_100783
rdn_100781:
buffer_load_dword v125,off,s[20:23],s92 sc1
s_branch rnx_100783
rfa_100782:
buffer_load_dwordx4 v[36:39],v0,s[20:23],s93 offen offset:1024 sc1
rnx_100783:
s_bitcmp1_b32 s55,6
s_cbranch_scc0 rdn_100784
s_waitcnt vmcnt(2)
v_max3_u32 v124,v40,v41,v42
v_max_u32 v124,v124,v43
v_cmp_eq_u32 vcc,-1,v124
s_cbranch_vccnz rfa_100785
buffer_load_dword v125,off,s[20:23],s92 sc1
s_bitset0_b32 s55,6
s_cmp_eq_u32 s55,0
s_cbranch_scc1 segb_100669
s_branch rnx_100786
rdn_100784:
buffer_load_dword v125,off,s[20:23],s92 sc1
s_branch rnx_100786
rfa_100785:
buffer_load_dwordx4 v[40:43],v0,s[20:23],s93 offen offset:2048 sc1
rnx_100786:
s_bitcmp1_b32 s55,7
s_cbranch_scc0 rdn_100787
s_waitcnt vmcnt(2)
v_max3_u32 v124,v44,v45,v46
v_max_u32 v124,v124,v47
v_cmp_eq_u32 vcc,-1,v124
s_cbranch_vccnz rfa_100788
buffer_load_dword v125,off,s[20:23],s92 sc1
s_bitset0_b32 s55,7
s_cmp_eq_u32 s55,0
s_cbranch_scc1 segb_100669
s_branch rnx_100789
rdn_100787:
buffer_load_dword v125,off,s[20:23],s92 sc1
s_branch rnx_100789
rfa_100788:
buffer_load_dwordx4 v[44:47],v0,s[20:23],s93 offen offset:3072 sc1
rnx_100789:
s_sub_u32 s90,s90,1
s_cmp_gt_i32 s90,0
s_cbranch_scc1 rot_100774
s_mov_b32 s55,0
s_branch segb_100669
fl_100677:
v_smfmac_f32_16x16x64_bf16 v[76:79],v[36:39],a[120:127],v1
flb_100685:
s_mov_b32 s55,192
s_bitcmp1_b32 s55,6
s_cbranch_scc0 rdn_100791
s_waitcnt vmcnt(6)
v_max3_u32 v124,v40,v41,v42
v_max_u32 v124,v124,v43
v_cmp_eq_u32 vcc,-1,v124
s_cbranch_vccnz rfa_100792
buffer_load_dword v125,off,s[20:23],s92 sc1
s_bitset0_b32 s55,6
s_cmp_eq_u32 s55,0
s_cbranch_scc1 segb_100669
s_branch rnx_100793
rdn_100791:
buffer_load_dword v125,off,s[20:23],s92 sc1
s_branch rnx_100793
rfa_100792:
buffer_load_dwordx4 v[40:43],v0,s[20:23],s93 offen offset:2048 sc1
rnx_100793:
s_bitcmp1_b32 s55,7
s_cbranch_scc0 rdn_100794
s_waitcnt vmcnt(6)
v_max3_u32 v124,v44,v45,v46
v_max_u32 v124,v124,v47
v_cmp_eq_u32 vcc,-1,v124
s_cbranch_vccnz rfa_100795
buffer_load_dword v125,off,s[20:23],s92 sc1
s_bitset0_b32 s55,7
s_cmp_eq_u32 s55,0
s_cbranch_scc1 segb_100669
s_branch rnx_100796
rdn_100794:
buffer_load_dword v125,off,s[20:23],s92 sc1
s_branch rnx_100796
rfa_100795:
buffer_load_dwordx4 v[44:47],v0,s[20:23],s93 offen offset:3072 sc1
rnx_100796:
rot_100790:
s_bitcmp1_b32 s55,6
s_cbranch_scc0 rdn_100797
s_waitcnt vmcnt(1)
v_max3_u32 v124,v40,v41,v42
v_max_u32 v124,v124,v43
v_cmp_eq_u32 vcc,-1,v124
s_cbranch_vccnz rfa_100798
buffer_load_dword v125,off,s[20:23],s92 sc1
s_bitset0_b32 s55,6
s_cmp_eq_u32 s55,0
s_cbranch_scc1 segb_100669
s_branch rnx_100799
rdn_100797:
buffer_load_dword v125,off,s[20:23],s92 sc1
s_branch rnx_100799
rfa_100798:
buffer_load_dwordx4 v[40:43],v0,s[20:23],s93 offen offset:2048 sc1
rnx_100799:
s_bitcmp1_b32 s55,7
s_cbranch_scc0 rdn_100800
s_waitcnt vmcnt(1)
v_max3_u32 v124,v44,v45,v46
v_max_u32 v124,v124,v47
v_cmp_eq_u32 vcc,-1,v124
s_cbranch_vccnz rfa_100801
buffer_load_dword v125,off,s[20:23],s92 sc1
s_bitset0_b32 s55,7
s_cmp_eq_u32 s55,0
s_cbranch_scc1 segb_100669
s_branch rnx_100802
rdn_100800:
buffer_load_dword v125,off,s[20:23],s92 sc1
s_branch rnx_100802
rfa_100801:
buffer_load_dwordx4 v[44:47],v0,s[20:23],s93 offen offset:3072 sc1
rnx_100802:
s_sub_u32 s90,s90,1
s_cmp_gt_i32 s90,0
s_cbranch_scc1 rot_100790
s_mov_b32 s55,0
s_branch segb_100669
dfl_100743:
buffer_load_dwordx4 v[20:23],v0,s[20:23],s92 offen offset:1024 sc1
s_bitset1_b32 s55,1
buffer_load_dwordx4 v[36:39],v0,s[20:23],s93 offen offset:1024 sc1
s_waitcnt vmcnt(5)
v_max3_u32 v124,v24,v25,v26
v_max_u32 v124,v124,v27
v_cmp_eq_u32 vcc,-1,v124
s_cbranch_vccnz dfl_100744
s_branch dseg_100747
dfl_100744:
buffer_load_dwordx4 v[24:27],v0,s[20:23],s92 offen offset:2048 sc1
s_bitset1_b32 s55,2
buffer_load_dwordx4 v[40:43],v0,s[20:23],s93 offen offset:2048 sc1
buffer_load_dwordx4 v[44:47],v0,s[20:23],s93 offen offset:3072 sc1
s_waitcnt vmcnt(7)
v_max3_u32 v124,v28,v29,v30
v_max_u32 v124,v124,v31
v_cmp_eq_u32 vcc,-1,v124
s_cbranch_vccnz dfl_100745
s_branch dseg_100748
dfl_100745:
buffer_load_dwordx4 v[28:31],v0,s[20:23],s92 offen offset:3072 sc1
s_bitset1_b32 s55,3
s_branch lap2_100749
dseg_100747:
v_smfmac_f32_16x16x64_bf16 v[48:51],v[24:27],a[128:135],v1
buffer_load_dword v125,off,s[20:23],s92 sc1
v_smfmac_f32_16x16x64_bf16 v[52:55],v[24:27],a[136:143],v1
buffer_load_dwordx4 v[40:43],v0,s[20:23],s93 offen offset:2048 sc1
v_smfmac_f32_16x16x64_bf16 v[56:59],v[24:27],a[144:151],v1
buffer_load_dwordx4 v[44:47],v0,s[20:23],s93 offen offset:3072 sc1
s_waitcnt vmcnt(7)
v_max3_u32 v124,v28,v29,v30
v_smfmac_f32_16x16x64_bf16 v[60:63],v[24:27],a[152:159],v1
v_max_u32 v124,v124,v31
v_smfmac_f32_16x16x64_bf16 v[64:67],v[24:27],a[160:167],v1
v_cmp_eq_u32 vcc,-1,v124
v_smfmac_f32_16x16x64_bf16 v[68:71],v[24:27],a[168:175],v1
v_smfmac_f32_16x16x64_bf16 v[72:75],v[24:27],a[176:183],v1
v_smfmac_f32_16x16x64_bf16 v[76:79],v[24:27],a[184:191],v1
s_cbranch_vccnz dfl_100745
dseg_100748:
v_smfmac_f32_16x16x64_bf16 v[48:51],v[28:31],a[192:199],v1
buffer_load_dword v125,off,s[20:23],s92 sc1
v_smfmac_f32_16x16x64_bf16 v[52:55],v[28:31],a[200:207],v1
v_smfmac_f32_16x16x64_bf16 v[56:59],v[28:31],a[208:215],v1
v_smfmac_f32_16x16x64_bf16 v[60:63],v[28:31],a[216:223],v1
v_smfmac_f32_16x16x64_bf16 v[64:67],v[28:31],a[224:231],v1
v_smfmac_f32_16x16x64_bf16 v[68:71],v[28:31],a[232:239],v1
v_smfmac_f32_16x16x64_bf16 v[72:75],v[28:31],a[240:247],v1
v_smfmac_f32_16x16x64_bf16 v[76:79],v[28:31],a[248:255],v1
lap2_100749:
s_bitcmp1_b32 s55,0
s_cbranch_scc0 l2s_100803
s_waitcnt vmcnt(7)
v_max3_u32 v124,v16,v17,v18
v_max_u32 v124,v124,v19
v_cmp_eq_u32 vcc,-1,v124
s_cbranch_vccnz l2s_100803
s_bitset0_b32 s55,0
v_smfmac_f32_16x16x64_bf16 v[48:51],v[16:19],a[0:7],v1
v_smfmac_f32_16x16x64_bf16 v[52:55],v[16:19],a[8:15],v1
v_smfmac_f32_16x16x64_bf16 v[56:59],v[16:19],a[16:23],v1
v_smfmac_f32_16x16x64_bf16 v[60:63],v[16:19],a[24:31],v1
v_smfmac_f32_16x16x64_bf16 v[64:67],v[16:19],a[32:39],v1
v_smfmac_f32_16x16x64_bf16 v[68:71],v[16:19],a[40:47],v1
v_smfmac_f32_16x16x64_bf16 v[72:75],v[16:19],a[48:55],v1
v_smfmac_f32_16x16x64_bf16 v[76:79],v[16:19],a[56:63],v1
l2s_100803:
s_bitcmp1_b32 s55,1
s_cbranch_scc0 l2s_100805
s_waitcnt vmcnt(5)
v_max3_u32 v124,v20,v21,v22
v_max_u32 v124,v124,v23
v_cmp_eq_u32 vcc,-1,v124
s_cbranch_vccnz l2s_100805
s_bitset0_b32 s55,1
v_smfmac_f32_16x16x64_bf16 v[48:51],v[20:23],a[64:71],v1
v_smfmac_f32_16x16x64_bf16 v[52:55],v[20:23],a[72:79],v1
v_smfmac_f32_16x16x64_bf16 v[56:59],v[20:23],a[80:87],v1
v_smfmac_f32_16x16x64_bf16 v[60:63],v[20:23],a[88:95],v1
v_smfmac_f32_16x16x64_bf16 v[64:67],v[20:23],a[96:103],v1
v_smfmac_f32_16x16x64_bf16 v[68:71],v[20:23],a[104:111],v1
v_smfmac_f32_16x16x64_bf16 v[72:75],v[20:23],a[112:119],v1
v_smfmac_f32_16x16x64_bf16 v[76:79],v[20:23],a[120:127],v1
l2s_100805:
s_bitcmp1_b32 s55,2
s_cbranch_scc0 l2s_100807
s_waitcnt vmcnt(3)
v_max3_u32 v124,v24,v25,v26
v_max_u32 v124,v124,v27
v_cmp_eq_u32 vcc,-1,v124
s_cbranch_vccnz l2s_100807
s_bitset0_b32 s55,2
v_smfmac_f32_16x16x64_bf16 v[48:51],v[24:27],a[128:135],v1
v_smfmac_f32_16x16x64_bf16 v[52:55],v[24:27],a[136:143],v1
v_smfmac_f32_16x16x64_bf16 v[56:59],v[24:27],a[144:151],v1
v_smfmac_f32_16x16x64_bf16 v[60:63],v[24:27],a[152:159],v1
v_smfmac_f32_16x16x64_bf16 v[64:67],v[24:27],a[160:167],v1
v_smfmac_f32_16x16x64_bf16 v[68:71],v[24:27],a[168:175],v1
v_smfmac_f32_16x16x64_bf16 v[72:75],v[24:27],a[176:183],v1
v_smfmac_f32_16x16x64_bf16 v[76:79],v[24:27],a[184:191],v1
l2s_100807:
s_bitcmp1_b32 s55,3
s_cbranch_scc0 l2s_100809
s_waitcnt vmcnt(0)
v_max3_u32 v124,v28,v29,v30
v_max_u32 v124,v124,v31
v_cmp_eq_u32 vcc,-1,v124
s_cbranch_vccnz l2s_100809
s_bitset0_b32 s55,3
v_smfmac_f32_16x16x64_bf16 v[48:51],v[28:31],a[192:199],v1
v_smfmac_f32_16x16x64_bf16 v[52:55],v[28:31],a[200:207],v1
v_smfmac_f32_16x16x64_bf16 v[56:59],v[28:31],a[208:215],v1
v_smfmac_f32_16x16x64_bf16 v[60:63],v[28:31],a[216:223],v1
v_smfmac_f32_16x16x64_bf16 v[64:67],v[28:31],a[224:231],v1
v_smfmac_f32_16x16x64_bf16 v[68:71],v[28:31],a[232:239],v1
v_smfmac_f32_16x16x64_bf16 v[72:75],v[28:31],a[240:247],v1
v_smfmac_f32_16x16x64_bf16 v[76:79],v[28:31],a[248:255],v1
l2s_100809:
s_cmp_eq_u32 s55,0
s_cbranch_scc0 lfb_100750
Ldone_100751:
s_waitcnt vmcnt(6)
v_max3_u32 v124,v32,v33,v34
v_max_u32 v124,v124,v35
v_cmp_eq_u32 vcc,-1,v124
s_cbranch_vccnz flb_100683
s_branch segb_100667
lfb_100750:
s_bitcmp1_b32 s55,0
s_cbranch_scc0 dsk_100811
buffer_load_dwordx4 v[16:19],v0,s[20:23],s92 offen offset:0 sc1
dsk_100811:
s_bitcmp1_b32 s55,1
s_cbranch_scc0 dsk_100812
buffer_load_dwordx4 v[20:23],v0,s[20:23],s92 offen offset:1024 sc1
dsk_100812:
s_bitcmp1_b32 s55,2
s_cbranch_scc0 dsk_100813
buffer_load_dwordx4 v[24:27],v0,s[20:23],s92 offen offset:2048 sc1
dsk_100813:
s_bitcmp1_b32 s55,3
s_cbranch_scc0 dsk_100814
buffer_load_dwordx4 v[28:31],v0,s[20:23],s92 offen offset:3072 sc1
dsk_100814:
s_bitcmp1_b32 s55,0
s_cbranch_scc0 dsk_100815
s_waitcnt vmcnt(2)
v_max3_u32 v124,v16,v17,v18
v_max_u32 v124,v124,v19
v_cmp_eq_u32 vcc,-1,v124
s_cbranch_vccz dgo_100816
s_nop 15
buffer_load_dwordx4 v[104:107],v0,s[20:23],s92 offen offset:0 sc1
s_nop 15
buffer_load_dwordx4 v[108:111],v0,s[20:23],s92 offen offset:0 sc1
dlp_100817:
s_waitcnt vmcnt(2)
v_max3_u32 v124,v16,v17,v18
v_max_u32 v124,v124,v19
v_cmp_eq_u32 vcc,-1,v124
s_cbranch_vccz dgo_100816
buffer_load_dwordx4 v[16:19],v0,s[20:23],s92 offen offset:0 sc1
s_waitcnt vmcnt(2)
v_max3_u32 v124,v104,v105,v106
v_max_u32 v124,v124,v107
v_cmp_eq_u32 vcc,-1,v124
s_cbranch_vccz dcp_100819
buffer_load_dwordx4 v[104:107],v0,s[20:23],s92 offen offset:0 sc1
s_waitcnt vmcnt(2)
v_max3_u32 v124,v108,v109,v110
v_max_u32 v124,v124,v111
v_cmp_eq_u32 vcc,-1,v124
s_cbranch_vccz dcp_100820
buffer_load_dwordx4 v[108:111],v0,s[20:23],s92 offen offset:0 sc1
s_sub_u32 s90,s90,1
s_cmp_gt_i32 s90,0
s_cbranch_scc1 dlp_100817
s_branch dgo_100816
dcp_100819:
v_mov_b32 v16,v104
v_mov_b32 v17,v105
v_mov_b32 v18,v106
v_mov_b32 v19,v107
s_nop 1
s_branch dgo_100816
dcp_100820:
v_mov_b32 v16,v108
v_mov_b32 v17,v109
v_mov_b32 v18,v110
v_mov_b32 v19,v111
s_nop 1
dgo_100816:
v_smfmac_f32_16x16x64_bf16 v[48:51],v[16:19],a[0:7],v1
v_smfmac_f32_16x16x64_bf16 v[52:55],v[16:19],a[8:15],v1
v_smfmac_f32_16x16x64_bf16 v[56:59],v[16:19],a[16:23],v1
v_smfmac_f32_16x16x64_bf16 v[60:63],v[16:19],a[24:31],v1
v_smfmac_f32_16x16x64_bf16 v[64:67],v[16:19],a[32:39],v1
v_smfmac_f32_16x16x64_bf16 v[68:71],v[16:19],a[40:47],v1
v_smfmac_f32_16x16x64_bf16 v[72:75],v[16:19],a[48:55],v1
v_smfmac_f32_16x16x64_bf16 v[76:79],v[16:19],a[56:63],v1
dsk_100815:
s_bitcmp1_b32 s55,1
s_cbranch_scc0 dsk_100821
s_waitcnt vmcnt(2)
v_max3_u32 v124,v20,v21,v22
v_max_u32 v124,v124,v23
v_cmp_eq_u32 vcc,-1,v124
s_cbranch_vccz dgo_100822
s_nop 15
buffer_load_dwordx4 v[104:107],v0,s[20:23],s92 offen offset:1024 sc1
s_nop 15
buffer_load_dwordx4 v[108:111],v0,s[20:23],s92 offen offset:1024 sc1
dlp_100823:
s_waitcnt vmcnt(2)
v_max3_u32 v124,v20,v21,v22
v_max_u32 v124,v124,v23
v_cmp_eq_u32 vcc,-1,v124
s_cbranch_vccz dgo_100822
buffer_load_dwordx4 v[20:23],v0,s[20:23],s92 offen offset:1024 sc1
s_waitcnt vmcnt(2)
v_max3_u32 v124,v104,v105,v106
v_max_u32 v124,v124,v107
v_cmp_eq_u32 vcc,-1,v124
s_cbranch_vccz dcp_100825
buffer_load_dwordx4 v[104:107],v0,s[20:23],s92 offen offset:1024 sc1
s_waitcnt vmcnt(2)
v_max3_u32 v124,v108,v109,v110
v_max_u32 v124,v124,v111
v_cmp_eq_u32 vcc,-1,v124
s_cbranch_vccz dcp_100826
buffer_load_dwordx4 v[108:111],v0,s[20:23],s92 offen offset:1024 sc1
s_sub_u32 s90,s90,1
s_cmp_gt_i32 s90,0
s_cbranch_scc1 dlp_100823
s_branch dgo_100822
dcp_100825:
v_mov_b32 v20,v104
v_mov_b32 v21,v105
v_mov_b32 v22,v106
v_mov_b32 v23,v107
s_nop 1
s_branch dgo_100822
dcp_100826:
v_mov_b32 v20,v108
v_mov_b32 v21,v109
v_mov_b32 v22,v110
v_mov_b32 v23,v111
s_nop 1
dgo_100822:
v_smfmac_f32_16x16x64_bf16 v[48:51],v[20:23],a[64:71],v1
v_smfmac_f32_16x16x64_bf16 v[52:55],v[20:23],a[72:79],v1
v_smfmac_f32_16x16x64_bf16 v[56:59],v[20:23],a[80:87],v1
v_smfmac_f32_16x16x64_bf16 v[60:63],v[20:23],a[88:95],v1
v_smfmac_f32_16x16x64_bf16 v[64:67],v[20:23],a[96:103],v1
v_smfmac_f32_16x16x64_bf16 v[68:71],v[20:23],a[104:111],v1
v_smfmac_f32_16x16x64_bf16 v[72:75],v[20:23],a[112:119],v1
v_smfmac_f32_16x16x64_bf16 v[76:79],v[20:23],a[120:127],v1
dsk_100821:
s_bitcmp1_b32 s55,2
s_cbranch_scc0 dsk_100827
s_waitcnt vmcnt(2)
v_max3_u32 v124,v24,v25,v26
v_max_u32 v124,v124,v27
v_cmp_eq_u32 vcc,-1,v124
s_cbranch_vccz dgo_100828
s_nop 15
buffer_load_dwordx4 v[104:107],v0,s[20:23],s92 offen offset:2048 sc1
s_nop 15
buffer_load_dwordx4 v[108:111],v0,s[20:23],s92 offen offset:2048 sc1
dlp_100829:
s_waitcnt vmcnt(2)
v_max3_u32 v124,v24,v25,v26
v_max_u32 v124,v124,v27
v_cmp_eq_u32 vcc,-1,v124
s_cbranch_vccz dgo_100828
buffer_load_dwordx4 v[24:27],v0,s[20:23],s92 offen offset:2048 sc1
s_waitcnt vmcnt(2)
v_max3_u32 v124,v104,v105,v106
v_max_u32 v124,v124,v107
v_cmp_eq_u32 vcc,-1,v124
s_cbranch_vccz dcp_100831
buffer_load_dwordx4 v[104:107],v0,s[20:23],s92 offen offset:2048 sc1
s_waitcnt vmcnt(2)
v_max3_u32 v124,v108,v109,v110
v_max_u32 v124,v124,v111
v_cmp_eq_u32 vcc,-1,v124
s_cbranch_vccz dcp_100832
buffer_load_dwordx4 v[108:111],v0,s[20:23],s92 offen offset:2048 sc1
s_sub_u32 s90,s90,1
s_cmp_gt_i32 s90,0
s_cbranch_scc1 dlp_100829
s_branch dgo_100828
dcp_100831:
v_mov_b32 v24,v104
v_mov_b32 v25,v105
v_mov_b32 v26,v106
v_mov_b32 v27,v107
s_nop 1
s_branch dgo_100828
dcp_100832:
v_mov_b32 v24,v108
v_mov_b32 v25,v109
v_mov_b32 v26,v110
v_mov_b32 v27,v111
s_nop 1
dgo_100828:
v_smfmac_f32_16x16x64_bf16 v[48:51],v[24:27],a[128:135],v1
v_smfmac_f32_16x16x64_bf16 v[52:55],v[24:27],a[136:143],v1
v_smfmac_f32_16x16x64_bf16 v[56:59],v[24:27],a[144:151],v1
v_smfmac_f32_16x16x64_bf16 v[60:63],v[24:27],a[152:159],v1
v_smfmac_f32_16x16x64_bf16 v[64:67],v[24:27],a[160:167],v1
v_smfmac_f32_16x16x64_bf16 v[68:71],v[24:27],a[168:175],v1
v_smfmac_f32_16x16x64_bf16 v[72:75],v[24:27],a[176:183],v1
v_smfmac_f32_16x16x64_bf16 v[76:79],v[24:27],a[184:191],v1
dsk_100827:
s_bitcmp1_b32 s55,3
s_cbranch_scc0 dsk_100833
s_waitcnt vmcnt(2)
v_max3_u32 v124,v28,v29,v30
v_max_u32 v124,v124,v31
v_cmp_eq_u32 vcc,-1,v124
s_cbranch_vccz dgo_100834
s_nop 15
buffer_load_dwordx4 v[104:107],v0,s[20:23],s92 offen offset:3072 sc1
s_nop 15
buffer_load_dwordx4 v[108:111],v0,s[20:23],s92 offen offset:3072 sc1
dlp_100835:
s_waitcnt vmcnt(2)
v_max3_u32 v124,v28,v29,v30
v_max_u32 v124,v124,v31
v_cmp_eq_u32 vcc,-1,v124
s_cbranch_vccz dgo_100834
buffer_load_dwordx4 v[28:31],v0,s[20:23],s92 offen offset:3072 sc1
s_waitcnt vmcnt(2)
v_max3_u32 v124,v104,v105,v106
v_max_u32 v124,v124,v107
v_cmp_eq_u32 vcc,-1,v124
s_cbranch_vccz dcp_100837
buffer_load_dwordx4 v[104:107],v0,s[20:23],s92 offen offset:3072 sc1
s_waitcnt vmcnt(2)
v_max3_u32 v124,v108,v109,v110
v_max_u32 v124,v124,v111
v_cmp_eq_u32 vcc,-1,v124
s_cbranch_vccz dcp_100838
buffer_load_dwordx4 v[108:111],v0,s[20:23],s92 offen offset:3072 sc1
s_sub_u32 s90,s90,1
s_cmp_gt_i32 s90,0
s_cbranch_scc1 dlp_100835
s_branch dgo_100834
dcp_100837:
v_mov_b32 v28,v104
v_mov_b32 v29,v105
v_mov_b32 v30,v106
v_mov_b32 v31,v107
s_nop 1
s_branch dgo_100834
dcp_100838:
v_mov_b32 v28,v108
v_mov_b32 v29,v109
v_mov_b32 v30,v110
v_mov_b32 v31,v111
s_nop 1
dgo_100834:
v_smfmac_f32_16x16x64_bf16 v[48:51],v[28:31],a[192:199],v1
v_smfmac_f32_16x16x64_bf16 v[52:55],v[28:31],a[200:207],v1
v_smfmac_f32_16x16x64_bf16 v[56:59],v[28:31],a[208:215],v1
v_smfmac_f32_16x16x64_bf16 v[60:63],v[28:31],a[216:223],v1
v_smfmac_f32_16x16x64_bf16 v[64:67],v[28:31],a[224:231],v1
v_smfmac_f32_16x16x64_bf16 v[68:71],v[28:31],a[232:239],v1
v_smfmac_f32_16x16x64_bf16 v[72:75],v[28:31],a[240:247],v1
v_smfmac_f32_16x16x64_bf16 v[76:79],v[28:31],a[248:255],v1
dsk_100833:
s_mov_b32 s55,0
s_branch Ldone_100751
slowA_100687:
buffer_load_dwordx4 v[44:47],v0,s[20:23],s93 offen offset:3072 sc1
dsk_100839:
s_bitcmp1_b32 s55,7
s_cbranch_scc0 dsk_100840
s_waitcnt vmcnt(2)
v_max3_u32 v124,v44,v45,v46
v_max_u32 v124,v124,v47
v_cmp_eq_u32 vcc,-1,v124
s_cbranch_vccz dgo_100841
s_nop 15
s_nop 3
buffer_load_dwordx4 v[104:107],v0,s[20:23],s93 offen offset:3072 sc1
s_nop 15
s_nop 3
buffer_load_dwordx4 v[108:111],v0,s[20:23],s93 offen offset:3072 sc1
dlp_100842:
s_waitcnt vmcnt(2)
v_max3_u32 v124,v44,v45,v46
v_max_u32 v124,v124,v47
v_cmp_eq_u32 vcc,-1,v124
s_cbranch_vccz dgo_100841
buffer_load_dwordx4 v[44:47],v0,s[20:23],s93 offen offset:3072 sc1
s_waitcnt vmcnt(2)
v_max3_u32 v124,v104,v105,v106
v_max_u32 v124,v124,v107
v_cmp_eq_u32 vcc,-1,v124
s_cbranch_vccz dcp_100844
buffer_load_dwordx4 v[104:107],v0,s[20:23],s93 offen offset:3072 sc1
s_waitcnt vmcnt(2)
v_max3_u32 v124,v108,v109,v110
v_max_u32 v124,v124,v111
v_cmp_eq_u32 vcc,-1,v124
s_cbranch_vccz dcp_100845
buffer_load_dwordx4 v[108:111],v0,s[20:23],s93 offen offset:3072 sc1
s_sub_u32 s90,s90,1
s_cmp_gt_i32 s90,0
s_cbranch_scc1 dlp_100842
s_branch dgo_100841
dcp_100844:
v_mov_b32 v44,v104
v_mov_b32 v45,v105
v_mov_b32 v46,v106
v_mov_b32 v47,v107
s_nop 1
s_branch dgo_100841
dcp_100845:
v_mov_b32 v44,v108
v_mov_b32 v45,v109
v_mov_b32 v46,v110
v_mov_b32 v47,v111
s_nop 1
dgo_100841:
dsk_100840:
s_mov_b32 s55,0
s_branch segb_100669
srt_100694:
s_sub_u32 s90,s90,1
s_cmp_gt_i32 s90,0
s_cbranch_scc0 sok_100693
buffer_load_dwordx4 v[16:19],v2,s[20:23],s94 offen offset:0 sc1
buffer_load_dwordx4 v[32:35],v2,s[20:23],s94 offen offset:1536 sc1
buffer_load_dwordx4 v[20:23],v2,s[20:23],s95 offen offset:0 sc1
buffer_load_dwordx4 v[36:39],v2,s[20:23],s95 offen offset:1536 sc1
buffer_load_dword v120,v3,s[20:23],s94 offen offset:0 sc1
buffer_load_dword v121,v3,s[20:23],s94 offen offset:1536 sc1
buffer_load_dword v122,v3,s[20:23],s95 offen offset:0 sc1
buffer_load_dword v123,v3,s[20:23],s95 offen offset:1536 sc1
s_branch sp_100692
of_100695:
s_mov_b32 s55,3
buffer_load_dwordx4 v[16:19],v0,s[20:23],s96 offen offset:0 sc1
buffer_load_dwordx4 v[20:23],v0,s[20:23],s96 offen offset:1024 sc1
v_readfirstlane_b32 s91,v126
s_waitcnt vmcnt(6)
v_max3_u32 v124,v24,v25,v26
v_max3_u32 v124,v124,v27,v28
v_max3_u32 v124,v124,v29,v30
v_max_u32 v124,v124,v31
v_cmp_eq_u32 vcc,-1,v124
s_cbranch_vccnz ost_100847
v_smfmac_f32_16x16x64_bf16 v[96:99],v[24:27],v[80:87],v1
buffer_load_dword v120,off,s[20:23],s96 sc1
v_smfmac_f32_16x16x64_bf16 v[100:103],v[24:27],v[88:95],v1
buffer_load_dword v120,off,s[20:23],s96 sc1
v_smfmac_f32_16x16x64_bf16 v[96:99],v[28:31],v[128:135],v1
v_smfmac_f32_16x16x64_bf16 v[100:103],v[28:31],v[136:143],v1
ort_100848:
s_waitcnt vmcnt(6)
v_max3_u32 v124,v32,v33,v34
v_max3_u32 v124,v124,v35,v36
v_max3_u32 v124,v124,v37,v38
v_max_u32 v124,v124,v39
v_cmp_eq_u32 vcc,-1,v124
s_cbranch_vccnz ost_100849
v_smfmac_f32_16x16x64_bf16 v[96:99],v[32:35],v[144:151],v1
buffer_load_dword v120,off,s[20:23],s96 sc1
v_smfmac_f32_16x16x64_bf16 v[100:103],v[32:35],v[152:159],v1
buffer_load_dword v120,off,s[20:23],s96 sc1
v_smfmac_f32_16x16x64_bf16 v[96:99],v[36:39],v[160:167],v1
v_smfmac_f32_16x16x64_bf16 v[100:103],v[36:39],v[168:175],v1
ort_100850:
s_waitcnt vmcnt(7)
v_max3_u32 v124,v40,v41,v42
v_max_u32 v124,v124,v43
v_cmp_eq_u32 vcc,-1,v124
s_cbranch_vccnz ost_100851
v_smfmac_f32_16x16x64_bf16 v[96:99],v[40:43],v[176:183],v1
buffer_load_dword v120,off,s[20:23],s96 sc1
v_smfmac_f32_16x16x64_bf16 v[100:103],v[40:43],v[184:191],v1
ort_100852:
s_waitcnt vmcnt(7)
v_max3_u32 v124,v44,v45,v46
v_max_u32 v124,v124,v47
v_cmp_eq_u32 vcc,-1,v124
s_cbranch_vccnz ost_100853
v_smfmac_f32_16x16x64_bf16 v[96:99],v[44:47],v[192:199],v1
buffer_load_dword v120,off,s[20:23],s96 sc1
v_smfmac_f32_16x16x64_bf16 v[100:103],v[44:47],v[200:207],v1
ort_100854:
s_waitcnt vmcnt(6)
v_max3_u32 v124,v16,v17,v18
v_max3_u32 v124,v124,v19,v20
v_max3_u32 v124,v124,v21,v22
v_max_u32 v124,v124,v23
v_cmp_eq_u32 vcc,-1,v124
s_cbranch_vccnz olap2_100846
s_andn2_b32 s55,s55,3
v_smfmac_f32_16x16x64_bf16 v[96:99],v[16:19],v[48:55],v1
v_smfmac_f32_16x16x64_bf16 v[100:103],v[16:19],v[56:63],v1
v_smfmac_f32_16x16x64_bf16 v[96:99],v[20:23],v[64:71],v1
v_smfmac_f32_16x16x64_bf16 v[100:103],v[20:23],v[72:79],v1
s_cbranch_scc0 oback_100706
s_branch olap2_100846
ost_100847:
buffer_load_dwordx4 v[24:27],v0,s[20:23],s96 offen offset:2048 sc1
buffer_load_dwordx4 v[28:31],v0,s[20:23],s96 offen offset:3072 sc1
s_or_b32 s55,s55,12
s_branch ort_100848
ost_100849:
buffer_load_dwordx4 v[32:35],v0,s[20:23],s97 offen offset:0 sc1
buffer_load_dwordx4 v[36:39],v0,s[20:23],s97 offen offset:1024 sc1
s_or_b32 s55,s55,48
s_branch ort_100850
ost_100851:
buffer_load_dwordx4 v[40:43],v0,s[20:23],s97 offen offset:2048 sc1
s_or_b32 s55,s55,64
s_branch ort_100852
ost_100853:
buffer_load_dwordx4 v[44:47],v0,s[20:23],s97 offen offset:3072 sc1
s_or_b32 s55,s55,128
s_branch ort_100854
of_100696:
s_mov_b32 s55,12
buffer_load_dwordx4 v[24:27],v0,s[20:23],s96 offen offset:2048 sc1
buffer_load_dwordx4 v[28:31],v0,s[20:23],s96 offen offset:3072 sc1
s_waitcnt vmcnt(4)
v_max3_u32 v124,v32,v33,v34
v_max3_u32 v124,v124,v35,v36
v_max3_u32 v124,v124,v37,v38
v_max_u32 v124,v124,v39
v_cmp_eq_u32 vcc,-1,v124
s_cbranch_vccnz ost_100856
v_smfmac_f32_16x16x64_bf16 v[96:99],v[32:35],v[144:151],v1
buffer_load_dword v120,off,s[20:23],s96 sc1
v_smfmac_f32_16x16x64_bf16 v[100:103],v[32:35],v[152:159],v1
buffer_load_dword v120,off,s[20:23],s96 sc1
v_smfmac_f32_16x16x64_bf16 v[96:99],v[36:39],v[160:167],v1
v_smfmac_f32_16x16x64_bf16 v[100:103],v[36:39],v[168:175],v1
ort_100857:
s_waitcnt vmcnt(5)
v_max3_u32 v124,v40,v41,v42
v_max_u32 v124,v124,v43
v_cmp_eq_u32 vcc,-1,v124
s_cbranch_vccnz ost_100858
v_smfmac_f32_16x16x64_bf16 v[96:99],v[40:43],v[176:183],v1
buffer_load_dword v120,off,s[20:23],s96 sc1
v_smfmac_f32_16x16x64_bf16 v[100:103],v[40:43],v[184:191],v1
ort_100859:
s_waitcnt vmcnt(5)
v_max3_u32 v124,v44,v45,v46
v_max_u32 v124,v124,v47
v_cmp_eq_u32 vcc,-1,v124
s_cbranch_vccnz ost_100860
v_smfmac_f32_16x16x64_bf16 v[96:99],v[44:47],v[192:199],v1
buffer_load_dword v120,off,s[20:23],s96 sc1
v_smfmac_f32_16x16x64_bf16 v[100:103],v[44:47],v[200:207],v1
ort_100861:
s_waitcnt vmcnt(4)
v_max3_u32 v124,v24,v25,v26
v_max3_u32 v124,v124,v27,v28
v_max3_u32 v124,v124,v29,v30
v_max_u32 v124,v124,v31
v_cmp_eq_u32 vcc,-1,v124
s_cbranch_vccnz olap2_100846
s_andn2_b32 s55,s55,12
v_smfmac_f32_16x16x64_bf16 v[96:99],v[24:27],v[80:87],v1
v_smfmac_f32_16x16x64_bf16 v[100:103],v[24:27],v[88:95],v1
v_smfmac_f32_16x16x64_bf16 v[96:99],v[28:31],v[128:135],v1
v_smfmac_f32_16x16x64_bf16 v[100:103],v[28:31],v[136:143],v1
s_cbranch_scc0 oback_100706
s_branch olap2_100846
ost_100856:
buffer_load_dwordx4 v[32:35],v0,s[20:23],s97 offen offset:0 sc1
buffer_load_dwordx4 v[36:39],v0,s[20:23],s97 offen offset:1024 sc1
s_or_b32 s55,s55,48
s_branch ort_100857
ost_100858:
buffer_load_dwordx4 v[40:43],v0,s[20:23],s97 offen offset:2048 sc1
s_or_b32 s55,s55,64
s_branch ort_100859
ost_100860:
buffer_load_dwordx4 v[44:47],v0,s[20:23],s97 offen offset:3072 sc1
s_or_b32 s55,s55,128
s_branch ort_100861
of_100697:
s_mov_b32 s55,48
buffer_load_dwordx4 v[32:35],v0,s[20:23],s97 offen offset:0 sc1
buffer_load_dwordx4 v[36:39],v0,s[20:23],s97 offen offset:1024 sc1
s_waitcnt vmcnt(3)
v_max3_u32 v124,v40,v41,v42
v_max_u32 v124,v124,v43
v_cmp_eq_u32 vcc,-1,v124
s_cbranch_vccnz ost_100863
v_smfmac_f32_16x16x64_bf16 v[96:99],v[40:43],v[176:183],v1
buffer_load_dword v120,off,s[20:23],s96 sc1
v_smfmac_f32_16x16x64_bf16 v[100:103],v[40:43],v[184:191],v1
ort_100864:
s_waitcnt vmcnt(3)
v_max3_u32 v124,v44,v45,v46
v_max_u32 v124,v124,v47
v_cmp_eq_u32 vcc,-1,v124
s_cbranch_vccnz ost_100865
v_smfmac_f32_16x16x64_bf16 v[96:99],v[44:47],v[192:199],v1
buffer_load_dword v120,off,s[20:23],s96 sc1
v_smfmac_f32_16x16x64_bf16 v[100:103],v[44:47],v[200:207],v1
ort_100866:
s_waitcnt vmcnt(2)
v_max3_u32 v124,v32,v33,v34
v_max3_u32 v124,v124,v35,v36
v_max3_u32 v124,v124,v37,v38
v_max_u32 v124,v124,v39
v_cmp_eq_u32 vcc,-1,v124
s_cbranch_vccnz olap2_100846
s_andn2_b32 s55,s55,48
v_smfmac_f32_16x16x64_bf16 v[96:99],v[32:35],v[144:151],v1
v_smfmac_f32_16x16x64_bf16 v[100:103],v[32:35],v[152:159],v1
v_smfmac_f32_16x16x64_bf16 v[96:99],v[36:39],v[160:167],v1
v_smfmac_f32_16x16x64_bf16 v[100:103],v[36:39],v[168:175],v1
s_cbranch_scc0 oback_100706
s_branch olap2_100846
ost_100863:
buffer_load_dwordx4 v[40:43],v0,s[20:23],s97 offen offset:2048 sc1
s_or_b32 s55,s55,64
s_branch ort_100864
ost_100865:
buffer_load_dwordx4 v[44:47],v0,s[20:23],s97 offen offset:3072 sc1
s_or_b32 s55,s55,128
s_branch ort_100866
of_100698:
s_mov_b32 s55,64
buffer_load_dwordx4 v[40:43],v0,s[20:23],s97 offen offset:2048 sc1
s_waitcnt vmcnt(1)
v_max3_u32 v124,v44,v45,v46
v_max_u32 v124,v124,v47
v_cmp_eq_u32 vcc,-1,v124
s_cbranch_vccnz ost_100868
v_smfmac_f32_16x16x64_bf16 v[96:99],v[44:47],v[192:199],v1
buffer_load_dword v120,off,s[20:23],s96 sc1
v_smfmac_f32_16x16x64_bf16 v[100:103],v[44:47],v[200:207],v1
ort_100869:
s_waitcnt vmcnt(1)
v_max3_u32 v124,v40,v41,v42
v_max_u32 v124,v124,v43
v_cmp_eq_u32 vcc,-1,v124
s_cbranch_vccnz olap2_100846
s_andn2_b32 s55,s55,64
v_smfmac_f32_16x16x64_bf16 v[96:99],v[40:43],v[176:183],v1
v_smfmac_f32_16x16x64_bf16 v[100:103],v[40:43],v[184:191],v1
s_cbranch_scc0 oback_100706
s_branch olap2_100846
ost_100868:
buffer_load_dwordx4 v[44:47],v0,s[20:23],s97 offen offset:3072 sc1
s_or_b32 s55,s55,128
s_branch ort_100869
of_100699:
s_mov_b32 s55,128
s_branch oslow_100705
olap2_100846:
s_bitcmp1_b32 s55,0
s_cbranch_scc0 l2s_100871
s_waitcnt vmcnt(6)
v_max3_u32 v124,v16,v17,v18
v_max3_u32 v124,v124,v19,v20
v_max3_u32 v124,v124,v21,v22
v_max_u32 v124,v124,v23
v_cmp_eq_u32 vcc,-1,v124
s_cbranch_vccnz l2s_100871
s_andn2_b32 s55,s55,3
v_smfmac_f32_16x16x64_bf16 v[96:99],v[16:19],v[48:55],v1
v_smfmac_f32_16x16x64_bf16 v[100:103],v[16:19],v[56:63],v1
v_smfmac_f32_16x16x64_bf16 v[96:99],v[20:23],v[64:71],v1
v_smfmac_f32_16x16x64_bf16 v[100:103],v[20:23],v[72:79],v1
l2s_100871:
s_bitcmp1_b32 s55,2
s_cbranch_scc0 l2s_100872
s_waitcnt vmcnt(4)
v_max3_u32 v124,v24,v25,v26
v_max3_u32 v124,v124,v27,v28
v_max3_u32 v124,v124,v29,v30
v_max_u32 v124,v124,v31
v_cmp_eq_u32 vcc,-1,v124
s_cbranch_vccnz l2s_100872
s_andn2_b32 s55,s55,12
v_smfmac_f32_16x16x64_bf16 v[96:99],v[24:27],v[80:87],v1
v_smfmac_f32_16x16x64_bf16 v[100:103],v[24:27],v[88:95],v1
v_smfmac_f32_16x16x64_bf16 v[96:99],v[28:31],v[128:135],v1
v_smfmac_f32_16x16x64_bf16 v[100:103],v[28:31],v[136:143],v1
l2s_100872:
s_bitcmp1_b32 s55,4
s_cbranch_scc0 l2s_100873
s_waitcnt vmcnt(2)
v_max3_u32 v124,v32,v33,v34
v_max3_u32 v124,v124,v35,v36
v_max3_u32 v124,v124,v37,v38
v_max_u32 v124,v124,v39
v_cmp_eq_u32 vcc,-1,v124
s_cbranch_vccnz l2s_100873
s_andn2_b32 s55,s55,48
v_smfmac_f32_16x16x64_bf16 v[96:99],v[32:35],v[144:151],v1
v_smfmac_f32_16x16x64_bf16 v[100:103],v[32:35],v[152:159],v1
v_smfmac_f32_16x16x64_bf16 v[96:99],v[36:39],v[160:167],v1
v_smfmac_f32_16x16x64_bf16 v[100:103],v[36:39],v[168:175],v1
l2s_100873:
s_bitcmp1_b32 s55,6
s_cbranch_scc0 l2s_100874
s_waitcnt vmcnt(1)
v_max3_u32 v124,v40,v41,v42
v_max_u32 v124,v124,v43
v_cmp_eq_u32 vcc,-1,v124
s_cbranch_vccnz l2s_100874
s_andn2_b32 s55,s55,64
v_smfmac_f32_16x16x64_bf16 v[96:99],v[40:43],v[176:183],v1
v_smfmac_f32_16x16x64_bf16 v[100:103],v[40:43],v[184:191],v1
l2s_100874:
s_bitcmp1_b32 s55,7
s_cbranch_scc0 l2s_100875
s_waitcnt vmcnt(0)
v_max3_u32 v124,v44,v45,v46
v_max_u32 v124,v124,v47
v_cmp_eq_u32 vcc,-1,v124
s_cbranch_vccnz l2s_100875
s_andn2_b32 s55,s55,128
v_smfmac_f32_16x16x64_bf16 v[96:99],v[44:47],v[192:199],v1
v_smfmac_f32_16x16x64_bf16 v[100:103],v[44:47],v[200:207],v1
l2s_100875:
s_cmp_eq_u32 s55,0
s_cbranch_scc1 oback_100706
oslow_100705:
s_bitcmp1_b32 s55,0
s_cbranch_scc0 dsk_100876
buffer_load_dwordx4 v[16:19],v0,s[20:23],s96 offen offset:0 sc1
dsk_100876:
s_bitcmp1_b32 s55,1
s_cbranch_scc0 dsk_100877
buffer_load_dwordx4 v[20:23],v0,s[20:23],s96 offen offset:1024 sc1
dsk_100877:
s_bitcmp1_b32 s55,2
s_cbranch_scc0 dsk_100878
buffer_load_dwordx4 v[24:27],v0,s[20:23],s96 offen offset:2048 sc1
dsk_100878:
s_bitcmp1_b32 s55,3
s_cbranch_scc0 dsk_100879
buffer_load_dwordx4 v[28:31],v0,s[20:23],s96 offen offset:3072 sc1
dsk_100879:
s_bitcmp1_b32 s55,4
s_cbranch_scc0 dsk_100880
buffer_load_dwordx4 v[32:35],v0,s[20:23],s97 offen offset:0 sc1
dsk_100880:
s_bitcmp1_b32 s55,5
s_cbranch_scc0 dsk_100881
buffer_load_dwordx4 v[36:39],v0,s[20:23],s97 offen offset:1024 sc1
dsk_100881:
s_bitcmp1_b32 s55,6
s_cbranch_scc0 dsk_100882
buffer_load_dwordx4 v[40:43],v0,s[20:23],s97 offen offset:2048 sc1
dsk_100882:
s_bitcmp1_b32 s55,7
s_cbranch_scc0 dsk_100883
buffer_load_dwordx4 v[44:47],v0,s[20:23],s97 offen offset:3072 sc1
dsk_100883:
s_bitcmp1_b32 s55,0
s_cbranch_scc0 dsk_100884
s_waitcnt vmcnt(2)
v_max3_u32 v124,v16,v17,v18
v_max_u32 v124,v124,v19
v_cmp_eq_u32 vcc,-1,v124
s_cbranch_vccz dgo_100885
s_nop 15
buffer_load_dwordx4 v[116:119],v0,s[20:23],s96 offen offset:0 sc1
s_nop 15
buffer_load_dwordx4 v[120:123],v0,s[20:23],s96 offen offset:0 sc1
dlp_100886:
s_waitcnt vmcnt(2)
v_max3_u32 v124,v16,v17,v18
v_max_u32 v124,v124,v19
v_cmp_eq_u32 vcc,-1,v124
s_cbranch_vccz dgo_100885
buffer_load_dwordx4 v[16:19],v0,s[20:23],s96 offen offset:0 sc1
s_waitcnt vmcnt(2)
v_max3_u32 v124,v116,v117,v118
v_max_u32 v124,v124,v119
v_cmp_eq_u32 vcc,-1,v124
s_cbranch_vccz dcp_100888
buffer_load_dwordx4 v[116:119],v0,s[20:23],s96 offen offset:0 sc1
s_waitcnt vmcnt(2)
v_max3_u32 v124,v120,v121,v122
v_max_u32 v124,v124,v123
v_cmp_eq_u32 vcc,-1,v124
s_cbranch_vccz dcp_100889
buffer_load_dwordx4 v[120:123],v0,s[20:23],s96 offen offset:0 sc1
s_sub_u32 s90,s90,1
s_cmp_gt_i32 s90,0
s_cbranch_scc1 dlp_100886
s_branch dgo_100885
dcp_100888:
v_mov_b32 v16,v116
v_mov_b32 v17,v117
v_mov_b32 v18,v118
v_mov_b32 v19,v119
s_nop 1
s_branch dgo_100885
dcp_100889:
v_mov_b32 v16,v120
v_mov_b32 v17,v121
v_mov_b32 v18,v122
v_mov_b32 v19,v123
s_nop 1
dgo_100885:
v_smfmac_f32_16x16x64_bf16 v[96:99],v[16:19],v[48:55],v1
v_smfmac_f32_16x16x64_bf16 v[100:103],v[16:19],v[56:63],v1
dsk_100884:
s_bitcmp1_b32 s55,1
s_cbranch_scc0 dsk_100890
s_waitcnt vmcnt(2)
v_max3_u32 v124,v20,v21,v22
v_max_u32 v124,v124,v23
v_cmp_eq_u32 vcc,-1,v124
s_cbranch_vccz dgo_100891
s_nop 15
buffer_load_dwordx4 v[116:119],v0,s[20:23],s96 offen offset:1024 sc1
s_nop 15
buffer_load_dwordx4 v[120:123],v0,s[20:23],s96 offen offset:1024 sc1
dlp_100892:
s_waitcnt vmcnt(2)
v_max3_u32 v124,v20,v21,v22
v_max_u32 v124,v124,v23
v_cmp_eq_u32 vcc,-1,v124
s_cbranch_vccz dgo_100891
buffer_load_dwordx4 v[20:23],v0,s[20:23],s96 offen offset:1024 sc1
s_waitcnt vmcnt(2)
v_max3_u32 v124,v116,v117,v118
v_max_u32 v124,v124,v119
v_cmp_eq_u32 vcc,-1,v124
s_cbranch_vccz dcp_100894
buffer_load_dwordx4 v[116:119],v0,s[20:23],s96 offen offset:1024 sc1
s_waitcnt vmcnt(2)
v_max3_u32 v124,v120,v121,v122
v_max_u32 v124,v124,v123
v_cmp_eq_u32 vcc,-1,v124
s_cbranch_vccz dcp_100895
buffer_load_dwordx4 v[120:123],v0,s[20:23],s96 offen offset:1024 sc1
s_sub_u32 s90,s90,1
s_cmp_gt_i32 s90,0
s_cbranch_scc1 dlp_100892
s_branch dgo_100891
dcp_100894:
v_mov_b32 v20,v116
v_mov_b32 v21,v117
v_mov_b32 v22,v118
v_mov_b32 v23,v119
s_nop 1
s_branch dgo_100891
dcp_100895:
v_mov_b32 v20,v120
v_mov_b32 v21,v121
v_mov_b32 v22,v122
v_mov_b32 v23,v123
s_nop 1
dgo_100891:
v_smfmac_f32_16x16x64_bf16 v[96:99],v[20:23],v[64:71],v1
v_smfmac_f32_16x16x64_bf16 v[100:103],v[20:23],v[72:79],v1
dsk_100890:
s_bitcmp1_b32 s55,2
s_cbranch_scc0 dsk_100896
s_waitcnt vmcnt(2)
v_max3_u32 v124,v24,v25,v26
v_max_u32 v124,v124,v27
v_cmp_eq_u32 vcc,-1,v124
s_cbranch_vccz dgo_100897
s_nop 15
buffer_load_dwordx4 v[116:119],v0,s[20:23],s96 offen offset:2048 sc1
s_nop 15
buffer_load_dwordx4 v[120:123],v0,s[20:23],s96 offen offset:2048 sc1
dlp_100898:
s_waitcnt vmcnt(2)
v_max3_u32 v124,v24,v25,v26
v_max_u32 v124,v124,v27
v_cmp_eq_u32 vcc,-1,v124
s_cbranch_vccz dgo_100897
buffer_load_dwordx4 v[24:27],v0,s[20:23],s96 offen offset:2048 sc1
s_waitcnt vmcnt(2)
v_max3_u32 v124,v116,v117,v118
v_max_u32 v124,v124,v119
v_cmp_eq_u32 vcc,-1,v124
s_cbranch_vccz dcp_100900
buffer_load_dwordx4 v[116:119],v0,s[20:23],s96 offen offset:2048 sc1
s_waitcnt vmcnt(2)
v_max3_u32 v124,v120,v121,v122
v_max_u32 v124,v124,v123
v_cmp_eq_u32 vcc,-1,v124
s_cbranch_vccz dcp_100901
buffer_load_dwordx4 v[120:123],v0,s[20:23],s96 offen offset:2048 sc1
s_sub_u32 s90,s90,1
s_cmp_gt_i32 s90,0
s_cbranch_scc1 dlp_100898
s_branch dgo_100897
dcp_100900:
v_mov_b32 v24,v116
v_mov_b32 v25,v117
v_mov_b32 v26,v118
v_mov_b32 v27,v119
s_nop 1
s_branch dgo_100897
dcp_100901:
v_mov_b32 v24,v120
v_mov_b32 v25,v121
v_mov_b32 v26,v122
v_mov_b32 v27,v123
s_nop 1
dgo_100897:
v_smfmac_f32_16x16x64_bf16 v[96:99],v[24:27],v[80:87],v1
v_smfmac_f32_16x16x64_bf16 v[100:103],v[24:27],v[88:95],v1
dsk_100896:
s_bitcmp1_b32 s55,3
s_cbranch_scc0 dsk_100902
s_waitcnt vmcnt(2)
v_max3_u32 v124,v28,v29,v30
v_max_u32 v124,v124,v31
v_cmp_eq_u32 vcc,-1,v124
s_cbranch_vccz dgo_100903
s_nop 15
buffer_load_dwordx4 v[116:119],v0,s[20:23],s96 offen offset:3072 sc1
s_nop 15
buffer_load_dwordx4 v[120:123],v0,s[20:23],s96 offen offset:3072 sc1
dlp_100904:
s_waitcnt vmcnt(2)
v_max3_u32 v124,v28,v29,v30
v_max_u32 v124,v124,v31
v_cmp_eq_u32 vcc,-1,v124
s_cbranch_vccz dgo_100903
buffer_load_dwordx4 v[28:31],v0,s[20:23],s96 offen offset:3072 sc1
s_waitcnt vmcnt(2)
v_max3_u32 v124,v116,v117,v118
v_max_u32 v124,v124,v119
v_cmp_eq_u32 vcc,-1,v124
s_cbranch_vccz dcp_100906
buffer_load_dwordx4 v[116:119],v0,s[20:23],s96 offen offset:3072 sc1
s_waitcnt vmcnt(2)
v_max3_u32 v124,v120,v121,v122
v_max_u32 v124,v124,v123
v_cmp_eq_u32 vcc,-1,v124
s_cbranch_vccz dcp_100907
buffer_load_dwordx4 v[120:123],v0,s[20:23],s96 offen offset:3072 sc1
s_sub_u32 s90,s90,1
s_cmp_gt_i32 s90,0
s_cbranch_scc1 dlp_100904
s_branch dgo_100903
dcp_100906:
v_mov_b32 v28,v116
v_mov_b32 v29,v117
v_mov_b32 v30,v118
v_mov_b32 v31,v119
s_nop 1
s_branch dgo_100903
dcp_100907:
v_mov_b32 v28,v120
v_mov_b32 v29,v121
v_mov_b32 v30,v122
v_mov_b32 v31,v123
s_nop 1
dgo_100903:
v_smfmac_f32_16x16x64_bf16 v[96:99],v[28:31],v[128:135],v1
v_smfmac_f32_16x16x64_bf16 v[100:103],v[28:31],v[136:143],v1
dsk_100902:
s_bitcmp1_b32 s55,4
s_cbranch_scc0 dsk_100908
s_waitcnt vmcnt(2)
v_max3_u32 v124,v32,v33,v34
v_max_u32 v124,v124,v35
v_cmp_eq_u32 vcc,-1,v124
s_cbranch_vccz dgo_100909
s_nop 15
buffer_load_dwordx4 v[116:119],v0,s[20:23],s97 offen offset:0 sc1
s_nop 15
buffer_load_dwordx4 v[120:123],v0,s[20:23],s97 offen offset:0 sc1
dlp_100910:
s_waitcnt vmcnt(2)
v_max3_u32 v124,v32,v33,v34
v_max_u32 v124,v124,v35
v_cmp_eq_u32 vcc,-1,v124
s_cbranch_vccz dgo_100909
buffer_load_dwordx4 v[32:35],v0,s[20:23],s97 offen offset:0 sc1
s_waitcnt vmcnt(2)
v_max3_u32 v124,v116,v117,v118
v_max_u32 v124,v124,v119
v_cmp_eq_u32 vcc,-1,v124
s_cbranch_vccz dcp_100912
buffer_load_dwordx4 v[116:119],v0,s[20:23],s97 offen offset:0 sc1
s_waitcnt vmcnt(2)
v_max3_u32 v124,v120,v121,v122
v_max_u32 v124,v124,v123
v_cmp_eq_u32 vcc,-1,v124
s_cbranch_vccz dcp_100913
buffer_load_dwordx4 v[120:123],v0,s[20:23],s97 offen offset:0 sc1
s_sub_u32 s90,s90,1
s_cmp_gt_i32 s90,0
s_cbranch_scc1 dlp_100910
s_branch dgo_100909
dcp_100912:
v_mov_b32 v32,v116
v_mov_b32 v33,v117
v_mov_b32 v34,v118
v_mov_b32 v35,v119
s_nop 1
s_branch dgo_100909
dcp_100913:
v_mov_b32 v32,v120
v_mov_b32 v33,v121
v_mov_b32 v34,v122
v_mov_b32 v35,v123
s_nop 1
dgo_100909:
v_smfmac_f32_16x16x64_bf16 v[96:99],v[32:35],v[144:151],v1
v_smfmac_f32_16x16x64_bf16 v[100:103],v[32:35],v[152:159],v1
dsk_100908:
s_bitcmp1_b32 s55,5
s_cbranch_scc0 dsk_100914
s_waitcnt vmcnt(2)
v_max3_u32 v124,v36,v37,v38
v_max_u32 v124,v124,v39
v_cmp_eq_u32 vcc,-1,v124
s_cbranch_vccz dgo_100915
s_nop 15
buffer_load_dwordx4 v[116:119],v0,s[20:23],s97 offen offset:1024 sc1
s_nop 15
buffer_load_dwordx4 v[120:123],v0,s[20:23],s97 offen offset:1024 sc1
dlp_100916:
s_waitcnt vmcnt(2)
v_max3_u32 v124,v36,v37,v38
v_max_u32 v124,v124,v39
v_cmp_eq_u32 vcc,-1,v124
s_cbranch_vccz dgo_100915
buffer_load_dwordx4 v[36:39],v0,s[20:23],s97 offen offset:1024 sc1
s_waitcnt vmcnt(2)
v_max3_u32 v124,v116,v117,v118
v_max_u32 v124,v124,v119
v_cmp_eq_u32 vcc,-1,v124
s_cbranch_vccz dcp_100918
buffer_load_dwordx4 v[116:119],v0,s[20:23],s97 offen offset:1024 sc1
s_waitcnt vmcnt(2)
v_max3_u32 v124,v120,v121,v122
v_max_u32 v124,v124,v123
v_cmp_eq_u32 vcc,-1,v124
s_cbranch_vccz dcp_100919
buffer_load_dwordx4 v[120:123],v0,s[20:23],s97 offen offset:1024 sc1
s_sub_u32 s90,s90,1
s_cmp_gt_i32 s90,0
s_cbranch_scc1 dlp_100916
s_branch dgo_100915
dcp_100918:
v_mov_b32 v36,v116
v_mov_b32 v37,v117
v_mov_b32 v38,v118
v_mov_b32 v39,v119
s_nop 1
s_branch dgo_100915
dcp_100919:
v_mov_b32 v36,v120
v_mov_b32 v37,v121
v_mov_b32 v38,v122
v_mov_b32 v39,v123
s_nop 1
dgo_100915:
v_smfmac_f32_16x16x64_bf16 v[96:99],v[36:39],v[160:167],v1
v_smfmac_f32_16x16x64_bf16 v[100:103],v[36:39],v[168:175],v1
dsk_100914:
s_bitcmp1_b32 s55,6
s_cbranch_scc0 dsk_100920
s_waitcnt vmcnt(2)
v_max3_u32 v124,v40,v41,v42
v_max_u32 v124,v124,v43
v_cmp_eq_u32 vcc,-1,v124
s_cbranch_vccz dgo_100921
s_nop 15
buffer_load_dwordx4 v[116:119],v0,s[20:23],s97 offen offset:2048 sc1
s_nop 15
buffer_load_dwordx4 v[120:123],v0,s[20:23],s97 offen offset:2048 sc1
dlp_100922:
s_waitcnt vmcnt(2)
v_max3_u32 v124,v40,v41,v42
v_max_u32 v124,v124,v43
v_cmp_eq_u32 vcc,-1,v124
s_cbranch_vccz dgo_100921
buffer_load_dwordx4 v[40:43],v0,s[20:23],s97 offen offset:2048 sc1
s_waitcnt vmcnt(2)
v_max3_u32 v124,v116,v117,v118
v_max_u32 v124,v124,v119
v_cmp_eq_u32 vcc,-1,v124
s_cbranch_vccz dcp_100924
buffer_load_dwordx4 v[116:119],v0,s[20:23],s97 offen offset:2048 sc1
s_waitcnt vmcnt(2)
v_max3_u32 v124,v120,v121,v122
v_max_u32 v124,v124,v123
v_cmp_eq_u32 vcc,-1,v124
s_cbranch_vccz dcp_100925
buffer_load_dwordx4 v[120:123],v0,s[20:23],s97 offen offset:2048 sc1
s_sub_u32 s90,s90,1
s_cmp_gt_i32 s90,0
s_cbranch_scc1 dlp_100922
s_branch dgo_100921
dcp_100924:
v_mov_b32 v40,v116
v_mov_b32 v41,v117
v_mov_b32 v42,v118
v_mov_b32 v43,v119
s_nop 1
s_branch dgo_100921
dcp_100925:
v_mov_b32 v40,v120
v_mov_b32 v41,v121
v_mov_b32 v42,v122
v_mov_b32 v43,v123
s_nop 1
dgo_100921:
v_smfmac_f32_16x16x64_bf16 v[96:99],v[40:43],v[176:183],v1
v_smfmac_f32_16x16x64_bf16 v[100:103],v[40:43],v[184:191],v1
dsk_100920:
s_bitcmp1_b32 s55,7
s_cbranch_scc0 dsk_100926
s_waitcnt vmcnt(2)
v_max3_u32 v124,v44,v45,v46
v_max_u32 v124,v124,v47
v_cmp_eq_u32 vcc,-1,v124
s_cbranch_vccz dgo_100927
s_nop 15
buffer_load_dwordx4 v[116:119],v0,s[20:23],s97 offen offset:3072 sc1
s_nop 15
buffer_load_dwordx4 v[120:123],v0,s[20:23],s97 offen offset:3072 sc1
dlp_100928:
s_waitcnt vmcnt(2)
v_max3_u32 v124,v44,v45,v46
v_max_u32 v124,v124,v47
v_cmp_eq_u32 vcc,-1,v124
s_cbranch_vccz dgo_100927
buffer_load_dwordx4 v[44:47],v0,s[20:23],s97 offen offset:3072 sc1
s_waitcnt vmcnt(2)
v_max3_u32 v124,v116,v117,v118
v_max_u32 v124,v124,v119
v_cmp_eq_u32 vcc,-1,v124
s_cbranch_vccz dcp_100930
buffer_load_dwordx4 v[116:119],v0,s[20:23],s97 offen offset:3072 sc1
s_waitcnt vmcnt(2)
v_max3_u32 v124,v120,v121,v122
v_max_u32 v124,v124,v123
v_cmp_eq_u32 vcc,-1,v124
s_cbranch_vccz dcp_100931
buffer_load_dwordx4 v[120:123],v0,s[20:23],s97 offen offset:3072 sc1
s_sub_u32 s90,s90,1
s_cmp_gt_i32 s90,0
s_cbranch_scc1 dlp_100928
s_branch dgo_100927
dcp_100930:
v_mov_b32 v44,v116
v_mov_b32 v45,v117
v_mov_b32 v46,v118
v_mov_b32 v47,v119
s_nop 1
s_branch dgo_100927
dcp_100931:
v_mov_b32 v44,v120
v_mov_b32 v45,v121
v_mov_b32 v46,v122
v_mov_b32 v47,v123
s_nop 1
dgo_100927:
v_smfmac_f32_16x16x64_bf16 v[96:99],v[44:47],v[192:199],v1
v_smfmac_f32_16x16x64_bf16 v[100:103],v[44:47],v[200:207],v1
dsk_100926:
s_mov_b32 s55,0
s_branch oback_100706
fl_100723:
flb_100731:
buffer_load_dwordx4 v[16:19],v0,s[20:23],s92 offen offset:0 sc1
s_mov_b32 s55,1
buffer_load_dwordx4 v[32:35],v0,s[20:23],s93 offen offset:0 sc1
s_waitcnt vmcnt(4)
v_max3_u32 v124,v20,v21,v22
v_max_u32 v124,v124,v23
v_cmp_eq_u32 vcc,-1,v124
s_cbranch_vccnz dfl_100932
v_smfmac_f32_16x16x64_bf16 v[64:67],v[20:23],a[96:103],v1
buffer_load_dword v125,off,s[20:23],s92 sc1
buffer_load_dwordx4 v[36:39],v0,s[20:23],s93 offen offset:1024 sc1
s_waitcnt vmcnt(5)
v_max3_u32 v124,v24,v25,v26
v_smfmac_f32_16x16x64_bf16 v[68:71],v[20:23],a[104:111],v1
v_max_u32 v124,v124,v27
v_cmp_eq_u32 vcc,-1,v124
v_smfmac_f32_16x16x64_bf16 v[72:75],v[20:23],a[112:119],v1
v_smfmac_f32_16x16x64_bf16 v[76:79],v[20:23],a[120:127],v1
s_cbranch_vccnz dfl_100933
v_smfmac_f32_16x16x64_bf16 v[64:67],v[24:27],a[160:167],v1
buffer_load_dword v125,off,s[20:23],s92 sc1
buffer_load_dwordx4 v[40:43],v0,s[20:23],s93 offen offset:2048 sc1
buffer_load_dwordx4 v[44:47],v0,s[20:23],s93 offen offset:3072 sc1
s_waitcnt vmcnt(7)
v_max3_u32 v124,v28,v29,v30
v_smfmac_f32_16x16x64_bf16 v[68:71],v[24:27],a[168:175],v1
v_max_u32 v124,v124,v31
v_cmp_eq_u32 vcc,-1,v124
v_smfmac_f32_16x16x64_bf16 v[72:75],v[24:27],a[176:183],v1
v_smfmac_f32_16x16x64_bf16 v[76:79],v[24:27],a[184:191],v1
s_cbranch_vccnz dfl_100934
v_smfmac_f32_16x16x64_bf16 v[64:67],v[28:31],a[224:231],v1
buffer_load_dword v125,off,s[20:23],s92 sc1
s_waitcnt vmcnt(7)
v_max3_u32 v124,v16,v17,v18
v_smfmac_f32_16x16x64_bf16 v[68:71],v[28:31],a[232:239],v1
v_max_u32 v124,v124,v19
v_cmp_eq_u32 vcc,-1,v124
v_smfmac_f32_16x16x64_bf16 v[72:75],v[28:31],a[240:247],v1
v_smfmac_f32_16x16x64_bf16 v[76:79],v[28:31],a[248:255],v1
s_cbranch_vccnz lfb_100939
s_mov_b32 s55,0
v_smfmac_f32_16x16x64_bf16 v[64:67],v[16:19],a[32:39],v1
s_waitcnt vmcnt(6)
v_max3_u32 v124,v32,v33,v34
v_max_u32 v124,v124,v35
v_cmp_eq_u32 vcc,-1,v124
v_smfmac_f32_16x16x64_bf16 v[68:71],v[16:19],a[40:47],v1
v_smfmac_f32_16x16x64_bf16 v[72:75],v[16:19],a[48:55],v1
v_smfmac_f32_16x16x64_bf16 v[76:79],v[16:19],a[56:63],v1
s_cbranch_vccnz flb_100735
s_branch segb_100719
fl_100724:
flb_100732:
buffer_load_dwordx4 v[20:23],v0,s[20:23],s92 offen offset:1024 sc1
s_mov_b32 s55,2
buffer_load_dwordx4 v[36:39],v0,s[20:23],s93 offen offset:1024 sc1
s_waitcnt vmcnt(5)
v_max3_u32 v124,v24,v25,v26
v_max_u32 v124,v124,v27
v_cmp_eq_u32 vcc,-1,v124
s_cbranch_vccnz dfl_100933
v_smfmac_f32_16x16x64_bf16 v[64:67],v[24:27],a[160:167],v1
buffer_load_dword v125,off,s[20:23],s92 sc1
buffer_load_dwordx4 v[40:43],v0,s[20:23],s93 offen offset:2048 sc1
buffer_load_dwordx4 v[44:47],v0,s[20:23],s93 offen offset:3072 sc1
s_waitcnt vmcnt(7)
v_max3_u32 v124,v28,v29,v30
v_smfmac_f32_16x16x64_bf16 v[68:71],v[24:27],a[168:175],v1
v_max_u32 v124,v124,v31
v_cmp_eq_u32 vcc,-1,v124
v_smfmac_f32_16x16x64_bf16 v[72:75],v[24:27],a[176:183],v1
v_smfmac_f32_16x16x64_bf16 v[76:79],v[24:27],a[184:191],v1
s_cbranch_vccnz dfl_100934
v_smfmac_f32_16x16x64_bf16 v[64:67],v[28:31],a[224:231],v1
buffer_load_dword v125,off,s[20:23],s92 sc1
s_waitcnt vmcnt(5)
v_max3_u32 v124,v20,v21,v22
v_smfmac_f32_16x16x64_bf16 v[68:71],v[28:31],a[232:239],v1
v_max_u32 v124,v124,v23
v_cmp_eq_u32 vcc,-1,v124
v_smfmac_f32_16x16x64_bf16 v[72:75],v[28:31],a[240:247],v1
v_smfmac_f32_16x16x64_bf16 v[76:79],v[28:31],a[248:255],v1
s_cbranch_vccnz lfb_100939
s_mov_b32 s55,0
v_smfmac_f32_16x16x64_bf16 v[64:67],v[20:23],a[96:103],v1
s_waitcnt vmcnt(6)
v_max3_u32 v124,v32,v33,v34
v_max_u32 v124,v124,v35
v_cmp_eq_u32 vcc,-1,v124
v_smfmac_f32_16x16x64_bf16 v[68:71],v[20:23],a[104:111],v1
v_smfmac_f32_16x16x64_bf16 v[72:75],v[20:23],a[112:119],v1
v_smfmac_f32_16x16x64_bf16 v[76:79],v[20:23],a[120:127],v1
s_cbranch_vccnz flb_100735
s_branch segb_100719
fl_100725:
flb_100733:
buffer_load_dwordx4 v[24:27],v0,s[20:23],s92 offen offset:2048 sc1
s_mov_b32 s55,4
buffer_load_dwordx4 v[40:43],v0,s[20:23],s93 offen offset:2048 sc1
buffer_load_dwordx4 v[44:47],v0,s[20:23],s93 offen offset:3072 sc1
s_waitcnt vmcnt(7)
v_max3_u32 v124,v28,v29,v30
v_max_u32 v124,v124,v31
v_cmp_eq_u32 vcc,-1,v124
s_cbranch_vccnz dfl_100934
v_smfmac_f32_16x16x64_bf16 v[64:67],v[28:31],a[224:231],v1
buffer_load_dword v125,off,s[20:23],s92 sc1
s_waitcnt vmcnt(3)
v_max3_u32 v124,v24,v25,v26
v_smfmac_f32_16x16x64_bf16 v[68:71],v[28:31],a[232:239],v1
v_max_u32 v124,v124,v27
v_cmp_eq_u32 vcc,-1,v124
v_smfmac_f32_16x16x64_bf16 v[72:75],v[28:31],a[240:247],v1
v_smfmac_f32_16x16x64_bf16 v[76:79],v[28:31],a[248:255],v1
s_cbranch_vccnz lfb_100939
s_mov_b32 s55,0
v_smfmac_f32_16x16x64_bf16 v[64:67],v[24:27],a[160:167],v1
s_waitcnt vmcnt(6)
v_max3_u32 v124,v32,v33,v34
v_max_u32 v124,v124,v35
v_cmp_eq_u32 vcc,-1,v124
v_smfmac_f32_16x16x64_bf16 v[68:71],v[24:27],a[168:175],v1
v_smfmac_f32_16x16x64_bf16 v[72:75],v[24:27],a[176:183],v1
v_smfmac_f32_16x16x64_bf16 v[76:79],v[24:27],a[184:191],v1
s_cbranch_vccnz flb_100735
s_branch segb_100719
fl_100726:
flb_100734:
buffer_load_dwordx4 v[28:31],v0,s[20:23],s92 offen offset:3072 sc1
s_mov_b32 s55,8
s_waitcnt vmcnt(0)
v_max3_u32 v124,v28,v29,v30
v_max_u32 v124,v124,v31
v_cmp_eq_u32 vcc,-1,v124
s_cbranch_vccnz lfb_100939
s_mov_b32 s55,0
v_smfmac_f32_16x16x64_bf16 v[64:67],v[28:31],a[224:231],v1
s_waitcnt vmcnt(6)
v_max3_u32 v124,v32,v33,v34
v_max_u32 v124,v124,v35
v_cmp_eq_u32 vcc,-1,v124
v_smfmac_f32_16x16x64_bf16 v[68:71],v[28:31],a[232:239],v1
v_smfmac_f32_16x16x64_bf16 v[72:75],v[28:31],a[240:247],v1
v_smfmac_f32_16x16x64_bf16 v[76:79],v[28:31],a[248:255],v1
s_cbranch_vccnz flb_100735
s_branch segb_100719
fl_100727:
flb_100735:
buffer_load_dwordx4 v[32:35],v0,s[20:23],s93 offen offset:0 sc1
s_mov_b32 s55,240
buffer_store_dwordx4 v[112:115],v120,s[20:23],s101 offen sc1
buffer_store_dword v126,v121,s[20:23],s69 offen sc1
s_bitcmp1_b32 s55,5
s_cbranch_scc0 rdn_100942
s_waitcnt vmcnt(7)
v_max3_u32 v124,v36,v37,v38
v_max_u32 v124,v124,v39
v_cmp_eq_u32 vcc,-1,v124
s_cbranch_vccnz rfa_100943
buffer_load_dword v125,off,s[20:23],s92 sc1
s_bitset0_b32 s55,5
v_smfmac_f32_16x16x64_bf16 v[64:67],v[36:39],a[96:103],v1
v_smfmac_f32_16x16x64_bf16 v[68:71],v[36:39],a[104:111],v1
v_smfmac_f32_16x16x64_bf16 v[72:75],v[36:39],a[112:119],v1
v_smfmac_f32_16x16x64_bf16 v[76:79],v[36:39],a[120:127],v1
s_cmp_eq_u32 s55,0
s_cbranch_scc1 segb_100721
s_branch rnx_100944
rdn_100942:
buffer_load_dword v125,off,s[20:23],s92 sc1
s_branch rnx_100944
rfa_100943:
buffer_load_dwordx4 v[36:39],v0,s[20:23],s93 offen offset:1024 sc1
rnx_100944:
s_bitcmp1_b32 s55,6
s_cbranch_scc0 rdn_100945
s_waitcnt vmcnt(6)
v_max3_u32 v124,v40,v41,v42
v_max_u32 v124,v124,v43
v_cmp_eq_u32 vcc,-1,v124
s_cbranch_vccnz rfa_100946
buffer_load_dword v125,off,s[20:23],s92 sc1
s_bitset0_b32 s55,6
s_cmp_eq_u32 s55,0
s_cbranch_scc1 segb_100721
s_branch rnx_100947
rdn_100945:
buffer_load_dword v125,off,s[20:23],s92 sc1
s_branch rnx_100947
rfa_100946:
buffer_load_dwordx4 v[40:43],v0,s[20:23],s93 offen offset:2048 sc1
rnx_100947:
s_bitcmp1_b32 s55,7
s_cbranch_scc0 rdn_100948
s_waitcnt vmcnt(6)
v_max3_u32 v124,v44,v45,v46
v_max_u32 v124,v124,v47
v_cmp_eq_u32 vcc,-1,v124
s_cbranch_vccnz rfa_100949
buffer_load_dword v125,off,s[20:23],s92 sc1
s_bitset0_b32 s55,7
s_cmp_eq_u32 s55,0
s_cbranch_scc1 segb_100721
s_branch rnx_100950
rdn_100948:
buffer_load_dword v125,off,s[20:23],s92 sc1
s_branch rnx_100950
rfa_100949:
buffer_load_dwordx4 v[44:47],v0,s[20:23],s93 offen offset:3072 sc1
rnx_100950:
rot_100941:
s_bitcmp1_b32 s55,4
s_cbranch_scc0 rdn_100951
s_waitcnt vmcnt(3)
v_max3_u32 v124,v32,v33,v34
v_max_u32 v124,v124,v35
v_cmp_eq_u32 vcc,-1,v124
s_cbranch_vccnz rfa_100952
buffer_load_dword v125,off,s[20:23],s92 sc1
s_bitset0_b32 s55,4
v_smfmac_f32_16x16x64_bf16 v[64:67],v[32:35],a[32:39],v1
v_smfmac_f32_16x16x64_bf16 v[68:71],v[32:35],a[40:47],v1
v_smfmac_f32_16x16x64_bf16 v[72:75],v[32:35],a[48:55],v1
v_smfmac_f32_16x16x64_bf16 v[76:79],v[32:35],a[56:63],v1
s_cmp_eq_u32 s55,0
s_cbranch_scc1 segb_100721
s_branch rnx_100953
rdn_100951:
buffer_load_dword v125,off,s[20:23],s92 sc1
s_branch rnx_100953
rfa_100952:
buffer_load_dwordx4 v[32:35],v0,s[20:23],s93 offen offset:0 sc1
rnx_100953:
s_bitcmp1_b32 s55,5
s_cbranch_scc0 rdn_100954
s_waitcnt vmcnt(3)
v_max3_u32 v124,v36,v37,v38
v_max_u32 v124,v124,v39
v_cmp_eq_u32 vcc,-1,v124
s_cbranch_vccnz rfa_100955
buffer_load_dword v125,off,s[20:23],s92 sc1
s_bitset0_b32 s55,5
v_smfmac_f32_16x16x64_bf16 v[64:67],v[36:39],a[96:103],v1
v_smfmac_f32_16x16x64_bf16 v[68:71],v[36:39],a[104:111],v1
v_smfmac_f32_16x16x64_bf16 v[72:75],v[36:39],a[112:119],v1
v_smfmac_f32_16x16x64_bf16 v[76:79],v[36:39],a[120:127],v1
s_cmp_eq_u32 s55,0
s_cbranch_scc1 segb_100721
s_branch rnx_100956
rdn_100954:
buffer_load_dword v125,off,s[20:23],s92 sc1
s_branch rnx_100956
rfa_100955:
buffer_load_dwordx4 v[36:39],v0,s[20:23],s93 offen offset:1024 sc1
rnx_100956:
s_bitcmp1_b32 s55,6
s_cbranch_scc0 rdn_100957
s_waitcnt vmcnt(3)
v_max3_u32 v124,v40,v41,v42
v_max_u32 v124,v124,v43
v_cmp_eq_u32 vcc,-1,v124
s_cbranch_vccnz rfa_100958
buffer_load_dword v125,off,s[20:23],s92 sc1
s_bitset0_b32 s55,6
s_cmp_eq_u32 s55,0
s_cbranch_scc1 segb_100721
s_branch rnx_100959
rdn_100957:
buffer_load_dword v125,off,s[20:23],s92 sc1
s_branch rnx_100959
rfa_100958:
buffer_load_dwordx4 v[40:43],v0,s[20:23],s93 offen offset:2048 sc1
rnx_100959:
s_bitcmp1_b32 s55,7
s_cbranch_scc0 rdn_100960
s_waitcnt vmcnt(3)
v_max3_u32 v124,v44,v45,v46
v_max_u32 v124,v124,v47
v_cmp_eq_u32 vcc,-1,v124
s_cbranch_vccnz rfa_100961
buffer_load_dword v125,off,s[20:23],s92 sc1
s_bitset0_b32 s55,7
s_cmp_eq_u32 s55,0
s_cbranch_scc1 segb_100721
s_branch rnx_100962
rdn_100960:
buffer_load_dword v125,off,s[20:23],s92 sc1
s_branch rnx_100962
rfa_100961:
buffer_load_dwordx4 v[44:47],v0,s[20:23],s93 offen offset:3072 sc1
rnx_100962:
s_sub_u32 s90,s90,1
s_cmp_gt_i32 s90,0
s_cbranch_scc1 rot_100941
s_mov_b32 s55,0
s_branch segb_100721
fl_100728:
flb_100736:
buffer_load_dwordx4 v[36:39],v0,s[20:23],s93 offen offset:1024 sc1
s_mov_b32 s55,224
s_bitcmp1_b32 s55,6
s_cbranch_scc0 rdn_100964
s_waitcnt vmcnt(6)
v_max3_u32 v124,v40,v41,v42
v_max_u32 v124,v124,v43
v_cmp_eq_u32 vcc,-1,v124
s_cbranch_vccnz rfa_100965
buffer_load_dword v125,off,s[20:23],s92 sc1
s_bitset0_b32 s55,6
s_cmp_eq_u32 s55,0
s_cbranch_scc1 segb_100721
s_branch rnx_100966
rdn_100964:
buffer_load_dword v125,off,s[20:23],s92 sc1
s_branch rnx_100966
rfa_100965:
buffer_load_dwordx4 v[40:43],v0,s[20:23],s93 offen offset:2048 sc1
rnx_100966:
s_bitcmp1_b32 s55,7
s_cbranch_scc0 rdn_100967
s_waitcnt vmcnt(6)
v_max3_u32 v124,v44,v45,v46
v_max_u32 v124,v124,v47
v_cmp_eq_u32 vcc,-1,v124
s_cbranch_vccnz rfa_100968
buffer_load_dword v125,off,s[20:23],s92 sc1
s_bitset0_b32 s55,7
s_cmp_eq_u32 s55,0
s_cbranch_scc1 segb_100721
s_branch rnx_100969
rdn_100967:
buffer_load_dword v125,off,s[20:23],s92 sc1
s_branch rnx_100969
rfa_100968:
buffer_load_dwordx4 v[44:47],v0,s[20:23],s93 offen offset:3072 sc1
rnx_100969:
rot_100963:
s_bitcmp1_b32 s55,5
s_cbranch_scc0 rdn_100970
s_waitcnt vmcnt(2)
v_max3_u32 v124,v36,v37,v38
v_max_u32 v124,v124,v39
v_cmp_eq_u32 vcc,-1,v124
s_cbranch_vccnz rfa_100971
buffer_load_dword v125,off,s[20:23],s92 sc1
s_bitset0_b32 s55,5
v_smfmac_f32_16x16x64_bf16 v[64:67],v[36:39],a[96:103],v1
v_smfmac_f32_16x16x64_bf16 v[68:71],v[36:39],a[104:111],v1
v_smfmac_f32_16x16x64_bf16 v[72:75],v[36:39],a[112:119],v1
v_smfmac_f32_16x16x64_bf16 v[76:79],v[36:39],a[120:127],v1
s_cmp_eq_u32 s55,0
s_cbranch_scc1 segb_100721
s_branch rnx_100972
rdn_100970:
buffer_load_dword v125,off,s[20:23],s92 sc1
s_branch rnx_100972
rfa_100971:
buffer_load_dwordx4 v[36:39],v0,s[20:23],s93 offen offset:1024 sc1
rnx_100972:
s_bitcmp1_b32 s55,6
s_cbranch_scc0 rdn_100973
s_waitcnt vmcnt(2)
v_max3_u32 v124,v40,v41,v42
v_max_u32 v124,v124,v43
v_cmp_eq_u32 vcc,-1,v124
s_cbranch_vccnz rfa_100974
buffer_load_dword v125,off,s[20:23],s92 sc1
s_bitset0_b32 s55,6
s_cmp_eq_u32 s55,0
s_cbranch_scc1 segb_100721
s_branch rnx_100975
rdn_100973:
buffer_load_dword v125,off,s[20:23],s92 sc1
s_branch rnx_100975
rfa_100974:
buffer_load_dwordx4 v[40:43],v0,s[20:23],s93 offen offset:2048 sc1
rnx_100975:
s_bitcmp1_b32 s55,7
s_cbranch_scc0 rdn_100976
s_waitcnt vmcnt(2)
v_max3_u32 v124,v44,v45,v46
v_max_u32 v124,v124,v47
v_cmp_eq_u32 vcc,-1,v124
s_cbranch_vccnz rfa_100977
buffer_load_dword v125,off,s[20:23],s92 sc1
s_bitset0_b32 s55,7
s_cmp_eq_u32 s55,0
s_cbranch_scc1 segb_100721
s_branch rnx_100978
rdn_100976:
buffer_load_dword v125,off,s[20:23],s92 sc1
s_branch rnx_100978
rfa_100977:
buffer_load_dwordx4 v[44:47],v0,s[20:23],s93 offen offset:3072 sc1
rnx_100978:
s_sub_u32 s90,s90,1
s_cmp_gt_i32 s90,0
s_cbranch_scc1 rot_100963
s_mov_b32 s55,0
s_branch segb_100721
fl_100729:
flb_100737:
s_mov_b32 s55,192
s_bitcmp1_b32 s55,6
s_cbranch_scc0 rdn_100980
s_waitcnt vmcnt(6)
v_max3_u32 v124,v40,v41,v42
v_max_u32 v124,v124,v43
v_cmp_eq_u32 vcc,-1,v124
s_cbranch_vccnz rfa_100981
buffer_load_dword v125,off,s[20:23],s92 sc1
s_bitset0_b32 s55,6
s_cmp_eq_u32 s55,0
s_cbranch_scc1 segb_100721
s_branch rnx_100982
rdn_100980:
buffer_load_dword v125,off,s[20:23],s92 sc1
s_branch rnx_100982
rfa_100981:
buffer_load_dwordx4 v[40:43],v0,s[20:23],s93 offen offset:2048 sc1
rnx_100982:
s_bitcmp1_b32 s55,7
s_cbranch_scc0 rdn_100983
s_waitcnt vmcnt(6)
v_max3_u32 v124,v44,v45,v46
v_max_u32 v124,v124,v47
v_cmp_eq_u32 vcc,-1,v124
s_cbranch_vccnz rfa_100984
buffer_load_dword v125,off,s[20:23],s92 sc1
s_bitset0_b32 s55,7
s_cmp_eq_u32 s55,0
s_cbranch_scc1 segb_100721
s_branch rnx_100985
rdn_100983:
buffer_load_dword v125,off,s[20:23],s92 sc1
s_branch rnx_100985
rfa_100984:
buffer_load_dwordx4 v[44:47],v0,s[20:23],s93 offen offset:3072 sc1
rnx_100985:
rot_100979:
s_bitcmp1_b32 s55,6
s_cbranch_scc0 rdn_100986
s_waitcnt vmcnt(1)
v_max3_u32 v124,v40,v41,v42
v_max_u32 v124,v124,v43
v_cmp_eq_u32 vcc,-1,v124
s_cbranch_vccnz rfa_100987
buffer_load_dword v125,off,s[20:23],s92 sc1
s_bitset0_b32 s55,6
s_cmp_eq_u32 s55,0
s_cbranch_scc1 segb_100721
s_branch rnx_100988
rdn_100986:
buffer_load_dword v125,off,s[20:23],s92 sc1
s_branch rnx_100988
rfa_100987:
buffer_load_dwordx4 v[40:43],v0,s[20:23],s93 offen offset:2048 sc1
rnx_100988:
s_bitcmp1_b32 s55,7
s_cbranch_scc0 rdn_100989
s_waitcnt vmcnt(1)
v_max3_u32 v124,v44,v45,v46
v_max_u32 v124,v124,v47
v_cmp_eq_u32 vcc,-1,v124
s_cbranch_vccnz rfa_100990
buffer_load_dword v125,off,s[20:23],s92 sc1
s_bitset0_b32 s55,7
s_cmp_eq_u32 s55,0
s_cbranch_scc1 segb_100721
s_branch rnx_100991
rdn_100989:
buffer_load_dword v125,off,s[20:23],s92 sc1
s_branch rnx_100991
rfa_100990:
buffer_load_dwordx4 v[44:47],v0,s[20:23],s93 offen offset:3072 sc1
rnx_100991:
s_sub_u32 s90,s90,1
s_cmp_gt_i32 s90,0
s_cbranch_scc1 rot_100979
s_mov_b32 s55,0
s_branch segb_100721
dfl_100932:
buffer_load_dwordx4 v[20:23],v0,s[20:23],s92 offen offset:1024 sc1
s_bitset1_b32 s55,1
buffer_load_dwordx4 v[36:39],v0,s[20:23],s93 offen offset:1024 sc1
s_waitcnt vmcnt(5)
v_max3_u32 v124,v24,v25,v26
v_max_u32 v124,v124,v27
v_cmp_eq_u32 vcc,-1,v124
s_cbranch_vccnz dfl_100933
s_branch dseg_100936
dfl_100933:
buffer_load_dwordx4 v[24:27],v0,s[20:23],s92 offen offset:2048 sc1
s_bitset1_b32 s55,2
buffer_load_dwordx4 v[40:43],v0,s[20:23],s93 offen offset:2048 sc1
buffer_load_dwordx4 v[44:47],v0,s[20:23],s93 offen offset:3072 sc1
s_waitcnt vmcnt(7)
v_max3_u32 v124,v28,v29,v30
v_max_u32 v124,v124,v31
v_cmp_eq_u32 vcc,-1,v124
s_cbranch_vccnz dfl_100934
s_branch dseg_100937
dfl_100934:
buffer_load_dwordx4 v[28:31],v0,s[20:23],s92 offen offset:3072 sc1
s_bitset1_b32 s55,3
s_branch lap2_100938
dseg_100936:
v_smfmac_f32_16x16x64_bf16 v[64:67],v[24:27],a[160:167],v1
buffer_load_dword v125,off,s[20:23],s92 sc1
buffer_load_dwordx4 v[40:43],v0,s[20:23],s93 offen offset:2048 sc1
buffer_load_dwordx4 v[44:47],v0,s[20:23],s93 offen offset:3072 sc1
s_waitcnt vmcnt(7)
v_max3_u32 v124,v28,v29,v30
v_smfmac_f32_16x16x64_bf16 v[68:71],v[24:27],a[168:175],v1
v_max_u32 v124,v124,v31
v_cmp_eq_u32 vcc,-1,v124
v_smfmac_f32_16x16x64_bf16 v[72:75],v[24:27],a[176:183],v1
v_smfmac_f32_16x16x64_bf16 v[76:79],v[24:27],a[184:191],v1
s_cbranch_vccnz dfl_100934
dseg_100937:
v_smfmac_f32_16x16x64_bf16 v[64:67],v[28:31],a[224:231],v1
buffer_load_dword v125,off,s[20:23],s92 sc1
v_smfmac_f32_16x16x64_bf16 v[68:71],v[28:31],a[232:239],v1
v_smfmac_f32_16x16x64_bf16 v[72:75],v[28:31],a[240:247],v1
v_smfmac_f32_16x16x64_bf16 v[76:79],v[28:31],a[248:255],v1
lap2_100938:
s_bitcmp1_b32 s55,0
s_cbranch_scc0 l2s_100992
s_waitcnt vmcnt(7)
v_max3_u32 v124,v16,v17,v18
v_max_u32 v124,v124,v19
v_cmp_eq_u32 vcc,-1,v124
s_cbranch_vccnz l2s_100992
s_bitset0_b32 s55,0
v_smfmac_f32_16x16x64_bf16 v[64:67],v[16:19],a[32:39],v1
v_smfmac_f32_16x16x64_bf16 v[68:71],v[16:19],a[40:47],v1
v_smfmac_f32_16x16x64_bf16 v[72:75],v[16:19],a[48:55],v1
v_smfmac_f32_16x16x64_bf16 v[76:79],v[16:19],a[56:63],v1
l2s_100992:
s_bitcmp1_b32 s55,1
s_cbranch_scc0 l2s_100994
s_waitcnt vmcnt(5)
v_max3_u32 v124,v20,v21,v22
v_max_u32 v124,v124,v23
v_cmp_eq_u32 vcc,-1,v124
s_cbranch_vccnz l2s_100994
s_bitset0_b32 s55,1
v_smfmac_f32_16x16x64_bf16 v[64:67],v[20:23],a[96:103],v1
v_smfmac_f32_16x16x64_bf16 v[68:71],v[20:23],a[104:111],v1
v_smfmac_f32_16x16x64_bf16 v[72:75],v[20:23],a[112:119],v1
v_smfmac_f32_16x16x64_bf16 v[76:79],v[20:23],a[120:127],v1
l2s_100994:
s_bitcmp1_b32 s55,2
s_cbranch_scc0 l2s_100996
s_waitcnt vmcnt(3)
v_max3_u32 v124,v24,v25,v26
v_max_u32 v124,v124,v27
v_cmp_eq_u32 vcc,-1,v124
s_cbranch_vccnz l2s_100996
s_bitset0_b32 s55,2
v_smfmac_f32_16x16x64_bf16 v[64:67],v[24:27],a[160:167],v1
v_smfmac_f32_16x16x64_bf16 v[68:71],v[24:27],a[168:175],v1
v_smfmac_f32_16x16x64_bf16 v[72:75],v[24:27],a[176:183],v1
v_smfmac_f32_16x16x64_bf16 v[76:79],v[24:27],a[184:191],v1
l2s_100996:
s_bitcmp1_b32 s55,3
s_cbranch_scc0 l2s_100998
s_waitcnt vmcnt(0)
v_max3_u32 v124,v28,v29,v30
v_max_u32 v124,v124,v31
v_cmp_eq_u32 vcc,-1,v124
s_cbranch_vccnz l2s_100998
s_bitset0_b32 s55,3
v_smfmac_f32_16x16x64_bf16 v[64:67],v[28:31],a[224:231],v1
v_smfmac_f32_16x16x64_bf16 v[68:71],v[28:31],a[232:239],v1
v_smfmac_f32_16x16x64_bf16 v[72:75],v[28:31],a[240:247],v1
v_smfmac_f32_16x16x64_bf16 v[76:79],v[28:31],a[248:255],v1
l2s_100998:
s_cmp_eq_u32 s55,0
s_cbranch_scc0 lfb_100939
Ldone_100940:
s_waitcnt vmcnt(6)
v_max3_u32 v124,v32,v33,v34
v_max_u32 v124,v124,v35
v_cmp_eq_u32 vcc,-1,v124
s_cbranch_vccnz flb_100735
s_branch segb_100719
lfb_100939:
s_bitcmp1_b32 s55,0
s_cbranch_scc0 dsk_101000
buffer_load_dwordx4 v[16:19],v0,s[20:23],s92 offen offset:0 sc1
dsk_101000:
s_bitcmp1_b32 s55,1
s_cbranch_scc0 dsk_101001
buffer_load_dwordx4 v[20:23],v0,s[20:23],s92 offen offset:1024 sc1
dsk_101001:
s_bitcmp1_b32 s55,2
s_cbranch_scc0 dsk_101002
buffer_load_dwordx4 v[24:27],v0,s[20:23],s92 offen offset:2048 sc1
dsk_101002:
s_bitcmp1_b32 s55,3
s_cbranch_scc0 dsk_101003
buffer_load_dwordx4 v[28:31],v0,s[20:23],s92 offen offset:3072 sc1
dsk_101003:
s_bitcmp1_b32 s55,0
s_cbranch_scc0 dsk_101004
s_waitcnt vmcnt(2)
v_max3_u32 v124,v16,v17,v18
v_max_u32 v124,v124,v19
v_cmp_eq_u32 vcc,-1,v124
s_cbranch_vccz dgo_101005
s_nop 15
buffer_load_dwordx4 v[104:107],v0,s[20:23],s92 offen offset:0 sc1
s_nop 15
buffer_load_dwordx4 v[108:111],v0,s[20:23],s92 offen offset:0 sc1
dlp_101006:
s_waitcnt vmcnt(2)
v_max3_u32 v124,v16,v17,v18
v_max_u32 v124,v124,v19
v_cmp_eq_u32 vcc,-1,v124
s_cbranch_vccz dgo_101005
buffer_load_dwordx4 v[16:19],v0,s[20:23],s92 offen offset:0 sc1
s_waitcnt vmcnt(2)
v_max3_u32 v124,v104,v105,v106
v_max_u32 v124,v124,v107
v_cmp_eq_u32 vcc,-1,v124
s_cbranch_vccz dcp_101008
buffer_load_dwordx4 v[104:107],v0,s[20:23],s92 offen offset:0 sc1
s_waitcnt vmcnt(2)
v_max3_u32 v124,v108,v109,v110
v_max_u32 v124,v124,v111
v_cmp_eq_u32 vcc,-1,v124
s_cbranch_vccz dcp_101009
buffer_load_dwordx4 v[108:111],v0,s[20:23],s92 offen offset:0 sc1
s_sub_u32 s90,s90,1
s_cmp_gt_i32 s90,0
s_cbranch_scc1 dlp_101006
s_branch dgo_101005
dcp_101008:
v_mov_b32 v16,v104
v_mov_b32 v17,v105
v_mov_b32 v18,v106
v_mov_b32 v19,v107
s_nop 1
s_branch dgo_101005
dcp_101009:
v_mov_b32 v16,v108
v_mov_b32 v17,v109
v_mov_b32 v18,v110
v_mov_b32 v19,v111
s_nop 1
dgo_101005:
v_smfmac_f32_16x16x64_bf16 v[64:67],v[16:19],a[32:39],v1
v_smfmac_f32_16x16x64_bf16 v[68:71],v[16:19],a[40:47],v1
v_smfmac_f32_16x16x64_bf16 v[72:75],v[16:19],a[48:55],v1
v_smfmac_f32_16x16x64_bf16 v[76:79],v[16:19],a[56:63],v1
dsk_101004:
s_bitcmp1_b32 s55,1
s_cbranch_scc0 dsk_101010
s_waitcnt vmcnt(2)
v_max3_u32 v124,v20,v21,v22
v_max_u32 v124,v124,v23
v_cmp_eq_u32 vcc,-1,v124
s_cbranch_vccz dgo_101011
s_nop 15
buffer_load_dwordx4 v[104:107],v0,s[20:23],s92 offen offset:1024 sc1
s_nop 15
buffer_load_dwordx4 v[108:111],v0,s[20:23],s92 offen offset:1024 sc1
dlp_101012:
s_waitcnt vmcnt(2)
v_max3_u32 v124,v20,v21,v22
v_max_u32 v124,v124,v23
v_cmp_eq_u32 vcc,-1,v124
s_cbranch_vccz dgo_101011
buffer_load_dwordx4 v[20:23],v0,s[20:23],s92 offen offset:1024 sc1
s_waitcnt vmcnt(2)
v_max3_u32 v124,v104,v105,v106
v_max_u32 v124,v124,v107
v_cmp_eq_u32 vcc,-1,v124
s_cbranch_vccz dcp_101014
buffer_load_dwordx4 v[104:107],v0,s[20:23],s92 offen offset:1024 sc1
s_waitcnt vmcnt(2)
v_max3_u32 v124,v108,v109,v110
v_max_u32 v124,v124,v111
v_cmp_eq_u32 vcc,-1,v124
s_cbranch_vccz dcp_101015
buffer_load_dwordx4 v[108:111],v0,s[20:23],s92 offen offset:1024 sc1
s_sub_u32 s90,s90,1
s_cmp_gt_i32 s90,0
s_cbranch_scc1 dlp_101012
s_branch dgo_101011
dcp_101014:
v_mov_b32 v20,v104
v_mov_b32 v21,v105
v_mov_b32 v22,v106
v_mov_b32 v23,v107
s_nop 1
s_branch dgo_101011
dcp_101015:
v_mov_b32 v20,v108
v_mov_b32 v21,v109
v_mov_b32 v22,v110
v_mov_b32 v23,v111
s_nop 1
dgo_101011:
v_smfmac_f32_16x16x64_bf16 v[64:67],v[20:23],a[96:103],v1
v_smfmac_f32_16x16x64_bf16 v[68:71],v[20:23],a[104:111],v1
v_smfmac_f32_16x16x64_bf16 v[72:75],v[20:23],a[112:119],v1
v_smfmac_f32_16x16x64_bf16 v[76:79],v[20:23],a[120:127],v1
dsk_101010:
s_bitcmp1_b32 s55,2
s_cbranch_scc0 dsk_101016
s_waitcnt vmcnt(2)
v_max3_u32 v124,v24,v25,v26
v_max_u32 v124,v124,v27
v_cmp_eq_u32 vcc,-1,v124
s_cbranch_vccz dgo_101017
s_nop 15
buffer_load_dwordx4 v[104:107],v0,s[20:23],s92 offen offset:2048 sc1
s_nop 15
buffer_load_dwordx4 v[108:111],v0,s[20:23],s92 offen offset:2048 sc1
dlp_101018:
s_waitcnt vmcnt(2)
v_max3_u32 v124,v24,v25,v26
v_max_u32 v124,v124,v27
v_cmp_eq_u32 vcc,-1,v124
s_cbranch_vccz dgo_101017
buffer_load_dwordx4 v[24:27],v0,s[20:23],s92 offen offset:2048 sc1
s_waitcnt vmcnt(2)
v_max3_u32 v124,v104,v105,v106
v_max_u32 v124,v124,v107
v_cmp_eq_u32 vcc,-1,v124
s_cbranch_vccz dcp_101020
buffer_load_dwordx4 v[104:107],v0,s[20:23],s92 offen offset:2048 sc1
s_waitcnt vmcnt(2)
v_max3_u32 v124,v108,v109,v110
v_max_u32 v124,v124,v111
v_cmp_eq_u32 vcc,-1,v124
s_cbranch_vccz dcp_101021
buffer_load_dwordx4 v[108:111],v0,s[20:23],s92 offen offset:2048 sc1
s_sub_u32 s90,s90,1
s_cmp_gt_i32 s90,0
s_cbranch_scc1 dlp_101018
s_branch dgo_101017
dcp_101020:
v_mov_b32 v24,v104
v_mov_b32 v25,v105
v_mov_b32 v26,v106
v_mov_b32 v27,v107
s_nop 1
s_branch dgo_101017
dcp_101021:
v_mov_b32 v24,v108
v_mov_b32 v25,v109
v_mov_b32 v26,v110
v_mov_b32 v27,v111
s_nop 1
dgo_101017:
v_smfmac_f32_16x16x64_bf16 v[64:67],v[24:27],a[160:167],v1
v_smfmac_f32_16x16x64_bf16 v[68:71],v[24:27],a[168:175],v1
v_smfmac_f32_16x16x64_bf16 v[72:75],v[24:27],a[176:183],v1
v_smfmac_f32_16x16x64_bf16 v[76:79],v[24:27],a[184:191],v1
dsk_101016:
s_bitcmp1_b32 s55,3
s_cbranch_scc0 dsk_101022
s_waitcnt vmcnt(2)
v_max3_u32 v124,v28,v29,v30
v_max_u32 v124,v124,v31
v_cmp_eq_u32 vcc,-1,v124
s_cbranch_vccz dgo_101023
s_nop 15
buffer_load_dwordx4 v[104:107],v0,s[20:23],s92 offen offset:3072 sc1
s_nop 15
buffer_load_dwordx4 v[108:111],v0,s[20:23],s92 offen offset:3072 sc1
dlp_101024:
s_waitcnt vmcnt(2)
v_max3_u32 v124,v28,v29,v30
v_max_u32 v124,v124,v31
v_cmp_eq_u32 vcc,-1,v124
s_cbranch_vccz dgo_101023
buffer_load_dwordx4 v[28:31],v0,s[20:23],s92 offen offset:3072 sc1
s_waitcnt vmcnt(2)
v_max3_u32 v124,v104,v105,v106
v_max_u32 v124,v124,v107
v_cmp_eq_u32 vcc,-1,v124
s_cbranch_vccz dcp_101026
buffer_load_dwordx4 v[104:107],v0,s[20:23],s92 offen offset:3072 sc1
s_waitcnt vmcnt(2)
v_max3_u32 v124,v108,v109,v110
v_max_u32 v124,v124,v111
v_cmp_eq_u32 vcc,-1,v124
s_cbranch_vccz dcp_101027
buffer_load_dwordx4 v[108:111],v0,s[20:23],s92 offen offset:3072 sc1
s_sub_u32 s90,s90,1
s_cmp_gt_i32 s90,0
s_cbranch_scc1 dlp_101024
s_branch dgo_101023
dcp_101026:
v_mov_b32 v28,v104
v_mov_b32 v29,v105
v_mov_b32 v30,v106
v_mov_b32 v31,v107
s_nop 1
s_branch dgo_101023
dcp_101027:
v_mov_b32 v28,v108
v_mov_b32 v29,v109
v_mov_b32 v30,v110
v_mov_b32 v31,v111
s_nop 1
dgo_101023:
v_smfmac_f32_16x16x64_bf16 v[64:67],v[28:31],a[224:231],v1
v_smfmac_f32_16x16x64_bf16 v[68:71],v[28:31],a[232:239],v1
v_smfmac_f32_16x16x64_bf16 v[72:75],v[28:31],a[240:247],v1
v_smfmac_f32_16x16x64_bf16 v[76:79],v[28:31],a[248:255],v1
dsk_101022:
s_mov_b32 s55,0
s_branch Ldone_100940
slowA_100739:
buffer_load_dwordx4 v[44:47],v0,s[20:23],s93 offen offset:3072 sc1
dsk_101028:
s_bitcmp1_b32 s55,7
s_cbranch_scc0 dsk_101029
s_waitcnt vmcnt(2)
v_max3_u32 v124,v44,v45,v46
v_max_u32 v124,v124,v47
v_cmp_eq_u32 vcc,-1,v124
s_cbranch_vccz dgo_101030
s_nop 15
s_nop 3
buffer_load_dwordx4 v[104:107],v0,s[20:23],s93 offen offset:3072 sc1
s_nop 15
s_nop 3
buffer_load_dwordx4 v[108:111],v0,s[20:23],s93 offen offset:3072 sc1
dlp_101031:
s_waitcnt vmcnt(2)
v_max3_u32 v124,v44,v45,v46
v_max_u32 v124,v124,v47
v_cmp_eq_u32 vcc,-1,v124
s_cbranch_vccz dgo_101030
buffer_load_dwordx4 v[44:47],v0,s[20:23],s93 offen offset:3072 sc1
s_waitcnt vmcnt(2)
v_max3_u32 v124,v104,v105,v106
v_max_u32 v124,v124,v107
v_cmp_eq_u32 vcc,-1,v124
s_cbranch_vccz dcp_101033
buffer_load_dwordx4 v[104:107],v0,s[20:23],s93 offen offset:3072 sc1
s_waitcnt vmcnt(2)
v_max3_u32 v124,v108,v109,v110
v_max_u32 v124,v124,v111
v_cmp_eq_u32 vcc,-1,v124
s_cbranch_vccz dcp_101034
buffer_load_dwordx4 v[108:111],v0,s[20:23],s93 offen offset:3072 sc1
s_sub_u32 s90,s90,1
s_cmp_gt_i32 s90,0
s_cbranch_scc1 dlp_101031
s_branch dgo_101030
dcp_101033:
v_mov_b32 v44,v104
v_mov_b32 v45,v105
v_mov_b32 v46,v106
v_mov_b32 v47,v107
s_nop 1
s_branch dgo_101030
dcp_101034:
v_mov_b32 v44,v108
v_mov_b32 v45,v109
v_mov_b32 v46,v110
v_mov_b32 v47,v111
s_nop 1
dgo_101030:
dsk_101029:
s_mov_b32 s55,0
s_branch segb_100721
recfin_100248:
s_endpgm
.section .rodata,"a"
.p2align 6
.amdhsa_kernel flow_kernel
  .amdhsa_next_free_vgpr 512
  .amdhsa_next_free_sgpr 102
  .amdhsa_accum_offset 256
  .amdhsa_group_segment_fixed_size 0
  .amdhsa_kernarg_size 136
  .amdhsa_user_sgpr_count 2
  .amdhsa_user_sgpr_kernarg_segment_ptr 1
  .amdhsa_system_sgpr_workgroup_id_x 1
.end_amdhsa_kernel
```

```asm
; @launch kernel=flow_kernel grid=(256,1,1) block=(256,1,1) lds=163840
.amdgcn_target "amdgcn-amd-amdhsa--gfx950"
.text
.globl flow_kernel
.p2align 8
.type flow_kernel,@function
flow_kernel:
s_cmp_ge_u32 s2,256
s_cbranch_scc1 done_1
s_lshr_b32 s49,s2,3
s_load_dwordx2 s[18:19],s[0:1],128
s_load_dwordx2 s[2:3],s[0:1],120
s_load_dwordx2 s[4:5],s[0:1],0
s_getreg_b32 s51,hwreg(HW_REG_XCC_ID)
v_lshrrev_b32 v2,6,v0
v_and_b32 v1,63,v0
s_and_b32 s51,s51,7
v_readfirstlane_b32 s50,v2
s_mov_b32 s90,40000
s_mov_b32 s56,2
s_mov_b32 s88,64
s_lshl_b32 s64,s51,2
s_lshr_b32 s64,0x76325410,s64
s_and_b32 s64,s64,7
s_lshl_b32 s58,s64,5
s_add_u32 s58,s58,s49
s_waitcnt lgkmcnt(0)
s_mov_b32 s20,s18
s_and_b32 s21,s19,0xffff
s_mov_b32 s22,0x10000000
s_mov_b32 s23,0x20000
s_cmp_lg_u32 s50,0
s_cbranch_scc1 fl_disp0
s_mov_b32 s92,s2
s_and_b32 s93,s3,0xffff
s_mov_b32 s94,0x100
s_mov_b32 s95,0x20000
s_lshl_b32 s64,1,s49
v_mov_b32 v2,s64
v_mov_b32 v3,0x100
s_lshl_b32 s64,s51,3
s_mov_b64 exec,1
buffer_atomic_add_x2 v[2:3],off,s[92:95],s64 sc1
s_mov_b64 exec,-1
fl_disp0:
v_mbcnt_lo_u32_b32 v1,-1,0
v_mbcnt_hi_u32_b32 v1,-1,v1
s_sub_u32 s59,s58,64
s_cbranch_scc0 nx_3
s_branch fl_rec
nx_3:
s_cmp_lt_u32 s58,128
s_cbranch_scc0 nx_4
s_branch fl_qkv
nx_4:
s_cmp_ge_u32 s58,192
s_cbranch_scc1 fl_dutb
s_load_dwordx4 s[4:7],s[0:1],96
s_load_dwordx2 s[8:9],s[0:1],0
s_sub_u32 s59,s58,128
s_and_b32 s52,s59,15
s_lshr_b32 s53,s59,4
s_lshl_b32 s64,s50,6
v_add_u32 v14,s64,v1
v_lshrrev_b32 v2,4,v14
v_and_b32 v3,15,v14
v_mul_u32_u24 v13,196608,v2
v_lshl_add_u32 v13,v3,4,v13
s_mul_i32 s54,s53,3145728
s_lshl_b32 s64,s52,8
s_add_u32 s54,s54,s64
s_add_u32 s54,s54,0
v_lshlrev_b32 v15,1,v14
s_lshl_b32 s55,s53,9
s_mov_b32 s60,0
s_mov_b32 s73,0xffff0000
s_sub_u32 s61,s58,128
s_lshl_b32 s61,s61,15
v_lshlrev_b32 v25,6,v2
v_lshlrev_b32 v24,4,v1
v_and_b32 v2,3,v1
v_lshrrev_b32 v3,2,v1
s_lshl_b32 s64,s60,2
v_add_u32 v4,s64,v2
s_lshl_b32 s65,s50,9
v_lshlrev_b32 v5,4,v3
v_add_u32 v5,s65,v5
v_lshl_add_u32 v8,v4,11,v5
v_lshlrev_b32 v9,1,v5
v_lshrrev_b32 v5,2,v3
v_and_b32 v3,3,v3
s_lshl_b32 s65,s50,13
v_lshlrev_b32 v5,10,v5
v_lshl_add_u32 v5,v3,8,v5
v_lshl_add_u32 v5,v4,4,v5
v_add_u32 v10,s65,v5
s_lshl_b32 s65,s50,9
v_lshlrev_b32 v5,3,v1
v_add_u32 v11,s65,v5
v_lshlrev_b32 v12,3,v2
s_waitcnt lgkmcnt(0)
s_mov_b32 s24,s4
s_and_b32 s25,s5,0xffff
s_mov_b32 s26,0x800
s_mov_b32 s27,0x20000
s_mov_b32 s28,s6
s_and_b32 s29,s7,0xffff
s_mov_b32 s30,0xc00000
s_mov_b32 s31,0x20000
s_mov_b32 s32,s8
s_and_b32 s33,s9,0xffff
s_mov_b32 s34,0x400000
s_mov_b32 s35,0x20000
v_mov_b32 v28,-1
v_mov_b32 v20,0
v_mov_b32 v29,-1
v_mov_b32 v21,0
v_mov_b32 v30,-1
v_mov_b32 v22,0
v_mov_b32 v31,-1
v_mov_b32 v23,0
buffer_load_ushort v16,v15,s[24:27],s55 offen
buffer_load_dwordx4 v[96:99],v13,s[28:31],s54 offen offset:0
s_add_u32 s54,s54,12288
buffer_load_dwordx4 v[100:103],v13,s[28:31],s54 offen offset:0
s_add_u32 s54,s54,12288
buffer_load_dwordx4 v[104:107],v13,s[28:31],s54 offen offset:0
s_add_u32 s54,s54,12288
buffer_load_dwordx4 v[108:111],v13,s[28:31],s54 offen offset:0
s_add_u32 s54,s54,12288
buffer_load_dwordx4 v[112:115],v13,s[28:31],s54 offen offset:0
s_add_u32 s54,s54,12288
buffer_load_dwordx4 v[116:119],v13,s[28:31],s54 offen offset:0
s_add_u32 s54,s54,12288
buffer_load_dwordx4 v[120:123],v13,s[28:31],s54 offen offset:0
s_add_u32 s54,s54,12288
buffer_load_dwordx4 v[124:127],v13,s[28:31],s54 offen offset:0
s_add_u32 s54,s54,12288
buffer_load_dwordx4 v[128:131],v13,s[28:31],s54 offen offset:0
s_add_u32 s54,s54,12288
buffer_load_dwordx4 v[132:135],v13,s[28:31],s54 offen offset:0
s_add_u32 s54,s54,12288
buffer_load_dwordx4 v[136:139],v13,s[28:31],s54 offen offset:0
s_add_u32 s54,s54,12288
buffer_load_dwordx4 v[140:143],v13,s[28:31],s54 offen offset:0
s_add_u32 s54,s54,12288
buffer_load_dwordx4 v[144:147],v13,s[28:31],s54 offen offset:0
s_add_u32 s54,s54,12288
buffer_load_dwordx4 v[148:151],v13,s[28:31],s54 offen offset:0
s_add_u32 s54,s54,12288
buffer_load_dwordx4 v[152:155],v13,s[28:31],s54 offen offset:0
s_add_u32 s54,s54,12288
buffer_load_dwordx4 v[156:159],v13,s[28:31],s54 offen offset:0
s_add_u32 s64,s61,0
buffer_load_dwordx4 v[48:51],v8,s[32:35],s64 offen offset:0
buffer_load_dwordx4 v[52:55],v8,s[32:35],s64 offen offset:256
s_add_u32 s64,s61,8192
buffer_load_dwordx4 v[56:59],v8,s[32:35],s64 offen offset:0
buffer_load_dwordx4 v[60:63],v8,s[32:35],s64 offen offset:256
s_add_u32 s64,s61,16384
buffer_load_dwordx4 v[64:67],v8,s[32:35],s64 offen offset:0
buffer_load_dwordx4 v[68:71],v8,s[32:35],s64 offen offset:256
s_add_u32 s64,s61,24576
buffer_load_dwordx4 v[72:75],v8,s[32:35],s64 offen offset:0
buffer_load_dwordx4 v[76:79],v8,s[32:35],s64 offen offset:256
s_waitcnt vmcnt(24)
v_lshlrev_b32 v16,16,v16
v_mul_f32 v17,0xbfb8aa3b,v16
v_exp_f32 v17,v17
s_nop 0
v_add_f32 v17,1.0,v17
v_rcp_f32 v17,v17
s_nop 0
v_mul_f32 v17,v17,v16
v_cvt_pk_bf16_f32 v17,v17,v17
v_and_b32 v17,s73,v17
v_lshlrev_b32 v18,2,v14
ds_write_b32 v18,v17 offset:8192
s_waitcnt lgkmcnt(0)
s_barrier
ds_read_b128 v[32:35],v25 offset:8192
ds_read_b128 v[36:39],v25 offset:8208
ds_read_b128 v[40:43],v25 offset:8224
ds_read_b128 v[44:47],v25 offset:8240
v_mov_b32 v80,0
v_mov_b32 v81,0
v_mov_b32 v82,0
v_mov_b32 v83,0
v_mov_b32 v84,0
v_mov_b32 v85,0
v_mov_b32 v86,0
v_mov_b32 v87,0
s_waitcnt lgkmcnt(0)
s_waitcnt vmcnt(23)
v_lshlrev_b32 v16,16,v96
v_and_b32 v17,s73,v96
v_pk_fma_f32 v[80:81],v[16:17],v[32:33],v[80:81] op_sel:[0,0,0] op_sel_hi:[1,0,1]
v_lshlrev_b32 v18,16,v97
v_and_b32 v19,s73,v97
v_pk_fma_f32 v[82:83],v[18:19],v[32:33],v[82:83] op_sel:[0,0,0] op_sel_hi:[1,0,1]
v_lshlrev_b32 v16,16,v98
v_and_b32 v17,s73,v98
v_pk_fma_f32 v[84:85],v[16:17],v[32:33],v[84:85] op_sel:[0,0,0] op_sel_hi:[1,0,1]
v_lshlrev_b32 v18,16,v99
v_and_b32 v19,s73,v99
v_pk_fma_f32 v[86:87],v[18:19],v[32:33],v[86:87] op_sel:[0,0,0] op_sel_hi:[1,0,1]
s_waitcnt vmcnt(22)
v_lshlrev_b32 v16,16,v100
v_and_b32 v17,s73,v100
v_pk_fma_f32 v[80:81],v[16:17],v[32:33],v[80:81] op_sel:[0,1,0] op_sel_hi:[1,1,1]
v_lshlrev_b32 v18,16,v101
v_and_b32 v19,s73,v101
v_pk_fma_f32 v[82:83],v[18:19],v[32:33],v[82:83] op_sel:[0,1,0] op_sel_hi:[1,1,1]
v_lshlrev_b32 v16,16,v102
v_and_b32 v17,s73,v102
v_pk_fma_f32 v[84:85],v[16:17],v[32:33],v[84:85] op_sel:[0,1,0] op_sel_hi:[1,1,1]
v_lshlrev_b32 v18,16,v103
v_and_b32 v19,s73,v103
v_pk_fma_f32 v[86:87],v[18:19],v[32:33],v[86:87] op_sel:[0,1,0] op_sel_hi:[1,1,1]
s_waitcnt vmcnt(21)
v_lshlrev_b32 v16,16,v104
v_and_b32 v17,s73,v104
v_pk_fma_f32 v[80:81],v[16:17],v[34:35],v[80:81] op_sel:[0,0,0] op_sel_hi:[1,0,1]
v_lshlrev_b32 v18,16,v105
v_and_b32 v19,s73,v105
v_pk_fma_f32 v[82:83],v[18:19],v[34:35],v[82:83] op_sel:[0,0,0] op_sel_hi:[1,0,1]
v_lshlrev_b32 v16,16,v106
v_and_b32 v17,s73,v106
v_pk_fma_f32 v[84:85],v[16:17],v[34:35],v[84:85] op_sel:[0,0,0] op_sel_hi:[1,0,1]
v_lshlrev_b32 v18,16,v107
v_and_b32 v19,s73,v107
v_pk_fma_f32 v[86:87],v[18:19],v[34:35],v[86:87] op_sel:[0,0,0] op_sel_hi:[1,0,1]
s_waitcnt vmcnt(20)
v_lshlrev_b32 v16,16,v108
v_and_b32 v17,s73,v108
v_pk_fma_f32 v[80:81],v[16:17],v[34:35],v[80:81] op_sel:[0,1,0] op_sel_hi:[1,1,1]
v_lshlrev_b32 v18,16,v109
v_and_b32 v19,s73,v109
v_pk_fma_f32 v[82:83],v[18:19],v[34:35],v[82:83] op_sel:[0,1,0] op_sel_hi:[1,1,1]
v_lshlrev_b32 v16,16,v110
v_and_b32 v17,s73,v110
v_pk_fma_f32 v[84:85],v[16:17],v[34:35],v[84:85] op_sel:[0,1,0] op_sel_hi:[1,1,1]
v_lshlrev_b32 v18,16,v111
v_and_b32 v19,s73,v111
v_pk_fma_f32 v[86:87],v[18:19],v[34:35],v[86:87] op_sel:[0,1,0] op_sel_hi:[1,1,1]
s_waitcnt vmcnt(19)
v_lshlrev_b32 v16,16,v112
v_and_b32 v17,s73,v112
v_pk_fma_f32 v[80:81],v[16:17],v[36:37],v[80:81] op_sel:[0,0,0] op_sel_hi:[1,0,1]
v_lshlrev_b32 v18,16,v113
v_and_b32 v19,s73,v113
v_pk_fma_f32 v[82:83],v[18:19],v[36:37],v[82:83] op_sel:[0,0,0] op_sel_hi:[1,0,1]
v_lshlrev_b32 v16,16,v114
v_and_b32 v17,s73,v114
v_pk_fma_f32 v[84:85],v[16:17],v[36:37],v[84:85] op_sel:[0,0,0] op_sel_hi:[1,0,1]
v_lshlrev_b32 v18,16,v115
v_and_b32 v19,s73,v115
v_pk_fma_f32 v[86:87],v[18:19],v[36:37],v[86:87] op_sel:[0,0,0] op_sel_hi:[1,0,1]
s_waitcnt vmcnt(18)
v_lshlrev_b32 v16,16,v116
v_and_b32 v17,s73,v116
v_pk_fma_f32 v[80:81],v[16:17],v[36:37],v[80:81] op_sel:[0,1,0] op_sel_hi:[1,1,1]
v_lshlrev_b32 v18,16,v117
v_and_b32 v19,s73,v117
v_pk_fma_f32 v[82:83],v[18:19],v[36:37],v[82:83] op_sel:[0,1,0] op_sel_hi:[1,1,1]
v_lshlrev_b32 v16,16,v118
v_and_b32 v17,s73,v118
v_pk_fma_f32 v[84:85],v[16:17],v[36:37],v[84:85] op_sel:[0,1,0] op_sel_hi:[1,1,1]
v_lshlrev_b32 v18,16,v119
v_and_b32 v19,s73,v119
v_pk_fma_f32 v[86:87],v[18:19],v[36:37],v[86:87] op_sel:[0,1,0] op_sel_hi:[1,1,1]
s_waitcnt vmcnt(17)
v_lshlrev_b32 v16,16,v120
v_and_b32 v17,s73,v120
v_pk_fma_f32 v[80:81],v[16:17],v[38:39],v[80:81] op_sel:[0,0,0] op_sel_hi:[1,0,1]
v_lshlrev_b32 v18,16,v121
v_and_b32 v19,s73,v121
v_pk_fma_f32 v[82:83],v[18:19],v[38:39],v[82:83] op_sel:[0,0,0] op_sel_hi:[1,0,1]
v_lshlrev_b32 v16,16,v122
v_and_b32 v17,s73,v122
v_pk_fma_f32 v[84:85],v[16:17],v[38:39],v[84:85] op_sel:[0,0,0] op_sel_hi:[1,0,1]
v_lshlrev_b32 v18,16,v123
v_and_b32 v19,s73,v123
v_pk_fma_f32 v[86:87],v[18:19],v[38:39],v[86:87] op_sel:[0,0,0] op_sel_hi:[1,0,1]
s_waitcnt vmcnt(16)
v_lshlrev_b32 v16,16,v124
v_and_b32 v17,s73,v124
v_pk_fma_f32 v[80:81],v[16:17],v[38:39],v[80:81] op_sel:[0,1,0] op_sel_hi:[1,1,1]
v_lshlrev_b32 v18,16,v125
v_and_b32 v19,s73,v125
v_pk_fma_f32 v[82:83],v[18:19],v[38:39],v[82:83] op_sel:[0,1,0] op_sel_hi:[1,1,1]
v_lshlrev_b32 v16,16,v126
v_and_b32 v17,s73,v126
v_pk_fma_f32 v[84:85],v[16:17],v[38:39],v[84:85] op_sel:[0,1,0] op_sel_hi:[1,1,1]
v_lshlrev_b32 v18,16,v127
v_and_b32 v19,s73,v127
v_pk_fma_f32 v[86:87],v[18:19],v[38:39],v[86:87] op_sel:[0,1,0] op_sel_hi:[1,1,1]
s_waitcnt vmcnt(15)
v_lshlrev_b32 v16,16,v128
v_and_b32 v17,s73,v128
v_pk_fma_f32 v[80:81],v[16:17],v[40:41],v[80:81] op_sel:[0,0,0] op_sel_hi:[1,0,1]
v_lshlrev_b32 v18,16,v129
v_and_b32 v19,s73,v129
v_pk_fma_f32 v[82:83],v[18:19],v[40:41],v[82:83] op_sel:[0,0,0] op_sel_hi:[1,0,1]
v_lshlrev_b32 v16,16,v130
v_and_b32 v17,s73,v130
v_pk_fma_f32 v[84:85],v[16:17],v[40:41],v[84:85] op_sel:[0,0,0] op_sel_hi:[1,0,1]
v_lshlrev_b32 v18,16,v131
v_and_b32 v19,s73,v131
v_pk_fma_f32 v[86:87],v[18:19],v[40:41],v[86:87] op_sel:[0,0,0] op_sel_hi:[1,0,1]
s_waitcnt vmcnt(14)
v_lshlrev_b32 v16,16,v132
v_and_b32 v17,s73,v132
v_pk_fma_f32 v[80:81],v[16:17],v[40:41],v[80:81] op_sel:[0,1,0] op_sel_hi:[1,1,1]
v_lshlrev_b32 v18,16,v133
v_and_b32 v19,s73,v133
v_pk_fma_f32 v[82:83],v[18:19],v[40:41],v[82:83] op_sel:[0,1,0] op_sel_hi:[1,1,1]
v_lshlrev_b32 v16,16,v134
v_and_b32 v17,s73,v134
v_pk_fma_f32 v[84:85],v[16:17],v[40:41],v[84:85] op_sel:[0,1,0] op_sel_hi:[1,1,1]
v_lshlrev_b32 v18,16,v135
v_and_b32 v19,s73,v135
v_pk_fma_f32 v[86:87],v[18:19],v[40:41],v[86:87] op_sel:[0,1,0] op_sel_hi:[1,1,1]
s_waitcnt vmcnt(13)
v_lshlrev_b32 v16,16,v136
v_and_b32 v17,s73,v136
v_pk_fma_f32 v[80:81],v[16:17],v[42:43],v[80:81] op_sel:[0,0,0] op_sel_hi:[1,0,1]
v_lshlrev_b32 v18,16,v137
v_and_b32 v19,s73,v137
v_pk_fma_f32 v[82:83],v[18:19],v[42:43],v[82:83] op_sel:[0,0,0] op_sel_hi:[1,0,1]
v_lshlrev_b32 v16,16,v138
v_and_b32 v17,s73,v138
v_pk_fma_f32 v[84:85],v[16:17],v[42:43],v[84:85] op_sel:[0,0,0] op_sel_hi:[1,0,1]
v_lshlrev_b32 v18,16,v139
v_and_b32 v19,s73,v139
v_pk_fma_f32 v[86:87],v[18:19],v[42:43],v[86:87] op_sel:[0,0,0] op_sel_hi:[1,0,1]
s_waitcnt vmcnt(12)
v_lshlrev_b32 v16,16,v140
v_and_b32 v17,s73,v140
v_pk_fma_f32 v[80:81],v[16:17],v[42:43],v[80:81] op_sel:[0,1,0] op_sel_hi:[1,1,1]
v_lshlrev_b32 v18,16,v141
v_and_b32 v19,s73,v141
v_pk_fma_f32 v[82:83],v[18:19],v[42:43],v[82:83] op_sel:[0,1,0] op_sel_hi:[1,1,1]
v_lshlrev_b32 v16,16,v142
v_and_b32 v17,s73,v142
v_pk_fma_f32 v[84:85],v[16:17],v[42:43],v[84:85] op_sel:[0,1,0] op_sel_hi:[1,1,1]
v_lshlrev_b32 v18,16,v143
v_and_b32 v19,s73,v143
v_pk_fma_f32 v[86:87],v[18:19],v[42:43],v[86:87] op_sel:[0,1,0] op_sel_hi:[1,1,1]
s_waitcnt vmcnt(11)
v_lshlrev_b32 v16,16,v144
v_and_b32 v17,s73,v144
v_pk_fma_f32 v[80:81],v[16:17],v[44:45],v[80:81] op_sel:[0,0,0] op_sel_hi:[1,0,1]
v_lshlrev_b32 v18,16,v145
v_and_b32 v19,s73,v145
v_pk_fma_f32 v[82:83],v[18:19],v[44:45],v[82:83] op_sel:[0,0,0] op_sel_hi:[1,0,1]
v_lshlrev_b32 v16,16,v146
v_and_b32 v17,s73,v146
v_pk_fma_f32 v[84:85],v[16:17],v[44:45],v[84:85] op_sel:[0,0,0] op_sel_hi:[1,0,1]
v_lshlrev_b32 v18,16,v147
v_and_b32 v19,s73,v147
v_pk_fma_f32 v[86:87],v[18:19],v[44:45],v[86:87] op_sel:[0,0,0] op_sel_hi:[1,0,1]
s_waitcnt vmcnt(10)
v_lshlrev_b32 v16,16,v148
v_and_b32 v17,s73,v148
v_pk_fma_f32 v[80:81],v[16:17],v[44:45],v[80:81] op_sel:[0,1,0] op_sel_hi:[1,1,1]
v_lshlrev_b32 v18,16,v149
v_and_b32 v19,s73,v149
v_pk_fma_f32 v[82:83],v[18:19],v[44:45],v[82:83] op_sel:[0,1,0] op_sel_hi:[1,1,1]
v_lshlrev_b32 v16,16,v150
v_and_b32 v17,s73,v150
v_pk_fma_f32 v[84:85],v[16:17],v[44:45],v[84:85] op_sel:[0,1,0] op_sel_hi:[1,1,1]
v_lshlrev_b32 v18,16,v151
v_and_b32 v19,s73,v151
v_pk_fma_f32 v[86:87],v[18:19],v[44:45],v[86:87] op_sel:[0,1,0] op_sel_hi:[1,1,1]
s_waitcnt vmcnt(9)
v_lshlrev_b32 v16,16,v152
v_and_b32 v17,s73,v152
v_pk_fma_f32 v[80:81],v[16:17],v[46:47],v[80:81] op_sel:[0,0,0] op_sel_hi:[1,0,1]
v_lshlrev_b32 v18,16,v153
v_and_b32 v19,s73,v153
v_pk_fma_f32 v[82:83],v[18:19],v[46:47],v[82:83] op_sel:[0,0,0] op_sel_hi:[1,0,1]
v_lshlrev_b32 v16,16,v154
v_and_b32 v17,s73,v154
v_pk_fma_f32 v[84:85],v[16:17],v[46:47],v[84:85] op_sel:[0,0,0] op_sel_hi:[1,0,1]
v_lshlrev_b32 v18,16,v155
v_and_b32 v19,s73,v155
v_pk_fma_f32 v[86:87],v[18:19],v[46:47],v[86:87] op_sel:[0,0,0] op_sel_hi:[1,0,1]
s_waitcnt vmcnt(8)
v_lshlrev_b32 v16,16,v156
v_and_b32 v17,s73,v156
v_pk_fma_f32 v[80:81],v[16:17],v[46:47],v[80:81] op_sel:[0,1,0] op_sel_hi:[1,1,1]
v_lshlrev_b32 v18,16,v157
v_and_b32 v19,s73,v157
v_pk_fma_f32 v[82:83],v[18:19],v[46:47],v[82:83] op_sel:[0,1,0] op_sel_hi:[1,1,1]
v_lshlrev_b32 v16,16,v158
v_and_b32 v17,s73,v158
v_pk_fma_f32 v[84:85],v[16:17],v[46:47],v[84:85] op_sel:[0,1,0] op_sel_hi:[1,1,1]
v_lshlrev_b32 v18,16,v159
v_and_b32 v19,s73,v159
v_pk_fma_f32 v[86:87],v[18:19],v[46:47],v[86:87] op_sel:[0,1,0] op_sel_hi:[1,1,1]
v_lshlrev_b32 v18,5,v14
ds_write_b128 v18,v[80:83] offset:16384
ds_write_b128 v18,v[84:87] offset:16400
v_and_b32 v18,127,v14
v_lshlrev_b32 v18,2,v18
v_lshrrev_b32 v19,7,v14
v_mov_b32 v19,v18
s_waitcnt lgkmcnt(0)
s_barrier
ds_read_b32 v32,v19 offset:16384
ds_read_b32 v33,v19 offset:16896
ds_read_b32 v34,v19 offset:17408
ds_read_b32 v35,v19 offset:17920
ds_read_b32 v36,v19 offset:18432
ds_read_b32 v37,v19 offset:18944
ds_read_b32 v38,v19 offset:19456
ds_read_b32 v39,v19 offset:19968
ds_read_b32 v40,v19 offset:20480
ds_read_b32 v41,v19 offset:20992
ds_read_b32 v42,v19 offset:21504
ds_read_b32 v43,v19 offset:22016
s_waitcnt lgkmcnt(4)
ds_read_b32 v44,v19 offset:22528
ds_read_b32 v45,v19 offset:23040
ds_read_b32 v46,v19 offset:23552
ds_read_b32 v47,v19 offset:24064
s_waitcnt lgkmcnt(0)
v_pk_add_f32 v[32:33],v[32:33],v[40:41]
v_pk_add_f32 v[34:35],v[34:35],v[42:43]
v_pk_add_f32 v[36:37],v[36:37],v[44:45]
v_pk_add_f32 v[38:39],v[38:39],v[46:47]
v_pk_add_f32 v[32:33],v[32:33],v[36:37]
v_pk_add_f32 v[34:35],v[34:35],v[38:39]
v_pk_add_f32 v[32:33],v[32:33],v[34:35]
v_add_f32 v32,v32,v33
s_mul_i32 s64,s53,24576
s_lshl_b32 s65,s52,9
s_add_u32 s64,s64,s65
s_add_u32 s64,s64,267386880
buffer_store_dword v32,v18,s[20:23],s64 offen sc1
s_waitcnt vmcnt(0)
s_barrier
s_cmp_lg_u32 s50,0
s_cbranch_scc1 sig_5
s_mov_b32 s92,s2
s_and_b32 s93,s3,0xffff
s_mov_b32 s94,0x100
s_mov_b32 s95,0x20000
s_add_u32 s64,s88,0
v_mov_b32 v16,1
s_mov_b64 exec,1
buffer_atomic_add v16,off,s[92:95],s64 sc1
s_mov_b64 exec,-1
sig_5:
v_lshlrev_b32 v128,16,v48
v_and_b32 v129,s73,v48
v_lshlrev_b32 v130,16,v49
v_and_b32 v131,s73,v49
v_lshlrev_b32 v132,16,v50
v_and_b32 v133,s73,v50
v_lshlrev_b32 v134,16,v51
v_and_b32 v135,s73,v51
v_lshlrev_b32 v136,16,v52
v_and_b32 v137,s73,v52
v_lshlrev_b32 v138,16,v53
v_and_b32 v139,s73,v53
v_lshlrev_b32 v140,16,v54
v_and_b32 v141,s73,v54
v_lshlrev_b32 v142,16,v55
v_and_b32 v143,s73,v55
v_lshlrev_b32 v144,16,v56
v_and_b32 v145,s73,v56
v_lshlrev_b32 v146,16,v57
v_and_b32 v147,s73,v57
v_lshlrev_b32 v148,16,v58
v_and_b32 v149,s73,v58
v_lshlrev_b32 v150,16,v59
v_and_b32 v151,s73,v59
v_lshlrev_b32 v152,16,v60
v_and_b32 v153,s73,v60
v_lshlrev_b32 v154,16,v61
v_and_b32 v155,s73,v61
v_lshlrev_b32 v156,16,v62
v_and_b32 v157,s73,v62
v_lshlrev_b32 v158,16,v63
v_and_b32 v159,s73,v63
v_lshlrev_b32 v160,16,v64
v_and_b32 v161,s73,v64
v_lshlrev_b32 v162,16,v65
v_and_b32 v163,s73,v65
v_lshlrev_b32 v164,16,v66
v_and_b32 v165,s73,v66
v_lshlrev_b32 v166,16,v67
v_and_b32 v167,s73,v67
v_lshlrev_b32 v168,16,v68
v_and_b32 v169,s73,v68
v_lshlrev_b32 v170,16,v69
v_and_b32 v171,s73,v69
v_lshlrev_b32 v172,16,v70
v_and_b32 v173,s73,v70
v_lshlrev_b32 v174,16,v71
v_and_b32 v175,s73,v71
v_lshlrev_b32 v176,16,v72
v_and_b32 v177,s73,v72
v_lshlrev_b32 v178,16,v73
v_and_b32 v179,s73,v73
v_lshlrev_b32 v180,16,v74
v_and_b32 v181,s73,v74
v_lshlrev_b32 v182,16,v75
v_and_b32 v183,s73,v75
v_lshlrev_b32 v184,16,v76
v_and_b32 v185,s73,v76
v_lshlrev_b32 v186,16,v77
v_and_b32 v187,s73,v77
v_lshlrev_b32 v188,16,v78
v_and_b32 v189,s73,v78
v_lshlrev_b32 v190,16,v79
v_and_b32 v191,s73,v79
v_add_f32 v208,v128,v129
v_mul_f32 v209,v128,v128
v_add_f32 v210,v130,v131
v_mul_f32 v211,v129,v129
v_fmac_f32 v209,v130,v130
v_fmac_f32 v211,v131,v131
v_add_f32 v208,v208,v132
v_fmac_f32 v209,v132,v132
v_add_f32 v210,v210,v133
v_fmac_f32 v211,v133,v133
v_add_f32 v208,v208,v134
v_fmac_f32 v209,v134,v134
v_add_f32 v210,v210,v135
v_fmac_f32 v211,v135,v135
v_add_f32 v208,v208,v136
v_fmac_f32 v209,v136,v136
v_add_f32 v210,v210,v137
v_fmac_f32 v211,v137,v137
v_add_f32 v208,v208,v138
v_fmac_f32 v209,v138,v138
v_add_f32 v210,v210,v139
v_fmac_f32 v211,v139,v139
v_add_f32 v208,v208,v140
v_fmac_f32 v209,v140,v140
v_add_f32 v210,v210,v141
v_fmac_f32 v211,v141,v141
v_add_f32 v208,v208,v142
v_fmac_f32 v209,v142,v142
v_add_f32 v210,v210,v143
v_fmac_f32 v211,v143,v143
v_add_f32 v208,v208,v210
v_add_f32 v209,v209,v211
v_add_f32 v212,v144,v145
v_mul_f32 v213,v144,v144
v_add_f32 v214,v146,v147
v_mul_f32 v215,v145,v145
v_fmac_f32 v213,v146,v146
v_fmac_f32 v215,v147,v147
v_add_f32 v212,v212,v148
v_fmac_f32 v213,v148,v148
v_add_f32 v214,v214,v149
v_fmac_f32 v215,v149,v149
v_add_f32 v212,v212,v150
v_fmac_f32 v213,v150,v150
v_add_f32 v214,v214,v151
v_fmac_f32 v215,v151,v151
v_add_f32 v212,v212,v152
v_fmac_f32 v213,v152,v152
v_add_f32 v214,v214,v153
v_fmac_f32 v215,v153,v153
v_add_f32 v212,v212,v154
v_fmac_f32 v213,v154,v154
v_add_f32 v214,v214,v155
v_fmac_f32 v215,v155,v155
v_add_f32 v212,v212,v156
v_fmac_f32 v213,v156,v156
v_add_f32 v214,v214,v157
v_fmac_f32 v215,v157,v157
v_add_f32 v212,v212,v158
v_fmac_f32 v213,v158,v158
v_add_f32 v214,v214,v159
v_fmac_f32 v215,v159,v159
v_add_f32 v212,v212,v214
v_add_f32 v213,v213,v215
v_add_f32 v216,v160,v161
v_mul_f32 v217,v160,v160
v_add_f32 v218,v162,v163
v_mul_f32 v219,v161,v161
v_fmac_f32 v217,v162,v162
v_fmac_f32 v219,v163,v163
v_add_f32 v216,v216,v164
v_fmac_f32 v217,v164,v164
v_add_f32 v218,v218,v165
v_fmac_f32 v219,v165,v165
v_add_f32 v216,v216,v166
v_fmac_f32 v217,v166,v166
v_add_f32 v218,v218,v167
v_fmac_f32 v219,v167,v167
v_add_f32 v216,v216,v168
v_fmac_f32 v217,v168,v168
v_add_f32 v218,v218,v169
v_fmac_f32 v219,v169,v169
v_add_f32 v216,v216,v170
v_fmac_f32 v217,v170,v170
v_add_f32 v218,v218,v171
v_fmac_f32 v219,v171,v171
v_add_f32 v216,v216,v172
v_fmac_f32 v217,v172,v172
v_add_f32 v218,v218,v173
v_fmac_f32 v219,v173,v173
v_add_f32 v216,v216,v174
v_fmac_f32 v217,v174,v174
v_add_f32 v218,v218,v175
v_fmac_f32 v219,v175,v175
v_add_f32 v216,v216,v218
v_add_f32 v217,v217,v219
v_add_f32 v220,v176,v177
v_mul_f32 v221,v176,v176
v_add_f32 v222,v178,v179
v_mul_f32 v223,v177,v177
v_fmac_f32 v221,v178,v178
v_fmac_f32 v223,v179,v179
v_add_f32 v220,v220,v180
v_fmac_f32 v221,v180,v180
v_add_f32 v222,v222,v181
v_fmac_f32 v223,v181,v181
v_add_f32 v220,v220,v182
v_fmac_f32 v221,v182,v182
v_add_f32 v222,v222,v183
v_fmac_f32 v223,v183,v183
v_add_f32 v220,v220,v184
v_fmac_f32 v221,v184,v184
v_add_f32 v222,v222,v185
v_fmac_f32 v223,v185,v185
v_add_f32 v220,v220,v186
v_fmac_f32 v221,v186,v186
v_add_f32 v222,v222,v187
v_fmac_f32 v223,v187,v187
v_add_f32 v220,v220,v188
v_fmac_f32 v221,v188,v188
v_add_f32 v222,v222,v189
v_fmac_f32 v223,v189,v189
v_add_f32 v220,v220,v190
v_fmac_f32 v221,v190,v190
v_add_f32 v222,v222,v191
v_fmac_f32 v223,v191,v191
v_add_f32 v220,v220,v222
v_add_f32 v221,v221,v223
v_add_f32_dpp v208,v208,v208 row_ror:4 row_mask:0xf bank_mask:0xf
v_add_f32_dpp v209,v209,v209 row_ror:4 row_mask:0xf bank_mask:0xf
v_add_f32_dpp v212,v212,v212 row_ror:4 row_mask:0xf bank_mask:0xf
v_add_f32_dpp v213,v213,v213 row_ror:4 row_mask:0xf bank_mask:0xf
v_add_f32_dpp v216,v216,v216 row_ror:4 row_mask:0xf bank_mask:0xf
v_add_f32_dpp v217,v217,v217 row_ror:4 row_mask:0xf bank_mask:0xf
v_add_f32_dpp v220,v220,v220 row_ror:4 row_mask:0xf bank_mask:0xf
v_add_f32_dpp v221,v221,v221 row_ror:4 row_mask:0xf bank_mask:0xf
v_add_f32_dpp v208,v208,v208 row_ror:8 row_mask:0xf bank_mask:0xf
v_add_f32_dpp v209,v209,v209 row_ror:8 row_mask:0xf bank_mask:0xf
v_add_f32_dpp v212,v212,v212 row_ror:8 row_mask:0xf bank_mask:0xf
v_add_f32_dpp v213,v213,v213 row_ror:8 row_mask:0xf bank_mask:0xf
v_add_f32_dpp v216,v216,v216 row_ror:8 row_mask:0xf bank_mask:0xf
v_add_f32_dpp v217,v217,v217 row_ror:8 row_mask:0xf bank_mask:0xf
v_add_f32_dpp v220,v220,v220 row_ror:8 row_mask:0xf bank_mask:0xf
v_add_f32_dpp v221,v221,v221 row_ror:8 row_mask:0xf bank_mask:0xf
v_mov_b32 v210,v208
v_mov_b32 v211,v209
s_nop 0
v_permlane16_swap_b32 v210,v208
v_permlane16_swap_b32 v211,v209
v_add_f32 v208,v208,v210
v_add_f32 v209,v209,v211
v_mov_b32 v214,v212
v_mov_b32 v215,v213
s_nop 0
v_permlane16_swap_b32 v214,v212
v_permlane16_swap_b32 v215,v213
v_add_f32 v212,v212,v214
v_add_f32 v213,v213,v215
v_mov_b32 v218,v216
v_mov_b32 v219,v217
s_nop 0
v_permlane16_swap_b32 v218,v216
v_permlane16_swap_b32 v219,v217
v_add_f32 v216,v216,v218
v_add_f32 v217,v217,v219
v_mov_b32 v222,v220
v_mov_b32 v223,v221
s_nop 0
v_permlane16_swap_b32 v222,v220
v_permlane16_swap_b32 v223,v221
v_add_f32 v220,v220,v222
v_add_f32 v221,v221,v223
v_mov_b32 v210,v208
v_mov_b32 v211,v209
s_nop 0
v_permlane32_swap_b32 v210,v208
v_permlane32_swap_b32 v211,v209
v_add_f32 v208,v208,v210
v_add_f32 v209,v209,v211
v_mov_b32 v214,v212
v_mov_b32 v215,v213
s_nop 0
v_permlane32_swap_b32 v214,v212
v_permlane32_swap_b32 v215,v213
v_add_f32 v212,v212,v214
v_add_f32 v213,v213,v215
v_mov_b32 v218,v216
v_mov_b32 v219,v217
s_nop 0
v_permlane32_swap_b32 v218,v216
v_permlane32_swap_b32 v219,v217
v_add_f32 v216,v216,v218
v_add_f32 v217,v217,v219
v_mov_b32 v222,v220
v_mov_b32 v223,v221
s_nop 0
v_permlane32_swap_b32 v222,v220
v_permlane32_swap_b32 v223,v221
v_add_f32 v220,v220,v222
v_add_f32 v221,v221,v223
ds_write_b64 v11,v[208:209] offset:32768
ds_write_b64 v11,v[212:213] offset:34816
ds_write_b64 v11,v[216:217] offset:36864
ds_write_b64 v11,v[220:221] offset:38912
s_waitcnt lgkmcnt(0)
s_barrier
ds_read_b64 v[32:33],v12 offset:32768
ds_read_b64 v[34:35],v12 offset:33280
ds_read_b64 v[36:37],v12 offset:33792
ds_read_b64 v[38:39],v12 offset:34304
s_waitcnt lgkmcnt(0)
v_add_f32 v32,v32,v34
v_add_f32 v33,v33,v35
v_add_f32 v36,v36,v38
v_add_f32 v37,v37,v39
v_add_f32 v32,v32,v36
v_add_f32 v33,v33,v37
v_mul_f32 v208,0xba800000,v32
v_mul_f32 v34,v208,v208
v_mul_f32 v33,0x3a800000,v33
v_sub_f32 v33,v33,v34
v_max_f32 v33,0,v33
v_add_f32 v33,0x3727c5ac,v33
v_rsq_f32 v209,v33
s_nop 0
v_mul_f32 v208,v208,v209
v_fma_f32 v128,v128,v209,v208
v_fma_f32 v129,v129,v209,v208
v_fma_f32 v130,v130,v209,v208
v_fma_f32 v131,v131,v209,v208
v_fma_f32 v132,v132,v209,v208
v_fma_f32 v133,v133,v209,v208
v_fma_f32 v134,v134,v209,v208
v_fma_f32 v135,v135,v209,v208
v_fma_f32 v136,v136,v209,v208
v_fma_f32 v137,v137,v209,v208
v_fma_f32 v138,v138,v209,v208
v_fma_f32 v139,v139,v209,v208
v_fma_f32 v140,v140,v209,v208
v_fma_f32 v141,v141,v209,v208
v_fma_f32 v142,v142,v209,v208
v_fma_f32 v143,v143,v209,v208
ds_read_b64 v[32:33],v12 offset:34816
ds_read_b64 v[34:35],v12 offset:35328
ds_read_b64 v[36:37],v12 offset:35840
ds_read_b64 v[38:39],v12 offset:36352
s_waitcnt lgkmcnt(0)
v_add_f32 v32,v32,v34
v_add_f32 v33,v33,v35
v_add_f32 v36,v36,v38
v_add_f32 v37,v37,v39
v_add_f32 v32,v32,v36
v_add_f32 v33,v33,v37
v_mul_f32 v208,0xba800000,v32
v_mul_f32 v34,v208,v208
v_mul_f32 v33,0x3a800000,v33
v_sub_f32 v33,v33,v34
v_max_f32 v33,0,v33
v_add_f32 v33,0x3727c5ac,v33
v_rsq_f32 v209,v33
s_nop 0
v_mul_f32 v208,v208,v209
v_fma_f32 v144,v144,v209,v208
v_fma_f32 v145,v145,v209,v208
v_fma_f32 v146,v146,v209,v208
v_fma_f32 v147,v147,v209,v208
v_fma_f32 v148,v148,v209,v208
v_fma_f32 v149,v149,v209,v208
v_fma_f32 v150,v150,v209,v208
v_fma_f32 v151,v151,v209,v208
v_fma_f32 v152,v152,v209,v208
v_fma_f32 v153,v153,v209,v208
v_fma_f32 v154,v154,v209,v208
v_fma_f32 v155,v155,v209,v208
v_fma_f32 v156,v156,v209,v208
v_fma_f32 v157,v157,v209,v208
v_fma_f32 v158,v158,v209,v208
v_fma_f32 v159,v159,v209,v208
ds_read_b64 v[32:33],v12 offset:36864
ds_read_b64 v[34:35],v12 offset:37376
ds_read_b64 v[36:37],v12 offset:37888
ds_read_b64 v[38:39],v12 offset:38400
s_waitcnt lgkmcnt(0)
v_add_f32 v32,v32,v34
v_add_f32 v33,v33,v35
v_add_f32 v36,v36,v38
v_add_f32 v37,v37,v39
v_add_f32 v32,v32,v36
v_add_f32 v33,v33,v37
v_mul_f32 v208,0xba800000,v32
v_mul_f32 v34,v208,v208
v_mul_f32 v33,0x3a800000,v33
v_sub_f32 v33,v33,v34
v_max_f32 v33,0,v33
v_add_f32 v33,0x3727c5ac,v33
v_rsq_f32 v209,v33
s_nop 0
v_mul_f32 v208,v208,v209
v_fma_f32 v160,v160,v209,v208
v_fma_f32 v161,v161,v209,v208
v_fma_f32 v162,v162,v209,v208
v_fma_f32 v163,v163,v209,v208
v_fma_f32 v164,v164,v209,v208
v_fma_f32 v165,v165,v209,v208
v_fma_f32 v166,v166,v209,v208
v_fma_f32 v167,v167,v209,v208
v_fma_f32 v168,v168,v209,v208
v_fma_f32 v169,v169,v209,v208
v_fma_f32 v170,v170,v209,v208
v_fma_f32 v171,v171,v209,v208
v_fma_f32 v172,v172,v209,v208
v_fma_f32 v173,v173,v209,v208
v_fma_f32 v174,v174,v209,v208
v_fma_f32 v175,v175,v209,v208
ds_read_b64 v[32:33],v12 offset:38912
ds_read_b64 v[34:35],v12 offset:39424
ds_read_b64 v[36:37],v12 offset:39936
ds_read_b64 v[38:39],v12 offset:40448
s_waitcnt lgkmcnt(0)
v_add_f32 v32,v32,v34
v_add_f32 v33,v33,v35
v_add_f32 v36,v36,v38
v_add_f32 v37,v37,v39
v_add_f32 v32,v32,v36
v_add_f32 v33,v33,v37
v_mul_f32 v208,0xba800000,v32
v_mul_f32 v34,v208,v208
v_mul_f32 v33,0x3a800000,v33
v_sub_f32 v33,v33,v34
v_max_f32 v33,0,v33
v_add_f32 v33,0x3727c5ac,v33
v_rsq_f32 v209,v33
s_nop 0
v_mul_f32 v208,v208,v209
v_fma_f32 v176,v176,v209,v208
v_fma_f32 v177,v177,v209,v208
v_fma_f32 v178,v178,v209,v208
v_fma_f32 v179,v179,v209,v208
v_fma_f32 v180,v180,v209,v208
v_fma_f32 v181,v181,v209,v208
v_fma_f32 v182,v182,v209,v208
v_fma_f32 v183,v183,v209,v208
v_fma_f32 v184,v184,v209,v208
v_fma_f32 v185,v185,v209,v208
v_fma_f32 v186,v186,v209,v208
v_fma_f32 v187,v187,v209,v208
v_fma_f32 v188,v188,v209,v208
v_fma_f32 v189,v189,v209,v208
v_fma_f32 v190,v190,v209,v208
v_fma_f32 v191,v191,v209,v208
s_mov_b32 s92,s2
s_and_b32 s93,s3,0xffff
s_mov_b32 s94,0x100
s_mov_b32 s95,0x20000
v_mbcnt_lo_u32_b32 v16,-1,0
v_mbcnt_hi_u32_b32 v16,-1,v16
v_mov_b32 v18,0
v_cmp_eq_u32 vcc,16,v16
s_nop 1
v_cndmask_b32 v18,v18,64,vcc
v_and_b32 v19,1,v16
v_cmp_eq_u32 vcc,1,v19
v_mov_b32 v19,8192
s_nop 0
v_cndmask_b32 v19,-1,v19,vcc
v_min_u32 v16,31,v16
v_lshlrev_b32 v16,2,v16
s_sub_u32 s66,s88,64
s_cmp_lg_u32 s50,0
s_cbranch_scc1 vot_10
vpoll_6:
buffer_load_dword v17,v16,s[92:95],s66 offen sc1
s_waitcnt vmcnt(0)
s_cmp_lg_u32 s56,2
s_cbranch_scc1 vck_7
v_cmp_eq_u32 vcc,v17,v19
s_and_b32 s64,vcc_lo,0xffff
s_cmp_eq_u32 s64,65535
s_cbranch_scc1 vck_7
s_mov_b32 s65,0
v_readlane_b32 s64,v17,1
s_lshr_b32 s64,s64,8
s_add_u32 s65,s65,s64
v_readlane_b32 s64,v17,3
s_lshr_b32 s64,s64,8
s_add_u32 s65,s65,s64
v_readlane_b32 s64,v17,5
s_lshr_b32 s64,s64,8
s_add_u32 s65,s65,s64
v_readlane_b32 s64,v17,7
s_lshr_b32 s64,s64,8
s_add_u32 s65,s65,s64
v_readlane_b32 s64,v17,9
s_lshr_b32 s64,s64,8
s_add_u32 s65,s65,s64
v_readlane_b32 s64,v17,11
s_lshr_b32 s64,s64,8
s_add_u32 s65,s65,s64
v_readlane_b32 s64,v17,13
s_lshr_b32 s64,s64,8
s_add_u32 s65,s65,s64
v_readlane_b32 s64,v17,15
s_lshr_b32 s64,s64,8
s_add_u32 s65,s65,s64
s_cmp_ge_u32 s65,256
s_cbranch_scc1 vok_9
s_branch vrt_8
vck_7:
v_cmp_gt_u32 vcc,v18,v17
s_cbranch_vccz vok_9
vrt_8:
s_sleep 8
s_sub_u32 s90,s90,1
s_cmp_gt_i32 s90,0
s_cbranch_scc1 vpoll_6
vok_9:
v_add_u32 v18,160000,v16
ds_write_b32 v18,v17
s_waitcnt lgkmcnt(0)
vot_10:
s_barrier
v_add_u32 v18,160000,v16
ds_read_b32 v17,v18
s_waitcnt lgkmcnt(0)
s_cmp_lg_u32 s56,2
s_cbranch_scc1 vfin_11
v_cmp_eq_u32 vcc,v17,v19
s_and_b32 s64,vcc_lo,0xffff
s_cmp_eq_u32 s64,65535
s_cbranch_scc1 vfin_11
s_mov_b32 s65,0
v_readlane_b32 s64,v17,1
s_lshr_b32 s64,s64,8
s_add_u32 s65,s65,s64
v_readlane_b32 s64,v17,3
s_lshr_b32 s64,s64,8
s_add_u32 s65,s65,s64
v_readlane_b32 s64,v17,5
s_lshr_b32 s64,s64,8
s_add_u32 s65,s65,s64
v_readlane_b32 s64,v17,7
s_lshr_b32 s64,s64,8
s_add_u32 s65,s65,s64
v_readlane_b32 s64,v17,9
s_lshr_b32 s64,s64,8
s_add_u32 s65,s65,s64
v_readlane_b32 s64,v17,11
s_lshr_b32 s64,s64,8
s_add_u32 s65,s65,s64
v_readlane_b32 s64,v17,13
s_lshr_b32 s64,s64,8
s_add_u32 s65,s65,s64
v_readlane_b32 s64,v17,15
s_lshr_b32 s64,s64,8
s_add_u32 s65,s65,s64
s_cmp_ge_u32 s65,256
s_cbranch_scc1 fl_fb
vfin_11:
s_and_b32 s56,s56,1
v_lshlrev_b32 v18,5,v14
s_mov_b32 s64,267386880
buffer_load_dwordx4 v[32:35],v18,s[20:23],s64 offen offset:0 sc1
buffer_load_dwordx4 v[36:39],v18,s[20:23],s64 offen offset:16 sc1
s_mov_b32 s64,267411456
buffer_load_dwordx4 v[40:43],v18,s[20:23],s64 offen offset:0 sc1
buffer_load_dwordx4 v[44:47],v18,s[20:23],s64 offen offset:16 sc1
s_mov_b32 s64,267436032
buffer_load_dwordx4 v[48:51],v18,s[20:23],s64 offen offset:0 sc1
buffer_load_dwordx4 v[52:55],v18,s[20:23],s64 offen offset:16 sc1
s_mov_b32 s64,267460608
buffer_load_dwordx4 v[56:59],v18,s[20:23],s64 offen offset:0 sc1
buffer_load_dwordx4 v[60:63],v18,s[20:23],s64 offen offset:16 sc1
s_cmp_gt_u32 s50,1
s_cselect_b32 s64,1.0,0
s_waitcnt vmcnt(0)
v_pk_add_f32 v[32:33],v[32:33],v[40:41]
v_pk_add_f32 v[48:49],v[48:49],v[56:57]
v_pk_add_f32 v[34:35],v[34:35],v[42:43]
v_pk_add_f32 v[50:51],v[50:51],v[58:59]
v_pk_add_f32 v[36:37],v[36:37],v[44:45]
v_pk_add_f32 v[52:53],v[52:53],v[60:61]
v_pk_add_f32 v[38:39],v[38:39],v[46:47]
v_pk_add_f32 v[54:55],v[54:55],v[62:63]
v_pk_add_f32 v[32:33],v[32:33],v[48:49]
v_pk_add_f32 v[34:35],v[34:35],v[50:51]
v_pk_add_f32 v[36:37],v[36:37],v[52:53]
v_pk_add_f32 v[38:39],v[38:39],v[54:55]
v_cvt_pk_bf16_f32 v40,v32,v33
v_cvt_pk_bf16_f32 v41,v34,v35
v_cvt_pk_bf16_f32 v42,v36,v37
v_cvt_pk_bf16_f32 v43,v38,v39
v_lshlrev_b32 v32,16,v40
v_and_b32 v33,s73,v40
v_lshlrev_b32 v34,16,v41
v_and_b32 v35,s73,v41
v_lshlrev_b32 v36,16,v42
v_and_b32 v37,s73,v42
v_lshlrev_b32 v38,16,v43
v_and_b32 v39,s73,v43
v_add_f32 v32,s64,v32
v_add_f32 v33,s64,v33
v_add_f32 v34,s64,v34
v_add_f32 v35,s64,v35
v_add_f32 v36,s64,v36
v_add_f32 v37,s64,v37
v_add_f32 v38,s64,v38
v_add_f32 v39,s64,v39
ds_write_b128 v18,v[32:35] offset:0
ds_write_b128 v18,v[36:39] offset:16
s_waitcnt lgkmcnt(0)
s_barrier
ds_read_b128 v[112:115],v9 offset:0
ds_read_b128 v[116:119],v9 offset:16
ds_read_b128 v[120:123],v9 offset:512
ds_read_b128 v[124:127],v9 offset:528
ds_read_b128 v[96:99],v9 offset:4096
ds_read_b128 v[100:103],v9 offset:4112
ds_read_b128 v[104:107],v9 offset:4608
ds_read_b128 v[108:111],v9 offset:4624
s_add_u32 s61,s61,146800640
s_add_u32 s62,s61,4096
s_waitcnt lgkmcnt(0)
v_fma_f32 v128,v128,v96,v112
v_fma_f32 v129,v129,v97,v113
v_fma_f32 v130,v130,v98,v114
v_fma_f32 v131,v131,v99,v115
v_fma_f32 v132,v132,v100,v116
v_fma_f32 v133,v133,v101,v117
v_fma_f32 v134,v134,v102,v118
v_fma_f32 v135,v135,v103,v119
v_fma_f32 v136,v136,v104,v120
v_fma_f32 v137,v137,v105,v121
v_fma_f32 v138,v138,v106,v122
v_fma_f32 v139,v139,v107,v123
v_fma_f32 v140,v140,v108,v124
v_fma_f32 v141,v141,v109,v125
v_fma_f32 v142,v142,v110,v126
v_fma_f32 v143,v143,v111,v127
v_cvt_pk_bf16_f32 v48,v128,v129
v_cvt_pk_bf16_f32 v49,v130,v131
v_cvt_pk_bf16_f32 v50,v132,v133
v_cvt_pk_bf16_f32 v51,v134,v135
v_cvt_pk_bf16_f32 v52,v136,v137
v_cvt_pk_bf16_f32 v53,v138,v139
v_cvt_pk_bf16_f32 v54,v140,v141
v_cvt_pk_bf16_f32 v55,v142,v143
buffer_store_dwordx4 v[48:51],v10,s[20:23],s61 offen offset:0 sc1
buffer_store_dwordx4 v[52:55],v10,s[20:23],s62 offen offset:0 sc1
v_fma_f32 v144,v144,v96,v112
v_fma_f32 v145,v145,v97,v113
v_fma_f32 v146,v146,v98,v114
v_fma_f32 v147,v147,v99,v115
v_fma_f32 v148,v148,v100,v116
v_fma_f32 v149,v149,v101,v117
v_fma_f32 v150,v150,v102,v118
v_fma_f32 v151,v151,v103,v119
v_fma_f32 v152,v152,v104,v120
v_fma_f32 v153,v153,v105,v121
v_fma_f32 v154,v154,v106,v122
v_fma_f32 v155,v155,v107,v123
v_fma_f32 v156,v156,v108,v124
v_fma_f32 v157,v157,v109,v125
v_fma_f32 v158,v158,v110,v126
v_fma_f32 v159,v159,v111,v127
v_cvt_pk_bf16_f32 v56,v144,v145
v_cvt_pk_bf16_f32 v57,v146,v147
v_cvt_pk_bf16_f32 v58,v148,v149
v_cvt_pk_bf16_f32 v59,v150,v151
v_cvt_pk_bf16_f32 v60,v152,v153
v_cvt_pk_bf16_f32 v61,v154,v155
v_cvt_pk_bf16_f32 v62,v156,v157
v_cvt_pk_bf16_f32 v63,v158,v159
buffer_store_dwordx4 v[56:59],v10,s[20:23],s61 offen offset:64 sc1
buffer_store_dwordx4 v[60:63],v10,s[20:23],s62 offen offset:64 sc1
v_fma_f32 v160,v160,v96,v112
v_fma_f32 v161,v161,v97,v113
v_fma_f32 v162,v162,v98,v114
v_fma_f32 v163,v163,v99,v115
v_fma_f32 v164,v164,v100,v116
v_fma_f32 v165,v165,v101,v117
v_fma_f32 v166,v166,v102,v118
v_fma_f32 v167,v167,v103,v119
v_fma_f32 v168,v168,v104,v120
v_fma_f32 v169,v169,v105,v121
v_fma_f32 v170,v170,v106,v122
v_fma_f32 v171,v171,v107,v123
v_fma_f32 v172,v172,v108,v124
v_fma_f32 v173,v173,v109,v125
v_fma_f32 v174,v174,v110,v126
v_fma_f32 v175,v175,v111,v127
v_cvt_pk_bf16_f32 v64,v160,v161
v_cvt_pk_bf16_f32 v65,v162,v163
v_cvt_pk_bf16_f32 v66,v164,v165
v_cvt_pk_bf16_f32 v67,v166,v167
v_cvt_pk_bf16_f32 v68,v168,v169
v_cvt_pk_bf16_f32 v69,v170,v171
v_cvt_pk_bf16_f32 v70,v172,v173
v_cvt_pk_bf16_f32 v71,v174,v175
buffer_store_dwordx4 v[64:67],v10,s[20:23],s61 offen offset:128 sc1
buffer_store_dwordx4 v[68:71],v10,s[20:23],s62 offen offset:128 sc1
v_fma_f32 v176,v176,v96,v112
v_fma_f32 v177,v177,v97,v113
v_fma_f32 v178,v178,v98,v114
v_fma_f32 v179,v179,v99,v115
v_fma_f32 v180,v180,v100,v116
v_fma_f32 v181,v181,v101,v117
v_fma_f32 v182,v182,v102,v118
v_fma_f32 v183,v183,v103,v119
v_fma_f32 v184,v184,v104,v120
v_fma_f32 v185,v185,v105,v121
v_fma_f32 v186,v186,v106,v122
v_fma_f32 v187,v187,v107,v123
v_fma_f32 v188,v188,v108,v124
v_fma_f32 v189,v189,v109,v125
v_fma_f32 v190,v190,v110,v126
v_fma_f32 v191,v191,v111,v127
v_cvt_pk_bf16_f32 v72,v176,v177
v_cvt_pk_bf16_f32 v73,v178,v179
v_cvt_pk_bf16_f32 v74,v180,v181
v_cvt_pk_bf16_f32 v75,v182,v183
v_cvt_pk_bf16_f32 v76,v184,v185
v_cvt_pk_bf16_f32 v77,v186,v187
v_cvt_pk_bf16_f32 v78,v188,v189
v_cvt_pk_bf16_f32 v79,v190,v191
buffer_store_dwordx4 v[72:75],v10,s[20:23],s61 offen offset:192 sc1
buffer_store_dwordx4 v[76:79],v10,s[20:23],s62 offen offset:192 sc1
s_waitcnt vmcnt(0)
s_barrier
s_cmp_lg_u32 s50,0
s_cbranch_scc1 sig_12
s_mov_b32 s92,s2
s_and_b32 s93,s3,0xffff
s_mov_b32 s94,0x100
s_mov_b32 s95,0x20000
s_add_u32 s64,s88,12
v_mov_b32 v16,1
s_mov_b64 exec,1
buffer_atomic_add v16,off,s[92:95],s64 sc1
s_mov_b64 exec,-1
sig_12:
s_branch fl_disp
fl_dutb:
s_load_dwordx4 s[4:7],s[0:1],96
s_load_dwordx2 s[8:9],s[0:1],0
s_cmp_lg_u32 s58,220
s_cbranch_scc1 nomeas_13
s_cmp_lg_u32 s50,0
s_cbranch_scc1 nomeas_13
s_mov_b64 exec,1
s_mov_b32 s65,1
s_cmp_eq_u32 s56,1
s_cbranch_scc1 pub_14
s_mov_b32 s66,138526720
s_mov_b32 s67,138534912
s_mov_b32 s70,0x7fffffff
s_mov_b32 s71,0x7fffffff
s_mov_b32 s72,8
mlp_15:
s_memtime s[94:95]
s_waitcnt lgkmcnt(0)
buffer_store_dword v16,off,s[20:23],s66 sc1
s_waitcnt vmcnt(0)
s_memtime s[96:97]
s_waitcnt lgkmcnt(0)
s_sub_u32 s96,s96,s94
s_min_u32 s70,s70,s96
s_memtime s[94:95]
s_waitcnt lgkmcnt(0)
buffer_store_dword v16,off,s[20:23],s67 sc1
s_waitcnt vmcnt(0)
s_memtime s[96:97]
s_waitcnt lgkmcnt(0)
s_sub_u32 s96,s96,s94
s_min_u32 s71,s71,s96
s_sub_u32 s72,s72,1
s_cmp_gt_u32 s72,0
s_cbranch_scc1 mlp_15
s_cmp_gt_u32 s71,s70
s_cselect_b32 s65,2,1
pub_14:
s_mov_b32 s92,s2
s_and_b32 s93,s3,0xffff
s_mov_b32 s94,0x100
s_mov_b32 s95,0x20000
v_mov_b32 v16,s65
s_add_u32 s64,s88,20
buffer_store_dword v16,off,s[92:95],s64 sc1
s_mov_b64 exec,-1
nomeas_13:
s_barrier
s_sub_u32 s59,s58,192
s_and_b32 s52,s59,15
s_lshr_b32 s53,s59,4
s_lshl_b32 s64,s50,6
v_add_u32 v14,s64,v1
v_lshrrev_b32 v2,4,v14
v_and_b32 v3,15,v14
v_mul_u32_u24 v13,196608,v2
v_lshl_add_u32 v13,v3,4,v13
s_mul_i32 s54,s53,3145728
s_lshl_b32 s64,s52,9
s_add_u32 s54,s54,s64
s_add_u32 s54,s54,4096
v_lshlrev_b32 v15,1,v14
s_lshl_b32 s55,s53,9
s_mov_b32 s60,0
s_mov_b32 s73,0xffff0000
s_sub_u32 s61,s58,128
s_lshl_b32 s61,s61,15
v_lshlrev_b32 v25,6,v2
v_lshlrev_b32 v24,4,v1
v_and_b32 v2,3,v1
v_lshrrev_b32 v3,2,v1
s_lshl_b32 s64,s60,2
v_add_u32 v4,s64,v2
s_lshl_b32 s65,s50,9
v_lshlrev_b32 v5,4,v3
v_add_u32 v5,s65,v5
v_lshl_add_u32 v8,v4,11,v5
v_lshlrev_b32 v9,1,v5
v_lshrrev_b32 v5,2,v3
v_and_b32 v3,3,v3
s_lshl_b32 s65,s50,13
v_lshlrev_b32 v5,10,v5
v_lshl_add_u32 v5,v3,8,v5
v_lshl_add_u32 v5,v4,4,v5
v_add_u32 v10,s65,v5
s_lshl_b32 s65,s50,9
v_lshlrev_b32 v5,3,v1
v_add_u32 v11,s65,v5
v_lshlrev_b32 v12,3,v2
s_waitcnt lgkmcnt(0)
s_mov_b32 s24,s4
s_and_b32 s25,s5,0xffff
s_mov_b32 s26,0x800
s_mov_b32 s27,0x20000
s_mov_b32 s28,s6
s_and_b32 s29,s7,0xffff
s_mov_b32 s30,0xc00000
s_mov_b32 s31,0x20000
s_mov_b32 s32,s8
s_and_b32 s33,s9,0xffff
s_mov_b32 s34,0x400000
s_mov_b32 s35,0x20000
v_mov_b32 v28,-1
v_mov_b32 v20,0
v_mov_b32 v29,-1
v_mov_b32 v21,0
v_mov_b32 v30,-1
v_mov_b32 v22,0
v_mov_b32 v31,-1
v_mov_b32 v23,0
s_cmp_eq_u32 s58,220
s_cbranch_scc1 fl2_17
s_mov_b32 s62,s59
fl1_16:
s_lshl_b32 s64,s62,2
s_add_u32 s64,s64,s50
s_mul_i32 s64,s64,2048
s_add_u32 s64,s64,142606336
buffer_store_dwordx4 v[28:31],v24,s[20:23],s64 offen offset:0 sc1
buffer_store_dwordx4 v[28:31],v24,s[20:23],s64 offen offset:1024 sc1
s_lshl_b32 s64,s62,2
s_add_u32 s64,s64,s50
s_lshr_b32 s65,s64,6
s_lshl_b32 s65,s65,19
s_and_b32 s64,s64,63
s_mul_i32 s64,s64,2048
s_add_u32 s64,s64,134217728
s_add_u32 s64,s64,s65
buffer_store_dwordx4 v[28:31],v24,s[20:23],s64 offen offset:0 sc1
buffer_store_dwordx4 v[28:31],v24,s[20:23],s64 offen offset:1024 sc1
s_lshl_b32 s64,s62,2
s_add_u32 s64,s64,s50
s_lshr_b32 s65,s64,6
s_lshl_b32 s65,s65,19
s_and_b32 s64,s64,63
s_mul_i32 s64,s64,4096
s_add_u32 s64,s64,134479872
s_add_u32 s64,s64,s65
buffer_store_dwordx4 v[28:31],v24,s[20:23],s64 offen offset:0 sc1
buffer_store_dwordx4 v[28:31],v24,s[20:23],s64 offen offset:1024 sc1
buffer_store_dwordx4 v[28:31],v24,s[20:23],s64 offen offset:2048 sc1
buffer_store_dwordx4 v[28:31],v24,s[20:23],s64 offen offset:3072 sc1
s_lshl_b32 s64,s62,2
s_add_u32 s64,s64,s50
s_mul_i32 s64,s64,1024
s_add_u32 s64,s64,138412032
buffer_store_dwordx4 v[20:23],v24,s[20:23],s64 offen offset:0 sc1
s_cmp_eq_u32 s62,29
s_mov_b32 s62,28
s_cbranch_scc1 fl1_16
fl2_17:
s_waitcnt vmcnt(0)
s_barrier
s_cmp_lg_u32 s50,0
s_cbranch_scc1 sig_18
s_mov_b32 s92,s2
s_and_b32 s93,s3,0xffff
s_mov_b32 s94,0x100
s_mov_b32 s95,0x20000
s_add_u32 s64,s88,24
s_add_u32 s65,s88,32
s_cmp_eq_u32 s58,220
s_cselect_b32 s64,s65,s64
v_mov_b32 v16,1
s_mov_b64 exec,1
buffer_atomic_add v16,off,s[92:95],s64 sc1
s_mov_b64 exec,-1
sig_18:
s_mov_b32 s92,s2
s_and_b32 s93,s3,0xffff
s_mov_b32 s94,0x100
s_mov_b32 s95,0x20000
v_mbcnt_lo_u32_b32 v16,-1,0
v_mbcnt_hi_u32_b32 v16,-1,v16
v_mov_b32 v18,0
v_and_b32 v19,1,v16
v_cmp_eq_u32 vcc,1,v19
v_mov_b32 v19,8192
s_nop 0
v_cndmask_b32 v19,-1,v19,vcc
v_min_u32 v16,31,v16
v_lshlrev_b32 v16,2,v16
s_sub_u32 s66,s88,64
s_cmp_lg_u32 s50,0
s_cbranch_scc1 vot_23
s_mov_b32 s64,10
pre_25:
s_sleep 32
s_sub_u32 s64,s64,1
s_cmp_gt_i32 s64,0
s_cbranch_scc1 pre_25
vpoll_19:
buffer_load_dword v17,v16,s[92:95],s66 offen sc1
s_waitcnt vmcnt(0)
s_cmp_lg_u32 s56,2
s_cbranch_scc1 vck_20
v_cmp_eq_u32 vcc,v17,v19
s_and_b32 s64,vcc_lo,0xffff
s_cmp_eq_u32 s64,65535
s_cbranch_scc1 vck_20
s_mov_b32 s65,0
v_readlane_b32 s64,v17,1
s_lshr_b32 s64,s64,8
s_add_u32 s65,s65,s64
v_readlane_b32 s64,v17,3
s_lshr_b32 s64,s64,8
s_add_u32 s65,s65,s64
v_readlane_b32 s64,v17,5
s_lshr_b32 s64,s64,8
s_add_u32 s65,s65,s64
v_readlane_b32 s64,v17,7
s_lshr_b32 s64,s64,8
s_add_u32 s65,s65,s64
v_readlane_b32 s64,v17,9
s_lshr_b32 s64,s64,8
s_add_u32 s65,s65,s64
v_readlane_b32 s64,v17,11
s_lshr_b32 s64,s64,8
s_add_u32 s65,s65,s64
v_readlane_b32 s64,v17,13
s_lshr_b32 s64,s64,8
s_add_u32 s65,s65,s64
v_readlane_b32 s64,v17,15
s_lshr_b32 s64,s64,8
s_add_u32 s65,s65,s64
s_cmp_ge_u32 s65,256
s_cbranch_scc1 vok_22
s_branch vrt_21
vck_20:
v_cmp_gt_u32 vcc,v18,v17
s_cbranch_vccz vok_22
vrt_21:
s_sleep 48
s_sub_u32 s90,s90,1
s_cmp_gt_i32 s90,0
s_cbranch_scc1 vpoll_19
vok_22:
v_add_u32 v18,160256,v16
ds_write_b32 v18,v17
s_waitcnt lgkmcnt(0)
vot_23:
s_barrier
v_add_u32 v18,160256,v16
ds_read_b32 v17,v18
s_waitcnt lgkmcnt(0)
s_cmp_lg_u32 s56,2
s_cbranch_scc1 vfin_24
v_cmp_eq_u32 vcc,v17,v19
s_and_b32 s64,vcc_lo,0xffff
s_cmp_eq_u32 s64,65535
s_cbranch_scc1 vfin_24
s_mov_b32 s65,0
v_readlane_b32 s64,v17,1
s_lshr_b32 s64,s64,8
s_add_u32 s65,s65,s64
v_readlane_b32 s64,v17,3
s_lshr_b32 s64,s64,8
s_add_u32 s65,s65,s64
v_readlane_b32 s64,v17,5
s_lshr_b32 s64,s64,8
s_add_u32 s65,s65,s64
v_readlane_b32 s64,v17,7
s_lshr_b32 s64,s64,8
s_add_u32 s65,s65,s64
v_readlane_b32 s64,v17,9
s_lshr_b32 s64,s64,8
s_add_u32 s65,s65,s64
v_readlane_b32 s64,v17,11
s_lshr_b32 s64,s64,8
s_add_u32 s65,s65,s64
v_readlane_b32 s64,v17,13
s_lshr_b32 s64,s64,8
s_add_u32 s65,s65,s64
v_readlane_b32 s64,v17,15
s_lshr_b32 s64,s64,8
s_add_u32 s65,s65,s64
s_cmp_ge_u32 s65,256
s_cbranch_scc1 fl_fb
vfin_24:
s_and_b32 s56,s56,1
buffer_load_ushort v16,v15,s[24:27],s55 offen
buffer_load_dwordx4 v[96:99],v13,s[28:31],s54 offen offset:0
buffer_load_dwordx4 v[160:163],v13,s[28:31],s54 offen offset:256
s_add_u32 s54,s54,12288
s_waitcnt vmcnt(3)
buffer_load_dwordx4 v[100:103],v13,s[28:31],s54 offen offset:0
buffer_load_dwordx4 v[164:167],v13,s[28:31],s54 offen offset:256
s_add_u32 s54,s54,12288
s_waitcnt vmcnt(3)
buffer_load_dwordx4 v[104:107],v13,s[28:31],s54 offen offset:0
buffer_load_dwordx4 v[168:171],v13,s[28:31],s54 offen offset:256
s_add_u32 s54,s54,12288
s_waitcnt vmcnt(3)
buffer_load_dwordx4 v[108:111],v13,s[28:31],s54 offen offset:0
buffer_load_dwordx4 v[172:175],v13,s[28:31],s54 offen offset:256
s_add_u32 s54,s54,12288
s_waitcnt vmcnt(3)
buffer_load_dwordx4 v[112:115],v13,s[28:31],s54 offen offset:0
buffer_load_dwordx4 v[176:179],v13,s[28:31],s54 offen offset:256
s_add_u32 s54,s54,12288
s_waitcnt vmcnt(3)
buffer_load_dwordx4 v[116:119],v13,s[28:31],s54 offen offset:0
buffer_load_dwordx4 v[180:183],v13,s[28:31],s54 offen offset:256
s_add_u32 s54,s54,12288
s_waitcnt vmcnt(3)
buffer_load_dwordx4 v[120:123],v13,s[28:31],s54 offen offset:0
buffer_load_dwordx4 v[184:187],v13,s[28:31],s54 offen offset:256
s_add_u32 s54,s54,12288
s_waitcnt vmcnt(3)
buffer_load_dwordx4 v[124:127],v13,s[28:31],s54 offen offset:0
buffer_load_dwordx4 v[188:191],v13,s[28:31],s54 offen offset:256
s_add_u32 s54,s54,12288
s_waitcnt vmcnt(3)
buffer_load_dwordx4 v[128:131],v13,s[28:31],s54 offen offset:0
buffer_load_dwordx4 v[192:195],v13,s[28:31],s54 offen offset:256
s_add_u32 s54,s54,12288
s_waitcnt vmcnt(3)
buffer_load_dwordx4 v[132:135],v13,s[28:31],s54 offen offset:0
buffer_load_dwordx4 v[196:199],v13,s[28:31],s54 offen offset:256
s_add_u32 s54,s54,12288
s_waitcnt vmcnt(3)
buffer_load_dwordx4 v[136:139],v13,s[28:31],s54 offen offset:0
buffer_load_dwordx4 v[200:203],v13,s[28:31],s54 offen offset:256
s_add_u32 s54,s54,12288
s_waitcnt vmcnt(3)
buffer_load_dwordx4 v[140:143],v13,s[28:31],s54 offen offset:0
buffer_load_dwordx4 v[204:207],v13,s[28:31],s54 offen offset:256
s_add_u32 s54,s54,12288
s_waitcnt vmcnt(3)
buffer_load_dwordx4 v[144:147],v13,s[28:31],s54 offen offset:0
buffer_load_dwordx4 v[208:211],v13,s[28:31],s54 offen offset:256
s_add_u32 s54,s54,12288
s_waitcnt vmcnt(3)
buffer_load_dwordx4 v[148:151],v13,s[28:31],s54 offen offset:0
buffer_load_dwordx4 v[212:215],v13,s[28:31],s54 offen offset:256
s_add_u32 s54,s54,12288
s_waitcnt vmcnt(3)
buffer_load_dwordx4 v[152:155],v13,s[28:31],s54 offen offset:0
buffer_load_dwordx4 v[216:219],v13,s[28:31],s54 offen offset:256
s_add_u32 s54,s54,12288
s_waitcnt vmcnt(3)
buffer_load_dwordx4 v[156:159],v13,s[28:31],s54 offen offset:0
buffer_load_dwordx4 v[220:223],v13,s[28:31],s54 offen offset:256
s_waitcnt vmcnt(3)
s_add_u32 s64,s61,0
buffer_load_dwordx4 v[48:51],v8,s[32:35],s64 offen offset:0
buffer_load_dwordx4 v[52:55],v8,s[32:35],s64 offen offset:256
s_add_u32 s64,s61,8192
buffer_load_dwordx4 v[56:59],v8,s[32:35],s64 offen offset:0
buffer_load_dwordx4 v[60:63],v8,s[32:35],s64 offen offset:256
s_add_u32 s64,s61,16384
buffer_load_dwordx4 v[64:67],v8,s[32:35],s64 offen offset:0
buffer_load_dwordx4 v[68:71],v8,s[32:35],s64 offen offset:256
s_add_u32 s64,s61,24576
buffer_load_dwordx4 v[72:75],v8,s[32:35],s64 offen offset:0
buffer_load_dwordx4 v[76:79],v8,s[32:35],s64 offen offset:256
s_waitcnt vmcnt(40)
v_lshlrev_b32 v16,16,v16
v_mul_f32 v17,0xbfb8aa3b,v16
v_exp_f32 v17,v17
s_nop 0
v_add_f32 v17,1.0,v17
v_rcp_f32 v17,v17
s_nop 0
v_mul_f32 v17,v17,v16
v_cvt_pk_bf16_f32 v17,v17,v17
v_and_b32 v17,s73,v17
v_lshlrev_b32 v18,2,v14
ds_write_b32 v18,v17 offset:8192
s_waitcnt lgkmcnt(0)
s_barrier
ds_read_b128 v[32:35],v25 offset:8192
ds_read_b128 v[36:39],v25 offset:8208
ds_read_b128 v[40:43],v25 offset:8224
ds_read_b128 v[44:47],v25 offset:8240
v_mov_b32 v80,0
v_mov_b32 v81,0
v_mov_b32 v82,0
v_mov_b32 v83,0
v_mov_b32 v84,0
v_mov_b32 v85,0
v_mov_b32 v86,0
v_mov_b32 v87,0
v_mov_b32 v88,0
v_mov_b32 v89,0
v_mov_b32 v90,0
v_mov_b32 v91,0
v_mov_b32 v92,0
v_mov_b32 v93,0
v_mov_b32 v94,0
v_mov_b32 v95,0
s_waitcnt lgkmcnt(0)
s_waitcnt vmcnt(39)
v_lshlrev_b32 v16,16,v96
v_and_b32 v17,s73,v96
v_pk_fma_f32 v[80:81],v[16:17],v[32:33],v[80:81] op_sel:[0,0,0] op_sel_hi:[1,0,1]
v_lshlrev_b32 v18,16,v97
v_and_b32 v19,s73,v97
v_pk_fma_f32 v[82:83],v[18:19],v[32:33],v[82:83] op_sel:[0,0,0] op_sel_hi:[1,0,1]
v_lshlrev_b32 v16,16,v98
v_and_b32 v17,s73,v98
v_pk_fma_f32 v[84:85],v[16:17],v[32:33],v[84:85] op_sel:[0,0,0] op_sel_hi:[1,0,1]
v_lshlrev_b32 v18,16,v99
v_and_b32 v19,s73,v99
v_pk_fma_f32 v[86:87],v[18:19],v[32:33],v[86:87] op_sel:[0,0,0] op_sel_hi:[1,0,1]
s_waitcnt vmcnt(38)
v_lshlrev_b32 v16,16,v160
v_and_b32 v17,s73,v160
v_pk_fma_f32 v[88:89],v[16:17],v[32:33],v[88:89] op_sel:[0,0,0] op_sel_hi:[1,0,1]
v_lshlrev_b32 v18,16,v161
v_and_b32 v19,s73,v161
v_pk_fma_f32 v[90:91],v[18:19],v[32:33],v[90:91] op_sel:[0,0,0] op_sel_hi:[1,0,1]
v_lshlrev_b32 v16,16,v162
v_and_b32 v17,s73,v162
v_pk_fma_f32 v[92:93],v[16:17],v[32:33],v[92:93] op_sel:[0,0,0] op_sel_hi:[1,0,1]
v_lshlrev_b32 v18,16,v163
v_and_b32 v19,s73,v163
v_pk_fma_f32 v[94:95],v[18:19],v[32:33],v[94:95] op_sel:[0,0,0] op_sel_hi:[1,0,1]
s_waitcnt vmcnt(37)
v_lshlrev_b32 v16,16,v100
v_and_b32 v17,s73,v100
v_pk_fma_f32 v[80:81],v[16:17],v[32:33],v[80:81] op_sel:[0,1,0] op_sel_hi:[1,1,1]
v_lshlrev_b32 v18,16,v101
v_and_b32 v19,s73,v101
v_pk_fma_f32 v[82:83],v[18:19],v[32:33],v[82:83] op_sel:[0,1,0] op_sel_hi:[1,1,1]
v_lshlrev_b32 v16,16,v102
v_and_b32 v17,s73,v102
v_pk_fma_f32 v[84:85],v[16:17],v[32:33],v[84:85] op_sel:[0,1,0] op_sel_hi:[1,1,1]
v_lshlrev_b32 v18,16,v103
v_and_b32 v19,s73,v103
v_pk_fma_f32 v[86:87],v[18:19],v[32:33],v[86:87] op_sel:[0,1,0] op_sel_hi:[1,1,1]
s_waitcnt vmcnt(36)
v_lshlrev_b32 v16,16,v164
v_and_b32 v17,s73,v164
v_pk_fma_f32 v[88:89],v[16:17],v[32:33],v[88:89] op_sel:[0,1,0] op_sel_hi:[1,1,1]
v_lshlrev_b32 v18,16,v165
v_and_b32 v19,s73,v165
v_pk_fma_f32 v[90:91],v[18:19],v[32:33],v[90:91] op_sel:[0,1,0] op_sel_hi:[1,1,1]
v_lshlrev_b32 v16,16,v166
v_and_b32 v17,s73,v166
v_pk_fma_f32 v[92:93],v[16:17],v[32:33],v[92:93] op_sel:[0,1,0] op_sel_hi:[1,1,1]
v_lshlrev_b32 v18,16,v167
v_and_b32 v19,s73,v167
v_pk_fma_f32 v[94:95],v[18:19],v[32:33],v[94:95] op_sel:[0,1,0] op_sel_hi:[1,1,1]
s_waitcnt vmcnt(35)
v_lshlrev_b32 v16,16,v104
v_and_b32 v17,s73,v104
v_pk_fma_f32 v[80:81],v[16:17],v[34:35],v[80:81] op_sel:[0,0,0] op_sel_hi:[1,0,1]
v_lshlrev_b32 v18,16,v105
v_and_b32 v19,s73,v105
v_pk_fma_f32 v[82:83],v[18:19],v[34:35],v[82:83] op_sel:[0,0,0] op_sel_hi:[1,0,1]
v_lshlrev_b32 v16,16,v106
v_and_b32 v17,s73,v106
v_pk_fma_f32 v[84:85],v[16:17],v[34:35],v[84:85] op_sel:[0,0,0] op_sel_hi:[1,0,1]
v_lshlrev_b32 v18,16,v107
v_and_b32 v19,s73,v107
v_pk_fma_f32 v[86:87],v[18:19],v[34:35],v[86:87] op_sel:[0,0,0] op_sel_hi:[1,0,1]
s_waitcnt vmcnt(34)
v_lshlrev_b32 v16,16,v168
v_and_b32 v17,s73,v168
v_pk_fma_f32 v[88:89],v[16:17],v[34:35],v[88:89] op_sel:[0,0,0] op_sel_hi:[1,0,1]
v_lshlrev_b32 v18,16,v169
v_and_b32 v19,s73,v169
v_pk_fma_f32 v[90:91],v[18:19],v[34:35],v[90:91] op_sel:[0,0,0] op_sel_hi:[1,0,1]
v_lshlrev_b32 v16,16,v170
v_and_b32 v17,s73,v170
v_pk_fma_f32 v[92:93],v[16:17],v[34:35],v[92:93] op_sel:[0,0,0] op_sel_hi:[1,0,1]
v_lshlrev_b32 v18,16,v171
v_and_b32 v19,s73,v171
v_pk_fma_f32 v[94:95],v[18:19],v[34:35],v[94:95] op_sel:[0,0,0] op_sel_hi:[1,0,1]
s_waitcnt vmcnt(33)
v_lshlrev_b32 v16,16,v108
v_and_b32 v17,s73,v108
v_pk_fma_f32 v[80:81],v[16:17],v[34:35],v[80:81] op_sel:[0,1,0] op_sel_hi:[1,1,1]
v_lshlrev_b32 v18,16,v109
v_and_b32 v19,s73,v109
v_pk_fma_f32 v[82:83],v[18:19],v[34:35],v[82:83] op_sel:[0,1,0] op_sel_hi:[1,1,1]
v_lshlrev_b32 v16,16,v110
v_and_b32 v17,s73,v110
v_pk_fma_f32 v[84:85],v[16:17],v[34:35],v[84:85] op_sel:[0,1,0] op_sel_hi:[1,1,1]
v_lshlrev_b32 v18,16,v111
v_and_b32 v19,s73,v111
v_pk_fma_f32 v[86:87],v[18:19],v[34:35],v[86:87] op_sel:[0,1,0] op_sel_hi:[1,1,1]
s_waitcnt vmcnt(32)
v_lshlrev_b32 v16,16,v172
v_and_b32 v17,s73,v172
v_pk_fma_f32 v[88:89],v[16:17],v[34:35],v[88:89] op_sel:[0,1,0] op_sel_hi:[1,1,1]
v_lshlrev_b32 v18,16,v173
v_and_b32 v19,s73,v173
v_pk_fma_f32 v[90:91],v[18:19],v[34:35],v[90:91] op_sel:[0,1,0] op_sel_hi:[1,1,1]
v_lshlrev_b32 v16,16,v174
v_and_b32 v17,s73,v174
v_pk_fma_f32 v[92:93],v[16:17],v[34:35],v[92:93] op_sel:[0,1,0] op_sel_hi:[1,1,1]
v_lshlrev_b32 v18,16,v175
v_and_b32 v19,s73,v175
v_pk_fma_f32 v[94:95],v[18:19],v[34:35],v[94:95] op_sel:[0,1,0] op_sel_hi:[1,1,1]
s_waitcnt vmcnt(31)
v_lshlrev_b32 v16,16,v112
v_and_b32 v17,s73,v112
v_pk_fma_f32 v[80:81],v[16:17],v[36:37],v[80:81] op_sel:[0,0,0] op_sel_hi:[1,0,1]
v_lshlrev_b32 v18,16,v113
v_and_b32 v19,s73,v113
v_pk_fma_f32 v[82:83],v[18:19],v[36:37],v[82:83] op_sel:[0,0,0] op_sel_hi:[1,0,1]
v_lshlrev_b32 v16,16,v114
v_and_b32 v17,s73,v114
v_pk_fma_f32 v[84:85],v[16:17],v[36:37],v[84:85] op_sel:[0,0,0] op_sel_hi:[1,0,1]
v_lshlrev_b32 v18,16,v115
v_and_b32 v19,s73,v115
v_pk_fma_f32 v[86:87],v[18:19],v[36:37],v[86:87] op_sel:[0,0,0] op_sel_hi:[1,0,1]
s_waitcnt vmcnt(30)
v_lshlrev_b32 v16,16,v176
v_and_b32 v17,s73,v176
v_pk_fma_f32 v[88:89],v[16:17],v[36:37],v[88:89] op_sel:[0,0,0] op_sel_hi:[1,0,1]
v_lshlrev_b32 v18,16,v177
v_and_b32 v19,s73,v177
v_pk_fma_f32 v[90:91],v[18:19],v[36:37],v[90:91] op_sel:[0,0,0] op_sel_hi:[1,0,1]
v_lshlrev_b32 v16,16,v178
v_and_b32 v17,s73,v178
v_pk_fma_f32 v[92:93],v[16:17],v[36:37],v[92:93] op_sel:[0,0,0] op_sel_hi:[1,0,1]
v_lshlrev_b32 v18,16,v179
v_and_b32 v19,s73,v179
v_pk_fma_f32 v[94:95],v[18:19],v[36:37],v[94:95] op_sel:[0,0,0] op_sel_hi:[1,0,1]
s_waitcnt vmcnt(29)
v_lshlrev_b32 v16,16,v116
v_and_b32 v17,s73,v116
v_pk_fma_f32 v[80:81],v[16:17],v[36:37],v[80:81] op_sel:[0,1,0] op_sel_hi:[1,1,1]
v_lshlrev_b32 v18,16,v117
v_and_b32 v19,s73,v117
v_pk_fma_f32 v[82:83],v[18:19],v[36:37],v[82:83] op_sel:[0,1,0] op_sel_hi:[1,1,1]
v_lshlrev_b32 v16,16,v118
v_and_b32 v17,s73,v118
v_pk_fma_f32 v[84:85],v[16:17],v[36:37],v[84:85] op_sel:[0,1,0] op_sel_hi:[1,1,1]
v_lshlrev_b32 v18,16,v119
v_and_b32 v19,s73,v119
v_pk_fma_f32 v[86:87],v[18:19],v[36:37],v[86:87] op_sel:[0,1,0] op_sel_hi:[1,1,1]
s_waitcnt vmcnt(28)
v_lshlrev_b32 v16,16,v180
v_and_b32 v17,s73,v180
v_pk_fma_f32 v[88:89],v[16:17],v[36:37],v[88:89] op_sel:[0,1,0] op_sel_hi:[1,1,1]
v_lshlrev_b32 v18,16,v181
v_and_b32 v19,s73,v181
v_pk_fma_f32 v[90:91],v[18:19],v[36:37],v[90:91] op_sel:[0,1,0] op_sel_hi:[1,1,1]
v_lshlrev_b32 v16,16,v182
v_and_b32 v17,s73,v182
v_pk_fma_f32 v[92:93],v[16:17],v[36:37],v[92:93] op_sel:[0,1,0] op_sel_hi:[1,1,1]
v_lshlrev_b32 v18,16,v183
v_and_b32 v19,s73,v183
v_pk_fma_f32 v[94:95],v[18:19],v[36:37],v[94:95] op_sel:[0,1,0] op_sel_hi:[1,1,1]
s_waitcnt vmcnt(27)
v_lshlrev_b32 v16,16,v120
v_and_b32 v17,s73,v120
v_pk_fma_f32 v[80:81],v[16:17],v[38:39],v[80:81] op_sel:[0,0,0] op_sel_hi:[1,0,1]
v_lshlrev_b32 v18,16,v121
v_and_b32 v19,s73,v121
v_pk_fma_f32 v[82:83],v[18:19],v[38:39],v[82:83] op_sel:[0,0,0] op_sel_hi:[1,0,1]
v_lshlrev_b32 v16,16,v122
v_and_b32 v17,s73,v122
v_pk_fma_f32 v[84:85],v[16:17],v[38:39],v[84:85] op_sel:[0,0,0] op_sel_hi:[1,0,1]
v_lshlrev_b32 v18,16,v123
v_and_b32 v19,s73,v123
v_pk_fma_f32 v[86:87],v[18:19],v[38:39],v[86:87] op_sel:[0,0,0] op_sel_hi:[1,0,1]
s_waitcnt vmcnt(26)
v_lshlrev_b32 v16,16,v184
v_and_b32 v17,s73,v184
v_pk_fma_f32 v[88:89],v[16:17],v[38:39],v[88:89] op_sel:[0,0,0] op_sel_hi:[1,0,1]
v_lshlrev_b32 v18,16,v185
v_and_b32 v19,s73,v185
v_pk_fma_f32 v[90:91],v[18:19],v[38:39],v[90:91] op_sel:[0,0,0] op_sel_hi:[1,0,1]
v_lshlrev_b32 v16,16,v186
v_and_b32 v17,s73,v186
v_pk_fma_f32 v[92:93],v[16:17],v[38:39],v[92:93] op_sel:[0,0,0] op_sel_hi:[1,0,1]
v_lshlrev_b32 v18,16,v187
v_and_b32 v19,s73,v187
v_pk_fma_f32 v[94:95],v[18:19],v[38:39],v[94:95] op_sel:[0,0,0] op_sel_hi:[1,0,1]
s_waitcnt vmcnt(25)
v_lshlrev_b32 v16,16,v124
v_and_b32 v17,s73,v124
v_pk_fma_f32 v[80:81],v[16:17],v[38:39],v[80:81] op_sel:[0,1,0] op_sel_hi:[1,1,1]
v_lshlrev_b32 v18,16,v125
v_and_b32 v19,s73,v125
v_pk_fma_f32 v[82:83],v[18:19],v[38:39],v[82:83] op_sel:[0,1,0] op_sel_hi:[1,1,1]
v_lshlrev_b32 v16,16,v126
v_and_b32 v17,s73,v126
v_pk_fma_f32 v[84:85],v[16:17],v[38:39],v[84:85] op_sel:[0,1,0] op_sel_hi:[1,1,1]
v_lshlrev_b32 v18,16,v127
v_and_b32 v19,s73,v127
v_pk_fma_f32 v[86:87],v[18:19],v[38:39],v[86:87] op_sel:[0,1,0] op_sel_hi:[1,1,1]
s_waitcnt vmcnt(24)
v_lshlrev_b32 v16,16,v188
v_and_b32 v17,s73,v188
v_pk_fma_f32 v[88:89],v[16:17],v[38:39],v[88:89] op_sel:[0,1,0] op_sel_hi:[1,1,1]
v_lshlrev_b32 v18,16,v189
v_and_b32 v19,s73,v189
v_pk_fma_f32 v[90:91],v[18:19],v[38:39],v[90:91] op_sel:[0,1,0] op_sel_hi:[1,1,1]
v_lshlrev_b32 v16,16,v190
v_and_b32 v17,s73,v190
v_pk_fma_f32 v[92:93],v[16:17],v[38:39],v[92:93] op_sel:[0,1,0] op_sel_hi:[1,1,1]
v_lshlrev_b32 v18,16,v191
v_and_b32 v19,s73,v191
v_pk_fma_f32 v[94:95],v[18:19],v[38:39],v[94:95] op_sel:[0,1,0] op_sel_hi:[1,1,1]
s_waitcnt vmcnt(23)
v_lshlrev_b32 v16,16,v128
v_and_b32 v17,s73,v128
v_pk_fma_f32 v[80:81],v[16:17],v[40:41],v[80:81] op_sel:[0,0,0] op_sel_hi:[1,0,1]
v_lshlrev_b32 v18,16,v129
v_and_b32 v19,s73,v129
v_pk_fma_f32 v[82:83],v[18:19],v[40:41],v[82:83] op_sel:[0,0,0] op_sel_hi:[1,0,1]
v_lshlrev_b32 v16,16,v130
v_and_b32 v17,s73,v130
v_pk_fma_f32 v[84:85],v[16:17],v[40:41],v[84:85] op_sel:[0,0,0] op_sel_hi:[1,0,1]
v_lshlrev_b32 v18,16,v131
v_and_b32 v19,s73,v131
v_pk_fma_f32 v[86:87],v[18:19],v[40:41],v[86:87] op_sel:[0,0,0] op_sel_hi:[1,0,1]
s_waitcnt vmcnt(22)
v_lshlrev_b32 v16,16,v192
v_and_b32 v17,s73,v192
v_pk_fma_f32 v[88:89],v[16:17],v[40:41],v[88:89] op_sel:[0,0,0] op_sel_hi:[1,0,1]
v_lshlrev_b32 v18,16,v193
v_and_b32 v19,s73,v193
v_pk_fma_f32 v[90:91],v[18:19],v[40:41],v[90:91] op_sel:[0,0,0] op_sel_hi:[1,0,1]
v_lshlrev_b32 v16,16,v194
v_and_b32 v17,s73,v194
v_pk_fma_f32 v[92:93],v[16:17],v[40:41],v[92:93] op_sel:[0,0,0] op_sel_hi:[1,0,1]
v_lshlrev_b32 v18,16,v195
v_and_b32 v19,s73,v195
v_pk_fma_f32 v[94:95],v[18:19],v[40:41],v[94:95] op_sel:[0,0,0] op_sel_hi:[1,0,1]
s_waitcnt vmcnt(21)
v_lshlrev_b32 v16,16,v132
v_and_b32 v17,s73,v132
v_pk_fma_f32 v[80:81],v[16:17],v[40:41],v[80:81] op_sel:[0,1,0] op_sel_hi:[1,1,1]
v_lshlrev_b32 v18,16,v133
v_and_b32 v19,s73,v133
v_pk_fma_f32 v[82:83],v[18:19],v[40:41],v[82:83] op_sel:[0,1,0] op_sel_hi:[1,1,1]
v_lshlrev_b32 v16,16,v134
v_and_b32 v17,s73,v134
v_pk_fma_f32 v[84:85],v[16:17],v[40:41],v[84:85] op_sel:[0,1,0] op_sel_hi:[1,1,1]
v_lshlrev_b32 v18,16,v135
v_and_b32 v19,s73,v135
v_pk_fma_f32 v[86:87],v[18:19],v[40:41],v[86:87] op_sel:[0,1,0] op_sel_hi:[1,1,1]
s_waitcnt vmcnt(20)
v_lshlrev_b32 v16,16,v196
v_and_b32 v17,s73,v196
v_pk_fma_f32 v[88:89],v[16:17],v[40:41],v[88:89] op_sel:[0,1,0] op_sel_hi:[1,1,1]
v_lshlrev_b32 v18,16,v197
v_and_b32 v19,s73,v197
v_pk_fma_f32 v[90:91],v[18:19],v[40:41],v[90:91] op_sel:[0,1,0] op_sel_hi:[1,1,1]
v_lshlrev_b32 v16,16,v198
v_and_b32 v17,s73,v198
v_pk_fma_f32 v[92:93],v[16:17],v[40:41],v[92:93] op_sel:[0,1,0] op_sel_hi:[1,1,1]
v_lshlrev_b32 v18,16,v199
v_and_b32 v19,s73,v199
v_pk_fma_f32 v[94:95],v[18:19],v[40:41],v[94:95] op_sel:[0,1,0] op_sel_hi:[1,1,1]
s_waitcnt vmcnt(19)
v_lshlrev_b32 v16,16,v136
v_and_b32 v17,s73,v136
v_pk_fma_f32 v[80:81],v[16:17],v[42:43],v[80:81] op_sel:[0,0,0] op_sel_hi:[1,0,1]
v_lshlrev_b32 v18,16,v137
v_and_b32 v19,s73,v137
v_pk_fma_f32 v[82:83],v[18:19],v[42:43],v[82:83] op_sel:[0,0,0] op_sel_hi:[1,0,1]
v_lshlrev_b32 v16,16,v138
v_and_b32 v17,s73,v138
v_pk_fma_f32 v[84:85],v[16:17],v[42:43],v[84:85] op_sel:[0,0,0] op_sel_hi:[1,0,1]
v_lshlrev_b32 v18,16,v139
v_and_b32 v19,s73,v139
v_pk_fma_f32 v[86:87],v[18:19],v[42:43],v[86:87] op_sel:[0,0,0] op_sel_hi:[1,0,1]
s_waitcnt vmcnt(18)
v_lshlrev_b32 v16,16,v200
v_and_b32 v17,s73,v200
v_pk_fma_f32 v[88:89],v[16:17],v[42:43],v[88:89] op_sel:[0,0,0] op_sel_hi:[1,0,1]
v_lshlrev_b32 v18,16,v201
v_and_b32 v19,s73,v201
v_pk_fma_f32 v[90:91],v[18:19],v[42:43],v[90:91] op_sel:[0,0,0] op_sel_hi:[1,0,1]
v_lshlrev_b32 v16,16,v202
v_and_b32 v17,s73,v202
v_pk_fma_f32 v[92:93],v[16:17],v[42:43],v[92:93] op_sel:[0,0,0] op_sel_hi:[1,0,1]
v_lshlrev_b32 v18,16,v203
v_and_b32 v19,s73,v203
v_pk_fma_f32 v[94:95],v[18:19],v[42:43],v[94:95] op_sel:[0,0,0] op_sel_hi:[1,0,1]
s_waitcnt vmcnt(17)
v_lshlrev_b32 v16,16,v140
v_and_b32 v17,s73,v140
v_pk_fma_f32 v[80:81],v[16:17],v[42:43],v[80:81] op_sel:[0,1,0] op_sel_hi:[1,1,1]
v_lshlrev_b32 v18,16,v141
v_and_b32 v19,s73,v141
v_pk_fma_f32 v[82:83],v[18:19],v[42:43],v[82:83] op_sel:[0,1,0] op_sel_hi:[1,1,1]
v_lshlrev_b32 v16,16,v142
v_and_b32 v17,s73,v142
v_pk_fma_f32 v[84:85],v[16:17],v[42:43],v[84:85] op_sel:[0,1,0] op_sel_hi:[1,1,1]
v_lshlrev_b32 v18,16,v143
v_and_b32 v19,s73,v143
v_pk_fma_f32 v[86:87],v[18:19],v[42:43],v[86:87] op_sel:[0,1,0] op_sel_hi:[1,1,1]
s_waitcnt vmcnt(16)
v_lshlrev_b32 v16,16,v204
v_and_b32 v17,s73,v204
v_pk_fma_f32 v[88:89],v[16:17],v[42:43],v[88:89] op_sel:[0,1,0] op_sel_hi:[1,1,1]
v_lshlrev_b32 v18,16,v205
v_and_b32 v19,s73,v205
v_pk_fma_f32 v[90:91],v[18:19],v[42:43],v[90:91] op_sel:[0,1,0] op_sel_hi:[1,1,1]
v_lshlrev_b32 v16,16,v206
v_and_b32 v17,s73,v206
v_pk_fma_f32 v[92:93],v[16:17],v[42:43],v[92:93] op_sel:[0,1,0] op_sel_hi:[1,1,1]
v_lshlrev_b32 v18,16,v207
v_and_b32 v19,s73,v207
v_pk_fma_f32 v[94:95],v[18:19],v[42:43],v[94:95] op_sel:[0,1,0] op_sel_hi:[1,1,1]
s_waitcnt vmcnt(15)
v_lshlrev_b32 v16,16,v144
v_and_b32 v17,s73,v144
v_pk_fma_f32 v[80:81],v[16:17],v[44:45],v[80:81] op_sel:[0,0,0] op_sel_hi:[1,0,1]
v_lshlrev_b32 v18,16,v145
v_and_b32 v19,s73,v145
v_pk_fma_f32 v[82:83],v[18:19],v[44:45],v[82:83] op_sel:[0,0,0] op_sel_hi:[1,0,1]
v_lshlrev_b32 v16,16,v146
v_and_b32 v17,s73,v146
v_pk_fma_f32 v[84:85],v[16:17],v[44:45],v[84:85] op_sel:[0,0,0] op_sel_hi:[1,0,1]
v_lshlrev_b32 v18,16,v147
v_and_b32 v19,s73,v147
v_pk_fma_f32 v[86:87],v[18:19],v[44:45],v[86:87] op_sel:[0,0,0] op_sel_hi:[1,0,1]
s_waitcnt vmcnt(14)
v_lshlrev_b32 v16,16,v208
v_and_b32 v17,s73,v208
v_pk_fma_f32 v[88:89],v[16:17],v[44:45],v[88:89] op_sel:[0,0,0] op_sel_hi:[1,0,1]
v_lshlrev_b32 v18,16,v209
v_and_b32 v19,s73,v209
v_pk_fma_f32 v[90:91],v[18:19],v[44:45],v[90:91] op_sel:[0,0,0] op_sel_hi:[1,0,1]
v_lshlrev_b32 v16,16,v210
v_and_b32 v17,s73,v210
v_pk_fma_f32 v[92:93],v[16:17],v[44:45],v[92:93] op_sel:[0,0,0] op_sel_hi:[1,0,1]
v_lshlrev_b32 v18,16,v211
v_and_b32 v19,s73,v211
v_pk_fma_f32 v[94:95],v[18:19],v[44:45],v[94:95] op_sel:[0,0,0] op_sel_hi:[1,0,1]
s_waitcnt vmcnt(13)
v_lshlrev_b32 v16,16,v148
v_and_b32 v17,s73,v148
v_pk_fma_f32 v[80:81],v[16:17],v[44:45],v[80:81] op_sel:[0,1,0] op_sel_hi:[1,1,1]
v_lshlrev_b32 v18,16,v149
v_and_b32 v19,s73,v149
v_pk_fma_f32 v[82:83],v[18:19],v[44:45],v[82:83] op_sel:[0,1,0] op_sel_hi:[1,1,1]
v_lshlrev_b32 v16,16,v150
v_and_b32 v17,s73,v150
v_pk_fma_f32 v[84:85],v[16:17],v[44:45],v[84:85] op_sel:[0,1,0] op_sel_hi:[1,1,1]
v_lshlrev_b32 v18,16,v151
v_and_b32 v19,s73,v151
v_pk_fma_f32 v[86:87],v[18:19],v[44:45],v[86:87] op_sel:[0,1,0] op_sel_hi:[1,1,1]
s_waitcnt vmcnt(12)
v_lshlrev_b32 v16,16,v212
v_and_b32 v17,s73,v212
v_pk_fma_f32 v[88:89],v[16:17],v[44:45],v[88:89] op_sel:[0,1,0] op_sel_hi:[1,1,1]
v_lshlrev_b32 v18,16,v213
v_and_b32 v19,s73,v213
v_pk_fma_f32 v[90:91],v[18:19],v[44:45],v[90:91] op_sel:[0,1,0] op_sel_hi:[1,1,1]
v_lshlrev_b32 v16,16,v214
v_and_b32 v17,s73,v214
v_pk_fma_f32 v[92:93],v[16:17],v[44:45],v[92:93] op_sel:[0,1,0] op_sel_hi:[1,1,1]
v_lshlrev_b32 v18,16,v215
v_and_b32 v19,s73,v215
v_pk_fma_f32 v[94:95],v[18:19],v[44:45],v[94:95] op_sel:[0,1,0] op_sel_hi:[1,1,1]
s_waitcnt vmcnt(11)
v_lshlrev_b32 v16,16,v152
v_and_b32 v17,s73,v152
v_pk_fma_f32 v[80:81],v[16:17],v[46:47],v[80:81] op_sel:[0,0,0] op_sel_hi:[1,0,1]
v_lshlrev_b32 v18,16,v153
v_and_b32 v19,s73,v153
v_pk_fma_f32 v[82:83],v[18:19],v[46:47],v[82:83] op_sel:[0,0,0] op_sel_hi:[1,0,1]
v_lshlrev_b32 v16,16,v154
v_and_b32 v17,s73,v154
v_pk_fma_f32 v[84:85],v[16:17],v[46:47],v[84:85] op_sel:[0,0,0] op_sel_hi:[1,0,1]
v_lshlrev_b32 v18,16,v155
v_and_b32 v19,s73,v155
v_pk_fma_f32 v[86:87],v[18:19],v[46:47],v[86:87] op_sel:[0,0,0] op_sel_hi:[1,0,1]
s_waitcnt vmcnt(10)
v_lshlrev_b32 v16,16,v216
v_and_b32 v17,s73,v216
v_pk_fma_f32 v[88:89],v[16:17],v[46:47],v[88:89] op_sel:[0,0,0] op_sel_hi:[1,0,1]
v_lshlrev_b32 v18,16,v217
v_and_b32 v19,s73,v217
v_pk_fma_f32 v[90:91],v[18:19],v[46:47],v[90:91] op_sel:[0,0,0] op_sel_hi:[1,0,1]
v_lshlrev_b32 v16,16,v218
v_and_b32 v17,s73,v218
v_pk_fma_f32 v[92:93],v[16:17],v[46:47],v[92:93] op_sel:[0,0,0] op_sel_hi:[1,0,1]
v_lshlrev_b32 v18,16,v219
v_and_b32 v19,s73,v219
v_pk_fma_f32 v[94:95],v[18:19],v[46:47],v[94:95] op_sel:[0,0,0] op_sel_hi:[1,0,1]
s_waitcnt vmcnt(9)
v_lshlrev_b32 v16,16,v156
v_and_b32 v17,s73,v156
v_pk_fma_f32 v[80:81],v[16:17],v[46:47],v[80:81] op_sel:[0,1,0] op_sel_hi:[1,1,1]
v_lshlrev_b32 v18,16,v157
v_and_b32 v19,s73,v157
v_pk_fma_f32 v[82:83],v[18:19],v[46:47],v[82:83] op_sel:[0,1,0] op_sel_hi:[1,1,1]
v_lshlrev_b32 v16,16,v158
v_and_b32 v17,s73,v158
v_pk_fma_f32 v[84:85],v[16:17],v[46:47],v[84:85] op_sel:[0,1,0] op_sel_hi:[1,1,1]
v_lshlrev_b32 v18,16,v159
v_and_b32 v19,s73,v159
v_pk_fma_f32 v[86:87],v[18:19],v[46:47],v[86:87] op_sel:[0,1,0] op_sel_hi:[1,1,1]
s_waitcnt vmcnt(8)
v_lshlrev_b32 v16,16,v220
v_and_b32 v17,s73,v220
v_pk_fma_f32 v[88:89],v[16:17],v[46:47],v[88:89] op_sel:[0,1,0] op_sel_hi:[1,1,1]
v_lshlrev_b32 v18,16,v221
v_and_b32 v19,s73,v221
v_pk_fma_f32 v[90:91],v[18:19],v[46:47],v[90:91] op_sel:[0,1,0] op_sel_hi:[1,1,1]
v_lshlrev_b32 v16,16,v222
v_and_b32 v17,s73,v222
v_pk_fma_f32 v[92:93],v[16:17],v[46:47],v[92:93] op_sel:[0,1,0] op_sel_hi:[1,1,1]
v_lshlrev_b32 v18,16,v223
v_and_b32 v19,s73,v223
v_pk_fma_f32 v[94:95],v[18:19],v[46:47],v[94:95] op_sel:[0,1,0] op_sel_hi:[1,1,1]
v_lshlrev_b32 v18,5,v14
ds_write_b128 v18,v[80:83] offset:16384
ds_write_b128 v18,v[84:87] offset:16400
ds_write_b128 v18,v[88:91] offset:24576
ds_write_b128 v18,v[92:95] offset:24592
v_and_b32 v18,127,v14
v_lshlrev_b32 v18,2,v18
v_lshrrev_b32 v19,7,v14
v_lshl_add_u32 v19,v19,13,v18
s_waitcnt lgkmcnt(0)
s_barrier
ds_read_b32 v32,v19 offset:16384
ds_read_b32 v33,v19 offset:16896
ds_read_b32 v34,v19 offset:17408
ds_read_b32 v35,v19 offset:17920
ds_read_b32 v36,v19 offset:18432
ds_read_b32 v37,v19 offset:18944
ds_read_b32 v38,v19 offset:19456
ds_read_b32 v39,v19 offset:19968
ds_read_b32 v40,v19 offset:20480
ds_read_b32 v41,v19 offset:20992
ds_read_b32 v42,v19 offset:21504
ds_read_b32 v43,v19 offset:22016
s_waitcnt lgkmcnt(4)
ds_read_b32 v44,v19 offset:22528
ds_read_b32 v45,v19 offset:23040
ds_read_b32 v46,v19 offset:23552
ds_read_b32 v47,v19 offset:24064
s_waitcnt lgkmcnt(0)
v_pk_add_f32 v[32:33],v[32:33],v[40:41]
v_pk_add_f32 v[34:35],v[34:35],v[42:43]
v_pk_add_f32 v[36:37],v[36:37],v[44:45]
v_pk_add_f32 v[38:39],v[38:39],v[46:47]
v_pk_add_f32 v[32:33],v[32:33],v[36:37]
v_pk_add_f32 v[34:35],v[34:35],v[38:39]
v_pk_add_f32 v[32:33],v[32:33],v[34:35]
v_add_f32 v32,v32,v33
s_mul_i32 s64,s53,24576
s_lshl_b32 s65,s52,10
s_add_u32 s64,s64,s65
s_add_u32 s64,s64,267395072
v_lshlrev_b32 v18,2,v14
buffer_store_dword v32,v18,s[20:23],s64 offen sc1
s_cmp_eq_u32 s58,220
s_cbranch_scc1 fl2_27
s_mov_b32 s62,s59
fl1_26:
s_lshl_b32 s64,s62,2
s_add_u32 s64,s64,s50
s_mul_i32 s64,s64,14336
s_add_u32 s64,s64,143130624
buffer_store_dwordx4 v[28:31],v24,s[20:23],s64 offen offset:0 sc1
s_waitcnt vmcnt(3)
buffer_store_dwordx4 v[28:31],v24,s[20:23],s64 offen offset:1024 sc1
s_waitcnt vmcnt(3)
buffer_store_dwordx4 v[28:31],v24,s[20:23],s64 offen offset:2048 sc1
s_waitcnt vmcnt(3)
buffer_store_dwordx4 v[28:31],v24,s[20:23],s64 offen offset:3072 sc1
s_waitcnt vmcnt(3)
s_add_u32 s64,s64,4096
buffer_store_dwordx4 v[28:31],v24,s[20:23],s64 offen offset:0 sc1
s_waitcnt vmcnt(3)
buffer_store_dwordx4 v[28:31],v24,s[20:23],s64 offen offset:1024 sc1
s_waitcnt vmcnt(3)
buffer_store_dwordx4 v[28:31],v24,s[20:23],s64 offen offset:2048 sc1
s_waitcnt vmcnt(3)
buffer_store_dwordx4 v[28:31],v24,s[20:23],s64 offen offset:3072 sc1
s_waitcnt vmcnt(3)
s_add_u32 s64,s64,4096
buffer_store_dwordx4 v[28:31],v24,s[20:23],s64 offen offset:0 sc1
s_waitcnt vmcnt(3)
buffer_store_dwordx4 v[28:31],v24,s[20:23],s64 offen offset:1024 sc1
s_waitcnt vmcnt(3)
buffer_store_dwordx4 v[28:31],v24,s[20:23],s64 offen offset:2048 sc1
s_waitcnt vmcnt(3)
buffer_store_dwordx4 v[28:31],v24,s[20:23],s64 offen offset:3072 sc1
s_waitcnt vmcnt(3)
s_add_u32 s64,s64,4096
buffer_store_dwordx4 v[28:31],v24,s[20:23],s64 offen offset:0 sc1
s_waitcnt vmcnt(3)
buffer_store_dwordx4 v[28:31],v24,s[20:23],s64 offen offset:1024 sc1
s_waitcnt vmcnt(3)
s_lshl_b32 s64,s62,2
s_add_u32 s64,s64,s50
s_mul_i32 s64,s64,6144
s_add_u32 s64,s64,167772160
buffer_store_dwordx4 v[28:31],v24,s[20:23],s64 offen offset:0 sc1
s_waitcnt vmcnt(3)
buffer_store_dwordx4 v[28:31],v24,s[20:23],s64 offen offset:1024 sc1
s_waitcnt vmcnt(3)
buffer_store_dwordx4 v[28:31],v24,s[20:23],s64 offen offset:2048 sc1
s_waitcnt vmcnt(3)
buffer_store_dwordx4 v[28:31],v24,s[20:23],s64 offen offset:3072 sc1
s_waitcnt vmcnt(3)
s_add_u32 s64,s64,4096
buffer_store_dwordx4 v[28:31],v24,s[20:23],s64 offen offset:0 sc1
s_waitcnt vmcnt(3)
buffer_store_dwordx4 v[28:31],v24,s[20:23],s64 offen offset:1024 sc1
s_waitcnt vmcnt(3)
s_and_b32 s64,s62,31
s_lshl_b32 s64,s64,10
s_add_u32 s64,s64,209715200
s_bitcmp1_b32 s62,5
s_cselect_b32 s65,4227072,0
s_add_u32 s64,s64,s65
buffer_store_dwordx4 v[20:23],v24,s[20:23],s64 offen sc1
s_cmp_eq_u32 s62,29
s_mov_b32 s62,28
s_cbranch_scc1 fl1_26
fl2_27:
s_waitcnt vmcnt(0)
s_barrier
s_cmp_lg_u32 s50,0
s_cbranch_scc1 sig_28
s_mov_b32 s92,s2
s_and_b32 s93,s3,0xffff
s_mov_b32 s94,0x100
s_mov_b32 s95,0x20000
s_add_u32 s64,s88,4
s_add_u32 s65,s88,8
s_cmp_eq_u32 s58,220
s_cselect_b32 s64,s65,s64
v_mov_b32 v16,1
s_mov_b64 exec,1
buffer_atomic_add v16,off,s[92:95],s64 sc1
s_mov_b64 exec,-1
sig_28:
v_lshlrev_b32 v128,16,v48
v_and_b32 v129,s73,v48
v_lshlrev_b32 v130,16,v49
v_and_b32 v131,s73,v49
v_lshlrev_b32 v132,16,v50
v_and_b32 v133,s73,v50
v_lshlrev_b32 v134,16,v51
v_and_b32 v135,s73,v51
v_lshlrev_b32 v136,16,v52
v_and_b32 v137,s73,v52
v_lshlrev_b32 v138,16,v53
v_and_b32 v139,s73,v53
v_lshlrev_b32 v140,16,v54
v_and_b32 v141,s73,v54
v_lshlrev_b32 v142,16,v55
v_and_b32 v143,s73,v55
v_lshlrev_b32 v144,16,v56
v_and_b32 v145,s73,v56
v_lshlrev_b32 v146,16,v57
v_and_b32 v147,s73,v57
v_lshlrev_b32 v148,16,v58
v_and_b32 v149,s73,v58
v_lshlrev_b32 v150,16,v59
v_and_b32 v151,s73,v59
v_lshlrev_b32 v152,16,v60
v_and_b32 v153,s73,v60
v_lshlrev_b32 v154,16,v61
v_and_b32 v155,s73,v61
v_lshlrev_b32 v156,16,v62
v_and_b32 v157,s73,v62
v_lshlrev_b32 v158,16,v63
v_and_b32 v159,s73,v63
v_lshlrev_b32 v160,16,v64
v_and_b32 v161,s73,v64
v_lshlrev_b32 v162,16,v65
v_and_b32 v163,s73,v65
v_lshlrev_b32 v164,16,v66
v_and_b32 v165,s73,v66
v_lshlrev_b32 v166,16,v67
v_and_b32 v167,s73,v67
v_lshlrev_b32 v168,16,v68
v_and_b32 v169,s73,v68
v_lshlrev_b32 v170,16,v69
v_and_b32 v171,s73,v69
v_lshlrev_b32 v172,16,v70
v_and_b32 v173,s73,v70
v_lshlrev_b32 v174,16,v71
v_and_b32 v175,s73,v71
v_lshlrev_b32 v176,16,v72
v_and_b32 v177,s73,v72
v_lshlrev_b32 v178,16,v73
v_and_b32 v179,s73,v73
v_lshlrev_b32 v180,16,v74
v_and_b32 v181,s73,v74
v_lshlrev_b32 v182,16,v75
v_and_b32 v183,s73,v75
v_lshlrev_b32 v184,16,v76
v_and_b32 v185,s73,v76
v_lshlrev_b32 v186,16,v77
v_and_b32 v187,s73,v77
v_lshlrev_b32 v188,16,v78
v_and_b32 v189,s73,v78
v_lshlrev_b32 v190,16,v79
v_and_b32 v191,s73,v79
v_add_f32 v208,v128,v129
v_mul_f32 v209,v128,v128
v_add_f32 v210,v130,v131
v_mul_f32 v211,v129,v129
v_fmac_f32 v209,v130,v130
v_fmac_f32 v211,v131,v131
v_add_f32 v208,v208,v132
v_fmac_f32 v209,v132,v132
v_add_f32 v210,v210,v133
v_fmac_f32 v211,v133,v133
v_add_f32 v208,v208,v134
v_fmac_f32 v209,v134,v134
v_add_f32 v210,v210,v135
v_fmac_f32 v211,v135,v135
v_add_f32 v208,v208,v136
v_fmac_f32 v209,v136,v136
v_add_f32 v210,v210,v137
v_fmac_f32 v211,v137,v137
v_add_f32 v208,v208,v138
v_fmac_f32 v209,v138,v138
v_add_f32 v210,v210,v139
v_fmac_f32 v211,v139,v139
v_add_f32 v208,v208,v140
v_fmac_f32 v209,v140,v140
v_add_f32 v210,v210,v141
v_fmac_f32 v211,v141,v141
v_add_f32 v208,v208,v142
v_fmac_f32 v209,v142,v142
v_add_f32 v210,v210,v143
v_fmac_f32 v211,v143,v143
v_add_f32 v208,v208,v210
v_add_f32 v209,v209,v211
v_add_f32 v212,v144,v145
v_mul_f32 v213,v144,v144
v_add_f32 v214,v146,v147
v_mul_f32 v215,v145,v145
v_fmac_f32 v213,v146,v146
v_fmac_f32 v215,v147,v147
v_add_f32 v212,v212,v148
v_fmac_f32 v213,v148,v148
v_add_f32 v214,v214,v149
v_fmac_f32 v215,v149,v149
v_add_f32 v212,v212,v150
v_fmac_f32 v213,v150,v150
v_add_f32 v214,v214,v151
v_fmac_f32 v215,v151,v151
v_add_f32 v212,v212,v152
v_fmac_f32 v213,v152,v152
v_add_f32 v214,v214,v153
v_fmac_f32 v215,v153,v153
v_add_f32 v212,v212,v154
v_fmac_f32 v213,v154,v154
v_add_f32 v214,v214,v155
v_fmac_f32 v215,v155,v155
v_add_f32 v212,v212,v156
v_fmac_f32 v213,v156,v156
v_add_f32 v214,v214,v157
v_fmac_f32 v215,v157,v157
v_add_f32 v212,v212,v158
v_fmac_f32 v213,v158,v158
v_add_f32 v214,v214,v159
v_fmac_f32 v215,v159,v159
v_add_f32 v212,v212,v214
v_add_f32 v213,v213,v215
v_add_f32 v216,v160,v161
v_mul_f32 v217,v160,v160
v_add_f32 v218,v162,v163
v_mul_f32 v219,v161,v161
v_fmac_f32 v217,v162,v162
v_fmac_f32 v219,v163,v163
v_add_f32 v216,v216,v164
v_fmac_f32 v217,v164,v164
v_add_f32 v218,v218,v165
v_fmac_f32 v219,v165,v165
v_add_f32 v216,v216,v166
v_fmac_f32 v217,v166,v166
v_add_f32 v218,v218,v167
v_fmac_f32 v219,v167,v167
v_add_f32 v216,v216,v168
v_fmac_f32 v217,v168,v168
v_add_f32 v218,v218,v169
v_fmac_f32 v219,v169,v169
v_add_f32 v216,v216,v170
v_fmac_f32 v217,v170,v170
v_add_f32 v218,v218,v171
v_fmac_f32 v219,v171,v171
v_add_f32 v216,v216,v172
v_fmac_f32 v217,v172,v172
v_add_f32 v218,v218,v173
v_fmac_f32 v219,v173,v173
v_add_f32 v216,v216,v174
v_fmac_f32 v217,v174,v174
v_add_f32 v218,v218,v175
v_fmac_f32 v219,v175,v175
v_add_f32 v216,v216,v218
v_add_f32 v217,v217,v219
v_add_f32 v220,v176,v177
v_mul_f32 v221,v176,v176
v_add_f32 v222,v178,v179
v_mul_f32 v223,v177,v177
v_fmac_f32 v221,v178,v178
v_fmac_f32 v223,v179,v179
v_add_f32 v220,v220,v180
v_fmac_f32 v221,v180,v180
v_add_f32 v222,v222,v181
v_fmac_f32 v223,v181,v181
v_add_f32 v220,v220,v182
v_fmac_f32 v221,v182,v182
v_add_f32 v222,v222,v183
v_fmac_f32 v223,v183,v183
v_add_f32 v220,v220,v184
v_fmac_f32 v221,v184,v184
v_add_f32 v222,v222,v185
v_fmac_f32 v223,v185,v185
v_add_f32 v220,v220,v186
v_fmac_f32 v221,v186,v186
v_add_f32 v222,v222,v187
v_fmac_f32 v223,v187,v187
v_add_f32 v220,v220,v188
v_fmac_f32 v221,v188,v188
v_add_f32 v222,v222,v189
v_fmac_f32 v223,v189,v189
v_add_f32 v220,v220,v190
v_fmac_f32 v221,v190,v190
v_add_f32 v222,v222,v191
v_fmac_f32 v223,v191,v191
v_add_f32 v220,v220,v222
v_add_f32 v221,v221,v223
v_add_f32_dpp v208,v208,v208 row_ror:4 row_mask:0xf bank_mask:0xf
v_add_f32_dpp v209,v209,v209 row_ror:4 row_mask:0xf bank_mask:0xf
v_add_f32_dpp v212,v212,v212 row_ror:4 row_mask:0xf bank_mask:0xf
v_add_f32_dpp v213,v213,v213 row_ror:4 row_mask:0xf bank_mask:0xf
v_add_f32_dpp v216,v216,v216 row_ror:4 row_mask:0xf bank_mask:0xf
v_add_f32_dpp v217,v217,v217 row_ror:4 row_mask:0xf bank_mask:0xf
v_add_f32_dpp v220,v220,v220 row_ror:4 row_mask:0xf bank_mask:0xf
v_add_f32_dpp v221,v221,v221 row_ror:4 row_mask:0xf bank_mask:0xf
v_add_f32_dpp v208,v208,v208 row_ror:8 row_mask:0xf bank_mask:0xf
v_add_f32_dpp v209,v209,v209 row_ror:8 row_mask:0xf bank_mask:0xf
v_add_f32_dpp v212,v212,v212 row_ror:8 row_mask:0xf bank_mask:0xf
v_add_f32_dpp v213,v213,v213 row_ror:8 row_mask:0xf bank_mask:0xf
v_add_f32_dpp v216,v216,v216 row_ror:8 row_mask:0xf bank_mask:0xf
v_add_f32_dpp v217,v217,v217 row_ror:8 row_mask:0xf bank_mask:0xf
v_add_f32_dpp v220,v220,v220 row_ror:8 row_mask:0xf bank_mask:0xf
v_add_f32_dpp v221,v221,v221 row_ror:8 row_mask:0xf bank_mask:0xf
v_mov_b32 v210,v208
v_mov_b32 v211,v209
s_nop 0
v_permlane16_swap_b32 v210,v208
v_permlane16_swap_b32 v211,v209
v_add_f32 v208,v208,v210
v_add_f32 v209,v209,v211
v_mov_b32 v214,v212
v_mov_b32 v215,v213
s_nop 0
v_permlane16_swap_b32 v214,v212
v_permlane16_swap_b32 v215,v213
v_add_f32 v212,v212,v214
v_add_f32 v213,v213,v215
v_mov_b32 v218,v216
v_mov_b32 v219,v217
s_nop 0
v_permlane16_swap_b32 v218,v216
v_permlane16_swap_b32 v219,v217
v_add_f32 v216,v216,v218
v_add_f32 v217,v217,v219
v_mov_b32 v222,v220
v_mov_b32 v223,v221
s_nop 0
v_permlane16_swap_b32 v222,v220
v_permlane16_swap_b32 v223,v221
v_add_f32 v220,v220,v222
v_add_f32 v221,v221,v223
v_mov_b32 v210,v208
v_mov_b32 v211,v209
s_nop 0
v_permlane32_swap_b32 v210,v208
v_permlane32_swap_b32 v211,v209
v_add_f32 v208,v208,v210
v_add_f32 v209,v209,v211
v_mov_b32 v214,v212
v_mov_b32 v215,v213
s_nop 0
v_permlane32_swap_b32 v214,v212
v_permlane32_swap_b32 v215,v213
v_add_f32 v212,v212,v214
v_add_f32 v213,v213,v215
v_mov_b32 v218,v216
v_mov_b32 v219,v217
s_nop 0
v_permlane32_swap_b32 v218,v216
v_permlane32_swap_b32 v219,v217
v_add_f32 v216,v216,v218
v_add_f32 v217,v217,v219
v_mov_b32 v222,v220
v_mov_b32 v223,v221
s_nop 0
v_permlane32_swap_b32 v222,v220
v_permlane32_swap_b32 v223,v221
v_add_f32 v220,v220,v222
v_add_f32 v221,v221,v223
ds_write_b64 v11,v[208:209] offset:32768
ds_write_b64 v11,v[212:213] offset:34816
ds_write_b64 v11,v[216:217] offset:36864
ds_write_b64 v11,v[220:221] offset:38912
s_waitcnt lgkmcnt(0)
s_barrier
ds_read_b64 v[32:33],v12 offset:32768
ds_read_b64 v[34:35],v12 offset:33280
ds_read_b64 v[36:37],v12 offset:33792
ds_read_b64 v[38:39],v12 offset:34304
s_waitcnt lgkmcnt(0)
v_add_f32 v32,v32,v34
v_add_f32 v33,v33,v35
v_add_f32 v36,v36,v38
v_add_f32 v37,v37,v39
v_add_f32 v32,v32,v36
v_add_f32 v33,v33,v37
v_mul_f32 v208,0xba800000,v32
v_mul_f32 v34,v208,v208
v_mul_f32 v33,0x3a800000,v33
v_sub_f32 v33,v33,v34
v_max_f32 v33,0,v33
v_add_f32 v33,0x3727c5ac,v33
v_rsq_f32 v209,v33
s_nop 0
v_mul_f32 v208,v208,v209
v_fma_f32 v128,v128,v209,v208
v_fma_f32 v129,v129,v209,v208
v_fma_f32 v130,v130,v209,v208
v_fma_f32 v131,v131,v209,v208
v_fma_f32 v132,v132,v209,v208
v_fma_f32 v133,v133,v209,v208
v_fma_f32 v134,v134,v209,v208
v_fma_f32 v135,v135,v209,v208
v_fma_f32 v136,v136,v209,v208
v_fma_f32 v137,v137,v209,v208
v_fma_f32 v138,v138,v209,v208
v_fma_f32 v139,v139,v209,v208
v_fma_f32 v140,v140,v209,v208
v_fma_f32 v141,v141,v209,v208
v_fma_f32 v142,v142,v209,v208
v_fma_f32 v143,v143,v209,v208
ds_read_b64 v[32:33],v12 offset:34816
ds_read_b64 v[34:35],v12 offset:35328
ds_read_b64 v[36:37],v12 offset:35840
ds_read_b64 v[38:39],v12 offset:36352
s_waitcnt lgkmcnt(0)
v_add_f32 v32,v32,v34
v_add_f32 v33,v33,v35
v_add_f32 v36,v36,v38
v_add_f32 v37,v37,v39
v_add_f32 v32,v32,v36
v_add_f32 v33,v33,v37
v_mul_f32 v208,0xba800000,v32
v_mul_f32 v34,v208,v208
v_mul_f32 v33,0x3a800000,v33
v_sub_f32 v33,v33,v34
v_max_f32 v33,0,v33
v_add_f32 v33,0x3727c5ac,v33
v_rsq_f32 v209,v33
s_nop 0
v_mul_f32 v208,v208,v209
v_fma_f32 v144,v144,v209,v208
v_fma_f32 v145,v145,v209,v208
v_fma_f32 v146,v146,v209,v208
v_fma_f32 v147,v147,v209,v208
v_fma_f32 v148,v148,v209,v208
v_fma_f32 v149,v149,v209,v208
v_fma_f32 v150,v150,v209,v208
v_fma_f32 v151,v151,v209,v208
v_fma_f32 v152,v152,v209,v208
v_fma_f32 v153,v153,v209,v208
v_fma_f32 v154,v154,v209,v208
v_fma_f32 v155,v155,v209,v208
v_fma_f32 v156,v156,v209,v208
v_fma_f32 v157,v157,v209,v208
v_fma_f32 v158,v158,v209,v208
v_fma_f32 v159,v159,v209,v208
ds_read_b64 v[32:33],v12 offset:36864
ds_read_b64 v[34:35],v12 offset:37376
ds_read_b64 v[36:37],v12 offset:37888
ds_read_b64 v[38:39],v12 offset:38400
s_waitcnt lgkmcnt(0)
v_add_f32 v32,v32,v34
v_add_f32 v33,v33,v35
v_add_f32 v36,v36,v38
v_add_f32 v37,v37,v39
v_add_f32 v32,v32,v36
v_add_f32 v33,v33,v37
v_mul_f32 v208,0xba800000,v32
v_mul_f32 v34,v208,v208
v_mul_f32 v33,0x3a800000,v33
v_sub_f32 v33,v33,v34
v_max_f32 v33,0,v33
v_add_f32 v33,0x3727c5ac,v33
v_rsq_f32 v209,v33
s_nop 0
v_mul_f32 v208,v208,v209
v_fma_f32 v160,v160,v209,v208
v_fma_f32 v161,v161,v209,v208
v_fma_f32 v162,v162,v209,v208
v_fma_f32 v163,v163,v209,v208
v_fma_f32 v164,v164,v209,v208
v_fma_f32 v165,v165,v209,v208
v_fma_f32 v166,v166,v209,v208
v_fma_f32 v167,v167,v209,v208
v_fma_f32 v168,v168,v209,v208
v_fma_f32 v169,v169,v209,v208
v_fma_f32 v170,v170,v209,v208
v_fma_f32 v171,v171,v209,v208
v_fma_f32 v172,v172,v209,v208
v_fma_f32 v173,v173,v209,v208
v_fma_f32 v174,v174,v209,v208
v_fma_f32 v175,v175,v209,v208
ds_read_b64 v[32:33],v12 offset:38912
ds_read_b64 v[34:35],v12 offset:39424
ds_read_b64 v[36:37],v12 offset:39936
ds_read_b64 v[38:39],v12 offset:40448
s_waitcnt lgkmcnt(0)
v_add_f32 v32,v32,v34
v_add_f32 v33,v33,v35
v_add_f32 v36,v36,v38
v_add_f32 v37,v37,v39
v_add_f32 v32,v32,v36
v_add_f32 v33,v33,v37
v_mul_f32 v208,0xba800000,v32
v_mul_f32 v34,v208,v208
v_mul_f32 v33,0x3a800000,v33
v_sub_f32 v33,v33,v34
v_max_f32 v33,0,v33
v_add_f32 v33,0x3727c5ac,v33
v_rsq_f32 v209,v33
s_nop 0
v_mul_f32 v208,v208,v209
v_fma_f32 v176,v176,v209,v208
v_fma_f32 v177,v177,v209,v208
v_fma_f32 v178,v178,v209,v208
v_fma_f32 v179,v179,v209,v208
v_fma_f32 v180,v180,v209,v208
v_fma_f32 v181,v181,v209,v208
v_fma_f32 v182,v182,v209,v208
v_fma_f32 v183,v183,v209,v208
v_fma_f32 v184,v184,v209,v208
v_fma_f32 v185,v185,v209,v208
v_fma_f32 v186,v186,v209,v208
v_fma_f32 v187,v187,v209,v208
v_fma_f32 v188,v188,v209,v208
v_fma_f32 v189,v189,v209,v208
v_fma_f32 v190,v190,v209,v208
v_fma_f32 v191,v191,v209,v208
s_mov_b32 s92,s2
s_and_b32 s93,s3,0xffff
s_mov_b32 s94,0x100
s_mov_b32 s95,0x20000
v_mbcnt_lo_u32_b32 v16,-1,0
v_mbcnt_hi_u32_b32 v16,-1,v16
v_mov_b32 v18,0
v_cmp_eq_u32 vcc,16,v16
s_nop 1
v_cndmask_b32 v18,v18,64,vcc
v_and_b32 v19,1,v16
v_cmp_eq_u32 vcc,1,v19
v_mov_b32 v19,8192
s_nop 0
v_cndmask_b32 v19,-1,v19,vcc
v_min_u32 v16,31,v16
v_lshlrev_b32 v16,2,v16
s_sub_u32 s66,s88,64
s_cmp_lg_u32 s50,0
s_cbranch_scc1 vot_33
vpoll_29:
buffer_load_dword v17,v16,s[92:95],s66 offen sc1
s_waitcnt vmcnt(0)
s_cmp_lg_u32 s56,2
s_cbranch_scc1 vck_30
v_cmp_eq_u32 vcc,v17,v19
s_and_b32 s64,vcc_lo,0xffff
s_cmp_eq_u32 s64,65535
s_cbranch_scc1 vck_30
s_mov_b32 s65,0
v_readlane_b32 s64,v17,1
s_lshr_b32 s64,s64,8
s_add_u32 s65,s65,s64
v_readlane_b32 s64,v17,3
s_lshr_b32 s64,s64,8
s_add_u32 s65,s65,s64
v_readlane_b32 s64,v17,5
s_lshr_b32 s64,s64,8
s_add_u32 s65,s65,s64
v_readlane_b32 s64,v17,7
s_lshr_b32 s64,s64,8
s_add_u32 s65,s65,s64
v_readlane_b32 s64,v17,9
s_lshr_b32 s64,s64,8
s_add_u32 s65,s65,s64
v_readlane_b32 s64,v17,11
s_lshr_b32 s64,s64,8
s_add_u32 s65,s65,s64
v_readlane_b32 s64,v17,13
s_lshr_b32 s64,s64,8
s_add_u32 s65,s65,s64
v_readlane_b32 s64,v17,15
s_lshr_b32 s64,s64,8
s_add_u32 s65,s65,s64
s_cmp_ge_u32 s65,256
s_cbranch_scc1 vok_32
s_branch vrt_31
vck_30:
v_cmp_gt_u32 vcc,v18,v17
s_cbranch_vccz vok_32
vrt_31:
s_sleep 8
s_sub_u32 s90,s90,1
s_cmp_gt_i32 s90,0
s_cbranch_scc1 vpoll_29
vok_32:
v_add_u32 v18,160512,v16
ds_write_b32 v18,v17
s_waitcnt lgkmcnt(0)
vot_33:
s_barrier
v_add_u32 v18,160512,v16
ds_read_b32 v17,v18
s_waitcnt lgkmcnt(0)
s_cmp_lg_u32 s56,2
s_cbranch_scc1 vfin_34
v_cmp_eq_u32 vcc,v17,v19
s_and_b32 s64,vcc_lo,0xffff
s_cmp_eq_u32 s64,65535
s_cbranch_scc1 vfin_34
s_mov_b32 s65,0
v_readlane_b32 s64,v17,1
s_lshr_b32 s64,s64,8
s_add_u32 s65,s65,s64
v_readlane_b32 s64,v17,3
s_lshr_b32 s64,s64,8
s_add_u32 s65,s65,s64
v_readlane_b32 s64,v17,5
s_lshr_b32 s64,s64,8
s_add_u32 s65,s65,s64
v_readlane_b32 s64,v17,7
s_lshr_b32 s64,s64,8
s_add_u32 s65,s65,s64
v_readlane_b32 s64,v17,9
s_lshr_b32 s64,s64,8
s_add_u32 s65,s65,s64
v_readlane_b32 s64,v17,11
s_lshr_b32 s64,s64,8
s_add_u32 s65,s65,s64
v_readlane_b32 s64,v17,13
s_lshr_b32 s64,s64,8
s_add_u32 s65,s65,s64
v_readlane_b32 s64,v17,15
s_lshr_b32 s64,s64,8
s_add_u32 s65,s65,s64
s_cmp_ge_u32 s65,256
s_cbranch_scc1 fl_fb
vfin_34:
s_and_b32 s56,s56,1
v_lshlrev_b32 v18,5,v14
s_mov_b32 s64,267386880
buffer_load_dwordx4 v[32:35],v18,s[20:23],s64 offen offset:0 sc1
buffer_load_dwordx4 v[36:39],v18,s[20:23],s64 offen offset:16 sc1
s_mov_b32 s64,267411456
buffer_load_dwordx4 v[40:43],v18,s[20:23],s64 offen offset:0 sc1
buffer_load_dwordx4 v[44:47],v18,s[20:23],s64 offen offset:16 sc1
s_mov_b32 s64,267436032
buffer_load_dwordx4 v[48:51],v18,s[20:23],s64 offen offset:0 sc1
buffer_load_dwordx4 v[52:55],v18,s[20:23],s64 offen offset:16 sc1
s_mov_b32 s64,267460608
buffer_load_dwordx4 v[56:59],v18,s[20:23],s64 offen offset:0 sc1
buffer_load_dwordx4 v[60:63],v18,s[20:23],s64 offen offset:16 sc1
s_cmp_gt_u32 s50,1
s_cselect_b32 s64,1.0,0
s_waitcnt vmcnt(0)
v_pk_add_f32 v[32:33],v[32:33],v[40:41]
v_pk_add_f32 v[48:49],v[48:49],v[56:57]
v_pk_add_f32 v[34:35],v[34:35],v[42:43]
v_pk_add_f32 v[50:51],v[50:51],v[58:59]
v_pk_add_f32 v[36:37],v[36:37],v[44:45]
v_pk_add_f32 v[52:53],v[52:53],v[60:61]
v_pk_add_f32 v[38:39],v[38:39],v[46:47]
v_pk_add_f32 v[54:55],v[54:55],v[62:63]
v_pk_add_f32 v[32:33],v[32:33],v[48:49]
v_pk_add_f32 v[34:35],v[34:35],v[50:51]
v_pk_add_f32 v[36:37],v[36:37],v[52:53]
v_pk_add_f32 v[38:39],v[38:39],v[54:55]
v_cvt_pk_bf16_f32 v40,v32,v33
v_cvt_pk_bf16_f32 v41,v34,v35
v_cvt_pk_bf16_f32 v42,v36,v37
v_cvt_pk_bf16_f32 v43,v38,v39
v_lshlrev_b32 v32,16,v40
v_and_b32 v33,s73,v40
v_lshlrev_b32 v34,16,v41
v_and_b32 v35,s73,v41
v_lshlrev_b32 v36,16,v42
v_and_b32 v37,s73,v42
v_lshlrev_b32 v38,16,v43
v_and_b32 v39,s73,v43
v_add_f32 v32,s64,v32
v_add_f32 v33,s64,v33
v_add_f32 v34,s64,v34
v_add_f32 v35,s64,v35
v_add_f32 v36,s64,v36
v_add_f32 v37,s64,v37
v_add_f32 v38,s64,v38
v_add_f32 v39,s64,v39
ds_write_b128 v18,v[32:35] offset:0
ds_write_b128 v18,v[36:39] offset:16
s_waitcnt lgkmcnt(0)
s_barrier
ds_read_b128 v[112:115],v9 offset:0
ds_read_b128 v[116:119],v9 offset:16
ds_read_b128 v[120:123],v9 offset:512
ds_read_b128 v[124:127],v9 offset:528
ds_read_b128 v[96:99],v9 offset:4096
ds_read_b128 v[100:103],v9 offset:4112
ds_read_b128 v[104:107],v9 offset:4608
ds_read_b128 v[108:111],v9 offset:4624
s_add_u32 s61,s61,146800640
s_add_u32 s62,s61,4096
s_waitcnt lgkmcnt(0)
v_fma_f32 v128,v128,v96,v112
v_fma_f32 v129,v129,v97,v113
v_fma_f32 v130,v130,v98,v114
v_fma_f32 v131,v131,v99,v115
v_fma_f32 v132,v132,v100,v116
v_fma_f32 v133,v133,v101,v117
v_fma_f32 v134,v134,v102,v118
v_fma_f32 v135,v135,v103,v119
v_fma_f32 v136,v136,v104,v120
v_fma_f32 v137,v137,v105,v121
v_fma_f32 v138,v138,v106,v122
v_fma_f32 v139,v139,v107,v123
v_fma_f32 v140,v140,v108,v124
v_fma_f32 v141,v141,v109,v125
v_fma_f32 v142,v142,v110,v126
v_fma_f32 v143,v143,v111,v127
v_cvt_pk_bf16_f32 v48,v128,v129
v_cvt_pk_bf16_f32 v49,v130,v131
v_cvt_pk_bf16_f32 v50,v132,v133
v_cvt_pk_bf16_f32 v51,v134,v135
v_cvt_pk_bf16_f32 v52,v136,v137
v_cvt_pk_bf16_f32 v53,v138,v139
v_cvt_pk_bf16_f32 v54,v140,v141
v_cvt_pk_bf16_f32 v55,v142,v143
buffer_store_dwordx4 v[48:51],v10,s[20:23],s61 offen offset:0 sc1
buffer_store_dwordx4 v[52:55],v10,s[20:23],s62 offen offset:0 sc1
v_fma_f32 v144,v144,v96,v112
v_fma_f32 v145,v145,v97,v113
v_fma_f32 v146,v146,v98,v114
v_fma_f32 v147,v147,v99,v115
v_fma_f32 v148,v148,v100,v116
v_fma_f32 v149,v149,v101,v117
v_fma_f32 v150,v150,v102,v118
v_fma_f32 v151,v151,v103,v119
v_fma_f32 v152,v152,v104,v120
v_fma_f32 v153,v153,v105,v121
v_fma_f32 v154,v154,v106,v122
v_fma_f32 v155,v155,v107,v123
v_fma_f32 v156,v156,v108,v124
v_fma_f32 v157,v157,v109,v125
v_fma_f32 v158,v158,v110,v126
v_fma_f32 v159,v159,v111,v127
v_cvt_pk_bf16_f32 v56,v144,v145
v_cvt_pk_bf16_f32 v57,v146,v147
v_cvt_pk_bf16_f32 v58,v148,v149
v_cvt_pk_bf16_f32 v59,v150,v151
v_cvt_pk_bf16_f32 v60,v152,v153
v_cvt_pk_bf16_f32 v61,v154,v155
v_cvt_pk_bf16_f32 v62,v156,v157
v_cvt_pk_bf16_f32 v63,v158,v159
buffer_store_dwordx4 v[56:59],v10,s[20:23],s61 offen offset:64 sc1
buffer_store_dwordx4 v[60:63],v10,s[20:23],s62 offen offset:64 sc1
v_fma_f32 v160,v160,v96,v112
v_fma_f32 v161,v161,v97,v113
v_fma_f32 v162,v162,v98,v114
v_fma_f32 v163,v163,v99,v115
v_fma_f32 v164,v164,v100,v116
v_fma_f32 v165,v165,v101,v117
v_fma_f32 v166,v166,v102,v118
v_fma_f32 v167,v167,v103,v119
v_fma_f32 v168,v168,v104,v120
v_fma_f32 v169,v169,v105,v121
v_fma_f32 v170,v170,v106,v122
v_fma_f32 v171,v171,v107,v123
v_fma_f32 v172,v172,v108,v124
v_fma_f32 v173,v173,v109,v125
v_fma_f32 v174,v174,v110,v126
v_fma_f32 v175,v175,v111,v127
v_cvt_pk_bf16_f32 v64,v160,v161
v_cvt_pk_bf16_f32 v65,v162,v163
v_cvt_pk_bf16_f32 v66,v164,v165
v_cvt_pk_bf16_f32 v67,v166,v167
v_cvt_pk_bf16_f32 v68,v168,v169
v_cvt_pk_bf16_f32 v69,v170,v171
v_cvt_pk_bf16_f32 v70,v172,v173
v_cvt_pk_bf16_f32 v71,v174,v175
buffer_store_dwordx4 v[64:67],v10,s[20:23],s61 offen offset:128 sc1
buffer_store_dwordx4 v[68:71],v10,s[20:23],s62 offen offset:128 sc1
v_fma_f32 v176,v176,v96,v112
v_fma_f32 v177,v177,v97,v113
v_fma_f32 v178,v178,v98,v114
v_fma_f32 v179,v179,v99,v115
v_fma_f32 v180,v180,v100,v116
v_fma_f32 v181,v181,v101,v117
v_fma_f32 v182,v182,v102,v118
v_fma_f32 v183,v183,v103,v119
v_fma_f32 v184,v184,v104,v120
v_fma_f32 v185,v185,v105,v121
v_fma_f32 v186,v186,v106,v122
v_fma_f32 v187,v187,v107,v123
v_fma_f32 v188,v188,v108,v124
v_fma_f32 v189,v189,v109,v125
v_fma_f32 v190,v190,v110,v126
v_fma_f32 v191,v191,v111,v127
v_cvt_pk_bf16_f32 v72,v176,v177
v_cvt_pk_bf16_f32 v73,v178,v179
v_cvt_pk_bf16_f32 v74,v180,v181
v_cvt_pk_bf16_f32 v75,v182,v183
v_cvt_pk_bf16_f32 v76,v184,v185
v_cvt_pk_bf16_f32 v77,v186,v187
v_cvt_pk_bf16_f32 v78,v188,v189
v_cvt_pk_bf16_f32 v79,v190,v191
buffer_store_dwordx4 v[72:75],v10,s[20:23],s61 offen offset:192 sc1
buffer_store_dwordx4 v[76:79],v10,s[20:23],s62 offen offset:192 sc1
s_waitcnt vmcnt(0)
s_barrier
s_cmp_lg_u32 s50,0
s_cbranch_scc1 sig_35
s_mov_b32 s92,s2
s_and_b32 s93,s3,0xffff
s_mov_b32 s94,0x100
s_mov_b32 s95,0x20000
s_add_u32 s64,s88,16
v_mov_b32 v16,1
s_mov_b64 exec,1
buffer_atomic_add v16,off,s[92:95],s64 sc1
s_mov_b64 exec,-1
sig_35:
fl_disp:
s_sub_u32 s59,s58,248
s_cbranch_scc1 nx_36
s_branch fl_w2
nx_36:
s_sub_u32 s59,s58,240
s_cbranch_scc1 nx_37
s_branch fl_w1
nx_37:
s_sub_u32 s59,s58,224
s_cbranch_scc1 nx_38
s_branch fl_att
nx_38:
s_sub_u32 s59,s58,220
s_cbranch_scc1 nx_39
s_branch fl_ln2
nx_39:
s_sub_u32 s59,s58,192
s_cbranch_scc1 nx_40
s_branch fl_w3
nx_40:
s_sub_u32 s59,s58,160
s_cbranch_scc1 nx_41
s_branch fl_w4
nx_41:
s_sub_u32 s59,s58,128
s_branch fl_wo
fl_fb:
s_mov_b32 s92,s2
s_and_b32 s93,s3,0xffff
s_mov_b32 s94,0x100
s_mov_b32 s95,0x20000
s_waitcnt vmcnt(0) lgkmcnt(0)
s_barrier
v_mov_b32 v4,0
s_cmp_lg_u32 s50,0
s_cbranch_scc1 norole_2
s_mov_b64 exec,1
v_mov_b32 v3,1
s_lshl_b32 s52,s51,2
s_add_u32 s52,s52,128
buffer_atomic_add v3,off,s[92:95],s52 sc0 sc1
s_waitcnt vmcnt(0)
ds_write_b32 v4,v3
s_waitcnt lgkmcnt(0)
s_mov_b64 exec,-1
norole_2:
s_barrier
ds_read_b32 v3,v4
v_mbcnt_lo_u32_b32 v16,-1,0
v_and_b32 v16,7,v16
v_lshlrev_b32 v16,2,v16
s_waitcnt lgkmcnt(0)
v_readfirstlane_b32 s49,v3
s_barrier
tp_42:
buffer_load_dword v17,v16,s[92:95],0 offen offset:128 sc1
s_waitcnt vmcnt(0)
v_readlane_b32 s72,v17,0
v_readlane_b32 s73,v17,1
v_readlane_b32 s74,v17,2
v_readlane_b32 s75,v17,3
v_readlane_b32 s76,v17,4
v_readlane_b32 s77,v17,5
v_readlane_b32 s78,v17,6
v_readlane_b32 s79,v17,7
s_add_u32 s65,s72,s73
s_add_u32 s65,s65,s74
s_add_u32 s65,s65,s75
s_add_u32 s65,s65,s76
s_add_u32 s65,s65,s77
s_add_u32 s65,s65,s78
s_add_u32 s65,s65,s79
s_cmp_ge_u32 s65,256
s_cbranch_scc1 tg_43
s_sleep 4
s_sub_u32 s90,s90,1
s_cmp_gt_i32 s90,0
s_cbranch_scc1 tp_42
tg_43:
s_min_u32 s65,s72,s73
s_min_u32 s65,s65,s74
s_min_u32 s65,s65,s75
s_min_u32 s65,s65,s76
s_min_u32 s65,s65,s77
s_min_u32 s65,s65,s78
s_min_u32 s65,s65,s79
s_mov_b32 s88,192
s_cmp_lt_u32 s65,32
s_cbranch_scc1 tsl_44
s_lshl_b32 s64,s51,2
s_lshr_b32 s64,0x76325410,s64
s_and_b32 s64,s64,7
s_lshl_b32 s58,s64,5
s_add_u32 s58,s58,s49
s_mov_b32 s56,0
s_branch fl_disp0
tsl_44:
s_mov_b32 s58,s49
s_cmp_gt_u32 s51,0
s_cselect_b32 s65,s72,0
s_add_u32 s58,s58,s65
s_cmp_gt_u32 s51,1
s_cselect_b32 s65,s73,0
s_add_u32 s58,s58,s65
s_cmp_gt_u32 s51,2
s_cselect_b32 s65,s74,0
s_add_u32 s58,s58,s65
s_cmp_gt_u32 s51,3
s_cselect_b32 s65,s75,0
s_add_u32 s58,s58,s65
s_cmp_gt_u32 s51,4
s_cselect_b32 s65,s76,0
s_add_u32 s58,s58,s65
s_cmp_gt_u32 s51,5
s_cselect_b32 s65,s77,0
s_add_u32 s58,s58,s65
s_cmp_gt_u32 s51,6
s_cselect_b32 s65,s78,0
s_add_u32 s58,s58,s65
s_mov_b32 s56,1
s_cmp_lt_u32 s58,256
s_cbranch_scc1 fl_disp0
done_1:
s_endpgm
fl_qkv:
v_and_b32 v21,15,v1
v_lshrrev_b32 v22,4,v1
v_lshrrev_b32 v23,2,v21
v_and_b32 v24,3,v21
s_lshl_b32 s61,s50,15
v_lshl_add_u32 v25,v22,3,v23
s_load_dwordx4 s[4:7],s[0:1],16
s_load_dwordx2 s[8:9],s[0:1],32
s_lshl_b32 s52,s59,7
s_and_b32 s64,s50,1
s_lshl_b32 s65,s64,6
s_add_u32 s53,s52,s65
s_lshr_b32 s65,s50,1
s_lshl_b32 s65,s65,6
s_add_u32 s52,s52,s65
s_lshl_b32 s54,s64,3
s_waitcnt lgkmcnt(0)
s_cmp_gt_u32 s50,1
s_cselect_b64 s[10:11],s[4:5],s[6:7]
s_mov_b32 s28,s10
s_and_b32 s29,s11,0xffff
s_mov_b32 s30,0x800000
s_mov_b32 s31,0x20000
s_mov_b32 s32,s8
s_and_b32 s33,s9,0xffff
s_mov_b32 s34,0x800000
s_mov_b32 s35,0x20000
s_and_b32 s64,s59,7
s_lshl_b32 s65,s64,3
s_and_b32 s66,s50,1
s_lshl_b32 s55,s66,2
s_add_u32 s65,s65,s55
s_lshl_b32 s66,s66,5
s_lshl_b32 s65,s65,13
s_andn2_b32 s55,s59,7
s_lshl_b32 s55,s55,7
s_add_u32 s65,s65,s55
s_add_u32 s65,s65,384
v_and_b32 v28,3,v1
v_lshlrev_b32 v28,13,v28
v_add_u32 v28,s65,v28
v_and_b32 v15,4,v1
v_lshl_add_u32 v28,v15,4,v28
s_and_b32 s55,s59,31
s_add_u32 s66,s66,s55
s_lshl_b32 s66,s66,13
s_add_u32 s66,s66,8064
v_writelane_b32 v28,s66,8
s_add_u32 s66,s66,64
v_writelane_b32 v28,s66,9
s_cmp_eq_u32 s64,3
s_cselect_b32 s65,0,15
s_sub_u32 s66,s59,32
s_cmp_lt_u32 s66,31
s_cselect_b32 s66,256,0
s_or_b32 vcc_lo,s65,s66
s_mov_b32 vcc_hi,0
v_cndmask_b32 v28,-1,v28,vcc
s_and_b32 s64,s59,7
s_lshl_b32 s65,s64,4
s_lshl_b32 s55,s50,2
s_add_u32 s65,s65,s55
s_lshl_b32 s66,s50,5
s_lshl_b32 s65,s65,13
s_andn2_b32 s55,s59,7
s_lshl_b32 s55,s55,7
s_add_u32 s65,s65,s55
s_add_u32 s65,s65,384
v_and_b32 v31,3,v1
v_lshlrev_b32 v31,13,v31
v_add_u32 v31,s65,v31
v_and_b32 v15,4,v1
v_lshl_add_u32 v31,v15,4,v31
s_and_b32 s55,s59,31
s_add_u32 s66,s66,s55
s_lshl_b32 s66,s66,13
s_add_u32 s66,s66,8064
v_writelane_b32 v31,s66,8
s_add_u32 s66,s66,64
v_writelane_b32 v31,s66,9
s_cmp_eq_u32 s64,3
s_cselect_b32 s65,0,15
s_sub_u32 s66,s59,32
s_cmp_lt_u32 s66,31
s_cselect_b32 s66,256,0
s_or_b32 vcc_lo,s65,s66
s_mov_b32 vcc_hi,0
v_cndmask_b32 v31,-1,v31,vcc
s_and_b32 s60,s50,1
s_lshl_b32 s60,s60,1
v_lshrrev_b32 v26,2,v1
v_and_b32 v27,3,v1
v_mul_u32_u24 v16,8192,v26
v_lshl_add_u32 v16,v27,4,v16
v_lshlrev_b32 v17,6,v25
v_lshl_add_u32 v17,v24,4,v17
v_add_u32 v17,s61,v17
s_mov_b32 s64,1048576
buffer_load_dword v29,v28,s[28:31],s64 offen
s_mov_b32 s64,1572864
buffer_load_dword v29,v28,s[28:31],s64 offen
s_add_u32 s62,s53,0
s_add_u32 m0,s61,0
s_nop 0
buffer_load_dwordx4 v16,s[28:31],s62 offen lds
s_add_u32 s62,s62,131072
s_add_u32 m0,m0,1024
s_waitcnt vmcnt(10)
buffer_load_dwordx4 v16,s[28:31],s62 offen lds
s_add_u32 s62,s62,131072
s_add_u32 m0,m0,1024
s_mov_b32 s64,0
buffer_load_dword v29,v31,s[32:35],s64 offen
s_waitcnt vmcnt(10)
buffer_load_dwordx4 v16,s[28:31],s62 offen lds
s_add_u32 s62,s62,131072
s_add_u32 m0,m0,1024
s_waitcnt vmcnt(10)
buffer_load_dwordx4 v16,s[28:31],s62 offen lds
s_add_u32 s62,s62,131072
s_add_u32 m0,m0,1024
s_waitcnt vmcnt(10)
buffer_load_dwordx4 v16,s[28:31],s62 offen lds
s_add_u32 s62,s62,131072
s_add_u32 m0,m0,1024
s_waitcnt vmcnt(10)
buffer_load_dwordx4 v16,s[28:31],s62 offen lds
s_add_u32 s62,s62,131072
s_add_u32 m0,m0,1024
s_waitcnt vmcnt(10)
buffer_load_dwordx4 v16,s[28:31],s62 offen lds
s_add_u32 s62,s62,131072
s_add_u32 m0,m0,1024
s_waitcnt vmcnt(10)
buffer_load_dwordx4 v16,s[28:31],s62 offen lds
s_add_u32 s62,s62,131072
s_add_u32 m0,m0,1024
s_waitcnt vmcnt(10)
buffer_load_dwordx4 v16,s[28:31],s62 offen lds
s_add_u32 s62,s62,131072
s_add_u32 m0,m0,1024
s_waitcnt vmcnt(10)
buffer_load_dwordx4 v16,s[28:31],s62 offen lds
s_add_u32 s62,s62,131072
s_add_u32 m0,m0,1024
s_mov_b32 s64,1048576
buffer_load_dword v29,v31,s[32:35],s64 offen
s_waitcnt vmcnt(10)
buffer_load_dwordx4 v16,s[28:31],s62 offen lds
s_add_u32 s62,s62,131072
s_add_u32 m0,m0,1024
s_waitcnt vmcnt(10)
buffer_load_dwordx4 v16,s[28:31],s62 offen lds
s_add_u32 s62,s62,131072
s_add_u32 m0,m0,1024
s_waitcnt vmcnt(10)
buffer_load_dwordx4 v16,s[28:31],s62 offen lds
s_add_u32 s62,s62,131072
s_add_u32 m0,m0,1024
s_waitcnt vmcnt(10)
buffer_load_dwordx4 v16,s[28:31],s62 offen lds
s_add_u32 s62,s62,131072
s_add_u32 m0,m0,1024
s_waitcnt vmcnt(10)
buffer_load_dwordx4 v16,s[28:31],s62 offen lds
s_add_u32 s62,s62,131072
s_add_u32 m0,m0,1024
s_waitcnt vmcnt(10)
buffer_load_dwordx4 v16,s[28:31],s62 offen lds
s_waitcnt vmcnt(10)
s_add_u32 s62,s52,0
s_add_u32 m0,s61,16384
s_nop 0
buffer_load_dwordx4 v16,s[32:35],s62 offen lds
s_add_u32 s62,s62,131072
s_add_u32 m0,m0,1024
s_waitcnt vmcnt(10)
buffer_load_dwordx4 v16,s[32:35],s62 offen lds
s_add_u32 s62,s62,131072
s_add_u32 m0,m0,1024
s_mov_b32 s64,2097152
buffer_load_dword v29,v28,s[28:31],s64 offen
s_waitcnt vmcnt(10)
buffer_load_dwordx4 v16,s[32:35],s62 offen lds
s_add_u32 s62,s62,131072
s_add_u32 m0,m0,1024
s_waitcnt vmcnt(10)
buffer_load_dwordx4 v16,s[32:35],s62 offen lds
s_add_u32 s62,s62,131072
s_add_u32 m0,m0,1024
s_waitcnt vmcnt(10)
buffer_load_dwordx4 v16,s[32:35],s62 offen lds
s_add_u32 s62,s62,131072
s_add_u32 m0,m0,1024
s_waitcnt vmcnt(10)
buffer_load_dwordx4 v16,s[32:35],s62 offen lds
s_add_u32 s62,s62,131072
s_add_u32 m0,m0,1024
s_mov_b32 s64,2621440
buffer_load_dword v29,v28,s[28:31],s64 offen
s_waitcnt vmcnt(10)
buffer_load_dwordx4 v16,s[32:35],s62 offen lds
s_add_u32 s62,s62,131072
s_add_u32 m0,m0,1024
s_waitcnt vmcnt(10)
buffer_load_dwordx4 v16,s[32:35],s62 offen lds
s_add_u32 s62,s62,131072
s_add_u32 m0,m0,1024
s_waitcnt vmcnt(10)
buffer_load_dwordx4 v16,s[32:35],s62 offen lds
s_add_u32 s62,s62,131072
s_add_u32 m0,m0,1024
s_waitcnt vmcnt(10)
buffer_load_dwordx4 v16,s[32:35],s62 offen lds
s_add_u32 s62,s62,131072
s_add_u32 m0,m0,1024
s_mov_b32 s64,3145728
buffer_load_dword v29,v28,s[28:31],s64 offen
s_waitcnt vmcnt(10)
buffer_load_dwordx4 v16,s[32:35],s62 offen lds
s_add_u32 s62,s62,131072
s_add_u32 m0,m0,1024
s_waitcnt vmcnt(10)
buffer_load_dwordx4 v16,s[32:35],s62 offen lds
s_add_u32 s62,s62,131072
s_add_u32 m0,m0,1024
s_waitcnt vmcnt(10)
buffer_load_dwordx4 v16,s[32:35],s62 offen lds
s_add_u32 s62,s62,131072
s_add_u32 m0,m0,1024
s_waitcnt vmcnt(10)
buffer_load_dwordx4 v16,s[32:35],s62 offen lds
s_add_u32 s62,s62,131072
s_add_u32 m0,m0,1024
s_mov_b32 s64,3670016
buffer_load_dword v29,v28,s[28:31],s64 offen
s_waitcnt vmcnt(10)
buffer_load_dwordx4 v16,s[32:35],s62 offen lds
s_add_u32 s62,s62,131072
s_add_u32 m0,m0,1024
s_waitcnt vmcnt(10)
buffer_load_dwordx4 v16,s[32:35],s62 offen lds
s_waitcnt vmcnt(10)
s_waitcnt vmcnt(20)
ds_read_b64_tr_b16 a[0:1],v17 offset:0
ds_read_b64_tr_b16 a[2:3],v17 offset:256
ds_read_b64_tr_b16 a[4:5],v17 offset:8
ds_read_b64_tr_b16 a[6:7],v17 offset:264
ds_read_b64_tr_b16 a[12:13],v17 offset:2048
ds_read_b64_tr_b16 a[14:15],v17 offset:2304
ds_read_b64_tr_b16 a[16:17],v17 offset:2056
ds_read_b64_tr_b16 a[18:19],v17 offset:2312
ds_read_b64_tr_b16 a[24:25],v17 offset:4096
ds_read_b64_tr_b16 a[26:27],v17 offset:4352
ds_read_b64_tr_b16 a[28:29],v17 offset:4104
ds_read_b64_tr_b16 a[30:31],v17 offset:4360
s_waitcnt lgkmcnt(0)
ds_read_b64_tr_b16 a[36:37],v17 offset:6144
ds_read_b64_tr_b16 a[38:39],v17 offset:6400
ds_read_b64_tr_b16 a[40:41],v17 offset:6152
ds_read_b64_tr_b16 a[42:43],v17 offset:6408
ds_read_b64_tr_b16 a[48:49],v17 offset:8192
ds_read_b64_tr_b16 a[50:51],v17 offset:8448
ds_read_b64_tr_b16 a[52:53],v17 offset:8200
ds_read_b64_tr_b16 a[54:55],v17 offset:8456
ds_read_b64_tr_b16 a[60:61],v17 offset:10240
ds_read_b64_tr_b16 a[62:63],v17 offset:10496
ds_read_b64_tr_b16 a[64:65],v17 offset:10248
ds_read_b64_tr_b16 a[66:67],v17 offset:10504
s_waitcnt lgkmcnt(0)
ds_read_b64_tr_b16 a[72:73],v17 offset:12288
ds_read_b64_tr_b16 a[74:75],v17 offset:12544
ds_read_b64_tr_b16 a[76:77],v17 offset:12296
ds_read_b64_tr_b16 a[78:79],v17 offset:12552
ds_read_b64_tr_b16 a[84:85],v17 offset:14336
ds_read_b64_tr_b16 a[86:87],v17 offset:14592
ds_read_b64_tr_b16 a[88:89],v17 offset:14344
ds_read_b64_tr_b16 a[90:91],v17 offset:14600
s_waitcnt lgkmcnt(0)
s_add_u32 s62,s53,2097152
s_add_u32 m0,s61,0
s_nop 0
buffer_load_dwordx4 v16,s[28:31],s62 offen lds
s_add_u32 s62,s62,131072
s_add_u32 m0,m0,1024
s_waitcnt vmcnt(10)
buffer_load_dwordx4 v16,s[28:31],s62 offen lds
s_add_u32 s62,s62,131072
s_add_u32 m0,m0,1024
s_mov_b32 s64,2097152
buffer_load_dword v29,v31,s[32:35],s64 offen
s_waitcnt vmcnt(10)
buffer_load_dwordx4 v16,s[28:31],s62 offen lds
s_add_u32 s62,s62,131072
s_add_u32 m0,m0,1024
s_waitcnt vmcnt(10)
buffer_load_dwordx4 v16,s[28:31],s62 offen lds
s_add_u32 s62,s62,131072
s_add_u32 m0,m0,1024
s_waitcnt vmcnt(10)
buffer_load_dwordx4 v16,s[28:31],s62 offen lds
s_add_u32 s62,s62,131072
s_add_u32 m0,m0,1024
s_waitcnt vmcnt(10)
buffer_load_dwordx4 v16,s[28:31],s62 offen lds
s_add_u32 s62,s62,131072
s_add_u32 m0,m0,1024
s_waitcnt vmcnt(10)
buffer_load_dwordx4 v16,s[28:31],s62 offen lds
s_add_u32 s62,s62,131072
s_add_u32 m0,m0,1024
s_waitcnt vmcnt(10)
buffer_load_dwordx4 v16,s[28:31],s62 offen lds
s_add_u32 s62,s62,131072
s_add_u32 m0,m0,1024
s_waitcnt vmcnt(10)
buffer_load_dwordx4 v16,s[28:31],s62 offen lds
s_add_u32 s62,s62,131072
s_add_u32 m0,m0,1024
s_waitcnt vmcnt(10)
buffer_load_dwordx4 v16,s[28:31],s62 offen lds
s_add_u32 s62,s62,131072
s_add_u32 m0,m0,1024
s_mov_b32 s64,3145728
buffer_load_dword v29,v31,s[32:35],s64 offen
s_waitcnt vmcnt(10)
buffer_load_dwordx4 v16,s[28:31],s62 offen lds
s_add_u32 s62,s62,131072
s_add_u32 m0,m0,1024
s_waitcnt vmcnt(10)
buffer_load_dwordx4 v16,s[28:31],s62 offen lds
s_add_u32 s62,s62,131072
s_add_u32 m0,m0,1024
s_waitcnt vmcnt(10)
buffer_load_dwordx4 v16,s[28:31],s62 offen lds
s_add_u32 s62,s62,131072
s_add_u32 m0,m0,1024
s_waitcnt vmcnt(10)
buffer_load_dwordx4 v16,s[28:31],s62 offen lds
s_add_u32 s62,s62,131072
s_add_u32 m0,m0,1024
s_waitcnt vmcnt(10)
buffer_load_dwordx4 v16,s[28:31],s62 offen lds
s_add_u32 s62,s62,131072
s_add_u32 m0,m0,1024
s_waitcnt vmcnt(10)
buffer_load_dwordx4 v16,s[28:31],s62 offen lds
s_waitcnt vmcnt(10)
s_waitcnt vmcnt(18)
v_add_u32 v18,s54,v17
ds_read_b64_tr_b16 a[8:9],v18 offset:16384
ds_read_b64_tr_b16 a[10:11],v18 offset:16640
ds_read_b64_tr_b16 a[20:21],v18 offset:18432
ds_read_b64_tr_b16 a[22:23],v18 offset:18688
ds_read_b64_tr_b16 a[32:33],v18 offset:20480
ds_read_b64_tr_b16 a[34:35],v18 offset:20736
ds_read_b64_tr_b16 a[44:45],v18 offset:22528
ds_read_b64_tr_b16 a[46:47],v18 offset:22784
ds_read_b64_tr_b16 a[56:57],v18 offset:24576
ds_read_b64_tr_b16 a[58:59],v18 offset:24832
ds_read_b64_tr_b16 a[68:69],v18 offset:26624
ds_read_b64_tr_b16 a[70:71],v18 offset:26880
s_waitcnt lgkmcnt(0)
ds_read_b64_tr_b16 a[80:81],v18 offset:28672
ds_read_b64_tr_b16 a[82:83],v18 offset:28928
ds_read_b64_tr_b16 a[92:93],v18 offset:30720
ds_read_b64_tr_b16 a[94:95],v18 offset:30976
s_waitcnt lgkmcnt(0)
s_add_u32 s62,s52,2097152
s_add_u32 m0,s61,16384
s_nop 0
buffer_load_dwordx4 v16,s[32:35],s62 offen lds
s_add_u32 s62,s62,131072
s_add_u32 m0,m0,1024
s_waitcnt vmcnt(10)
buffer_load_dwordx4 v16,s[32:35],s62 offen lds
s_add_u32 s62,s62,131072
s_add_u32 m0,m0,1024
s_mov_b32 s64,4194304
buffer_load_dword v29,v28,s[28:31],s64 offen
s_waitcnt vmcnt(10)
buffer_load_dwordx4 v16,s[32:35],s62 offen lds
s_add_u32 s62,s62,131072
s_add_u32 m0,m0,1024
s_waitcnt vmcnt(10)
buffer_load_dwordx4 v16,s[32:35],s62 offen lds
s_add_u32 s62,s62,131072
s_add_u32 m0,m0,1024
s_waitcnt vmcnt(10)
buffer_load_dwordx4 v16,s[32:35],s62 offen lds
s_add_u32 s62,s62,131072
s_add_u32 m0,m0,1024
s_waitcnt vmcnt(10)
buffer_load_dwordx4 v16,s[32:35],s62 offen lds
s_add_u32 s62,s62,131072
s_add_u32 m0,m0,1024
s_mov_b32 s64,4718592
buffer_load_dword v29,v28,s[28:31],s64 offen
s_waitcnt vmcnt(10)
buffer_load_dwordx4 v16,s[32:35],s62 offen lds
s_add_u32 s62,s62,131072
s_add_u32 m0,m0,1024
s_waitcnt vmcnt(10)
buffer_load_dwordx4 v16,s[32:35],s62 offen lds
s_add_u32 s62,s62,131072
s_add_u32 m0,m0,1024
s_waitcnt vmcnt(10)
buffer_load_dwordx4 v16,s[32:35],s62 offen lds
s_add_u32 s62,s62,131072
s_add_u32 m0,m0,1024
s_waitcnt vmcnt(10)
buffer_load_dwordx4 v16,s[32:35],s62 offen lds
s_add_u32 s62,s62,131072
s_add_u32 m0,m0,1024
s_mov_b32 s64,5242880
buffer_load_dword v29,v28,s[28:31],s64 offen
s_waitcnt vmcnt(10)
buffer_load_dwordx4 v16,s[32:35],s62 offen lds
s_add_u32 s62,s62,131072
s_add_u32 m0,m0,1024
s_waitcnt vmcnt(10)
buffer_load_dwordx4 v16,s[32:35],s62 offen lds
s_add_u32 s62,s62,131072
s_add_u32 m0,m0,1024
s_waitcnt vmcnt(10)
buffer_load_dwordx4 v16,s[32:35],s62 offen lds
s_add_u32 s62,s62,131072
s_add_u32 m0,m0,1024
s_waitcnt vmcnt(10)
buffer_load_dwordx4 v16,s[32:35],s62 offen lds
s_add_u32 s62,s62,131072
s_add_u32 m0,m0,1024
s_mov_b32 s64,5767168
buffer_load_dword v29,v28,s[28:31],s64 offen
s_waitcnt vmcnt(10)
buffer_load_dwordx4 v16,s[32:35],s62 offen lds
s_add_u32 s62,s62,131072
s_add_u32 m0,m0,1024
s_waitcnt vmcnt(10)
buffer_load_dwordx4 v16,s[32:35],s62 offen lds
s_waitcnt vmcnt(10)
s_waitcnt vmcnt(20)
ds_read_b64_tr_b16 a[96:97],v17 offset:0
ds_read_b64_tr_b16 a[98:99],v17 offset:256
ds_read_b64_tr_b16 a[100:101],v17 offset:8
ds_read_b64_tr_b16 a[102:103],v17 offset:264
ds_read_b64_tr_b16 a[108:109],v17 offset:2048
ds_read_b64_tr_b16 a[110:111],v17 offset:2304
ds_read_b64_tr_b16 a[112:113],v17 offset:2056
ds_read_b64_tr_b16 a[114:115],v17 offset:2312
ds_read_b64_tr_b16 a[120:121],v17 offset:4096
ds_read_b64_tr_b16 a[122:123],v17 offset:4352
ds_read_b64_tr_b16 a[124:125],v17 offset:4104
ds_read_b64_tr_b16 a[126:127],v17 offset:4360
s_waitcnt lgkmcnt(0)
ds_read_b64_tr_b16 a[132:133],v17 offset:6144
ds_read_b64_tr_b16 a[134:135],v17 offset:6400
ds_read_b64_tr_b16 a[136:137],v17 offset:6152
ds_read_b64_tr_b16 a[138:139],v17 offset:6408
ds_read_b64_tr_b16 a[144:145],v17 offset:8192
ds_read_b64_tr_b16 a[146:147],v17 offset:8448
ds_read_b64_tr_b16 a[148:149],v17 offset:8200
ds_read_b64_tr_b16 a[150:151],v17 offset:8456
ds_read_b64_tr_b16 a[156:157],v17 offset:10240
ds_read_b64_tr_b16 a[158:159],v17 offset:10496
ds_read_b64_tr_b16 a[160:161],v17 offset:10248
ds_read_b64_tr_b16 a[162:163],v17 offset:10504
s_waitcnt lgkmcnt(0)
ds_read_b64_tr_b16 a[168:169],v17 offset:12288
ds_read_b64_tr_b16 a[170:171],v17 offset:12544
ds_read_b64_tr_b16 a[172:173],v17 offset:12296
ds_read_b64_tr_b16 a[174:175],v17 offset:12552
ds_read_b64_tr_b16 a[180:181],v17 offset:14336
ds_read_b64_tr_b16 a[182:183],v17 offset:14592
ds_read_b64_tr_b16 a[184:185],v17 offset:14344
ds_read_b64_tr_b16 a[186:187],v17 offset:14600
s_waitcnt lgkmcnt(0)
s_add_u32 s62,s53,4194304
s_add_u32 m0,s61,0
s_nop 0
buffer_load_dwordx4 v16,s[28:31],s62 offen lds
s_add_u32 s62,s62,131072
s_add_u32 m0,m0,1024
s_waitcnt vmcnt(10)
buffer_load_dwordx4 v16,s[28:31],s62 offen lds
s_add_u32 s62,s62,131072
s_add_u32 m0,m0,1024
s_mov_b32 s64,4194304
buffer_load_dword v29,v31,s[32:35],s64 offen
s_waitcnt vmcnt(10)
buffer_load_dwordx4 v16,s[28:31],s62 offen lds
s_add_u32 s62,s62,131072
s_add_u32 m0,m0,1024
s_waitcnt vmcnt(10)
buffer_load_dwordx4 v16,s[28:31],s62 offen lds
s_add_u32 s62,s62,131072
s_add_u32 m0,m0,1024
s_waitcnt vmcnt(10)
buffer_load_dwordx4 v16,s[28:31],s62 offen lds
s_add_u32 s62,s62,131072
s_add_u32 m0,m0,1024
s_waitcnt vmcnt(10)
buffer_load_dwordx4 v16,s[28:31],s62 offen lds
s_add_u32 s62,s62,131072
s_add_u32 m0,m0,1024
s_waitcnt vmcnt(10)
buffer_load_dwordx4 v16,s[28:31],s62 offen lds
s_add_u32 s62,s62,131072
s_add_u32 m0,m0,1024
s_waitcnt vmcnt(10)
buffer_load_dwordx4 v16,s[28:31],s62 offen lds
s_add_u32 s62,s62,131072
s_add_u32 m0,m0,1024
s_waitcnt vmcnt(10)
buffer_load_dwordx4 v16,s[28:31],s62 offen lds
s_add_u32 s62,s62,131072
s_add_u32 m0,m0,1024
s_waitcnt vmcnt(10)
buffer_load_dwordx4 v16,s[28:31],s62 offen lds
s_add_u32 s62,s62,131072
s_add_u32 m0,m0,1024
s_mov_b32 s64,5242880
buffer_load_dword v29,v31,s[32:35],s64 offen
s_waitcnt vmcnt(10)
buffer_load_dwordx4 v16,s[28:31],s62 offen lds
s_add_u32 s62,s62,131072
s_add_u32 m0,m0,1024
s_waitcnt vmcnt(10)
buffer_load_dwordx4 v16,s[28:31],s62 offen lds
s_add_u32 s62,s62,131072
s_add_u32 m0,m0,1024
s_waitcnt vmcnt(10)
buffer_load_dwordx4 v16,s[28:31],s62 offen lds
s_add_u32 s62,s62,131072
s_add_u32 m0,m0,1024
s_waitcnt vmcnt(10)
buffer_load_dwordx4 v16,s[28:31],s62 offen lds
s_add_u32 s62,s62,131072
s_add_u32 m0,m0,1024
s_waitcnt vmcnt(10)
buffer_load_dwordx4 v16,s[28:31],s62 offen lds
s_add_u32 s62,s62,131072
s_add_u32 m0,m0,1024
s_waitcnt vmcnt(10)
buffer_load_dwordx4 v16,s[28:31],s62 offen lds
s_waitcnt vmcnt(10)
s_waitcnt vmcnt(18)
ds_read_b64_tr_b16 a[104:105],v18 offset:16384
ds_read_b64_tr_b16 a[106:107],v18 offset:16640
ds_read_b64_tr_b16 a[116:117],v18 offset:18432
ds_read_b64_tr_b16 a[118:119],v18 offset:18688
ds_read_b64_tr_b16 a[128:129],v18 offset:20480
ds_read_b64_tr_b16 a[130:131],v18 offset:20736
ds_read_b64_tr_b16 a[140:141],v18 offset:22528
ds_read_b64_tr_b16 a[142:143],v18 offset:22784
ds_read_b64_tr_b16 a[152:153],v18 offset:24576
ds_read_b64_tr_b16 a[154:155],v18 offset:24832
ds_read_b64_tr_b16 a[164:165],v18 offset:26624
ds_read_b64_tr_b16 a[166:167],v18 offset:26880
s_waitcnt lgkmcnt(0)
ds_read_b64_tr_b16 a[176:177],v18 offset:28672
ds_read_b64_tr_b16 a[178:179],v18 offset:28928
ds_read_b64_tr_b16 a[188:189],v18 offset:30720
ds_read_b64_tr_b16 a[190:191],v18 offset:30976
s_waitcnt lgkmcnt(0)
s_add_u32 s62,s52,4194304
s_add_u32 m0,s61,16384
s_nop 0
buffer_load_dwordx4 v16,s[32:35],s62 offen lds
s_add_u32 s62,s62,131072
s_add_u32 m0,m0,1024
s_waitcnt vmcnt(10)
buffer_load_dwordx4 v16,s[32:35],s62 offen lds
s_add_u32 s62,s62,131072
s_add_u32 m0,m0,1024
s_mov_b32 s64,6291456
buffer_load_dword v29,v28,s[28:31],s64 offen
s_waitcnt vmcnt(10)
buffer_load_dwordx4 v16,s[32:35],s62 offen lds
s_add_u32 s62,s62,131072
s_add_u32 m0,m0,1024
s_waitcnt vmcnt(10)
buffer_load_dwordx4 v16,s[32:35],s62 offen lds
s_add_u32 s62,s62,131072
s_add_u32 m0,m0,1024
s_waitcnt vmcnt(10)
buffer_load_dwordx4 v16,s[32:35],s62 offen lds
s_add_u32 s62,s62,131072
s_add_u32 m0,m0,1024
s_waitcnt vmcnt(10)
buffer_load_dwordx4 v16,s[32:35],s62 offen lds
s_add_u32 s62,s62,131072
s_add_u32 m0,m0,1024
s_mov_b32 s64,6815744
buffer_load_dword v29,v28,s[28:31],s64 offen
s_waitcnt vmcnt(10)
buffer_load_dwordx4 v16,s[32:35],s62 offen lds
s_add_u32 s62,s62,131072
s_add_u32 m0,m0,1024
s_waitcnt vmcnt(10)
buffer_load_dwordx4 v16,s[32:35],s62 offen lds
s_add_u32 s62,s62,131072
s_add_u32 m0,m0,1024
s_waitcnt vmcnt(10)
buffer_load_dwordx4 v16,s[32:35],s62 offen lds
s_add_u32 s62,s62,131072
s_add_u32 m0,m0,1024
s_waitcnt vmcnt(10)
buffer_load_dwordx4 v16,s[32:35],s62 offen lds
s_add_u32 s62,s62,131072
s_add_u32 m0,m0,1024
s_mov_b32 s64,7340032
buffer_load_dword v29,v28,s[28:31],s64 offen
s_waitcnt vmcnt(10)
buffer_load_dwordx4 v16,s[32:35],s62 offen lds
s_add_u32 s62,s62,131072
s_add_u32 m0,m0,1024
s_waitcnt vmcnt(10)
buffer_load_dwordx4 v16,s[32:35],s62 offen lds
s_add_u32 s62,s62,131072
s_add_u32 m0,m0,1024
s_waitcnt vmcnt(10)
buffer_load_dwordx4 v16,s[32:35],s62 offen lds
s_add_u32 s62,s62,131072
s_add_u32 m0,m0,1024
s_waitcnt vmcnt(10)
buffer_load_dwordx4 v16,s[32:35],s62 offen lds
s_add_u32 s62,s62,131072
s_add_u32 m0,m0,1024
s_mov_b32 s64,7864320
buffer_load_dword v29,v28,s[28:31],s64 offen
s_waitcnt vmcnt(10)
buffer_load_dwordx4 v16,s[32:35],s62 offen lds
s_add_u32 s62,s62,131072
s_add_u32 m0,m0,1024
s_waitcnt vmcnt(10)
buffer_load_dwordx4 v16,s[32:35],s62 offen lds
s_waitcnt vmcnt(10)
s_waitcnt vmcnt(20)
ds_read_b64_tr_b16 a[192:193],v17 offset:0
ds_read_b64_tr_b16 a[194:195],v17 offset:256
ds_read_b64_tr_b16 a[196:197],v17 offset:8
ds_read_b64_tr_b16 a[198:199],v17 offset:264
ds_read_b64_tr_b16 a[204:205],v17 offset:2048
ds_read_b64_tr_b16 a[206:207],v17 offset:2304
ds_read_b64_tr_b16 a[208:209],v17 offset:2056
ds_read_b64_tr_b16 a[210:211],v17 offset:2312
ds_read_b64_tr_b16 a[216:217],v17 offset:4096
ds_read_b64_tr_b16 a[218:219],v17 offset:4352
ds_read_b64_tr_b16 a[220:221],v17 offset:4104
ds_read_b64_tr_b16 a[222:223],v17 offset:4360
s_waitcnt lgkmcnt(0)
ds_read_b64_tr_b16 a[228:229],v17 offset:6144
ds_read_b64_tr_b16 a[230:231],v17 offset:6400
ds_read_b64_tr_b16 a[232:233],v17 offset:6152
ds_read_b64_tr_b16 a[234:235],v17 offset:6408
ds_read_b64_tr_b16 a[240:241],v17 offset:8192
ds_read_b64_tr_b16 a[242:243],v17 offset:8448
ds_read_b64_tr_b16 a[244:245],v17 offset:8200
ds_read_b64_tr_b16 a[246:247],v17 offset:8456
ds_read_b64_tr_b16 a[252:253],v17 offset:10240
ds_read_b64_tr_b16 a[254:255],v17 offset:10496
ds_read_b64_tr_b16 v[128:129],v17 offset:10248
ds_read_b64_tr_b16 v[130:131],v17 offset:10504
s_waitcnt lgkmcnt(0)
ds_read_b64_tr_b16 v[136:137],v17 offset:12288
ds_read_b64_tr_b16 v[138:139],v17 offset:12544
ds_read_b64_tr_b16 v[140:141],v17 offset:12296
ds_read_b64_tr_b16 v[142:143],v17 offset:12552
ds_read_b64_tr_b16 v[148:149],v17 offset:14336
ds_read_b64_tr_b16 v[150:151],v17 offset:14592
ds_read_b64_tr_b16 v[152:153],v17 offset:14344
ds_read_b64_tr_b16 v[154:155],v17 offset:14600
s_waitcnt lgkmcnt(0)
s_add_u32 s62,s53,6291456
s_add_u32 m0,s61,0
s_nop 0
buffer_load_dwordx4 v16,s[28:31],s62 offen lds
s_add_u32 s62,s62,131072
s_add_u32 m0,m0,1024
s_waitcnt vmcnt(10)
buffer_load_dwordx4 v16,s[28:31],s62 offen lds
s_add_u32 s62,s62,131072
s_add_u32 m0,m0,1024
s_mov_b32 s64,6291456
buffer_load_dword v29,v31,s[32:35],s64 offen
s_waitcnt vmcnt(10)
buffer_load_dwordx4 v16,s[28:31],s62 offen lds
s_add_u32 s62,s62,131072
s_add_u32 m0,m0,1024
s_waitcnt vmcnt(10)
buffer_load_dwordx4 v16,s[28:31],s62 offen lds
s_add_u32 s62,s62,131072
s_add_u32 m0,m0,1024
s_waitcnt vmcnt(10)
buffer_load_dwordx4 v16,s[28:31],s62 offen lds
s_add_u32 s62,s62,131072
s_add_u32 m0,m0,1024
s_waitcnt vmcnt(10)
buffer_load_dwordx4 v16,s[28:31],s62 offen lds
s_add_u32 s62,s62,131072
s_add_u32 m0,m0,1024
s_waitcnt vmcnt(10)
buffer_load_dwordx4 v16,s[28:31],s62 offen lds
s_add_u32 s62,s62,131072
s_add_u32 m0,m0,1024
s_waitcnt vmcnt(10)
buffer_load_dwordx4 v16,s[28:31],s62 offen lds
s_add_u32 s62,s62,131072
s_add_u32 m0,m0,1024
s_waitcnt vmcnt(10)
buffer_load_dwordx4 v16,s[28:31],s62 offen lds
s_add_u32 s62,s62,131072
s_add_u32 m0,m0,1024
s_waitcnt vmcnt(10)
buffer_load_dwordx4 v16,s[28:31],s62 offen lds
s_add_u32 s62,s62,131072
s_add_u32 m0,m0,1024
s_mov_b32 s64,7340032
buffer_load_dword v29,v31,s[32:35],s64 offen
s_waitcnt vmcnt(10)
buffer_load_dwordx4 v16,s[28:31],s62 offen lds
s_add_u32 s62,s62,131072
s_add_u32 m0,m0,1024
s_waitcnt vmcnt(10)
buffer_load_dwordx4 v16,s[28:31],s62 offen lds
s_add_u32 s62,s62,131072
s_add_u32 m0,m0,1024
s_waitcnt vmcnt(10)
buffer_load_dwordx4 v16,s[28:31],s62 offen lds
s_add_u32 s62,s62,131072
s_add_u32 m0,m0,1024
s_waitcnt vmcnt(10)
buffer_load_dwordx4 v16,s[28:31],s62 offen lds
s_add_u32 s62,s62,131072
s_add_u32 m0,m0,1024
s_waitcnt vmcnt(10)
buffer_load_dwordx4 v16,s[28:31],s62 offen lds
s_add_u32 s62,s62,131072
s_add_u32 m0,m0,1024
s_waitcnt vmcnt(10)
buffer_load_dwordx4 v16,s[28:31],s62 offen lds
s_waitcnt vmcnt(10)
s_waitcnt vmcnt(18)
ds_read_b64_tr_b16 a[200:201],v18 offset:16384
ds_read_b64_tr_b16 a[202:203],v18 offset:16640
ds_read_b64_tr_b16 a[212:213],v18 offset:18432
ds_read_b64_tr_b16 a[214:215],v18 offset:18688
ds_read_b64_tr_b16 a[224:225],v18 offset:20480
ds_read_b64_tr_b16 a[226:227],v18 offset:20736
ds_read_b64_tr_b16 a[236:237],v18 offset:22528
ds_read_b64_tr_b16 a[238:239],v18 offset:22784
ds_read_b64_tr_b16 a[248:249],v18 offset:24576
ds_read_b64_tr_b16 a[250:251],v18 offset:24832
ds_read_b64_tr_b16 v[132:133],v18 offset:26624
ds_read_b64_tr_b16 v[134:135],v18 offset:26880
s_waitcnt lgkmcnt(0)
ds_read_b64_tr_b16 v[144:145],v18 offset:28672
ds_read_b64_tr_b16 v[146:147],v18 offset:28928
ds_read_b64_tr_b16 v[156:157],v18 offset:30720
ds_read_b64_tr_b16 v[158:159],v18 offset:30976
s_waitcnt lgkmcnt(0)
s_add_u32 s62,s52,6291456
s_add_u32 m0,s61,16384
s_nop 0
buffer_load_dwordx4 v16,s[32:35],s62 offen lds
s_add_u32 s62,s62,131072
s_add_u32 m0,m0,1024
s_waitcnt vmcnt(10)
buffer_load_dwordx4 v16,s[32:35],s62 offen lds
s_add_u32 s62,s62,131072
s_add_u32 m0,m0,1024
s_waitcnt vmcnt(10)
buffer_load_dwordx4 v16,s[32:35],s62 offen lds
s_add_u32 s62,s62,131072
s_add_u32 m0,m0,1024
s_waitcnt vmcnt(10)
buffer_load_dwordx4 v16,s[32:35],s62 offen lds
s_add_u32 s62,s62,131072
s_add_u32 m0,m0,1024
s_waitcnt vmcnt(10)
buffer_load_dwordx4 v16,s[32:35],s62 offen lds
s_add_u32 s62,s62,131072
s_add_u32 m0,m0,1024
s_waitcnt vmcnt(10)
buffer_load_dwordx4 v16,s[32:35],s62 offen lds
s_add_u32 s62,s62,131072
s_add_u32 m0,m0,1024
s_waitcnt vmcnt(10)
buffer_load_dwordx4 v16,s[32:35],s62 offen lds
s_add_u32 s62,s62,131072
s_add_u32 m0,m0,1024
s_waitcnt vmcnt(10)
buffer_load_dwordx4 v16,s[32:35],s62 offen lds
s_add_u32 s62,s62,131072
s_add_u32 m0,m0,1024
s_waitcnt vmcnt(10)
buffer_load_dwordx4 v16,s[32:35],s62 offen lds
s_add_u32 s62,s62,131072
s_add_u32 m0,m0,1024
s_waitcnt vmcnt(10)
buffer_load_dwordx4 v16,s[32:35],s62 offen lds
s_add_u32 s62,s62,131072
s_add_u32 m0,m0,1024
s_waitcnt vmcnt(10)
buffer_load_dwordx4 v16,s[32:35],s62 offen lds
s_add_u32 s62,s62,131072
s_add_u32 m0,m0,1024
s_waitcnt vmcnt(10)
buffer_load_dwordx4 v16,s[32:35],s62 offen lds
s_add_u32 s62,s62,131072
s_add_u32 m0,m0,1024
s_waitcnt vmcnt(10)
buffer_load_dwordx4 v16,s[32:35],s62 offen lds
s_add_u32 s62,s62,131072
s_add_u32 m0,m0,1024
s_waitcnt vmcnt(10)
buffer_load_dwordx4 v16,s[32:35],s62 offen lds
s_add_u32 s62,s62,131072
s_add_u32 m0,m0,1024
s_waitcnt vmcnt(10)
buffer_load_dwordx4 v16,s[32:35],s62 offen lds
s_add_u32 s62,s62,131072
s_add_u32 m0,m0,1024
s_waitcnt vmcnt(10)
buffer_load_dwordx4 v16,s[32:35],s62 offen lds
s_waitcnt vmcnt(10)
s_waitcnt vmcnt(16)
ds_read_b64_tr_b16 v[160:161],v17 offset:0
ds_read_b64_tr_b16 v[162:163],v17 offset:256
ds_read_b64_tr_b16 v[164:165],v17 offset:8
ds_read_b64_tr_b16 v[166:167],v17 offset:264
ds_read_b64_tr_b16 v[172:173],v17 offset:2048
ds_read_b64_tr_b16 v[174:175],v17 offset:2304
ds_read_b64_tr_b16 v[176:177],v17 offset:2056
ds_read_b64_tr_b16 v[178:179],v17 offset:2312
ds_read_b64_tr_b16 v[184:185],v17 offset:4096
ds_read_b64_tr_b16 v[186:187],v17 offset:4352
ds_read_b64_tr_b16 v[188:189],v17 offset:4104
ds_read_b64_tr_b16 v[190:191],v17 offset:4360
s_waitcnt lgkmcnt(0)
ds_read_b64_tr_b16 v[196:197],v17 offset:6144
ds_read_b64_tr_b16 v[198:199],v17 offset:6400
ds_read_b64_tr_b16 v[200:201],v17 offset:6152
ds_read_b64_tr_b16 v[202:203],v17 offset:6408
ds_read_b64_tr_b16 v[208:209],v17 offset:8192
ds_read_b64_tr_b16 v[210:211],v17 offset:8448
ds_read_b64_tr_b16 v[212:213],v17 offset:8200
ds_read_b64_tr_b16 v[214:215],v17 offset:8456
ds_read_b64_tr_b16 v[220:221],v17 offset:10240
ds_read_b64_tr_b16 v[222:223],v17 offset:10496
ds_read_b64_tr_b16 v[224:225],v17 offset:10248
ds_read_b64_tr_b16 v[226:227],v17 offset:10504
s_waitcnt lgkmcnt(0)
ds_read_b64_tr_b16 v[232:233],v17 offset:12288
ds_read_b64_tr_b16 v[234:235],v17 offset:12544
ds_read_b64_tr_b16 v[236:237],v17 offset:12296
ds_read_b64_tr_b16 v[238:239],v17 offset:12552
ds_read_b64_tr_b16 v[244:245],v17 offset:14336
ds_read_b64_tr_b16 v[246:247],v17 offset:14592
ds_read_b64_tr_b16 v[248:249],v17 offset:14344
ds_read_b64_tr_b16 v[250:251],v17 offset:14600
s_waitcnt lgkmcnt(0)
s_waitcnt vmcnt(0)
ds_read_b64_tr_b16 v[168:169],v18 offset:16384
ds_read_b64_tr_b16 v[170:171],v18 offset:16640
ds_read_b64_tr_b16 v[180:181],v18 offset:18432
ds_read_b64_tr_b16 v[182:183],v18 offset:18688
ds_read_b64_tr_b16 v[192:193],v18 offset:20480
ds_read_b64_tr_b16 v[194:195],v18 offset:20736
ds_read_b64_tr_b16 v[204:205],v18 offset:22528
ds_read_b64_tr_b16 v[206:207],v18 offset:22784
ds_read_b64_tr_b16 v[216:217],v18 offset:24576
ds_read_b64_tr_b16 v[218:219],v18 offset:24832
ds_read_b64_tr_b16 v[228:229],v18 offset:26624
ds_read_b64_tr_b16 v[230:231],v18 offset:26880
s_waitcnt lgkmcnt(0)
ds_read_b64_tr_b16 v[240:241],v18 offset:28672
ds_read_b64_tr_b16 v[242:243],v18 offset:28928
ds_read_b64_tr_b16 v[252:253],v18 offset:30720
ds_read_b64_tr_b16 v[254:255],v18 offset:30976
s_waitcnt lgkmcnt(0)
s_mov_b32 s92,s2
s_and_b32 s93,s3,0xffff
s_mov_b32 s94,0x100
s_mov_b32 s95,0x20000
v_mbcnt_lo_u32_b32 v16,-1,0
v_mbcnt_hi_u32_b32 v16,-1,v16
v_mov_b32 v18,0
v_cmp_eq_u32 vcc,22,v16
s_nop 1
v_cndmask_b32 v18,v18,63,vcc
v_cmp_eq_u32 vcc,19,v16
s_nop 1
v_cndmask_b32 v18,v18,64,vcc
v_cmp_eq_u32 vcc,21,v16
s_nop 1
v_cndmask_b32 v18,v18,1,vcc
v_and_b32 v19,1,v16
v_cmp_eq_u32 vcc,1,v19
v_mov_b32 v19,8192
s_nop 0
v_cndmask_b32 v19,-1,v19,vcc
v_min_u32 v16,31,v16
v_lshlrev_b32 v16,2,v16
s_sub_u32 s66,s88,64
s_cmp_lg_u32 s50,0
s_cbranch_scc1 vot_50
vpoll_46:
buffer_load_dword v17,v16,s[92:95],s66 offen sc1
s_waitcnt vmcnt(0)
s_cmp_lg_u32 s56,2
s_cbranch_scc1 vck_47
v_cmp_eq_u32 vcc,v17,v19
s_and_b32 s64,vcc_lo,0xffff
s_cmp_eq_u32 s64,65535
s_cbranch_scc1 vck_47
s_mov_b32 s65,0
v_readlane_b32 s64,v17,1
s_lshr_b32 s64,s64,8
s_add_u32 s65,s65,s64
v_readlane_b32 s64,v17,3
s_lshr_b32 s64,s64,8
s_add_u32 s65,s65,s64
v_readlane_b32 s64,v17,5
s_lshr_b32 s64,s64,8
s_add_u32 s65,s65,s64
v_readlane_b32 s64,v17,7
s_lshr_b32 s64,s64,8
s_add_u32 s65,s65,s64
v_readlane_b32 s64,v17,9
s_lshr_b32 s64,s64,8
s_add_u32 s65,s65,s64
v_readlane_b32 s64,v17,11
s_lshr_b32 s64,s64,8
s_add_u32 s65,s65,s64
v_readlane_b32 s64,v17,13
s_lshr_b32 s64,s64,8
s_add_u32 s65,s65,s64
v_readlane_b32 s64,v17,15
s_lshr_b32 s64,s64,8
s_add_u32 s65,s65,s64
s_cmp_ge_u32 s65,256
s_cbranch_scc1 vok_49
s_branch vrt_48
vck_47:
v_cmp_gt_u32 vcc,v18,v17
s_cbranch_vccz vok_49
vrt_48:
s_sleep 8
s_sub_u32 s90,s90,1
s_cmp_gt_i32 s90,0
s_cbranch_scc1 vpoll_46
vok_49:
v_add_u32 v18,160768,v16
ds_write_b32 v18,v17
s_waitcnt lgkmcnt(0)
vot_50:
s_barrier
v_add_u32 v18,160768,v16
ds_read_b32 v17,v18
s_waitcnt lgkmcnt(0)
s_cmp_lg_u32 s56,2
s_cbranch_scc1 vfin_51
v_cmp_eq_u32 vcc,v17,v19
s_and_b32 s64,vcc_lo,0xffff
s_cmp_eq_u32 s64,65535
s_cbranch_scc1 vfin_51
s_mov_b32 s65,0
v_readlane_b32 s64,v17,1
s_lshr_b32 s64,s64,8
s_add_u32 s65,s65,s64
v_readlane_b32 s64,v17,3
s_lshr_b32 s64,s64,8
s_add_u32 s65,s65,s64
v_readlane_b32 s64,v17,5
s_lshr_b32 s64,s64,8
s_add_u32 s65,s65,s64
v_readlane_b32 s64,v17,7
s_lshr_b32 s64,s64,8
s_add_u32 s65,s65,s64
v_readlane_b32 s64,v17,9
s_lshr_b32 s64,s64,8
s_add_u32 s65,s65,s64
v_readlane_b32 s64,v17,11
s_lshr_b32 s64,s64,8
s_add_u32 s65,s65,s64
v_readlane_b32 s64,v17,13
s_lshr_b32 s64,s64,8
s_add_u32 s65,s65,s64
v_readlane_b32 s64,v17,15
s_lshr_b32 s64,s64,8
s_add_u32 s65,s65,s64
s_cmp_ge_u32 s65,256
s_cbranch_scc1 fl_fb
vfin_51:
s_and_b32 s56,s56,1
s_mov_b32 s67,0
v_readlane_b32 s65,v17,21
s_and_b32 s65,s65,2
s_lshl_b32 s67,s65,12
s_barrier
v_lshlrev_b32 v0,4,v1
s_mov_b32 s60,0
s_lshl_b32 s63,s50,13
s_add_u32 s61,s63,146800640
s_mov_b32 s70,0
s_lshl_b32 s52,s59,14
s_and_b32 s64,s50,1
s_lshl_b32 s64,s64,11
s_add_u32 s53,s52,s64
s_lshl_b32 s64,s50,10
s_add_u32 s52,s52,s64
s_add_u32 s52,s52,4096
s_cmp_gt_u32 s50,1
s_cselect_b32 s54,0x2000,0
s_lshl_b32 s69,s59,6
s_add_u32 s69,s69,s67
s_add_u32 s69,s69,138412032
v_mov_b32 v4,v0
v_add_u32 v5,32768,v0
s_add_u32 m0,s70,s63
s_add_u32 s62,s61,4096
buffer_load_dwordx4 v0,s[20:23],s61 offen offset:0 lds
buffer_load_dwordx4 v0,s[20:23],s61 offen offset:1024 lds
buffer_load_dwordx4 v0,s[20:23],s61 offen offset:2048 lds
buffer_load_dwordx4 v0,s[20:23],s61 offen offset:3072 lds
s_add_u32 m0,m0,4096
s_nop 0
buffer_load_dwordx4 v0,s[20:23],s62 offen offset:0 lds
buffer_load_dwordx4 v0,s[20:23],s62 offen offset:1024 lds
buffer_load_dwordx4 v0,s[20:23],s62 offen offset:2048 lds
buffer_load_dwordx4 v0,s[20:23],s62 offen offset:3072 lds
s_add_u32 s61,s61,32768
s_add_u32 s70,s70,32768
s_and_b32 s70,s70,0x1ffff
s_add_u32 m0,s70,s63
s_add_u32 s62,s61,4096
buffer_load_dwordx4 v0,s[20:23],s61 offen offset:0 lds
buffer_load_dwordx4 v0,s[20:23],s61 offen offset:1024 lds
buffer_load_dwordx4 v0,s[20:23],s61 offen offset:2048 lds
buffer_load_dwordx4 v0,s[20:23],s61 offen offset:3072 lds
s_add_u32 m0,m0,4096
s_nop 0
buffer_load_dwordx4 v0,s[20:23],s62 offen offset:0 lds
buffer_load_dwordx4 v0,s[20:23],s62 offen offset:1024 lds
buffer_load_dwordx4 v0,s[20:23],s62 offen offset:2048 lds
buffer_load_dwordx4 v0,s[20:23],s62 offen offset:3072 lds
s_add_u32 s61,s61,32768
s_add_u32 s70,s70,32768
s_and_b32 s70,s70,0x1ffff
s_waitcnt vmcnt(8)
s_barrier
ds_read_b128 v[64:67],v4 offset:0
ds_read_b128 v[68:71],v4 offset:1024
ds_read_b128 v[72:75],v4 offset:2048
ds_read_b128 v[76:79],v4 offset:3072
ds_read_b128 v[80:83],v4 offset:4096
top_52:
s_waitcnt lgkmcnt(4)
v_mfma_f32_16x16x32_bf16 v[32:35],a[0:3],v[64:67],0
ds_read_b128 v[84:87],v4 offset:5120
v_mfma_f32_16x16x32_bf16 v[36:39],a[4:7],v[64:67],0
v_mfma_f32_16x16x32_bf16 v[40:43],v[64:67],a[8:11],0
s_waitcnt lgkmcnt(4)
v_mfma_f32_16x16x32_bf16 v[32:35],a[12:15],v[68:71],v[32:35]
ds_read_b128 v[88:91],v4 offset:6144
s_sub_u32 s66,s60,1
s_lshr_b32 s64,s66,1
v_mfma_f32_16x16x32_bf16 v[36:39],a[16:19],v[68:71],v[36:39]
s_lshl_b32 s65,s64,12
s_and_b32 s65,s65,0x2000
v_mfma_f32_16x16x32_bf16 v[40:43],v[68:71],a[20:23],v[40:43]
s_xor_b32 s65,s65,s67
s_lshl_b32 s64,s64,20
s_waitcnt lgkmcnt(4)
v_mfma_f32_16x16x32_bf16 v[32:35],a[24:27],v[72:75],v[32:35]
ds_read_b128 v[92:95],v4 offset:7168
s_add_u32 s64,s64,s65
s_add_u32 s65,s64,s52
v_mfma_f32_16x16x32_bf16 v[36:39],a[28:31],v[72:75],v[36:39]
s_xor_b32 s64,s64,s54
s_add_u32 s66,s64,s53
v_mfma_f32_16x16x32_bf16 v[40:43],v[72:75],a[32:35],v[40:43]
s_cmp_eq_u32 s60,0
s_cselect_b32 s65,138608640,s65
s_waitcnt lgkmcnt(4)
v_mfma_f32_16x16x32_bf16 v[32:35],a[36:39],v[76:79],v[32:35]
ds_read_b128 v[96:99],v4 offset:8192
s_cselect_b32 s66,138608640,s66
v_mfma_f32_16x16x32_bf16 v[36:39],a[40:43],v[76:79],v[36:39]
v_cvt_pk_bf16_f32 v60,v44,v45
v_mfma_f32_16x16x32_bf16 v[40:43],v[76:79],a[44:47],v[40:43]
v_cvt_pk_bf16_f32 v61,v46,v47
s_waitcnt lgkmcnt(4)
v_mfma_f32_16x16x32_bf16 v[32:35],a[48:51],v[80:83],v[32:35]
ds_read_b128 v[100:103],v4 offset:9216
v_cvt_pk_bf16_f32 v62,v48,v49
v_mfma_f32_16x16x32_bf16 v[36:39],a[52:55],v[80:83],v[36:39]
v_cvt_pk_bf16_f32 v63,v50,v51
v_mfma_f32_16x16x32_bf16 v[40:43],v[80:83],a[56:59],v[40:43]
v_cvt_pk_bf16_f32 v58,v52,v53
s_waitcnt lgkmcnt(4)
v_mfma_f32_16x16x32_bf16 v[32:35],a[60:63],v[84:87],v[32:35]
ds_read_b128 v[104:107],v4 offset:10240
v_cvt_pk_bf16_f32 v59,v54,v55
v_mfma_f32_16x16x32_bf16 v[36:39],a[64:67],v[84:87],v[36:39]
buffer_store_dwordx4 v[60:63],v0,s[20:23],s66 offen offset:1024 sc1
v_mfma_f32_16x16x32_bf16 v[40:43],v[84:87],a[68:71],v[40:43]
buffer_store_dwordx4 v[56:59],v0,s[20:23],s65 offen sc1
s_waitcnt lgkmcnt(4)
v_mfma_f32_16x16x32_bf16 v[32:35],a[72:75],v[88:91],v[32:35]
ds_read_b128 v[108:111],v4 offset:11264
v_mfma_f32_16x16x32_bf16 v[36:39],a[76:79],v[88:91],v[36:39]
v_mfma_f32_16x16x32_bf16 v[40:43],v[88:91],a[80:83],v[40:43]
s_waitcnt lgkmcnt(4)
v_mfma_f32_16x16x32_bf16 v[32:35],a[84:87],v[92:95],v[32:35]
ds_read_b128 v[112:115],v4 offset:12288
v_mfma_f32_16x16x32_bf16 v[36:39],a[88:91],v[92:95],v[36:39]
v_mfma_f32_16x16x32_bf16 v[40:43],v[92:95],a[92:95],v[40:43]
s_waitcnt lgkmcnt(4)
v_mfma_f32_16x16x32_bf16 v[32:35],a[96:99],v[96:99],v[32:35]
ds_read_b128 v[116:119],v4 offset:13312
v_mfma_f32_16x16x32_bf16 v[36:39],a[100:103],v[96:99],v[36:39]
v_mfma_f32_16x16x32_bf16 v[40:43],v[96:99],a[104:107],v[40:43]
s_waitcnt lgkmcnt(4)
v_mfma_f32_16x16x32_bf16 v[32:35],a[108:111],v[100:103],v[32:35]
ds_read_b128 v[120:123],v4 offset:14336
v_mfma_f32_16x16x32_bf16 v[36:39],a[112:115],v[100:103],v[36:39]
v_mfma_f32_16x16x32_bf16 v[40:43],v[100:103],a[116:119],v[40:43]
s_waitcnt lgkmcnt(4)
v_mfma_f32_16x16x32_bf16 v[32:35],a[120:123],v[104:107],v[32:35]
ds_read_b128 v[124:127],v4 offset:15360
v_mfma_f32_16x16x32_bf16 v[36:39],a[124:127],v[104:107],v[36:39]
v_mfma_f32_16x16x32_bf16 v[40:43],v[104:107],a[128:131],v[40:43]
s_waitcnt lgkmcnt(4)
v_mfma_f32_16x16x32_bf16 v[32:35],a[132:135],v[108:111],v[32:35]
ds_read_b128 v[64:67],v4 offset:16384
v_mfma_f32_16x16x32_bf16 v[36:39],a[136:139],v[108:111],v[36:39]
v_mfma_f32_16x16x32_bf16 v[40:43],v[108:111],a[140:143],v[40:43]
s_waitcnt lgkmcnt(4)
v_mfma_f32_16x16x32_bf16 v[32:35],a[144:147],v[112:115],v[32:35]
ds_read_b128 v[68:71],v4 offset:17408
v_mfma_f32_16x16x32_bf16 v[36:39],a[148:151],v[112:115],v[36:39]
v_mfma_f32_16x16x32_bf16 v[40:43],v[112:115],a[152:155],v[40:43]
s_waitcnt lgkmcnt(4)
v_mfma_f32_16x16x32_bf16 v[32:35],a[156:159],v[116:119],v[32:35]
ds_read_b128 v[72:75],v4 offset:18432
v_mfma_f32_16x16x32_bf16 v[36:39],a[160:163],v[116:119],v[36:39]
v_mfma_f32_16x16x32_bf16 v[40:43],v[116:119],a[164:167],v[40:43]
s_waitcnt lgkmcnt(4)
v_mfma_f32_16x16x32_bf16 v[32:35],a[168:171],v[120:123],v[32:35]
ds_read_b128 v[76:79],v4 offset:19456
v_mfma_f32_16x16x32_bf16 v[36:39],a[172:175],v[120:123],v[36:39]
v_mfma_f32_16x16x32_bf16 v[40:43],v[120:123],a[176:179],v[40:43]
s_waitcnt lgkmcnt(4)
v_mfma_f32_16x16x32_bf16 v[32:35],a[180:183],v[124:127],v[32:35]
ds_read_b128 v[80:83],v4 offset:20480
v_mfma_f32_16x16x32_bf16 v[36:39],a[184:187],v[124:127],v[36:39]
s_waitcnt vmcnt(2)
s_cmp_eq_u32 s60,60
s_cbranch_scc1 hb_55
s_cmp_eq_u32 s60,16
s_cbranch_scc1 hc_57
hb2_56:
s_sub_u32 s64,s60,2
s_cmp_gt_u32 s64,2
s_cbranch_scc1 sk_54
s_waitcnt vmcnt(0)
sk_54:
s_cselect_b32 s64,1,s50
s_barrier
s_cmp_ge_u32 s60,126
s_cselect_b32 s61,146800640,s61
s_cmp_lg_u32 s64,0
s_cbranch_scc1 nf_53
s_lshr_b32 s64,s60,1
v_mov_b32 v6,s64
s_mov_b64 exec,1
buffer_store_dword v6,off,s[20:23],s69 sc1
s_mov_b64 exec,-1
nf_53:
v_mfma_f32_16x16x32_bf16 v[40:43],v[124:127],a[188:191],v[40:43]
s_waitcnt lgkmcnt(4)
v_mfma_f32_16x16x32_bf16 v[32:35],a[192:195],v[64:67],v[32:35]
ds_read_b128 v[84:87],v4 offset:21504
s_add_u32 m0,s70,s63
v_mfma_f32_16x16x32_bf16 v[36:39],a[196:199],v[64:67],v[36:39]
v_mfma_f32_16x16x32_bf16 v[40:43],v[64:67],a[200:203],v[40:43]
s_add_u32 s62,s61,4096
s_waitcnt lgkmcnt(4)
v_mfma_f32_16x16x32_bf16 v[32:35],a[204:207],v[68:71],v[32:35]
ds_read_b128 v[88:91],v4 offset:22528
v_mfma_f32_16x16x32_bf16 v[36:39],a[208:211],v[68:71],v[36:39]
buffer_load_dwordx4 v0,s[20:23],s61 offen offset:0 lds
v_mfma_f32_16x16x32_bf16 v[40:43],v[68:71],a[212:215],v[40:43]
s_waitcnt lgkmcnt(4)
v_mfma_f32_16x16x32_bf16 v[32:35],a[216:219],v[72:75],v[32:35]
ds_read_b128 v[92:95],v4 offset:23552
buffer_load_dwordx4 v0,s[20:23],s61 offen offset:1024 lds
v_mfma_f32_16x16x32_bf16 v[36:39],a[220:223],v[72:75],v[36:39]
v_mfma_f32_16x16x32_bf16 v[40:43],v[72:75],a[224:227],v[40:43]
buffer_load_dwordx4 v0,s[20:23],s61 offen offset:2048 lds
s_waitcnt lgkmcnt(4)
v_mfma_f32_16x16x32_bf16 v[32:35],a[228:231],v[76:79],v[32:35]
ds_read_b128 v[96:99],v4 offset:24576
v_mfma_f32_16x16x32_bf16 v[36:39],a[232:235],v[76:79],v[36:39]
buffer_load_dwordx4 v0,s[20:23],s61 offen offset:3072 lds
v_mfma_f32_16x16x32_bf16 v[40:43],v[76:79],a[236:239],v[40:43]
s_waitcnt lgkmcnt(4)
v_mfma_f32_16x16x32_bf16 v[32:35],a[240:243],v[80:83],v[32:35]
ds_read_b128 v[100:103],v4 offset:25600
s_add_u32 m0,m0,4096
v_mfma_f32_16x16x32_bf16 v[36:39],a[244:247],v[80:83],v[36:39]
v_mfma_f32_16x16x32_bf16 v[40:43],v[80:83],a[248:251],v[40:43]
buffer_load_dwordx4 v0,s[20:23],s62 offen offset:0 lds
s_waitcnt lgkmcnt(4)
v_mfma_f32_16x16x32_bf16 v[32:35],a[252:255],v[84:87],v[32:35]
ds_read_b128 v[104:107],v4 offset:26624
v_mfma_f32_16x16x32_bf16 v[36:39],v[128:131],v[84:87],v[36:39]
buffer_load_dwordx4 v0,s[20:23],s62 offen offset:1024 lds
v_mfma_f32_16x16x32_bf16 v[40:43],v[84:87],v[132:135],v[40:43]
s_waitcnt lgkmcnt(4)
v_mfma_f32_16x16x32_bf16 v[32:35],v[136:139],v[88:91],v[32:35]
ds_read_b128 v[108:111],v4 offset:27648
buffer_load_dwordx4 v0,s[20:23],s62 offen offset:2048 lds
v_mfma_f32_16x16x32_bf16 v[36:39],v[140:143],v[88:91],v[36:39]
v_mfma_f32_16x16x32_bf16 v[40:43],v[88:91],v[144:147],v[40:43]
buffer_load_dwordx4 v0,s[20:23],s62 offen offset:3072 lds
s_waitcnt lgkmcnt(4)
v_mfma_f32_16x16x32_bf16 v[32:35],v[148:151],v[92:95],v[32:35]
ds_read_b128 v[112:115],v4 offset:28672
v_mfma_f32_16x16x32_bf16 v[36:39],v[152:155],v[92:95],v[36:39]
s_add_u32 s61,s61,32768
v_mfma_f32_16x16x32_bf16 v[40:43],v[92:95],v[156:159],v[40:43]
s_waitcnt lgkmcnt(4)
v_mfma_f32_16x16x32_bf16 v[32:35],v[160:163],v[96:99],v[32:35]
ds_read_b128 v[116:119],v4 offset:29696
s_add_u32 s70,s70,32768
v_mfma_f32_16x16x32_bf16 v[36:39],v[164:167],v[96:99],v[36:39]
v_mfma_f32_16x16x32_bf16 v[40:43],v[96:99],v[168:171],v[40:43]
s_and_b32 s70,s70,0x1ffff
s_waitcnt lgkmcnt(4)
v_mfma_f32_16x16x32_bf16 v[32:35],v[172:175],v[100:103],v[32:35]
ds_read_b128 v[120:123],v4 offset:30720
v_mfma_f32_16x16x32_bf16 v[36:39],v[176:179],v[100:103],v[36:39]
v_mfma_f32_16x16x32_bf16 v[40:43],v[100:103],v[180:183],v[40:43]
s_waitcnt lgkmcnt(4)
v_mfma_f32_16x16x32_bf16 v[32:35],v[184:187],v[104:107],v[32:35]
ds_read_b128 v[124:127],v4 offset:31744
v_mfma_f32_16x16x32_bf16 v[36:39],v[188:191],v[104:107],v[36:39]
v_mfma_f32_16x16x32_bf16 v[40:43],v[104:107],v[192:195],v[40:43]
s_waitcnt lgkmcnt(4)
v_mfma_f32_16x16x32_bf16 v[32:35],v[196:199],v[108:111],v[32:35]
ds_read_b128 v[64:67],v5 offset:0
v_mfma_f32_16x16x32_bf16 v[36:39],v[200:203],v[108:111],v[36:39]
v_mfma_f32_16x16x32_bf16 v[40:43],v[108:111],v[204:207],v[40:43]
s_waitcnt lgkmcnt(4)
v_mfma_f32_16x16x32_bf16 v[32:35],v[208:211],v[112:115],v[32:35]
ds_read_b128 v[68:71],v5 offset:1024
v_mfma_f32_16x16x32_bf16 v[36:39],v[212:215],v[112:115],v[36:39]
v_mfma_f32_16x16x32_bf16 v[40:43],v[112:115],v[216:219],v[40:43]
s_waitcnt lgkmcnt(4)
v_mfma_f32_16x16x32_bf16 v[32:35],v[220:223],v[116:119],v[32:35]
ds_read_b128 v[72:75],v5 offset:2048
v_mfma_f32_16x16x32_bf16 v[36:39],v[224:227],v[116:119],v[36:39]
v_mfma_f32_16x16x32_bf16 v[40:43],v[116:119],v[228:231],v[40:43]
s_waitcnt lgkmcnt(4)
v_mfma_f32_16x16x32_bf16 v[32:35],v[232:235],v[120:123],v[32:35]
ds_read_b128 v[76:79],v5 offset:3072
v_mfma_f32_16x16x32_bf16 v[36:39],v[236:239],v[120:123],v[36:39]
v_mfma_f32_16x16x32_bf16 v[40:43],v[120:123],v[240:243],v[40:43]
s_waitcnt lgkmcnt(4)
v_mfma_f32_16x16x32_bf16 v[32:35],v[244:247],v[124:127],v[32:35]
ds_read_b128 v[80:83],v5 offset:4096
v_mfma_f32_16x16x32_bf16 v[36:39],v[248:251],v[124:127],v[36:39]
v_mfma_f32_16x16x32_bf16 v[40:43],v[124:127],v[252:255],v[40:43]
v_mov_b32 v4,v5
v_add_u32 v5,32768,v5
v_and_b32 v5,0x1ffff,v5
s_add_u32 s60,s60,1
s_waitcnt lgkmcnt(4)
v_mfma_f32_16x16x32_bf16 v[44:47],a[0:3],v[64:67],0
ds_read_b128 v[84:87],v4 offset:5120
v_mfma_f32_16x16x32_bf16 v[48:51],a[4:7],v[64:67],0
v_mfma_f32_16x16x32_bf16 v[52:55],v[64:67],a[8:11],0
s_waitcnt lgkmcnt(4)
v_mfma_f32_16x16x32_bf16 v[44:47],a[12:15],v[68:71],v[44:47]
ds_read_b128 v[88:91],v4 offset:6144
s_sub_u32 s66,s60,1
s_lshr_b32 s64,s66,1
v_mfma_f32_16x16x32_bf16 v[48:51],a[16:19],v[68:71],v[48:51]
s_lshl_b32 s65,s64,12
s_and_b32 s65,s65,0x2000
v_mfma_f32_16x16x32_bf16 v[52:55],v[68:71],a[20:23],v[52:55]
s_xor_b32 s65,s65,s67
s_lshl_b32 s64,s64,20
s_waitcnt lgkmcnt(4)
v_mfma_f32_16x16x32_bf16 v[44:47],a[24:27],v[72:75],v[44:47]
ds_read_b128 v[92:95],v4 offset:7168
s_add_u32 s64,s64,s65
s_add_u32 s65,s64,s52
v_mfma_f32_16x16x32_bf16 v[48:51],a[28:31],v[72:75],v[48:51]
s_xor_b32 s64,s64,s54
s_add_u32 s66,s64,s53
v_mfma_f32_16x16x32_bf16 v[52:55],v[72:75],a[32:35],v[52:55]
v_cvt_pk_bf16_f32 v60,v32,v33
v_cvt_pk_bf16_f32 v61,v34,v35
s_waitcnt lgkmcnt(4)
v_mfma_f32_16x16x32_bf16 v[44:47],a[36:39],v[76:79],v[44:47]
ds_read_b128 v[96:99],v4 offset:8192
v_cvt_pk_bf16_f32 v62,v36,v37
v_mfma_f32_16x16x32_bf16 v[48:51],a[40:43],v[76:79],v[48:51]
v_cvt_pk_bf16_f32 v63,v38,v39
v_mfma_f32_16x16x32_bf16 v[52:55],v[76:79],a[44:47],v[52:55]
v_cvt_pk_bf16_f32 v56,v40,v41
s_waitcnt lgkmcnt(4)
v_mfma_f32_16x16x32_bf16 v[44:47],a[48:51],v[80:83],v[44:47]
ds_read_b128 v[100:103],v4 offset:9216
v_cvt_pk_bf16_f32 v57,v42,v43
v_mfma_f32_16x16x32_bf16 v[48:51],a[52:55],v[80:83],v[48:51]
buffer_store_dwordx4 v[60:63],v0,s[20:23],s66 offen offset:0 sc1
v_mfma_f32_16x16x32_bf16 v[52:55],v[80:83],a[56:59],v[52:55]
s_waitcnt lgkmcnt(4)
v_mfma_f32_16x16x32_bf16 v[44:47],a[60:63],v[84:87],v[44:47]
ds_read_b128 v[104:107],v4 offset:10240
v_mfma_f32_16x16x32_bf16 v[48:51],a[64:67],v[84:87],v[48:51]
v_mfma_f32_16x16x32_bf16 v[52:55],v[84:87],a[68:71],v[52:55]
s_waitcnt lgkmcnt(4)
v_mfma_f32_16x16x32_bf16 v[44:47],a[72:75],v[88:91],v[44:47]
ds_read_b128 v[108:111],v4 offset:11264
v_mfma_f32_16x16x32_bf16 v[48:51],a[76:79],v[88:91],v[48:51]
v_mfma_f32_16x16x32_bf16 v[52:55],v[88:91],a[80:83],v[52:55]
s_waitcnt lgkmcnt(4)
v_mfma_f32_16x16x32_bf16 v[44:47],a[84:87],v[92:95],v[44:47]
ds_read_b128 v[112:115],v4 offset:12288
v_mfma_f32_16x16x32_bf16 v[48:51],a[88:91],v[92:95],v[48:51]
v_mfma_f32_16x16x32_bf16 v[52:55],v[92:95],a[92:95],v[52:55]
s_waitcnt lgkmcnt(4)
v_mfma_f32_16x16x32_bf16 v[44:47],a[96:99],v[96:99],v[44:47]
ds_read_b128 v[116:119],v4 offset:13312
v_mfma_f32_16x16x32_bf16 v[48:51],a[100:103],v[96:99],v[48:51]
v_mfma_f32_16x16x32_bf16 v[52:55],v[96:99],a[104:107],v[52:55]
s_waitcnt lgkmcnt(4)
v_mfma_f32_16x16x32_bf16 v[44:47],a[108:111],v[100:103],v[44:47]
ds_read_b128 v[120:123],v4 offset:14336
v_mfma_f32_16x16x32_bf16 v[48:51],a[112:115],v[100:103],v[48:51]
v_mfma_f32_16x16x32_bf16 v[52:55],v[100:103],a[116:119],v[52:55]
s_waitcnt lgkmcnt(4)
v_mfma_f32_16x16x32_bf16 v[44:47],a[120:123],v[104:107],v[44:47]
ds_read_b128 v[124:127],v4 offset:15360
v_mfma_f32_16x16x32_bf16 v[48:51],a[124:127],v[104:107],v[48:51]
v_mfma_f32_16x16x32_bf16 v[52:55],v[104:107],a[128:131],v[52:55]
s_waitcnt lgkmcnt(4)
v_mfma_f32_16x16x32_bf16 v[44:47],a[132:135],v[108:111],v[44:47]
ds_read_b128 v[64:67],v4 offset:16384
v_mfma_f32_16x16x32_bf16 v[48:51],a[136:139],v[108:111],v[48:51]
v_mfma_f32_16x16x32_bf16 v[52:55],v[108:111],a[140:143],v[52:55]
s_waitcnt lgkmcnt(4)
v_mfma_f32_16x16x32_bf16 v[44:47],a[144:147],v[112:115],v[44:47]
ds_read_b128 v[68:71],v4 offset:17408
v_mfma_f32_16x16x32_bf16 v[48:51],a[148:151],v[112:115],v[48:51]
v_mfma_f32_16x16x32_bf16 v[52:55],v[112:115],a[152:155],v[52:55]
s_waitcnt lgkmcnt(4)
v_mfma_f32_16x16x32_bf16 v[44:47],a[156:159],v[116:119],v[44:47]
ds_read_b128 v[72:75],v4 offset:18432
v_mfma_f32_16x16x32_bf16 v[48:51],a[160:163],v[116:119],v[48:51]
v_mfma_f32_16x16x32_bf16 v[52:55],v[116:119],a[164:167],v[52:55]
s_waitcnt lgkmcnt(4)
v_mfma_f32_16x16x32_bf16 v[44:47],a[168:171],v[120:123],v[44:47]
ds_read_b128 v[76:79],v4 offset:19456
v_mfma_f32_16x16x32_bf16 v[48:51],a[172:175],v[120:123],v[48:51]
v_mfma_f32_16x16x32_bf16 v[52:55],v[120:123],a[176:179],v[52:55]
s_waitcnt lgkmcnt(4)
v_mfma_f32_16x16x32_bf16 v[44:47],a[180:183],v[124:127],v[44:47]
ds_read_b128 v[80:83],v4 offset:20480
v_mfma_f32_16x16x32_bf16 v[48:51],a[184:187],v[124:127],v[48:51]
s_waitcnt vmcnt(1)
s_mov_b32 s64,s50
s_barrier
s_cmp_ge_u32 s60,126
s_cselect_b32 s61,146800640,s61
s_cmp_lg_u32 s64,0
s_cbranch_scc1 nf_58
s_lshr_b32 s64,s60,1
v_mov_b32 v6,s64
s_mov_b64 exec,1
buffer_store_dword v6,off,s[20:23],s69 sc1
s_mov_b64 exec,-1
nf_58:
v_mfma_f32_16x16x32_bf16 v[52:55],v[124:127],a[188:191],v[52:55]
s_waitcnt lgkmcnt(4)
v_mfma_f32_16x16x32_bf16 v[44:47],a[192:195],v[64:67],v[44:47]
ds_read_b128 v[84:87],v4 offset:21504
s_add_u32 m0,s70,s63
v_mfma_f32_16x16x32_bf16 v[48:51],a[196:199],v[64:67],v[48:51]
v_mfma_f32_16x16x32_bf16 v[52:55],v[64:67],a[200:203],v[52:55]
s_add_u32 s62,s61,4096
s_waitcnt lgkmcnt(4)
v_mfma_f32_16x16x32_bf16 v[44:47],a[204:207],v[68:71],v[44:47]
ds_read_b128 v[88:91],v4 offset:22528
v_mfma_f32_16x16x32_bf16 v[48:51],a[208:211],v[68:71],v[48:51]
buffer_load_dwordx4 v0,s[20:23],s61 offen offset:0 lds
v_mfma_f32_16x16x32_bf16 v[52:55],v[68:71],a[212:215],v[52:55]
s_waitcnt lgkmcnt(4)
v_mfma_f32_16x16x32_bf16 v[44:47],a[216:219],v[72:75],v[44:47]
ds_read_b128 v[92:95],v4 offset:23552
buffer_load_dwordx4 v0,s[20:23],s61 offen offset:1024 lds
v_mfma_f32_16x16x32_bf16 v[48:51],a[220:223],v[72:75],v[48:51]
v_mfma_f32_16x16x32_bf16 v[52:55],v[72:75],a[224:227],v[52:55]
buffer_load_dwordx4 v0,s[20:23],s61 offen offset:2048 lds
s_waitcnt lgkmcnt(4)
v_mfma_f32_16x16x32_bf16 v[44:47],a[228:231],v[76:79],v[44:47]
ds_read_b128 v[96:99],v4 offset:24576
v_mfma_f32_16x16x32_bf16 v[48:51],a[232:235],v[76:79],v[48:51]
buffer_load_dwordx4 v0,s[20:23],s61 offen offset:3072 lds
v_mfma_f32_16x16x32_bf16 v[52:55],v[76:79],a[236:239],v[52:55]
s_waitcnt lgkmcnt(4)
v_mfma_f32_16x16x32_bf16 v[44:47],a[240:243],v[80:83],v[44:47]
ds_read_b128 v[100:103],v4 offset:25600
s_add_u32 m0,m0,4096
v_mfma_f32_16x16x32_bf16 v[48:51],a[244:247],v[80:83],v[48:51]
v_mfma_f32_16x16x32_bf16 v[52:55],v[80:83],a[248:251],v[52:55]
buffer_load_dwordx4 v0,s[20:23],s62 offen offset:0 lds
s_waitcnt lgkmcnt(4)
v_mfma_f32_16x16x32_bf16 v[44:47],a[252:255],v[84:87],v[44:47]
ds_read_b128 v[104:107],v4 offset:26624
v_mfma_f32_16x16x32_bf16 v[48:51],v[128:131],v[84:87],v[48:51]
buffer_load_dwordx4 v0,s[20:23],s62 offen offset:1024 lds
v_mfma_f32_16x16x32_bf16 v[52:55],v[84:87],v[132:135],v[52:55]
s_waitcnt lgkmcnt(4)
v_mfma_f32_16x16x32_bf16 v[44:47],v[136:139],v[88:91],v[44:47]
ds_read_b128 v[108:111],v4 offset:27648
buffer_load_dwordx4 v0,s[20:23],s62 offen offset:2048 lds
v_mfma_f32_16x16x32_bf16 v[48:51],v[140:143],v[88:91],v[48:51]
v_mfma_f32_16x16x32_bf16 v[52:55],v[88:91],v[144:147],v[52:55]
buffer_load_dwordx4 v0,s[20:23],s62 offen offset:3072 lds
s_waitcnt lgkmcnt(4)
v_mfma_f32_16x16x32_bf16 v[44:47],v[148:151],v[92:95],v[44:47]
ds_read_b128 v[112:115],v4 offset:28672
v_mfma_f32_16x16x32_bf16 v[48:51],v[152:155],v[92:95],v[48:51]
s_add_u32 s61,s61,32768
v_mfma_f32_16x16x32_bf16 v[52:55],v[92:95],v[156:159],v[52:55]
s_waitcnt lgkmcnt(4)
v_mfma_f32_16x16x32_bf16 v[44:47],v[160:163],v[96:99],v[44:47]
ds_read_b128 v[116:119],v4 offset:29696
s_add_u32 s70,s70,32768
v_mfma_f32_16x16x32_bf16 v[48:51],v[164:167],v[96:99],v[48:51]
v_mfma_f32_16x16x32_bf16 v[52:55],v[96:99],v[168:171],v[52:55]
s_and_b32 s70,s70,0x1ffff
s_waitcnt lgkmcnt(4)
v_mfma_f32_16x16x32_bf16 v[44:47],v[172:175],v[100:103],v[44:47]
ds_read_b128 v[120:123],v4 offset:30720
v_mfma_f32_16x16x32_bf16 v[48:51],v[176:179],v[100:103],v[48:51]
v_mfma_f32_16x16x32_bf16 v[52:55],v[100:103],v[180:183],v[52:55]
s_waitcnt lgkmcnt(4)
v_mfma_f32_16x16x32_bf16 v[44:47],v[184:187],v[104:107],v[44:47]
ds_read_b128 v[124:127],v4 offset:31744
v_mfma_f32_16x16x32_bf16 v[48:51],v[188:191],v[104:107],v[48:51]
v_mfma_f32_16x16x32_bf16 v[52:55],v[104:107],v[192:195],v[52:55]
s_waitcnt lgkmcnt(4)
v_mfma_f32_16x16x32_bf16 v[44:47],v[196:199],v[108:111],v[44:47]
ds_read_b128 v[64:67],v5 offset:0
v_mfma_f32_16x16x32_bf16 v[48:51],v[200:203],v[108:111],v[48:51]
v_mfma_f32_16x16x32_bf16 v[52:55],v[108:111],v[204:207],v[52:55]
s_waitcnt lgkmcnt(4)
v_mfma_f32_16x16x32_bf16 v[44:47],v[208:211],v[112:115],v[44:47]
ds_read_b128 v[68:71],v5 offset:1024
v_mfma_f32_16x16x32_bf16 v[48:51],v[212:215],v[112:115],v[48:51]
v_mfma_f32_16x16x32_bf16 v[52:55],v[112:115],v[216:219],v[52:55]
s_waitcnt lgkmcnt(4)
v_mfma_f32_16x16x32_bf16 v[44:47],v[220:223],v[116:119],v[44:47]
ds_read_b128 v[72:75],v5 offset:2048
v_mfma_f32_16x16x32_bf16 v[48:51],v[224:227],v[116:119],v[48:51]
v_mfma_f32_16x16x32_bf16 v[52:55],v[116:119],v[228:231],v[52:55]
s_waitcnt lgkmcnt(4)
v_mfma_f32_16x16x32_bf16 v[44:47],v[232:235],v[120:123],v[44:47]
ds_read_b128 v[76:79],v5 offset:3072
v_mfma_f32_16x16x32_bf16 v[48:51],v[236:239],v[120:123],v[48:51]
v_mfma_f32_16x16x32_bf16 v[52:55],v[120:123],v[240:243],v[52:55]
s_waitcnt lgkmcnt(4)
v_mfma_f32_16x16x32_bf16 v[44:47],v[244:247],v[124:127],v[44:47]
ds_read_b128 v[80:83],v5 offset:4096
v_mfma_f32_16x16x32_bf16 v[48:51],v[248:251],v[124:127],v[48:51]
v_mfma_f32_16x16x32_bf16 v[52:55],v[124:127],v[252:255],v[52:55]
v_mov_b32 v4,v5
v_add_u32 v5,32768,v5
v_and_b32 v5,0x1ffff,v5
s_add_u32 s60,s60,1
s_cmp_lt_u32 s60,128
s_cbranch_scc1 top_52
s_sub_u32 s66,s60,1
s_lshr_b32 s64,s66,1
s_lshl_b32 s65,s64,12
s_and_b32 s65,s65,0x2000
s_xor_b32 s65,s65,s67
s_lshl_b32 s64,s64,20
s_add_u32 s64,s64,s65
s_add_u32 s65,s64,s52
s_xor_b32 s64,s64,s54
s_add_u32 s66,s64,s53
s_cmp_eq_u32 s60,0
s_cselect_b32 s65,138608640,s65
s_cselect_b32 s66,138608640,s66
v_cvt_pk_bf16_f32 v60,v44,v45
v_cvt_pk_bf16_f32 v61,v46,v47
v_cvt_pk_bf16_f32 v62,v48,v49
v_cvt_pk_bf16_f32 v63,v50,v51
v_cvt_pk_bf16_f32 v58,v52,v53
v_cvt_pk_bf16_f32 v59,v54,v55
buffer_store_dwordx4 v[60:63],v0,s[20:23],s66 offen offset:1024 sc1
buffer_store_dwordx4 v[56:59],v0,s[20:23],s65 offen sc1
s_waitcnt vmcnt(0) lgkmcnt(0)
s_barrier
s_cmp_lg_u32 s50,0
s_cbranch_scc1 done_45
v_mov_b32 v6,64
s_mov_b64 exec,1
buffer_store_dword v6,off,s[20:23],s69 sc1
s_mov_b64 exec,-1
done_45:
s_endpgm
hb_55:
s_mov_b32 s28,s2
s_and_b32 s29,s3,0xffff
s_mov_b32 s30,0x100
s_mov_b32 s31,0x20000
v_mbcnt_lo_u32_b32 v12,-1,0
v_mbcnt_hi_u32_b32 v12,-1,v12
v_mov_b32 v14,0
v_cmp_eq_u32 vcc,20,v12
s_nop 1
v_cndmask_b32 v14,v14,64,vcc
v_and_b32 v15,1,v12
v_cmp_eq_u32 vcc,1,v15
v_mov_b32 v15,8192
s_nop 0
v_cndmask_b32 v15,-1,v15,vcc
v_min_u32 v12,31,v12
v_lshlrev_b32 v12,2,v12
s_sub_u32 s66,s88,64
vpoll_59:
buffer_load_dword v13,v12,s[28:31],s66 offen sc1
s_waitcnt vmcnt(0)
vck_60:
v_cmp_gt_u32 vcc,v14,v13
s_cbranch_vccz vok_62
vrt_61:
s_sleep 8
s_sub_u32 s90,s90,1
s_cmp_gt_i32 s90,0
s_cbranch_scc1 vpoll_59
vok_62:
s_branch hb2_56
hc_57:
s_mov_b32 s28,s2
s_and_b32 s29,s3,0xffff
s_mov_b32 s30,0x100
s_mov_b32 s31,0x20000
v_mbcnt_lo_u32_b32 v12,-1,0
v_mbcnt_hi_u32_b32 v12,-1,v12
v_mov_b32 v14,0
v_cmp_eq_u32 vcc,17,v12
s_nop 1
v_cndmask_b32 v14,v14,63,vcc
v_and_b32 v15,1,v12
v_cmp_eq_u32 vcc,1,v15
v_mov_b32 v15,8192
s_nop 0
v_cndmask_b32 v15,-1,v15,vcc
v_min_u32 v12,31,v12
v_lshlrev_b32 v12,2,v12
s_sub_u32 s66,s88,64
vpoll_65:
buffer_load_dword v13,v12,s[28:31],s66 offen sc1
s_waitcnt vmcnt(0)
vck_66:
v_cmp_gt_u32 vcc,v14,v13
s_cbranch_vccz vok_68
vrt_67:
s_sleep 8
s_sub_u32 s90,s90,1
s_cmp_gt_i32 s90,0
s_cbranch_scc1 vpoll_65
vok_68:
s_branch hb2_56
fl_wo:
v_and_b32 v21,15,v1
v_lshrrev_b32 v22,4,v1
v_lshrrev_b32 v23,2,v21
v_and_b32 v24,3,v21
s_lshl_b32 s61,s50,15
v_lshl_add_u32 v25,v22,3,v23
s_load_dwordx2 s[4:5],s[0:1],40
s_load_dwordx2 s[6:7],s[0:1],0
s_lshr_b32 s52,s59,3
s_and_b32 s53,s59,7
s_mul_i32 s54,s52,2097152
s_lshl_b32 s64,s53,8
s_add_u32 s54,s54,s64
s_lshl_b32 s64,s50,6
s_add_u32 s54,s54,s64
s_waitcnt lgkmcnt(0)
s_mov_b32 s28,s4
s_and_b32 s29,s5,0xffff
s_mov_b32 s30,0x800000
s_mov_b32 s31,0x20000
s_mov_b32 s24,s6
s_and_b32 s25,s7,0xffff
s_mov_b32 s26,0x400000
s_mov_b32 s27,0x20000
v_lshrrev_b32 v26,2,v1
v_and_b32 v27,3,v1
v_mul_u32_u24 v16,2048,v26
v_lshl_add_u32 v16,v27,4,v16
v_lshlrev_b32 v17,6,v25
v_lshl_add_u32 v17,v24,4,v17
v_add_u32 v17,s61,v17
s_xor_b32 s62,s50,0
s_mul_i32 s62,s62,524288
s_add_u32 s62,s62,s54
s_add_u32 m0,s61,0
s_nop 0
buffer_load_dwordx4 v16,s[28:31],s62 offen lds
s_add_u32 s62,s62,32768
s_add_u32 m0,m0,1024
s_waitcnt vmcnt(6)
buffer_load_dwordx4 v16,s[28:31],s62 offen lds
s_add_u32 s62,s62,32768
s_add_u32 m0,m0,1024
s_waitcnt vmcnt(6)
buffer_load_dwordx4 v16,s[28:31],s62 offen lds
s_add_u32 s62,s62,32768
s_add_u32 m0,m0,1024
s_waitcnt vmcnt(6)
buffer_load_dwordx4 v16,s[28:31],s62 offen lds
s_add_u32 s62,s62,32768
s_add_u32 m0,m0,1024
s_waitcnt vmcnt(6)
buffer_load_dwordx4 v16,s[28:31],s62 offen lds
s_add_u32 s62,s62,32768
s_add_u32 m0,m0,1024
s_waitcnt vmcnt(6)
buffer_load_dwordx4 v16,s[28:31],s62 offen lds
s_add_u32 s62,s62,32768
s_add_u32 m0,m0,1024
s_waitcnt vmcnt(6)
buffer_load_dwordx4 v16,s[28:31],s62 offen lds
s_add_u32 s62,s62,32768
s_add_u32 m0,m0,1024
s_waitcnt vmcnt(6)
buffer_load_dwordx4 v16,s[28:31],s62 offen lds
s_add_u32 s62,s62,32768
s_add_u32 m0,m0,1024
s_waitcnt vmcnt(6)
buffer_load_dwordx4 v16,s[28:31],s62 offen lds
s_add_u32 s62,s62,32768
s_add_u32 m0,m0,1024
s_waitcnt vmcnt(6)
buffer_load_dwordx4 v16,s[28:31],s62 offen lds
s_add_u32 s62,s62,32768
s_add_u32 m0,m0,1024
s_waitcnt vmcnt(6)
buffer_load_dwordx4 v16,s[28:31],s62 offen lds
s_add_u32 s62,s62,32768
s_add_u32 m0,m0,1024
s_waitcnt vmcnt(6)
buffer_load_dwordx4 v16,s[28:31],s62 offen lds
s_add_u32 s62,s62,32768
s_add_u32 m0,m0,1024
s_waitcnt vmcnt(6)
buffer_load_dwordx4 v16,s[28:31],s62 offen lds
s_add_u32 s62,s62,32768
s_add_u32 m0,m0,1024
s_waitcnt vmcnt(6)
buffer_load_dwordx4 v16,s[28:31],s62 offen lds
s_add_u32 s62,s62,32768
s_add_u32 m0,m0,1024
s_waitcnt vmcnt(6)
buffer_load_dwordx4 v16,s[28:31],s62 offen lds
s_add_u32 s62,s62,32768
s_add_u32 m0,m0,1024
s_waitcnt vmcnt(6)
buffer_load_dwordx4 v16,s[28:31],s62 offen lds
s_waitcnt vmcnt(6)
s_xor_b32 s62,s50,1
s_mul_i32 s62,s62,524288
s_add_u32 s62,s62,s54
s_add_u32 m0,s61,16384
s_nop 0
buffer_load_dwordx4 v16,s[28:31],s62 offen lds
s_add_u32 s62,s62,32768
s_add_u32 m0,m0,1024
s_waitcnt vmcnt(6)
buffer_load_dwordx4 v16,s[28:31],s62 offen lds
s_add_u32 s62,s62,32768
s_add_u32 m0,m0,1024
s_waitcnt vmcnt(6)
buffer_load_dwordx4 v16,s[28:31],s62 offen lds
s_add_u32 s62,s62,32768
s_add_u32 m0,m0,1024
s_waitcnt vmcnt(6)
buffer_load_dwordx4 v16,s[28:31],s62 offen lds
s_add_u32 s62,s62,32768
s_add_u32 m0,m0,1024
s_waitcnt vmcnt(6)
buffer_load_dwordx4 v16,s[28:31],s62 offen lds
s_add_u32 s62,s62,32768
s_add_u32 m0,m0,1024
s_waitcnt vmcnt(6)
buffer_load_dwordx4 v16,s[28:31],s62 offen lds
s_add_u32 s62,s62,32768
s_add_u32 m0,m0,1024
s_waitcnt vmcnt(6)
buffer_load_dwordx4 v16,s[28:31],s62 offen lds
s_add_u32 s62,s62,32768
s_add_u32 m0,m0,1024
s_waitcnt vmcnt(6)
buffer_load_dwordx4 v16,s[28:31],s62 offen lds
s_add_u32 s62,s62,32768
s_add_u32 m0,m0,1024
s_waitcnt vmcnt(6)
buffer_load_dwordx4 v16,s[28:31],s62 offen lds
s_add_u32 s62,s62,32768
s_add_u32 m0,m0,1024
s_waitcnt vmcnt(6)
buffer_load_dwordx4 v16,s[28:31],s62 offen lds
s_add_u32 s62,s62,32768
s_add_u32 m0,m0,1024
s_waitcnt vmcnt(6)
buffer_load_dwordx4 v16,s[28:31],s62 offen lds
s_add_u32 s62,s62,32768
s_add_u32 m0,m0,1024
s_waitcnt vmcnt(6)
buffer_load_dwordx4 v16,s[28:31],s62 offen lds
s_add_u32 s62,s62,32768
s_add_u32 m0,m0,1024
s_waitcnt vmcnt(6)
buffer_load_dwordx4 v16,s[28:31],s62 offen lds
s_add_u32 s62,s62,32768
s_add_u32 m0,m0,1024
s_waitcnt vmcnt(6)
buffer_load_dwordx4 v16,s[28:31],s62 offen lds
s_add_u32 s62,s62,32768
s_add_u32 m0,m0,1024
s_waitcnt vmcnt(6)
buffer_load_dwordx4 v16,s[28:31],s62 offen lds
s_add_u32 s62,s62,32768
s_add_u32 m0,m0,1024
s_waitcnt vmcnt(6)
buffer_load_dwordx4 v16,s[28:31],s62 offen lds
s_waitcnt vmcnt(6)
s_waitcnt vmcnt(16)
ds_read_b64_tr_b16 a[0:1],v17 offset:0
ds_read_b64_tr_b16 a[2:3],v17 offset:256
ds_read_b64_tr_b16 a[4:5],v17 offset:8
ds_read_b64_tr_b16 a[6:7],v17 offset:264
ds_read_b64_tr_b16 a[8:9],v17 offset:2048
ds_read_b64_tr_b16 a[10:11],v17 offset:2304
ds_read_b64_tr_b16 a[12:13],v17 offset:2056
ds_read_b64_tr_b16 a[14:15],v17 offset:2312
ds_read_b64_tr_b16 a[16:17],v17 offset:4096
ds_read_b64_tr_b16 a[18:19],v17 offset:4352
ds_read_b64_tr_b16 a[20:21],v17 offset:4104
ds_read_b64_tr_b16 a[22:23],v17 offset:4360
s_waitcnt lgkmcnt(0)
ds_read_b64_tr_b16 a[24:25],v17 offset:6144
ds_read_b64_tr_b16 a[26:27],v17 offset:6400
ds_read_b64_tr_b16 a[28:29],v17 offset:6152
ds_read_b64_tr_b16 a[30:31],v17 offset:6408
ds_read_b64_tr_b16 a[32:33],v17 offset:8192
ds_read_b64_tr_b16 a[34:35],v17 offset:8448
ds_read_b64_tr_b16 a[36:37],v17 offset:8200
ds_read_b64_tr_b16 a[38:39],v17 offset:8456
ds_read_b64_tr_b16 a[40:41],v17 offset:10240
ds_read_b64_tr_b16 a[42:43],v17 offset:10496
ds_read_b64_tr_b16 a[44:45],v17 offset:10248
ds_read_b64_tr_b16 a[46:47],v17 offset:10504
s_waitcnt lgkmcnt(0)
ds_read_b64_tr_b16 a[48:49],v17 offset:12288
ds_read_b64_tr_b16 a[50:51],v17 offset:12544
ds_read_b64_tr_b16 a[52:53],v17 offset:12296
ds_read_b64_tr_b16 a[54:55],v17 offset:12552
ds_read_b64_tr_b16 a[56:57],v17 offset:14336
ds_read_b64_tr_b16 a[58:59],v17 offset:14592
ds_read_b64_tr_b16 a[60:61],v17 offset:14344
ds_read_b64_tr_b16 a[62:63],v17 offset:14600
s_waitcnt lgkmcnt(0)
s_xor_b32 s62,s50,2
s_mul_i32 s62,s62,524288
s_add_u32 s62,s62,s54
s_add_u32 m0,s61,0
s_nop 0
buffer_load_dwordx4 v16,s[28:31],s62 offen lds
s_add_u32 s62,s62,32768
s_add_u32 m0,m0,1024
s_waitcnt vmcnt(6)
buffer_load_dwordx4 v16,s[28:31],s62 offen lds
s_add_u32 s62,s62,32768
s_add_u32 m0,m0,1024
s_waitcnt vmcnt(6)
buffer_load_dwordx4 v16,s[28:31],s62 offen lds
s_add_u32 s62,s62,32768
s_add_u32 m0,m0,1024
s_waitcnt vmcnt(6)
buffer_load_dwordx4 v16,s[28:31],s62 offen lds
s_add_u32 s62,s62,32768
s_add_u32 m0,m0,1024
s_waitcnt vmcnt(6)
buffer_load_dwordx4 v16,s[28:31],s62 offen lds
s_add_u32 s62,s62,32768
s_add_u32 m0,m0,1024
s_waitcnt vmcnt(6)
buffer_load_dwordx4 v16,s[28:31],s62 offen lds
s_add_u32 s62,s62,32768
s_add_u32 m0,m0,1024
s_waitcnt vmcnt(6)
buffer_load_dwordx4 v16,s[28:31],s62 offen lds
s_add_u32 s62,s62,32768
s_add_u32 m0,m0,1024
s_waitcnt vmcnt(6)
buffer_load_dwordx4 v16,s[28:31],s62 offen lds
s_add_u32 s62,s62,32768
s_add_u32 m0,m0,1024
s_waitcnt vmcnt(6)
buffer_load_dwordx4 v16,s[28:31],s62 offen lds
s_add_u32 s62,s62,32768
s_add_u32 m0,m0,1024
s_waitcnt vmcnt(6)
buffer_load_dwordx4 v16,s[28:31],s62 offen lds
s_add_u32 s62,s62,32768
s_add_u32 m0,m0,1024
s_waitcnt vmcnt(6)
buffer_load_dwordx4 v16,s[28:31],s62 offen lds
s_add_u32 s62,s62,32768
s_add_u32 m0,m0,1024
s_waitcnt vmcnt(6)
buffer_load_dwordx4 v16,s[28:31],s62 offen lds
s_add_u32 s62,s62,32768
s_add_u32 m0,m0,1024
s_waitcnt vmcnt(6)
buffer_load_dwordx4 v16,s[28:31],s62 offen lds
s_add_u32 s62,s62,32768
s_add_u32 m0,m0,1024
s_waitcnt vmcnt(6)
buffer_load_dwordx4 v16,s[28:31],s62 offen lds
s_add_u32 s62,s62,32768
s_add_u32 m0,m0,1024
s_waitcnt vmcnt(6)
buffer_load_dwordx4 v16,s[28:31],s62 offen lds
s_add_u32 s62,s62,32768
s_add_u32 m0,m0,1024
s_waitcnt vmcnt(6)
buffer_load_dwordx4 v16,s[28:31],s62 offen lds
s_waitcnt vmcnt(6)
s_waitcnt vmcnt(16)
ds_read_b64_tr_b16 a[64:65],v17 offset:16384
ds_read_b64_tr_b16 a[66:67],v17 offset:16640
ds_read_b64_tr_b16 a[68:69],v17 offset:16392
ds_read_b64_tr_b16 a[70:71],v17 offset:16648
ds_read_b64_tr_b16 a[72:73],v17 offset:18432
ds_read_b64_tr_b16 a[74:75],v17 offset:18688
ds_read_b64_tr_b16 a[76:77],v17 offset:18440
ds_read_b64_tr_b16 a[78:79],v17 offset:18696
ds_read_b64_tr_b16 a[80:81],v17 offset:20480
ds_read_b64_tr_b16 a[82:83],v17 offset:20736
ds_read_b64_tr_b16 a[84:85],v17 offset:20488
ds_read_b64_tr_b16 a[86:87],v17 offset:20744
s_waitcnt lgkmcnt(0)
ds_read_b64_tr_b16 a[88:89],v17 offset:22528
ds_read_b64_tr_b16 a[90:91],v17 offset:22784
ds_read_b64_tr_b16 a[92:93],v17 offset:22536
ds_read_b64_tr_b16 a[94:95],v17 offset:22792
ds_read_b64_tr_b16 a[96:97],v17 offset:24576
ds_read_b64_tr_b16 a[98:99],v17 offset:24832
ds_read_b64_tr_b16 a[100:101],v17 offset:24584
ds_read_b64_tr_b16 a[102:103],v17 offset:24840
ds_read_b64_tr_b16 a[104:105],v17 offset:26624
ds_read_b64_tr_b16 a[106:107],v17 offset:26880
ds_read_b64_tr_b16 a[108:109],v17 offset:26632
ds_read_b64_tr_b16 a[110:111],v17 offset:26888
s_waitcnt lgkmcnt(0)
ds_read_b64_tr_b16 a[112:113],v17 offset:28672
ds_read_b64_tr_b16 a[114:115],v17 offset:28928
ds_read_b64_tr_b16 a[116:117],v17 offset:28680
ds_read_b64_tr_b16 a[118:119],v17 offset:28936
ds_read_b64_tr_b16 a[120:121],v17 offset:30720
ds_read_b64_tr_b16 a[122:123],v17 offset:30976
ds_read_b64_tr_b16 a[124:125],v17 offset:30728
ds_read_b64_tr_b16 a[126:127],v17 offset:30984
s_waitcnt lgkmcnt(0)
s_xor_b32 s62,s50,3
s_mul_i32 s62,s62,524288
s_add_u32 s62,s62,s54
s_add_u32 m0,s61,16384
s_nop 0
buffer_load_dwordx4 v16,s[28:31],s62 offen lds
s_add_u32 s62,s62,32768
s_add_u32 m0,m0,1024
s_waitcnt vmcnt(6)
buffer_load_dwordx4 v16,s[28:31],s62 offen lds
s_add_u32 s62,s62,32768
s_add_u32 m0,m0,1024
s_waitcnt vmcnt(6)
buffer_load_dwordx4 v16,s[28:31],s62 offen lds
s_add_u32 s62,s62,32768
s_add_u32 m0,m0,1024
s_waitcnt vmcnt(6)
buffer_load_dwordx4 v16,s[28:31],s62 offen lds
s_add_u32 s62,s62,32768
s_add_u32 m0,m0,1024
s_waitcnt vmcnt(6)
buffer_load_dwordx4 v16,s[28:31],s62 offen lds
s_add_u32 s62,s62,32768
s_add_u32 m0,m0,1024
s_waitcnt vmcnt(6)
buffer_load_dwordx4 v16,s[28:31],s62 offen lds
s_add_u32 s62,s62,32768
s_add_u32 m0,m0,1024
s_waitcnt vmcnt(6)
buffer_load_dwordx4 v16,s[28:31],s62 offen lds
s_add_u32 s62,s62,32768
s_add_u32 m0,m0,1024
s_waitcnt vmcnt(6)
buffer_load_dwordx4 v16,s[28:31],s62 offen lds
s_add_u32 s62,s62,32768
s_add_u32 m0,m0,1024
s_waitcnt vmcnt(6)
buffer_load_dwordx4 v16,s[28:31],s62 offen lds
s_add_u32 s62,s62,32768
s_add_u32 m0,m0,1024
s_waitcnt vmcnt(6)
buffer_load_dwordx4 v16,s[28:31],s62 offen lds
s_add_u32 s62,s62,32768
s_add_u32 m0,m0,1024
s_waitcnt vmcnt(6)
buffer_load_dwordx4 v16,s[28:31],s62 offen lds
s_add_u32 s62,s62,32768
s_add_u32 m0,m0,1024
s_waitcnt vmcnt(6)
buffer_load_dwordx4 v16,s[28:31],s62 offen lds
s_add_u32 s62,s62,32768
s_add_u32 m0,m0,1024
s_waitcnt vmcnt(6)
buffer_load_dwordx4 v16,s[28:31],s62 offen lds
s_add_u32 s62,s62,32768
s_add_u32 m0,m0,1024
s_waitcnt vmcnt(6)
buffer_load_dwordx4 v16,s[28:31],s62 offen lds
s_add_u32 s62,s62,32768
s_add_u32 m0,m0,1024
s_waitcnt vmcnt(6)
buffer_load_dwordx4 v16,s[28:31],s62 offen lds
s_add_u32 s62,s62,32768
s_add_u32 m0,m0,1024
s_waitcnt vmcnt(6)
buffer_load_dwordx4 v16,s[28:31],s62 offen lds
s_waitcnt vmcnt(6)
s_waitcnt vmcnt(16)
ds_read_b64_tr_b16 a[128:129],v17 offset:0
ds_read_b64_tr_b16 a[130:131],v17 offset:256
ds_read_b64_tr_b16 a[132:133],v17 offset:8
ds_read_b64_tr_b16 a[134:135],v17 offset:264
ds_read_b64_tr_b16 a[136:137],v17 offset:2048
ds_read_b64_tr_b16 a[138:139],v17 offset:2304
ds_read_b64_tr_b16 a[140:141],v17 offset:2056
ds_read_b64_tr_b16 a[142:143],v17 offset:2312
ds_read_b64_tr_b16 a[144:145],v17 offset:4096
ds_read_b64_tr_b16 a[146:147],v17 offset:4352
ds_read_b64_tr_b16 a[148:149],v17 offset:4104
ds_read_b64_tr_b16 a[150:151],v17 offset:4360
s_waitcnt lgkmcnt(0)
ds_read_b64_tr_b16 a[152:153],v17 offset:6144
ds_read_b64_tr_b16 a[154:155],v17 offset:6400
ds_read_b64_tr_b16 a[156:157],v17 offset:6152
ds_read_b64_tr_b16 a[158:159],v17 offset:6408
ds_read_b64_tr_b16 a[160:161],v17 offset:8192
ds_read_b64_tr_b16 a[162:163],v17 offset:8448
ds_read_b64_tr_b16 a[164:165],v17 offset:8200
ds_read_b64_tr_b16 a[166:167],v17 offset:8456
ds_read_b64_tr_b16 a[168:169],v17 offset:10240
ds_read_b64_tr_b16 a[170:171],v17 offset:10496
ds_read_b64_tr_b16 a[172:173],v17 offset:10248
ds_read_b64_tr_b16 a[174:175],v17 offset:10504
s_waitcnt lgkmcnt(0)
ds_read_b64_tr_b16 a[176:177],v17 offset:12288
ds_read_b64_tr_b16 a[178:179],v17 offset:12544
ds_read_b64_tr_b16 a[180:181],v17 offset:12296
ds_read_b64_tr_b16 a[182:183],v17 offset:12552
ds_read_b64_tr_b16 a[184:185],v17 offset:14336
ds_read_b64_tr_b16 a[186:187],v17 offset:14592
ds_read_b64_tr_b16 a[188:189],v17 offset:14344
ds_read_b64_tr_b16 a[190:191],v17 offset:14600
s_waitcnt lgkmcnt(0)
s_waitcnt vmcnt(0)
ds_read_b64_tr_b16 a[192:193],v17 offset:16384
ds_read_b64_tr_b16 a[194:195],v17 offset:16640
ds_read_b64_tr_b16 a[196:197],v17 offset:16392
ds_read_b64_tr_b16 a[198:199],v17 offset:16648
ds_read_b64_tr_b16 a[200:201],v17 offset:18432
ds_read_b64_tr_b16 a[202:203],v17 offset:18688
ds_read_b64_tr_b16 a[204:205],v17 offset:18440
ds_read_b64_tr_b16 a[206:207],v17 offset:18696
ds_read_b64_tr_b16 a[208:209],v17 offset:20480
ds_read_b64_tr_b16 a[210:211],v17 offset:20736
ds_read_b64_tr_b16 a[212:213],v17 offset:20488
ds_read_b64_tr_b16 a[214:215],v17 offset:20744
s_waitcnt lgkmcnt(0)
ds_read_b64_tr_b16 a[216:217],v17 offset:22528
ds_read_b64_tr_b16 a[218:219],v17 offset:22784
ds_read_b64_tr_b16 a[220:221],v17 offset:22536
ds_read_b64_tr_b16 a[222:223],v17 offset:22792
ds_read_b64_tr_b16 a[224:225],v17 offset:24576
ds_read_b64_tr_b16 a[226:227],v17 offset:24832
ds_read_b64_tr_b16 a[228:229],v17 offset:24584
ds_read_b64_tr_b16 a[230:231],v17 offset:24840
ds_read_b64_tr_b16 a[232:233],v17 offset:26624
ds_read_b64_tr_b16 a[234:235],v17 offset:26880
ds_read_b64_tr_b16 a[236:237],v17 offset:26632
ds_read_b64_tr_b16 a[238:239],v17 offset:26888
s_waitcnt lgkmcnt(0)
ds_read_b64_tr_b16 a[240:241],v17 offset:28672
ds_read_b64_tr_b16 a[242:243],v17 offset:28928
ds_read_b64_tr_b16 a[244:245],v17 offset:28680
ds_read_b64_tr_b16 a[246:247],v17 offset:28936
ds_read_b64_tr_b16 a[248:249],v17 offset:30720
ds_read_b64_tr_b16 a[250:251],v17 offset:30976
ds_read_b64_tr_b16 a[252:253],v17 offset:30728
ds_read_b64_tr_b16 a[254:255],v17 offset:30984
s_waitcnt lgkmcnt(0)
s_mov_b32 s92,s2
s_and_b32 s93,s3,0xffff
s_mov_b32 s94,0x100
s_mov_b32 s95,0x20000
v_mbcnt_lo_u32_b32 v16,-1,0
v_mbcnt_hi_u32_b32 v16,-1,v16
v_mov_b32 v18,0
v_cmp_eq_u32 vcc,22,v16
s_nop 1
v_cndmask_b32 v18,v18,63,vcc
v_cmp_eq_u32 vcc,17,v16
s_nop 1
v_cndmask_b32 v18,v18,63,vcc
v_cmp_eq_u32 vcc,18,v16
s_nop 1
v_cndmask_b32 v18,v18,1,vcc
v_and_b32 v19,1,v16
v_cmp_eq_u32 vcc,1,v19
v_mov_b32 v19,8192
s_nop 0
v_cndmask_b32 v19,-1,v19,vcc
v_min_u32 v16,31,v16
v_lshlrev_b32 v16,2,v16
s_sub_u32 s66,s88,64
s_cmp_lg_u32 s50,0
s_cbranch_scc1 vot_76
vpoll_72:
buffer_load_dword v17,v16,s[92:95],s66 offen sc1
s_waitcnt vmcnt(0)
s_cmp_lg_u32 s56,2
s_cbranch_scc1 vck_73
v_cmp_eq_u32 vcc,v17,v19
s_and_b32 s64,vcc_lo,0xffff
s_cmp_eq_u32 s64,65535
s_cbranch_scc1 vck_73
s_mov_b32 s65,0
v_readlane_b32 s64,v17,1
s_lshr_b32 s64,s64,8
s_add_u32 s65,s65,s64
v_readlane_b32 s64,v17,3
s_lshr_b32 s64,s64,8
s_add_u32 s65,s65,s64
v_readlane_b32 s64,v17,5
s_lshr_b32 s64,s64,8
s_add_u32 s65,s65,s64
v_readlane_b32 s64,v17,7
s_lshr_b32 s64,s64,8
s_add_u32 s65,s65,s64
v_readlane_b32 s64,v17,9
s_lshr_b32 s64,s64,8
s_add_u32 s65,s65,s64
v_readlane_b32 s64,v17,11
s_lshr_b32 s64,s64,8
s_add_u32 s65,s65,s64
v_readlane_b32 s64,v17,13
s_lshr_b32 s64,s64,8
s_add_u32 s65,s65,s64
v_readlane_b32 s64,v17,15
s_lshr_b32 s64,s64,8
s_add_u32 s65,s65,s64
s_cmp_ge_u32 s65,256
s_cbranch_scc1 vok_75
s_branch vrt_74
vck_73:
v_cmp_gt_u32 vcc,v18,v17
s_cbranch_vccz vok_75
vrt_74:
s_sleep 48
s_sub_u32 s90,s90,1
s_cmp_gt_i32 s90,0
s_cbranch_scc1 vpoll_72
vok_75:
v_add_u32 v18,161536,v16
ds_write_b32 v18,v17
s_waitcnt lgkmcnt(0)
vot_76:
s_barrier
v_add_u32 v18,161536,v16
ds_read_b32 v17,v18
s_waitcnt lgkmcnt(0)
s_cmp_lg_u32 s56,2
s_cbranch_scc1 vfin_77
v_cmp_eq_u32 vcc,v17,v19
s_and_b32 s64,vcc_lo,0xffff
s_cmp_eq_u32 s64,65535
s_cbranch_scc1 vfin_77
s_mov_b32 s65,0
v_readlane_b32 s64,v17,1
s_lshr_b32 s64,s64,8
s_add_u32 s65,s65,s64
v_readlane_b32 s64,v17,3
s_lshr_b32 s64,s64,8
s_add_u32 s65,s65,s64
v_readlane_b32 s64,v17,5
s_lshr_b32 s64,s64,8
s_add_u32 s65,s65,s64
v_readlane_b32 s64,v17,7
s_lshr_b32 s64,s64,8
s_add_u32 s65,s65,s64
v_readlane_b32 s64,v17,9
s_lshr_b32 s64,s64,8
s_add_u32 s65,s65,s64
v_readlane_b32 s64,v17,11
s_lshr_b32 s64,s64,8
s_add_u32 s65,s65,s64
v_readlane_b32 s64,v17,13
s_lshr_b32 s64,s64,8
s_add_u32 s65,s65,s64
v_readlane_b32 s64,v17,15
s_lshr_b32 s64,s64,8
s_add_u32 s65,s65,s64
s_cmp_ge_u32 s65,256
s_cbranch_scc1 fl_fb
vfin_77:
s_and_b32 s56,s56,1
s_mov_b32 s67,0
s_barrier
v_lshlrev_b32 v0,4,v1
s_mov_b32 s60,0
s_lshl_b32 s70,s50,13
s_mov_b32 s55,0
v_mov_b32 v3,v0
s_mov_b32 s73,0xffff0000
s_lshl_b32 s64,s52,2
s_add_u32 s64,s64,s50
s_mul_i32 s61,s64,8192
s_add_u32 s61,s61,150994944
s_lshl_b32 s68,s64,8
s_add_u32 s68,s68,138543104
s_lshl_b32 s83,s53,2
s_add_u32 s83,s83,s50
s_mov_b32 s63,0
s_xor_b32 s64,s50,0
s_lshl_b32 s64,s64,13
v_add_u32 v8,s64,v0
v_mov_b32 v4,v8
s_xor_b32 s64,s50,1
s_lshl_b32 s64,s64,13
v_add_u32 v9,s64,v0
v_mov_b32 v5,v9
s_xor_b32 s64,s50,2
s_lshl_b32 s64,s64,13
v_add_u32 v10,s64,v0
v_mov_b32 v6,v10
s_xor_b32 s64,s50,3
s_lshl_b32 s64,s64,13
v_add_u32 v11,s64,v0
v_mov_b32 v7,v11
v_min_u32 v2,3,v1
v_lshlrev_b32 v2,2,v2
s_add_u32 s62,s61,4096
s_lshl_b32 s66,s83,10
s_lshr_b32 s65,s83,3
s_lshl_b32 s65,s65,8
s_and_b32 s64,s83,7
s_lshl_b32 s64,s64,2
s_add_u32 s69,s64,s65
s_add_u32 s69,s69,138547200
s_mov_b32 s82,0
s_lshl_b32 s64,s53,2
s_add_u32 s64,s64,s50
s_mul_i32 s74,s64,24576
s_xor_b32 s64,s50,s52
s_sub_u32 s64,s64,1
s_max_i32 s64,s64,0
s_lshl_b32 s64,s64,11
s_add_u32 s74,s74,s64
s_add_u32 s74,s74,167772160
s_mov_b32 s75,0
s_mov_b32 s77,0
v_lshlrev_b32 v26,11,v21
v_lshl_add_u32 v26,v22,4,v26
s_lshl_b32 s64,s83,6
v_add_u32 v18,s64,v26
v_lshlrev_b32 v26,5,v22
s_lshl_b32 s64,s83,7
s_add_u32 s64,s64,267395072
buffer_load_dwordx4 v[152:155],v26,s[20:23],s64 offen offset:0 sc1
buffer_load_dwordx4 v[156:159],v26,s[20:23],s64 offen offset:16 sc1
s_add_u32 s64,s64,24576
buffer_load_dwordx4 v[128:131],v26,s[20:23],s64 offen offset:0 sc1
buffer_load_dwordx4 v[132:135],v26,s[20:23],s64 offen offset:16 sc1
s_add_u32 s64,s64,24576
buffer_load_dwordx4 v[136:139],v26,s[20:23],s64 offen offset:0 sc1
buffer_load_dwordx4 v[140:143],v26,s[20:23],s64 offen offset:16 sc1
s_add_u32 s64,s64,24576
buffer_load_dwordx4 v[144:147],v26,s[20:23],s64 offen offset:0 sc1
buffer_load_dwordx4 v[148:151],v26,s[20:23],s64 offen offset:16 sc1
s_add_u32 s64,s64,24576
s_waitcnt vmcnt(0)
v_pk_add_f32 v[152:153],v[152:153],v[128:129]
v_pk_add_f32 v[136:137],v[136:137],v[144:145]
v_pk_add_f32 v[154:155],v[154:155],v[130:131]
v_pk_add_f32 v[138:139],v[138:139],v[146:147]
v_pk_add_f32 v[156:157],v[156:157],v[132:133]
v_pk_add_f32 v[140:141],v[140:141],v[148:149]
v_pk_add_f32 v[158:159],v[158:159],v[134:135]
v_pk_add_f32 v[142:143],v[142:143],v[150:151]
v_pk_add_f32 v[152:153],v[152:153],v[136:137]
v_pk_add_f32 v[154:155],v[154:155],v[138:139]
v_pk_add_f32 v[156:157],v[156:157],v[140:141]
v_pk_add_f32 v[158:159],v[158:159],v[142:143]
v_cvt_pk_bf16_f32 v128,v152,v153
v_cvt_pk_bf16_f32 v129,v154,v155
v_cvt_pk_bf16_f32 v130,v156,v157
v_cvt_pk_bf16_f32 v131,v158,v159
v_lshlrev_b32 v152,16,v128
v_and_b32 v153,s73,v128
v_lshlrev_b32 v154,16,v129
v_and_b32 v155,s73,v129
v_lshlrev_b32 v156,16,v130
v_and_b32 v157,s73,v130
v_lshlrev_b32 v158,16,v131
v_and_b32 v159,s73,v131
v_mov_b32 v204,-1
v_mov_b32 v205,-1
v_mov_b32 v206,-1
v_mov_b32 v207,-1
s_cmp_eq_u32 s50,s52
s_cbranch_scc1 lfin_78
s_add_u32 s71,s60,1
s_add_u32 s53,s60,2
plp_88:
buffer_load_dword v16,v2,s[20:23],s68 offen sc1
s_waitcnt vmcnt(0)
v_cmp_gt_u32 vcc,s71,v16
s_cbranch_vccz pok_89
s_sleep 4
s_sub_u32 s90,s90,1
s_cmp_gt_i32 s90,0
s_cbranch_scc1 plp_88
pok_89:
lag_85:
s_mov_b32 m0,s70
s_nop 0
buffer_load_dwordx4 v3,s[20:23],s61 offen offset:0 lds
buffer_load_dwordx4 v3,s[20:23],s61 offen offset:1024 lds
buffer_load_dwordx4 v3,s[20:23],s61 offen offset:2048 lds
buffer_load_dwordx4 v3,s[20:23],s61 offen offset:3072 lds
s_add_u32 m0,s70,4096
s_nop 0
buffer_load_dwordx4 v3,s[20:23],s62 offen offset:0 lds
buffer_load_dwordx4 v3,s[20:23],s62 offen offset:1024 lds
buffer_load_dwordx4 v3,s[20:23],s62 offen offset:2048 lds
buffer_load_dwordx4 v3,s[20:23],s62 offen offset:3072 lds
s_add_u32 s61,s61,131072
s_add_u32 s62,s62,131072
s_add_u32 s70,s70,32768
s_and_b32 s70,s70,0x1ffff
buffer_load_dword v23,off,s[20:23],s66
buffer_load_dword v23,off,s[20:23],s66
dec_86:
v_cmp_gt_u32 vcc,s53,v16
s_cbranch_vccnz BN_84
BR_83:
s_waitcnt vmcnt(9)
ds_read_b128 v[64:67],v4 offset:0
s_waitcnt vmcnt(8)
ds_read_b128 v[68:71],v4 offset:1024
s_waitcnt vmcnt(7)
ds_read_b128 v[72:75],v4 offset:2048
s_waitcnt vmcnt(6)
ds_read_b128 v[76:79],v4 offset:3072
s_waitcnt lgkmcnt(3)
v_mfma_f32_16x16x32_bf16 v[32:35],a[0:3],v[64:67],0
s_add_u32 s71,s60,2
s_add_u32 s53,s60,3
v_mfma_f32_16x16x32_bf16 v[36:39],a[4:7],v[64:67],0
s_waitcnt lgkmcnt(2)
s_waitcnt vmcnt(5)
ds_read_b128 v[80:83],v4 offset:4096
v_mfma_f32_16x16x32_bf16 v[32:35],a[8:11],v[68:71],v[32:35]
v_mfma_f32_16x16x32_bf16 v[36:39],a[12:15],v[68:71],v[36:39]
s_waitcnt lgkmcnt(2)
s_waitcnt vmcnt(4)
s_mov_b32 m0,s70
ds_read_b128 v[84:87],v4 offset:5120
v_mfma_f32_16x16x32_bf16 v[32:35],a[16:19],v[72:75],v[32:35]
buffer_load_dwordx4 v3,s[20:23],s61 offen offset:0 lds
v_mfma_f32_16x16x32_bf16 v[36:39],a[20:23],v[72:75],v[36:39]
s_waitcnt lgkmcnt(2)
s_waitcnt vmcnt(4)
ds_read_b128 v[88:91],v4 offset:6144
v_mfma_f32_16x16x32_bf16 v[32:35],a[24:27],v[76:79],v[32:35]
buffer_load_dwordx4 v3,s[20:23],s61 offen offset:1024 lds
v_mfma_f32_16x16x32_bf16 v[36:39],a[28:31],v[76:79],v[36:39]
s_waitcnt lgkmcnt(2)
s_waitcnt vmcnt(4)
ds_read_b128 v[92:95],v4 offset:7168
v_mfma_f32_16x16x32_bf16 v[32:35],a[32:35],v[80:83],v[32:35]
v_mfma_f32_16x16x32_bf16 v[36:39],a[36:39],v[80:83],v[36:39]
s_waitcnt lgkmcnt(2)
s_barrier
ds_read_b128 v[96:99],v5 offset:0
v_mfma_f32_16x16x32_bf16 v[32:35],a[40:43],v[84:87],v[32:35]
ds_read_b128 v[100:103],v5 offset:1024
v_mfma_f32_16x16x32_bf16 v[36:39],a[44:47],v[84:87],v[36:39]
s_waitcnt lgkmcnt(3)
ds_read_b128 v[104:107],v5 offset:2048
v_mfma_f32_16x16x32_bf16 v[32:35],a[48:51],v[88:91],v[32:35]
ds_read_b128 v[108:111],v5 offset:3072
v_mfma_f32_16x16x32_bf16 v[36:39],a[52:55],v[88:91],v[36:39]
s_waitcnt lgkmcnt(4)
ds_read_b128 v[112:115],v5 offset:4096
v_mfma_f32_16x16x32_bf16 v[32:35],a[56:59],v[92:95],v[32:35]
ds_read_b128 v[116:119],v5 offset:5120
v_mfma_f32_16x16x32_bf16 v[36:39],a[60:63],v[92:95],v[36:39]
s_waitcnt lgkmcnt(5)
buffer_load_dwordx4 v3,s[20:23],s61 offen offset:2048 lds
v_mfma_f32_16x16x32_bf16 v[32:35],a[64:67],v[96:99],v[32:35]
ds_read_b128 v[120:123],v5 offset:6144
v_mfma_f32_16x16x32_bf16 v[36:39],a[68:71],v[96:99],v[36:39]
s_waitcnt lgkmcnt(5)
buffer_load_dwordx4 v3,s[20:23],s61 offen offset:3072 lds
v_mfma_f32_16x16x32_bf16 v[32:35],a[72:75],v[100:103],v[32:35]
s_add_u32 m0,s70,4096
ds_read_b128 v[124:127],v5 offset:7168
v_mfma_f32_16x16x32_bf16 v[36:39],a[76:79],v[100:103],v[36:39]
s_waitcnt lgkmcnt(5)
buffer_load_dwordx4 v3,s[20:23],s62 offen offset:0 lds
v_mfma_f32_16x16x32_bf16 v[32:35],a[80:83],v[104:107],v[32:35]
ds_read_b128 v[64:67],v6 offset:0
v_mfma_f32_16x16x32_bf16 v[36:39],a[84:87],v[104:107],v[36:39]
s_waitcnt lgkmcnt(5)
buffer_load_dwordx4 v3,s[20:23],s62 offen offset:1024 lds
v_mfma_f32_16x16x32_bf16 v[32:35],a[88:91],v[108:111],v[32:35]
ds_read_b128 v[68:71],v6 offset:1024
v_mfma_f32_16x16x32_bf16 v[36:39],a[92:95],v[108:111],v[36:39]
s_waitcnt lgkmcnt(5)
buffer_load_dwordx4 v3,s[20:23],s62 offen offset:2048 lds
v_mfma_f32_16x16x32_bf16 v[32:35],a[96:99],v[112:115],v[32:35]
ds_read_b128 v[72:75],v6 offset:2048
v_mfma_f32_16x16x32_bf16 v[36:39],a[100:103],v[112:115],v[36:39]
s_waitcnt lgkmcnt(5)
buffer_load_dword v16,v2,s[20:23],s68 offen sc1
v_mfma_f32_16x16x32_bf16 v[32:35],a[104:107],v[116:119],v[32:35]
ds_read_b128 v[76:79],v6 offset:3072
v_mfma_f32_16x16x32_bf16 v[36:39],a[108:111],v[116:119],v[36:39]
s_waitcnt lgkmcnt(5)
buffer_load_dwordx4 v3,s[20:23],s62 offen offset:3072 lds
v_mfma_f32_16x16x32_bf16 v[32:35],a[112:115],v[120:123],v[32:35]
ds_read_b128 v[80:83],v6 offset:4096
v_mfma_f32_16x16x32_bf16 v[36:39],a[116:119],v[120:123],v[36:39]
s_waitcnt lgkmcnt(5)
v_mfma_f32_16x16x32_bf16 v[32:35],a[120:123],v[124:127],v[32:35]
ds_read_b128 v[84:87],v6 offset:5120
v_mfma_f32_16x16x32_bf16 v[36:39],a[124:127],v[124:127],v[36:39]
s_waitcnt lgkmcnt(5)
v_mfma_f32_16x16x32_bf16 v[32:35],a[128:131],v[64:67],v[32:35]
ds_read_b128 v[88:91],v6 offset:6144
v_mfma_f32_16x16x32_bf16 v[36:39],a[132:135],v[64:67],v[36:39]
s_waitcnt lgkmcnt(5)
v_mfma_f32_16x16x32_bf16 v[32:35],a[136:139],v[68:71],v[32:35]
ds_read_b128 v[92:95],v6 offset:7168
v_mfma_f32_16x16x32_bf16 v[36:39],a[140:143],v[68:71],v[36:39]
s_waitcnt lgkmcnt(5)
v_mfma_f32_16x16x32_bf16 v[32:35],a[144:147],v[72:75],v[32:35]
ds_read_b128 v[96:99],v7 offset:0
v_mfma_f32_16x16x32_bf16 v[36:39],a[148:151],v[72:75],v[36:39]
s_waitcnt lgkmcnt(5)
v_mfma_f32_16x16x32_bf16 v[32:35],a[152:155],v[76:79],v[32:35]
ds_read_b128 v[100:103],v7 offset:1024
v_mfma_f32_16x16x32_bf16 v[36:39],a[156:159],v[76:79],v[36:39]
s_waitcnt lgkmcnt(5)
v_mfma_f32_16x16x32_bf16 v[32:35],a[160:163],v[80:83],v[32:35]
ds_read_b128 v[104:107],v7 offset:2048
v_mfma_f32_16x16x32_bf16 v[36:39],a[164:167],v[80:83],v[36:39]
s_waitcnt lgkmcnt(5)
v_mfma_f32_16x16x32_bf16 v[32:35],a[168:171],v[84:87],v[32:35]
ds_read_b128 v[108:111],v7 offset:3072
v_mfma_f32_16x16x32_bf16 v[36:39],a[172:175],v[84:87],v[36:39]
s_waitcnt lgkmcnt(5)
v_mfma_f32_16x16x32_bf16 v[32:35],a[176:179],v[88:91],v[32:35]
ds_read_b128 v[112:115],v7 offset:4096
v_mfma_f32_16x16x32_bf16 v[36:39],a[180:183],v[88:91],v[36:39]
s_waitcnt lgkmcnt(5)
v_mfma_f32_16x16x32_bf16 v[32:35],a[184:187],v[92:95],v[32:35]
ds_read_b128 v[116:119],v7 offset:5120
v_mfma_f32_16x16x32_bf16 v[36:39],a[188:191],v[92:95],v[36:39]
s_waitcnt lgkmcnt(5)
v_mfma_f32_16x16x32_bf16 v[32:35],a[192:195],v[96:99],v[32:35]
ds_read_b128 v[120:123],v7 offset:6144
v_mfma_f32_16x16x32_bf16 v[36:39],a[196:199],v[96:99],v[36:39]
s_waitcnt lgkmcnt(5)
v_mfma_f32_16x16x32_bf16 v[32:35],a[200:203],v[100:103],v[32:35]
ds_read_b128 v[124:127],v7 offset:7168
v_mfma_f32_16x16x32_bf16 v[36:39],a[204:207],v[100:103],v[36:39]
s_waitcnt lgkmcnt(5)
s_add_u32 s61,s61,131072
s_add_u32 s62,s62,131072
v_mfma_f32_16x16x32_bf16 v[32:35],a[208:211],v[104:107],v[32:35]
s_add_u32 s70,s70,32768
s_and_b32 s70,s70,0x1ffff
s_add_u32 s55,s55,32768
v_mfma_f32_16x16x32_bf16 v[36:39],a[212:215],v[104:107],v[36:39]
s_waitcnt lgkmcnt(4)
s_and_b32 s55,s55,0x1ffff
v_add_u32 v4,s55,v8
v_mfma_f32_16x16x32_bf16 v[32:35],a[216:219],v[108:111],v[32:35]
v_add_u32 v5,s55,v9
v_add_u32 v6,s55,v10
v_mfma_f32_16x16x32_bf16 v[36:39],a[220:223],v[108:111],v[36:39]
s_waitcnt lgkmcnt(3)
v_add_u32 v7,s55,v11
v_mfma_f32_16x16x32_bf16 v[32:35],a[224:227],v[112:115],v[32:35]
s_waitcnt vmcnt(0)
ds_read_b128 v[64:67],v4 offset:0
v_mfma_f32_16x16x32_bf16 v[36:39],a[228:231],v[112:115],v[36:39]
s_waitcnt lgkmcnt(3)
ds_read_b128 v[68:71],v4 offset:1024
v_mfma_f32_16x16x32_bf16 v[32:35],a[232:235],v[116:119],v[32:35]
ds_read_b128 v[72:75],v4 offset:2048
v_mfma_f32_16x16x32_bf16 v[36:39],a[236:239],v[116:119],v[36:39]
s_waitcnt lgkmcnt(4)
v_mfma_f32_16x16x32_bf16 v[32:35],a[240:243],v[120:123],v[32:35]
v_mfma_f32_16x16x32_bf16 v[36:39],a[244:247],v[120:123],v[36:39]
s_waitcnt lgkmcnt(3)
v_mfma_f32_16x16x32_bf16 v[40:43],a[248:251],v[124:127],v[32:35]
v_mfma_f32_16x16x32_bf16 v[44:47],a[252:255],v[124:127],v[36:39]
v_cmp_gt_u32 vcc,s53,v16
s_add_u32 s60,s60,1
s_cbranch_vccnz WN_82
WR_81:
s_waitcnt lgkmcnt(2)
v_mfma_f32_16x16x32_bf16 v[32:35],a[0:3],v[64:67],0
s_add_u32 s71,s60,2
s_add_u32 s53,s60,3
ds_read_b128 v[76:79],v4 offset:3072
v_mfma_f32_16x16x32_bf16 v[36:39],a[4:7],v[64:67],0
s_waitcnt lgkmcnt(2)
ds_read_b128 v[80:83],v4 offset:4096
v_mfma_f32_16x16x32_bf16 v[32:35],a[8:11],v[68:71],v[32:35]
ds_read_b128 v[84:87],v4 offset:5120
s_add_u32 s64,s74,s75
s_cmp_eq_u32 s56,1
s_cbranch_scc1 b1_90
buffer_store_dwordx4 v[40:43],v0,s[20:23],s64 offen offset:0
buffer_store_dwordx4 v[44:47],v0,s[20:23],s64 offen offset:1024
b2_91:
v_mfma_f32_16x16x32_bf16 v[36:39],a[12:15],v[68:71],v[36:39]
s_waitcnt lgkmcnt(3)
s_add_u32 s75,s75,6144
ds_read_b128 v[88:91],v4 offset:6144
v_mfma_f32_16x16x32_bf16 v[32:35],a[16:19],v[72:75],v[32:35]
s_cmp_eq_u32 s75,24576
s_cselect_b32 s75,0,s75
ds_read_b128 v[92:95],v4 offset:7168
v_mfma_f32_16x16x32_bf16 v[36:39],a[20:23],v[72:75],v[36:39]
s_waitcnt lgkmcnt(4)
s_barrier
ds_read_b128 v[96:99],v5 offset:0
v_mfma_f32_16x16x32_bf16 v[32:35],a[24:27],v[76:79],v[32:35]
s_mov_b32 m0,s70
ds_read_b128 v[100:103],v5 offset:1024
v_mfma_f32_16x16x32_bf16 v[36:39],a[28:31],v[76:79],v[36:39]
s_waitcnt lgkmcnt(5)
buffer_load_dwordx4 v3,s[20:23],s61 offen offset:0 lds
v_mfma_f32_16x16x32_bf16 v[32:35],a[32:35],v[80:83],v[32:35]
ds_read_b128 v[104:107],v5 offset:2048
v_mfma_f32_16x16x32_bf16 v[36:39],a[36:39],v[80:83],v[36:39]
s_waitcnt lgkmcnt(5)
buffer_load_dwordx4 v3,s[20:23],s61 offen offset:1024 lds
v_mfma_f32_16x16x32_bf16 v[32:35],a[40:43],v[84:87],v[32:35]
ds_read_b128 v[108:111],v5 offset:3072
v_mfma_f32_16x16x32_bf16 v[36:39],a[44:47],v[84:87],v[36:39]
s_waitcnt lgkmcnt(5)
buffer_load_dwordx4 v3,s[20:23],s61 offen offset:2048 lds
v_mfma_f32_16x16x32_bf16 v[32:35],a[48:51],v[88:91],v[32:35]
ds_read_b128 v[112:115],v5 offset:4096
v_mfma_f32_16x16x32_bf16 v[36:39],a[52:55],v[88:91],v[36:39]
s_waitcnt lgkmcnt(5)
buffer_load_dwordx4 v3,s[20:23],s61 offen offset:3072 lds
v_mfma_f32_16x16x32_bf16 v[32:35],a[56:59],v[92:95],v[32:35]
ds_read_b128 v[116:119],v5 offset:5120
v_mfma_f32_16x16x32_bf16 v[36:39],a[60:63],v[92:95],v[36:39]
s_waitcnt lgkmcnt(5)
v_mfma_f32_16x16x32_bf16 v[32:35],a[64:67],v[96:99],v[32:35]
s_add_u32 m0,s70,4096
ds_read_b128 v[120:123],v5 offset:6144
v_mfma_f32_16x16x32_bf16 v[36:39],a[68:71],v[96:99],v[36:39]
s_waitcnt lgkmcnt(5)
buffer_load_dwordx4 v3,s[20:23],s62 offen offset:0 lds
v_mfma_f32_16x16x32_bf16 v[32:35],a[72:75],v[100:103],v[32:35]
ds_read_b128 v[124:127],v5 offset:7168
v_mfma_f32_16x16x32_bf16 v[36:39],a[76:79],v[100:103],v[36:39]
s_waitcnt lgkmcnt(5)
buffer_load_dwordx4 v3,s[20:23],s62 offen offset:1024 lds
v_mfma_f32_16x16x32_bf16 v[32:35],a[80:83],v[104:107],v[32:35]
ds_read_b128 v[64:67],v6 offset:0
v_mfma_f32_16x16x32_bf16 v[36:39],a[84:87],v[104:107],v[36:39]
s_waitcnt lgkmcnt(5)
v_mfma_f32_16x16x32_bf16 v[32:35],a[88:91],v[108:111],v[32:35]
ds_read_b128 v[68:71],v6 offset:1024
v_mfma_f32_16x16x32_bf16 v[36:39],a[92:95],v[108:111],v[36:39]
s_waitcnt lgkmcnt(5)
buffer_load_dwordx4 v3,s[20:23],s62 offen offset:2048 lds
v_mfma_f32_16x16x32_bf16 v[32:35],a[96:99],v[112:115],v[32:35]
ds_read_b128 v[72:75],v6 offset:2048
v_mfma_f32_16x16x32_bf16 v[36:39],a[100:103],v[112:115],v[36:39]
s_waitcnt lgkmcnt(5)
buffer_load_dword v16,v2,s[20:23],s68 offen sc1
v_mfma_f32_16x16x32_bf16 v[32:35],a[104:107],v[116:119],v[32:35]
ds_read_b128 v[76:79],v6 offset:3072
v_mfma_f32_16x16x32_bf16 v[36:39],a[108:111],v[116:119],v[36:39]
s_waitcnt lgkmcnt(5)
buffer_load_dwordx4 v3,s[20:23],s62 offen offset:3072 lds
v_mfma_f32_16x16x32_bf16 v[32:35],a[112:115],v[120:123],v[32:35]
ds_read_b128 v[80:83],v6 offset:4096
v_mfma_f32_16x16x32_bf16 v[36:39],a[116:119],v[120:123],v[36:39]
s_waitcnt lgkmcnt(5)
v_mfma_f32_16x16x32_bf16 v[32:35],a[120:123],v[124:127],v[32:35]
ds_read_b128 v[84:87],v6 offset:5120
v_mfma_f32_16x16x32_bf16 v[36:39],a[124:127],v[124:127],v[36:39]
s_waitcnt lgkmcnt(5)
v_mfma_f32_16x16x32_bf16 v[32:35],a[128:131],v[64:67],v[32:35]
ds_read_b128 v[88:91],v6 offset:6144
v_mfma_f32_16x16x32_bf16 v[36:39],a[132:135],v[64:67],v[36:39]
s_waitcnt lgkmcnt(5)
v_mfma_f32_16x16x32_bf16 v[32:35],a[136:139],v[68:71],v[32:35]
ds_read_b128 v[92:95],v6 offset:7168
v_mfma_f32_16x16x32_bf16 v[36:39],a[140:143],v[68:71],v[36:39]
s_waitcnt lgkmcnt(5)
v_mfma_f32_16x16x32_bf16 v[32:35],a[144:147],v[72:75],v[32:35]
ds_read_b128 v[96:99],v7 offset:0
v_mfma_f32_16x16x32_bf16 v[36:39],a[148:151],v[72:75],v[36:39]
s_waitcnt lgkmcnt(5)
v_mfma_f32_16x16x32_bf16 v[32:35],a[152:155],v[76:79],v[32:35]
ds_read_b128 v[100:103],v7 offset:1024
v_mfma_f32_16x16x32_bf16 v[36:39],a[156:159],v[76:79],v[36:39]
s_waitcnt lgkmcnt(5)
v_mfma_f32_16x16x32_bf16 v[32:35],a[160:163],v[80:83],v[32:35]
ds_read_b128 v[104:107],v7 offset:2048
v_mfma_f32_16x16x32_bf16 v[36:39],a[164:167],v[80:83],v[36:39]
s_waitcnt lgkmcnt(5)
v_mfma_f32_16x16x32_bf16 v[32:35],a[168:171],v[84:87],v[32:35]
ds_read_b128 v[108:111],v7 offset:3072
v_mfma_f32_16x16x32_bf16 v[36:39],a[172:175],v[84:87],v[36:39]
s_waitcnt lgkmcnt(5)
v_mfma_f32_16x16x32_bf16 v[32:35],a[176:179],v[88:91],v[32:35]
ds_read_b128 v[112:115],v7 offset:4096
v_mfma_f32_16x16x32_bf16 v[36:39],a[180:183],v[88:91],v[36:39]
s_waitcnt lgkmcnt(5)
v_mfma_f32_16x16x32_bf16 v[32:35],a[184:187],v[92:95],v[32:35]
ds_read_b128 v[116:119],v7 offset:5120
v_mfma_f32_16x16x32_bf16 v[36:39],a[188:191],v[92:95],v[36:39]
s_waitcnt lgkmcnt(5)
v_mfma_f32_16x16x32_bf16 v[32:35],a[192:195],v[96:99],v[32:35]
ds_read_b128 v[120:123],v7 offset:6144
v_mfma_f32_16x16x32_bf16 v[36:39],a[196:199],v[96:99],v[36:39]
s_waitcnt lgkmcnt(5)
v_mfma_f32_16x16x32_bf16 v[32:35],a[200:203],v[100:103],v[32:35]
ds_read_b128 v[124:127],v7 offset:7168
v_mfma_f32_16x16x32_bf16 v[36:39],a[204:207],v[100:103],v[36:39]
s_waitcnt lgkmcnt(5)
s_add_u32 s61,s61,131072
s_add_u32 s62,s62,131072
v_mfma_f32_16x16x32_bf16 v[32:35],a[208:211],v[104:107],v[32:35]
s_add_u32 s70,s70,32768
s_and_b32 s70,s70,0x1ffff
s_add_u32 s55,s55,32768
v_mfma_f32_16x16x32_bf16 v[36:39],a[212:215],v[104:107],v[36:39]
s_waitcnt lgkmcnt(4)
s_and_b32 s55,s55,0x1ffff
v_add_u32 v4,s55,v8
v_mfma_f32_16x16x32_bf16 v[32:35],a[216:219],v[108:111],v[32:35]
v_add_u32 v5,s55,v9
v_add_u32 v6,s55,v10
v_mfma_f32_16x16x32_bf16 v[36:39],a[220:223],v[108:111],v[36:39]
s_waitcnt lgkmcnt(3)
v_add_u32 v7,s55,v11
v_mfma_f32_16x16x32_bf16 v[32:35],a[224:227],v[112:115],v[32:35]
s_waitcnt vmcnt(0)
ds_read_b128 v[64:67],v4 offset:0
v_mfma_f32_16x16x32_bf16 v[36:39],a[228:231],v[112:115],v[36:39]
s_waitcnt lgkmcnt(3)
ds_read_b128 v[68:71],v4 offset:1024
v_mfma_f32_16x16x32_bf16 v[32:35],a[232:235],v[116:119],v[32:35]
ds_read_b128 v[72:75],v4 offset:2048
v_mfma_f32_16x16x32_bf16 v[36:39],a[236:239],v[116:119],v[36:39]
s_waitcnt lgkmcnt(4)
v_mfma_f32_16x16x32_bf16 v[32:35],a[240:243],v[120:123],v[32:35]
v_mfma_f32_16x16x32_bf16 v[36:39],a[244:247],v[120:123],v[36:39]
s_waitcnt lgkmcnt(3)
v_mfma_f32_16x16x32_bf16 v[40:43],a[248:251],v[124:127],v[32:35]
v_mfma_f32_16x16x32_bf16 v[44:47],a[252:255],v[124:127],v[36:39]
v_cmp_gt_u32 vcc,s53,v16
s_add_u32 s60,s60,1
s_cbranch_vccz WR_81
WN_82:
s_waitcnt lgkmcnt(2)
v_mfma_f32_16x16x32_bf16 v[32:35],a[0:3],v[64:67],0
s_add_u32 s71,s60,2
s_add_u32 s53,s60,3
ds_read_b128 v[76:79],v4 offset:3072
v_mfma_f32_16x16x32_bf16 v[36:39],a[4:7],v[64:67],0
s_waitcnt lgkmcnt(2)
ds_read_b128 v[80:83],v4 offset:4096
v_mfma_f32_16x16x32_bf16 v[32:35],a[8:11],v[68:71],v[32:35]
ds_read_b128 v[84:87],v4 offset:5120
s_add_u32 s64,s74,s75
s_cmp_eq_u32 s56,1
s_cbranch_scc1 b1_93
buffer_store_dwordx4 v[40:43],v0,s[20:23],s64 offen offset:0
buffer_store_dwordx4 v[44:47],v0,s[20:23],s64 offen offset:1024
b2_94:
v_mfma_f32_16x16x32_bf16 v[36:39],a[12:15],v[68:71],v[36:39]
s_waitcnt lgkmcnt(3)
s_add_u32 s75,s75,6144
ds_read_b128 v[88:91],v4 offset:6144
v_mfma_f32_16x16x32_bf16 v[32:35],a[16:19],v[72:75],v[32:35]
s_cmp_eq_u32 s75,24576
s_cselect_b32 s75,0,s75
ds_read_b128 v[92:95],v4 offset:7168
v_mfma_f32_16x16x32_bf16 v[36:39],a[20:23],v[72:75],v[36:39]
s_waitcnt lgkmcnt(4)
s_barrier
ds_read_b128 v[96:99],v5 offset:0
v_mfma_f32_16x16x32_bf16 v[32:35],a[24:27],v[76:79],v[32:35]
ds_read_b128 v[100:103],v5 offset:1024
v_mfma_f32_16x16x32_bf16 v[36:39],a[28:31],v[76:79],v[36:39]
s_waitcnt lgkmcnt(5)
v_mfma_f32_16x16x32_bf16 v[32:35],a[32:35],v[80:83],v[32:35]
ds_read_b128 v[104:107],v5 offset:2048
v_mfma_f32_16x16x32_bf16 v[36:39],a[36:39],v[80:83],v[36:39]
s_waitcnt lgkmcnt(5)
v_mfma_f32_16x16x32_bf16 v[32:35],a[40:43],v[84:87],v[32:35]
ds_read_b128 v[108:111],v5 offset:3072
v_mfma_f32_16x16x32_bf16 v[36:39],a[44:47],v[84:87],v[36:39]
s_waitcnt lgkmcnt(5)
v_mfma_f32_16x16x32_bf16 v[32:35],a[48:51],v[88:91],v[32:35]
ds_read_b128 v[112:115],v5 offset:4096
v_mfma_f32_16x16x32_bf16 v[36:39],a[52:55],v[88:91],v[36:39]
s_waitcnt lgkmcnt(5)
v_mfma_f32_16x16x32_bf16 v[32:35],a[56:59],v[92:95],v[32:35]
ds_read_b128 v[116:119],v5 offset:5120
v_mfma_f32_16x16x32_bf16 v[36:39],a[60:63],v[92:95],v[36:39]
s_waitcnt lgkmcnt(5)
v_mfma_f32_16x16x32_bf16 v[32:35],a[64:67],v[96:99],v[32:35]
ds_read_b128 v[120:123],v5 offset:6144
v_mfma_f32_16x16x32_bf16 v[36:39],a[68:71],v[96:99],v[36:39]
s_waitcnt lgkmcnt(5)
v_mfma_f32_16x16x32_bf16 v[32:35],a[72:75],v[100:103],v[32:35]
ds_read_b128 v[124:127],v5 offset:7168
v_mfma_f32_16x16x32_bf16 v[36:39],a[76:79],v[100:103],v[36:39]
s_waitcnt lgkmcnt(5)
v_mfma_f32_16x16x32_bf16 v[32:35],a[80:83],v[104:107],v[32:35]
ds_read_b128 v[64:67],v6 offset:0
v_mfma_f32_16x16x32_bf16 v[36:39],a[84:87],v[104:107],v[36:39]
s_waitcnt lgkmcnt(5)
v_mfma_f32_16x16x32_bf16 v[32:35],a[88:91],v[108:111],v[32:35]
ds_read_b128 v[68:71],v6 offset:1024
v_mfma_f32_16x16x32_bf16 v[36:39],a[92:95],v[108:111],v[36:39]
s_waitcnt lgkmcnt(5)
v_mfma_f32_16x16x32_bf16 v[32:35],a[96:99],v[112:115],v[32:35]
ds_read_b128 v[72:75],v6 offset:2048
v_mfma_f32_16x16x32_bf16 v[36:39],a[100:103],v[112:115],v[36:39]
s_waitcnt lgkmcnt(5)
v_mfma_f32_16x16x32_bf16 v[32:35],a[104:107],v[116:119],v[32:35]
ds_read_b128 v[76:79],v6 offset:3072
v_mfma_f32_16x16x32_bf16 v[36:39],a[108:111],v[116:119],v[36:39]
s_waitcnt lgkmcnt(5)
v_mfma_f32_16x16x32_bf16 v[32:35],a[112:115],v[120:123],v[32:35]
ds_read_b128 v[80:83],v6 offset:4096
v_mfma_f32_16x16x32_bf16 v[36:39],a[116:119],v[120:123],v[36:39]
s_waitcnt lgkmcnt(5)
v_mfma_f32_16x16x32_bf16 v[32:35],a[120:123],v[124:127],v[32:35]
ds_read_b128 v[84:87],v6 offset:5120
v_mfma_f32_16x16x32_bf16 v[36:39],a[124:127],v[124:127],v[36:39]
s_waitcnt lgkmcnt(5)
v_mfma_f32_16x16x32_bf16 v[32:35],a[128:131],v[64:67],v[32:35]
ds_read_b128 v[88:91],v6 offset:6144
v_mfma_f32_16x16x32_bf16 v[36:39],a[132:135],v[64:67],v[36:39]
s_waitcnt lgkmcnt(5)
v_mfma_f32_16x16x32_bf16 v[32:35],a[136:139],v[68:71],v[32:35]
ds_read_b128 v[92:95],v6 offset:7168
v_mfma_f32_16x16x32_bf16 v[36:39],a[140:143],v[68:71],v[36:39]
s_waitcnt lgkmcnt(5)
v_mfma_f32_16x16x32_bf16 v[32:35],a[144:147],v[72:75],v[32:35]
ds_read_b128 v[96:99],v7 offset:0
v_mfma_f32_16x16x32_bf16 v[36:39],a[148:151],v[72:75],v[36:39]
s_waitcnt lgkmcnt(5)
v_mfma_f32_16x16x32_bf16 v[32:35],a[152:155],v[76:79],v[32:35]
ds_read_b128 v[100:103],v7 offset:1024
v_mfma_f32_16x16x32_bf16 v[36:39],a[156:159],v[76:79],v[36:39]
s_waitcnt lgkmcnt(5)
v_mfma_f32_16x16x32_bf16 v[32:35],a[160:163],v[80:83],v[32:35]
ds_read_b128 v[104:107],v7 offset:2048
v_mfma_f32_16x16x32_bf16 v[36:39],a[164:167],v[80:83],v[36:39]
s_waitcnt lgkmcnt(5)
buffer_load_dword v16,v2,s[20:23],s68 offen sc1
v_mfma_f32_16x16x32_bf16 v[32:35],a[168:171],v[84:87],v[32:35]
ds_read_b128 v[108:111],v7 offset:3072
v_mfma_f32_16x16x32_bf16 v[36:39],a[172:175],v[84:87],v[36:39]
s_waitcnt lgkmcnt(5)
v_mfma_f32_16x16x32_bf16 v[32:35],a[176:179],v[88:91],v[32:35]
ds_read_b128 v[112:115],v7 offset:4096
v_mfma_f32_16x16x32_bf16 v[36:39],a[180:183],v[88:91],v[36:39]
s_waitcnt lgkmcnt(5)
v_mfma_f32_16x16x32_bf16 v[32:35],a[184:187],v[92:95],v[32:35]
ds_read_b128 v[116:119],v7 offset:5120
v_mfma_f32_16x16x32_bf16 v[36:39],a[188:191],v[92:95],v[36:39]
s_waitcnt lgkmcnt(5)
v_mfma_f32_16x16x32_bf16 v[32:35],a[192:195],v[96:99],v[32:35]
ds_read_b128 v[120:123],v7 offset:6144
v_mfma_f32_16x16x32_bf16 v[36:39],a[196:199],v[96:99],v[36:39]
s_waitcnt lgkmcnt(5)
v_mfma_f32_16x16x32_bf16 v[32:35],a[200:203],v[100:103],v[32:35]
ds_read_b128 v[124:127],v7 offset:7168
v_mfma_f32_16x16x32_bf16 v[36:39],a[204:207],v[100:103],v[36:39]
s_waitcnt lgkmcnt(5)
s_add_u32 s55,s55,32768
s_and_b32 s55,s55,0x1ffff
v_mfma_f32_16x16x32_bf16 v[32:35],a[208:211],v[104:107],v[32:35]
v_add_u32 v4,s55,v8
v_add_u32 v5,s55,v9
v_mfma_f32_16x16x32_bf16 v[36:39],a[212:215],v[104:107],v[36:39]
s_waitcnt lgkmcnt(4)
v_add_u32 v6,s55,v10
v_add_u32 v7,s55,v11
v_mfma_f32_16x16x32_bf16 v[32:35],a[216:219],v[108:111],v[32:35]
v_mfma_f32_16x16x32_bf16 v[36:39],a[220:223],v[108:111],v[36:39]
s_waitcnt lgkmcnt(3)
v_mfma_f32_16x16x32_bf16 v[32:35],a[224:227],v[112:115],v[32:35]
v_mfma_f32_16x16x32_bf16 v[36:39],a[228:231],v[112:115],v[36:39]
s_waitcnt lgkmcnt(2)
v_mfma_f32_16x16x32_bf16 v[32:35],a[232:235],v[116:119],v[32:35]
v_mfma_f32_16x16x32_bf16 v[36:39],a[236:239],v[116:119],v[36:39]
s_waitcnt lgkmcnt(1)
v_mfma_f32_16x16x32_bf16 v[32:35],a[240:243],v[120:123],v[32:35]
v_mfma_f32_16x16x32_bf16 v[36:39],a[244:247],v[120:123],v[36:39]
s_waitcnt lgkmcnt(0)
v_mfma_f32_16x16x32_bf16 v[40:43],a[248:251],v[124:127],v[32:35]
v_mfma_f32_16x16x32_bf16 v[44:47],a[252:255],v[124:127],v[36:39]
s_waitcnt vmcnt(0)
v_cmp_gt_u32 vcc,s71,v16
s_add_u32 s60,s60,1
s_branch endN_92
BN_84:
s_waitcnt vmcnt(9)
ds_read_b128 v[64:67],v4 offset:0
s_waitcnt vmcnt(8)
ds_read_b128 v[68:71],v4 offset:1024
s_waitcnt vmcnt(7)
ds_read_b128 v[72:75],v4 offset:2048
s_waitcnt vmcnt(6)
ds_read_b128 v[76:79],v4 offset:3072
s_waitcnt lgkmcnt(3)
v_mfma_f32_16x16x32_bf16 v[32:35],a[0:3],v[64:67],0
s_add_u32 s71,s60,2
s_add_u32 s53,s60,3
v_mfma_f32_16x16x32_bf16 v[36:39],a[4:7],v[64:67],0
s_waitcnt lgkmcnt(2)
s_waitcnt vmcnt(5)
ds_read_b128 v[80:83],v4 offset:4096
v_mfma_f32_16x16x32_bf16 v[32:35],a[8:11],v[68:71],v[32:35]
v_mfma_f32_16x16x32_bf16 v[36:39],a[12:15],v[68:71],v[36:39]
s_waitcnt lgkmcnt(2)
s_waitcnt vmcnt(4)
ds_read_b128 v[84:87],v4 offset:5120
v_mfma_f32_16x16x32_bf16 v[32:35],a[16:19],v[72:75],v[32:35]
v_mfma_f32_16x16x32_bf16 v[36:39],a[20:23],v[72:75],v[36:39]
s_waitcnt lgkmcnt(2)
s_waitcnt vmcnt(3)
ds_read_b128 v[88:91],v4 offset:6144
v_mfma_f32_16x16x32_bf16 v[32:35],a[24:27],v[76:79],v[32:35]
v_mfma_f32_16x16x32_bf16 v[36:39],a[28:31],v[76:79],v[36:39]
s_waitcnt lgkmcnt(2)
s_waitcnt vmcnt(2)
ds_read_b128 v[92:95],v4 offset:7168
v_mfma_f32_16x16x32_bf16 v[32:35],a[32:35],v[80:83],v[32:35]
v_mfma_f32_16x16x32_bf16 v[36:39],a[36:39],v[80:83],v[36:39]
s_waitcnt lgkmcnt(2)
s_barrier
ds_read_b128 v[96:99],v5 offset:0
v_mfma_f32_16x16x32_bf16 v[32:35],a[40:43],v[84:87],v[32:35]
ds_read_b128 v[100:103],v5 offset:1024
v_mfma_f32_16x16x32_bf16 v[36:39],a[44:47],v[84:87],v[36:39]
s_waitcnt lgkmcnt(3)
ds_read_b128 v[104:107],v5 offset:2048
v_mfma_f32_16x16x32_bf16 v[32:35],a[48:51],v[88:91],v[32:35]
ds_read_b128 v[108:111],v5 offset:3072
v_mfma_f32_16x16x32_bf16 v[36:39],a[52:55],v[88:91],v[36:39]
s_waitcnt lgkmcnt(4)
ds_read_b128 v[112:115],v5 offset:4096
v_mfma_f32_16x16x32_bf16 v[32:35],a[56:59],v[92:95],v[32:35]
ds_read_b128 v[116:119],v5 offset:5120
v_mfma_f32_16x16x32_bf16 v[36:39],a[60:63],v[92:95],v[36:39]
s_waitcnt lgkmcnt(5)
v_mfma_f32_16x16x32_bf16 v[32:35],a[64:67],v[96:99],v[32:35]
ds_read_b128 v[120:123],v5 offset:6144
v_mfma_f32_16x16x32_bf16 v[36:39],a[68:71],v[96:99],v[36:39]
s_waitcnt lgkmcnt(5)
v_mfma_f32_16x16x32_bf16 v[32:35],a[72:75],v[100:103],v[32:35]
ds_read_b128 v[124:127],v5 offset:7168
v_mfma_f32_16x16x32_bf16 v[36:39],a[76:79],v[100:103],v[36:39]
s_waitcnt lgkmcnt(5)
v_mfma_f32_16x16x32_bf16 v[32:35],a[80:83],v[104:107],v[32:35]
ds_read_b128 v[64:67],v6 offset:0
v_mfma_f32_16x16x32_bf16 v[36:39],a[84:87],v[104:107],v[36:39]
s_waitcnt lgkmcnt(5)
v_mfma_f32_16x16x32_bf16 v[32:35],a[88:91],v[108:111],v[32:35]
ds_read_b128 v[68:71],v6 offset:1024
v_mfma_f32_16x16x32_bf16 v[36:39],a[92:95],v[108:111],v[36:39]
s_waitcnt lgkmcnt(5)
v_mfma_f32_16x16x32_bf16 v[32:35],a[96:99],v[112:115],v[32:35]
ds_read_b128 v[72:75],v6 offset:2048
v_mfma_f32_16x16x32_bf16 v[36:39],a[100:103],v[112:115],v[36:39]
s_waitcnt lgkmcnt(5)
v_mfma_f32_16x16x32_bf16 v[32:35],a[104:107],v[116:119],v[32:35]
ds_read_b128 v[76:79],v6 offset:3072
v_mfma_f32_16x16x32_bf16 v[36:39],a[108:111],v[116:119],v[36:39]
s_waitcnt lgkmcnt(5)
v_mfma_f32_16x16x32_bf16 v[32:35],a[112:115],v[120:123],v[32:35]
ds_read_b128 v[80:83],v6 offset:4096
v_mfma_f32_16x16x32_bf16 v[36:39],a[116:119],v[120:123],v[36:39]
s_waitcnt lgkmcnt(5)
v_mfma_f32_16x16x32_bf16 v[32:35],a[120:123],v[124:127],v[32:35]
ds_read_b128 v[84:87],v6 offset:5120
v_mfma_f32_16x16x32_bf16 v[36:39],a[124:127],v[124:127],v[36:39]
s_waitcnt lgkmcnt(5)
v_mfma_f32_16x16x32_bf16 v[32:35],a[128:131],v[64:67],v[32:35]
ds_read_b128 v[88:91],v6 offset:6144
v_mfma_f32_16x16x32_bf16 v[36:39],a[132:135],v[64:67],v[36:39]
s_waitcnt lgkmcnt(5)
v_mfma_f32_16x16x32_bf16 v[32:35],a[136:139],v[68:71],v[32:35]
ds_read_b128 v[92:95],v6 offset:7168
v_mfma_f32_16x16x32_bf16 v[36:39],a[140:143],v[68:71],v[36:39]
s_waitcnt lgkmcnt(5)
v_mfma_f32_16x16x32_bf16 v[32:35],a[144:147],v[72:75],v[32:35]
ds_read_b128 v[96:99],v7 offset:0
v_mfma_f32_16x16x32_bf16 v[36:39],a[148:151],v[72:75],v[36:39]
s_waitcnt lgkmcnt(5)
v_mfma_f32_16x16x32_bf16 v[32:35],a[152:155],v[76:79],v[32:35]
ds_read_b128 v[100:103],v7 offset:1024
v_mfma_f32_16x16x32_bf16 v[36:39],a[156:159],v[76:79],v[36:39]
s_waitcnt lgkmcnt(5)
v_mfma_f32_16x16x32_bf16 v[32:35],a[160:163],v[80:83],v[32:35]
ds_read_b128 v[104:107],v7 offset:2048
v_mfma_f32_16x16x32_bf16 v[36:39],a[164:167],v[80:83],v[36:39]
s_waitcnt lgkmcnt(5)
buffer_load_dword v16,v2,s[20:23],s68 offen sc1
v_mfma_f32_16x16x32_bf16 v[32:35],a[168:171],v[84:87],v[32:35]
ds_read_b128 v[108:111],v7 offset:3072
v_mfma_f32_16x16x32_bf16 v[36:39],a[172:175],v[84:87],v[36:39]
s_waitcnt lgkmcnt(5)
v_mfma_f32_16x16x32_bf16 v[32:35],a[176:179],v[88:91],v[32:35]
ds_read_b128 v[112:115],v7 offset:4096
v_mfma_f32_16x16x32_bf16 v[36:39],a[180:183],v[88:91],v[36:39]
s_waitcnt lgkmcnt(5)
v_mfma_f32_16x16x32_bf16 v[32:35],a[184:187],v[92:95],v[32:35]
ds_read_b128 v[116:119],v7 offset:5120
v_mfma_f32_16x16x32_bf16 v[36:39],a[188:191],v[92:95],v[36:39]
s_waitcnt lgkmcnt(5)
v_mfma_f32_16x16x32_bf16 v[32:35],a[192:195],v[96:99],v[32:35]
ds_read_b128 v[120:123],v7 offset:6144
v_mfma_f32_16x16x32_bf16 v[36:39],a[196:199],v[96:99],v[36:39]
s_waitcnt lgkmcnt(5)
v_mfma_f32_16x16x32_bf16 v[32:35],a[200:203],v[100:103],v[32:35]
ds_read_b128 v[124:127],v7 offset:7168
v_mfma_f32_16x16x32_bf16 v[36:39],a[204:207],v[100:103],v[36:39]
s_waitcnt lgkmcnt(5)
s_add_u32 s55,s55,32768
s_and_b32 s55,s55,0x1ffff
v_mfma_f32_16x16x32_bf16 v[32:35],a[208:211],v[104:107],v[32:35]
v_add_u32 v4,s55,v8
v_add_u32 v5,s55,v9
v_mfma_f32_16x16x32_bf16 v[36:39],a[212:215],v[104:107],v[36:39]
s_waitcnt lgkmcnt(4)
v_add_u32 v6,s55,v10
v_add_u32 v7,s55,v11
v_mfma_f32_16x16x32_bf16 v[32:35],a[216:219],v[108:111],v[32:35]
v_mfma_f32_16x16x32_bf16 v[36:39],a[220:223],v[108:111],v[36:39]
s_waitcnt lgkmcnt(3)
v_mfma_f32_16x16x32_bf16 v[32:35],a[224:227],v[112:115],v[32:35]
v_mfma_f32_16x16x32_bf16 v[36:39],a[228:231],v[112:115],v[36:39]
s_waitcnt lgkmcnt(2)
v_mfma_f32_16x16x32_bf16 v[32:35],a[232:235],v[116:119],v[32:35]
v_mfma_f32_16x16x32_bf16 v[36:39],a[236:239],v[116:119],v[36:39]
s_waitcnt lgkmcnt(1)
v_mfma_f32_16x16x32_bf16 v[32:35],a[240:243],v[120:123],v[32:35]
v_mfma_f32_16x16x32_bf16 v[36:39],a[244:247],v[120:123],v[36:39]
s_waitcnt lgkmcnt(0)
v_mfma_f32_16x16x32_bf16 v[40:43],a[248:251],v[124:127],v[32:35]
v_mfma_f32_16x16x32_bf16 v[44:47],a[252:255],v[124:127],v[36:39]
s_waitcnt vmcnt(0)
v_cmp_gt_u32 vcc,s71,v16
s_add_u32 s60,s60,1
endN_92:
s_cbranch_vccnz nb_87
s_mov_b32 m0,s70
s_nop 0
buffer_load_dwordx4 v3,s[20:23],s61 offen offset:0 lds
buffer_load_dwordx4 v3,s[20:23],s61 offen offset:1024 lds
buffer_load_dwordx4 v3,s[20:23],s61 offen offset:2048 lds
buffer_load_dwordx4 v3,s[20:23],s61 offen offset:3072 lds
s_add_u32 m0,s70,4096
s_nop 0
buffer_load_dwordx4 v3,s[20:23],s62 offen offset:0 lds
buffer_load_dwordx4 v3,s[20:23],s62 offen offset:1024 lds
buffer_load_dwordx4 v3,s[20:23],s62 offen offset:2048 lds
buffer_load_dwordx4 v3,s[20:23],s62 offen offset:3072 lds
s_add_u32 s61,s61,131072
s_add_u32 s62,s62,131072
s_add_u32 s70,s70,32768
s_and_b32 s70,s70,0x1ffff
s_add_u32 s64,s74,s75
s_cmp_eq_u32 s56,1
s_cbranch_scc1 b1_95
buffer_store_dwordx4 v[40:43],v0,s[20:23],s64 offen offset:0
buffer_store_dwordx4 v[44:47],v0,s[20:23],s64 offen offset:1024
b2_96:
s_add_u32 s75,s75,6144
s_cmp_eq_u32 s75,24576
s_cselect_b32 s75,0,s75
s_branch dec_86
nb_87:
buffer_load_dword v16,v2,s[20:23],s68 offen sc1
s_nop 3
s_add_u32 s64,s74,s75
s_cmp_eq_u32 s56,1
s_cbranch_scc1 b1_97
buffer_store_dwordx4 v[40:43],v0,s[20:23],s64 offen offset:0
buffer_store_dwordx4 v[44:47],v0,s[20:23],s64 offen offset:1024
b2_98:
s_add_u32 s75,s75,6144
s_cmp_eq_u32 s75,24576
s_cselect_b32 s75,0,s75
s_waitcnt vmcnt(2)
v_cmp_gt_u32 vcc,s71,v16
s_cbranch_vccz lag_85
s_cmp_ge_u32 s60,128
s_cbranch_scc1 done_71
plp_99:
buffer_load_dword v16,v2,s[20:23],s68 offen sc1
s_waitcnt vmcnt(0)
v_cmp_gt_u32 vcc,s71,v16
s_cbranch_vccz pok_100
s_sleep 4
s_sub_u32 s90,s90,1
s_cmp_gt_i32 s90,0
s_cbranch_scc1 plp_99
pok_100:
s_branch lag_85
lfin_78:
s_add_u32 s71,s60,1
s_add_u32 s53,s60,2
plp_120:
buffer_load_dword v16,v2,s[20:23],s68 offen sc1
s_waitcnt vmcnt(0)
v_cmp_gt_u32 vcc,s71,v16
s_cbranch_vccz pok_121
s_sleep 4
s_sub_u32 s90,s90,1
s_cmp_gt_i32 s90,0
s_cbranch_scc1 plp_120
pok_121:
lag_117:
s_mov_b32 m0,s70
s_nop 0
buffer_load_dwordx4 v3,s[20:23],s61 offen offset:0 lds
buffer_load_dwordx4 v3,s[20:23],s61 offen offset:1024 lds
buffer_load_dwordx4 v3,s[20:23],s61 offen offset:2048 lds
buffer_load_dwordx4 v3,s[20:23],s61 offen offset:3072 lds
s_add_u32 m0,s70,4096
s_nop 0
buffer_load_dwordx4 v3,s[20:23],s62 offen offset:0 lds
buffer_load_dwordx4 v3,s[20:23],s62 offen offset:1024 lds
buffer_load_dwordx4 v3,s[20:23],s62 offen offset:2048 lds
buffer_load_dwordx4 v3,s[20:23],s62 offen offset:3072 lds
s_add_u32 s61,s61,131072
s_add_u32 s62,s62,131072
s_add_u32 s70,s70,32768
s_and_b32 s70,s70,0x1ffff
dec_118:
v_cmp_gt_u32 vcc,s53,v16
s_cbranch_vccnz BN_116
BR_115:
s_waitcnt vmcnt(7)
ds_read_b128 v[64:67],v4 offset:0
s_waitcnt vmcnt(6)
ds_read_b128 v[68:71],v4 offset:1024
s_waitcnt vmcnt(5)
ds_read_b128 v[72:75],v4 offset:2048
s_waitcnt vmcnt(4)
ds_read_b128 v[76:79],v4 offset:3072
s_waitcnt lgkmcnt(3)
v_mfma_f32_16x16x32_bf16 v[32:35],a[0:3],v[64:67],0
s_add_u32 s71,s60,2
s_add_u32 s53,s60,3
v_mfma_f32_16x16x32_bf16 v[36:39],a[4:7],v[64:67],0
s_waitcnt lgkmcnt(2)
s_waitcnt vmcnt(3)
ds_read_b128 v[80:83],v4 offset:4096
v_mfma_f32_16x16x32_bf16 v[32:35],a[8:11],v[68:71],v[32:35]
v_mfma_f32_16x16x32_bf16 v[36:39],a[12:15],v[68:71],v[36:39]
s_waitcnt lgkmcnt(2)
s_waitcnt vmcnt(2)
s_mov_b32 m0,s70
ds_read_b128 v[84:87],v4 offset:5120
v_mfma_f32_16x16x32_bf16 v[32:35],a[16:19],v[72:75],v[32:35]
buffer_load_dwordx4 v3,s[20:23],s61 offen offset:0 lds
v_mfma_f32_16x16x32_bf16 v[36:39],a[20:23],v[72:75],v[36:39]
s_waitcnt lgkmcnt(2)
s_waitcnt vmcnt(2)
ds_read_b128 v[88:91],v4 offset:6144
v_mfma_f32_16x16x32_bf16 v[32:35],a[24:27],v[76:79],v[32:35]
buffer_load_dwordx4 v3,s[20:23],s61 offen offset:1024 lds
v_mfma_f32_16x16x32_bf16 v[36:39],a[28:31],v[76:79],v[36:39]
s_waitcnt lgkmcnt(2)
s_waitcnt vmcnt(2)
ds_read_b128 v[92:95],v4 offset:7168
v_mfma_f32_16x16x32_bf16 v[32:35],a[32:35],v[80:83],v[32:35]
v_mfma_f32_16x16x32_bf16 v[36:39],a[36:39],v[80:83],v[36:39]
s_waitcnt lgkmcnt(2)
s_barrier
ds_read_b128 v[96:99],v5 offset:0
v_mfma_f32_16x16x32_bf16 v[32:35],a[40:43],v[84:87],v[32:35]
ds_read_b128 v[100:103],v5 offset:1024
v_mfma_f32_16x16x32_bf16 v[36:39],a[44:47],v[84:87],v[36:39]
s_waitcnt lgkmcnt(3)
ds_read_b128 v[104:107],v5 offset:2048
v_mfma_f32_16x16x32_bf16 v[32:35],a[48:51],v[88:91],v[32:35]
ds_read_b128 v[108:111],v5 offset:3072
v_mfma_f32_16x16x32_bf16 v[36:39],a[52:55],v[88:91],v[36:39]
s_waitcnt lgkmcnt(4)
ds_read_b128 v[112:115],v5 offset:4096
v_mfma_f32_16x16x32_bf16 v[32:35],a[56:59],v[92:95],v[32:35]
s_cmp_eq_u32 s77,0
s_cselect_b32 s57,2.0,0
ds_read_b128 v[116:119],v5 offset:5120
v_mfma_f32_16x16x32_bf16 v[36:39],a[60:63],v[92:95],v[36:39]
s_waitcnt lgkmcnt(5)
buffer_load_dwordx4 v3,s[20:23],s61 offen offset:2048 lds
v_or_b32 v21,s57,v0
v_mfma_f32_16x16x32_bf16 v[32:35],a[64:67],v[96:99],v[32:35]
ds_read_b128 v[120:123],v5 offset:6144
v_lshlrev_b32 v168,16,v160
v_mfma_f32_16x16x32_bf16 v[36:39],a[68:71],v[96:99],v[36:39]
s_waitcnt lgkmcnt(5)
buffer_load_dwordx4 v3,s[20:23],s61 offen offset:3072 lds
v_and_b32 v169,s73,v160
v_mfma_f32_16x16x32_bf16 v[32:35],a[72:75],v[100:103],v[32:35]
s_add_u32 m0,s70,4096
ds_read_b128 v[124:127],v5 offset:7168
v_lshlrev_b32 v170,16,v161
v_mfma_f32_16x16x32_bf16 v[36:39],a[76:79],v[100:103],v[36:39]
s_waitcnt lgkmcnt(5)
buffer_load_dwordx4 v3,s[20:23],s62 offen offset:0 lds
v_and_b32 v171,s73,v161
v_mfma_f32_16x16x32_bf16 v[32:35],a[80:83],v[104:107],v[32:35]
ds_read_b128 v[64:67],v6 offset:0
v_lshlrev_b32 v172,16,v162
v_mfma_f32_16x16x32_bf16 v[36:39],a[84:87],v[104:107],v[36:39]
s_waitcnt lgkmcnt(5)
buffer_load_dwordx4 v3,s[20:23],s62 offen offset:1024 lds
v_and_b32 v173,s73,v162
v_mfma_f32_16x16x32_bf16 v[32:35],a[88:91],v[108:111],v[32:35]
ds_read_b128 v[68:71],v6 offset:1024
v_lshlrev_b32 v174,16,v163
v_mfma_f32_16x16x32_bf16 v[36:39],a[92:95],v[108:111],v[36:39]
s_waitcnt lgkmcnt(5)
buffer_load_dwordx4 v3,s[20:23],s62 offen offset:2048 lds
v_and_b32 v175,s73,v163
v_mfma_f32_16x16x32_bf16 v[32:35],a[96:99],v[112:115],v[32:35]
ds_read_b128 v[72:75],v6 offset:2048
v_fma_f32 v168,v212,v152,v168
v_mfma_f32_16x16x32_bf16 v[36:39],a[100:103],v[112:115],v[36:39]
s_waitcnt lgkmcnt(5)
buffer_load_dword v16,v2,s[20:23],s68 offen sc1
v_fma_f32 v169,v213,v153,v169
v_mfma_f32_16x16x32_bf16 v[32:35],a[104:107],v[116:119],v[32:35]
ds_read_b128 v[76:79],v6 offset:3072
v_fma_f32 v170,v214,v154,v170
v_mfma_f32_16x16x32_bf16 v[36:39],a[108:111],v[116:119],v[36:39]
s_waitcnt lgkmcnt(5)
buffer_load_dwordx4 v3,s[20:23],s62 offen offset:3072 lds
v_fma_f32 v171,v215,v155,v171
v_mfma_f32_16x16x32_bf16 v[32:35],a[112:115],v[120:123],v[32:35]
s_add_u32 s84,s74,s75
s_add_u32 s85,s84,4096
ds_read_b128 v[80:83],v6 offset:4096
v_mfma_f32_16x16x32_bf16 v[36:39],a[116:119],v[120:123],v[36:39]
s_waitcnt lgkmcnt(5)
buffer_load_dwordx4 v[128:131],v0,s[20:23],s84 offen offset:0 sc1
v_fma_f32 v172,v216,v156,v172
v_mfma_f32_16x16x32_bf16 v[32:35],a[120:123],v[124:127],v[32:35]
ds_read_b128 v[84:87],v6 offset:5120
v_fma_f32 v173,v217,v157,v173
v_mfma_f32_16x16x32_bf16 v[36:39],a[124:127],v[124:127],v[36:39]
s_waitcnt lgkmcnt(5)
buffer_load_dwordx4 v[132:135],v0,s[20:23],s84 offen offset:1024 sc1
v_fma_f32 v174,v218,v158,v174
v_mfma_f32_16x16x32_bf16 v[32:35],a[128:131],v[64:67],v[32:35]
ds_read_b128 v[88:91],v6 offset:6144
v_fma_f32 v175,v219,v159,v175
v_mfma_f32_16x16x32_bf16 v[36:39],a[132:135],v[64:67],v[36:39]
s_waitcnt lgkmcnt(5)
buffer_load_dwordx4 v[136:139],v0,s[20:23],s84 offen offset:2048 sc1
buffer_load_dwordx4 v[160:163],v18,s[24:27],s82 offen
v_mfma_f32_16x16x32_bf16 v[32:35],a[136:139],v[68:71],v[32:35]
s_add_u32 s82,s82,32768
ds_read_b128 v[92:95],v6 offset:7168
v_mfma_f32_16x16x32_bf16 v[36:39],a[140:143],v[68:71],v[36:39]
s_waitcnt lgkmcnt(5)
buffer_load_dwordx4 v[140:143],v0,s[20:23],s84 offen offset:3072 sc1
v_mfma_f32_16x16x32_bf16 v[32:35],a[144:147],v[72:75],v[32:35]
ds_read_b128 v[96:99],v7 offset:0
v_mfma_f32_16x16x32_bf16 v[36:39],a[148:151],v[72:75],v[36:39]
s_waitcnt lgkmcnt(5)
buffer_load_dwordx4 v[144:147],v0,s[20:23],s85 offen offset:0 sc1
v_mfma_f32_16x16x32_bf16 v[32:35],a[152:155],v[76:79],v[32:35]
ds_read_b128 v[100:103],v7 offset:1024
v_mfma_f32_16x16x32_bf16 v[36:39],a[156:159],v[76:79],v[36:39]
s_waitcnt lgkmcnt(5)
buffer_load_dwordx4 v[148:151],v0,s[20:23],s85 offen offset:1024 sc1
v_mfma_f32_16x16x32_bf16 v[32:35],a[160:163],v[80:83],v[32:35]
ds_read_b128 v[104:107],v7 offset:2048
v_mfma_f32_16x16x32_bf16 v[36:39],a[164:167],v[80:83],v[36:39]
s_waitcnt lgkmcnt(5)
v_mfma_f32_16x16x32_bf16 v[32:35],a[168:171],v[84:87],v[32:35]
ds_read_b128 v[108:111],v7 offset:3072
v_mfma_f32_16x16x32_bf16 v[36:39],a[172:175],v[84:87],v[36:39]
s_waitcnt lgkmcnt(5)
v_mfma_f32_16x16x32_bf16 v[32:35],a[176:179],v[88:91],v[32:35]
ds_read_b128 v[112:115],v7 offset:4096
v_mfma_f32_16x16x32_bf16 v[36:39],a[180:183],v[88:91],v[36:39]
s_waitcnt lgkmcnt(5)
v_mfma_f32_16x16x32_bf16 v[32:35],a[184:187],v[92:95],v[32:35]
ds_read_b128 v[116:119],v7 offset:5120
v_mfma_f32_16x16x32_bf16 v[36:39],a[188:191],v[92:95],v[36:39]
s_waitcnt lgkmcnt(5)
v_mfma_f32_16x16x32_bf16 v[32:35],a[192:195],v[96:99],v[32:35]
ds_read_b128 v[120:123],v7 offset:6144
v_mfma_f32_16x16x32_bf16 v[36:39],a[196:199],v[96:99],v[36:39]
s_waitcnt lgkmcnt(5)
v_mfma_f32_16x16x32_bf16 v[32:35],a[200:203],v[100:103],v[32:35]
ds_read_b128 v[124:127],v7 offset:7168
v_mfma_f32_16x16x32_bf16 v[36:39],a[204:207],v[100:103],v[36:39]
s_waitcnt lgkmcnt(5)
s_add_u32 s61,s61,131072
s_add_u32 s62,s62,131072
v_mfma_f32_16x16x32_bf16 v[32:35],a[208:211],v[104:107],v[32:35]
s_add_u32 s70,s70,32768
s_and_b32 s70,s70,0x1ffff
s_add_u32 s55,s55,32768
v_mfma_f32_16x16x32_bf16 v[36:39],a[212:215],v[104:107],v[36:39]
s_waitcnt lgkmcnt(4)
s_and_b32 s55,s55,0x1ffff
v_add_u32 v4,s55,v8
v_mfma_f32_16x16x32_bf16 v[32:35],a[216:219],v[108:111],v[32:35]
v_add_u32 v5,s55,v9
v_add_u32 v6,s55,v10
v_mfma_f32_16x16x32_bf16 v[36:39],a[220:223],v[108:111],v[36:39]
s_waitcnt lgkmcnt(3)
v_add_u32 v7,s55,v11
v_mfma_f32_16x16x32_bf16 v[32:35],a[224:227],v[112:115],v[32:35]
s_waitcnt vmcnt(7)
ds_read_b128 v[64:67],v4 offset:0
v_mfma_f32_16x16x32_bf16 v[36:39],a[228:231],v[112:115],v[36:39]
s_waitcnt lgkmcnt(3)
ds_read_b128 v[68:71],v4 offset:1024
v_mfma_f32_16x16x32_bf16 v[32:35],a[232:235],v[116:119],v[32:35]
s_waitcnt vmcnt(0)
v_mov_b32 v17,s63
s_mov_b64 exec,1
buffer_store_dword v17,off,s[20:23],s69 sc1
s_mov_b64 exec,-1
s_cmp_eq_u32 s77,0
s_cbranch_scc1 go_130
ck_128:
v_max3_u32 v184,v128,v129,v130
v_max3_u32 v185,v140,v141,v142
v_max3_u32 v184,v184,v131,v132
v_max3_u32 v185,v185,v143,v144
v_max3_u32 v184,v184,v133,v134
v_max3_u32 v185,v185,v145,v146
v_max3_u32 v184,v184,v135,v136
v_max3_u32 v185,v185,v147,v148
v_max3_u32 v184,v184,v137,v138
v_max3_u32 v185,v185,v149,v150
v_max3_u32 v184,v184,v139,v151
v_max_u32 v184,v184,v185
v_cmp_eq_u32 vcc,-1,v184
s_cbranch_vccnz rt_129
go_130:
v_mfma_f32_16x16x32_bf16 v[36:39],a[236:239],v[116:119],v[36:39]
s_waitcnt lgkmcnt(3)
ds_read_b128 v[72:75],v4 offset:2048
v_add_f32 v128,v128,v136
v_add_f32 v129,v129,v137
v_mfma_f32_16x16x32_bf16 v[32:35],a[240:243],v[120:123],v[32:35]
v_add_f32 v130,v130,v138
v_add_f32 v131,v131,v139
v_add_f32 v132,v132,v140
v_mfma_f32_16x16x32_bf16 v[36:39],a[244:247],v[120:123],v[36:39]
s_waitcnt lgkmcnt(3)
v_add_f32 v133,v133,v141
v_add_f32 v134,v134,v142
v_add_f32 v135,v135,v143
v_mfma_f32_16x16x32_bf16 v[40:43],a[248:251],v[124:127],v[32:35]
v_add_f32 v128,v128,v144
v_add_f32 v129,v129,v145
v_add_f32 v130,v130,v146
v_mfma_f32_16x16x32_bf16 v[44:47],a[252:255],v[124:127],v[36:39]
v_add_f32 v131,v131,v147
v_add_f32 v132,v132,v148
v_add_f32 v133,v133,v149
v_add_f32 v134,v134,v150
v_add_f32 v135,v135,v151
v_fma_f32 v168,v128,v152,v168
v_fma_f32 v169,v129,v153,v169
v_fma_f32 v170,v130,v154,v170
v_fma_f32 v171,v131,v155,v171
v_fma_f32 v172,v132,v156,v172
v_fma_f32 v173,v133,v157,v173
v_fma_f32 v174,v134,v158,v174
v_fma_f32 v175,v135,v159,v175
v_cvt_pk_bf16_f32 v176,v168,v169
v_cvt_pk_bf16_f32 v177,v170,v171
v_cvt_pk_bf16_f32 v178,v172,v173
v_cvt_pk_bf16_f32 v179,v174,v175
s_add_u32 s64,s66,201326592
buffer_store_dwordx4 v[176:179],v21,s[20:23],s64 offen sc1
s_cmp_eq_u32 s56,1
s_cbranch_scc1 b1_122
buffer_store_dwordx4 v[204:207],v21,s[20:23],s84 offen offset:0
buffer_store_dwordx4 v[204:207],v21,s[20:23],s84 offen offset:1024
b2_123:
s_cmp_eq_u32 s56,1
s_cbranch_scc1 b1_124
buffer_store_dwordx4 v[204:207],v21,s[20:23],s84 offen offset:2048
buffer_store_dwordx4 v[204:207],v21,s[20:23],s84 offen offset:3072
b2_125:
s_cmp_eq_u32 s56,1
s_cbranch_scc1 b1_126
buffer_store_dwordx4 v[204:207],v21,s[20:23],s85 offen offset:0
buffer_store_dwordx4 v[204:207],v21,s[20:23],s85 offen offset:1024
b2_127:
s_mul_i32 s64,s77,32768
s_add_u32 s66,s66,s64
s_mul_i32 s64,s77,6144
s_add_u32 s75,s75,s64
s_cmp_eq_u32 s75,24576
s_cselect_b32 s75,0,s75
s_add_u32 s63,s63,s77
s_mov_b32 s77,0
v_cmp_gt_u32 vcc,s53,v16
s_add_u32 s60,s60,1
s_cbranch_vccnz WN_114
WR_113:
s_waitcnt lgkmcnt(2)
v_mfma_f32_16x16x32_bf16 v[32:35],a[0:3],v[64:67],0
s_add_u32 s71,s60,2
s_add_u32 s53,s60,3
ds_read_b128 v[76:79],v4 offset:3072
v_mfma_f32_16x16x32_bf16 v[36:39],a[4:7],v[64:67],0
s_waitcnt lgkmcnt(2)
ds_read_b128 v[80:83],v4 offset:4096
v_mfma_f32_16x16x32_bf16 v[32:35],a[8:11],v[68:71],v[32:35]
ds_read_b128 v[84:87],v4 offset:5120
v_mov_b32 v212,v40
v_mfma_f32_16x16x32_bf16 v[36:39],a[12:15],v[68:71],v[36:39]
s_waitcnt lgkmcnt(3)
ds_read_b128 v[88:91],v4 offset:6144
v_mov_b32 v213,v41
v_mfma_f32_16x16x32_bf16 v[32:35],a[16:19],v[72:75],v[32:35]
ds_read_b128 v[92:95],v4 offset:7168
v_mov_b32 v214,v42
v_mfma_f32_16x16x32_bf16 v[36:39],a[20:23],v[72:75],v[36:39]
s_waitcnt lgkmcnt(4)
s_barrier
ds_read_b128 v[96:99],v5 offset:0
v_mfma_f32_16x16x32_bf16 v[32:35],a[24:27],v[76:79],v[32:35]
s_mov_b32 m0,s70
ds_read_b128 v[100:103],v5 offset:1024
v_mov_b32 v215,v43
v_mfma_f32_16x16x32_bf16 v[36:39],a[28:31],v[76:79],v[36:39]
s_waitcnt lgkmcnt(5)
buffer_load_dwordx4 v3,s[20:23],s61 offen offset:0 lds
v_mov_b32 v216,v44
v_mfma_f32_16x16x32_bf16 v[32:35],a[32:35],v[80:83],v[32:35]
ds_read_b128 v[104:107],v5 offset:2048
v_mov_b32 v217,v45
v_mfma_f32_16x16x32_bf16 v[36:39],a[36:39],v[80:83],v[36:39]
s_waitcnt lgkmcnt(5)
buffer_load_dwordx4 v3,s[20:23],s61 offen offset:1024 lds
v_mov_b32 v218,v46
v_mfma_f32_16x16x32_bf16 v[32:35],a[40:43],v[84:87],v[32:35]
ds_read_b128 v[108:111],v5 offset:3072
v_mov_b32 v219,v47
v_mfma_f32_16x16x32_bf16 v[36:39],a[44:47],v[84:87],v[36:39]
s_waitcnt lgkmcnt(5)
s_mov_b32 s77,1
buffer_load_dwordx4 v3,s[20:23],s61 offen offset:2048 lds
v_mfma_f32_16x16x32_bf16 v[32:35],a[48:51],v[88:91],v[32:35]
ds_read_b128 v[112:115],v5 offset:4096
v_mfma_f32_16x16x32_bf16 v[36:39],a[52:55],v[88:91],v[36:39]
s_waitcnt lgkmcnt(5)
buffer_load_dwordx4 v3,s[20:23],s61 offen offset:3072 lds
v_mfma_f32_16x16x32_bf16 v[32:35],a[56:59],v[92:95],v[32:35]
s_waitcnt vmcnt(15)
s_cmp_eq_u32 s77,0
s_cselect_b32 s57,2.0,0
ds_read_b128 v[116:119],v5 offset:5120
v_mfma_f32_16x16x32_bf16 v[36:39],a[60:63],v[92:95],v[36:39]
s_waitcnt lgkmcnt(5)
v_or_b32 v21,s57,v0
v_lshlrev_b32 v168,16,v160
v_mfma_f32_16x16x32_bf16 v[32:35],a[64:67],v[96:99],v[32:35]
s_add_u32 m0,s70,4096
ds_read_b128 v[120:123],v5 offset:6144
v_and_b32 v169,s73,v160
v_mfma_f32_16x16x32_bf16 v[36:39],a[68:71],v[96:99],v[36:39]
s_waitcnt lgkmcnt(5)
buffer_load_dwordx4 v3,s[20:23],s62 offen offset:0 lds
v_lshlrev_b32 v170,16,v161
v_mfma_f32_16x16x32_bf16 v[32:35],a[72:75],v[100:103],v[32:35]
ds_read_b128 v[124:127],v5 offset:7168
v_and_b32 v171,s73,v161
v_mfma_f32_16x16x32_bf16 v[36:39],a[76:79],v[100:103],v[36:39]
s_waitcnt lgkmcnt(5)
buffer_load_dwordx4 v3,s[20:23],s62 offen offset:1024 lds
v_lshlrev_b32 v172,16,v162
v_mfma_f32_16x16x32_bf16 v[32:35],a[80:83],v[104:107],v[32:35]
ds_read_b128 v[64:67],v6 offset:0
v_and_b32 v173,s73,v162
v_mfma_f32_16x16x32_bf16 v[36:39],a[84:87],v[104:107],v[36:39]
s_waitcnt lgkmcnt(5)
v_lshlrev_b32 v174,16,v163
v_and_b32 v175,s73,v163
v_mfma_f32_16x16x32_bf16 v[32:35],a[88:91],v[108:111],v[32:35]
ds_read_b128 v[68:71],v6 offset:1024
v_fma_f32 v168,v212,v152,v168
v_mfma_f32_16x16x32_bf16 v[36:39],a[92:95],v[108:111],v[36:39]
s_waitcnt lgkmcnt(5)
buffer_load_dwordx4 v3,s[20:23],s62 offen offset:2048 lds
v_fma_f32 v169,v213,v153,v169
v_mfma_f32_16x16x32_bf16 v[32:35],a[96:99],v[112:115],v[32:35]
ds_read_b128 v[72:75],v6 offset:2048
v_fma_f32 v170,v214,v154,v170
v_mfma_f32_16x16x32_bf16 v[36:39],a[100:103],v[112:115],v[36:39]
s_waitcnt lgkmcnt(5)
buffer_load_dword v16,v2,s[20:23],s68 offen sc1
v_fma_f32 v171,v215,v155,v171
v_mfma_f32_16x16x32_bf16 v[32:35],a[104:107],v[116:119],v[32:35]
ds_read_b128 v[76:79],v6 offset:3072
v_fma_f32 v172,v216,v156,v172
v_mfma_f32_16x16x32_bf16 v[36:39],a[108:111],v[116:119],v[36:39]
s_waitcnt lgkmcnt(5)
buffer_load_dwordx4 v3,s[20:23],s62 offen offset:3072 lds
v_fma_f32 v173,v217,v157,v173
v_mfma_f32_16x16x32_bf16 v[32:35],a[112:115],v[120:123],v[32:35]
s_add_u32 s84,s74,s75
s_add_u32 s85,s84,4096
ds_read_b128 v[80:83],v6 offset:4096
v_mfma_f32_16x16x32_bf16 v[36:39],a[116:119],v[120:123],v[36:39]
s_waitcnt lgkmcnt(5)
buffer_load_dwordx4 v[128:131],v0,s[20:23],s84 offen offset:0 sc1
v_fma_f32 v174,v218,v158,v174
v_mfma_f32_16x16x32_bf16 v[32:35],a[120:123],v[124:127],v[32:35]
ds_read_b128 v[84:87],v6 offset:5120
v_fma_f32 v175,v219,v159,v175
v_mfma_f32_16x16x32_bf16 v[36:39],a[124:127],v[124:127],v[36:39]
s_waitcnt lgkmcnt(5)
buffer_load_dwordx4 v[132:135],v0,s[20:23],s84 offen offset:1024 sc1
buffer_load_dwordx4 v[160:163],v18,s[24:27],s82 offen
v_mfma_f32_16x16x32_bf16 v[32:35],a[128:131],v[64:67],v[32:35]
s_add_u32 s82,s82,32768
ds_read_b128 v[88:91],v6 offset:6144
v_mfma_f32_16x16x32_bf16 v[36:39],a[132:135],v[64:67],v[36:39]
s_waitcnt lgkmcnt(5)
buffer_load_dwordx4 v[136:139],v0,s[20:23],s84 offen offset:2048 sc1
v_mfma_f32_16x16x32_bf16 v[32:35],a[136:139],v[68:71],v[32:35]
ds_read_b128 v[92:95],v6 offset:7168
v_mfma_f32_16x16x32_bf16 v[36:39],a[140:143],v[68:71],v[36:39]
s_waitcnt lgkmcnt(5)
buffer_load_dwordx4 v[140:143],v0,s[20:23],s84 offen offset:3072 sc1
v_mfma_f32_16x16x32_bf16 v[32:35],a[144:147],v[72:75],v[32:35]
ds_read_b128 v[96:99],v7 offset:0
v_mfma_f32_16x16x32_bf16 v[36:39],a[148:151],v[72:75],v[36:39]
s_waitcnt lgkmcnt(5)
buffer_load_dwordx4 v[144:147],v0,s[20:23],s85 offen offset:0 sc1
v_mfma_f32_16x16x32_bf16 v[32:35],a[152:155],v[76:79],v[32:35]
ds_read_b128 v[100:103],v7 offset:1024
v_mfma_f32_16x16x32_bf16 v[36:39],a[156:159],v[76:79],v[36:39]
s_waitcnt lgkmcnt(5)
buffer_load_dwordx4 v[148:151],v0,s[20:23],s85 offen offset:1024 sc1
v_mfma_f32_16x16x32_bf16 v[32:35],a[160:163],v[80:83],v[32:35]
ds_read_b128 v[104:107],v7 offset:2048
v_mfma_f32_16x16x32_bf16 v[36:39],a[164:167],v[80:83],v[36:39]
s_waitcnt lgkmcnt(5)
v_mfma_f32_16x16x32_bf16 v[32:35],a[168:171],v[84:87],v[32:35]
ds_read_b128 v[108:111],v7 offset:3072
v_mfma_f32_16x16x32_bf16 v[36:39],a[172:175],v[84:87],v[36:39]
s_waitcnt lgkmcnt(5)
v_mfma_f32_16x16x32_bf16 v[32:35],a[176:179],v[88:91],v[32:35]
ds_read_b128 v[112:115],v7 offset:4096
v_mfma_f32_16x16x32_bf16 v[36:39],a[180:183],v[88:91],v[36:39]
s_waitcnt lgkmcnt(5)
v_mfma_f32_16x16x32_bf16 v[32:35],a[184:187],v[92:95],v[32:35]
ds_read_b128 v[116:119],v7 offset:5120
v_mfma_f32_16x16x32_bf16 v[36:39],a[188:191],v[92:95],v[36:39]
s_waitcnt lgkmcnt(5)
v_mfma_f32_16x16x32_bf16 v[32:35],a[192:195],v[96:99],v[32:35]
ds_read_b128 v[120:123],v7 offset:6144
v_mfma_f32_16x16x32_bf16 v[36:39],a[196:199],v[96:99],v[36:39]
s_waitcnt lgkmcnt(5)
v_mfma_f32_16x16x32_bf16 v[32:35],a[200:203],v[100:103],v[32:35]
ds_read_b128 v[124:127],v7 offset:7168
v_mfma_f32_16x16x32_bf16 v[36:39],a[204:207],v[100:103],v[36:39]
s_waitcnt lgkmcnt(5)
s_add_u32 s61,s61,131072
s_add_u32 s62,s62,131072
v_mfma_f32_16x16x32_bf16 v[32:35],a[208:211],v[104:107],v[32:35]
s_add_u32 s70,s70,32768
s_and_b32 s70,s70,0x1ffff
s_add_u32 s55,s55,32768
v_mfma_f32_16x16x32_bf16 v[36:39],a[212:215],v[104:107],v[36:39]
s_waitcnt lgkmcnt(4)
s_and_b32 s55,s55,0x1ffff
v_add_u32 v4,s55,v8
v_mfma_f32_16x16x32_bf16 v[32:35],a[216:219],v[108:111],v[32:35]
v_add_u32 v5,s55,v9
v_add_u32 v6,s55,v10
v_mfma_f32_16x16x32_bf16 v[36:39],a[220:223],v[108:111],v[36:39]
s_waitcnt lgkmcnt(3)
v_add_u32 v7,s55,v11
v_mfma_f32_16x16x32_bf16 v[32:35],a[224:227],v[112:115],v[32:35]
s_waitcnt vmcnt(7)
ds_read_b128 v[64:67],v4 offset:0
v_mfma_f32_16x16x32_bf16 v[36:39],a[228:231],v[112:115],v[36:39]
s_waitcnt lgkmcnt(3)
ds_read_b128 v[68:71],v4 offset:1024
v_mfma_f32_16x16x32_bf16 v[32:35],a[232:235],v[116:119],v[32:35]
s_waitcnt vmcnt(0)
v_mov_b32 v17,s63
s_mov_b64 exec,1
buffer_store_dword v17,off,s[20:23],s69 sc1
s_mov_b64 exec,-1
s_cmp_eq_u32 s77,0
s_cbranch_scc1 go_139
ck_137:
v_max3_u32 v184,v128,v129,v130
v_max3_u32 v185,v140,v141,v142
v_max3_u32 v184,v184,v131,v132
v_max3_u32 v185,v185,v143,v144
v_max3_u32 v184,v184,v133,v134
v_max3_u32 v185,v185,v145,v146
v_max3_u32 v184,v184,v135,v136
v_max3_u32 v185,v185,v147,v148
v_max3_u32 v184,v184,v137,v138
v_max3_u32 v185,v185,v149,v150
v_max3_u32 v184,v184,v139,v151
v_max_u32 v184,v184,v185
v_cmp_eq_u32 vcc,-1,v184
s_cbranch_vccnz rt_138
go_139:
v_mfma_f32_16x16x32_bf16 v[36:39],a[236:239],v[116:119],v[36:39]
s_waitcnt lgkmcnt(3)
ds_read_b128 v[72:75],v4 offset:2048
v_add_f32 v128,v128,v136
v_add_f32 v129,v129,v137
v_mfma_f32_16x16x32_bf16 v[32:35],a[240:243],v[120:123],v[32:35]
v_add_f32 v130,v130,v138
v_add_f32 v131,v131,v139
v_add_f32 v132,v132,v140
v_mfma_f32_16x16x32_bf16 v[36:39],a[244:247],v[120:123],v[36:39]
s_waitcnt lgkmcnt(3)
v_add_f32 v133,v133,v141
v_add_f32 v134,v134,v142
v_add_f32 v135,v135,v143
v_mfma_f32_16x16x32_bf16 v[40:43],a[248:251],v[124:127],v[32:35]
v_add_f32 v128,v128,v144
v_add_f32 v129,v129,v145
v_add_f32 v130,v130,v146
v_mfma_f32_16x16x32_bf16 v[44:47],a[252:255],v[124:127],v[36:39]
v_add_f32 v131,v131,v147
v_add_f32 v132,v132,v148
v_add_f32 v133,v133,v149
v_add_f32 v134,v134,v150
v_add_f32 v135,v135,v151
v_fma_f32 v168,v128,v152,v168
v_fma_f32 v169,v129,v153,v169
v_fma_f32 v170,v130,v154,v170
v_fma_f32 v171,v131,v155,v171
v_fma_f32 v172,v132,v156,v172
v_fma_f32 v173,v133,v157,v173
v_fma_f32 v174,v134,v158,v174
v_fma_f32 v175,v135,v159,v175
v_cvt_pk_bf16_f32 v176,v168,v169
v_cvt_pk_bf16_f32 v177,v170,v171
v_cvt_pk_bf16_f32 v178,v172,v173
v_cvt_pk_bf16_f32 v179,v174,v175
s_add_u32 s64,s66,201326592
buffer_store_dwordx4 v[176:179],v21,s[20:23],s64 offen sc1
s_cmp_eq_u32 s56,1
s_cbranch_scc1 b1_131
buffer_store_dwordx4 v[204:207],v21,s[20:23],s84 offen offset:0
buffer_store_dwordx4 v[204:207],v21,s[20:23],s84 offen offset:1024
b2_132:
s_cmp_eq_u32 s56,1
s_cbranch_scc1 b1_133
buffer_store_dwordx4 v[204:207],v21,s[20:23],s84 offen offset:2048
buffer_store_dwordx4 v[204:207],v21,s[20:23],s84 offen offset:3072
b2_134:
s_cmp_eq_u32 s56,1
s_cbranch_scc1 b1_135
buffer_store_dwordx4 v[204:207],v21,s[20:23],s85 offen offset:0
buffer_store_dwordx4 v[204:207],v21,s[20:23],s85 offen offset:1024
b2_136:
s_mul_i32 s64,s77,32768
s_add_u32 s66,s66,s64
s_mul_i32 s64,s77,6144
s_add_u32 s75,s75,s64
s_cmp_eq_u32 s75,24576
s_cselect_b32 s75,0,s75
s_add_u32 s63,s63,s77
s_mov_b32 s77,0
v_cmp_gt_u32 vcc,s53,v16
s_add_u32 s60,s60,1
s_cbranch_vccz WR_113
WN_114:
s_waitcnt lgkmcnt(2)
v_mfma_f32_16x16x32_bf16 v[32:35],a[0:3],v[64:67],0
s_add_u32 s71,s60,2
s_add_u32 s53,s60,3
ds_read_b128 v[76:79],v4 offset:3072
v_mfma_f32_16x16x32_bf16 v[36:39],a[4:7],v[64:67],0
s_waitcnt lgkmcnt(2)
ds_read_b128 v[80:83],v4 offset:4096
v_mfma_f32_16x16x32_bf16 v[32:35],a[8:11],v[68:71],v[32:35]
ds_read_b128 v[84:87],v4 offset:5120
v_mov_b32 v212,v40
v_mfma_f32_16x16x32_bf16 v[36:39],a[12:15],v[68:71],v[36:39]
s_waitcnt lgkmcnt(3)
ds_read_b128 v[88:91],v4 offset:6144
v_mov_b32 v213,v41
v_mfma_f32_16x16x32_bf16 v[32:35],a[16:19],v[72:75],v[32:35]
ds_read_b128 v[92:95],v4 offset:7168
v_mov_b32 v214,v42
v_mfma_f32_16x16x32_bf16 v[36:39],a[20:23],v[72:75],v[36:39]
s_waitcnt lgkmcnt(4)
s_barrier
ds_read_b128 v[96:99],v5 offset:0
v_mfma_f32_16x16x32_bf16 v[32:35],a[24:27],v[76:79],v[32:35]
ds_read_b128 v[100:103],v5 offset:1024
v_mov_b32 v215,v43
v_mfma_f32_16x16x32_bf16 v[36:39],a[28:31],v[76:79],v[36:39]
s_waitcnt lgkmcnt(5)
v_mov_b32 v216,v44
v_mov_b32 v217,v45
v_mfma_f32_16x16x32_bf16 v[32:35],a[32:35],v[80:83],v[32:35]
ds_read_b128 v[104:107],v5 offset:2048
v_mov_b32 v218,v46
v_mfma_f32_16x16x32_bf16 v[36:39],a[36:39],v[80:83],v[36:39]
s_waitcnt lgkmcnt(5)
v_mov_b32 v219,v47
v_mfma_f32_16x16x32_bf16 v[32:35],a[40:43],v[84:87],v[32:35]
s_mov_b32 s77,1
ds_read_b128 v[108:111],v5 offset:3072
v_mfma_f32_16x16x32_bf16 v[36:39],a[44:47],v[84:87],v[36:39]
s_waitcnt lgkmcnt(5)
v_mfma_f32_16x16x32_bf16 v[32:35],a[48:51],v[88:91],v[32:35]
ds_read_b128 v[112:115],v5 offset:4096
v_mfma_f32_16x16x32_bf16 v[36:39],a[52:55],v[88:91],v[36:39]
s_waitcnt lgkmcnt(5)
v_mfma_f32_16x16x32_bf16 v[32:35],a[56:59],v[92:95],v[32:35]
s_waitcnt vmcnt(11)
s_cmp_eq_u32 s77,0
s_cselect_b32 s57,2.0,0
ds_read_b128 v[116:119],v5 offset:5120
v_mfma_f32_16x16x32_bf16 v[36:39],a[60:63],v[92:95],v[36:39]
s_waitcnt lgkmcnt(5)
v_or_b32 v21,s57,v0
v_lshlrev_b32 v168,16,v160
v_mfma_f32_16x16x32_bf16 v[32:35],a[64:67],v[96:99],v[32:35]
ds_read_b128 v[120:123],v5 offset:6144
v_and_b32 v169,s73,v160
v_mfma_f32_16x16x32_bf16 v[36:39],a[68:71],v[96:99],v[36:39]
s_waitcnt lgkmcnt(5)
v_lshlrev_b32 v170,16,v161
v_and_b32 v171,s73,v161
v_mfma_f32_16x16x32_bf16 v[32:35],a[72:75],v[100:103],v[32:35]
ds_read_b128 v[124:127],v5 offset:7168
v_lshlrev_b32 v172,16,v162
v_mfma_f32_16x16x32_bf16 v[36:39],a[76:79],v[100:103],v[36:39]
s_waitcnt lgkmcnt(5)
v_and_b32 v173,s73,v162
v_lshlrev_b32 v174,16,v163
v_mfma_f32_16x16x32_bf16 v[32:35],a[80:83],v[104:107],v[32:35]
ds_read_b128 v[64:67],v6 offset:0
v_and_b32 v175,s73,v163
v_mfma_f32_16x16x32_bf16 v[36:39],a[84:87],v[104:107],v[36:39]
s_waitcnt lgkmcnt(5)
v_fma_f32 v168,v212,v152,v168
v_fma_f32 v169,v213,v153,v169
v_mfma_f32_16x16x32_bf16 v[32:35],a[88:91],v[108:111],v[32:35]
ds_read_b128 v[68:71],v6 offset:1024
v_fma_f32 v170,v214,v154,v170
v_mfma_f32_16x16x32_bf16 v[36:39],a[92:95],v[108:111],v[36:39]
s_waitcnt lgkmcnt(5)
v_fma_f32 v171,v215,v155,v171
v_fma_f32 v172,v216,v156,v172
v_mfma_f32_16x16x32_bf16 v[32:35],a[96:99],v[112:115],v[32:35]
ds_read_b128 v[72:75],v6 offset:2048
v_fma_f32 v173,v217,v157,v173
v_mfma_f32_16x16x32_bf16 v[36:39],a[100:103],v[112:115],v[36:39]
s_waitcnt lgkmcnt(5)
v_fma_f32 v174,v218,v158,v174
v_fma_f32 v175,v219,v159,v175
v_mfma_f32_16x16x32_bf16 v[32:35],a[104:107],v[116:119],v[32:35]
ds_read_b128 v[76:79],v6 offset:3072
v_mfma_f32_16x16x32_bf16 v[36:39],a[108:111],v[116:119],v[36:39]
s_waitcnt lgkmcnt(5)
buffer_load_dwordx4 v[160:163],v18,s[24:27],s82 offen
v_mfma_f32_16x16x32_bf16 v[32:35],a[112:115],v[120:123],v[32:35]
s_add_u32 s84,s74,s75
s_add_u32 s85,s84,4096
ds_read_b128 v[80:83],v6 offset:4096
v_mfma_f32_16x16x32_bf16 v[36:39],a[116:119],v[120:123],v[36:39]
s_waitcnt lgkmcnt(5)
s_add_u32 s82,s82,32768
buffer_load_dwordx4 v[128:131],v0,s[20:23],s84 offen offset:0 sc1
v_mfma_f32_16x16x32_bf16 v[32:35],a[120:123],v[124:127],v[32:35]
ds_read_b128 v[84:87],v6 offset:5120
v_mfma_f32_16x16x32_bf16 v[36:39],a[124:127],v[124:127],v[36:39]
s_waitcnt lgkmcnt(5)
buffer_load_dwordx4 v[132:135],v0,s[20:23],s84 offen offset:1024 sc1
v_mfma_f32_16x16x32_bf16 v[32:35],a[128:131],v[64:67],v[32:35]
ds_read_b128 v[88:91],v6 offset:6144
v_mfma_f32_16x16x32_bf16 v[36:39],a[132:135],v[64:67],v[36:39]
s_waitcnt lgkmcnt(5)
buffer_load_dwordx4 v[136:139],v0,s[20:23],s84 offen offset:2048 sc1
v_mfma_f32_16x16x32_bf16 v[32:35],a[136:139],v[68:71],v[32:35]
ds_read_b128 v[92:95],v6 offset:7168
v_mfma_f32_16x16x32_bf16 v[36:39],a[140:143],v[68:71],v[36:39]
s_waitcnt lgkmcnt(5)
buffer_load_dwordx4 v[140:143],v0,s[20:23],s84 offen offset:3072 sc1
v_mfma_f32_16x16x32_bf16 v[32:35],a[144:147],v[72:75],v[32:35]
ds_read_b128 v[96:99],v7 offset:0
v_mfma_f32_16x16x32_bf16 v[36:39],a[148:151],v[72:75],v[36:39]
s_waitcnt lgkmcnt(5)
buffer_load_dwordx4 v[144:147],v0,s[20:23],s85 offen offset:0 sc1
v_mfma_f32_16x16x32_bf16 v[32:35],a[152:155],v[76:79],v[32:35]
ds_read_b128 v[100:103],v7 offset:1024
v_mfma_f32_16x16x32_bf16 v[36:39],a[156:159],v[76:79],v[36:39]
s_waitcnt lgkmcnt(5)
buffer_load_dwordx4 v[148:151],v0,s[20:23],s85 offen offset:1024 sc1
v_mfma_f32_16x16x32_bf16 v[32:35],a[160:163],v[80:83],v[32:35]
ds_read_b128 v[104:107],v7 offset:2048
v_mfma_f32_16x16x32_bf16 v[36:39],a[164:167],v[80:83],v[36:39]
s_waitcnt lgkmcnt(5)
buffer_load_dword v16,v2,s[20:23],s68 offen sc1
v_mfma_f32_16x16x32_bf16 v[32:35],a[168:171],v[84:87],v[32:35]
ds_read_b128 v[108:111],v7 offset:3072
v_mfma_f32_16x16x32_bf16 v[36:39],a[172:175],v[84:87],v[36:39]
s_waitcnt lgkmcnt(5)
v_mfma_f32_16x16x32_bf16 v[32:35],a[176:179],v[88:91],v[32:35]
ds_read_b128 v[112:115],v7 offset:4096
v_mfma_f32_16x16x32_bf16 v[36:39],a[180:183],v[88:91],v[36:39]
s_waitcnt lgkmcnt(5)
v_mfma_f32_16x16x32_bf16 v[32:35],a[184:187],v[92:95],v[32:35]
ds_read_b128 v[116:119],v7 offset:5120
v_mfma_f32_16x16x32_bf16 v[36:39],a[188:191],v[92:95],v[36:39]
s_waitcnt lgkmcnt(5)
v_mfma_f32_16x16x32_bf16 v[32:35],a[192:195],v[96:99],v[32:35]
ds_read_b128 v[120:123],v7 offset:6144
v_mfma_f32_16x16x32_bf16 v[36:39],a[196:199],v[96:99],v[36:39]
s_waitcnt lgkmcnt(5)
v_mfma_f32_16x16x32_bf16 v[32:35],a[200:203],v[100:103],v[32:35]
s_waitcnt vmcnt(1)
ds_read_b128 v[124:127],v7 offset:7168
v_mov_b32 v17,s63
s_mov_b64 exec,1
buffer_store_dword v17,off,s[20:23],s69 sc1
s_mov_b64 exec,-1
s_cmp_eq_u32 s77,0
s_cbranch_scc1 go_149
ck_147:
v_max3_u32 v184,v128,v129,v130
v_max3_u32 v185,v140,v141,v142
v_max3_u32 v184,v184,v131,v132
v_max3_u32 v185,v185,v143,v144
v_max3_u32 v184,v184,v133,v134
v_max3_u32 v185,v185,v145,v146
v_max3_u32 v184,v184,v135,v136
v_max3_u32 v185,v185,v147,v148
v_max3_u32 v184,v184,v137,v138
v_max3_u32 v185,v185,v149,v150
v_max3_u32 v184,v184,v139,v151
v_max_u32 v184,v184,v185
v_cmp_eq_u32 vcc,-1,v184
s_cbranch_vccnz rt_148
go_149:
v_mfma_f32_16x16x32_bf16 v[36:39],a[204:207],v[100:103],v[36:39]
s_waitcnt lgkmcnt(5)
s_add_u32 s55,s55,32768
s_and_b32 s55,s55,0x1ffff
v_add_f32 v128,v128,v136
v_mfma_f32_16x16x32_bf16 v[32:35],a[208:211],v[104:107],v[32:35]
v_add_u32 v4,s55,v8
v_add_u32 v5,s55,v9
v_add_f32 v129,v129,v137
v_mfma_f32_16x16x32_bf16 v[36:39],a[212:215],v[104:107],v[36:39]
s_waitcnt lgkmcnt(4)
v_add_u32 v6,s55,v10
v_add_u32 v7,s55,v11
v_add_f32 v130,v130,v138
v_mfma_f32_16x16x32_bf16 v[32:35],a[216:219],v[108:111],v[32:35]
v_add_f32 v131,v131,v139
v_add_f32 v132,v132,v140
v_add_f32 v133,v133,v141
v_mfma_f32_16x16x32_bf16 v[36:39],a[220:223],v[108:111],v[36:39]
s_waitcnt lgkmcnt(3)
v_add_f32 v134,v134,v142
v_add_f32 v135,v135,v143
v_add_f32 v128,v128,v144
v_mfma_f32_16x16x32_bf16 v[32:35],a[224:227],v[112:115],v[32:35]
v_add_f32 v129,v129,v145
v_add_f32 v130,v130,v146
v_add_f32 v131,v131,v147
v_mfma_f32_16x16x32_bf16 v[36:39],a[228:231],v[112:115],v[36:39]
s_waitcnt lgkmcnt(2)
v_add_f32 v132,v132,v148
v_add_f32 v133,v133,v149
v_add_f32 v134,v134,v150
v_mfma_f32_16x16x32_bf16 v[32:35],a[232:235],v[116:119],v[32:35]
v_add_f32 v135,v135,v151
v_fma_f32 v168,v128,v152,v168
v_fma_f32 v169,v129,v153,v169
v_mfma_f32_16x16x32_bf16 v[36:39],a[236:239],v[116:119],v[36:39]
s_waitcnt lgkmcnt(1)
v_fma_f32 v170,v130,v154,v170
v_fma_f32 v171,v131,v155,v171
v_fma_f32 v172,v132,v156,v172
v_mfma_f32_16x16x32_bf16 v[32:35],a[240:243],v[120:123],v[32:35]
v_fma_f32 v173,v133,v157,v173
v_fma_f32 v174,v134,v158,v174
v_fma_f32 v175,v135,v159,v175
v_mfma_f32_16x16x32_bf16 v[36:39],a[244:247],v[120:123],v[36:39]
s_waitcnt lgkmcnt(0)
v_cvt_pk_bf16_f32 v176,v168,v169
v_cvt_pk_bf16_f32 v177,v170,v171
v_cvt_pk_bf16_f32 v178,v172,v173
v_mfma_f32_16x16x32_bf16 v[40:43],a[248:251],v[124:127],v[32:35]
v_cvt_pk_bf16_f32 v179,v174,v175
v_mfma_f32_16x16x32_bf16 v[44:47],a[252:255],v[124:127],v[36:39]
s_waitcnt vmcnt(1)
s_add_u32 s64,s66,201326592
buffer_store_dwordx4 v[176:179],v21,s[20:23],s64 offen sc1
s_cmp_eq_u32 s56,1
s_cbranch_scc1 b1_141
buffer_store_dwordx4 v[204:207],v21,s[20:23],s84 offen offset:0
buffer_store_dwordx4 v[204:207],v21,s[20:23],s84 offen offset:1024
b2_142:
s_cmp_eq_u32 s56,1
s_cbranch_scc1 b1_143
buffer_store_dwordx4 v[204:207],v21,s[20:23],s84 offen offset:2048
buffer_store_dwordx4 v[204:207],v21,s[20:23],s84 offen offset:3072
b2_144:
s_cmp_eq_u32 s56,1
s_cbranch_scc1 b1_145
buffer_store_dwordx4 v[204:207],v21,s[20:23],s85 offen offset:0
buffer_store_dwordx4 v[204:207],v21,s[20:23],s85 offen offset:1024
b2_146:
s_mul_i32 s64,s77,32768
s_add_u32 s66,s66,s64
s_mul_i32 s64,s77,6144
s_add_u32 s75,s75,s64
s_cmp_eq_u32 s75,24576
s_cselect_b32 s75,0,s75
s_add_u32 s63,s63,s77
s_mov_b32 s77,0
v_cmp_gt_u32 vcc,s71,v16
s_add_u32 s60,s60,1
s_branch endN_140
BN_116:
s_waitcnt vmcnt(7)
ds_read_b128 v[64:67],v4 offset:0
s_waitcnt vmcnt(6)
ds_read_b128 v[68:71],v4 offset:1024
s_waitcnt vmcnt(5)
ds_read_b128 v[72:75],v4 offset:2048
s_waitcnt vmcnt(4)
ds_read_b128 v[76:79],v4 offset:3072
s_waitcnt lgkmcnt(3)
v_mfma_f32_16x16x32_bf16 v[32:35],a[0:3],v[64:67],0
s_add_u32 s71,s60,2
s_add_u32 s53,s60,3
v_mfma_f32_16x16x32_bf16 v[36:39],a[4:7],v[64:67],0
s_waitcnt lgkmcnt(2)
s_waitcnt vmcnt(3)
ds_read_b128 v[80:83],v4 offset:4096
v_mfma_f32_16x16x32_bf16 v[32:35],a[8:11],v[68:71],v[32:35]
v_mfma_f32_16x16x32_bf16 v[36:39],a[12:15],v[68:71],v[36:39]
s_waitcnt lgkmcnt(2)
s_waitcnt vmcnt(2)
ds_read_b128 v[84:87],v4 offset:5120
v_mfma_f32_16x16x32_bf16 v[32:35],a[16:19],v[72:75],v[32:35]
v_mfma_f32_16x16x32_bf16 v[36:39],a[20:23],v[72:75],v[36:39]
s_waitcnt lgkmcnt(2)
s_waitcnt vmcnt(1)
ds_read_b128 v[88:91],v4 offset:6144
v_mfma_f32_16x16x32_bf16 v[32:35],a[24:27],v[76:79],v[32:35]
v_mfma_f32_16x16x32_bf16 v[36:39],a[28:31],v[76:79],v[36:39]
s_waitcnt lgkmcnt(2)
s_waitcnt vmcnt(0)
ds_read_b128 v[92:95],v4 offset:7168
v_mfma_f32_16x16x32_bf16 v[32:35],a[32:35],v[80:83],v[32:35]
v_mfma_f32_16x16x32_bf16 v[36:39],a[36:39],v[80:83],v[36:39]
s_waitcnt lgkmcnt(2)
s_barrier
ds_read_b128 v[96:99],v5 offset:0
v_mfma_f32_16x16x32_bf16 v[32:35],a[40:43],v[84:87],v[32:35]
ds_read_b128 v[100:103],v5 offset:1024
v_mfma_f32_16x16x32_bf16 v[36:39],a[44:47],v[84:87],v[36:39]
s_waitcnt lgkmcnt(3)
ds_read_b128 v[104:107],v5 offset:2048
v_mfma_f32_16x16x32_bf16 v[32:35],a[48:51],v[88:91],v[32:35]
ds_read_b128 v[108:111],v5 offset:3072
v_mfma_f32_16x16x32_bf16 v[36:39],a[52:55],v[88:91],v[36:39]
s_waitcnt lgkmcnt(4)
ds_read_b128 v[112:115],v5 offset:4096
v_mfma_f32_16x16x32_bf16 v[32:35],a[56:59],v[92:95],v[32:35]
s_cmp_eq_u32 s77,0
s_cselect_b32 s57,2.0,0
ds_read_b128 v[116:119],v5 offset:5120
v_mfma_f32_16x16x32_bf16 v[36:39],a[60:63],v[92:95],v[36:39]
s_waitcnt lgkmcnt(5)
v_or_b32 v21,s57,v0
v_lshlrev_b32 v168,16,v160
v_mfma_f32_16x16x32_bf16 v[32:35],a[64:67],v[96:99],v[32:35]
ds_read_b128 v[120:123],v5 offset:6144
v_and_b32 v169,s73,v160
v_mfma_f32_16x16x32_bf16 v[36:39],a[68:71],v[96:99],v[36:39]
s_waitcnt lgkmcnt(5)
v_lshlrev_b32 v170,16,v161
v_and_b32 v171,s73,v161
v_mfma_f32_16x16x32_bf16 v[32:35],a[72:75],v[100:103],v[32:35]
ds_read_b128 v[124:127],v5 offset:7168
v_lshlrev_b32 v172,16,v162
v_mfma_f32_16x16x32_bf16 v[36:39],a[76:79],v[100:103],v[36:39]
s_waitcnt lgkmcnt(5)
v_and_b32 v173,s73,v162
v_lshlrev_b32 v174,16,v163
v_mfma_f32_16x16x32_bf16 v[32:35],a[80:83],v[104:107],v[32:35]
ds_read_b128 v[64:67],v6 offset:0
v_and_b32 v175,s73,v163
v_mfma_f32_16x16x32_bf16 v[36:39],a[84:87],v[104:107],v[36:39]
s_waitcnt lgkmcnt(5)
v_fma_f32 v168,v212,v152,v168
v_fma_f32 v169,v213,v153,v169
v_mfma_f32_16x16x32_bf16 v[32:35],a[88:91],v[108:111],v[32:35]
ds_read_b128 v[68:71],v6 offset:1024
v_fma_f32 v170,v214,v154,v170
v_mfma_f32_16x16x32_bf16 v[36:39],a[92:95],v[108:111],v[36:39]
s_waitcnt lgkmcnt(5)
v_fma_f32 v171,v215,v155,v171
v_fma_f32 v172,v216,v156,v172
v_mfma_f32_16x16x32_bf16 v[32:35],a[96:99],v[112:115],v[32:35]
ds_read_b128 v[72:75],v6 offset:2048
v_fma_f32 v173,v217,v157,v173
v_mfma_f32_16x16x32_bf16 v[36:39],a[100:103],v[112:115],v[36:39]
s_waitcnt lgkmcnt(5)
v_fma_f32 v174,v218,v158,v174
v_fma_f32 v175,v219,v159,v175
v_mfma_f32_16x16x32_bf16 v[32:35],a[104:107],v[116:119],v[32:35]
ds_read_b128 v[76:79],v6 offset:3072
v_mfma_f32_16x16x32_bf16 v[36:39],a[108:111],v[116:119],v[36:39]
s_waitcnt lgkmcnt(5)
buffer_load_dwordx4 v[160:163],v18,s[24:27],s82 offen
v_mfma_f32_16x16x32_bf16 v[32:35],a[112:115],v[120:123],v[32:35]
s_add_u32 s84,s74,s75
s_add_u32 s85,s84,4096
ds_read_b128 v[80:83],v6 offset:4096
v_mfma_f32_16x16x32_bf16 v[36:39],a[116:119],v[120:123],v[36:39]
s_waitcnt lgkmcnt(5)
s_add_u32 s82,s82,32768
buffer_load_dwordx4 v[128:131],v0,s[20:23],s84 offen offset:0 sc1
v_mfma_f32_16x16x32_bf16 v[32:35],a[120:123],v[124:127],v[32:35]
ds_read_b128 v[84:87],v6 offset:5120
v_mfma_f32_16x16x32_bf16 v[36:39],a[124:127],v[124:127],v[36:39]
s_waitcnt lgkmcnt(5)
buffer_load_dwordx4 v[132:135],v0,s[20:23],s84 offen offset:1024 sc1
v_mfma_f32_16x16x32_bf16 v[32:35],a[128:131],v[64:67],v[32:35]
ds_read_b128 v[88:91],v6 offset:6144
v_mfma_f32_16x16x32_bf16 v[36:39],a[132:135],v[64:67],v[36:39]
s_waitcnt lgkmcnt(5)
buffer_load_dwordx4 v[136:139],v0,s[20:23],s84 offen offset:2048 sc1
v_mfma_f32_16x16x32_bf16 v[32:35],a[136:139],v[68:71],v[32:35]
ds_read_b128 v[92:95],v6 offset:7168
v_mfma_f32_16x16x32_bf16 v[36:39],a[140:143],v[68:71],v[36:39]
s_waitcnt lgkmcnt(5)
buffer_load_dwordx4 v[140:143],v0,s[20:23],s84 offen offset:3072 sc1
v_mfma_f32_16x16x32_bf16 v[32:35],a[144:147],v[72:75],v[32:35]
ds_read_b128 v[96:99],v7 offset:0
v_mfma_f32_16x16x32_bf16 v[36:39],a[148:151],v[72:75],v[36:39]
s_waitcnt lgkmcnt(5)
buffer_load_dwordx4 v[144:147],v0,s[20:23],s85 offen offset:0 sc1
v_mfma_f32_16x16x32_bf16 v[32:35],a[152:155],v[76:79],v[32:35]
ds_read_b128 v[100:103],v7 offset:1024
v_mfma_f32_16x16x32_bf16 v[36:39],a[156:159],v[76:79],v[36:39]
s_waitcnt lgkmcnt(5)
buffer_load_dwordx4 v[148:151],v0,s[20:23],s85 offen offset:1024 sc1
v_mfma_f32_16x16x32_bf16 v[32:35],a[160:163],v[80:83],v[32:35]
ds_read_b128 v[104:107],v7 offset:2048
v_mfma_f32_16x16x32_bf16 v[36:39],a[164:167],v[80:83],v[36:39]
s_waitcnt lgkmcnt(5)
buffer_load_dword v16,v2,s[20:23],s68 offen sc1
v_mfma_f32_16x16x32_bf16 v[32:35],a[168:171],v[84:87],v[32:35]
ds_read_b128 v[108:111],v7 offset:3072
v_mfma_f32_16x16x32_bf16 v[36:39],a[172:175],v[84:87],v[36:39]
s_waitcnt lgkmcnt(5)
v_mfma_f32_16x16x32_bf16 v[32:35],a[176:179],v[88:91],v[32:35]
ds_read_b128 v[112:115],v7 offset:4096
v_mfma_f32_16x16x32_bf16 v[36:39],a[180:183],v[88:91],v[36:39]
s_waitcnt lgkmcnt(5)
v_mfma_f32_16x16x32_bf16 v[32:35],a[184:187],v[92:95],v[32:35]
ds_read_b128 v[116:119],v7 offset:5120
v_mfma_f32_16x16x32_bf16 v[36:39],a[188:191],v[92:95],v[36:39]
s_waitcnt lgkmcnt(5)
v_mfma_f32_16x16x32_bf16 v[32:35],a[192:195],v[96:99],v[32:35]
ds_read_b128 v[120:123],v7 offset:6144
v_mfma_f32_16x16x32_bf16 v[36:39],a[196:199],v[96:99],v[36:39]
s_waitcnt lgkmcnt(5)
v_mfma_f32_16x16x32_bf16 v[32:35],a[200:203],v[100:103],v[32:35]
s_waitcnt vmcnt(1)
ds_read_b128 v[124:127],v7 offset:7168
v_mov_b32 v17,s63
s_mov_b64 exec,1
buffer_store_dword v17,off,s[20:23],s69 sc1
s_mov_b64 exec,-1
s_cmp_eq_u32 s77,0
s_cbranch_scc1 go_158
ck_156:
v_max3_u32 v184,v128,v129,v130
v_max3_u32 v185,v140,v141,v142
v_max3_u32 v184,v184,v131,v132
v_max3_u32 v185,v185,v143,v144
v_max3_u32 v184,v184,v133,v134
v_max3_u32 v185,v185,v145,v146
v_max3_u32 v184,v184,v135,v136
v_max3_u32 v185,v185,v147,v148
v_max3_u32 v184,v184,v137,v138
v_max3_u32 v185,v185,v149,v150
v_max3_u32 v184,v184,v139,v151
v_max_u32 v184,v184,v185
v_cmp_eq_u32 vcc,-1,v184
s_cbranch_vccnz rt_157
go_158:
v_mfma_f32_16x16x32_bf16 v[36:39],a[204:207],v[100:103],v[36:39]
s_waitcnt lgkmcnt(5)
s_add_u32 s55,s55,32768
s_and_b32 s55,s55,0x1ffff
v_add_f32 v128,v128,v136
v_mfma_f32_16x16x32_bf16 v[32:35],a[208:211],v[104:107],v[32:35]
v_add_u32 v4,s55,v8
v_add_u32 v5,s55,v9
v_add_f32 v129,v129,v137
v_mfma_f32_16x16x32_bf16 v[36:39],a[212:215],v[104:107],v[36:39]
s_waitcnt lgkmcnt(4)
v_add_u32 v6,s55,v10
v_add_u32 v7,s55,v11
v_add_f32 v130,v130,v138
v_mfma_f32_16x16x32_bf16 v[32:35],a[216:219],v[108:111],v[32:35]
v_add_f32 v131,v131,v139
v_add_f32 v132,v132,v140
v_add_f32 v133,v133,v141
v_mfma_f32_16x16x32_bf16 v[36:39],a[220:223],v[108:111],v[36:39]
s_waitcnt lgkmcnt(3)
v_add_f32 v134,v134,v142
v_add_f32 v135,v135,v143
v_add_f32 v128,v128,v144
v_mfma_f32_16x16x32_bf16 v[32:35],a[224:227],v[112:115],v[32:35]
v_add_f32 v129,v129,v145
v_add_f32 v130,v130,v146
v_add_f32 v131,v131,v147
v_mfma_f32_16x16x32_bf16 v[36:39],a[228:231],v[112:115],v[36:39]
s_waitcnt lgkmcnt(2)
v_add_f32 v132,v132,v148
v_add_f32 v133,v133,v149
v_add_f32 v134,v134,v150
v_mfma_f32_16x16x32_bf16 v[32:35],a[232:235],v[116:119],v[32:35]
v_add_f32 v135,v135,v151
v_fma_f32 v168,v128,v152,v168
v_fma_f32 v169,v129,v153,v169
v_mfma_f32_16x16x32_bf16 v[36:39],a[236:239],v[116:119],v[36:39]
s_waitcnt lgkmcnt(1)
v_fma_f32 v170,v130,v154,v170
v_fma_f32 v171,v131,v155,v171
v_fma_f32 v172,v132,v156,v172
v_mfma_f32_16x16x32_bf16 v[32:35],a[240:243],v[120:123],v[32:35]
v_fma_f32 v173,v133,v157,v173
v_fma_f32 v174,v134,v158,v174
v_fma_f32 v175,v135,v159,v175
v_mfma_f32_16x16x32_bf16 v[36:39],a[244:247],v[120:123],v[36:39]
s_waitcnt lgkmcnt(0)
v_cvt_pk_bf16_f32 v176,v168,v169
v_cvt_pk_bf16_f32 v177,v170,v171
v_cvt_pk_bf16_f32 v178,v172,v173
v_mfma_f32_16x16x32_bf16 v[40:43],a[248:251],v[124:127],v[32:35]
v_cvt_pk_bf16_f32 v179,v174,v175
v_mfma_f32_16x16x32_bf16 v[44:47],a[252:255],v[124:127],v[36:39]
s_waitcnt vmcnt(1)
s_add_u32 s64,s66,201326592
buffer_store_dwordx4 v[176:179],v21,s[20:23],s64 offen sc1
s_cmp_eq_u32 s56,1
s_cbranch_scc1 b1_150
buffer_store_dwordx4 v[204:207],v21,s[20:23],s84 offen offset:0
buffer_store_dwordx4 v[204:207],v21,s[20:23],s84 offen offset:1024
b2_151:
s_cmp_eq_u32 s56,1
s_cbranch_scc1 b1_152
buffer_store_dwordx4 v[204:207],v21,s[20:23],s84 offen offset:2048
buffer_store_dwordx4 v[204:207],v21,s[20:23],s84 offen offset:3072
b2_153:
s_cmp_eq_u32 s56,1
s_cbranch_scc1 b1_154
buffer_store_dwordx4 v[204:207],v21,s[20:23],s85 offen offset:0
buffer_store_dwordx4 v[204:207],v21,s[20:23],s85 offen offset:1024
b2_155:
s_mul_i32 s64,s77,32768
s_add_u32 s66,s66,s64
s_mul_i32 s64,s77,6144
s_add_u32 s75,s75,s64
s_cmp_eq_u32 s75,24576
s_cselect_b32 s75,0,s75
s_add_u32 s63,s63,s77
s_mov_b32 s77,0
v_cmp_gt_u32 vcc,s71,v16
s_add_u32 s60,s60,1
endN_140:
s_cbranch_vccnz nb_119
s_mov_b32 m0,s70
s_nop 0
buffer_load_dwordx4 v3,s[20:23],s61 offen offset:0 lds
buffer_load_dwordx4 v3,s[20:23],s61 offen offset:1024 lds
buffer_load_dwordx4 v3,s[20:23],s61 offen offset:2048 lds
buffer_load_dwordx4 v3,s[20:23],s61 offen offset:3072 lds
s_add_u32 m0,s70,4096
s_nop 0
buffer_load_dwordx4 v3,s[20:23],s62 offen offset:0 lds
buffer_load_dwordx4 v3,s[20:23],s62 offen offset:1024 lds
buffer_load_dwordx4 v3,s[20:23],s62 offen offset:2048 lds
buffer_load_dwordx4 v3,s[20:23],s62 offen offset:3072 lds
s_add_u32 s61,s61,131072
s_add_u32 s62,s62,131072
s_add_u32 s70,s70,32768
s_and_b32 s70,s70,0x1ffff
v_mov_b32 v212,v40
v_mov_b32 v213,v41
v_mov_b32 v214,v42
v_mov_b32 v215,v43
v_mov_b32 v216,v44
v_mov_b32 v217,v45
v_mov_b32 v218,v46
v_mov_b32 v219,v47
s_mov_b32 s77,1
s_branch dec_118
nb_119:
s_nop 3
s_mov_b32 s77,1
s_add_u32 s84,s74,s75
s_add_u32 s85,s84,4096
buffer_load_dwordx4 v[128:131],v0,s[20:23],s84 offen offset:0 sc1
buffer_load_dwordx4 v[132:135],v0,s[20:23],s84 offen offset:1024 sc1
buffer_load_dwordx4 v[136:139],v0,s[20:23],s84 offen offset:2048 sc1
buffer_load_dwordx4 v[140:143],v0,s[20:23],s84 offen offset:3072 sc1
buffer_load_dwordx4 v[144:147],v0,s[20:23],s85 offen offset:0 sc1
buffer_load_dwordx4 v[148:151],v0,s[20:23],s85 offen offset:1024 sc1
s_cmp_eq_u32 s77,0
s_cselect_b32 s57,2.0,0
v_or_b32 v21,s57,v0
v_lshlrev_b32 v168,16,v160
v_and_b32 v169,s73,v160
v_lshlrev_b32 v170,16,v161
v_and_b32 v171,s73,v161
v_lshlrev_b32 v172,16,v162
v_and_b32 v173,s73,v162
v_lshlrev_b32 v174,16,v163
v_and_b32 v175,s73,v163
v_pk_fma_f32 v[168:169],v[40:41],v[152:153],v[168:169]
v_pk_fma_f32 v[170:171],v[42:43],v[154:155],v[170:171]
v_pk_fma_f32 v[172:173],v[44:45],v[156:157],v[172:173]
v_pk_fma_f32 v[174:175],v[46:47],v[158:159],v[174:175]
s_waitcnt vmcnt(0)
v_mov_b32 v17,s63
s_mov_b64 exec,1
buffer_store_dword v17,off,s[20:23],s69 sc1
s_mov_b64 exec,-1
s_cmp_eq_u32 s77,0
s_cbranch_scc1 go_167
ck_165:
v_max3_u32 v184,v128,v129,v130
v_max3_u32 v185,v140,v141,v142
v_max3_u32 v184,v184,v131,v132
v_max3_u32 v185,v185,v143,v144
v_max3_u32 v184,v184,v133,v134
v_max3_u32 v185,v185,v145,v146
v_max3_u32 v184,v184,v135,v136
v_max3_u32 v185,v185,v147,v148
v_max3_u32 v184,v184,v137,v138
v_max3_u32 v185,v185,v149,v150
v_max3_u32 v184,v184,v139,v151
v_max_u32 v184,v184,v185
v_cmp_eq_u32 vcc,-1,v184
s_cbranch_vccnz rt_166
go_167:
buffer_load_dword v16,v2,s[20:23],s68 offen sc1
v_pk_add_f32 v[128:129],v[128:129],v[136:137]
v_pk_add_f32 v[130:131],v[130:131],v[138:139]
v_pk_add_f32 v[132:133],v[132:133],v[140:141]
v_pk_add_f32 v[134:135],v[134:135],v[142:143]
v_pk_add_f32 v[128:129],v[128:129],v[144:145]
v_pk_add_f32 v[130:131],v[130:131],v[146:147]
v_pk_add_f32 v[132:133],v[132:133],v[148:149]
v_pk_add_f32 v[134:135],v[134:135],v[150:151]
v_pk_fma_f32 v[168:169],v[128:129],v[152:153],v[168:169]
v_pk_fma_f32 v[170:171],v[130:131],v[154:155],v[170:171]
v_pk_fma_f32 v[172:173],v[132:133],v[156:157],v[172:173]
v_pk_fma_f32 v[174:175],v[134:135],v[158:159],v[174:175]
v_cvt_pk_bf16_f32 v176,v168,v169
v_cvt_pk_bf16_f32 v177,v170,v171
v_cvt_pk_bf16_f32 v178,v172,v173
v_cvt_pk_bf16_f32 v179,v174,v175
s_add_u32 s64,s66,201326592
buffer_store_dwordx4 v[176:179],v21,s[20:23],s64 offen sc1
s_cmp_eq_u32 s56,1
s_cbranch_scc1 b1_159
buffer_store_dwordx4 v[204:207],v21,s[20:23],s84 offen offset:0
buffer_store_dwordx4 v[204:207],v21,s[20:23],s84 offen offset:1024
b2_160:
s_cmp_eq_u32 s56,1
s_cbranch_scc1 b1_161
buffer_store_dwordx4 v[204:207],v21,s[20:23],s84 offen offset:2048
buffer_store_dwordx4 v[204:207],v21,s[20:23],s84 offen offset:3072
b2_162:
s_cmp_eq_u32 s56,1
s_cbranch_scc1 b1_163
buffer_store_dwordx4 v[204:207],v21,s[20:23],s85 offen offset:0
buffer_store_dwordx4 v[204:207],v21,s[20:23],s85 offen offset:1024
b2_164:
s_mul_i32 s64,s77,32768
s_add_u32 s66,s66,s64
s_mul_i32 s64,s77,6144
s_add_u32 s75,s75,s64
s_cmp_eq_u32 s75,24576
s_cselect_b32 s75,0,s75
s_add_u32 s63,s63,s77
s_mov_b32 s77,0
s_waitcnt vmcnt(6)
v_mov_b32 v17,s63
s_mov_b64 exec,1
buffer_store_dword v17,off,s[20:23],s69 sc1
s_mov_b64 exec,-1
v_cmp_gt_u32 vcc,s71,v16
s_cbranch_vccz lag_117
s_cmp_ge_u32 s60,128
s_cbranch_scc1 done_71
plp_168:
buffer_load_dword v16,v2,s[20:23],s68 offen sc1
s_waitcnt vmcnt(0)
v_cmp_gt_u32 vcc,s71,v16
s_cbranch_vccz pok_169
s_sleep 4
s_sub_u32 s90,s90,1
s_cmp_gt_i32 s90,0
s_cbranch_scc1 plp_168
pok_169:
s_branch lag_117
b1_90:
s_nop 7
buffer_store_dwordx4 v[40:43],v0,s[20:23],s64 offen offset:0 sc1
buffer_store_dwordx4 v[44:47],v0,s[20:23],s64 offen offset:1024 sc1
s_branch b2_91
b1_93:
s_nop 7
buffer_store_dwordx4 v[40:43],v0,s[20:23],s64 offen offset:0 sc1
buffer_store_dwordx4 v[44:47],v0,s[20:23],s64 offen offset:1024 sc1
s_branch b2_94
b1_95:
s_nop 7
buffer_store_dwordx4 v[40:43],v0,s[20:23],s64 offen offset:0 sc1
buffer_store_dwordx4 v[44:47],v0,s[20:23],s64 offen offset:1024 sc1
s_branch b2_96
b1_97:
s_nop 7
buffer_store_dwordx4 v[40:43],v0,s[20:23],s64 offen offset:0 sc1
buffer_store_dwordx4 v[44:47],v0,s[20:23],s64 offen offset:1024 sc1
s_branch b2_98
b1_122:
s_nop 7
buffer_store_dwordx4 v[204:207],v21,s[20:23],s84 offen offset:0 sc1
buffer_store_dwordx4 v[204:207],v21,s[20:23],s84 offen offset:1024 sc1
s_branch b2_123
b1_124:
s_nop 7
buffer_store_dwordx4 v[204:207],v21,s[20:23],s84 offen offset:2048 sc1
buffer_store_dwordx4 v[204:207],v21,s[20:23],s84 offen offset:3072 sc1
s_branch b2_125
b1_126:
s_nop 7
buffer_store_dwordx4 v[204:207],v21,s[20:23],s85 offen offset:0 sc1
buffer_store_dwordx4 v[204:207],v21,s[20:23],s85 offen offset:1024 sc1
s_branch b2_127
rt_129:
s_sub_u32 s90,s90,1
s_cmp_gt_i32 s90,0
s_cbranch_scc0 go_130
s_add_u32 s84,s74,s75
s_add_u32 s85,s84,4096
buffer_load_dwordx4 v[128:131],v0,s[20:23],s84 offen offset:0 sc1
buffer_load_dwordx4 v[132:135],v0,s[20:23],s84 offen offset:1024 sc1
buffer_load_dwordx4 v[136:139],v0,s[20:23],s84 offen offset:2048 sc1
buffer_load_dwordx4 v[140:143],v0,s[20:23],s84 offen offset:3072 sc1
buffer_load_dwordx4 v[144:147],v0,s[20:23],s85 offen offset:0 sc1
buffer_load_dwordx4 v[148:151],v0,s[20:23],s85 offen offset:1024 sc1
s_waitcnt vmcnt(0)
s_branch ck_128
b1_131:
s_nop 7
buffer_store_dwordx4 v[204:207],v21,s[20:23],s84 offen offset:0 sc1
buffer_store_dwordx4 v[204:207],v21,s[20:23],s84 offen offset:1024 sc1
s_branch b2_132
b1_133:
s_nop 7
buffer_store_dwordx4 v[204:207],v21,s[20:23],s84 offen offset:2048 sc1
buffer_store_dwordx4 v[204:207],v21,s[20:23],s84 offen offset:3072 sc1
s_branch b2_134
b1_135:
s_nop 7
buffer_store_dwordx4 v[204:207],v21,s[20:23],s85 offen offset:0 sc1
buffer_store_dwordx4 v[204:207],v21,s[20:23],s85 offen offset:1024 sc1
s_branch b2_136
rt_138:
s_sub_u32 s90,s90,1
s_cmp_gt_i32 s90,0
s_cbranch_scc0 go_139
s_add_u32 s84,s74,s75
s_add_u32 s85,s84,4096
buffer_load_dwordx4 v[128:131],v0,s[20:23],s84 offen offset:0 sc1
buffer_load_dwordx4 v[132:135],v0,s[20:23],s84 offen offset:1024 sc1
buffer_load_dwordx4 v[136:139],v0,s[20:23],s84 offen offset:2048 sc1
buffer_load_dwordx4 v[140:143],v0,s[20:23],s84 offen offset:3072 sc1
buffer_load_dwordx4 v[144:147],v0,s[20:23],s85 offen offset:0 sc1
buffer_load_dwordx4 v[148:151],v0,s[20:23],s85 offen offset:1024 sc1
s_waitcnt vmcnt(0)
s_branch ck_137
b1_141:
s_nop 7
buffer_store_dwordx4 v[204:207],v21,s[20:23],s84 offen offset:0 sc1
buffer_store_dwordx4 v[204:207],v21,s[20:23],s84 offen offset:1024 sc1
s_branch b2_142
b1_143:
s_nop 7
buffer_store_dwordx4 v[204:207],v21,s[20:23],s84 offen offset:2048 sc1
buffer_store_dwordx4 v[204:207],v21,s[20:23],s84 offen offset:3072 sc1
s_branch b2_144
b1_145:
s_nop 7
buffer_store_dwordx4 v[204:207],v21,s[20:23],s85 offen offset:0 sc1
buffer_store_dwordx4 v[204:207],v21,s[20:23],s85 offen offset:1024 sc1
s_branch b2_146
rt_148:
s_sub_u32 s90,s90,1
s_cmp_gt_i32 s90,0
s_cbranch_scc0 go_149
s_add_u32 s84,s74,s75
s_add_u32 s85,s84,4096
buffer_load_dwordx4 v[128:131],v0,s[20:23],s84 offen offset:0 sc1
buffer_load_dwordx4 v[132:135],v0,s[20:23],s84 offen offset:1024 sc1
buffer_load_dwordx4 v[136:139],v0,s[20:23],s84 offen offset:2048 sc1
buffer_load_dwordx4 v[140:143],v0,s[20:23],s84 offen offset:3072 sc1
buffer_load_dwordx4 v[144:147],v0,s[20:23],s85 offen offset:0 sc1
buffer_load_dwordx4 v[148:151],v0,s[20:23],s85 offen offset:1024 sc1
s_waitcnt vmcnt(0)
s_branch ck_147
b1_150:
s_nop 7
buffer_store_dwordx4 v[204:207],v21,s[20:23],s84 offen offset:0 sc1
buffer_store_dwordx4 v[204:207],v21,s[20:23],s84 offen offset:1024 sc1
s_branch b2_151
b1_152:
s_nop 7
buffer_store_dwordx4 v[204:207],v21,s[20:23],s84 offen offset:2048 sc1
buffer_store_dwordx4 v[204:207],v21,s[20:23],s84 offen offset:3072 sc1
s_branch b2_153
b1_154:
s_nop 7
buffer_store_dwordx4 v[204:207],v21,s[20:23],s85 offen offset:0 sc1
buffer_store_dwordx4 v[204:207],v21,s[20:23],s85 offen offset:1024 sc1
s_branch b2_155
rt_157:
s_sub_u32 s90,s90,1
s_cmp_gt_i32 s90,0
s_cbranch_scc0 go_158
s_add_u32 s84,s74,s75
s_add_u32 s85,s84,4096
buffer_load_dwordx4 v[128:131],v0,s[20:23],s84 offen offset:0 sc1
buffer_load_dwordx4 v[132:135],v0,s[20:23],s84 offen offset:1024 sc1
buffer_load_dwordx4 v[136:139],v0,s[20:23],s84 offen offset:2048 sc1
buffer_load_dwordx4 v[140:143],v0,s[20:23],s84 offen offset:3072 sc1
buffer_load_dwordx4 v[144:147],v0,s[20:23],s85 offen offset:0 sc1
buffer_load_dwordx4 v[148:151],v0,s[20:23],s85 offen offset:1024 sc1
s_waitcnt vmcnt(0)
s_branch ck_156
b1_159:
s_nop 7
buffer_store_dwordx4 v[204:207],v21,s[20:23],s84 offen offset:0 sc1
buffer_store_dwordx4 v[204:207],v21,s[20:23],s84 offen offset:1024 sc1
s_branch b2_160
b1_161:
s_nop 7
buffer_store_dwordx4 v[204:207],v21,s[20:23],s84 offen offset:2048 sc1
buffer_store_dwordx4 v[204:207],v21,s[20:23],s84 offen offset:3072 sc1
s_branch b2_162
b1_163:
s_nop 7
buffer_store_dwordx4 v[204:207],v21,s[20:23],s85 offen offset:0 sc1
buffer_store_dwordx4 v[204:207],v21,s[20:23],s85 offen offset:1024 sc1
s_branch b2_164
rt_166:
s_sub_u32 s90,s90,1
s_cmp_gt_i32 s90,0
s_cbranch_scc0 go_167
s_add_u32 s84,s74,s75
s_add_u32 s85,s84,4096
buffer_load_dwordx4 v[128:131],v0,s[20:23],s84 offen offset:0 sc1
buffer_load_dwordx4 v[132:135],v0,s[20:23],s84 offen offset:1024 sc1
buffer_load_dwordx4 v[136:139],v0,s[20:23],s84 offen offset:2048 sc1
buffer_load_dwordx4 v[140:143],v0,s[20:23],s84 offen offset:3072 sc1
buffer_load_dwordx4 v[144:147],v0,s[20:23],s85 offen offset:0 sc1
buffer_load_dwordx4 v[148:151],v0,s[20:23],s85 offen offset:1024 sc1
s_waitcnt vmcnt(0)
s_branch ck_165
done_71:
s_endpgm
fl_w4:
v_and_b32 v21,15,v1
v_lshrrev_b32 v22,4,v1
v_lshrrev_b32 v23,2,v21
v_and_b32 v24,3,v21
s_lshl_b32 s61,s50,15
v_lshl_add_u32 v25,v22,3,v23
s_load_dwordx2 s[4:5],s[0:1],88
s_load_dwordx2 s[6:7],s[0:1],112
s_lshr_b32 s52,s59,3
s_and_b32 s53,s59,7
s_mul_i32 s54,s52,1835008
s_lshl_b32 s64,s53,8
s_add_u32 s54,s54,s64
s_lshl_b32 s64,s50,6
s_add_u32 s54,s54,s64
s_waitcnt lgkmcnt(0)
s_mov_b32 s28,s4
s_and_b32 s29,s5,0xffff
s_mov_b32 s30,0x700000
s_mov_b32 s31,0x20000
s_mov_b32 s24,s6
s_and_b32 s25,s7,0xffff
s_mov_b32 s26,0x400000
s_mov_b32 s27,0x20000
s_mov_b32 s92,s2
s_and_b32 s93,s3,0xffff
s_mov_b32 s94,0x100
s_mov_b32 s95,0x20000
v_mbcnt_lo_u32_b32 v16,-1,0
v_mbcnt_hi_u32_b32 v16,-1,v16
v_mov_b32 v18,0
v_cmp_eq_u32 vcc,17,v16
s_nop 1
v_cndmask_b32 v18,v18,63,vcc
v_and_b32 v19,1,v16
v_cmp_eq_u32 vcc,1,v19
v_mov_b32 v19,8192
s_nop 0
v_cndmask_b32 v19,-1,v19,vcc
v_min_u32 v16,31,v16
v_lshlrev_b32 v16,2,v16
s_sub_u32 s66,s88,64
s_cmp_lg_u32 s50,0
s_cbranch_scc1 vot_175
vpoll_171:
buffer_load_dword v17,v16,s[92:95],s66 offen sc1
s_waitcnt vmcnt(0)
s_cmp_lg_u32 s56,2
s_cbranch_scc1 vck_172
v_cmp_eq_u32 vcc,v17,v19
s_and_b32 s64,vcc_lo,0xffff
s_cmp_eq_u32 s64,65535
s_cbranch_scc1 vck_172
s_mov_b32 s65,0
v_readlane_b32 s64,v17,1
s_lshr_b32 s64,s64,8
s_add_u32 s65,s65,s64
v_readlane_b32 s64,v17,3
s_lshr_b32 s64,s64,8
s_add_u32 s65,s65,s64
v_readlane_b32 s64,v17,5
s_lshr_b32 s64,s64,8
s_add_u32 s65,s65,s64
v_readlane_b32 s64,v17,7
s_lshr_b32 s64,s64,8
s_add_u32 s65,s65,s64
v_readlane_b32 s64,v17,9
s_lshr_b32 s64,s64,8
s_add_u32 s65,s65,s64
v_readlane_b32 s64,v17,11
s_lshr_b32 s64,s64,8
s_add_u32 s65,s65,s64
v_readlane_b32 s64,v17,13
s_lshr_b32 s64,s64,8
s_add_u32 s65,s65,s64
v_readlane_b32 s64,v17,15
s_lshr_b32 s64,s64,8
s_add_u32 s65,s65,s64
s_cmp_ge_u32 s65,256
s_cbranch_scc1 vok_174
s_branch vrt_173
vck_172:
v_cmp_gt_u32 vcc,v18,v17
s_cbranch_vccz vok_174
vrt_173:
s_sleep 48
s_sub_u32 s90,s90,1
s_cmp_gt_i32 s90,0
s_cbranch_scc1 vpoll_171
vok_174:
v_add_u32 v18,159744,v16
ds_write_b32 v18,v17
s_waitcnt lgkmcnt(0)
vot_175:
s_barrier
v_add_u32 v18,159744,v16
ds_read_b32 v17,v18
s_waitcnt lgkmcnt(0)
s_cmp_lg_u32 s56,2
s_cbranch_scc1 vfin_176
v_cmp_eq_u32 vcc,v17,v19
s_and_b32 s64,vcc_lo,0xffff
s_cmp_eq_u32 s64,65535
s_cbranch_scc1 vfin_176
s_mov_b32 s65,0
v_readlane_b32 s64,v17,1
s_lshr_b32 s64,s64,8
s_add_u32 s65,s65,s64
v_readlane_b32 s64,v17,3
s_lshr_b32 s64,s64,8
s_add_u32 s65,s65,s64
v_readlane_b32 s64,v17,5
s_lshr_b32 s64,s64,8
s_add_u32 s65,s65,s64
v_readlane_b32 s64,v17,7
s_lshr_b32 s64,s64,8
s_add_u32 s65,s65,s64
v_readlane_b32 s64,v17,9
s_lshr_b32 s64,s64,8
s_add_u32 s65,s65,s64
v_readlane_b32 s64,v17,11
s_lshr_b32 s64,s64,8
s_add_u32 s65,s65,s64
v_readlane_b32 s64,v17,13
s_lshr_b32 s64,s64,8
s_add_u32 s65,s65,s64
v_readlane_b32 s64,v17,15
s_lshr_b32 s64,s64,8
s_add_u32 s65,s65,s64
s_cmp_ge_u32 s65,256
s_cbranch_scc1 fl_fb
vfin_176:
s_and_b32 s56,s56,1
v_lshrrev_b32 v26,2,v1
v_and_b32 v27,3,v1
v_mul_u32_u24 v16,2048,v26
v_lshl_add_u32 v16,v27,4,v16
v_lshlrev_b32 v17,6,v25
v_lshl_add_u32 v17,v24,4,v17
v_add_u32 v17,s61,v17
s_xor_b32 s62,s50,0
s_mul_i32 s62,s62,458752
s_add_u32 s62,s62,s54
s_add_u32 m0,s61,0
s_nop 0
buffer_load_dwordx4 v16,s[28:31],s62 offen lds
s_add_u32 s62,s62,32768
s_add_u32 m0,m0,1024
s_waitcnt vmcnt(6)
buffer_load_dwordx4 v16,s[28:31],s62 offen lds
s_add_u32 s62,s62,32768
s_add_u32 m0,m0,1024
s_waitcnt vmcnt(6)
buffer_load_dwordx4 v16,s[28:31],s62 offen lds
s_add_u32 s62,s62,32768
s_add_u32 m0,m0,1024
s_waitcnt vmcnt(6)
buffer_load_dwordx4 v16,s[28:31],s62 offen lds
s_add_u32 s62,s62,32768
s_add_u32 m0,m0,1024
s_waitcnt vmcnt(6)
buffer_load_dwordx4 v16,s[28:31],s62 offen lds
s_add_u32 s62,s62,32768
s_add_u32 m0,m0,1024
s_waitcnt vmcnt(6)
buffer_load_dwordx4 v16,s[28:31],s62 offen lds
s_add_u32 s62,s62,32768
s_add_u32 m0,m0,1024
s_waitcnt vmcnt(6)
buffer_load_dwordx4 v16,s[28:31],s62 offen lds
s_add_u32 s62,s62,32768
s_add_u32 m0,m0,1024
s_waitcnt vmcnt(6)
buffer_load_dwordx4 v16,s[28:31],s62 offen lds
s_add_u32 s62,s62,32768
s_add_u32 m0,m0,1024
s_waitcnt vmcnt(6)
buffer_load_dwordx4 v16,s[28:31],s62 offen lds
s_add_u32 s62,s62,32768
s_add_u32 m0,m0,1024
s_waitcnt vmcnt(6)
buffer_load_dwordx4 v16,s[28:31],s62 offen lds
s_add_u32 s62,s62,32768
s_add_u32 m0,m0,1024
s_waitcnt vmcnt(6)
buffer_load_dwordx4 v16,s[28:31],s62 offen lds
s_add_u32 s62,s62,32768
s_add_u32 m0,m0,1024
s_waitcnt vmcnt(6)
buffer_load_dwordx4 v16,s[28:31],s62 offen lds
s_add_u32 s62,s62,32768
s_add_u32 m0,m0,1024
s_waitcnt vmcnt(6)
buffer_load_dwordx4 v16,s[28:31],s62 offen lds
s_add_u32 s62,s62,32768
s_add_u32 m0,m0,1024
s_waitcnt vmcnt(6)
buffer_load_dwordx4 v16,s[28:31],s62 offen lds
s_waitcnt vmcnt(6)
s_xor_b32 s62,s50,1
s_mul_i32 s62,s62,458752
s_add_u32 s62,s62,s54
s_add_u32 m0,s61,16384
s_nop 0
buffer_load_dwordx4 v16,s[28:31],s62 offen lds
s_add_u32 s62,s62,32768
s_add_u32 m0,m0,1024
s_waitcnt vmcnt(6)
buffer_load_dwordx4 v16,s[28:31],s62 offen lds
s_add_u32 s62,s62,32768
s_add_u32 m0,m0,1024
s_waitcnt vmcnt(6)
buffer_load_dwordx4 v16,s[28:31],s62 offen lds
s_add_u32 s62,s62,32768
s_add_u32 m0,m0,1024
s_waitcnt vmcnt(6)
buffer_load_dwordx4 v16,s[28:31],s62 offen lds
s_add_u32 s62,s62,32768
s_add_u32 m0,m0,1024
s_waitcnt vmcnt(6)
buffer_load_dwordx4 v16,s[28:31],s62 offen lds
s_add_u32 s62,s62,32768
s_add_u32 m0,m0,1024
s_waitcnt vmcnt(6)
buffer_load_dwordx4 v16,s[28:31],s62 offen lds
s_add_u32 s62,s62,32768
s_add_u32 m0,m0,1024
s_waitcnt vmcnt(6)
buffer_load_dwordx4 v16,s[28:31],s62 offen lds
s_add_u32 s62,s62,32768
s_add_u32 m0,m0,1024
s_waitcnt vmcnt(6)
buffer_load_dwordx4 v16,s[28:31],s62 offen lds
s_add_u32 s62,s62,32768
s_add_u32 m0,m0,1024
s_waitcnt vmcnt(6)
buffer_load_dwordx4 v16,s[28:31],s62 offen lds
s_add_u32 s62,s62,32768
s_add_u32 m0,m0,1024
s_waitcnt vmcnt(6)
buffer_load_dwordx4 v16,s[28:31],s62 offen lds
s_add_u32 s62,s62,32768
s_add_u32 m0,m0,1024
s_waitcnt vmcnt(6)
buffer_load_dwordx4 v16,s[28:31],s62 offen lds
s_add_u32 s62,s62,32768
s_add_u32 m0,m0,1024
s_waitcnt vmcnt(6)
buffer_load_dwordx4 v16,s[28:31],s62 offen lds
s_add_u32 s62,s62,32768
s_add_u32 m0,m0,1024
s_waitcnt vmcnt(6)
buffer_load_dwordx4 v16,s[28:31],s62 offen lds
s_add_u32 s62,s62,32768
s_add_u32 m0,m0,1024
s_waitcnt vmcnt(6)
buffer_load_dwordx4 v16,s[28:31],s62 offen lds
s_waitcnt vmcnt(6)
s_waitcnt vmcnt(14)
ds_read_b64_tr_b16 a[0:1],v17 offset:0
ds_read_b64_tr_b16 a[2:3],v17 offset:256
ds_read_b64_tr_b16 a[4:5],v17 offset:8
ds_read_b64_tr_b16 a[6:7],v17 offset:264
ds_read_b64_tr_b16 a[8:9],v17 offset:2048
ds_read_b64_tr_b16 a[10:11],v17 offset:2304
ds_read_b64_tr_b16 a[12:13],v17 offset:2056
ds_read_b64_tr_b16 a[14:15],v17 offset:2312
ds_read_b64_tr_b16 a[16:17],v17 offset:4096
ds_read_b64_tr_b16 a[18:19],v17 offset:4352
ds_read_b64_tr_b16 a[20:21],v17 offset:4104
ds_read_b64_tr_b16 a[22:23],v17 offset:4360
s_waitcnt lgkmcnt(0)
ds_read_b64_tr_b16 a[24:25],v17 offset:6144
ds_read_b64_tr_b16 a[26:27],v17 offset:6400
ds_read_b64_tr_b16 a[28:29],v17 offset:6152
ds_read_b64_tr_b16 a[30:31],v17 offset:6408
ds_read_b64_tr_b16 a[32:33],v17 offset:8192
ds_read_b64_tr_b16 a[34:35],v17 offset:8448
ds_read_b64_tr_b16 a[36:37],v17 offset:8200
ds_read_b64_tr_b16 a[38:39],v17 offset:8456
ds_read_b64_tr_b16 a[40:41],v17 offset:10240
ds_read_b64_tr_b16 a[42:43],v17 offset:10496
ds_read_b64_tr_b16 a[44:45],v17 offset:10248
ds_read_b64_tr_b16 a[46:47],v17 offset:10504
s_waitcnt lgkmcnt(0)
ds_read_b64_tr_b16 a[48:49],v17 offset:12288
ds_read_b64_tr_b16 a[50:51],v17 offset:12544
ds_read_b64_tr_b16 a[52:53],v17 offset:12296
ds_read_b64_tr_b16 a[54:55],v17 offset:12552
s_waitcnt lgkmcnt(0)
s_xor_b32 s62,s50,2
s_mul_i32 s62,s62,458752
s_add_u32 s62,s62,s54
s_add_u32 m0,s61,0
s_nop 0
buffer_load_dwordx4 v16,s[28:31],s62 offen lds
s_add_u32 s62,s62,32768
s_add_u32 m0,m0,1024
s_waitcnt vmcnt(6)
buffer_load_dwordx4 v16,s[28:31],s62 offen lds
s_add_u32 s62,s62,32768
s_add_u32 m0,m0,1024
s_waitcnt vmcnt(6)
buffer_load_dwordx4 v16,s[28:31],s62 offen lds
s_add_u32 s62,s62,32768
s_add_u32 m0,m0,1024
s_waitcnt vmcnt(6)
buffer_load_dwordx4 v16,s[28:31],s62 offen lds
s_add_u32 s62,s62,32768
s_add_u32 m0,m0,1024
s_waitcnt vmcnt(6)
buffer_load_dwordx4 v16,s[28:31],s62 offen lds
s_add_u32 s62,s62,32768
s_add_u32 m0,m0,1024
s_waitcnt vmcnt(6)
buffer_load_dwordx4 v16,s[28:31],s62 offen lds
s_add_u32 s62,s62,32768
s_add_u32 m0,m0,1024
s_waitcnt vmcnt(6)
buffer_load_dwordx4 v16,s[28:31],s62 offen lds
s_add_u32 s62,s62,32768
s_add_u32 m0,m0,1024
s_waitcnt vmcnt(6)
buffer_load_dwordx4 v16,s[28:31],s62 offen lds
s_add_u32 s62,s62,32768
s_add_u32 m0,m0,1024
s_waitcnt vmcnt(6)
buffer_load_dwordx4 v16,s[28:31],s62 offen lds
s_add_u32 s62,s62,32768
s_add_u32 m0,m0,1024
s_waitcnt vmcnt(6)
buffer_load_dwordx4 v16,s[28:31],s62 offen lds
s_add_u32 s62,s62,32768
s_add_u32 m0,m0,1024
s_waitcnt vmcnt(6)
buffer_load_dwordx4 v16,s[28:31],s62 offen lds
s_add_u32 s62,s62,32768
s_add_u32 m0,m0,1024
s_waitcnt vmcnt(6)
buffer_load_dwordx4 v16,s[28:31],s62 offen lds
s_add_u32 s62,s62,32768
s_add_u32 m0,m0,1024
s_waitcnt vmcnt(6)
buffer_load_dwordx4 v16,s[28:31],s62 offen lds
s_add_u32 s62,s62,32768
s_add_u32 m0,m0,1024
s_waitcnt vmcnt(6)
buffer_load_dwordx4 v16,s[28:31],s62 offen lds
s_waitcnt vmcnt(6)
s_waitcnt vmcnt(14)
ds_read_b64_tr_b16 a[56:57],v17 offset:16384
ds_read_b64_tr_b16 a[58:59],v17 offset:16640
ds_read_b64_tr_b16 a[60:61],v17 offset:16392
ds_read_b64_tr_b16 a[62:63],v17 offset:16648
ds_read_b64_tr_b16 a[64:65],v17 offset:18432
ds_read_b64_tr_b16 a[66:67],v17 offset:18688
ds_read_b64_tr_b16 a[68:69],v17 offset:18440
ds_read_b64_tr_b16 a[70:71],v17 offset:18696
ds_read_b64_tr_b16 a[72:73],v17 offset:20480
ds_read_b64_tr_b16 a[74:75],v17 offset:20736
ds_read_b64_tr_b16 a[76:77],v17 offset:20488
ds_read_b64_tr_b16 a[78:79],v17 offset:20744
s_waitcnt lgkmcnt(0)
ds_read_b64_tr_b16 a[80:81],v17 offset:22528
ds_read_b64_tr_b16 a[82:83],v17 offset:22784
ds_read_b64_tr_b16 a[84:85],v17 offset:22536
ds_read_b64_tr_b16 a[86:87],v17 offset:22792
ds_read_b64_tr_b16 a[88:89],v17 offset:24576
ds_read_b64_tr_b16 a[90:91],v17 offset:24832
ds_read_b64_tr_b16 a[92:93],v17 offset:24584
ds_read_b64_tr_b16 a[94:95],v17 offset:24840
ds_read_b64_tr_b16 a[96:97],v17 offset:26624
ds_read_b64_tr_b16 a[98:99],v17 offset:26880
ds_read_b64_tr_b16 a[100:101],v17 offset:26632
ds_read_b64_tr_b16 a[102:103],v17 offset:26888
s_waitcnt lgkmcnt(0)
ds_read_b64_tr_b16 a[104:105],v17 offset:28672
ds_read_b64_tr_b16 a[106:107],v17 offset:28928
ds_read_b64_tr_b16 a[108:109],v17 offset:28680
ds_read_b64_tr_b16 a[110:111],v17 offset:28936
s_waitcnt lgkmcnt(0)
s_xor_b32 s62,s50,3
s_mul_i32 s62,s62,458752
s_add_u32 s62,s62,s54
s_add_u32 m0,s61,16384
s_nop 0
buffer_load_dwordx4 v16,s[28:31],s62 offen lds
s_add_u32 s62,s62,32768
s_add_u32 m0,m0,1024
s_waitcnt vmcnt(6)
buffer_load_dwordx4 v16,s[28:31],s62 offen lds
s_add_u32 s62,s62,32768
s_add_u32 m0,m0,1024
s_waitcnt vmcnt(6)
buffer_load_dwordx4 v16,s[28:31],s62 offen lds
s_add_u32 s62,s62,32768
s_add_u32 m0,m0,1024
s_waitcnt vmcnt(6)
buffer_load_dwordx4 v16,s[28:31],s62 offen lds
s_add_u32 s62,s62,32768
s_add_u32 m0,m0,1024
s_waitcnt vmcnt(6)
buffer_load_dwordx4 v16,s[28:31],s62 offen lds
s_add_u32 s62,s62,32768
s_add_u32 m0,m0,1024
s_waitcnt vmcnt(6)
buffer_load_dwordx4 v16,s[28:31],s62 offen lds
s_add_u32 s62,s62,32768
s_add_u32 m0,m0,1024
s_waitcnt vmcnt(6)
buffer_load_dwordx4 v16,s[28:31],s62 offen lds
s_add_u32 s62,s62,32768
s_add_u32 m0,m0,1024
s_waitcnt vmcnt(6)
buffer_load_dwordx4 v16,s[28:31],s62 offen lds
s_add_u32 s62,s62,32768
s_add_u32 m0,m0,1024
s_waitcnt vmcnt(6)
buffer_load_dwordx4 v16,s[28:31],s62 offen lds
s_add_u32 s62,s62,32768
s_add_u32 m0,m0,1024
s_waitcnt vmcnt(6)
buffer_load_dwordx4 v16,s[28:31],s62 offen lds
s_add_u32 s62,s62,32768
s_add_u32 m0,m0,1024
s_waitcnt vmcnt(6)
buffer_load_dwordx4 v16,s[28:31],s62 offen lds
s_add_u32 s62,s62,32768
s_add_u32 m0,m0,1024
s_waitcnt vmcnt(6)
buffer_load_dwordx4 v16,s[28:31],s62 offen lds
s_add_u32 s62,s62,32768
s_add_u32 m0,m0,1024
s_waitcnt vmcnt(6)
buffer_load_dwordx4 v16,s[28:31],s62 offen lds
s_add_u32 s62,s62,32768
s_add_u32 m0,m0,1024
s_waitcnt vmcnt(6)
buffer_load_dwordx4 v16,s[28:31],s62 offen lds
s_waitcnt vmcnt(6)
s_waitcnt vmcnt(14)
ds_read_b64_tr_b16 a[112:113],v17 offset:0
ds_read_b64_tr_b16 a[114:115],v17 offset:256
ds_read_b64_tr_b16 a[116:117],v17 offset:8
ds_read_b64_tr_b16 a[118:119],v17 offset:264
ds_read_b64_tr_b16 a[120:121],v17 offset:2048
ds_read_b64_tr_b16 a[122:123],v17 offset:2304
ds_read_b64_tr_b16 a[124:125],v17 offset:2056
ds_read_b64_tr_b16 a[126:127],v17 offset:2312
ds_read_b64_tr_b16 a[128:129],v17 offset:4096
ds_read_b64_tr_b16 a[130:131],v17 offset:4352
ds_read_b64_tr_b16 a[132:133],v17 offset:4104
ds_read_b64_tr_b16 a[134:135],v17 offset:4360
s_waitcnt lgkmcnt(0)
ds_read_b64_tr_b16 a[136:137],v17 offset:6144
ds_read_b64_tr_b16 a[138:139],v17 offset:6400
ds_read_b64_tr_b16 a[140:141],v17 offset:6152
ds_read_b64_tr_b16 a[142:143],v17 offset:6408
ds_read_b64_tr_b16 a[144:145],v17 offset:8192
ds_read_b64_tr_b16 a[146:147],v17 offset:8448
ds_read_b64_tr_b16 a[148:149],v17 offset:8200
ds_read_b64_tr_b16 a[150:151],v17 offset:8456
ds_read_b64_tr_b16 a[152:153],v17 offset:10240
ds_read_b64_tr_b16 a[154:155],v17 offset:10496
ds_read_b64_tr_b16 a[156:157],v17 offset:10248
ds_read_b64_tr_b16 a[158:159],v17 offset:10504
s_waitcnt lgkmcnt(0)
ds_read_b64_tr_b16 a[160:161],v17 offset:12288
ds_read_b64_tr_b16 a[162:163],v17 offset:12544
ds_read_b64_tr_b16 a[164:165],v17 offset:12296
ds_read_b64_tr_b16 a[166:167],v17 offset:12552
s_waitcnt lgkmcnt(0)
s_waitcnt vmcnt(0)
ds_read_b64_tr_b16 a[168:169],v17 offset:16384
ds_read_b64_tr_b16 a[170:171],v17 offset:16640
ds_read_b64_tr_b16 a[172:173],v17 offset:16392
ds_read_b64_tr_b16 a[174:175],v17 offset:16648
ds_read_b64_tr_b16 a[176:177],v17 offset:18432
ds_read_b64_tr_b16 a[178:179],v17 offset:18688
ds_read_b64_tr_b16 a[180:181],v17 offset:18440
ds_read_b64_tr_b16 a[182:183],v17 offset:18696
ds_read_b64_tr_b16 a[184:185],v17 offset:20480
ds_read_b64_tr_b16 a[186:187],v17 offset:20736
ds_read_b64_tr_b16 a[188:189],v17 offset:20488
ds_read_b64_tr_b16 a[190:191],v17 offset:20744
s_waitcnt lgkmcnt(0)
ds_read_b64_tr_b16 a[192:193],v17 offset:22528
ds_read_b64_tr_b16 a[194:195],v17 offset:22784
ds_read_b64_tr_b16 a[196:197],v17 offset:22536
ds_read_b64_tr_b16 a[198:199],v17 offset:22792
ds_read_b64_tr_b16 a[200:201],v17 offset:24576
ds_read_b64_tr_b16 a[202:203],v17 offset:24832
ds_read_b64_tr_b16 a[204:205],v17 offset:24584
ds_read_b64_tr_b16 a[206:207],v17 offset:24840
ds_read_b64_tr_b16 a[208:209],v17 offset:26624
ds_read_b64_tr_b16 a[210:211],v17 offset:26880
ds_read_b64_tr_b16 a[212:213],v17 offset:26632
ds_read_b64_tr_b16 a[214:215],v17 offset:26888
s_waitcnt lgkmcnt(0)
ds_read_b64_tr_b16 a[216:217],v17 offset:28672
ds_read_b64_tr_b16 a[218:219],v17 offset:28928
ds_read_b64_tr_b16 a[220:221],v17 offset:28680
ds_read_b64_tr_b16 a[222:223],v17 offset:28936
s_waitcnt lgkmcnt(0)
s_mov_b32 s92,s2
s_and_b32 s93,s3,0xffff
s_mov_b32 s94,0x100
s_mov_b32 s95,0x20000
v_mbcnt_lo_u32_b32 v16,-1,0
v_mbcnt_hi_u32_b32 v16,-1,v16
v_mov_b32 v18,0
v_cmp_eq_u32 vcc,22,v16
s_nop 1
v_cndmask_b32 v18,v18,63,vcc
v_cmp_eq_u32 vcc,17,v16
s_nop 1
v_cndmask_b32 v18,v18,63,vcc
v_cmp_eq_u32 vcc,18,v16
s_nop 1
v_cndmask_b32 v18,v18,1,vcc
v_and_b32 v19,1,v16
v_cmp_eq_u32 vcc,1,v19
v_mov_b32 v19,8192
s_nop 0
v_cndmask_b32 v19,-1,v19,vcc
v_min_u32 v16,31,v16
v_lshlrev_b32 v16,2,v16
s_sub_u32 s66,s88,64
s_cmp_lg_u32 s50,0
s_cbranch_scc1 vot_181
vpoll_177:
buffer_load_dword v17,v16,s[92:95],s66 offen sc1
s_waitcnt vmcnt(0)
s_cmp_lg_u32 s56,2
s_cbranch_scc1 vck_178
v_cmp_eq_u32 vcc,v17,v19
s_and_b32 s64,vcc_lo,0xffff
s_cmp_eq_u32 s64,65535
s_cbranch_scc1 vck_178
s_mov_b32 s65,0
v_readlane_b32 s64,v17,1
s_lshr_b32 s64,s64,8
s_add_u32 s65,s65,s64
v_readlane_b32 s64,v17,3
s_lshr_b32 s64,s64,8
s_add_u32 s65,s65,s64
v_readlane_b32 s64,v17,5
s_lshr_b32 s64,s64,8
s_add_u32 s65,s65,s64
v_readlane_b32 s64,v17,7
s_lshr_b32 s64,s64,8
s_add_u32 s65,s65,s64
v_readlane_b32 s64,v17,9
s_lshr_b32 s64,s64,8
s_add_u32 s65,s65,s64
v_readlane_b32 s64,v17,11
s_lshr_b32 s64,s64,8
s_add_u32 s65,s65,s64
v_readlane_b32 s64,v17,13
s_lshr_b32 s64,s64,8
s_add_u32 s65,s65,s64
v_readlane_b32 s64,v17,15
s_lshr_b32 s64,s64,8
s_add_u32 s65,s65,s64
s_cmp_ge_u32 s65,256
s_cbranch_scc1 vok_180
s_branch vrt_179
vck_178:
v_cmp_gt_u32 vcc,v18,v17
s_cbranch_vccz vok_180
vrt_179:
s_sleep 48
s_sub_u32 s90,s90,1
s_cmp_gt_i32 s90,0
s_cbranch_scc1 vpoll_177
vok_180:
v_add_u32 v18,160000,v16
ds_write_b32 v18,v17
s_waitcnt lgkmcnt(0)
vot_181:
s_barrier
v_add_u32 v18,160000,v16
ds_read_b32 v17,v18
s_waitcnt lgkmcnt(0)
s_cmp_lg_u32 s56,2
s_cbranch_scc1 vfin_182
v_cmp_eq_u32 vcc,v17,v19
s_and_b32 s64,vcc_lo,0xffff
s_cmp_eq_u32 s64,65535
s_cbranch_scc1 vfin_182
s_mov_b32 s65,0
v_readlane_b32 s64,v17,1
s_lshr_b32 s64,s64,8
s_add_u32 s65,s65,s64
v_readlane_b32 s64,v17,3
s_lshr_b32 s64,s64,8
s_add_u32 s65,s65,s64
v_readlane_b32 s64,v17,5
s_lshr_b32 s64,s64,8
s_add_u32 s65,s65,s64
v_readlane_b32 s64,v17,7
s_lshr_b32 s64,s64,8
s_add_u32 s65,s65,s64
v_readlane_b32 s64,v17,9
s_lshr_b32 s64,s64,8
s_add_u32 s65,s65,s64
v_readlane_b32 s64,v17,11
s_lshr_b32 s64,s64,8
s_add_u32 s65,s65,s64
v_readlane_b32 s64,v17,13
s_lshr_b32 s64,s64,8
s_add_u32 s65,s65,s64
v_readlane_b32 s64,v17,15
s_lshr_b32 s64,s64,8
s_add_u32 s65,s65,s64
s_cmp_ge_u32 s65,256
s_cbranch_scc1 fl_fb
vfin_182:
s_and_b32 s56,s56,1
s_mov_b32 s67,0
s_barrier
v_lshlrev_b32 v0,4,v1
s_mov_b32 s60,0
s_lshl_b32 s70,s50,13
s_mov_b32 s55,0
v_mov_b32 v3,v0
s_mov_b32 s73,0xffff0000
s_lshl_b32 s64,s52,2
s_add_u32 s64,s64,s50
s_mul_i32 s61,s64,7168
s_add_u32 s61,s61,219152384
s_lshl_b32 s68,s64,8
s_add_u32 s68,s68,138551296
s_lshl_b32 s83,s53,2
s_add_u32 s83,s83,s50
s_mov_b32 s63,0
s_xor_b32 s64,s50,0
s_lshl_b32 s64,s64,13
v_add_u32 v8,s64,v0
v_mov_b32 v4,v8
s_xor_b32 s64,s50,1
s_lshl_b32 s64,s64,13
v_add_u32 v9,s64,v0
v_mov_b32 v5,v9
s_xor_b32 s64,s50,2
s_lshl_b32 s64,s64,13
v_add_u32 v10,s64,v0
v_mov_b32 v6,v10
s_xor_b32 s64,s50,3
s_lshl_b32 s64,s64,13
v_add_u32 v11,s64,v0
v_mov_b32 v7,v11
v_min_u32 v2,6,v1
v_lshlrev_b32 v2,2,v2
s_add_u32 s62,s61,4096
s_lshl_b32 s66,s83,10
s_lshr_b32 s65,s83,3
s_lshl_b32 s65,s65,8
s_and_b32 s64,s83,7
s_lshl_b32 s64,s64,2
s_add_u32 s69,s64,s65
s_add_u32 s69,s69,138555392
s_add_u32 s82,s66,201326592
s_lshl_b32 s64,s53,2
s_add_u32 s64,s64,s50
s_mul_i32 s74,s64,24576
s_xor_b32 s64,s50,s52
s_sub_u32 s64,s64,1
s_max_i32 s64,s64,0
s_lshl_b32 s64,s64,11
s_add_u32 s74,s74,s64
s_add_u32 s74,s74,168558592
s_mov_b32 s75,0
s_mov_b32 s77,0
v_lshlrev_b32 v26,11,v21
v_lshl_add_u32 v26,v22,4,v26
s_lshl_b32 s64,s83,6
v_add_u32 v18,s64,v26
v_lshlrev_b32 v26,5,v22
s_lshl_b32 s64,s83,7
s_add_u32 s64,s64,267407360
buffer_load_dwordx4 v[152:155],v26,s[20:23],s64 offen offset:0 sc1
buffer_load_dwordx4 v[156:159],v26,s[20:23],s64 offen offset:16 sc1
s_add_u32 s64,s64,24576
buffer_load_dwordx4 v[128:131],v26,s[20:23],s64 offen offset:0 sc1
buffer_load_dwordx4 v[132:135],v26,s[20:23],s64 offen offset:16 sc1
s_add_u32 s64,s64,24576
buffer_load_dwordx4 v[136:139],v26,s[20:23],s64 offen offset:0 sc1
buffer_load_dwordx4 v[140:143],v26,s[20:23],s64 offen offset:16 sc1
s_add_u32 s64,s64,24576
buffer_load_dwordx4 v[144:147],v26,s[20:23],s64 offen offset:0 sc1
buffer_load_dwordx4 v[148:151],v26,s[20:23],s64 offen offset:16 sc1
s_add_u32 s64,s64,24576
s_waitcnt vmcnt(0)
v_pk_add_f32 v[152:153],v[152:153],v[128:129]
v_pk_add_f32 v[136:137],v[136:137],v[144:145]
v_pk_add_f32 v[154:155],v[154:155],v[130:131]
v_pk_add_f32 v[138:139],v[138:139],v[146:147]
v_pk_add_f32 v[156:157],v[156:157],v[132:133]
v_pk_add_f32 v[140:141],v[140:141],v[148:149]
v_pk_add_f32 v[158:159],v[158:159],v[134:135]
v_pk_add_f32 v[142:143],v[142:143],v[150:151]
v_pk_add_f32 v[152:153],v[152:153],v[136:137]
v_pk_add_f32 v[154:155],v[154:155],v[138:139]
v_pk_add_f32 v[156:157],v[156:157],v[140:141]
v_pk_add_f32 v[158:159],v[158:159],v[142:143]
v_cvt_pk_bf16_f32 v128,v152,v153
v_cvt_pk_bf16_f32 v129,v154,v155
v_cvt_pk_bf16_f32 v130,v156,v157
v_cvt_pk_bf16_f32 v131,v158,v159
v_lshlrev_b32 v152,16,v128
v_and_b32 v153,s73,v128
v_lshlrev_b32 v154,16,v129
v_and_b32 v155,s73,v129
v_lshlrev_b32 v156,16,v130
v_and_b32 v157,s73,v130
v_lshlrev_b32 v158,16,v131
v_and_b32 v159,s73,v131
v_mov_b32 v204,-1
v_mov_b32 v205,-1
v_mov_b32 v206,-1
v_mov_b32 v207,-1
s_cmp_eq_u32 s50,s52
s_cbranch_scc1 lfin_183
s_add_u32 s71,s60,1
s_add_u32 s53,s60,2
plp_193:
buffer_load_dword v16,v2,s[20:23],s68 offen sc1
s_waitcnt vmcnt(0)
v_cmp_gt_u32 vcc,s71,v16
s_cbranch_vccz pok_194
s_sleep 4
s_sub_u32 s90,s90,1
s_cmp_gt_i32 s90,0
s_cbranch_scc1 plp_193
pok_194:
lag_190:
s_mov_b32 m0,s70
s_nop 0
buffer_load_dwordx4 v3,s[20:23],s61 offen offset:0 lds
buffer_load_dwordx4 v3,s[20:23],s61 offen offset:1024 lds
buffer_load_dwordx4 v3,s[20:23],s61 offen offset:2048 lds
buffer_load_dwordx4 v3,s[20:23],s61 offen offset:3072 lds
s_add_u32 m0,s70,4096
s_nop 0
buffer_load_dwordx4 v3,s[20:23],s62 offen offset:0 lds
buffer_load_dwordx4 v3,s[20:23],s62 offen offset:1024 lds
buffer_load_dwordx4 v3,s[20:23],s62 offen offset:2048 lds
s_add_u32 s61,s61,114688
s_add_u32 s62,s62,114688
s_add_u32 s70,s70,32768
s_and_b32 s70,s70,0x1ffff
buffer_load_dword v23,off,s[20:23],s66
buffer_load_dword v23,off,s[20:23],s66
dec_191:
v_cmp_gt_u32 vcc,s53,v16
s_cbranch_vccnz BN_189
BR_188:
s_waitcnt vmcnt(8)
ds_read_b128 v[64:67],v4 offset:0
s_waitcnt vmcnt(7)
ds_read_b128 v[68:71],v4 offset:1024
s_waitcnt vmcnt(6)
ds_read_b128 v[72:75],v4 offset:2048
s_waitcnt vmcnt(5)
ds_read_b128 v[76:79],v4 offset:3072
s_waitcnt lgkmcnt(3)
v_mfma_f32_16x16x32_bf16 v[32:35],a[0:3],v[64:67],0
s_add_u32 s71,s60,2
s_add_u32 s53,s60,3
v_mfma_f32_16x16x32_bf16 v[36:39],a[4:7],v[64:67],0
s_waitcnt lgkmcnt(2)
s_waitcnt vmcnt(4)
ds_read_b128 v[80:83],v4 offset:4096
v_mfma_f32_16x16x32_bf16 v[32:35],a[8:11],v[68:71],v[32:35]
v_mfma_f32_16x16x32_bf16 v[36:39],a[12:15],v[68:71],v[36:39]
s_waitcnt lgkmcnt(2)
s_waitcnt vmcnt(3)
s_mov_b32 m0,s70
ds_read_b128 v[84:87],v4 offset:5120
v_mfma_f32_16x16x32_bf16 v[32:35],a[16:19],v[72:75],v[32:35]
buffer_load_dwordx4 v3,s[20:23],s61 offen offset:0 lds
v_mfma_f32_16x16x32_bf16 v[36:39],a[20:23],v[72:75],v[36:39]
s_waitcnt lgkmcnt(2)
s_waitcnt vmcnt(3)
ds_read_b128 v[88:91],v4 offset:6144
v_mfma_f32_16x16x32_bf16 v[32:35],a[24:27],v[76:79],v[32:35]
buffer_load_dwordx4 v3,s[20:23],s61 offen offset:1024 lds
v_mfma_f32_16x16x32_bf16 v[36:39],a[28:31],v[76:79],v[36:39]
s_waitcnt lgkmcnt(2)
s_barrier
ds_read_b128 v[92:95],v5 offset:0
v_mfma_f32_16x16x32_bf16 v[32:35],a[32:35],v[80:83],v[32:35]
ds_read_b128 v[96:99],v5 offset:1024
v_mfma_f32_16x16x32_bf16 v[36:39],a[36:39],v[80:83],v[36:39]
s_waitcnt lgkmcnt(3)
ds_read_b128 v[100:103],v5 offset:2048
v_mfma_f32_16x16x32_bf16 v[32:35],a[40:43],v[84:87],v[32:35]
ds_read_b128 v[104:107],v5 offset:3072
v_mfma_f32_16x16x32_bf16 v[36:39],a[44:47],v[84:87],v[36:39]
s_waitcnt lgkmcnt(4)
ds_read_b128 v[108:111],v5 offset:4096
v_mfma_f32_16x16x32_bf16 v[32:35],a[48:51],v[88:91],v[32:35]
ds_read_b128 v[112:115],v5 offset:5120
v_mfma_f32_16x16x32_bf16 v[36:39],a[52:55],v[88:91],v[36:39]
s_waitcnt lgkmcnt(5)
buffer_load_dwordx4 v3,s[20:23],s61 offen offset:2048 lds
v_mfma_f32_16x16x32_bf16 v[32:35],a[56:59],v[92:95],v[32:35]
ds_read_b128 v[116:119],v5 offset:6144
v_mfma_f32_16x16x32_bf16 v[36:39],a[60:63],v[92:95],v[36:39]
s_waitcnt lgkmcnt(5)
buffer_load_dwordx4 v3,s[20:23],s61 offen offset:3072 lds
v_mfma_f32_16x16x32_bf16 v[32:35],a[64:67],v[96:99],v[32:35]
s_add_u32 m0,s70,4096
ds_read_b128 v[120:123],v6 offset:0
v_mfma_f32_16x16x32_bf16 v[36:39],a[68:71],v[96:99],v[36:39]
s_waitcnt lgkmcnt(5)
buffer_load_dwordx4 v3,s[20:23],s62 offen offset:0 lds
v_mfma_f32_16x16x32_bf16 v[32:35],a[72:75],v[100:103],v[32:35]
ds_read_b128 v[124:127],v6 offset:1024
v_mfma_f32_16x16x32_bf16 v[36:39],a[76:79],v[100:103],v[36:39]
s_waitcnt lgkmcnt(5)
buffer_load_dwordx4 v3,s[20:23],s62 offen offset:1024 lds
v_mfma_f32_16x16x32_bf16 v[32:35],a[80:83],v[104:107],v[32:35]
ds_read_b128 v[64:67],v6 offset:2048
v_mfma_f32_16x16x32_bf16 v[36:39],a[84:87],v[104:107],v[36:39]
s_waitcnt lgkmcnt(5)
buffer_load_dword v16,v2,s[20:23],s68 offen sc1
v_mfma_f32_16x16x32_bf16 v[32:35],a[88:91],v[108:111],v[32:35]
ds_read_b128 v[68:71],v6 offset:3072
v_mfma_f32_16x16x32_bf16 v[36:39],a[92:95],v[108:111],v[36:39]
s_waitcnt lgkmcnt(5)
buffer_load_dwordx4 v3,s[20:23],s62 offen offset:2048 lds
v_mfma_f32_16x16x32_bf16 v[32:35],a[96:99],v[112:115],v[32:35]
ds_read_b128 v[72:75],v6 offset:4096
v_mfma_f32_16x16x32_bf16 v[36:39],a[100:103],v[112:115],v[36:39]
s_waitcnt lgkmcnt(5)
v_mfma_f32_16x16x32_bf16 v[32:35],a[104:107],v[116:119],v[32:35]
ds_read_b128 v[76:79],v6 offset:5120
v_mfma_f32_16x16x32_bf16 v[36:39],a[108:111],v[116:119],v[36:39]
s_waitcnt lgkmcnt(5)
v_mfma_f32_16x16x32_bf16 v[32:35],a[112:115],v[120:123],v[32:35]
ds_read_b128 v[80:83],v6 offset:6144
v_mfma_f32_16x16x32_bf16 v[36:39],a[116:119],v[120:123],v[36:39]
s_waitcnt lgkmcnt(5)
v_mfma_f32_16x16x32_bf16 v[32:35],a[120:123],v[124:127],v[32:35]
ds_read_b128 v[84:87],v7 offset:0
v_mfma_f32_16x16x32_bf16 v[36:39],a[124:127],v[124:127],v[36:39]
s_waitcnt lgkmcnt(5)
v_mfma_f32_16x16x32_bf16 v[32:35],a[128:131],v[64:67],v[32:35]
ds_read_b128 v[88:91],v7 offset:1024
v_mfma_f32_16x16x32_bf16 v[36:39],a[132:135],v[64:67],v[36:39]
s_waitcnt lgkmcnt(5)
v_mfma_f32_16x16x32_bf16 v[32:35],a[136:139],v[68:71],v[32:35]
ds_read_b128 v[92:95],v7 offset:2048
v_mfma_f32_16x16x32_bf16 v[36:39],a[140:143],v[68:71],v[36:39]
s_waitcnt lgkmcnt(5)
v_mfma_f32_16x16x32_bf16 v[32:35],a[144:147],v[72:75],v[32:35]
ds_read_b128 v[96:99],v7 offset:3072
v_mfma_f32_16x16x32_bf16 v[36:39],a[148:151],v[72:75],v[36:39]
s_waitcnt lgkmcnt(5)
v_mfma_f32_16x16x32_bf16 v[32:35],a[152:155],v[76:79],v[32:35]
ds_read_b128 v[100:103],v7 offset:4096
v_mfma_f32_16x16x32_bf16 v[36:39],a[156:159],v[76:79],v[36:39]
s_waitcnt lgkmcnt(5)
v_mfma_f32_16x16x32_bf16 v[32:35],a[160:163],v[80:83],v[32:35]
ds_read_b128 v[104:107],v7 offset:5120
v_mfma_f32_16x16x32_bf16 v[36:39],a[164:167],v[80:83],v[36:39]
s_waitcnt lgkmcnt(5)
v_mfma_f32_16x16x32_bf16 v[32:35],a[168:171],v[84:87],v[32:35]
ds_read_b128 v[108:111],v7 offset:6144
v_mfma_f32_16x16x32_bf16 v[36:39],a[172:175],v[84:87],v[36:39]
s_waitcnt lgkmcnt(5)
s_add_u32 s61,s61,114688
s_add_u32 s62,s62,114688
v_mfma_f32_16x16x32_bf16 v[32:35],a[176:179],v[88:91],v[32:35]
s_add_u32 s70,s70,32768
s_and_b32 s70,s70,0x1ffff
s_add_u32 s55,s55,32768
v_mfma_f32_16x16x32_bf16 v[36:39],a[180:183],v[88:91],v[36:39]
s_waitcnt lgkmcnt(4)
s_and_b32 s55,s55,0x1ffff
v_add_u32 v4,s55,v8
v_mfma_f32_16x16x32_bf16 v[32:35],a[184:187],v[92:95],v[32:35]
v_add_u32 v5,s55,v9
v_add_u32 v6,s55,v10
v_mfma_f32_16x16x32_bf16 v[36:39],a[188:191],v[92:95],v[36:39]
s_waitcnt lgkmcnt(3)
v_add_u32 v7,s55,v11
v_mfma_f32_16x16x32_bf16 v[32:35],a[192:195],v[96:99],v[32:35]
s_waitcnt vmcnt(0)
ds_read_b128 v[64:67],v4 offset:0
v_mfma_f32_16x16x32_bf16 v[36:39],a[196:199],v[96:99],v[36:39]
s_waitcnt lgkmcnt(3)
ds_read_b128 v[68:71],v4 offset:1024
v_mfma_f32_16x16x32_bf16 v[32:35],a[200:203],v[100:103],v[32:35]
ds_read_b128 v[72:75],v4 offset:2048
v_mfma_f32_16x16x32_bf16 v[36:39],a[204:207],v[100:103],v[36:39]
s_waitcnt lgkmcnt(4)
v_mfma_f32_16x16x32_bf16 v[32:35],a[208:211],v[104:107],v[32:35]
v_mfma_f32_16x16x32_bf16 v[36:39],a[212:215],v[104:107],v[36:39]
s_waitcnt lgkmcnt(3)
v_mfma_f32_16x16x32_bf16 v[40:43],a[216:219],v[108:111],v[32:35]
v_mfma_f32_16x16x32_bf16 v[44:47],a[220:223],v[108:111],v[36:39]
v_cmp_gt_u32 vcc,s53,v16
s_add_u32 s60,s60,1
s_cbranch_vccnz WN_187
WR_186:
s_waitcnt lgkmcnt(2)
v_mfma_f32_16x16x32_bf16 v[32:35],a[0:3],v[64:67],0
s_add_u32 s71,s60,2
s_add_u32 s53,s60,3
ds_read_b128 v[76:79],v4 offset:3072
v_mfma_f32_16x16x32_bf16 v[36:39],a[4:7],v[64:67],0
s_waitcnt lgkmcnt(2)
ds_read_b128 v[80:83],v4 offset:4096
v_mfma_f32_16x16x32_bf16 v[32:35],a[8:11],v[68:71],v[32:35]
ds_read_b128 v[84:87],v4 offset:5120
s_add_u32 s64,s74,s75
s_cmp_eq_u32 s56,1
s_cbranch_scc1 b1_195
buffer_store_dwordx4 v[40:43],v0,s[20:23],s64 offen offset:0
buffer_store_dwordx4 v[44:47],v0,s[20:23],s64 offen offset:1024
b2_196:
v_mfma_f32_16x16x32_bf16 v[36:39],a[12:15],v[68:71],v[36:39]
s_waitcnt lgkmcnt(3)
s_add_u32 s75,s75,6144
ds_read_b128 v[88:91],v4 offset:6144
v_mfma_f32_16x16x32_bf16 v[32:35],a[16:19],v[72:75],v[32:35]
s_barrier
s_cmp_eq_u32 s75,24576
s_cselect_b32 s75,0,s75
ds_read_b128 v[92:95],v5 offset:0
v_mfma_f32_16x16x32_bf16 v[36:39],a[20:23],v[72:75],v[36:39]
s_waitcnt lgkmcnt(4)
ds_read_b128 v[96:99],v5 offset:1024
v_mfma_f32_16x16x32_bf16 v[32:35],a[24:27],v[76:79],v[32:35]
s_mov_b32 m0,s70
ds_read_b128 v[100:103],v5 offset:2048
v_mfma_f32_16x16x32_bf16 v[36:39],a[28:31],v[76:79],v[36:39]
s_waitcnt lgkmcnt(5)
buffer_load_dwordx4 v3,s[20:23],s61 offen offset:0 lds
v_mfma_f32_16x16x32_bf16 v[32:35],a[32:35],v[80:83],v[32:35]
ds_read_b128 v[104:107],v5 offset:3072
v_mfma_f32_16x16x32_bf16 v[36:39],a[36:39],v[80:83],v[36:39]
s_waitcnt lgkmcnt(5)
buffer_load_dwordx4 v3,s[20:23],s61 offen offset:1024 lds
v_mfma_f32_16x16x32_bf16 v[32:35],a[40:43],v[84:87],v[32:35]
ds_read_b128 v[108:111],v5 offset:4096
v_mfma_f32_16x16x32_bf16 v[36:39],a[44:47],v[84:87],v[36:39]
s_waitcnt lgkmcnt(5)
buffer_load_dwordx4 v3,s[20:23],s61 offen offset:2048 lds
v_mfma_f32_16x16x32_bf16 v[32:35],a[48:51],v[88:91],v[32:35]
ds_read_b128 v[112:115],v5 offset:5120
v_mfma_f32_16x16x32_bf16 v[36:39],a[52:55],v[88:91],v[36:39]
s_waitcnt lgkmcnt(5)
buffer_load_dwordx4 v3,s[20:23],s61 offen offset:3072 lds
v_mfma_f32_16x16x32_bf16 v[32:35],a[56:59],v[92:95],v[32:35]
ds_read_b128 v[116:119],v5 offset:6144
v_mfma_f32_16x16x32_bf16 v[36:39],a[60:63],v[92:95],v[36:39]
s_waitcnt lgkmcnt(5)
v_mfma_f32_16x16x32_bf16 v[32:35],a[64:67],v[96:99],v[32:35]
s_add_u32 m0,s70,4096
ds_read_b128 v[120:123],v6 offset:0
v_mfma_f32_16x16x32_bf16 v[36:39],a[68:71],v[96:99],v[36:39]
s_waitcnt lgkmcnt(5)
buffer_load_dwordx4 v3,s[20:23],s62 offen offset:0 lds
v_mfma_f32_16x16x32_bf16 v[32:35],a[72:75],v[100:103],v[32:35]
ds_read_b128 v[124:127],v6 offset:1024
v_mfma_f32_16x16x32_bf16 v[36:39],a[76:79],v[100:103],v[36:39]
s_waitcnt lgkmcnt(5)
buffer_load_dwordx4 v3,s[20:23],s62 offen offset:1024 lds
v_mfma_f32_16x16x32_bf16 v[32:35],a[80:83],v[104:107],v[32:35]
ds_read_b128 v[64:67],v6 offset:2048
v_mfma_f32_16x16x32_bf16 v[36:39],a[84:87],v[104:107],v[36:39]
s_waitcnt lgkmcnt(5)
buffer_load_dword v16,v2,s[20:23],s68 offen sc1
v_mfma_f32_16x16x32_bf16 v[32:35],a[88:91],v[108:111],v[32:35]
ds_read_b128 v[68:71],v6 offset:3072
v_mfma_f32_16x16x32_bf16 v[36:39],a[92:95],v[108:111],v[36:39]
s_waitcnt lgkmcnt(5)
buffer_load_dwordx4 v3,s[20:23],s62 offen offset:2048 lds
v_mfma_f32_16x16x32_bf16 v[32:35],a[96:99],v[112:115],v[32:35]
ds_read_b128 v[72:75],v6 offset:4096
v_mfma_f32_16x16x32_bf16 v[36:39],a[100:103],v[112:115],v[36:39]
s_waitcnt lgkmcnt(5)
v_mfma_f32_16x16x32_bf16 v[32:35],a[104:107],v[116:119],v[32:35]
ds_read_b128 v[76:79],v6 offset:5120
v_mfma_f32_16x16x32_bf16 v[36:39],a[108:111],v[116:119],v[36:39]
s_waitcnt lgkmcnt(5)
v_mfma_f32_16x16x32_bf16 v[32:35],a[112:115],v[120:123],v[32:35]
ds_read_b128 v[80:83],v6 offset:6144
v_mfma_f32_16x16x32_bf16 v[36:39],a[116:119],v[120:123],v[36:39]
s_waitcnt lgkmcnt(5)
v_mfma_f32_16x16x32_bf16 v[32:35],a[120:123],v[124:127],v[32:35]
ds_read_b128 v[84:87],v7 offset:0
v_mfma_f32_16x16x32_bf16 v[36:39],a[124:127],v[124:127],v[36:39]
s_waitcnt lgkmcnt(5)
v_mfma_f32_16x16x32_bf16 v[32:35],a[128:131],v[64:67],v[32:35]
ds_read_b128 v[88:91],v7 offset:1024
v_mfma_f32_16x16x32_bf16 v[36:39],a[132:135],v[64:67],v[36:39]
s_waitcnt lgkmcnt(5)
v_mfma_f32_16x16x32_bf16 v[32:35],a[136:139],v[68:71],v[32:35]
ds_read_b128 v[92:95],v7 offset:2048
v_mfma_f32_16x16x32_bf16 v[36:39],a[140:143],v[68:71],v[36:39]
s_waitcnt lgkmcnt(5)
v_mfma_f32_16x16x32_bf16 v[32:35],a[144:147],v[72:75],v[32:35]
ds_read_b128 v[96:99],v7 offset:3072
v_mfma_f32_16x16x32_bf16 v[36:39],a[148:151],v[72:75],v[36:39]
s_waitcnt lgkmcnt(5)
v_mfma_f32_16x16x32_bf16 v[32:35],a[152:155],v[76:79],v[32:35]
ds_read_b128 v[100:103],v7 offset:4096
v_mfma_f32_16x16x32_bf16 v[36:39],a[156:159],v[76:79],v[36:39]
s_waitcnt lgkmcnt(5)
v_mfma_f32_16x16x32_bf16 v[32:35],a[160:163],v[80:83],v[32:35]
ds_read_b128 v[104:107],v7 offset:5120
v_mfma_f32_16x16x32_bf16 v[36:39],a[164:167],v[80:83],v[36:39]
s_waitcnt lgkmcnt(5)
v_mfma_f32_16x16x32_bf16 v[32:35],a[168:171],v[84:87],v[32:35]
ds_read_b128 v[108:111],v7 offset:6144
v_mfma_f32_16x16x32_bf16 v[36:39],a[172:175],v[84:87],v[36:39]
s_waitcnt lgkmcnt(5)
s_add_u32 s61,s61,114688
s_add_u32 s62,s62,114688
v_mfma_f32_16x16x32_bf16 v[32:35],a[176:179],v[88:91],v[32:35]
s_add_u32 s70,s70,32768
s_and_b32 s70,s70,0x1ffff
s_add_u32 s55,s55,32768
v_mfma_f32_16x16x32_bf16 v[36:39],a[180:183],v[88:91],v[36:39]
s_waitcnt lgkmcnt(4)
s_and_b32 s55,s55,0x1ffff
v_add_u32 v4,s55,v8
v_mfma_f32_16x16x32_bf16 v[32:35],a[184:187],v[92:95],v[32:35]
v_add_u32 v5,s55,v9
v_add_u32 v6,s55,v10
v_mfma_f32_16x16x32_bf16 v[36:39],a[188:191],v[92:95],v[36:39]
s_waitcnt lgkmcnt(3)
v_add_u32 v7,s55,v11
v_mfma_f32_16x16x32_bf16 v[32:35],a[192:195],v[96:99],v[32:35]
s_waitcnt vmcnt(0)
ds_read_b128 v[64:67],v4 offset:0
v_mfma_f32_16x16x32_bf16 v[36:39],a[196:199],v[96:99],v[36:39]
s_waitcnt lgkmcnt(3)
ds_read_b128 v[68:71],v4 offset:1024
v_mfma_f32_16x16x32_bf16 v[32:35],a[200:203],v[100:103],v[32:35]
ds_read_b128 v[72:75],v4 offset:2048
v_mfma_f32_16x16x32_bf16 v[36:39],a[204:207],v[100:103],v[36:39]
s_waitcnt lgkmcnt(4)
v_mfma_f32_16x16x32_bf16 v[32:35],a[208:211],v[104:107],v[32:35]
v_mfma_f32_16x16x32_bf16 v[36:39],a[212:215],v[104:107],v[36:39]
s_waitcnt lgkmcnt(3)
v_mfma_f32_16x16x32_bf16 v[40:43],a[216:219],v[108:111],v[32:35]
v_mfma_f32_16x16x32_bf16 v[44:47],a[220:223],v[108:111],v[36:39]
v_cmp_gt_u32 vcc,s53,v16
s_add_u32 s60,s60,1
s_cbranch_vccz WR_186
WN_187:
s_waitcnt lgkmcnt(2)
v_mfma_f32_16x16x32_bf16 v[32:35],a[0:3],v[64:67],0
s_add_u32 s71,s60,2
s_add_u32 s53,s60,3
ds_read_b128 v[76:79],v4 offset:3072
v_mfma_f32_16x16x32_bf16 v[36:39],a[4:7],v[64:67],0
s_waitcnt lgkmcnt(2)
ds_read_b128 v[80:83],v4 offset:4096
v_mfma_f32_16x16x32_bf16 v[32:35],a[8:11],v[68:71],v[32:35]
ds_read_b128 v[84:87],v4 offset:5120
s_add_u32 s64,s74,s75
s_cmp_eq_u32 s56,1
s_cbranch_scc1 b1_198
buffer_store_dwordx4 v[40:43],v0,s[20:23],s64 offen offset:0
buffer_store_dwordx4 v[44:47],v0,s[20:23],s64 offen offset:1024
b2_199:
v_mfma_f32_16x16x32_bf16 v[36:39],a[12:15],v[68:71],v[36:39]
s_waitcnt lgkmcnt(3)
s_add_u32 s75,s75,6144
ds_read_b128 v[88:91],v4 offset:6144
v_mfma_f32_16x16x32_bf16 v[32:35],a[16:19],v[72:75],v[32:35]
s_barrier
s_cmp_eq_u32 s75,24576
s_cselect_b32 s75,0,s75
ds_read_b128 v[92:95],v5 offset:0
v_mfma_f32_16x16x32_bf16 v[36:39],a[20:23],v[72:75],v[36:39]
s_waitcnt lgkmcnt(4)
ds_read_b128 v[96:99],v5 offset:1024
v_mfma_f32_16x16x32_bf16 v[32:35],a[24:27],v[76:79],v[32:35]
ds_read_b128 v[100:103],v5 offset:2048
v_mfma_f32_16x16x32_bf16 v[36:39],a[28:31],v[76:79],v[36:39]
s_waitcnt lgkmcnt(5)
v_mfma_f32_16x16x32_bf16 v[32:35],a[32:35],v[80:83],v[32:35]
ds_read_b128 v[104:107],v5 offset:3072
v_mfma_f32_16x16x32_bf16 v[36:39],a[36:39],v[80:83],v[36:39]
s_waitcnt lgkmcnt(5)
v_mfma_f32_16x16x32_bf16 v[32:35],a[40:43],v[84:87],v[32:35]
ds_read_b128 v[108:111],v5 offset:4096
v_mfma_f32_16x16x32_bf16 v[36:39],a[44:47],v[84:87],v[36:39]
s_waitcnt lgkmcnt(5)
v_mfma_f32_16x16x32_bf16 v[32:35],a[48:51],v[88:91],v[32:35]
ds_read_b128 v[112:115],v5 offset:5120
v_mfma_f32_16x16x32_bf16 v[36:39],a[52:55],v[88:91],v[36:39]
s_waitcnt lgkmcnt(5)
v_mfma_f32_16x16x32_bf16 v[32:35],a[56:59],v[92:95],v[32:35]
ds_read_b128 v[116:119],v5 offset:6144
v_mfma_f32_16x16x32_bf16 v[36:39],a[60:63],v[92:95],v[36:39]
s_waitcnt lgkmcnt(5)
v_mfma_f32_16x16x32_bf16 v[32:35],a[64:67],v[96:99],v[32:35]
ds_read_b128 v[120:123],v6 offset:0
v_mfma_f32_16x16x32_bf16 v[36:39],a[68:71],v[96:99],v[36:39]
s_waitcnt lgkmcnt(5)
v_mfma_f32_16x16x32_bf16 v[32:35],a[72:75],v[100:103],v[32:35]
ds_read_b128 v[124:127],v6 offset:1024
v_mfma_f32_16x16x32_bf16 v[36:39],a[76:79],v[100:103],v[36:39]
s_waitcnt lgkmcnt(5)
v_mfma_f32_16x16x32_bf16 v[32:35],a[80:83],v[104:107],v[32:35]
ds_read_b128 v[64:67],v6 offset:2048
v_mfma_f32_16x16x32_bf16 v[36:39],a[84:87],v[104:107],v[36:39]
s_waitcnt lgkmcnt(5)
v_mfma_f32_16x16x32_bf16 v[32:35],a[88:91],v[108:111],v[32:35]
ds_read_b128 v[68:71],v6 offset:3072
v_mfma_f32_16x16x32_bf16 v[36:39],a[92:95],v[108:111],v[36:39]
s_waitcnt lgkmcnt(5)
v_mfma_f32_16x16x32_bf16 v[32:35],a[96:99],v[112:115],v[32:35]
ds_read_b128 v[72:75],v6 offset:4096
v_mfma_f32_16x16x32_bf16 v[36:39],a[100:103],v[112:115],v[36:39]
s_waitcnt lgkmcnt(5)
v_mfma_f32_16x16x32_bf16 v[32:35],a[104:107],v[116:119],v[32:35]
ds_read_b128 v[76:79],v6 offset:5120
v_mfma_f32_16x16x32_bf16 v[36:39],a[108:111],v[116:119],v[36:39]
s_waitcnt lgkmcnt(5)
v_mfma_f32_16x16x32_bf16 v[32:35],a[112:115],v[120:123],v[32:35]
ds_read_b128 v[80:83],v6 offset:6144
v_mfma_f32_16x16x32_bf16 v[36:39],a[116:119],v[120:123],v[36:39]
s_waitcnt lgkmcnt(5)
v_mfma_f32_16x16x32_bf16 v[32:35],a[120:123],v[124:127],v[32:35]
ds_read_b128 v[84:87],v7 offset:0
v_mfma_f32_16x16x32_bf16 v[36:39],a[124:127],v[124:127],v[36:39]
s_waitcnt lgkmcnt(5)
v_mfma_f32_16x16x32_bf16 v[32:35],a[128:131],v[64:67],v[32:35]
ds_read_b128 v[88:91],v7 offset:1024
v_mfma_f32_16x16x32_bf16 v[36:39],a[132:135],v[64:67],v[36:39]
s_waitcnt lgkmcnt(5)
v_mfma_f32_16x16x32_bf16 v[32:35],a[136:139],v[68:71],v[32:35]
ds_read_b128 v[92:95],v7 offset:2048
v_mfma_f32_16x16x32_bf16 v[36:39],a[140:143],v[68:71],v[36:39]
s_waitcnt lgkmcnt(5)
buffer_load_dword v16,v2,s[20:23],s68 offen sc1
v_mfma_f32_16x16x32_bf16 v[32:35],a[144:147],v[72:75],v[32:35]
ds_read_b128 v[96:99],v7 offset:3072
v_mfma_f32_16x16x32_bf16 v[36:39],a[148:151],v[72:75],v[36:39]
s_waitcnt lgkmcnt(5)
v_mfma_f32_16x16x32_bf16 v[32:35],a[152:155],v[76:79],v[32:35]
ds_read_b128 v[100:103],v7 offset:4096
v_mfma_f32_16x16x32_bf16 v[36:39],a[156:159],v[76:79],v[36:39]
s_waitcnt lgkmcnt(5)
v_mfma_f32_16x16x32_bf16 v[32:35],a[160:163],v[80:83],v[32:35]
ds_read_b128 v[104:107],v7 offset:5120
v_mfma_f32_16x16x32_bf16 v[36:39],a[164:167],v[80:83],v[36:39]
s_waitcnt lgkmcnt(5)
v_mfma_f32_16x16x32_bf16 v[32:35],a[168:171],v[84:87],v[32:35]
ds_read_b128 v[108:111],v7 offset:6144
v_mfma_f32_16x16x32_bf16 v[36:39],a[172:175],v[84:87],v[36:39]
s_waitcnt lgkmcnt(5)
s_add_u32 s55,s55,32768
s_and_b32 s55,s55,0x1ffff
v_mfma_f32_16x16x32_bf16 v[32:35],a[176:179],v[88:91],v[32:35]
v_add_u32 v4,s55,v8
v_add_u32 v5,s55,v9
v_mfma_f32_16x16x32_bf16 v[36:39],a[180:183],v[88:91],v[36:39]
s_waitcnt lgkmcnt(4)
v_add_u32 v6,s55,v10
v_add_u32 v7,s55,v11
v_mfma_f32_16x16x32_bf16 v[32:35],a[184:187],v[92:95],v[32:35]
v_mfma_f32_16x16x32_bf16 v[36:39],a[188:191],v[92:95],v[36:39]
s_waitcnt lgkmcnt(3)
v_mfma_f32_16x16x32_bf16 v[32:35],a[192:195],v[96:99],v[32:35]
v_mfma_f32_16x16x32_bf16 v[36:39],a[196:199],v[96:99],v[36:39]
s_waitcnt lgkmcnt(2)
v_mfma_f32_16x16x32_bf16 v[32:35],a[200:203],v[100:103],v[32:35]
v_mfma_f32_16x16x32_bf16 v[36:39],a[204:207],v[100:103],v[36:39]
s_waitcnt lgkmcnt(1)
v_mfma_f32_16x16x32_bf16 v[32:35],a[208:211],v[104:107],v[32:35]
v_mfma_f32_16x16x32_bf16 v[36:39],a[212:215],v[104:107],v[36:39]
s_waitcnt lgkmcnt(0)
v_mfma_f32_16x16x32_bf16 v[40:43],a[216:219],v[108:111],v[32:35]
v_mfma_f32_16x16x32_bf16 v[44:47],a[220:223],v[108:111],v[36:39]
s_waitcnt vmcnt(0)
v_cmp_gt_u32 vcc,s71,v16
s_add_u32 s60,s60,1
s_branch endN_197
BN_189:
s_waitcnt vmcnt(8)
ds_read_b128 v[64:67],v4 offset:0
s_waitcnt vmcnt(7)
ds_read_b128 v[68:71],v4 offset:1024
s_waitcnt vmcnt(6)
ds_read_b128 v[72:75],v4 offset:2048
s_waitcnt vmcnt(5)
ds_read_b128 v[76:79],v4 offset:3072
s_waitcnt lgkmcnt(3)
v_mfma_f32_16x16x32_bf16 v[32:35],a[0:3],v[64:67],0
s_add_u32 s71,s60,2
s_add_u32 s53,s60,3
v_mfma_f32_16x16x32_bf16 v[36:39],a[4:7],v[64:67],0
s_waitcnt lgkmcnt(2)
s_waitcnt vmcnt(4)
ds_read_b128 v[80:83],v4 offset:4096
v_mfma_f32_16x16x32_bf16 v[32:35],a[8:11],v[68:71],v[32:35]
v_mfma_f32_16x16x32_bf16 v[36:39],a[12:15],v[68:71],v[36:39]
s_waitcnt lgkmcnt(2)
s_waitcnt vmcnt(3)
ds_read_b128 v[84:87],v4 offset:5120
v_mfma_f32_16x16x32_bf16 v[32:35],a[16:19],v[72:75],v[32:35]
v_mfma_f32_16x16x32_bf16 v[36:39],a[20:23],v[72:75],v[36:39]
s_waitcnt lgkmcnt(2)
s_waitcnt vmcnt(2)
ds_read_b128 v[88:91],v4 offset:6144
v_mfma_f32_16x16x32_bf16 v[32:35],a[24:27],v[76:79],v[32:35]
v_mfma_f32_16x16x32_bf16 v[36:39],a[28:31],v[76:79],v[36:39]
s_waitcnt lgkmcnt(2)
s_barrier
ds_read_b128 v[92:95],v5 offset:0
v_mfma_f32_16x16x32_bf16 v[32:35],a[32:35],v[80:83],v[32:35]
ds_read_b128 v[96:99],v5 offset:1024
v_mfma_f32_16x16x32_bf16 v[36:39],a[36:39],v[80:83],v[36:39]
s_waitcnt lgkmcnt(3)
ds_read_b128 v[100:103],v5 offset:2048
v_mfma_f32_16x16x32_bf16 v[32:35],a[40:43],v[84:87],v[32:35]
ds_read_b128 v[104:107],v5 offset:3072
v_mfma_f32_16x16x32_bf16 v[36:39],a[44:47],v[84:87],v[36:39]
s_waitcnt lgkmcnt(4)
ds_read_b128 v[108:111],v5 offset:4096
v_mfma_f32_16x16x32_bf16 v[32:35],a[48:51],v[88:91],v[32:35]
ds_read_b128 v[112:115],v5 offset:5120
v_mfma_f32_16x16x32_bf16 v[36:39],a[52:55],v[88:91],v[36:39]
s_waitcnt lgkmcnt(5)
v_mfma_f32_16x16x32_bf16 v[32:35],a[56:59],v[92:95],v[32:35]
ds_read_b128 v[116:119],v5 offset:6144
v_mfma_f32_16x16x32_bf16 v[36:39],a[60:63],v[92:95],v[36:39]
s_waitcnt lgkmcnt(5)
v_mfma_f32_16x16x32_bf16 v[32:35],a[64:67],v[96:99],v[32:35]
ds_read_b128 v[120:123],v6 offset:0
v_mfma_f32_16x16x32_bf16 v[36:39],a[68:71],v[96:99],v[36:39]
s_waitcnt lgkmcnt(5)
v_mfma_f32_16x16x32_bf16 v[32:35],a[72:75],v[100:103],v[32:35]
ds_read_b128 v[124:127],v6 offset:1024
v_mfma_f32_16x16x32_bf16 v[36:39],a[76:79],v[100:103],v[36:39]
s_waitcnt lgkmcnt(5)
v_mfma_f32_16x16x32_bf16 v[32:35],a[80:83],v[104:107],v[32:35]
ds_read_b128 v[64:67],v6 offset:2048
v_mfma_f32_16x16x32_bf16 v[36:39],a[84:87],v[104:107],v[36:39]
s_waitcnt lgkmcnt(5)
v_mfma_f32_16x16x32_bf16 v[32:35],a[88:91],v[108:111],v[32:35]
ds_read_b128 v[68:71],v6 offset:3072
v_mfma_f32_16x16x32_bf16 v[36:39],a[92:95],v[108:111],v[36:39]
s_waitcnt lgkmcnt(5)
v_mfma_f32_16x16x32_bf16 v[32:35],a[96:99],v[112:115],v[32:35]
ds_read_b128 v[72:75],v6 offset:4096
v_mfma_f32_16x16x32_bf16 v[36:39],a[100:103],v[112:115],v[36:39]
s_waitcnt lgkmcnt(5)
v_mfma_f32_16x16x32_bf16 v[32:35],a[104:107],v[116:119],v[32:35]
ds_read_b128 v[76:79],v6 offset:5120
v_mfma_f32_16x16x32_bf16 v[36:39],a[108:111],v[116:119],v[36:39]
s_waitcnt lgkmcnt(5)
v_mfma_f32_16x16x32_bf16 v[32:35],a[112:115],v[120:123],v[32:35]
ds_read_b128 v[80:83],v6 offset:6144
v_mfma_f32_16x16x32_bf16 v[36:39],a[116:119],v[120:123],v[36:39]
s_waitcnt lgkmcnt(5)
v_mfma_f32_16x16x32_bf16 v[32:35],a[120:123],v[124:127],v[32:35]
ds_read_b128 v[84:87],v7 offset:0
v_mfma_f32_16x16x32_bf16 v[36:39],a[124:127],v[124:127],v[36:39]
s_waitcnt lgkmcnt(5)
v_mfma_f32_16x16x32_bf16 v[32:35],a[128:131],v[64:67],v[32:35]
ds_read_b128 v[88:91],v7 offset:1024
v_mfma_f32_16x16x32_bf16 v[36:39],a[132:135],v[64:67],v[36:39]
s_waitcnt lgkmcnt(5)
v_mfma_f32_16x16x32_bf16 v[32:35],a[136:139],v[68:71],v[32:35]
ds_read_b128 v[92:95],v7 offset:2048
v_mfma_f32_16x16x32_bf16 v[36:39],a[140:143],v[68:71],v[36:39]
s_waitcnt lgkmcnt(5)
buffer_load_dword v16,v2,s[20:23],s68 offen sc1
v_mfma_f32_16x16x32_bf16 v[32:35],a[144:147],v[72:75],v[32:35]
ds_read_b128 v[96:99],v7 offset:3072
v_mfma_f32_16x16x32_bf16 v[36:39],a[148:151],v[72:75],v[36:39]
s_waitcnt lgkmcnt(5)
v_mfma_f32_16x16x32_bf16 v[32:35],a[152:155],v[76:79],v[32:35]
ds_read_b128 v[100:103],v7 offset:4096
v_mfma_f32_16x16x32_bf16 v[36:39],a[156:159],v[76:79],v[36:39]
s_waitcnt lgkmcnt(5)
v_mfma_f32_16x16x32_bf16 v[32:35],a[160:163],v[80:83],v[32:35]
ds_read_b128 v[104:107],v7 offset:5120
v_mfma_f32_16x16x32_bf16 v[36:39],a[164:167],v[80:83],v[36:39]
s_waitcnt lgkmcnt(5)
v_mfma_f32_16x16x32_bf16 v[32:35],a[168:171],v[84:87],v[32:35]
ds_read_b128 v[108:111],v7 offset:6144
v_mfma_f32_16x16x32_bf16 v[36:39],a[172:175],v[84:87],v[36:39]
s_waitcnt lgkmcnt(5)
s_add_u32 s55,s55,32768
s_and_b32 s55,s55,0x1ffff
v_mfma_f32_16x16x32_bf16 v[32:35],a[176:179],v[88:91],v[32:35]
v_add_u32 v4,s55,v8
v_add_u32 v5,s55,v9
v_mfma_f32_16x16x32_bf16 v[36:39],a[180:183],v[88:91],v[36:39]
s_waitcnt lgkmcnt(4)
v_add_u32 v6,s55,v10
v_add_u32 v7,s55,v11
v_mfma_f32_16x16x32_bf16 v[32:35],a[184:187],v[92:95],v[32:35]
v_mfma_f32_16x16x32_bf16 v[36:39],a[188:191],v[92:95],v[36:39]
s_waitcnt lgkmcnt(3)
v_mfma_f32_16x16x32_bf16 v[32:35],a[192:195],v[96:99],v[32:35]
v_mfma_f32_16x16x32_bf16 v[36:39],a[196:199],v[96:99],v[36:39]
s_waitcnt lgkmcnt(2)
v_mfma_f32_16x16x32_bf16 v[32:35],a[200:203],v[100:103],v[32:35]
v_mfma_f32_16x16x32_bf16 v[36:39],a[204:207],v[100:103],v[36:39]
s_waitcnt lgkmcnt(1)
v_mfma_f32_16x16x32_bf16 v[32:35],a[208:211],v[104:107],v[32:35]
v_mfma_f32_16x16x32_bf16 v[36:39],a[212:215],v[104:107],v[36:39]
s_waitcnt lgkmcnt(0)
v_mfma_f32_16x16x32_bf16 v[40:43],a[216:219],v[108:111],v[32:35]
v_mfma_f32_16x16x32_bf16 v[44:47],a[220:223],v[108:111],v[36:39]
s_waitcnt vmcnt(0)
v_cmp_gt_u32 vcc,s71,v16
s_add_u32 s60,s60,1
endN_197:
s_cbranch_vccnz nb_192
s_mov_b32 m0,s70
s_nop 0
buffer_load_dwordx4 v3,s[20:23],s61 offen offset:0 lds
buffer_load_dwordx4 v3,s[20:23],s61 offen offset:1024 lds
buffer_load_dwordx4 v3,s[20:23],s61 offen offset:2048 lds
buffer_load_dwordx4 v3,s[20:23],s61 offen offset:3072 lds
s_add_u32 m0,s70,4096
s_nop 0
buffer_load_dwordx4 v3,s[20:23],s62 offen offset:0 lds
buffer_load_dwordx4 v3,s[20:23],s62 offen offset:1024 lds
buffer_load_dwordx4 v3,s[20:23],s62 offen offset:2048 lds
s_add_u32 s61,s61,114688
s_add_u32 s62,s62,114688
s_add_u32 s70,s70,32768
s_and_b32 s70,s70,0x1ffff
s_add_u32 s64,s74,s75
s_cmp_eq_u32 s56,1
s_cbranch_scc1 b1_200
buffer_store_dwordx4 v[40:43],v0,s[20:23],s64 offen offset:0
buffer_store_dwordx4 v[44:47],v0,s[20:23],s64 offen offset:1024
b2_201:
s_add_u32 s75,s75,6144
s_cmp_eq_u32 s75,24576
s_cselect_b32 s75,0,s75
s_branch dec_191
nb_192:
buffer_load_dword v16,v2,s[20:23],s68 offen sc1
s_nop 3
s_add_u32 s64,s74,s75
s_cmp_eq_u32 s56,1
s_cbranch_scc1 b1_202
buffer_store_dwordx4 v[40:43],v0,s[20:23],s64 offen offset:0
buffer_store_dwordx4 v[44:47],v0,s[20:23],s64 offen offset:1024
b2_203:
s_add_u32 s75,s75,6144
s_cmp_eq_u32 s75,24576
s_cselect_b32 s75,0,s75
s_waitcnt vmcnt(2)
v_cmp_gt_u32 vcc,s71,v16
s_cbranch_vccz lag_190
s_cmp_ge_u32 s60,128
s_cbranch_scc1 done_170
plp_204:
buffer_load_dword v16,v2,s[20:23],s68 offen sc1
s_waitcnt vmcnt(0)
v_cmp_gt_u32 vcc,s71,v16
s_cbranch_vccz pok_205
s_sleep 4
s_sub_u32 s90,s90,1
s_cmp_gt_i32 s90,0
s_cbranch_scc1 plp_204
pok_205:
s_branch lag_190
lfin_183:
s_add_u32 s71,s60,1
s_add_u32 s53,s60,2
plp_225:
buffer_load_dword v16,v2,s[20:23],s68 offen sc1
s_waitcnt vmcnt(0)
v_cmp_gt_u32 vcc,s71,v16
s_cbranch_vccz pok_226
s_sleep 4
s_sub_u32 s90,s90,1
s_cmp_gt_i32 s90,0
s_cbranch_scc1 plp_225
pok_226:
lag_222:
s_mov_b32 m0,s70
s_nop 0
buffer_load_dwordx4 v3,s[20:23],s61 offen offset:0 lds
buffer_load_dwordx4 v3,s[20:23],s61 offen offset:1024 lds
buffer_load_dwordx4 v3,s[20:23],s61 offen offset:2048 lds
buffer_load_dwordx4 v3,s[20:23],s61 offen offset:3072 lds
s_add_u32 m0,s70,4096
s_nop 0
buffer_load_dwordx4 v3,s[20:23],s62 offen offset:0 lds
buffer_load_dwordx4 v3,s[20:23],s62 offen offset:1024 lds
buffer_load_dwordx4 v3,s[20:23],s62 offen offset:2048 lds
s_add_u32 s61,s61,114688
s_add_u32 s62,s62,114688
s_add_u32 s70,s70,32768
s_and_b32 s70,s70,0x1ffff
dec_223:
v_cmp_gt_u32 vcc,s53,v16
s_cbranch_vccnz BN_221
BR_220:
s_waitcnt vmcnt(6)
ds_read_b128 v[64:67],v4 offset:0
s_waitcnt vmcnt(5)
ds_read_b128 v[68:71],v4 offset:1024
s_waitcnt vmcnt(4)
ds_read_b128 v[72:75],v4 offset:2048
s_waitcnt vmcnt(3)
ds_read_b128 v[76:79],v4 offset:3072
s_waitcnt lgkmcnt(3)
v_mfma_f32_16x16x32_bf16 v[32:35],a[0:3],v[64:67],0
s_add_u32 s71,s60,2
s_add_u32 s53,s60,3
v_mfma_f32_16x16x32_bf16 v[36:39],a[4:7],v[64:67],0
s_waitcnt lgkmcnt(2)
s_waitcnt vmcnt(2)
ds_read_b128 v[80:83],v4 offset:4096
v_mfma_f32_16x16x32_bf16 v[32:35],a[8:11],v[68:71],v[32:35]
v_mfma_f32_16x16x32_bf16 v[36:39],a[12:15],v[68:71],v[36:39]
s_waitcnt lgkmcnt(2)
s_waitcnt vmcnt(1)
s_mov_b32 m0,s70
ds_read_b128 v[84:87],v4 offset:5120
v_mfma_f32_16x16x32_bf16 v[32:35],a[16:19],v[72:75],v[32:35]
buffer_load_dwordx4 v3,s[20:23],s61 offen offset:0 lds
v_mfma_f32_16x16x32_bf16 v[36:39],a[20:23],v[72:75],v[36:39]
s_waitcnt lgkmcnt(2)
s_waitcnt vmcnt(1)
ds_read_b128 v[88:91],v4 offset:6144
v_mfma_f32_16x16x32_bf16 v[32:35],a[24:27],v[76:79],v[32:35]
buffer_load_dwordx4 v3,s[20:23],s61 offen offset:1024 lds
v_mfma_f32_16x16x32_bf16 v[36:39],a[28:31],v[76:79],v[36:39]
s_waitcnt lgkmcnt(2)
s_barrier
ds_read_b128 v[92:95],v5 offset:0
v_mfma_f32_16x16x32_bf16 v[32:35],a[32:35],v[80:83],v[32:35]
ds_read_b128 v[96:99],v5 offset:1024
v_mfma_f32_16x16x32_bf16 v[36:39],a[36:39],v[80:83],v[36:39]
s_waitcnt lgkmcnt(3)
ds_read_b128 v[100:103],v5 offset:2048
v_mfma_f32_16x16x32_bf16 v[32:35],a[40:43],v[84:87],v[32:35]
ds_read_b128 v[104:107],v5 offset:3072
v_mfma_f32_16x16x32_bf16 v[36:39],a[44:47],v[84:87],v[36:39]
s_waitcnt lgkmcnt(4)
ds_read_b128 v[108:111],v5 offset:4096
v_mfma_f32_16x16x32_bf16 v[32:35],a[48:51],v[88:91],v[32:35]
ds_read_b128 v[112:115],v5 offset:5120
v_mfma_f32_16x16x32_bf16 v[36:39],a[52:55],v[88:91],v[36:39]
s_waitcnt lgkmcnt(5)
buffer_load_dwordx4 v3,s[20:23],s61 offen offset:2048 lds
v_mfma_f32_16x16x32_bf16 v[32:35],a[56:59],v[92:95],v[32:35]
s_cmp_eq_u32 s77,0
s_cselect_b32 s57,2.0,0
ds_read_b128 v[116:119],v5 offset:6144
v_mfma_f32_16x16x32_bf16 v[36:39],a[60:63],v[92:95],v[36:39]
s_waitcnt lgkmcnt(5)
buffer_load_dwordx4 v3,s[20:23],s61 offen offset:3072 lds
v_or_b32 v21,s57,v0
v_mfma_f32_16x16x32_bf16 v[32:35],a[64:67],v[96:99],v[32:35]
s_add_u32 m0,s70,4096
ds_read_b128 v[120:123],v6 offset:0
v_or_b32 v22,s57,v18
v_mfma_f32_16x16x32_bf16 v[36:39],a[68:71],v[96:99],v[36:39]
s_waitcnt lgkmcnt(5)
buffer_load_dwordx4 v3,s[20:23],s62 offen offset:0 lds
v_lshlrev_b32 v168,16,v160
v_mfma_f32_16x16x32_bf16 v[32:35],a[72:75],v[100:103],v[32:35]
ds_read_b128 v[124:127],v6 offset:1024
v_and_b32 v169,s73,v160
v_mfma_f32_16x16x32_bf16 v[36:39],a[76:79],v[100:103],v[36:39]
s_waitcnt lgkmcnt(5)
buffer_load_dwordx4 v3,s[20:23],s62 offen offset:1024 lds
v_lshlrev_b32 v170,16,v161
v_mfma_f32_16x16x32_bf16 v[32:35],a[80:83],v[104:107],v[32:35]
ds_read_b128 v[64:67],v6 offset:2048
v_and_b32 v171,s73,v161
v_mfma_f32_16x16x32_bf16 v[36:39],a[84:87],v[104:107],v[36:39]
s_waitcnt lgkmcnt(5)
buffer_load_dword v16,v2,s[20:23],s68 offen sc1
v_lshlrev_b32 v172,16,v162
v_mfma_f32_16x16x32_bf16 v[32:35],a[88:91],v[108:111],v[32:35]
ds_read_b128 v[68:71],v6 offset:3072
v_and_b32 v173,s73,v162
v_mfma_f32_16x16x32_bf16 v[36:39],a[92:95],v[108:111],v[36:39]
s_waitcnt lgkmcnt(5)
buffer_load_dwordx4 v3,s[20:23],s62 offen offset:2048 lds
v_lshlrev_b32 v174,16,v163
v_mfma_f32_16x16x32_bf16 v[32:35],a[96:99],v[112:115],v[32:35]
s_add_u32 s84,s74,s75
s_add_u32 s85,s84,4096
ds_read_b128 v[72:75],v6 offset:4096
v_mfma_f32_16x16x32_bf16 v[36:39],a[100:103],v[112:115],v[36:39]
s_waitcnt lgkmcnt(5)
buffer_load_dwordx4 v[128:131],v0,s[20:23],s84 offen offset:0 sc1
v_and_b32 v175,s73,v163
v_mfma_f32_16x16x32_bf16 v[32:35],a[104:107],v[116:119],v[32:35]
ds_read_b128 v[76:79],v6 offset:5120
v_lshlrev_b32 v176,16,v164
v_mfma_f32_16x16x32_bf16 v[36:39],a[108:111],v[116:119],v[36:39]
s_waitcnt lgkmcnt(5)
buffer_load_dwordx4 v[132:135],v0,s[20:23],s84 offen offset:1024 sc1
v_and_b32 v177,s73,v164
v_mfma_f32_16x16x32_bf16 v[32:35],a[112:115],v[120:123],v[32:35]
ds_read_b128 v[80:83],v6 offset:6144
v_lshlrev_b32 v178,16,v165
v_mfma_f32_16x16x32_bf16 v[36:39],a[116:119],v[120:123],v[36:39]
s_waitcnt lgkmcnt(5)
buffer_load_dwordx4 v[136:139],v0,s[20:23],s84 offen offset:2048 sc1
v_and_b32 v179,s73,v165
v_mfma_f32_16x16x32_bf16 v[32:35],a[120:123],v[124:127],v[32:35]
ds_read_b128 v[84:87],v7 offset:0
v_lshlrev_b32 v180,16,v166
v_mfma_f32_16x16x32_bf16 v[36:39],a[124:127],v[124:127],v[36:39]
s_waitcnt lgkmcnt(5)
buffer_load_dwordx4 v[140:143],v0,s[20:23],s84 offen offset:3072 sc1
v_and_b32 v181,s73,v166
v_mfma_f32_16x16x32_bf16 v[32:35],a[128:131],v[64:67],v[32:35]
ds_read_b128 v[88:91],v7 offset:1024
v_lshlrev_b32 v182,16,v167
v_mfma_f32_16x16x32_bf16 v[36:39],a[132:135],v[64:67],v[36:39]
s_waitcnt lgkmcnt(5)
buffer_load_dwordx4 v[144:147],v0,s[20:23],s85 offen offset:0 sc1
v_and_b32 v183,s73,v167
v_mfma_f32_16x16x32_bf16 v[32:35],a[136:139],v[68:71],v[32:35]
ds_read_b128 v[92:95],v7 offset:2048
v_add_f32 v212,v212,v176
v_mfma_f32_16x16x32_bf16 v[36:39],a[140:143],v[68:71],v[36:39]
s_waitcnt lgkmcnt(5)
buffer_load_dwordx4 v[148:151],v0,s[20:23],s85 offen offset:1024 sc1
v_add_f32 v213,v213,v177
v_mfma_f32_16x16x32_bf16 v[32:35],a[144:147],v[72:75],v[32:35]
ds_read_b128 v[96:99],v7 offset:3072
v_add_f32 v214,v214,v178
v_mfma_f32_16x16x32_bf16 v[36:39],a[148:151],v[72:75],v[36:39]
s_waitcnt lgkmcnt(5)
v_add_f32 v215,v215,v179
v_add_f32 v216,v216,v180
v_mfma_f32_16x16x32_bf16 v[32:35],a[152:155],v[76:79],v[32:35]
ds_read_b128 v[100:103],v7 offset:4096
v_add_f32 v217,v217,v181
v_mfma_f32_16x16x32_bf16 v[36:39],a[156:159],v[76:79],v[36:39]
s_waitcnt lgkmcnt(5)
v_add_f32 v218,v218,v182
v_add_f32 v219,v219,v183
v_mfma_f32_16x16x32_bf16 v[32:35],a[160:163],v[80:83],v[32:35]
ds_read_b128 v[104:107],v7 offset:5120
v_fma_f32 v168,v212,v152,v168
v_mfma_f32_16x16x32_bf16 v[36:39],a[164:167],v[80:83],v[36:39]
s_waitcnt lgkmcnt(5)
v_fma_f32 v169,v213,v153,v169
v_fma_f32 v170,v214,v154,v170
v_mfma_f32_16x16x32_bf16 v[32:35],a[168:171],v[84:87],v[32:35]
ds_read_b128 v[108:111],v7 offset:6144
v_fma_f32 v171,v215,v155,v171
v_mfma_f32_16x16x32_bf16 v[36:39],a[172:175],v[84:87],v[36:39]
s_waitcnt lgkmcnt(5)
v_fma_f32 v172,v216,v156,v172
v_fma_f32 v173,v217,v157,v173
v_mfma_f32_16x16x32_bf16 v[32:35],a[176:179],v[88:91],v[32:35]
s_add_u32 s61,s61,114688
v_fma_f32 v174,v218,v158,v174
v_fma_f32 v175,v219,v159,v175
v_mfma_f32_16x16x32_bf16 v[36:39],a[180:183],v[88:91],v[36:39]
s_waitcnt lgkmcnt(4)
s_add_u32 s62,s62,114688
buffer_load_dwordx4 v[160:163],v0,s[20:23],s82 offen
v_mfma_f32_16x16x32_bf16 v[32:35],a[184:187],v[92:95],v[32:35]
s_add_u32 s70,s70,32768
s_add_u32 s64,s82,13631488
buffer_load_dwordx4 v[164:167],v0,s[20:23],s64 offen
v_mfma_f32_16x16x32_bf16 v[36:39],a[188:191],v[92:95],v[36:39]
s_waitcnt lgkmcnt(3)
s_add_u32 s82,s82,32768
s_and_b32 s70,s70,0x1ffff
v_mfma_f32_16x16x32_bf16 v[32:35],a[192:195],v[96:99],v[32:35]
s_add_u32 s55,s55,32768
s_and_b32 s55,s55,0x1ffff
v_add_u32 v4,s55,v8
v_mfma_f32_16x16x32_bf16 v[36:39],a[196:199],v[96:99],v[36:39]
s_waitcnt lgkmcnt(2)
v_add_u32 v5,s55,v9
v_add_u32 v6,s55,v10
v_mfma_f32_16x16x32_bf16 v[32:35],a[200:203],v[100:103],v[32:35]
s_waitcnt vmcnt(2)
s_cmp_eq_u32 s77,0
s_cbranch_scc1 go_235
ck_233:
v_max3_u32 v184,v128,v129,v130
v_max3_u32 v185,v140,v141,v142
v_max3_u32 v184,v184,v131,v132
v_max3_u32 v185,v185,v143,v144
v_max3_u32 v184,v184,v133,v134
v_max3_u32 v185,v185,v145,v146
v_max3_u32 v184,v184,v135,v136
v_max3_u32 v185,v185,v147,v148
v_max3_u32 v184,v184,v137,v138
v_max3_u32 v185,v185,v149,v150
v_max3_u32 v184,v184,v139,v151
v_max_u32 v184,v184,v185
v_cmp_eq_u32 vcc,-1,v184
s_cbranch_vccnz rt_234
go_235:
v_mfma_f32_16x16x32_bf16 v[36:39],a[204:207],v[100:103],v[36:39]
s_waitcnt lgkmcnt(1)
v_add_u32 v7,s55,v11
v_add_f32 v128,v128,v136
v_add_f32 v129,v129,v137
v_mfma_f32_16x16x32_bf16 v[32:35],a[208:211],v[104:107],v[32:35]
ds_read_b128 v[64:67],v4 offset:0
v_add_f32 v130,v130,v138
v_add_f32 v131,v131,v139
v_mfma_f32_16x16x32_bf16 v[36:39],a[212:215],v[104:107],v[36:39]
s_waitcnt lgkmcnt(1)
ds_read_b128 v[68:71],v4 offset:1024
v_add_f32 v132,v132,v140
v_add_f32 v133,v133,v141
v_mfma_f32_16x16x32_bf16 v[40:43],a[216:219],v[108:111],v[32:35]
ds_read_b128 v[72:75],v4 offset:2048
v_add_f32 v134,v134,v142
v_add_f32 v135,v135,v143
v_mfma_f32_16x16x32_bf16 v[44:47],a[220:223],v[108:111],v[36:39]
v_add_f32 v128,v128,v144
v_add_f32 v129,v129,v145
v_add_f32 v130,v130,v146
v_add_f32 v131,v131,v147
v_add_f32 v132,v132,v148
v_add_f32 v133,v133,v149
v_add_f32 v134,v134,v150
v_add_f32 v135,v135,v151
v_fma_f32 v168,v128,v152,v168
v_fma_f32 v169,v129,v153,v169
v_fma_f32 v170,v130,v154,v170
v_fma_f32 v171,v131,v155,v171
v_fma_f32 v172,v132,v156,v172
v_fma_f32 v173,v133,v157,v173
v_fma_f32 v174,v134,v158,v174
v_fma_f32 v175,v135,v159,v175
v_cvt_pk_bf16_f32 v176,v168,v169
v_cvt_pk_bf16_f32 v177,v170,v171
v_cvt_pk_bf16_f32 v178,v172,v173
v_cvt_pk_bf16_f32 v179,v174,v175
s_and_b32 s64,s66,0xffff8000
buffer_store_dwordx4 v[176:179],v22,s[24:27],s64 offen
s_cmp_eq_u32 s56,1
s_cbranch_scc1 b1_227
buffer_store_dwordx4 v[204:207],v21,s[20:23],s84 offen offset:0
buffer_store_dwordx4 v[204:207],v21,s[20:23],s84 offen offset:1024
b2_228:
s_cmp_eq_u32 s56,1
s_cbranch_scc1 b1_229
buffer_store_dwordx4 v[204:207],v21,s[20:23],s84 offen offset:2048
buffer_store_dwordx4 v[204:207],v21,s[20:23],s84 offen offset:3072
b2_230:
s_cmp_eq_u32 s56,1
s_cbranch_scc1 b1_231
buffer_store_dwordx4 v[204:207],v21,s[20:23],s85 offen offset:0
buffer_store_dwordx4 v[204:207],v21,s[20:23],s85 offen offset:1024
b2_232:
s_mul_i32 s64,s77,32768
s_add_u32 s66,s66,s64
s_mul_i32 s64,s77,6144
s_add_u32 s75,s75,s64
s_cmp_eq_u32 s75,24576
s_cselect_b32 s75,0,s75
s_add_u32 s63,s63,s77
s_mov_b32 s77,0
v_cmp_gt_u32 vcc,s53,v16
s_add_u32 s60,s60,1
s_cbranch_vccnz WN_219
WR_218:
s_waitcnt lgkmcnt(2)
v_mfma_f32_16x16x32_bf16 v[32:35],a[0:3],v[64:67],0
s_add_u32 s71,s60,2
s_add_u32 s53,s60,3
ds_read_b128 v[76:79],v4 offset:3072
v_mfma_f32_16x16x32_bf16 v[36:39],a[4:7],v[64:67],0
s_waitcnt lgkmcnt(2)
ds_read_b128 v[80:83],v4 offset:4096
v_mfma_f32_16x16x32_bf16 v[32:35],a[8:11],v[68:71],v[32:35]
ds_read_b128 v[84:87],v4 offset:5120
v_mov_b32 v212,v40
v_mfma_f32_16x16x32_bf16 v[36:39],a[12:15],v[68:71],v[36:39]
s_waitcnt lgkmcnt(3)
ds_read_b128 v[88:91],v4 offset:6144
v_mov_b32 v213,v41
v_mfma_f32_16x16x32_bf16 v[32:35],a[16:19],v[72:75],v[32:35]
s_barrier
ds_read_b128 v[92:95],v5 offset:0
v_mov_b32 v214,v42
v_mfma_f32_16x16x32_bf16 v[36:39],a[20:23],v[72:75],v[36:39]
s_waitcnt lgkmcnt(4)
ds_read_b128 v[96:99],v5 offset:1024
v_mov_b32 v215,v43
v_mfma_f32_16x16x32_bf16 v[32:35],a[24:27],v[76:79],v[32:35]
s_mov_b32 m0,s70
ds_read_b128 v[100:103],v5 offset:2048
v_mov_b32 v216,v44
v_mfma_f32_16x16x32_bf16 v[36:39],a[28:31],v[76:79],v[36:39]
s_waitcnt lgkmcnt(5)
buffer_load_dwordx4 v3,s[20:23],s61 offen offset:0 lds
v_mov_b32 v217,v45
v_mfma_f32_16x16x32_bf16 v[32:35],a[32:35],v[80:83],v[32:35]
ds_read_b128 v[104:107],v5 offset:3072
v_mov_b32 v218,v46
v_mfma_f32_16x16x32_bf16 v[36:39],a[36:39],v[80:83],v[36:39]
s_waitcnt lgkmcnt(5)
buffer_load_dwordx4 v3,s[20:23],s61 offen offset:1024 lds
v_mov_b32 v219,v47
v_mfma_f32_16x16x32_bf16 v[32:35],a[40:43],v[84:87],v[32:35]
s_mov_b32 s77,1
ds_read_b128 v[108:111],v5 offset:4096
v_mfma_f32_16x16x32_bf16 v[36:39],a[44:47],v[84:87],v[36:39]
s_waitcnt lgkmcnt(5)
buffer_load_dwordx4 v3,s[20:23],s61 offen offset:2048 lds
v_mfma_f32_16x16x32_bf16 v[32:35],a[48:51],v[88:91],v[32:35]
ds_read_b128 v[112:115],v5 offset:5120
v_mfma_f32_16x16x32_bf16 v[36:39],a[52:55],v[88:91],v[36:39]
s_waitcnt lgkmcnt(5)
buffer_load_dwordx4 v3,s[20:23],s61 offen offset:3072 lds
v_mfma_f32_16x16x32_bf16 v[32:35],a[56:59],v[92:95],v[32:35]
s_waitcnt vmcnt(11)
s_cmp_eq_u32 s77,0
s_cselect_b32 s57,2.0,0
ds_read_b128 v[116:119],v5 offset:6144
v_mfma_f32_16x16x32_bf16 v[36:39],a[60:63],v[92:95],v[36:39]
s_waitcnt lgkmcnt(5)
v_or_b32 v21,s57,v0
v_or_b32 v22,s57,v18
v_mfma_f32_16x16x32_bf16 v[32:35],a[64:67],v[96:99],v[32:35]
s_add_u32 m0,s70,4096
ds_read_b128 v[120:123],v6 offset:0
v_lshlrev_b32 v168,16,v160
v_mfma_f32_16x16x32_bf16 v[36:39],a[68:71],v[96:99],v[36:39]
s_waitcnt lgkmcnt(5)
buffer_load_dwordx4 v3,s[20:23],s62 offen offset:0 lds
v_and_b32 v169,s73,v160
v_mfma_f32_16x16x32_bf16 v[32:35],a[72:75],v[100:103],v[32:35]
ds_read_b128 v[124:127],v6 offset:1024
v_lshlrev_b32 v170,16,v161
v_mfma_f32_16x16x32_bf16 v[36:39],a[76:79],v[100:103],v[36:39]
s_waitcnt lgkmcnt(5)
buffer_load_dwordx4 v3,s[20:23],s62 offen offset:1024 lds
v_and_b32 v171,s73,v161
v_mfma_f32_16x16x32_bf16 v[32:35],a[80:83],v[104:107],v[32:35]
ds_read_b128 v[64:67],v6 offset:2048
v_lshlrev_b32 v172,16,v162
v_mfma_f32_16x16x32_bf16 v[36:39],a[84:87],v[104:107],v[36:39]
s_waitcnt lgkmcnt(5)
buffer_load_dword v16,v2,s[20:23],s68 offen sc1
v_and_b32 v173,s73,v162
v_mfma_f32_16x16x32_bf16 v[32:35],a[88:91],v[108:111],v[32:35]
ds_read_b128 v[68:71],v6 offset:3072
v_lshlrev_b32 v174,16,v163
v_mfma_f32_16x16x32_bf16 v[36:39],a[92:95],v[108:111],v[36:39]
s_waitcnt lgkmcnt(5)
buffer_load_dwordx4 v3,s[20:23],s62 offen offset:2048 lds
v_and_b32 v175,s73,v163
v_mfma_f32_16x16x32_bf16 v[32:35],a[96:99],v[112:115],v[32:35]
s_add_u32 s84,s74,s75
s_add_u32 s85,s84,4096
ds_read_b128 v[72:75],v6 offset:4096
v_mfma_f32_16x16x32_bf16 v[36:39],a[100:103],v[112:115],v[36:39]
s_waitcnt lgkmcnt(5)
buffer_load_dwordx4 v[128:131],v0,s[20:23],s84 offen offset:0 sc1
v_lshlrev_b32 v176,16,v164
v_mfma_f32_16x16x32_bf16 v[32:35],a[104:107],v[116:119],v[32:35]
ds_read_b128 v[76:79],v6 offset:5120
v_and_b32 v177,s73,v164
v_mfma_f32_16x16x32_bf16 v[36:39],a[108:111],v[116:119],v[36:39]
s_waitcnt lgkmcnt(5)
buffer_load_dwordx4 v[132:135],v0,s[20:23],s84 offen offset:1024 sc1
v_lshlrev_b32 v178,16,v165
v_mfma_f32_16x16x32_bf16 v[32:35],a[112:115],v[120:123],v[32:35]
ds_read_b128 v[80:83],v6 offset:6144
v_and_b32 v179,s73,v165
v_mfma_f32_16x16x32_bf16 v[36:39],a[116:119],v[120:123],v[36:39]
s_waitcnt lgkmcnt(5)
buffer_load_dwordx4 v[136:139],v0,s[20:23],s84 offen offset:2048 sc1
v_lshlrev_b32 v180,16,v166
v_mfma_f32_16x16x32_bf16 v[32:35],a[120:123],v[124:127],v[32:35]
ds_read_b128 v[84:87],v7 offset:0
v_and_b32 v181,s73,v166
v_mfma_f32_16x16x32_bf16 v[36:39],a[124:127],v[124:127],v[36:39]
s_waitcnt lgkmcnt(5)
buffer_load_dwordx4 v[140:143],v0,s[20:23],s84 offen offset:3072 sc1
v_lshlrev_b32 v182,16,v167
v_mfma_f32_16x16x32_bf16 v[32:35],a[128:131],v[64:67],v[32:35]
ds_read_b128 v[88:91],v7 offset:1024
v_and_b32 v183,s73,v167
v_mfma_f32_16x16x32_bf16 v[36:39],a[132:135],v[64:67],v[36:39]
s_waitcnt lgkmcnt(5)
buffer_load_dwordx4 v[144:147],v0,s[20:23],s85 offen offset:0 sc1
v_add_f32 v212,v212,v176
v_mfma_f32_16x16x32_bf16 v[32:35],a[136:139],v[68:71],v[32:35]
ds_read_b128 v[92:95],v7 offset:2048
v_add_f32 v213,v213,v177
v_mfma_f32_16x16x32_bf16 v[36:39],a[140:143],v[68:71],v[36:39]
s_waitcnt lgkmcnt(5)
buffer_load_dwordx4 v[148:151],v0,s[20:23],s85 offen offset:1024 sc1
v_add_f32 v214,v214,v178
v_mfma_f32_16x16x32_bf16 v[32:35],a[144:147],v[72:75],v[32:35]
ds_read_b128 v[96:99],v7 offset:3072
v_add_f32 v215,v215,v179
v_mfma_f32_16x16x32_bf16 v[36:39],a[148:151],v[72:75],v[36:39]
s_waitcnt lgkmcnt(5)
v_add_f32 v216,v216,v180
v_add_f32 v217,v217,v181
v_mfma_f32_16x16x32_bf16 v[32:35],a[152:155],v[76:79],v[32:35]
ds_read_b128 v[100:103],v7 offset:4096
v_add_f32 v218,v218,v182
v_mfma_f32_16x16x32_bf16 v[36:39],a[156:159],v[76:79],v[36:39]
s_waitcnt lgkmcnt(5)
v_add_f32 v219,v219,v183
v_fma_f32 v168,v212,v152,v168
v_mfma_f32_16x16x32_bf16 v[32:35],a[160:163],v[80:83],v[32:35]
ds_read_b128 v[104:107],v7 offset:5120
v_fma_f32 v169,v213,v153,v169
v_mfma_f32_16x16x32_bf16 v[36:39],a[164:167],v[80:83],v[36:39]
s_waitcnt lgkmcnt(5)
v_fma_f32 v170,v214,v154,v170
v_fma_f32 v171,v215,v155,v171
v_mfma_f32_16x16x32_bf16 v[32:35],a[168:171],v[84:87],v[32:35]
ds_read_b128 v[108:111],v7 offset:6144
v_fma_f32 v172,v216,v156,v172
v_mfma_f32_16x16x32_bf16 v[36:39],a[172:175],v[84:87],v[36:39]
s_waitcnt lgkmcnt(5)
v_fma_f32 v173,v217,v157,v173
v_fma_f32 v174,v218,v158,v174
v_mfma_f32_16x16x32_bf16 v[32:35],a[176:179],v[88:91],v[32:35]
s_add_u32 s61,s61,114688
s_add_u32 s62,s62,114688
v_fma_f32 v175,v219,v159,v175
v_mfma_f32_16x16x32_bf16 v[36:39],a[180:183],v[88:91],v[36:39]
s_waitcnt lgkmcnt(4)
s_add_u32 s70,s70,32768
buffer_load_dwordx4 v[160:163],v0,s[20:23],s82 offen
v_mfma_f32_16x16x32_bf16 v[32:35],a[184:187],v[92:95],v[32:35]
s_and_b32 s70,s70,0x1ffff
s_add_u32 s64,s82,13631488
buffer_load_dwordx4 v[164:167],v0,s[20:23],s64 offen
v_mfma_f32_16x16x32_bf16 v[36:39],a[188:191],v[92:95],v[36:39]
s_waitcnt lgkmcnt(3)
s_add_u32 s82,s82,32768
s_add_u32 s55,s55,32768
v_mfma_f32_16x16x32_bf16 v[32:35],a[192:195],v[96:99],v[32:35]
s_and_b32 s55,s55,0x1ffff
v_add_u32 v4,s55,v8
v_add_u32 v5,s55,v9
v_mfma_f32_16x16x32_bf16 v[36:39],a[196:199],v[96:99],v[36:39]
s_waitcnt lgkmcnt(2)
v_add_u32 v6,s55,v10
v_add_u32 v7,s55,v11
v_mfma_f32_16x16x32_bf16 v[32:35],a[200:203],v[100:103],v[32:35]
s_waitcnt vmcnt(2)
s_cmp_eq_u32 s77,0
s_cbranch_scc1 go_244
ck_242:
v_max3_u32 v184,v128,v129,v130
v_max3_u32 v185,v140,v141,v142
v_max3_u32 v184,v184,v131,v132
v_max3_u32 v185,v185,v143,v144
v_max3_u32 v184,v184,v133,v134
v_max3_u32 v185,v185,v145,v146
v_max3_u32 v184,v184,v135,v136
v_max3_u32 v185,v185,v147,v148
v_max3_u32 v184,v184,v137,v138
v_max3_u32 v185,v185,v149,v150
v_max3_u32 v184,v184,v139,v151
v_max_u32 v184,v184,v185
v_cmp_eq_u32 vcc,-1,v184
s_cbranch_vccnz rt_243
go_244:
v_mfma_f32_16x16x32_bf16 v[36:39],a[204:207],v[100:103],v[36:39]
s_waitcnt lgkmcnt(1)
ds_read_b128 v[64:67],v4 offset:0
v_add_f32 v128,v128,v136
v_mfma_f32_16x16x32_bf16 v[32:35],a[208:211],v[104:107],v[32:35]
ds_read_b128 v[68:71],v4 offset:1024
v_add_f32 v129,v129,v137
v_add_f32 v130,v130,v138
v_mfma_f32_16x16x32_bf16 v[36:39],a[212:215],v[104:107],v[36:39]
s_waitcnt lgkmcnt(2)
ds_read_b128 v[72:75],v4 offset:2048
v_add_f32 v131,v131,v139
v_add_f32 v132,v132,v140
v_mfma_f32_16x16x32_bf16 v[40:43],a[216:219],v[108:111],v[32:35]
v_add_f32 v133,v133,v141
v_add_f32 v134,v134,v142
v_add_f32 v135,v135,v143
v_mfma_f32_16x16x32_bf16 v[44:47],a[220:223],v[108:111],v[36:39]
v_add_f32 v128,v128,v144
v_add_f32 v129,v129,v145
v_add_f32 v130,v130,v146
v_add_f32 v131,v131,v147
v_add_f32 v132,v132,v148
v_add_f32 v133,v133,v149
v_add_f32 v134,v134,v150
v_add_f32 v135,v135,v151
v_fma_f32 v168,v128,v152,v168
v_fma_f32 v169,v129,v153,v169
v_fma_f32 v170,v130,v154,v170
v_fma_f32 v171,v131,v155,v171
v_fma_f32 v172,v132,v156,v172
v_fma_f32 v173,v133,v157,v173
v_fma_f32 v174,v134,v158,v174
v_fma_f32 v175,v135,v159,v175
v_cvt_pk_bf16_f32 v176,v168,v169
v_cvt_pk_bf16_f32 v177,v170,v171
v_cvt_pk_bf16_f32 v178,v172,v173
v_cvt_pk_bf16_f32 v179,v174,v175
s_and_b32 s64,s66,0xffff8000
buffer_store_dwordx4 v[176:179],v22,s[24:27],s64 offen
s_cmp_eq_u32 s56,1
s_cbranch_scc1 b1_236
buffer_store_dwordx4 v[204:207],v21,s[20:23],s84 offen offset:0
buffer_store_dwordx4 v[204:207],v21,s[20:23],s84 offen offset:1024
b2_237:
s_cmp_eq_u32 s56,1
s_cbranch_scc1 b1_238
buffer_store_dwordx4 v[204:207],v21,s[20:23],s84 offen offset:2048
buffer_store_dwordx4 v[204:207],v21,s[20:23],s84 offen offset:3072
b2_239:
s_cmp_eq_u32 s56,1
s_cbranch_scc1 b1_240
buffer_store_dwordx4 v[204:207],v21,s[20:23],s85 offen offset:0
buffer_store_dwordx4 v[204:207],v21,s[20:23],s85 offen offset:1024
b2_241:
s_mul_i32 s64,s77,32768
s_add_u32 s66,s66,s64
s_mul_i32 s64,s77,6144
s_add_u32 s75,s75,s64
s_cmp_eq_u32 s75,24576
s_cselect_b32 s75,0,s75
s_add_u32 s63,s63,s77
s_mov_b32 s77,0
v_cmp_gt_u32 vcc,s53,v16
s_add_u32 s60,s60,1
s_cbranch_vccz WR_218
WN_219:
s_waitcnt lgkmcnt(2)
v_mfma_f32_16x16x32_bf16 v[32:35],a[0:3],v[64:67],0
s_add_u32 s71,s60,2
s_add_u32 s53,s60,3
ds_read_b128 v[76:79],v4 offset:3072
v_mfma_f32_16x16x32_bf16 v[36:39],a[4:7],v[64:67],0
s_waitcnt lgkmcnt(2)
ds_read_b128 v[80:83],v4 offset:4096
v_mfma_f32_16x16x32_bf16 v[32:35],a[8:11],v[68:71],v[32:35]
ds_read_b128 v[84:87],v4 offset:5120
v_mov_b32 v212,v40
v_mfma_f32_16x16x32_bf16 v[36:39],a[12:15],v[68:71],v[36:39]
s_waitcnt lgkmcnt(3)
ds_read_b128 v[88:91],v4 offset:6144
v_mov_b32 v213,v41
v_mfma_f32_16x16x32_bf16 v[32:35],a[16:19],v[72:75],v[32:35]
s_barrier
ds_read_b128 v[92:95],v5 offset:0
v_mov_b32 v214,v42
v_mfma_f32_16x16x32_bf16 v[36:39],a[20:23],v[72:75],v[36:39]
s_waitcnt lgkmcnt(4)
ds_read_b128 v[96:99],v5 offset:1024
v_mov_b32 v215,v43
v_mfma_f32_16x16x32_bf16 v[32:35],a[24:27],v[76:79],v[32:35]
ds_read_b128 v[100:103],v5 offset:2048
v_mov_b32 v216,v44
v_mfma_f32_16x16x32_bf16 v[36:39],a[28:31],v[76:79],v[36:39]
s_waitcnt lgkmcnt(5)
v_mov_b32 v217,v45
v_mov_b32 v218,v46
v_mfma_f32_16x16x32_bf16 v[32:35],a[32:35],v[80:83],v[32:35]
ds_read_b128 v[104:107],v5 offset:3072
v_mov_b32 v219,v47
v_mfma_f32_16x16x32_bf16 v[36:39],a[36:39],v[80:83],v[36:39]
s_waitcnt lgkmcnt(5)
s_mov_b32 s77,1
v_mfma_f32_16x16x32_bf16 v[32:35],a[40:43],v[84:87],v[32:35]
ds_read_b128 v[108:111],v5 offset:4096
v_mfma_f32_16x16x32_bf16 v[36:39],a[44:47],v[84:87],v[36:39]
s_waitcnt lgkmcnt(5)
v_mfma_f32_16x16x32_bf16 v[32:35],a[48:51],v[88:91],v[32:35]
ds_read_b128 v[112:115],v5 offset:5120
v_mfma_f32_16x16x32_bf16 v[36:39],a[52:55],v[88:91],v[36:39]
s_waitcnt lgkmcnt(5)
v_mfma_f32_16x16x32_bf16 v[32:35],a[56:59],v[92:95],v[32:35]
s_waitcnt vmcnt(7)
s_cmp_eq_u32 s77,0
s_cselect_b32 s57,2.0,0
ds_read_b128 v[116:119],v5 offset:6144
v_mfma_f32_16x16x32_bf16 v[36:39],a[60:63],v[92:95],v[36:39]
s_waitcnt lgkmcnt(5)
v_or_b32 v21,s57,v0
v_or_b32 v22,s57,v18
v_mfma_f32_16x16x32_bf16 v[32:35],a[64:67],v[96:99],v[32:35]
ds_read_b128 v[120:123],v6 offset:0
v_lshlrev_b32 v168,16,v160
v_mfma_f32_16x16x32_bf16 v[36:39],a[68:71],v[96:99],v[36:39]
s_waitcnt lgkmcnt(5)
v_and_b32 v169,s73,v160
v_lshlrev_b32 v170,16,v161
v_mfma_f32_16x16x32_bf16 v[32:35],a[72:75],v[100:103],v[32:35]
ds_read_b128 v[124:127],v6 offset:1024
v_and_b32 v171,s73,v161
v_mfma_f32_16x16x32_bf16 v[36:39],a[76:79],v[100:103],v[36:39]
s_waitcnt lgkmcnt(5)
v_lshlrev_b32 v172,16,v162
v_and_b32 v173,s73,v162
v_mfma_f32_16x16x32_bf16 v[32:35],a[80:83],v[104:107],v[32:35]
ds_read_b128 v[64:67],v6 offset:2048
v_lshlrev_b32 v174,16,v163
v_mfma_f32_16x16x32_bf16 v[36:39],a[84:87],v[104:107],v[36:39]
s_waitcnt lgkmcnt(5)
v_and_b32 v175,s73,v163
v_lshlrev_b32 v176,16,v164
v_mfma_f32_16x16x32_bf16 v[32:35],a[88:91],v[108:111],v[32:35]
ds_read_b128 v[68:71],v6 offset:3072
v_and_b32 v177,s73,v164
v_mfma_f32_16x16x32_bf16 v[36:39],a[92:95],v[108:111],v[36:39]
s_waitcnt lgkmcnt(5)
v_lshlrev_b32 v178,16,v165
v_and_b32 v179,s73,v165
v_mfma_f32_16x16x32_bf16 v[32:35],a[96:99],v[112:115],v[32:35]
s_add_u32 s84,s74,s75
s_add_u32 s85,s84,4096
ds_read_b128 v[72:75],v6 offset:4096
buffer_load_dwordx4 v[128:131],v0,s[20:23],s84 offen offset:0 sc1
buffer_load_dwordx4 v[132:135],v0,s[20:23],s84 offen offset:1024 sc1
v_mfma_f32_16x16x32_bf16 v[36:39],a[100:103],v[112:115],v[36:39]
s_waitcnt lgkmcnt(5)
buffer_load_dwordx4 v[136:139],v0,s[20:23],s84 offen offset:2048 sc1
v_lshlrev_b32 v180,16,v166
v_mfma_f32_16x16x32_bf16 v[32:35],a[104:107],v[116:119],v[32:35]
ds_read_b128 v[76:79],v6 offset:5120
v_and_b32 v181,s73,v166
v_mfma_f32_16x16x32_bf16 v[36:39],a[108:111],v[116:119],v[36:39]
s_waitcnt lgkmcnt(5)
buffer_load_dwordx4 v[140:143],v0,s[20:23],s84 offen offset:3072 sc1
v_lshlrev_b32 v182,16,v167
v_mfma_f32_16x16x32_bf16 v[32:35],a[112:115],v[120:123],v[32:35]
ds_read_b128 v[80:83],v6 offset:6144
v_and_b32 v183,s73,v167
v_mfma_f32_16x16x32_bf16 v[36:39],a[116:119],v[120:123],v[36:39]
s_waitcnt lgkmcnt(5)
buffer_load_dwordx4 v[144:147],v0,s[20:23],s85 offen offset:0 sc1
v_add_f32 v212,v212,v176
v_mfma_f32_16x16x32_bf16 v[32:35],a[120:123],v[124:127],v[32:35]
ds_read_b128 v[84:87],v7 offset:0
v_add_f32 v213,v213,v177
v_mfma_f32_16x16x32_bf16 v[36:39],a[124:127],v[124:127],v[36:39]
s_waitcnt lgkmcnt(5)
buffer_load_dwordx4 v[148:151],v0,s[20:23],s85 offen offset:1024 sc1
v_add_f32 v214,v214,v178
v_mfma_f32_16x16x32_bf16 v[32:35],a[128:131],v[64:67],v[32:35]
ds_read_b128 v[88:91],v7 offset:1024
v_add_f32 v215,v215,v179
v_mfma_f32_16x16x32_bf16 v[36:39],a[132:135],v[64:67],v[36:39]
s_waitcnt lgkmcnt(5)
v_add_f32 v216,v216,v180
v_add_f32 v217,v217,v181
v_mfma_f32_16x16x32_bf16 v[32:35],a[136:139],v[68:71],v[32:35]
ds_read_b128 v[92:95],v7 offset:2048
v_add_f32 v218,v218,v182
v_mfma_f32_16x16x32_bf16 v[36:39],a[140:143],v[68:71],v[36:39]
s_waitcnt lgkmcnt(5)
buffer_load_dword v16,v2,s[20:23],s68 offen sc1
v_add_f32 v219,v219,v183
v_mfma_f32_16x16x32_bf16 v[32:35],a[144:147],v[72:75],v[32:35]
ds_read_b128 v[96:99],v7 offset:3072
v_fma_f32 v168,v212,v152,v168
v_mfma_f32_16x16x32_bf16 v[36:39],a[148:151],v[72:75],v[36:39]
s_waitcnt lgkmcnt(5)
v_fma_f32 v169,v213,v153,v169
v_fma_f32 v170,v214,v154,v170
v_mfma_f32_16x16x32_bf16 v[32:35],a[152:155],v[76:79],v[32:35]
ds_read_b128 v[100:103],v7 offset:4096
v_fma_f32 v171,v215,v155,v171
v_mfma_f32_16x16x32_bf16 v[36:39],a[156:159],v[76:79],v[36:39]
s_waitcnt lgkmcnt(5)
v_fma_f32 v172,v216,v156,v172
v_fma_f32 v173,v217,v157,v173
v_mfma_f32_16x16x32_bf16 v[32:35],a[160:163],v[80:83],v[32:35]
ds_read_b128 v[104:107],v7 offset:5120
v_fma_f32 v174,v218,v158,v174
v_mfma_f32_16x16x32_bf16 v[36:39],a[164:167],v[80:83],v[36:39]
s_waitcnt lgkmcnt(5)
v_fma_f32 v175,v219,v159,v175
v_mfma_f32_16x16x32_bf16 v[32:35],a[168:171],v[84:87],v[32:35]
ds_read_b128 v[108:111],v7 offset:6144
v_mfma_f32_16x16x32_bf16 v[36:39],a[172:175],v[84:87],v[36:39]
s_waitcnt lgkmcnt(5)
s_add_u32 s55,s55,32768
buffer_load_dwordx4 v[160:163],v0,s[20:23],s82 offen
v_mfma_f32_16x16x32_bf16 v[32:35],a[176:179],v[88:91],v[32:35]
s_and_b32 s55,s55,0x1ffff
s_add_u32 s64,s82,13631488
buffer_load_dwordx4 v[164:167],v0,s[20:23],s64 offen
v_mfma_f32_16x16x32_bf16 v[36:39],a[180:183],v[88:91],v[36:39]
s_waitcnt lgkmcnt(4)
s_add_u32 s82,s82,32768
v_add_u32 v4,s55,v8
v_mfma_f32_16x16x32_bf16 v[32:35],a[184:187],v[92:95],v[32:35]
s_waitcnt vmcnt(3)
s_cmp_eq_u32 s77,0
s_cbranch_scc1 go_254
ck_252:
v_max3_u32 v184,v128,v129,v130
v_max3_u32 v185,v140,v141,v142
v_max3_u32 v184,v184,v131,v132
v_max3_u32 v185,v185,v143,v144
v_max3_u32 v184,v184,v133,v134
v_max3_u32 v185,v185,v145,v146
v_max3_u32 v184,v184,v135,v136
v_max3_u32 v185,v185,v147,v148
v_max3_u32 v184,v184,v137,v138
v_max3_u32 v185,v185,v149,v150
v_max3_u32 v184,v184,v139,v151
v_max_u32 v184,v184,v185
v_cmp_eq_u32 vcc,-1,v184
s_cbranch_vccnz rt_253
go_254:
v_mfma_f32_16x16x32_bf16 v[36:39],a[188:191],v[92:95],v[36:39]
s_waitcnt lgkmcnt(3)
v_add_u32 v5,s55,v9
v_add_u32 v6,s55,v10
v_add_f32 v128,v128,v136
v_mfma_f32_16x16x32_bf16 v[32:35],a[192:195],v[96:99],v[32:35]
v_add_u32 v7,s55,v11
v_add_f32 v129,v129,v137
v_add_f32 v130,v130,v138
v_mfma_f32_16x16x32_bf16 v[36:39],a[196:199],v[96:99],v[36:39]
s_waitcnt lgkmcnt(2)
v_add_f32 v131,v131,v139
v_add_f32 v132,v132,v140
v_add_f32 v133,v133,v141
v_mfma_f32_16x16x32_bf16 v[32:35],a[200:203],v[100:103],v[32:35]
v_add_f32 v134,v134,v142
v_add_f32 v135,v135,v143
v_add_f32 v128,v128,v144
v_mfma_f32_16x16x32_bf16 v[36:39],a[204:207],v[100:103],v[36:39]
s_waitcnt lgkmcnt(1)
v_add_f32 v129,v129,v145
v_add_f32 v130,v130,v146
v_add_f32 v131,v131,v147
v_mfma_f32_16x16x32_bf16 v[32:35],a[208:211],v[104:107],v[32:35]
v_add_f32 v132,v132,v148
v_add_f32 v133,v133,v149
v_add_f32 v134,v134,v150
v_mfma_f32_16x16x32_bf16 v[36:39],a[212:215],v[104:107],v[36:39]
s_waitcnt lgkmcnt(0)
v_add_f32 v135,v135,v151
v_fma_f32 v168,v128,v152,v168
v_fma_f32 v169,v129,v153,v169
v_mfma_f32_16x16x32_bf16 v[40:43],a[216:219],v[108:111],v[32:35]
v_fma_f32 v170,v130,v154,v170
v_fma_f32 v171,v131,v155,v171
v_fma_f32 v172,v132,v156,v172
v_mfma_f32_16x16x32_bf16 v[44:47],a[220:223],v[108:111],v[36:39]
s_waitcnt vmcnt(2)
v_fma_f32 v173,v133,v157,v173
v_fma_f32 v174,v134,v158,v174
v_fma_f32 v175,v135,v159,v175
v_cvt_pk_bf16_f32 v176,v168,v169
v_cvt_pk_bf16_f32 v177,v170,v171
v_cvt_pk_bf16_f32 v178,v172,v173
v_cvt_pk_bf16_f32 v179,v174,v175
s_and_b32 s64,s66,0xffff8000
buffer_store_dwordx4 v[176:179],v22,s[24:27],s64 offen
s_cmp_eq_u32 s56,1
s_cbranch_scc1 b1_246
buffer_store_dwordx4 v[204:207],v21,s[20:23],s84 offen offset:0
buffer_store_dwordx4 v[204:207],v21,s[20:23],s84 offen offset:1024
b2_247:
s_cmp_eq_u32 s56,1
s_cbranch_scc1 b1_248
buffer_store_dwordx4 v[204:207],v21,s[20:23],s84 offen offset:2048
buffer_store_dwordx4 v[204:207],v21,s[20:23],s84 offen offset:3072
b2_249:
s_cmp_eq_u32 s56,1
s_cbranch_scc1 b1_250
buffer_store_dwordx4 v[204:207],v21,s[20:23],s85 offen offset:0
buffer_store_dwordx4 v[204:207],v21,s[20:23],s85 offen offset:1024
b2_251:
s_mul_i32 s64,s77,32768
s_add_u32 s66,s66,s64
s_mul_i32 s64,s77,6144
s_add_u32 s75,s75,s64
s_cmp_eq_u32 s75,24576
s_cselect_b32 s75,0,s75
s_add_u32 s63,s63,s77
s_mov_b32 s77,0
v_cmp_gt_u32 vcc,s71,v16
s_add_u32 s60,s60,1
s_branch endN_245
BN_221:
s_waitcnt vmcnt(6)
ds_read_b128 v[64:67],v4 offset:0
s_waitcnt vmcnt(5)
ds_read_b128 v[68:71],v4 offset:1024
s_waitcnt vmcnt(4)
ds_read_b128 v[72:75],v4 offset:2048
s_waitcnt vmcnt(3)
ds_read_b128 v[76:79],v4 offset:3072
s_waitcnt lgkmcnt(3)
v_mfma_f32_16x16x32_bf16 v[32:35],a[0:3],v[64:67],0
s_add_u32 s71,s60,2
s_add_u32 s53,s60,3
v_mfma_f32_16x16x32_bf16 v[36:39],a[4:7],v[64:67],0
s_waitcnt lgkmcnt(2)
s_waitcnt vmcnt(2)
ds_read_b128 v[80:83],v4 offset:4096
v_mfma_f32_16x16x32_bf16 v[32:35],a[8:11],v[68:71],v[32:35]
v_mfma_f32_16x16x32_bf16 v[36:39],a[12:15],v[68:71],v[36:39]
s_waitcnt lgkmcnt(2)
s_waitcnt vmcnt(1)
ds_read_b128 v[84:87],v4 offset:5120
v_mfma_f32_16x16x32_bf16 v[32:35],a[16:19],v[72:75],v[32:35]
v_mfma_f32_16x16x32_bf16 v[36:39],a[20:23],v[72:75],v[36:39]
s_waitcnt lgkmcnt(2)
s_waitcnt vmcnt(0)
ds_read_b128 v[88:91],v4 offset:6144
v_mfma_f32_16x16x32_bf16 v[32:35],a[24:27],v[76:79],v[32:35]
v_mfma_f32_16x16x32_bf16 v[36:39],a[28:31],v[76:79],v[36:39]
s_waitcnt lgkmcnt(2)
s_barrier
ds_read_b128 v[92:95],v5 offset:0
v_mfma_f32_16x16x32_bf16 v[32:35],a[32:35],v[80:83],v[32:35]
ds_read_b128 v[96:99],v5 offset:1024
v_mfma_f32_16x16x32_bf16 v[36:39],a[36:39],v[80:83],v[36:39]
s_waitcnt lgkmcnt(3)
ds_read_b128 v[100:103],v5 offset:2048
v_mfma_f32_16x16x32_bf16 v[32:35],a[40:43],v[84:87],v[32:35]
ds_read_b128 v[104:107],v5 offset:3072
v_mfma_f32_16x16x32_bf16 v[36:39],a[44:47],v[84:87],v[36:39]
s_waitcnt lgkmcnt(4)
ds_read_b128 v[108:111],v5 offset:4096
v_mfma_f32_16x16x32_bf16 v[32:35],a[48:51],v[88:91],v[32:35]
ds_read_b128 v[112:115],v5 offset:5120
v_mfma_f32_16x16x32_bf16 v[36:39],a[52:55],v[88:91],v[36:39]
s_waitcnt lgkmcnt(5)
v_mfma_f32_16x16x32_bf16 v[32:35],a[56:59],v[92:95],v[32:35]
s_cmp_eq_u32 s77,0
s_cselect_b32 s57,2.0,0
ds_read_b128 v[116:119],v5 offset:6144
v_mfma_f32_16x16x32_bf16 v[36:39],a[60:63],v[92:95],v[36:39]
s_waitcnt lgkmcnt(5)
v_or_b32 v21,s57,v0
v_or_b32 v22,s57,v18
v_mfma_f32_16x16x32_bf16 v[32:35],a[64:67],v[96:99],v[32:35]
ds_read_b128 v[120:123],v6 offset:0
v_lshlrev_b32 v168,16,v160
v_mfma_f32_16x16x32_bf16 v[36:39],a[68:71],v[96:99],v[36:39]
s_waitcnt lgkmcnt(5)
v_and_b32 v169,s73,v160
v_lshlrev_b32 v170,16,v161
v_mfma_f32_16x16x32_bf16 v[32:35],a[72:75],v[100:103],v[32:35]
ds_read_b128 v[124:127],v6 offset:1024
v_and_b32 v171,s73,v161
v_mfma_f32_16x16x32_bf16 v[36:39],a[76:79],v[100:103],v[36:39]
s_waitcnt lgkmcnt(5)
v_lshlrev_b32 v172,16,v162
v_and_b32 v173,s73,v162
v_mfma_f32_16x16x32_bf16 v[32:35],a[80:83],v[104:107],v[32:35]
ds_read_b128 v[64:67],v6 offset:2048
v_lshlrev_b32 v174,16,v163
v_mfma_f32_16x16x32_bf16 v[36:39],a[84:87],v[104:107],v[36:39]
s_waitcnt lgkmcnt(5)
v_and_b32 v175,s73,v163
v_lshlrev_b32 v176,16,v164
v_mfma_f32_16x16x32_bf16 v[32:35],a[88:91],v[108:111],v[32:35]
ds_read_b128 v[68:71],v6 offset:3072
v_and_b32 v177,s73,v164
v_mfma_f32_16x16x32_bf16 v[36:39],a[92:95],v[108:111],v[36:39]
s_waitcnt lgkmcnt(5)
v_lshlrev_b32 v178,16,v165
v_and_b32 v179,s73,v165
v_mfma_f32_16x16x32_bf16 v[32:35],a[96:99],v[112:115],v[32:35]
s_add_u32 s84,s74,s75
s_add_u32 s85,s84,4096
ds_read_b128 v[72:75],v6 offset:4096
buffer_load_dwordx4 v[128:131],v0,s[20:23],s84 offen offset:0 sc1
buffer_load_dwordx4 v[132:135],v0,s[20:23],s84 offen offset:1024 sc1
v_mfma_f32_16x16x32_bf16 v[36:39],a[100:103],v[112:115],v[36:39]
s_waitcnt lgkmcnt(5)
buffer_load_dwordx4 v[136:139],v0,s[20:23],s84 offen offset:2048 sc1
v_lshlrev_b32 v180,16,v166
v_mfma_f32_16x16x32_bf16 v[32:35],a[104:107],v[116:119],v[32:35]
ds_read_b128 v[76:79],v6 offset:5120
v_and_b32 v181,s73,v166
v_mfma_f32_16x16x32_bf16 v[36:39],a[108:111],v[116:119],v[36:39]
s_waitcnt lgkmcnt(5)
buffer_load_dwordx4 v[140:143],v0,s[20:23],s84 offen offset:3072 sc1
v_lshlrev_b32 v182,16,v167
v_mfma_f32_16x16x32_bf16 v[32:35],a[112:115],v[120:123],v[32:35]
ds_read_b128 v[80:83],v6 offset:6144
v_and_b32 v183,s73,v167
v_mfma_f32_16x16x32_bf16 v[36:39],a[116:119],v[120:123],v[36:39]
s_waitcnt lgkmcnt(5)
buffer_load_dwordx4 v[144:147],v0,s[20:23],s85 offen offset:0 sc1
v_add_f32 v212,v212,v176
v_mfma_f32_16x16x32_bf16 v[32:35],a[120:123],v[124:127],v[32:35]
ds_read_b128 v[84:87],v7 offset:0
v_add_f32 v213,v213,v177
v_mfma_f32_16x16x32_bf16 v[36:39],a[124:127],v[124:127],v[36:39]
s_waitcnt lgkmcnt(5)
buffer_load_dwordx4 v[148:151],v0,s[20:23],s85 offen offset:1024 sc1
v_add_f32 v214,v214,v178
v_mfma_f32_16x16x32_bf16 v[32:35],a[128:131],v[64:67],v[32:35]
ds_read_b128 v[88:91],v7 offset:1024
v_add_f32 v215,v215,v179
v_mfma_f32_16x16x32_bf16 v[36:39],a[132:135],v[64:67],v[36:39]
s_waitcnt lgkmcnt(5)
v_add_f32 v216,v216,v180
v_add_f32 v217,v217,v181
v_mfma_f32_16x16x32_bf16 v[32:35],a[136:139],v[68:71],v[32:35]
ds_read_b128 v[92:95],v7 offset:2048
v_add_f32 v218,v218,v182
v_mfma_f32_16x16x32_bf16 v[36:39],a[140:143],v[68:71],v[36:39]
s_waitcnt lgkmcnt(5)
buffer_load_dword v16,v2,s[20:23],s68 offen sc1
v_add_f32 v219,v219,v183
v_mfma_f32_16x16x32_bf16 v[32:35],a[144:147],v[72:75],v[32:35]
ds_read_b128 v[96:99],v7 offset:3072
v_fma_f32 v168,v212,v152,v168
v_mfma_f32_16x16x32_bf16 v[36:39],a[148:151],v[72:75],v[36:39]
s_waitcnt lgkmcnt(5)
v_fma_f32 v169,v213,v153,v169
v_fma_f32 v170,v214,v154,v170
v_mfma_f32_16x16x32_bf16 v[32:35],a[152:155],v[76:79],v[32:35]
ds_read_b128 v[100:103],v7 offset:4096
v_fma_f32 v171,v215,v155,v171
v_mfma_f32_16x16x32_bf16 v[36:39],a[156:159],v[76:79],v[36:39]
s_waitcnt lgkmcnt(5)
v_fma_f32 v172,v216,v156,v172
v_fma_f32 v173,v217,v157,v173
v_mfma_f32_16x16x32_bf16 v[32:35],a[160:163],v[80:83],v[32:35]
ds_read_b128 v[104:107],v7 offset:5120
v_fma_f32 v174,v218,v158,v174
v_mfma_f32_16x16x32_bf16 v[36:39],a[164:167],v[80:83],v[36:39]
s_waitcnt lgkmcnt(5)
v_fma_f32 v175,v219,v159,v175
v_mfma_f32_16x16x32_bf16 v[32:35],a[168:171],v[84:87],v[32:35]
ds_read_b128 v[108:111],v7 offset:6144
v_mfma_f32_16x16x32_bf16 v[36:39],a[172:175],v[84:87],v[36:39]
s_waitcnt lgkmcnt(5)
s_add_u32 s55,s55,32768
buffer_load_dwordx4 v[160:163],v0,s[20:23],s82 offen
v_mfma_f32_16x16x32_bf16 v[32:35],a[176:179],v[88:91],v[32:35]
s_and_b32 s55,s55,0x1ffff
s_add_u32 s64,s82,13631488
buffer_load_dwordx4 v[164:167],v0,s[20:23],s64 offen
v_mfma_f32_16x16x32_bf16 v[36:39],a[180:183],v[88:91],v[36:39]
s_waitcnt lgkmcnt(4)
s_add_u32 s82,s82,32768
v_add_u32 v4,s55,v8
v_mfma_f32_16x16x32_bf16 v[32:35],a[184:187],v[92:95],v[32:35]
s_waitcnt vmcnt(3)
s_cmp_eq_u32 s77,0
s_cbranch_scc1 go_263
ck_261:
v_max3_u32 v184,v128,v129,v130
v_max3_u32 v185,v140,v141,v142
v_max3_u32 v184,v184,v131,v132
v_max3_u32 v185,v185,v143,v144
v_max3_u32 v184,v184,v133,v134
v_max3_u32 v185,v185,v145,v146
v_max3_u32 v184,v184,v135,v136
v_max3_u32 v185,v185,v147,v148
v_max3_u32 v184,v184,v137,v138
v_max3_u32 v185,v185,v149,v150
v_max3_u32 v184,v184,v139,v151
v_max_u32 v184,v184,v185
v_cmp_eq_u32 vcc,-1,v184
s_cbranch_vccnz rt_262
go_263:
v_mfma_f32_16x16x32_bf16 v[36:39],a[188:191],v[92:95],v[36:39]
s_waitcnt lgkmcnt(3)
v_add_u32 v5,s55,v9
v_add_u32 v6,s55,v10
v_add_f32 v128,v128,v136
v_mfma_f32_16x16x32_bf16 v[32:35],a[192:195],v[96:99],v[32:35]
v_add_u32 v7,s55,v11
v_add_f32 v129,v129,v137
v_add_f32 v130,v130,v138
v_mfma_f32_16x16x32_bf16 v[36:39],a[196:199],v[96:99],v[36:39]
s_waitcnt lgkmcnt(2)
v_add_f32 v131,v131,v139
v_add_f32 v132,v132,v140
v_add_f32 v133,v133,v141
v_mfma_f32_16x16x32_bf16 v[32:35],a[200:203],v[100:103],v[32:35]
v_add_f32 v134,v134,v142
v_add_f32 v135,v135,v143
v_add_f32 v128,v128,v144
v_mfma_f32_16x16x32_bf16 v[36:39],a[204:207],v[100:103],v[36:39]
s_waitcnt lgkmcnt(1)
v_add_f32 v129,v129,v145
v_add_f32 v130,v130,v146
v_add_f32 v131,v131,v147
v_mfma_f32_16x16x32_bf16 v[32:35],a[208:211],v[104:107],v[32:35]
v_add_f32 v132,v132,v148
v_add_f32 v133,v133,v149
v_add_f32 v134,v134,v150
v_mfma_f32_16x16x32_bf16 v[36:39],a[212:215],v[104:107],v[36:39]
s_waitcnt lgkmcnt(0)
v_add_f32 v135,v135,v151
v_fma_f32 v168,v128,v152,v168
v_fma_f32 v169,v129,v153,v169
v_mfma_f32_16x16x32_bf16 v[40:43],a[216:219],v[108:111],v[32:35]
v_fma_f32 v170,v130,v154,v170
v_fma_f32 v171,v131,v155,v171
v_fma_f32 v172,v132,v156,v172
v_mfma_f32_16x16x32_bf16 v[44:47],a[220:223],v[108:111],v[36:39]
s_waitcnt vmcnt(2)
v_fma_f32 v173,v133,v157,v173
v_fma_f32 v174,v134,v158,v174
v_fma_f32 v175,v135,v159,v175
v_cvt_pk_bf16_f32 v176,v168,v169
v_cvt_pk_bf16_f32 v177,v170,v171
v_cvt_pk_bf16_f32 v178,v172,v173
v_cvt_pk_bf16_f32 v179,v174,v175
s_and_b32 s64,s66,0xffff8000
buffer_store_dwordx4 v[176:179],v22,s[24:27],s64 offen
s_cmp_eq_u32 s56,1
s_cbranch_scc1 b1_255
buffer_store_dwordx4 v[204:207],v21,s[20:23],s84 offen offset:0
buffer_store_dwordx4 v[204:207],v21,s[20:23],s84 offen offset:1024
b2_256:
s_cmp_eq_u32 s56,1
s_cbranch_scc1 b1_257
buffer_store_dwordx4 v[204:207],v21,s[20:23],s84 offen offset:2048
buffer_store_dwordx4 v[204:207],v21,s[20:23],s84 offen offset:3072
b2_258:
s_cmp_eq_u32 s56,1
s_cbranch_scc1 b1_259
buffer_store_dwordx4 v[204:207],v21,s[20:23],s85 offen offset:0
buffer_store_dwordx4 v[204:207],v21,s[20:23],s85 offen offset:1024
b2_260:
s_mul_i32 s64,s77,32768
s_add_u32 s66,s66,s64
s_mul_i32 s64,s77,6144
s_add_u32 s75,s75,s64
s_cmp_eq_u32 s75,24576
s_cselect_b32 s75,0,s75
s_add_u32 s63,s63,s77
s_mov_b32 s77,0
v_cmp_gt_u32 vcc,s71,v16
s_add_u32 s60,s60,1
endN_245:
s_cbranch_vccnz nb_224
s_mov_b32 m0,s70
s_nop 0
buffer_load_dwordx4 v3,s[20:23],s61 offen offset:0 lds
buffer_load_dwordx4 v3,s[20:23],s61 offen offset:1024 lds
buffer_load_dwordx4 v3,s[20:23],s61 offen offset:2048 lds
buffer_load_dwordx4 v3,s[20:23],s61 offen offset:3072 lds
s_add_u32 m0,s70,4096
s_nop 0
buffer_load_dwordx4 v3,s[20:23],s62 offen offset:0 lds
buffer_load_dwordx4 v3,s[20:23],s62 offen offset:1024 lds
buffer_load_dwordx4 v3,s[20:23],s62 offen offset:2048 lds
s_add_u32 s61,s61,114688
s_add_u32 s62,s62,114688
s_add_u32 s70,s70,32768
s_and_b32 s70,s70,0x1ffff
v_mov_b32 v212,v40
v_mov_b32 v213,v41
v_mov_b32 v214,v42
v_mov_b32 v215,v43
v_mov_b32 v216,v44
v_mov_b32 v217,v45
v_mov_b32 v218,v46
v_mov_b32 v219,v47
s_mov_b32 s77,1
s_branch dec_223
nb_224:
s_nop 3
s_mov_b32 s77,1
s_add_u32 s84,s74,s75
s_add_u32 s85,s84,4096
buffer_load_dwordx4 v[128:131],v0,s[20:23],s84 offen offset:0 sc1
buffer_load_dwordx4 v[132:135],v0,s[20:23],s84 offen offset:1024 sc1
buffer_load_dwordx4 v[136:139],v0,s[20:23],s84 offen offset:2048 sc1
buffer_load_dwordx4 v[140:143],v0,s[20:23],s84 offen offset:3072 sc1
buffer_load_dwordx4 v[144:147],v0,s[20:23],s85 offen offset:0 sc1
buffer_load_dwordx4 v[148:151],v0,s[20:23],s85 offen offset:1024 sc1
s_waitcnt vmcnt(13)
s_cmp_eq_u32 s77,0
s_cselect_b32 s57,2.0,0
v_or_b32 v21,s57,v0
v_or_b32 v22,s57,v18
v_lshlrev_b32 v168,16,v160
v_and_b32 v169,s73,v160
v_lshlrev_b32 v170,16,v161
v_and_b32 v171,s73,v161
v_lshlrev_b32 v172,16,v162
v_and_b32 v173,s73,v162
v_lshlrev_b32 v174,16,v163
v_and_b32 v175,s73,v163
v_lshlrev_b32 v176,16,v164
v_and_b32 v177,s73,v164
v_lshlrev_b32 v178,16,v165
v_and_b32 v179,s73,v165
v_lshlrev_b32 v180,16,v166
v_and_b32 v181,s73,v166
v_lshlrev_b32 v182,16,v167
v_and_b32 v183,s73,v167
v_pk_add_f32 v[40:41],v[40:41],v[176:177]
v_pk_add_f32 v[42:43],v[42:43],v[178:179]
v_pk_add_f32 v[44:45],v[44:45],v[180:181]
v_pk_add_f32 v[46:47],v[46:47],v[182:183]
v_pk_fma_f32 v[168:169],v[40:41],v[152:153],v[168:169]
v_pk_fma_f32 v[170:171],v[42:43],v[154:155],v[170:171]
v_pk_fma_f32 v[172:173],v[44:45],v[156:157],v[172:173]
v_pk_fma_f32 v[174:175],v[46:47],v[158:159],v[174:175]
s_waitcnt vmcnt(0)
s_cmp_eq_u32 s77,0
s_cbranch_scc1 go_272
ck_270:
v_max3_u32 v184,v128,v129,v130
v_max3_u32 v185,v140,v141,v142
v_max3_u32 v184,v184,v131,v132
v_max3_u32 v185,v185,v143,v144
v_max3_u32 v184,v184,v133,v134
v_max3_u32 v185,v185,v145,v146
v_max3_u32 v184,v184,v135,v136
v_max3_u32 v185,v185,v147,v148
v_max3_u32 v184,v184,v137,v138
v_max3_u32 v185,v185,v149,v150
v_max3_u32 v184,v184,v139,v151
v_max_u32 v184,v184,v185
v_cmp_eq_u32 vcc,-1,v184
s_cbranch_vccnz rt_271
go_272:
buffer_load_dword v16,v2,s[20:23],s68 offen sc1
v_pk_add_f32 v[128:129],v[128:129],v[136:137]
v_pk_add_f32 v[130:131],v[130:131],v[138:139]
v_pk_add_f32 v[132:133],v[132:133],v[140:141]
v_pk_add_f32 v[134:135],v[134:135],v[142:143]
v_pk_add_f32 v[128:129],v[128:129],v[144:145]
v_pk_add_f32 v[130:131],v[130:131],v[146:147]
v_pk_add_f32 v[132:133],v[132:133],v[148:149]
v_pk_add_f32 v[134:135],v[134:135],v[150:151]
v_pk_fma_f32 v[168:169],v[128:129],v[152:153],v[168:169]
v_pk_fma_f32 v[170:171],v[130:131],v[154:155],v[170:171]
v_pk_fma_f32 v[172:173],v[132:133],v[156:157],v[172:173]
v_pk_fma_f32 v[174:175],v[134:135],v[158:159],v[174:175]
v_cvt_pk_bf16_f32 v176,v168,v169
v_cvt_pk_bf16_f32 v177,v170,v171
v_cvt_pk_bf16_f32 v178,v172,v173
v_cvt_pk_bf16_f32 v179,v174,v175
s_and_b32 s64,s66,0xffff8000
buffer_store_dwordx4 v[176:179],v22,s[24:27],s64 offen
s_cmp_eq_u32 s56,1
s_cbranch_scc1 b1_264
buffer_store_dwordx4 v[204:207],v21,s[20:23],s84 offen offset:0
buffer_store_dwordx4 v[204:207],v21,s[20:23],s84 offen offset:1024
b2_265:
s_cmp_eq_u32 s56,1
s_cbranch_scc1 b1_266
buffer_store_dwordx4 v[204:207],v21,s[20:23],s84 offen offset:2048
buffer_store_dwordx4 v[204:207],v21,s[20:23],s84 offen offset:3072
b2_267:
s_cmp_eq_u32 s56,1
s_cbranch_scc1 b1_268
buffer_store_dwordx4 v[204:207],v21,s[20:23],s85 offen offset:0
buffer_store_dwordx4 v[204:207],v21,s[20:23],s85 offen offset:1024
b2_269:
s_mul_i32 s64,s77,32768
s_add_u32 s66,s66,s64
s_mul_i32 s64,s77,6144
s_add_u32 s75,s75,s64
s_cmp_eq_u32 s75,24576
s_cselect_b32 s75,0,s75
s_add_u32 s63,s63,s77
s_mov_b32 s77,0
s_waitcnt vmcnt(7)
v_cmp_gt_u32 vcc,s71,v16
s_cbranch_vccz lag_222
s_cmp_ge_u32 s60,128
s_cbranch_scc1 done_170
plp_273:
buffer_load_dword v16,v2,s[20:23],s68 offen sc1
s_waitcnt vmcnt(0)
v_cmp_gt_u32 vcc,s71,v16
s_cbranch_vccz pok_274
s_sleep 4
s_sub_u32 s90,s90,1
s_cmp_gt_i32 s90,0
s_cbranch_scc1 plp_273
pok_274:
s_branch lag_222
b1_195:
s_nop 7
buffer_store_dwordx4 v[40:43],v0,s[20:23],s64 offen offset:0 sc1
buffer_store_dwordx4 v[44:47],v0,s[20:23],s64 offen offset:1024 sc1
s_branch b2_196
b1_198:
s_nop 7
buffer_store_dwordx4 v[40:43],v0,s[20:23],s64 offen offset:0 sc1
buffer_store_dwordx4 v[44:47],v0,s[20:23],s64 offen offset:1024 sc1
s_branch b2_199
b1_200:
s_nop 7
buffer_store_dwordx4 v[40:43],v0,s[20:23],s64 offen offset:0 sc1
buffer_store_dwordx4 v[44:47],v0,s[20:23],s64 offen offset:1024 sc1
s_branch b2_201
b1_202:
s_nop 7
buffer_store_dwordx4 v[40:43],v0,s[20:23],s64 offen offset:0 sc1
buffer_store_dwordx4 v[44:47],v0,s[20:23],s64 offen offset:1024 sc1
s_branch b2_203
b1_227:
s_nop 7
buffer_store_dwordx4 v[204:207],v21,s[20:23],s84 offen offset:0 sc1
buffer_store_dwordx4 v[204:207],v21,s[20:23],s84 offen offset:1024 sc1
s_branch b2_228
b1_229:
s_nop 7
buffer_store_dwordx4 v[204:207],v21,s[20:23],s84 offen offset:2048 sc1
buffer_store_dwordx4 v[204:207],v21,s[20:23],s84 offen offset:3072 sc1
s_branch b2_230
b1_231:
s_nop 7
buffer_store_dwordx4 v[204:207],v21,s[20:23],s85 offen offset:0 sc1
buffer_store_dwordx4 v[204:207],v21,s[20:23],s85 offen offset:1024 sc1
s_branch b2_232
rt_234:
s_sub_u32 s90,s90,1
s_cmp_gt_i32 s90,0
s_cbranch_scc0 go_235
s_add_u32 s84,s74,s75
s_add_u32 s85,s84,4096
buffer_load_dwordx4 v[128:131],v0,s[20:23],s84 offen offset:0 sc1
buffer_load_dwordx4 v[132:135],v0,s[20:23],s84 offen offset:1024 sc1
buffer_load_dwordx4 v[136:139],v0,s[20:23],s84 offen offset:2048 sc1
buffer_load_dwordx4 v[140:143],v0,s[20:23],s84 offen offset:3072 sc1
buffer_load_dwordx4 v[144:147],v0,s[20:23],s85 offen offset:0 sc1
buffer_load_dwordx4 v[148:151],v0,s[20:23],s85 offen offset:1024 sc1
s_waitcnt vmcnt(0)
s_branch ck_233
b1_236:
s_nop 7
buffer_store_dwordx4 v[204:207],v21,s[20:23],s84 offen offset:0 sc1
buffer_store_dwordx4 v[204:207],v21,s[20:23],s84 offen offset:1024 sc1
s_branch b2_237
b1_238:
s_nop 7
buffer_store_dwordx4 v[204:207],v21,s[20:23],s84 offen offset:2048 sc1
buffer_store_dwordx4 v[204:207],v21,s[20:23],s84 offen offset:3072 sc1
s_branch b2_239
b1_240:
s_nop 7
buffer_store_dwordx4 v[204:207],v21,s[20:23],s85 offen offset:0 sc1
buffer_store_dwordx4 v[204:207],v21,s[20:23],s85 offen offset:1024 sc1
s_branch b2_241
rt_243:
s_sub_u32 s90,s90,1
s_cmp_gt_i32 s90,0
s_cbranch_scc0 go_244
s_add_u32 s84,s74,s75
s_add_u32 s85,s84,4096
buffer_load_dwordx4 v[128:131],v0,s[20:23],s84 offen offset:0 sc1
buffer_load_dwordx4 v[132:135],v0,s[20:23],s84 offen offset:1024 sc1
buffer_load_dwordx4 v[136:139],v0,s[20:23],s84 offen offset:2048 sc1
buffer_load_dwordx4 v[140:143],v0,s[20:23],s84 offen offset:3072 sc1
buffer_load_dwordx4 v[144:147],v0,s[20:23],s85 offen offset:0 sc1
buffer_load_dwordx4 v[148:151],v0,s[20:23],s85 offen offset:1024 sc1
s_waitcnt vmcnt(0)
s_branch ck_242
b1_246:
s_nop 7
buffer_store_dwordx4 v[204:207],v21,s[20:23],s84 offen offset:0 sc1
buffer_store_dwordx4 v[204:207],v21,s[20:23],s84 offen offset:1024 sc1
s_branch b2_247
b1_248:
s_nop 7
buffer_store_dwordx4 v[204:207],v21,s[20:23],s84 offen offset:2048 sc1
buffer_store_dwordx4 v[204:207],v21,s[20:23],s84 offen offset:3072 sc1
s_branch b2_249
b1_250:
s_nop 7
buffer_store_dwordx4 v[204:207],v21,s[20:23],s85 offen offset:0 sc1
buffer_store_dwordx4 v[204:207],v21,s[20:23],s85 offen offset:1024 sc1
s_branch b2_251
rt_253:
s_sub_u32 s90,s90,1
s_cmp_gt_i32 s90,0
s_cbranch_scc0 go_254
s_add_u32 s84,s74,s75
s_add_u32 s85,s84,4096
buffer_load_dwordx4 v[128:131],v0,s[20:23],s84 offen offset:0 sc1
buffer_load_dwordx4 v[132:135],v0,s[20:23],s84 offen offset:1024 sc1
buffer_load_dwordx4 v[136:139],v0,s[20:23],s84 offen offset:2048 sc1
buffer_load_dwordx4 v[140:143],v0,s[20:23],s84 offen offset:3072 sc1
buffer_load_dwordx4 v[144:147],v0,s[20:23],s85 offen offset:0 sc1
buffer_load_dwordx4 v[148:151],v0,s[20:23],s85 offen offset:1024 sc1
s_waitcnt vmcnt(0)
s_branch ck_252
b1_255:
s_nop 7
buffer_store_dwordx4 v[204:207],v21,s[20:23],s84 offen offset:0 sc1
buffer_store_dwordx4 v[204:207],v21,s[20:23],s84 offen offset:1024 sc1
s_branch b2_256
b1_257:
s_nop 7
buffer_store_dwordx4 v[204:207],v21,s[20:23],s84 offen offset:2048 sc1
buffer_store_dwordx4 v[204:207],v21,s[20:23],s84 offen offset:3072 sc1
s_branch b2_258
b1_259:
s_nop 7
buffer_store_dwordx4 v[204:207],v21,s[20:23],s85 offen offset:0 sc1
buffer_store_dwordx4 v[204:207],v21,s[20:23],s85 offen offset:1024 sc1
s_branch b2_260
rt_262:
s_sub_u32 s90,s90,1
s_cmp_gt_i32 s90,0
s_cbranch_scc0 go_263
s_add_u32 s84,s74,s75
s_add_u32 s85,s84,4096
buffer_load_dwordx4 v[128:131],v0,s[20:23],s84 offen offset:0 sc1
buffer_load_dwordx4 v[132:135],v0,s[20:23],s84 offen offset:1024 sc1
buffer_load_dwordx4 v[136:139],v0,s[20:23],s84 offen offset:2048 sc1
buffer_load_dwordx4 v[140:143],v0,s[20:23],s84 offen offset:3072 sc1
buffer_load_dwordx4 v[144:147],v0,s[20:23],s85 offen offset:0 sc1
buffer_load_dwordx4 v[148:151],v0,s[20:23],s85 offen offset:1024 sc1
s_waitcnt vmcnt(0)
s_branch ck_261
b1_264:
s_nop 7
buffer_store_dwordx4 v[204:207],v21,s[20:23],s84 offen offset:0 sc1
buffer_store_dwordx4 v[204:207],v21,s[20:23],s84 offen offset:1024 sc1
s_branch b2_265
b1_266:
s_nop 7
buffer_store_dwordx4 v[204:207],v21,s[20:23],s84 offen offset:2048 sc1
buffer_store_dwordx4 v[204:207],v21,s[20:23],s84 offen offset:3072 sc1
s_branch b2_267
b1_268:
s_nop 7
buffer_store_dwordx4 v[204:207],v21,s[20:23],s85 offen offset:0 sc1
buffer_store_dwordx4 v[204:207],v21,s[20:23],s85 offen offset:1024 sc1
s_branch b2_269
rt_271:
s_sub_u32 s90,s90,1
s_cmp_gt_i32 s90,0
s_cbranch_scc0 go_272
s_add_u32 s84,s74,s75
s_add_u32 s85,s84,4096
buffer_load_dwordx4 v[128:131],v0,s[20:23],s84 offen offset:0 sc1
buffer_load_dwordx4 v[132:135],v0,s[20:23],s84 offen offset:1024 sc1
buffer_load_dwordx4 v[136:139],v0,s[20:23],s84 offen offset:2048 sc1
buffer_load_dwordx4 v[140:143],v0,s[20:23],s84 offen offset:3072 sc1
buffer_load_dwordx4 v[144:147],v0,s[20:23],s85 offen offset:0 sc1
buffer_load_dwordx4 v[148:151],v0,s[20:23],s85 offen offset:1024 sc1
s_waitcnt vmcnt(0)
s_branch ck_270
done_170:
s_endpgm
fl_w3:
v_and_b32 v21,15,v1
v_lshrrev_b32 v22,4,v1
v_lshrrev_b32 v23,2,v21
v_and_b32 v24,3,v21
s_lshl_b32 s61,s50,15
v_lshl_add_u32 v25,v22,3,v23
s_load_dwordx2 s[4:5],s[0:1],80
s_mov_b32 s52,0
s_mov_b32 s53,s59
s_mul_i32 s54,s52,7340032
s_lshl_b32 s64,s53,8
s_add_u32 s54,s54,s64
s_lshl_b32 s64,s50,6
s_add_u32 s54,s54,s64
s_waitcnt lgkmcnt(0)
s_mov_b32 s28,s4
s_and_b32 s29,s5,0xffff
s_mov_b32 s30,0x700000
s_mov_b32 s31,0x20000
v_lshrrev_b32 v26,2,v1
v_and_b32 v27,3,v1
v_mul_u32_u24 v16,7168,v26
v_lshl_add_u32 v16,v27,4,v16
v_lshlrev_b32 v17,6,v25
v_lshl_add_u32 v17,v24,4,v17
v_add_u32 v17,s61,v17
s_xor_b32 s62,s50,0
s_mul_i32 s62,s62,1835008
s_add_u32 s62,s62,s54
s_add_u32 m0,s61,0
s_nop 0
buffer_load_dwordx4 v16,s[28:31],s62 offen lds
s_add_u32 s62,s62,114688
s_add_u32 m0,m0,1024
s_waitcnt vmcnt(6)
buffer_load_dwordx4 v16,s[28:31],s62 offen lds
s_add_u32 s62,s62,114688
s_add_u32 m0,m0,1024
s_waitcnt vmcnt(6)
buffer_load_dwordx4 v16,s[28:31],s62 offen lds
s_add_u32 s62,s62,114688
s_add_u32 m0,m0,1024
s_waitcnt vmcnt(6)
buffer_load_dwordx4 v16,s[28:31],s62 offen lds
s_add_u32 s62,s62,114688
s_add_u32 m0,m0,1024
s_waitcnt vmcnt(6)
buffer_load_dwordx4 v16,s[28:31],s62 offen lds
s_add_u32 s62,s62,114688
s_add_u32 m0,m0,1024
s_waitcnt vmcnt(6)
buffer_load_dwordx4 v16,s[28:31],s62 offen lds
s_add_u32 s62,s62,114688
s_add_u32 m0,m0,1024
s_waitcnt vmcnt(6)
buffer_load_dwordx4 v16,s[28:31],s62 offen lds
s_add_u32 s62,s62,114688
s_add_u32 m0,m0,1024
s_waitcnt vmcnt(6)
buffer_load_dwordx4 v16,s[28:31],s62 offen lds
s_add_u32 s62,s62,114688
s_add_u32 m0,m0,1024
s_waitcnt vmcnt(6)
buffer_load_dwordx4 v16,s[28:31],s62 offen lds
s_add_u32 s62,s62,114688
s_add_u32 m0,m0,1024
s_waitcnt vmcnt(6)
buffer_load_dwordx4 v16,s[28:31],s62 offen lds
s_add_u32 s62,s62,114688
s_add_u32 m0,m0,1024
s_waitcnt vmcnt(6)
buffer_load_dwordx4 v16,s[28:31],s62 offen lds
s_add_u32 s62,s62,114688
s_add_u32 m0,m0,1024
s_waitcnt vmcnt(6)
buffer_load_dwordx4 v16,s[28:31],s62 offen lds
s_add_u32 s62,s62,114688
s_add_u32 m0,m0,1024
s_waitcnt vmcnt(6)
buffer_load_dwordx4 v16,s[28:31],s62 offen lds
s_add_u32 s62,s62,114688
s_add_u32 m0,m0,1024
s_waitcnt vmcnt(6)
buffer_load_dwordx4 v16,s[28:31],s62 offen lds
s_add_u32 s62,s62,114688
s_add_u32 m0,m0,1024
s_waitcnt vmcnt(6)
buffer_load_dwordx4 v16,s[28:31],s62 offen lds
s_add_u32 s62,s62,114688
s_add_u32 m0,m0,1024
s_waitcnt vmcnt(6)
buffer_load_dwordx4 v16,s[28:31],s62 offen lds
s_waitcnt vmcnt(6)
s_xor_b32 s62,s50,1
s_mul_i32 s62,s62,1835008
s_add_u32 s62,s62,s54
s_add_u32 m0,s61,16384
s_nop 0
buffer_load_dwordx4 v16,s[28:31],s62 offen lds
s_add_u32 s62,s62,114688
s_add_u32 m0,m0,1024
s_waitcnt vmcnt(6)
buffer_load_dwordx4 v16,s[28:31],s62 offen lds
s_add_u32 s62,s62,114688
s_add_u32 m0,m0,1024
s_waitcnt vmcnt(6)
buffer_load_dwordx4 v16,s[28:31],s62 offen lds
s_add_u32 s62,s62,114688
s_add_u32 m0,m0,1024
s_waitcnt vmcnt(6)
buffer_load_dwordx4 v16,s[28:31],s62 offen lds
s_add_u32 s62,s62,114688
s_add_u32 m0,m0,1024
s_waitcnt vmcnt(6)
buffer_load_dwordx4 v16,s[28:31],s62 offen lds
s_add_u32 s62,s62,114688
s_add_u32 m0,m0,1024
s_waitcnt vmcnt(6)
buffer_load_dwordx4 v16,s[28:31],s62 offen lds
s_add_u32 s62,s62,114688
s_add_u32 m0,m0,1024
s_waitcnt vmcnt(6)
buffer_load_dwordx4 v16,s[28:31],s62 offen lds
s_add_u32 s62,s62,114688
s_add_u32 m0,m0,1024
s_waitcnt vmcnt(6)
buffer_load_dwordx4 v16,s[28:31],s62 offen lds
s_add_u32 s62,s62,114688
s_add_u32 m0,m0,1024
s_waitcnt vmcnt(6)
buffer_load_dwordx4 v16,s[28:31],s62 offen lds
s_add_u32 s62,s62,114688
s_add_u32 m0,m0,1024
s_waitcnt vmcnt(6)
buffer_load_dwordx4 v16,s[28:31],s62 offen lds
s_add_u32 s62,s62,114688
s_add_u32 m0,m0,1024
s_waitcnt vmcnt(6)
buffer_load_dwordx4 v16,s[28:31],s62 offen lds
s_add_u32 s62,s62,114688
s_add_u32 m0,m0,1024
s_waitcnt vmcnt(6)
buffer_load_dwordx4 v16,s[28:31],s62 offen lds
s_add_u32 s62,s62,114688
s_add_u32 m0,m0,1024
s_waitcnt vmcnt(6)
buffer_load_dwordx4 v16,s[28:31],s62 offen lds
s_add_u32 s62,s62,114688
s_add_u32 m0,m0,1024
s_waitcnt vmcnt(6)
buffer_load_dwordx4 v16,s[28:31],s62 offen lds
s_add_u32 s62,s62,114688
s_add_u32 m0,m0,1024
s_waitcnt vmcnt(6)
buffer_load_dwordx4 v16,s[28:31],s62 offen lds
s_add_u32 s62,s62,114688
s_add_u32 m0,m0,1024
s_waitcnt vmcnt(6)
buffer_load_dwordx4 v16,s[28:31],s62 offen lds
s_waitcnt vmcnt(6)
s_waitcnt vmcnt(16)
ds_read_b64_tr_b16 a[0:1],v17 offset:0
ds_read_b64_tr_b16 a[2:3],v17 offset:256
ds_read_b64_tr_b16 a[4:5],v17 offset:8
ds_read_b64_tr_b16 a[6:7],v17 offset:264
ds_read_b64_tr_b16 a[8:9],v17 offset:2048
ds_read_b64_tr_b16 a[10:11],v17 offset:2304
ds_read_b64_tr_b16 a[12:13],v17 offset:2056
ds_read_b64_tr_b16 a[14:15],v17 offset:2312
ds_read_b64_tr_b16 a[16:17],v17 offset:4096
ds_read_b64_tr_b16 a[18:19],v17 offset:4352
ds_read_b64_tr_b16 a[20:21],v17 offset:4104
ds_read_b64_tr_b16 a[22:23],v17 offset:4360
s_waitcnt lgkmcnt(0)
ds_read_b64_tr_b16 a[24:25],v17 offset:6144
ds_read_b64_tr_b16 a[26:27],v17 offset:6400
ds_read_b64_tr_b16 a[28:29],v17 offset:6152
ds_read_b64_tr_b16 a[30:31],v17 offset:6408
ds_read_b64_tr_b16 a[32:33],v17 offset:8192
ds_read_b64_tr_b16 a[34:35],v17 offset:8448
ds_read_b64_tr_b16 a[36:37],v17 offset:8200
ds_read_b64_tr_b16 a[38:39],v17 offset:8456
ds_read_b64_tr_b16 a[40:41],v17 offset:10240
ds_read_b64_tr_b16 a[42:43],v17 offset:10496
ds_read_b64_tr_b16 a[44:45],v17 offset:10248
ds_read_b64_tr_b16 a[46:47],v17 offset:10504
s_waitcnt lgkmcnt(0)
ds_read_b64_tr_b16 a[48:49],v17 offset:12288
ds_read_b64_tr_b16 a[50:51],v17 offset:12544
ds_read_b64_tr_b16 a[52:53],v17 offset:12296
ds_read_b64_tr_b16 a[54:55],v17 offset:12552
ds_read_b64_tr_b16 a[56:57],v17 offset:14336
ds_read_b64_tr_b16 a[58:59],v17 offset:14592
ds_read_b64_tr_b16 a[60:61],v17 offset:14344
ds_read_b64_tr_b16 a[62:63],v17 offset:14600
s_waitcnt lgkmcnt(0)
s_xor_b32 s62,s50,2
s_mul_i32 s62,s62,1835008
s_add_u32 s62,s62,s54
s_add_u32 m0,s61,0
s_nop 0
buffer_load_dwordx4 v16,s[28:31],s62 offen lds
s_add_u32 s62,s62,114688
s_add_u32 m0,m0,1024
s_waitcnt vmcnt(6)
buffer_load_dwordx4 v16,s[28:31],s62 offen lds
s_add_u32 s62,s62,114688
s_add_u32 m0,m0,1024
s_waitcnt vmcnt(6)
buffer_load_dwordx4 v16,s[28:31],s62 offen lds
s_add_u32 s62,s62,114688
s_add_u32 m0,m0,1024
s_waitcnt vmcnt(6)
buffer_load_dwordx4 v16,s[28:31],s62 offen lds
s_add_u32 s62,s62,114688
s_add_u32 m0,m0,1024
s_waitcnt vmcnt(6)
buffer_load_dwordx4 v16,s[28:31],s62 offen lds
s_add_u32 s62,s62,114688
s_add_u32 m0,m0,1024
s_waitcnt vmcnt(6)
buffer_load_dwordx4 v16,s[28:31],s62 offen lds
s_add_u32 s62,s62,114688
s_add_u32 m0,m0,1024
s_waitcnt vmcnt(6)
buffer_load_dwordx4 v16,s[28:31],s62 offen lds
s_add_u32 s62,s62,114688
s_add_u32 m0,m0,1024
s_waitcnt vmcnt(6)
buffer_load_dwordx4 v16,s[28:31],s62 offen lds
s_add_u32 s62,s62,114688
s_add_u32 m0,m0,1024
s_waitcnt vmcnt(6)
buffer_load_dwordx4 v16,s[28:31],s62 offen lds
s_add_u32 s62,s62,114688
s_add_u32 m0,m0,1024
s_waitcnt vmcnt(6)
buffer_load_dwordx4 v16,s[28:31],s62 offen lds
s_add_u32 s62,s62,114688
s_add_u32 m0,m0,1024
s_waitcnt vmcnt(6)
buffer_load_dwordx4 v16,s[28:31],s62 offen lds
s_add_u32 s62,s62,114688
s_add_u32 m0,m0,1024
s_waitcnt vmcnt(6)
buffer_load_dwordx4 v16,s[28:31],s62 offen lds
s_add_u32 s62,s62,114688
s_add_u32 m0,m0,1024
s_waitcnt vmcnt(6)
buffer_load_dwordx4 v16,s[28:31],s62 offen lds
s_add_u32 s62,s62,114688
s_add_u32 m0,m0,1024
s_waitcnt vmcnt(6)
buffer_load_dwordx4 v16,s[28:31],s62 offen lds
s_add_u32 s62,s62,114688
s_add_u32 m0,m0,1024
s_waitcnt vmcnt(6)
buffer_load_dwordx4 v16,s[28:31],s62 offen lds
s_add_u32 s62,s62,114688
s_add_u32 m0,m0,1024
s_waitcnt vmcnt(6)
buffer_load_dwordx4 v16,s[28:31],s62 offen lds
s_waitcnt vmcnt(6)
s_waitcnt vmcnt(16)
ds_read_b64_tr_b16 a[64:65],v17 offset:16384
ds_read_b64_tr_b16 a[66:67],v17 offset:16640
ds_read_b64_tr_b16 a[68:69],v17 offset:16392
ds_read_b64_tr_b16 a[70:71],v17 offset:16648
ds_read_b64_tr_b16 a[72:73],v17 offset:18432
ds_read_b64_tr_b16 a[74:75],v17 offset:18688
ds_read_b64_tr_b16 a[76:77],v17 offset:18440
ds_read_b64_tr_b16 a[78:79],v17 offset:18696
ds_read_b64_tr_b16 a[80:81],v17 offset:20480
ds_read_b64_tr_b16 a[82:83],v17 offset:20736
ds_read_b64_tr_b16 a[84:85],v17 offset:20488
ds_read_b64_tr_b16 a[86:87],v17 offset:20744
s_waitcnt lgkmcnt(0)
ds_read_b64_tr_b16 a[88:89],v17 offset:22528
ds_read_b64_tr_b16 a[90:91],v17 offset:22784
ds_read_b64_tr_b16 a[92:93],v17 offset:22536
ds_read_b64_tr_b16 a[94:95],v17 offset:22792
ds_read_b64_tr_b16 a[96:97],v17 offset:24576
ds_read_b64_tr_b16 a[98:99],v17 offset:24832
ds_read_b64_tr_b16 a[100:101],v17 offset:24584
ds_read_b64_tr_b16 a[102:103],v17 offset:24840
ds_read_b64_tr_b16 a[104:105],v17 offset:26624
ds_read_b64_tr_b16 a[106:107],v17 offset:26880
ds_read_b64_tr_b16 a[108:109],v17 offset:26632
ds_read_b64_tr_b16 a[110:111],v17 offset:26888
s_waitcnt lgkmcnt(0)
ds_read_b64_tr_b16 a[112:113],v17 offset:28672
ds_read_b64_tr_b16 a[114:115],v17 offset:28928
ds_read_b64_tr_b16 a[116:117],v17 offset:28680
ds_read_b64_tr_b16 a[118:119],v17 offset:28936
ds_read_b64_tr_b16 a[120:121],v17 offset:30720
ds_read_b64_tr_b16 a[122:123],v17 offset:30976
ds_read_b64_tr_b16 a[124:125],v17 offset:30728
ds_read_b64_tr_b16 a[126:127],v17 offset:30984
s_waitcnt lgkmcnt(0)
s_xor_b32 s62,s50,3
s_mul_i32 s62,s62,1835008
s_add_u32 s62,s62,s54
s_add_u32 m0,s61,16384
s_nop 0
buffer_load_dwordx4 v16,s[28:31],s62 offen lds
s_add_u32 s62,s62,114688
s_add_u32 m0,m0,1024
s_waitcnt vmcnt(6)
buffer_load_dwordx4 v16,s[28:31],s62 offen lds
s_add_u32 s62,s62,114688
s_add_u32 m0,m0,1024
s_waitcnt vmcnt(6)
buffer_load_dwordx4 v16,s[28:31],s62 offen lds
s_add_u32 s62,s62,114688
s_add_u32 m0,m0,1024
s_waitcnt vmcnt(6)
buffer_load_dwordx4 v16,s[28:31],s62 offen lds
s_add_u32 s62,s62,114688
s_add_u32 m0,m0,1024
s_waitcnt vmcnt(6)
buffer_load_dwordx4 v16,s[28:31],s62 offen lds
s_add_u32 s62,s62,114688
s_add_u32 m0,m0,1024
s_waitcnt vmcnt(6)
buffer_load_dwordx4 v16,s[28:31],s62 offen lds
s_add_u32 s62,s62,114688
s_add_u32 m0,m0,1024
s_waitcnt vmcnt(6)
buffer_load_dwordx4 v16,s[28:31],s62 offen lds
s_add_u32 s62,s62,114688
s_add_u32 m0,m0,1024
s_waitcnt vmcnt(6)
buffer_load_dwordx4 v16,s[28:31],s62 offen lds
s_add_u32 s62,s62,114688
s_add_u32 m0,m0,1024
s_waitcnt vmcnt(6)
buffer_load_dwordx4 v16,s[28:31],s62 offen lds
s_add_u32 s62,s62,114688
s_add_u32 m0,m0,1024
s_waitcnt vmcnt(6)
buffer_load_dwordx4 v16,s[28:31],s62 offen lds
s_add_u32 s62,s62,114688
s_add_u32 m0,m0,1024
s_waitcnt vmcnt(6)
buffer_load_dwordx4 v16,s[28:31],s62 offen lds
s_add_u32 s62,s62,114688
s_add_u32 m0,m0,1024
s_waitcnt vmcnt(6)
buffer_load_dwordx4 v16,s[28:31],s62 offen lds
s_add_u32 s62,s62,114688
s_add_u32 m0,m0,1024
s_waitcnt vmcnt(6)
buffer_load_dwordx4 v16,s[28:31],s62 offen lds
s_add_u32 s62,s62,114688
s_add_u32 m0,m0,1024
s_waitcnt vmcnt(6)
buffer_load_dwordx4 v16,s[28:31],s62 offen lds
s_add_u32 s62,s62,114688
s_add_u32 m0,m0,1024
s_waitcnt vmcnt(6)
buffer_load_dwordx4 v16,s[28:31],s62 offen lds
s_add_u32 s62,s62,114688
s_add_u32 m0,m0,1024
s_waitcnt vmcnt(6)
buffer_load_dwordx4 v16,s[28:31],s62 offen lds
s_waitcnt vmcnt(6)
s_waitcnt vmcnt(16)
ds_read_b64_tr_b16 a[128:129],v17 offset:0
ds_read_b64_tr_b16 a[130:131],v17 offset:256
ds_read_b64_tr_b16 a[132:133],v17 offset:8
ds_read_b64_tr_b16 a[134:135],v17 offset:264
ds_read_b64_tr_b16 a[136:137],v17 offset:2048
ds_read_b64_tr_b16 a[138:139],v17 offset:2304
ds_read_b64_tr_b16 a[140:141],v17 offset:2056
ds_read_b64_tr_b16 a[142:143],v17 offset:2312
ds_read_b64_tr_b16 a[144:145],v17 offset:4096
ds_read_b64_tr_b16 a[146:147],v17 offset:4352
ds_read_b64_tr_b16 a[148:149],v17 offset:4104
ds_read_b64_tr_b16 a[150:151],v17 offset:4360
s_waitcnt lgkmcnt(0)
ds_read_b64_tr_b16 a[152:153],v17 offset:6144
ds_read_b64_tr_b16 a[154:155],v17 offset:6400
ds_read_b64_tr_b16 a[156:157],v17 offset:6152
ds_read_b64_tr_b16 a[158:159],v17 offset:6408
ds_read_b64_tr_b16 a[160:161],v17 offset:8192
ds_read_b64_tr_b16 a[162:163],v17 offset:8448
ds_read_b64_tr_b16 a[164:165],v17 offset:8200
ds_read_b64_tr_b16 a[166:167],v17 offset:8456
ds_read_b64_tr_b16 a[168:169],v17 offset:10240
ds_read_b64_tr_b16 a[170:171],v17 offset:10496
ds_read_b64_tr_b16 a[172:173],v17 offset:10248
ds_read_b64_tr_b16 a[174:175],v17 offset:10504
s_waitcnt lgkmcnt(0)
ds_read_b64_tr_b16 a[176:177],v17 offset:12288
ds_read_b64_tr_b16 a[178:179],v17 offset:12544
ds_read_b64_tr_b16 a[180:181],v17 offset:12296
ds_read_b64_tr_b16 a[182:183],v17 offset:12552
ds_read_b64_tr_b16 a[184:185],v17 offset:14336
ds_read_b64_tr_b16 a[186:187],v17 offset:14592
ds_read_b64_tr_b16 a[188:189],v17 offset:14344
ds_read_b64_tr_b16 a[190:191],v17 offset:14600
s_waitcnt lgkmcnt(0)
s_waitcnt vmcnt(0)
ds_read_b64_tr_b16 a[192:193],v17 offset:16384
ds_read_b64_tr_b16 a[194:195],v17 offset:16640
ds_read_b64_tr_b16 a[196:197],v17 offset:16392
ds_read_b64_tr_b16 a[198:199],v17 offset:16648
ds_read_b64_tr_b16 a[200:201],v17 offset:18432
ds_read_b64_tr_b16 a[202:203],v17 offset:18688
ds_read_b64_tr_b16 a[204:205],v17 offset:18440
ds_read_b64_tr_b16 a[206:207],v17 offset:18696
ds_read_b64_tr_b16 a[208:209],v17 offset:20480
ds_read_b64_tr_b16 a[210:211],v17 offset:20736
ds_read_b64_tr_b16 a[212:213],v17 offset:20488
ds_read_b64_tr_b16 a[214:215],v17 offset:20744
s_waitcnt lgkmcnt(0)
ds_read_b64_tr_b16 a[216:217],v17 offset:22528
ds_read_b64_tr_b16 a[218:219],v17 offset:22784
ds_read_b64_tr_b16 a[220:221],v17 offset:22536
ds_read_b64_tr_b16 a[222:223],v17 offset:22792
ds_read_b64_tr_b16 a[224:225],v17 offset:24576
ds_read_b64_tr_b16 a[226:227],v17 offset:24832
ds_read_b64_tr_b16 a[228:229],v17 offset:24584
ds_read_b64_tr_b16 a[230:231],v17 offset:24840
ds_read_b64_tr_b16 a[232:233],v17 offset:26624
ds_read_b64_tr_b16 a[234:235],v17 offset:26880
ds_read_b64_tr_b16 a[236:237],v17 offset:26632
ds_read_b64_tr_b16 a[238:239],v17 offset:26888
s_waitcnt lgkmcnt(0)
ds_read_b64_tr_b16 a[240:241],v17 offset:28672
ds_read_b64_tr_b16 a[242:243],v17 offset:28928
ds_read_b64_tr_b16 a[244:245],v17 offset:28680
ds_read_b64_tr_b16 a[246:247],v17 offset:28936
ds_read_b64_tr_b16 a[248:249],v17 offset:30720
ds_read_b64_tr_b16 a[250:251],v17 offset:30976
ds_read_b64_tr_b16 a[252:253],v17 offset:30728
ds_read_b64_tr_b16 a[254:255],v17 offset:30984
s_waitcnt lgkmcnt(0)
s_mov_b32 s92,s2
s_and_b32 s93,s3,0xffff
s_mov_b32 s94,0x100
s_mov_b32 s95,0x20000
v_mbcnt_lo_u32_b32 v16,-1,0
v_mbcnt_hi_u32_b32 v16,-1,v16
v_mov_b32 v18,0
v_cmp_eq_u32 vcc,22,v16
s_nop 1
v_cndmask_b32 v18,v18,63,vcc
v_cmp_eq_u32 vcc,17,v16
s_nop 1
v_cndmask_b32 v18,v18,63,vcc
v_cmp_eq_u32 vcc,18,v16
s_nop 1
v_cndmask_b32 v18,v18,1,vcc
v_and_b32 v19,1,v16
v_cmp_eq_u32 vcc,1,v19
v_mov_b32 v19,8192
s_nop 0
v_cndmask_b32 v19,-1,v19,vcc
v_min_u32 v16,31,v16
v_lshlrev_b32 v16,2,v16
s_sub_u32 s66,s88,64
s_cmp_lg_u32 s50,0
s_cbranch_scc1 vot_280
vpoll_276:
buffer_load_dword v17,v16,s[92:95],s66 offen sc1
s_waitcnt vmcnt(0)
s_cmp_lg_u32 s56,2
s_cbranch_scc1 vck_277
v_cmp_eq_u32 vcc,v17,v19
s_and_b32 s64,vcc_lo,0xffff
s_cmp_eq_u32 s64,65535
s_cbranch_scc1 vck_277
s_mov_b32 s65,0
v_readlane_b32 s64,v17,1
s_lshr_b32 s64,s64,8
s_add_u32 s65,s65,s64
v_readlane_b32 s64,v17,3
s_lshr_b32 s64,s64,8
s_add_u32 s65,s65,s64
v_readlane_b32 s64,v17,5
s_lshr_b32 s64,s64,8
s_add_u32 s65,s65,s64
v_readlane_b32 s64,v17,7
s_lshr_b32 s64,s64,8
s_add_u32 s65,s65,s64
v_readlane_b32 s64,v17,9
s_lshr_b32 s64,s64,8
s_add_u32 s65,s65,s64
v_readlane_b32 s64,v17,11
s_lshr_b32 s64,s64,8
s_add_u32 s65,s65,s64
v_readlane_b32 s64,v17,13
s_lshr_b32 s64,s64,8
s_add_u32 s65,s65,s64
v_readlane_b32 s64,v17,15
s_lshr_b32 s64,s64,8
s_add_u32 s65,s65,s64
s_cmp_ge_u32 s65,256
s_cbranch_scc1 vok_279
s_branch vrt_278
vck_277:
v_cmp_gt_u32 vcc,v18,v17
s_cbranch_vccz vok_279
vrt_278:
s_sleep 48
s_sub_u32 s90,s90,1
s_cmp_gt_i32 s90,0
s_cbranch_scc1 vpoll_276
vok_279:
v_add_u32 v18,160256,v16
ds_write_b32 v18,v17
s_waitcnt lgkmcnt(0)
vot_280:
s_barrier
v_add_u32 v18,160256,v16
ds_read_b32 v17,v18
s_waitcnt lgkmcnt(0)
s_cmp_lg_u32 s56,2
s_cbranch_scc1 vfin_281
v_cmp_eq_u32 vcc,v17,v19
s_and_b32 s64,vcc_lo,0xffff
s_cmp_eq_u32 s64,65535
s_cbranch_scc1 vfin_281
s_mov_b32 s65,0
v_readlane_b32 s64,v17,1
s_lshr_b32 s64,s64,8
s_add_u32 s65,s65,s64
v_readlane_b32 s64,v17,3
s_lshr_b32 s64,s64,8
s_add_u32 s65,s65,s64
v_readlane_b32 s64,v17,5
s_lshr_b32 s64,s64,8
s_add_u32 s65,s65,s64
v_readlane_b32 s64,v17,7
s_lshr_b32 s64,s64,8
s_add_u32 s65,s65,s64
v_readlane_b32 s64,v17,9
s_lshr_b32 s64,s64,8
s_add_u32 s65,s65,s64
v_readlane_b32 s64,v17,11
s_lshr_b32 s64,s64,8
s_add_u32 s65,s65,s64
v_readlane_b32 s64,v17,13
s_lshr_b32 s64,s64,8
s_add_u32 s65,s65,s64
v_readlane_b32 s64,v17,15
s_lshr_b32 s64,s64,8
s_add_u32 s65,s65,s64
s_cmp_ge_u32 s65,256
s_cbranch_scc1 fl_fb
vfin_281:
s_and_b32 s56,s56,1
s_mov_b32 s67,0
s_barrier
v_lshlrev_b32 v0,4,v1
s_mov_b32 s60,0
s_lshl_b32 s70,s50,13
s_mov_b32 s55,0
v_mov_b32 v3,v0
s_mov_b32 s73,0xffff0000
s_lshl_b32 s64,s52,2
s_add_u32 s64,s64,s50
s_mul_i32 s61,s64,8192
s_add_u32 s61,s61,214958080
s_lshl_b32 s68,s64,8
s_add_u32 s68,s68,138550272
s_lshl_b32 s83,s53,2
s_add_u32 s83,s83,s50
s_mov_b32 s63,0
s_xor_b32 s64,s50,0
s_lshl_b32 s64,s64,13
v_add_u32 v8,s64,v0
v_mov_b32 v4,v8
s_xor_b32 s64,s50,1
s_lshl_b32 s64,s64,13
v_add_u32 v9,s64,v0
v_mov_b32 v5,v9
s_xor_b32 s64,s50,2
s_lshl_b32 s64,s64,13
v_add_u32 v10,s64,v0
v_mov_b32 v6,v10
s_xor_b32 s64,s50,3
s_lshl_b32 s64,s64,13
v_add_u32 v11,s64,v0
v_mov_b32 v7,v11
v_min_u32 v2,7,v1
v_lshlrev_b32 v2,2,v2
s_add_u32 s62,s61,4096
s_lshl_b32 s66,s83,10
s_mul_i32 s65,s83,147
s_lshr_b32 s65,s65,10
s_mul_i32 s69,s65,228
s_lshl_b32 s64,s83,2
s_add_u32 s69,s69,s64
s_add_u32 s69,s69,138551296
s_add_u32 s82,s66,201326592
s_add_u32 s66,s66,219152384
s_lshl_b32 s64,s50,9
s_add_u32 s64,s64,131072
v_lshlrev_b32 v26,3,v1
v_add_u32 v19,s64,v26
v_lshl_add_u32 v26,v23,4,v21
v_lshlrev_b32 v26,3,v26
v_add_u32 v20,131072,v26
s_mov_b32 s74,0x22222222
s_mov_b32 s75,0x22222222
s_mov_b32 s76,0x44444444
s_mov_b32 s77,0x44444444
s_mov_b32 s78,0x88888888
s_mov_b32 s79,0x88888888
v_mov_b32 v208,0xbdd2d3e8
v_mov_b32 v209,0xc0135761
v_mov_b32 v210,1.0
v_mov_b32 v211,1.0
v_mov_b32 v12,0x3f803f80
v_mov_b32 v13,0x3f803f80
v_mov_b32 v14,0x3f803f80
v_mov_b32 v15,0x3f803f80
s_nop 1
v_mfma_f32_16x16x32_bf16 v[152:155],a[0:3],v[12:15],0
v_mfma_f32_16x16x32_bf16 v[156:159],a[4:7],v[12:15],0
v_mfma_f32_16x16x32_bf16 v[152:155],a[8:11],v[12:15],v[152:155]
v_mfma_f32_16x16x32_bf16 v[156:159],a[12:15],v[12:15],v[156:159]
v_mfma_f32_16x16x32_bf16 v[152:155],a[16:19],v[12:15],v[152:155]
v_mfma_f32_16x16x32_bf16 v[156:159],a[20:23],v[12:15],v[156:159]
v_mfma_f32_16x16x32_bf16 v[152:155],a[24:27],v[12:15],v[152:155]
v_mfma_f32_16x16x32_bf16 v[156:159],a[28:31],v[12:15],v[156:159]
v_mfma_f32_16x16x32_bf16 v[152:155],a[32:35],v[12:15],v[152:155]
v_mfma_f32_16x16x32_bf16 v[156:159],a[36:39],v[12:15],v[156:159]
v_mfma_f32_16x16x32_bf16 v[152:155],a[40:43],v[12:15],v[152:155]
v_mfma_f32_16x16x32_bf16 v[156:159],a[44:47],v[12:15],v[156:159]
v_mfma_f32_16x16x32_bf16 v[152:155],a[48:51],v[12:15],v[152:155]
v_mfma_f32_16x16x32_bf16 v[156:159],a[52:55],v[12:15],v[156:159]
v_mfma_f32_16x16x32_bf16 v[152:155],a[56:59],v[12:15],v[152:155]
v_mfma_f32_16x16x32_bf16 v[156:159],a[60:63],v[12:15],v[156:159]
v_mfma_f32_16x16x32_bf16 v[152:155],a[64:67],v[12:15],v[152:155]
v_mfma_f32_16x16x32_bf16 v[156:159],a[68:71],v[12:15],v[156:159]
v_mfma_f32_16x16x32_bf16 v[152:155],a[72:75],v[12:15],v[152:155]
v_mfma_f32_16x16x32_bf16 v[156:159],a[76:79],v[12:15],v[156:159]
v_mfma_f32_16x16x32_bf16 v[152:155],a[80:83],v[12:15],v[152:155]
v_mfma_f32_16x16x32_bf16 v[156:159],a[84:87],v[12:15],v[156:159]
v_mfma_f32_16x16x32_bf16 v[152:155],a[88:91],v[12:15],v[152:155]
v_mfma_f32_16x16x32_bf16 v[156:159],a[92:95],v[12:15],v[156:159]
v_mfma_f32_16x16x32_bf16 v[152:155],a[96:99],v[12:15],v[152:155]
v_mfma_f32_16x16x32_bf16 v[156:159],a[100:103],v[12:15],v[156:159]
v_mfma_f32_16x16x32_bf16 v[152:155],a[104:107],v[12:15],v[152:155]
v_mfma_f32_16x16x32_bf16 v[156:159],a[108:111],v[12:15],v[156:159]
v_mfma_f32_16x16x32_bf16 v[152:155],a[112:115],v[12:15],v[152:155]
v_mfma_f32_16x16x32_bf16 v[156:159],a[116:119],v[12:15],v[156:159]
v_mfma_f32_16x16x32_bf16 v[152:155],a[120:123],v[12:15],v[152:155]
v_mfma_f32_16x16x32_bf16 v[156:159],a[124:127],v[12:15],v[156:159]
v_mfma_f32_16x16x32_bf16 v[152:155],a[128:131],v[12:15],v[152:155]
v_mfma_f32_16x16x32_bf16 v[156:159],a[132:135],v[12:15],v[156:159]
v_mfma_f32_16x16x32_bf16 v[152:155],a[136:139],v[12:15],v[152:155]
v_mfma_f32_16x16x32_bf16 v[156:159],a[140:143],v[12:15],v[156:159]
v_mfma_f32_16x16x32_bf16 v[152:155],a[144:147],v[12:15],v[152:155]
v_mfma_f32_16x16x32_bf16 v[156:159],a[148:151],v[12:15],v[156:159]
v_mfma_f32_16x16x32_bf16 v[152:155],a[152:155],v[12:15],v[152:155]
v_mfma_f32_16x16x32_bf16 v[156:159],a[156:159],v[12:15],v[156:159]
v_mfma_f32_16x16x32_bf16 v[152:155],a[160:163],v[12:15],v[152:155]
v_mfma_f32_16x16x32_bf16 v[156:159],a[164:167],v[12:15],v[156:159]
v_mfma_f32_16x16x32_bf16 v[152:155],a[168:171],v[12:15],v[152:155]
v_mfma_f32_16x16x32_bf16 v[156:159],a[172:175],v[12:15],v[156:159]
v_mfma_f32_16x16x32_bf16 v[152:155],a[176:179],v[12:15],v[152:155]
v_mfma_f32_16x16x32_bf16 v[156:159],a[180:183],v[12:15],v[156:159]
v_mfma_f32_16x16x32_bf16 v[152:155],a[184:187],v[12:15],v[152:155]
v_mfma_f32_16x16x32_bf16 v[156:159],a[188:191],v[12:15],v[156:159]
v_mfma_f32_16x16x32_bf16 v[152:155],a[192:195],v[12:15],v[152:155]
v_mfma_f32_16x16x32_bf16 v[156:159],a[196:199],v[12:15],v[156:159]
v_mfma_f32_16x16x32_bf16 v[152:155],a[200:203],v[12:15],v[152:155]
v_mfma_f32_16x16x32_bf16 v[156:159],a[204:207],v[12:15],v[156:159]
v_mfma_f32_16x16x32_bf16 v[152:155],a[208:211],v[12:15],v[152:155]
v_mfma_f32_16x16x32_bf16 v[156:159],a[212:215],v[12:15],v[156:159]
v_mfma_f32_16x16x32_bf16 v[152:155],a[216:219],v[12:15],v[152:155]
v_mfma_f32_16x16x32_bf16 v[156:159],a[220:223],v[12:15],v[156:159]
v_mfma_f32_16x16x32_bf16 v[152:155],a[224:227],v[12:15],v[152:155]
v_mfma_f32_16x16x32_bf16 v[156:159],a[228:231],v[12:15],v[156:159]
v_mfma_f32_16x16x32_bf16 v[152:155],a[232:235],v[12:15],v[152:155]
v_mfma_f32_16x16x32_bf16 v[156:159],a[236:239],v[12:15],v[156:159]
v_mfma_f32_16x16x32_bf16 v[152:155],a[240:243],v[12:15],v[152:155]
v_mfma_f32_16x16x32_bf16 v[156:159],a[244:247],v[12:15],v[156:159]
v_mfma_f32_16x16x32_bf16 v[152:155],a[248:251],v[12:15],v[152:155]
v_mfma_f32_16x16x32_bf16 v[156:159],a[252:255],v[12:15],v[156:159]
s_add_u32 s71,s60,1
s_add_u32 s53,s60,2
plp_289:
buffer_load_dword v16,v2,s[20:23],s68 offen sc1
s_waitcnt vmcnt(0)
v_cmp_gt_u32 vcc,s71,v16
s_cbranch_vccz pok_290
s_sleep 4
s_sub_u32 s90,s90,1
s_cmp_gt_i32 s90,0
s_cbranch_scc1 plp_289
pok_290:
lag_286:
s_mov_b32 m0,s70
s_nop 0
buffer_load_dwordx4 v3,s[20:23],s61 offen offset:0 lds
buffer_load_dwordx4 v3,s[20:23],s61 offen offset:1024 lds
buffer_load_dwordx4 v3,s[20:23],s61 offen offset:2048 lds
buffer_load_dwordx4 v3,s[20:23],s61 offen offset:3072 lds
s_add_u32 m0,s70,4096
s_nop 0
buffer_load_dwordx4 v3,s[20:23],s62 offen offset:0 lds
buffer_load_dwordx4 v3,s[20:23],s62 offen offset:1024 lds
buffer_load_dwordx4 v3,s[20:23],s62 offen offset:2048 lds
buffer_load_dwordx4 v3,s[20:23],s62 offen offset:3072 lds
s_add_u32 s61,s61,32768
s_add_u32 s62,s62,32768
s_add_u32 s70,s70,32768
s_and_b32 s70,s70,0x1ffff
buffer_load_dword v23,off,s[20:23],s66
dec_287:
v_cmp_gt_u32 vcc,s53,v16
s_cbranch_vccnz BN_285
BR_284:
s_waitcnt vmcnt(8)
ds_read_b128 v[64:67],v4 offset:0
s_waitcnt vmcnt(7)
ds_read_b128 v[68:71],v4 offset:1024
s_waitcnt vmcnt(6)
ds_read_b128 v[72:75],v4 offset:2048
s_waitcnt vmcnt(5)
ds_read_b128 v[76:79],v4 offset:3072
s_waitcnt lgkmcnt(3)
v_mfma_f32_16x16x32_bf16 v[32:35],a[0:3],v[64:67],0
s_add_u32 s71,s60,2
s_add_u32 s53,s60,3
s_mov_b32 s57,s63
v_mfma_f32_16x16x32_bf16 v[36:39],a[4:7],v[64:67],0
v_mfma_f32_16x16x32_bf16 v[48:51],v[12:15],v[64:67],0
v_mfma_f32_16x16x32_bf16 v[52:55],v[64:67],v[64:67],0
s_waitcnt lgkmcnt(2)
s_waitcnt vmcnt(4)
s_mov_b32 m0,s70
ds_read_b128 v[80:83],v4 offset:4096
v_mfma_f32_16x16x32_bf16 v[32:35],a[8:11],v[68:71],v[32:35]
buffer_load_dwordx4 v3,s[20:23],s61 offen offset:0 lds
v_mfma_f32_16x16x32_bf16 v[36:39],a[12:15],v[68:71],v[36:39]
v_mfma_f32_16x16x32_bf16 v[48:51],v[12:15],v[68:71],v[48:51]
v_mfma_f32_16x16x32_bf16 v[52:55],v[68:71],v[68:71],v[52:55]
s_waitcnt lgkmcnt(2)
s_waitcnt vmcnt(4)
ds_read_b128 v[84:87],v4 offset:5120
v_mfma_f32_16x16x32_bf16 v[32:35],a[16:19],v[72:75],v[32:35]
buffer_load_dwordx4 v3,s[20:23],s61 offen offset:1024 lds
v_mfma_f32_16x16x32_bf16 v[36:39],a[20:23],v[72:75],v[36:39]
v_mfma_f32_16x16x32_bf16 v[48:51],v[12:15],v[72:75],v[48:51]
v_mfma_f32_16x16x32_bf16 v[52:55],v[72:75],v[72:75],v[52:55]
s_waitcnt lgkmcnt(2)
s_waitcnt vmcnt(4)
ds_read_b128 v[88:91],v4 offset:6144
v_mfma_f32_16x16x32_bf16 v[32:35],a[24:27],v[76:79],v[32:35]
buffer_load_dwordx4 v3,s[20:23],s61 offen offset:2048 lds
v_mfma_f32_16x16x32_bf16 v[36:39],a[28:31],v[76:79],v[36:39]
v_mfma_f32_16x16x32_bf16 v[48:51],v[12:15],v[76:79],v[48:51]
v_mfma_f32_16x16x32_bf16 v[52:55],v[76:79],v[76:79],v[52:55]
s_waitcnt lgkmcnt(2)
s_waitcnt vmcnt(4)
ds_read_b128 v[92:95],v4 offset:7168
v_mfma_f32_16x16x32_bf16 v[32:35],a[32:35],v[80:83],v[32:35]
buffer_load_dwordx4 v3,s[20:23],s61 offen offset:3072 lds
v_mfma_f32_16x16x32_bf16 v[36:39],a[36:39],v[80:83],v[36:39]
v_mfma_f32_16x16x32_bf16 v[48:51],v[12:15],v[80:83],v[48:51]
v_mfma_f32_16x16x32_bf16 v[52:55],v[80:83],v[80:83],v[52:55]
s_waitcnt lgkmcnt(2)
s_barrier
ds_read_b128 v[96:99],v5 offset:0
v_mfma_f32_16x16x32_bf16 v[32:35],a[40:43],v[84:87],v[32:35]
ds_read_b128 v[100:103],v5 offset:1024
v_mfma_f32_16x16x32_bf16 v[36:39],a[44:47],v[84:87],v[36:39]
ds_read_b128 v[104:107],v5 offset:2048
v_mfma_f32_16x16x32_bf16 v[48:51],v[12:15],v[84:87],v[48:51]
s_add_u32 m0,s70,4096
ds_read_b128 v[108:111],v5 offset:3072
v_mfma_f32_16x16x32_bf16 v[52:55],v[84:87],v[84:87],v[52:55]
s_waitcnt lgkmcnt(5)
buffer_load_dwordx4 v3,s[20:23],s62 offen offset:0 lds
v_mfma_f32_16x16x32_bf16 v[32:35],a[48:51],v[88:91],v[32:35]
ds_read_b128 v[112:115],v5 offset:4096
v_mfma_f32_16x16x32_bf16 v[36:39],a[52:55],v[88:91],v[36:39]
buffer_load_dwordx4 v3,s[20:23],s62 offen offset:1024 lds
v_mfma_f32_16x16x32_bf16 v[48:51],v[12:15],v[88:91],v[48:51]
s_waitcnt vmcnt(6)
v_mov_b32 v17,s57
s_mov_b64 exec,1
buffer_store_dword v17,off,s[20:23],s69 sc1
s_mov_b64 exec,-1
v_mfma_f32_16x16x32_bf16 v[52:55],v[88:91],v[88:91],v[52:55]
s_waitcnt lgkmcnt(5)
v_mfma_f32_16x16x32_bf16 v[32:35],a[56:59],v[92:95],v[32:35]
ds_read_b128 v[116:119],v5 offset:5120
v_mfma_f32_16x16x32_bf16 v[36:39],a[60:63],v[92:95],v[36:39]
buffer_load_dwordx4 v3,s[20:23],s62 offen offset:2048 lds
v_mfma_f32_16x16x32_bf16 v[48:51],v[12:15],v[92:95],v[48:51]
buffer_load_dword v16,v2,s[20:23],s68 offen sc1
v_mfma_f32_16x16x32_bf16 v[52:55],v[92:95],v[92:95],v[52:55]
s_waitcnt lgkmcnt(5)
v_mfma_f32_16x16x32_bf16 v[32:35],a[64:67],v[96:99],v[32:35]
ds_read_b128 v[120:123],v5 offset:6144
v_mfma_f32_16x16x32_bf16 v[36:39],a[68:71],v[96:99],v[36:39]
s_waitcnt lgkmcnt(5)
buffer_load_dwordx4 v3,s[20:23],s62 offen offset:3072 lds
v_mfma_f32_16x16x32_bf16 v[32:35],a[72:75],v[100:103],v[32:35]
ds_read_b128 v[124:127],v5 offset:7168
v_mfma_f32_16x16x32_bf16 v[36:39],a[76:79],v[100:103],v[36:39]
s_waitcnt lgkmcnt(5)
v_mfma_f32_16x16x32_bf16 v[32:35],a[80:83],v[104:107],v[32:35]
ds_read_b128 v[64:67],v6 offset:0
v_cndmask_b32 v49,v52,v53,s[74:75]
v_mfma_f32_16x16x32_bf16 v[36:39],a[84:87],v[104:107],v[36:39]
s_waitcnt lgkmcnt(5)
v_cndmask_b32 v49,v49,v54,s[76:77]
v_cndmask_b32 v49,v49,v55,s[78:79]
v_mfma_f32_16x16x32_bf16 v[32:35],a[88:91],v[108:111],v[32:35]
ds_read_b128 v[68:71],v6 offset:1024
v_mfma_f32_16x16x32_bf16 v[36:39],a[92:95],v[108:111],v[36:39]
s_waitcnt lgkmcnt(5)
ds_write_b64 v19,v[48:49]
v_mfma_f32_16x16x32_bf16 v[32:35],a[96:99],v[112:115],v[32:35]
ds_read_b128 v[72:75],v6 offset:2048
v_mfma_f32_16x16x32_bf16 v[36:39],a[100:103],v[112:115],v[36:39]
s_waitcnt lgkmcnt(6)
v_mfma_f32_16x16x32_bf16 v[32:35],a[104:107],v[116:119],v[32:35]
ds_read_b128 v[76:79],v6 offset:3072
v_mfma_f32_16x16x32_bf16 v[36:39],a[108:111],v[116:119],v[36:39]
s_waitcnt lgkmcnt(6)
v_mfma_f32_16x16x32_bf16 v[32:35],a[112:115],v[120:123],v[32:35]
s_waitcnt lgkmcnt(2)
s_barrier
ds_read_b128 v[80:83],v6 offset:4096
v_mfma_f32_16x16x32_bf16 v[36:39],a[116:119],v[120:123],v[36:39]
ds_read_b64 v[56:57],v20 offset:0
v_mfma_f32_16x16x32_bf16 v[32:35],a[120:123],v[124:127],v[32:35]
ds_read_b128 v[84:87],v6 offset:5120
v_mfma_f32_16x16x32_bf16 v[36:39],a[124:127],v[124:127],v[36:39]
ds_read_b64 v[58:59],v20 offset:512
v_mfma_f32_16x16x32_bf16 v[32:35],a[128:131],v[64:67],v[32:35]
ds_read_b128 v[88:91],v6 offset:6144
v_mfma_f32_16x16x32_bf16 v[36:39],a[132:135],v[64:67],v[36:39]
ds_read_b64 v[60:61],v20 offset:1024
v_mfma_f32_16x16x32_bf16 v[32:35],a[136:139],v[68:71],v[32:35]
ds_read_b128 v[92:95],v6 offset:7168
v_mfma_f32_16x16x32_bf16 v[36:39],a[140:143],v[68:71],v[36:39]
s_waitcnt lgkmcnt(8)
ds_read_b64 v[62:63],v20 offset:1536
v_mfma_f32_16x16x32_bf16 v[32:35],a[144:147],v[72:75],v[32:35]
ds_read_b128 v[96:99],v7 offset:0
v_mfma_f32_16x16x32_bf16 v[36:39],a[148:151],v[72:75],v[36:39]
s_waitcnt lgkmcnt(9)
v_mfma_f32_16x16x32_bf16 v[32:35],a[152:155],v[76:79],v[32:35]
ds_read_b128 v[100:103],v7 offset:1024
v_mfma_f32_16x16x32_bf16 v[36:39],a[156:159],v[76:79],v[36:39]
s_waitcnt lgkmcnt(9)
v_mfma_f32_16x16x32_bf16 v[32:35],a[160:163],v[80:83],v[32:35]
ds_read_b128 v[104:107],v7 offset:2048
v_mfma_f32_16x16x32_bf16 v[36:39],a[164:167],v[80:83],v[36:39]
s_waitcnt lgkmcnt(8)
s_waitcnt lgkmcnt(3)
v_add_f32 v56,v56,v58
v_mfma_f32_16x16x32_bf16 v[32:35],a[168:171],v[84:87],v[32:35]
ds_read_b128 v[108:111],v7 offset:3072
v_add_f32 v57,v57,v59
v_mfma_f32_16x16x32_bf16 v[36:39],a[172:175],v[84:87],v[36:39]
v_add_f32 v60,v60,v62
v_add_f32 v61,v61,v63
v_mfma_f32_16x16x32_bf16 v[32:35],a[176:179],v[88:91],v[32:35]
ds_read_b128 v[112:115],v7 offset:4096
v_add_f32 v56,v56,v60
v_mfma_f32_16x16x32_bf16 v[36:39],a[180:183],v[88:91],v[36:39]
v_add_f32 v57,v57,v61
v_mul_f32 v188,0xba800000,v56
v_mfma_f32_16x16x32_bf16 v[32:35],a[184:187],v[92:95],v[32:35]
ds_read_b128 v[116:119],v7 offset:5120
v_mul_f32 v58,v188,v188
v_mfma_f32_16x16x32_bf16 v[36:39],a[188:191],v[92:95],v[36:39]
s_waitcnt lgkmcnt(5)
v_mul_f32 v57,0x3a800000,v57
v_sub_f32 v57,v57,v58
v_mfma_f32_16x16x32_bf16 v[32:35],a[192:195],v[96:99],v[32:35]
ds_read_b128 v[120:123],v7 offset:6144
v_max_f32 v57,0,v57
v_mfma_f32_16x16x32_bf16 v[36:39],a[196:199],v[96:99],v[36:39]
s_waitcnt lgkmcnt(5)
v_add_f32 v57,0x3727c5ac,v57
v_mfma_f32_16x16x32_bf16 v[32:35],a[200:203],v[100:103],v[32:35]
ds_read_b128 v[124:127],v7 offset:7168
v_mfma_f32_16x16x32_bf16 v[36:39],a[204:207],v[100:103],v[36:39]
s_waitcnt lgkmcnt(5)
v_rsq_f32 v189,v57
v_mfma_f32_16x16x32_bf16 v[32:35],a[208:211],v[104:107],v[32:35]
s_add_u32 s61,s61,32768
s_add_u32 s62,s62,32768
s_add_u32 s70,s70,32768
v_mfma_f32_16x16x32_bf16 v[36:39],a[212:215],v[104:107],v[36:39]
s_waitcnt lgkmcnt(4)
s_and_b32 s70,s70,0x1ffff
s_add_u32 s55,s55,32768
v_mfma_f32_16x16x32_bf16 v[32:35],a[216:219],v[108:111],v[32:35]
s_and_b32 s55,s55,0x1ffff
v_add_u32 v4,s55,v8
v_add_u32 v5,s55,v9
v_mfma_f32_16x16x32_bf16 v[36:39],a[220:223],v[108:111],v[36:39]
s_waitcnt lgkmcnt(3)
v_add_u32 v6,s55,v10
v_add_u32 v7,s55,v11
v_mfma_f32_16x16x32_bf16 v[32:35],a[224:227],v[112:115],v[32:35]
s_waitcnt vmcnt(0)
ds_read_b128 v[64:67],v4 offset:0
v_mfma_f32_16x16x32_bf16 v[36:39],a[228:231],v[112:115],v[36:39]
s_waitcnt lgkmcnt(3)
ds_read_b128 v[68:71],v4 offset:1024
v_mfma_f32_16x16x32_bf16 v[32:35],a[232:235],v[116:119],v[32:35]
ds_read_b128 v[72:75],v4 offset:2048
v_mfma_f32_16x16x32_bf16 v[36:39],a[236:239],v[116:119],v[36:39]
s_waitcnt lgkmcnt(4)
v_mfma_f32_16x16x32_bf16 v[32:35],a[240:243],v[120:123],v[32:35]
v_mfma_f32_16x16x32_bf16 v[36:39],a[244:247],v[120:123],v[36:39]
s_waitcnt lgkmcnt(3)
v_mfma_f32_16x16x32_bf16 v[40:43],a[248:251],v[124:127],v[32:35]
v_mfma_f32_16x16x32_bf16 v[44:47],a[252:255],v[124:127],v[36:39]
v_cmp_gt_u32 vcc,s53,v16
s_add_u32 s60,s60,1
s_cbranch_vccnz WN_283
WR_282:
s_waitcnt lgkmcnt(2)
v_mfma_f32_16x16x32_bf16 v[32:35],a[0:3],v[64:67],0
s_add_u32 s71,s60,2
s_add_u32 s53,s60,3
ds_read_b128 v[76:79],v4 offset:3072
v_mfma_f32_16x16x32_bf16 v[36:39],a[4:7],v[64:67],0
s_mov_b32 s57,s63
ds_read_b128 v[80:83],v4 offset:4096
v_mfma_f32_16x16x32_bf16 v[48:51],v[12:15],v[64:67],0
ds_read_b128 v[84:87],v4 offset:5120
v_fma_f32 v40,v152,v188,v40
v_fma_f32 v41,v153,v188,v41
v_mfma_f32_16x16x32_bf16 v[52:55],v[64:67],v[64:67],0
s_waitcnt lgkmcnt(4)
ds_read_b128 v[88:91],v4 offset:6144
v_mul_f32 v40,v40,v189
v_mul_f32 v41,v41,v189
v_mfma_f32_16x16x32_bf16 v[32:35],a[8:11],v[68:71],v[32:35]
s_mov_b32 m0,s70
ds_read_b128 v[92:95],v4 offset:7168
v_mul_f32 v168,v40,v40
v_mul_f32 v169,v41,v41
v_mfma_f32_16x16x32_bf16 v[36:39],a[12:15],v[68:71],v[36:39]
buffer_load_dwordx4 v3,s[20:23],s61 offen offset:0 lds
v_fma_f32 v168,v168,v208,v209
v_fma_f32 v169,v169,v208,v209
v_mfma_f32_16x16x32_bf16 v[48:51],v[12:15],v[68:71],v[48:51]
v_mul_f32 v168,v168,v40
v_exp_f32 v168,v168
v_mfma_f32_16x16x32_bf16 v[52:55],v[68:71],v[68:71],v[52:55]
s_waitcnt lgkmcnt(5)
buffer_load_dwordx4 v3,s[20:23],s61 offen offset:1024 lds
v_mul_f32 v169,v169,v41
v_add_f32 v168,1.0,v168
v_mfma_f32_16x16x32_bf16 v[32:35],a[16:19],v[72:75],v[32:35]
s_barrier
ds_read_b128 v[96:99],v5 offset:0
v_exp_f32 v169,v169
v_mfma_f32_16x16x32_bf16 v[36:39],a[20:23],v[72:75],v[36:39]
v_rcp_f32 v168,v168
v_add_f32 v169,1.0,v169
v_mfma_f32_16x16x32_bf16 v[48:51],v[12:15],v[72:75],v[48:51]
v_rcp_f32 v169,v169
v_mul_f32 v40,v168,v40
v_mfma_f32_16x16x32_bf16 v[52:55],v[72:75],v[72:75],v[52:55]
s_waitcnt lgkmcnt(5)
buffer_load_dwordx4 v3,s[20:23],s61 offen offset:2048 lds
v_mul_f32 v41,v169,v41
v_fma_f32 v42,v154,v188,v42
v_mfma_f32_16x16x32_bf16 v[32:35],a[24:27],v[76:79],v[32:35]
ds_read_b128 v[100:103],v5 offset:1024
v_fma_f32 v43,v155,v188,v43
v_mul_f32 v42,v42,v189
v_mfma_f32_16x16x32_bf16 v[36:39],a[28:31],v[76:79],v[36:39]
v_mul_f32 v43,v43,v189
v_mul_f32 v170,v42,v42
v_mul_f32 v171,v43,v43
v_mfma_f32_16x16x32_bf16 v[48:51],v[12:15],v[76:79],v[48:51]
v_fma_f32 v170,v170,v208,v209
v_fma_f32 v171,v171,v208,v209
v_mul_f32 v170,v170,v42
v_mfma_f32_16x16x32_bf16 v[52:55],v[76:79],v[76:79],v[52:55]
s_waitcnt lgkmcnt(5)
buffer_load_dwordx4 v3,s[20:23],s61 offen offset:3072 lds
v_exp_f32 v170,v170
v_mfma_f32_16x16x32_bf16 v[32:35],a[32:35],v[80:83],v[32:35]
ds_read_b128 v[104:107],v5 offset:2048
v_mul_f32 v171,v171,v43
v_add_f32 v170,1.0,v170
v_mfma_f32_16x16x32_bf16 v[36:39],a[36:39],v[80:83],v[36:39]
v_exp_f32 v171,v171
v_fma_f32 v44,v156,v188,v44
v_mfma_f32_16x16x32_bf16 v[48:51],v[12:15],v[80:83],v[48:51]
v_rcp_f32 v170,v170
v_add_f32 v171,1.0,v171
v_mfma_f32_16x16x32_bf16 v[52:55],v[80:83],v[80:83],v[52:55]
s_waitcnt lgkmcnt(5)
v_rcp_f32 v171,v171
v_mfma_f32_16x16x32_bf16 v[32:35],a[40:43],v[84:87],v[32:35]
s_add_u32 m0,s70,4096
ds_read_b128 v[108:111],v5 offset:3072
v_mul_f32 v42,v170,v42
v_mfma_f32_16x16x32_bf16 v[36:39],a[44:47],v[84:87],v[36:39]
buffer_load_dwordx4 v3,s[20:23],s62 offen offset:0 lds
v_mul_f32 v43,v171,v43
v_mfma_f32_16x16x32_bf16 v[48:51],v[12:15],v[84:87],v[48:51]
s_waitcnt vmcnt(5)
v_mov_b32 v17,s57
s_mov_b64 exec,1
buffer_store_dword v17,off,s[20:23],s69 sc1
s_mov_b64 exec,-1
v_mfma_f32_16x16x32_bf16 v[52:55],v[84:87],v[84:87],v[52:55]
s_waitcnt lgkmcnt(5)
v_fma_f32 v45,v157,v188,v45
v_mul_f32 v44,v44,v189
v_mfma_f32_16x16x32_bf16 v[32:35],a[48:51],v[88:91],v[32:35]
ds_read_b128 v[112:115],v5 offset:4096
v_mul_f32 v45,v45,v189
v_mfma_f32_16x16x32_bf16 v[36:39],a[52:55],v[88:91],v[36:39]
buffer_load_dwordx4 v3,s[20:23],s62 offen offset:1024 lds
v_mul_f32 v172,v44,v44
v_mfma_f32_16x16x32_bf16 v[48:51],v[12:15],v[88:91],v[48:51]
v_mul_f32 v173,v45,v45
v_fma_f32 v172,v172,v208,v209
v_mfma_f32_16x16x32_bf16 v[52:55],v[88:91],v[88:91],v[52:55]
s_waitcnt lgkmcnt(5)
v_fma_f32 v173,v173,v208,v209
v_mul_f32 v172,v172,v44
v_mfma_f32_16x16x32_bf16 v[32:35],a[56:59],v[92:95],v[32:35]
ds_read_b128 v[116:119],v5 offset:5120
v_mul_f32 v173,v173,v45
v_mfma_f32_16x16x32_bf16 v[36:39],a[60:63],v[92:95],v[36:39]
buffer_load_dwordx4 v3,s[20:23],s62 offen offset:2048 lds
v_fma_f32 v46,v158,v188,v46
v_mfma_f32_16x16x32_bf16 v[48:51],v[12:15],v[92:95],v[48:51]
buffer_load_dword v16,v2,s[20:23],s68 offen sc1
v_fma_f32 v47,v159,v188,v47
v_mfma_f32_16x16x32_bf16 v[52:55],v[92:95],v[92:95],v[52:55]
s_waitcnt lgkmcnt(5)
v_exp_f32 v172,v172
v_mfma_f32_16x16x32_bf16 v[32:35],a[64:67],v[96:99],v[32:35]
ds_read_b128 v[120:123],v5 offset:6144
v_add_f32 v172,1.0,v172
v_mfma_f32_16x16x32_bf16 v[36:39],a[68:71],v[96:99],v[36:39]
s_waitcnt lgkmcnt(5)
buffer_load_dwordx4 v3,s[20:23],s62 offen offset:3072 lds
v_mul_f32 v46,v46,v189
v_mfma_f32_16x16x32_bf16 v[32:35],a[72:75],v[100:103],v[32:35]
ds_read_b128 v[124:127],v5 offset:7168
v_mul_f32 v47,v47,v189
v_mfma_f32_16x16x32_bf16 v[36:39],a[76:79],v[100:103],v[36:39]
s_waitcnt lgkmcnt(5)
v_exp_f32 v173,v173
v_mfma_f32_16x16x32_bf16 v[32:35],a[80:83],v[104:107],v[32:35]
ds_read_b128 v[64:67],v6 offset:0
v_cndmask_b32 v49,v52,v53,s[74:75]
v_mfma_f32_16x16x32_bf16 v[36:39],a[84:87],v[104:107],v[36:39]
s_waitcnt lgkmcnt(5)
v_cndmask_b32 v49,v49,v54,s[76:77]
v_cndmask_b32 v49,v49,v55,s[78:79]
v_mfma_f32_16x16x32_bf16 v[32:35],a[88:91],v[108:111],v[32:35]
ds_read_b128 v[68:71],v6 offset:1024
v_add_f32 v173,1.0,v173
v_mfma_f32_16x16x32_bf16 v[36:39],a[92:95],v[108:111],v[36:39]
s_waitcnt lgkmcnt(5)
ds_write_b64 v19,v[48:49]
v_mfma_f32_16x16x32_bf16 v[32:35],a[96:99],v[112:115],v[32:35]
ds_read_b128 v[72:75],v6 offset:2048
v_mul_f32 v174,v46,v46
v_mfma_f32_16x16x32_bf16 v[36:39],a[100:103],v[112:115],v[36:39]
s_waitcnt lgkmcnt(6)
v_rcp_f32 v172,v172
v_mfma_f32_16x16x32_bf16 v[32:35],a[104:107],v[116:119],v[32:35]
ds_read_b128 v[76:79],v6 offset:3072
v_mul_f32 v44,v172,v44
v_mfma_f32_16x16x32_bf16 v[36:39],a[108:111],v[116:119],v[36:39]
s_waitcnt lgkmcnt(6)
v_rcp_f32 v173,v173
v_mfma_f32_16x16x32_bf16 v[32:35],a[112:115],v[120:123],v[32:35]
s_waitcnt lgkmcnt(2)
s_barrier
ds_read_b128 v[80:83],v6 offset:4096
v_mfma_f32_16x16x32_bf16 v[36:39],a[116:119],v[120:123],v[36:39]
ds_read_b64 v[56:57],v20 offset:0
v_mul_f32 v45,v173,v45
v_mfma_f32_16x16x32_bf16 v[32:35],a[120:123],v[124:127],v[32:35]
ds_read_b128 v[84:87],v6 offset:5120
v_mul_f32 v175,v47,v47
v_mfma_f32_16x16x32_bf16 v[36:39],a[124:127],v[124:127],v[36:39]
ds_read_b64 v[58:59],v20 offset:512
v_fma_f32 v174,v174,v208,v209
v_mfma_f32_16x16x32_bf16 v[32:35],a[128:131],v[64:67],v[32:35]
ds_read_b128 v[88:91],v6 offset:6144
v_fma_f32 v175,v175,v208,v209
v_mfma_f32_16x16x32_bf16 v[36:39],a[132:135],v[64:67],v[36:39]
ds_read_b64 v[60:61],v20 offset:1024
v_mul_f32 v174,v174,v46
v_mfma_f32_16x16x32_bf16 v[32:35],a[136:139],v[68:71],v[32:35]
ds_read_b128 v[92:95],v6 offset:7168
v_mul_f32 v175,v175,v47
v_mfma_f32_16x16x32_bf16 v[36:39],a[140:143],v[68:71],v[36:39]
s_waitcnt lgkmcnt(8)
ds_read_b64 v[62:63],v20 offset:1536
v_cvt_pk_bf16_f32 v176,v40,v41
v_mfma_f32_16x16x32_bf16 v[32:35],a[144:147],v[72:75],v[32:35]
ds_read_b128 v[96:99],v7 offset:0
v_cvt_pk_bf16_f32 v177,v42,v43
v_mfma_f32_16x16x32_bf16 v[36:39],a[148:151],v[72:75],v[36:39]
s_waitcnt lgkmcnt(9)
v_exp_f32 v174,v174
v_mfma_f32_16x16x32_bf16 v[32:35],a[152:155],v[76:79],v[32:35]
ds_read_b128 v[100:103],v7 offset:1024
v_add_f32 v174,1.0,v174
v_mfma_f32_16x16x32_bf16 v[36:39],a[156:159],v[76:79],v[36:39]
s_waitcnt lgkmcnt(9)
v_exp_f32 v175,v175
v_mfma_f32_16x16x32_bf16 v[32:35],a[160:163],v[80:83],v[32:35]
ds_read_b128 v[104:107],v7 offset:2048
v_add_f32 v175,1.0,v175
v_mfma_f32_16x16x32_bf16 v[36:39],a[164:167],v[80:83],v[36:39]
s_waitcnt lgkmcnt(8)
s_waitcnt lgkmcnt(3)
v_rcp_f32 v174,v174
v_mfma_f32_16x16x32_bf16 v[32:35],a[168:171],v[84:87],v[32:35]
ds_read_b128 v[108:111],v7 offset:3072
v_mul_f32 v46,v174,v46
v_mfma_f32_16x16x32_bf16 v[36:39],a[172:175],v[84:87],v[36:39]
v_rcp_f32 v175,v175
v_mfma_f32_16x16x32_bf16 v[32:35],a[176:179],v[88:91],v[32:35]
ds_read_b128 v[112:115],v7 offset:4096
v_mul_f32 v47,v175,v47
v_mfma_f32_16x16x32_bf16 v[36:39],a[180:183],v[88:91],v[36:39]
v_cvt_pk_bf16_f32 v178,v44,v45
v_cvt_pk_bf16_f32 v179,v46,v47
v_mfma_f32_16x16x32_bf16 v[32:35],a[184:187],v[92:95],v[32:35]
ds_read_b128 v[116:119],v7 offset:5120
v_add_f32 v56,v56,v58
v_mfma_f32_16x16x32_bf16 v[36:39],a[188:191],v[92:95],v[36:39]
s_waitcnt lgkmcnt(5)
buffer_store_dwordx4 v[176:179],v0,s[20:23],s66 offen sc1
v_mfma_f32_16x16x32_bf16 v[32:35],a[192:195],v[96:99],v[32:35]
s_add_u32 s66,s66,114688
s_add_u32 s63,s63,1
ds_read_b128 v[120:123],v7 offset:6144
v_mfma_f32_16x16x32_bf16 v[36:39],a[196:199],v[96:99],v[36:39]
s_waitcnt lgkmcnt(5)
v_add_f32 v57,v57,v59
v_add_f32 v60,v60,v62
v_mfma_f32_16x16x32_bf16 v[32:35],a[200:203],v[100:103],v[32:35]
ds_read_b128 v[124:127],v7 offset:7168
v_add_f32 v61,v61,v63
v_mfma_f32_16x16x32_bf16 v[36:39],a[204:207],v[100:103],v[36:39]
s_waitcnt lgkmcnt(5)
v_add_f32 v56,v56,v60
v_add_f32 v57,v57,v61
v_mfma_f32_16x16x32_bf16 v[32:35],a[208:211],v[104:107],v[32:35]
s_add_u32 s61,s61,32768
v_mul_f32 v188,0xba800000,v56
v_mul_f32 v58,v188,v188
v_mfma_f32_16x16x32_bf16 v[36:39],a[212:215],v[104:107],v[36:39]
s_waitcnt lgkmcnt(4)
v_mul_f32 v57,0x3a800000,v57
v_sub_f32 v57,v57,v58
v_mfma_f32_16x16x32_bf16 v[32:35],a[216:219],v[108:111],v[32:35]
s_add_u32 s62,s62,32768
v_max_f32 v57,0,v57
v_add_f32 v57,0x3727c5ac,v57
v_mfma_f32_16x16x32_bf16 v[36:39],a[220:223],v[108:111],v[36:39]
s_waitcnt lgkmcnt(3)
v_rsq_f32 v189,v57
v_mfma_f32_16x16x32_bf16 v[32:35],a[224:227],v[112:115],v[32:35]
s_add_u32 s70,s70,32768
s_and_b32 s70,s70,0x1ffff
s_add_u32 s55,s55,32768
v_mfma_f32_16x16x32_bf16 v[36:39],a[228:231],v[112:115],v[36:39]
s_waitcnt lgkmcnt(2)
s_and_b32 s55,s55,0x1ffff
v_add_u32 v4,s55,v8
v_mfma_f32_16x16x32_bf16 v[32:35],a[232:235],v[116:119],v[32:35]
v_add_u32 v5,s55,v9
v_add_u32 v6,s55,v10
v_mfma_f32_16x16x32_bf16 v[36:39],a[236:239],v[116:119],v[36:39]
s_waitcnt lgkmcnt(1)
v_add_u32 v7,s55,v11
v_mfma_f32_16x16x32_bf16 v[32:35],a[240:243],v[120:123],v[32:35]
s_waitcnt vmcnt(1)
ds_read_b128 v[64:67],v4 offset:0
v_mfma_f32_16x16x32_bf16 v[36:39],a[244:247],v[120:123],v[36:39]
s_waitcnt lgkmcnt(1)
ds_read_b128 v[68:71],v4 offset:1024
v_mfma_f32_16x16x32_bf16 v[40:43],a[248:251],v[124:127],v[32:35]
ds_read_b128 v[72:75],v4 offset:2048
v_mfma_f32_16x16x32_bf16 v[44:47],a[252:255],v[124:127],v[36:39]
v_cmp_gt_u32 vcc,s53,v16
s_add_u32 s60,s60,1
s_cbranch_vccz WR_282
WN_283:
s_waitcnt lgkmcnt(2)
v_mfma_f32_16x16x32_bf16 v[32:35],a[0:3],v[64:67],0
s_add_u32 s71,s60,2
s_add_u32 s53,s60,3
ds_read_b128 v[76:79],v4 offset:3072
v_mfma_f32_16x16x32_bf16 v[36:39],a[4:7],v[64:67],0
s_mov_b32 s57,s63
ds_read_b128 v[80:83],v4 offset:4096
v_mfma_f32_16x16x32_bf16 v[48:51],v[12:15],v[64:67],0
ds_read_b128 v[84:87],v4 offset:5120
v_fma_f32 v40,v152,v188,v40
v_fma_f32 v41,v153,v188,v41
v_mfma_f32_16x16x32_bf16 v[52:55],v[64:67],v[64:67],0
s_waitcnt lgkmcnt(4)
ds_read_b128 v[88:91],v4 offset:6144
v_mul_f32 v40,v40,v189
v_mul_f32 v41,v41,v189
v_mfma_f32_16x16x32_bf16 v[32:35],a[8:11],v[68:71],v[32:35]
ds_read_b128 v[92:95],v4 offset:7168
v_mul_f32 v168,v40,v40
v_mul_f32 v169,v41,v41
v_mfma_f32_16x16x32_bf16 v[36:39],a[12:15],v[68:71],v[36:39]
v_fma_f32 v168,v168,v208,v209
v_fma_f32 v169,v169,v208,v209
v_mul_f32 v168,v168,v40
v_mfma_f32_16x16x32_bf16 v[48:51],v[12:15],v[68:71],v[48:51]
v_exp_f32 v168,v168
v_mul_f32 v169,v169,v41
v_mfma_f32_16x16x32_bf16 v[52:55],v[68:71],v[68:71],v[52:55]
s_waitcnt lgkmcnt(5)
v_exp_f32 v169,v169
v_add_f32 v168,1.0,v168
v_mfma_f32_16x16x32_bf16 v[32:35],a[16:19],v[72:75],v[32:35]
s_barrier
ds_read_b128 v[96:99],v5 offset:0
v_rcp_f32 v168,v168
v_mfma_f32_16x16x32_bf16 v[36:39],a[20:23],v[72:75],v[36:39]
v_add_f32 v169,1.0,v169
v_rcp_f32 v169,v169
v_mfma_f32_16x16x32_bf16 v[48:51],v[12:15],v[72:75],v[48:51]
v_mul_f32 v40,v168,v40
v_mul_f32 v41,v169,v41
v_fma_f32 v42,v154,v188,v42
v_mfma_f32_16x16x32_bf16 v[52:55],v[72:75],v[72:75],v[52:55]
s_waitcnt lgkmcnt(5)
v_fma_f32 v43,v155,v188,v43
v_mul_f32 v42,v42,v189
v_mul_f32 v43,v43,v189
v_mfma_f32_16x16x32_bf16 v[32:35],a[24:27],v[76:79],v[32:35]
ds_read_b128 v[100:103],v5 offset:1024
v_mul_f32 v170,v42,v42
v_mul_f32 v171,v43,v43
v_mfma_f32_16x16x32_bf16 v[36:39],a[28:31],v[76:79],v[36:39]
v_fma_f32 v170,v170,v208,v209
v_fma_f32 v171,v171,v208,v209
v_mul_f32 v170,v170,v42
v_mfma_f32_16x16x32_bf16 v[48:51],v[12:15],v[76:79],v[48:51]
v_exp_f32 v170,v170
v_mul_f32 v171,v171,v43
v_mfma_f32_16x16x32_bf16 v[52:55],v[76:79],v[76:79],v[52:55]
s_waitcnt lgkmcnt(5)
v_exp_f32 v171,v171
v_add_f32 v170,1.0,v170
v_mfma_f32_16x16x32_bf16 v[32:35],a[32:35],v[80:83],v[32:35]
ds_read_b128 v[104:107],v5 offset:2048
v_rcp_f32 v170,v170
v_mfma_f32_16x16x32_bf16 v[36:39],a[36:39],v[80:83],v[36:39]
v_add_f32 v171,1.0,v171
v_mul_f32 v42,v170,v42
v_mfma_f32_16x16x32_bf16 v[48:51],v[12:15],v[80:83],v[48:51]
v_rcp_f32 v171,v171
v_mfma_f32_16x16x32_bf16 v[52:55],v[80:83],v[80:83],v[52:55]
s_waitcnt lgkmcnt(5)
v_mul_f32 v43,v171,v43
v_fma_f32 v44,v156,v188,v44
v_mfma_f32_16x16x32_bf16 v[32:35],a[40:43],v[84:87],v[32:35]
ds_read_b128 v[108:111],v5 offset:3072
v_fma_f32 v45,v157,v188,v45
v_mfma_f32_16x16x32_bf16 v[36:39],a[44:47],v[84:87],v[36:39]
s_waitcnt vmcnt(0)
v_mov_b32 v17,s57
s_mov_b64 exec,1
buffer_store_dword v17,off,s[20:23],s69 sc1
s_mov_b64 exec,-1
v_mfma_f32_16x16x32_bf16 v[48:51],v[12:15],v[84:87],v[48:51]
v_mul_f32 v44,v44,v189
v_mul_f32 v45,v45,v189
v_mfma_f32_16x16x32_bf16 v[52:55],v[84:87],v[84:87],v[52:55]
s_waitcnt lgkmcnt(5)
v_mul_f32 v172,v44,v44
v_mul_f32 v173,v45,v45
v_mfma_f32_16x16x32_bf16 v[32:35],a[48:51],v[88:91],v[32:35]
ds_read_b128 v[112:115],v5 offset:4096
v_fma_f32 v172,v172,v208,v209
v_mfma_f32_16x16x32_bf16 v[36:39],a[52:55],v[88:91],v[36:39]
v_fma_f32 v173,v173,v208,v209
v_mul_f32 v172,v172,v44
v_mfma_f32_16x16x32_bf16 v[48:51],v[12:15],v[88:91],v[48:51]
v_exp_f32 v172,v172
v_mfma_f32_16x16x32_bf16 v[52:55],v[88:91],v[88:91],v[52:55]
s_waitcnt lgkmcnt(5)
v_mul_f32 v173,v173,v45
v_add_f32 v172,1.0,v172
v_mfma_f32_16x16x32_bf16 v[32:35],a[56:59],v[92:95],v[32:35]
ds_read_b128 v[116:119],v5 offset:5120
v_fma_f32 v46,v158,v188,v46
v_mfma_f32_16x16x32_bf16 v[36:39],a[60:63],v[92:95],v[36:39]
v_exp_f32 v173,v173
v_mfma_f32_16x16x32_bf16 v[48:51],v[12:15],v[92:95],v[48:51]
v_rcp_f32 v172,v172
v_mfma_f32_16x16x32_bf16 v[52:55],v[92:95],v[92:95],v[52:55]
s_waitcnt lgkmcnt(5)
v_add_f32 v173,1.0,v173
v_mul_f32 v44,v172,v44
v_mfma_f32_16x16x32_bf16 v[32:35],a[64:67],v[96:99],v[32:35]
ds_read_b128 v[120:123],v5 offset:6144
v_fma_f32 v47,v159,v188,v47
v_mfma_f32_16x16x32_bf16 v[36:39],a[68:71],v[96:99],v[36:39]
s_waitcnt lgkmcnt(5)
v_rcp_f32 v173,v173
v_mfma_f32_16x16x32_bf16 v[32:35],a[72:75],v[100:103],v[32:35]
ds_read_b128 v[124:127],v5 offset:7168
v_mul_f32 v45,v173,v45
v_mfma_f32_16x16x32_bf16 v[36:39],a[76:79],v[100:103],v[36:39]
s_waitcnt lgkmcnt(5)
v_mul_f32 v46,v46,v189
v_mul_f32 v47,v47,v189
v_mfma_f32_16x16x32_bf16 v[32:35],a[80:83],v[104:107],v[32:35]
ds_read_b128 v[64:67],v6 offset:0
v_cndmask_b32 v49,v52,v53,s[74:75]
v_mfma_f32_16x16x32_bf16 v[36:39],a[84:87],v[104:107],v[36:39]
s_waitcnt lgkmcnt(5)
v_cndmask_b32 v49,v49,v54,s[76:77]
v_cndmask_b32 v49,v49,v55,s[78:79]
v_mfma_f32_16x16x32_bf16 v[32:35],a[88:91],v[108:111],v[32:35]
ds_read_b128 v[68:71],v6 offset:1024
v_mul_f32 v174,v46,v46
v_mfma_f32_16x16x32_bf16 v[36:39],a[92:95],v[108:111],v[36:39]
s_waitcnt lgkmcnt(5)
ds_write_b64 v19,v[48:49]
v_mfma_f32_16x16x32_bf16 v[32:35],a[96:99],v[112:115],v[32:35]
ds_read_b128 v[72:75],v6 offset:2048
v_mul_f32 v175,v47,v47
v_mfma_f32_16x16x32_bf16 v[36:39],a[100:103],v[112:115],v[36:39]
s_waitcnt lgkmcnt(6)
v_fma_f32 v174,v174,v208,v209
v_fma_f32 v175,v175,v208,v209
v_mfma_f32_16x16x32_bf16 v[32:35],a[104:107],v[116:119],v[32:35]
ds_read_b128 v[76:79],v6 offset:3072
v_mul_f32 v174,v174,v46
v_mfma_f32_16x16x32_bf16 v[36:39],a[108:111],v[116:119],v[36:39]
s_waitcnt lgkmcnt(6)
v_exp_f32 v174,v174
v_mfma_f32_16x16x32_bf16 v[32:35],a[112:115],v[120:123],v[32:35]
s_waitcnt lgkmcnt(2)
s_barrier
ds_read_b128 v[80:83],v6 offset:4096
v_mfma_f32_16x16x32_bf16 v[36:39],a[116:119],v[120:123],v[36:39]
ds_read_b64 v[56:57],v20 offset:0
v_mul_f32 v175,v175,v47
v_mfma_f32_16x16x32_bf16 v[32:35],a[120:123],v[124:127],v[32:35]
ds_read_b128 v[84:87],v6 offset:5120
v_add_f32 v174,1.0,v174
v_mfma_f32_16x16x32_bf16 v[36:39],a[124:127],v[124:127],v[36:39]
ds_read_b64 v[58:59],v20 offset:512
v_cvt_pk_bf16_f32 v176,v40,v41
v_mfma_f32_16x16x32_bf16 v[32:35],a[128:131],v[64:67],v[32:35]
ds_read_b128 v[88:91],v6 offset:6144
v_cvt_pk_bf16_f32 v177,v42,v43
v_mfma_f32_16x16x32_bf16 v[36:39],a[132:135],v[64:67],v[36:39]
ds_read_b64 v[60:61],v20 offset:1024
v_cvt_pk_bf16_f32 v178,v44,v45
v_mfma_f32_16x16x32_bf16 v[32:35],a[136:139],v[68:71],v[32:35]
ds_read_b128 v[92:95],v6 offset:7168
v_mfma_f32_16x16x32_bf16 v[36:39],a[140:143],v[68:71],v[36:39]
s_waitcnt lgkmcnt(8)
ds_read_b64 v[62:63],v20 offset:1536
v_mfma_f32_16x16x32_bf16 v[32:35],a[144:147],v[72:75],v[32:35]
ds_read_b128 v[96:99],v7 offset:0
v_mfma_f32_16x16x32_bf16 v[36:39],a[148:151],v[72:75],v[36:39]
s_waitcnt lgkmcnt(9)
buffer_load_dword v16,v2,s[20:23],s68 offen sc1
v_mfma_f32_16x16x32_bf16 v[32:35],a[152:155],v[76:79],v[32:35]
ds_read_b128 v[100:103],v7 offset:1024
v_mfma_f32_16x16x32_bf16 v[36:39],a[156:159],v[76:79],v[36:39]
s_waitcnt lgkmcnt(9)
v_exp_f32 v175,v175
v_mfma_f32_16x16x32_bf16 v[32:35],a[160:163],v[80:83],v[32:35]
ds_read_b128 v[104:107],v7 offset:2048
v_add_f32 v175,1.0,v175
v_mfma_f32_16x16x32_bf16 v[36:39],a[164:167],v[80:83],v[36:39]
s_waitcnt lgkmcnt(8)
s_waitcnt lgkmcnt(3)
v_rcp_f32 v174,v174
v_mfma_f32_16x16x32_bf16 v[32:35],a[168:171],v[84:87],v[32:35]
ds_read_b128 v[108:111],v7 offset:3072
v_mul_f32 v46,v174,v46
v_mfma_f32_16x16x32_bf16 v[36:39],a[172:175],v[84:87],v[36:39]
v_rcp_f32 v175,v175
v_mfma_f32_16x16x32_bf16 v[32:35],a[176:179],v[88:91],v[32:35]
ds_read_b128 v[112:115],v7 offset:4096
v_mul_f32 v47,v175,v47
v_mfma_f32_16x16x32_bf16 v[36:39],a[180:183],v[88:91],v[36:39]
v_cvt_pk_bf16_f32 v179,v46,v47
v_add_f32 v56,v56,v58
v_mfma_f32_16x16x32_bf16 v[32:35],a[184:187],v[92:95],v[32:35]
ds_read_b128 v[116:119],v7 offset:5120
v_add_f32 v57,v57,v59
v_mfma_f32_16x16x32_bf16 v[36:39],a[188:191],v[92:95],v[36:39]
s_waitcnt lgkmcnt(5)
buffer_store_dwordx4 v[176:179],v0,s[20:23],s66 offen sc1
v_mfma_f32_16x16x32_bf16 v[32:35],a[192:195],v[96:99],v[32:35]
s_add_u32 s66,s66,114688
s_add_u32 s63,s63,1
ds_read_b128 v[120:123],v7 offset:6144
v_mfma_f32_16x16x32_bf16 v[36:39],a[196:199],v[96:99],v[36:39]
s_waitcnt lgkmcnt(5)
v_add_f32 v60,v60,v62
v_add_f32 v61,v61,v63
v_mfma_f32_16x16x32_bf16 v[32:35],a[200:203],v[100:103],v[32:35]
ds_read_b128 v[124:127],v7 offset:7168
v_add_f32 v56,v56,v60
v_mfma_f32_16x16x32_bf16 v[36:39],a[204:207],v[100:103],v[36:39]
s_waitcnt lgkmcnt(5)
v_add_f32 v57,v57,v61
v_mul_f32 v188,0xba800000,v56
v_mfma_f32_16x16x32_bf16 v[32:35],a[208:211],v[104:107],v[32:35]
s_add_u32 s55,s55,32768
v_mul_f32 v58,v188,v188
v_mul_f32 v57,0x3a800000,v57
v_mfma_f32_16x16x32_bf16 v[36:39],a[212:215],v[104:107],v[36:39]
s_waitcnt lgkmcnt(4)
v_sub_f32 v57,v57,v58
v_max_f32 v57,0,v57
v_mfma_f32_16x16x32_bf16 v[32:35],a[216:219],v[108:111],v[32:35]
s_and_b32 s55,s55,0x1ffff
v_add_f32 v57,0x3727c5ac,v57
v_add_u32 v4,s55,v8
v_mfma_f32_16x16x32_bf16 v[36:39],a[220:223],v[108:111],v[36:39]
s_waitcnt lgkmcnt(3)
v_rsq_f32 v189,v57
v_mfma_f32_16x16x32_bf16 v[32:35],a[224:227],v[112:115],v[32:35]
v_add_u32 v5,s55,v9
v_add_u32 v6,s55,v10
v_mfma_f32_16x16x32_bf16 v[36:39],a[228:231],v[112:115],v[36:39]
s_waitcnt lgkmcnt(2)
v_add_u32 v7,s55,v11
v_mfma_f32_16x16x32_bf16 v[32:35],a[232:235],v[116:119],v[32:35]
v_mfma_f32_16x16x32_bf16 v[36:39],a[236:239],v[116:119],v[36:39]
s_waitcnt lgkmcnt(1)
v_mfma_f32_16x16x32_bf16 v[32:35],a[240:243],v[120:123],v[32:35]
v_mfma_f32_16x16x32_bf16 v[36:39],a[244:247],v[120:123],v[36:39]
s_waitcnt lgkmcnt(0)
v_mfma_f32_16x16x32_bf16 v[40:43],a[248:251],v[124:127],v[32:35]
v_mfma_f32_16x16x32_bf16 v[44:47],a[252:255],v[124:127],v[36:39]
s_waitcnt vmcnt(1)
v_cmp_gt_u32 vcc,s71,v16
s_add_u32 s60,s60,1
s_branch endN_291
BN_285:
s_waitcnt vmcnt(8)
ds_read_b128 v[64:67],v4 offset:0
s_waitcnt vmcnt(7)
ds_read_b128 v[68:71],v4 offset:1024
s_waitcnt vmcnt(6)
ds_read_b128 v[72:75],v4 offset:2048
s_waitcnt vmcnt(5)
ds_read_b128 v[76:79],v4 offset:3072
s_waitcnt lgkmcnt(3)
v_mfma_f32_16x16x32_bf16 v[32:35],a[0:3],v[64:67],0
s_add_u32 s71,s60,2
s_add_u32 s53,s60,3
s_mov_b32 s57,s63
v_mfma_f32_16x16x32_bf16 v[36:39],a[4:7],v[64:67],0
v_mfma_f32_16x16x32_bf16 v[48:51],v[12:15],v[64:67],0
v_mfma_f32_16x16x32_bf16 v[52:55],v[64:67],v[64:67],0
s_waitcnt lgkmcnt(2)
s_waitcnt vmcnt(4)
ds_read_b128 v[80:83],v4 offset:4096
v_mfma_f32_16x16x32_bf16 v[32:35],a[8:11],v[68:71],v[32:35]
v_mfma_f32_16x16x32_bf16 v[36:39],a[12:15],v[68:71],v[36:39]
v_mfma_f32_16x16x32_bf16 v[48:51],v[12:15],v[68:71],v[48:51]
v_mfma_f32_16x16x32_bf16 v[52:55],v[68:71],v[68:71],v[52:55]
s_waitcnt lgkmcnt(2)
s_waitcnt vmcnt(3)
ds_read_b128 v[84:87],v4 offset:5120
v_mfma_f32_16x16x32_bf16 v[32:35],a[16:19],v[72:75],v[32:35]
v_mfma_f32_16x16x32_bf16 v[36:39],a[20:23],v[72:75],v[36:39]
v_mfma_f32_16x16x32_bf16 v[48:51],v[12:15],v[72:75],v[48:51]
v_mfma_f32_16x16x32_bf16 v[52:55],v[72:75],v[72:75],v[52:55]
s_waitcnt lgkmcnt(2)
s_waitcnt vmcnt(2)
ds_read_b128 v[88:91],v4 offset:6144
v_mfma_f32_16x16x32_bf16 v[32:35],a[24:27],v[76:79],v[32:35]
v_mfma_f32_16x16x32_bf16 v[36:39],a[28:31],v[76:79],v[36:39]
v_mfma_f32_16x16x32_bf16 v[48:51],v[12:15],v[76:79],v[48:51]
v_mfma_f32_16x16x32_bf16 v[52:55],v[76:79],v[76:79],v[52:55]
s_waitcnt lgkmcnt(2)
s_waitcnt vmcnt(1)
ds_read_b128 v[92:95],v4 offset:7168
v_mfma_f32_16x16x32_bf16 v[32:35],a[32:35],v[80:83],v[32:35]
v_mfma_f32_16x16x32_bf16 v[36:39],a[36:39],v[80:83],v[36:39]
v_mfma_f32_16x16x32_bf16 v[48:51],v[12:15],v[80:83],v[48:51]
v_mfma_f32_16x16x32_bf16 v[52:55],v[80:83],v[80:83],v[52:55]
s_waitcnt lgkmcnt(2)
s_barrier
ds_read_b128 v[96:99],v5 offset:0
v_mfma_f32_16x16x32_bf16 v[32:35],a[40:43],v[84:87],v[32:35]
ds_read_b128 v[100:103],v5 offset:1024
v_mfma_f32_16x16x32_bf16 v[36:39],a[44:47],v[84:87],v[36:39]
ds_read_b128 v[104:107],v5 offset:2048
v_mfma_f32_16x16x32_bf16 v[48:51],v[12:15],v[84:87],v[48:51]
ds_read_b128 v[108:111],v5 offset:3072
v_mfma_f32_16x16x32_bf16 v[52:55],v[84:87],v[84:87],v[52:55]
s_waitcnt lgkmcnt(5)
s_waitcnt vmcnt(0)
v_mov_b32 v17,s57
s_mov_b64 exec,1
buffer_store_dword v17,off,s[20:23],s69 sc1
s_mov_b64 exec,-1
v_mfma_f32_16x16x32_bf16 v[32:35],a[48:51],v[88:91],v[32:35]
ds_read_b128 v[112:115],v5 offset:4096
v_mfma_f32_16x16x32_bf16 v[36:39],a[52:55],v[88:91],v[36:39]
v_mfma_f32_16x16x32_bf16 v[48:51],v[12:15],v[88:91],v[48:51]
v_mfma_f32_16x16x32_bf16 v[52:55],v[88:91],v[88:91],v[52:55]
s_waitcnt lgkmcnt(5)
v_mfma_f32_16x16x32_bf16 v[32:35],a[56:59],v[92:95],v[32:35]
ds_read_b128 v[116:119],v5 offset:5120
v_mfma_f32_16x16x32_bf16 v[36:39],a[60:63],v[92:95],v[36:39]
v_mfma_f32_16x16x32_bf16 v[48:51],v[12:15],v[92:95],v[48:51]
v_mfma_f32_16x16x32_bf16 v[52:55],v[92:95],v[92:95],v[52:55]
s_waitcnt lgkmcnt(5)
v_mfma_f32_16x16x32_bf16 v[32:35],a[64:67],v[96:99],v[32:35]
ds_read_b128 v[120:123],v5 offset:6144
v_mfma_f32_16x16x32_bf16 v[36:39],a[68:71],v[96:99],v[36:39]
s_waitcnt lgkmcnt(5)
v_mfma_f32_16x16x32_bf16 v[32:35],a[72:75],v[100:103],v[32:35]
ds_read_b128 v[124:127],v5 offset:7168
v_mfma_f32_16x16x32_bf16 v[36:39],a[76:79],v[100:103],v[36:39]
s_waitcnt lgkmcnt(5)
v_mfma_f32_16x16x32_bf16 v[32:35],a[80:83],v[104:107],v[32:35]
ds_read_b128 v[64:67],v6 offset:0
v_cndmask_b32 v49,v52,v53,s[74:75]
v_mfma_f32_16x16x32_bf16 v[36:39],a[84:87],v[104:107],v[36:39]
s_waitcnt lgkmcnt(5)
v_cndmask_b32 v49,v49,v54,s[76:77]
v_cndmask_b32 v49,v49,v55,s[78:79]
v_mfma_f32_16x16x32_bf16 v[32:35],a[88:91],v[108:111],v[32:35]
ds_read_b128 v[68:71],v6 offset:1024
v_mfma_f32_16x16x32_bf16 v[36:39],a[92:95],v[108:111],v[36:39]
s_waitcnt lgkmcnt(5)
ds_write_b64 v19,v[48:49]
v_mfma_f32_16x16x32_bf16 v[32:35],a[96:99],v[112:115],v[32:35]
ds_read_b128 v[72:75],v6 offset:2048
v_mfma_f32_16x16x32_bf16 v[36:39],a[100:103],v[112:115],v[36:39]
s_waitcnt lgkmcnt(6)
v_mfma_f32_16x16x32_bf16 v[32:35],a[104:107],v[116:119],v[32:35]
ds_read_b128 v[76:79],v6 offset:3072
v_mfma_f32_16x16x32_bf16 v[36:39],a[108:111],v[116:119],v[36:39]
s_waitcnt lgkmcnt(6)
v_mfma_f32_16x16x32_bf16 v[32:35],a[112:115],v[120:123],v[32:35]
s_waitcnt lgkmcnt(2)
s_barrier
ds_read_b128 v[80:83],v6 offset:4096
v_mfma_f32_16x16x32_bf16 v[36:39],a[116:119],v[120:123],v[36:39]
ds_read_b64 v[56:57],v20 offset:0
v_mfma_f32_16x16x32_bf16 v[32:35],a[120:123],v[124:127],v[32:35]
ds_read_b128 v[84:87],v6 offset:5120
v_mfma_f32_16x16x32_bf16 v[36:39],a[124:127],v[124:127],v[36:39]
ds_read_b64 v[58:59],v20 offset:512
v_mfma_f32_16x16x32_bf16 v[32:35],a[128:131],v[64:67],v[32:35]
ds_read_b128 v[88:91],v6 offset:6144
v_mfma_f32_16x16x32_bf16 v[36:39],a[132:135],v[64:67],v[36:39]
ds_read_b64 v[60:61],v20 offset:1024
v_mfma_f32_16x16x32_bf16 v[32:35],a[136:139],v[68:71],v[32:35]
ds_read_b128 v[92:95],v6 offset:7168
v_mfma_f32_16x16x32_bf16 v[36:39],a[140:143],v[68:71],v[36:39]
s_waitcnt lgkmcnt(8)
ds_read_b64 v[62:63],v20 offset:1536
v_mfma_f32_16x16x32_bf16 v[32:35],a[144:147],v[72:75],v[32:35]
ds_read_b128 v[96:99],v7 offset:0
v_mfma_f32_16x16x32_bf16 v[36:39],a[148:151],v[72:75],v[36:39]
s_waitcnt lgkmcnt(9)
buffer_load_dword v16,v2,s[20:23],s68 offen sc1
v_mfma_f32_16x16x32_bf16 v[32:35],a[152:155],v[76:79],v[32:35]
ds_read_b128 v[100:103],v7 offset:1024
v_mfma_f32_16x16x32_bf16 v[36:39],a[156:159],v[76:79],v[36:39]
s_waitcnt lgkmcnt(9)
v_mfma_f32_16x16x32_bf16 v[32:35],a[160:163],v[80:83],v[32:35]
ds_read_b128 v[104:107],v7 offset:2048
v_mfma_f32_16x16x32_bf16 v[36:39],a[164:167],v[80:83],v[36:39]
s_waitcnt lgkmcnt(8)
s_waitcnt lgkmcnt(3)
v_add_f32 v56,v56,v58
v_mfma_f32_16x16x32_bf16 v[32:35],a[168:171],v[84:87],v[32:35]
ds_read_b128 v[108:111],v7 offset:3072
v_add_f32 v57,v57,v59
v_mfma_f32_16x16x32_bf16 v[36:39],a[172:175],v[84:87],v[36:39]
v_add_f32 v60,v60,v62
v_add_f32 v61,v61,v63
v_mfma_f32_16x16x32_bf16 v[32:35],a[176:179],v[88:91],v[32:35]
ds_read_b128 v[112:115],v7 offset:4096
v_add_f32 v56,v56,v60
v_mfma_f32_16x16x32_bf16 v[36:39],a[180:183],v[88:91],v[36:39]
v_add_f32 v57,v57,v61
v_mul_f32 v188,0xba800000,v56
v_mfma_f32_16x16x32_bf16 v[32:35],a[184:187],v[92:95],v[32:35]
ds_read_b128 v[116:119],v7 offset:5120
v_mul_f32 v58,v188,v188
v_mfma_f32_16x16x32_bf16 v[36:39],a[188:191],v[92:95],v[36:39]
s_waitcnt lgkmcnt(5)
v_mul_f32 v57,0x3a800000,v57
v_sub_f32 v57,v57,v58
v_mfma_f32_16x16x32_bf16 v[32:35],a[192:195],v[96:99],v[32:35]
ds_read_b128 v[120:123],v7 offset:6144
v_max_f32 v57,0,v57
v_mfma_f32_16x16x32_bf16 v[36:39],a[196:199],v[96:99],v[36:39]
s_waitcnt lgkmcnt(5)
v_add_f32 v57,0x3727c5ac,v57
v_mfma_f32_16x16x32_bf16 v[32:35],a[200:203],v[100:103],v[32:35]
ds_read_b128 v[124:127],v7 offset:7168
v_mfma_f32_16x16x32_bf16 v[36:39],a[204:207],v[100:103],v[36:39]
s_waitcnt lgkmcnt(5)
v_rsq_f32 v189,v57
v_mfma_f32_16x16x32_bf16 v[32:35],a[208:211],v[104:107],v[32:35]
s_add_u32 s55,s55,32768
s_and_b32 s55,s55,0x1ffff
v_add_u32 v4,s55,v8
v_mfma_f32_16x16x32_bf16 v[36:39],a[212:215],v[104:107],v[36:39]
s_waitcnt lgkmcnt(4)
v_add_u32 v5,s55,v9
v_add_u32 v6,s55,v10
v_mfma_f32_16x16x32_bf16 v[32:35],a[216:219],v[108:111],v[32:35]
v_add_u32 v7,s55,v11
v_mfma_f32_16x16x32_bf16 v[36:39],a[220:223],v[108:111],v[36:39]
s_waitcnt lgkmcnt(3)
v_mfma_f32_16x16x32_bf16 v[32:35],a[224:227],v[112:115],v[32:35]
v_mfma_f32_16x16x32_bf16 v[36:39],a[228:231],v[112:115],v[36:39]
s_waitcnt lgkmcnt(2)
v_mfma_f32_16x16x32_bf16 v[32:35],a[232:235],v[116:119],v[32:35]
v_mfma_f32_16x16x32_bf16 v[36:39],a[236:239],v[116:119],v[36:39]
s_waitcnt lgkmcnt(1)
v_mfma_f32_16x16x32_bf16 v[32:35],a[240:243],v[120:123],v[32:35]
v_mfma_f32_16x16x32_bf16 v[36:39],a[244:247],v[120:123],v[36:39]
s_waitcnt lgkmcnt(0)
v_mfma_f32_16x16x32_bf16 v[40:43],a[248:251],v[124:127],v[32:35]
v_mfma_f32_16x16x32_bf16 v[44:47],a[252:255],v[124:127],v[36:39]
s_waitcnt vmcnt(0)
v_cmp_gt_u32 vcc,s71,v16
s_add_u32 s60,s60,1
endN_291:
s_cbranch_vccnz nb_288
s_mov_b32 m0,s70
s_nop 0
buffer_load_dwordx4 v3,s[20:23],s61 offen offset:0 lds
buffer_load_dwordx4 v3,s[20:23],s61 offen offset:1024 lds
buffer_load_dwordx4 v3,s[20:23],s61 offen offset:2048 lds
buffer_load_dwordx4 v3,s[20:23],s61 offen offset:3072 lds
s_add_u32 m0,s70,4096
s_nop 0
buffer_load_dwordx4 v3,s[20:23],s62 offen offset:0 lds
buffer_load_dwordx4 v3,s[20:23],s62 offen offset:1024 lds
buffer_load_dwordx4 v3,s[20:23],s62 offen offset:2048 lds
buffer_load_dwordx4 v3,s[20:23],s62 offen offset:3072 lds
s_add_u32 s61,s61,32768
s_add_u32 s62,s62,32768
s_add_u32 s70,s70,32768
s_and_b32 s70,s70,0x1ffff
v_pk_fma_f32 v[40:41],v[152:153],v[188:189],v[40:41] op_sel_hi:[1,0,1]
v_pk_fma_f32 v[42:43],v[154:155],v[188:189],v[42:43] op_sel_hi:[1,0,1]
v_pk_fma_f32 v[44:45],v[156:157],v[188:189],v[44:45] op_sel_hi:[1,0,1]
v_pk_fma_f32 v[46:47],v[158:159],v[188:189],v[46:47] op_sel_hi:[1,0,1]
v_pk_mul_f32 v[40:41],v[40:41],v[188:189] op_sel:[0,1] op_sel_hi:[1,1]
v_pk_mul_f32 v[42:43],v[42:43],v[188:189] op_sel:[0,1] op_sel_hi:[1,1]
v_pk_mul_f32 v[44:45],v[44:45],v[188:189] op_sel:[0,1] op_sel_hi:[1,1]
v_pk_mul_f32 v[46:47],v[46:47],v[188:189] op_sel:[0,1] op_sel_hi:[1,1]
v_pk_mul_f32 v[168:169],v[40:41],v[40:41]
v_pk_mul_f32 v[170:171],v[42:43],v[42:43]
v_pk_mul_f32 v[172:173],v[44:45],v[44:45]
v_pk_mul_f32 v[174:175],v[46:47],v[46:47]
s_waitcnt vmcnt(8)
v_mov_b32 v17,s63
s_mov_b64 exec,1
buffer_store_dword v17,off,s[20:23],s69 sc1
s_mov_b64 exec,-1
v_pk_fma_f32 v[168:169],v[168:169],v[208:209],v[208:209] op_sel:[0,0,1] op_sel_hi:[1,0,1]
v_pk_fma_f32 v[170:171],v[170:171],v[208:209],v[208:209] op_sel:[0,0,1] op_sel_hi:[1,0,1]
v_pk_fma_f32 v[172:173],v[172:173],v[208:209],v[208:209] op_sel:[0,0,1] op_sel_hi:[1,0,1]
v_pk_fma_f32 v[174:175],v[174:175],v[208:209],v[208:209] op_sel:[0,0,1] op_sel_hi:[1,0,1]
v_pk_mul_f32 v[168:169],v[168:169],v[40:41]
v_pk_mul_f32 v[170:171],v[170:171],v[42:43]
v_pk_mul_f32 v[172:173],v[172:173],v[44:45]
v_pk_mul_f32 v[174:175],v[174:175],v[46:47]
v_exp_f32 v168,v168
v_exp_f32 v169,v169
v_exp_f32 v170,v170
v_exp_f32 v171,v171
v_exp_f32 v172,v172
v_exp_f32 v173,v173
v_exp_f32 v174,v174
v_exp_f32 v175,v175
v_pk_add_f32 v[168:169],v[168:169],v[210:211]
v_pk_add_f32 v[170:171],v[170:171],v[210:211]
v_pk_add_f32 v[172:173],v[172:173],v[210:211]
v_pk_add_f32 v[174:175],v[174:175],v[210:211]
v_rcp_f32 v168,v168
v_rcp_f32 v169,v169
v_rcp_f32 v170,v170
v_rcp_f32 v171,v171
v_rcp_f32 v172,v172
v_rcp_f32 v173,v173
v_rcp_f32 v174,v174
v_rcp_f32 v175,v175
v_pk_mul_f32 v[40:41],v[168:169],v[40:41]
v_pk_mul_f32 v[42:43],v[170:171],v[42:43]
v_pk_mul_f32 v[44:45],v[172:173],v[44:45]
v_pk_mul_f32 v[46:47],v[174:175],v[46:47]
v_cvt_pk_bf16_f32 v176,v40,v41
v_cvt_pk_bf16_f32 v177,v42,v43
v_cvt_pk_bf16_f32 v178,v44,v45
v_cvt_pk_bf16_f32 v179,v46,v47
buffer_store_dwordx4 v[176:179],v0,s[20:23],s66 offen sc1
s_add_u32 s66,s66,114688
s_add_u32 s63,s63,1
s_branch dec_287
nb_288:
buffer_load_dword v16,v2,s[20:23],s68 offen sc1
s_nop 3
v_pk_fma_f32 v[40:41],v[152:153],v[188:189],v[40:41] op_sel_hi:[1,0,1]
v_pk_fma_f32 v[42:43],v[154:155],v[188:189],v[42:43] op_sel_hi:[1,0,1]
v_pk_fma_f32 v[44:45],v[156:157],v[188:189],v[44:45] op_sel_hi:[1,0,1]
v_pk_fma_f32 v[46:47],v[158:159],v[188:189],v[46:47] op_sel_hi:[1,0,1]
v_pk_mul_f32 v[40:41],v[40:41],v[188:189] op_sel:[0,1] op_sel_hi:[1,1]
v_pk_mul_f32 v[42:43],v[42:43],v[188:189] op_sel:[0,1] op_sel_hi:[1,1]
v_pk_mul_f32 v[44:45],v[44:45],v[188:189] op_sel:[0,1] op_sel_hi:[1,1]
v_pk_mul_f32 v[46:47],v[46:47],v[188:189] op_sel:[0,1] op_sel_hi:[1,1]
v_pk_mul_f32 v[168:169],v[40:41],v[40:41]
v_pk_mul_f32 v[170:171],v[42:43],v[42:43]
v_pk_mul_f32 v[172:173],v[44:45],v[44:45]
v_pk_mul_f32 v[174:175],v[46:47],v[46:47]
s_waitcnt vmcnt(1)
v_mov_b32 v17,s63
s_mov_b64 exec,1
buffer_store_dword v17,off,s[20:23],s69 sc1
s_mov_b64 exec,-1
v_pk_fma_f32 v[168:169],v[168:169],v[208:209],v[208:209] op_sel:[0,0,1] op_sel_hi:[1,0,1]
v_pk_fma_f32 v[170:171],v[170:171],v[208:209],v[208:209] op_sel:[0,0,1] op_sel_hi:[1,0,1]
v_pk_fma_f32 v[172:173],v[172:173],v[208:209],v[208:209] op_sel:[0,0,1] op_sel_hi:[1,0,1]
v_pk_fma_f32 v[174:175],v[174:175],v[208:209],v[208:209] op_sel:[0,0,1] op_sel_hi:[1,0,1]
v_pk_mul_f32 v[168:169],v[168:169],v[40:41]
v_pk_mul_f32 v[170:171],v[170:171],v[42:43]
v_pk_mul_f32 v[172:173],v[172:173],v[44:45]
v_pk_mul_f32 v[174:175],v[174:175],v[46:47]
v_exp_f32 v168,v168
v_exp_f32 v169,v169
v_exp_f32 v170,v170
v_exp_f32 v171,v171
v_exp_f32 v172,v172
v_exp_f32 v173,v173
v_exp_f32 v174,v174
v_exp_f32 v175,v175
v_pk_add_f32 v[168:169],v[168:169],v[210:211]
v_pk_add_f32 v[170:171],v[170:171],v[210:211]
v_pk_add_f32 v[172:173],v[172:173],v[210:211]
v_pk_add_f32 v[174:175],v[174:175],v[210:211]
v_rcp_f32 v168,v168
v_rcp_f32 v169,v169
v_rcp_f32 v170,v170
v_rcp_f32 v171,v171
v_rcp_f32 v172,v172
v_rcp_f32 v173,v173
v_rcp_f32 v174,v174
v_rcp_f32 v175,v175
v_pk_mul_f32 v[40:41],v[168:169],v[40:41]
v_pk_mul_f32 v[42:43],v[170:171],v[42:43]
v_pk_mul_f32 v[44:45],v[172:173],v[44:45]
v_pk_mul_f32 v[46:47],v[174:175],v[46:47]
v_cvt_pk_bf16_f32 v176,v40,v41
v_cvt_pk_bf16_f32 v177,v42,v43
v_cvt_pk_bf16_f32 v178,v44,v45
v_cvt_pk_bf16_f32 v179,v46,v47
buffer_store_dwordx4 v[176:179],v0,s[20:23],s66 offen sc1
s_add_u32 s66,s66,114688
s_add_u32 s63,s63,1
s_waitcnt vmcnt(2)
v_cmp_gt_u32 vcc,s71,v16
s_cbranch_vccz lag_286
s_waitcnt vmcnt(0)
v_mov_b32 v17,s63
s_mov_b64 exec,1
buffer_store_dword v17,off,s[20:23],s69 sc1
s_mov_b64 exec,-1
s_cmp_ge_u32 s60,128
s_cbranch_scc1 done_275
plp_292:
buffer_load_dword v16,v2,s[20:23],s68 offen sc1
s_waitcnt vmcnt(0)
v_cmp_gt_u32 vcc,s71,v16
s_cbranch_vccz pok_293
s_sleep 4
s_sub_u32 s90,s90,1
s_cmp_gt_i32 s90,0
s_cbranch_scc1 plp_292
pok_293:
s_branch lag_286
done_275:
s_endpgm
fl_w1:
v_and_b32 v21,15,v1
v_lshrrev_b32 v22,4,v1
v_lshrrev_b32 v23,2,v21
v_and_b32 v24,3,v21
s_lshl_b32 s61,s50,15
v_lshl_add_u32 v25,v22,3,v23
s_load_dwordx2 s[4:5],s[0:1],64
s_mov_b32 s52,0
s_mov_b32 s53,s59
s_mul_i32 s54,s52,2097152
s_lshl_b32 s64,s53,8
s_add_u32 s54,s54,s64
s_lshl_b32 s64,s50,6
s_add_u32 s54,s54,s64
s_waitcnt lgkmcnt(0)
s_mov_b32 s28,s4
s_and_b32 s29,s5,0xffff
s_mov_b32 s30,0x200000
s_mov_b32 s31,0x20000
v_lshrrev_b32 v26,2,v1
v_and_b32 v27,3,v1
v_mul_u32_u24 v16,2048,v26
v_lshl_add_u32 v16,v27,4,v16
v_lshlrev_b32 v17,6,v25
v_lshl_add_u32 v17,v24,4,v17
v_add_u32 v17,s61,v17
s_xor_b32 s62,s50,0
s_mul_i32 s62,s62,524288
s_add_u32 s62,s62,s54
s_add_u32 m0,s61,0
s_nop 0
buffer_load_dwordx4 v16,s[28:31],s62 offen lds
s_add_u32 s62,s62,32768
s_add_u32 m0,m0,1024
s_waitcnt vmcnt(6)
buffer_load_dwordx4 v16,s[28:31],s62 offen lds
s_add_u32 s62,s62,32768
s_add_u32 m0,m0,1024
s_waitcnt vmcnt(6)
buffer_load_dwordx4 v16,s[28:31],s62 offen lds
s_add_u32 s62,s62,32768
s_add_u32 m0,m0,1024
s_waitcnt vmcnt(6)
buffer_load_dwordx4 v16,s[28:31],s62 offen lds
s_add_u32 s62,s62,32768
s_add_u32 m0,m0,1024
s_waitcnt vmcnt(6)
buffer_load_dwordx4 v16,s[28:31],s62 offen lds
s_add_u32 s62,s62,32768
s_add_u32 m0,m0,1024
s_waitcnt vmcnt(6)
buffer_load_dwordx4 v16,s[28:31],s62 offen lds
s_add_u32 s62,s62,32768
s_add_u32 m0,m0,1024
s_waitcnt vmcnt(6)
buffer_load_dwordx4 v16,s[28:31],s62 offen lds
s_add_u32 s62,s62,32768
s_add_u32 m0,m0,1024
s_waitcnt vmcnt(6)
buffer_load_dwordx4 v16,s[28:31],s62 offen lds
s_add_u32 s62,s62,32768
s_add_u32 m0,m0,1024
s_waitcnt vmcnt(6)
buffer_load_dwordx4 v16,s[28:31],s62 offen lds
s_add_u32 s62,s62,32768
s_add_u32 m0,m0,1024
s_waitcnt vmcnt(6)
buffer_load_dwordx4 v16,s[28:31],s62 offen lds
s_add_u32 s62,s62,32768
s_add_u32 m0,m0,1024
s_waitcnt vmcnt(6)
buffer_load_dwordx4 v16,s[28:31],s62 offen lds
s_add_u32 s62,s62,32768
s_add_u32 m0,m0,1024
s_waitcnt vmcnt(6)
buffer_load_dwordx4 v16,s[28:31],s62 offen lds
s_add_u32 s62,s62,32768
s_add_u32 m0,m0,1024
s_waitcnt vmcnt(6)
buffer_load_dwordx4 v16,s[28:31],s62 offen lds
s_add_u32 s62,s62,32768
s_add_u32 m0,m0,1024
s_waitcnt vmcnt(6)
buffer_load_dwordx4 v16,s[28:31],s62 offen lds
s_add_u32 s62,s62,32768
s_add_u32 m0,m0,1024
s_waitcnt vmcnt(6)
buffer_load_dwordx4 v16,s[28:31],s62 offen lds
s_add_u32 s62,s62,32768
s_add_u32 m0,m0,1024
s_waitcnt vmcnt(6)
buffer_load_dwordx4 v16,s[28:31],s62 offen lds
s_waitcnt vmcnt(6)
s_xor_b32 s62,s50,1
s_mul_i32 s62,s62,524288
s_add_u32 s62,s62,s54
s_add_u32 m0,s61,16384
s_nop 0
buffer_load_dwordx4 v16,s[28:31],s62 offen lds
s_add_u32 s62,s62,32768
s_add_u32 m0,m0,1024
s_waitcnt vmcnt(6)
buffer_load_dwordx4 v16,s[28:31],s62 offen lds
s_add_u32 s62,s62,32768
s_add_u32 m0,m0,1024
s_waitcnt vmcnt(6)
buffer_load_dwordx4 v16,s[28:31],s62 offen lds
s_add_u32 s62,s62,32768
s_add_u32 m0,m0,1024
s_waitcnt vmcnt(6)
buffer_load_dwordx4 v16,s[28:31],s62 offen lds
s_add_u32 s62,s62,32768
s_add_u32 m0,m0,1024
s_waitcnt vmcnt(6)
buffer_load_dwordx4 v16,s[28:31],s62 offen lds
s_add_u32 s62,s62,32768
s_add_u32 m0,m0,1024
s_waitcnt vmcnt(6)
buffer_load_dwordx4 v16,s[28:31],s62 offen lds
s_add_u32 s62,s62,32768
s_add_u32 m0,m0,1024
s_waitcnt vmcnt(6)
buffer_load_dwordx4 v16,s[28:31],s62 offen lds
s_add_u32 s62,s62,32768
s_add_u32 m0,m0,1024
s_waitcnt vmcnt(6)
buffer_load_dwordx4 v16,s[28:31],s62 offen lds
s_add_u32 s62,s62,32768
s_add_u32 m0,m0,1024
s_waitcnt vmcnt(6)
buffer_load_dwordx4 v16,s[28:31],s62 offen lds
s_add_u32 s62,s62,32768
s_add_u32 m0,m0,1024
s_waitcnt vmcnt(6)
buffer_load_dwordx4 v16,s[28:31],s62 offen lds
s_add_u32 s62,s62,32768
s_add_u32 m0,m0,1024
s_waitcnt vmcnt(6)
buffer_load_dwordx4 v16,s[28:31],s62 offen lds
s_add_u32 s62,s62,32768
s_add_u32 m0,m0,1024
s_waitcnt vmcnt(6)
buffer_load_dwordx4 v16,s[28:31],s62 offen lds
s_add_u32 s62,s62,32768
s_add_u32 m0,m0,1024
s_waitcnt vmcnt(6)
buffer_load_dwordx4 v16,s[28:31],s62 offen lds
s_add_u32 s62,s62,32768
s_add_u32 m0,m0,1024
s_waitcnt vmcnt(6)
buffer_load_dwordx4 v16,s[28:31],s62 offen lds
s_add_u32 s62,s62,32768
s_add_u32 m0,m0,1024
s_waitcnt vmcnt(6)
buffer_load_dwordx4 v16,s[28:31],s62 offen lds
s_add_u32 s62,s62,32768
s_add_u32 m0,m0,1024
s_waitcnt vmcnt(6)
buffer_load_dwordx4 v16,s[28:31],s62 offen lds
s_waitcnt vmcnt(6)
s_waitcnt vmcnt(16)
ds_read_b64_tr_b16 a[0:1],v17 offset:0
ds_read_b64_tr_b16 a[2:3],v17 offset:256
ds_read_b64_tr_b16 a[4:5],v17 offset:8
ds_read_b64_tr_b16 a[6:7],v17 offset:264
ds_read_b64_tr_b16 a[8:9],v17 offset:2048
ds_read_b64_tr_b16 a[10:11],v17 offset:2304
ds_read_b64_tr_b16 a[12:13],v17 offset:2056
ds_read_b64_tr_b16 a[14:15],v17 offset:2312
ds_read_b64_tr_b16 a[16:17],v17 offset:4096
ds_read_b64_tr_b16 a[18:19],v17 offset:4352
ds_read_b64_tr_b16 a[20:21],v17 offset:4104
ds_read_b64_tr_b16 a[22:23],v17 offset:4360
s_waitcnt lgkmcnt(0)
ds_read_b64_tr_b16 a[24:25],v17 offset:6144
ds_read_b64_tr_b16 a[26:27],v17 offset:6400
ds_read_b64_tr_b16 a[28:29],v17 offset:6152
ds_read_b64_tr_b16 a[30:31],v17 offset:6408
ds_read_b64_tr_b16 a[32:33],v17 offset:8192
ds_read_b64_tr_b16 a[34:35],v17 offset:8448
ds_read_b64_tr_b16 a[36:37],v17 offset:8200
ds_read_b64_tr_b16 a[38:39],v17 offset:8456
ds_read_b64_tr_b16 a[40:41],v17 offset:10240
ds_read_b64_tr_b16 a[42:43],v17 offset:10496
ds_read_b64_tr_b16 a[44:45],v17 offset:10248
ds_read_b64_tr_b16 a[46:47],v17 offset:10504
s_waitcnt lgkmcnt(0)
ds_read_b64_tr_b16 a[48:49],v17 offset:12288
ds_read_b64_tr_b16 a[50:51],v17 offset:12544
ds_read_b64_tr_b16 a[52:53],v17 offset:12296
ds_read_b64_tr_b16 a[54:55],v17 offset:12552
ds_read_b64_tr_b16 a[56:57],v17 offset:14336
ds_read_b64_tr_b16 a[58:59],v17 offset:14592
ds_read_b64_tr_b16 a[60:61],v17 offset:14344
ds_read_b64_tr_b16 a[62:63],v17 offset:14600
s_waitcnt lgkmcnt(0)
s_xor_b32 s62,s50,2
s_mul_i32 s62,s62,524288
s_add_u32 s62,s62,s54
s_add_u32 m0,s61,0
s_nop 0
buffer_load_dwordx4 v16,s[28:31],s62 offen lds
s_add_u32 s62,s62,32768
s_add_u32 m0,m0,1024
s_waitcnt vmcnt(6)
buffer_load_dwordx4 v16,s[28:31],s62 offen lds
s_add_u32 s62,s62,32768
s_add_u32 m0,m0,1024
s_waitcnt vmcnt(6)
buffer_load_dwordx4 v16,s[28:31],s62 offen lds
s_add_u32 s62,s62,32768
s_add_u32 m0,m0,1024
s_waitcnt vmcnt(6)
buffer_load_dwordx4 v16,s[28:31],s62 offen lds
s_add_u32 s62,s62,32768
s_add_u32 m0,m0,1024
s_waitcnt vmcnt(6)
buffer_load_dwordx4 v16,s[28:31],s62 offen lds
s_add_u32 s62,s62,32768
s_add_u32 m0,m0,1024
s_waitcnt vmcnt(6)
buffer_load_dwordx4 v16,s[28:31],s62 offen lds
s_add_u32 s62,s62,32768
s_add_u32 m0,m0,1024
s_waitcnt vmcnt(6)
buffer_load_dwordx4 v16,s[28:31],s62 offen lds
s_add_u32 s62,s62,32768
s_add_u32 m0,m0,1024
s_waitcnt vmcnt(6)
buffer_load_dwordx4 v16,s[28:31],s62 offen lds
s_add_u32 s62,s62,32768
s_add_u32 m0,m0,1024
s_waitcnt vmcnt(6)
buffer_load_dwordx4 v16,s[28:31],s62 offen lds
s_add_u32 s62,s62,32768
s_add_u32 m0,m0,1024
s_waitcnt vmcnt(6)
buffer_load_dwordx4 v16,s[28:31],s62 offen lds
s_add_u32 s62,s62,32768
s_add_u32 m0,m0,1024
s_waitcnt vmcnt(6)
buffer_load_dwordx4 v16,s[28:31],s62 offen lds
s_add_u32 s62,s62,32768
s_add_u32 m0,m0,1024
s_waitcnt vmcnt(6)
buffer_load_dwordx4 v16,s[28:31],s62 offen lds
s_add_u32 s62,s62,32768
s_add_u32 m0,m0,1024
s_waitcnt vmcnt(6)
buffer_load_dwordx4 v16,s[28:31],s62 offen lds
s_add_u32 s62,s62,32768
s_add_u32 m0,m0,1024
s_waitcnt vmcnt(6)
buffer_load_dwordx4 v16,s[28:31],s62 offen lds
s_add_u32 s62,s62,32768
s_add_u32 m0,m0,1024
s_waitcnt vmcnt(6)
buffer_load_dwordx4 v16,s[28:31],s62 offen lds
s_add_u32 s62,s62,32768
s_add_u32 m0,m0,1024
s_waitcnt vmcnt(6)
buffer_load_dwordx4 v16,s[28:31],s62 offen lds
s_waitcnt vmcnt(6)
s_waitcnt vmcnt(16)
ds_read_b64_tr_b16 a[64:65],v17 offset:16384
ds_read_b64_tr_b16 a[66:67],v17 offset:16640
ds_read_b64_tr_b16 a[68:69],v17 offset:16392
ds_read_b64_tr_b16 a[70:71],v17 offset:16648
ds_read_b64_tr_b16 a[72:73],v17 offset:18432
ds_read_b64_tr_b16 a[74:75],v17 offset:18688
ds_read_b64_tr_b16 a[76:77],v17 offset:18440
ds_read_b64_tr_b16 a[78:79],v17 offset:18696
ds_read_b64_tr_b16 a[80:81],v17 offset:20480
ds_read_b64_tr_b16 a[82:83],v17 offset:20736
ds_read_b64_tr_b16 a[84:85],v17 offset:20488
ds_read_b64_tr_b16 a[86:87],v17 offset:20744
s_waitcnt lgkmcnt(0)
ds_read_b64_tr_b16 a[88:89],v17 offset:22528
ds_read_b64_tr_b16 a[90:91],v17 offset:22784
ds_read_b64_tr_b16 a[92:93],v17 offset:22536
ds_read_b64_tr_b16 a[94:95],v17 offset:22792
ds_read_b64_tr_b16 a[96:97],v17 offset:24576
ds_read_b64_tr_b16 a[98:99],v17 offset:24832
ds_read_b64_tr_b16 a[100:101],v17 offset:24584
ds_read_b64_tr_b16 a[102:103],v17 offset:24840
ds_read_b64_tr_b16 a[104:105],v17 offset:26624
ds_read_b64_tr_b16 a[106:107],v17 offset:26880
ds_read_b64_tr_b16 a[108:109],v17 offset:26632
ds_read_b64_tr_b16 a[110:111],v17 offset:26888
s_waitcnt lgkmcnt(0)
ds_read_b64_tr_b16 a[112:113],v17 offset:28672
ds_read_b64_tr_b16 a[114:115],v17 offset:28928
ds_read_b64_tr_b16 a[116:117],v17 offset:28680
ds_read_b64_tr_b16 a[118:119],v17 offset:28936
ds_read_b64_tr_b16 a[120:121],v17 offset:30720
ds_read_b64_tr_b16 a[122:123],v17 offset:30976
ds_read_b64_tr_b16 a[124:125],v17 offset:30728
ds_read_b64_tr_b16 a[126:127],v17 offset:30984
s_waitcnt lgkmcnt(0)
s_xor_b32 s62,s50,3
s_mul_i32 s62,s62,524288
s_add_u32 s62,s62,s54
s_add_u32 m0,s61,16384
s_nop 0
buffer_load_dwordx4 v16,s[28:31],s62 offen lds
s_add_u32 s62,s62,32768
s_add_u32 m0,m0,1024
s_waitcnt vmcnt(6)
buffer_load_dwordx4 v16,s[28:31],s62 offen lds
s_add_u32 s62,s62,32768
s_add_u32 m0,m0,1024
s_waitcnt vmcnt(6)
buffer_load_dwordx4 v16,s[28:31],s62 offen lds
s_add_u32 s62,s62,32768
s_add_u32 m0,m0,1024
s_waitcnt vmcnt(6)
buffer_load_dwordx4 v16,s[28:31],s62 offen lds
s_add_u32 s62,s62,32768
s_add_u32 m0,m0,1024
s_waitcnt vmcnt(6)
buffer_load_dwordx4 v16,s[28:31],s62 offen lds
s_add_u32 s62,s62,32768
s_add_u32 m0,m0,1024
s_waitcnt vmcnt(6)
buffer_load_dwordx4 v16,s[28:31],s62 offen lds
s_add_u32 s62,s62,32768
s_add_u32 m0,m0,1024
s_waitcnt vmcnt(6)
buffer_load_dwordx4 v16,s[28:31],s62 offen lds
s_add_u32 s62,s62,32768
s_add_u32 m0,m0,1024
s_waitcnt vmcnt(6)
buffer_load_dwordx4 v16,s[28:31],s62 offen lds
s_add_u32 s62,s62,32768
s_add_u32 m0,m0,1024
s_waitcnt vmcnt(6)
buffer_load_dwordx4 v16,s[28:31],s62 offen lds
s_add_u32 s62,s62,32768
s_add_u32 m0,m0,1024
s_waitcnt vmcnt(6)
buffer_load_dwordx4 v16,s[28:31],s62 offen lds
s_add_u32 s62,s62,32768
s_add_u32 m0,m0,1024
s_waitcnt vmcnt(6)
buffer_load_dwordx4 v16,s[28:31],s62 offen lds
s_add_u32 s62,s62,32768
s_add_u32 m0,m0,1024
s_waitcnt vmcnt(6)
buffer_load_dwordx4 v16,s[28:31],s62 offen lds
s_add_u32 s62,s62,32768
s_add_u32 m0,m0,1024
s_waitcnt vmcnt(6)
buffer_load_dwordx4 v16,s[28:31],s62 offen lds
s_add_u32 s62,s62,32768
s_add_u32 m0,m0,1024
s_waitcnt vmcnt(6)
buffer_load_dwordx4 v16,s[28:31],s62 offen lds
s_add_u32 s62,s62,32768
s_add_u32 m0,m0,1024
s_waitcnt vmcnt(6)
buffer_load_dwordx4 v16,s[28:31],s62 offen lds
s_add_u32 s62,s62,32768
s_add_u32 m0,m0,1024
s_waitcnt vmcnt(6)
buffer_load_dwordx4 v16,s[28:31],s62 offen lds
s_waitcnt vmcnt(6)
s_waitcnt vmcnt(16)
ds_read_b64_tr_b16 a[128:129],v17 offset:0
ds_read_b64_tr_b16 a[130:131],v17 offset:256
ds_read_b64_tr_b16 a[132:133],v17 offset:8
ds_read_b64_tr_b16 a[134:135],v17 offset:264
ds_read_b64_tr_b16 a[136:137],v17 offset:2048
ds_read_b64_tr_b16 a[138:139],v17 offset:2304
ds_read_b64_tr_b16 a[140:141],v17 offset:2056
ds_read_b64_tr_b16 a[142:143],v17 offset:2312
ds_read_b64_tr_b16 a[144:145],v17 offset:4096
ds_read_b64_tr_b16 a[146:147],v17 offset:4352
ds_read_b64_tr_b16 a[148:149],v17 offset:4104
ds_read_b64_tr_b16 a[150:151],v17 offset:4360
s_waitcnt lgkmcnt(0)
ds_read_b64_tr_b16 a[152:153],v17 offset:6144
ds_read_b64_tr_b16 a[154:155],v17 offset:6400
ds_read_b64_tr_b16 a[156:157],v17 offset:6152
ds_read_b64_tr_b16 a[158:159],v17 offset:6408
ds_read_b64_tr_b16 a[160:161],v17 offset:8192
ds_read_b64_tr_b16 a[162:163],v17 offset:8448
ds_read_b64_tr_b16 a[164:165],v17 offset:8200
ds_read_b64_tr_b16 a[166:167],v17 offset:8456
ds_read_b64_tr_b16 a[168:169],v17 offset:10240
ds_read_b64_tr_b16 a[170:171],v17 offset:10496
ds_read_b64_tr_b16 a[172:173],v17 offset:10248
ds_read_b64_tr_b16 a[174:175],v17 offset:10504
s_waitcnt lgkmcnt(0)
ds_read_b64_tr_b16 a[176:177],v17 offset:12288
ds_read_b64_tr_b16 a[178:179],v17 offset:12544
ds_read_b64_tr_b16 a[180:181],v17 offset:12296
ds_read_b64_tr_b16 a[182:183],v17 offset:12552
ds_read_b64_tr_b16 a[184:185],v17 offset:14336
ds_read_b64_tr_b16 a[186:187],v17 offset:14592
ds_read_b64_tr_b16 a[188:189],v17 offset:14344
ds_read_b64_tr_b16 a[190:191],v17 offset:14600
s_waitcnt lgkmcnt(0)
s_waitcnt vmcnt(0)
ds_read_b64_tr_b16 a[192:193],v17 offset:16384
ds_read_b64_tr_b16 a[194:195],v17 offset:16640
ds_read_b64_tr_b16 a[196:197],v17 offset:16392
ds_read_b64_tr_b16 a[198:199],v17 offset:16648
ds_read_b64_tr_b16 a[200:201],v17 offset:18432
ds_read_b64_tr_b16 a[202:203],v17 offset:18688
ds_read_b64_tr_b16 a[204:205],v17 offset:18440
ds_read_b64_tr_b16 a[206:207],v17 offset:18696
ds_read_b64_tr_b16 a[208:209],v17 offset:20480
ds_read_b64_tr_b16 a[210:211],v17 offset:20736
ds_read_b64_tr_b16 a[212:213],v17 offset:20488
ds_read_b64_tr_b16 a[214:215],v17 offset:20744
s_waitcnt lgkmcnt(0)
ds_read_b64_tr_b16 a[216:217],v17 offset:22528
ds_read_b64_tr_b16 a[218:219],v17 offset:22784
ds_read_b64_tr_b16 a[220:221],v17 offset:22536
ds_read_b64_tr_b16 a[222:223],v17 offset:22792
ds_read_b64_tr_b16 a[224:225],v17 offset:24576
ds_read_b64_tr_b16 a[226:227],v17 offset:24832
ds_read_b64_tr_b16 a[228:229],v17 offset:24584
ds_read_b64_tr_b16 a[230:231],v17 offset:24840
ds_read_b64_tr_b16 a[232:233],v17 offset:26624
ds_read_b64_tr_b16 a[234:235],v17 offset:26880
ds_read_b64_tr_b16 a[236:237],v17 offset:26632
ds_read_b64_tr_b16 a[238:239],v17 offset:26888
s_waitcnt lgkmcnt(0)
ds_read_b64_tr_b16 a[240:241],v17 offset:28672
ds_read_b64_tr_b16 a[242:243],v17 offset:28928
ds_read_b64_tr_b16 a[244:245],v17 offset:28680
ds_read_b64_tr_b16 a[246:247],v17 offset:28936
ds_read_b64_tr_b16 a[248:249],v17 offset:30720
ds_read_b64_tr_b16 a[250:251],v17 offset:30976
ds_read_b64_tr_b16 a[252:253],v17 offset:30728
ds_read_b64_tr_b16 a[254:255],v17 offset:30984
s_waitcnt lgkmcnt(0)
s_mov_b32 s92,s2
s_and_b32 s93,s3,0xffff
s_mov_b32 s94,0x100
s_mov_b32 s95,0x20000
v_mbcnt_lo_u32_b32 v16,-1,0
v_mbcnt_hi_u32_b32 v16,-1,v16
v_mov_b32 v18,0
v_cmp_eq_u32 vcc,22,v16
s_nop 1
v_cndmask_b32 v18,v18,63,vcc
v_cmp_eq_u32 vcc,17,v16
s_nop 1
v_cndmask_b32 v18,v18,63,vcc
v_cmp_eq_u32 vcc,18,v16
s_nop 1
v_cndmask_b32 v18,v18,1,vcc
v_and_b32 v19,1,v16
v_cmp_eq_u32 vcc,1,v19
v_mov_b32 v19,8192
s_nop 0
v_cndmask_b32 v19,-1,v19,vcc
v_min_u32 v16,31,v16
v_lshlrev_b32 v16,2,v16
s_sub_u32 s66,s88,64
s_cmp_lg_u32 s50,0
s_cbranch_scc1 vot_299
vpoll_295:
buffer_load_dword v17,v16,s[92:95],s66 offen sc1
s_waitcnt vmcnt(0)
s_cmp_lg_u32 s56,2
s_cbranch_scc1 vck_296
v_cmp_eq_u32 vcc,v17,v19
s_and_b32 s64,vcc_lo,0xffff
s_cmp_eq_u32 s64,65535
s_cbranch_scc1 vck_296
s_mov_b32 s65,0
v_readlane_b32 s64,v17,1
s_lshr_b32 s64,s64,8
s_add_u32 s65,s65,s64
v_readlane_b32 s64,v17,3
s_lshr_b32 s64,s64,8
s_add_u32 s65,s65,s64
v_readlane_b32 s64,v17,5
s_lshr_b32 s64,s64,8
s_add_u32 s65,s65,s64
v_readlane_b32 s64,v17,7
s_lshr_b32 s64,s64,8
s_add_u32 s65,s65,s64
v_readlane_b32 s64,v17,9
s_lshr_b32 s64,s64,8
s_add_u32 s65,s65,s64
v_readlane_b32 s64,v17,11
s_lshr_b32 s64,s64,8
s_add_u32 s65,s65,s64
v_readlane_b32 s64,v17,13
s_lshr_b32 s64,s64,8
s_add_u32 s65,s65,s64
v_readlane_b32 s64,v17,15
s_lshr_b32 s64,s64,8
s_add_u32 s65,s65,s64
s_cmp_ge_u32 s65,256
s_cbranch_scc1 vok_298
s_branch vrt_297
vck_296:
v_cmp_gt_u32 vcc,v18,v17
s_cbranch_vccz vok_298
vrt_297:
s_sleep 48
s_sub_u32 s90,s90,1
s_cmp_gt_i32 s90,0
s_cbranch_scc1 vpoll_295
vok_298:
v_add_u32 v18,160512,v16
ds_write_b32 v18,v17
s_waitcnt lgkmcnt(0)
vot_299:
s_barrier
v_add_u32 v18,160512,v16
ds_read_b32 v17,v18
s_waitcnt lgkmcnt(0)
s_cmp_lg_u32 s56,2
s_cbranch_scc1 vfin_300
v_cmp_eq_u32 vcc,v17,v19
s_and_b32 s64,vcc_lo,0xffff
s_cmp_eq_u32 s64,65535
s_cbranch_scc1 vfin_300
s_mov_b32 s65,0
v_readlane_b32 s64,v17,1
s_lshr_b32 s64,s64,8
s_add_u32 s65,s65,s64
v_readlane_b32 s64,v17,3
s_lshr_b32 s64,s64,8
s_add_u32 s65,s65,s64
v_readlane_b32 s64,v17,5
s_lshr_b32 s64,s64,8
s_add_u32 s65,s65,s64
v_readlane_b32 s64,v17,7
s_lshr_b32 s64,s64,8
s_add_u32 s65,s65,s64
v_readlane_b32 s64,v17,9
s_lshr_b32 s64,s64,8
s_add_u32 s65,s65,s64
v_readlane_b32 s64,v17,11
s_lshr_b32 s64,s64,8
s_add_u32 s65,s65,s64
v_readlane_b32 s64,v17,13
s_lshr_b32 s64,s64,8
s_add_u32 s65,s65,s64
v_readlane_b32 s64,v17,15
s_lshr_b32 s64,s64,8
s_add_u32 s65,s65,s64
s_cmp_ge_u32 s65,256
s_cbranch_scc1 fl_fb
vfin_300:
s_and_b32 s56,s56,1
s_mov_b32 s67,0
s_barrier
v_lshlrev_b32 v0,4,v1
s_mov_b32 s60,0
s_lshl_b32 s70,s50,13
s_mov_b32 s55,0
v_mov_b32 v3,v0
s_mov_b32 s73,0xffff0000
s_lshl_b32 s64,s52,2
s_add_u32 s64,s64,s50
s_mul_i32 s61,s64,8192
s_add_u32 s61,s61,205520896
s_lshl_b32 s68,s64,8
s_add_u32 s68,s68,138548224
s_lshl_b32 s83,s53,2
s_add_u32 s83,s83,s50
s_mov_b32 s63,0
s_xor_b32 s64,s50,0
s_lshl_b32 s64,s64,13
v_add_u32 v8,s64,v0
v_mov_b32 v4,v8
s_xor_b32 s64,s50,1
s_lshl_b32 s64,s64,13
v_add_u32 v9,s64,v0
v_mov_b32 v5,v9
s_xor_b32 s64,s50,2
s_lshl_b32 s64,s64,13
v_add_u32 v10,s64,v0
v_mov_b32 v6,v10
s_xor_b32 s64,s50,3
s_lshl_b32 s64,s64,13
v_add_u32 v11,s64,v0
v_mov_b32 v7,v11
v_min_u32 v2,3,v1
v_lshlrev_b32 v2,2,v2
s_add_u32 s62,s61,4096
s_lshl_b32 s66,s83,10
s_lshr_b32 s65,s83,3
s_lshl_b32 s65,s65,8
s_and_b32 s64,s83,7
s_lshl_b32 s64,s64,2
s_add_u32 s69,s64,s65
s_add_u32 s69,s69,138549248
s_add_u32 s82,s66,201326592
s_add_u32 s66,s66,209747968
s_lshl_b32 s64,s50,9
s_add_u32 s64,s64,131072
v_lshlrev_b32 v26,3,v1
v_add_u32 v19,s64,v26
v_lshl_add_u32 v26,v23,4,v21
v_lshlrev_b32 v26,3,v26
v_add_u32 v20,131072,v26
s_mov_b32 s74,0x22222222
s_mov_b32 s75,0x22222222
s_mov_b32 s76,0x44444444
s_mov_b32 s77,0x44444444
s_mov_b32 s78,0x88888888
s_mov_b32 s79,0x88888888
v_mov_b32 v208,0xbdd2d3e8
v_mov_b32 v209,0xc0135761
v_mov_b32 v210,1.0
v_mov_b32 v211,1.0
v_mov_b32 v12,0x3f803f80
v_mov_b32 v13,0x3f803f80
v_mov_b32 v14,0x3f803f80
v_mov_b32 v15,0x3f803f80
s_nop 1
v_mfma_f32_16x16x32_bf16 v[152:155],a[0:3],v[12:15],0
v_mfma_f32_16x16x32_bf16 v[156:159],a[4:7],v[12:15],0
v_mfma_f32_16x16x32_bf16 v[152:155],a[8:11],v[12:15],v[152:155]
v_mfma_f32_16x16x32_bf16 v[156:159],a[12:15],v[12:15],v[156:159]
v_mfma_f32_16x16x32_bf16 v[152:155],a[16:19],v[12:15],v[152:155]
v_mfma_f32_16x16x32_bf16 v[156:159],a[20:23],v[12:15],v[156:159]
v_mfma_f32_16x16x32_bf16 v[152:155],a[24:27],v[12:15],v[152:155]
v_mfma_f32_16x16x32_bf16 v[156:159],a[28:31],v[12:15],v[156:159]
v_mfma_f32_16x16x32_bf16 v[152:155],a[32:35],v[12:15],v[152:155]
v_mfma_f32_16x16x32_bf16 v[156:159],a[36:39],v[12:15],v[156:159]
v_mfma_f32_16x16x32_bf16 v[152:155],a[40:43],v[12:15],v[152:155]
v_mfma_f32_16x16x32_bf16 v[156:159],a[44:47],v[12:15],v[156:159]
v_mfma_f32_16x16x32_bf16 v[152:155],a[48:51],v[12:15],v[152:155]
v_mfma_f32_16x16x32_bf16 v[156:159],a[52:55],v[12:15],v[156:159]
v_mfma_f32_16x16x32_bf16 v[152:155],a[56:59],v[12:15],v[152:155]
v_mfma_f32_16x16x32_bf16 v[156:159],a[60:63],v[12:15],v[156:159]
v_mfma_f32_16x16x32_bf16 v[152:155],a[64:67],v[12:15],v[152:155]
v_mfma_f32_16x16x32_bf16 v[156:159],a[68:71],v[12:15],v[156:159]
v_mfma_f32_16x16x32_bf16 v[152:155],a[72:75],v[12:15],v[152:155]
v_mfma_f32_16x16x32_bf16 v[156:159],a[76:79],v[12:15],v[156:159]
v_mfma_f32_16x16x32_bf16 v[152:155],a[80:83],v[12:15],v[152:155]
v_mfma_f32_16x16x32_bf16 v[156:159],a[84:87],v[12:15],v[156:159]
v_mfma_f32_16x16x32_bf16 v[152:155],a[88:91],v[12:15],v[152:155]
v_mfma_f32_16x16x32_bf16 v[156:159],a[92:95],v[12:15],v[156:159]
v_mfma_f32_16x16x32_bf16 v[152:155],a[96:99],v[12:15],v[152:155]
v_mfma_f32_16x16x32_bf16 v[156:159],a[100:103],v[12:15],v[156:159]
v_mfma_f32_16x16x32_bf16 v[152:155],a[104:107],v[12:15],v[152:155]
v_mfma_f32_16x16x32_bf16 v[156:159],a[108:111],v[12:15],v[156:159]
v_mfma_f32_16x16x32_bf16 v[152:155],a[112:115],v[12:15],v[152:155]
v_mfma_f32_16x16x32_bf16 v[156:159],a[116:119],v[12:15],v[156:159]
v_mfma_f32_16x16x32_bf16 v[152:155],a[120:123],v[12:15],v[152:155]
v_mfma_f32_16x16x32_bf16 v[156:159],a[124:127],v[12:15],v[156:159]
v_mfma_f32_16x16x32_bf16 v[152:155],a[128:131],v[12:15],v[152:155]
v_mfma_f32_16x16x32_bf16 v[156:159],a[132:135],v[12:15],v[156:159]
v_mfma_f32_16x16x32_bf16 v[152:155],a[136:139],v[12:15],v[152:155]
v_mfma_f32_16x16x32_bf16 v[156:159],a[140:143],v[12:15],v[156:159]
v_mfma_f32_16x16x32_bf16 v[152:155],a[144:147],v[12:15],v[152:155]
v_mfma_f32_16x16x32_bf16 v[156:159],a[148:151],v[12:15],v[156:159]
v_mfma_f32_16x16x32_bf16 v[152:155],a[152:155],v[12:15],v[152:155]
v_mfma_f32_16x16x32_bf16 v[156:159],a[156:159],v[12:15],v[156:159]
v_mfma_f32_16x16x32_bf16 v[152:155],a[160:163],v[12:15],v[152:155]
v_mfma_f32_16x16x32_bf16 v[156:159],a[164:167],v[12:15],v[156:159]
v_mfma_f32_16x16x32_bf16 v[152:155],a[168:171],v[12:15],v[152:155]
v_mfma_f32_16x16x32_bf16 v[156:159],a[172:175],v[12:15],v[156:159]
v_mfma_f32_16x16x32_bf16 v[152:155],a[176:179],v[12:15],v[152:155]
v_mfma_f32_16x16x32_bf16 v[156:159],a[180:183],v[12:15],v[156:159]
v_mfma_f32_16x16x32_bf16 v[152:155],a[184:187],v[12:15],v[152:155]
v_mfma_f32_16x16x32_bf16 v[156:159],a[188:191],v[12:15],v[156:159]
v_mfma_f32_16x16x32_bf16 v[152:155],a[192:195],v[12:15],v[152:155]
v_mfma_f32_16x16x32_bf16 v[156:159],a[196:199],v[12:15],v[156:159]
v_mfma_f32_16x16x32_bf16 v[152:155],a[200:203],v[12:15],v[152:155]
v_mfma_f32_16x16x32_bf16 v[156:159],a[204:207],v[12:15],v[156:159]
v_mfma_f32_16x16x32_bf16 v[152:155],a[208:211],v[12:15],v[152:155]
v_mfma_f32_16x16x32_bf16 v[156:159],a[212:215],v[12:15],v[156:159]
v_mfma_f32_16x16x32_bf16 v[152:155],a[216:219],v[12:15],v[152:155]
v_mfma_f32_16x16x32_bf16 v[156:159],a[220:223],v[12:15],v[156:159]
v_mfma_f32_16x16x32_bf16 v[152:155],a[224:227],v[12:15],v[152:155]
v_mfma_f32_16x16x32_bf16 v[156:159],a[228:231],v[12:15],v[156:159]
v_mfma_f32_16x16x32_bf16 v[152:155],a[232:235],v[12:15],v[152:155]
v_mfma_f32_16x16x32_bf16 v[156:159],a[236:239],v[12:15],v[156:159]
v_mfma_f32_16x16x32_bf16 v[152:155],a[240:243],v[12:15],v[152:155]
v_mfma_f32_16x16x32_bf16 v[156:159],a[244:247],v[12:15],v[156:159]
v_mfma_f32_16x16x32_bf16 v[152:155],a[248:251],v[12:15],v[152:155]
v_mfma_f32_16x16x32_bf16 v[156:159],a[252:255],v[12:15],v[156:159]
s_add_u32 s71,s60,1
s_add_u32 s53,s60,2
plp_308:
buffer_load_dword v16,v2,s[20:23],s68 offen sc1
s_waitcnt vmcnt(0)
v_cmp_gt_u32 vcc,s71,v16
s_cbranch_vccz pok_309
s_sleep 4
s_sub_u32 s90,s90,1
s_cmp_gt_i32 s90,0
s_cbranch_scc1 plp_308
pok_309:
lag_305:
s_mov_b32 m0,s70
s_nop 0
buffer_load_dwordx4 v3,s[20:23],s61 offen offset:0 lds
buffer_load_dwordx4 v3,s[20:23],s61 offen offset:1024 lds
buffer_load_dwordx4 v3,s[20:23],s61 offen offset:2048 lds
buffer_load_dwordx4 v3,s[20:23],s61 offen offset:3072 lds
s_add_u32 m0,s70,4096
s_nop 0
buffer_load_dwordx4 v3,s[20:23],s62 offen offset:0 lds
buffer_load_dwordx4 v3,s[20:23],s62 offen offset:1024 lds
buffer_load_dwordx4 v3,s[20:23],s62 offen offset:2048 lds
buffer_load_dwordx4 v3,s[20:23],s62 offen offset:3072 lds
s_add_u32 s61,s61,32768
s_add_u32 s62,s62,32768
s_add_u32 s70,s70,32768
s_and_b32 s70,s70,0x1ffff
buffer_load_dword v23,off,s[20:23],s66
dec_306:
v_cmp_gt_u32 vcc,s53,v16
s_cbranch_vccnz BN_304
BR_303:
s_waitcnt vmcnt(8)
ds_read_b128 v[64:67],v4 offset:0
s_waitcnt vmcnt(7)
ds_read_b128 v[68:71],v4 offset:1024
s_waitcnt vmcnt(6)
ds_read_b128 v[72:75],v4 offset:2048
s_waitcnt vmcnt(5)
ds_read_b128 v[76:79],v4 offset:3072
s_waitcnt lgkmcnt(3)
v_mfma_f32_16x16x32_bf16 v[32:35],a[0:3],v[64:67],0
s_add_u32 s71,s60,2
s_add_u32 s53,s60,3
s_mov_b32 s57,s63
v_mfma_f32_16x16x32_bf16 v[36:39],a[4:7],v[64:67],0
v_mfma_f32_16x16x32_bf16 v[48:51],v[12:15],v[64:67],0
v_mfma_f32_16x16x32_bf16 v[52:55],v[64:67],v[64:67],0
s_waitcnt lgkmcnt(2)
s_waitcnt vmcnt(4)
s_mov_b32 m0,s70
ds_read_b128 v[80:83],v4 offset:4096
v_mfma_f32_16x16x32_bf16 v[32:35],a[8:11],v[68:71],v[32:35]
buffer_load_dwordx4 v3,s[20:23],s61 offen offset:0 lds
v_mfma_f32_16x16x32_bf16 v[36:39],a[12:15],v[68:71],v[36:39]
v_mfma_f32_16x16x32_bf16 v[48:51],v[12:15],v[68:71],v[48:51]
v_mfma_f32_16x16x32_bf16 v[52:55],v[68:71],v[68:71],v[52:55]
s_waitcnt lgkmcnt(2)
s_waitcnt vmcnt(4)
ds_read_b128 v[84:87],v4 offset:5120
v_mfma_f32_16x16x32_bf16 v[32:35],a[16:19],v[72:75],v[32:35]
buffer_load_dwordx4 v3,s[20:23],s61 offen offset:1024 lds
v_mfma_f32_16x16x32_bf16 v[36:39],a[20:23],v[72:75],v[36:39]
v_mfma_f32_16x16x32_bf16 v[48:51],v[12:15],v[72:75],v[48:51]
v_mfma_f32_16x16x32_bf16 v[52:55],v[72:75],v[72:75],v[52:55]
s_waitcnt lgkmcnt(2)
s_waitcnt vmcnt(4)
ds_read_b128 v[88:91],v4 offset:6144
v_mfma_f32_16x16x32_bf16 v[32:35],a[24:27],v[76:79],v[32:35]
buffer_load_dwordx4 v3,s[20:23],s61 offen offset:2048 lds
v_mfma_f32_16x16x32_bf16 v[36:39],a[28:31],v[76:79],v[36:39]
v_mfma_f32_16x16x32_bf16 v[48:51],v[12:15],v[76:79],v[48:51]
v_mfma_f32_16x16x32_bf16 v[52:55],v[76:79],v[76:79],v[52:55]
s_waitcnt lgkmcnt(2)
s_waitcnt vmcnt(4)
ds_read_b128 v[92:95],v4 offset:7168
v_mfma_f32_16x16x32_bf16 v[32:35],a[32:35],v[80:83],v[32:35]
buffer_load_dwordx4 v3,s[20:23],s61 offen offset:3072 lds
v_mfma_f32_16x16x32_bf16 v[36:39],a[36:39],v[80:83],v[36:39]
v_mfma_f32_16x16x32_bf16 v[48:51],v[12:15],v[80:83],v[48:51]
v_mfma_f32_16x16x32_bf16 v[52:55],v[80:83],v[80:83],v[52:55]
s_waitcnt lgkmcnt(2)
s_barrier
ds_read_b128 v[96:99],v5 offset:0
v_mfma_f32_16x16x32_bf16 v[32:35],a[40:43],v[84:87],v[32:35]
ds_read_b128 v[100:103],v5 offset:1024
v_mfma_f32_16x16x32_bf16 v[36:39],a[44:47],v[84:87],v[36:39]
ds_read_b128 v[104:107],v5 offset:2048
v_mfma_f32_16x16x32_bf16 v[48:51],v[12:15],v[84:87],v[48:51]
s_add_u32 m0,s70,4096
ds_read_b128 v[108:111],v5 offset:3072
v_mfma_f32_16x16x32_bf16 v[52:55],v[84:87],v[84:87],v[52:55]
s_waitcnt lgkmcnt(5)
buffer_load_dwordx4 v3,s[20:23],s62 offen offset:0 lds
v_mfma_f32_16x16x32_bf16 v[32:35],a[48:51],v[88:91],v[32:35]
ds_read_b128 v[112:115],v5 offset:4096
v_mfma_f32_16x16x32_bf16 v[36:39],a[52:55],v[88:91],v[36:39]
buffer_load_dwordx4 v3,s[20:23],s62 offen offset:1024 lds
v_mfma_f32_16x16x32_bf16 v[48:51],v[12:15],v[88:91],v[48:51]
s_waitcnt vmcnt(6)
v_mov_b32 v17,s57
s_mov_b64 exec,1
buffer_store_dword v17,off,s[20:23],s69 sc1
s_mov_b64 exec,-1
v_mfma_f32_16x16x32_bf16 v[52:55],v[88:91],v[88:91],v[52:55]
s_waitcnt lgkmcnt(5)
v_mfma_f32_16x16x32_bf16 v[32:35],a[56:59],v[92:95],v[32:35]
ds_read_b128 v[116:119],v5 offset:5120
v_mfma_f32_16x16x32_bf16 v[36:39],a[60:63],v[92:95],v[36:39]
buffer_load_dwordx4 v3,s[20:23],s62 offen offset:2048 lds
v_mfma_f32_16x16x32_bf16 v[48:51],v[12:15],v[92:95],v[48:51]
buffer_load_dword v16,v2,s[20:23],s68 offen sc1
v_mfma_f32_16x16x32_bf16 v[52:55],v[92:95],v[92:95],v[52:55]
s_waitcnt lgkmcnt(5)
v_mfma_f32_16x16x32_bf16 v[32:35],a[64:67],v[96:99],v[32:35]
ds_read_b128 v[120:123],v5 offset:6144
v_mfma_f32_16x16x32_bf16 v[36:39],a[68:71],v[96:99],v[36:39]
s_waitcnt lgkmcnt(5)
buffer_load_dwordx4 v3,s[20:23],s62 offen offset:3072 lds
v_mfma_f32_16x16x32_bf16 v[32:35],a[72:75],v[100:103],v[32:35]
ds_read_b128 v[124:127],v5 offset:7168
v_mfma_f32_16x16x32_bf16 v[36:39],a[76:79],v[100:103],v[36:39]
s_waitcnt lgkmcnt(5)
v_mfma_f32_16x16x32_bf16 v[32:35],a[80:83],v[104:107],v[32:35]
ds_read_b128 v[64:67],v6 offset:0
v_cndmask_b32 v49,v52,v53,s[74:75]
v_mfma_f32_16x16x32_bf16 v[36:39],a[84:87],v[104:107],v[36:39]
s_waitcnt lgkmcnt(5)
v_cndmask_b32 v49,v49,v54,s[76:77]
v_cndmask_b32 v49,v49,v55,s[78:79]
v_mfma_f32_16x16x32_bf16 v[32:35],a[88:91],v[108:111],v[32:35]
ds_read_b128 v[68:71],v6 offset:1024
v_mfma_f32_16x16x32_bf16 v[36:39],a[92:95],v[108:111],v[36:39]
s_waitcnt lgkmcnt(5)
ds_write_b64 v19,v[48:49]
v_mfma_f32_16x16x32_bf16 v[32:35],a[96:99],v[112:115],v[32:35]
ds_read_b128 v[72:75],v6 offset:2048
v_mfma_f32_16x16x32_bf16 v[36:39],a[100:103],v[112:115],v[36:39]
s_waitcnt lgkmcnt(6)
v_mfma_f32_16x16x32_bf16 v[32:35],a[104:107],v[116:119],v[32:35]
ds_read_b128 v[76:79],v6 offset:3072
v_mfma_f32_16x16x32_bf16 v[36:39],a[108:111],v[116:119],v[36:39]
s_waitcnt lgkmcnt(6)
v_mfma_f32_16x16x32_bf16 v[32:35],a[112:115],v[120:123],v[32:35]
s_waitcnt lgkmcnt(2)
s_barrier
ds_read_b128 v[80:83],v6 offset:4096
v_mfma_f32_16x16x32_bf16 v[36:39],a[116:119],v[120:123],v[36:39]
ds_read_b64 v[56:57],v20 offset:0
v_mfma_f32_16x16x32_bf16 v[32:35],a[120:123],v[124:127],v[32:35]
ds_read_b128 v[84:87],v6 offset:5120
v_mfma_f32_16x16x32_bf16 v[36:39],a[124:127],v[124:127],v[36:39]
ds_read_b64 v[58:59],v20 offset:512
v_mfma_f32_16x16x32_bf16 v[32:35],a[128:131],v[64:67],v[32:35]
ds_read_b128 v[88:91],v6 offset:6144
v_mfma_f32_16x16x32_bf16 v[36:39],a[132:135],v[64:67],v[36:39]
ds_read_b64 v[60:61],v20 offset:1024
v_mfma_f32_16x16x32_bf16 v[32:35],a[136:139],v[68:71],v[32:35]
ds_read_b128 v[92:95],v6 offset:7168
v_mfma_f32_16x16x32_bf16 v[36:39],a[140:143],v[68:71],v[36:39]
s_waitcnt lgkmcnt(8)
ds_read_b64 v[62:63],v20 offset:1536
v_mfma_f32_16x16x32_bf16 v[32:35],a[144:147],v[72:75],v[32:35]
ds_read_b128 v[96:99],v7 offset:0
v_mfma_f32_16x16x32_bf16 v[36:39],a[148:151],v[72:75],v[36:39]
s_waitcnt lgkmcnt(9)
v_mfma_f32_16x16x32_bf16 v[32:35],a[152:155],v[76:79],v[32:35]
ds_read_b128 v[100:103],v7 offset:1024
v_mfma_f32_16x16x32_bf16 v[36:39],a[156:159],v[76:79],v[36:39]
s_waitcnt lgkmcnt(9)
v_mfma_f32_16x16x32_bf16 v[32:35],a[160:163],v[80:83],v[32:35]
ds_read_b128 v[104:107],v7 offset:2048
v_mfma_f32_16x16x32_bf16 v[36:39],a[164:167],v[80:83],v[36:39]
s_waitcnt lgkmcnt(8)
s_waitcnt lgkmcnt(3)
v_add_f32 v56,v56,v58
v_mfma_f32_16x16x32_bf16 v[32:35],a[168:171],v[84:87],v[32:35]
ds_read_b128 v[108:111],v7 offset:3072
v_add_f32 v57,v57,v59
v_mfma_f32_16x16x32_bf16 v[36:39],a[172:175],v[84:87],v[36:39]
v_add_f32 v60,v60,v62
v_add_f32 v61,v61,v63
v_mfma_f32_16x16x32_bf16 v[32:35],a[176:179],v[88:91],v[32:35]
ds_read_b128 v[112:115],v7 offset:4096
v_add_f32 v56,v56,v60
v_mfma_f32_16x16x32_bf16 v[36:39],a[180:183],v[88:91],v[36:39]
v_add_f32 v57,v57,v61
v_mul_f32 v188,0xba800000,v56
v_mfma_f32_16x16x32_bf16 v[32:35],a[184:187],v[92:95],v[32:35]
ds_read_b128 v[116:119],v7 offset:5120
v_mul_f32 v58,v188,v188
v_mfma_f32_16x16x32_bf16 v[36:39],a[188:191],v[92:95],v[36:39]
s_waitcnt lgkmcnt(5)
v_mul_f32 v57,0x3a800000,v57
v_sub_f32 v57,v57,v58
v_mfma_f32_16x16x32_bf16 v[32:35],a[192:195],v[96:99],v[32:35]
ds_read_b128 v[120:123],v7 offset:6144
v_max_f32 v57,0,v57
v_mfma_f32_16x16x32_bf16 v[36:39],a[196:199],v[96:99],v[36:39]
s_waitcnt lgkmcnt(5)
v_add_f32 v57,0x3727c5ac,v57
v_mfma_f32_16x16x32_bf16 v[32:35],a[200:203],v[100:103],v[32:35]
ds_read_b128 v[124:127],v7 offset:7168
v_mfma_f32_16x16x32_bf16 v[36:39],a[204:207],v[100:103],v[36:39]
s_waitcnt lgkmcnt(5)
v_rsq_f32 v189,v57
v_mfma_f32_16x16x32_bf16 v[32:35],a[208:211],v[104:107],v[32:35]
s_add_u32 s61,s61,32768
s_add_u32 s62,s62,32768
s_add_u32 s70,s70,32768
v_mfma_f32_16x16x32_bf16 v[36:39],a[212:215],v[104:107],v[36:39]
s_waitcnt lgkmcnt(4)
s_and_b32 s70,s70,0x1ffff
s_add_u32 s55,s55,32768
v_mfma_f32_16x16x32_bf16 v[32:35],a[216:219],v[108:111],v[32:35]
s_and_b32 s55,s55,0x1ffff
v_add_u32 v4,s55,v8
v_add_u32 v5,s55,v9
v_mfma_f32_16x16x32_bf16 v[36:39],a[220:223],v[108:111],v[36:39]
s_waitcnt lgkmcnt(3)
v_add_u32 v6,s55,v10
v_add_u32 v7,s55,v11
v_mfma_f32_16x16x32_bf16 v[32:35],a[224:227],v[112:115],v[32:35]
s_waitcnt vmcnt(0)
ds_read_b128 v[64:67],v4 offset:0
v_mfma_f32_16x16x32_bf16 v[36:39],a[228:231],v[112:115],v[36:39]
s_waitcnt lgkmcnt(3)
ds_read_b128 v[68:71],v4 offset:1024
v_mfma_f32_16x16x32_bf16 v[32:35],a[232:235],v[116:119],v[32:35]
ds_read_b128 v[72:75],v4 offset:2048
v_mfma_f32_16x16x32_bf16 v[36:39],a[236:239],v[116:119],v[36:39]
s_waitcnt lgkmcnt(4)
v_mfma_f32_16x16x32_bf16 v[32:35],a[240:243],v[120:123],v[32:35]
v_mfma_f32_16x16x32_bf16 v[36:39],a[244:247],v[120:123],v[36:39]
s_waitcnt lgkmcnt(3)
v_mfma_f32_16x16x32_bf16 v[40:43],a[248:251],v[124:127],v[32:35]
v_mfma_f32_16x16x32_bf16 v[44:47],a[252:255],v[124:127],v[36:39]
v_cmp_gt_u32 vcc,s53,v16
s_add_u32 s60,s60,1
s_cbranch_vccnz WN_302
WR_301:
s_waitcnt lgkmcnt(2)
v_mfma_f32_16x16x32_bf16 v[32:35],a[0:3],v[64:67],0
s_add_u32 s71,s60,2
s_add_u32 s53,s60,3
ds_read_b128 v[76:79],v4 offset:3072
v_mfma_f32_16x16x32_bf16 v[36:39],a[4:7],v[64:67],0
s_mov_b32 s57,s63
ds_read_b128 v[80:83],v4 offset:4096
v_mfma_f32_16x16x32_bf16 v[48:51],v[12:15],v[64:67],0
ds_read_b128 v[84:87],v4 offset:5120
v_fma_f32 v40,v152,v188,v40
v_fma_f32 v41,v153,v188,v41
v_mfma_f32_16x16x32_bf16 v[52:55],v[64:67],v[64:67],0
s_waitcnt lgkmcnt(4)
ds_read_b128 v[88:91],v4 offset:6144
v_mul_f32 v40,v40,v189
v_mul_f32 v41,v41,v189
v_mfma_f32_16x16x32_bf16 v[32:35],a[8:11],v[68:71],v[32:35]
s_mov_b32 m0,s70
ds_read_b128 v[92:95],v4 offset:7168
v_mul_f32 v168,v40,v40
v_mul_f32 v169,v41,v41
v_mfma_f32_16x16x32_bf16 v[36:39],a[12:15],v[68:71],v[36:39]
buffer_load_dwordx4 v3,s[20:23],s61 offen offset:0 lds
v_fma_f32 v168,v168,v208,v209
v_fma_f32 v169,v169,v208,v209
v_mfma_f32_16x16x32_bf16 v[48:51],v[12:15],v[68:71],v[48:51]
v_mul_f32 v168,v168,v40
v_exp_f32 v168,v168
v_mfma_f32_16x16x32_bf16 v[52:55],v[68:71],v[68:71],v[52:55]
s_waitcnt lgkmcnt(5)
buffer_load_dwordx4 v3,s[20:23],s61 offen offset:1024 lds
v_mul_f32 v169,v169,v41
v_add_f32 v168,1.0,v168
v_mfma_f32_16x16x32_bf16 v[32:35],a[16:19],v[72:75],v[32:35]
s_barrier
ds_read_b128 v[96:99],v5 offset:0
v_exp_f32 v169,v169
v_mfma_f32_16x16x32_bf16 v[36:39],a[20:23],v[72:75],v[36:39]
v_rcp_f32 v168,v168
v_add_f32 v169,1.0,v169
v_mfma_f32_16x16x32_bf16 v[48:51],v[12:15],v[72:75],v[48:51]
v_rcp_f32 v169,v169
v_mul_f32 v40,v168,v40
v_mfma_f32_16x16x32_bf16 v[52:55],v[72:75],v[72:75],v[52:55]
s_waitcnt lgkmcnt(5)
buffer_load_dwordx4 v3,s[20:23],s61 offen offset:2048 lds
v_mul_f32 v41,v169,v41
v_fma_f32 v42,v154,v188,v42
v_mfma_f32_16x16x32_bf16 v[32:35],a[24:27],v[76:79],v[32:35]
ds_read_b128 v[100:103],v5 offset:1024
v_fma_f32 v43,v155,v188,v43
v_mul_f32 v42,v42,v189
v_mfma_f32_16x16x32_bf16 v[36:39],a[28:31],v[76:79],v[36:39]
v_mul_f32 v43,v43,v189
v_mul_f32 v170,v42,v42
v_mul_f32 v171,v43,v43
v_mfma_f32_16x16x32_bf16 v[48:51],v[12:15],v[76:79],v[48:51]
v_fma_f32 v170,v170,v208,v209
v_fma_f32 v171,v171,v208,v209
v_mul_f32 v170,v170,v42
v_mfma_f32_16x16x32_bf16 v[52:55],v[76:79],v[76:79],v[52:55]
s_waitcnt lgkmcnt(5)
buffer_load_dwordx4 v3,s[20:23],s61 offen offset:3072 lds
v_exp_f32 v170,v170
v_mfma_f32_16x16x32_bf16 v[32:35],a[32:35],v[80:83],v[32:35]
ds_read_b128 v[104:107],v5 offset:2048
v_mul_f32 v171,v171,v43
v_add_f32 v170,1.0,v170
v_mfma_f32_16x16x32_bf16 v[36:39],a[36:39],v[80:83],v[36:39]
v_exp_f32 v171,v171
v_fma_f32 v44,v156,v188,v44
v_mfma_f32_16x16x32_bf16 v[48:51],v[12:15],v[80:83],v[48:51]
v_rcp_f32 v170,v170
v_add_f32 v171,1.0,v171
v_mfma_f32_16x16x32_bf16 v[52:55],v[80:83],v[80:83],v[52:55]
s_waitcnt lgkmcnt(5)
v_rcp_f32 v171,v171
v_mfma_f32_16x16x32_bf16 v[32:35],a[40:43],v[84:87],v[32:35]
s_add_u32 m0,s70,4096
ds_read_b128 v[108:111],v5 offset:3072
v_mul_f32 v42,v170,v42
v_mfma_f32_16x16x32_bf16 v[36:39],a[44:47],v[84:87],v[36:39]
buffer_load_dwordx4 v3,s[20:23],s62 offen offset:0 lds
v_mul_f32 v43,v171,v43
v_mfma_f32_16x16x32_bf16 v[48:51],v[12:15],v[84:87],v[48:51]
s_waitcnt vmcnt(5)
v_mov_b32 v17,s57
s_mov_b64 exec,1
buffer_store_dword v17,off,s[20:23],s69 sc1
s_mov_b64 exec,-1
v_mfma_f32_16x16x32_bf16 v[52:55],v[84:87],v[84:87],v[52:55]
s_waitcnt lgkmcnt(5)
v_fma_f32 v45,v157,v188,v45
v_mul_f32 v44,v44,v189
v_mfma_f32_16x16x32_bf16 v[32:35],a[48:51],v[88:91],v[32:35]
ds_read_b128 v[112:115],v5 offset:4096
v_mul_f32 v45,v45,v189
v_mfma_f32_16x16x32_bf16 v[36:39],a[52:55],v[88:91],v[36:39]
buffer_load_dwordx4 v3,s[20:23],s62 offen offset:1024 lds
v_mul_f32 v172,v44,v44
v_mfma_f32_16x16x32_bf16 v[48:51],v[12:15],v[88:91],v[48:51]
v_mul_f32 v173,v45,v45
v_fma_f32 v172,v172,v208,v209
v_mfma_f32_16x16x32_bf16 v[52:55],v[88:91],v[88:91],v[52:55]
s_waitcnt lgkmcnt(5)
v_fma_f32 v173,v173,v208,v209
v_mul_f32 v172,v172,v44
v_mfma_f32_16x16x32_bf16 v[32:35],a[56:59],v[92:95],v[32:35]
ds_read_b128 v[116:119],v5 offset:5120
v_mul_f32 v173,v173,v45
v_mfma_f32_16x16x32_bf16 v[36:39],a[60:63],v[92:95],v[36:39]
buffer_load_dwordx4 v3,s[20:23],s62 offen offset:2048 lds
v_fma_f32 v46,v158,v188,v46
v_mfma_f32_16x16x32_bf16 v[48:51],v[12:15],v[92:95],v[48:51]
buffer_load_dword v16,v2,s[20:23],s68 offen sc1
v_fma_f32 v47,v159,v188,v47
v_mfma_f32_16x16x32_bf16 v[52:55],v[92:95],v[92:95],v[52:55]
s_waitcnt lgkmcnt(5)
v_exp_f32 v172,v172
v_mfma_f32_16x16x32_bf16 v[32:35],a[64:67],v[96:99],v[32:35]
ds_read_b128 v[120:123],v5 offset:6144
v_add_f32 v172,1.0,v172
v_mfma_f32_16x16x32_bf16 v[36:39],a[68:71],v[96:99],v[36:39]
s_waitcnt lgkmcnt(5)
buffer_load_dwordx4 v3,s[20:23],s62 offen offset:3072 lds
v_mul_f32 v46,v46,v189
v_mfma_f32_16x16x32_bf16 v[32:35],a[72:75],v[100:103],v[32:35]
ds_read_b128 v[124:127],v5 offset:7168
v_mul_f32 v47,v47,v189
v_mfma_f32_16x16x32_bf16 v[36:39],a[76:79],v[100:103],v[36:39]
s_waitcnt lgkmcnt(5)
v_exp_f32 v173,v173
v_mfma_f32_16x16x32_bf16 v[32:35],a[80:83],v[104:107],v[32:35]
ds_read_b128 v[64:67],v6 offset:0
v_cndmask_b32 v49,v52,v53,s[74:75]
v_mfma_f32_16x16x32_bf16 v[36:39],a[84:87],v[104:107],v[36:39]
s_waitcnt lgkmcnt(5)
v_cndmask_b32 v49,v49,v54,s[76:77]
v_cndmask_b32 v49,v49,v55,s[78:79]
v_mfma_f32_16x16x32_bf16 v[32:35],a[88:91],v[108:111],v[32:35]
ds_read_b128 v[68:71],v6 offset:1024
v_add_f32 v173,1.0,v173
v_mfma_f32_16x16x32_bf16 v[36:39],a[92:95],v[108:111],v[36:39]
s_waitcnt lgkmcnt(5)
ds_write_b64 v19,v[48:49]
v_mfma_f32_16x16x32_bf16 v[32:35],a[96:99],v[112:115],v[32:35]
ds_read_b128 v[72:75],v6 offset:2048
v_mul_f32 v174,v46,v46
v_mfma_f32_16x16x32_bf16 v[36:39],a[100:103],v[112:115],v[36:39]
s_waitcnt lgkmcnt(6)
v_rcp_f32 v172,v172
v_mfma_f32_16x16x32_bf16 v[32:35],a[104:107],v[116:119],v[32:35]
ds_read_b128 v[76:79],v6 offset:3072
v_mul_f32 v44,v172,v44
v_mfma_f32_16x16x32_bf16 v[36:39],a[108:111],v[116:119],v[36:39]
s_waitcnt lgkmcnt(6)
v_rcp_f32 v173,v173
v_mfma_f32_16x16x32_bf16 v[32:35],a[112:115],v[120:123],v[32:35]
s_waitcnt lgkmcnt(2)
s_barrier
ds_read_b128 v[80:83],v6 offset:4096
v_mfma_f32_16x16x32_bf16 v[36:39],a[116:119],v[120:123],v[36:39]
ds_read_b64 v[56:57],v20 offset:0
v_mul_f32 v45,v173,v45
v_mfma_f32_16x16x32_bf16 v[32:35],a[120:123],v[124:127],v[32:35]
ds_read_b128 v[84:87],v6 offset:5120
v_mul_f32 v175,v47,v47
v_mfma_f32_16x16x32_bf16 v[36:39],a[124:127],v[124:127],v[36:39]
ds_read_b64 v[58:59],v20 offset:512
v_fma_f32 v174,v174,v208,v209
v_mfma_f32_16x16x32_bf16 v[32:35],a[128:131],v[64:67],v[32:35]
ds_read_b128 v[88:91],v6 offset:6144
v_fma_f32 v175,v175,v208,v209
v_mfma_f32_16x16x32_bf16 v[36:39],a[132:135],v[64:67],v[36:39]
ds_read_b64 v[60:61],v20 offset:1024
v_mul_f32 v174,v174,v46
v_mfma_f32_16x16x32_bf16 v[32:35],a[136:139],v[68:71],v[32:35]
ds_read_b128 v[92:95],v6 offset:7168
v_mul_f32 v175,v175,v47
v_mfma_f32_16x16x32_bf16 v[36:39],a[140:143],v[68:71],v[36:39]
s_waitcnt lgkmcnt(8)
ds_read_b64 v[62:63],v20 offset:1536
v_cvt_pk_bf16_f32 v176,v40,v41
v_mfma_f32_16x16x32_bf16 v[32:35],a[144:147],v[72:75],v[32:35]
ds_read_b128 v[96:99],v7 offset:0
v_cvt_pk_bf16_f32 v177,v42,v43
v_mfma_f32_16x16x32_bf16 v[36:39],a[148:151],v[72:75],v[36:39]
s_waitcnt lgkmcnt(9)
v_exp_f32 v174,v174
v_mfma_f32_16x16x32_bf16 v[32:35],a[152:155],v[76:79],v[32:35]
ds_read_b128 v[100:103],v7 offset:1024
v_add_f32 v174,1.0,v174
v_mfma_f32_16x16x32_bf16 v[36:39],a[156:159],v[76:79],v[36:39]
s_waitcnt lgkmcnt(9)
v_exp_f32 v175,v175
v_mfma_f32_16x16x32_bf16 v[32:35],a[160:163],v[80:83],v[32:35]
ds_read_b128 v[104:107],v7 offset:2048
v_add_f32 v175,1.0,v175
v_mfma_f32_16x16x32_bf16 v[36:39],a[164:167],v[80:83],v[36:39]
s_waitcnt lgkmcnt(8)
s_waitcnt lgkmcnt(3)
v_rcp_f32 v174,v174
v_mfma_f32_16x16x32_bf16 v[32:35],a[168:171],v[84:87],v[32:35]
ds_read_b128 v[108:111],v7 offset:3072
v_mul_f32 v46,v174,v46
v_mfma_f32_16x16x32_bf16 v[36:39],a[172:175],v[84:87],v[36:39]
v_rcp_f32 v175,v175
v_mfma_f32_16x16x32_bf16 v[32:35],a[176:179],v[88:91],v[32:35]
ds_read_b128 v[112:115],v7 offset:4096
v_mul_f32 v47,v175,v47
v_mfma_f32_16x16x32_bf16 v[36:39],a[180:183],v[88:91],v[36:39]
v_cvt_pk_bf16_f32 v178,v44,v45
v_cvt_pk_bf16_f32 v179,v46,v47
v_mfma_f32_16x16x32_bf16 v[32:35],a[184:187],v[92:95],v[32:35]
ds_read_b128 v[116:119],v7 offset:5120
v_add_f32 v56,v56,v58
v_mfma_f32_16x16x32_bf16 v[36:39],a[188:191],v[92:95],v[36:39]
s_waitcnt lgkmcnt(5)
buffer_store_dwordx4 v[176:179],v0,s[20:23],s66 offen sc1
v_mfma_f32_16x16x32_bf16 v[32:35],a[192:195],v[96:99],v[32:35]
s_add_u32 s66,s66,32768
s_add_u32 s63,s63,1
ds_read_b128 v[120:123],v7 offset:6144
v_mfma_f32_16x16x32_bf16 v[36:39],a[196:199],v[96:99],v[36:39]
s_waitcnt lgkmcnt(5)
v_add_f32 v57,v57,v59
v_add_f32 v60,v60,v62
v_mfma_f32_16x16x32_bf16 v[32:35],a[200:203],v[100:103],v[32:35]
ds_read_b128 v[124:127],v7 offset:7168
v_add_f32 v61,v61,v63
v_mfma_f32_16x16x32_bf16 v[36:39],a[204:207],v[100:103],v[36:39]
s_waitcnt lgkmcnt(5)
v_add_f32 v56,v56,v60
v_add_f32 v57,v57,v61
v_mfma_f32_16x16x32_bf16 v[32:35],a[208:211],v[104:107],v[32:35]
s_add_u32 s61,s61,32768
v_mul_f32 v188,0xba800000,v56
v_mul_f32 v58,v188,v188
v_mfma_f32_16x16x32_bf16 v[36:39],a[212:215],v[104:107],v[36:39]
s_waitcnt lgkmcnt(4)
v_mul_f32 v57,0x3a800000,v57
v_sub_f32 v57,v57,v58
v_mfma_f32_16x16x32_bf16 v[32:35],a[216:219],v[108:111],v[32:35]
s_add_u32 s62,s62,32768
v_max_f32 v57,0,v57
v_add_f32 v57,0x3727c5ac,v57
v_mfma_f32_16x16x32_bf16 v[36:39],a[220:223],v[108:111],v[36:39]
s_waitcnt lgkmcnt(3)
v_rsq_f32 v189,v57
v_mfma_f32_16x16x32_bf16 v[32:35],a[224:227],v[112:115],v[32:35]
s_add_u32 s70,s70,32768
s_and_b32 s70,s70,0x1ffff
s_add_u32 s55,s55,32768
v_mfma_f32_16x16x32_bf16 v[36:39],a[228:231],v[112:115],v[36:39]
s_waitcnt lgkmcnt(2)
s_and_b32 s55,s55,0x1ffff
v_add_u32 v4,s55,v8
v_mfma_f32_16x16x32_bf16 v[32:35],a[232:235],v[116:119],v[32:35]
v_add_u32 v5,s55,v9
v_add_u32 v6,s55,v10
v_mfma_f32_16x16x32_bf16 v[36:39],a[236:239],v[116:119],v[36:39]
s_waitcnt lgkmcnt(1)
v_add_u32 v7,s55,v11
v_mfma_f32_16x16x32_bf16 v[32:35],a[240:243],v[120:123],v[32:35]
s_waitcnt vmcnt(1)
ds_read_b128 v[64:67],v4 offset:0
v_mfma_f32_16x16x32_bf16 v[36:39],a[244:247],v[120:123],v[36:39]
s_waitcnt lgkmcnt(1)
ds_read_b128 v[68:71],v4 offset:1024
v_mfma_f32_16x16x32_bf16 v[40:43],a[248:251],v[124:127],v[32:35]
ds_read_b128 v[72:75],v4 offset:2048
v_mfma_f32_16x16x32_bf16 v[44:47],a[252:255],v[124:127],v[36:39]
v_cmp_gt_u32 vcc,s53,v16
s_add_u32 s60,s60,1
s_cbranch_vccz WR_301
WN_302:
s_waitcnt lgkmcnt(2)
v_mfma_f32_16x16x32_bf16 v[32:35],a[0:3],v[64:67],0
s_add_u32 s71,s60,2
s_add_u32 s53,s60,3
ds_read_b128 v[76:79],v4 offset:3072
v_mfma_f32_16x16x32_bf16 v[36:39],a[4:7],v[64:67],0
s_mov_b32 s57,s63
ds_read_b128 v[80:83],v4 offset:4096
v_mfma_f32_16x16x32_bf16 v[48:51],v[12:15],v[64:67],0
ds_read_b128 v[84:87],v4 offset:5120
v_fma_f32 v40,v152,v188,v40
v_fma_f32 v41,v153,v188,v41
v_mfma_f32_16x16x32_bf16 v[52:55],v[64:67],v[64:67],0
s_waitcnt lgkmcnt(4)
ds_read_b128 v[88:91],v4 offset:6144
v_mul_f32 v40,v40,v189
v_mul_f32 v41,v41,v189
v_mfma_f32_16x16x32_bf16 v[32:35],a[8:11],v[68:71],v[32:35]
ds_read_b128 v[92:95],v4 offset:7168
v_mul_f32 v168,v40,v40
v_mul_f32 v169,v41,v41
v_mfma_f32_16x16x32_bf16 v[36:39],a[12:15],v[68:71],v[36:39]
v_fma_f32 v168,v168,v208,v209
v_fma_f32 v169,v169,v208,v209
v_mul_f32 v168,v168,v40
v_mfma_f32_16x16x32_bf16 v[48:51],v[12:15],v[68:71],v[48:51]
v_exp_f32 v168,v168
v_mul_f32 v169,v169,v41
v_mfma_f32_16x16x32_bf16 v[52:55],v[68:71],v[68:71],v[52:55]
s_waitcnt lgkmcnt(5)
v_exp_f32 v169,v169
v_add_f32 v168,1.0,v168
v_mfma_f32_16x16x32_bf16 v[32:35],a[16:19],v[72:75],v[32:35]
s_barrier
ds_read_b128 v[96:99],v5 offset:0
v_rcp_f32 v168,v168
v_mfma_f32_16x16x32_bf16 v[36:39],a[20:23],v[72:75],v[36:39]
v_add_f32 v169,1.0,v169
v_rcp_f32 v169,v169
v_mfma_f32_16x16x32_bf16 v[48:51],v[12:15],v[72:75],v[48:51]
v_mul_f32 v40,v168,v40
v_mul_f32 v41,v169,v41
v_fma_f32 v42,v154,v188,v42
v_mfma_f32_16x16x32_bf16 v[52:55],v[72:75],v[72:75],v[52:55]
s_waitcnt lgkmcnt(5)
v_fma_f32 v43,v155,v188,v43
v_mul_f32 v42,v42,v189
v_mul_f32 v43,v43,v189
v_mfma_f32_16x16x32_bf16 v[32:35],a[24:27],v[76:79],v[32:35]
ds_read_b128 v[100:103],v5 offset:1024
v_mul_f32 v170,v42,v42
v_mul_f32 v171,v43,v43
v_mfma_f32_16x16x32_bf16 v[36:39],a[28:31],v[76:79],v[36:39]
v_fma_f32 v170,v170,v208,v209
v_fma_f32 v171,v171,v208,v209
v_mul_f32 v170,v170,v42
v_mfma_f32_16x16x32_bf16 v[48:51],v[12:15],v[76:79],v[48:51]
v_exp_f32 v170,v170
v_mul_f32 v171,v171,v43
v_mfma_f32_16x16x32_bf16 v[52:55],v[76:79],v[76:79],v[52:55]
s_waitcnt lgkmcnt(5)
v_exp_f32 v171,v171
v_add_f32 v170,1.0,v170
v_mfma_f32_16x16x32_bf16 v[32:35],a[32:35],v[80:83],v[32:35]
ds_read_b128 v[104:107],v5 offset:2048
v_rcp_f32 v170,v170
v_mfma_f32_16x16x32_bf16 v[36:39],a[36:39],v[80:83],v[36:39]
v_add_f32 v171,1.0,v171
v_mul_f32 v42,v170,v42
v_mfma_f32_16x16x32_bf16 v[48:51],v[12:15],v[80:83],v[48:51]
v_rcp_f32 v171,v171
v_mfma_f32_16x16x32_bf16 v[52:55],v[80:83],v[80:83],v[52:55]
s_waitcnt lgkmcnt(5)
v_mul_f32 v43,v171,v43
v_fma_f32 v44,v156,v188,v44
v_mfma_f32_16x16x32_bf16 v[32:35],a[40:43],v[84:87],v[32:35]
ds_read_b128 v[108:111],v5 offset:3072
v_fma_f32 v45,v157,v188,v45
v_mfma_f32_16x16x32_bf16 v[36:39],a[44:47],v[84:87],v[36:39]
s_waitcnt vmcnt(0)
v_mov_b32 v17,s57
s_mov_b64 exec,1
buffer_store_dword v17,off,s[20:23],s69 sc1
s_mov_b64 exec,-1
v_mfma_f32_16x16x32_bf16 v[48:51],v[12:15],v[84:87],v[48:51]
v_mul_f32 v44,v44,v189
v_mul_f32 v45,v45,v189
v_mfma_f32_16x16x32_bf16 v[52:55],v[84:87],v[84:87],v[52:55]
s_waitcnt lgkmcnt(5)
v_mul_f32 v172,v44,v44
v_mul_f32 v173,v45,v45
v_mfma_f32_16x16x32_bf16 v[32:35],a[48:51],v[88:91],v[32:35]
ds_read_b128 v[112:115],v5 offset:4096
v_fma_f32 v172,v172,v208,v209
v_mfma_f32_16x16x32_bf16 v[36:39],a[52:55],v[88:91],v[36:39]
v_fma_f32 v173,v173,v208,v209
v_mul_f32 v172,v172,v44
v_mfma_f32_16x16x32_bf16 v[48:51],v[12:15],v[88:91],v[48:51]
v_exp_f32 v172,v172
v_mfma_f32_16x16x32_bf16 v[52:55],v[88:91],v[88:91],v[52:55]
s_waitcnt lgkmcnt(5)
v_mul_f32 v173,v173,v45
v_add_f32 v172,1.0,v172
v_mfma_f32_16x16x32_bf16 v[32:35],a[56:59],v[92:95],v[32:35]
ds_read_b128 v[116:119],v5 offset:5120
v_fma_f32 v46,v158,v188,v46
v_mfma_f32_16x16x32_bf16 v[36:39],a[60:63],v[92:95],v[36:39]
v_exp_f32 v173,v173
v_mfma_f32_16x16x32_bf16 v[48:51],v[12:15],v[92:95],v[48:51]
v_rcp_f32 v172,v172
v_mfma_f32_16x16x32_bf16 v[52:55],v[92:95],v[92:95],v[52:55]
s_waitcnt lgkmcnt(5)
v_add_f32 v173,1.0,v173
v_mul_f32 v44,v172,v44
v_mfma_f32_16x16x32_bf16 v[32:35],a[64:67],v[96:99],v[32:35]
ds_read_b128 v[120:123],v5 offset:6144
v_fma_f32 v47,v159,v188,v47
v_mfma_f32_16x16x32_bf16 v[36:39],a[68:71],v[96:99],v[36:39]
s_waitcnt lgkmcnt(5)
v_rcp_f32 v173,v173
v_mfma_f32_16x16x32_bf16 v[32:35],a[72:75],v[100:103],v[32:35]
ds_read_b128 v[124:127],v5 offset:7168
v_mul_f32 v45,v173,v45
v_mfma_f32_16x16x32_bf16 v[36:39],a[76:79],v[100:103],v[36:39]
s_waitcnt lgkmcnt(5)
v_mul_f32 v46,v46,v189
v_mul_f32 v47,v47,v189
v_mfma_f32_16x16x32_bf16 v[32:35],a[80:83],v[104:107],v[32:35]
ds_read_b128 v[64:67],v6 offset:0
v_cndmask_b32 v49,v52,v53,s[74:75]
v_mfma_f32_16x16x32_bf16 v[36:39],a[84:87],v[104:107],v[36:39]
s_waitcnt lgkmcnt(5)
v_cndmask_b32 v49,v49,v54,s[76:77]
v_cndmask_b32 v49,v49,v55,s[78:79]
v_mfma_f32_16x16x32_bf16 v[32:35],a[88:91],v[108:111],v[32:35]
ds_read_b128 v[68:71],v6 offset:1024
v_mul_f32 v174,v46,v46
v_mfma_f32_16x16x32_bf16 v[36:39],a[92:95],v[108:111],v[36:39]
s_waitcnt lgkmcnt(5)
ds_write_b64 v19,v[48:49]
v_mfma_f32_16x16x32_bf16 v[32:35],a[96:99],v[112:115],v[32:35]
ds_read_b128 v[72:75],v6 offset:2048
v_mul_f32 v175,v47,v47
v_mfma_f32_16x16x32_bf16 v[36:39],a[100:103],v[112:115],v[36:39]
s_waitcnt lgkmcnt(6)
v_fma_f32 v174,v174,v208,v209
v_fma_f32 v175,v175,v208,v209
v_mfma_f32_16x16x32_bf16 v[32:35],a[104:107],v[116:119],v[32:35]
ds_read_b128 v[76:79],v6 offset:3072
v_mul_f32 v174,v174,v46
v_mfma_f32_16x16x32_bf16 v[36:39],a[108:111],v[116:119],v[36:39]
s_waitcnt lgkmcnt(6)
v_exp_f32 v174,v174
v_mfma_f32_16x16x32_bf16 v[32:35],a[112:115],v[120:123],v[32:35]
s_waitcnt lgkmcnt(2)
s_barrier
ds_read_b128 v[80:83],v6 offset:4096
v_mfma_f32_16x16x32_bf16 v[36:39],a[116:119],v[120:123],v[36:39]
ds_read_b64 v[56:57],v20 offset:0
v_mul_f32 v175,v175,v47
v_mfma_f32_16x16x32_bf16 v[32:35],a[120:123],v[124:127],v[32:35]
ds_read_b128 v[84:87],v6 offset:5120
v_add_f32 v174,1.0,v174
v_mfma_f32_16x16x32_bf16 v[36:39],a[124:127],v[124:127],v[36:39]
ds_read_b64 v[58:59],v20 offset:512
v_cvt_pk_bf16_f32 v176,v40,v41
v_mfma_f32_16x16x32_bf16 v[32:35],a[128:131],v[64:67],v[32:35]
ds_read_b128 v[88:91],v6 offset:6144
v_cvt_pk_bf16_f32 v177,v42,v43
v_mfma_f32_16x16x32_bf16 v[36:39],a[132:135],v[64:67],v[36:39]
ds_read_b64 v[60:61],v20 offset:1024
v_cvt_pk_bf16_f32 v178,v44,v45
v_mfma_f32_16x16x32_bf16 v[32:35],a[136:139],v[68:71],v[32:35]
ds_read_b128 v[92:95],v6 offset:7168
v_mfma_f32_16x16x32_bf16 v[36:39],a[140:143],v[68:71],v[36:39]
s_waitcnt lgkmcnt(8)
ds_read_b64 v[62:63],v20 offset:1536
v_mfma_f32_16x16x32_bf16 v[32:35],a[144:147],v[72:75],v[32:35]
ds_read_b128 v[96:99],v7 offset:0
v_mfma_f32_16x16x32_bf16 v[36:39],a[148:151],v[72:75],v[36:39]
s_waitcnt lgkmcnt(9)
buffer_load_dword v16,v2,s[20:23],s68 offen sc1
v_mfma_f32_16x16x32_bf16 v[32:35],a[152:155],v[76:79],v[32:35]
ds_read_b128 v[100:103],v7 offset:1024
v_mfma_f32_16x16x32_bf16 v[36:39],a[156:159],v[76:79],v[36:39]
s_waitcnt lgkmcnt(9)
v_exp_f32 v175,v175
v_mfma_f32_16x16x32_bf16 v[32:35],a[160:163],v[80:83],v[32:35]
ds_read_b128 v[104:107],v7 offset:2048
v_add_f32 v175,1.0,v175
v_mfma_f32_16x16x32_bf16 v[36:39],a[164:167],v[80:83],v[36:39]
s_waitcnt lgkmcnt(8)
s_waitcnt lgkmcnt(3)
v_rcp_f32 v174,v174
v_mfma_f32_16x16x32_bf16 v[32:35],a[168:171],v[84:87],v[32:35]
ds_read_b128 v[108:111],v7 offset:3072
v_mul_f32 v46,v174,v46
v_mfma_f32_16x16x32_bf16 v[36:39],a[172:175],v[84:87],v[36:39]
v_rcp_f32 v175,v175
v_mfma_f32_16x16x32_bf16 v[32:35],a[176:179],v[88:91],v[32:35]
ds_read_b128 v[112:115],v7 offset:4096
v_mul_f32 v47,v175,v47
v_mfma_f32_16x16x32_bf16 v[36:39],a[180:183],v[88:91],v[36:39]
v_cvt_pk_bf16_f32 v179,v46,v47
v_add_f32 v56,v56,v58
v_mfma_f32_16x16x32_bf16 v[32:35],a[184:187],v[92:95],v[32:35]
ds_read_b128 v[116:119],v7 offset:5120
v_add_f32 v57,v57,v59
v_mfma_f32_16x16x32_bf16 v[36:39],a[188:191],v[92:95],v[36:39]
s_waitcnt lgkmcnt(5)
buffer_store_dwordx4 v[176:179],v0,s[20:23],s66 offen sc1
v_mfma_f32_16x16x32_bf16 v[32:35],a[192:195],v[96:99],v[32:35]
s_add_u32 s66,s66,32768
s_add_u32 s63,s63,1
ds_read_b128 v[120:123],v7 offset:6144
v_mfma_f32_16x16x32_bf16 v[36:39],a[196:199],v[96:99],v[36:39]
s_waitcnt lgkmcnt(5)
v_add_f32 v60,v60,v62
v_add_f32 v61,v61,v63
v_mfma_f32_16x16x32_bf16 v[32:35],a[200:203],v[100:103],v[32:35]
ds_read_b128 v[124:127],v7 offset:7168
v_add_f32 v56,v56,v60
v_mfma_f32_16x16x32_bf16 v[36:39],a[204:207],v[100:103],v[36:39]
s_waitcnt lgkmcnt(5)
v_add_f32 v57,v57,v61
v_mul_f32 v188,0xba800000,v56
v_mfma_f32_16x16x32_bf16 v[32:35],a[208:211],v[104:107],v[32:35]
s_add_u32 s55,s55,32768
v_mul_f32 v58,v188,v188
v_mul_f32 v57,0x3a800000,v57
v_mfma_f32_16x16x32_bf16 v[36:39],a[212:215],v[104:107],v[36:39]
s_waitcnt lgkmcnt(4)
v_sub_f32 v57,v57,v58
v_max_f32 v57,0,v57
v_mfma_f32_16x16x32_bf16 v[32:35],a[216:219],v[108:111],v[32:35]
s_and_b32 s55,s55,0x1ffff
v_add_f32 v57,0x3727c5ac,v57
v_add_u32 v4,s55,v8
v_mfma_f32_16x16x32_bf16 v[36:39],a[220:223],v[108:111],v[36:39]
s_waitcnt lgkmcnt(3)
v_rsq_f32 v189,v57
v_mfma_f32_16x16x32_bf16 v[32:35],a[224:227],v[112:115],v[32:35]
v_add_u32 v5,s55,v9
v_add_u32 v6,s55,v10
v_mfma_f32_16x16x32_bf16 v[36:39],a[228:231],v[112:115],v[36:39]
s_waitcnt lgkmcnt(2)
v_add_u32 v7,s55,v11
v_mfma_f32_16x16x32_bf16 v[32:35],a[232:235],v[116:119],v[32:35]
v_mfma_f32_16x16x32_bf16 v[36:39],a[236:239],v[116:119],v[36:39]
s_waitcnt lgkmcnt(1)
v_mfma_f32_16x16x32_bf16 v[32:35],a[240:243],v[120:123],v[32:35]
v_mfma_f32_16x16x32_bf16 v[36:39],a[244:247],v[120:123],v[36:39]
s_waitcnt lgkmcnt(0)
v_mfma_f32_16x16x32_bf16 v[40:43],a[248:251],v[124:127],v[32:35]
v_mfma_f32_16x16x32_bf16 v[44:47],a[252:255],v[124:127],v[36:39]
s_waitcnt vmcnt(1)
v_cmp_gt_u32 vcc,s71,v16
s_add_u32 s60,s60,1
s_branch endN_310
BN_304:
s_waitcnt vmcnt(8)
ds_read_b128 v[64:67],v4 offset:0
s_waitcnt vmcnt(7)
ds_read_b128 v[68:71],v4 offset:1024
s_waitcnt vmcnt(6)
ds_read_b128 v[72:75],v4 offset:2048
s_waitcnt vmcnt(5)
ds_read_b128 v[76:79],v4 offset:3072
s_waitcnt lgkmcnt(3)
v_mfma_f32_16x16x32_bf16 v[32:35],a[0:3],v[64:67],0
s_add_u32 s71,s60,2
s_add_u32 s53,s60,3
s_mov_b32 s57,s63
v_mfma_f32_16x16x32_bf16 v[36:39],a[4:7],v[64:67],0
v_mfma_f32_16x16x32_bf16 v[48:51],v[12:15],v[64:67],0
v_mfma_f32_16x16x32_bf16 v[52:55],v[64:67],v[64:67],0
s_waitcnt lgkmcnt(2)
s_waitcnt vmcnt(4)
ds_read_b128 v[80:83],v4 offset:4096
v_mfma_f32_16x16x32_bf16 v[32:35],a[8:11],v[68:71],v[32:35]
v_mfma_f32_16x16x32_bf16 v[36:39],a[12:15],v[68:71],v[36:39]
v_mfma_f32_16x16x32_bf16 v[48:51],v[12:15],v[68:71],v[48:51]
v_mfma_f32_16x16x32_bf16 v[52:55],v[68:71],v[68:71],v[52:55]
s_waitcnt lgkmcnt(2)
s_waitcnt vmcnt(3)
ds_read_b128 v[84:87],v4 offset:5120
v_mfma_f32_16x16x32_bf16 v[32:35],a[16:19],v[72:75],v[32:35]
v_mfma_f32_16x16x32_bf16 v[36:39],a[20:23],v[72:75],v[36:39]
v_mfma_f32_16x16x32_bf16 v[48:51],v[12:15],v[72:75],v[48:51]
v_mfma_f32_16x16x32_bf16 v[52:55],v[72:75],v[72:75],v[52:55]
s_waitcnt lgkmcnt(2)
s_waitcnt vmcnt(2)
ds_read_b128 v[88:91],v4 offset:6144
v_mfma_f32_16x16x32_bf16 v[32:35],a[24:27],v[76:79],v[32:35]
v_mfma_f32_16x16x32_bf16 v[36:39],a[28:31],v[76:79],v[36:39]
v_mfma_f32_16x16x32_bf16 v[48:51],v[12:15],v[76:79],v[48:51]
v_mfma_f32_16x16x32_bf16 v[52:55],v[76:79],v[76:79],v[52:55]
s_waitcnt lgkmcnt(2)
s_waitcnt vmcnt(1)
ds_read_b128 v[92:95],v4 offset:7168
v_mfma_f32_16x16x32_bf16 v[32:35],a[32:35],v[80:83],v[32:35]
v_mfma_f32_16x16x32_bf16 v[36:39],a[36:39],v[80:83],v[36:39]
v_mfma_f32_16x16x32_bf16 v[48:51],v[12:15],v[80:83],v[48:51]
v_mfma_f32_16x16x32_bf16 v[52:55],v[80:83],v[80:83],v[52:55]
s_waitcnt lgkmcnt(2)
s_barrier
ds_read_b128 v[96:99],v5 offset:0
v_mfma_f32_16x16x32_bf16 v[32:35],a[40:43],v[84:87],v[32:35]
ds_read_b128 v[100:103],v5 offset:1024
v_mfma_f32_16x16x32_bf16 v[36:39],a[44:47],v[84:87],v[36:39]
ds_read_b128 v[104:107],v5 offset:2048
v_mfma_f32_16x16x32_bf16 v[48:51],v[12:15],v[84:87],v[48:51]
ds_read_b128 v[108:111],v5 offset:3072
v_mfma_f32_16x16x32_bf16 v[52:55],v[84:87],v[84:87],v[52:55]
s_waitcnt lgkmcnt(5)
s_waitcnt vmcnt(0)
v_mov_b32 v17,s57
s_mov_b64 exec,1
buffer_store_dword v17,off,s[20:23],s69 sc1
s_mov_b64 exec,-1
v_mfma_f32_16x16x32_bf16 v[32:35],a[48:51],v[88:91],v[32:35]
ds_read_b128 v[112:115],v5 offset:4096
v_mfma_f32_16x16x32_bf16 v[36:39],a[52:55],v[88:91],v[36:39]
v_mfma_f32_16x16x32_bf16 v[48:51],v[12:15],v[88:91],v[48:51]
v_mfma_f32_16x16x32_bf16 v[52:55],v[88:91],v[88:91],v[52:55]
s_waitcnt lgkmcnt(5)
v_mfma_f32_16x16x32_bf16 v[32:35],a[56:59],v[92:95],v[32:35]
ds_read_b128 v[116:119],v5 offset:5120
v_mfma_f32_16x16x32_bf16 v[36:39],a[60:63],v[92:95],v[36:39]
v_mfma_f32_16x16x32_bf16 v[48:51],v[12:15],v[92:95],v[48:51]
v_mfma_f32_16x16x32_bf16 v[52:55],v[92:95],v[92:95],v[52:55]
s_waitcnt lgkmcnt(5)
v_mfma_f32_16x16x32_bf16 v[32:35],a[64:67],v[96:99],v[32:35]
ds_read_b128 v[120:123],v5 offset:6144
v_mfma_f32_16x16x32_bf16 v[36:39],a[68:71],v[96:99],v[36:39]
s_waitcnt lgkmcnt(5)
v_mfma_f32_16x16x32_bf16 v[32:35],a[72:75],v[100:103],v[32:35]
ds_read_b128 v[124:127],v5 offset:7168
v_mfma_f32_16x16x32_bf16 v[36:39],a[76:79],v[100:103],v[36:39]
s_waitcnt lgkmcnt(5)
v_mfma_f32_16x16x32_bf16 v[32:35],a[80:83],v[104:107],v[32:35]
ds_read_b128 v[64:67],v6 offset:0
v_cndmask_b32 v49,v52,v53,s[74:75]
v_mfma_f32_16x16x32_bf16 v[36:39],a[84:87],v[104:107],v[36:39]
s_waitcnt lgkmcnt(5)
v_cndmask_b32 v49,v49,v54,s[76:77]
v_cndmask_b32 v49,v49,v55,s[78:79]
v_mfma_f32_16x16x32_bf16 v[32:35],a[88:91],v[108:111],v[32:35]
ds_read_b128 v[68:71],v6 offset:1024
v_mfma_f32_16x16x32_bf16 v[36:39],a[92:95],v[108:111],v[36:39]
s_waitcnt lgkmcnt(5)
ds_write_b64 v19,v[48:49]
v_mfma_f32_16x16x32_bf16 v[32:35],a[96:99],v[112:115],v[32:35]
ds_read_b128 v[72:75],v6 offset:2048
v_mfma_f32_16x16x32_bf16 v[36:39],a[100:103],v[112:115],v[36:39]
s_waitcnt lgkmcnt(6)
v_mfma_f32_16x16x32_bf16 v[32:35],a[104:107],v[116:119],v[32:35]
ds_read_b128 v[76:79],v6 offset:3072
v_mfma_f32_16x16x32_bf16 v[36:39],a[108:111],v[116:119],v[36:39]
s_waitcnt lgkmcnt(6)
v_mfma_f32_16x16x32_bf16 v[32:35],a[112:115],v[120:123],v[32:35]
s_waitcnt lgkmcnt(2)
s_barrier
ds_read_b128 v[80:83],v6 offset:4096
v_mfma_f32_16x16x32_bf16 v[36:39],a[116:119],v[120:123],v[36:39]
ds_read_b64 v[56:57],v20 offset:0
v_mfma_f32_16x16x32_bf16 v[32:35],a[120:123],v[124:127],v[32:35]
ds_read_b128 v[84:87],v6 offset:5120
v_mfma_f32_16x16x32_bf16 v[36:39],a[124:127],v[124:127],v[36:39]
ds_read_b64 v[58:59],v20 offset:512
v_mfma_f32_16x16x32_bf16 v[32:35],a[128:131],v[64:67],v[32:35]
ds_read_b128 v[88:91],v6 offset:6144
v_mfma_f32_16x16x32_bf16 v[36:39],a[132:135],v[64:67],v[36:39]
ds_read_b64 v[60:61],v20 offset:1024
v_mfma_f32_16x16x32_bf16 v[32:35],a[136:139],v[68:71],v[32:35]
ds_read_b128 v[92:95],v6 offset:7168
v_mfma_f32_16x16x32_bf16 v[36:39],a[140:143],v[68:71],v[36:39]
s_waitcnt lgkmcnt(8)
ds_read_b64 v[62:63],v20 offset:1536
v_mfma_f32_16x16x32_bf16 v[32:35],a[144:147],v[72:75],v[32:35]
ds_read_b128 v[96:99],v7 offset:0
v_mfma_f32_16x16x32_bf16 v[36:39],a[148:151],v[72:75],v[36:39]
s_waitcnt lgkmcnt(9)
buffer_load_dword v16,v2,s[20:23],s68 offen sc1
v_mfma_f32_16x16x32_bf16 v[32:35],a[152:155],v[76:79],v[32:35]
ds_read_b128 v[100:103],v7 offset:1024
v_mfma_f32_16x16x32_bf16 v[36:39],a[156:159],v[76:79],v[36:39]
s_waitcnt lgkmcnt(9)
v_mfma_f32_16x16x32_bf16 v[32:35],a[160:163],v[80:83],v[32:35]
ds_read_b128 v[104:107],v7 offset:2048
v_mfma_f32_16x16x32_bf16 v[36:39],a[164:167],v[80:83],v[36:39]
s_waitcnt lgkmcnt(8)
s_waitcnt lgkmcnt(3)
v_add_f32 v56,v56,v58
v_mfma_f32_16x16x32_bf16 v[32:35],a[168:171],v[84:87],v[32:35]
ds_read_b128 v[108:111],v7 offset:3072
v_add_f32 v57,v57,v59
v_mfma_f32_16x16x32_bf16 v[36:39],a[172:175],v[84:87],v[36:39]
v_add_f32 v60,v60,v62
v_add_f32 v61,v61,v63
v_mfma_f32_16x16x32_bf16 v[32:35],a[176:179],v[88:91],v[32:35]
ds_read_b128 v[112:115],v7 offset:4096
v_add_f32 v56,v56,v60
v_mfma_f32_16x16x32_bf16 v[36:39],a[180:183],v[88:91],v[36:39]
v_add_f32 v57,v57,v61
v_mul_f32 v188,0xba800000,v56
v_mfma_f32_16x16x32_bf16 v[32:35],a[184:187],v[92:95],v[32:35]
ds_read_b128 v[116:119],v7 offset:5120
v_mul_f32 v58,v188,v188
v_mfma_f32_16x16x32_bf16 v[36:39],a[188:191],v[92:95],v[36:39]
s_waitcnt lgkmcnt(5)
v_mul_f32 v57,0x3a800000,v57
v_sub_f32 v57,v57,v58
v_mfma_f32_16x16x32_bf16 v[32:35],a[192:195],v[96:99],v[32:35]
ds_read_b128 v[120:123],v7 offset:6144
v_max_f32 v57,0,v57
v_mfma_f32_16x16x32_bf16 v[36:39],a[196:199],v[96:99],v[36:39]
s_waitcnt lgkmcnt(5)
v_add_f32 v57,0x3727c5ac,v57
v_mfma_f32_16x16x32_bf16 v[32:35],a[200:203],v[100:103],v[32:35]
ds_read_b128 v[124:127],v7 offset:7168
v_mfma_f32_16x16x32_bf16 v[36:39],a[204:207],v[100:103],v[36:39]
s_waitcnt lgkmcnt(5)
v_rsq_f32 v189,v57
v_mfma_f32_16x16x32_bf16 v[32:35],a[208:211],v[104:107],v[32:35]
s_add_u32 s55,s55,32768
s_and_b32 s55,s55,0x1ffff
v_add_u32 v4,s55,v8
v_mfma_f32_16x16x32_bf16 v[36:39],a[212:215],v[104:107],v[36:39]
s_waitcnt lgkmcnt(4)
v_add_u32 v5,s55,v9
v_add_u32 v6,s55,v10
v_mfma_f32_16x16x32_bf16 v[32:35],a[216:219],v[108:111],v[32:35]
v_add_u32 v7,s55,v11
v_mfma_f32_16x16x32_bf16 v[36:39],a[220:223],v[108:111],v[36:39]
s_waitcnt lgkmcnt(3)
v_mfma_f32_16x16x32_bf16 v[32:35],a[224:227],v[112:115],v[32:35]
v_mfma_f32_16x16x32_bf16 v[36:39],a[228:231],v[112:115],v[36:39]
s_waitcnt lgkmcnt(2)
v_mfma_f32_16x16x32_bf16 v[32:35],a[232:235],v[116:119],v[32:35]
v_mfma_f32_16x16x32_bf16 v[36:39],a[236:239],v[116:119],v[36:39]
s_waitcnt lgkmcnt(1)
v_mfma_f32_16x16x32_bf16 v[32:35],a[240:243],v[120:123],v[32:35]
v_mfma_f32_16x16x32_bf16 v[36:39],a[244:247],v[120:123],v[36:39]
s_waitcnt lgkmcnt(0)
v_mfma_f32_16x16x32_bf16 v[40:43],a[248:251],v[124:127],v[32:35]
v_mfma_f32_16x16x32_bf16 v[44:47],a[252:255],v[124:127],v[36:39]
s_waitcnt vmcnt(0)
v_cmp_gt_u32 vcc,s71,v16
s_add_u32 s60,s60,1
endN_310:
s_cbranch_vccnz nb_307
s_mov_b32 m0,s70
s_nop 0
buffer_load_dwordx4 v3,s[20:23],s61 offen offset:0 lds
buffer_load_dwordx4 v3,s[20:23],s61 offen offset:1024 lds
buffer_load_dwordx4 v3,s[20:23],s61 offen offset:2048 lds
buffer_load_dwordx4 v3,s[20:23],s61 offen offset:3072 lds
s_add_u32 m0,s70,4096
s_nop 0
buffer_load_dwordx4 v3,s[20:23],s62 offen offset:0 lds
buffer_load_dwordx4 v3,s[20:23],s62 offen offset:1024 lds
buffer_load_dwordx4 v3,s[20:23],s62 offen offset:2048 lds
buffer_load_dwordx4 v3,s[20:23],s62 offen offset:3072 lds
s_add_u32 s61,s61,32768
s_add_u32 s62,s62,32768
s_add_u32 s70,s70,32768
s_and_b32 s70,s70,0x1ffff
v_pk_fma_f32 v[40:41],v[152:153],v[188:189],v[40:41] op_sel_hi:[1,0,1]
v_pk_fma_f32 v[42:43],v[154:155],v[188:189],v[42:43] op_sel_hi:[1,0,1]
v_pk_fma_f32 v[44:45],v[156:157],v[188:189],v[44:45] op_sel_hi:[1,0,1]
v_pk_fma_f32 v[46:47],v[158:159],v[188:189],v[46:47] op_sel_hi:[1,0,1]
v_pk_mul_f32 v[40:41],v[40:41],v[188:189] op_sel:[0,1] op_sel_hi:[1,1]
v_pk_mul_f32 v[42:43],v[42:43],v[188:189] op_sel:[0,1] op_sel_hi:[1,1]
v_pk_mul_f32 v[44:45],v[44:45],v[188:189] op_sel:[0,1] op_sel_hi:[1,1]
v_pk_mul_f32 v[46:47],v[46:47],v[188:189] op_sel:[0,1] op_sel_hi:[1,1]
v_pk_mul_f32 v[168:169],v[40:41],v[40:41]
v_pk_mul_f32 v[170:171],v[42:43],v[42:43]
v_pk_mul_f32 v[172:173],v[44:45],v[44:45]
v_pk_mul_f32 v[174:175],v[46:47],v[46:47]
s_waitcnt vmcnt(8)
v_mov_b32 v17,s63
s_mov_b64 exec,1
buffer_store_dword v17,off,s[20:23],s69 sc1
s_mov_b64 exec,-1
v_pk_fma_f32 v[168:169],v[168:169],v[208:209],v[208:209] op_sel:[0,0,1] op_sel_hi:[1,0,1]
v_pk_fma_f32 v[170:171],v[170:171],v[208:209],v[208:209] op_sel:[0,0,1] op_sel_hi:[1,0,1]
v_pk_fma_f32 v[172:173],v[172:173],v[208:209],v[208:209] op_sel:[0,0,1] op_sel_hi:[1,0,1]
v_pk_fma_f32 v[174:175],v[174:175],v[208:209],v[208:209] op_sel:[0,0,1] op_sel_hi:[1,0,1]
v_pk_mul_f32 v[168:169],v[168:169],v[40:41]
v_pk_mul_f32 v[170:171],v[170:171],v[42:43]
v_pk_mul_f32 v[172:173],v[172:173],v[44:45]
v_pk_mul_f32 v[174:175],v[174:175],v[46:47]
v_exp_f32 v168,v168
v_exp_f32 v169,v169
v_exp_f32 v170,v170
v_exp_f32 v171,v171
v_exp_f32 v172,v172
v_exp_f32 v173,v173
v_exp_f32 v174,v174
v_exp_f32 v175,v175
v_pk_add_f32 v[168:169],v[168:169],v[210:211]
v_pk_add_f32 v[170:171],v[170:171],v[210:211]
v_pk_add_f32 v[172:173],v[172:173],v[210:211]
v_pk_add_f32 v[174:175],v[174:175],v[210:211]
v_rcp_f32 v168,v168
v_rcp_f32 v169,v169
v_rcp_f32 v170,v170
v_rcp_f32 v171,v171
v_rcp_f32 v172,v172
v_rcp_f32 v173,v173
v_rcp_f32 v174,v174
v_rcp_f32 v175,v175
v_pk_mul_f32 v[40:41],v[168:169],v[40:41]
v_pk_mul_f32 v[42:43],v[170:171],v[42:43]
v_pk_mul_f32 v[44:45],v[172:173],v[44:45]
v_pk_mul_f32 v[46:47],v[174:175],v[46:47]
v_cvt_pk_bf16_f32 v176,v40,v41
v_cvt_pk_bf16_f32 v177,v42,v43
v_cvt_pk_bf16_f32 v178,v44,v45
v_cvt_pk_bf16_f32 v179,v46,v47
buffer_store_dwordx4 v[176:179],v0,s[20:23],s66 offen sc1
s_add_u32 s66,s66,32768
s_add_u32 s63,s63,1
s_branch dec_306
nb_307:
buffer_load_dword v16,v2,s[20:23],s68 offen sc1
s_nop 3
v_pk_fma_f32 v[40:41],v[152:153],v[188:189],v[40:41] op_sel_hi:[1,0,1]
v_pk_fma_f32 v[42:43],v[154:155],v[188:189],v[42:43] op_sel_hi:[1,0,1]
v_pk_fma_f32 v[44:45],v[156:157],v[188:189],v[44:45] op_sel_hi:[1,0,1]
v_pk_fma_f32 v[46:47],v[158:159],v[188:189],v[46:47] op_sel_hi:[1,0,1]
v_pk_mul_f32 v[40:41],v[40:41],v[188:189] op_sel:[0,1] op_sel_hi:[1,1]
v_pk_mul_f32 v[42:43],v[42:43],v[188:189] op_sel:[0,1] op_sel_hi:[1,1]
v_pk_mul_f32 v[44:45],v[44:45],v[188:189] op_sel:[0,1] op_sel_hi:[1,1]
v_pk_mul_f32 v[46:47],v[46:47],v[188:189] op_sel:[0,1] op_sel_hi:[1,1]
v_pk_mul_f32 v[168:169],v[40:41],v[40:41]
v_pk_mul_f32 v[170:171],v[42:43],v[42:43]
v_pk_mul_f32 v[172:173],v[44:45],v[44:45]
v_pk_mul_f32 v[174:175],v[46:47],v[46:47]
s_waitcnt vmcnt(1)
v_mov_b32 v17,s63
s_mov_b64 exec,1
buffer_store_dword v17,off,s[20:23],s69 sc1
s_mov_b64 exec,-1
v_pk_fma_f32 v[168:169],v[168:169],v[208:209],v[208:209] op_sel:[0,0,1] op_sel_hi:[1,0,1]
v_pk_fma_f32 v[170:171],v[170:171],v[208:209],v[208:209] op_sel:[0,0,1] op_sel_hi:[1,0,1]
v_pk_fma_f32 v[172:173],v[172:173],v[208:209],v[208:209] op_sel:[0,0,1] op_sel_hi:[1,0,1]
v_pk_fma_f32 v[174:175],v[174:175],v[208:209],v[208:209] op_sel:[0,0,1] op_sel_hi:[1,0,1]
v_pk_mul_f32 v[168:169],v[168:169],v[40:41]
v_pk_mul_f32 v[170:171],v[170:171],v[42:43]
v_pk_mul_f32 v[172:173],v[172:173],v[44:45]
v_pk_mul_f32 v[174:175],v[174:175],v[46:47]
v_exp_f32 v168,v168
v_exp_f32 v169,v169
v_exp_f32 v170,v170
v_exp_f32 v171,v171
v_exp_f32 v172,v172
v_exp_f32 v173,v173
v_exp_f32 v174,v174
v_exp_f32 v175,v175
v_pk_add_f32 v[168:169],v[168:169],v[210:211]
v_pk_add_f32 v[170:171],v[170:171],v[210:211]
v_pk_add_f32 v[172:173],v[172:173],v[210:211]
v_pk_add_f32 v[174:175],v[174:175],v[210:211]
v_rcp_f32 v168,v168
v_rcp_f32 v169,v169
v_rcp_f32 v170,v170
v_rcp_f32 v171,v171
v_rcp_f32 v172,v172
v_rcp_f32 v173,v173
v_rcp_f32 v174,v174
v_rcp_f32 v175,v175
v_pk_mul_f32 v[40:41],v[168:169],v[40:41]
v_pk_mul_f32 v[42:43],v[170:171],v[42:43]
v_pk_mul_f32 v[44:45],v[172:173],v[44:45]
v_pk_mul_f32 v[46:47],v[174:175],v[46:47]
v_cvt_pk_bf16_f32 v176,v40,v41
v_cvt_pk_bf16_f32 v177,v42,v43
v_cvt_pk_bf16_f32 v178,v44,v45
v_cvt_pk_bf16_f32 v179,v46,v47
buffer_store_dwordx4 v[176:179],v0,s[20:23],s66 offen sc1
s_add_u32 s66,s66,32768
s_add_u32 s63,s63,1
s_waitcnt vmcnt(2)
v_cmp_gt_u32 vcc,s71,v16
s_cbranch_vccz lag_305
s_waitcnt vmcnt(0)
v_mov_b32 v17,s63
s_mov_b64 exec,1
buffer_store_dword v17,off,s[20:23],s69 sc1
s_mov_b64 exec,-1
s_cmp_ge_u32 s60,128
s_cbranch_scc1 done_294
plp_311:
buffer_load_dword v16,v2,s[20:23],s68 offen sc1
s_waitcnt vmcnt(0)
v_cmp_gt_u32 vcc,s71,v16
s_cbranch_vccz pok_312
s_sleep 4
s_sub_u32 s90,s90,1
s_cmp_gt_i32 s90,0
s_cbranch_scc1 plp_311
pok_312:
s_branch lag_305
done_294:
s_endpgm
fl_w2:
v_and_b32 v21,15,v1
v_lshrrev_b32 v22,4,v1
v_lshrrev_b32 v23,2,v21
v_and_b32 v24,3,v21
s_lshl_b32 s61,s50,15
v_lshl_add_u32 v25,v22,3,v23
s_load_dwordx2 s[4:5],s[0:1],72
s_mov_b32 s52,0
s_mov_b32 s53,s59
s_mul_i32 s54,s52,2097152
s_lshl_b32 s64,s53,8
s_add_u32 s54,s54,s64
s_lshl_b32 s64,s50,6
s_add_u32 s54,s54,s64
s_waitcnt lgkmcnt(0)
s_mov_b32 s28,s4
s_and_b32 s29,s5,0xffff
s_mov_b32 s30,0x200000
s_mov_b32 s31,0x20000
v_lshrrev_b32 v26,2,v1
v_and_b32 v27,3,v1
v_mul_u32_u24 v16,2048,v26
v_lshl_add_u32 v16,v27,4,v16
v_lshlrev_b32 v17,6,v25
v_lshl_add_u32 v17,v24,4,v17
v_add_u32 v17,s61,v17
s_xor_b32 s62,s50,0
s_mul_i32 s62,s62,524288
s_add_u32 s62,s62,s54
s_add_u32 m0,s61,0
s_nop 0
buffer_load_dwordx4 v16,s[28:31],s62 offen lds
s_add_u32 s62,s62,32768
s_add_u32 m0,m0,1024
s_waitcnt vmcnt(6)
buffer_load_dwordx4 v16,s[28:31],s62 offen lds
s_add_u32 s62,s62,32768
s_add_u32 m0,m0,1024
s_waitcnt vmcnt(6)
buffer_load_dwordx4 v16,s[28:31],s62 offen lds
s_add_u32 s62,s62,32768
s_add_u32 m0,m0,1024
s_waitcnt vmcnt(6)
buffer_load_dwordx4 v16,s[28:31],s62 offen lds
s_add_u32 s62,s62,32768
s_add_u32 m0,m0,1024
s_waitcnt vmcnt(6)
buffer_load_dwordx4 v16,s[28:31],s62 offen lds
s_add_u32 s62,s62,32768
s_add_u32 m0,m0,1024
s_waitcnt vmcnt(6)
buffer_load_dwordx4 v16,s[28:31],s62 offen lds
s_add_u32 s62,s62,32768
s_add_u32 m0,m0,1024
s_waitcnt vmcnt(6)
buffer_load_dwordx4 v16,s[28:31],s62 offen lds
s_add_u32 s62,s62,32768
s_add_u32 m0,m0,1024
s_waitcnt vmcnt(6)
buffer_load_dwordx4 v16,s[28:31],s62 offen lds
s_add_u32 s62,s62,32768
s_add_u32 m0,m0,1024
s_waitcnt vmcnt(6)
buffer_load_dwordx4 v16,s[28:31],s62 offen lds
s_add_u32 s62,s62,32768
s_add_u32 m0,m0,1024
s_waitcnt vmcnt(6)
buffer_load_dwordx4 v16,s[28:31],s62 offen lds
s_add_u32 s62,s62,32768
s_add_u32 m0,m0,1024
s_waitcnt vmcnt(6)
buffer_load_dwordx4 v16,s[28:31],s62 offen lds
s_add_u32 s62,s62,32768
s_add_u32 m0,m0,1024
s_waitcnt vmcnt(6)
buffer_load_dwordx4 v16,s[28:31],s62 offen lds
s_add_u32 s62,s62,32768
s_add_u32 m0,m0,1024
s_waitcnt vmcnt(6)
buffer_load_dwordx4 v16,s[28:31],s62 offen lds
s_add_u32 s62,s62,32768
s_add_u32 m0,m0,1024
s_waitcnt vmcnt(6)
buffer_load_dwordx4 v16,s[28:31],s62 offen lds
s_add_u32 s62,s62,32768
s_add_u32 m0,m0,1024
s_waitcnt vmcnt(6)
buffer_load_dwordx4 v16,s[28:31],s62 offen lds
s_add_u32 s62,s62,32768
s_add_u32 m0,m0,1024
s_waitcnt vmcnt(6)
buffer_load_dwordx4 v16,s[28:31],s62 offen lds
s_waitcnt vmcnt(6)
s_xor_b32 s62,s50,1
s_mul_i32 s62,s62,524288
s_add_u32 s62,s62,s54
s_add_u32 m0,s61,16384
s_nop 0
buffer_load_dwordx4 v16,s[28:31],s62 offen lds
s_add_u32 s62,s62,32768
s_add_u32 m0,m0,1024
s_waitcnt vmcnt(6)
buffer_load_dwordx4 v16,s[28:31],s62 offen lds
s_add_u32 s62,s62,32768
s_add_u32 m0,m0,1024
s_waitcnt vmcnt(6)
buffer_load_dwordx4 v16,s[28:31],s62 offen lds
s_add_u32 s62,s62,32768
s_add_u32 m0,m0,1024
s_waitcnt vmcnt(6)
buffer_load_dwordx4 v16,s[28:31],s62 offen lds
s_add_u32 s62,s62,32768
s_add_u32 m0,m0,1024
s_waitcnt vmcnt(6)
buffer_load_dwordx4 v16,s[28:31],s62 offen lds
s_add_u32 s62,s62,32768
s_add_u32 m0,m0,1024
s_waitcnt vmcnt(6)
buffer_load_dwordx4 v16,s[28:31],s62 offen lds
s_add_u32 s62,s62,32768
s_add_u32 m0,m0,1024
s_waitcnt vmcnt(6)
buffer_load_dwordx4 v16,s[28:31],s62 offen lds
s_add_u32 s62,s62,32768
s_add_u32 m0,m0,1024
s_waitcnt vmcnt(6)
buffer_load_dwordx4 v16,s[28:31],s62 offen lds
s_add_u32 s62,s62,32768
s_add_u32 m0,m0,1024
s_waitcnt vmcnt(6)
buffer_load_dwordx4 v16,s[28:31],s62 offen lds
s_add_u32 s62,s62,32768
s_add_u32 m0,m0,1024
s_waitcnt vmcnt(6)
buffer_load_dwordx4 v16,s[28:31],s62 offen lds
s_add_u32 s62,s62,32768
s_add_u32 m0,m0,1024
s_waitcnt vmcnt(6)
buffer_load_dwordx4 v16,s[28:31],s62 offen lds
s_add_u32 s62,s62,32768
s_add_u32 m0,m0,1024
s_waitcnt vmcnt(6)
buffer_load_dwordx4 v16,s[28:31],s62 offen lds
s_add_u32 s62,s62,32768
s_add_u32 m0,m0,1024
s_waitcnt vmcnt(6)
buffer_load_dwordx4 v16,s[28:31],s62 offen lds
s_add_u32 s62,s62,32768
s_add_u32 m0,m0,1024
s_waitcnt vmcnt(6)
buffer_load_dwordx4 v16,s[28:31],s62 offen lds
s_add_u32 s62,s62,32768
s_add_u32 m0,m0,1024
s_waitcnt vmcnt(6)
buffer_load_dwordx4 v16,s[28:31],s62 offen lds
s_add_u32 s62,s62,32768
s_add_u32 m0,m0,1024
s_waitcnt vmcnt(6)
buffer_load_dwordx4 v16,s[28:31],s62 offen lds
s_waitcnt vmcnt(6)
s_waitcnt vmcnt(16)
ds_read_b64_tr_b16 a[0:1],v17 offset:0
ds_read_b64_tr_b16 a[2:3],v17 offset:256
ds_read_b64_tr_b16 a[4:5],v17 offset:8
ds_read_b64_tr_b16 a[6:7],v17 offset:264
ds_read_b64_tr_b16 a[8:9],v17 offset:2048
ds_read_b64_tr_b16 a[10:11],v17 offset:2304
ds_read_b64_tr_b16 a[12:13],v17 offset:2056
ds_read_b64_tr_b16 a[14:15],v17 offset:2312
ds_read_b64_tr_b16 a[16:17],v17 offset:4096
ds_read_b64_tr_b16 a[18:19],v17 offset:4352
ds_read_b64_tr_b16 a[20:21],v17 offset:4104
ds_read_b64_tr_b16 a[22:23],v17 offset:4360
s_waitcnt lgkmcnt(0)
ds_read_b64_tr_b16 a[24:25],v17 offset:6144
ds_read_b64_tr_b16 a[26:27],v17 offset:6400
ds_read_b64_tr_b16 a[28:29],v17 offset:6152
ds_read_b64_tr_b16 a[30:31],v17 offset:6408
ds_read_b64_tr_b16 a[32:33],v17 offset:8192
ds_read_b64_tr_b16 a[34:35],v17 offset:8448
ds_read_b64_tr_b16 a[36:37],v17 offset:8200
ds_read_b64_tr_b16 a[38:39],v17 offset:8456
ds_read_b64_tr_b16 a[40:41],v17 offset:10240
ds_read_b64_tr_b16 a[42:43],v17 offset:10496
ds_read_b64_tr_b16 a[44:45],v17 offset:10248
ds_read_b64_tr_b16 a[46:47],v17 offset:10504
s_waitcnt lgkmcnt(0)
ds_read_b64_tr_b16 a[48:49],v17 offset:12288
ds_read_b64_tr_b16 a[50:51],v17 offset:12544
ds_read_b64_tr_b16 a[52:53],v17 offset:12296
ds_read_b64_tr_b16 a[54:55],v17 offset:12552
ds_read_b64_tr_b16 a[56:57],v17 offset:14336
ds_read_b64_tr_b16 a[58:59],v17 offset:14592
ds_read_b64_tr_b16 a[60:61],v17 offset:14344
ds_read_b64_tr_b16 a[62:63],v17 offset:14600
s_waitcnt lgkmcnt(0)
s_xor_b32 s62,s50,2
s_mul_i32 s62,s62,524288
s_add_u32 s62,s62,s54
s_add_u32 m0,s61,0
s_nop 0
buffer_load_dwordx4 v16,s[28:31],s62 offen lds
s_add_u32 s62,s62,32768
s_add_u32 m0,m0,1024
s_waitcnt vmcnt(6)
buffer_load_dwordx4 v16,s[28:31],s62 offen lds
s_add_u32 s62,s62,32768
s_add_u32 m0,m0,1024
s_waitcnt vmcnt(6)
buffer_load_dwordx4 v16,s[28:31],s62 offen lds
s_add_u32 s62,s62,32768
s_add_u32 m0,m0,1024
s_waitcnt vmcnt(6)
buffer_load_dwordx4 v16,s[28:31],s62 offen lds
s_add_u32 s62,s62,32768
s_add_u32 m0,m0,1024
s_waitcnt vmcnt(6)
buffer_load_dwordx4 v16,s[28:31],s62 offen lds
s_add_u32 s62,s62,32768
s_add_u32 m0,m0,1024
s_waitcnt vmcnt(6)
buffer_load_dwordx4 v16,s[28:31],s62 offen lds
s_add_u32 s62,s62,32768
s_add_u32 m0,m0,1024
s_waitcnt vmcnt(6)
buffer_load_dwordx4 v16,s[28:31],s62 offen lds
s_add_u32 s62,s62,32768
s_add_u32 m0,m0,1024
s_waitcnt vmcnt(6)
buffer_load_dwordx4 v16,s[28:31],s62 offen lds
s_add_u32 s62,s62,32768
s_add_u32 m0,m0,1024
s_waitcnt vmcnt(6)
buffer_load_dwordx4 v16,s[28:31],s62 offen lds
s_add_u32 s62,s62,32768
s_add_u32 m0,m0,1024
s_waitcnt vmcnt(6)
buffer_load_dwordx4 v16,s[28:31],s62 offen lds
s_add_u32 s62,s62,32768
s_add_u32 m0,m0,1024
s_waitcnt vmcnt(6)
buffer_load_dwordx4 v16,s[28:31],s62 offen lds
s_add_u32 s62,s62,32768
s_add_u32 m0,m0,1024
s_waitcnt vmcnt(6)
buffer_load_dwordx4 v16,s[28:31],s62 offen lds
s_add_u32 s62,s62,32768
s_add_u32 m0,m0,1024
s_waitcnt vmcnt(6)
buffer_load_dwordx4 v16,s[28:31],s62 offen lds
s_add_u32 s62,s62,32768
s_add_u32 m0,m0,1024
s_waitcnt vmcnt(6)
buffer_load_dwordx4 v16,s[28:31],s62 offen lds
s_add_u32 s62,s62,32768
s_add_u32 m0,m0,1024
s_waitcnt vmcnt(6)
buffer_load_dwordx4 v16,s[28:31],s62 offen lds
s_add_u32 s62,s62,32768
s_add_u32 m0,m0,1024
s_waitcnt vmcnt(6)
buffer_load_dwordx4 v16,s[28:31],s62 offen lds
s_waitcnt vmcnt(6)
s_waitcnt vmcnt(16)
ds_read_b64_tr_b16 a[64:65],v17 offset:16384
ds_read_b64_tr_b16 a[66:67],v17 offset:16640
ds_read_b64_tr_b16 a[68:69],v17 offset:16392
ds_read_b64_tr_b16 a[70:71],v17 offset:16648
ds_read_b64_tr_b16 a[72:73],v17 offset:18432
ds_read_b64_tr_b16 a[74:75],v17 offset:18688
ds_read_b64_tr_b16 a[76:77],v17 offset:18440
ds_read_b64_tr_b16 a[78:79],v17 offset:18696
ds_read_b64_tr_b16 a[80:81],v17 offset:20480
ds_read_b64_tr_b16 a[82:83],v17 offset:20736
ds_read_b64_tr_b16 a[84:85],v17 offset:20488
ds_read_b64_tr_b16 a[86:87],v17 offset:20744
s_waitcnt lgkmcnt(0)
ds_read_b64_tr_b16 a[88:89],v17 offset:22528
ds_read_b64_tr_b16 a[90:91],v17 offset:22784
ds_read_b64_tr_b16 a[92:93],v17 offset:22536
ds_read_b64_tr_b16 a[94:95],v17 offset:22792
ds_read_b64_tr_b16 a[96:97],v17 offset:24576
ds_read_b64_tr_b16 a[98:99],v17 offset:24832
ds_read_b64_tr_b16 a[100:101],v17 offset:24584
ds_read_b64_tr_b16 a[102:103],v17 offset:24840
ds_read_b64_tr_b16 a[104:105],v17 offset:26624
ds_read_b64_tr_b16 a[106:107],v17 offset:26880
ds_read_b64_tr_b16 a[108:109],v17 offset:26632
ds_read_b64_tr_b16 a[110:111],v17 offset:26888
s_waitcnt lgkmcnt(0)
ds_read_b64_tr_b16 a[112:113],v17 offset:28672
ds_read_b64_tr_b16 a[114:115],v17 offset:28928
ds_read_b64_tr_b16 a[116:117],v17 offset:28680
ds_read_b64_tr_b16 a[118:119],v17 offset:28936
ds_read_b64_tr_b16 a[120:121],v17 offset:30720
ds_read_b64_tr_b16 a[122:123],v17 offset:30976
ds_read_b64_tr_b16 a[124:125],v17 offset:30728
ds_read_b64_tr_b16 a[126:127],v17 offset:30984
s_waitcnt lgkmcnt(0)
s_xor_b32 s62,s50,3
s_mul_i32 s62,s62,524288
s_add_u32 s62,s62,s54
s_add_u32 m0,s61,16384
s_nop 0
buffer_load_dwordx4 v16,s[28:31],s62 offen lds
s_add_u32 s62,s62,32768
s_add_u32 m0,m0,1024
s_waitcnt vmcnt(6)
buffer_load_dwordx4 v16,s[28:31],s62 offen lds
s_add_u32 s62,s62,32768
s_add_u32 m0,m0,1024
s_waitcnt vmcnt(6)
buffer_load_dwordx4 v16,s[28:31],s62 offen lds
s_add_u32 s62,s62,32768
s_add_u32 m0,m0,1024
s_waitcnt vmcnt(6)
buffer_load_dwordx4 v16,s[28:31],s62 offen lds
s_add_u32 s62,s62,32768
s_add_u32 m0,m0,1024
s_waitcnt vmcnt(6)
buffer_load_dwordx4 v16,s[28:31],s62 offen lds
s_add_u32 s62,s62,32768
s_add_u32 m0,m0,1024
s_waitcnt vmcnt(6)
buffer_load_dwordx4 v16,s[28:31],s62 offen lds
s_add_u32 s62,s62,32768
s_add_u32 m0,m0,1024
s_waitcnt vmcnt(6)
buffer_load_dwordx4 v16,s[28:31],s62 offen lds
s_add_u32 s62,s62,32768
s_add_u32 m0,m0,1024
s_waitcnt vmcnt(6)
buffer_load_dwordx4 v16,s[28:31],s62 offen lds
s_add_u32 s62,s62,32768
s_add_u32 m0,m0,1024
s_waitcnt vmcnt(6)
buffer_load_dwordx4 v16,s[28:31],s62 offen lds
s_add_u32 s62,s62,32768
s_add_u32 m0,m0,1024
s_waitcnt vmcnt(6)
buffer_load_dwordx4 v16,s[28:31],s62 offen lds
s_add_u32 s62,s62,32768
s_add_u32 m0,m0,1024
s_waitcnt vmcnt(6)
buffer_load_dwordx4 v16,s[28:31],s62 offen lds
s_add_u32 s62,s62,32768
s_add_u32 m0,m0,1024
s_waitcnt vmcnt(6)
buffer_load_dwordx4 v16,s[28:31],s62 offen lds
s_add_u32 s62,s62,32768
s_add_u32 m0,m0,1024
s_waitcnt vmcnt(6)
buffer_load_dwordx4 v16,s[28:31],s62 offen lds
s_add_u32 s62,s62,32768
s_add_u32 m0,m0,1024
s_waitcnt vmcnt(6)
buffer_load_dwordx4 v16,s[28:31],s62 offen lds
s_add_u32 s62,s62,32768
s_add_u32 m0,m0,1024
s_waitcnt vmcnt(6)
buffer_load_dwordx4 v16,s[28:31],s62 offen lds
s_add_u32 s62,s62,32768
s_add_u32 m0,m0,1024
s_waitcnt vmcnt(6)
buffer_load_dwordx4 v16,s[28:31],s62 offen lds
s_waitcnt vmcnt(6)
s_waitcnt vmcnt(16)
ds_read_b64_tr_b16 a[128:129],v17 offset:0
ds_read_b64_tr_b16 a[130:131],v17 offset:256
ds_read_b64_tr_b16 a[132:133],v17 offset:8
ds_read_b64_tr_b16 a[134:135],v17 offset:264
ds_read_b64_tr_b16 a[136:137],v17 offset:2048
ds_read_b64_tr_b16 a[138:139],v17 offset:2304
ds_read_b64_tr_b16 a[140:141],v17 offset:2056
ds_read_b64_tr_b16 a[142:143],v17 offset:2312
ds_read_b64_tr_b16 a[144:145],v17 offset:4096
ds_read_b64_tr_b16 a[146:147],v17 offset:4352
ds_read_b64_tr_b16 a[148:149],v17 offset:4104
ds_read_b64_tr_b16 a[150:151],v17 offset:4360
s_waitcnt lgkmcnt(0)
ds_read_b64_tr_b16 a[152:153],v17 offset:6144
ds_read_b64_tr_b16 a[154:155],v17 offset:6400
ds_read_b64_tr_b16 a[156:157],v17 offset:6152
ds_read_b64_tr_b16 a[158:159],v17 offset:6408
ds_read_b64_tr_b16 a[160:161],v17 offset:8192
ds_read_b64_tr_b16 a[162:163],v17 offset:8448
ds_read_b64_tr_b16 a[164:165],v17 offset:8200
ds_read_b64_tr_b16 a[166:167],v17 offset:8456
ds_read_b64_tr_b16 a[168:169],v17 offset:10240
ds_read_b64_tr_b16 a[170:171],v17 offset:10496
ds_read_b64_tr_b16 a[172:173],v17 offset:10248
ds_read_b64_tr_b16 a[174:175],v17 offset:10504
s_waitcnt lgkmcnt(0)
ds_read_b64_tr_b16 a[176:177],v17 offset:12288
ds_read_b64_tr_b16 a[178:179],v17 offset:12544
ds_read_b64_tr_b16 a[180:181],v17 offset:12296
ds_read_b64_tr_b16 a[182:183],v17 offset:12552
ds_read_b64_tr_b16 a[184:185],v17 offset:14336
ds_read_b64_tr_b16 a[186:187],v17 offset:14592
ds_read_b64_tr_b16 a[188:189],v17 offset:14344
ds_read_b64_tr_b16 a[190:191],v17 offset:14600
s_waitcnt lgkmcnt(0)
s_waitcnt vmcnt(0)
ds_read_b64_tr_b16 a[192:193],v17 offset:16384
ds_read_b64_tr_b16 a[194:195],v17 offset:16640
ds_read_b64_tr_b16 a[196:197],v17 offset:16392
ds_read_b64_tr_b16 a[198:199],v17 offset:16648
ds_read_b64_tr_b16 a[200:201],v17 offset:18432
ds_read_b64_tr_b16 a[202:203],v17 offset:18688
ds_read_b64_tr_b16 a[204:205],v17 offset:18440
ds_read_b64_tr_b16 a[206:207],v17 offset:18696
ds_read_b64_tr_b16 a[208:209],v17 offset:20480
ds_read_b64_tr_b16 a[210:211],v17 offset:20736
ds_read_b64_tr_b16 a[212:213],v17 offset:20488
ds_read_b64_tr_b16 a[214:215],v17 offset:20744
s_waitcnt lgkmcnt(0)
ds_read_b64_tr_b16 a[216:217],v17 offset:22528
ds_read_b64_tr_b16 a[218:219],v17 offset:22784
ds_read_b64_tr_b16 a[220:221],v17 offset:22536
ds_read_b64_tr_b16 a[222:223],v17 offset:22792
ds_read_b64_tr_b16 a[224:225],v17 offset:24576
ds_read_b64_tr_b16 a[226:227],v17 offset:24832
ds_read_b64_tr_b16 a[228:229],v17 offset:24584
ds_read_b64_tr_b16 a[230:231],v17 offset:24840
ds_read_b64_tr_b16 a[232:233],v17 offset:26624
ds_read_b64_tr_b16 a[234:235],v17 offset:26880
ds_read_b64_tr_b16 a[236:237],v17 offset:26632
ds_read_b64_tr_b16 a[238:239],v17 offset:26888
s_waitcnt lgkmcnt(0)
ds_read_b64_tr_b16 a[240:241],v17 offset:28672
ds_read_b64_tr_b16 a[242:243],v17 offset:28928
ds_read_b64_tr_b16 a[244:245],v17 offset:28680
ds_read_b64_tr_b16 a[246:247],v17 offset:28936
ds_read_b64_tr_b16 a[248:249],v17 offset:30720
ds_read_b64_tr_b16 a[250:251],v17 offset:30976
ds_read_b64_tr_b16 a[252:253],v17 offset:30728
ds_read_b64_tr_b16 a[254:255],v17 offset:30984
s_waitcnt lgkmcnt(0)
s_mov_b32 s92,s2
s_and_b32 s93,s3,0xffff
s_mov_b32 s94,0x100
s_mov_b32 s95,0x20000
v_mbcnt_lo_u32_b32 v16,-1,0
v_mbcnt_hi_u32_b32 v16,-1,v16
v_mov_b32 v18,0
v_cmp_eq_u32 vcc,22,v16
s_nop 1
v_cndmask_b32 v18,v18,63,vcc
v_cmp_eq_u32 vcc,17,v16
s_nop 1
v_cndmask_b32 v18,v18,63,vcc
v_cmp_eq_u32 vcc,18,v16
s_nop 1
v_cndmask_b32 v18,v18,1,vcc
v_and_b32 v19,1,v16
v_cmp_eq_u32 vcc,1,v19
v_mov_b32 v19,8192
s_nop 0
v_cndmask_b32 v19,-1,v19,vcc
v_min_u32 v16,31,v16
v_lshlrev_b32 v16,2,v16
s_sub_u32 s66,s88,64
s_cmp_lg_u32 s50,0
s_cbranch_scc1 vot_318
vpoll_314:
buffer_load_dword v17,v16,s[92:95],s66 offen sc1
s_waitcnt vmcnt(0)
s_cmp_lg_u32 s56,2
s_cbranch_scc1 vck_315
v_cmp_eq_u32 vcc,v17,v19
s_and_b32 s64,vcc_lo,0xffff
s_cmp_eq_u32 s64,65535
s_cbranch_scc1 vck_315
s_mov_b32 s65,0
v_readlane_b32 s64,v17,1
s_lshr_b32 s64,s64,8
s_add_u32 s65,s65,s64
v_readlane_b32 s64,v17,3
s_lshr_b32 s64,s64,8
s_add_u32 s65,s65,s64
v_readlane_b32 s64,v17,5
s_lshr_b32 s64,s64,8
s_add_u32 s65,s65,s64
v_readlane_b32 s64,v17,7
s_lshr_b32 s64,s64,8
s_add_u32 s65,s65,s64
v_readlane_b32 s64,v17,9
s_lshr_b32 s64,s64,8
s_add_u32 s65,s65,s64
v_readlane_b32 s64,v17,11
s_lshr_b32 s64,s64,8
s_add_u32 s65,s65,s64
v_readlane_b32 s64,v17,13
s_lshr_b32 s64,s64,8
s_add_u32 s65,s65,s64
v_readlane_b32 s64,v17,15
s_lshr_b32 s64,s64,8
s_add_u32 s65,s65,s64
s_cmp_ge_u32 s65,256
s_cbranch_scc1 vok_317
s_branch vrt_316
vck_315:
v_cmp_gt_u32 vcc,v18,v17
s_cbranch_vccz vok_317
vrt_316:
s_sleep 48
s_sub_u32 s90,s90,1
s_cmp_gt_i32 s90,0
s_cbranch_scc1 vpoll_314
vok_317:
v_add_u32 v18,160768,v16
ds_write_b32 v18,v17
s_waitcnt lgkmcnt(0)
vot_318:
s_barrier
v_add_u32 v18,160768,v16
ds_read_b32 v17,v18
s_waitcnt lgkmcnt(0)
s_cmp_lg_u32 s56,2
s_cbranch_scc1 vfin_319
v_cmp_eq_u32 vcc,v17,v19
s_and_b32 s64,vcc_lo,0xffff
s_cmp_eq_u32 s64,65535
s_cbranch_scc1 vfin_319
s_mov_b32 s65,0
v_readlane_b32 s64,v17,1
s_lshr_b32 s64,s64,8
s_add_u32 s65,s65,s64
v_readlane_b32 s64,v17,3
s_lshr_b32 s64,s64,8
s_add_u32 s65,s65,s64
v_readlane_b32 s64,v17,5
s_lshr_b32 s64,s64,8
s_add_u32 s65,s65,s64
v_readlane_b32 s64,v17,7
s_lshr_b32 s64,s64,8
s_add_u32 s65,s65,s64
v_readlane_b32 s64,v17,9
s_lshr_b32 s64,s64,8
s_add_u32 s65,s65,s64
v_readlane_b32 s64,v17,11
s_lshr_b32 s64,s64,8
s_add_u32 s65,s65,s64
v_readlane_b32 s64,v17,13
s_lshr_b32 s64,s64,8
s_add_u32 s65,s65,s64
v_readlane_b32 s64,v17,15
s_lshr_b32 s64,s64,8
s_add_u32 s65,s65,s64
s_cmp_ge_u32 s65,256
s_cbranch_scc1 fl_fb
vfin_319:
s_and_b32 s56,s56,1
s_mov_b32 s67,0
s_barrier
v_lshlrev_b32 v0,4,v1
s_mov_b32 s60,0
s_lshl_b32 s70,s50,13
s_mov_b32 s55,0
v_mov_b32 v3,v0
s_mov_b32 s73,0xffff0000
s_lshl_b32 s64,s52,2
s_add_u32 s64,s64,s50
s_mul_i32 s61,s64,8192
s_add_u32 s61,s61,209747968
s_lshl_b32 s68,s64,8
s_add_u32 s68,s68,138549248
s_lshl_b32 s83,s53,2
s_add_u32 s83,s83,s50
s_mov_b32 s63,0
s_xor_b32 s64,s50,0
s_lshl_b32 s64,s64,13
v_add_u32 v8,s64,v0
v_mov_b32 v4,v8
s_xor_b32 s64,s50,1
s_lshl_b32 s64,s64,13
v_add_u32 v9,s64,v0
v_mov_b32 v5,v9
s_xor_b32 s64,s50,2
s_lshl_b32 s64,s64,13
v_add_u32 v10,s64,v0
v_mov_b32 v6,v10
s_xor_b32 s64,s50,3
s_lshl_b32 s64,s64,13
v_add_u32 v11,s64,v0
v_mov_b32 v7,v11
v_min_u32 v2,7,v1
v_lshlrev_b32 v2,2,v2
s_lshr_b32 s64,s50,1
s_add_u32 s64,s64,1
s_sub_u32 s65,0,s64
s_bitcmp1_b32 s50,0
s_cselect_b32 s64,s64,s65
s_add_u32 s64,s64,16
v_add_u32 v26,s64,v21
v_lshrrev_b32 v27,4,v26
v_and_b32 v26,15,v26
v_lshl_add_u32 v26,v22,4,v26
v_lshlrev_b32 v26,4,v26
v_lshl_add_u32 v3,v27,15,v26
s_sub_u32 s61,s61,32768
s_add_u32 s62,s61,4096
s_lshl_b32 s66,s83,10
s_lshr_b32 s65,s83,3
s_lshl_b32 s65,s65,8
s_and_b32 s64,s83,7
s_lshl_b32 s64,s64,2
s_add_u32 s69,s64,s65
s_add_u32 s69,s69,138550272
s_add_u32 s82,s66,205520896
s_add_u32 s66,s66,214958080
s_add_u32 s71,s60,1
s_and_b32 s64,s50,1
s_add_u32 s71,s71,s64
s_min_u32 s71,s71,128
s_cmp_ge_u32 s60,128
s_cselect_b32 s71,-1,s71
s_add_u32 s53,s60,2
s_and_b32 s64,s50,1
s_add_u32 s53,s53,s64
s_min_u32 s53,s53,128
s_cmp_ge_u32 s60,127
s_cselect_b32 s53,-1,s53
plp_327:
buffer_load_dword v16,v2,s[20:23],s68 offen sc1
s_waitcnt vmcnt(0)
v_cmp_gt_u32 vcc,s71,v16
s_cbranch_vccz pok_328
s_sleep 4
s_sub_u32 s90,s90,1
s_cmp_gt_i32 s90,0
s_cbranch_scc1 plp_327
pok_328:
lag_324:
s_mov_b32 m0,s70
s_nop 0
buffer_load_dwordx4 v3,s[20:23],s61 offen offset:0 lds
buffer_load_dwordx4 v3,s[20:23],s61 offen offset:1024 lds
buffer_load_dwordx4 v3,s[20:23],s61 offen offset:2048 lds
buffer_load_dwordx4 v3,s[20:23],s61 offen offset:3072 lds
s_add_u32 m0,s70,4096
s_nop 0
buffer_load_dwordx4 v3,s[20:23],s62 offen offset:0 lds
buffer_load_dwordx4 v3,s[20:23],s62 offen offset:1024 lds
buffer_load_dwordx4 v3,s[20:23],s62 offen offset:2048 lds
buffer_load_dwordx4 v3,s[20:23],s62 offen offset:3072 lds
s_add_u32 s61,s61,32768
s_add_u32 s62,s62,32768
s_add_u32 s70,s70,32768
s_and_b32 s70,s70,0x1ffff
buffer_load_dword v23,off,s[20:23],s66
dec_325:
v_cmp_gt_u32 vcc,s53,v16
s_cbranch_vccnz BN_323
BR_322:
s_waitcnt vmcnt(8)
ds_read_b128 v[64:67],v4 offset:0
s_waitcnt vmcnt(7)
ds_read_b128 v[68:71],v4 offset:1024
s_waitcnt vmcnt(6)
ds_read_b128 v[72:75],v4 offset:2048
s_waitcnt vmcnt(5)
ds_read_b128 v[76:79],v4 offset:3072
s_waitcnt lgkmcnt(3)
v_mfma_f32_16x16x32_bf16 v[32:35],a[0:3],v[64:67],0
s_add_u32 s71,s60,2
s_and_b32 s64,s50,1
s_add_u32 s71,s71,s64
s_min_u32 s71,s71,128
s_cmp_ge_u32 s60,127
s_cselect_b32 s71,-1,s71
v_mfma_f32_16x16x32_bf16 v[36:39],a[4:7],v[64:67],0
s_waitcnt lgkmcnt(2)
s_waitcnt vmcnt(4)
ds_read_b128 v[80:83],v4 offset:4096
v_mfma_f32_16x16x32_bf16 v[32:35],a[8:11],v[68:71],v[32:35]
s_add_u32 s53,s60,3
s_and_b32 s64,s50,1
s_add_u32 s53,s53,s64
s_min_u32 s53,s53,128
s_cmp_ge_u32 s60,126
s_cselect_b32 s53,-1,s53
v_mfma_f32_16x16x32_bf16 v[36:39],a[12:15],v[68:71],v[36:39]
s_waitcnt lgkmcnt(2)
s_waitcnt vmcnt(3)
s_mov_b32 m0,s70
s_mov_b32 s57,s63
ds_read_b128 v[84:87],v4 offset:5120
v_mfma_f32_16x16x32_bf16 v[32:35],a[16:19],v[72:75],v[32:35]
buffer_load_dwordx4 v3,s[20:23],s61 offen offset:0 lds
v_mfma_f32_16x16x32_bf16 v[36:39],a[20:23],v[72:75],v[36:39]
s_waitcnt lgkmcnt(2)
s_waitcnt vmcnt(3)
ds_read_b128 v[88:91],v4 offset:6144
v_mfma_f32_16x16x32_bf16 v[32:35],a[24:27],v[76:79],v[32:35]
buffer_load_dwordx4 v3,s[20:23],s61 offen offset:1024 lds
v_mfma_f32_16x16x32_bf16 v[36:39],a[28:31],v[76:79],v[36:39]
s_waitcnt lgkmcnt(2)
s_waitcnt vmcnt(3)
ds_read_b128 v[92:95],v4 offset:7168
v_mfma_f32_16x16x32_bf16 v[32:35],a[32:35],v[80:83],v[32:35]
buffer_load_dwordx4 v[160:163],v0,s[20:23],s82 offen
v_mfma_f32_16x16x32_bf16 v[36:39],a[36:39],v[80:83],v[36:39]
s_waitcnt lgkmcnt(2)
s_barrier
s_add_u32 s82,s82,32768
ds_read_b128 v[96:99],v5 offset:0
v_mfma_f32_16x16x32_bf16 v[32:35],a[40:43],v[84:87],v[32:35]
ds_read_b128 v[100:103],v5 offset:1024
v_mfma_f32_16x16x32_bf16 v[36:39],a[44:47],v[84:87],v[36:39]
s_waitcnt lgkmcnt(3)
ds_read_b128 v[104:107],v5 offset:2048
v_mfma_f32_16x16x32_bf16 v[32:35],a[48:51],v[88:91],v[32:35]
ds_read_b128 v[108:111],v5 offset:3072
v_mfma_f32_16x16x32_bf16 v[36:39],a[52:55],v[88:91],v[36:39]
s_waitcnt lgkmcnt(4)
ds_read_b128 v[112:115],v5 offset:4096
v_mfma_f32_16x16x32_bf16 v[32:35],a[56:59],v[92:95],v[32:35]
ds_read_b128 v[116:119],v5 offset:5120
v_mfma_f32_16x16x32_bf16 v[36:39],a[60:63],v[92:95],v[36:39]
s_waitcnt lgkmcnt(5)
buffer_load_dwordx4 v3,s[20:23],s61 offen offset:2048 lds
v_mfma_f32_16x16x32_bf16 v[32:35],a[64:67],v[96:99],v[32:35]
ds_read_b128 v[120:123],v5 offset:6144
v_mfma_f32_16x16x32_bf16 v[36:39],a[68:71],v[96:99],v[36:39]
s_waitcnt lgkmcnt(5)
buffer_load_dwordx4 v3,s[20:23],s61 offen offset:3072 lds
v_mfma_f32_16x16x32_bf16 v[32:35],a[72:75],v[100:103],v[32:35]
s_add_u32 m0,s70,4096
ds_read_b128 v[124:127],v5 offset:7168
v_mfma_f32_16x16x32_bf16 v[36:39],a[76:79],v[100:103],v[36:39]
s_waitcnt lgkmcnt(5)
buffer_load_dwordx4 v3,s[20:23],s62 offen offset:0 lds
v_mfma_f32_16x16x32_bf16 v[32:35],a[80:83],v[104:107],v[32:35]
ds_read_b128 v[64:67],v6 offset:0
v_mfma_f32_16x16x32_bf16 v[36:39],a[84:87],v[104:107],v[36:39]
s_waitcnt lgkmcnt(5)
buffer_load_dwordx4 v3,s[20:23],s62 offen offset:1024 lds
v_mfma_f32_16x16x32_bf16 v[32:35],a[88:91],v[108:111],v[32:35]
ds_read_b128 v[68:71],v6 offset:1024
v_mfma_f32_16x16x32_bf16 v[36:39],a[92:95],v[108:111],v[36:39]
s_waitcnt lgkmcnt(5)
buffer_load_dwordx4 v3,s[20:23],s62 offen offset:2048 lds
v_mfma_f32_16x16x32_bf16 v[32:35],a[96:99],v[112:115],v[32:35]
ds_read_b128 v[72:75],v6 offset:2048
v_mfma_f32_16x16x32_bf16 v[36:39],a[100:103],v[112:115],v[36:39]
s_waitcnt lgkmcnt(5)
buffer_load_dword v16,v2,s[20:23],s68 offen sc1
v_mfma_f32_16x16x32_bf16 v[32:35],a[104:107],v[116:119],v[32:35]
ds_read_b128 v[76:79],v6 offset:3072
v_mfma_f32_16x16x32_bf16 v[36:39],a[108:111],v[116:119],v[36:39]
s_waitcnt lgkmcnt(5)
buffer_load_dwordx4 v3,s[20:23],s62 offen offset:3072 lds
v_mfma_f32_16x16x32_bf16 v[32:35],a[112:115],v[120:123],v[32:35]
ds_read_b128 v[80:83],v6 offset:4096
v_mfma_f32_16x16x32_bf16 v[36:39],a[116:119],v[120:123],v[36:39]
s_waitcnt lgkmcnt(5)
s_waitcnt vmcnt(10)
v_mov_b32 v17,s57
s_mov_b64 exec,1
buffer_store_dword v17,off,s[20:23],s69 sc1
s_mov_b64 exec,-1
v_mfma_f32_16x16x32_bf16 v[32:35],a[120:123],v[124:127],v[32:35]
ds_read_b128 v[84:87],v6 offset:5120
v_mfma_f32_16x16x32_bf16 v[36:39],a[124:127],v[124:127],v[36:39]
s_waitcnt lgkmcnt(5)
v_mfma_f32_16x16x32_bf16 v[32:35],a[128:131],v[64:67],v[32:35]
ds_read_b128 v[88:91],v6 offset:6144
v_mfma_f32_16x16x32_bf16 v[36:39],a[132:135],v[64:67],v[36:39]
s_waitcnt lgkmcnt(5)
v_mfma_f32_16x16x32_bf16 v[32:35],a[136:139],v[68:71],v[32:35]
ds_read_b128 v[92:95],v6 offset:7168
v_mfma_f32_16x16x32_bf16 v[36:39],a[140:143],v[68:71],v[36:39]
s_waitcnt lgkmcnt(5)
v_mfma_f32_16x16x32_bf16 v[32:35],a[144:147],v[72:75],v[32:35]
ds_read_b128 v[96:99],v7 offset:0
v_mfma_f32_16x16x32_bf16 v[36:39],a[148:151],v[72:75],v[36:39]
s_waitcnt lgkmcnt(5)
v_mfma_f32_16x16x32_bf16 v[32:35],a[152:155],v[76:79],v[32:35]
ds_read_b128 v[100:103],v7 offset:1024
v_mfma_f32_16x16x32_bf16 v[36:39],a[156:159],v[76:79],v[36:39]
s_waitcnt lgkmcnt(5)
v_mfma_f32_16x16x32_bf16 v[32:35],a[160:163],v[80:83],v[32:35]
ds_read_b128 v[104:107],v7 offset:2048
v_mfma_f32_16x16x32_bf16 v[36:39],a[164:167],v[80:83],v[36:39]
s_waitcnt lgkmcnt(5)
v_mfma_f32_16x16x32_bf16 v[32:35],a[168:171],v[84:87],v[32:35]
ds_read_b128 v[108:111],v7 offset:3072
v_mfma_f32_16x16x32_bf16 v[36:39],a[172:175],v[84:87],v[36:39]
s_waitcnt lgkmcnt(5)
v_mfma_f32_16x16x32_bf16 v[32:35],a[176:179],v[88:91],v[32:35]
ds_read_b128 v[112:115],v7 offset:4096
v_mfma_f32_16x16x32_bf16 v[36:39],a[180:183],v[88:91],v[36:39]
s_waitcnt lgkmcnt(5)
v_mfma_f32_16x16x32_bf16 v[32:35],a[184:187],v[92:95],v[32:35]
ds_read_b128 v[116:119],v7 offset:5120
v_mfma_f32_16x16x32_bf16 v[36:39],a[188:191],v[92:95],v[36:39]
s_waitcnt lgkmcnt(5)
v_mfma_f32_16x16x32_bf16 v[32:35],a[192:195],v[96:99],v[32:35]
ds_read_b128 v[120:123],v7 offset:6144
v_mfma_f32_16x16x32_bf16 v[36:39],a[196:199],v[96:99],v[36:39]
s_waitcnt lgkmcnt(5)
v_mfma_f32_16x16x32_bf16 v[32:35],a[200:203],v[100:103],v[32:35]
s_waitcnt vmcnt(8)
ds_read_b128 v[124:127],v7 offset:7168
v_lshlrev_b32 v168,16,v160
v_mfma_f32_16x16x32_bf16 v[36:39],a[204:207],v[100:103],v[36:39]
s_waitcnt lgkmcnt(5)
v_and_b32 v169,s73,v160
v_lshlrev_b32 v170,16,v161
v_mfma_f32_16x16x32_bf16 v[32:35],a[208:211],v[104:107],v[32:35]
s_add_u32 s61,s61,32768
v_and_b32 v171,s73,v161
v_lshlrev_b32 v172,16,v162
v_mfma_f32_16x16x32_bf16 v[36:39],a[212:215],v[104:107],v[36:39]
s_waitcnt lgkmcnt(4)
v_and_b32 v173,s73,v162
v_lshlrev_b32 v174,16,v163
v_mfma_f32_16x16x32_bf16 v[32:35],a[216:219],v[108:111],v[32:35]
s_add_u32 s62,s62,32768
s_add_u32 s70,s70,32768
v_and_b32 v175,s73,v163
v_mfma_f32_16x16x32_bf16 v[36:39],a[220:223],v[108:111],v[36:39]
s_waitcnt lgkmcnt(3)
s_and_b32 s70,s70,0x1ffff
s_add_u32 s55,s55,32768
v_mfma_f32_16x16x32_bf16 v[32:35],a[224:227],v[112:115],v[32:35]
s_and_b32 s55,s55,0x1ffff
v_add_u32 v4,s55,v8
v_add_u32 v5,s55,v9
v_mfma_f32_16x16x32_bf16 v[36:39],a[228:231],v[112:115],v[36:39]
s_waitcnt lgkmcnt(2)
v_add_u32 v6,s55,v10
v_add_u32 v7,s55,v11
v_mfma_f32_16x16x32_bf16 v[32:35],a[232:235],v[116:119],v[32:35]
s_waitcnt vmcnt(1)
ds_read_b128 v[64:67],v4 offset:0
v_mfma_f32_16x16x32_bf16 v[36:39],a[236:239],v[116:119],v[36:39]
s_waitcnt lgkmcnt(2)
ds_read_b128 v[68:71],v4 offset:1024
v_mfma_f32_16x16x32_bf16 v[32:35],a[240:243],v[120:123],v[32:35]
ds_read_b128 v[72:75],v4 offset:2048
v_mfma_f32_16x16x32_bf16 v[36:39],a[244:247],v[120:123],v[36:39]
s_waitcnt lgkmcnt(3)
v_mfma_f32_16x16x32_bf16 v[40:43],a[248:251],v[124:127],v[32:35]
v_mfma_f32_16x16x32_bf16 v[44:47],a[252:255],v[124:127],v[36:39]
v_cmp_gt_u32 vcc,s53,v16
s_add_u32 s60,s60,1
s_cbranch_vccnz WN_321
WR_320:
s_waitcnt lgkmcnt(2)
v_mfma_f32_16x16x32_bf16 v[32:35],a[0:3],v[64:67],0
s_add_u32 s71,s60,2
s_and_b32 s64,s50,1
s_add_u32 s71,s71,s64
s_min_u32 s71,s71,128
s_cmp_ge_u32 s60,127
s_cselect_b32 s71,-1,s71
ds_read_b128 v[76:79],v4 offset:3072
v_mfma_f32_16x16x32_bf16 v[36:39],a[4:7],v[64:67],0
s_waitcnt lgkmcnt(2)
ds_read_b128 v[80:83],v4 offset:4096
v_mfma_f32_16x16x32_bf16 v[32:35],a[8:11],v[68:71],v[32:35]
s_add_u32 s53,s60,3
s_and_b32 s64,s50,1
s_add_u32 s53,s53,s64
s_min_u32 s53,s53,128
s_cmp_ge_u32 s60,126
s_cselect_b32 s53,-1,s53
ds_read_b128 v[84:87],v4 offset:5120
v_mfma_f32_16x16x32_bf16 v[36:39],a[12:15],v[68:71],v[36:39]
s_waitcnt lgkmcnt(3)
s_mov_b32 s57,s63
ds_read_b128 v[88:91],v4 offset:6144
v_add_f32 v40,v40,v168
v_mfma_f32_16x16x32_bf16 v[32:35],a[16:19],v[72:75],v[32:35]
ds_read_b128 v[92:95],v4 offset:7168
v_add_f32 v41,v41,v169
v_add_f32 v42,v42,v170
v_mfma_f32_16x16x32_bf16 v[36:39],a[20:23],v[72:75],v[36:39]
s_waitcnt lgkmcnt(4)
s_barrier
ds_read_b128 v[96:99],v5 offset:0
v_add_f32 v43,v43,v171
v_mfma_f32_16x16x32_bf16 v[32:35],a[24:27],v[76:79],v[32:35]
s_mov_b32 m0,s70
ds_read_b128 v[100:103],v5 offset:1024
v_add_f32 v44,v44,v172
v_mfma_f32_16x16x32_bf16 v[36:39],a[28:31],v[76:79],v[36:39]
s_waitcnt lgkmcnt(5)
buffer_load_dwordx4 v3,s[20:23],s61 offen offset:0 lds
v_add_f32 v45,v45,v173
v_mfma_f32_16x16x32_bf16 v[32:35],a[32:35],v[80:83],v[32:35]
ds_read_b128 v[104:107],v5 offset:2048
v_add_f32 v46,v46,v174
v_mfma_f32_16x16x32_bf16 v[36:39],a[36:39],v[80:83],v[36:39]
s_waitcnt lgkmcnt(5)
buffer_load_dwordx4 v3,s[20:23],s61 offen offset:1024 lds
v_add_f32 v47,v47,v175
v_mfma_f32_16x16x32_bf16 v[32:35],a[40:43],v[84:87],v[32:35]
ds_read_b128 v[108:111],v5 offset:3072
v_cvt_pk_bf16_f32 v176,v40,v41
v_mfma_f32_16x16x32_bf16 v[36:39],a[44:47],v[84:87],v[36:39]
s_waitcnt lgkmcnt(5)
buffer_load_dwordx4 v3,s[20:23],s61 offen offset:2048 lds
v_cvt_pk_bf16_f32 v177,v42,v43
v_mfma_f32_16x16x32_bf16 v[32:35],a[48:51],v[88:91],v[32:35]
ds_read_b128 v[112:115],v5 offset:4096
v_cvt_pk_bf16_f32 v178,v44,v45
v_mfma_f32_16x16x32_bf16 v[36:39],a[52:55],v[88:91],v[36:39]
s_waitcnt lgkmcnt(5)
buffer_load_dwordx4 v3,s[20:23],s61 offen offset:3072 lds
v_cvt_pk_bf16_f32 v179,v46,v47
v_mfma_f32_16x16x32_bf16 v[32:35],a[56:59],v[92:95],v[32:35]
ds_read_b128 v[116:119],v5 offset:5120
v_mfma_f32_16x16x32_bf16 v[36:39],a[60:63],v[92:95],v[36:39]
s_waitcnt lgkmcnt(5)
buffer_store_dwordx4 v[176:179],v0,s[20:23],s66 offen sc1
v_mfma_f32_16x16x32_bf16 v[32:35],a[64:67],v[96:99],v[32:35]
s_add_u32 m0,s70,4096
s_add_u32 s66,s66,32768
ds_read_b128 v[120:123],v5 offset:6144
v_mfma_f32_16x16x32_bf16 v[36:39],a[68:71],v[96:99],v[36:39]
s_waitcnt lgkmcnt(5)
s_add_u32 s63,s63,1
buffer_load_dwordx4 v3,s[20:23],s62 offen offset:0 lds
v_mfma_f32_16x16x32_bf16 v[32:35],a[72:75],v[100:103],v[32:35]
ds_read_b128 v[124:127],v5 offset:7168
v_mfma_f32_16x16x32_bf16 v[36:39],a[76:79],v[100:103],v[36:39]
s_waitcnt lgkmcnt(5)
buffer_load_dwordx4 v3,s[20:23],s62 offen offset:1024 lds
v_mfma_f32_16x16x32_bf16 v[32:35],a[80:83],v[104:107],v[32:35]
ds_read_b128 v[64:67],v6 offset:0
v_mfma_f32_16x16x32_bf16 v[36:39],a[84:87],v[104:107],v[36:39]
s_waitcnt lgkmcnt(5)
buffer_load_dwordx4 v[160:163],v0,s[20:23],s82 offen
v_mfma_f32_16x16x32_bf16 v[32:35],a[88:91],v[108:111],v[32:35]
s_add_u32 s82,s82,32768
ds_read_b128 v[68:71],v6 offset:1024
v_mfma_f32_16x16x32_bf16 v[36:39],a[92:95],v[108:111],v[36:39]
s_waitcnt lgkmcnt(5)
buffer_load_dwordx4 v3,s[20:23],s62 offen offset:2048 lds
v_mfma_f32_16x16x32_bf16 v[32:35],a[96:99],v[112:115],v[32:35]
ds_read_b128 v[72:75],v6 offset:2048
v_mfma_f32_16x16x32_bf16 v[36:39],a[100:103],v[112:115],v[36:39]
s_waitcnt lgkmcnt(5)
buffer_load_dword v16,v2,s[20:23],s68 offen sc1
v_mfma_f32_16x16x32_bf16 v[32:35],a[104:107],v[116:119],v[32:35]
ds_read_b128 v[76:79],v6 offset:3072
v_mfma_f32_16x16x32_bf16 v[36:39],a[108:111],v[116:119],v[36:39]
s_waitcnt lgkmcnt(5)
buffer_load_dwordx4 v3,s[20:23],s62 offen offset:3072 lds
v_mfma_f32_16x16x32_bf16 v[32:35],a[112:115],v[120:123],v[32:35]
ds_read_b128 v[80:83],v6 offset:4096
v_mfma_f32_16x16x32_bf16 v[36:39],a[116:119],v[120:123],v[36:39]
s_waitcnt lgkmcnt(5)
v_mfma_f32_16x16x32_bf16 v[32:35],a[120:123],v[124:127],v[32:35]
ds_read_b128 v[84:87],v6 offset:5120
v_mfma_f32_16x16x32_bf16 v[36:39],a[124:127],v[124:127],v[36:39]
s_waitcnt lgkmcnt(5)
v_mfma_f32_16x16x32_bf16 v[32:35],a[128:131],v[64:67],v[32:35]
ds_read_b128 v[88:91],v6 offset:6144
v_mfma_f32_16x16x32_bf16 v[36:39],a[132:135],v[64:67],v[36:39]
s_waitcnt lgkmcnt(5)
v_mfma_f32_16x16x32_bf16 v[32:35],a[136:139],v[68:71],v[32:35]
ds_read_b128 v[92:95],v6 offset:7168
v_mfma_f32_16x16x32_bf16 v[36:39],a[140:143],v[68:71],v[36:39]
s_waitcnt lgkmcnt(5)
v_mfma_f32_16x16x32_bf16 v[32:35],a[144:147],v[72:75],v[32:35]
ds_read_b128 v[96:99],v7 offset:0
v_mfma_f32_16x16x32_bf16 v[36:39],a[148:151],v[72:75],v[36:39]
s_waitcnt lgkmcnt(5)
v_mfma_f32_16x16x32_bf16 v[32:35],a[152:155],v[76:79],v[32:35]
ds_read_b128 v[100:103],v7 offset:1024
v_mfma_f32_16x16x32_bf16 v[36:39],a[156:159],v[76:79],v[36:39]
s_waitcnt lgkmcnt(5)
v_mfma_f32_16x16x32_bf16 v[32:35],a[160:163],v[80:83],v[32:35]
ds_read_b128 v[104:107],v7 offset:2048
v_mfma_f32_16x16x32_bf16 v[36:39],a[164:167],v[80:83],v[36:39]
s_waitcnt lgkmcnt(5)
v_mfma_f32_16x16x32_bf16 v[32:35],a[168:171],v[84:87],v[32:35]
ds_read_b128 v[108:111],v7 offset:3072
v_mfma_f32_16x16x32_bf16 v[36:39],a[172:175],v[84:87],v[36:39]
s_waitcnt lgkmcnt(5)
v_mfma_f32_16x16x32_bf16 v[32:35],a[176:179],v[88:91],v[32:35]
ds_read_b128 v[112:115],v7 offset:4096
v_mfma_f32_16x16x32_bf16 v[36:39],a[180:183],v[88:91],v[36:39]
s_waitcnt lgkmcnt(5)
v_mfma_f32_16x16x32_bf16 v[32:35],a[184:187],v[92:95],v[32:35]
ds_read_b128 v[116:119],v7 offset:5120
v_mfma_f32_16x16x32_bf16 v[36:39],a[188:191],v[92:95],v[36:39]
s_waitcnt lgkmcnt(5)
v_mfma_f32_16x16x32_bf16 v[32:35],a[192:195],v[96:99],v[32:35]
ds_read_b128 v[120:123],v7 offset:6144
v_mfma_f32_16x16x32_bf16 v[36:39],a[196:199],v[96:99],v[36:39]
s_waitcnt lgkmcnt(5)
v_mfma_f32_16x16x32_bf16 v[32:35],a[200:203],v[100:103],v[32:35]
s_waitcnt vmcnt(3)
ds_read_b128 v[124:127],v7 offset:7168
v_lshlrev_b32 v168,16,v160
v_mfma_f32_16x16x32_bf16 v[36:39],a[204:207],v[100:103],v[36:39]
s_waitcnt lgkmcnt(5)
v_and_b32 v169,s73,v160
v_lshlrev_b32 v170,16,v161
v_mfma_f32_16x16x32_bf16 v[32:35],a[208:211],v[104:107],v[32:35]
s_add_u32 s61,s61,32768
v_and_b32 v171,s73,v161
v_lshlrev_b32 v172,16,v162
v_mfma_f32_16x16x32_bf16 v[36:39],a[212:215],v[104:107],v[36:39]
s_waitcnt lgkmcnt(4)
v_and_b32 v173,s73,v162
v_lshlrev_b32 v174,16,v163
v_mfma_f32_16x16x32_bf16 v[32:35],a[216:219],v[108:111],v[32:35]
s_add_u32 s62,s62,32768
s_add_u32 s70,s70,32768
v_and_b32 v175,s73,v163
v_mfma_f32_16x16x32_bf16 v[36:39],a[220:223],v[108:111],v[36:39]
s_waitcnt lgkmcnt(3)
s_and_b32 s70,s70,0x1ffff
s_add_u32 s55,s55,32768
v_mfma_f32_16x16x32_bf16 v[32:35],a[224:227],v[112:115],v[32:35]
s_and_b32 s55,s55,0x1ffff
v_add_u32 v4,s55,v8
v_add_u32 v5,s55,v9
v_mfma_f32_16x16x32_bf16 v[36:39],a[228:231],v[112:115],v[36:39]
s_waitcnt lgkmcnt(2)
v_add_u32 v6,s55,v10
v_add_u32 v7,s55,v11
v_mfma_f32_16x16x32_bf16 v[32:35],a[232:235],v[116:119],v[32:35]
s_waitcnt vmcnt(0)
ds_read_b128 v[64:67],v4 offset:0
v_mfma_f32_16x16x32_bf16 v[36:39],a[236:239],v[116:119],v[36:39]
s_waitcnt lgkmcnt(2)
v_mov_b32 v17,s63
s_mov_b64 exec,1
buffer_store_dword v17,off,s[20:23],s69 sc1
s_mov_b64 exec,-1
v_mfma_f32_16x16x32_bf16 v[32:35],a[240:243],v[120:123],v[32:35]
ds_read_b128 v[68:71],v4 offset:1024
v_mfma_f32_16x16x32_bf16 v[36:39],a[244:247],v[120:123],v[36:39]
s_waitcnt lgkmcnt(2)
ds_read_b128 v[72:75],v4 offset:2048
v_mfma_f32_16x16x32_bf16 v[40:43],a[248:251],v[124:127],v[32:35]
v_mfma_f32_16x16x32_bf16 v[44:47],a[252:255],v[124:127],v[36:39]
v_cmp_gt_u32 vcc,s53,v16
s_add_u32 s60,s60,1
s_cbranch_vccz WR_320
WN_321:
s_waitcnt lgkmcnt(2)
v_mfma_f32_16x16x32_bf16 v[32:35],a[0:3],v[64:67],0
s_add_u32 s71,s60,2
s_and_b32 s64,s50,1
s_add_u32 s71,s71,s64
s_min_u32 s71,s71,128
s_cmp_ge_u32 s60,127
s_cselect_b32 s71,-1,s71
ds_read_b128 v[76:79],v4 offset:3072
v_mfma_f32_16x16x32_bf16 v[36:39],a[4:7],v[64:67],0
s_waitcnt lgkmcnt(2)
ds_read_b128 v[80:83],v4 offset:4096
v_mfma_f32_16x16x32_bf16 v[32:35],a[8:11],v[68:71],v[32:35]
s_add_u32 s53,s60,3
s_and_b32 s64,s50,1
s_add_u32 s53,s53,s64
s_min_u32 s53,s53,128
s_cmp_ge_u32 s60,126
s_cselect_b32 s53,-1,s53
ds_read_b128 v[84:87],v4 offset:5120
v_mfma_f32_16x16x32_bf16 v[36:39],a[12:15],v[68:71],v[36:39]
s_waitcnt lgkmcnt(3)
s_mov_b32 s57,s63
ds_read_b128 v[88:91],v4 offset:6144
v_mfma_f32_16x16x32_bf16 v[32:35],a[16:19],v[72:75],v[32:35]
ds_read_b128 v[92:95],v4 offset:7168
v_add_f32 v40,v40,v168
v_mfma_f32_16x16x32_bf16 v[36:39],a[20:23],v[72:75],v[36:39]
s_waitcnt lgkmcnt(4)
s_barrier
ds_read_b128 v[96:99],v5 offset:0
v_mfma_f32_16x16x32_bf16 v[32:35],a[24:27],v[76:79],v[32:35]
ds_read_b128 v[100:103],v5 offset:1024
v_add_f32 v41,v41,v169
v_mfma_f32_16x16x32_bf16 v[36:39],a[28:31],v[76:79],v[36:39]
s_waitcnt lgkmcnt(5)
v_add_f32 v42,v42,v170
v_add_f32 v43,v43,v171
v_mfma_f32_16x16x32_bf16 v[32:35],a[32:35],v[80:83],v[32:35]
ds_read_b128 v[104:107],v5 offset:2048
v_add_f32 v44,v44,v172
v_mfma_f32_16x16x32_bf16 v[36:39],a[36:39],v[80:83],v[36:39]
s_waitcnt lgkmcnt(5)
v_add_f32 v45,v45,v173
v_add_f32 v46,v46,v174
v_mfma_f32_16x16x32_bf16 v[32:35],a[40:43],v[84:87],v[32:35]
ds_read_b128 v[108:111],v5 offset:3072
v_add_f32 v47,v47,v175
v_mfma_f32_16x16x32_bf16 v[36:39],a[44:47],v[84:87],v[36:39]
s_waitcnt lgkmcnt(5)
v_cvt_pk_bf16_f32 v176,v40,v41
v_cvt_pk_bf16_f32 v177,v42,v43
v_mfma_f32_16x16x32_bf16 v[32:35],a[48:51],v[88:91],v[32:35]
ds_read_b128 v[112:115],v5 offset:4096
v_cvt_pk_bf16_f32 v178,v44,v45
v_mfma_f32_16x16x32_bf16 v[36:39],a[52:55],v[88:91],v[36:39]
s_waitcnt lgkmcnt(5)
buffer_load_dwordx4 v[160:163],v0,s[20:23],s82 offen
v_cvt_pk_bf16_f32 v179,v46,v47
v_mfma_f32_16x16x32_bf16 v[32:35],a[56:59],v[92:95],v[32:35]
s_add_u32 s82,s82,32768
ds_read_b128 v[116:119],v5 offset:5120
v_mfma_f32_16x16x32_bf16 v[36:39],a[60:63],v[92:95],v[36:39]
s_waitcnt lgkmcnt(5)
buffer_store_dwordx4 v[176:179],v0,s[20:23],s66 offen sc1
v_mfma_f32_16x16x32_bf16 v[32:35],a[64:67],v[96:99],v[32:35]
s_add_u32 s66,s66,32768
s_add_u32 s63,s63,1
ds_read_b128 v[120:123],v5 offset:6144
v_mfma_f32_16x16x32_bf16 v[36:39],a[68:71],v[96:99],v[36:39]
s_waitcnt lgkmcnt(5)
v_mfma_f32_16x16x32_bf16 v[32:35],a[72:75],v[100:103],v[32:35]
ds_read_b128 v[124:127],v5 offset:7168
v_mfma_f32_16x16x32_bf16 v[36:39],a[76:79],v[100:103],v[36:39]
s_waitcnt lgkmcnt(5)
v_mfma_f32_16x16x32_bf16 v[32:35],a[80:83],v[104:107],v[32:35]
ds_read_b128 v[64:67],v6 offset:0
v_mfma_f32_16x16x32_bf16 v[36:39],a[84:87],v[104:107],v[36:39]
s_waitcnt lgkmcnt(5)
v_mfma_f32_16x16x32_bf16 v[32:35],a[88:91],v[108:111],v[32:35]
ds_read_b128 v[68:71],v6 offset:1024
v_mfma_f32_16x16x32_bf16 v[36:39],a[92:95],v[108:111],v[36:39]
s_waitcnt lgkmcnt(5)
v_mfma_f32_16x16x32_bf16 v[32:35],a[96:99],v[112:115],v[32:35]
ds_read_b128 v[72:75],v6 offset:2048
v_mfma_f32_16x16x32_bf16 v[36:39],a[100:103],v[112:115],v[36:39]
s_waitcnt lgkmcnt(5)
v_mfma_f32_16x16x32_bf16 v[32:35],a[104:107],v[116:119],v[32:35]
ds_read_b128 v[76:79],v6 offset:3072
v_mfma_f32_16x16x32_bf16 v[36:39],a[108:111],v[116:119],v[36:39]
s_waitcnt lgkmcnt(5)
v_mfma_f32_16x16x32_bf16 v[32:35],a[112:115],v[120:123],v[32:35]
ds_read_b128 v[80:83],v6 offset:4096
v_mfma_f32_16x16x32_bf16 v[36:39],a[116:119],v[120:123],v[36:39]
s_waitcnt lgkmcnt(5)
v_mfma_f32_16x16x32_bf16 v[32:35],a[120:123],v[124:127],v[32:35]
ds_read_b128 v[84:87],v6 offset:5120
v_mfma_f32_16x16x32_bf16 v[36:39],a[124:127],v[124:127],v[36:39]
s_waitcnt lgkmcnt(5)
v_mfma_f32_16x16x32_bf16 v[32:35],a[128:131],v[64:67],v[32:35]
ds_read_b128 v[88:91],v6 offset:6144
v_mfma_f32_16x16x32_bf16 v[36:39],a[132:135],v[64:67],v[36:39]
s_waitcnt lgkmcnt(5)
v_mfma_f32_16x16x32_bf16 v[32:35],a[136:139],v[68:71],v[32:35]
ds_read_b128 v[92:95],v6 offset:7168
v_mfma_f32_16x16x32_bf16 v[36:39],a[140:143],v[68:71],v[36:39]
s_waitcnt lgkmcnt(5)
v_mfma_f32_16x16x32_bf16 v[32:35],a[144:147],v[72:75],v[32:35]
ds_read_b128 v[96:99],v7 offset:0
v_mfma_f32_16x16x32_bf16 v[36:39],a[148:151],v[72:75],v[36:39]
s_waitcnt lgkmcnt(5)
v_mfma_f32_16x16x32_bf16 v[32:35],a[152:155],v[76:79],v[32:35]
ds_read_b128 v[100:103],v7 offset:1024
v_mfma_f32_16x16x32_bf16 v[36:39],a[156:159],v[76:79],v[36:39]
s_waitcnt lgkmcnt(5)
v_mfma_f32_16x16x32_bf16 v[32:35],a[160:163],v[80:83],v[32:35]
ds_read_b128 v[104:107],v7 offset:2048
v_mfma_f32_16x16x32_bf16 v[36:39],a[164:167],v[80:83],v[36:39]
s_waitcnt lgkmcnt(5)
buffer_load_dword v16,v2,s[20:23],s68 offen sc1
v_mfma_f32_16x16x32_bf16 v[32:35],a[168:171],v[84:87],v[32:35]
ds_read_b128 v[108:111],v7 offset:3072
v_mfma_f32_16x16x32_bf16 v[36:39],a[172:175],v[84:87],v[36:39]
s_waitcnt lgkmcnt(5)
v_mfma_f32_16x16x32_bf16 v[32:35],a[176:179],v[88:91],v[32:35]
ds_read_b128 v[112:115],v7 offset:4096
v_mfma_f32_16x16x32_bf16 v[36:39],a[180:183],v[88:91],v[36:39]
s_waitcnt lgkmcnt(5)
v_mfma_f32_16x16x32_bf16 v[32:35],a[184:187],v[92:95],v[32:35]
ds_read_b128 v[116:119],v7 offset:5120
v_mfma_f32_16x16x32_bf16 v[36:39],a[188:191],v[92:95],v[36:39]
s_waitcnt lgkmcnt(5)
v_mfma_f32_16x16x32_bf16 v[32:35],a[192:195],v[96:99],v[32:35]
ds_read_b128 v[120:123],v7 offset:6144
v_mfma_f32_16x16x32_bf16 v[36:39],a[196:199],v[96:99],v[36:39]
s_waitcnt lgkmcnt(5)
v_mfma_f32_16x16x32_bf16 v[32:35],a[200:203],v[100:103],v[32:35]
s_waitcnt vmcnt(2)
ds_read_b128 v[124:127],v7 offset:7168
v_lshlrev_b32 v168,16,v160
v_mfma_f32_16x16x32_bf16 v[36:39],a[204:207],v[100:103],v[36:39]
s_waitcnt lgkmcnt(5)
v_and_b32 v169,s73,v160
v_lshlrev_b32 v170,16,v161
v_mfma_f32_16x16x32_bf16 v[32:35],a[208:211],v[104:107],v[32:35]
s_add_u32 s55,s55,32768
v_and_b32 v171,s73,v161
v_lshlrev_b32 v172,16,v162
v_mfma_f32_16x16x32_bf16 v[36:39],a[212:215],v[104:107],v[36:39]
s_waitcnt lgkmcnt(4)
v_and_b32 v173,s73,v162
v_lshlrev_b32 v174,16,v163
v_mfma_f32_16x16x32_bf16 v[32:35],a[216:219],v[108:111],v[32:35]
s_and_b32 s55,s55,0x1ffff
v_and_b32 v175,s73,v163
v_add_u32 v4,s55,v8
v_mfma_f32_16x16x32_bf16 v[36:39],a[220:223],v[108:111],v[36:39]
s_waitcnt lgkmcnt(3)
v_add_u32 v5,s55,v9
v_add_u32 v6,s55,v10
v_mfma_f32_16x16x32_bf16 v[32:35],a[224:227],v[112:115],v[32:35]
v_add_u32 v7,s55,v11
v_mfma_f32_16x16x32_bf16 v[36:39],a[228:231],v[112:115],v[36:39]
s_waitcnt lgkmcnt(2)
v_mfma_f32_16x16x32_bf16 v[32:35],a[232:235],v[116:119],v[32:35]
v_mfma_f32_16x16x32_bf16 v[36:39],a[236:239],v[116:119],v[36:39]
s_waitcnt lgkmcnt(1)
s_waitcnt vmcnt(1)
v_mov_b32 v17,s63
s_mov_b64 exec,1
buffer_store_dword v17,off,s[20:23],s69 sc1
s_mov_b64 exec,-1
v_mfma_f32_16x16x32_bf16 v[32:35],a[240:243],v[120:123],v[32:35]
v_mfma_f32_16x16x32_bf16 v[36:39],a[244:247],v[120:123],v[36:39]
s_waitcnt lgkmcnt(0)
v_mfma_f32_16x16x32_bf16 v[40:43],a[248:251],v[124:127],v[32:35]
v_mfma_f32_16x16x32_bf16 v[44:47],a[252:255],v[124:127],v[36:39]
s_waitcnt vmcnt(1)
v_cmp_gt_u32 vcc,s71,v16
s_add_u32 s60,s60,1
s_branch endN_329
BN_323:
s_waitcnt vmcnt(8)
ds_read_b128 v[64:67],v4 offset:0
s_waitcnt vmcnt(7)
ds_read_b128 v[68:71],v4 offset:1024
s_waitcnt vmcnt(6)
ds_read_b128 v[72:75],v4 offset:2048
s_waitcnt vmcnt(5)
ds_read_b128 v[76:79],v4 offset:3072
s_waitcnt lgkmcnt(3)
v_mfma_f32_16x16x32_bf16 v[32:35],a[0:3],v[64:67],0
s_add_u32 s71,s60,2
s_and_b32 s64,s50,1
s_add_u32 s71,s71,s64
s_min_u32 s71,s71,128
s_cmp_ge_u32 s60,127
s_cselect_b32 s71,-1,s71
v_mfma_f32_16x16x32_bf16 v[36:39],a[4:7],v[64:67],0
s_waitcnt lgkmcnt(2)
s_waitcnt vmcnt(4)
ds_read_b128 v[80:83],v4 offset:4096
v_mfma_f32_16x16x32_bf16 v[32:35],a[8:11],v[68:71],v[32:35]
s_add_u32 s53,s60,3
s_and_b32 s64,s50,1
s_add_u32 s53,s53,s64
s_min_u32 s53,s53,128
s_cmp_ge_u32 s60,126
s_cselect_b32 s53,-1,s53
v_mfma_f32_16x16x32_bf16 v[36:39],a[12:15],v[68:71],v[36:39]
s_waitcnt lgkmcnt(2)
s_waitcnt vmcnt(3)
s_mov_b32 s57,s63
ds_read_b128 v[84:87],v4 offset:5120
v_mfma_f32_16x16x32_bf16 v[32:35],a[16:19],v[72:75],v[32:35]
buffer_load_dwordx4 v[160:163],v0,s[20:23],s82 offen
v_mfma_f32_16x16x32_bf16 v[36:39],a[20:23],v[72:75],v[36:39]
s_waitcnt lgkmcnt(2)
s_waitcnt vmcnt(3)
s_add_u32 s82,s82,32768
ds_read_b128 v[88:91],v4 offset:6144
v_mfma_f32_16x16x32_bf16 v[32:35],a[24:27],v[76:79],v[32:35]
v_mfma_f32_16x16x32_bf16 v[36:39],a[28:31],v[76:79],v[36:39]
s_waitcnt lgkmcnt(2)
s_waitcnt vmcnt(2)
ds_read_b128 v[92:95],v4 offset:7168
v_mfma_f32_16x16x32_bf16 v[32:35],a[32:35],v[80:83],v[32:35]
v_mfma_f32_16x16x32_bf16 v[36:39],a[36:39],v[80:83],v[36:39]
s_waitcnt lgkmcnt(2)
s_barrier
ds_read_b128 v[96:99],v5 offset:0
v_mfma_f32_16x16x32_bf16 v[32:35],a[40:43],v[84:87],v[32:35]
ds_read_b128 v[100:103],v5 offset:1024
v_mfma_f32_16x16x32_bf16 v[36:39],a[44:47],v[84:87],v[36:39]
s_waitcnt lgkmcnt(3)
ds_read_b128 v[104:107],v5 offset:2048
v_mfma_f32_16x16x32_bf16 v[32:35],a[48:51],v[88:91],v[32:35]
ds_read_b128 v[108:111],v5 offset:3072
v_mfma_f32_16x16x32_bf16 v[36:39],a[52:55],v[88:91],v[36:39]
s_waitcnt lgkmcnt(4)
ds_read_b128 v[112:115],v5 offset:4096
v_mfma_f32_16x16x32_bf16 v[32:35],a[56:59],v[92:95],v[32:35]
ds_read_b128 v[116:119],v5 offset:5120
v_mfma_f32_16x16x32_bf16 v[36:39],a[60:63],v[92:95],v[36:39]
s_waitcnt lgkmcnt(5)
v_mfma_f32_16x16x32_bf16 v[32:35],a[64:67],v[96:99],v[32:35]
ds_read_b128 v[120:123],v5 offset:6144
v_mfma_f32_16x16x32_bf16 v[36:39],a[68:71],v[96:99],v[36:39]
s_waitcnt lgkmcnt(5)
v_mfma_f32_16x16x32_bf16 v[32:35],a[72:75],v[100:103],v[32:35]
ds_read_b128 v[124:127],v5 offset:7168
v_mfma_f32_16x16x32_bf16 v[36:39],a[76:79],v[100:103],v[36:39]
s_waitcnt lgkmcnt(5)
v_mfma_f32_16x16x32_bf16 v[32:35],a[80:83],v[104:107],v[32:35]
ds_read_b128 v[64:67],v6 offset:0
v_mfma_f32_16x16x32_bf16 v[36:39],a[84:87],v[104:107],v[36:39]
s_waitcnt lgkmcnt(5)
s_waitcnt vmcnt(1)
v_mov_b32 v17,s57
s_mov_b64 exec,1
buffer_store_dword v17,off,s[20:23],s69 sc1
s_mov_b64 exec,-1
v_mfma_f32_16x16x32_bf16 v[32:35],a[88:91],v[108:111],v[32:35]
ds_read_b128 v[68:71],v6 offset:1024
v_mfma_f32_16x16x32_bf16 v[36:39],a[92:95],v[108:111],v[36:39]
s_waitcnt lgkmcnt(5)
v_mfma_f32_16x16x32_bf16 v[32:35],a[96:99],v[112:115],v[32:35]
ds_read_b128 v[72:75],v6 offset:2048
v_mfma_f32_16x16x32_bf16 v[36:39],a[100:103],v[112:115],v[36:39]
s_waitcnt lgkmcnt(5)
v_mfma_f32_16x16x32_bf16 v[32:35],a[104:107],v[116:119],v[32:35]
ds_read_b128 v[76:79],v6 offset:3072
v_mfma_f32_16x16x32_bf16 v[36:39],a[108:111],v[116:119],v[36:39]
s_waitcnt lgkmcnt(5)
v_mfma_f32_16x16x32_bf16 v[32:35],a[112:115],v[120:123],v[32:35]
ds_read_b128 v[80:83],v6 offset:4096
v_mfma_f32_16x16x32_bf16 v[36:39],a[116:119],v[120:123],v[36:39]
s_waitcnt lgkmcnt(5)
v_mfma_f32_16x16x32_bf16 v[32:35],a[120:123],v[124:127],v[32:35]
ds_read_b128 v[84:87],v6 offset:5120
v_mfma_f32_16x16x32_bf16 v[36:39],a[124:127],v[124:127],v[36:39]
s_waitcnt lgkmcnt(5)
v_mfma_f32_16x16x32_bf16 v[32:35],a[128:131],v[64:67],v[32:35]
ds_read_b128 v[88:91],v6 offset:6144
v_mfma_f32_16x16x32_bf16 v[36:39],a[132:135],v[64:67],v[36:39]
s_waitcnt lgkmcnt(5)
v_mfma_f32_16x16x32_bf16 v[32:35],a[136:139],v[68:71],v[32:35]
ds_read_b128 v[92:95],v6 offset:7168
v_mfma_f32_16x16x32_bf16 v[36:39],a[140:143],v[68:71],v[36:39]
s_waitcnt lgkmcnt(5)
v_mfma_f32_16x16x32_bf16 v[32:35],a[144:147],v[72:75],v[32:35]
ds_read_b128 v[96:99],v7 offset:0
v_mfma_f32_16x16x32_bf16 v[36:39],a[148:151],v[72:75],v[36:39]
s_waitcnt lgkmcnt(5)
v_mfma_f32_16x16x32_bf16 v[32:35],a[152:155],v[76:79],v[32:35]
ds_read_b128 v[100:103],v7 offset:1024
v_mfma_f32_16x16x32_bf16 v[36:39],a[156:159],v[76:79],v[36:39]
s_waitcnt lgkmcnt(5)
v_mfma_f32_16x16x32_bf16 v[32:35],a[160:163],v[80:83],v[32:35]
ds_read_b128 v[104:107],v7 offset:2048
v_mfma_f32_16x16x32_bf16 v[36:39],a[164:167],v[80:83],v[36:39]
s_waitcnt lgkmcnt(5)
buffer_load_dword v16,v2,s[20:23],s68 offen sc1
v_mfma_f32_16x16x32_bf16 v[32:35],a[168:171],v[84:87],v[32:35]
ds_read_b128 v[108:111],v7 offset:3072
v_mfma_f32_16x16x32_bf16 v[36:39],a[172:175],v[84:87],v[36:39]
s_waitcnt lgkmcnt(5)
v_mfma_f32_16x16x32_bf16 v[32:35],a[176:179],v[88:91],v[32:35]
ds_read_b128 v[112:115],v7 offset:4096
v_mfma_f32_16x16x32_bf16 v[36:39],a[180:183],v[88:91],v[36:39]
s_waitcnt lgkmcnt(5)
v_mfma_f32_16x16x32_bf16 v[32:35],a[184:187],v[92:95],v[32:35]
ds_read_b128 v[116:119],v7 offset:5120
v_mfma_f32_16x16x32_bf16 v[36:39],a[188:191],v[92:95],v[36:39]
s_waitcnt lgkmcnt(5)
v_mfma_f32_16x16x32_bf16 v[32:35],a[192:195],v[96:99],v[32:35]
ds_read_b128 v[120:123],v7 offset:6144
v_mfma_f32_16x16x32_bf16 v[36:39],a[196:199],v[96:99],v[36:39]
s_waitcnt lgkmcnt(5)
v_mfma_f32_16x16x32_bf16 v[32:35],a[200:203],v[100:103],v[32:35]
s_waitcnt vmcnt(2)
ds_read_b128 v[124:127],v7 offset:7168
v_lshlrev_b32 v168,16,v160
v_mfma_f32_16x16x32_bf16 v[36:39],a[204:207],v[100:103],v[36:39]
s_waitcnt lgkmcnt(5)
v_and_b32 v169,s73,v160
v_lshlrev_b32 v170,16,v161
v_mfma_f32_16x16x32_bf16 v[32:35],a[208:211],v[104:107],v[32:35]
s_add_u32 s55,s55,32768
v_and_b32 v171,s73,v161
v_lshlrev_b32 v172,16,v162
v_mfma_f32_16x16x32_bf16 v[36:39],a[212:215],v[104:107],v[36:39]
s_waitcnt lgkmcnt(4)
v_and_b32 v173,s73,v162
v_lshlrev_b32 v174,16,v163
v_mfma_f32_16x16x32_bf16 v[32:35],a[216:219],v[108:111],v[32:35]
s_and_b32 s55,s55,0x1ffff
v_and_b32 v175,s73,v163
v_add_u32 v4,s55,v8
v_mfma_f32_16x16x32_bf16 v[36:39],a[220:223],v[108:111],v[36:39]
s_waitcnt lgkmcnt(3)
v_add_u32 v5,s55,v9
v_add_u32 v6,s55,v10
v_mfma_f32_16x16x32_bf16 v[32:35],a[224:227],v[112:115],v[32:35]
v_add_u32 v7,s55,v11
v_mfma_f32_16x16x32_bf16 v[36:39],a[228:231],v[112:115],v[36:39]
s_waitcnt lgkmcnt(2)
v_mfma_f32_16x16x32_bf16 v[32:35],a[232:235],v[116:119],v[32:35]
v_mfma_f32_16x16x32_bf16 v[36:39],a[236:239],v[116:119],v[36:39]
s_waitcnt lgkmcnt(1)
v_mfma_f32_16x16x32_bf16 v[32:35],a[240:243],v[120:123],v[32:35]
v_mfma_f32_16x16x32_bf16 v[36:39],a[244:247],v[120:123],v[36:39]
s_waitcnt lgkmcnt(0)
v_mfma_f32_16x16x32_bf16 v[40:43],a[248:251],v[124:127],v[32:35]
v_mfma_f32_16x16x32_bf16 v[44:47],a[252:255],v[124:127],v[36:39]
s_waitcnt vmcnt(0)
v_cmp_gt_u32 vcc,s71,v16
s_add_u32 s60,s60,1
endN_329:
s_cbranch_vccnz nb_326
s_mov_b32 m0,s70
s_nop 0
buffer_load_dwordx4 v3,s[20:23],s61 offen offset:0 lds
buffer_load_dwordx4 v3,s[20:23],s61 offen offset:1024 lds
buffer_load_dwordx4 v3,s[20:23],s61 offen offset:2048 lds
buffer_load_dwordx4 v3,s[20:23],s61 offen offset:3072 lds
s_add_u32 m0,s70,4096
s_nop 0
buffer_load_dwordx4 v3,s[20:23],s62 offen offset:0 lds
buffer_load_dwordx4 v3,s[20:23],s62 offen offset:1024 lds
buffer_load_dwordx4 v3,s[20:23],s62 offen offset:2048 lds
buffer_load_dwordx4 v3,s[20:23],s62 offen offset:3072 lds
s_add_u32 s61,s61,32768
s_add_u32 s62,s62,32768
s_add_u32 s70,s70,32768
s_and_b32 s70,s70,0x1ffff
v_pk_add_f32 v[40:41],v[40:41],v[168:169]
v_pk_add_f32 v[42:43],v[42:43],v[170:171]
v_pk_add_f32 v[44:45],v[44:45],v[172:173]
v_pk_add_f32 v[46:47],v[46:47],v[174:175]
v_cvt_pk_bf16_f32 v176,v40,v41
v_cvt_pk_bf16_f32 v177,v42,v43
v_cvt_pk_bf16_f32 v178,v44,v45
v_cvt_pk_bf16_f32 v179,v46,v47
buffer_store_dwordx4 v[176:179],v0,s[20:23],s66 offen sc1
s_add_u32 s66,s66,32768
s_add_u32 s63,s63,1
s_branch dec_325
nb_326:
buffer_load_dword v16,v2,s[20:23],s68 offen sc1
s_nop 3
v_pk_add_f32 v[40:41],v[40:41],v[168:169]
v_pk_add_f32 v[42:43],v[42:43],v[170:171]
v_pk_add_f32 v[44:45],v[44:45],v[172:173]
v_pk_add_f32 v[46:47],v[46:47],v[174:175]
v_cvt_pk_bf16_f32 v176,v40,v41
v_cvt_pk_bf16_f32 v177,v42,v43
v_cvt_pk_bf16_f32 v178,v44,v45
v_cvt_pk_bf16_f32 v179,v46,v47
buffer_store_dwordx4 v[176:179],v0,s[20:23],s66 offen sc1
s_add_u32 s66,s66,32768
s_add_u32 s63,s63,1
s_waitcnt vmcnt(1)
v_cmp_gt_u32 vcc,s71,v16
s_cbranch_vccz lag_324
s_waitcnt vmcnt(0)
v_mov_b32 v17,s63
s_mov_b64 exec,1
buffer_store_dword v17,off,s[20:23],s69 sc1
s_mov_b64 exec,-1
s_cmp_ge_u32 s60,128
s_cbranch_scc1 done_313
plp_330:
buffer_load_dword v16,v2,s[20:23],s68 offen sc1
s_waitcnt vmcnt(0)
v_cmp_gt_u32 vcc,s71,v16
s_cbranch_vccz pok_331
s_sleep 4
s_sub_u32 s90,s90,1
s_cmp_gt_i32 s90,0
s_cbranch_scc1 plp_330
pok_331:
s_branch lag_324
done_313:
s_endpgm
fl_ln2:
s_mov_b32 s52,s59
s_mov_b32 s60,0
s_mov_b32 s73,0xffff0000
v_and_b32 v2,3,v1
v_lshrrev_b32 v3,2,v1
s_lshl_b32 s64,s52,2
v_add_u32 v4,s64,v2
s_lshl_b32 s65,s50,9
v_lshlrev_b32 v5,4,v3
v_add_u32 v5,s65,v5
v_lshl_add_u32 v8,v4,11,v5
v_lshlrev_b32 v9,1,v5
v_lshrrev_b32 v5,2,v3
v_and_b32 v3,3,v3
s_lshl_b32 s65,s50,13
v_lshlrev_b32 v5,10,v5
v_lshl_add_u32 v5,v3,8,v5
v_lshl_add_u32 v5,v4,4,v5
v_add_u32 v10,s65,v5
s_lshl_b32 s65,s50,9
v_lshlrev_b32 v5,3,v1
v_add_u32 v11,s65,v5
v_lshlrev_b32 v12,3,v2
v_and_b32 v13,7,v1
v_lshlrev_b32 v13,2,v13
s_mov_b32 s92,s2
s_and_b32 s93,s3,0xffff
s_mov_b32 s94,0x100
s_mov_b32 s95,0x20000
v_mbcnt_lo_u32_b32 v16,-1,0
v_mbcnt_hi_u32_b32 v16,-1,v16
v_mov_b32 v18,0
v_cmp_eq_u32 vcc,22,v16
s_nop 1
v_cndmask_b32 v18,v18,63,vcc
v_cmp_eq_u32 vcc,17,v16
s_nop 1
v_cndmask_b32 v18,v18,63,vcc
v_cmp_eq_u32 vcc,18,v16
s_nop 1
v_cndmask_b32 v18,v18,1,vcc
v_and_b32 v19,1,v16
v_cmp_eq_u32 vcc,1,v19
v_mov_b32 v19,8192
s_nop 0
v_cndmask_b32 v19,-1,v19,vcc
v_min_u32 v16,31,v16
v_lshlrev_b32 v16,2,v16
s_sub_u32 s66,s88,64
s_cmp_lg_u32 s50,0
s_cbranch_scc1 vot_337
vpoll_333:
buffer_load_dword v17,v16,s[92:95],s66 offen sc1
s_waitcnt vmcnt(0)
s_cmp_lg_u32 s56,2
s_cbranch_scc1 vck_334
v_cmp_eq_u32 vcc,v17,v19
s_and_b32 s64,vcc_lo,0xffff
s_cmp_eq_u32 s64,65535
s_cbranch_scc1 vck_334
s_mov_b32 s65,0
v_readlane_b32 s64,v17,1
s_lshr_b32 s64,s64,8
s_add_u32 s65,s65,s64
v_readlane_b32 s64,v17,3
s_lshr_b32 s64,s64,8
s_add_u32 s65,s65,s64
v_readlane_b32 s64,v17,5
s_lshr_b32 s64,s64,8
s_add_u32 s65,s65,s64
v_readlane_b32 s64,v17,7
s_lshr_b32 s64,s64,8
s_add_u32 s65,s65,s64
v_readlane_b32 s64,v17,9
s_lshr_b32 s64,s64,8
s_add_u32 s65,s65,s64
v_readlane_b32 s64,v17,11
s_lshr_b32 s64,s64,8
s_add_u32 s65,s65,s64
v_readlane_b32 s64,v17,13
s_lshr_b32 s64,s64,8
s_add_u32 s65,s65,s64
v_readlane_b32 s64,v17,15
s_lshr_b32 s64,s64,8
s_add_u32 s65,s65,s64
s_cmp_ge_u32 s65,256
s_cbranch_scc1 vok_336
s_branch vrt_335
vck_334:
v_cmp_gt_u32 vcc,v18,v17
s_cbranch_vccz vok_336
vrt_335:
s_sleep 48
s_sub_u32 s90,s90,1
s_cmp_gt_i32 s90,0
s_cbranch_scc1 vpoll_333
vok_336:
v_add_u32 v18,161024,v16
ds_write_b32 v18,v17
s_waitcnt lgkmcnt(0)
vot_337:
s_barrier
v_add_u32 v18,161024,v16
ds_read_b32 v17,v18
s_waitcnt lgkmcnt(0)
s_cmp_lg_u32 s56,2
s_cbranch_scc1 vfin_338
v_cmp_eq_u32 vcc,v17,v19
s_and_b32 s64,vcc_lo,0xffff
s_cmp_eq_u32 s64,65535
s_cbranch_scc1 vfin_338
s_mov_b32 s65,0
v_readlane_b32 s64,v17,1
s_lshr_b32 s64,s64,8
s_add_u32 s65,s65,s64
v_readlane_b32 s64,v17,3
s_lshr_b32 s64,s64,8
s_add_u32 s65,s65,s64
v_readlane_b32 s64,v17,5
s_lshr_b32 s64,s64,8
s_add_u32 s65,s65,s64
v_readlane_b32 s64,v17,7
s_lshr_b32 s64,s64,8
s_add_u32 s65,s65,s64
v_readlane_b32 s64,v17,9
s_lshr_b32 s64,s64,8
s_add_u32 s65,s65,s64
v_readlane_b32 s64,v17,11
s_lshr_b32 s64,s64,8
s_add_u32 s65,s65,s64
v_readlane_b32 s64,v17,13
s_lshr_b32 s64,s64,8
s_add_u32 s65,s65,s64
v_readlane_b32 s64,v17,15
s_lshr_b32 s64,s64,8
s_add_u32 s65,s65,s64
s_cmp_ge_u32 s65,256
s_cbranch_scc1 fl_fb
vfin_338:
s_and_b32 s56,s56,1
s_mov_b32 s67,0
s_mov_b32 s64,267403264
buffer_load_dwordx4 v[32:35],v9,s[20:23],s64 offen offset:0 sc1
buffer_load_dwordx4 v[36:39],v9,s[20:23],s64 offen offset:16 sc1
buffer_load_dwordx4 v[40:43],v9,s[20:23],s64 offen offset:512 sc1
buffer_load_dwordx4 v[44:47],v9,s[20:23],s64 offen offset:528 sc1
s_mov_b32 s64,267427840
buffer_load_dwordx4 v[64:67],v9,s[20:23],s64 offen offset:0 sc1
buffer_load_dwordx4 v[68:71],v9,s[20:23],s64 offen offset:16 sc1
buffer_load_dwordx4 v[72:75],v9,s[20:23],s64 offen offset:512 sc1
buffer_load_dwordx4 v[76:79],v9,s[20:23],s64 offen offset:528 sc1
s_mov_b32 s64,267452416
buffer_load_dwordx4 v[80:83],v9,s[20:23],s64 offen offset:0 sc1
buffer_load_dwordx4 v[84:87],v9,s[20:23],s64 offen offset:16 sc1
buffer_load_dwordx4 v[88:91],v9,s[20:23],s64 offen offset:512 sc1
buffer_load_dwordx4 v[92:95],v9,s[20:23],s64 offen offset:528 sc1
s_mov_b32 s64,267476992
buffer_load_dwordx4 v[96:99],v9,s[20:23],s64 offen offset:0 sc1
buffer_load_dwordx4 v[100:103],v9,s[20:23],s64 offen offset:16 sc1
buffer_load_dwordx4 v[104:107],v9,s[20:23],s64 offen offset:512 sc1
buffer_load_dwordx4 v[108:111],v9,s[20:23],s64 offen offset:528 sc1
s_waitcnt vmcnt(0)
v_pk_add_f32 v[32:33],v[32:33],v[64:65]
v_pk_add_f32 v[80:81],v[80:81],v[96:97]
v_pk_add_f32 v[34:35],v[34:35],v[66:67]
v_pk_add_f32 v[82:83],v[82:83],v[98:99]
v_pk_add_f32 v[36:37],v[36:37],v[68:69]
v_pk_add_f32 v[84:85],v[84:85],v[100:101]
v_pk_add_f32 v[38:39],v[38:39],v[70:71]
v_pk_add_f32 v[86:87],v[86:87],v[102:103]
v_pk_add_f32 v[40:41],v[40:41],v[72:73]
v_pk_add_f32 v[88:89],v[88:89],v[104:105]
v_pk_add_f32 v[42:43],v[42:43],v[74:75]
v_pk_add_f32 v[90:91],v[90:91],v[106:107]
v_pk_add_f32 v[44:45],v[44:45],v[76:77]
v_pk_add_f32 v[92:93],v[92:93],v[108:109]
v_pk_add_f32 v[46:47],v[46:47],v[78:79]
v_pk_add_f32 v[94:95],v[94:95],v[110:111]
v_pk_add_f32 v[32:33],v[32:33],v[80:81]
v_pk_add_f32 v[34:35],v[34:35],v[82:83]
v_pk_add_f32 v[36:37],v[36:37],v[84:85]
v_pk_add_f32 v[38:39],v[38:39],v[86:87]
v_pk_add_f32 v[40:41],v[40:41],v[88:89]
v_pk_add_f32 v[42:43],v[42:43],v[90:91]
v_pk_add_f32 v[44:45],v[44:45],v[92:93]
v_pk_add_f32 v[46:47],v[46:47],v[94:95]
v_cvt_pk_bf16_f32 v64,v32,v33
v_cvt_pk_bf16_f32 v65,v34,v35
v_cvt_pk_bf16_f32 v66,v36,v37
v_cvt_pk_bf16_f32 v67,v38,v39
v_cvt_pk_bf16_f32 v68,v40,v41
v_cvt_pk_bf16_f32 v69,v42,v43
v_cvt_pk_bf16_f32 v70,v44,v45
v_cvt_pk_bf16_f32 v71,v46,v47
v_lshlrev_b32 v32,16,v64
v_and_b32 v33,s73,v64
v_lshlrev_b32 v34,16,v65
v_and_b32 v35,s73,v65
v_lshlrev_b32 v36,16,v66
v_and_b32 v37,s73,v66
v_lshlrev_b32 v38,16,v67
v_and_b32 v39,s73,v67
v_lshlrev_b32 v40,16,v68
v_and_b32 v41,s73,v68
v_lshlrev_b32 v42,16,v69
v_and_b32 v43,s73,v69
v_lshlrev_b32 v44,16,v70
v_and_b32 v45,s73,v70
v_lshlrev_b32 v46,16,v71
v_and_b32 v47,s73,v71
v_add_f32 v32,1.0,v32
v_add_f32 v33,1.0,v33
v_add_f32 v34,1.0,v34
v_add_f32 v35,1.0,v35
v_add_f32 v36,1.0,v36
v_add_f32 v37,1.0,v37
v_add_f32 v38,1.0,v38
v_add_f32 v39,1.0,v39
v_add_f32 v40,1.0,v40
v_add_f32 v41,1.0,v41
v_add_f32 v42,1.0,v42
v_add_f32 v43,1.0,v43
v_add_f32 v44,1.0,v44
v_add_f32 v45,1.0,v45
v_add_f32 v46,1.0,v46
v_add_f32 v47,1.0,v47
s_mov_b32 s64,267399168
buffer_load_dwordx4 v[48:51],v9,s[20:23],s64 offen offset:0 sc1
buffer_load_dwordx4 v[52:55],v9,s[20:23],s64 offen offset:16 sc1
buffer_load_dwordx4 v[56:59],v9,s[20:23],s64 offen offset:512 sc1
buffer_load_dwordx4 v[60:63],v9,s[20:23],s64 offen offset:528 sc1
s_mov_b32 s64,267423744
buffer_load_dwordx4 v[64:67],v9,s[20:23],s64 offen offset:0 sc1
buffer_load_dwordx4 v[68:71],v9,s[20:23],s64 offen offset:16 sc1
buffer_load_dwordx4 v[72:75],v9,s[20:23],s64 offen offset:512 sc1
buffer_load_dwordx4 v[76:79],v9,s[20:23],s64 offen offset:528 sc1
s_mov_b32 s64,267448320
buffer_load_dwordx4 v[80:83],v9,s[20:23],s64 offen offset:0 sc1
buffer_load_dwordx4 v[84:87],v9,s[20:23],s64 offen offset:16 sc1
buffer_load_dwordx4 v[88:91],v9,s[20:23],s64 offen offset:512 sc1
buffer_load_dwordx4 v[92:95],v9,s[20:23],s64 offen offset:528 sc1
s_mov_b32 s64,267472896
buffer_load_dwordx4 v[96:99],v9,s[20:23],s64 offen offset:0 sc1
buffer_load_dwordx4 v[100:103],v9,s[20:23],s64 offen offset:16 sc1
buffer_load_dwordx4 v[104:107],v9,s[20:23],s64 offen offset:512 sc1
buffer_load_dwordx4 v[108:111],v9,s[20:23],s64 offen offset:528 sc1
s_waitcnt vmcnt(0)
v_pk_add_f32 v[48:49],v[48:49],v[64:65]
v_pk_add_f32 v[80:81],v[80:81],v[96:97]
v_pk_add_f32 v[50:51],v[50:51],v[66:67]
v_pk_add_f32 v[82:83],v[82:83],v[98:99]
v_pk_add_f32 v[52:53],v[52:53],v[68:69]
v_pk_add_f32 v[84:85],v[84:85],v[100:101]
v_pk_add_f32 v[54:55],v[54:55],v[70:71]
v_pk_add_f32 v[86:87],v[86:87],v[102:103]
v_pk_add_f32 v[56:57],v[56:57],v[72:73]
v_pk_add_f32 v[88:89],v[88:89],v[104:105]
v_pk_add_f32 v[58:59],v[58:59],v[74:75]
v_pk_add_f32 v[90:91],v[90:91],v[106:107]
v_pk_add_f32 v[60:61],v[60:61],v[76:77]
v_pk_add_f32 v[92:93],v[92:93],v[108:109]
v_pk_add_f32 v[62:63],v[62:63],v[78:79]
v_pk_add_f32 v[94:95],v[94:95],v[110:111]
v_pk_add_f32 v[48:49],v[48:49],v[80:81]
v_pk_add_f32 v[50:51],v[50:51],v[82:83]
v_pk_add_f32 v[52:53],v[52:53],v[84:85]
v_pk_add_f32 v[54:55],v[54:55],v[86:87]
v_pk_add_f32 v[56:57],v[56:57],v[88:89]
v_pk_add_f32 v[58:59],v[58:59],v[90:91]
v_pk_add_f32 v[60:61],v[60:61],v[92:93]
v_pk_add_f32 v[62:63],v[62:63],v[94:95]
v_cvt_pk_bf16_f32 v64,v48,v49
v_cvt_pk_bf16_f32 v65,v50,v51
v_cvt_pk_bf16_f32 v66,v52,v53
v_cvt_pk_bf16_f32 v67,v54,v55
v_cvt_pk_bf16_f32 v68,v56,v57
v_cvt_pk_bf16_f32 v69,v58,v59
v_cvt_pk_bf16_f32 v70,v60,v61
v_cvt_pk_bf16_f32 v71,v62,v63
v_lshlrev_b32 v48,16,v64
v_and_b32 v49,s73,v64
v_lshlrev_b32 v50,16,v65
v_and_b32 v51,s73,v65
v_lshlrev_b32 v52,16,v66
v_and_b32 v53,s73,v66
v_lshlrev_b32 v54,16,v67
v_and_b32 v55,s73,v67
v_lshlrev_b32 v56,16,v68
v_and_b32 v57,s73,v68
v_lshlrev_b32 v58,16,v69
v_and_b32 v59,s73,v69
v_lshlrev_b32 v60,16,v70
v_and_b32 v61,s73,v70
v_lshlrev_b32 v62,16,v71
v_and_b32 v63,s73,v71
s_mov_b32 s63,201326592
s_mov_b32 s66,205520896
s_lshl_b32 s64,s50,8
s_add_u32 s68,s64,138547200
s_lshl_b32 s65,s59,2
s_add_u32 s69,s64,s65
s_add_u32 s69,s69,138548224
s_mov_b32 s71,1
plp_341:
buffer_load_dword v14,v13,s[20:23],s68 offen sc1
s_waitcnt vmcnt(0)
v_cmp_gt_u32 vcc,s71,v14
s_cbranch_vccz pok_342
s_sleep 4
s_sub_u32 s90,s90,1
s_cmp_gt_i32 s90,0
s_cbranch_scc1 plp_341
pok_342:
s_add_u32 s64,s63,4096
buffer_load_dwordx4 v[64:67],v10,s[20:23],s63 offen
buffer_load_dwordx4 v[68:71],v10,s[20:23],s64 offen
s_add_u32 s63,s63,32768
buffer_load_dword v15,off,s[20:23],s68
buffer_load_dword v15,off,s[20:23],s68
top0_339:
buffer_load_dword v14,v13,s[20:23],s68 offen sc1
s_add_u32 s71,s60,2
s_waitcnt vmcnt(3)
v_lshlrev_b32 v80,16,v64
v_and_b32 v81,s73,v64
v_lshlrev_b32 v82,16,v65
v_and_b32 v83,s73,v65
v_lshlrev_b32 v84,16,v66
v_and_b32 v85,s73,v66
v_lshlrev_b32 v86,16,v67
v_and_b32 v87,s73,v67
v_lshlrev_b32 v88,16,v68
v_and_b32 v89,s73,v68
v_lshlrev_b32 v90,16,v69
v_and_b32 v91,s73,v69
v_lshlrev_b32 v92,16,v70
v_and_b32 v93,s73,v70
v_lshlrev_b32 v94,16,v71
v_and_b32 v95,s73,v71
v_add_f32 v96,v80,v81
v_mul_f32 v97,v80,v80
v_add_f32 v98,v82,v83
v_mul_f32 v99,v81,v81
v_fmac_f32 v97,v82,v82
v_fmac_f32 v99,v83,v83
v_add_f32 v96,v96,v84
v_fmac_f32 v97,v84,v84
v_add_f32 v98,v98,v85
v_fmac_f32 v99,v85,v85
v_add_f32 v96,v96,v86
v_fmac_f32 v97,v86,v86
v_add_f32 v98,v98,v87
v_fmac_f32 v99,v87,v87
v_add_f32 v96,v96,v88
v_fmac_f32 v97,v88,v88
v_add_f32 v98,v98,v89
v_fmac_f32 v99,v89,v89
v_add_f32 v96,v96,v90
v_fmac_f32 v97,v90,v90
v_add_f32 v98,v98,v91
v_fmac_f32 v99,v91,v91
v_add_f32 v96,v96,v92
v_fmac_f32 v97,v92,v92
v_add_f32 v98,v98,v93
v_fmac_f32 v99,v93,v93
v_add_f32 v96,v96,v94
v_fmac_f32 v97,v94,v94
v_add_f32 v98,v98,v95
v_fmac_f32 v99,v95,v95
v_add_f32 v96,v96,v98
v_add_f32 v97,v97,v99
s_nop 0
v_add_f32_dpp v96,v96,v96 row_ror:4 row_mask:0xf bank_mask:0xf
v_add_f32_dpp v97,v97,v97 row_ror:4 row_mask:0xf bank_mask:0xf
s_nop 0
v_add_f32_dpp v96,v96,v96 row_ror:8 row_mask:0xf bank_mask:0xf
v_add_f32_dpp v97,v97,v97 row_ror:8 row_mask:0xf bank_mask:0xf
v_mov_b32 v98,v96
v_mov_b32 v99,v97
s_nop 0
v_permlane16_swap_b32 v98,v96
v_permlane16_swap_b32 v99,v97
v_add_f32 v96,v96,v98
v_add_f32 v97,v97,v99
v_mov_b32 v98,v96
v_mov_b32 v99,v97
s_nop 0
v_permlane32_swap_b32 v98,v96
v_permlane32_swap_b32 v99,v97
v_add_f32 v96,v96,v98
v_add_f32 v97,v97,v99
ds_write_b64 v11,v[96:97] offset:0
s_waitcnt lgkmcnt(0)
s_barrier
s_waitcnt vmcnt(0)
v_mov_b32 v15,s60
s_mov_b64 exec,1
buffer_store_dword v15,off,s[20:23],s69 sc1
s_mov_b64 exec,-1
v_cmp_gt_u32 vcc,s71,v14
s_mov_b32 s72,0
s_cbranch_vccnz p2_344
s_mov_b32 s72,1
s_add_u32 s64,s63,4096
buffer_load_dwordx4 v[72:75],v10,s[20:23],s63 offen
buffer_load_dwordx4 v[76:79],v10,s[20:23],s64 offen
s_add_u32 s63,s63,32768
p2_344:
ds_read_b64 v[100:101],v12 offset:0
ds_read_b64 v[102:103],v12 offset:512
ds_read_b64 v[104:105],v12 offset:1024
ds_read_b64 v[106:107],v12 offset:1536
s_waitcnt lgkmcnt(0)
v_add_f32 v100,v100,v102
v_add_f32 v101,v101,v103
v_add_f32 v104,v104,v106
v_add_f32 v105,v105,v107
v_add_f32 v100,v100,v104
v_add_f32 v101,v101,v105
v_mul_f32 v96,0xba800000,v100
v_mul_f32 v102,v96,v96
v_mul_f32 v101,0x3a800000,v101
v_sub_f32 v101,v101,v102
v_max_f32 v101,0,v101
v_add_f32 v101,0x3727c5ac,v101
v_rsq_f32 v97,v101
s_nop 0
v_mul_f32 v96,v96,v97
v_fma_f32 v80,v80,v97,v96
v_fma_f32 v81,v81,v97,v96
v_fma_f32 v82,v82,v97,v96
v_fma_f32 v83,v83,v97,v96
v_fma_f32 v84,v84,v97,v96
v_fma_f32 v85,v85,v97,v96
v_fma_f32 v86,v86,v97,v96
v_fma_f32 v87,v87,v97,v96
v_fma_f32 v88,v88,v97,v96
v_fma_f32 v89,v89,v97,v96
v_fma_f32 v90,v90,v97,v96
v_fma_f32 v91,v91,v97,v96
v_fma_f32 v92,v92,v97,v96
v_fma_f32 v93,v93,v97,v96
v_fma_f32 v94,v94,v97,v96
v_fma_f32 v95,v95,v97,v96
v_fma_f32 v80,v80,v32,v48
v_fma_f32 v81,v81,v33,v49
v_fma_f32 v82,v82,v34,v50
v_fma_f32 v83,v83,v35,v51
v_fma_f32 v84,v84,v36,v52
v_fma_f32 v85,v85,v37,v53
v_fma_f32 v86,v86,v38,v54
v_fma_f32 v87,v87,v39,v55
v_fma_f32 v88,v88,v40,v56
v_fma_f32 v89,v89,v41,v57
v_fma_f32 v90,v90,v42,v58
v_fma_f32 v91,v91,v43,v59
v_fma_f32 v92,v92,v44,v60
v_fma_f32 v93,v93,v45,v61
v_fma_f32 v94,v94,v46,v62
v_fma_f32 v95,v95,v47,v63
v_cvt_pk_bf16_f32 v112,v80,v81
v_cvt_pk_bf16_f32 v113,v82,v83
v_cvt_pk_bf16_f32 v114,v84,v85
v_cvt_pk_bf16_f32 v115,v86,v87
v_cvt_pk_bf16_f32 v116,v88,v89
v_cvt_pk_bf16_f32 v117,v90,v91
v_cvt_pk_bf16_f32 v118,v92,v93
v_cvt_pk_bf16_f32 v119,v94,v95
s_add_u32 s64,s66,4096
buffer_store_dwordx4 v[112:115],v10,s[20:23],s66 offen sc1
buffer_store_dwordx4 v[116:119],v10,s[20:23],s64 offen sc1
s_add_u32 s66,s66,32768
s_add_u32 s60,s60,1
s_cmp_eq_u32 s72,0
s_cbranch_scc1 slowp_343
top1_340:
buffer_load_dword v14,v13,s[20:23],s68 offen sc1
s_add_u32 s71,s60,2
s_waitcnt vmcnt(3)
v_lshlrev_b32 v80,16,v72
v_and_b32 v81,s73,v72
v_lshlrev_b32 v82,16,v73
v_and_b32 v83,s73,v73
v_lshlrev_b32 v84,16,v74
v_and_b32 v85,s73,v74
v_lshlrev_b32 v86,16,v75
v_and_b32 v87,s73,v75
v_lshlrev_b32 v88,16,v76
v_and_b32 v89,s73,v76
v_lshlrev_b32 v90,16,v77
v_and_b32 v91,s73,v77
v_lshlrev_b32 v92,16,v78
v_and_b32 v93,s73,v78
v_lshlrev_b32 v94,16,v79
v_and_b32 v95,s73,v79
v_add_f32 v96,v80,v81
v_mul_f32 v97,v80,v80
v_add_f32 v98,v82,v83
v_mul_f32 v99,v81,v81
v_fmac_f32 v97,v82,v82
v_fmac_f32 v99,v83,v83
v_add_f32 v96,v96,v84
v_fmac_f32 v97,v84,v84
v_add_f32 v98,v98,v85
v_fmac_f32 v99,v85,v85
v_add_f32 v96,v96,v86
v_fmac_f32 v97,v86,v86
v_add_f32 v98,v98,v87
v_fmac_f32 v99,v87,v87
v_add_f32 v96,v96,v88
v_fmac_f32 v97,v88,v88
v_add_f32 v98,v98,v89
v_fmac_f32 v99,v89,v89
v_add_f32 v96,v96,v90
v_fmac_f32 v97,v90,v90
v_add_f32 v98,v98,v91
v_fmac_f32 v99,v91,v91
v_add_f32 v96,v96,v92
v_fmac_f32 v97,v92,v92
v_add_f32 v98,v98,v93
v_fmac_f32 v99,v93,v93
v_add_f32 v96,v96,v94
v_fmac_f32 v97,v94,v94
v_add_f32 v98,v98,v95
v_fmac_f32 v99,v95,v95
v_add_f32 v96,v96,v98
v_add_f32 v97,v97,v99
s_nop 0
v_add_f32_dpp v96,v96,v96 row_ror:4 row_mask:0xf bank_mask:0xf
v_add_f32_dpp v97,v97,v97 row_ror:4 row_mask:0xf bank_mask:0xf
s_nop 0
v_add_f32_dpp v96,v96,v96 row_ror:8 row_mask:0xf bank_mask:0xf
v_add_f32_dpp v97,v97,v97 row_ror:8 row_mask:0xf bank_mask:0xf
v_mov_b32 v98,v96
v_mov_b32 v99,v97
s_nop 0
v_permlane16_swap_b32 v98,v96
v_permlane16_swap_b32 v99,v97
v_add_f32 v96,v96,v98
v_add_f32 v97,v97,v99
v_mov_b32 v98,v96
v_mov_b32 v99,v97
s_nop 0
v_permlane32_swap_b32 v98,v96
v_permlane32_swap_b32 v99,v97
v_add_f32 v96,v96,v98
v_add_f32 v97,v97,v99
ds_write_b64 v11,v[96:97] offset:2048
s_waitcnt lgkmcnt(0)
s_barrier
s_waitcnt vmcnt(0)
v_mov_b32 v15,s60
s_mov_b64 exec,1
buffer_store_dword v15,off,s[20:23],s69 sc1
s_mov_b64 exec,-1
v_cmp_gt_u32 vcc,s71,v14
s_mov_b32 s72,0
s_cbranch_vccnz p2_346
s_mov_b32 s72,1
s_add_u32 s64,s63,4096
buffer_load_dwordx4 v[64:67],v10,s[20:23],s63 offen
buffer_load_dwordx4 v[68:71],v10,s[20:23],s64 offen
s_add_u32 s63,s63,32768
p2_346:
ds_read_b64 v[100:101],v12 offset:2048
ds_read_b64 v[102:103],v12 offset:2560
ds_read_b64 v[104:105],v12 offset:3072
ds_read_b64 v[106:107],v12 offset:3584
s_waitcnt lgkmcnt(0)
v_add_f32 v100,v100,v102
v_add_f32 v101,v101,v103
v_add_f32 v104,v104,v106
v_add_f32 v105,v105,v107
v_add_f32 v100,v100,v104
v_add_f32 v101,v101,v105
v_mul_f32 v96,0xba800000,v100
v_mul_f32 v102,v96,v96
v_mul_f32 v101,0x3a800000,v101
v_sub_f32 v101,v101,v102
v_max_f32 v101,0,v101
v_add_f32 v101,0x3727c5ac,v101
v_rsq_f32 v97,v101
s_nop 0
v_mul_f32 v96,v96,v97
v_fma_f32 v80,v80,v97,v96
v_fma_f32 v81,v81,v97,v96
v_fma_f32 v82,v82,v97,v96
v_fma_f32 v83,v83,v97,v96
v_fma_f32 v84,v84,v97,v96
v_fma_f32 v85,v85,v97,v96
v_fma_f32 v86,v86,v97,v96
v_fma_f32 v87,v87,v97,v96
v_fma_f32 v88,v88,v97,v96
v_fma_f32 v89,v89,v97,v96
v_fma_f32 v90,v90,v97,v96
v_fma_f32 v91,v91,v97,v96
v_fma_f32 v92,v92,v97,v96
v_fma_f32 v93,v93,v97,v96
v_fma_f32 v94,v94,v97,v96
v_fma_f32 v95,v95,v97,v96
v_fma_f32 v80,v80,v32,v48
v_fma_f32 v81,v81,v33,v49
v_fma_f32 v82,v82,v34,v50
v_fma_f32 v83,v83,v35,v51
v_fma_f32 v84,v84,v36,v52
v_fma_f32 v85,v85,v37,v53
v_fma_f32 v86,v86,v38,v54
v_fma_f32 v87,v87,v39,v55
v_fma_f32 v88,v88,v40,v56
v_fma_f32 v89,v89,v41,v57
v_fma_f32 v90,v90,v42,v58
v_fma_f32 v91,v91,v43,v59
v_fma_f32 v92,v92,v44,v60
v_fma_f32 v93,v93,v45,v61
v_fma_f32 v94,v94,v46,v62
v_fma_f32 v95,v95,v47,v63
v_cvt_pk_bf16_f32 v112,v80,v81
v_cvt_pk_bf16_f32 v113,v82,v83
v_cvt_pk_bf16_f32 v114,v84,v85
v_cvt_pk_bf16_f32 v115,v86,v87
v_cvt_pk_bf16_f32 v116,v88,v89
v_cvt_pk_bf16_f32 v117,v90,v91
v_cvt_pk_bf16_f32 v118,v92,v93
v_cvt_pk_bf16_f32 v119,v94,v95
s_add_u32 s64,s66,4096
buffer_store_dwordx4 v[112:115],v10,s[20:23],s66 offen sc1
buffer_store_dwordx4 v[116:119],v10,s[20:23],s64 offen sc1
s_add_u32 s66,s66,32768
s_add_u32 s60,s60,1
s_cmp_eq_u32 s72,0
s_cbranch_scc1 slowp_345
s_branch top0_339
slowp_343:
buffer_load_dword v14,v13,s[20:23],s68 offen sc1
s_waitcnt vmcnt(1)
v_mov_b32 v15,s60
s_mov_b64 exec,1
buffer_store_dword v15,off,s[20:23],s69 sc1
s_mov_b64 exec,-1
s_cmp_ge_u32 s60,128
s_cbranch_scc1 done_332
s_waitcnt vmcnt(1)
v_cmp_gt_u32 vcc,s71,v14
s_cbranch_vccz go_347
plp_348:
buffer_load_dword v14,v13,s[20:23],s68 offen sc1
s_waitcnt vmcnt(0)
v_cmp_gt_u32 vcc,s71,v14
s_cbranch_vccz pok_349
s_sleep 4
s_sub_u32 s90,s90,1
s_cmp_gt_i32 s90,0
s_cbranch_scc1 plp_348
pok_349:
go_347:
s_add_u32 s64,s63,4096
buffer_load_dwordx4 v[72:75],v10,s[20:23],s63 offen
buffer_load_dwordx4 v[76:79],v10,s[20:23],s64 offen
s_add_u32 s63,s63,32768
buffer_load_dword v15,off,s[20:23],s68
buffer_load_dword v15,off,s[20:23],s68
s_branch top1_340
slowp_345:
buffer_load_dword v14,v13,s[20:23],s68 offen sc1
s_waitcnt vmcnt(1)
v_mov_b32 v15,s60
s_mov_b64 exec,1
buffer_store_dword v15,off,s[20:23],s69 sc1
s_mov_b64 exec,-1
s_cmp_ge_u32 s60,128
s_cbranch_scc1 done_332
s_waitcnt vmcnt(1)
v_cmp_gt_u32 vcc,s71,v14
s_cbranch_vccz go_350
plp_351:
buffer_load_dword v14,v13,s[20:23],s68 offen sc1
s_waitcnt vmcnt(0)
v_cmp_gt_u32 vcc,s71,v14
s_cbranch_vccz pok_352
s_sleep 4
s_sub_u32 s90,s90,1
s_cmp_gt_i32 s90,0
s_cbranch_scc1 plp_351
pok_352:
go_350:
s_add_u32 s64,s63,4096
buffer_load_dwordx4 v[64:67],v10,s[20:23],s63 offen
buffer_load_dwordx4 v[68:71],v10,s[20:23],s64 offen
s_add_u32 s63,s63,32768
buffer_load_dword v15,off,s[20:23],s68
buffer_load_dword v15,off,s[20:23],s68
s_branch top0_339
done_332:
s_endpgm
fl_att:
s_mov_b32 s92,s2
s_and_b32 s93,s3,0xffff
s_mov_b32 s94,0x100
s_mov_b32 s95,0x20000
v_mbcnt_lo_u32_b32 v16,-1,0
v_mbcnt_hi_u32_b32 v16,-1,v16
v_mov_b32 v18,0
v_cmp_eq_u32 vcc,22,v16
s_nop 1
v_cndmask_b32 v18,v18,63,vcc
v_cmp_eq_u32 vcc,21,v16
s_nop 1
v_cndmask_b32 v18,v18,1,vcc
v_and_b32 v19,1,v16
v_cmp_eq_u32 vcc,1,v19
v_mov_b32 v19,8192
s_nop 0
v_cndmask_b32 v19,-1,v19,vcc
v_min_u32 v16,31,v16
v_lshlrev_b32 v16,2,v16
s_sub_u32 s66,s88,64
s_cmp_lg_u32 s50,0
s_cbranch_scc1 vot_357
vpoll_353:
buffer_load_dword v17,v16,s[92:95],s66 offen sc1
s_waitcnt vmcnt(0)
s_cmp_lg_u32 s56,2
s_cbranch_scc1 vck_354
v_cmp_eq_u32 vcc,v17,v19
s_and_b32 s64,vcc_lo,0xffff
s_cmp_eq_u32 s64,65535
s_cbranch_scc1 vck_354
s_mov_b32 s65,0
v_readlane_b32 s64,v17,1
s_lshr_b32 s64,s64,8
s_add_u32 s65,s65,s64
v_readlane_b32 s64,v17,3
s_lshr_b32 s64,s64,8
s_add_u32 s65,s65,s64
v_readlane_b32 s64,v17,5
s_lshr_b32 s64,s64,8
s_add_u32 s65,s65,s64
v_readlane_b32 s64,v17,7
s_lshr_b32 s64,s64,8
s_add_u32 s65,s65,s64
v_readlane_b32 s64,v17,9
s_lshr_b32 s64,s64,8
s_add_u32 s65,s65,s64
v_readlane_b32 s64,v17,11
s_lshr_b32 s64,s64,8
s_add_u32 s65,s65,s64
v_readlane_b32 s64,v17,13
s_lshr_b32 s64,s64,8
s_add_u32 s65,s65,s64
v_readlane_b32 s64,v17,15
s_lshr_b32 s64,s64,8
s_add_u32 s65,s65,s64
s_cmp_ge_u32 s65,256
s_cbranch_scc1 vok_356
s_branch vrt_355
vck_354:
v_cmp_gt_u32 vcc,v18,v17
s_cbranch_vccz vok_356
vrt_355:
s_sleep 8
s_sub_u32 s90,s90,1
s_cmp_gt_i32 s90,0
s_cbranch_scc1 vpoll_353
vok_356:
v_add_u32 v18,161280,v16
ds_write_b32 v18,v17
s_waitcnt lgkmcnt(0)
vot_357:
s_barrier
v_add_u32 v18,161280,v16
ds_read_b32 v17,v18
s_waitcnt lgkmcnt(0)
s_cmp_lg_u32 s56,2
s_cbranch_scc1 vfin_358
v_cmp_eq_u32 vcc,v17,v19
s_and_b32 s64,vcc_lo,0xffff
s_cmp_eq_u32 s64,65535
s_cbranch_scc1 vfin_358
s_mov_b32 s65,0
v_readlane_b32 s64,v17,1
s_lshr_b32 s64,s64,8
s_add_u32 s65,s65,s64
v_readlane_b32 s64,v17,3
s_lshr_b32 s64,s64,8
s_add_u32 s65,s65,s64
v_readlane_b32 s64,v17,5
s_lshr_b32 s64,s64,8
s_add_u32 s65,s65,s64
v_readlane_b32 s64,v17,7
s_lshr_b32 s64,s64,8
s_add_u32 s65,s65,s64
v_readlane_b32 s64,v17,9
s_lshr_b32 s64,s64,8
s_add_u32 s65,s65,s64
v_readlane_b32 s64,v17,11
s_lshr_b32 s64,s64,8
s_add_u32 s65,s65,s64
v_readlane_b32 s64,v17,13
s_lshr_b32 s64,s64,8
s_add_u32 s65,s65,s64
v_readlane_b32 s64,v17,15
s_lshr_b32 s64,s64,8
s_add_u32 s65,s65,s64
s_cmp_ge_u32 s65,256
s_cbranch_scc1 fl_fb
vfin_358:
s_and_b32 s56,s56,1
s_mov_b32 s67,0
v_readlane_b32 s65,v17,21
s_and_b32 s65,s65,2
s_lshl_b32 s67,s65,12
v_lshlrev_b32 v0,4,v1
v_and_b32 v21,15,v1
v_lshrrev_b32 v22,4,v1
v_and_b32 v23,7,v21
v_lshlrev_b32 v23,4,v23
v_lshl_add_u32 v3,v22,8,v23
v_and_b32 v23,31,v1
v_lshlrev_b32 v4,4,v23
v_and_b32 v23,3,v1
v_bfe_u32 v24,v1,2,1
v_lshlrev_b32 v23,14,v23
v_lshl_add_u32 v2,v24,7,v23
v_mov_b32 v7,0xff800000
s_and_b32 s54,s50,1
s_lshl_b32 s64,s54,4
v_lshlrev_b32 v23,2,v22
v_sub_u32 v23,v21,v23
v_add_u32 v23,s64,v23
v_cmp_le_i32 s[28:29],0,v23
v_cmp_le_i32 s[30:31],1,v23
v_cmp_le_i32 s[32:33],2,v23
v_cmp_le_i32 s[34:35],3,v23
v_cmp_le_i32 s[36:37],16,v23
v_cmp_le_i32 s[38:39],17,v23
v_cmp_le_i32 s[40:41],18,v23
v_cmp_le_i32 s[42:43],19,v23
s_mov_b32 s44,-1
s_mov_b32 s45,0
s_mov_b32 s80,0x3e0293ee
s_lshl_b32 s52,s59,1
s_lshr_b32 s64,s50,1
s_add_u32 s52,s52,s64
s_lshl_b32 s53,s52,15
s_lshl_b32 s68,s52,8
s_add_u32 s68,s68,s67
s_add_u32 s68,s68,138428416
s_lshl_b32 s69,s59,8
s_lshl_b32 s64,s64,2
s_add_u32 s69,s69,s64
s_lshl_b32 s64,s54,3
s_add_u32 s69,s69,s64
s_add_u32 s69,s69,138543104
s_lshl_b32 s66,s52,12
s_lshl_b32 s64,s54,17
s_add_u32 s66,s66,s64
s_add_u32 s66,s66,150994944
s_lshl_b32 s55,s54,10
s_xor_b32 s55,s55,0x2000
s_mov_b32 s60,0
s_mov_b32 s71,1
plp_359:
buffer_load_dword v5,v2,s[20:23],s68 offen sc1
s_waitcnt vmcnt(0)
v_cmp_gt_u32 vcc,s71,v5
s_cbranch_vccz pok_360
s_sleep 4
s_sub_u32 s90,s90,1
s_cmp_gt_i32 s90,0
s_cbranch_scc1 plp_359
pok_360:
s_add_u32 s64,s60,0
s_lshl_b32 s65,s64,11
s_and_b32 s65,s65,0x2000
s_xor_b32 s65,s65,s67
s_lshl_b32 s64,s64,19
s_add_u32 s64,s64,s65
s_add_u32 s92,s64,s53
s_add_u32 s93,s92,16384
s_add_u32 s94,s92,4096
s_add_u32 s95,s93,4096
s_xor_b32 s96,s92,s55
s_xor_b32 s97,s93,s55
buffer_load_dwordx4 a[0:3],v0,s[20:23],s96 offen offset:0
buffer_load_dwordx4 a[16:19],v0,s[20:23],s92 offen offset:0
buffer_load_dwordx4 a[32:35],v0,s[20:23],s92 offen offset:1024
buffer_load_dwordx4 a[4:7],v0,s[20:23],s96 offen offset:2048
buffer_load_dwordx4 a[20:23],v0,s[20:23],s92 offen offset:2048
buffer_load_dwordx4 a[36:39],v0,s[20:23],s92 offen offset:3072
buffer_load_dwordx4 a[8:11],v0,s[20:23],s97 offen offset:0
buffer_load_dwordx4 a[24:27],v0,s[20:23],s93 offen offset:0
buffer_load_dwordx4 a[40:43],v0,s[20:23],s93 offen offset:1024
buffer_load_dwordx4 a[12:15],v0,s[20:23],s97 offen offset:2048
buffer_load_dwordx4 a[28:31],v0,s[20:23],s93 offen offset:2048
buffer_load_dwordx4 a[44:47],v0,s[20:23],s93 offen offset:3072
buffer_load_dwordx4 a[48:51],v0,s[20:23],s94 offen offset:0
buffer_load_dwordx4 a[52:55],v0,s[20:23],s94 offen offset:1024
buffer_load_dwordx4 a[56:59],v0,s[20:23],s94 offen offset:2048
buffer_load_dwordx4 a[60:63],v0,s[20:23],s94 offen offset:3072
buffer_load_dwordx4 a[64:67],v0,s[20:23],s95 offen offset:0
buffer_load_dwordx4 a[68:71],v0,s[20:23],s95 offen offset:1024
buffer_load_dwordx4 a[72:75],v0,s[20:23],s95 offen offset:2048
buffer_load_dwordx4 a[76:79],v0,s[20:23],s95 offen offset:3072
s_waitcnt vmcnt(8)
top0_361:
v_mfma_f32_16x16x32_bf16 v[48:51],a[16:19],a[0:3],0
v_mfma_f32_16x16x32_bf16 v[52:55],a[32:35],a[0:3],0
v_mfma_f32_16x16x32_bf16 v[48:51],a[20:23],a[4:7],v[48:51]
v_mfma_f32_16x16x32_bf16 v[52:55],a[36:39],a[4:7],v[52:55]
v_mfma_f32_16x16x32_bf16 v[48:51],a[24:27],a[8:11],v[48:51]
v_mfma_f32_16x16x32_bf16 v[52:55],a[40:43],a[8:11],v[52:55]
v_mfma_f32_16x16x32_bf16 v[48:51],a[28:31],a[12:15],v[48:51]
v_mfma_f32_16x16x32_bf16 v[52:55],a[44:47],a[12:15],v[52:55]
s_nop 6
v_cndmask_b32 v48,v7,v48,s[28:29]
v_cndmask_b32 v49,v7,v49,s[30:31]
v_cndmask_b32 v50,v7,v50,s[32:33]
v_cndmask_b32 v51,v7,v51,s[34:35]
v_cndmask_b32 v52,v7,v52,s[36:37]
v_cndmask_b32 v53,v7,v53,s[38:39]
v_cndmask_b32 v54,v7,v54,s[40:41]
v_cndmask_b32 v55,v7,v55,s[42:43]
v_max3_f32 v72,v48,v49,v50
v_max3_f32 v72,v72,v51,v52
v_max3_f32 v72,v72,v53,v54
v_max_f32 v72,v72,v55
s_add_u32 s64,s60,0
s_lshl_b32 s65,s64,11
s_and_b32 s65,s65,0x2000
s_xor_b32 s65,s65,s67
s_lshl_b32 s64,s64,19
s_add_u32 s64,s64,s65
s_add_u32 s98,s64,s53
s_add_u32 s98,s98,67108864
s_add_u32 s99,s98,16384
s_lshr_b32 s71,s60,1
s_add_u32 s71,s71,1
plp_363:
buffer_load_dword v5,v2,s[20:23],s68 offen sc1
s_waitcnt vmcnt(0)
v_cmp_gt_u32 vcc,s71,v5
s_cbranch_vccz pok_364
s_sleep 4
s_sub_u32 s90,s90,1
s_cmp_gt_i32 s90,0
s_cbranch_scc1 plp_363
pok_364:
buffer_load_dwordx4 v[16:19],v3,s[20:23],s98 offen offset:0
buffer_load_dwordx4 v[20:23],v3,s[20:23],s98 offen offset:128
buffer_load_dwordx4 v[24:27],v3,s[20:23],s99 offen offset:0
buffer_load_dwordx4 v[28:31],v3,s[20:23],s99 offen offset:128
buffer_load_dwordx4 v[32:35],v4,s[20:23],s98 offen offset:1024
buffer_load_dwordx4 v[36:39],v4,s[20:23],s98 offen offset:1536
buffer_load_dwordx4 v[40:43],v4,s[20:23],s99 offen offset:1024
buffer_load_dwordx4 v[44:47],v4,s[20:23],s99 offen offset:1536
s_barrier
s_add_u32 s64,s60,2
s_lshl_b32 s65,s64,11
s_and_b32 s65,s65,0x2000
s_xor_b32 s65,s65,s67
s_lshl_b32 s64,s64,19
s_add_u32 s64,s64,s65
s_add_u32 s92,s64,s53
s_add_u32 s93,s92,16384
s_add_u32 s94,s92,4096
s_add_u32 s95,s93,4096
s_xor_b32 s96,s92,s55
s_xor_b32 s97,s93,s55
buffer_load_dwordx4 a[80:83],v0,s[20:23],s96 offen offset:0
buffer_load_dwordx4 a[96:99],v0,s[20:23],s92 offen offset:0
buffer_load_dwordx4 a[112:115],v0,s[20:23],s92 offen offset:1024
buffer_load_dwordx4 a[84:87],v0,s[20:23],s96 offen offset:2048
buffer_load_dwordx4 a[100:103],v0,s[20:23],s92 offen offset:2048
buffer_load_dwordx4 a[116:119],v0,s[20:23],s92 offen offset:3072
buffer_load_dwordx4 a[88:91],v0,s[20:23],s97 offen offset:0
buffer_load_dwordx4 a[104:107],v0,s[20:23],s93 offen offset:0
buffer_load_dwordx4 a[120:123],v0,s[20:23],s93 offen offset:1024
buffer_load_dwordx4 a[92:95],v0,s[20:23],s97 offen offset:2048
buffer_load_dwordx4 a[108:111],v0,s[20:23],s93 offen offset:2048
buffer_load_dwordx4 a[124:127],v0,s[20:23],s93 offen offset:3072
s_waitcnt vmcnt(16)
v_mfma_f32_16x16x32_bf16 v[56:59],v[16:19],a[0:3],0
v_mfma_f32_16x16x32_bf16 v[56:59],v[20:23],a[4:7],v[56:59]
v_mfma_f32_16x16x32_bf16 v[56:59],v[24:27],a[8:11],v[56:59]
v_mfma_f32_16x16x32_bf16 v[56:59],v[28:31],a[12:15],v[56:59]
s_nop 7
v_cndmask_b32 v56,v7,v56,s[44:45]
v_cndmask_b32 v57,v7,v57,s[44:45]
v_cndmask_b32 v58,v7,v58,s[44:45]
v_cndmask_b32 v59,v7,v59,s[44:45]
v_max3_f32 v72,v72,v56,v57
v_max3_f32 v72,v72,v58,v59
v_mov_b32 v73,v72
s_nop 1
v_permlane16_swap_b32 v73,v72
v_max_f32 v72,v72,v73
v_mov_b32 v73,v72
s_nop 1
v_permlane32_swap_b32 v73,v72
v_max_f32 v72,v72,v73
v_mul_f32 v72,s80,v72
v_fma_f32 v48,v48,s80,-v72
v_fma_f32 v49,v49,s80,-v72
v_fma_f32 v50,v50,s80,-v72
v_fma_f32 v51,v51,s80,-v72
v_fma_f32 v52,v52,s80,-v72
v_fma_f32 v53,v53,s80,-v72
v_fma_f32 v54,v54,s80,-v72
v_fma_f32 v55,v55,s80,-v72
v_fma_f32 v56,v56,s80,-v72
v_fma_f32 v57,v57,s80,-v72
v_fma_f32 v58,v58,s80,-v72
v_fma_f32 v59,v59,s80,-v72
v_exp_f32 v48,v48
v_exp_f32 v49,v49
v_exp_f32 v50,v50
v_exp_f32 v51,v51
v_exp_f32 v52,v52
v_exp_f32 v53,v53
v_exp_f32 v54,v54
v_exp_f32 v55,v55
v_exp_f32 v56,v56
v_exp_f32 v57,v57
v_exp_f32 v58,v58
v_exp_f32 v59,v59
v_add_f32 v74,v48,v49
v_add_f32 v75,v50,v51
v_add_f32 v74,v74,v52
v_add_f32 v75,v75,v53
v_add_f32 v74,v74,v54
v_add_f32 v75,v75,v55
v_add_f32 v74,v74,v56
v_add_f32 v75,v75,v57
v_add_f32 v74,v74,v58
v_add_f32 v75,v75,v59
v_add_f32 v74,v74,v75
v_mov_b32 v73,v74
s_nop 1
v_permlane16_swap_b32 v73,v74
v_add_f32 v74,v74,v73
v_mov_b32 v73,v74
s_nop 1
v_permlane32_swap_b32 v73,v74
v_add_f32 v74,v74,v73
v_rcp_f32 v75,v74
s_nop 0
v_mul_f32 v48,v48,v75
v_mul_f32 v49,v49,v75
v_mul_f32 v50,v50,v75
v_mul_f32 v51,v51,v75
v_mul_f32 v52,v52,v75
v_mul_f32 v53,v53,v75
v_mul_f32 v54,v54,v75
v_mul_f32 v55,v55,v75
v_mul_f32 v56,v56,v75
v_mul_f32 v57,v57,v75
v_mul_f32 v58,v58,v75
v_mul_f32 v59,v59,v75
v_cvt_pk_bf16_f32 v64,v48,v49
v_cvt_pk_bf16_f32 v65,v50,v51
v_cvt_pk_bf16_f32 v66,v52,v53
v_cvt_pk_bf16_f32 v67,v54,v55
v_cvt_pk_bf16_f32 v68,v56,v57
v_cvt_pk_bf16_f32 v69,v58,v59
v_mfma_f32_16x16x32_bf16 v[80:83],a[48:51],v[64:67],0
v_mfma_f32_16x16x32_bf16 v[84:87],a[52:55],v[64:67],0
v_mfma_f32_16x16x32_bf16 v[88:91],a[56:59],v[64:67],0
v_mfma_f32_16x16x32_bf16 v[92:95],a[60:63],v[64:67],0
v_mfma_f32_16x16x32_bf16 v[96:99],a[64:67],v[64:67],0
v_mfma_f32_16x16x32_bf16 v[100:103],a[68:71],v[64:67],0
v_mfma_f32_16x16x32_bf16 v[104:107],a[72:75],v[64:67],0
v_mfma_f32_16x16x32_bf16 v[108:111],a[76:79],v[64:67],0
s_waitcnt vmcnt(12)
v_mfma_f32_16x16x16_bf16 v[80:83],v[32:33],v[68:69],v[80:83]
v_mfma_f32_16x16x16_bf16 v[84:87],v[34:35],v[68:69],v[84:87]
v_mfma_f32_16x16x16_bf16 v[88:91],v[36:37],v[68:69],v[88:91]
v_mfma_f32_16x16x16_bf16 v[92:95],v[38:39],v[68:69],v[92:95]
v_mfma_f32_16x16x16_bf16 v[96:99],v[40:41],v[68:69],v[96:99]
v_mfma_f32_16x16x16_bf16 v[100:103],v[42:43],v[68:69],v[100:103]
v_mfma_f32_16x16x16_bf16 v[104:107],v[44:45],v[68:69],v[104:107]
v_mfma_f32_16x16x16_bf16 v[108:111],v[46:47],v[68:69],v[108:111]
s_nop 0
v_cvt_pk_bf16_f32 v112,v80,v81
v_cvt_pk_bf16_f32 v113,v82,v83
v_cvt_pk_bf16_f32 v114,v84,v85
v_cvt_pk_bf16_f32 v115,v86,v87
buffer_store_dwordx4 v[112:115],v0,s[20:23],s66 offen offset:0 sc1
v_cvt_pk_bf16_f32 v116,v88,v89
v_cvt_pk_bf16_f32 v117,v90,v91
v_cvt_pk_bf16_f32 v118,v92,v93
v_cvt_pk_bf16_f32 v119,v94,v95
buffer_store_dwordx4 v[116:119],v0,s[20:23],s66 offen offset:1024 sc1
v_cvt_pk_bf16_f32 v112,v96,v97
v_cvt_pk_bf16_f32 v113,v98,v99
v_cvt_pk_bf16_f32 v114,v100,v101
v_cvt_pk_bf16_f32 v115,v102,v103
buffer_store_dwordx4 v[112:115],v0,s[20:23],s66 offen offset:2048 sc1
v_cvt_pk_bf16_f32 v116,v104,v105
v_cvt_pk_bf16_f32 v117,v106,v107
v_cvt_pk_bf16_f32 v118,v108,v109
v_cvt_pk_bf16_f32 v119,v110,v111
buffer_store_dwordx4 v[116:119],v0,s[20:23],s66 offen offset:3072 sc1
s_barrier
buffer_load_dwordx4 a[128:131],v0,s[20:23],s94 offen offset:0
buffer_load_dwordx4 a[132:135],v0,s[20:23],s94 offen offset:1024
buffer_load_dwordx4 a[136:139],v0,s[20:23],s94 offen offset:2048
buffer_load_dwordx4 a[140:143],v0,s[20:23],s94 offen offset:3072
buffer_load_dwordx4 a[144:147],v0,s[20:23],s95 offen offset:0
buffer_load_dwordx4 a[148:151],v0,s[20:23],s95 offen offset:1024
buffer_load_dwordx4 a[152:155],v0,s[20:23],s95 offen offset:2048
buffer_load_dwordx4 a[156:159],v0,s[20:23],s95 offen offset:3072
s_add_u32 s66,s66,262144
s_add_u32 s60,s60,2
s_add_u32 s72,s60,s54
s_waitcnt vmcnt(8)
v_mov_b32 v6,s72
s_mov_b64 exec,1
buffer_store_dword v6,off,s[20:23],s69 sc1
s_mov_b64 exec,-1
top1_362:
v_mfma_f32_16x16x32_bf16 v[48:51],a[96:99],a[80:83],0
v_mfma_f32_16x16x32_bf16 v[52:55],a[112:115],a[80:83],0
v_mfma_f32_16x16x32_bf16 v[48:51],a[100:103],a[84:87],v[48:51]
v_mfma_f32_16x16x32_bf16 v[52:55],a[116:119],a[84:87],v[52:55]
v_mfma_f32_16x16x32_bf16 v[48:51],a[104:107],a[88:91],v[48:51]
v_mfma_f32_16x16x32_bf16 v[52:55],a[120:123],a[88:91],v[52:55]
v_mfma_f32_16x16x32_bf16 v[48:51],a[108:111],a[92:95],v[48:51]
v_mfma_f32_16x16x32_bf16 v[52:55],a[124:127],a[92:95],v[52:55]
s_nop 6
v_cndmask_b32 v48,v7,v48,s[28:29]
v_cndmask_b32 v49,v7,v49,s[30:31]
v_cndmask_b32 v50,v7,v50,s[32:33]
v_cndmask_b32 v51,v7,v51,s[34:35]
v_cndmask_b32 v52,v7,v52,s[36:37]
v_cndmask_b32 v53,v7,v53,s[38:39]
v_cndmask_b32 v54,v7,v54,s[40:41]
v_cndmask_b32 v55,v7,v55,s[42:43]
v_max3_f32 v72,v48,v49,v50
v_max3_f32 v72,v72,v51,v52
v_max3_f32 v72,v72,v53,v54
v_max_f32 v72,v72,v55
s_add_u32 s64,s60,0
s_lshl_b32 s65,s64,11
s_and_b32 s65,s65,0x2000
s_xor_b32 s65,s65,s67
s_lshl_b32 s64,s64,19
s_add_u32 s64,s64,s65
s_add_u32 s98,s64,s53
s_add_u32 s98,s98,67108864
s_add_u32 s99,s98,16384
s_lshr_b32 s71,s60,1
s_add_u32 s71,s71,1
plp_365:
buffer_load_dword v5,v2,s[20:23],s68 offen sc1
s_waitcnt vmcnt(0)
v_cmp_gt_u32 vcc,s71,v5
s_cbranch_vccz pok_366
s_sleep 4
s_sub_u32 s90,s90,1
s_cmp_gt_i32 s90,0
s_cbranch_scc1 plp_365
pok_366:
buffer_load_dwordx4 v[16:19],v3,s[20:23],s98 offen offset:0
buffer_load_dwordx4 v[20:23],v3,s[20:23],s98 offen offset:128
buffer_load_dwordx4 v[24:27],v3,s[20:23],s99 offen offset:0
buffer_load_dwordx4 v[28:31],v3,s[20:23],s99 offen offset:128
buffer_load_dwordx4 v[32:35],v4,s[20:23],s98 offen offset:1024
buffer_load_dwordx4 v[36:39],v4,s[20:23],s98 offen offset:1536
buffer_load_dwordx4 v[40:43],v4,s[20:23],s99 offen offset:1024
buffer_load_dwordx4 v[44:47],v4,s[20:23],s99 offen offset:1536
s_barrier
s_cmp_lt_u32 s60,126
s_cbranch_scc1 pf_367
s_waitcnt vmcnt(0)
s_branch j1_368
pf_367:
s_add_u32 s64,s60,2
s_lshl_b32 s65,s64,11
s_and_b32 s65,s65,0x2000
s_xor_b32 s65,s65,s67
s_lshl_b32 s64,s64,19
s_add_u32 s64,s64,s65
s_add_u32 s92,s64,s53
s_add_u32 s93,s92,16384
s_add_u32 s94,s92,4096
s_add_u32 s95,s93,4096
s_xor_b32 s96,s92,s55
s_xor_b32 s97,s93,s55
buffer_load_dwordx4 a[0:3],v0,s[20:23],s96 offen offset:0
buffer_load_dwordx4 a[16:19],v0,s[20:23],s92 offen offset:0
buffer_load_dwordx4 a[32:35],v0,s[20:23],s92 offen offset:1024
buffer_load_dwordx4 a[4:7],v0,s[20:23],s96 offen offset:2048
buffer_load_dwordx4 a[20:23],v0,s[20:23],s92 offen offset:2048
buffer_load_dwordx4 a[36:39],v0,s[20:23],s92 offen offset:3072
buffer_load_dwordx4 a[8:11],v0,s[20:23],s97 offen offset:0
buffer_load_dwordx4 a[24:27],v0,s[20:23],s93 offen offset:0
buffer_load_dwordx4 a[40:43],v0,s[20:23],s93 offen offset:1024
buffer_load_dwordx4 a[12:15],v0,s[20:23],s97 offen offset:2048
buffer_load_dwordx4 a[28:31],v0,s[20:23],s93 offen offset:2048
buffer_load_dwordx4 a[44:47],v0,s[20:23],s93 offen offset:3072
j1_368:
s_waitcnt vmcnt(16)
v_mfma_f32_16x16x32_bf16 v[56:59],v[16:19],a[80:83],0
v_mfma_f32_16x16x32_bf16 v[56:59],v[20:23],a[84:87],v[56:59]
v_mfma_f32_16x16x32_bf16 v[56:59],v[24:27],a[88:91],v[56:59]
v_mfma_f32_16x16x32_bf16 v[56:59],v[28:31],a[92:95],v[56:59]
s_nop 7
v_cndmask_b32 v56,v7,v56,s[44:45]
v_cndmask_b32 v57,v7,v57,s[44:45]
v_cndmask_b32 v58,v7,v58,s[44:45]
v_cndmask_b32 v59,v7,v59,s[44:45]
v_max3_f32 v72,v72,v56,v57
v_max3_f32 v72,v72,v58,v59
v_mov_b32 v73,v72
s_nop 1
v_permlane16_swap_b32 v73,v72
v_max_f32 v72,v72,v73
v_mov_b32 v73,v72
s_nop 1
v_permlane32_swap_b32 v73,v72
v_max_f32 v72,v72,v73
v_mul_f32 v72,s80,v72
v_fma_f32 v48,v48,s80,-v72
v_fma_f32 v49,v49,s80,-v72
v_fma_f32 v50,v50,s80,-v72
v_fma_f32 v51,v51,s80,-v72
v_fma_f32 v52,v52,s80,-v72
v_fma_f32 v53,v53,s80,-v72
v_fma_f32 v54,v54,s80,-v72
v_fma_f32 v55,v55,s80,-v72
v_fma_f32 v56,v56,s80,-v72
v_fma_f32 v57,v57,s80,-v72
v_fma_f32 v58,v58,s80,-v72
v_fma_f32 v59,v59,s80,-v72
v_exp_f32 v48,v48
v_exp_f32 v49,v49
v_exp_f32 v50,v50
v_exp_f32 v51,v51
v_exp_f32 v52,v52
v_exp_f32 v53,v53
v_exp_f32 v54,v54
v_exp_f32 v55,v55
v_exp_f32 v56,v56
v_exp_f32 v57,v57
v_exp_f32 v58,v58
v_exp_f32 v59,v59
v_add_f32 v74,v48,v49
v_add_f32 v75,v50,v51
v_add_f32 v74,v74,v52
v_add_f32 v75,v75,v53
v_add_f32 v74,v74,v54
v_add_f32 v75,v75,v55
v_add_f32 v74,v74,v56
v_add_f32 v75,v75,v57
v_add_f32 v74,v74,v58
v_add_f32 v75,v75,v59
v_add_f32 v74,v74,v75
v_mov_b32 v73,v74
s_nop 1
v_permlane16_swap_b32 v73,v74
v_add_f32 v74,v74,v73
v_mov_b32 v73,v74
s_nop 1
v_permlane32_swap_b32 v73,v74
v_add_f32 v74,v74,v73
v_rcp_f32 v75,v74
s_nop 0
v_mul_f32 v48,v48,v75
v_mul_f32 v49,v49,v75
v_mul_f32 v50,v50,v75
v_mul_f32 v51,v51,v75
v_mul_f32 v52,v52,v75
v_mul_f32 v53,v53,v75
v_mul_f32 v54,v54,v75
v_mul_f32 v55,v55,v75
v_mul_f32 v56,v56,v75
v_mul_f32 v57,v57,v75
v_mul_f32 v58,v58,v75
v_mul_f32 v59,v59,v75
v_cvt_pk_bf16_f32 v64,v48,v49
v_cvt_pk_bf16_f32 v65,v50,v51
v_cvt_pk_bf16_f32 v66,v52,v53
v_cvt_pk_bf16_f32 v67,v54,v55
v_cvt_pk_bf16_f32 v68,v56,v57
v_cvt_pk_bf16_f32 v69,v58,v59
v_mfma_f32_16x16x32_bf16 v[80:83],a[128:131],v[64:67],0
v_mfma_f32_16x16x32_bf16 v[84:87],a[132:135],v[64:67],0
v_mfma_f32_16x16x32_bf16 v[88:91],a[136:139],v[64:67],0
v_mfma_f32_16x16x32_bf16 v[92:95],a[140:143],v[64:67],0
v_mfma_f32_16x16x32_bf16 v[96:99],a[144:147],v[64:67],0
v_mfma_f32_16x16x32_bf16 v[100:103],a[148:151],v[64:67],0
v_mfma_f32_16x16x32_bf16 v[104:107],a[152:155],v[64:67],0
v_mfma_f32_16x16x32_bf16 v[108:111],a[156:159],v[64:67],0
s_waitcnt vmcnt(12)
v_mfma_f32_16x16x16_bf16 v[80:83],v[32:33],v[68:69],v[80:83]
v_mfma_f32_16x16x16_bf16 v[84:87],v[34:35],v[68:69],v[84:87]
v_mfma_f32_16x16x16_bf16 v[88:91],v[36:37],v[68:69],v[88:91]
v_mfma_f32_16x16x16_bf16 v[92:95],v[38:39],v[68:69],v[92:95]
v_mfma_f32_16x16x16_bf16 v[96:99],v[40:41],v[68:69],v[96:99]
v_mfma_f32_16x16x16_bf16 v[100:103],v[42:43],v[68:69],v[100:103]
v_mfma_f32_16x16x16_bf16 v[104:107],v[44:45],v[68:69],v[104:107]
v_mfma_f32_16x16x16_bf16 v[108:111],v[46:47],v[68:69],v[108:111]
s_nop 0
v_cvt_pk_bf16_f32 v112,v80,v81
v_cvt_pk_bf16_f32 v113,v82,v83
v_cvt_pk_bf16_f32 v114,v84,v85
v_cvt_pk_bf16_f32 v115,v86,v87
buffer_store_dwordx4 v[112:115],v0,s[20:23],s66 offen offset:0 sc1
v_cvt_pk_bf16_f32 v116,v88,v89
v_cvt_pk_bf16_f32 v117,v90,v91
v_cvt_pk_bf16_f32 v118,v92,v93
v_cvt_pk_bf16_f32 v119,v94,v95
buffer_store_dwordx4 v[116:119],v0,s[20:23],s66 offen offset:1024 sc1
v_cvt_pk_bf16_f32 v112,v96,v97
v_cvt_pk_bf16_f32 v113,v98,v99
v_cvt_pk_bf16_f32 v114,v100,v101
v_cvt_pk_bf16_f32 v115,v102,v103
buffer_store_dwordx4 v[112:115],v0,s[20:23],s66 offen offset:2048 sc1
v_cvt_pk_bf16_f32 v116,v104,v105
v_cvt_pk_bf16_f32 v117,v106,v107
v_cvt_pk_bf16_f32 v118,v108,v109
v_cvt_pk_bf16_f32 v119,v110,v111
buffer_store_dwordx4 v[116:119],v0,s[20:23],s66 offen offset:3072 sc1
s_barrier
s_cmp_lt_u32 s60,126
s_cbranch_scc1 pf_369
s_waitcnt vmcnt(0)
s_branch j1_370
pf_369:
buffer_load_dwordx4 a[48:51],v0,s[20:23],s94 offen offset:0
buffer_load_dwordx4 a[52:55],v0,s[20:23],s94 offen offset:1024
buffer_load_dwordx4 a[56:59],v0,s[20:23],s94 offen offset:2048
buffer_load_dwordx4 a[60:63],v0,s[20:23],s94 offen offset:3072
buffer_load_dwordx4 a[64:67],v0,s[20:23],s95 offen offset:0
buffer_load_dwordx4 a[68:71],v0,s[20:23],s95 offen offset:1024
buffer_load_dwordx4 a[72:75],v0,s[20:23],s95 offen offset:2048
buffer_load_dwordx4 a[76:79],v0,s[20:23],s95 offen offset:3072
j1_370:
s_add_u32 s66,s66,262144
s_add_u32 s60,s60,2
s_add_u32 s72,s60,s54
s_waitcnt vmcnt(8)
v_mov_b32 v6,s72
s_mov_b64 exec,1
buffer_store_dword v6,off,s[20:23],s69 sc1
s_mov_b64 exec,-1
s_cmp_lt_u32 s60,128
s_cbranch_scc1 top0_361
s_endpgm
fl_rec:
s_load_dwordx8 s[4:11],s[0:1],8
s_load_dwordx2 s[12:13],s[0:1],40
s_mov_b32 s57,s58
v_mov_b32 v0,v1
s_waitcnt lgkmcnt(0)
s_mov_b32 s28,s6
s_and_b32 s29,s7,0xffff
s_mov_b32 s30,0x800000
s_mov_b32 s31,0x20000
s_mov_b32 s32,s8
s_and_b32 s33,s9,0xffff
s_mov_b32 s34,0x800000
s_mov_b32 s35,0x20000
s_mov_b32 s36,s10
s_and_b32 s37,s11,0xffff
s_mov_b32 s38,0x800000
s_mov_b32 s39,0x20000
s_mov_b32 s40,s12
s_and_b32 s41,s13,0xffff
s_mov_b32 s42,0x800000
s_mov_b32 s43,0x20000
s_mov_b32 s44,s4
s_and_b32 s45,s5,0xffff
s_mov_b32 s46,0x4000
s_mov_b32 s47,0x20000
s_lshr_b32 s58,s57,5
s_and_b32 s59,s57,31
v_and_b32 v20,63,v0
v_and_b32 v21,15,v20
v_lshrrev_b32 v22,4,v20
v_lshrrev_b32 v23,3,v20
v_and_b32 v24,7,v20
v_lshlrev_b32 v16,13,v23
v_lshl_add_u32 v16,v24,4,v16
v_lshrrev_b32 v23,2,v20
v_and_b32 v24,3,v20
v_lshlrev_b32 v17,11,v23
v_lshl_add_u32 v17,v24,4,v17
s_lshl_b32 s61,s50,15
s_add_u32 s61,s61,32768
s_lshl_b32 s62,s50,21
s_lshl_b32 s64,s57,7
s_add_u32 s62,s62,s64
s_lshl_b32 s63,s58,22
s_lshl_b32 s64,s50,20
s_add_u32 s63,s63,s64
s_lshl_b32 s64,s59,6
s_add_u32 s63,s63,s64
v_lshrrev_b32 v23,1,v22
v_lshlrev_b32 v25,4,v23
v_and_b32 v23,1,v22
v_lshl_add_u32 v25,v23,2,v25
v_lshrrev_b32 v23,3,v21
v_lshl_add_u32 v25,v23,3,v25
v_bfe_u32 v23,v21,2,1
v_add_u32 v25,v25,v23
v_lshlrev_b32 v28,4,v23
v_lshrrev_b32 v23,1,v22
v_lshl_add_u32 v28,v23,3,v28
v_lshrrev_b32 v23,3,v21
v_lshl_add_u32 v28,v23,2,v28
v_and_b32 v23,1,v22
v_lshl_add_u32 v28,v23,1,v28
v_and_b32 v24,3,v21
v_lshlrev_b32 v26,7,v28
v_add_u32 v26,s61,v26
v_lshl_add_u32 v18,v24,3,v26
v_lshl_add_u32 v19,v24,4,v26
v_lshlrev_b32 v26,6,v25
v_add_u32 v26,s61,v26
v_lshl_add_u32 v27,v24,3,v26
v_lshlrev_b32 v0,4,v20
v_add_u32 v7,s61,v0
s_and_b32 s64,s59,1
s_lshl_b32 s65,s64,18
s_add_u32 s70,s63,s65
s_sub_u32 s71,s63,s65
s_lshl_b32 s65,s64,13
s_add_u32 s72,s61,s65
s_sub_u32 s73,s61,s65
s_and_b32 s64,s57,7
s_lshl_b32 s65,s64,2
s_mov_b32 s66,0
s_lshl_b32 s65,s65,13
s_andn2_b32 s55,s57,7
s_lshl_b32 s55,s55,7
s_add_u32 s65,s65,s55
s_add_u32 s65,s65,384
v_and_b32 v29,3,v20
v_lshlrev_b32 v29,13,v29
v_add_u32 v29,s65,v29
v_and_b32 v15,4,v20
v_lshl_add_u32 v29,v15,4,v29
s_and_b32 s55,s57,31
s_add_u32 s66,s66,s55
s_lshl_b32 s66,s66,13
s_add_u32 s66,s66,8064
v_writelane_b32 v29,s66,8
s_add_u32 s66,s66,64
v_writelane_b32 v29,s66,9
s_cmp_eq_u32 s64,3
s_cselect_b32 s65,0,15
s_sub_u32 s66,s57,32
s_cmp_lt_u32 s66,31
s_cselect_b32 s66,256,0
s_or_b32 vcc_lo,s65,s66
s_mov_b32 vcc_hi,0
v_cndmask_b32 v29,-1,v29,vcc
s_lshl_b32 s68,s50,21
s_lshl_b32 s64,s58,22
s_lshl_b32 s65,s50,20
s_add_u32 s64,s64,s65
s_and_b32 s66,s59,15
s_lshl_b32 s65,s66,13
s_add_u32 s64,s64,s65
s_lshr_b32 s65,s59,4
s_lshl_b32 s65,s65,10
s_add_u32 s69,s64,s65
s_add_u32 s69,s69,384
s_lshr_b32 s66,s66,1
s_cmp_eq_u32 s66,3
s_cselect_b32 s65,0,4
v_and_b32 v30,3,v20
v_lshlrev_b32 v30,11,v30
v_and_b32 v31,4,v20
v_lshl_add_u32 v30,v31,4,v30
v_cmp_gt_u32 vcc,s65,v20
s_nop 1
v_cndmask_b32 v30,-1,v30,vcc
s_add_u32 s64,s68,262144
buffer_load_dword v31,v29,s[28:31],s64 offen
s_add_u32 s64,s68,524288
buffer_load_dword v31,v29,s[28:31],s64 offen
s_add_u32 s64,s68,786432
buffer_load_dword v31,v29,s[28:31],s64 offen
s_add_u32 s64,s62,0
s_add_u32 m0,s61,0
s_nop 0
buffer_load_dwordx4 v16,s[28:31],s64 offen lds
s_waitcnt vmcnt(10)
s_add_u32 s64,s62,65536
s_add_u32 m0,s61,1024
s_nop 0
buffer_load_dwordx4 v16,s[28:31],s64 offen lds
s_add_u32 s64,s68,1048576
buffer_load_dword v31,v29,s[28:31],s64 offen
s_waitcnt vmcnt(10)
s_add_u32 s64,s62,131072
s_add_u32 m0,s61,2048
s_nop 0
buffer_load_dwordx4 v16,s[28:31],s64 offen lds
s_waitcnt vmcnt(10)
s_add_u32 s64,s62,196608
s_add_u32 m0,s61,3072
s_nop 0
buffer_load_dwordx4 v16,s[28:31],s64 offen lds
s_waitcnt vmcnt(10)
s_add_u32 s64,s62,262144
s_add_u32 m0,s61,4096
s_nop 0
buffer_load_dwordx4 v16,s[28:31],s64 offen lds
s_waitcnt vmcnt(10)
s_add_u32 s64,s62,327680
s_add_u32 m0,s61,5120
s_nop 0
buffer_load_dwordx4 v16,s[28:31],s64 offen lds
s_add_u32 s64,s68,1310720
buffer_load_dword v31,v29,s[28:31],s64 offen
s_waitcnt vmcnt(10)
s_add_u32 s64,s62,393216
s_add_u32 m0,s61,6144
s_nop 0
buffer_load_dwordx4 v16,s[28:31],s64 offen lds
s_waitcnt vmcnt(10)
s_add_u32 s64,s62,458752
s_add_u32 m0,s61,7168
s_nop 0
buffer_load_dwordx4 v16,s[28:31],s64 offen lds
s_waitcnt vmcnt(10)
s_add_u32 s64,s62,524288
s_add_u32 m0,s61,8192
s_nop 0
buffer_load_dwordx4 v16,s[28:31],s64 offen lds
s_waitcnt vmcnt(10)
s_add_u32 s64,s62,589824
s_add_u32 m0,s61,9216
s_nop 0
buffer_load_dwordx4 v16,s[28:31],s64 offen lds
s_add_u32 s64,s68,1572864
buffer_load_dword v31,v29,s[28:31],s64 offen
s_waitcnt vmcnt(10)
s_add_u32 s64,s62,655360
s_add_u32 m0,s61,10240
s_nop 0
buffer_load_dwordx4 v16,s[28:31],s64 offen lds
s_waitcnt vmcnt(10)
s_add_u32 s64,s62,720896
s_add_u32 m0,s61,11264
s_nop 0
buffer_load_dwordx4 v16,s[28:31],s64 offen lds
s_waitcnt vmcnt(10)
s_add_u32 s64,s62,786432
s_add_u32 m0,s61,12288
s_nop 0
buffer_load_dwordx4 v16,s[28:31],s64 offen lds
s_waitcnt vmcnt(10)
s_add_u32 s64,s62,851968
s_add_u32 m0,s61,13312
s_nop 0
buffer_load_dwordx4 v16,s[28:31],s64 offen lds
s_add_u32 s64,s68,1835008
buffer_load_dword v31,v29,s[28:31],s64 offen
s_waitcnt vmcnt(10)
s_add_u32 s64,s62,917504
s_add_u32 m0,s61,14336
s_nop 0
buffer_load_dwordx4 v16,s[28:31],s64 offen lds
s_waitcnt vmcnt(10)
s_add_u32 s64,s62,983040
s_add_u32 m0,s61,15360
s_nop 0
buffer_load_dwordx4 v16,s[28:31],s64 offen lds
s_add_u32 s64,s62,1048576
s_add_u32 m0,s61,16384
s_nop 0
buffer_load_dwordx4 v16,s[28:31],s64 offen lds
s_waitcnt vmcnt(10)
s_add_u32 s64,s62,1114112
s_add_u32 m0,s61,17408
s_nop 0
buffer_load_dwordx4 v16,s[28:31],s64 offen lds
s_add_u32 s64,s68,0
buffer_load_dword v31,v29,s[32:35],s64 offen
s_waitcnt vmcnt(10)
s_add_u32 s64,s62,1179648
s_add_u32 m0,s61,18432
s_nop 0
buffer_load_dwordx4 v16,s[28:31],s64 offen lds
s_waitcnt vmcnt(10)
s_add_u32 s64,s62,1245184
s_add_u32 m0,s61,19456
s_nop 0
buffer_load_dwordx4 v16,s[28:31],s64 offen lds
s_waitcnt vmcnt(10)
s_add_u32 s64,s62,1310720
s_add_u32 m0,s61,20480
s_nop 0
buffer_load_dwordx4 v16,s[28:31],s64 offen lds
s_waitcnt vmcnt(10)
s_add_u32 s64,s62,1376256
s_add_u32 m0,s61,21504
s_nop 0
buffer_load_dwordx4 v16,s[28:31],s64 offen lds
s_add_u32 s64,s68,262144
buffer_load_dword v31,v29,s[32:35],s64 offen
s_waitcnt vmcnt(10)
s_add_u32 s64,s62,1441792
s_add_u32 m0,s61,22528
s_nop 0
buffer_load_dwordx4 v16,s[28:31],s64 offen lds
s_waitcnt vmcnt(10)
s_add_u32 s64,s62,1507328
s_add_u32 m0,s61,23552
s_nop 0
buffer_load_dwordx4 v16,s[28:31],s64 offen lds
s_waitcnt vmcnt(10)
s_add_u32 s64,s62,1572864
s_add_u32 m0,s61,24576
s_nop 0
buffer_load_dwordx4 v16,s[28:31],s64 offen lds
s_waitcnt vmcnt(10)
s_add_u32 s64,s62,1638400
s_add_u32 m0,s61,25600
s_nop 0
buffer_load_dwordx4 v16,s[28:31],s64 offen lds
s_add_u32 s64,s68,524288
buffer_load_dword v31,v29,s[32:35],s64 offen
s_waitcnt vmcnt(10)
s_add_u32 s64,s62,1703936
s_add_u32 m0,s61,26624
s_nop 0
buffer_load_dwordx4 v16,s[28:31],s64 offen lds
s_waitcnt vmcnt(10)
s_add_u32 s64,s62,1769472
s_add_u32 m0,s61,27648
s_nop 0
buffer_load_dwordx4 v16,s[28:31],s64 offen lds
s_waitcnt vmcnt(10)
s_add_u32 s64,s62,1835008
s_add_u32 m0,s61,28672
s_nop 0
buffer_load_dwordx4 v16,s[28:31],s64 offen lds
s_waitcnt vmcnt(10)
s_add_u32 s64,s62,1900544
s_add_u32 m0,s61,29696
s_nop 0
buffer_load_dwordx4 v16,s[28:31],s64 offen lds
s_add_u32 s64,s68,786432
buffer_load_dword v31,v29,s[32:35],s64 offen
s_waitcnt vmcnt(10)
s_add_u32 s64,s62,1966080
s_add_u32 m0,s61,30720
s_nop 0
buffer_load_dwordx4 v16,s[28:31],s64 offen lds
s_waitcnt vmcnt(10)
s_add_u32 s64,s62,2031616
s_add_u32 m0,s61,31744
s_nop 0
buffer_load_dwordx4 v16,s[28:31],s64 offen lds
s_waitcnt vmcnt(20)
ds_read_b64_tr_b16 a[0:1],v18 offset:0
ds_read_b64_tr_b16 a[2:3],v18 offset:128
ds_read_b64_tr_b16 a[4:5],v18 offset:4096
ds_read_b64_tr_b16 a[6:7],v18 offset:4224
ds_read_b64_tr_b16 a[8:9],v18 offset:32
ds_read_b64_tr_b16 a[10:11],v18 offset:160
ds_read_b64_tr_b16 a[12:13],v18 offset:4128
ds_read_b64_tr_b16 a[14:15],v18 offset:4256
ds_read_b64_tr_b16 a[16:17],v18 offset:64
ds_read_b64_tr_b16 a[18:19],v18 offset:192
ds_read_b64_tr_b16 a[20:21],v18 offset:4160
ds_read_b64_tr_b16 a[22:23],v18 offset:4288
ds_read_b64_tr_b16 a[24:25],v18 offset:96
ds_read_b64_tr_b16 a[26:27],v18 offset:224
ds_read_b64_tr_b16 a[28:29],v18 offset:4192
ds_read_b64_tr_b16 a[30:31],v18 offset:4320
s_waitcnt lgkmcnt(0)
ds_read_b64_tr_b16 a[64:65],v18 offset:8192
ds_read_b64_tr_b16 a[66:67],v18 offset:8320
ds_read_b64_tr_b16 a[68:69],v18 offset:12288
ds_read_b64_tr_b16 a[70:71],v18 offset:12416
ds_read_b64_tr_b16 a[72:73],v18 offset:8224
ds_read_b64_tr_b16 a[74:75],v18 offset:8352
ds_read_b64_tr_b16 a[76:77],v18 offset:12320
ds_read_b64_tr_b16 a[78:79],v18 offset:12448
ds_read_b64_tr_b16 a[80:81],v18 offset:8256
ds_read_b64_tr_b16 a[82:83],v18 offset:8384
ds_read_b64_tr_b16 a[84:85],v18 offset:12352
ds_read_b64_tr_b16 a[86:87],v18 offset:12480
ds_read_b64_tr_b16 a[88:89],v18 offset:8288
ds_read_b64_tr_b16 a[90:91],v18 offset:8416
ds_read_b64_tr_b16 a[92:93],v18 offset:12384
ds_read_b64_tr_b16 a[94:95],v18 offset:12512
s_waitcnt lgkmcnt(0)
s_add_u32 s64,s62,0
s_add_u32 m0,s61,0
s_nop 0
buffer_load_dwordx4 v16,s[32:35],s64 offen lds
s_waitcnt vmcnt(10)
s_add_u32 s64,s62,65536
s_add_u32 m0,s61,1024
s_nop 0
buffer_load_dwordx4 v16,s[32:35],s64 offen lds
s_add_u32 s64,s68,1048576
buffer_load_dword v31,v29,s[32:35],s64 offen
s_waitcnt vmcnt(10)
s_add_u32 s64,s62,131072
s_add_u32 m0,s61,2048
s_nop 0
buffer_load_dwordx4 v16,s[32:35],s64 offen lds
s_waitcnt vmcnt(10)
s_add_u32 s64,s62,196608
s_add_u32 m0,s61,3072
s_nop 0
buffer_load_dwordx4 v16,s[32:35],s64 offen lds
s_waitcnt vmcnt(10)
s_add_u32 s64,s62,262144
s_add_u32 m0,s61,4096
s_nop 0
buffer_load_dwordx4 v16,s[32:35],s64 offen lds
s_waitcnt vmcnt(10)
s_add_u32 s64,s62,327680
s_add_u32 m0,s61,5120
s_nop 0
buffer_load_dwordx4 v16,s[32:35],s64 offen lds
s_add_u32 s64,s68,1310720
buffer_load_dword v31,v29,s[32:35],s64 offen
s_waitcnt vmcnt(10)
s_add_u32 s64,s62,393216
s_add_u32 m0,s61,6144
s_nop 0
buffer_load_dwordx4 v16,s[32:35],s64 offen lds
s_waitcnt vmcnt(10)
s_add_u32 s64,s62,458752
s_add_u32 m0,s61,7168
s_nop 0
buffer_load_dwordx4 v16,s[32:35],s64 offen lds
s_waitcnt vmcnt(10)
s_add_u32 s64,s62,524288
s_add_u32 m0,s61,8192
s_nop 0
buffer_load_dwordx4 v16,s[32:35],s64 offen lds
s_waitcnt vmcnt(10)
s_add_u32 s64,s62,589824
s_add_u32 m0,s61,9216
s_nop 0
buffer_load_dwordx4 v16,s[32:35],s64 offen lds
s_add_u32 s64,s68,1572864
buffer_load_dword v31,v29,s[32:35],s64 offen
s_waitcnt vmcnt(10)
s_add_u32 s64,s62,655360
s_add_u32 m0,s61,10240
s_nop 0
buffer_load_dwordx4 v16,s[32:35],s64 offen lds
s_waitcnt vmcnt(10)
s_add_u32 s64,s62,720896
s_add_u32 m0,s61,11264
s_nop 0
buffer_load_dwordx4 v16,s[32:35],s64 offen lds
s_waitcnt vmcnt(10)
s_add_u32 s64,s62,786432
s_add_u32 m0,s61,12288
s_nop 0
buffer_load_dwordx4 v16,s[32:35],s64 offen lds
s_waitcnt vmcnt(10)
s_add_u32 s64,s62,851968
s_add_u32 m0,s61,13312
s_nop 0
buffer_load_dwordx4 v16,s[32:35],s64 offen lds
s_add_u32 s64,s68,1835008
buffer_load_dword v31,v29,s[32:35],s64 offen
s_waitcnt vmcnt(10)
s_add_u32 s64,s62,917504
s_add_u32 m0,s61,14336
s_nop 0
buffer_load_dwordx4 v16,s[32:35],s64 offen lds
s_waitcnt vmcnt(10)
s_add_u32 s64,s62,983040
s_add_u32 m0,s61,15360
s_nop 0
buffer_load_dwordx4 v16,s[32:35],s64 offen lds
s_waitcnt vmcnt(20)
ds_read_b64_tr_b16 a[128:129],v18 offset:16384
ds_read_b64_tr_b16 a[130:131],v18 offset:16512
ds_read_b64_tr_b16 a[132:133],v18 offset:20480
ds_read_b64_tr_b16 a[134:135],v18 offset:20608
ds_read_b64_tr_b16 a[136:137],v18 offset:16416
ds_read_b64_tr_b16 a[138:139],v18 offset:16544
ds_read_b64_tr_b16 a[140:141],v18 offset:20512
ds_read_b64_tr_b16 a[142:143],v18 offset:20640
ds_read_b64_tr_b16 a[144:145],v18 offset:16448
ds_read_b64_tr_b16 a[146:147],v18 offset:16576
ds_read_b64_tr_b16 a[148:149],v18 offset:20544
ds_read_b64_tr_b16 a[150:151],v18 offset:20672
ds_read_b64_tr_b16 a[152:153],v18 offset:16480
ds_read_b64_tr_b16 a[154:155],v18 offset:16608
ds_read_b64_tr_b16 a[156:157],v18 offset:20576
ds_read_b64_tr_b16 a[158:159],v18 offset:20704
s_waitcnt lgkmcnt(0)
ds_read_b64_tr_b16 a[192:193],v18 offset:24576
ds_read_b64_tr_b16 a[194:195],v18 offset:24704
ds_read_b64_tr_b16 a[196:197],v18 offset:28672
ds_read_b64_tr_b16 a[198:199],v18 offset:28800
ds_read_b64_tr_b16 a[200:201],v18 offset:24608
ds_read_b64_tr_b16 a[202:203],v18 offset:24736
ds_read_b64_tr_b16 a[204:205],v18 offset:28704
ds_read_b64_tr_b16 a[206:207],v18 offset:28832
ds_read_b64_tr_b16 a[208:209],v18 offset:24640
ds_read_b64_tr_b16 a[210:211],v18 offset:24768
ds_read_b64_tr_b16 a[212:213],v18 offset:28736
ds_read_b64_tr_b16 a[214:215],v18 offset:28864
ds_read_b64_tr_b16 a[216:217],v18 offset:24672
ds_read_b64_tr_b16 a[218:219],v18 offset:24800
ds_read_b64_tr_b16 a[220:221],v18 offset:28768
ds_read_b64_tr_b16 a[222:223],v18 offset:28896
s_waitcnt lgkmcnt(0)
s_add_u32 s64,s62,1048576
s_add_u32 m0,s61,16384
s_nop 0
buffer_load_dwordx4 v16,s[32:35],s64 offen lds
s_waitcnt vmcnt(10)
s_add_u32 s64,s62,1114112
s_add_u32 m0,s61,17408
s_nop 0
buffer_load_dwordx4 v16,s[32:35],s64 offen lds
s_add_u32 s64,s69,0
buffer_load_dword v31,v30,s[40:43],s64 offen
s_waitcnt vmcnt(10)
s_add_u32 s64,s62,1179648
s_add_u32 m0,s61,18432
s_nop 0
buffer_load_dwordx4 v16,s[32:35],s64 offen lds
s_waitcnt vmcnt(10)
s_add_u32 s64,s62,1245184
s_add_u32 m0,s61,19456
s_nop 0
buffer_load_dwordx4 v16,s[32:35],s64 offen lds
s_waitcnt vmcnt(10)
s_add_u32 s64,s62,1310720
s_add_u32 m0,s61,20480
s_nop 0
buffer_load_dwordx4 v16,s[32:35],s64 offen lds
s_waitcnt vmcnt(10)
s_add_u32 s64,s62,1376256
s_add_u32 m0,s61,21504
s_nop 0
buffer_load_dwordx4 v16,s[32:35],s64 offen lds
s_add_u32 s64,s69,131072
buffer_load_dword v31,v30,s[40:43],s64 offen
s_waitcnt vmcnt(10)
s_add_u32 s64,s62,1441792
s_add_u32 m0,s61,22528
s_nop 0
buffer_load_dwordx4 v16,s[32:35],s64 offen lds
s_waitcnt vmcnt(10)
s_add_u32 s64,s62,1507328
s_add_u32 m0,s61,23552
s_nop 0
buffer_load_dwordx4 v16,s[32:35],s64 offen lds
s_waitcnt vmcnt(10)
s_add_u32 s64,s62,1572864
s_add_u32 m0,s61,24576
s_nop 0
buffer_load_dwordx4 v16,s[32:35],s64 offen lds
s_waitcnt vmcnt(10)
s_add_u32 s64,s62,1638400
s_add_u32 m0,s61,25600
s_nop 0
buffer_load_dwordx4 v16,s[32:35],s64 offen lds
s_add_u32 s64,s69,262144
buffer_load_dword v31,v30,s[40:43],s64 offen
s_waitcnt vmcnt(10)
s_add_u32 s64,s62,1703936
s_add_u32 m0,s61,26624
s_nop 0
buffer_load_dwordx4 v16,s[32:35],s64 offen lds
s_waitcnt vmcnt(10)
s_add_u32 s64,s62,1769472
s_add_u32 m0,s61,27648
s_nop 0
buffer_load_dwordx4 v16,s[32:35],s64 offen lds
s_waitcnt vmcnt(10)
s_add_u32 s64,s62,1835008
s_add_u32 m0,s61,28672
s_nop 0
buffer_load_dwordx4 v16,s[32:35],s64 offen lds
s_waitcnt vmcnt(10)
s_add_u32 s64,s62,1900544
s_add_u32 m0,s61,29696
s_nop 0
buffer_load_dwordx4 v16,s[32:35],s64 offen lds
s_add_u32 s64,s69,393216
buffer_load_dword v31,v30,s[40:43],s64 offen
s_waitcnt vmcnt(10)
s_add_u32 s64,s62,1966080
s_add_u32 m0,s61,30720
s_nop 0
buffer_load_dwordx4 v16,s[32:35],s64 offen lds
s_waitcnt vmcnt(10)
s_add_u32 s64,s62,2031616
s_add_u32 m0,s61,31744
s_nop 0
buffer_load_dwordx4 v16,s[32:35],s64 offen lds
s_waitcnt vmcnt(20)
ds_read_b64_tr_b16 a[32:33],v18 offset:0
ds_read_b64_tr_b16 a[34:35],v18 offset:128
ds_read_b64_tr_b16 a[36:37],v18 offset:4096
ds_read_b64_tr_b16 a[38:39],v18 offset:4224
ds_read_b64_tr_b16 a[40:41],v18 offset:32
ds_read_b64_tr_b16 a[42:43],v18 offset:160
ds_read_b64_tr_b16 a[44:45],v18 offset:4128
ds_read_b64_tr_b16 a[46:47],v18 offset:4256
ds_read_b64_tr_b16 a[48:49],v18 offset:64
ds_read_b64_tr_b16 a[50:51],v18 offset:192
ds_read_b64_tr_b16 a[52:53],v18 offset:4160
ds_read_b64_tr_b16 a[54:55],v18 offset:4288
ds_read_b64_tr_b16 a[56:57],v18 offset:96
ds_read_b64_tr_b16 a[58:59],v18 offset:224
ds_read_b64_tr_b16 a[60:61],v18 offset:4192
ds_read_b64_tr_b16 a[62:63],v18 offset:4320
s_waitcnt lgkmcnt(0)
ds_read_b64_tr_b16 a[96:97],v18 offset:8192
ds_read_b64_tr_b16 a[98:99],v18 offset:8320
ds_read_b64_tr_b16 a[100:101],v18 offset:12288
ds_read_b64_tr_b16 a[102:103],v18 offset:12416
ds_read_b64_tr_b16 a[104:105],v18 offset:8224
ds_read_b64_tr_b16 a[106:107],v18 offset:8352
ds_read_b64_tr_b16 a[108:109],v18 offset:12320
ds_read_b64_tr_b16 a[110:111],v18 offset:12448
ds_read_b64_tr_b16 a[112:113],v18 offset:8256
ds_read_b64_tr_b16 a[114:115],v18 offset:8384
ds_read_b64_tr_b16 a[116:117],v18 offset:12352
ds_read_b64_tr_b16 a[118:119],v18 offset:12480
ds_read_b64_tr_b16 a[120:121],v18 offset:8288
ds_read_b64_tr_b16 a[122:123],v18 offset:8416
ds_read_b64_tr_b16 a[124:125],v18 offset:12384
ds_read_b64_tr_b16 a[126:127],v18 offset:12512
s_waitcnt lgkmcnt(0)
s_add_u32 s64,s70,0
s_add_u32 m0,s72,0
s_nop 0
buffer_load_dwordx4 v17,s[40:43],s64 offen lds
s_waitcnt vmcnt(10)
s_add_u32 s64,s70,32768
s_add_u32 m0,s72,1024
s_nop 0
buffer_load_dwordx4 v17,s[40:43],s64 offen lds
s_add_u32 s64,s69,524288
buffer_load_dword v31,v30,s[40:43],s64 offen
s_waitcnt vmcnt(10)
s_add_u32 s64,s70,65536
s_add_u32 m0,s72,2048
s_nop 0
buffer_load_dwordx4 v17,s[40:43],s64 offen lds
s_waitcnt vmcnt(10)
s_add_u32 s64,s70,98304
s_add_u32 m0,s72,3072
s_nop 0
buffer_load_dwordx4 v17,s[40:43],s64 offen lds
s_waitcnt vmcnt(10)
s_add_u32 s64,s70,131072
s_add_u32 m0,s72,4096
s_nop 0
buffer_load_dwordx4 v17,s[40:43],s64 offen lds
s_waitcnt vmcnt(10)
s_add_u32 s64,s70,163840
s_add_u32 m0,s72,5120
s_nop 0
buffer_load_dwordx4 v17,s[40:43],s64 offen lds
s_add_u32 s64,s69,655360
buffer_load_dword v31,v30,s[40:43],s64 offen
s_waitcnt vmcnt(10)
s_add_u32 s64,s70,196608
s_add_u32 m0,s72,6144
s_nop 0
buffer_load_dwordx4 v17,s[40:43],s64 offen lds
s_waitcnt vmcnt(10)
s_add_u32 s64,s70,229376
s_add_u32 m0,s72,7168
s_nop 0
buffer_load_dwordx4 v17,s[40:43],s64 offen lds
s_waitcnt vmcnt(10)
s_add_u32 s64,s71,262144
s_add_u32 m0,s73,8192
s_nop 0
buffer_load_dwordx4 v17,s[40:43],s64 offen lds
s_waitcnt vmcnt(10)
s_add_u32 s64,s71,294912
s_add_u32 m0,s73,9216
s_nop 0
buffer_load_dwordx4 v17,s[40:43],s64 offen lds
s_add_u32 s64,s69,786432
buffer_load_dword v31,v30,s[40:43],s64 offen
s_waitcnt vmcnt(10)
s_add_u32 s64,s71,327680
s_add_u32 m0,s73,10240
s_nop 0
buffer_load_dwordx4 v17,s[40:43],s64 offen lds
s_waitcnt vmcnt(10)
s_add_u32 s64,s71,360448
s_add_u32 m0,s73,11264
s_nop 0
buffer_load_dwordx4 v17,s[40:43],s64 offen lds
s_waitcnt vmcnt(10)
s_add_u32 s64,s71,393216
s_add_u32 m0,s73,12288
s_nop 0
buffer_load_dwordx4 v17,s[40:43],s64 offen lds
s_waitcnt vmcnt(10)
s_add_u32 s64,s71,425984
s_add_u32 m0,s73,13312
s_nop 0
buffer_load_dwordx4 v17,s[40:43],s64 offen lds
s_add_u32 s64,s69,917504
buffer_load_dword v31,v30,s[40:43],s64 offen
s_waitcnt vmcnt(10)
s_add_u32 s64,s71,458752
s_add_u32 m0,s73,14336
s_nop 0
buffer_load_dwordx4 v17,s[40:43],s64 offen lds
s_waitcnt vmcnt(10)
s_add_u32 s64,s71,491520
s_add_u32 m0,s73,15360
s_nop 0
buffer_load_dwordx4 v17,s[40:43],s64 offen lds
s_waitcnt vmcnt(20)
ds_read_b64_tr_b16 a[160:161],v18 offset:16384
ds_read_b64_tr_b16 a[162:163],v18 offset:16512
ds_read_b64_tr_b16 a[164:165],v18 offset:20480
ds_read_b64_tr_b16 a[166:167],v18 offset:20608
ds_read_b64_tr_b16 a[168:169],v18 offset:16416
ds_read_b64_tr_b16 a[170:171],v18 offset:16544
ds_read_b64_tr_b16 a[172:173],v18 offset:20512
ds_read_b64_tr_b16 a[174:175],v18 offset:20640
ds_read_b64_tr_b16 a[176:177],v18 offset:16448
ds_read_b64_tr_b16 a[178:179],v18 offset:16576
ds_read_b64_tr_b16 a[180:181],v18 offset:20544
ds_read_b64_tr_b16 a[182:183],v18 offset:20672
ds_read_b64_tr_b16 a[184:185],v18 offset:16480
ds_read_b64_tr_b16 a[186:187],v18 offset:16608
ds_read_b64_tr_b16 a[188:189],v18 offset:20576
ds_read_b64_tr_b16 a[190:191],v18 offset:20704
s_waitcnt lgkmcnt(0)
ds_read_b64_tr_b16 a[224:225],v18 offset:24576
ds_read_b64_tr_b16 a[226:227],v18 offset:24704
ds_read_b64_tr_b16 a[228:229],v18 offset:28672
ds_read_b64_tr_b16 a[230:231],v18 offset:28800
ds_read_b64_tr_b16 a[232:233],v18 offset:24608
ds_read_b64_tr_b16 a[234:235],v18 offset:24736
ds_read_b64_tr_b16 a[236:237],v18 offset:28704
ds_read_b64_tr_b16 a[238:239],v18 offset:28832
ds_read_b64_tr_b16 a[240:241],v18 offset:24640
ds_read_b64_tr_b16 a[242:243],v18 offset:24768
ds_read_b64_tr_b16 a[244:245],v18 offset:28736
ds_read_b64_tr_b16 a[246:247],v18 offset:28864
ds_read_b64_tr_b16 a[248:249],v18 offset:24672
ds_read_b64_tr_b16 a[250:251],v18 offset:24800
ds_read_b64_tr_b16 a[252:253],v18 offset:28768
ds_read_b64_tr_b16 a[254:255],v18 offset:28896
s_waitcnt lgkmcnt(0)
s_add_u32 s64,s70,524288
s_add_u32 m0,s72,16384
s_nop 0
buffer_load_dwordx4 v17,s[40:43],s64 offen lds
s_waitcnt vmcnt(10)
s_add_u32 s64,s70,557056
s_add_u32 m0,s72,17408
s_nop 0
buffer_load_dwordx4 v17,s[40:43],s64 offen lds
s_add_u32 s64,s68,0
buffer_load_dword v31,v29,s[36:39],s64 offen
s_waitcnt vmcnt(10)
s_add_u32 s64,s70,589824
s_add_u32 m0,s72,18432
s_nop 0
buffer_load_dwordx4 v17,s[40:43],s64 offen lds
s_waitcnt vmcnt(10)
s_add_u32 s64,s70,622592
s_add_u32 m0,s72,19456
s_nop 0
buffer_load_dwordx4 v17,s[40:43],s64 offen lds
s_waitcnt vmcnt(10)
s_add_u32 s64,s70,655360
s_add_u32 m0,s72,20480
s_nop 0
buffer_load_dwordx4 v17,s[40:43],s64 offen lds
s_waitcnt vmcnt(10)
s_add_u32 s64,s70,688128
s_add_u32 m0,s72,21504
s_nop 0
buffer_load_dwordx4 v17,s[40:43],s64 offen lds
s_add_u32 s64,s68,262144
buffer_load_dword v31,v29,s[36:39],s64 offen
s_waitcnt vmcnt(10)
s_add_u32 s64,s70,720896
s_add_u32 m0,s72,22528
s_nop 0
buffer_load_dwordx4 v17,s[40:43],s64 offen lds
s_waitcnt vmcnt(10)
s_add_u32 s64,s70,753664
s_add_u32 m0,s72,23552
s_nop 0
buffer_load_dwordx4 v17,s[40:43],s64 offen lds
s_waitcnt vmcnt(10)
s_add_u32 s64,s71,786432
s_add_u32 m0,s73,24576
s_nop 0
buffer_load_dwordx4 v17,s[40:43],s64 offen lds
s_waitcnt vmcnt(10)
s_add_u32 s64,s71,819200
s_add_u32 m0,s73,25600
s_nop 0
buffer_load_dwordx4 v17,s[40:43],s64 offen lds
s_add_u32 s64,s68,524288
buffer_load_dword v31,v29,s[36:39],s64 offen
s_waitcnt vmcnt(10)
s_add_u32 s64,s71,851968
s_add_u32 m0,s73,26624
s_nop 0
buffer_load_dwordx4 v17,s[40:43],s64 offen lds
s_waitcnt vmcnt(10)
s_add_u32 s64,s71,884736
s_add_u32 m0,s73,27648
s_nop 0
buffer_load_dwordx4 v17,s[40:43],s64 offen lds
s_waitcnt vmcnt(10)
s_add_u32 s64,s71,917504
s_add_u32 m0,s73,28672
s_nop 0
buffer_load_dwordx4 v17,s[40:43],s64 offen lds
s_waitcnt vmcnt(10)
s_add_u32 s64,s71,950272
s_add_u32 m0,s73,29696
s_nop 0
buffer_load_dwordx4 v17,s[40:43],s64 offen lds
s_add_u32 s64,s68,786432
buffer_load_dword v31,v29,s[36:39],s64 offen
s_waitcnt vmcnt(10)
s_add_u32 s64,s71,983040
s_add_u32 m0,s73,30720
s_nop 0
buffer_load_dwordx4 v17,s[40:43],s64 offen lds
s_waitcnt vmcnt(10)
s_add_u32 s64,s71,1015808
s_add_u32 m0,s73,31744
s_nop 0
buffer_load_dwordx4 v17,s[40:43],s64 offen lds
s_waitcnt vmcnt(20)
ds_read_b64_tr_b16 v[48:49],v27 offset:0
ds_read_b64_tr_b16 v[50:51],v27 offset:128
ds_read_b64_tr_b16 v[52:53],v27 offset:2048
ds_read_b64_tr_b16 v[54:55],v27 offset:2176
ds_read_b64_tr_b16 v[56:57],v27 offset:32
ds_read_b64_tr_b16 v[58:59],v27 offset:160
ds_read_b64_tr_b16 v[60:61],v27 offset:2080
ds_read_b64_tr_b16 v[62:63],v27 offset:2208
ds_read_b64_tr_b16 v[64:65],v27 offset:4096
ds_read_b64_tr_b16 v[66:67],v27 offset:4224
ds_read_b64_tr_b16 v[68:69],v27 offset:6144
ds_read_b64_tr_b16 v[70:71],v27 offset:6272
ds_read_b64_tr_b16 v[72:73],v27 offset:4128
ds_read_b64_tr_b16 v[74:75],v27 offset:4256
ds_read_b64_tr_b16 v[76:77],v27 offset:6176
ds_read_b64_tr_b16 v[78:79],v27 offset:6304
s_waitcnt lgkmcnt(0)
ds_read_b64_tr_b16 v[80:81],v27 offset:8192
ds_read_b64_tr_b16 v[82:83],v27 offset:8320
ds_read_b64_tr_b16 v[84:85],v27 offset:10240
ds_read_b64_tr_b16 v[86:87],v27 offset:10368
ds_read_b64_tr_b16 v[88:89],v27 offset:8224
ds_read_b64_tr_b16 v[90:91],v27 offset:8352
ds_read_b64_tr_b16 v[92:93],v27 offset:10272
ds_read_b64_tr_b16 v[94:95],v27 offset:10400
ds_read_b64_tr_b16 v[128:129],v27 offset:12288
ds_read_b64_tr_b16 v[130:131],v27 offset:12416
ds_read_b64_tr_b16 v[132:133],v27 offset:14336
ds_read_b64_tr_b16 v[134:135],v27 offset:14464
ds_read_b64_tr_b16 v[136:137],v27 offset:12320
ds_read_b64_tr_b16 v[138:139],v27 offset:12448
ds_read_b64_tr_b16 v[140:141],v27 offset:14368
ds_read_b64_tr_b16 v[142:143],v27 offset:14496
s_waitcnt lgkmcnt(0)
s_add_u32 s64,s62,0
s_add_u32 m0,s61,0
s_nop 0
buffer_load_dwordx4 v16,s[36:39],s64 offen lds
s_waitcnt vmcnt(10)
s_add_u32 s64,s62,65536
s_add_u32 m0,s61,1024
s_nop 0
buffer_load_dwordx4 v16,s[36:39],s64 offen lds
s_add_u32 s64,s68,1048576
buffer_load_dword v31,v29,s[36:39],s64 offen
s_waitcnt vmcnt(10)
s_add_u32 s64,s62,131072
s_add_u32 m0,s61,2048
s_nop 0
buffer_load_dwordx4 v16,s[36:39],s64 offen lds
s_waitcnt vmcnt(10)
s_add_u32 s64,s62,196608
s_add_u32 m0,s61,3072
s_nop 0
buffer_load_dwordx4 v16,s[36:39],s64 offen lds
s_waitcnt vmcnt(10)
s_add_u32 s64,s62,262144
s_add_u32 m0,s61,4096
s_nop 0
buffer_load_dwordx4 v16,s[36:39],s64 offen lds
s_waitcnt vmcnt(10)
s_add_u32 s64,s62,327680
s_add_u32 m0,s61,5120
s_nop 0
buffer_load_dwordx4 v16,s[36:39],s64 offen lds
s_add_u32 s64,s68,1310720
buffer_load_dword v31,v29,s[36:39],s64 offen
s_waitcnt vmcnt(10)
s_add_u32 s64,s62,393216
s_add_u32 m0,s61,6144
s_nop 0
buffer_load_dwordx4 v16,s[36:39],s64 offen lds
s_waitcnt vmcnt(10)
s_add_u32 s64,s62,458752
s_add_u32 m0,s61,7168
s_nop 0
buffer_load_dwordx4 v16,s[36:39],s64 offen lds
s_waitcnt vmcnt(10)
s_add_u32 s64,s62,524288
s_add_u32 m0,s61,8192
s_nop 0
buffer_load_dwordx4 v16,s[36:39],s64 offen lds
s_waitcnt vmcnt(10)
s_add_u32 s64,s62,589824
s_add_u32 m0,s61,9216
s_nop 0
buffer_load_dwordx4 v16,s[36:39],s64 offen lds
s_add_u32 s64,s68,1572864
buffer_load_dword v31,v29,s[36:39],s64 offen
s_waitcnt vmcnt(10)
s_add_u32 s64,s62,655360
s_add_u32 m0,s61,10240
s_nop 0
buffer_load_dwordx4 v16,s[36:39],s64 offen lds
s_waitcnt vmcnt(10)
s_add_u32 s64,s62,720896
s_add_u32 m0,s61,11264
s_nop 0
buffer_load_dwordx4 v16,s[36:39],s64 offen lds
s_waitcnt vmcnt(10)
s_add_u32 s64,s62,786432
s_add_u32 m0,s61,12288
s_nop 0
buffer_load_dwordx4 v16,s[36:39],s64 offen lds
s_waitcnt vmcnt(10)
s_add_u32 s64,s62,851968
s_add_u32 m0,s61,13312
s_nop 0
buffer_load_dwordx4 v16,s[36:39],s64 offen lds
s_add_u32 s64,s68,1835008
buffer_load_dword v31,v29,s[36:39],s64 offen
s_waitcnt vmcnt(10)
s_add_u32 s64,s62,917504
s_add_u32 m0,s61,14336
s_nop 0
buffer_load_dwordx4 v16,s[36:39],s64 offen lds
s_waitcnt vmcnt(10)
s_add_u32 s64,s62,983040
s_add_u32 m0,s61,15360
s_nop 0
buffer_load_dwordx4 v16,s[36:39],s64 offen lds
s_waitcnt vmcnt(20)
ds_read_b64_tr_b16 v[144:145],v27 offset:16384
ds_read_b64_tr_b16 v[146:147],v27 offset:16512
ds_read_b64_tr_b16 v[148:149],v27 offset:18432
ds_read_b64_tr_b16 v[150:151],v27 offset:18560
ds_read_b64_tr_b16 v[152:153],v27 offset:16416
ds_read_b64_tr_b16 v[154:155],v27 offset:16544
ds_read_b64_tr_b16 v[156:157],v27 offset:18464
ds_read_b64_tr_b16 v[158:159],v27 offset:18592
ds_read_b64_tr_b16 v[160:161],v27 offset:20480
ds_read_b64_tr_b16 v[162:163],v27 offset:20608
ds_read_b64_tr_b16 v[164:165],v27 offset:22528
ds_read_b64_tr_b16 v[166:167],v27 offset:22656
ds_read_b64_tr_b16 v[168:169],v27 offset:20512
ds_read_b64_tr_b16 v[170:171],v27 offset:20640
ds_read_b64_tr_b16 v[172:173],v27 offset:22560
ds_read_b64_tr_b16 v[174:175],v27 offset:22688
s_waitcnt lgkmcnt(0)
ds_read_b64_tr_b16 v[176:177],v27 offset:24576
ds_read_b64_tr_b16 v[178:179],v27 offset:24704
ds_read_b64_tr_b16 v[180:181],v27 offset:26624
ds_read_b64_tr_b16 v[182:183],v27 offset:26752
ds_read_b64_tr_b16 v[184:185],v27 offset:24608
ds_read_b64_tr_b16 v[186:187],v27 offset:24736
ds_read_b64_tr_b16 v[188:189],v27 offset:26656
ds_read_b64_tr_b16 v[190:191],v27 offset:26784
ds_read_b64_tr_b16 v[192:193],v27 offset:28672
ds_read_b64_tr_b16 v[194:195],v27 offset:28800
ds_read_b64_tr_b16 v[196:197],v27 offset:30720
ds_read_b64_tr_b16 v[198:199],v27 offset:30848
ds_read_b64_tr_b16 v[200:201],v27 offset:28704
ds_read_b64_tr_b16 v[202:203],v27 offset:28832
ds_read_b64_tr_b16 v[204:205],v27 offset:30752
ds_read_b64_tr_b16 v[206:207],v27 offset:30880
s_waitcnt lgkmcnt(0)
s_add_u32 s64,s62,1048576
s_add_u32 m0,s61,16384
s_nop 0
buffer_load_dwordx4 v16,s[36:39],s64 offen lds
s_waitcnt vmcnt(10)
s_add_u32 s64,s62,1114112
s_add_u32 m0,s61,17408
s_nop 0
buffer_load_dwordx4 v16,s[36:39],s64 offen lds
s_waitcnt vmcnt(10)
s_add_u32 s64,s62,1179648
s_add_u32 m0,s61,18432
s_nop 0
buffer_load_dwordx4 v16,s[36:39],s64 offen lds
s_waitcnt vmcnt(10)
s_add_u32 s64,s62,1245184
s_add_u32 m0,s61,19456
s_nop 0
buffer_load_dwordx4 v16,s[36:39],s64 offen lds
s_waitcnt vmcnt(10)
s_add_u32 s64,s62,1310720
s_add_u32 m0,s61,20480
s_nop 0
buffer_load_dwordx4 v16,s[36:39],s64 offen lds
s_waitcnt vmcnt(10)
s_add_u32 s64,s62,1376256
s_add_u32 m0,s61,21504
s_nop 0
buffer_load_dwordx4 v16,s[36:39],s64 offen lds
s_waitcnt vmcnt(10)
s_add_u32 s64,s62,1441792
s_add_u32 m0,s61,22528
s_nop 0
buffer_load_dwordx4 v16,s[36:39],s64 offen lds
s_waitcnt vmcnt(10)
s_add_u32 s64,s62,1507328
s_add_u32 m0,s61,23552
s_nop 0
buffer_load_dwordx4 v16,s[36:39],s64 offen lds
s_waitcnt vmcnt(10)
s_add_u32 s64,s62,1572864
s_add_u32 m0,s61,24576
s_nop 0
buffer_load_dwordx4 v16,s[36:39],s64 offen lds
s_waitcnt vmcnt(10)
s_add_u32 s64,s62,1638400
s_add_u32 m0,s61,25600
s_nop 0
buffer_load_dwordx4 v16,s[36:39],s64 offen lds
s_waitcnt vmcnt(10)
s_add_u32 s64,s62,1703936
s_add_u32 m0,s61,26624
s_nop 0
buffer_load_dwordx4 v16,s[36:39],s64 offen lds
s_waitcnt vmcnt(10)
s_add_u32 s64,s62,1769472
s_add_u32 m0,s61,27648
s_nop 0
buffer_load_dwordx4 v16,s[36:39],s64 offen lds
s_waitcnt vmcnt(10)
s_add_u32 s64,s62,1835008
s_add_u32 m0,s61,28672
s_nop 0
buffer_load_dwordx4 v16,s[36:39],s64 offen lds
s_waitcnt vmcnt(10)
s_add_u32 s64,s62,1900544
s_add_u32 m0,s61,29696
s_nop 0
buffer_load_dwordx4 v16,s[36:39],s64 offen lds
s_waitcnt vmcnt(10)
s_add_u32 s64,s62,1966080
s_add_u32 m0,s61,30720
s_nop 0
buffer_load_dwordx4 v16,s[36:39],s64 offen lds
s_waitcnt vmcnt(10)
s_add_u32 s64,s62,2031616
s_add_u32 m0,s61,31744
s_nop 0
buffer_load_dwordx4 v16,s[36:39],s64 offen lds
s_waitcnt vmcnt(16)
ds_read_b64_tr_b16 v[208:209],v19 offset:0
ds_read_b64_tr_b16 v[210:211],v19 offset:128
ds_read_b64_tr_b16 v[212:213],v19 offset:4096
ds_read_b64_tr_b16 v[214:215],v19 offset:4224
ds_read_b64_tr_b16 v[216:217],v19 offset:8
ds_read_b64_tr_b16 v[218:219],v19 offset:136
ds_read_b64_tr_b16 v[220:221],v19 offset:4104
ds_read_b64_tr_b16 v[222:223],v19 offset:4232
ds_read_b64_tr_b16 v[224:225],v19 offset:64
ds_read_b64_tr_b16 v[226:227],v19 offset:192
ds_read_b64_tr_b16 v[228:229],v19 offset:4160
ds_read_b64_tr_b16 v[230:231],v19 offset:4288
ds_read_b64_tr_b16 v[232:233],v19 offset:72
ds_read_b64_tr_b16 v[234:235],v19 offset:200
ds_read_b64_tr_b16 v[236:237],v19 offset:4168
ds_read_b64_tr_b16 v[238:239],v19 offset:4296
s_waitcnt lgkmcnt(0)
ds_read_b64_tr_b16 v[240:241],v19 offset:8192
ds_read_b64_tr_b16 v[242:243],v19 offset:8320
ds_read_b64_tr_b16 v[244:245],v19 offset:12288
ds_read_b64_tr_b16 v[246:247],v19 offset:12416
ds_read_b64_tr_b16 v[248:249],v19 offset:8200
ds_read_b64_tr_b16 v[250:251],v19 offset:8328
ds_read_b64_tr_b16 v[252:253],v19 offset:12296
ds_read_b64_tr_b16 v[254:255],v19 offset:12424
ds_read_b64_tr_b16 v[96:97],v19 offset:8256
ds_read_b64_tr_b16 v[98:99],v19 offset:8384
ds_read_b64_tr_b16 v[100:101],v19 offset:12352
ds_read_b64_tr_b16 v[102:103],v19 offset:12480
ds_read_b64_tr_b16 v[104:105],v19 offset:8264
ds_read_b64_tr_b16 v[106:107],v19 offset:8392
ds_read_b64_tr_b16 v[108:109],v19 offset:12360
ds_read_b64_tr_b16 v[110:111],v19 offset:12488
s_waitcnt lgkmcnt(0)
s_waitcnt vmcnt(0)
ds_write_b128 v7,v[96:99] offset:0
ds_write_b128 v7,v[100:103] offset:1024
ds_write_b128 v7,v[104:107] offset:2048
ds_write_b128 v7,v[108:111] offset:3072
s_waitcnt lgkmcnt(0)
ds_read_b64_tr_b16 v[96:97],v19 offset:16384
ds_read_b64_tr_b16 v[98:99],v19 offset:16512
ds_read_b64_tr_b16 v[100:101],v19 offset:20480
ds_read_b64_tr_b16 v[102:103],v19 offset:20608
ds_read_b64_tr_b16 v[104:105],v19 offset:16392
ds_read_b64_tr_b16 v[106:107],v19 offset:16520
ds_read_b64_tr_b16 v[108:109],v19 offset:20488
ds_read_b64_tr_b16 v[110:111],v19 offset:20616
s_waitcnt lgkmcnt(0)
ds_write_b128 v7,v[96:99] offset:4096
ds_write_b128 v7,v[100:103] offset:5120
ds_write_b128 v7,v[104:107] offset:6144
ds_write_b128 v7,v[108:111] offset:7168
s_waitcnt lgkmcnt(0)
ds_read_b64_tr_b16 v[96:97],v19 offset:16448
ds_read_b64_tr_b16 v[98:99],v19 offset:16576
ds_read_b64_tr_b16 v[100:101],v19 offset:20544
ds_read_b64_tr_b16 v[102:103],v19 offset:20672
ds_read_b64_tr_b16 v[104:105],v19 offset:16456
ds_read_b64_tr_b16 v[106:107],v19 offset:16584
ds_read_b64_tr_b16 v[108:109],v19 offset:20552
ds_read_b64_tr_b16 v[110:111],v19 offset:20680
s_waitcnt lgkmcnt(0)
ds_write_b128 v7,v[96:99] offset:8192
ds_write_b128 v7,v[100:103] offset:9216
ds_write_b128 v7,v[104:107] offset:10240
ds_write_b128 v7,v[108:111] offset:11264
s_waitcnt lgkmcnt(0)
ds_read_b64_tr_b16 v[96:97],v19 offset:24576
ds_read_b64_tr_b16 v[98:99],v19 offset:24704
ds_read_b64_tr_b16 v[100:101],v19 offset:28672
ds_read_b64_tr_b16 v[102:103],v19 offset:28800
ds_read_b64_tr_b16 v[104:105],v19 offset:24584
ds_read_b64_tr_b16 v[106:107],v19 offset:24712
ds_read_b64_tr_b16 v[108:109],v19 offset:28680
ds_read_b64_tr_b16 v[110:111],v19 offset:28808
s_waitcnt lgkmcnt(0)
ds_write_b128 v7,v[96:99] offset:12288
ds_write_b128 v7,v[100:103] offset:13312
ds_write_b128 v7,v[104:107] offset:14336
ds_write_b128 v7,v[108:111] offset:15360
s_waitcnt lgkmcnt(0)
ds_read_b64_tr_b16 v[112:113],v19 offset:24640
ds_read_b64_tr_b16 v[114:115],v19 offset:24768
ds_read_b64_tr_b16 v[116:117],v19 offset:28736
ds_read_b64_tr_b16 v[118:119],v19 offset:28864
ds_read_b64_tr_b16 v[120:121],v19 offset:24648
ds_read_b64_tr_b16 v[122:123],v19 offset:24776
ds_read_b64_tr_b16 v[124:125],v19 offset:28744
ds_read_b64_tr_b16 v[126:127],v19 offset:28872
s_waitcnt lgkmcnt(0)
ds_write_b128 v7,v[112:115] offset:16384
ds_write_b128 v7,v[116:119] offset:17408
ds_write_b128 v7,v[120:123] offset:18432
ds_write_b128 v7,v[124:127] offset:19456
ds_write_b128 v7,v[48:51] offset:20480
ds_write_b128 v7,v[52:55] offset:21504
ds_write_b128 v7,v[56:59] offset:22528
ds_write_b128 v7,v[60:63] offset:23552
ds_write_b128 v7,v[64:67] offset:24576
ds_write_b128 v7,v[68:71] offset:25600
ds_write_b128 v7,v[72:75] offset:26624
ds_write_b128 v7,v[76:79] offset:27648
ds_write_b128 v7,v[80:83] offset:28672
ds_write_b128 v7,v[84:87] offset:29696
ds_write_b128 v7,v[88:91] offset:30720
ds_write_b128 v7,v[92:95] offset:31744
s_waitcnt lgkmcnt(0)
v_and_b32 v23,1,v21
v_mov_b32 v1,0x4444
v_mov_b32 v24,0xeeee
v_cmp_eq_u32 vcc,1,v23
s_nop 1
v_cndmask_b32 v1,v1,v24,vcc
v_lshlrev_b32 v23,1,v22
v_sub_u32 v23,v21,v23
v_mov_b32 v5,0
v_mov_b32 v24,0x3f80
v_cmp_eq_u32 vcc,0,v23
s_nop 1
v_cndmask_b32 v5,v5,v24,vcc
v_mov_b32 v24,0x3f800000
v_cmp_eq_u32 vcc,1,v23
s_nop 1
v_cndmask_b32 v5,v5,v24,vcc
s_and_b32 s64,s50,1
s_lshl_b32 s64,s64,11
v_lshl_add_u32 v127,v20,2,s64
v_and_b32 v23,7,v21
v_lshrrev_b32 v24,3,v21
v_lshlrev_b32 v25,8,v24
v_lshl_add_u32 v25,v22,6,v25
v_lshl_add_u32 v4,v23,2,v25
v_lshrrev_b32 v25,1,v22
v_lshl_add_u32 v25,v25,3,v23
v_lshlrev_b32 v25,5,v25
v_and_b32 v26,1,v22
v_lshl_add_u32 v6,v26,4,v25
v_lshl_add_u32 v27,v22,3,v23
v_lshlrev_b32 v27,4,v27
s_mov_b32 s80,0x3e0293ee
s_mov_b32 s81,0xfffffffe
s_mov_b32 s84,0x00ff00ff
s_mov_b32 s85,0x00ff00ff
s_mov_b32 s86,-1
s_mov_b32 s87,0
s_cmp_gt_u32 s50,1
s_cselect_b32 s82,0xff00ff00,-1
s_cselect_b32 s83,0xff00ff00,0
s_lshl_b32 m0,s50,8
s_cmp_gt_u32 s50,1
s_cbranch_scc1 w23_100371
v_lshl_add_u32 v2,v24,9,v27
v_lshrrev_b32 v25,1,v22
v_lshl_add_u32 v25,v25,3,v23
v_lshlrev_b32 v25,4,v25
v_lshl_add_u32 v26,v26,1,v24
v_lshl_add_u32 v3,v26,2,v25
v_add_u32 v3,1024 + 256,v3
v_cndmask_b32 v6,2.0,v6,s[84:85]
v_mov_b32 v8,0x3f803f80
v_mov_b32 v9,0x3f803f80
v_mov_b32 v10,0x3f803f80
v_mov_b32 v11,0x3f803f80
v_mov_b32 v12,0x3f803f80
v_mov_b32 v13,0
v_mov_b32 v14,0
v_mov_b32 v15,0
s_branch jn_100372
w23_100371:
s_sub_u32 s64,s50,2
s_mul_i32 s64,s64,4160
v_lshrrev_b32 v25,1,v22
v_mul_u32_u24 v25,2080,v25
v_and_b32 v28,1,v23
v_mul_u32_u24 v28,1040,v28
v_add_u32 v25,v25,v28
v_lshrrev_b32 v28,1,v23
v_lshl_add_u32 v25,v28,6,v25
v_lshl_add_u32 v25,v26,5,v25
v_mul_u32_u24 v28,8448,v24
v_add3_u32 v2,v25,v28,s64
v_cndmask_b32 v3,2.0,v27,s[84:85]
v_mov_b32 v8,-1
v_mov_b32 v9,-1
v_mov_b32 v10,-1
v_mov_b32 v11,-1
jn_100372:
s_mov_b32 s92,s2
s_and_b32 s93,s3,0xffff
s_mov_b32 s94,0x100
s_mov_b32 s95,0x20000
v_mbcnt_lo_u32_b32 v16,-1,0
v_mbcnt_hi_u32_b32 v16,-1,v16
v_mov_b32 v18,0
v_cmp_eq_u32 vcc,22,v16
s_nop 1
v_cndmask_b32 v18,v18,63,vcc
v_cmp_eq_u32 vcc,21,v16
s_nop 1
v_cndmask_b32 v18,v18,1,vcc
v_and_b32 v19,1,v16
v_cmp_eq_u32 vcc,1,v19
v_mov_b32 v19,8192
s_nop 0
v_cndmask_b32 v19,-1,v19,vcc
v_min_u32 v16,31,v16
v_lshlrev_b32 v16,2,v16
s_sub_u32 s66,s88,64
s_cmp_lg_u32 s50,0
s_cbranch_scc1 vot_100379
vpoll_100375:
buffer_load_dword v17,v16,s[92:95],s66 offen sc1
s_waitcnt vmcnt(0)
s_cmp_lg_u32 s56,2
s_cbranch_scc1 vck_100376
v_cmp_eq_u32 vcc,v17,v19
s_and_b32 s64,vcc_lo,0xffff
s_cmp_eq_u32 s64,65535
s_cbranch_scc1 vck_100376
s_mov_b32 s65,0
v_readlane_b32 s64,v17,1
s_lshr_b32 s64,s64,8
s_add_u32 s65,s65,s64
v_readlane_b32 s64,v17,3
s_lshr_b32 s64,s64,8
s_add_u32 s65,s65,s64
v_readlane_b32 s64,v17,5
s_lshr_b32 s64,s64,8
s_add_u32 s65,s65,s64
v_readlane_b32 s64,v17,7
s_lshr_b32 s64,s64,8
s_add_u32 s65,s65,s64
v_readlane_b32 s64,v17,9
s_lshr_b32 s64,s64,8
s_add_u32 s65,s65,s64
v_readlane_b32 s64,v17,11
s_lshr_b32 s64,s64,8
s_add_u32 s65,s65,s64
v_readlane_b32 s64,v17,13
s_lshr_b32 s64,s64,8
s_add_u32 s65,s65,s64
v_readlane_b32 s64,v17,15
s_lshr_b32 s64,s64,8
s_add_u32 s65,s65,s64
s_cmp_ge_u32 s65,256
s_cbranch_scc1 vok_100378
s_branch vrt_100377
vck_100376:
v_cmp_gt_u32 vcc,v18,v17
s_cbranch_vccz vok_100378
vrt_100377:
s_sleep 8
s_sub_u32 s90,s90,1
s_cmp_gt_i32 s90,0
s_cbranch_scc1 vpoll_100375
vok_100378:
ds_write_b32 v16,v17 offset:1792
s_waitcnt lgkmcnt(0)
vot_100379:
s_barrier
v_add_u32 v18,1792,v16
ds_read_b32 v17,v18
s_waitcnt lgkmcnt(0)
s_cmp_lg_u32 s56,2
s_cbranch_scc1 vfin_100380
v_cmp_eq_u32 vcc,v17,v19
s_and_b32 s64,vcc_lo,0xffff
s_cmp_eq_u32 s64,65535
s_cbranch_scc1 vfin_100380
s_mov_b32 s65,0
v_readlane_b32 s64,v17,1
s_lshr_b32 s64,s64,8
s_add_u32 s65,s65,s64
v_readlane_b32 s64,v17,3
s_lshr_b32 s64,s64,8
s_add_u32 s65,s65,s64
v_readlane_b32 s64,v17,5
s_lshr_b32 s64,s64,8
s_add_u32 s65,s65,s64
v_readlane_b32 s64,v17,7
s_lshr_b32 s64,s64,8
s_add_u32 s65,s65,s64
v_readlane_b32 s64,v17,9
s_lshr_b32 s64,s64,8
s_add_u32 s65,s65,s64
v_readlane_b32 s64,v17,11
s_lshr_b32 s64,s64,8
s_add_u32 s65,s65,s64
v_readlane_b32 s64,v17,13
s_lshr_b32 s64,s64,8
s_add_u32 s65,s65,s64
v_readlane_b32 s64,v17,15
s_lshr_b32 s64,s64,8
s_add_u32 s65,s65,s64
s_cmp_ge_u32 s65,256
s_cbranch_scc1 fl_fb
vfin_100380:
s_and_b32 s56,s56,1
s_mov_b32 s67,0
v_readlane_b32 s65,v17,21
s_and_b32 s65,s65,2
s_lshl_b32 s67,s65,12
s_lshl_b32 s64,s58,14
s_lshl_b32 s65,s50,12
s_add_u32 s70,s64,s65
s_add_u32 s70,s70,134217728
s_lshl_b32 s65,s59,9
s_add_u32 s71,s64,s65
s_add_u32 s71,s71,134217728
s_xor_b32 s64,s58,1
s_lshl_b32 s64,s64,15
s_lshr_b32 s65,s50,1
s_lshl_b32 s65,s65,14
s_add_u32 s64,s64,s65
s_and_b32 s65,s50,1
s_lshl_b32 s65,s65,12
s_add_u32 s64,s64,s65
s_add_u32 s72,s64,s67
s_add_u32 s72,s72,142606336
s_lshl_b32 s64,s58,15
s_lshr_b32 s65,s59,4
s_lshl_b32 s65,s65,14
s_add_u32 s64,s64,s65
s_and_b32 s65,s59,15
s_lshl_b32 s65,s65,9
s_add_u32 s64,s64,s65
s_add_u32 s73,s64,s67
s_add_u32 s73,s73,142606336
s_cmp_eq_u32 s50,1
s_cselect_b32 s54,2048 - 256,0
s_sub_u32 s71,s71,s54
s_lshl_b32 s64,s58,15
s_lshl_b32 s65,s50,13
s_add_u32 s74,s64,s65
s_add_u32 s74,s74,134250496
s_lshl_b32 s64,s57,10
s_and_b32 s65,s50,1
s_lshl_b32 s65,s65,9
s_cmp_gt_u32 s50,1
s_cselect_b32 s65,0,s65
s_add_u32 s75,s64,s65
s_add_u32 s75,s75,134250496
s_lshl_b32 s64,s57,12
s_and_b32 s65,s64,0xffffe000
s_cmp_eq_u32 s50,3
s_cselect_b32 s66,1536,0
s_add_u32 s64,s64,s66
s_cmp_gt_u32 s50,1
s_cselect_b32 s76,s64,s65
s_add_u32 s76,s76,134479872
s_lshl_b32 s64,s57,14
s_and_b32 s65,s50,1
s_lshl_b32 s66,s65,11
s_add_u32 s77,s64,s66
s_cmp_gt_u32 s50,1
s_cselect_b32 s66,0,4096
s_add_u32 s77,s77,s66
s_add_u32 s77,s77,0
s_lshl_b32 s66,s65,9
s_add_u32 s66,s66,1024 + 128
s_lshl_b32 s65,s65,7
s_cmp_gt_u32 s50,1
s_cselect_b32 s65,s65,s66
s_add_u32 s78,s64,s65
s_add_u32 s78,s78,67108736
s_lshl_b32 s64,s57,6
s_add_u32 s68,s64,s67
s_add_u32 s69,s68,s64
s_add_u32 s69,s69,138428416
s_lshl_b32 s64,s50,14
s_add_u32 s69,s69,s64
s_and_b32 s64,s50,1
s_lshl_b32 s64,s64,11
s_sub_u32 s69,s69,s64
s_add_u32 s68,s68,138412032
s_mov_b32 s79,0
s_mov_b32 s91,0
s_mov_b32 s90,100000
s_barrier
s_cmp_eq_u32 s56,1
s_cbranch_scc1 recslow_100373
s_mov_b32 s55,0
s_cmp_lg_u32 s50,0
s_cbranch_scc1 np0_100383
v_mov_b32 v120,0
v_mov_b32 v121,0
s_cmp_lg_u32 s58,0
s_cbranch_scc1 z1_100384
v_lshrrev_b32 v124,6,v127
v_lshlrev_b32 v124,12,v124
v_bfe_u32 v125,v127,1,5
v_add_u32 v124,v124,v125
s_lshl_b32 s64,s59,6
buffer_load_ushort v120,v124,s[44:47],s64 offen
buffer_load_ushort v122,v124,s[44:47],s64 offen offset:32
buffer_load_ushort v121,v124,s[44:47],s64 offen offset:2048
buffer_load_ushort v123,v124,s[44:47],s64 offen offset:2080
s_waitcnt vmcnt(0)
v_lshl_or_b32 v120,v122,16,v120
v_lshl_or_b32 v121,v123,16,v121
v_min_u32 v120,s81,v120
v_min_u32 v121,s81,v121
z1_100384:
buffer_store_dword v120,v4,s[20:23],s71 offen
buffer_store_dword v121,v4,s[20:23],s71 offen offset:32
buffer_store_dword v120,v4,s[20:23],s73 offen sc1
buffer_store_dword v121,v4,s[20:23],s73 offen offset:32 sc1
np0_100383:
v_lshrrev_b32 v124,2,v0
v_bfe_u32 v125,v124,5,1
v_mul_u32_u24 v125,2048,v125
s_and_b32 s64,s50,1
s_lshl_b32 s64,s64,5
v_add3_u32 v4,v124,v125,s64
s_add_u32 s64,s79,0
s_cmp_gt_u32 s91,s64
s_cbranch_scc0 flp_100387
fok_100386:
s_add_u32 s64,s79,0
s_lshl_b32 s65,s64,12
s_and_b32 s65,s65,0x2000
s_xor_b32 s65,s65,s67
s_lshl_b32 s64,s64,20
s_add_u32 s65,s65,s64
s_add_u32 s99,s65,s77
buffer_load_dwordx4 v[104:107],v0,s[20:23],s99 offen
buffer_load_dwordx4 v[108:111],v0,s[20:23],s99 offen offset:1024
s_waitcnt vmcnt(0)
s_mov_b32 s92,s70
s_mov_b32 s93,s72
s_mov_b32 s94,s76
s_add_u32 s95,s94,4096
s_mov_b32 s96,s74
s_add_u32 s97,s96,4096
s_mov_b32 s98,s75
s_barrier
v_mov_b32 v96,v104
v_mov_b32 v97,v105
v_mov_b32 v98,v106
v_mov_b32 v99,v107
v_mov_b32 v100,v108
v_mov_b32 v101,v109
v_mov_b32 v102,v110
v_mov_b32 v103,v111
v_mov_b32 v48,0
v_mov_b32 v49,0
v_mov_b32 v50,0
v_mov_b32 v51,0
v_mov_b32 v52,0
v_mov_b32 v53,0
v_mov_b32 v54,0
v_mov_b32 v55,0
v_mov_b32 v56,0
v_mov_b32 v57,0
v_mov_b32 v58,0
v_mov_b32 v59,0
v_mov_b32 v60,0
v_mov_b32 v61,0
v_mov_b32 v62,0
v_mov_b32 v63,0
v_mov_b32 v64,0
v_mov_b32 v65,0
v_mov_b32 v66,0
v_mov_b32 v67,0
v_mov_b32 v68,0
v_mov_b32 v69,0
v_mov_b32 v70,0
v_mov_b32 v71,0
v_mov_b32 v72,0
v_mov_b32 v73,0
v_mov_b32 v74,0
v_mov_b32 v75,0
v_mov_b32 v76,0
v_mov_b32 v77,0
v_mov_b32 v78,0
v_mov_b32 v79,0
v_mov_b32 v80,0
v_mov_b32 v81,0
v_mov_b32 v82,0
v_mov_b32 v83,0
v_mov_b32 v84,0
v_mov_b32 v85,0
v_mov_b32 v86,0
v_mov_b32 v87,0
v_mov_b32 v88,0
v_mov_b32 v89,0
v_mov_b32 v90,0
v_mov_b32 v91,0
v_mov_b32 v92,0
v_mov_b32 v93,0
v_mov_b32 v94,0
v_mov_b32 v95,0
s_cmp_gt_u32 s50,1
s_cbranch_scc0 loop0_100385x
loop_100381:
v_mov_b32 v125,0
s_nop 1
v_mfma_f32_16x16x1_4b_f32 v[48:63],v125,v125,0
v_mfma_f32_16x16x1_4b_f32 v[64:79],v125,v125,0
v_mfma_f32_16x16x1_4b_f32 v[80:95],v125,v125,0
s_nop 15
s_nop 15
s_nop 15
s_nop 15
buffer_load_dwordx4 v[16:19],v0,s[20:23],s92 offen offset:0 sc1
s_nop 7
buffer_load_dwordx4 v[20:23],v0,s[20:23],s92 offen offset:1024 sc1
s_nop 7
buffer_load_dwordx4 v[24:27],v0,s[20:23],s92 offen offset:2048 sc1
s_nop 7
buffer_load_dwordx4 v[28:31],v0,s[20:23],s92 offen offset:3072 sc1
v_mov_b32 v96,v104
v_mov_b32 v97,v105
v_mov_b32 v98,v106
v_mov_b32 v99,v107
v_mov_b32 v100,v108
v_mov_b32 v101,v109
v_mov_b32 v102,v110
v_mov_b32 v103,v111
s_branch ja_100388
loop0_100385x:
v_mov_b32 v125,0
s_nop 1
v_mfma_f32_16x16x1_4b_f32 v[48:63],v125,v125,0
v_mfma_f32_16x16x1_4b_f32 v[64:79],v125,v125,0
v_mfma_f32_16x16x1_4b_f32 v[80:95],v125,v125,0
s_nop 15
s_nop 11
buffer_load_dwordx4 v[16:19],v0,s[20:23],s92 offen offset:0 sc1
s_nop 7
buffer_load_dwordx4 v[20:23],v0,s[20:23],s92 offen offset:1024 sc1
s_nop 7
buffer_load_dwordx4 v[24:27],v0,s[20:23],s92 offen offset:2048 sc1
s_nop 7
buffer_load_dwordx4 v[28:31],v0,s[20:23],s92 offen offset:3072 sc1
ja_100388:
s_max_u32 s66,s79,1
s_sub_u32 s66,s66,1
v_mov_b32 v126,s66
s_add_u32 s64,s66,0
s_lshl_b32 s65,s64,12
s_and_b32 s65,s65,0x2000
s_xor_b32 s65,s65,s67
s_lshl_b32 s64,s64,20
s_add_u32 s65,s65,s64
s_add_u32 s101,s65,s78
s_cmp_eq_u32 s79,63
s_cbranch_scc1 last_100382
s_add_u32 s64,s79,1
s_lshl_b32 s65,s64,12
s_and_b32 s65,s65,0x2000
s_xor_b32 s65,s65,s67
s_lshl_b32 s64,s64,20
s_add_u32 s65,s65,s64
s_add_u32 s99,s65,s77
s_waitcnt vmcnt(3)
v_max3_u32 v124,v16,v17,v18
v_max_u32 v124,v124,v19
v_cmp_eq_u32 vcc,-1,v124
v_cndmask_b32 v120,2.0,v0,s[82:83]
v_cndmask_b32 v121,2.0,v127,s[86:87]
s_cbranch_vccnz flb_100415
seg_100391:
segb_100399:
v_smfmac_f32_16x16x64_bf16 v[48:51],v[16:19],a[0:7],v1
buffer_load_dword v125,off,s[20:23],s92 sc1
v_smfmac_f32_16x16x64_bf16 v[52:55],v[16:19],a[8:15],v1
buffer_load_dwordx4 v[32:35],v0,s[20:23],s93 offen offset:0 sc1
v_smfmac_f32_16x16x64_bf16 v[56:59],v[16:19],a[16:23],v1
s_waitcnt vmcnt(4)
v_max3_u32 v124,v20,v21,v22
v_smfmac_f32_16x16x64_bf16 v[60:63],v[16:19],a[24:31],v1
v_max_u32 v124,v124,v23
v_smfmac_f32_16x16x64_bf16 v[64:67],v[16:19],a[32:39],v1
v_cmp_eq_u32 vcc,-1,v124
v_smfmac_f32_16x16x64_bf16 v[68:71],v[16:19],a[40:47],v1
v_smfmac_f32_16x16x64_bf16 v[72:75],v[16:19],a[48:55],v1
s_cbranch_vccnz fl_100408
seg_100392:
v_smfmac_f32_16x16x64_bf16 v[76:79],v[16:19],a[56:63],v1
segb_100400:
v_smfmac_f32_16x16x64_bf16 v[48:51],v[20:23],a[64:71],v1
buffer_load_dword v125,off,s[20:23],s92 sc1
v_smfmac_f32_16x16x64_bf16 v[52:55],v[20:23],a[72:79],v1
buffer_load_dwordx4 v[36:39],v0,s[20:23],s93 offen offset:1024 sc1
v_smfmac_f32_16x16x64_bf16 v[56:59],v[20:23],a[80:87],v1
s_waitcnt vmcnt(5)
v_max3_u32 v124,v24,v25,v26
v_smfmac_f32_16x16x64_bf16 v[60:63],v[20:23],a[88:95],v1
v_max_u32 v124,v124,v27
v_smfmac_f32_16x16x64_bf16 v[64:67],v[20:23],a[96:103],v1
v_cmp_eq_u32 vcc,-1,v124
v_smfmac_f32_16x16x64_bf16 v[68:71],v[20:23],a[104:111],v1
v_smfmac_f32_16x16x64_bf16 v[72:75],v[20:23],a[112:119],v1
s_cbranch_vccnz fl_100409
seg_100393:
v_smfmac_f32_16x16x64_bf16 v[76:79],v[20:23],a[120:127],v1
segb_100401:
v_smfmac_f32_16x16x64_bf16 v[48:51],v[24:27],a[128:135],v1
buffer_load_dword v125,off,s[20:23],s92 sc1
v_smfmac_f32_16x16x64_bf16 v[52:55],v[24:27],a[136:143],v1
buffer_load_dwordx4 v[40:43],v0,s[20:23],s93 offen offset:2048 sc1
v_smfmac_f32_16x16x64_bf16 v[56:59],v[24:27],a[144:151],v1
buffer_load_dwordx4 v[44:47],v0,s[20:23],s93 offen offset:3072 sc1
s_waitcnt vmcnt(7)
v_max3_u32 v124,v28,v29,v30
v_smfmac_f32_16x16x64_bf16 v[60:63],v[24:27],a[152:159],v1
v_max_u32 v124,v124,v31
v_smfmac_f32_16x16x64_bf16 v[64:67],v[24:27],a[160:167],v1
v_cmp_eq_u32 vcc,-1,v124
v_smfmac_f32_16x16x64_bf16 v[68:71],v[24:27],a[168:175],v1
v_smfmac_f32_16x16x64_bf16 v[72:75],v[24:27],a[176:183],v1
s_cbranch_vccnz fl_100410
seg_100394:
v_smfmac_f32_16x16x64_bf16 v[76:79],v[24:27],a[184:191],v1
segb_100402:
v_smfmac_f32_16x16x64_bf16 v[48:51],v[28:31],a[192:199],v1
buffer_load_dword v125,off,s[20:23],s92 sc1
v_smfmac_f32_16x16x64_bf16 v[52:55],v[28:31],a[200:207],v1
v_smfmac_f32_16x16x64_bf16 v[56:59],v[28:31],a[208:215],v1
s_waitcnt vmcnt(6)
v_max3_u32 v124,v32,v33,v34
v_smfmac_f32_16x16x64_bf16 v[60:63],v[28:31],a[216:223],v1
v_max_u32 v124,v124,v35
v_smfmac_f32_16x16x64_bf16 v[64:67],v[28:31],a[224:231],v1
v_cmp_eq_u32 vcc,-1,v124
v_smfmac_f32_16x16x64_bf16 v[68:71],v[28:31],a[232:239],v1
v_smfmac_f32_16x16x64_bf16 v[72:75],v[28:31],a[240:247],v1
s_cbranch_vccnz fl_100411
seg_100395:
v_smfmac_f32_16x16x64_bf16 v[76:79],v[28:31],a[248:255],v1
segb_100403:
v_smfmac_f32_16x16x64_bf16 v[48:51],v[32:35],a[0:7],v1
buffer_load_dword v125,off,s[20:23],s92 sc1
v_smfmac_f32_16x16x64_bf16 v[52:55],v[32:35],a[8:15],v1
buffer_store_dwordx4 v[112:115],v120,s[20:23],s101 offen sc1
v_smfmac_f32_16x16x64_bf16 v[56:59],v[32:35],a[16:23],v1
buffer_store_dword v126,v121,s[20:23],s69 offen sc1
s_waitcnt vmcnt(7)
v_max3_u32 v124,v36,v37,v38
v_smfmac_f32_16x16x64_bf16 v[60:63],v[32:35],a[24:31],v1
v_max_u32 v124,v124,v39
v_smfmac_f32_16x16x64_bf16 v[64:67],v[32:35],a[32:39],v1
v_cmp_eq_u32 vcc,-1,v124
v_smfmac_f32_16x16x64_bf16 v[68:71],v[32:35],a[40:47],v1
v_smfmac_f32_16x16x64_bf16 v[72:75],v[32:35],a[48:55],v1
s_cbranch_vccnz fl_100412
seg_100396:
v_smfmac_f32_16x16x64_bf16 v[76:79],v[32:35],a[56:63],v1
segb_100404:
v_smfmac_f32_16x16x64_bf16 v[48:51],v[36:39],a[64:71],v1
buffer_load_dword v125,off,s[20:23],s92 sc1
s_waitcnt vmcnt(5)
v_max3_u32 v124,v40,v41,v42
v_smfmac_f32_16x16x64_bf16 v[52:55],v[36:39],a[72:79],v1
v_max3_u32 v124,v124,v43,v44
v_smfmac_f32_16x16x64_bf16 v[56:59],v[36:39],a[80:87],v1
v_max3_u32 v124,v124,v45,v46
v_smfmac_f32_16x16x64_bf16 v[60:63],v[36:39],a[88:95],v1
v_max_u32 v124,v124,v47
v_smfmac_f32_16x16x64_bf16 v[64:67],v[36:39],a[96:103],v1
v_cmp_eq_u32 vcc,-1,v124
v_smfmac_f32_16x16x64_bf16 v[68:71],v[36:39],a[104:111],v1
v_smfmac_f32_16x16x64_bf16 v[72:75],v[36:39],a[112:119],v1
s_cbranch_vccnz fl_100413
seg_100397:
v_smfmac_f32_16x16x64_bf16 v[76:79],v[36:39],a[120:127],v1
segb_100405:
v_smfmac_f32_16x16x64_bf16 v[48:51],v[40:43],a[128:135],v1
s_add_u32 s64,s79,1
s_cmp_gt_u32 s91,s64
s_cbranch_scc0 flp_100390
fok_100389:
v_smfmac_f32_16x16x64_bf16 v[52:55],v[40:43],a[136:143],v1
buffer_load_dwordx4 v[104:107],v0,s[20:23],s99 offen
buffer_load_dwordx4 v[108:111],v0,s[20:23],s99 offen offset:1024
v_smfmac_f32_16x16x64_bf16 v[48:51],v[44:47],a[192:199],v1
buffer_load_dword v126,off,s[20:23],s68 sc1
s_add_u32 s64,s79,2
v_smfmac_f32_16x16x64_bf16 v[52:55],v[44:47],a[200:207],v1
s_and_b32 s64,s64,3
s_lshl_b32 s100,s64,19
s_nop 0
v_add_f32 v48,v48,v49
v_smfmac_f32_16x16x64_bf16 v[56:59],v[40:43],a[144:151],v1
ds_write_addtid_b32 v48 offset:0
v_add_f32 v50,v50,v51
v_smfmac_f32_16x16x64_bf16 v[60:63],v[40:43],a[152:159],v1
ds_write_addtid_b32 v50 offset:1040
v_add_f32 v52,v52,v53
v_smfmac_f32_16x16x64_bf16 v[56:59],v[44:47],a[208:215],v1
ds_write_addtid_b32 v52 offset:2080
v_add_f32 v54,v54,v55
v_smfmac_f32_16x16x64_bf16 v[60:63],v[44:47],a[216:223],v1
ds_write_addtid_b32 v54 offset:3120
s_nop 1
v_add_f32 v56,v56,v57
v_smfmac_f32_16x16x64_bf16 v[64:67],v[40:43],a[160:167],v1
ds_write_addtid_b32 v56 offset:4160
v_add_f32 v58,v58,v59
v_smfmac_f32_16x16x64_bf16 v[68:71],v[40:43],a[168:175],v1
ds_write_addtid_b32 v58 offset:5200
v_add_f32 v60,v60,v61
v_smfmac_f32_16x16x64_bf16 v[64:67],v[44:47],a[224:231],v1
ds_write_addtid_b32 v60 offset:6240
v_add_f32 v62,v62,v63
v_smfmac_f32_16x16x64_bf16 v[68:71],v[44:47],a[232:239],v1
ds_write_addtid_b32 v62 offset:7280
s_nop 1
v_add_f32 v64,v64,v65
v_smfmac_f32_16x16x64_bf16 v[72:75],v[40:43],a[176:183],v1
ds_write_addtid_b32 v64 offset:8448
v_add_f32 v66,v66,v67
v_smfmac_f32_16x16x64_bf16 v[76:79],v[40:43],a[184:191],v1
ds_write_addtid_b32 v66 offset:9488
v_add_f32 v68,v68,v69
v_smfmac_f32_16x16x64_bf16 v[72:75],v[44:47],a[240:247],v1
ds_write_addtid_b32 v68 offset:10528
v_add_f32 v70,v70,v71
v_smfmac_f32_16x16x64_bf16 v[76:79],v[44:47],a[248:255],v1
ds_write_addtid_b32 v70 offset:11568
s_nop 1
v_add_f32 v72,v72,v73
v_smfmac_f32_16x16x64_bf16 v[80:83],v[16:19],v[208:215],v1
ds_write_addtid_b32 v72 offset:12608
v_add_f32 v74,v74,v75
v_smfmac_f32_16x16x64_bf16 v[80:83],v[32:35],v[208:215],v1
ds_write_addtid_b32 v74 offset:13648
v_add_f32 v76,v76,v77
ds_write_addtid_b32 v76 offset:14688
v_add_f32 v78,v78,v79
ds_write_addtid_b32 v78 offset:15728
doneA_100424:
s_waitcnt lgkmcnt(0)
s_barrier
s_cmp_gt_u32 s50,1
s_cbranch_scc1 w23_100425
v_smfmac_f32_16x16x64_bf16 v[84:87],v[16:19],v[216:223],v1
v_smfmac_f32_16x16x64_bf16 v[84:87],v[32:35],v[216:223],v1
v_smfmac_f32_16x16x64_bf16 v[88:91],v[16:19],v[224:231],v1
v_smfmac_f32_16x16x64_bf16 v[88:91],v[32:35],v[224:231],v1
v_smfmac_f32_16x16x64_bf16 v[92:95],v[16:19],v[232:239],v1
ds_read_b128 v[48:51],v7 offset:0
ds_read_b128 v[52:55],v7 offset:1024
v_smfmac_f32_16x16x64_bf16 v[92:95],v[32:35],v[232:239],v1
ds_read_b128 v[56:59],v7 offset:2048
ds_read_b128 v[60:63],v7 offset:3072
v_smfmac_f32_16x16x64_bf16 v[80:83],v[20:23],v[240:247],v1
ds_read_b128 v[64:67],v7 offset:4096
ds_read_b128 v[68:71],v7 offset:5120
v_smfmac_f32_16x16x64_bf16 v[80:83],v[36:39],v[240:247],v1
ds_read_b128 v[72:75],v7 offset:6144
ds_read_b128 v[76:79],v7 offset:7168
v_smfmac_f32_16x16x64_bf16 v[84:87],v[20:23],v[248:255],v1
v_smfmac_f32_16x16x64_bf16 v[84:87],v[36:39],v[248:255],v1
s_waitcnt lgkmcnt(6)
v_smfmac_f32_16x16x64_bf16 v[88:91],v[20:23],v[48:55],v1
v_smfmac_f32_16x16x64_bf16 v[88:91],v[36:39],v[48:55],v1
ds_read_b128 v[48:51],v7 offset:8192
ds_read_b128 v[52:55],v7 offset:9216
s_waitcnt lgkmcnt(6)
v_smfmac_f32_16x16x64_bf16 v[92:95],v[20:23],v[56:63],v1
v_smfmac_f32_16x16x64_bf16 v[92:95],v[36:39],v[56:63],v1
ds_read_b128 v[56:59],v7 offset:10240
ds_read_b128 v[60:63],v7 offset:11264
s_waitcnt lgkmcnt(6)
v_smfmac_f32_16x16x64_bf16 v[80:83],v[24:27],v[64:71],v1
v_smfmac_f32_16x16x64_bf16 v[80:83],v[40:43],v[64:71],v1
ds_read_b128 v[64:67],v7 offset:12288
ds_read_b128 v[68:71],v7 offset:13312
s_waitcnt lgkmcnt(6)
v_smfmac_f32_16x16x64_bf16 v[84:87],v[24:27],v[72:79],v1
v_smfmac_f32_16x16x64_bf16 v[84:87],v[40:43],v[72:79],v1
ds_read_b128 v[72:75],v7 offset:14336
ds_read_b128 v[76:79],v7 offset:15360
s_waitcnt lgkmcnt(6)
v_smfmac_f32_16x16x64_bf16 v[88:91],v[24:27],v[48:55],v1
v_smfmac_f32_16x16x64_bf16 v[88:91],v[40:43],v[48:55],v1
ds_read_b128 v[48:51],v7 offset:16384
ds_read_b128 v[52:55],v7 offset:17408
s_waitcnt lgkmcnt(6)
v_smfmac_f32_16x16x64_bf16 v[92:95],v[24:27],v[56:63],v1
v_smfmac_f32_16x16x64_bf16 v[92:95],v[40:43],v[56:63],v1
ds_read_b128 v[56:59],v7 offset:18432
ds_read_b128 v[60:63],v7 offset:19456
s_waitcnt lgkmcnt(6)
v_smfmac_f32_16x16x64_bf16 v[80:83],v[28:31],v[64:71],v1
v_smfmac_f32_16x16x64_bf16 v[80:83],v[44:47],v[64:71],v1
s_waitcnt lgkmcnt(4)
v_smfmac_f32_16x16x64_bf16 v[84:87],v[28:31],v[72:79],v1
v_smfmac_f32_16x16x64_bf16 v[84:87],v[44:47],v[72:79],v1
s_waitcnt lgkmcnt(2)
v_smfmac_f32_16x16x64_bf16 v[88:91],v[28:31],v[48:55],v1
v_add_f32 v80,v80,v81
v_smfmac_f32_16x16x64_bf16 v[88:91],v[44:47],v[48:55],v1
v_add_f32 v82,v82,v83
s_waitcnt lgkmcnt(0)
v_smfmac_f32_16x16x64_bf16 v[92:95],v[28:31],v[56:63],v1
v_cvt_pk_bf16_f32 v80,v80,v82
v_smfmac_f32_16x16x64_bf16 v[92:95],v[44:47],v[56:63],v1
ds_write_addtid_b32 v80 offset:16896
v_add_f32 v84,v84,v85
buffer_load_dwordx4 v[16:19],v2,s[20:23],s94 offen offset:0 sc1
buffer_load_dwordx4 v[32:35],v2,s[20:23],s94 offen offset:1536 sc1
buffer_load_dwordx4 v[20:23],v2,s[20:23],s95 offen offset:0 sc1
buffer_load_dwordx4 v[36:39],v2,s[20:23],s95 offen offset:1536 sc1
buffer_load_dword v120,v3,s[20:23],s94 offen offset:0 sc1
buffer_load_dword v121,v3,s[20:23],s94 offen offset:1536 sc1
buffer_load_dword v122,v3,s[20:23],s95 offen offset:0 sc1
buffer_load_dword v123,v3,s[20:23],s95 offen offset:1536 sc1
v_add_f32 v86,v86,v87
v_cvt_pk_bf16_f32 v84,v84,v86
v_add_f32 v88,v88,v89
v_add_f32 v90,v90,v91
v_cvt_pk_bf16_f32 v88,v88,v90
v_add_f32 v92,v92,v93
v_add_f32 v94,v94,v95
v_cvt_pk_bf16_f32 v92,v92,v94
ds_write_addtid_b32 v84 offset:17920
ds_write_addtid_b32 v88 offset:18944
ds_write_addtid_b32 v92 offset:19968
sp_100428:
s_waitcnt vmcnt(6)
v_pk_add_f32 v[16:17],v[16:17],v[32:33]
v_pk_add_f32 v[18:19],v[18:19],v[34:35]
s_waitcnt vmcnt(4)
v_pk_add_f32 v[20:21],v[20:21],v[36:37]
v_pk_add_f32 v[22:23],v[22:23],v[38:39]
v_pk_add_f32 v[16:17],v[16:17],v[20:21]
v_pk_add_f32 v[18:19],v[18:19],v[22:23]
v_max3_f32 v124,v16,v17,v18
v_pk_add_f32 v[20:21],v[16:17],v[18:19]
s_waitcnt vmcnt(0)
v_pk_add_f32 v[120:121],v[120:121],v[122:123]
v_add_f32 v120,v120,v121
v_max3_f32 v124,v124,v19,v120
v_add_f32 v20,v20,v120
v_cmp_u_f32 vcc,v20,v21
v_max_f32_dpp v124,v124,v124 row_ror:8 row_mask:0xf bank_mask:0xf
v_mov_b32 v125,v124
s_cbranch_vccnz srt_100430
sok_100429:
s_nop 0
v_permlane16_swap_b32 v125,v124
v_max_f32 v124,v124,v125
v_mov_b32 v125,v124
s_nop 1
v_permlane32_swap_b32 v125,v124
v_max_f32 v124,v124,v125
v_mul_f32 v124,s80,v124
v_fma_f32 v16,v16,s80,-v124
v_fma_f32 v17,v17,s80,-v124
v_fma_f32 v18,v18,s80,-v124
v_fma_f32 v19,v19,s80,-v124
v_fma_f32 v120,v120,s80,-v124
s_waitcnt lgkmcnt(0)
s_barrier
ds_read2st64_b32 v[112:113],v127 offset0:66 offset1:67
ds_read2st64_b32 v[114:115],v127 offset0:68 offset1:69
ds_read2st64_b32 v[116:117],v127 offset0:70 offset1:71
ds_read2st64_b32 v[118:119],v127 offset0:72 offset1:73
v_exp_f32 v16,v16
v_exp_f32 v17,v17
v_exp_f32 v18,v18
v_exp_f32 v19,v19
v_cvt_pk_bf16_f32 v48,v16,v17
v_cvt_pk_bf16_f32 v49,v18,v19
v_exp_f32 v120,v120
v_mov_b32_dpp v50,v48 row_ror:8 row_mask:0xf bank_mask:0xf
v_mov_b32_dpp v51,v49 row_ror:8 row_mask:0xf bank_mask:0xf
v_mov_b32_dpp v121,v120 row_ror:8 row_mask:0xf bank_mask:0xf
v_cvt_pk_bf16_f32 v52,v120,v121
v_mfma_f32_16x16x32_bf16 v[64:67],v[8:11],v[48:51],0
v_mov_b32 v53,v52
v_mfma_f32_16x16x32_bf16 v[56:59],v[96:99],v[48:51],0
v_mov_b32 v54,v52
v_mov_b32 v55,v52
v_mfma_f32_16x16x32_bf16 v[60:63],v[100:103],v[48:51],0
v_mfma_f32_16x16x32_bf16 v[64:67],v[12:15],v[52:55],v[64:67]
s_waitcnt lgkmcnt(0)
v_mfma_f32_16x16x32_bf16 v[56:59],v[112:115],v[52:55],v[56:59]
v_mfma_f32_16x16x32_bf16 v[60:63],v[116:119],v[52:55],v[60:63]
s_nop 0
v_rcp_f32 v66,v64
s_nop 2
v_pk_mul_f32 v[56:57],v[56:57],v[66:67] op_sel_hi:[1,0]
v_pk_mul_f32 v[58:59],v[58:59],v[66:67] op_sel_hi:[1,0]
s_nop 0
v_pk_mul_f32 v[60:61],v[60:61],v[66:67] op_sel_hi:[1,0]
v_pk_mul_f32 v[62:63],v[62:63],v[66:67] op_sel_hi:[1,0]
v_cvt_pk_bf16_f32 v120,v56,v57
v_cvt_pk_bf16_f32 v121,v58,v59
v_cvt_pk_bf16_f32 v122,v60,v61
v_cvt_pk_bf16_f32 v123,v62,v63
buffer_store_dwordx4 v[120:123],v6,s[20:23],s98 offen
s_barrier
ds_read_b128 v[48:51],v7 offset:20480
ds_read_b128 v[52:55],v7 offset:21504
ds_read_b128 v[56:59],v7 offset:22528
ds_read_b128 v[60:63],v7 offset:23552
ds_read_b128 v[64:67],v7 offset:24576
ds_read_b128 v[68:71],v7 offset:25600
ds_read_b128 v[72:75],v7 offset:26624
ds_read_b128 v[76:79],v7 offset:27648
ds_read_b128 v[80:83],v7 offset:28672
ds_read_b128 v[84:87],v7 offset:29696
ds_read_b128 v[88:91],v7 offset:30720
ds_read_b128 v[92:95],v7 offset:31744
v_mov_b32 v96,0
v_mov_b32 v97,0
v_mov_b32 v98,0
v_mov_b32 v99,0
v_mov_b32 v100,0
v_mov_b32 v101,0
v_mov_b32 v102,0
v_mov_b32 v103,0
s_nop 11
buffer_load_dwordx4 v[16:19],v0,s[20:23],s96 offen offset:0 sc1
v_mov_b32 v120,v5
v_mov_b32 v121,v5
v_mov_b32 v122,v5
v_mov_b32 v123,v5
s_nop 1
v_mfma_f32_16x16x32_bf16 v[112:115],v[120:123],v[112:115],0
buffer_load_dwordx4 v[20:23],v0,s[20:23],s96 offen offset:1024 sc1
v_mfma_f32_16x16x32_bf16 v[116:119],v[120:123],v[116:119],0
s_add_u32 s79,s79,1
s_and_b32 s64,s79,3
s_lshl_b32 s64,s64,19
s_lshl_b32 s65,s79,8
buffer_load_dwordx4 v[24:27],v0,s[20:23],s96 offen offset:2048 sc1
s_and_b32 s65,s65,0x2000
s_lshl_b32 s66,s79,16
s_xor_b32 s88,s73,s65
s_add_u32 s88,s88,s66
s_sub_u32 s88,s88,s54
s_add_u32 s89,s71,s64
s_add_u32 s92,s70,s64
s_xor_b32 s93,s72,s65
buffer_load_dwordx4 v[28:31],v0,s[20:23],s96 offen offset:3072 sc1
s_add_u32 s93,s93,s66
s_add_u32 s94,s76,s64
s_add_u32 s95,s94,4096
s_add_u32 s98,s75,s64
s_add_u32 s60,s74,s64
v_cvt_pk_bf16_f32 v112,v112,v113
v_cvt_pk_bf16_f32 v113,v114,v115
v_cvt_pk_bf16_f32 v114,v116,v117
buffer_load_dwordx4 v[32:35],v0,s[20:23],s97 offen offset:0 sc1
v_cvt_pk_bf16_f32 v115,v118,v119
s_nop 6
buffer_load_dwordx4 v[36:39],v0,s[20:23],s97 offen offset:1024 sc1
s_nop 7
buffer_load_dwordx4 v[40:43],v0,s[20:23],s97 offen offset:2048 sc1
s_nop 7
buffer_load_dwordx4 v[44:47],v0,s[20:23],s97 offen offset:3072 sc1
s_branch ogo_100426
w23_100425:
ds_read_b128 v[48:51],v2 offset:0
ds_read_b128 v[52:55],v2 offset:256
ds_read_b128 v[56:59],v2 offset:512
ds_read_b128 v[60:63],v2 offset:768
ds_read_b128 v[64:67],v2 offset:16
ds_read_b128 v[68:71],v2 offset:272
ds_read_b128 v[72:75],v2 offset:528
ds_read_b128 v[76:79],v2 offset:784
s_waitcnt lgkmcnt(6)
v_pk_add_f32 v[48:49],v[48:49],v[52:53]
v_pk_add_f32 v[50:51],v[50:51],v[54:55]
s_waitcnt lgkmcnt(4)
v_pk_add_f32 v[56:57],v[56:57],v[60:61]
v_pk_add_f32 v[58:59],v[58:59],v[62:63]
v_pk_add_f32 v[48:49],v[48:49],v[56:57]
v_pk_add_f32 v[50:51],v[50:51],v[58:59]
v_cvt_pk_bf16_f32 v112,v48,v49
v_cvt_pk_bf16_f32 v113,v50,v51
s_waitcnt lgkmcnt(2)
v_pk_add_f32 v[64:65],v[64:65],v[68:69]
v_pk_add_f32 v[66:67],v[66:67],v[70:71]
s_waitcnt lgkmcnt(0)
v_pk_add_f32 v[72:73],v[72:73],v[76:77]
v_pk_add_f32 v[74:75],v[74:75],v[78:79]
v_pk_add_f32 v[64:65],v[64:65],v[72:73]
v_pk_add_f32 v[66:67],v[66:67],v[74:75]
v_cvt_pk_bf16_f32 v114,v64,v65
v_cvt_pk_bf16_f32 v115,v66,v67
s_nop 1
v_mfma_f32_16x16x32_bf16 v[116:119],v[96:99],v[112:115],0
v_mfma_f32_16x16x32_bf16 v[120:123],v[100:103],v[112:115],0
v_mfma_f32_16x16x32_bf16 v[12:15],v[112:115],v[112:115],0
ds_read_b128 v[48:51],v7 offset:0
ds_read_b128 v[52:55],v7 offset:1024
ds_read_b128 v[56:59],v7 offset:2048
ds_read_b128 v[60:63],v7 offset:3072
ds_read_b128 v[64:67],v7 offset:4096
buffer_store_dwordx4 v[116:119],v3,s[20:23],s94 offen
buffer_store_dwordx4 v[120:123],v3,s[20:23],s94 offen offset:512
s_nop 0
buffer_store_dwordx4 v[12:15],v3,s[20:23],s94 offen offset:1024
ds_read_b128 v[68:71],v7 offset:5120
ds_read_b128 v[72:75],v7 offset:6144
ds_read_b128 v[76:79],v7 offset:7168
v_smfmac_f32_16x16x64_bf16 v[84:87],v[16:19],v[216:223],v1
v_smfmac_f32_16x16x64_bf16 v[84:87],v[32:35],v[216:223],v1
v_smfmac_f32_16x16x64_bf16 v[88:91],v[16:19],v[224:231],v1
v_smfmac_f32_16x16x64_bf16 v[88:91],v[32:35],v[224:231],v1
v_smfmac_f32_16x16x64_bf16 v[92:95],v[16:19],v[232:239],v1
v_smfmac_f32_16x16x64_bf16 v[92:95],v[32:35],v[232:239],v1
v_smfmac_f32_16x16x64_bf16 v[80:83],v[20:23],v[240:247],v1
v_smfmac_f32_16x16x64_bf16 v[80:83],v[36:39],v[240:247],v1
v_smfmac_f32_16x16x64_bf16 v[84:87],v[20:23],v[248:255],v1
v_smfmac_f32_16x16x64_bf16 v[84:87],v[36:39],v[248:255],v1
s_waitcnt lgkmcnt(6)
v_smfmac_f32_16x16x64_bf16 v[88:91],v[20:23],v[48:55],v1
v_smfmac_f32_16x16x64_bf16 v[88:91],v[36:39],v[48:55],v1
ds_read_b128 v[48:51],v7 offset:8192
ds_read_b128 v[52:55],v7 offset:9216
s_waitcnt lgkmcnt(6)
v_smfmac_f32_16x16x64_bf16 v[92:95],v[20:23],v[56:63],v1
v_smfmac_f32_16x16x64_bf16 v[92:95],v[36:39],v[56:63],v1
ds_read_b128 v[56:59],v7 offset:10240
ds_read_b128 v[60:63],v7 offset:11264
s_waitcnt lgkmcnt(6)
v_smfmac_f32_16x16x64_bf16 v[80:83],v[24:27],v[64:71],v1
v_smfmac_f32_16x16x64_bf16 v[80:83],v[40:43],v[64:71],v1
ds_read_b128 v[64:67],v7 offset:12288
ds_read_b128 v[68:71],v7 offset:13312
s_waitcnt lgkmcnt(6)
v_smfmac_f32_16x16x64_bf16 v[84:87],v[24:27],v[72:79],v1
v_smfmac_f32_16x16x64_bf16 v[84:87],v[40:43],v[72:79],v1
ds_read_b128 v[72:75],v7 offset:14336
ds_read_b128 v[76:79],v7 offset:15360
s_waitcnt lgkmcnt(6)
v_smfmac_f32_16x16x64_bf16 v[88:91],v[24:27],v[48:55],v1
v_smfmac_f32_16x16x64_bf16 v[88:91],v[40:43],v[48:55],v1
ds_read_b128 v[48:51],v7 offset:16384
ds_read_b128 v[52:55],v7 offset:17408
s_waitcnt lgkmcnt(6)
v_smfmac_f32_16x16x64_bf16 v[92:95],v[24:27],v[56:63],v1
v_smfmac_f32_16x16x64_bf16 v[92:95],v[40:43],v[56:63],v1
ds_read_b128 v[56:59],v7 offset:18432
ds_read_b128 v[60:63],v7 offset:19456
s_waitcnt lgkmcnt(6)
v_smfmac_f32_16x16x64_bf16 v[80:83],v[28:31],v[64:71],v1
v_smfmac_f32_16x16x64_bf16 v[80:83],v[44:47],v[64:71],v1
s_waitcnt lgkmcnt(4)
v_smfmac_f32_16x16x64_bf16 v[84:87],v[28:31],v[72:79],v1
v_smfmac_f32_16x16x64_bf16 v[84:87],v[44:47],v[72:79],v1
s_waitcnt lgkmcnt(2)
v_smfmac_f32_16x16x64_bf16 v[88:91],v[28:31],v[48:55],v1
v_add_f32 v80,v80,v81
v_smfmac_f32_16x16x64_bf16 v[88:91],v[44:47],v[48:55],v1
v_add_f32 v82,v82,v83
s_waitcnt lgkmcnt(0)
v_smfmac_f32_16x16x64_bf16 v[92:95],v[28:31],v[56:63],v1
v_cvt_pk_bf16_f32 v80,v80,v82
v_smfmac_f32_16x16x64_bf16 v[92:95],v[44:47],v[56:63],v1
ds_write_addtid_b32 v80 offset:16896
v_add_f32 v84,v84,v85
v_add_f32 v86,v86,v87
v_cvt_pk_bf16_f32 v84,v84,v86
v_add_f32 v88,v88,v89
v_add_f32 v90,v90,v91
v_cvt_pk_bf16_f32 v88,v88,v90
s_nop 0
v_add_f32 v92,v92,v93
v_add_f32 v94,v94,v95
v_cvt_pk_bf16_f32 v92,v92,v94
ds_write_addtid_b32 v84 offset:17920
ds_write_addtid_b32 v88 offset:18944
ds_write_addtid_b32 v92 offset:19968
s_waitcnt lgkmcnt(0)
s_barrier
ds_read_b128 v[48:51],v7 offset:20480
ds_read_b128 v[52:55],v7 offset:21504
ds_read_b128 v[56:59],v7 offset:22528
ds_read_b128 v[60:63],v7 offset:23552
ds_read_b128 v[64:67],v7 offset:24576
ds_read_b128 v[68:71],v7 offset:25600
ds_read_b128 v[72:75],v7 offset:26624
ds_read_b128 v[76:79],v7 offset:27648
ds_read_b128 v[80:83],v7 offset:28672
ds_read_b128 v[84:87],v7 offset:29696
ds_read_b128 v[88:91],v7 offset:30720
ds_read_b128 v[92:95],v7 offset:31744
s_add_u32 s65,s76,s100
s_add_u32 s66,s75,s100
s_add_u32 s64,s71,s100
s_cmp_eq_u32 s50,2
s_cselect_b32 s66,s66,s64
buffer_store_dwordx4 v[8:11],v0,s[20:23],s65 offen
s_cmp_eq_u32 s50,2
s_cselect_b32 exec_hi,-1,0
buffer_store_dwordx4 v[8:11],v0,s[20:23],s66 offen
s_mov_b32 exec_hi,0
buffer_store_dwordx4 v[8:11],v0,s[20:23],s65 offen offset:1024
s_mov_b64 exec,-1
v_mov_b32 v96,0
v_mov_b32 v97,0
v_mov_b32 v98,0
v_mov_b32 v99,0
v_mov_b32 v100,0
v_mov_b32 v101,0
v_mov_b32 v102,0
v_mov_b32 v103,0
s_barrier
s_nop 15
s_nop 15
s_nop 7
buffer_load_dwordx4 v[16:19],v0,s[20:23],s96 offen offset:0 sc1
s_add_u32 s79,s79,1
s_and_b32 s64,s79,3
s_lshl_b32 s64,s64,19
s_lshl_b32 s65,s79,8
s_and_b32 s65,s65,0x2000
s_lshl_b32 s66,s79,16
s_xor_b32 s88,s73,s65
s_add_u32 s88,s88,s66
buffer_load_dwordx4 v[20:23],v0,s[20:23],s96 offen offset:1024 sc1
s_sub_u32 s88,s88,s54
s_add_u32 s89,s71,s64
s_add_u32 s92,s70,s64
s_xor_b32 s93,s72,s65
s_add_u32 s93,s93,s66
s_add_u32 s94,s76,s64
s_add_u32 s95,s94,4096
s_add_u32 s98,s75,s64
buffer_load_dwordx4 v[24:27],v0,s[20:23],s96 offen offset:2048 sc1
s_add_u32 s60,s74,s64
s_nop 6
buffer_load_dwordx4 v[28:31],v0,s[20:23],s96 offen offset:3072 sc1
s_nop 7
buffer_load_dwordx4 v[32:35],v0,s[20:23],s97 offen offset:0 sc1
s_nop 7
buffer_load_dwordx4 v[36:39],v0,s[20:23],s97 offen offset:1024 sc1
s_nop 7
buffer_load_dwordx4 v[40:43],v0,s[20:23],s97 offen offset:2048 sc1
s_nop 7
buffer_load_dwordx4 v[44:47],v0,s[20:23],s97 offen offset:3072 sc1
ogo_100426:
s_waitcnt lgkmcnt(0)
s_waitcnt vmcnt(6)
v_max3_u32 v124,v16,v17,v18
v_max3_u32 v124,v124,v19,v20
v_max3_u32 v124,v124,v21,v22
v_max_u32 v124,v124,v23
v_cmp_eq_u32 vcc,-1,v124
s_cbranch_vccnz of_100431
v_smfmac_f32_16x16x64_bf16 v[96:99],v[16:19],v[48:55],v1
v_smfmac_f32_16x16x64_bf16 v[100:103],v[16:19],v[56:63],v1
v_smfmac_f32_16x16x64_bf16 v[96:99],v[20:23],v[64:71],v1
v_smfmac_f32_16x16x64_bf16 v[100:103],v[20:23],v[72:79],v1
v_readfirstlane_b32 s91,v126
s_waitcnt vmcnt(4)
v_max3_u32 v124,v24,v25,v26
v_max3_u32 v124,v124,v27,v28
v_max3_u32 v124,v124,v29,v30
v_max_u32 v124,v124,v31
v_cmp_eq_u32 vcc,-1,v124
s_cbranch_vccnz of_100432
v_smfmac_f32_16x16x64_bf16 v[96:99],v[24:27],v[80:87],v1
v_smfmac_f32_16x16x64_bf16 v[100:103],v[24:27],v[88:95],v1
v_smfmac_f32_16x16x64_bf16 v[96:99],v[28:31],v[128:135],v1
v_smfmac_f32_16x16x64_bf16 v[100:103],v[28:31],v[136:143],v1
s_waitcnt vmcnt(2)
v_max3_u32 v124,v32,v33,v34
v_max3_u32 v124,v124,v35,v36
v_max3_u32 v124,v124,v37,v38
v_max_u32 v124,v124,v39
v_cmp_eq_u32 vcc,-1,v124
s_cbranch_vccnz of_100433
v_smfmac_f32_16x16x64_bf16 v[96:99],v[32:35],v[144:151],v1
v_smfmac_f32_16x16x64_bf16 v[100:103],v[32:35],v[152:159],v1
v_smfmac_f32_16x16x64_bf16 v[96:99],v[36:39],v[160:167],v1
v_smfmac_f32_16x16x64_bf16 v[100:103],v[36:39],v[168:175],v1
s_waitcnt vmcnt(1)
v_max3_u32 v124,v40,v41,v42
v_max_u32 v124,v124,v43
v_cmp_eq_u32 vcc,-1,v124
s_cbranch_vccnz of_100434
v_smfmac_f32_16x16x64_bf16 v[96:99],v[40:43],v[176:183],v1
v_smfmac_f32_16x16x64_bf16 v[100:103],v[40:43],v[184:191],v1
s_waitcnt vmcnt(0)
v_max3_u32 v124,v44,v45,v46
v_max_u32 v124,v124,v47
v_cmp_eq_u32 vcc,-1,v124
s_cbranch_vccnz of_100435
v_smfmac_f32_16x16x64_bf16 v[96:99],v[44:47],v[192:199],v1
v_smfmac_f32_16x16x64_bf16 v[100:103],v[44:47],v[200:207],v1
oback_100442:
s_nop 4
v_add_f32 v96,v96,v97
v_add_f32 v98,v98,v99
s_nop 0
v_add_f32 v100,v100,v101
v_add_f32 v102,v102,v103
ds_write_addtid_b32 v96 offset:20992
ds_write_addtid_b32 v98 offset:23072
ds_write_addtid_b32 v100 offset:22016
ds_write_addtid_b32 v102 offset:24096
s_mov_b32 s96,s60
s_add_u32 s97,s60,4096
s_cmp_gt_u32 s50,1
s_waitcnt lgkmcnt(0)
s_barrier
s_cbranch_scc1 loop_100381
ds_read2st64_b32 v[48:49],v4 offset0:82 offset1:86
ds_read2st64_b32 v[50:51],v4 offset0:83 offset1:87
ds_read2st64_b32 v[52:53],v4 offset0:84 offset1:88
ds_read2st64_b32 v[54:55],v4 offset0:85 offset1:89
v_mov_b32 v96,v104
v_mov_b32 v97,v105
v_mov_b32 v98,v106
v_mov_b32 v99,v107
v_mov_b32 v100,v108
v_mov_b32 v101,v109
v_mov_b32 v102,v110
v_mov_b32 v103,v111
s_waitcnt lgkmcnt(2)
v_pk_add_f32 v[48:49],v[48:49],v[50:51]
s_waitcnt lgkmcnt(0)
v_pk_add_f32 v[52:53],v[52:53],v[54:55]
v_pk_add_f32 v[48:49],v[48:49],v[52:53]
v_cvt_pk_bf16_f32 v124,v48,v49
buffer_store_dword v124,v127,s[20:23],s89 offen
s_nop 7
buffer_store_dword v124,v127,s[20:23],s88 offen sc1
s_branch loop0_100385x
last_100382:
s_waitcnt vmcnt(3)
v_max3_u32 v124,v16,v17,v18
v_max_u32 v124,v124,v19
v_cmp_eq_u32 vcc,-1,v124
v_cndmask_b32 v120,2.0,v0,s[82:83]
v_cndmask_b32 v121,2.0,v127,s[86:87]
s_cbranch_vccnz flb_100467
seg_100443:
segb_100451:
v_smfmac_f32_16x16x64_bf16 v[64:67],v[16:19],a[32:39],v1
buffer_load_dword v125,off,s[20:23],s92 sc1
buffer_load_dwordx4 v[32:35],v0,s[20:23],s93 offen offset:0 sc1
s_waitcnt vmcnt(4)
v_max3_u32 v124,v20,v21,v22
v_smfmac_f32_16x16x64_bf16 v[68:71],v[16:19],a[40:47],v1
v_max_u32 v124,v124,v23
v_cmp_eq_u32 vcc,-1,v124
v_smfmac_f32_16x16x64_bf16 v[72:75],v[16:19],a[48:55],v1
v_smfmac_f32_16x16x64_bf16 v[76:79],v[16:19],a[56:63],v1
s_cbranch_vccnz fl_100460
seg_100444:
segb_100452:
v_smfmac_f32_16x16x64_bf16 v[64:67],v[20:23],a[96:103],v1
buffer_load_dword v125,off,s[20:23],s92 sc1
buffer_load_dwordx4 v[36:39],v0,s[20:23],s93 offen offset:1024 sc1
s_waitcnt vmcnt(5)
v_max3_u32 v124,v24,v25,v26
v_smfmac_f32_16x16x64_bf16 v[68:71],v[20:23],a[104:111],v1
v_max_u32 v124,v124,v27
v_cmp_eq_u32 vcc,-1,v124
v_smfmac_f32_16x16x64_bf16 v[72:75],v[20:23],a[112:119],v1
v_smfmac_f32_16x16x64_bf16 v[76:79],v[20:23],a[120:127],v1
s_cbranch_vccnz fl_100461
seg_100445:
segb_100453:
v_smfmac_f32_16x16x64_bf16 v[64:67],v[24:27],a[160:167],v1
buffer_load_dword v125,off,s[20:23],s92 sc1
buffer_load_dwordx4 v[40:43],v0,s[20:23],s93 offen offset:2048 sc1
buffer_load_dwordx4 v[44:47],v0,s[20:23],s93 offen offset:3072 sc1
s_waitcnt vmcnt(7)
v_max3_u32 v124,v28,v29,v30
v_smfmac_f32_16x16x64_bf16 v[68:71],v[24:27],a[168:175],v1
v_max_u32 v124,v124,v31
v_cmp_eq_u32 vcc,-1,v124
v_smfmac_f32_16x16x64_bf16 v[72:75],v[24:27],a[176:183],v1
v_smfmac_f32_16x16x64_bf16 v[76:79],v[24:27],a[184:191],v1
s_cbranch_vccnz fl_100462
seg_100446:
segb_100454:
v_smfmac_f32_16x16x64_bf16 v[64:67],v[28:31],a[224:231],v1
buffer_load_dword v125,off,s[20:23],s92 sc1
s_waitcnt vmcnt(6)
v_max3_u32 v124,v32,v33,v34
v_smfmac_f32_16x16x64_bf16 v[68:71],v[28:31],a[232:239],v1
v_max_u32 v124,v124,v35
v_cmp_eq_u32 vcc,-1,v124
v_smfmac_f32_16x16x64_bf16 v[72:75],v[28:31],a[240:247],v1
v_smfmac_f32_16x16x64_bf16 v[76:79],v[28:31],a[248:255],v1
s_cbranch_vccnz fl_100463
seg_100447:
segb_100455:
v_smfmac_f32_16x16x64_bf16 v[64:67],v[32:35],a[32:39],v1
buffer_load_dword v125,off,s[20:23],s92 sc1
buffer_store_dwordx4 v[112:115],v120,s[20:23],s101 offen sc1
buffer_store_dword v126,v121,s[20:23],s69 offen sc1
s_waitcnt vmcnt(7)
v_max3_u32 v124,v36,v37,v38
v_smfmac_f32_16x16x64_bf16 v[68:71],v[32:35],a[40:47],v1
v_max_u32 v124,v124,v39
v_cmp_eq_u32 vcc,-1,v124
v_smfmac_f32_16x16x64_bf16 v[72:75],v[32:35],a[48:55],v1
v_smfmac_f32_16x16x64_bf16 v[76:79],v[32:35],a[56:63],v1
s_cbranch_vccnz fl_100464
seg_100448:
segb_100456:
v_smfmac_f32_16x16x64_bf16 v[64:67],v[36:39],a[96:103],v1
buffer_load_dword v125,off,s[20:23],s92 sc1
s_waitcnt vmcnt(5)
v_max3_u32 v124,v40,v41,v42
v_smfmac_f32_16x16x64_bf16 v[68:71],v[36:39],a[104:111],v1
v_max3_u32 v124,v124,v43,v44
v_max3_u32 v124,v124,v45,v46
v_max_u32 v124,v124,v47
v_cmp_eq_u32 vcc,-1,v124
v_smfmac_f32_16x16x64_bf16 v[72:75],v[36:39],a[112:119],v1
v_smfmac_f32_16x16x64_bf16 v[76:79],v[36:39],a[120:127],v1
s_cbranch_vccnz fl_100465
seg_100449:
segb_100457:
v_smfmac_f32_16x16x64_bf16 v[64:67],v[40:43],a[160:167],v1
v_smfmac_f32_16x16x64_bf16 v[68:71],v[40:43],a[168:175],v1
v_smfmac_f32_16x16x64_bf16 v[64:67],v[44:47],a[224:231],v1
v_smfmac_f32_16x16x64_bf16 v[68:71],v[44:47],a[232:239],v1
v_smfmac_f32_16x16x64_bf16 v[72:75],v[40:43],a[176:183],v1
s_nop 1
v_add_f32 v64,v64,v65
v_smfmac_f32_16x16x64_bf16 v[76:79],v[40:43],a[184:191],v1
ds_write_addtid_b32 v64 offset:8448
v_add_f32 v66,v66,v67
v_smfmac_f32_16x16x64_bf16 v[72:75],v[44:47],a[240:247],v1
ds_write_addtid_b32 v66 offset:9488
v_add_f32 v68,v68,v69
v_smfmac_f32_16x16x64_bf16 v[76:79],v[44:47],a[248:255],v1
ds_write_addtid_b32 v68 offset:10528
v_add_f32 v70,v70,v71
v_smfmac_f32_16x16x64_bf16 v[80:83],v[16:19],v[208:215],v1
ds_write_addtid_b32 v70 offset:11568
v_add_f32 v72,v72,v73
v_smfmac_f32_16x16x64_bf16 v[80:83],v[32:35],v[208:215],v1
ds_write_addtid_b32 v72 offset:12608
v_add_f32 v74,v74,v75
v_smfmac_f32_16x16x64_bf16 v[84:87],v[16:19],v[216:223],v1
ds_write_addtid_b32 v74 offset:13648
v_add_f32 v76,v76,v77
v_smfmac_f32_16x16x64_bf16 v[84:87],v[32:35],v[216:223],v1
ds_write_addtid_b32 v76 offset:14688
v_add_f32 v78,v78,v79
v_smfmac_f32_16x16x64_bf16 v[88:91],v[16:19],v[224:231],v1
ds_write_addtid_b32 v78 offset:15728
v_smfmac_f32_16x16x64_bf16 v[88:91],v[32:35],v[224:231],v1
v_smfmac_f32_16x16x64_bf16 v[92:95],v[16:19],v[232:239],v1
v_smfmac_f32_16x16x64_bf16 v[92:95],v[32:35],v[232:239],v1
doneA_100476:
s_waitcnt vmcnt(0) lgkmcnt(0)
s_add_u32 s64,s79,0
s_lshl_b32 s65,s64,12
s_and_b32 s65,s65,0x2000
s_xor_b32 s65,s65,s67
s_lshl_b32 s64,s64,20
s_add_u32 s65,s65,s64
s_add_u32 s101,s65,s78
v_smfmac_f32_16x16x64_bf16 v[80:83],v[20:23],v[240:247],v1
ds_read_b128 v[48:51],v7 offset:0
ds_read_b128 v[52:55],v7 offset:1024
v_smfmac_f32_16x16x64_bf16 v[80:83],v[36:39],v[240:247],v1
ds_read_b128 v[56:59],v7 offset:2048
ds_read_b128 v[60:63],v7 offset:3072
v_smfmac_f32_16x16x64_bf16 v[84:87],v[20:23],v[248:255],v1
ds_read_b128 v[64:67],v7 offset:4096
ds_read_b128 v[68:71],v7 offset:5120
v_smfmac_f32_16x16x64_bf16 v[84:87],v[36:39],v[248:255],v1
ds_read_b128 v[72:75],v7 offset:6144
ds_read_b128 v[76:79],v7 offset:7168
s_waitcnt lgkmcnt(6)
v_smfmac_f32_16x16x64_bf16 v[88:91],v[20:23],v[48:55],v1
v_smfmac_f32_16x16x64_bf16 v[88:91],v[36:39],v[48:55],v1
ds_read_b128 v[48:51],v7 offset:8192
ds_read_b128 v[52:55],v7 offset:9216
s_waitcnt lgkmcnt(6)
v_smfmac_f32_16x16x64_bf16 v[92:95],v[20:23],v[56:63],v1
v_smfmac_f32_16x16x64_bf16 v[92:95],v[36:39],v[56:63],v1
ds_read_b128 v[56:59],v7 offset:10240
ds_read_b128 v[60:63],v7 offset:11264
s_waitcnt lgkmcnt(6)
v_smfmac_f32_16x16x64_bf16 v[80:83],v[24:27],v[64:71],v1
v_smfmac_f32_16x16x64_bf16 v[80:83],v[40:43],v[64:71],v1
ds_read_b128 v[64:67],v7 offset:12288
ds_read_b128 v[68:71],v7 offset:13312
s_waitcnt lgkmcnt(6)
v_smfmac_f32_16x16x64_bf16 v[84:87],v[24:27],v[72:79],v1
v_smfmac_f32_16x16x64_bf16 v[84:87],v[40:43],v[72:79],v1
ds_read_b128 v[72:75],v7 offset:14336
ds_read_b128 v[76:79],v7 offset:15360
s_waitcnt lgkmcnt(6)
v_smfmac_f32_16x16x64_bf16 v[88:91],v[24:27],v[48:55],v1
v_smfmac_f32_16x16x64_bf16 v[88:91],v[40:43],v[48:55],v1
ds_read_b128 v[48:51],v7 offset:16384
ds_read_b128 v[52:55],v7 offset:17408
s_waitcnt lgkmcnt(6)
v_smfmac_f32_16x16x64_bf16 v[92:95],v[24:27],v[56:63],v1
v_smfmac_f32_16x16x64_bf16 v[92:95],v[40:43],v[56:63],v1
ds_read_b128 v[56:59],v7 offset:18432
ds_read_b128 v[60:63],v7 offset:19456
s_waitcnt lgkmcnt(6)
v_smfmac_f32_16x16x64_bf16 v[80:83],v[28:31],v[64:71],v1
v_smfmac_f32_16x16x64_bf16 v[80:83],v[44:47],v[64:71],v1
s_waitcnt lgkmcnt(4)
v_smfmac_f32_16x16x64_bf16 v[84:87],v[28:31],v[72:79],v1
v_smfmac_f32_16x16x64_bf16 v[84:87],v[44:47],v[72:79],v1
s_waitcnt lgkmcnt(2)
v_smfmac_f32_16x16x64_bf16 v[88:91],v[28:31],v[48:55],v1
v_add_f32 v80,v80,v81
v_smfmac_f32_16x16x64_bf16 v[88:91],v[44:47],v[48:55],v1
v_add_f32 v82,v82,v83
s_waitcnt lgkmcnt(0)
v_smfmac_f32_16x16x64_bf16 v[92:95],v[28:31],v[56:63],v1
v_cvt_pk_bf16_f32 v80,v80,v82
v_smfmac_f32_16x16x64_bf16 v[92:95],v[44:47],v[56:63],v1
ds_write_addtid_b32 v80 offset:16896
v_add_f32 v84,v84,v85
v_add_f32 v86,v86,v87
v_cvt_pk_bf16_f32 v84,v84,v86
v_add_f32 v88,v88,v89
v_add_f32 v90,v90,v91
v_cvt_pk_bf16_f32 v88,v88,v90
s_nop 0
v_add_f32 v92,v92,v93
v_add_f32 v94,v94,v95
v_cvt_pk_bf16_f32 v92,v92,v94
ds_write_addtid_b32 v84 offset:17920
ds_write_addtid_b32 v88 offset:18944
ds_write_addtid_b32 v92 offset:19968
s_waitcnt lgkmcnt(0)
s_barrier
s_cmp_gt_u32 s50,1
s_cbranch_scc1 l23_100477
ds_read2st64_b32 v[112:113],v127 offset0:66 offset1:67
ds_read2st64_b32 v[114:115],v127 offset0:68 offset1:69
ds_read2st64_b32 v[116:117],v127 offset0:70 offset1:71
ds_read2st64_b32 v[118:119],v127 offset0:72 offset1:73
s_waitcnt lgkmcnt(0)
v_mov_b32 v120,v5
v_mov_b32 v121,v5
v_mov_b32 v122,v5
v_mov_b32 v123,v5
s_nop 1
v_mfma_f32_16x16x32_bf16 v[112:115],v[120:123],v[112:115],0
v_mfma_f32_16x16x32_bf16 v[116:119],v[120:123],v[116:119],0
s_nop 4
v_cvt_pk_bf16_f32 v112,v112,v113
v_cvt_pk_bf16_f32 v113,v114,v115
s_nop 0
v_cvt_pk_bf16_f32 v114,v116,v117
v_cvt_pk_bf16_f32 v115,v118,v119
s_branch lj_100478
l23_100477:
ds_read_b128 v[48:51],v2 offset:0
ds_read_b128 v[52:55],v2 offset:256
ds_read_b128 v[56:59],v2 offset:512
ds_read_b128 v[60:63],v2 offset:768
ds_read_b128 v[64:67],v2 offset:16
ds_read_b128 v[68:71],v2 offset:272
ds_read_b128 v[72:75],v2 offset:528
ds_read_b128 v[76:79],v2 offset:784
s_waitcnt lgkmcnt(6)
v_pk_add_f32 v[48:49],v[48:49],v[52:53]
v_pk_add_f32 v[50:51],v[50:51],v[54:55]
s_waitcnt lgkmcnt(4)
v_pk_add_f32 v[56:57],v[56:57],v[60:61]
v_pk_add_f32 v[58:59],v[58:59],v[62:63]
v_pk_add_f32 v[48:49],v[48:49],v[56:57]
v_pk_add_f32 v[50:51],v[50:51],v[58:59]
v_cvt_pk_bf16_f32 v112,v48,v49
v_cvt_pk_bf16_f32 v113,v50,v51
s_waitcnt lgkmcnt(2)
v_pk_add_f32 v[64:65],v[64:65],v[68:69]
v_pk_add_f32 v[66:67],v[66:67],v[70:71]
s_waitcnt lgkmcnt(0)
v_pk_add_f32 v[72:73],v[72:73],v[76:77]
v_pk_add_f32 v[74:75],v[74:75],v[78:79]
v_pk_add_f32 v[64:65],v[64:65],v[72:73]
v_pk_add_f32 v[66:67],v[66:67],v[74:75]
v_cvt_pk_bf16_f32 v114,v64,v65
v_cvt_pk_bf16_f32 v115,v66,v67
lj_100478:
v_cndmask_b32 v120,2.0,v0,s[82:83]
v_cndmask_b32 v121,2.0,v127,s[86:87]
buffer_store_dwordx4 v[112:115],v120,s[20:23],s101 offen sc1
s_waitcnt vmcnt(0)
s_barrier
v_mov_b32 v126,64
buffer_store_dword v126,v121,s[20:23],s69 offen sc1
s_branch recfin_100374
flp_100387:
buffer_load_dword v124,off,s[20:23],s68 sc1
s_waitcnt vmcnt(0)
v_readfirstlane_b32 s91,v124
s_cmp_gt_u32 s91,s64
s_cbranch_scc1 fok_100386
s_sleep 2
s_sub_u32 s90,s90,1
s_cmp_gt_i32 s90,0
s_cbranch_scc1 flp_100387
s_branch fok_100386
flp_100390:
buffer_load_dword v124,off,s[20:23],s68 sc1
s_waitcnt vmcnt(0)
v_readfirstlane_b32 s91,v124
s_cmp_gt_u32 s91,s64
s_cbranch_scc1 fok_100389
s_sleep 2
s_sub_u32 s90,s90,1
s_cmp_gt_i32 s90,0
s_cbranch_scc1 flp_100390
s_branch fok_100389
fl_100407:
flb_100415:
buffer_load_dwordx4 v[16:19],v0,s[20:23],s92 offen offset:0 sc1
s_mov_b32 s55,1
buffer_load_dwordx4 v[32:35],v0,s[20:23],s93 offen offset:0 sc1
s_waitcnt vmcnt(4)
v_max3_u32 v124,v20,v21,v22
v_max_u32 v124,v124,v23
v_cmp_eq_u32 vcc,-1,v124
s_cbranch_vccnz dfl_100479
v_smfmac_f32_16x16x64_bf16 v[48:51],v[20:23],a[64:71],v1
buffer_load_dword v125,off,s[20:23],s92 sc1
v_smfmac_f32_16x16x64_bf16 v[52:55],v[20:23],a[72:79],v1
buffer_load_dwordx4 v[36:39],v0,s[20:23],s93 offen offset:1024 sc1
v_smfmac_f32_16x16x64_bf16 v[56:59],v[20:23],a[80:87],v1
s_waitcnt vmcnt(5)
v_max3_u32 v124,v24,v25,v26
v_smfmac_f32_16x16x64_bf16 v[60:63],v[20:23],a[88:95],v1
v_max_u32 v124,v124,v27
v_smfmac_f32_16x16x64_bf16 v[64:67],v[20:23],a[96:103],v1
v_cmp_eq_u32 vcc,-1,v124
v_smfmac_f32_16x16x64_bf16 v[68:71],v[20:23],a[104:111],v1
v_smfmac_f32_16x16x64_bf16 v[72:75],v[20:23],a[112:119],v1
v_smfmac_f32_16x16x64_bf16 v[76:79],v[20:23],a[120:127],v1
s_cbranch_vccnz dfl_100480
v_smfmac_f32_16x16x64_bf16 v[48:51],v[24:27],a[128:135],v1
buffer_load_dword v125,off,s[20:23],s92 sc1
v_smfmac_f32_16x16x64_bf16 v[52:55],v[24:27],a[136:143],v1
buffer_load_dwordx4 v[40:43],v0,s[20:23],s93 offen offset:2048 sc1
v_smfmac_f32_16x16x64_bf16 v[56:59],v[24:27],a[144:151],v1
buffer_load_dwordx4 v[44:47],v0,s[20:23],s93 offen offset:3072 sc1
s_waitcnt vmcnt(7)
v_max3_u32 v124,v28,v29,v30
v_smfmac_f32_16x16x64_bf16 v[60:63],v[24:27],a[152:159],v1
v_max_u32 v124,v124,v31
v_smfmac_f32_16x16x64_bf16 v[64:67],v[24:27],a[160:167],v1
v_cmp_eq_u32 vcc,-1,v124
v_smfmac_f32_16x16x64_bf16 v[68:71],v[24:27],a[168:175],v1
v_smfmac_f32_16x16x64_bf16 v[72:75],v[24:27],a[176:183],v1
v_smfmac_f32_16x16x64_bf16 v[76:79],v[24:27],a[184:191],v1
s_cbranch_vccnz dfl_100481
v_smfmac_f32_16x16x64_bf16 v[48:51],v[28:31],a[192:199],v1
buffer_load_dword v125,off,s[20:23],s92 sc1
v_smfmac_f32_16x16x64_bf16 v[52:55],v[28:31],a[200:207],v1
v_smfmac_f32_16x16x64_bf16 v[56:59],v[28:31],a[208:215],v1
s_waitcnt vmcnt(7)
v_max3_u32 v124,v16,v17,v18
v_smfmac_f32_16x16x64_bf16 v[60:63],v[28:31],a[216:223],v1
v_max_u32 v124,v124,v19
v_smfmac_f32_16x16x64_bf16 v[64:67],v[28:31],a[224:231],v1
v_cmp_eq_u32 vcc,-1,v124
v_smfmac_f32_16x16x64_bf16 v[68:71],v[28:31],a[232:239],v1
v_smfmac_f32_16x16x64_bf16 v[72:75],v[28:31],a[240:247],v1
v_smfmac_f32_16x16x64_bf16 v[76:79],v[28:31],a[248:255],v1
s_cbranch_vccnz lfb_100486
s_mov_b32 s55,0
v_smfmac_f32_16x16x64_bf16 v[48:51],v[16:19],a[0:7],v1
v_smfmac_f32_16x16x64_bf16 v[52:55],v[16:19],a[8:15],v1
v_smfmac_f32_16x16x64_bf16 v[56:59],v[16:19],a[16:23],v1
s_waitcnt vmcnt(6)
v_max3_u32 v124,v32,v33,v34
v_max_u32 v124,v124,v35
v_cmp_eq_u32 vcc,-1,v124
v_smfmac_f32_16x16x64_bf16 v[60:63],v[16:19],a[24:31],v1
v_smfmac_f32_16x16x64_bf16 v[64:67],v[16:19],a[32:39],v1
v_smfmac_f32_16x16x64_bf16 v[68:71],v[16:19],a[40:47],v1
v_smfmac_f32_16x16x64_bf16 v[72:75],v[16:19],a[48:55],v1
v_smfmac_f32_16x16x64_bf16 v[76:79],v[16:19],a[56:63],v1
s_cbranch_vccnz flb_100419
s_branch segb_100403
fl_100408:
v_smfmac_f32_16x16x64_bf16 v[76:79],v[16:19],a[56:63],v1
flb_100416:
buffer_load_dwordx4 v[20:23],v0,s[20:23],s92 offen offset:1024 sc1
s_mov_b32 s55,2
buffer_load_dwordx4 v[36:39],v0,s[20:23],s93 offen offset:1024 sc1
s_waitcnt vmcnt(5)
v_max3_u32 v124,v24,v25,v26
v_max_u32 v124,v124,v27
v_cmp_eq_u32 vcc,-1,v124
s_cbranch_vccnz dfl_100480
v_smfmac_f32_16x16x64_bf16 v[48:51],v[24:27],a[128:135],v1
buffer_load_dword v125,off,s[20:23],s92 sc1
v_smfmac_f32_16x16x64_bf16 v[52:55],v[24:27],a[136:143],v1
buffer_load_dwordx4 v[40:43],v0,s[20:23],s93 offen offset:2048 sc1
v_smfmac_f32_16x16x64_bf16 v[56:59],v[24:27],a[144:151],v1
buffer_load_dwordx4 v[44:47],v0,s[20:23],s93 offen offset:3072 sc1
s_waitcnt vmcnt(7)
v_max3_u32 v124,v28,v29,v30
v_smfmac_f32_16x16x64_bf16 v[60:63],v[24:27],a[152:159],v1
v_max_u32 v124,v124,v31
v_smfmac_f32_16x16x64_bf16 v[64:67],v[24:27],a[160:167],v1
v_cmp_eq_u32 vcc,-1,v124
v_smfmac_f32_16x16x64_bf16 v[68:71],v[24:27],a[168:175],v1
v_smfmac_f32_16x16x64_bf16 v[72:75],v[24:27],a[176:183],v1
v_smfmac_f32_16x16x64_bf16 v[76:79],v[24:27],a[184:191],v1
s_cbranch_vccnz dfl_100481
v_smfmac_f32_16x16x64_bf16 v[48:51],v[28:31],a[192:199],v1
buffer_load_dword v125,off,s[20:23],s92 sc1
v_smfmac_f32_16x16x64_bf16 v[52:55],v[28:31],a[200:207],v1
v_smfmac_f32_16x16x64_bf16 v[56:59],v[28:31],a[208:215],v1
s_waitcnt vmcnt(5)
v_max3_u32 v124,v20,v21,v22
v_smfmac_f32_16x16x64_bf16 v[60:63],v[28:31],a[216:223],v1
v_max_u32 v124,v124,v23
v_smfmac_f32_16x16x64_bf16 v[64:67],v[28:31],a[224:231],v1
v_cmp_eq_u32 vcc,-1,v124
v_smfmac_f32_16x16x64_bf16 v[68:71],v[28:31],a[232:239],v1
v_smfmac_f32_16x16x64_bf16 v[72:75],v[28:31],a[240:247],v1
v_smfmac_f32_16x16x64_bf16 v[76:79],v[28:31],a[248:255],v1
s_cbranch_vccnz lfb_100486
s_mov_b32 s55,0
v_smfmac_f32_16x16x64_bf16 v[48:51],v[20:23],a[64:71],v1
v_smfmac_f32_16x16x64_bf16 v[52:55],v[20:23],a[72:79],v1
v_smfmac_f32_16x16x64_bf16 v[56:59],v[20:23],a[80:87],v1
s_waitcnt vmcnt(6)
v_max3_u32 v124,v32,v33,v34
v_max_u32 v124,v124,v35
v_cmp_eq_u32 vcc,-1,v124
v_smfmac_f32_16x16x64_bf16 v[60:63],v[20:23],a[88:95],v1
v_smfmac_f32_16x16x64_bf16 v[64:67],v[20:23],a[96:103],v1
v_smfmac_f32_16x16x64_bf16 v[68:71],v[20:23],a[104:111],v1
v_smfmac_f32_16x16x64_bf16 v[72:75],v[20:23],a[112:119],v1
v_smfmac_f32_16x16x64_bf16 v[76:79],v[20:23],a[120:127],v1
s_cbranch_vccnz flb_100419
s_branch segb_100403
fl_100409:
v_smfmac_f32_16x16x64_bf16 v[76:79],v[20:23],a[120:127],v1
flb_100417:
buffer_load_dwordx4 v[24:27],v0,s[20:23],s92 offen offset:2048 sc1
s_mov_b32 s55,4
buffer_load_dwordx4 v[40:43],v0,s[20:23],s93 offen offset:2048 sc1
buffer_load_dwordx4 v[44:47],v0,s[20:23],s93 offen offset:3072 sc1
s_waitcnt vmcnt(7)
v_max3_u32 v124,v28,v29,v30
v_max_u32 v124,v124,v31
v_cmp_eq_u32 vcc,-1,v124
s_cbranch_vccnz dfl_100481
v_smfmac_f32_16x16x64_bf16 v[48:51],v[28:31],a[192:199],v1
buffer_load_dword v125,off,s[20:23],s92 sc1
v_smfmac_f32_16x16x64_bf16 v[52:55],v[28:31],a[200:207],v1
v_smfmac_f32_16x16x64_bf16 v[56:59],v[28:31],a[208:215],v1
s_waitcnt vmcnt(3)
v_max3_u32 v124,v24,v25,v26
v_smfmac_f32_16x16x64_bf16 v[60:63],v[28:31],a[216:223],v1
v_max_u32 v124,v124,v27
v_smfmac_f32_16x16x64_bf16 v[64:67],v[28:31],a[224:231],v1
v_cmp_eq_u32 vcc,-1,v124
v_smfmac_f32_16x16x64_bf16 v[68:71],v[28:31],a[232:239],v1
v_smfmac_f32_16x16x64_bf16 v[72:75],v[28:31],a[240:247],v1
v_smfmac_f32_16x16x64_bf16 v[76:79],v[28:31],a[248:255],v1
s_cbranch_vccnz lfb_100486
s_mov_b32 s55,0
v_smfmac_f32_16x16x64_bf16 v[48:51],v[24:27],a[128:135],v1
v_smfmac_f32_16x16x64_bf16 v[52:55],v[24:27],a[136:143],v1
v_smfmac_f32_16x16x64_bf16 v[56:59],v[24:27],a[144:151],v1
s_waitcnt vmcnt(6)
v_max3_u32 v124,v32,v33,v34
v_max_u32 v124,v124,v35
v_cmp_eq_u32 vcc,-1,v124
v_smfmac_f32_16x16x64_bf16 v[60:63],v[24:27],a[152:159],v1
v_smfmac_f32_16x16x64_bf16 v[64:67],v[24:27],a[160:167],v1
v_smfmac_f32_16x16x64_bf16 v[68:71],v[24:27],a[168:175],v1
v_smfmac_f32_16x16x64_bf16 v[72:75],v[24:27],a[176:183],v1
v_smfmac_f32_16x16x64_bf16 v[76:79],v[24:27],a[184:191],v1
s_cbranch_vccnz flb_100419
s_branch segb_100403
fl_100410:
v_smfmac_f32_16x16x64_bf16 v[76:79],v[24:27],a[184:191],v1
flb_100418:
buffer_load_dwordx4 v[28:31],v0,s[20:23],s92 offen offset:3072 sc1
s_mov_b32 s55,8
s_waitcnt vmcnt(0)
v_max3_u32 v124,v28,v29,v30
v_max_u32 v124,v124,v31
v_cmp_eq_u32 vcc,-1,v124
s_cbranch_vccnz lfb_100486
s_mov_b32 s55,0
v_smfmac_f32_16x16x64_bf16 v[48:51],v[28:31],a[192:199],v1
v_smfmac_f32_16x16x64_bf16 v[52:55],v[28:31],a[200:207],v1
v_smfmac_f32_16x16x64_bf16 v[56:59],v[28:31],a[208:215],v1
s_waitcnt vmcnt(6)
v_max3_u32 v124,v32,v33,v34
v_max_u32 v124,v124,v35
v_cmp_eq_u32 vcc,-1,v124
v_smfmac_f32_16x16x64_bf16 v[60:63],v[28:31],a[216:223],v1
v_smfmac_f32_16x16x64_bf16 v[64:67],v[28:31],a[224:231],v1
v_smfmac_f32_16x16x64_bf16 v[68:71],v[28:31],a[232:239],v1
v_smfmac_f32_16x16x64_bf16 v[72:75],v[28:31],a[240:247],v1
v_smfmac_f32_16x16x64_bf16 v[76:79],v[28:31],a[248:255],v1
s_cbranch_vccnz flb_100419
s_branch segb_100403
fl_100411:
v_smfmac_f32_16x16x64_bf16 v[76:79],v[28:31],a[248:255],v1
flb_100419:
buffer_load_dwordx4 v[32:35],v0,s[20:23],s93 offen offset:0 sc1
s_mov_b32 s55,240
buffer_store_dwordx4 v[112:115],v120,s[20:23],s101 offen sc1
buffer_store_dword v126,v121,s[20:23],s69 offen sc1
s_bitcmp1_b32 s55,5
s_cbranch_scc0 rdn_100489
s_waitcnt vmcnt(7)
v_max3_u32 v124,v36,v37,v38
v_max_u32 v124,v124,v39
v_cmp_eq_u32 vcc,-1,v124
s_cbranch_vccnz rfa_100490
buffer_load_dword v125,off,s[20:23],s92 sc1
s_bitset0_b32 s55,5
v_smfmac_f32_16x16x64_bf16 v[48:51],v[36:39],a[64:71],v1
v_smfmac_f32_16x16x64_bf16 v[52:55],v[36:39],a[72:79],v1
v_smfmac_f32_16x16x64_bf16 v[56:59],v[36:39],a[80:87],v1
v_smfmac_f32_16x16x64_bf16 v[60:63],v[36:39],a[88:95],v1
v_smfmac_f32_16x16x64_bf16 v[64:67],v[36:39],a[96:103],v1
v_smfmac_f32_16x16x64_bf16 v[68:71],v[36:39],a[104:111],v1
v_smfmac_f32_16x16x64_bf16 v[72:75],v[36:39],a[112:119],v1
v_smfmac_f32_16x16x64_bf16 v[76:79],v[36:39],a[120:127],v1
s_cmp_eq_u32 s55,0
s_cbranch_scc1 segb_100405
s_branch rnx_100491
rdn_100489:
buffer_load_dword v125,off,s[20:23],s92 sc1
s_branch rnx_100491
rfa_100490:
buffer_load_dwordx4 v[36:39],v0,s[20:23],s93 offen offset:1024 sc1
rnx_100491:
s_bitcmp1_b32 s55,6
s_cbranch_scc0 rdn_100492
s_waitcnt vmcnt(6)
v_max3_u32 v124,v40,v41,v42
v_max_u32 v124,v124,v43
v_cmp_eq_u32 vcc,-1,v124
s_cbranch_vccnz rfa_100493
buffer_load_dword v125,off,s[20:23],s92 sc1
s_bitset0_b32 s55,6
s_cmp_eq_u32 s55,0
s_cbranch_scc1 segb_100405
s_branch rnx_100494
rdn_100492:
buffer_load_dword v125,off,s[20:23],s92 sc1
s_branch rnx_100494
rfa_100493:
buffer_load_dwordx4 v[40:43],v0,s[20:23],s93 offen offset:2048 sc1
rnx_100494:
s_bitcmp1_b32 s55,7
s_cbranch_scc0 rdn_100495
s_waitcnt vmcnt(6)
v_max3_u32 v124,v44,v45,v46
v_max_u32 v124,v124,v47
v_cmp_eq_u32 vcc,-1,v124
s_cbranch_vccnz rfa_100496
buffer_load_dword v125,off,s[20:23],s92 sc1
s_bitset0_b32 s55,7
s_cmp_eq_u32 s55,0
s_cbranch_scc1 segb_100405
s_branch rnx_100497
rdn_100495:
buffer_load_dword v125,off,s[20:23],s92 sc1
s_branch rnx_100497
rfa_100496:
buffer_load_dwordx4 v[44:47],v0,s[20:23],s93 offen offset:3072 sc1
rnx_100497:
rot_100488:
s_bitcmp1_b32 s55,4
s_cbranch_scc0 rdn_100498
s_waitcnt vmcnt(3)
v_max3_u32 v124,v32,v33,v34
v_max_u32 v124,v124,v35
v_cmp_eq_u32 vcc,-1,v124
s_cbranch_vccnz rfa_100499
buffer_load_dword v125,off,s[20:23],s92 sc1
s_bitset0_b32 s55,4
v_smfmac_f32_16x16x64_bf16 v[48:51],v[32:35],a[0:7],v1
v_smfmac_f32_16x16x64_bf16 v[52:55],v[32:35],a[8:15],v1
v_smfmac_f32_16x16x64_bf16 v[56:59],v[32:35],a[16:23],v1
v_smfmac_f32_16x16x64_bf16 v[60:63],v[32:35],a[24:31],v1
v_smfmac_f32_16x16x64_bf16 v[64:67],v[32:35],a[32:39],v1
v_smfmac_f32_16x16x64_bf16 v[68:71],v[32:35],a[40:47],v1
v_smfmac_f32_16x16x64_bf16 v[72:75],v[32:35],a[48:55],v1
v_smfmac_f32_16x16x64_bf16 v[76:79],v[32:35],a[56:63],v1
s_cmp_eq_u32 s55,0
s_cbranch_scc1 segb_100405
s_branch rnx_100500
rdn_100498:
buffer_load_dword v125,off,s[20:23],s92 sc1
s_branch rnx_100500
rfa_100499:
buffer_load_dwordx4 v[32:35],v0,s[20:23],s93 offen offset:0 sc1
rnx_100500:
s_bitcmp1_b32 s55,5
s_cbranch_scc0 rdn_100501
s_waitcnt vmcnt(3)
v_max3_u32 v124,v36,v37,v38
v_max_u32 v124,v124,v39
v_cmp_eq_u32 vcc,-1,v124
s_cbranch_vccnz rfa_100502
buffer_load_dword v125,off,s[20:23],s92 sc1
s_bitset0_b32 s55,5
v_smfmac_f32_16x16x64_bf16 v[48:51],v[36:39],a[64:71],v1
v_smfmac_f32_16x16x64_bf16 v[52:55],v[36:39],a[72:79],v1
v_smfmac_f32_16x16x64_bf16 v[56:59],v[36:39],a[80:87],v1
v_smfmac_f32_16x16x64_bf16 v[60:63],v[36:39],a[88:95],v1
v_smfmac_f32_16x16x64_bf16 v[64:67],v[36:39],a[96:103],v1
v_smfmac_f32_16x16x64_bf16 v[68:71],v[36:39],a[104:111],v1
v_smfmac_f32_16x16x64_bf16 v[72:75],v[36:39],a[112:119],v1
v_smfmac_f32_16x16x64_bf16 v[76:79],v[36:39],a[120:127],v1
s_cmp_eq_u32 s55,0
s_cbranch_scc1 segb_100405
s_branch rnx_100503
rdn_100501:
buffer_load_dword v125,off,s[20:23],s92 sc1
s_branch rnx_100503
rfa_100502:
buffer_load_dwordx4 v[36:39],v0,s[20:23],s93 offen offset:1024 sc1
rnx_100503:
s_bitcmp1_b32 s55,6
s_cbranch_scc0 rdn_100504
s_waitcnt vmcnt(3)
v_max3_u32 v124,v40,v41,v42
v_max_u32 v124,v124,v43
v_cmp_eq_u32 vcc,-1,v124
s_cbranch_vccnz rfa_100505
buffer_load_dword v125,off,s[20:23],s92 sc1
s_bitset0_b32 s55,6
s_cmp_eq_u32 s55,0
s_cbranch_scc1 segb_100405
s_branch rnx_100506
rdn_100504:
buffer_load_dword v125,off,s[20:23],s92 sc1
s_branch rnx_100506
rfa_100505:
buffer_load_dwordx4 v[40:43],v0,s[20:23],s93 offen offset:2048 sc1
rnx_100506:
s_bitcmp1_b32 s55,7
s_cbranch_scc0 rdn_100507
s_waitcnt vmcnt(3)
v_max3_u32 v124,v44,v45,v46
v_max_u32 v124,v124,v47
v_cmp_eq_u32 vcc,-1,v124
s_cbranch_vccnz rfa_100508
buffer_load_dword v125,off,s[20:23],s92 sc1
s_bitset0_b32 s55,7
s_cmp_eq_u32 s55,0
s_cbranch_scc1 segb_100405
s_branch rnx_100509
rdn_100507:
buffer_load_dword v125,off,s[20:23],s92 sc1
s_branch rnx_100509
rfa_100508:
buffer_load_dwordx4 v[44:47],v0,s[20:23],s93 offen offset:3072 sc1
rnx_100509:
s_sub_u32 s90,s90,1
s_cmp_gt_i32 s90,0
s_cbranch_scc1 rot_100488
s_mov_b32 s55,0
s_branch segb_100405
fl_100412:
v_smfmac_f32_16x16x64_bf16 v[76:79],v[32:35],a[56:63],v1
flb_100420:
buffer_load_dwordx4 v[36:39],v0,s[20:23],s93 offen offset:1024 sc1
s_mov_b32 s55,224
s_bitcmp1_b32 s55,6
s_cbranch_scc0 rdn_100511
s_waitcnt vmcnt(6)
v_max3_u32 v124,v40,v41,v42
v_max_u32 v124,v124,v43
v_cmp_eq_u32 vcc,-1,v124
s_cbranch_vccnz rfa_100512
buffer_load_dword v125,off,s[20:23],s92 sc1
s_bitset0_b32 s55,6
s_cmp_eq_u32 s55,0
s_cbranch_scc1 segb_100405
s_branch rnx_100513
rdn_100511:
buffer_load_dword v125,off,s[20:23],s92 sc1
s_branch rnx_100513
rfa_100512:
buffer_load_dwordx4 v[40:43],v0,s[20:23],s93 offen offset:2048 sc1
rnx_100513:
s_bitcmp1_b32 s55,7
s_cbranch_scc0 rdn_100514
s_waitcnt vmcnt(6)
v_max3_u32 v124,v44,v45,v46
v_max_u32 v124,v124,v47
v_cmp_eq_u32 vcc,-1,v124
s_cbranch_vccnz rfa_100515
buffer_load_dword v125,off,s[20:23],s92 sc1
s_bitset0_b32 s55,7
s_cmp_eq_u32 s55,0
s_cbranch_scc1 segb_100405
s_branch rnx_100516
rdn_100514:
buffer_load_dword v125,off,s[20:23],s92 sc1
s_branch rnx_100516
rfa_100515:
buffer_load_dwordx4 v[44:47],v0,s[20:23],s93 offen offset:3072 sc1
rnx_100516:
rot_100510:
s_bitcmp1_b32 s55,5
s_cbranch_scc0 rdn_100517
s_waitcnt vmcnt(2)
v_max3_u32 v124,v36,v37,v38
v_max_u32 v124,v124,v39
v_cmp_eq_u32 vcc,-1,v124
s_cbranch_vccnz rfa_100518
buffer_load_dword v125,off,s[20:23],s92 sc1
s_bitset0_b32 s55,5
v_smfmac_f32_16x16x64_bf16 v[48:51],v[36:39],a[64:71],v1
v_smfmac_f32_16x16x64_bf16 v[52:55],v[36:39],a[72:79],v1
v_smfmac_f32_16x16x64_bf16 v[56:59],v[36:39],a[80:87],v1
v_smfmac_f32_16x16x64_bf16 v[60:63],v[36:39],a[88:95],v1
v_smfmac_f32_16x16x64_bf16 v[64:67],v[36:39],a[96:103],v1
v_smfmac_f32_16x16x64_bf16 v[68:71],v[36:39],a[104:111],v1
v_smfmac_f32_16x16x64_bf16 v[72:75],v[36:39],a[112:119],v1
v_smfmac_f32_16x16x64_bf16 v[76:79],v[36:39],a[120:127],v1
s_cmp_eq_u32 s55,0
s_cbranch_scc1 segb_100405
s_branch rnx_100519
rdn_100517:
buffer_load_dword v125,off,s[20:23],s92 sc1
s_branch rnx_100519
rfa_100518:
buffer_load_dwordx4 v[36:39],v0,s[20:23],s93 offen offset:1024 sc1
rnx_100519:
s_bitcmp1_b32 s55,6
s_cbranch_scc0 rdn_100520
s_waitcnt vmcnt(2)
v_max3_u32 v124,v40,v41,v42
v_max_u32 v124,v124,v43
v_cmp_eq_u32 vcc,-1,v124
s_cbranch_vccnz rfa_100521
buffer_load_dword v125,off,s[20:23],s92 sc1
s_bitset0_b32 s55,6
s_cmp_eq_u32 s55,0
s_cbranch_scc1 segb_100405
s_branch rnx_100522
rdn_100520:
buffer_load_dword v125,off,s[20:23],s92 sc1
s_branch rnx_100522
rfa_100521:
buffer_load_dwordx4 v[40:43],v0,s[20:23],s93 offen offset:2048 sc1
rnx_100522:
s_bitcmp1_b32 s55,7
s_cbranch_scc0 rdn_100523
s_waitcnt vmcnt(2)
v_max3_u32 v124,v44,v45,v46
v_max_u32 v124,v124,v47
v_cmp_eq_u32 vcc,-1,v124
s_cbranch_vccnz rfa_100524
buffer_load_dword v125,off,s[20:23],s92 sc1
s_bitset0_b32 s55,7
s_cmp_eq_u32 s55,0
s_cbranch_scc1 segb_100405
s_branch rnx_100525
rdn_100523:
buffer_load_dword v125,off,s[20:23],s92 sc1
s_branch rnx_100525
rfa_100524:
buffer_load_dwordx4 v[44:47],v0,s[20:23],s93 offen offset:3072 sc1
rnx_100525:
s_sub_u32 s90,s90,1
s_cmp_gt_i32 s90,0
s_cbranch_scc1 rot_100510
s_mov_b32 s55,0
s_branch segb_100405
fl_100413:
v_smfmac_f32_16x16x64_bf16 v[76:79],v[36:39],a[120:127],v1
flb_100421:
s_mov_b32 s55,192
s_bitcmp1_b32 s55,6
s_cbranch_scc0 rdn_100527
s_waitcnt vmcnt(6)
v_max3_u32 v124,v40,v41,v42
v_max_u32 v124,v124,v43
v_cmp_eq_u32 vcc,-1,v124
s_cbranch_vccnz rfa_100528
buffer_load_dword v125,off,s[20:23],s92 sc1
s_bitset0_b32 s55,6
s_cmp_eq_u32 s55,0
s_cbranch_scc1 segb_100405
s_branch rnx_100529
rdn_100527:
buffer_load_dword v125,off,s[20:23],s92 sc1
s_branch rnx_100529
rfa_100528:
buffer_load_dwordx4 v[40:43],v0,s[20:23],s93 offen offset:2048 sc1
rnx_100529:
s_bitcmp1_b32 s55,7
s_cbranch_scc0 rdn_100530
s_waitcnt vmcnt(6)
v_max3_u32 v124,v44,v45,v46
v_max_u32 v124,v124,v47
v_cmp_eq_u32 vcc,-1,v124
s_cbranch_vccnz rfa_100531
buffer_load_dword v125,off,s[20:23],s92 sc1
s_bitset0_b32 s55,7
s_cmp_eq_u32 s55,0
s_cbranch_scc1 segb_100405
s_branch rnx_100532
rdn_100530:
buffer_load_dword v125,off,s[20:23],s92 sc1
s_branch rnx_100532
rfa_100531:
buffer_load_dwordx4 v[44:47],v0,s[20:23],s93 offen offset:3072 sc1
rnx_100532:
rot_100526:
s_bitcmp1_b32 s55,6
s_cbranch_scc0 rdn_100533
s_waitcnt vmcnt(1)
v_max3_u32 v124,v40,v41,v42
v_max_u32 v124,v124,v43
v_cmp_eq_u32 vcc,-1,v124
s_cbranch_vccnz rfa_100534
buffer_load_dword v125,off,s[20:23],s92 sc1
s_bitset0_b32 s55,6
s_cmp_eq_u32 s55,0
s_cbranch_scc1 segb_100405
s_branch rnx_100535
rdn_100533:
buffer_load_dword v125,off,s[20:23],s92 sc1
s_branch rnx_100535
rfa_100534:
buffer_load_dwordx4 v[40:43],v0,s[20:23],s93 offen offset:2048 sc1
rnx_100535:
s_bitcmp1_b32 s55,7
s_cbranch_scc0 rdn_100536
s_waitcnt vmcnt(1)
v_max3_u32 v124,v44,v45,v46
v_max_u32 v124,v124,v47
v_cmp_eq_u32 vcc,-1,v124
s_cbranch_vccnz rfa_100537
buffer_load_dword v125,off,s[20:23],s92 sc1
s_bitset0_b32 s55,7
s_cmp_eq_u32 s55,0
s_cbranch_scc1 segb_100405
s_branch rnx_100538
rdn_100536:
buffer_load_dword v125,off,s[20:23],s92 sc1
s_branch rnx_100538
rfa_100537:
buffer_load_dwordx4 v[44:47],v0,s[20:23],s93 offen offset:3072 sc1
rnx_100538:
s_sub_u32 s90,s90,1
s_cmp_gt_i32 s90,0
s_cbranch_scc1 rot_100526
s_mov_b32 s55,0
s_branch segb_100405
dfl_100479:
buffer_load_dwordx4 v[20:23],v0,s[20:23],s92 offen offset:1024 sc1
s_bitset1_b32 s55,1
buffer_load_dwordx4 v[36:39],v0,s[20:23],s93 offen offset:1024 sc1
s_waitcnt vmcnt(5)
v_max3_u32 v124,v24,v25,v26
v_max_u32 v124,v124,v27
v_cmp_eq_u32 vcc,-1,v124
s_cbranch_vccnz dfl_100480
s_branch dseg_100483
dfl_100480:
buffer_load_dwordx4 v[24:27],v0,s[20:23],s92 offen offset:2048 sc1
s_bitset1_b32 s55,2
buffer_load_dwordx4 v[40:43],v0,s[20:23],s93 offen offset:2048 sc1
buffer_load_dwordx4 v[44:47],v0,s[20:23],s93 offen offset:3072 sc1
s_waitcnt vmcnt(7)
v_max3_u32 v124,v28,v29,v30
v_max_u32 v124,v124,v31
v_cmp_eq_u32 vcc,-1,v124
s_cbranch_vccnz dfl_100481
s_branch dseg_100484
dfl_100481:
buffer_load_dwordx4 v[28:31],v0,s[20:23],s92 offen offset:3072 sc1
s_bitset1_b32 s55,3
s_branch lap2_100485
dseg_100483:
v_smfmac_f32_16x16x64_bf16 v[48:51],v[24:27],a[128:135],v1
buffer_load_dword v125,off,s[20:23],s92 sc1
v_smfmac_f32_16x16x64_bf16 v[52:55],v[24:27],a[136:143],v1
buffer_load_dwordx4 v[40:43],v0,s[20:23],s93 offen offset:2048 sc1
v_smfmac_f32_16x16x64_bf16 v[56:59],v[24:27],a[144:151],v1
buffer_load_dwordx4 v[44:47],v0,s[20:23],s93 offen offset:3072 sc1
s_waitcnt vmcnt(7)
v_max3_u32 v124,v28,v29,v30
v_smfmac_f32_16x16x64_bf16 v[60:63],v[24:27],a[152:159],v1
v_max_u32 v124,v124,v31
v_smfmac_f32_16x16x64_bf16 v[64:67],v[24:27],a[160:167],v1
v_cmp_eq_u32 vcc,-1,v124
v_smfmac_f32_16x16x64_bf16 v[68:71],v[24:27],a[168:175],v1
v_smfmac_f32_16x16x64_bf16 v[72:75],v[24:27],a[176:183],v1
v_smfmac_f32_16x16x64_bf16 v[76:79],v[24:27],a[184:191],v1
s_cbranch_vccnz dfl_100481
dseg_100484:
v_smfmac_f32_16x16x64_bf16 v[48:51],v[28:31],a[192:199],v1
buffer_load_dword v125,off,s[20:23],s92 sc1
v_smfmac_f32_16x16x64_bf16 v[52:55],v[28:31],a[200:207],v1
v_smfmac_f32_16x16x64_bf16 v[56:59],v[28:31],a[208:215],v1
v_smfmac_f32_16x16x64_bf16 v[60:63],v[28:31],a[216:223],v1
v_smfmac_f32_16x16x64_bf16 v[64:67],v[28:31],a[224:231],v1
v_smfmac_f32_16x16x64_bf16 v[68:71],v[28:31],a[232:239],v1
v_smfmac_f32_16x16x64_bf16 v[72:75],v[28:31],a[240:247],v1
v_smfmac_f32_16x16x64_bf16 v[76:79],v[28:31],a[248:255],v1
lap2_100485:
s_bitcmp1_b32 s55,0
s_cbranch_scc0 l2s_100539
s_waitcnt vmcnt(7)
v_max3_u32 v124,v16,v17,v18
v_max_u32 v124,v124,v19
v_cmp_eq_u32 vcc,-1,v124
s_cbranch_vccnz l2s_100539
s_bitset0_b32 s55,0
v_smfmac_f32_16x16x64_bf16 v[48:51],v[16:19],a[0:7],v1
v_smfmac_f32_16x16x64_bf16 v[52:55],v[16:19],a[8:15],v1
v_smfmac_f32_16x16x64_bf16 v[56:59],v[16:19],a[16:23],v1
v_smfmac_f32_16x16x64_bf16 v[60:63],v[16:19],a[24:31],v1
v_smfmac_f32_16x16x64_bf16 v[64:67],v[16:19],a[32:39],v1
v_smfmac_f32_16x16x64_bf16 v[68:71],v[16:19],a[40:47],v1
v_smfmac_f32_16x16x64_bf16 v[72:75],v[16:19],a[48:55],v1
v_smfmac_f32_16x16x64_bf16 v[76:79],v[16:19],a[56:63],v1
l2s_100539:
s_bitcmp1_b32 s55,1
s_cbranch_scc0 l2s_100541
s_waitcnt vmcnt(5)
v_max3_u32 v124,v20,v21,v22
v_max_u32 v124,v124,v23
v_cmp_eq_u32 vcc,-1,v124
s_cbranch_vccnz l2s_100541
s_bitset0_b32 s55,1
v_smfmac_f32_16x16x64_bf16 v[48:51],v[20:23],a[64:71],v1
v_smfmac_f32_16x16x64_bf16 v[52:55],v[20:23],a[72:79],v1
v_smfmac_f32_16x16x64_bf16 v[56:59],v[20:23],a[80:87],v1
v_smfmac_f32_16x16x64_bf16 v[60:63],v[20:23],a[88:95],v1
v_smfmac_f32_16x16x64_bf16 v[64:67],v[20:23],a[96:103],v1
v_smfmac_f32_16x16x64_bf16 v[68:71],v[20:23],a[104:111],v1
v_smfmac_f32_16x16x64_bf16 v[72:75],v[20:23],a[112:119],v1
v_smfmac_f32_16x16x64_bf16 v[76:79],v[20:23],a[120:127],v1
l2s_100541:
s_bitcmp1_b32 s55,2
s_cbranch_scc0 l2s_100543
s_waitcnt vmcnt(3)
v_max3_u32 v124,v24,v25,v26
v_max_u32 v124,v124,v27
v_cmp_eq_u32 vcc,-1,v124
s_cbranch_vccnz l2s_100543
s_bitset0_b32 s55,2
v_smfmac_f32_16x16x64_bf16 v[48:51],v[24:27],a[128:135],v1
v_smfmac_f32_16x16x64_bf16 v[52:55],v[24:27],a[136:143],v1
v_smfmac_f32_16x16x64_bf16 v[56:59],v[24:27],a[144:151],v1
v_smfmac_f32_16x16x64_bf16 v[60:63],v[24:27],a[152:159],v1
v_smfmac_f32_16x16x64_bf16 v[64:67],v[24:27],a[160:167],v1
v_smfmac_f32_16x16x64_bf16 v[68:71],v[24:27],a[168:175],v1
v_smfmac_f32_16x16x64_bf16 v[72:75],v[24:27],a[176:183],v1
v_smfmac_f32_16x16x64_bf16 v[76:79],v[24:27],a[184:191],v1
l2s_100543:
s_bitcmp1_b32 s55,3
s_cbranch_scc0 l2s_100545
s_waitcnt vmcnt(0)
v_max3_u32 v124,v28,v29,v30
v_max_u32 v124,v124,v31
v_cmp_eq_u32 vcc,-1,v124
s_cbranch_vccnz l2s_100545
s_bitset0_b32 s55,3
v_smfmac_f32_16x16x64_bf16 v[48:51],v[28:31],a[192:199],v1
v_smfmac_f32_16x16x64_bf16 v[52:55],v[28:31],a[200:207],v1
v_smfmac_f32_16x16x64_bf16 v[56:59],v[28:31],a[208:215],v1
v_smfmac_f32_16x16x64_bf16 v[60:63],v[28:31],a[216:223],v1
v_smfmac_f32_16x16x64_bf16 v[64:67],v[28:31],a[224:231],v1
v_smfmac_f32_16x16x64_bf16 v[68:71],v[28:31],a[232:239],v1
v_smfmac_f32_16x16x64_bf16 v[72:75],v[28:31],a[240:247],v1
v_smfmac_f32_16x16x64_bf16 v[76:79],v[28:31],a[248:255],v1
l2s_100545:
s_cmp_eq_u32 s55,0
s_cbranch_scc0 lfb_100486
Ldone_100487:
s_waitcnt vmcnt(6)
v_max3_u32 v124,v32,v33,v34
v_max_u32 v124,v124,v35
v_cmp_eq_u32 vcc,-1,v124
s_cbranch_vccnz flb_100419
s_branch segb_100403
lfb_100486:
s_bitcmp1_b32 s55,0
s_cbranch_scc0 dsk_100547
buffer_load_dwordx4 v[16:19],v0,s[20:23],s92 offen offset:0 sc1
dsk_100547:
s_bitcmp1_b32 s55,1
s_cbranch_scc0 dsk_100548
buffer_load_dwordx4 v[20:23],v0,s[20:23],s92 offen offset:1024 sc1
dsk_100548:
s_bitcmp1_b32 s55,2
s_cbranch_scc0 dsk_100549
buffer_load_dwordx4 v[24:27],v0,s[20:23],s92 offen offset:2048 sc1
dsk_100549:
s_bitcmp1_b32 s55,3
s_cbranch_scc0 dsk_100550
buffer_load_dwordx4 v[28:31],v0,s[20:23],s92 offen offset:3072 sc1
dsk_100550:
s_bitcmp1_b32 s55,0
s_cbranch_scc0 dsk_100551
s_waitcnt vmcnt(2)
v_max3_u32 v124,v16,v17,v18
v_max_u32 v124,v124,v19
v_cmp_eq_u32 vcc,-1,v124
s_cbranch_vccz dgo_100552
s_nop 15
buffer_load_dwordx4 v[104:107],v0,s[20:23],s92 offen offset:0 sc1
s_nop 15
buffer_load_dwordx4 v[108:111],v0,s[20:23],s92 offen offset:0 sc1
dlp_100553:
s_waitcnt vmcnt(2)
v_max3_u32 v124,v16,v17,v18
v_max_u32 v124,v124,v19
v_cmp_eq_u32 vcc,-1,v124
s_cbranch_vccz dgo_100552
buffer_load_dwordx4 v[16:19],v0,s[20:23],s92 offen offset:0 sc1
s_waitcnt vmcnt(2)
v_max3_u32 v124,v104,v105,v106
v_max_u32 v124,v124,v107
v_cmp_eq_u32 vcc,-1,v124
s_cbranch_vccz dcp_100555
buffer_load_dwordx4 v[104:107],v0,s[20:23],s92 offen offset:0 sc1
s_waitcnt vmcnt(2)
v_max3_u32 v124,v108,v109,v110
v_max_u32 v124,v124,v111
v_cmp_eq_u32 vcc,-1,v124
s_cbranch_vccz dcp_100556
buffer_load_dwordx4 v[108:111],v0,s[20:23],s92 offen offset:0 sc1
s_sub_u32 s90,s90,1
s_cmp_gt_i32 s90,0
s_cbranch_scc1 dlp_100553
s_branch dgo_100552
dcp_100555:
v_mov_b32 v16,v104
v_mov_b32 v17,v105
v_mov_b32 v18,v106
v_mov_b32 v19,v107
s_nop 1
s_branch dgo_100552
dcp_100556:
v_mov_b32 v16,v108
v_mov_b32 v17,v109
v_mov_b32 v18,v110
v_mov_b32 v19,v111
s_nop 1
dgo_100552:
v_smfmac_f32_16x16x64_bf16 v[48:51],v[16:19],a[0:7],v1
v_smfmac_f32_16x16x64_bf16 v[52:55],v[16:19],a[8:15],v1
v_smfmac_f32_16x16x64_bf16 v[56:59],v[16:19],a[16:23],v1
v_smfmac_f32_16x16x64_bf16 v[60:63],v[16:19],a[24:31],v1
v_smfmac_f32_16x16x64_bf16 v[64:67],v[16:19],a[32:39],v1
v_smfmac_f32_16x16x64_bf16 v[68:71],v[16:19],a[40:47],v1
v_smfmac_f32_16x16x64_bf16 v[72:75],v[16:19],a[48:55],v1
v_smfmac_f32_16x16x64_bf16 v[76:79],v[16:19],a[56:63],v1
dsk_100551:
s_bitcmp1_b32 s55,1
s_cbranch_scc0 dsk_100557
s_waitcnt vmcnt(2)
v_max3_u32 v124,v20,v21,v22
v_max_u32 v124,v124,v23
v_cmp_eq_u32 vcc,-1,v124
s_cbranch_vccz dgo_100558
s_nop 15
buffer_load_dwordx4 v[104:107],v0,s[20:23],s92 offen offset:1024 sc1
s_nop 15
buffer_load_dwordx4 v[108:111],v0,s[20:23],s92 offen offset:1024 sc1
dlp_100559:
s_waitcnt vmcnt(2)
v_max3_u32 v124,v20,v21,v22
v_max_u32 v124,v124,v23
v_cmp_eq_u32 vcc,-1,v124
s_cbranch_vccz dgo_100558
buffer_load_dwordx4 v[20:23],v0,s[20:23],s92 offen offset:1024 sc1
s_waitcnt vmcnt(2)
v_max3_u32 v124,v104,v105,v106
v_max_u32 v124,v124,v107
v_cmp_eq_u32 vcc,-1,v124
s_cbranch_vccz dcp_100561
buffer_load_dwordx4 v[104:107],v0,s[20:23],s92 offen offset:1024 sc1
s_waitcnt vmcnt(2)
v_max3_u32 v124,v108,v109,v110
v_max_u32 v124,v124,v111
v_cmp_eq_u32 vcc,-1,v124
s_cbranch_vccz dcp_100562
buffer_load_dwordx4 v[108:111],v0,s[20:23],s92 offen offset:1024 sc1
s_sub_u32 s90,s90,1
s_cmp_gt_i32 s90,0
s_cbranch_scc1 dlp_100559
s_branch dgo_100558
dcp_100561:
v_mov_b32 v20,v104
v_mov_b32 v21,v105
v_mov_b32 v22,v106
v_mov_b32 v23,v107
s_nop 1
s_branch dgo_100558
dcp_100562:
v_mov_b32 v20,v108
v_mov_b32 v21,v109
v_mov_b32 v22,v110
v_mov_b32 v23,v111
s_nop 1
dgo_100558:
v_smfmac_f32_16x16x64_bf16 v[48:51],v[20:23],a[64:71],v1
v_smfmac_f32_16x16x64_bf16 v[52:55],v[20:23],a[72:79],v1
v_smfmac_f32_16x16x64_bf16 v[56:59],v[20:23],a[80:87],v1
v_smfmac_f32_16x16x64_bf16 v[60:63],v[20:23],a[88:95],v1
v_smfmac_f32_16x16x64_bf16 v[64:67],v[20:23],a[96:103],v1
v_smfmac_f32_16x16x64_bf16 v[68:71],v[20:23],a[104:111],v1
v_smfmac_f32_16x16x64_bf16 v[72:75],v[20:23],a[112:119],v1
v_smfmac_f32_16x16x64_bf16 v[76:79],v[20:23],a[120:127],v1
dsk_100557:
s_bitcmp1_b32 s55,2
s_cbranch_scc0 dsk_100563
s_waitcnt vmcnt(2)
v_max3_u32 v124,v24,v25,v26
v_max_u32 v124,v124,v27
v_cmp_eq_u32 vcc,-1,v124
s_cbranch_vccz dgo_100564
s_nop 15
buffer_load_dwordx4 v[104:107],v0,s[20:23],s92 offen offset:2048 sc1
s_nop 15
buffer_load_dwordx4 v[108:111],v0,s[20:23],s92 offen offset:2048 sc1
dlp_100565:
s_waitcnt vmcnt(2)
v_max3_u32 v124,v24,v25,v26
v_max_u32 v124,v124,v27
v_cmp_eq_u32 vcc,-1,v124
s_cbranch_vccz dgo_100564
buffer_load_dwordx4 v[24:27],v0,s[20:23],s92 offen offset:2048 sc1
s_waitcnt vmcnt(2)
v_max3_u32 v124,v104,v105,v106
v_max_u32 v124,v124,v107
v_cmp_eq_u32 vcc,-1,v124
s_cbranch_vccz dcp_100567
buffer_load_dwordx4 v[104:107],v0,s[20:23],s92 offen offset:2048 sc1
s_waitcnt vmcnt(2)
v_max3_u32 v124,v108,v109,v110
v_max_u32 v124,v124,v111
v_cmp_eq_u32 vcc,-1,v124
s_cbranch_vccz dcp_100568
buffer_load_dwordx4 v[108:111],v0,s[20:23],s92 offen offset:2048 sc1
s_sub_u32 s90,s90,1
s_cmp_gt_i32 s90,0
s_cbranch_scc1 dlp_100565
s_branch dgo_100564
dcp_100567:
v_mov_b32 v24,v104
v_mov_b32 v25,v105
v_mov_b32 v26,v106
v_mov_b32 v27,v107
s_nop 1
s_branch dgo_100564
dcp_100568:
v_mov_b32 v24,v108
v_mov_b32 v25,v109
v_mov_b32 v26,v110
v_mov_b32 v27,v111
s_nop 1
dgo_100564:
v_smfmac_f32_16x16x64_bf16 v[48:51],v[24:27],a[128:135],v1
v_smfmac_f32_16x16x64_bf16 v[52:55],v[24:27],a[136:143],v1
v_smfmac_f32_16x16x64_bf16 v[56:59],v[24:27],a[144:151],v1
v_smfmac_f32_16x16x64_bf16 v[60:63],v[24:27],a[152:159],v1
v_smfmac_f32_16x16x64_bf16 v[64:67],v[24:27],a[160:167],v1
v_smfmac_f32_16x16x64_bf16 v[68:71],v[24:27],a[168:175],v1
v_smfmac_f32_16x16x64_bf16 v[72:75],v[24:27],a[176:183],v1
v_smfmac_f32_16x16x64_bf16 v[76:79],v[24:27],a[184:191],v1
dsk_100563:
s_bitcmp1_b32 s55,3
s_cbranch_scc0 dsk_100569
s_waitcnt vmcnt(2)
v_max3_u32 v124,v28,v29,v30
v_max_u32 v124,v124,v31
v_cmp_eq_u32 vcc,-1,v124
s_cbranch_vccz dgo_100570
s_nop 15
buffer_load_dwordx4 v[104:107],v0,s[20:23],s92 offen offset:3072 sc1
s_nop 15
buffer_load_dwordx4 v[108:111],v0,s[20:23],s92 offen offset:3072 sc1
dlp_100571:
s_waitcnt vmcnt(2)
v_max3_u32 v124,v28,v29,v30
v_max_u32 v124,v124,v31
v_cmp_eq_u32 vcc,-1,v124
s_cbranch_vccz dgo_100570
buffer_load_dwordx4 v[28:31],v0,s[20:23],s92 offen offset:3072 sc1
s_waitcnt vmcnt(2)
v_max3_u32 v124,v104,v105,v106
v_max_u32 v124,v124,v107
v_cmp_eq_u32 vcc,-1,v124
s_cbranch_vccz dcp_100573
buffer_load_dwordx4 v[104:107],v0,s[20:23],s92 offen offset:3072 sc1
s_waitcnt vmcnt(2)
v_max3_u32 v124,v108,v109,v110
v_max_u32 v124,v124,v111
v_cmp_eq_u32 vcc,-1,v124
s_cbranch_vccz dcp_100574
buffer_load_dwordx4 v[108:111],v0,s[20:23],s92 offen offset:3072 sc1
s_sub_u32 s90,s90,1
s_cmp_gt_i32 s90,0
s_cbranch_scc1 dlp_100571
s_branch dgo_100570
dcp_100573:
v_mov_b32 v28,v104
v_mov_b32 v29,v105
v_mov_b32 v30,v106
v_mov_b32 v31,v107
s_nop 1
s_branch dgo_100570
dcp_100574:
v_mov_b32 v28,v108
v_mov_b32 v29,v109
v_mov_b32 v30,v110
v_mov_b32 v31,v111
s_nop 1
dgo_100570:
v_smfmac_f32_16x16x64_bf16 v[48:51],v[28:31],a[192:199],v1
v_smfmac_f32_16x16x64_bf16 v[52:55],v[28:31],a[200:207],v1
v_smfmac_f32_16x16x64_bf16 v[56:59],v[28:31],a[208:215],v1
v_smfmac_f32_16x16x64_bf16 v[60:63],v[28:31],a[216:223],v1
v_smfmac_f32_16x16x64_bf16 v[64:67],v[28:31],a[224:231],v1
v_smfmac_f32_16x16x64_bf16 v[68:71],v[28:31],a[232:239],v1
v_smfmac_f32_16x16x64_bf16 v[72:75],v[28:31],a[240:247],v1
v_smfmac_f32_16x16x64_bf16 v[76:79],v[28:31],a[248:255],v1
dsk_100569:
s_mov_b32 s55,0
s_branch Ldone_100487
slowA_100423:
buffer_load_dwordx4 v[44:47],v0,s[20:23],s93 offen offset:3072 sc1
dsk_100575:
s_bitcmp1_b32 s55,7
s_cbranch_scc0 dsk_100576
s_waitcnt vmcnt(2)
v_max3_u32 v124,v44,v45,v46
v_max_u32 v124,v124,v47
v_cmp_eq_u32 vcc,-1,v124
s_cbranch_vccz dgo_100577
s_nop 15
s_nop 3
buffer_load_dwordx4 v[104:107],v0,s[20:23],s93 offen offset:3072 sc1
s_nop 15
s_nop 3
buffer_load_dwordx4 v[108:111],v0,s[20:23],s93 offen offset:3072 sc1
dlp_100578:
s_waitcnt vmcnt(2)
v_max3_u32 v124,v44,v45,v46
v_max_u32 v124,v124,v47
v_cmp_eq_u32 vcc,-1,v124
s_cbranch_vccz dgo_100577
buffer_load_dwordx4 v[44:47],v0,s[20:23],s93 offen offset:3072 sc1
s_waitcnt vmcnt(2)
v_max3_u32 v124,v104,v105,v106
v_max_u32 v124,v124,v107
v_cmp_eq_u32 vcc,-1,v124
s_cbranch_vccz dcp_100580
buffer_load_dwordx4 v[104:107],v0,s[20:23],s93 offen offset:3072 sc1
s_waitcnt vmcnt(2)
v_max3_u32 v124,v108,v109,v110
v_max_u32 v124,v124,v111
v_cmp_eq_u32 vcc,-1,v124
s_cbranch_vccz dcp_100581
buffer_load_dwordx4 v[108:111],v0,s[20:23],s93 offen offset:3072 sc1
s_sub_u32 s90,s90,1
s_cmp_gt_i32 s90,0
s_cbranch_scc1 dlp_100578
s_branch dgo_100577
dcp_100580:
v_mov_b32 v44,v104
v_mov_b32 v45,v105
v_mov_b32 v46,v106
v_mov_b32 v47,v107
s_nop 1
s_branch dgo_100577
dcp_100581:
v_mov_b32 v44,v108
v_mov_b32 v45,v109
v_mov_b32 v46,v110
v_mov_b32 v47,v111
s_nop 1
dgo_100577:
dsk_100576:
s_mov_b32 s55,0
s_branch segb_100405
srt_100430:
s_sub_u32 s90,s90,1
s_cmp_gt_i32 s90,0
s_cbranch_scc0 sok_100429
buffer_load_dwordx4 v[16:19],v2,s[20:23],s94 offen offset:0 sc1
buffer_load_dwordx4 v[32:35],v2,s[20:23],s94 offen offset:1536 sc1
buffer_load_dwordx4 v[20:23],v2,s[20:23],s95 offen offset:0 sc1
buffer_load_dwordx4 v[36:39],v2,s[20:23],s95 offen offset:1536 sc1
buffer_load_dword v120,v3,s[20:23],s94 offen offset:0 sc1
buffer_load_dword v121,v3,s[20:23],s94 offen offset:1536 sc1
buffer_load_dword v122,v3,s[20:23],s95 offen offset:0 sc1
buffer_load_dword v123,v3,s[20:23],s95 offen offset:1536 sc1
s_branch sp_100428
of_100431:
s_mov_b32 s55,3
buffer_load_dwordx4 v[16:19],v0,s[20:23],s96 offen offset:0 sc1
buffer_load_dwordx4 v[20:23],v0,s[20:23],s96 offen offset:1024 sc1
v_readfirstlane_b32 s91,v126
s_waitcnt vmcnt(6)
v_max3_u32 v124,v24,v25,v26
v_max3_u32 v124,v124,v27,v28
v_max3_u32 v124,v124,v29,v30
v_max_u32 v124,v124,v31
v_cmp_eq_u32 vcc,-1,v124
s_cbranch_vccnz ost_100583
v_smfmac_f32_16x16x64_bf16 v[96:99],v[24:27],v[80:87],v1
buffer_load_dword v120,off,s[20:23],s96 sc1
v_smfmac_f32_16x16x64_bf16 v[100:103],v[24:27],v[88:95],v1
buffer_load_dword v120,off,s[20:23],s96 sc1
v_smfmac_f32_16x16x64_bf16 v[96:99],v[28:31],v[128:135],v1
v_smfmac_f32_16x16x64_bf16 v[100:103],v[28:31],v[136:143],v1
ort_100584:
s_waitcnt vmcnt(6)
v_max3_u32 v124,v32,v33,v34
v_max3_u32 v124,v124,v35,v36
v_max3_u32 v124,v124,v37,v38
v_max_u32 v124,v124,v39
v_cmp_eq_u32 vcc,-1,v124
s_cbranch_vccnz ost_100585
v_smfmac_f32_16x16x64_bf16 v[96:99],v[32:35],v[144:151],v1
buffer_load_dword v120,off,s[20:23],s96 sc1
v_smfmac_f32_16x16x64_bf16 v[100:103],v[32:35],v[152:159],v1
buffer_load_dword v120,off,s[20:23],s96 sc1
v_smfmac_f32_16x16x64_bf16 v[96:99],v[36:39],v[160:167],v1
v_smfmac_f32_16x16x64_bf16 v[100:103],v[36:39],v[168:175],v1
ort_100586:
s_waitcnt vmcnt(7)
v_max3_u32 v124,v40,v41,v42
v_max_u32 v124,v124,v43
v_cmp_eq_u32 vcc,-1,v124
s_cbranch_vccnz ost_100587
v_smfmac_f32_16x16x64_bf16 v[96:99],v[40:43],v[176:183],v1
buffer_load_dword v120,off,s[20:23],s96 sc1
v_smfmac_f32_16x16x64_bf16 v[100:103],v[40:43],v[184:191],v1
ort_100588:
s_waitcnt vmcnt(7)
v_max3_u32 v124,v44,v45,v46
v_max_u32 v124,v124,v47
v_cmp_eq_u32 vcc,-1,v124
s_cbranch_vccnz ost_100589
v_smfmac_f32_16x16x64_bf16 v[96:99],v[44:47],v[192:199],v1
buffer_load_dword v120,off,s[20:23],s96 sc1
v_smfmac_f32_16x16x64_bf16 v[100:103],v[44:47],v[200:207],v1
ort_100590:
s_waitcnt vmcnt(6)
v_max3_u32 v124,v16,v17,v18
v_max3_u32 v124,v124,v19,v20
v_max3_u32 v124,v124,v21,v22
v_max_u32 v124,v124,v23
v_cmp_eq_u32 vcc,-1,v124
s_cbranch_vccnz olap2_100582
s_andn2_b32 s55,s55,3
v_smfmac_f32_16x16x64_bf16 v[96:99],v[16:19],v[48:55],v1
v_smfmac_f32_16x16x64_bf16 v[100:103],v[16:19],v[56:63],v1
v_smfmac_f32_16x16x64_bf16 v[96:99],v[20:23],v[64:71],v1
v_smfmac_f32_16x16x64_bf16 v[100:103],v[20:23],v[72:79],v1
s_cbranch_scc0 oback_100442
s_branch olap2_100582
ost_100583:
buffer_load_dwordx4 v[24:27],v0,s[20:23],s96 offen offset:2048 sc1
buffer_load_dwordx4 v[28:31],v0,s[20:23],s96 offen offset:3072 sc1
s_or_b32 s55,s55,12
s_branch ort_100584
ost_100585:
buffer_load_dwordx4 v[32:35],v0,s[20:23],s97 offen offset:0 sc1
buffer_load_dwordx4 v[36:39],v0,s[20:23],s97 offen offset:1024 sc1
s_or_b32 s55,s55,48
s_branch ort_100586
ost_100587:
buffer_load_dwordx4 v[40:43],v0,s[20:23],s97 offen offset:2048 sc1
s_or_b32 s55,s55,64
s_branch ort_100588
ost_100589:
buffer_load_dwordx4 v[44:47],v0,s[20:23],s97 offen offset:3072 sc1
s_or_b32 s55,s55,128
s_branch ort_100590
of_100432:
s_mov_b32 s55,12
buffer_load_dwordx4 v[24:27],v0,s[20:23],s96 offen offset:2048 sc1
buffer_load_dwordx4 v[28:31],v0,s[20:23],s96 offen offset:3072 sc1
s_waitcnt vmcnt(4)
v_max3_u32 v124,v32,v33,v34
v_max3_u32 v124,v124,v35,v36
v_max3_u32 v124,v124,v37,v38
v_max_u32 v124,v124,v39
v_cmp_eq_u32 vcc,-1,v124
s_cbranch_vccnz ost_100592
v_smfmac_f32_16x16x64_bf16 v[96:99],v[32:35],v[144:151],v1
buffer_load_dword v120,off,s[20:23],s96 sc1
v_smfmac_f32_16x16x64_bf16 v[100:103],v[32:35],v[152:159],v1
buffer_load_dword v120,off,s[20:23],s96 sc1
v_smfmac_f32_16x16x64_bf16 v[96:99],v[36:39],v[160:167],v1
v_smfmac_f32_16x16x64_bf16 v[100:103],v[36:39],v[168:175],v1
ort_100593:
s_waitcnt vmcnt(5)
v_max3_u32 v124,v40,v41,v42
v_max_u32 v124,v124,v43
v_cmp_eq_u32 vcc,-1,v124
s_cbranch_vccnz ost_100594
v_smfmac_f32_16x16x64_bf16 v[96:99],v[40:43],v[176:183],v1
buffer_load_dword v120,off,s[20:23],s96 sc1
v_smfmac_f32_16x16x64_bf16 v[100:103],v[40:43],v[184:191],v1
ort_100595:
s_waitcnt vmcnt(5)
v_max3_u32 v124,v44,v45,v46
v_max_u32 v124,v124,v47
v_cmp_eq_u32 vcc,-1,v124
s_cbranch_vccnz ost_100596
v_smfmac_f32_16x16x64_bf16 v[96:99],v[44:47],v[192:199],v1
buffer_load_dword v120,off,s[20:23],s96 sc1
v_smfmac_f32_16x16x64_bf16 v[100:103],v[44:47],v[200:207],v1
ort_100597:
s_waitcnt vmcnt(4)
v_max3_u32 v124,v24,v25,v26
v_max3_u32 v124,v124,v27,v28
v_max3_u32 v124,v124,v29,v30
v_max_u32 v124,v124,v31
v_cmp_eq_u32 vcc,-1,v124
s_cbranch_vccnz olap2_100582
s_andn2_b32 s55,s55,12
v_smfmac_f32_16x16x64_bf16 v[96:99],v[24:27],v[80:87],v1
v_smfmac_f32_16x16x64_bf16 v[100:103],v[24:27],v[88:95],v1
v_smfmac_f32_16x16x64_bf16 v[96:99],v[28:31],v[128:135],v1
v_smfmac_f32_16x16x64_bf16 v[100:103],v[28:31],v[136:143],v1
s_cbranch_scc0 oback_100442
s_branch olap2_100582
ost_100592:
buffer_load_dwordx4 v[32:35],v0,s[20:23],s97 offen offset:0 sc1
buffer_load_dwordx4 v[36:39],v0,s[20:23],s97 offen offset:1024 sc1
s_or_b32 s55,s55,48
s_branch ort_100593
ost_100594:
buffer_load_dwordx4 v[40:43],v0,s[20:23],s97 offen offset:2048 sc1
s_or_b32 s55,s55,64
s_branch ort_100595
ost_100596:
buffer_load_dwordx4 v[44:47],v0,s[20:23],s97 offen offset:3072 sc1
s_or_b32 s55,s55,128
s_branch ort_100597
of_100433:
s_mov_b32 s55,48
buffer_load_dwordx4 v[32:35],v0,s[20:23],s97 offen offset:0 sc1
buffer_load_dwordx4 v[36:39],v0,s[20:23],s97 offen offset:1024 sc1
s_waitcnt vmcnt(3)
v_max3_u32 v124,v40,v41,v42
v_max_u32 v124,v124,v43
v_cmp_eq_u32 vcc,-1,v124
s_cbranch_vccnz ost_100599
v_smfmac_f32_16x16x64_bf16 v[96:99],v[40:43],v[176:183],v1
buffer_load_dword v120,off,s[20:23],s96 sc1
v_smfmac_f32_16x16x64_bf16 v[100:103],v[40:43],v[184:191],v1
ort_100600:
s_waitcnt vmcnt(3)
v_max3_u32 v124,v44,v45,v46
v_max_u32 v124,v124,v47
v_cmp_eq_u32 vcc,-1,v124
s_cbranch_vccnz ost_100601
v_smfmac_f32_16x16x64_bf16 v[96:99],v[44:47],v[192:199],v1
buffer_load_dword v120,off,s[20:23],s96 sc1
v_smfmac_f32_16x16x64_bf16 v[100:103],v[44:47],v[200:207],v1
ort_100602:
s_waitcnt vmcnt(2)
v_max3_u32 v124,v32,v33,v34
v_max3_u32 v124,v124,v35,v36
v_max3_u32 v124,v124,v37,v38
v_max_u32 v124,v124,v39
v_cmp_eq_u32 vcc,-1,v124
s_cbranch_vccnz olap2_100582
s_andn2_b32 s55,s55,48
v_smfmac_f32_16x16x64_bf16 v[96:99],v[32:35],v[144:151],v1
v_smfmac_f32_16x16x64_bf16 v[100:103],v[32:35],v[152:159],v1
v_smfmac_f32_16x16x64_bf16 v[96:99],v[36:39],v[160:167],v1
v_smfmac_f32_16x16x64_bf16 v[100:103],v[36:39],v[168:175],v1
s_cbranch_scc0 oback_100442
s_branch olap2_100582
ost_100599:
buffer_load_dwordx4 v[40:43],v0,s[20:23],s97 offen offset:2048 sc1
s_or_b32 s55,s55,64
s_branch ort_100600
ost_100601:
buffer_load_dwordx4 v[44:47],v0,s[20:23],s97 offen offset:3072 sc1
s_or_b32 s55,s55,128
s_branch ort_100602
of_100434:
s_mov_b32 s55,64
buffer_load_dwordx4 v[40:43],v0,s[20:23],s97 offen offset:2048 sc1
s_waitcnt vmcnt(1)
v_max3_u32 v124,v44,v45,v46
v_max_u32 v124,v124,v47
v_cmp_eq_u32 vcc,-1,v124
s_cbranch_vccnz ost_100604
v_smfmac_f32_16x16x64_bf16 v[96:99],v[44:47],v[192:199],v1
buffer_load_dword v120,off,s[20:23],s96 sc1
v_smfmac_f32_16x16x64_bf16 v[100:103],v[44:47],v[200:207],v1
ort_100605:
s_waitcnt vmcnt(1)
v_max3_u32 v124,v40,v41,v42
v_max_u32 v124,v124,v43
v_cmp_eq_u32 vcc,-1,v124
s_cbranch_vccnz olap2_100582
s_andn2_b32 s55,s55,64
v_smfmac_f32_16x16x64_bf16 v[96:99],v[40:43],v[176:183],v1
v_smfmac_f32_16x16x64_bf16 v[100:103],v[40:43],v[184:191],v1
s_cbranch_scc0 oback_100442
s_branch olap2_100582
ost_100604:
buffer_load_dwordx4 v[44:47],v0,s[20:23],s97 offen offset:3072 sc1
s_or_b32 s55,s55,128
s_branch ort_100605
of_100435:
s_mov_b32 s55,128
s_branch oslow_100441
olap2_100582:
s_bitcmp1_b32 s55,0
s_cbranch_scc0 l2s_100607
s_waitcnt vmcnt(6)
v_max3_u32 v124,v16,v17,v18
v_max3_u32 v124,v124,v19,v20
v_max3_u32 v124,v124,v21,v22
v_max_u32 v124,v124,v23
v_cmp_eq_u32 vcc,-1,v124
s_cbranch_vccnz l2s_100607
s_andn2_b32 s55,s55,3
v_smfmac_f32_16x16x64_bf16 v[96:99],v[16:19],v[48:55],v1
v_smfmac_f32_16x16x64_bf16 v[100:103],v[16:19],v[56:63],v1
v_smfmac_f32_16x16x64_bf16 v[96:99],v[20:23],v[64:71],v1
v_smfmac_f32_16x16x64_bf16 v[100:103],v[20:23],v[72:79],v1
l2s_100607:
s_bitcmp1_b32 s55,2
s_cbranch_scc0 l2s_100608
s_waitcnt vmcnt(4)
v_max3_u32 v124,v24,v25,v26
v_max3_u32 v124,v124,v27,v28
v_max3_u32 v124,v124,v29,v30
v_max_u32 v124,v124,v31
v_cmp_eq_u32 vcc,-1,v124
s_cbranch_vccnz l2s_100608
s_andn2_b32 s55,s55,12
v_smfmac_f32_16x16x64_bf16 v[96:99],v[24:27],v[80:87],v1
v_smfmac_f32_16x16x64_bf16 v[100:103],v[24:27],v[88:95],v1
v_smfmac_f32_16x16x64_bf16 v[96:99],v[28:31],v[128:135],v1
v_smfmac_f32_16x16x64_bf16 v[100:103],v[28:31],v[136:143],v1
l2s_100608:
s_bitcmp1_b32 s55,4
s_cbranch_scc0 l2s_100609
s_waitcnt vmcnt(2)
v_max3_u32 v124,v32,v33,v34
v_max3_u32 v124,v124,v35,v36
v_max3_u32 v124,v124,v37,v38
v_max_u32 v124,v124,v39
v_cmp_eq_u32 vcc,-1,v124
s_cbranch_vccnz l2s_100609
s_andn2_b32 s55,s55,48
v_smfmac_f32_16x16x64_bf16 v[96:99],v[32:35],v[144:151],v1
v_smfmac_f32_16x16x64_bf16 v[100:103],v[32:35],v[152:159],v1
v_smfmac_f32_16x16x64_bf16 v[96:99],v[36:39],v[160:167],v1
v_smfmac_f32_16x16x64_bf16 v[100:103],v[36:39],v[168:175],v1
l2s_100609:
s_bitcmp1_b32 s55,6
s_cbranch_scc0 l2s_100610
s_waitcnt vmcnt(1)
v_max3_u32 v124,v40,v41,v42
v_max_u32 v124,v124,v43
v_cmp_eq_u32 vcc,-1,v124
s_cbranch_vccnz l2s_100610
s_andn2_b32 s55,s55,64
v_smfmac_f32_16x16x64_bf16 v[96:99],v[40:43],v[176:183],v1
v_smfmac_f32_16x16x64_bf16 v[100:103],v[40:43],v[184:191],v1
l2s_100610:
s_bitcmp1_b32 s55,7
s_cbranch_scc0 l2s_100611
s_waitcnt vmcnt(0)
v_max3_u32 v124,v44,v45,v46
v_max_u32 v124,v124,v47
v_cmp_eq_u32 vcc,-1,v124
s_cbranch_vccnz l2s_100611
s_andn2_b32 s55,s55,128
v_smfmac_f32_16x16x64_bf16 v[96:99],v[44:47],v[192:199],v1
v_smfmac_f32_16x16x64_bf16 v[100:103],v[44:47],v[200:207],v1
l2s_100611:
s_cmp_eq_u32 s55,0
s_cbranch_scc1 oback_100442
oslow_100441:
s_bitcmp1_b32 s55,0
s_cbranch_scc0 dsk_100612
buffer_load_dwordx4 v[16:19],v0,s[20:23],s96 offen offset:0 sc1
dsk_100612:
s_bitcmp1_b32 s55,1
s_cbranch_scc0 dsk_100613
buffer_load_dwordx4 v[20:23],v0,s[20:23],s96 offen offset:1024 sc1
dsk_100613:
s_bitcmp1_b32 s55,2
s_cbranch_scc0 dsk_100614
buffer_load_dwordx4 v[24:27],v0,s[20:23],s96 offen offset:2048 sc1
dsk_100614:
s_bitcmp1_b32 s55,3
s_cbranch_scc0 dsk_100615
buffer_load_dwordx4 v[28:31],v0,s[20:23],s96 offen offset:3072 sc1
dsk_100615:
s_bitcmp1_b32 s55,4
s_cbranch_scc0 dsk_100616
buffer_load_dwordx4 v[32:35],v0,s[20:23],s97 offen offset:0 sc1
dsk_100616:
s_bitcmp1_b32 s55,5
s_cbranch_scc0 dsk_100617
buffer_load_dwordx4 v[36:39],v0,s[20:23],s97 offen offset:1024 sc1
dsk_100617:
s_bitcmp1_b32 s55,6
s_cbranch_scc0 dsk_100618
buffer_load_dwordx4 v[40:43],v0,s[20:23],s97 offen offset:2048 sc1
dsk_100618:
s_bitcmp1_b32 s55,7
s_cbranch_scc0 dsk_100619
buffer_load_dwordx4 v[44:47],v0,s[20:23],s97 offen offset:3072 sc1
dsk_100619:
s_bitcmp1_b32 s55,0
s_cbranch_scc0 dsk_100620
s_waitcnt vmcnt(2)
v_max3_u32 v124,v16,v17,v18
v_max_u32 v124,v124,v19
v_cmp_eq_u32 vcc,-1,v124
s_cbranch_vccz dgo_100621
s_nop 15
buffer_load_dwordx4 v[116:119],v0,s[20:23],s96 offen offset:0 sc1
s_nop 15
buffer_load_dwordx4 v[120:123],v0,s[20:23],s96 offen offset:0 sc1
dlp_100622:
s_waitcnt vmcnt(2)
v_max3_u32 v124,v16,v17,v18
v_max_u32 v124,v124,v19
v_cmp_eq_u32 vcc,-1,v124
s_cbranch_vccz dgo_100621
buffer_load_dwordx4 v[16:19],v0,s[20:23],s96 offen offset:0 sc1
s_waitcnt vmcnt(2)
v_max3_u32 v124,v116,v117,v118
v_max_u32 v124,v124,v119
v_cmp_eq_u32 vcc,-1,v124
s_cbranch_vccz dcp_100624
buffer_load_dwordx4 v[116:119],v0,s[20:23],s96 offen offset:0 sc1
s_waitcnt vmcnt(2)
v_max3_u32 v124,v120,v121,v122
v_max_u32 v124,v124,v123
v_cmp_eq_u32 vcc,-1,v124
s_cbranch_vccz dcp_100625
buffer_load_dwordx4 v[120:123],v0,s[20:23],s96 offen offset:0 sc1
s_sub_u32 s90,s90,1
s_cmp_gt_i32 s90,0
s_cbranch_scc1 dlp_100622
s_branch dgo_100621
dcp_100624:
v_mov_b32 v16,v116
v_mov_b32 v17,v117
v_mov_b32 v18,v118
v_mov_b32 v19,v119
s_nop 1
s_branch dgo_100621
dcp_100625:
v_mov_b32 v16,v120
v_mov_b32 v17,v121
v_mov_b32 v18,v122
v_mov_b32 v19,v123
s_nop 1
dgo_100621:
v_smfmac_f32_16x16x64_bf16 v[96:99],v[16:19],v[48:55],v1
v_smfmac_f32_16x16x64_bf16 v[100:103],v[16:19],v[56:63],v1
dsk_100620:
s_bitcmp1_b32 s55,1
s_cbranch_scc0 dsk_100626
s_waitcnt vmcnt(2)
v_max3_u32 v124,v20,v21,v22
v_max_u32 v124,v124,v23
v_cmp_eq_u32 vcc,-1,v124
s_cbranch_vccz dgo_100627
s_nop 15
buffer_load_dwordx4 v[116:119],v0,s[20:23],s96 offen offset:1024 sc1
s_nop 15
buffer_load_dwordx4 v[120:123],v0,s[20:23],s96 offen offset:1024 sc1
dlp_100628:
s_waitcnt vmcnt(2)
v_max3_u32 v124,v20,v21,v22
v_max_u32 v124,v124,v23
v_cmp_eq_u32 vcc,-1,v124
s_cbranch_vccz dgo_100627
buffer_load_dwordx4 v[20:23],v0,s[20:23],s96 offen offset:1024 sc1
s_waitcnt vmcnt(2)
v_max3_u32 v124,v116,v117,v118
v_max_u32 v124,v124,v119
v_cmp_eq_u32 vcc,-1,v124
s_cbranch_vccz dcp_100630
buffer_load_dwordx4 v[116:119],v0,s[20:23],s96 offen offset:1024 sc1
s_waitcnt vmcnt(2)
v_max3_u32 v124,v120,v121,v122
v_max_u32 v124,v124,v123
v_cmp_eq_u32 vcc,-1,v124
s_cbranch_vccz dcp_100631
buffer_load_dwordx4 v[120:123],v0,s[20:23],s96 offen offset:1024 sc1
s_sub_u32 s90,s90,1
s_cmp_gt_i32 s90,0
s_cbranch_scc1 dlp_100628
s_branch dgo_100627
dcp_100630:
v_mov_b32 v20,v116
v_mov_b32 v21,v117
v_mov_b32 v22,v118
v_mov_b32 v23,v119
s_nop 1
s_branch dgo_100627
dcp_100631:
v_mov_b32 v20,v120
v_mov_b32 v21,v121
v_mov_b32 v22,v122
v_mov_b32 v23,v123
s_nop 1
dgo_100627:
v_smfmac_f32_16x16x64_bf16 v[96:99],v[20:23],v[64:71],v1
v_smfmac_f32_16x16x64_bf16 v[100:103],v[20:23],v[72:79],v1
dsk_100626:
s_bitcmp1_b32 s55,2
s_cbranch_scc0 dsk_100632
s_waitcnt vmcnt(2)
v_max3_u32 v124,v24,v25,v26
v_max_u32 v124,v124,v27
v_cmp_eq_u32 vcc,-1,v124
s_cbranch_vccz dgo_100633
s_nop 15
buffer_load_dwordx4 v[116:119],v0,s[20:23],s96 offen offset:2048 sc1
s_nop 15
buffer_load_dwordx4 v[120:123],v0,s[20:23],s96 offen offset:2048 sc1
dlp_100634:
s_waitcnt vmcnt(2)
v_max3_u32 v124,v24,v25,v26
v_max_u32 v124,v124,v27
v_cmp_eq_u32 vcc,-1,v124
s_cbranch_vccz dgo_100633
buffer_load_dwordx4 v[24:27],v0,s[20:23],s96 offen offset:2048 sc1
s_waitcnt vmcnt(2)
v_max3_u32 v124,v116,v117,v118
v_max_u32 v124,v124,v119
v_cmp_eq_u32 vcc,-1,v124
s_cbranch_vccz dcp_100636
buffer_load_dwordx4 v[116:119],v0,s[20:23],s96 offen offset:2048 sc1
s_waitcnt vmcnt(2)
v_max3_u32 v124,v120,v121,v122
v_max_u32 v124,v124,v123
v_cmp_eq_u32 vcc,-1,v124
s_cbranch_vccz dcp_100637
buffer_load_dwordx4 v[120:123],v0,s[20:23],s96 offen offset:2048 sc1
s_sub_u32 s90,s90,1
s_cmp_gt_i32 s90,0
s_cbranch_scc1 dlp_100634
s_branch dgo_100633
dcp_100636:
v_mov_b32 v24,v116
v_mov_b32 v25,v117
v_mov_b32 v26,v118
v_mov_b32 v27,v119
s_nop 1
s_branch dgo_100633
dcp_100637:
v_mov_b32 v24,v120
v_mov_b32 v25,v121
v_mov_b32 v26,v122
v_mov_b32 v27,v123
s_nop 1
dgo_100633:
v_smfmac_f32_16x16x64_bf16 v[96:99],v[24:27],v[80:87],v1
v_smfmac_f32_16x16x64_bf16 v[100:103],v[24:27],v[88:95],v1
dsk_100632:
s_bitcmp1_b32 s55,3
s_cbranch_scc0 dsk_100638
s_waitcnt vmcnt(2)
v_max3_u32 v124,v28,v29,v30
v_max_u32 v124,v124,v31
v_cmp_eq_u32 vcc,-1,v124
s_cbranch_vccz dgo_100639
s_nop 15
buffer_load_dwordx4 v[116:119],v0,s[20:23],s96 offen offset:3072 sc1
s_nop 15
buffer_load_dwordx4 v[120:123],v0,s[20:23],s96 offen offset:3072 sc1
dlp_100640:
s_waitcnt vmcnt(2)
v_max3_u32 v124,v28,v29,v30
v_max_u32 v124,v124,v31
v_cmp_eq_u32 vcc,-1,v124
s_cbranch_vccz dgo_100639
buffer_load_dwordx4 v[28:31],v0,s[20:23],s96 offen offset:3072 sc1
s_waitcnt vmcnt(2)
v_max3_u32 v124,v116,v117,v118
v_max_u32 v124,v124,v119
v_cmp_eq_u32 vcc,-1,v124
s_cbranch_vccz dcp_100642
buffer_load_dwordx4 v[116:119],v0,s[20:23],s96 offen offset:3072 sc1
s_waitcnt vmcnt(2)
v_max3_u32 v124,v120,v121,v122
v_max_u32 v124,v124,v123
v_cmp_eq_u32 vcc,-1,v124
s_cbranch_vccz dcp_100643
buffer_load_dwordx4 v[120:123],v0,s[20:23],s96 offen offset:3072 sc1
s_sub_u32 s90,s90,1
s_cmp_gt_i32 s90,0
s_cbranch_scc1 dlp_100640
s_branch dgo_100639
dcp_100642:
v_mov_b32 v28,v116
v_mov_b32 v29,v117
v_mov_b32 v30,v118
v_mov_b32 v31,v119
s_nop 1
s_branch dgo_100639
dcp_100643:
v_mov_b32 v28,v120
v_mov_b32 v29,v121
v_mov_b32 v30,v122
v_mov_b32 v31,v123
s_nop 1
dgo_100639:
v_smfmac_f32_16x16x64_bf16 v[96:99],v[28:31],v[128:135],v1
v_smfmac_f32_16x16x64_bf16 v[100:103],v[28:31],v[136:143],v1
dsk_100638:
s_bitcmp1_b32 s55,4
s_cbranch_scc0 dsk_100644
s_waitcnt vmcnt(2)
v_max3_u32 v124,v32,v33,v34
v_max_u32 v124,v124,v35
v_cmp_eq_u32 vcc,-1,v124
s_cbranch_vccz dgo_100645
s_nop 15
buffer_load_dwordx4 v[116:119],v0,s[20:23],s97 offen offset:0 sc1
s_nop 15
buffer_load_dwordx4 v[120:123],v0,s[20:23],s97 offen offset:0 sc1
dlp_100646:
s_waitcnt vmcnt(2)
v_max3_u32 v124,v32,v33,v34
v_max_u32 v124,v124,v35
v_cmp_eq_u32 vcc,-1,v124
s_cbranch_vccz dgo_100645
buffer_load_dwordx4 v[32:35],v0,s[20:23],s97 offen offset:0 sc1
s_waitcnt vmcnt(2)
v_max3_u32 v124,v116,v117,v118
v_max_u32 v124,v124,v119
v_cmp_eq_u32 vcc,-1,v124
s_cbranch_vccz dcp_100648
buffer_load_dwordx4 v[116:119],v0,s[20:23],s97 offen offset:0 sc1
s_waitcnt vmcnt(2)
v_max3_u32 v124,v120,v121,v122
v_max_u32 v124,v124,v123
v_cmp_eq_u32 vcc,-1,v124
s_cbranch_vccz dcp_100649
buffer_load_dwordx4 v[120:123],v0,s[20:23],s97 offen offset:0 sc1
s_sub_u32 s90,s90,1
s_cmp_gt_i32 s90,0
s_cbranch_scc1 dlp_100646
s_branch dgo_100645
dcp_100648:
v_mov_b32 v32,v116
v_mov_b32 v33,v117
v_mov_b32 v34,v118
v_mov_b32 v35,v119
s_nop 1
s_branch dgo_100645
dcp_100649:
v_mov_b32 v32,v120
v_mov_b32 v33,v121
v_mov_b32 v34,v122
v_mov_b32 v35,v123
s_nop 1
dgo_100645:
v_smfmac_f32_16x16x64_bf16 v[96:99],v[32:35],v[144:151],v1
v_smfmac_f32_16x16x64_bf16 v[100:103],v[32:35],v[152:159],v1
dsk_100644:
s_bitcmp1_b32 s55,5
s_cbranch_scc0 dsk_100650
s_waitcnt vmcnt(2)
v_max3_u32 v124,v36,v37,v38
v_max_u32 v124,v124,v39
v_cmp_eq_u32 vcc,-1,v124
s_cbranch_vccz dgo_100651
s_nop 15
buffer_load_dwordx4 v[116:119],v0,s[20:23],s97 offen offset:1024 sc1
s_nop 15
buffer_load_dwordx4 v[120:123],v0,s[20:23],s97 offen offset:1024 sc1
dlp_100652:
s_waitcnt vmcnt(2)
v_max3_u32 v124,v36,v37,v38
v_max_u32 v124,v124,v39
v_cmp_eq_u32 vcc,-1,v124
s_cbranch_vccz dgo_100651
buffer_load_dwordx4 v[36:39],v0,s[20:23],s97 offen offset:1024 sc1
s_waitcnt vmcnt(2)
v_max3_u32 v124,v116,v117,v118
v_max_u32 v124,v124,v119
v_cmp_eq_u32 vcc,-1,v124
s_cbranch_vccz dcp_100654
buffer_load_dwordx4 v[116:119],v0,s[20:23],s97 offen offset:1024 sc1
s_waitcnt vmcnt(2)
v_max3_u32 v124,v120,v121,v122
v_max_u32 v124,v124,v123
v_cmp_eq_u32 vcc,-1,v124
s_cbranch_vccz dcp_100655
buffer_load_dwordx4 v[120:123],v0,s[20:23],s97 offen offset:1024 sc1
s_sub_u32 s90,s90,1
s_cmp_gt_i32 s90,0
s_cbranch_scc1 dlp_100652
s_branch dgo_100651
dcp_100654:
v_mov_b32 v36,v116
v_mov_b32 v37,v117
v_mov_b32 v38,v118
v_mov_b32 v39,v119
s_nop 1
s_branch dgo_100651
dcp_100655:
v_mov_b32 v36,v120
v_mov_b32 v37,v121
v_mov_b32 v38,v122
v_mov_b32 v39,v123
s_nop 1
dgo_100651:
v_smfmac_f32_16x16x64_bf16 v[96:99],v[36:39],v[160:167],v1
v_smfmac_f32_16x16x64_bf16 v[100:103],v[36:39],v[168:175],v1
dsk_100650:
s_bitcmp1_b32 s55,6
s_cbranch_scc0 dsk_100656
s_waitcnt vmcnt(2)
v_max3_u32 v124,v40,v41,v42
v_max_u32 v124,v124,v43
v_cmp_eq_u32 vcc,-1,v124
s_cbranch_vccz dgo_100657
s_nop 15
buffer_load_dwordx4 v[116:119],v0,s[20:23],s97 offen offset:2048 sc1
s_nop 15
buffer_load_dwordx4 v[120:123],v0,s[20:23],s97 offen offset:2048 sc1
dlp_100658:
s_waitcnt vmcnt(2)
v_max3_u32 v124,v40,v41,v42
v_max_u32 v124,v124,v43
v_cmp_eq_u32 vcc,-1,v124
s_cbranch_vccz dgo_100657
buffer_load_dwordx4 v[40:43],v0,s[20:23],s97 offen offset:2048 sc1
s_waitcnt vmcnt(2)
v_max3_u32 v124,v116,v117,v118
v_max_u32 v124,v124,v119
v_cmp_eq_u32 vcc,-1,v124
s_cbranch_vccz dcp_100660
buffer_load_dwordx4 v[116:119],v0,s[20:23],s97 offen offset:2048 sc1
s_waitcnt vmcnt(2)
v_max3_u32 v124,v120,v121,v122
v_max_u32 v124,v124,v123
v_cmp_eq_u32 vcc,-1,v124
s_cbranch_vccz dcp_100661
buffer_load_dwordx4 v[120:123],v0,s[20:23],s97 offen offset:2048 sc1
s_sub_u32 s90,s90,1
s_cmp_gt_i32 s90,0
s_cbranch_scc1 dlp_100658
s_branch dgo_100657
dcp_100660:
v_mov_b32 v40,v116
v_mov_b32 v41,v117
v_mov_b32 v42,v118
v_mov_b32 v43,v119
s_nop 1
s_branch dgo_100657
dcp_100661:
v_mov_b32 v40,v120
v_mov_b32 v41,v121
v_mov_b32 v42,v122
v_mov_b32 v43,v123
s_nop 1
dgo_100657:
v_smfmac_f32_16x16x64_bf16 v[96:99],v[40:43],v[176:183],v1
v_smfmac_f32_16x16x64_bf16 v[100:103],v[40:43],v[184:191],v1
dsk_100656:
s_bitcmp1_b32 s55,7
s_cbranch_scc0 dsk_100662
s_waitcnt vmcnt(2)
v_max3_u32 v124,v44,v45,v46
v_max_u32 v124,v124,v47
v_cmp_eq_u32 vcc,-1,v124
s_cbranch_vccz dgo_100663
s_nop 15
buffer_load_dwordx4 v[116:119],v0,s[20:23],s97 offen offset:3072 sc1
s_nop 15
buffer_load_dwordx4 v[120:123],v0,s[20:23],s97 offen offset:3072 sc1
dlp_100664:
s_waitcnt vmcnt(2)
v_max3_u32 v124,v44,v45,v46
v_max_u32 v124,v124,v47
v_cmp_eq_u32 vcc,-1,v124
s_cbranch_vccz dgo_100663
buffer_load_dwordx4 v[44:47],v0,s[20:23],s97 offen offset:3072 sc1
s_waitcnt vmcnt(2)
v_max3_u32 v124,v116,v117,v118
v_max_u32 v124,v124,v119
v_cmp_eq_u32 vcc,-1,v124
s_cbranch_vccz dcp_100666
buffer_load_dwordx4 v[116:119],v0,s[20:23],s97 offen offset:3072 sc1
s_waitcnt vmcnt(2)
v_max3_u32 v124,v120,v121,v122
v_max_u32 v124,v124,v123
v_cmp_eq_u32 vcc,-1,v124
s_cbranch_vccz dcp_100667
buffer_load_dwordx4 v[120:123],v0,s[20:23],s97 offen offset:3072 sc1
s_sub_u32 s90,s90,1
s_cmp_gt_i32 s90,0
s_cbranch_scc1 dlp_100664
s_branch dgo_100663
dcp_100666:
v_mov_b32 v44,v116
v_mov_b32 v45,v117
v_mov_b32 v46,v118
v_mov_b32 v47,v119
s_nop 1
s_branch dgo_100663
dcp_100667:
v_mov_b32 v44,v120
v_mov_b32 v45,v121
v_mov_b32 v46,v122
v_mov_b32 v47,v123
s_nop 1
dgo_100663:
v_smfmac_f32_16x16x64_bf16 v[96:99],v[44:47],v[192:199],v1
v_smfmac_f32_16x16x64_bf16 v[100:103],v[44:47],v[200:207],v1
dsk_100662:
s_mov_b32 s55,0
s_branch oback_100442
fl_100459:
flb_100467:
buffer_load_dwordx4 v[16:19],v0,s[20:23],s92 offen offset:0 sc1
s_mov_b32 s55,1
buffer_load_dwordx4 v[32:35],v0,s[20:23],s93 offen offset:0 sc1
s_waitcnt vmcnt(4)
v_max3_u32 v124,v20,v21,v22
v_max_u32 v124,v124,v23
v_cmp_eq_u32 vcc,-1,v124
s_cbranch_vccnz dfl_100668
v_smfmac_f32_16x16x64_bf16 v[64:67],v[20:23],a[96:103],v1
buffer_load_dword v125,off,s[20:23],s92 sc1
buffer_load_dwordx4 v[36:39],v0,s[20:23],s93 offen offset:1024 sc1
s_waitcnt vmcnt(5)
v_max3_u32 v124,v24,v25,v26
v_smfmac_f32_16x16x64_bf16 v[68:71],v[20:23],a[104:111],v1
v_max_u32 v124,v124,v27
v_cmp_eq_u32 vcc,-1,v124
v_smfmac_f32_16x16x64_bf16 v[72:75],v[20:23],a[112:119],v1
v_smfmac_f32_16x16x64_bf16 v[76:79],v[20:23],a[120:127],v1
s_cbranch_vccnz dfl_100669
v_smfmac_f32_16x16x64_bf16 v[64:67],v[24:27],a[160:167],v1
buffer_load_dword v125,off,s[20:23],s92 sc1
buffer_load_dwordx4 v[40:43],v0,s[20:23],s93 offen offset:2048 sc1
buffer_load_dwordx4 v[44:47],v0,s[20:23],s93 offen offset:3072 sc1
s_waitcnt vmcnt(7)
v_max3_u32 v124,v28,v29,v30
v_smfmac_f32_16x16x64_bf16 v[68:71],v[24:27],a[168:175],v1
v_max_u32 v124,v124,v31
v_cmp_eq_u32 vcc,-1,v124
v_smfmac_f32_16x16x64_bf16 v[72:75],v[24:27],a[176:183],v1
v_smfmac_f32_16x16x64_bf16 v[76:79],v[24:27],a[184:191],v1
s_cbranch_vccnz dfl_100670
v_smfmac_f32_16x16x64_bf16 v[64:67],v[28:31],a[224:231],v1
buffer_load_dword v125,off,s[20:23],s92 sc1
s_waitcnt vmcnt(7)
v_max3_u32 v124,v16,v17,v18
v_smfmac_f32_16x16x64_bf16 v[68:71],v[28:31],a[232:239],v1
v_max_u32 v124,v124,v19
v_cmp_eq_u32 vcc,-1,v124
v_smfmac_f32_16x16x64_bf16 v[72:75],v[28:31],a[240:247],v1
v_smfmac_f32_16x16x64_bf16 v[76:79],v[28:31],a[248:255],v1
s_cbranch_vccnz lfb_100675
s_mov_b32 s55,0
v_smfmac_f32_16x16x64_bf16 v[64:67],v[16:19],a[32:39],v1
s_waitcnt vmcnt(6)
v_max3_u32 v124,v32,v33,v34
v_max_u32 v124,v124,v35
v_cmp_eq_u32 vcc,-1,v124
v_smfmac_f32_16x16x64_bf16 v[68:71],v[16:19],a[40:47],v1
v_smfmac_f32_16x16x64_bf16 v[72:75],v[16:19],a[48:55],v1
v_smfmac_f32_16x16x64_bf16 v[76:79],v[16:19],a[56:63],v1
s_cbranch_vccnz flb_100471
s_branch segb_100455
fl_100460:
flb_100468:
buffer_load_dwordx4 v[20:23],v0,s[20:23],s92 offen offset:1024 sc1
s_mov_b32 s55,2
buffer_load_dwordx4 v[36:39],v0,s[20:23],s93 offen offset:1024 sc1
s_waitcnt vmcnt(5)
v_max3_u32 v124,v24,v25,v26
v_max_u32 v124,v124,v27
v_cmp_eq_u32 vcc,-1,v124
s_cbranch_vccnz dfl_100669
v_smfmac_f32_16x16x64_bf16 v[64:67],v[24:27],a[160:167],v1
buffer_load_dword v125,off,s[20:23],s92 sc1
buffer_load_dwordx4 v[40:43],v0,s[20:23],s93 offen offset:2048 sc1
buffer_load_dwordx4 v[44:47],v0,s[20:23],s93 offen offset:3072 sc1
s_waitcnt vmcnt(7)
v_max3_u32 v124,v28,v29,v30
v_smfmac_f32_16x16x64_bf16 v[68:71],v[24:27],a[168:175],v1
v_max_u32 v124,v124,v31
v_cmp_eq_u32 vcc,-1,v124
v_smfmac_f32_16x16x64_bf16 v[72:75],v[24:27],a[176:183],v1
v_smfmac_f32_16x16x64_bf16 v[76:79],v[24:27],a[184:191],v1
s_cbranch_vccnz dfl_100670
v_smfmac_f32_16x16x64_bf16 v[64:67],v[28:31],a[224:231],v1
buffer_load_dword v125,off,s[20:23],s92 sc1
s_waitcnt vmcnt(5)
v_max3_u32 v124,v20,v21,v22
v_smfmac_f32_16x16x64_bf16 v[68:71],v[28:31],a[232:239],v1
v_max_u32 v124,v124,v23
v_cmp_eq_u32 vcc,-1,v124
v_smfmac_f32_16x16x64_bf16 v[72:75],v[28:31],a[240:247],v1
v_smfmac_f32_16x16x64_bf16 v[76:79],v[28:31],a[248:255],v1
s_cbranch_vccnz lfb_100675
s_mov_b32 s55,0
v_smfmac_f32_16x16x64_bf16 v[64:67],v[20:23],a[96:103],v1
s_waitcnt vmcnt(6)
v_max3_u32 v124,v32,v33,v34
v_max_u32 v124,v124,v35
v_cmp_eq_u32 vcc,-1,v124
v_smfmac_f32_16x16x64_bf16 v[68:71],v[20:23],a[104:111],v1
v_smfmac_f32_16x16x64_bf16 v[72:75],v[20:23],a[112:119],v1
v_smfmac_f32_16x16x64_bf16 v[76:79],v[20:23],a[120:127],v1
s_cbranch_vccnz flb_100471
s_branch segb_100455
fl_100461:
flb_100469:
buffer_load_dwordx4 v[24:27],v0,s[20:23],s92 offen offset:2048 sc1
s_mov_b32 s55,4
buffer_load_dwordx4 v[40:43],v0,s[20:23],s93 offen offset:2048 sc1
buffer_load_dwordx4 v[44:47],v0,s[20:23],s93 offen offset:3072 sc1
s_waitcnt vmcnt(7)
v_max3_u32 v124,v28,v29,v30
v_max_u32 v124,v124,v31
v_cmp_eq_u32 vcc,-1,v124
s_cbranch_vccnz dfl_100670
v_smfmac_f32_16x16x64_bf16 v[64:67],v[28:31],a[224:231],v1
buffer_load_dword v125,off,s[20:23],s92 sc1
s_waitcnt vmcnt(3)
v_max3_u32 v124,v24,v25,v26
v_smfmac_f32_16x16x64_bf16 v[68:71],v[28:31],a[232:239],v1
v_max_u32 v124,v124,v27
v_cmp_eq_u32 vcc,-1,v124
v_smfmac_f32_16x16x64_bf16 v[72:75],v[28:31],a[240:247],v1
v_smfmac_f32_16x16x64_bf16 v[76:79],v[28:31],a[248:255],v1
s_cbranch_vccnz lfb_100675
s_mov_b32 s55,0
v_smfmac_f32_16x16x64_bf16 v[64:67],v[24:27],a[160:167],v1
s_waitcnt vmcnt(6)
v_max3_u32 v124,v32,v33,v34
v_max_u32 v124,v124,v35
v_cmp_eq_u32 vcc,-1,v124
v_smfmac_f32_16x16x64_bf16 v[68:71],v[24:27],a[168:175],v1
v_smfmac_f32_16x16x64_bf16 v[72:75],v[24:27],a[176:183],v1
v_smfmac_f32_16x16x64_bf16 v[76:79],v[24:27],a[184:191],v1
s_cbranch_vccnz flb_100471
s_branch segb_100455
fl_100462:
flb_100470:
buffer_load_dwordx4 v[28:31],v0,s[20:23],s92 offen offset:3072 sc1
s_mov_b32 s55,8
s_waitcnt vmcnt(0)
v_max3_u32 v124,v28,v29,v30
v_max_u32 v124,v124,v31
v_cmp_eq_u32 vcc,-1,v124
s_cbranch_vccnz lfb_100675
s_mov_b32 s55,0
v_smfmac_f32_16x16x64_bf16 v[64:67],v[28:31],a[224:231],v1
s_waitcnt vmcnt(6)
v_max3_u32 v124,v32,v33,v34
v_max_u32 v124,v124,v35
v_cmp_eq_u32 vcc,-1,v124
v_smfmac_f32_16x16x64_bf16 v[68:71],v[28:31],a[232:239],v1
v_smfmac_f32_16x16x64_bf16 v[72:75],v[28:31],a[240:247],v1
v_smfmac_f32_16x16x64_bf16 v[76:79],v[28:31],a[248:255],v1
s_cbranch_vccnz flb_100471
s_branch segb_100455
fl_100463:
flb_100471:
buffer_load_dwordx4 v[32:35],v0,s[20:23],s93 offen offset:0 sc1
s_mov_b32 s55,240
buffer_store_dwordx4 v[112:115],v120,s[20:23],s101 offen sc1
buffer_store_dword v126,v121,s[20:23],s69 offen sc1
s_bitcmp1_b32 s55,5
s_cbranch_scc0 rdn_100678
s_waitcnt vmcnt(7)
v_max3_u32 v124,v36,v37,v38
v_max_u32 v124,v124,v39
v_cmp_eq_u32 vcc,-1,v124
s_cbranch_vccnz rfa_100679
buffer_load_dword v125,off,s[20:23],s92 sc1
s_bitset0_b32 s55,5
v_smfmac_f32_16x16x64_bf16 v[64:67],v[36:39],a[96:103],v1
v_smfmac_f32_16x16x64_bf16 v[68:71],v[36:39],a[104:111],v1
v_smfmac_f32_16x16x64_bf16 v[72:75],v[36:39],a[112:119],v1
v_smfmac_f32_16x16x64_bf16 v[76:79],v[36:39],a[120:127],v1
s_cmp_eq_u32 s55,0
s_cbranch_scc1 segb_100457
s_branch rnx_100680
rdn_100678:
buffer_load_dword v125,off,s[20:23],s92 sc1
s_branch rnx_100680
rfa_100679:
buffer_load_dwordx4 v[36:39],v0,s[20:23],s93 offen offset:1024 sc1
rnx_100680:
s_bitcmp1_b32 s55,6
s_cbranch_scc0 rdn_100681
s_waitcnt vmcnt(6)
v_max3_u32 v124,v40,v41,v42
v_max_u32 v124,v124,v43
v_cmp_eq_u32 vcc,-1,v124
s_cbranch_vccnz rfa_100682
buffer_load_dword v125,off,s[20:23],s92 sc1
s_bitset0_b32 s55,6
s_cmp_eq_u32 s55,0
s_cbranch_scc1 segb_100457
s_branch rnx_100683
rdn_100681:
buffer_load_dword v125,off,s[20:23],s92 sc1
s_branch rnx_100683
rfa_100682:
buffer_load_dwordx4 v[40:43],v0,s[20:23],s93 offen offset:2048 sc1
rnx_100683:
s_bitcmp1_b32 s55,7
s_cbranch_scc0 rdn_100684
s_waitcnt vmcnt(6)
v_max3_u32 v124,v44,v45,v46
v_max_u32 v124,v124,v47
v_cmp_eq_u32 vcc,-1,v124
s_cbranch_vccnz rfa_100685
buffer_load_dword v125,off,s[20:23],s92 sc1
s_bitset0_b32 s55,7
s_cmp_eq_u32 s55,0
s_cbranch_scc1 segb_100457
s_branch rnx_100686
rdn_100684:
buffer_load_dword v125,off,s[20:23],s92 sc1
s_branch rnx_100686
rfa_100685:
buffer_load_dwordx4 v[44:47],v0,s[20:23],s93 offen offset:3072 sc1
rnx_100686:
rot_100677:
s_bitcmp1_b32 s55,4
s_cbranch_scc0 rdn_100687
s_waitcnt vmcnt(3)
v_max3_u32 v124,v32,v33,v34
v_max_u32 v124,v124,v35
v_cmp_eq_u32 vcc,-1,v124
s_cbranch_vccnz rfa_100688
buffer_load_dword v125,off,s[20:23],s92 sc1
s_bitset0_b32 s55,4
v_smfmac_f32_16x16x64_bf16 v[64:67],v[32:35],a[32:39],v1
v_smfmac_f32_16x16x64_bf16 v[68:71],v[32:35],a[40:47],v1
v_smfmac_f32_16x16x64_bf16 v[72:75],v[32:35],a[48:55],v1
v_smfmac_f32_16x16x64_bf16 v[76:79],v[32:35],a[56:63],v1
s_cmp_eq_u32 s55,0
s_cbranch_scc1 segb_100457
s_branch rnx_100689
rdn_100687:
buffer_load_dword v125,off,s[20:23],s92 sc1
s_branch rnx_100689
rfa_100688:
buffer_load_dwordx4 v[32:35],v0,s[20:23],s93 offen offset:0 sc1
rnx_100689:
s_bitcmp1_b32 s55,5
s_cbranch_scc0 rdn_100690
s_waitcnt vmcnt(3)
v_max3_u32 v124,v36,v37,v38
v_max_u32 v124,v124,v39
v_cmp_eq_u32 vcc,-1,v124
s_cbranch_vccnz rfa_100691
buffer_load_dword v125,off,s[20:23],s92 sc1
s_bitset0_b32 s55,5
v_smfmac_f32_16x16x64_bf16 v[64:67],v[36:39],a[96:103],v1
v_smfmac_f32_16x16x64_bf16 v[68:71],v[36:39],a[104:111],v1
v_smfmac_f32_16x16x64_bf16 v[72:75],v[36:39],a[112:119],v1
v_smfmac_f32_16x16x64_bf16 v[76:79],v[36:39],a[120:127],v1
s_cmp_eq_u32 s55,0
s_cbranch_scc1 segb_100457
s_branch rnx_100692
rdn_100690:
buffer_load_dword v125,off,s[20:23],s92 sc1
s_branch rnx_100692
rfa_100691:
buffer_load_dwordx4 v[36:39],v0,s[20:23],s93 offen offset:1024 sc1
rnx_100692:
s_bitcmp1_b32 s55,6
s_cbranch_scc0 rdn_100693
s_waitcnt vmcnt(3)
v_max3_u32 v124,v40,v41,v42
v_max_u32 v124,v124,v43
v_cmp_eq_u32 vcc,-1,v124
s_cbranch_vccnz rfa_100694
buffer_load_dword v125,off,s[20:23],s92 sc1
s_bitset0_b32 s55,6
s_cmp_eq_u32 s55,0
s_cbranch_scc1 segb_100457
s_branch rnx_100695
rdn_100693:
buffer_load_dword v125,off,s[20:23],s92 sc1
s_branch rnx_100695
rfa_100694:
buffer_load_dwordx4 v[40:43],v0,s[20:23],s93 offen offset:2048 sc1
rnx_100695:
s_bitcmp1_b32 s55,7
s_cbranch_scc0 rdn_100696
s_waitcnt vmcnt(3)
v_max3_u32 v124,v44,v45,v46
v_max_u32 v124,v124,v47
v_cmp_eq_u32 vcc,-1,v124
s_cbranch_vccnz rfa_100697
buffer_load_dword v125,off,s[20:23],s92 sc1
s_bitset0_b32 s55,7
s_cmp_eq_u32 s55,0
s_cbranch_scc1 segb_100457
s_branch rnx_100698
rdn_100696:
buffer_load_dword v125,off,s[20:23],s92 sc1
s_branch rnx_100698
rfa_100697:
buffer_load_dwordx4 v[44:47],v0,s[20:23],s93 offen offset:3072 sc1
rnx_100698:
s_sub_u32 s90,s90,1
s_cmp_gt_i32 s90,0
s_cbranch_scc1 rot_100677
s_mov_b32 s55,0
s_branch segb_100457
fl_100464:
flb_100472:
buffer_load_dwordx4 v[36:39],v0,s[20:23],s93 offen offset:1024 sc1
s_mov_b32 s55,224
s_bitcmp1_b32 s55,6
s_cbranch_scc0 rdn_100700
s_waitcnt vmcnt(6)
v_max3_u32 v124,v40,v41,v42
v_max_u32 v124,v124,v43
v_cmp_eq_u32 vcc,-1,v124
s_cbranch_vccnz rfa_100701
buffer_load_dword v125,off,s[20:23],s92 sc1
s_bitset0_b32 s55,6
s_cmp_eq_u32 s55,0
s_cbranch_scc1 segb_100457
s_branch rnx_100702
rdn_100700:
buffer_load_dword v125,off,s[20:23],s92 sc1
s_branch rnx_100702
rfa_100701:
buffer_load_dwordx4 v[40:43],v0,s[20:23],s93 offen offset:2048 sc1
rnx_100702:
s_bitcmp1_b32 s55,7
s_cbranch_scc0 rdn_100703
s_waitcnt vmcnt(6)
v_max3_u32 v124,v44,v45,v46
v_max_u32 v124,v124,v47
v_cmp_eq_u32 vcc,-1,v124
s_cbranch_vccnz rfa_100704
buffer_load_dword v125,off,s[20:23],s92 sc1
s_bitset0_b32 s55,7
s_cmp_eq_u32 s55,0
s_cbranch_scc1 segb_100457
s_branch rnx_100705
rdn_100703:
buffer_load_dword v125,off,s[20:23],s92 sc1
s_branch rnx_100705
rfa_100704:
buffer_load_dwordx4 v[44:47],v0,s[20:23],s93 offen offset:3072 sc1
rnx_100705:
rot_100699:
s_bitcmp1_b32 s55,5
s_cbranch_scc0 rdn_100706
s_waitcnt vmcnt(2)
v_max3_u32 v124,v36,v37,v38
v_max_u32 v124,v124,v39
v_cmp_eq_u32 vcc,-1,v124
s_cbranch_vccnz rfa_100707
buffer_load_dword v125,off,s[20:23],s92 sc1
s_bitset0_b32 s55,5
v_smfmac_f32_16x16x64_bf16 v[64:67],v[36:39],a[96:103],v1
v_smfmac_f32_16x16x64_bf16 v[68:71],v[36:39],a[104:111],v1
v_smfmac_f32_16x16x64_bf16 v[72:75],v[36:39],a[112:119],v1
v_smfmac_f32_16x16x64_bf16 v[76:79],v[36:39],a[120:127],v1
s_cmp_eq_u32 s55,0
s_cbranch_scc1 segb_100457
s_branch rnx_100708
rdn_100706:
buffer_load_dword v125,off,s[20:23],s92 sc1
s_branch rnx_100708
rfa_100707:
buffer_load_dwordx4 v[36:39],v0,s[20:23],s93 offen offset:1024 sc1
rnx_100708:
s_bitcmp1_b32 s55,6
s_cbranch_scc0 rdn_100709
s_waitcnt vmcnt(2)
v_max3_u32 v124,v40,v41,v42
v_max_u32 v124,v124,v43
v_cmp_eq_u32 vcc,-1,v124
s_cbranch_vccnz rfa_100710
buffer_load_dword v125,off,s[20:23],s92 sc1
s_bitset0_b32 s55,6
s_cmp_eq_u32 s55,0
s_cbranch_scc1 segb_100457
s_branch rnx_100711
rdn_100709:
buffer_load_dword v125,off,s[20:23],s92 sc1
s_branch rnx_100711
rfa_100710:
buffer_load_dwordx4 v[40:43],v0,s[20:23],s93 offen offset:2048 sc1
rnx_100711:
s_bitcmp1_b32 s55,7
s_cbranch_scc0 rdn_100712
s_waitcnt vmcnt(2)
v_max3_u32 v124,v44,v45,v46
v_max_u32 v124,v124,v47
v_cmp_eq_u32 vcc,-1,v124
s_cbranch_vccnz rfa_100713
buffer_load_dword v125,off,s[20:23],s92 sc1
s_bitset0_b32 s55,7
s_cmp_eq_u32 s55,0
s_cbranch_scc1 segb_100457
s_branch rnx_100714
rdn_100712:
buffer_load_dword v125,off,s[20:23],s92 sc1
s_branch rnx_100714
rfa_100713:
buffer_load_dwordx4 v[44:47],v0,s[20:23],s93 offen offset:3072 sc1
rnx_100714:
s_sub_u32 s90,s90,1
s_cmp_gt_i32 s90,0
s_cbranch_scc1 rot_100699
s_mov_b32 s55,0
s_branch segb_100457
fl_100465:
flb_100473:
s_mov_b32 s55,192
s_bitcmp1_b32 s55,6
s_cbranch_scc0 rdn_100716
s_waitcnt vmcnt(6)
v_max3_u32 v124,v40,v41,v42
v_max_u32 v124,v124,v43
v_cmp_eq_u32 vcc,-1,v124
s_cbranch_vccnz rfa_100717
buffer_load_dword v125,off,s[20:23],s92 sc1
s_bitset0_b32 s55,6
s_cmp_eq_u32 s55,0
s_cbranch_scc1 segb_100457
s_branch rnx_100718
rdn_100716:
buffer_load_dword v125,off,s[20:23],s92 sc1
s_branch rnx_100718
rfa_100717:
buffer_load_dwordx4 v[40:43],v0,s[20:23],s93 offen offset:2048 sc1
rnx_100718:
s_bitcmp1_b32 s55,7
s_cbranch_scc0 rdn_100719
s_waitcnt vmcnt(6)
v_max3_u32 v124,v44,v45,v46
v_max_u32 v124,v124,v47
v_cmp_eq_u32 vcc,-1,v124
s_cbranch_vccnz rfa_100720
buffer_load_dword v125,off,s[20:23],s92 sc1
s_bitset0_b32 s55,7
s_cmp_eq_u32 s55,0
s_cbranch_scc1 segb_100457
s_branch rnx_100721
rdn_100719:
buffer_load_dword v125,off,s[20:23],s92 sc1
s_branch rnx_100721
rfa_100720:
buffer_load_dwordx4 v[44:47],v0,s[20:23],s93 offen offset:3072 sc1
rnx_100721:
rot_100715:
s_bitcmp1_b32 s55,6
s_cbranch_scc0 rdn_100722
s_waitcnt vmcnt(1)
v_max3_u32 v124,v40,v41,v42
v_max_u32 v124,v124,v43
v_cmp_eq_u32 vcc,-1,v124
s_cbranch_vccnz rfa_100723
buffer_load_dword v125,off,s[20:23],s92 sc1
s_bitset0_b32 s55,6
s_cmp_eq_u32 s55,0
s_cbranch_scc1 segb_100457
s_branch rnx_100724
rdn_100722:
buffer_load_dword v125,off,s[20:23],s92 sc1
s_branch rnx_100724
rfa_100723:
buffer_load_dwordx4 v[40:43],v0,s[20:23],s93 offen offset:2048 sc1
rnx_100724:
s_bitcmp1_b32 s55,7
s_cbranch_scc0 rdn_100725
s_waitcnt vmcnt(1)
v_max3_u32 v124,v44,v45,v46
v_max_u32 v124,v124,v47
v_cmp_eq_u32 vcc,-1,v124
s_cbranch_vccnz rfa_100726
buffer_load_dword v125,off,s[20:23],s92 sc1
s_bitset0_b32 s55,7
s_cmp_eq_u32 s55,0
s_cbranch_scc1 segb_100457
s_branch rnx_100727
rdn_100725:
buffer_load_dword v125,off,s[20:23],s92 sc1
s_branch rnx_100727
rfa_100726:
buffer_load_dwordx4 v[44:47],v0,s[20:23],s93 offen offset:3072 sc1
rnx_100727:
s_sub_u32 s90,s90,1
s_cmp_gt_i32 s90,0
s_cbranch_scc1 rot_100715
s_mov_b32 s55,0
s_branch segb_100457
dfl_100668:
buffer_load_dwordx4 v[20:23],v0,s[20:23],s92 offen offset:1024 sc1
s_bitset1_b32 s55,1
buffer_load_dwordx4 v[36:39],v0,s[20:23],s93 offen offset:1024 sc1
s_waitcnt vmcnt(5)
v_max3_u32 v124,v24,v25,v26
v_max_u32 v124,v124,v27
v_cmp_eq_u32 vcc,-1,v124
s_cbranch_vccnz dfl_100669
s_branch dseg_100672
dfl_100669:
buffer_load_dwordx4 v[24:27],v0,s[20:23],s92 offen offset:2048 sc1
s_bitset1_b32 s55,2
buffer_load_dwordx4 v[40:43],v0,s[20:23],s93 offen offset:2048 sc1
buffer_load_dwordx4 v[44:47],v0,s[20:23],s93 offen offset:3072 sc1
s_waitcnt vmcnt(7)
v_max3_u32 v124,v28,v29,v30
v_max_u32 v124,v124,v31
v_cmp_eq_u32 vcc,-1,v124
s_cbranch_vccnz dfl_100670
s_branch dseg_100673
dfl_100670:
buffer_load_dwordx4 v[28:31],v0,s[20:23],s92 offen offset:3072 sc1
s_bitset1_b32 s55,3
s_branch lap2_100674
dseg_100672:
v_smfmac_f32_16x16x64_bf16 v[64:67],v[24:27],a[160:167],v1
buffer_load_dword v125,off,s[20:23],s92 sc1
buffer_load_dwordx4 v[40:43],v0,s[20:23],s93 offen offset:2048 sc1
buffer_load_dwordx4 v[44:47],v0,s[20:23],s93 offen offset:3072 sc1
s_waitcnt vmcnt(7)
v_max3_u32 v124,v28,v29,v30
v_smfmac_f32_16x16x64_bf16 v[68:71],v[24:27],a[168:175],v1
v_max_u32 v124,v124,v31
v_cmp_eq_u32 vcc,-1,v124
v_smfmac_f32_16x16x64_bf16 v[72:75],v[24:27],a[176:183],v1
v_smfmac_f32_16x16x64_bf16 v[76:79],v[24:27],a[184:191],v1
s_cbranch_vccnz dfl_100670
dseg_100673:
v_smfmac_f32_16x16x64_bf16 v[64:67],v[28:31],a[224:231],v1
buffer_load_dword v125,off,s[20:23],s92 sc1
v_smfmac_f32_16x16x64_bf16 v[68:71],v[28:31],a[232:239],v1
v_smfmac_f32_16x16x64_bf16 v[72:75],v[28:31],a[240:247],v1
v_smfmac_f32_16x16x64_bf16 v[76:79],v[28:31],a[248:255],v1
lap2_100674:
s_bitcmp1_b32 s55,0
s_cbranch_scc0 l2s_100728
s_waitcnt vmcnt(7)
v_max3_u32 v124,v16,v17,v18
v_max_u32 v124,v124,v19
v_cmp_eq_u32 vcc,-1,v124
s_cbranch_vccnz l2s_100728
s_bitset0_b32 s55,0
v_smfmac_f32_16x16x64_bf16 v[64:67],v[16:19],a[32:39],v1
v_smfmac_f32_16x16x64_bf16 v[68:71],v[16:19],a[40:47],v1
v_smfmac_f32_16x16x64_bf16 v[72:75],v[16:19],a[48:55],v1
v_smfmac_f32_16x16x64_bf16 v[76:79],v[16:19],a[56:63],v1
l2s_100728:
s_bitcmp1_b32 s55,1
s_cbranch_scc0 l2s_100730
s_waitcnt vmcnt(5)
v_max3_u32 v124,v20,v21,v22
v_max_u32 v124,v124,v23
v_cmp_eq_u32 vcc,-1,v124
s_cbranch_vccnz l2s_100730
s_bitset0_b32 s55,1
v_smfmac_f32_16x16x64_bf16 v[64:67],v[20:23],a[96:103],v1
v_smfmac_f32_16x16x64_bf16 v[68:71],v[20:23],a[104:111],v1
v_smfmac_f32_16x16x64_bf16 v[72:75],v[20:23],a[112:119],v1
v_smfmac_f32_16x16x64_bf16 v[76:79],v[20:23],a[120:127],v1
l2s_100730:
s_bitcmp1_b32 s55,2
s_cbranch_scc0 l2s_100732
s_waitcnt vmcnt(3)
v_max3_u32 v124,v24,v25,v26
v_max_u32 v124,v124,v27
v_cmp_eq_u32 vcc,-1,v124
s_cbranch_vccnz l2s_100732
s_bitset0_b32 s55,2
v_smfmac_f32_16x16x64_bf16 v[64:67],v[24:27],a[160:167],v1
v_smfmac_f32_16x16x64_bf16 v[68:71],v[24:27],a[168:175],v1
v_smfmac_f32_16x16x64_bf16 v[72:75],v[24:27],a[176:183],v1
v_smfmac_f32_16x16x64_bf16 v[76:79],v[24:27],a[184:191],v1
l2s_100732:
s_bitcmp1_b32 s55,3
s_cbranch_scc0 l2s_100734
s_waitcnt vmcnt(0)
v_max3_u32 v124,v28,v29,v30
v_max_u32 v124,v124,v31
v_cmp_eq_u32 vcc,-1,v124
s_cbranch_vccnz l2s_100734
s_bitset0_b32 s55,3
v_smfmac_f32_16x16x64_bf16 v[64:67],v[28:31],a[224:231],v1
v_smfmac_f32_16x16x64_bf16 v[68:71],v[28:31],a[232:239],v1
v_smfmac_f32_16x16x64_bf16 v[72:75],v[28:31],a[240:247],v1
v_smfmac_f32_16x16x64_bf16 v[76:79],v[28:31],a[248:255],v1
l2s_100734:
s_cmp_eq_u32 s55,0
s_cbranch_scc0 lfb_100675
Ldone_100676:
s_waitcnt vmcnt(6)
v_max3_u32 v124,v32,v33,v34
v_max_u32 v124,v124,v35
v_cmp_eq_u32 vcc,-1,v124
s_cbranch_vccnz flb_100471
s_branch segb_100455
lfb_100675:
s_bitcmp1_b32 s55,0
s_cbranch_scc0 dsk_100736
buffer_load_dwordx4 v[16:19],v0,s[20:23],s92 offen offset:0 sc1
dsk_100736:
s_bitcmp1_b32 s55,1
s_cbranch_scc0 dsk_100737
buffer_load_dwordx4 v[20:23],v0,s[20:23],s92 offen offset:1024 sc1
dsk_100737:
s_bitcmp1_b32 s55,2
s_cbranch_scc0 dsk_100738
buffer_load_dwordx4 v[24:27],v0,s[20:23],s92 offen offset:2048 sc1
dsk_100738:
s_bitcmp1_b32 s55,3
s_cbranch_scc0 dsk_100739
buffer_load_dwordx4 v[28:31],v0,s[20:23],s92 offen offset:3072 sc1
dsk_100739:
s_bitcmp1_b32 s55,0
s_cbranch_scc0 dsk_100740
s_waitcnt vmcnt(2)
v_max3_u32 v124,v16,v17,v18
v_max_u32 v124,v124,v19
v_cmp_eq_u32 vcc,-1,v124
s_cbranch_vccz dgo_100741
s_nop 15
buffer_load_dwordx4 v[104:107],v0,s[20:23],s92 offen offset:0 sc1
s_nop 15
buffer_load_dwordx4 v[108:111],v0,s[20:23],s92 offen offset:0 sc1
dlp_100742:
s_waitcnt vmcnt(2)
v_max3_u32 v124,v16,v17,v18
v_max_u32 v124,v124,v19
v_cmp_eq_u32 vcc,-1,v124
s_cbranch_vccz dgo_100741
buffer_load_dwordx4 v[16:19],v0,s[20:23],s92 offen offset:0 sc1
s_waitcnt vmcnt(2)
v_max3_u32 v124,v104,v105,v106
v_max_u32 v124,v124,v107
v_cmp_eq_u32 vcc,-1,v124
s_cbranch_vccz dcp_100744
buffer_load_dwordx4 v[104:107],v0,s[20:23],s92 offen offset:0 sc1
s_waitcnt vmcnt(2)
v_max3_u32 v124,v108,v109,v110
v_max_u32 v124,v124,v111
v_cmp_eq_u32 vcc,-1,v124
s_cbranch_vccz dcp_100745
buffer_load_dwordx4 v[108:111],v0,s[20:23],s92 offen offset:0 sc1
s_sub_u32 s90,s90,1
s_cmp_gt_i32 s90,0
s_cbranch_scc1 dlp_100742
s_branch dgo_100741
dcp_100744:
v_mov_b32 v16,v104
v_mov_b32 v17,v105
v_mov_b32 v18,v106
v_mov_b32 v19,v107
s_nop 1
s_branch dgo_100741
dcp_100745:
v_mov_b32 v16,v108
v_mov_b32 v17,v109
v_mov_b32 v18,v110
v_mov_b32 v19,v111
s_nop 1
dgo_100741:
v_smfmac_f32_16x16x64_bf16 v[64:67],v[16:19],a[32:39],v1
v_smfmac_f32_16x16x64_bf16 v[68:71],v[16:19],a[40:47],v1
v_smfmac_f32_16x16x64_bf16 v[72:75],v[16:19],a[48:55],v1
v_smfmac_f32_16x16x64_bf16 v[76:79],v[16:19],a[56:63],v1
dsk_100740:
s_bitcmp1_b32 s55,1
s_cbranch_scc0 dsk_100746
s_waitcnt vmcnt(2)
v_max3_u32 v124,v20,v21,v22
v_max_u32 v124,v124,v23
v_cmp_eq_u32 vcc,-1,v124
s_cbranch_vccz dgo_100747
s_nop 15
buffer_load_dwordx4 v[104:107],v0,s[20:23],s92 offen offset:1024 sc1
s_nop 15
buffer_load_dwordx4 v[108:111],v0,s[20:23],s92 offen offset:1024 sc1
dlp_100748:
s_waitcnt vmcnt(2)
v_max3_u32 v124,v20,v21,v22
v_max_u32 v124,v124,v23
v_cmp_eq_u32 vcc,-1,v124
s_cbranch_vccz dgo_100747
buffer_load_dwordx4 v[20:23],v0,s[20:23],s92 offen offset:1024 sc1
s_waitcnt vmcnt(2)
v_max3_u32 v124,v104,v105,v106
v_max_u32 v124,v124,v107
v_cmp_eq_u32 vcc,-1,v124
s_cbranch_vccz dcp_100750
buffer_load_dwordx4 v[104:107],v0,s[20:23],s92 offen offset:1024 sc1
s_waitcnt vmcnt(2)
v_max3_u32 v124,v108,v109,v110
v_max_u32 v124,v124,v111
v_cmp_eq_u32 vcc,-1,v124
s_cbranch_vccz dcp_100751
buffer_load_dwordx4 v[108:111],v0,s[20:23],s92 offen offset:1024 sc1
s_sub_u32 s90,s90,1
s_cmp_gt_i32 s90,0
s_cbranch_scc1 dlp_100748
s_branch dgo_100747
dcp_100750:
v_mov_b32 v20,v104
v_mov_b32 v21,v105
v_mov_b32 v22,v106
v_mov_b32 v23,v107
s_nop 1
s_branch dgo_100747
dcp_100751:
v_mov_b32 v20,v108
v_mov_b32 v21,v109
v_mov_b32 v22,v110
v_mov_b32 v23,v111
s_nop 1
dgo_100747:
v_smfmac_f32_16x16x64_bf16 v[64:67],v[20:23],a[96:103],v1
v_smfmac_f32_16x16x64_bf16 v[68:71],v[20:23],a[104:111],v1
v_smfmac_f32_16x16x64_bf16 v[72:75],v[20:23],a[112:119],v1
v_smfmac_f32_16x16x64_bf16 v[76:79],v[20:23],a[120:127],v1
dsk_100746:
s_bitcmp1_b32 s55,2
s_cbranch_scc0 dsk_100752
s_waitcnt vmcnt(2)
v_max3_u32 v124,v24,v25,v26
v_max_u32 v124,v124,v27
v_cmp_eq_u32 vcc,-1,v124
s_cbranch_vccz dgo_100753
s_nop 15
buffer_load_dwordx4 v[104:107],v0,s[20:23],s92 offen offset:2048 sc1
s_nop 15
buffer_load_dwordx4 v[108:111],v0,s[20:23],s92 offen offset:2048 sc1
dlp_100754:
s_waitcnt vmcnt(2)
v_max3_u32 v124,v24,v25,v26
v_max_u32 v124,v124,v27
v_cmp_eq_u32 vcc,-1,v124
s_cbranch_vccz dgo_100753
buffer_load_dwordx4 v[24:27],v0,s[20:23],s92 offen offset:2048 sc1
s_waitcnt vmcnt(2)
v_max3_u32 v124,v104,v105,v106
v_max_u32 v124,v124,v107
v_cmp_eq_u32 vcc,-1,v124
s_cbranch_vccz dcp_100756
buffer_load_dwordx4 v[104:107],v0,s[20:23],s92 offen offset:2048 sc1
s_waitcnt vmcnt(2)
v_max3_u32 v124,v108,v109,v110
v_max_u32 v124,v124,v111
v_cmp_eq_u32 vcc,-1,v124
s_cbranch_vccz dcp_100757
buffer_load_dwordx4 v[108:111],v0,s[20:23],s92 offen offset:2048 sc1
s_sub_u32 s90,s90,1
s_cmp_gt_i32 s90,0
s_cbranch_scc1 dlp_100754
s_branch dgo_100753
dcp_100756:
v_mov_b32 v24,v104
v_mov_b32 v25,v105
v_mov_b32 v26,v106
v_mov_b32 v27,v107
s_nop 1
s_branch dgo_100753
dcp_100757:
v_mov_b32 v24,v108
v_mov_b32 v25,v109
v_mov_b32 v26,v110
v_mov_b32 v27,v111
s_nop 1
dgo_100753:
v_smfmac_f32_16x16x64_bf16 v[64:67],v[24:27],a[160:167],v1
v_smfmac_f32_16x16x64_bf16 v[68:71],v[24:27],a[168:175],v1
v_smfmac_f32_16x16x64_bf16 v[72:75],v[24:27],a[176:183],v1
v_smfmac_f32_16x16x64_bf16 v[76:79],v[24:27],a[184:191],v1
dsk_100752:
s_bitcmp1_b32 s55,3
s_cbranch_scc0 dsk_100758
s_waitcnt vmcnt(2)
v_max3_u32 v124,v28,v29,v30
v_max_u32 v124,v124,v31
v_cmp_eq_u32 vcc,-1,v124
s_cbranch_vccz dgo_100759
s_nop 15
buffer_load_dwordx4 v[104:107],v0,s[20:23],s92 offen offset:3072 sc1
s_nop 15
buffer_load_dwordx4 v[108:111],v0,s[20:23],s92 offen offset:3072 sc1
dlp_100760:
s_waitcnt vmcnt(2)
v_max3_u32 v124,v28,v29,v30
v_max_u32 v124,v124,v31
v_cmp_eq_u32 vcc,-1,v124
s_cbranch_vccz dgo_100759
buffer_load_dwordx4 v[28:31],v0,s[20:23],s92 offen offset:3072 sc1
s_waitcnt vmcnt(2)
v_max3_u32 v124,v104,v105,v106
v_max_u32 v124,v124,v107
v_cmp_eq_u32 vcc,-1,v124
s_cbranch_vccz dcp_100762
buffer_load_dwordx4 v[104:107],v0,s[20:23],s92 offen offset:3072 sc1
s_waitcnt vmcnt(2)
v_max3_u32 v124,v108,v109,v110
v_max_u32 v124,v124,v111
v_cmp_eq_u32 vcc,-1,v124
s_cbranch_vccz dcp_100763
buffer_load_dwordx4 v[108:111],v0,s[20:23],s92 offen offset:3072 sc1
s_sub_u32 s90,s90,1
s_cmp_gt_i32 s90,0
s_cbranch_scc1 dlp_100760
s_branch dgo_100759
dcp_100762:
v_mov_b32 v28,v104
v_mov_b32 v29,v105
v_mov_b32 v30,v106
v_mov_b32 v31,v107
s_nop 1
s_branch dgo_100759
dcp_100763:
v_mov_b32 v28,v108
v_mov_b32 v29,v109
v_mov_b32 v30,v110
v_mov_b32 v31,v111
s_nop 1
dgo_100759:
v_smfmac_f32_16x16x64_bf16 v[64:67],v[28:31],a[224:231],v1
v_smfmac_f32_16x16x64_bf16 v[68:71],v[28:31],a[232:239],v1
v_smfmac_f32_16x16x64_bf16 v[72:75],v[28:31],a[240:247],v1
v_smfmac_f32_16x16x64_bf16 v[76:79],v[28:31],a[248:255],v1
dsk_100758:
s_mov_b32 s55,0
s_branch Ldone_100676
slowA_100475:
buffer_load_dwordx4 v[44:47],v0,s[20:23],s93 offen offset:3072 sc1
dsk_100764:
s_bitcmp1_b32 s55,7
s_cbranch_scc0 dsk_100765
s_waitcnt vmcnt(2)
v_max3_u32 v124,v44,v45,v46
v_max_u32 v124,v124,v47
v_cmp_eq_u32 vcc,-1,v124
s_cbranch_vccz dgo_100766
s_nop 15
s_nop 3
buffer_load_dwordx4 v[104:107],v0,s[20:23],s93 offen offset:3072 sc1
s_nop 15
s_nop 3
buffer_load_dwordx4 v[108:111],v0,s[20:23],s93 offen offset:3072 sc1
dlp_100767:
s_waitcnt vmcnt(2)
v_max3_u32 v124,v44,v45,v46
v_max_u32 v124,v124,v47
v_cmp_eq_u32 vcc,-1,v124
s_cbranch_vccz dgo_100766
buffer_load_dwordx4 v[44:47],v0,s[20:23],s93 offen offset:3072 sc1
s_waitcnt vmcnt(2)
v_max3_u32 v124,v104,v105,v106
v_max_u32 v124,v124,v107
v_cmp_eq_u32 vcc,-1,v124
s_cbranch_vccz dcp_100769
buffer_load_dwordx4 v[104:107],v0,s[20:23],s93 offen offset:3072 sc1
s_waitcnt vmcnt(2)
v_max3_u32 v124,v108,v109,v110
v_max_u32 v124,v124,v111
v_cmp_eq_u32 vcc,-1,v124
s_cbranch_vccz dcp_100770
buffer_load_dwordx4 v[108:111],v0,s[20:23],s93 offen offset:3072 sc1
s_sub_u32 s90,s90,1
s_cmp_gt_i32 s90,0
s_cbranch_scc1 dlp_100767
s_branch dgo_100766
dcp_100769:
v_mov_b32 v44,v104
v_mov_b32 v45,v105
v_mov_b32 v46,v106
v_mov_b32 v47,v107
s_nop 1
s_branch dgo_100766
dcp_100770:
v_mov_b32 v44,v108
v_mov_b32 v45,v109
v_mov_b32 v46,v110
v_mov_b32 v47,v111
s_nop 1
dgo_100766:
dsk_100765:
s_mov_b32 s55,0
s_branch segb_100457
recslow_100373:
s_mov_b32 s55,0
s_cmp_lg_u32 s50,0
s_cbranch_scc1 np0_100773
v_mov_b32 v120,0
v_mov_b32 v121,0
s_cmp_lg_u32 s58,0
s_cbranch_scc1 z1_100774
v_lshrrev_b32 v124,6,v127
v_lshlrev_b32 v124,12,v124
v_bfe_u32 v125,v127,1,5
v_add_u32 v124,v124,v125
s_lshl_b32 s64,s59,6
buffer_load_ushort v120,v124,s[44:47],s64 offen
buffer_load_ushort v122,v124,s[44:47],s64 offen offset:32
buffer_load_ushort v121,v124,s[44:47],s64 offen offset:2048
buffer_load_ushort v123,v124,s[44:47],s64 offen offset:2080
s_waitcnt vmcnt(0)
v_lshl_or_b32 v120,v122,16,v120
v_lshl_or_b32 v121,v123,16,v121
v_min_u32 v120,s81,v120
v_min_u32 v121,s81,v121
z1_100774:
buffer_store_dword v120,v4,s[20:23],s71 offen sc1
buffer_store_dword v121,v4,s[20:23],s71 offen offset:32 sc1
buffer_store_dword v120,v4,s[20:23],s73 offen sc1
buffer_store_dword v121,v4,s[20:23],s73 offen offset:32 sc1
np0_100773:
v_lshrrev_b32 v124,2,v0
v_bfe_u32 v125,v124,5,1
v_mul_u32_u24 v125,2048,v125
s_and_b32 s64,s50,1
s_lshl_b32 s64,s64,5
v_add3_u32 v4,v124,v125,s64
s_add_u32 s64,s79,0
s_cmp_gt_u32 s91,s64
s_cbranch_scc0 flp_100777
fok_100776:
s_add_u32 s64,s79,0
s_lshl_b32 s65,s64,12
s_and_b32 s65,s65,0x2000
s_xor_b32 s65,s65,s67
s_lshl_b32 s64,s64,20
s_add_u32 s65,s65,s64
s_add_u32 s99,s65,s77
buffer_load_dwordx4 v[104:107],v0,s[20:23],s99 offen
buffer_load_dwordx4 v[108:111],v0,s[20:23],s99 offen offset:1024
s_waitcnt vmcnt(0)
s_mov_b32 s92,s70
s_mov_b32 s93,s72
s_mov_b32 s94,s76
s_add_u32 s95,s94,4096
s_mov_b32 s96,s74
s_add_u32 s97,s96,4096
s_mov_b32 s98,s75
s_barrier
v_mov_b32 v96,v104
v_mov_b32 v97,v105
v_mov_b32 v98,v106
v_mov_b32 v99,v107
v_mov_b32 v100,v108
v_mov_b32 v101,v109
v_mov_b32 v102,v110
v_mov_b32 v103,v111
v_mov_b32 v48,0
v_mov_b32 v49,0
v_mov_b32 v50,0
v_mov_b32 v51,0
v_mov_b32 v52,0
v_mov_b32 v53,0
v_mov_b32 v54,0
v_mov_b32 v55,0
v_mov_b32 v56,0
v_mov_b32 v57,0
v_mov_b32 v58,0
v_mov_b32 v59,0
v_mov_b32 v60,0
v_mov_b32 v61,0
v_mov_b32 v62,0
v_mov_b32 v63,0
v_mov_b32 v64,0
v_mov_b32 v65,0
v_mov_b32 v66,0
v_mov_b32 v67,0
v_mov_b32 v68,0
v_mov_b32 v69,0
v_mov_b32 v70,0
v_mov_b32 v71,0
v_mov_b32 v72,0
v_mov_b32 v73,0
v_mov_b32 v74,0
v_mov_b32 v75,0
v_mov_b32 v76,0
v_mov_b32 v77,0
v_mov_b32 v78,0
v_mov_b32 v79,0
v_mov_b32 v80,0
v_mov_b32 v81,0
v_mov_b32 v82,0
v_mov_b32 v83,0
v_mov_b32 v84,0
v_mov_b32 v85,0
v_mov_b32 v86,0
v_mov_b32 v87,0
v_mov_b32 v88,0
v_mov_b32 v89,0
v_mov_b32 v90,0
v_mov_b32 v91,0
v_mov_b32 v92,0
v_mov_b32 v93,0
v_mov_b32 v94,0
v_mov_b32 v95,0
s_cmp_gt_u32 s50,1
s_cbranch_scc0 loop0_100775x
loop_100771:
v_mov_b32 v125,0
s_nop 1
v_mfma_f32_16x16x1_4b_f32 v[48:63],v125,v125,0
v_mfma_f32_16x16x1_4b_f32 v[64:79],v125,v125,0
v_mfma_f32_16x16x1_4b_f32 v[80:95],v125,v125,0
s_nop 15
s_nop 15
s_nop 15
s_nop 15
buffer_load_dwordx4 v[16:19],v0,s[20:23],s92 offen offset:0 sc1
s_nop 7
buffer_load_dwordx4 v[20:23],v0,s[20:23],s92 offen offset:1024 sc1
s_nop 7
buffer_load_dwordx4 v[24:27],v0,s[20:23],s92 offen offset:2048 sc1
s_nop 7
buffer_load_dwordx4 v[28:31],v0,s[20:23],s92 offen offset:3072 sc1
v_mov_b32 v96,v104
v_mov_b32 v97,v105
v_mov_b32 v98,v106
v_mov_b32 v99,v107
v_mov_b32 v100,v108
v_mov_b32 v101,v109
v_mov_b32 v102,v110
v_mov_b32 v103,v111
s_branch ja_100778
loop0_100775x:
v_mov_b32 v125,0
s_nop 1
v_mfma_f32_16x16x1_4b_f32 v[48:63],v125,v125,0
v_mfma_f32_16x16x1_4b_f32 v[64:79],v125,v125,0
v_mfma_f32_16x16x1_4b_f32 v[80:95],v125,v125,0
s_nop 15
s_nop 11
buffer_load_dwordx4 v[16:19],v0,s[20:23],s92 offen offset:0 sc1
s_nop 7
buffer_load_dwordx4 v[20:23],v0,s[20:23],s92 offen offset:1024 sc1
s_nop 7
buffer_load_dwordx4 v[24:27],v0,s[20:23],s92 offen offset:2048 sc1
s_nop 7
buffer_load_dwordx4 v[28:31],v0,s[20:23],s92 offen offset:3072 sc1
ja_100778:
s_max_u32 s66,s79,1
s_sub_u32 s66,s66,1
v_mov_b32 v126,s66
s_add_u32 s64,s66,0
s_lshl_b32 s65,s64,12
s_and_b32 s65,s65,0x2000
s_xor_b32 s65,s65,s67
s_lshl_b32 s64,s64,20
s_add_u32 s65,s65,s64
s_add_u32 s101,s65,s78
s_cmp_eq_u32 s79,63
s_cbranch_scc1 last_100772
s_add_u32 s64,s79,1
s_lshl_b32 s65,s64,12
s_and_b32 s65,s65,0x2000
s_xor_b32 s65,s65,s67
s_lshl_b32 s64,s64,20
s_add_u32 s65,s65,s64
s_add_u32 s99,s65,s77
s_waitcnt vmcnt(3)
v_max3_u32 v124,v16,v17,v18
v_max_u32 v124,v124,v19
v_cmp_eq_u32 vcc,-1,v124
v_cndmask_b32 v120,2.0,v0,s[82:83]
v_cndmask_b32 v121,2.0,v127,s[86:87]
s_cbranch_vccnz flb_100805
seg_100781:
segb_100789:
v_smfmac_f32_16x16x64_bf16 v[48:51],v[16:19],a[0:7],v1
buffer_load_dword v125,off,s[20:23],s92 sc1
v_smfmac_f32_16x16x64_bf16 v[52:55],v[16:19],a[8:15],v1
buffer_load_dwordx4 v[32:35],v0,s[20:23],s93 offen offset:0 sc1
v_smfmac_f32_16x16x64_bf16 v[56:59],v[16:19],a[16:23],v1
s_waitcnt vmcnt(4)
v_max3_u32 v124,v20,v21,v22
v_smfmac_f32_16x16x64_bf16 v[60:63],v[16:19],a[24:31],v1
v_max_u32 v124,v124,v23
v_smfmac_f32_16x16x64_bf16 v[64:67],v[16:19],a[32:39],v1
v_cmp_eq_u32 vcc,-1,v124
v_smfmac_f32_16x16x64_bf16 v[68:71],v[16:19],a[40:47],v1
v_smfmac_f32_16x16x64_bf16 v[72:75],v[16:19],a[48:55],v1
s_cbranch_vccnz fl_100798
seg_100782:
v_smfmac_f32_16x16x64_bf16 v[76:79],v[16:19],a[56:63],v1
segb_100790:
v_smfmac_f32_16x16x64_bf16 v[48:51],v[20:23],a[64:71],v1
buffer_load_dword v125,off,s[20:23],s92 sc1
v_smfmac_f32_16x16x64_bf16 v[52:55],v[20:23],a[72:79],v1
buffer_load_dwordx4 v[36:39],v0,s[20:23],s93 offen offset:1024 sc1
v_smfmac_f32_16x16x64_bf16 v[56:59],v[20:23],a[80:87],v1
s_waitcnt vmcnt(5)
v_max3_u32 v124,v24,v25,v26
v_smfmac_f32_16x16x64_bf16 v[60:63],v[20:23],a[88:95],v1
v_max_u32 v124,v124,v27
v_smfmac_f32_16x16x64_bf16 v[64:67],v[20:23],a[96:103],v1
v_cmp_eq_u32 vcc,-1,v124
v_smfmac_f32_16x16x64_bf16 v[68:71],v[20:23],a[104:111],v1
v_smfmac_f32_16x16x64_bf16 v[72:75],v[20:23],a[112:119],v1
s_cbranch_vccnz fl_100799
seg_100783:
v_smfmac_f32_16x16x64_bf16 v[76:79],v[20:23],a[120:127],v1
segb_100791:
v_smfmac_f32_16x16x64_bf16 v[48:51],v[24:27],a[128:135],v1
buffer_load_dword v125,off,s[20:23],s92 sc1
v_smfmac_f32_16x16x64_bf16 v[52:55],v[24:27],a[136:143],v1
buffer_load_dwordx4 v[40:43],v0,s[20:23],s93 offen offset:2048 sc1
v_smfmac_f32_16x16x64_bf16 v[56:59],v[24:27],a[144:151],v1
buffer_load_dwordx4 v[44:47],v0,s[20:23],s93 offen offset:3072 sc1
s_waitcnt vmcnt(7)
v_max3_u32 v124,v28,v29,v30
v_smfmac_f32_16x16x64_bf16 v[60:63],v[24:27],a[152:159],v1
v_max_u32 v124,v124,v31
v_smfmac_f32_16x16x64_bf16 v[64:67],v[24:27],a[160:167],v1
v_cmp_eq_u32 vcc,-1,v124
v_smfmac_f32_16x16x64_bf16 v[68:71],v[24:27],a[168:175],v1
v_smfmac_f32_16x16x64_bf16 v[72:75],v[24:27],a[176:183],v1
s_cbranch_vccnz fl_100800
seg_100784:
v_smfmac_f32_16x16x64_bf16 v[76:79],v[24:27],a[184:191],v1
segb_100792:
v_smfmac_f32_16x16x64_bf16 v[48:51],v[28:31],a[192:199],v1
buffer_load_dword v125,off,s[20:23],s92 sc1
v_smfmac_f32_16x16x64_bf16 v[52:55],v[28:31],a[200:207],v1
v_smfmac_f32_16x16x64_bf16 v[56:59],v[28:31],a[208:215],v1
s_waitcnt vmcnt(6)
v_max3_u32 v124,v32,v33,v34
v_smfmac_f32_16x16x64_bf16 v[60:63],v[28:31],a[216:223],v1
v_max_u32 v124,v124,v35
v_smfmac_f32_16x16x64_bf16 v[64:67],v[28:31],a[224:231],v1
v_cmp_eq_u32 vcc,-1,v124
v_smfmac_f32_16x16x64_bf16 v[68:71],v[28:31],a[232:239],v1
v_smfmac_f32_16x16x64_bf16 v[72:75],v[28:31],a[240:247],v1
s_cbranch_vccnz fl_100801
seg_100785:
v_smfmac_f32_16x16x64_bf16 v[76:79],v[28:31],a[248:255],v1
segb_100793:
v_smfmac_f32_16x16x64_bf16 v[48:51],v[32:35],a[0:7],v1
buffer_load_dword v125,off,s[20:23],s92 sc1
v_smfmac_f32_16x16x64_bf16 v[52:55],v[32:35],a[8:15],v1
buffer_store_dwordx4 v[112:115],v120,s[20:23],s101 offen sc1
v_smfmac_f32_16x16x64_bf16 v[56:59],v[32:35],a[16:23],v1
buffer_store_dword v126,v121,s[20:23],s69 offen sc1
s_waitcnt vmcnt(7)
v_max3_u32 v124,v36,v37,v38
v_smfmac_f32_16x16x64_bf16 v[60:63],v[32:35],a[24:31],v1
v_max_u32 v124,v124,v39
v_smfmac_f32_16x16x64_bf16 v[64:67],v[32:35],a[32:39],v1
v_cmp_eq_u32 vcc,-1,v124
v_smfmac_f32_16x16x64_bf16 v[68:71],v[32:35],a[40:47],v1
v_smfmac_f32_16x16x64_bf16 v[72:75],v[32:35],a[48:55],v1
s_cbranch_vccnz fl_100802
seg_100786:
v_smfmac_f32_16x16x64_bf16 v[76:79],v[32:35],a[56:63],v1
segb_100794:
v_smfmac_f32_16x16x64_bf16 v[48:51],v[36:39],a[64:71],v1
buffer_load_dword v125,off,s[20:23],s92 sc1
s_waitcnt vmcnt(5)
v_max3_u32 v124,v40,v41,v42
v_smfmac_f32_16x16x64_bf16 v[52:55],v[36:39],a[72:79],v1
v_max3_u32 v124,v124,v43,v44
v_smfmac_f32_16x16x64_bf16 v[56:59],v[36:39],a[80:87],v1
v_max3_u32 v124,v124,v45,v46
v_smfmac_f32_16x16x64_bf16 v[60:63],v[36:39],a[88:95],v1
v_max_u32 v124,v124,v47
v_smfmac_f32_16x16x64_bf16 v[64:67],v[36:39],a[96:103],v1
v_cmp_eq_u32 vcc,-1,v124
v_smfmac_f32_16x16x64_bf16 v[68:71],v[36:39],a[104:111],v1
v_smfmac_f32_16x16x64_bf16 v[72:75],v[36:39],a[112:119],v1
s_cbranch_vccnz fl_100803
seg_100787:
v_smfmac_f32_16x16x64_bf16 v[76:79],v[36:39],a[120:127],v1
segb_100795:
v_smfmac_f32_16x16x64_bf16 v[48:51],v[40:43],a[128:135],v1
s_add_u32 s64,s79,1
s_cmp_gt_u32 s91,s64
s_cbranch_scc0 flp_100780
fok_100779:
v_smfmac_f32_16x16x64_bf16 v[52:55],v[40:43],a[136:143],v1
buffer_load_dwordx4 v[104:107],v0,s[20:23],s99 offen
buffer_load_dwordx4 v[108:111],v0,s[20:23],s99 offen offset:1024
v_smfmac_f32_16x16x64_bf16 v[48:51],v[44:47],a[192:199],v1
buffer_load_dword v126,off,s[20:23],s68 sc1
s_add_u32 s64,s79,2
v_smfmac_f32_16x16x64_bf16 v[52:55],v[44:47],a[200:207],v1
s_and_b32 s64,s64,3
s_lshl_b32 s100,s64,19
s_nop 0
v_add_f32 v48,v48,v49
v_smfmac_f32_16x16x64_bf16 v[56:59],v[40:43],a[144:151],v1
ds_write_addtid_b32 v48 offset:0
v_add_f32 v50,v50,v51
v_smfmac_f32_16x16x64_bf16 v[60:63],v[40:43],a[152:159],v1
ds_write_addtid_b32 v50 offset:1040
v_add_f32 v52,v52,v53
v_smfmac_f32_16x16x64_bf16 v[56:59],v[44:47],a[208:215],v1
ds_write_addtid_b32 v52 offset:2080
v_add_f32 v54,v54,v55
v_smfmac_f32_16x16x64_bf16 v[60:63],v[44:47],a[216:223],v1
ds_write_addtid_b32 v54 offset:3120
s_nop 1
v_add_f32 v56,v56,v57
v_smfmac_f32_16x16x64_bf16 v[64:67],v[40:43],a[160:167],v1
ds_write_addtid_b32 v56 offset:4160
v_add_f32 v58,v58,v59
v_smfmac_f32_16x16x64_bf16 v[68:71],v[40:43],a[168:175],v1
ds_write_addtid_b32 v58 offset:5200
v_add_f32 v60,v60,v61
v_smfmac_f32_16x16x64_bf16 v[64:67],v[44:47],a[224:231],v1
ds_write_addtid_b32 v60 offset:6240
v_add_f32 v62,v62,v63
v_smfmac_f32_16x16x64_bf16 v[68:71],v[44:47],a[232:239],v1
ds_write_addtid_b32 v62 offset:7280
s_nop 1
v_add_f32 v64,v64,v65
v_smfmac_f32_16x16x64_bf16 v[72:75],v[40:43],a[176:183],v1
ds_write_addtid_b32 v64 offset:8448
v_add_f32 v66,v66,v67
v_smfmac_f32_16x16x64_bf16 v[76:79],v[40:43],a[184:191],v1
ds_write_addtid_b32 v66 offset:9488
v_add_f32 v68,v68,v69
v_smfmac_f32_16x16x64_bf16 v[72:75],v[44:47],a[240:247],v1
ds_write_addtid_b32 v68 offset:10528
v_add_f32 v70,v70,v71
v_smfmac_f32_16x16x64_bf16 v[76:79],v[44:47],a[248:255],v1
ds_write_addtid_b32 v70 offset:11568
s_nop 1
v_add_f32 v72,v72,v73
v_smfmac_f32_16x16x64_bf16 v[80:83],v[16:19],v[208:215],v1
ds_write_addtid_b32 v72 offset:12608
v_add_f32 v74,v74,v75
v_smfmac_f32_16x16x64_bf16 v[80:83],v[32:35],v[208:215],v1
ds_write_addtid_b32 v74 offset:13648
v_add_f32 v76,v76,v77
ds_write_addtid_b32 v76 offset:14688
v_add_f32 v78,v78,v79
ds_write_addtid_b32 v78 offset:15728
doneA_100814:
s_waitcnt lgkmcnt(0)
s_barrier
s_cmp_gt_u32 s50,1
s_cbranch_scc1 w23_100815
v_smfmac_f32_16x16x64_bf16 v[84:87],v[16:19],v[216:223],v1
v_smfmac_f32_16x16x64_bf16 v[84:87],v[32:35],v[216:223],v1
v_smfmac_f32_16x16x64_bf16 v[88:91],v[16:19],v[224:231],v1
v_smfmac_f32_16x16x64_bf16 v[88:91],v[32:35],v[224:231],v1
v_smfmac_f32_16x16x64_bf16 v[92:95],v[16:19],v[232:239],v1
ds_read_b128 v[48:51],v7 offset:0
ds_read_b128 v[52:55],v7 offset:1024
v_smfmac_f32_16x16x64_bf16 v[92:95],v[32:35],v[232:239],v1
ds_read_b128 v[56:59],v7 offset:2048
ds_read_b128 v[60:63],v7 offset:3072
v_smfmac_f32_16x16x64_bf16 v[80:83],v[20:23],v[240:247],v1
ds_read_b128 v[64:67],v7 offset:4096
ds_read_b128 v[68:71],v7 offset:5120
v_smfmac_f32_16x16x64_bf16 v[80:83],v[36:39],v[240:247],v1
ds_read_b128 v[72:75],v7 offset:6144
ds_read_b128 v[76:79],v7 offset:7168
v_smfmac_f32_16x16x64_bf16 v[84:87],v[20:23],v[248:255],v1
v_smfmac_f32_16x16x64_bf16 v[84:87],v[36:39],v[248:255],v1
s_waitcnt lgkmcnt(6)
v_smfmac_f32_16x16x64_bf16 v[88:91],v[20:23],v[48:55],v1
v_smfmac_f32_16x16x64_bf16 v[88:91],v[36:39],v[48:55],v1
ds_read_b128 v[48:51],v7 offset:8192
ds_read_b128 v[52:55],v7 offset:9216
s_waitcnt lgkmcnt(6)
v_smfmac_f32_16x16x64_bf16 v[92:95],v[20:23],v[56:63],v1
v_smfmac_f32_16x16x64_bf16 v[92:95],v[36:39],v[56:63],v1
ds_read_b128 v[56:59],v7 offset:10240
ds_read_b128 v[60:63],v7 offset:11264
s_waitcnt lgkmcnt(6)
v_smfmac_f32_16x16x64_bf16 v[80:83],v[24:27],v[64:71],v1
v_smfmac_f32_16x16x64_bf16 v[80:83],v[40:43],v[64:71],v1
ds_read_b128 v[64:67],v7 offset:12288
ds_read_b128 v[68:71],v7 offset:13312
s_waitcnt lgkmcnt(6)
v_smfmac_f32_16x16x64_bf16 v[84:87],v[24:27],v[72:79],v1
v_smfmac_f32_16x16x64_bf16 v[84:87],v[40:43],v[72:79],v1
ds_read_b128 v[72:75],v7 offset:14336
ds_read_b128 v[76:79],v7 offset:15360
s_waitcnt lgkmcnt(6)
v_smfmac_f32_16x16x64_bf16 v[88:91],v[24:27],v[48:55],v1
v_smfmac_f32_16x16x64_bf16 v[88:91],v[40:43],v[48:55],v1
ds_read_b128 v[48:51],v7 offset:16384
ds_read_b128 v[52:55],v7 offset:17408
s_waitcnt lgkmcnt(6)
v_smfmac_f32_16x16x64_bf16 v[92:95],v[24:27],v[56:63],v1
v_smfmac_f32_16x16x64_bf16 v[92:95],v[40:43],v[56:63],v1
ds_read_b128 v[56:59],v7 offset:18432
ds_read_b128 v[60:63],v7 offset:19456
s_waitcnt lgkmcnt(6)
v_smfmac_f32_16x16x64_bf16 v[80:83],v[28:31],v[64:71],v1
v_smfmac_f32_16x16x64_bf16 v[80:83],v[44:47],v[64:71],v1
s_waitcnt lgkmcnt(4)
v_smfmac_f32_16x16x64_bf16 v[84:87],v[28:31],v[72:79],v1
v_smfmac_f32_16x16x64_bf16 v[84:87],v[44:47],v[72:79],v1
s_waitcnt lgkmcnt(2)
v_smfmac_f32_16x16x64_bf16 v[88:91],v[28:31],v[48:55],v1
v_add_f32 v80,v80,v81
v_smfmac_f32_16x16x64_bf16 v[88:91],v[44:47],v[48:55],v1
v_add_f32 v82,v82,v83
s_waitcnt lgkmcnt(0)
v_smfmac_f32_16x16x64_bf16 v[92:95],v[28:31],v[56:63],v1
v_cvt_pk_bf16_f32 v80,v80,v82
v_smfmac_f32_16x16x64_bf16 v[92:95],v[44:47],v[56:63],v1
ds_write_addtid_b32 v80 offset:16896
v_add_f32 v84,v84,v85
buffer_load_dwordx4 v[16:19],v2,s[20:23],s94 offen offset:0 sc1
buffer_load_dwordx4 v[32:35],v2,s[20:23],s94 offen offset:1536 sc1
buffer_load_dwordx4 v[20:23],v2,s[20:23],s95 offen offset:0 sc1
buffer_load_dwordx4 v[36:39],v2,s[20:23],s95 offen offset:1536 sc1
buffer_load_dword v120,v3,s[20:23],s94 offen offset:0 sc1
buffer_load_dword v121,v3,s[20:23],s94 offen offset:1536 sc1
buffer_load_dword v122,v3,s[20:23],s95 offen offset:0 sc1
buffer_load_dword v123,v3,s[20:23],s95 offen offset:1536 sc1
v_add_f32 v86,v86,v87
v_cvt_pk_bf16_f32 v84,v84,v86
v_add_f32 v88,v88,v89
v_add_f32 v90,v90,v91
v_cvt_pk_bf16_f32 v88,v88,v90
v_add_f32 v92,v92,v93
v_add_f32 v94,v94,v95
v_cvt_pk_bf16_f32 v92,v92,v94
ds_write_addtid_b32 v84 offset:17920
ds_write_addtid_b32 v88 offset:18944
ds_write_addtid_b32 v92 offset:19968
sp_100818:
s_waitcnt vmcnt(6)
v_pk_add_f32 v[16:17],v[16:17],v[32:33]
v_pk_add_f32 v[18:19],v[18:19],v[34:35]
s_waitcnt vmcnt(4)
v_pk_add_f32 v[20:21],v[20:21],v[36:37]
v_pk_add_f32 v[22:23],v[22:23],v[38:39]
v_pk_add_f32 v[16:17],v[16:17],v[20:21]
v_pk_add_f32 v[18:19],v[18:19],v[22:23]
v_max3_f32 v124,v16,v17,v18
v_pk_add_f32 v[20:21],v[16:17],v[18:19]
s_waitcnt vmcnt(0)
v_pk_add_f32 v[120:121],v[120:121],v[122:123]
v_add_f32 v120,v120,v121
v_max3_f32 v124,v124,v19,v120
v_add_f32 v20,v20,v120
v_cmp_u_f32 vcc,v20,v21
v_max_f32_dpp v124,v124,v124 row_ror:8 row_mask:0xf bank_mask:0xf
v_mov_b32 v125,v124
s_cbranch_vccnz srt_100820
sok_100819:
s_nop 0
v_permlane16_swap_b32 v125,v124
v_max_f32 v124,v124,v125
v_mov_b32 v125,v124
s_nop 1
v_permlane32_swap_b32 v125,v124
v_max_f32 v124,v124,v125
v_mul_f32 v124,s80,v124
v_fma_f32 v16,v16,s80,-v124
v_fma_f32 v17,v17,s80,-v124
v_fma_f32 v18,v18,s80,-v124
v_fma_f32 v19,v19,s80,-v124
v_fma_f32 v120,v120,s80,-v124
s_waitcnt lgkmcnt(0)
s_barrier
ds_read2st64_b32 v[112:113],v127 offset0:66 offset1:67
ds_read2st64_b32 v[114:115],v127 offset0:68 offset1:69
ds_read2st64_b32 v[116:117],v127 offset0:70 offset1:71
ds_read2st64_b32 v[118:119],v127 offset0:72 offset1:73
v_exp_f32 v16,v16
v_exp_f32 v17,v17
v_exp_f32 v18,v18
v_exp_f32 v19,v19
v_cvt_pk_bf16_f32 v48,v16,v17
v_cvt_pk_bf16_f32 v49,v18,v19
v_exp_f32 v120,v120
v_mov_b32_dpp v50,v48 row_ror:8 row_mask:0xf bank_mask:0xf
v_mov_b32_dpp v51,v49 row_ror:8 row_mask:0xf bank_mask:0xf
v_mov_b32_dpp v121,v120 row_ror:8 row_mask:0xf bank_mask:0xf
v_cvt_pk_bf16_f32 v52,v120,v121
v_mfma_f32_16x16x32_bf16 v[64:67],v[8:11],v[48:51],0
v_mov_b32 v53,v52
v_mfma_f32_16x16x32_bf16 v[56:59],v[96:99],v[48:51],0
v_mov_b32 v54,v52
v_mov_b32 v55,v52
v_mfma_f32_16x16x32_bf16 v[60:63],v[100:103],v[48:51],0
v_mfma_f32_16x16x32_bf16 v[64:67],v[12:15],v[52:55],v[64:67]
s_waitcnt lgkmcnt(0)
v_mfma_f32_16x16x32_bf16 v[56:59],v[112:115],v[52:55],v[56:59]
v_mfma_f32_16x16x32_bf16 v[60:63],v[116:119],v[52:55],v[60:63]
s_nop 0
v_rcp_f32 v66,v64
s_nop 2
v_pk_mul_f32 v[56:57],v[56:57],v[66:67] op_sel_hi:[1,0]
v_pk_mul_f32 v[58:59],v[58:59],v[66:67] op_sel_hi:[1,0]
s_nop 0
v_pk_mul_f32 v[60:61],v[60:61],v[66:67] op_sel_hi:[1,0]
v_pk_mul_f32 v[62:63],v[62:63],v[66:67] op_sel_hi:[1,0]
v_cvt_pk_bf16_f32 v120,v56,v57
v_cvt_pk_bf16_f32 v121,v58,v59
v_cvt_pk_bf16_f32 v122,v60,v61
v_cvt_pk_bf16_f32 v123,v62,v63
buffer_store_dwordx4 v[120:123],v6,s[20:23],s98 offen sc1
s_barrier
ds_read_b128 v[48:51],v7 offset:20480
ds_read_b128 v[52:55],v7 offset:21504
ds_read_b128 v[56:59],v7 offset:22528
ds_read_b128 v[60:63],v7 offset:23552
ds_read_b128 v[64:67],v7 offset:24576
ds_read_b128 v[68:71],v7 offset:25600
ds_read_b128 v[72:75],v7 offset:26624
ds_read_b128 v[76:79],v7 offset:27648
ds_read_b128 v[80:83],v7 offset:28672
ds_read_b128 v[84:87],v7 offset:29696
ds_read_b128 v[88:91],v7 offset:30720
ds_read_b128 v[92:95],v7 offset:31744
v_mov_b32 v96,0
v_mov_b32 v97,0
v_mov_b32 v98,0
v_mov_b32 v99,0
v_mov_b32 v100,0
v_mov_b32 v101,0
v_mov_b32 v102,0
v_mov_b32 v103,0
s_nop 11
buffer_load_dwordx4 v[16:19],v0,s[20:23],s96 offen offset:0 sc1
v_mov_b32 v120,v5
v_mov_b32 v121,v5
v_mov_b32 v122,v5
v_mov_b32 v123,v5
s_nop 1
v_mfma_f32_16x16x32_bf16 v[112:115],v[120:123],v[112:115],0
buffer_load_dwordx4 v[20:23],v0,s[20:23],s96 offen offset:1024 sc1
v_mfma_f32_16x16x32_bf16 v[116:119],v[120:123],v[116:119],0
s_add_u32 s79,s79,1
s_and_b32 s64,s79,3
s_lshl_b32 s64,s64,19
s_lshl_b32 s65,s79,8
buffer_load_dwordx4 v[24:27],v0,s[20:23],s96 offen offset:2048 sc1
s_and_b32 s65,s65,0x2000
s_lshl_b32 s66,s79,16
s_xor_b32 s88,s73,s65
s_add_u32 s88,s88,s66
s_sub_u32 s88,s88,s54
s_add_u32 s89,s71,s64
s_add_u32 s92,s70,s64
s_xor_b32 s93,s72,s65
buffer_load_dwordx4 v[28:31],v0,s[20:23],s96 offen offset:3072 sc1
s_add_u32 s93,s93,s66
s_add_u32 s94,s76,s64
s_add_u32 s95,s94,4096
s_add_u32 s98,s75,s64
s_add_u32 s60,s74,s64
v_cvt_pk_bf16_f32 v112,v112,v113
v_cvt_pk_bf16_f32 v113,v114,v115
v_cvt_pk_bf16_f32 v114,v116,v117
buffer_load_dwordx4 v[32:35],v0,s[20:23],s97 offen offset:0 sc1
v_cvt_pk_bf16_f32 v115,v118,v119
s_nop 6
buffer_load_dwordx4 v[36:39],v0,s[20:23],s97 offen offset:1024 sc1
s_nop 7
buffer_load_dwordx4 v[40:43],v0,s[20:23],s97 offen offset:2048 sc1
s_nop 7
buffer_load_dwordx4 v[44:47],v0,s[20:23],s97 offen offset:3072 sc1
s_branch ogo_100816
w23_100815:
ds_read_b128 v[48:51],v2 offset:0
ds_read_b128 v[52:55],v2 offset:256
ds_read_b128 v[56:59],v2 offset:512
ds_read_b128 v[60:63],v2 offset:768
ds_read_b128 v[64:67],v2 offset:16
ds_read_b128 v[68:71],v2 offset:272
ds_read_b128 v[72:75],v2 offset:528
ds_read_b128 v[76:79],v2 offset:784
s_waitcnt lgkmcnt(6)
v_pk_add_f32 v[48:49],v[48:49],v[52:53]
v_pk_add_f32 v[50:51],v[50:51],v[54:55]
s_waitcnt lgkmcnt(4)
v_pk_add_f32 v[56:57],v[56:57],v[60:61]
v_pk_add_f32 v[58:59],v[58:59],v[62:63]
v_pk_add_f32 v[48:49],v[48:49],v[56:57]
v_pk_add_f32 v[50:51],v[50:51],v[58:59]
v_cvt_pk_bf16_f32 v112,v48,v49
v_cvt_pk_bf16_f32 v113,v50,v51
s_waitcnt lgkmcnt(2)
v_pk_add_f32 v[64:65],v[64:65],v[68:69]
v_pk_add_f32 v[66:67],v[66:67],v[70:71]
s_waitcnt lgkmcnt(0)
v_pk_add_f32 v[72:73],v[72:73],v[76:77]
v_pk_add_f32 v[74:75],v[74:75],v[78:79]
v_pk_add_f32 v[64:65],v[64:65],v[72:73]
v_pk_add_f32 v[66:67],v[66:67],v[74:75]
v_cvt_pk_bf16_f32 v114,v64,v65
v_cvt_pk_bf16_f32 v115,v66,v67
s_nop 1
v_mfma_f32_16x16x32_bf16 v[116:119],v[96:99],v[112:115],0
v_mfma_f32_16x16x32_bf16 v[120:123],v[100:103],v[112:115],0
v_mfma_f32_16x16x32_bf16 v[12:15],v[112:115],v[112:115],0
ds_read_b128 v[48:51],v7 offset:0
ds_read_b128 v[52:55],v7 offset:1024
ds_read_b128 v[56:59],v7 offset:2048
ds_read_b128 v[60:63],v7 offset:3072
ds_read_b128 v[64:67],v7 offset:4096
buffer_store_dwordx4 v[116:119],v3,s[20:23],s94 offen sc1
buffer_store_dwordx4 v[120:123],v3,s[20:23],s94 offen offset:512 sc1
s_nop 0
buffer_store_dwordx4 v[12:15],v3,s[20:23],s94 offen offset:1024 sc1
ds_read_b128 v[68:71],v7 offset:5120
ds_read_b128 v[72:75],v7 offset:6144
ds_read_b128 v[76:79],v7 offset:7168
v_smfmac_f32_16x16x64_bf16 v[84:87],v[16:19],v[216:223],v1
v_smfmac_f32_16x16x64_bf16 v[84:87],v[32:35],v[216:223],v1
v_smfmac_f32_16x16x64_bf16 v[88:91],v[16:19],v[224:231],v1
v_smfmac_f32_16x16x64_bf16 v[88:91],v[32:35],v[224:231],v1
v_smfmac_f32_16x16x64_bf16 v[92:95],v[16:19],v[232:239],v1
v_smfmac_f32_16x16x64_bf16 v[92:95],v[32:35],v[232:239],v1
v_smfmac_f32_16x16x64_bf16 v[80:83],v[20:23],v[240:247],v1
v_smfmac_f32_16x16x64_bf16 v[80:83],v[36:39],v[240:247],v1
v_smfmac_f32_16x16x64_bf16 v[84:87],v[20:23],v[248:255],v1
v_smfmac_f32_16x16x64_bf16 v[84:87],v[36:39],v[248:255],v1
s_waitcnt lgkmcnt(6)
v_smfmac_f32_16x16x64_bf16 v[88:91],v[20:23],v[48:55],v1
v_smfmac_f32_16x16x64_bf16 v[88:91],v[36:39],v[48:55],v1
ds_read_b128 v[48:51],v7 offset:8192
ds_read_b128 v[52:55],v7 offset:9216
s_waitcnt lgkmcnt(6)
v_smfmac_f32_16x16x64_bf16 v[92:95],v[20:23],v[56:63],v1
v_smfmac_f32_16x16x64_bf16 v[92:95],v[36:39],v[56:63],v1
ds_read_b128 v[56:59],v7 offset:10240
ds_read_b128 v[60:63],v7 offset:11264
s_waitcnt lgkmcnt(6)
v_smfmac_f32_16x16x64_bf16 v[80:83],v[24:27],v[64:71],v1
v_smfmac_f32_16x16x64_bf16 v[80:83],v[40:43],v[64:71],v1
ds_read_b128 v[64:67],v7 offset:12288
ds_read_b128 v[68:71],v7 offset:13312
s_waitcnt lgkmcnt(6)
v_smfmac_f32_16x16x64_bf16 v[84:87],v[24:27],v[72:79],v1
v_smfmac_f32_16x16x64_bf16 v[84:87],v[40:43],v[72:79],v1
ds_read_b128 v[72:75],v7 offset:14336
ds_read_b128 v[76:79],v7 offset:15360
s_waitcnt lgkmcnt(6)
v_smfmac_f32_16x16x64_bf16 v[88:91],v[24:27],v[48:55],v1
v_smfmac_f32_16x16x64_bf16 v[88:91],v[40:43],v[48:55],v1
ds_read_b128 v[48:51],v7 offset:16384
ds_read_b128 v[52:55],v7 offset:17408
s_waitcnt lgkmcnt(6)
v_smfmac_f32_16x16x64_bf16 v[92:95],v[24:27],v[56:63],v1
v_smfmac_f32_16x16x64_bf16 v[92:95],v[40:43],v[56:63],v1
ds_read_b128 v[56:59],v7 offset:18432
ds_read_b128 v[60:63],v7 offset:19456
s_waitcnt lgkmcnt(6)
v_smfmac_f32_16x16x64_bf16 v[80:83],v[28:31],v[64:71],v1
v_smfmac_f32_16x16x64_bf16 v[80:83],v[44:47],v[64:71],v1
s_waitcnt lgkmcnt(4)
v_smfmac_f32_16x16x64_bf16 v[84:87],v[28:31],v[72:79],v1
v_smfmac_f32_16x16x64_bf16 v[84:87],v[44:47],v[72:79],v1
s_waitcnt lgkmcnt(2)
v_smfmac_f32_16x16x64_bf16 v[88:91],v[28:31],v[48:55],v1
v_add_f32 v80,v80,v81
v_smfmac_f32_16x16x64_bf16 v[88:91],v[44:47],v[48:55],v1
v_add_f32 v82,v82,v83
s_waitcnt lgkmcnt(0)
v_smfmac_f32_16x16x64_bf16 v[92:95],v[28:31],v[56:63],v1
v_cvt_pk_bf16_f32 v80,v80,v82
v_smfmac_f32_16x16x64_bf16 v[92:95],v[44:47],v[56:63],v1
ds_write_addtid_b32 v80 offset:16896
v_add_f32 v84,v84,v85
v_add_f32 v86,v86,v87
v_cvt_pk_bf16_f32 v84,v84,v86
v_add_f32 v88,v88,v89
v_add_f32 v90,v90,v91
v_cvt_pk_bf16_f32 v88,v88,v90
s_nop 0
v_add_f32 v92,v92,v93
v_add_f32 v94,v94,v95
v_cvt_pk_bf16_f32 v92,v92,v94
ds_write_addtid_b32 v84 offset:17920
ds_write_addtid_b32 v88 offset:18944
ds_write_addtid_b32 v92 offset:19968
s_waitcnt lgkmcnt(0)
s_barrier
ds_read_b128 v[48:51],v7 offset:20480
ds_read_b128 v[52:55],v7 offset:21504
ds_read_b128 v[56:59],v7 offset:22528
ds_read_b128 v[60:63],v7 offset:23552
ds_read_b128 v[64:67],v7 offset:24576
ds_read_b128 v[68:71],v7 offset:25600
ds_read_b128 v[72:75],v7 offset:26624
ds_read_b128 v[76:79],v7 offset:27648
ds_read_b128 v[80:83],v7 offset:28672
ds_read_b128 v[84:87],v7 offset:29696
ds_read_b128 v[88:91],v7 offset:30720
ds_read_b128 v[92:95],v7 offset:31744
s_add_u32 s65,s76,s100
s_add_u32 s66,s75,s100
s_add_u32 s64,s71,s100
s_cmp_eq_u32 s50,2
s_cselect_b32 s66,s66,s64
buffer_store_dwordx4 v[8:11],v0,s[20:23],s65 offen sc1
s_cmp_eq_u32 s50,2
s_cselect_b32 exec_hi,-1,0
buffer_store_dwordx4 v[8:11],v0,s[20:23],s66 offen sc1
s_mov_b32 exec_hi,0
buffer_store_dwordx4 v[8:11],v0,s[20:23],s65 offen offset:1024 sc1
s_mov_b64 exec,-1
v_mov_b32 v96,0
v_mov_b32 v97,0
v_mov_b32 v98,0
v_mov_b32 v99,0
v_mov_b32 v100,0
v_mov_b32 v101,0
v_mov_b32 v102,0
v_mov_b32 v103,0
s_barrier
s_nop 15
s_nop 15
s_nop 7
buffer_load_dwordx4 v[16:19],v0,s[20:23],s96 offen offset:0 sc1
s_add_u32 s79,s79,1
s_and_b32 s64,s79,3
s_lshl_b32 s64,s64,19
s_lshl_b32 s65,s79,8
s_and_b32 s65,s65,0x2000
s_lshl_b32 s66,s79,16
s_xor_b32 s88,s73,s65
s_add_u32 s88,s88,s66
buffer_load_dwordx4 v[20:23],v0,s[20:23],s96 offen offset:1024 sc1
s_sub_u32 s88,s88,s54
s_add_u32 s89,s71,s64
s_add_u32 s92,s70,s64
s_xor_b32 s93,s72,s65
s_add_u32 s93,s93,s66
s_add_u32 s94,s76,s64
s_add_u32 s95,s94,4096
s_add_u32 s98,s75,s64
buffer_load_dwordx4 v[24:27],v0,s[20:23],s96 offen offset:2048 sc1
s_add_u32 s60,s74,s64
s_nop 6
buffer_load_dwordx4 v[28:31],v0,s[20:23],s96 offen offset:3072 sc1
s_nop 7
buffer_load_dwordx4 v[32:35],v0,s[20:23],s97 offen offset:0 sc1
s_nop 7
buffer_load_dwordx4 v[36:39],v0,s[20:23],s97 offen offset:1024 sc1
s_nop 7
buffer_load_dwordx4 v[40:43],v0,s[20:23],s97 offen offset:2048 sc1
s_nop 7
buffer_load_dwordx4 v[44:47],v0,s[20:23],s97 offen offset:3072 sc1
ogo_100816:
s_waitcnt lgkmcnt(0)
s_waitcnt vmcnt(6)
v_max3_u32 v124,v16,v17,v18
v_max3_u32 v124,v124,v19,v20
v_max3_u32 v124,v124,v21,v22
v_max_u32 v124,v124,v23
v_cmp_eq_u32 vcc,-1,v124
s_cbranch_vccnz of_100821
v_smfmac_f32_16x16x64_bf16 v[96:99],v[16:19],v[48:55],v1
v_smfmac_f32_16x16x64_bf16 v[100:103],v[16:19],v[56:63],v1
v_smfmac_f32_16x16x64_bf16 v[96:99],v[20:23],v[64:71],v1
v_smfmac_f32_16x16x64_bf16 v[100:103],v[20:23],v[72:79],v1
v_readfirstlane_b32 s91,v126
s_waitcnt vmcnt(4)
v_max3_u32 v124,v24,v25,v26
v_max3_u32 v124,v124,v27,v28
v_max3_u32 v124,v124,v29,v30
v_max_u32 v124,v124,v31
v_cmp_eq_u32 vcc,-1,v124
s_cbranch_vccnz of_100822
v_smfmac_f32_16x16x64_bf16 v[96:99],v[24:27],v[80:87],v1
v_smfmac_f32_16x16x64_bf16 v[100:103],v[24:27],v[88:95],v1
v_smfmac_f32_16x16x64_bf16 v[96:99],v[28:31],v[128:135],v1
v_smfmac_f32_16x16x64_bf16 v[100:103],v[28:31],v[136:143],v1
s_waitcnt vmcnt(2)
v_max3_u32 v124,v32,v33,v34
v_max3_u32 v124,v124,v35,v36
v_max3_u32 v124,v124,v37,v38
v_max_u32 v124,v124,v39
v_cmp_eq_u32 vcc,-1,v124
s_cbranch_vccnz of_100823
v_smfmac_f32_16x16x64_bf16 v[96:99],v[32:35],v[144:151],v1
v_smfmac_f32_16x16x64_bf16 v[100:103],v[32:35],v[152:159],v1
v_smfmac_f32_16x16x64_bf16 v[96:99],v[36:39],v[160:167],v1
v_smfmac_f32_16x16x64_bf16 v[100:103],v[36:39],v[168:175],v1
s_waitcnt vmcnt(1)
v_max3_u32 v124,v40,v41,v42
v_max_u32 v124,v124,v43
v_cmp_eq_u32 vcc,-1,v124
s_cbranch_vccnz of_100824
v_smfmac_f32_16x16x64_bf16 v[96:99],v[40:43],v[176:183],v1
v_smfmac_f32_16x16x64_bf16 v[100:103],v[40:43],v[184:191],v1
s_waitcnt vmcnt(0)
v_max3_u32 v124,v44,v45,v46
v_max_u32 v124,v124,v47
v_cmp_eq_u32 vcc,-1,v124
s_cbranch_vccnz of_100825
v_smfmac_f32_16x16x64_bf16 v[96:99],v[44:47],v[192:199],v1
v_smfmac_f32_16x16x64_bf16 v[100:103],v[44:47],v[200:207],v1
oback_100832:
s_nop 4
v_add_f32 v96,v96,v97
v_add_f32 v98,v98,v99
s_nop 0
v_add_f32 v100,v100,v101
v_add_f32 v102,v102,v103
ds_write_addtid_b32 v96 offset:20992
ds_write_addtid_b32 v98 offset:23072
ds_write_addtid_b32 v100 offset:22016
ds_write_addtid_b32 v102 offset:24096
s_mov_b32 s96,s60
s_add_u32 s97,s60,4096
s_cmp_gt_u32 s50,1
s_waitcnt lgkmcnt(0)
s_barrier
s_cbranch_scc1 loop_100771
ds_read2st64_b32 v[48:49],v4 offset0:82 offset1:86
ds_read2st64_b32 v[50:51],v4 offset0:83 offset1:87
ds_read2st64_b32 v[52:53],v4 offset0:84 offset1:88
ds_read2st64_b32 v[54:55],v4 offset0:85 offset1:89
v_mov_b32 v96,v104
v_mov_b32 v97,v105
v_mov_b32 v98,v106
v_mov_b32 v99,v107
v_mov_b32 v100,v108
v_mov_b32 v101,v109
v_mov_b32 v102,v110
v_mov_b32 v103,v111
s_waitcnt lgkmcnt(2)
v_pk_add_f32 v[48:49],v[48:49],v[50:51]
s_waitcnt lgkmcnt(0)
v_pk_add_f32 v[52:53],v[52:53],v[54:55]
v_pk_add_f32 v[48:49],v[48:49],v[52:53]
v_cvt_pk_bf16_f32 v124,v48,v49
buffer_store_dword v124,v127,s[20:23],s89 offen sc1
s_nop 7
buffer_store_dword v124,v127,s[20:23],s88 offen sc1
s_branch loop0_100775x
last_100772:
s_waitcnt vmcnt(3)
v_max3_u32 v124,v16,v17,v18
v_max_u32 v124,v124,v19
v_cmp_eq_u32 vcc,-1,v124
v_cndmask_b32 v120,2.0,v0,s[82:83]
v_cndmask_b32 v121,2.0,v127,s[86:87]
s_cbranch_vccnz flb_100857
seg_100833:
segb_100841:
v_smfmac_f32_16x16x64_bf16 v[64:67],v[16:19],a[32:39],v1
buffer_load_dword v125,off,s[20:23],s92 sc1
buffer_load_dwordx4 v[32:35],v0,s[20:23],s93 offen offset:0 sc1
s_waitcnt vmcnt(4)
v_max3_u32 v124,v20,v21,v22
v_smfmac_f32_16x16x64_bf16 v[68:71],v[16:19],a[40:47],v1
v_max_u32 v124,v124,v23
v_cmp_eq_u32 vcc,-1,v124
v_smfmac_f32_16x16x64_bf16 v[72:75],v[16:19],a[48:55],v1
v_smfmac_f32_16x16x64_bf16 v[76:79],v[16:19],a[56:63],v1
s_cbranch_vccnz fl_100850
seg_100834:
segb_100842:
v_smfmac_f32_16x16x64_bf16 v[64:67],v[20:23],a[96:103],v1
buffer_load_dword v125,off,s[20:23],s92 sc1
buffer_load_dwordx4 v[36:39],v0,s[20:23],s93 offen offset:1024 sc1
s_waitcnt vmcnt(5)
v_max3_u32 v124,v24,v25,v26
v_smfmac_f32_16x16x64_bf16 v[68:71],v[20:23],a[104:111],v1
v_max_u32 v124,v124,v27
v_cmp_eq_u32 vcc,-1,v124
v_smfmac_f32_16x16x64_bf16 v[72:75],v[20:23],a[112:119],v1
v_smfmac_f32_16x16x64_bf16 v[76:79],v[20:23],a[120:127],v1
s_cbranch_vccnz fl_100851
seg_100835:
segb_100843:
v_smfmac_f32_16x16x64_bf16 v[64:67],v[24:27],a[160:167],v1
buffer_load_dword v125,off,s[20:23],s92 sc1
buffer_load_dwordx4 v[40:43],v0,s[20:23],s93 offen offset:2048 sc1
buffer_load_dwordx4 v[44:47],v0,s[20:23],s93 offen offset:3072 sc1
s_waitcnt vmcnt(7)
v_max3_u32 v124,v28,v29,v30
v_smfmac_f32_16x16x64_bf16 v[68:71],v[24:27],a[168:175],v1
v_max_u32 v124,v124,v31
v_cmp_eq_u32 vcc,-1,v124
v_smfmac_f32_16x16x64_bf16 v[72:75],v[24:27],a[176:183],v1
v_smfmac_f32_16x16x64_bf16 v[76:79],v[24:27],a[184:191],v1
s_cbranch_vccnz fl_100852
seg_100836:
segb_100844:
v_smfmac_f32_16x16x64_bf16 v[64:67],v[28:31],a[224:231],v1
buffer_load_dword v125,off,s[20:23],s92 sc1
s_waitcnt vmcnt(6)
v_max3_u32 v124,v32,v33,v34
v_smfmac_f32_16x16x64_bf16 v[68:71],v[28:31],a[232:239],v1
v_max_u32 v124,v124,v35
v_cmp_eq_u32 vcc,-1,v124
v_smfmac_f32_16x16x64_bf16 v[72:75],v[28:31],a[240:247],v1
v_smfmac_f32_16x16x64_bf16 v[76:79],v[28:31],a[248:255],v1
s_cbranch_vccnz fl_100853
seg_100837:
segb_100845:
v_smfmac_f32_16x16x64_bf16 v[64:67],v[32:35],a[32:39],v1
buffer_load_dword v125,off,s[20:23],s92 sc1
buffer_store_dwordx4 v[112:115],v120,s[20:23],s101 offen sc1
buffer_store_dword v126,v121,s[20:23],s69 offen sc1
s_waitcnt vmcnt(7)
v_max3_u32 v124,v36,v37,v38
v_smfmac_f32_16x16x64_bf16 v[68:71],v[32:35],a[40:47],v1
v_max_u32 v124,v124,v39
v_cmp_eq_u32 vcc,-1,v124
v_smfmac_f32_16x16x64_bf16 v[72:75],v[32:35],a[48:55],v1
v_smfmac_f32_16x16x64_bf16 v[76:79],v[32:35],a[56:63],v1
s_cbranch_vccnz fl_100854
seg_100838:
segb_100846:
v_smfmac_f32_16x16x64_bf16 v[64:67],v[36:39],a[96:103],v1
buffer_load_dword v125,off,s[20:23],s92 sc1
s_waitcnt vmcnt(5)
v_max3_u32 v124,v40,v41,v42
v_smfmac_f32_16x16x64_bf16 v[68:71],v[36:39],a[104:111],v1
v_max3_u32 v124,v124,v43,v44
v_max3_u32 v124,v124,v45,v46
v_max_u32 v124,v124,v47
v_cmp_eq_u32 vcc,-1,v124
v_smfmac_f32_16x16x64_bf16 v[72:75],v[36:39],a[112:119],v1
v_smfmac_f32_16x16x64_bf16 v[76:79],v[36:39],a[120:127],v1
s_cbranch_vccnz fl_100855
seg_100839:
segb_100847:
v_smfmac_f32_16x16x64_bf16 v[64:67],v[40:43],a[160:167],v1
v_smfmac_f32_16x16x64_bf16 v[68:71],v[40:43],a[168:175],v1
v_smfmac_f32_16x16x64_bf16 v[64:67],v[44:47],a[224:231],v1
v_smfmac_f32_16x16x64_bf16 v[68:71],v[44:47],a[232:239],v1
v_smfmac_f32_16x16x64_bf16 v[72:75],v[40:43],a[176:183],v1
s_nop 1
v_add_f32 v64,v64,v65
v_smfmac_f32_16x16x64_bf16 v[76:79],v[40:43],a[184:191],v1
ds_write_addtid_b32 v64 offset:8448
v_add_f32 v66,v66,v67
v_smfmac_f32_16x16x64_bf16 v[72:75],v[44:47],a[240:247],v1
ds_write_addtid_b32 v66 offset:9488
v_add_f32 v68,v68,v69
v_smfmac_f32_16x16x64_bf16 v[76:79],v[44:47],a[248:255],v1
ds_write_addtid_b32 v68 offset:10528
v_add_f32 v70,v70,v71
v_smfmac_f32_16x16x64_bf16 v[80:83],v[16:19],v[208:215],v1
ds_write_addtid_b32 v70 offset:11568
v_add_f32 v72,v72,v73
v_smfmac_f32_16x16x64_bf16 v[80:83],v[32:35],v[208:215],v1
ds_write_addtid_b32 v72 offset:12608
v_add_f32 v74,v74,v75
v_smfmac_f32_16x16x64_bf16 v[84:87],v[16:19],v[216:223],v1
ds_write_addtid_b32 v74 offset:13648
v_add_f32 v76,v76,v77
v_smfmac_f32_16x16x64_bf16 v[84:87],v[32:35],v[216:223],v1
ds_write_addtid_b32 v76 offset:14688
v_add_f32 v78,v78,v79
v_smfmac_f32_16x16x64_bf16 v[88:91],v[16:19],v[224:231],v1
ds_write_addtid_b32 v78 offset:15728
v_smfmac_f32_16x16x64_bf16 v[88:91],v[32:35],v[224:231],v1
v_smfmac_f32_16x16x64_bf16 v[92:95],v[16:19],v[232:239],v1
v_smfmac_f32_16x16x64_bf16 v[92:95],v[32:35],v[232:239],v1
doneA_100866:
s_waitcnt vmcnt(0) lgkmcnt(0)
s_add_u32 s64,s79,0
s_lshl_b32 s65,s64,12
s_and_b32 s65,s65,0x2000
s_xor_b32 s65,s65,s67
s_lshl_b32 s64,s64,20
s_add_u32 s65,s65,s64
s_add_u32 s101,s65,s78
v_smfmac_f32_16x16x64_bf16 v[80:83],v[20:23],v[240:247],v1
ds_read_b128 v[48:51],v7 offset:0
ds_read_b128 v[52:55],v7 offset:1024
v_smfmac_f32_16x16x64_bf16 v[80:83],v[36:39],v[240:247],v1
ds_read_b128 v[56:59],v7 offset:2048
ds_read_b128 v[60:63],v7 offset:3072
v_smfmac_f32_16x16x64_bf16 v[84:87],v[20:23],v[248:255],v1
ds_read_b128 v[64:67],v7 offset:4096
ds_read_b128 v[68:71],v7 offset:5120
v_smfmac_f32_16x16x64_bf16 v[84:87],v[36:39],v[248:255],v1
ds_read_b128 v[72:75],v7 offset:6144
ds_read_b128 v[76:79],v7 offset:7168
s_waitcnt lgkmcnt(6)
v_smfmac_f32_16x16x64_bf16 v[88:91],v[20:23],v[48:55],v1
v_smfmac_f32_16x16x64_bf16 v[88:91],v[36:39],v[48:55],v1
ds_read_b128 v[48:51],v7 offset:8192
ds_read_b128 v[52:55],v7 offset:9216
s_waitcnt lgkmcnt(6)
v_smfmac_f32_16x16x64_bf16 v[92:95],v[20:23],v[56:63],v1
v_smfmac_f32_16x16x64_bf16 v[92:95],v[36:39],v[56:63],v1
ds_read_b128 v[56:59],v7 offset:10240
ds_read_b128 v[60:63],v7 offset:11264
s_waitcnt lgkmcnt(6)
v_smfmac_f32_16x16x64_bf16 v[80:83],v[24:27],v[64:71],v1
v_smfmac_f32_16x16x64_bf16 v[80:83],v[40:43],v[64:71],v1
ds_read_b128 v[64:67],v7 offset:12288
ds_read_b128 v[68:71],v7 offset:13312
s_waitcnt lgkmcnt(6)
v_smfmac_f32_16x16x64_bf16 v[84:87],v[24:27],v[72:79],v1
v_smfmac_f32_16x16x64_bf16 v[84:87],v[40:43],v[72:79],v1
ds_read_b128 v[72:75],v7 offset:14336
ds_read_b128 v[76:79],v7 offset:15360
s_waitcnt lgkmcnt(6)
v_smfmac_f32_16x16x64_bf16 v[88:91],v[24:27],v[48:55],v1
v_smfmac_f32_16x16x64_bf16 v[88:91],v[40:43],v[48:55],v1
ds_read_b128 v[48:51],v7 offset:16384
ds_read_b128 v[52:55],v7 offset:17408
s_waitcnt lgkmcnt(6)
v_smfmac_f32_16x16x64_bf16 v[92:95],v[24:27],v[56:63],v1
v_smfmac_f32_16x16x64_bf16 v[92:95],v[40:43],v[56:63],v1
ds_read_b128 v[56:59],v7 offset:18432
ds_read_b128 v[60:63],v7 offset:19456
s_waitcnt lgkmcnt(6)
v_smfmac_f32_16x16x64_bf16 v[80:83],v[28:31],v[64:71],v1
v_smfmac_f32_16x16x64_bf16 v[80:83],v[44:47],v[64:71],v1
s_waitcnt lgkmcnt(4)
v_smfmac_f32_16x16x64_bf16 v[84:87],v[28:31],v[72:79],v1
v_smfmac_f32_16x16x64_bf16 v[84:87],v[44:47],v[72:79],v1
s_waitcnt lgkmcnt(2)
v_smfmac_f32_16x16x64_bf16 v[88:91],v[28:31],v[48:55],v1
v_add_f32 v80,v80,v81
v_smfmac_f32_16x16x64_bf16 v[88:91],v[44:47],v[48:55],v1
v_add_f32 v82,v82,v83
s_waitcnt lgkmcnt(0)
v_smfmac_f32_16x16x64_bf16 v[92:95],v[28:31],v[56:63],v1
v_cvt_pk_bf16_f32 v80,v80,v82
v_smfmac_f32_16x16x64_bf16 v[92:95],v[44:47],v[56:63],v1
ds_write_addtid_b32 v80 offset:16896
v_add_f32 v84,v84,v85
v_add_f32 v86,v86,v87
v_cvt_pk_bf16_f32 v84,v84,v86
v_add_f32 v88,v88,v89
v_add_f32 v90,v90,v91
v_cvt_pk_bf16_f32 v88,v88,v90
s_nop 0
v_add_f32 v92,v92,v93
v_add_f32 v94,v94,v95
v_cvt_pk_bf16_f32 v92,v92,v94
ds_write_addtid_b32 v84 offset:17920
ds_write_addtid_b32 v88 offset:18944
ds_write_addtid_b32 v92 offset:19968
s_waitcnt lgkmcnt(0)
s_barrier
s_cmp_gt_u32 s50,1
s_cbranch_scc1 l23_100867
ds_read2st64_b32 v[112:113],v127 offset0:66 offset1:67
ds_read2st64_b32 v[114:115],v127 offset0:68 offset1:69
ds_read2st64_b32 v[116:117],v127 offset0:70 offset1:71
ds_read2st64_b32 v[118:119],v127 offset0:72 offset1:73
s_waitcnt lgkmcnt(0)
v_mov_b32 v120,v5
v_mov_b32 v121,v5
v_mov_b32 v122,v5
v_mov_b32 v123,v5
s_nop 1
v_mfma_f32_16x16x32_bf16 v[112:115],v[120:123],v[112:115],0
v_mfma_f32_16x16x32_bf16 v[116:119],v[120:123],v[116:119],0
s_nop 4
v_cvt_pk_bf16_f32 v112,v112,v113
v_cvt_pk_bf16_f32 v113,v114,v115
s_nop 0
v_cvt_pk_bf16_f32 v114,v116,v117
v_cvt_pk_bf16_f32 v115,v118,v119
s_branch lj_100868
l23_100867:
ds_read_b128 v[48:51],v2 offset:0
ds_read_b128 v[52:55],v2 offset:256
ds_read_b128 v[56:59],v2 offset:512
ds_read_b128 v[60:63],v2 offset:768
ds_read_b128 v[64:67],v2 offset:16
ds_read_b128 v[68:71],v2 offset:272
ds_read_b128 v[72:75],v2 offset:528
ds_read_b128 v[76:79],v2 offset:784
s_waitcnt lgkmcnt(6)
v_pk_add_f32 v[48:49],v[48:49],v[52:53]
v_pk_add_f32 v[50:51],v[50:51],v[54:55]
s_waitcnt lgkmcnt(4)
v_pk_add_f32 v[56:57],v[56:57],v[60:61]
v_pk_add_f32 v[58:59],v[58:59],v[62:63]
v_pk_add_f32 v[48:49],v[48:49],v[56:57]
v_pk_add_f32 v[50:51],v[50:51],v[58:59]
v_cvt_pk_bf16_f32 v112,v48,v49
v_cvt_pk_bf16_f32 v113,v50,v51
s_waitcnt lgkmcnt(2)
v_pk_add_f32 v[64:65],v[64:65],v[68:69]
v_pk_add_f32 v[66:67],v[66:67],v[70:71]
s_waitcnt lgkmcnt(0)
v_pk_add_f32 v[72:73],v[72:73],v[76:77]
v_pk_add_f32 v[74:75],v[74:75],v[78:79]
v_pk_add_f32 v[64:65],v[64:65],v[72:73]
v_pk_add_f32 v[66:67],v[66:67],v[74:75]
v_cvt_pk_bf16_f32 v114,v64,v65
v_cvt_pk_bf16_f32 v115,v66,v67
lj_100868:
v_cndmask_b32 v120,2.0,v0,s[82:83]
v_cndmask_b32 v121,2.0,v127,s[86:87]
buffer_store_dwordx4 v[112:115],v120,s[20:23],s101 offen sc1
s_waitcnt vmcnt(0)
s_barrier
v_mov_b32 v126,64
buffer_store_dword v126,v121,s[20:23],s69 offen sc1
s_branch recfin_100374
flp_100777:
buffer_load_dword v124,off,s[20:23],s68 sc1
s_waitcnt vmcnt(0)
v_readfirstlane_b32 s91,v124
s_cmp_gt_u32 s91,s64
s_cbranch_scc1 fok_100776
s_sleep 2
s_sub_u32 s90,s90,1
s_cmp_gt_i32 s90,0
s_cbranch_scc1 flp_100777
s_branch fok_100776
flp_100780:
buffer_load_dword v124,off,s[20:23],s68 sc1
s_waitcnt vmcnt(0)
v_readfirstlane_b32 s91,v124
s_cmp_gt_u32 s91,s64
s_cbranch_scc1 fok_100779
s_sleep 2
s_sub_u32 s90,s90,1
s_cmp_gt_i32 s90,0
s_cbranch_scc1 flp_100780
s_branch fok_100779
fl_100797:
flb_100805:
buffer_load_dwordx4 v[16:19],v0,s[20:23],s92 offen offset:0 sc1
s_mov_b32 s55,1
buffer_load_dwordx4 v[32:35],v0,s[20:23],s93 offen offset:0 sc1
s_waitcnt vmcnt(4)
v_max3_u32 v124,v20,v21,v22
v_max_u32 v124,v124,v23
v_cmp_eq_u32 vcc,-1,v124
s_cbranch_vccnz dfl_100869
v_smfmac_f32_16x16x64_bf16 v[48:51],v[20:23],a[64:71],v1
buffer_load_dword v125,off,s[20:23],s92 sc1
v_smfmac_f32_16x16x64_bf16 v[52:55],v[20:23],a[72:79],v1
buffer_load_dwordx4 v[36:39],v0,s[20:23],s93 offen offset:1024 sc1
v_smfmac_f32_16x16x64_bf16 v[56:59],v[20:23],a[80:87],v1
s_waitcnt vmcnt(5)
v_max3_u32 v124,v24,v25,v26
v_smfmac_f32_16x16x64_bf16 v[60:63],v[20:23],a[88:95],v1
v_max_u32 v124,v124,v27
v_smfmac_f32_16x16x64_bf16 v[64:67],v[20:23],a[96:103],v1
v_cmp_eq_u32 vcc,-1,v124
v_smfmac_f32_16x16x64_bf16 v[68:71],v[20:23],a[104:111],v1
v_smfmac_f32_16x16x64_bf16 v[72:75],v[20:23],a[112:119],v1
v_smfmac_f32_16x16x64_bf16 v[76:79],v[20:23],a[120:127],v1
s_cbranch_vccnz dfl_100870
v_smfmac_f32_16x16x64_bf16 v[48:51],v[24:27],a[128:135],v1
buffer_load_dword v125,off,s[20:23],s92 sc1
v_smfmac_f32_16x16x64_bf16 v[52:55],v[24:27],a[136:143],v1
buffer_load_dwordx4 v[40:43],v0,s[20:23],s93 offen offset:2048 sc1
v_smfmac_f32_16x16x64_bf16 v[56:59],v[24:27],a[144:151],v1
buffer_load_dwordx4 v[44:47],v0,s[20:23],s93 offen offset:3072 sc1
s_waitcnt vmcnt(7)
v_max3_u32 v124,v28,v29,v30
v_smfmac_f32_16x16x64_bf16 v[60:63],v[24:27],a[152:159],v1
v_max_u32 v124,v124,v31
v_smfmac_f32_16x16x64_bf16 v[64:67],v[24:27],a[160:167],v1
v_cmp_eq_u32 vcc,-1,v124
v_smfmac_f32_16x16x64_bf16 v[68:71],v[24:27],a[168:175],v1
v_smfmac_f32_16x16x64_bf16 v[72:75],v[24:27],a[176:183],v1
v_smfmac_f32_16x16x64_bf16 v[76:79],v[24:27],a[184:191],v1
s_cbranch_vccnz dfl_100871
v_smfmac_f32_16x16x64_bf16 v[48:51],v[28:31],a[192:199],v1
buffer_load_dword v125,off,s[20:23],s92 sc1
v_smfmac_f32_16x16x64_bf16 v[52:55],v[28:31],a[200:207],v1
v_smfmac_f32_16x16x64_bf16 v[56:59],v[28:31],a[208:215],v1
s_waitcnt vmcnt(7)
v_max3_u32 v124,v16,v17,v18
v_smfmac_f32_16x16x64_bf16 v[60:63],v[28:31],a[216:223],v1
v_max_u32 v124,v124,v19
v_smfmac_f32_16x16x64_bf16 v[64:67],v[28:31],a[224:231],v1
v_cmp_eq_u32 vcc,-1,v124
v_smfmac_f32_16x16x64_bf16 v[68:71],v[28:31],a[232:239],v1
v_smfmac_f32_16x16x64_bf16 v[72:75],v[28:31],a[240:247],v1
v_smfmac_f32_16x16x64_bf16 v[76:79],v[28:31],a[248:255],v1
s_cbranch_vccnz lfb_100876
s_mov_b32 s55,0
v_smfmac_f32_16x16x64_bf16 v[48:51],v[16:19],a[0:7],v1
v_smfmac_f32_16x16x64_bf16 v[52:55],v[16:19],a[8:15],v1
v_smfmac_f32_16x16x64_bf16 v[56:59],v[16:19],a[16:23],v1
s_waitcnt vmcnt(6)
v_max3_u32 v124,v32,v33,v34
v_max_u32 v124,v124,v35
v_cmp_eq_u32 vcc,-1,v124
v_smfmac_f32_16x16x64_bf16 v[60:63],v[16:19],a[24:31],v1
v_smfmac_f32_16x16x64_bf16 v[64:67],v[16:19],a[32:39],v1
v_smfmac_f32_16x16x64_bf16 v[68:71],v[16:19],a[40:47],v1
v_smfmac_f32_16x16x64_bf16 v[72:75],v[16:19],a[48:55],v1
v_smfmac_f32_16x16x64_bf16 v[76:79],v[16:19],a[56:63],v1
s_cbranch_vccnz flb_100809
s_branch segb_100793
fl_100798:
v_smfmac_f32_16x16x64_bf16 v[76:79],v[16:19],a[56:63],v1
flb_100806:
buffer_load_dwordx4 v[20:23],v0,s[20:23],s92 offen offset:1024 sc1
s_mov_b32 s55,2
buffer_load_dwordx4 v[36:39],v0,s[20:23],s93 offen offset:1024 sc1
s_waitcnt vmcnt(5)
v_max3_u32 v124,v24,v25,v26
v_max_u32 v124,v124,v27
v_cmp_eq_u32 vcc,-1,v124
s_cbranch_vccnz dfl_100870
v_smfmac_f32_16x16x64_bf16 v[48:51],v[24:27],a[128:135],v1
buffer_load_dword v125,off,s[20:23],s92 sc1
v_smfmac_f32_16x16x64_bf16 v[52:55],v[24:27],a[136:143],v1
buffer_load_dwordx4 v[40:43],v0,s[20:23],s93 offen offset:2048 sc1
v_smfmac_f32_16x16x64_bf16 v[56:59],v[24:27],a[144:151],v1
buffer_load_dwordx4 v[44:47],v0,s[20:23],s93 offen offset:3072 sc1
s_waitcnt vmcnt(7)
v_max3_u32 v124,v28,v29,v30
v_smfmac_f32_16x16x64_bf16 v[60:63],v[24:27],a[152:159],v1
v_max_u32 v124,v124,v31
v_smfmac_f32_16x16x64_bf16 v[64:67],v[24:27],a[160:167],v1
v_cmp_eq_u32 vcc,-1,v124
v_smfmac_f32_16x16x64_bf16 v[68:71],v[24:27],a[168:175],v1
v_smfmac_f32_16x16x64_bf16 v[72:75],v[24:27],a[176:183],v1
v_smfmac_f32_16x16x64_bf16 v[76:79],v[24:27],a[184:191],v1
s_cbranch_vccnz dfl_100871
v_smfmac_f32_16x16x64_bf16 v[48:51],v[28:31],a[192:199],v1
buffer_load_dword v125,off,s[20:23],s92 sc1
v_smfmac_f32_16x16x64_bf16 v[52:55],v[28:31],a[200:207],v1
v_smfmac_f32_16x16x64_bf16 v[56:59],v[28:31],a[208:215],v1
s_waitcnt vmcnt(5)
v_max3_u32 v124,v20,v21,v22
v_smfmac_f32_16x16x64_bf16 v[60:63],v[28:31],a[216:223],v1
v_max_u32 v124,v124,v23
v_smfmac_f32_16x16x64_bf16 v[64:67],v[28:31],a[224:231],v1
v_cmp_eq_u32 vcc,-1,v124
v_smfmac_f32_16x16x64_bf16 v[68:71],v[28:31],a[232:239],v1
v_smfmac_f32_16x16x64_bf16 v[72:75],v[28:31],a[240:247],v1
v_smfmac_f32_16x16x64_bf16 v[76:79],v[28:31],a[248:255],v1
s_cbranch_vccnz lfb_100876
s_mov_b32 s55,0
v_smfmac_f32_16x16x64_bf16 v[48:51],v[20:23],a[64:71],v1
v_smfmac_f32_16x16x64_bf16 v[52:55],v[20:23],a[72:79],v1
v_smfmac_f32_16x16x64_bf16 v[56:59],v[20:23],a[80:87],v1
s_waitcnt vmcnt(6)
v_max3_u32 v124,v32,v33,v34
v_max_u32 v124,v124,v35
v_cmp_eq_u32 vcc,-1,v124
v_smfmac_f32_16x16x64_bf16 v[60:63],v[20:23],a[88:95],v1
v_smfmac_f32_16x16x64_bf16 v[64:67],v[20:23],a[96:103],v1
v_smfmac_f32_16x16x64_bf16 v[68:71],v[20:23],a[104:111],v1
v_smfmac_f32_16x16x64_bf16 v[72:75],v[20:23],a[112:119],v1
v_smfmac_f32_16x16x64_bf16 v[76:79],v[20:23],a[120:127],v1
s_cbranch_vccnz flb_100809
s_branch segb_100793
fl_100799:
v_smfmac_f32_16x16x64_bf16 v[76:79],v[20:23],a[120:127],v1
flb_100807:
buffer_load_dwordx4 v[24:27],v0,s[20:23],s92 offen offset:2048 sc1
s_mov_b32 s55,4
buffer_load_dwordx4 v[40:43],v0,s[20:23],s93 offen offset:2048 sc1
buffer_load_dwordx4 v[44:47],v0,s[20:23],s93 offen offset:3072 sc1
s_waitcnt vmcnt(7)
v_max3_u32 v124,v28,v29,v30
v_max_u32 v124,v124,v31
v_cmp_eq_u32 vcc,-1,v124
s_cbranch_vccnz dfl_100871
v_smfmac_f32_16x16x64_bf16 v[48:51],v[28:31],a[192:199],v1
buffer_load_dword v125,off,s[20:23],s92 sc1
v_smfmac_f32_16x16x64_bf16 v[52:55],v[28:31],a[200:207],v1
v_smfmac_f32_16x16x64_bf16 v[56:59],v[28:31],a[208:215],v1
s_waitcnt vmcnt(3)
v_max3_u32 v124,v24,v25,v26
v_smfmac_f32_16x16x64_bf16 v[60:63],v[28:31],a[216:223],v1
v_max_u32 v124,v124,v27
v_smfmac_f32_16x16x64_bf16 v[64:67],v[28:31],a[224:231],v1
v_cmp_eq_u32 vcc,-1,v124
v_smfmac_f32_16x16x64_bf16 v[68:71],v[28:31],a[232:239],v1
v_smfmac_f32_16x16x64_bf16 v[72:75],v[28:31],a[240:247],v1
v_smfmac_f32_16x16x64_bf16 v[76:79],v[28:31],a[248:255],v1
s_cbranch_vccnz lfb_100876
s_mov_b32 s55,0
v_smfmac_f32_16x16x64_bf16 v[48:51],v[24:27],a[128:135],v1
v_smfmac_f32_16x16x64_bf16 v[52:55],v[24:27],a[136:143],v1
v_smfmac_f32_16x16x64_bf16 v[56:59],v[24:27],a[144:151],v1
s_waitcnt vmcnt(6)
v_max3_u32 v124,v32,v33,v34
v_max_u32 v124,v124,v35
v_cmp_eq_u32 vcc,-1,v124
v_smfmac_f32_16x16x64_bf16 v[60:63],v[24:27],a[152:159],v1
v_smfmac_f32_16x16x64_bf16 v[64:67],v[24:27],a[160:167],v1
v_smfmac_f32_16x16x64_bf16 v[68:71],v[24:27],a[168:175],v1
v_smfmac_f32_16x16x64_bf16 v[72:75],v[24:27],a[176:183],v1
v_smfmac_f32_16x16x64_bf16 v[76:79],v[24:27],a[184:191],v1
s_cbranch_vccnz flb_100809
s_branch segb_100793
fl_100800:
v_smfmac_f32_16x16x64_bf16 v[76:79],v[24:27],a[184:191],v1
flb_100808:
buffer_load_dwordx4 v[28:31],v0,s[20:23],s92 offen offset:3072 sc1
s_mov_b32 s55,8
s_waitcnt vmcnt(0)
v_max3_u32 v124,v28,v29,v30
v_max_u32 v124,v124,v31
v_cmp_eq_u32 vcc,-1,v124
s_cbranch_vccnz lfb_100876
s_mov_b32 s55,0
v_smfmac_f32_16x16x64_bf16 v[48:51],v[28:31],a[192:199],v1
v_smfmac_f32_16x16x64_bf16 v[52:55],v[28:31],a[200:207],v1
v_smfmac_f32_16x16x64_bf16 v[56:59],v[28:31],a[208:215],v1
s_waitcnt vmcnt(6)
v_max3_u32 v124,v32,v33,v34
v_max_u32 v124,v124,v35
v_cmp_eq_u32 vcc,-1,v124
v_smfmac_f32_16x16x64_bf16 v[60:63],v[28:31],a[216:223],v1
v_smfmac_f32_16x16x64_bf16 v[64:67],v[28:31],a[224:231],v1
v_smfmac_f32_16x16x64_bf16 v[68:71],v[28:31],a[232:239],v1
v_smfmac_f32_16x16x64_bf16 v[72:75],v[28:31],a[240:247],v1
v_smfmac_f32_16x16x64_bf16 v[76:79],v[28:31],a[248:255],v1
s_cbranch_vccnz flb_100809
s_branch segb_100793
fl_100801:
v_smfmac_f32_16x16x64_bf16 v[76:79],v[28:31],a[248:255],v1
flb_100809:
buffer_load_dwordx4 v[32:35],v0,s[20:23],s93 offen offset:0 sc1
s_mov_b32 s55,240
buffer_store_dwordx4 v[112:115],v120,s[20:23],s101 offen sc1
buffer_store_dword v126,v121,s[20:23],s69 offen sc1
s_bitcmp1_b32 s55,5
s_cbranch_scc0 rdn_100879
s_waitcnt vmcnt(7)
v_max3_u32 v124,v36,v37,v38
v_max_u32 v124,v124,v39
v_cmp_eq_u32 vcc,-1,v124
s_cbranch_vccnz rfa_100880
buffer_load_dword v125,off,s[20:23],s92 sc1
s_bitset0_b32 s55,5
v_smfmac_f32_16x16x64_bf16 v[48:51],v[36:39],a[64:71],v1
v_smfmac_f32_16x16x64_bf16 v[52:55],v[36:39],a[72:79],v1
v_smfmac_f32_16x16x64_bf16 v[56:59],v[36:39],a[80:87],v1
v_smfmac_f32_16x16x64_bf16 v[60:63],v[36:39],a[88:95],v1
v_smfmac_f32_16x16x64_bf16 v[64:67],v[36:39],a[96:103],v1
v_smfmac_f32_16x16x64_bf16 v[68:71],v[36:39],a[104:111],v1
v_smfmac_f32_16x16x64_bf16 v[72:75],v[36:39],a[112:119],v1
v_smfmac_f32_16x16x64_bf16 v[76:79],v[36:39],a[120:127],v1
s_cmp_eq_u32 s55,0
s_cbranch_scc1 segb_100795
s_branch rnx_100881
rdn_100879:
buffer_load_dword v125,off,s[20:23],s92 sc1
s_branch rnx_100881
rfa_100880:
buffer_load_dwordx4 v[36:39],v0,s[20:23],s93 offen offset:1024 sc1
rnx_100881:
s_bitcmp1_b32 s55,6
s_cbranch_scc0 rdn_100882
s_waitcnt vmcnt(6)
v_max3_u32 v124,v40,v41,v42
v_max_u32 v124,v124,v43
v_cmp_eq_u32 vcc,-1,v124
s_cbranch_vccnz rfa_100883
buffer_load_dword v125,off,s[20:23],s92 sc1
s_bitset0_b32 s55,6
s_cmp_eq_u32 s55,0
s_cbranch_scc1 segb_100795
s_branch rnx_100884
rdn_100882:
buffer_load_dword v125,off,s[20:23],s92 sc1
s_branch rnx_100884
rfa_100883:
buffer_load_dwordx4 v[40:43],v0,s[20:23],s93 offen offset:2048 sc1
rnx_100884:
s_bitcmp1_b32 s55,7
s_cbranch_scc0 rdn_100885
s_waitcnt vmcnt(6)
v_max3_u32 v124,v44,v45,v46
v_max_u32 v124,v124,v47
v_cmp_eq_u32 vcc,-1,v124
s_cbranch_vccnz rfa_100886
buffer_load_dword v125,off,s[20:23],s92 sc1
s_bitset0_b32 s55,7
s_cmp_eq_u32 s55,0
s_cbranch_scc1 segb_100795
s_branch rnx_100887
rdn_100885:
buffer_load_dword v125,off,s[20:23],s92 sc1
s_branch rnx_100887
rfa_100886:
buffer_load_dwordx4 v[44:47],v0,s[20:23],s93 offen offset:3072 sc1
rnx_100887:
rot_100878:
s_bitcmp1_b32 s55,4
s_cbranch_scc0 rdn_100888
s_waitcnt vmcnt(3)
v_max3_u32 v124,v32,v33,v34
v_max_u32 v124,v124,v35
v_cmp_eq_u32 vcc,-1,v124
s_cbranch_vccnz rfa_100889
buffer_load_dword v125,off,s[20:23],s92 sc1
s_bitset0_b32 s55,4
v_smfmac_f32_16x16x64_bf16 v[48:51],v[32:35],a[0:7],v1
v_smfmac_f32_16x16x64_bf16 v[52:55],v[32:35],a[8:15],v1
v_smfmac_f32_16x16x64_bf16 v[56:59],v[32:35],a[16:23],v1
v_smfmac_f32_16x16x64_bf16 v[60:63],v[32:35],a[24:31],v1
v_smfmac_f32_16x16x64_bf16 v[64:67],v[32:35],a[32:39],v1
v_smfmac_f32_16x16x64_bf16 v[68:71],v[32:35],a[40:47],v1
v_smfmac_f32_16x16x64_bf16 v[72:75],v[32:35],a[48:55],v1
v_smfmac_f32_16x16x64_bf16 v[76:79],v[32:35],a[56:63],v1
s_cmp_eq_u32 s55,0
s_cbranch_scc1 segb_100795
s_branch rnx_100890
rdn_100888:
buffer_load_dword v125,off,s[20:23],s92 sc1
s_branch rnx_100890
rfa_100889:
buffer_load_dwordx4 v[32:35],v0,s[20:23],s93 offen offset:0 sc1
rnx_100890:
s_bitcmp1_b32 s55,5
s_cbranch_scc0 rdn_100891
s_waitcnt vmcnt(3)
v_max3_u32 v124,v36,v37,v38
v_max_u32 v124,v124,v39
v_cmp_eq_u32 vcc,-1,v124
s_cbranch_vccnz rfa_100892
buffer_load_dword v125,off,s[20:23],s92 sc1
s_bitset0_b32 s55,5
v_smfmac_f32_16x16x64_bf16 v[48:51],v[36:39],a[64:71],v1
v_smfmac_f32_16x16x64_bf16 v[52:55],v[36:39],a[72:79],v1
v_smfmac_f32_16x16x64_bf16 v[56:59],v[36:39],a[80:87],v1
v_smfmac_f32_16x16x64_bf16 v[60:63],v[36:39],a[88:95],v1
v_smfmac_f32_16x16x64_bf16 v[64:67],v[36:39],a[96:103],v1
v_smfmac_f32_16x16x64_bf16 v[68:71],v[36:39],a[104:111],v1
v_smfmac_f32_16x16x64_bf16 v[72:75],v[36:39],a[112:119],v1
v_smfmac_f32_16x16x64_bf16 v[76:79],v[36:39],a[120:127],v1
s_cmp_eq_u32 s55,0
s_cbranch_scc1 segb_100795
s_branch rnx_100893
rdn_100891:
buffer_load_dword v125,off,s[20:23],s92 sc1
s_branch rnx_100893
rfa_100892:
buffer_load_dwordx4 v[36:39],v0,s[20:23],s93 offen offset:1024 sc1
rnx_100893:
s_bitcmp1_b32 s55,6
s_cbranch_scc0 rdn_100894
s_waitcnt vmcnt(3)
v_max3_u32 v124,v40,v41,v42
v_max_u32 v124,v124,v43
v_cmp_eq_u32 vcc,-1,v124
s_cbranch_vccnz rfa_100895
buffer_load_dword v125,off,s[20:23],s92 sc1
s_bitset0_b32 s55,6
s_cmp_eq_u32 s55,0
s_cbranch_scc1 segb_100795
s_branch rnx_100896
rdn_100894:
buffer_load_dword v125,off,s[20:23],s92 sc1
s_branch rnx_100896
rfa_100895:
buffer_load_dwordx4 v[40:43],v0,s[20:23],s93 offen offset:2048 sc1
rnx_100896:
s_bitcmp1_b32 s55,7
s_cbranch_scc0 rdn_100897
s_waitcnt vmcnt(3)
v_max3_u32 v124,v44,v45,v46
v_max_u32 v124,v124,v47
v_cmp_eq_u32 vcc,-1,v124
s_cbranch_vccnz rfa_100898
buffer_load_dword v125,off,s[20:23],s92 sc1
s_bitset0_b32 s55,7
s_cmp_eq_u32 s55,0
s_cbranch_scc1 segb_100795
s_branch rnx_100899
rdn_100897:
buffer_load_dword v125,off,s[20:23],s92 sc1
s_branch rnx_100899
rfa_100898:
buffer_load_dwordx4 v[44:47],v0,s[20:23],s93 offen offset:3072 sc1
rnx_100899:
s_sub_u32 s90,s90,1
s_cmp_gt_i32 s90,0
s_cbranch_scc1 rot_100878
s_mov_b32 s55,0
s_branch segb_100795
fl_100802:
v_smfmac_f32_16x16x64_bf16 v[76:79],v[32:35],a[56:63],v1
flb_100810:
buffer_load_dwordx4 v[36:39],v0,s[20:23],s93 offen offset:1024 sc1
s_mov_b32 s55,224
s_bitcmp1_b32 s55,6
s_cbranch_scc0 rdn_100901
s_waitcnt vmcnt(6)
v_max3_u32 v124,v40,v41,v42
v_max_u32 v124,v124,v43
v_cmp_eq_u32 vcc,-1,v124
s_cbranch_vccnz rfa_100902
buffer_load_dword v125,off,s[20:23],s92 sc1
s_bitset0_b32 s55,6
s_cmp_eq_u32 s55,0
s_cbranch_scc1 segb_100795
s_branch rnx_100903
rdn_100901:
buffer_load_dword v125,off,s[20:23],s92 sc1
s_branch rnx_100903
rfa_100902:
buffer_load_dwordx4 v[40:43],v0,s[20:23],s93 offen offset:2048 sc1
rnx_100903:
s_bitcmp1_b32 s55,7
s_cbranch_scc0 rdn_100904
s_waitcnt vmcnt(6)
v_max3_u32 v124,v44,v45,v46
v_max_u32 v124,v124,v47
v_cmp_eq_u32 vcc,-1,v124
s_cbranch_vccnz rfa_100905
buffer_load_dword v125,off,s[20:23],s92 sc1
s_bitset0_b32 s55,7
s_cmp_eq_u32 s55,0
s_cbranch_scc1 segb_100795
s_branch rnx_100906
rdn_100904:
buffer_load_dword v125,off,s[20:23],s92 sc1
s_branch rnx_100906
rfa_100905:
buffer_load_dwordx4 v[44:47],v0,s[20:23],s93 offen offset:3072 sc1
rnx_100906:
rot_100900:
s_bitcmp1_b32 s55,5
s_cbranch_scc0 rdn_100907
s_waitcnt vmcnt(2)
v_max3_u32 v124,v36,v37,v38
v_max_u32 v124,v124,v39
v_cmp_eq_u32 vcc,-1,v124
s_cbranch_vccnz rfa_100908
buffer_load_dword v125,off,s[20:23],s92 sc1
s_bitset0_b32 s55,5
v_smfmac_f32_16x16x64_bf16 v[48:51],v[36:39],a[64:71],v1
v_smfmac_f32_16x16x64_bf16 v[52:55],v[36:39],a[72:79],v1
v_smfmac_f32_16x16x64_bf16 v[56:59],v[36:39],a[80:87],v1
v_smfmac_f32_16x16x64_bf16 v[60:63],v[36:39],a[88:95],v1
v_smfmac_f32_16x16x64_bf16 v[64:67],v[36:39],a[96:103],v1
v_smfmac_f32_16x16x64_bf16 v[68:71],v[36:39],a[104:111],v1
v_smfmac_f32_16x16x64_bf16 v[72:75],v[36:39],a[112:119],v1
v_smfmac_f32_16x16x64_bf16 v[76:79],v[36:39],a[120:127],v1
s_cmp_eq_u32 s55,0
s_cbranch_scc1 segb_100795
s_branch rnx_100909
rdn_100907:
buffer_load_dword v125,off,s[20:23],s92 sc1
s_branch rnx_100909
rfa_100908:
buffer_load_dwordx4 v[36:39],v0,s[20:23],s93 offen offset:1024 sc1
rnx_100909:
s_bitcmp1_b32 s55,6
s_cbranch_scc0 rdn_100910
s_waitcnt vmcnt(2)
v_max3_u32 v124,v40,v41,v42
v_max_u32 v124,v124,v43
v_cmp_eq_u32 vcc,-1,v124
s_cbranch_vccnz rfa_100911
buffer_load_dword v125,off,s[20:23],s92 sc1
s_bitset0_b32 s55,6
s_cmp_eq_u32 s55,0
s_cbranch_scc1 segb_100795
s_branch rnx_100912
rdn_100910:
buffer_load_dword v125,off,s[20:23],s92 sc1
s_branch rnx_100912
rfa_100911:
buffer_load_dwordx4 v[40:43],v0,s[20:23],s93 offen offset:2048 sc1
rnx_100912:
s_bitcmp1_b32 s55,7
s_cbranch_scc0 rdn_100913
s_waitcnt vmcnt(2)
v_max3_u32 v124,v44,v45,v46
v_max_u32 v124,v124,v47
v_cmp_eq_u32 vcc,-1,v124
s_cbranch_vccnz rfa_100914
buffer_load_dword v125,off,s[20:23],s92 sc1
s_bitset0_b32 s55,7
s_cmp_eq_u32 s55,0
s_cbranch_scc1 segb_100795
s_branch rnx_100915
rdn_100913:
buffer_load_dword v125,off,s[20:23],s92 sc1
s_branch rnx_100915
rfa_100914:
buffer_load_dwordx4 v[44:47],v0,s[20:23],s93 offen offset:3072 sc1
rnx_100915:
s_sub_u32 s90,s90,1
s_cmp_gt_i32 s90,0
s_cbranch_scc1 rot_100900
s_mov_b32 s55,0
s_branch segb_100795
fl_100803:
v_smfmac_f32_16x16x64_bf16 v[76:79],v[36:39],a[120:127],v1
flb_100811:
s_mov_b32 s55,192
s_bitcmp1_b32 s55,6
s_cbranch_scc0 rdn_100917
s_waitcnt vmcnt(6)
v_max3_u32 v124,v40,v41,v42
v_max_u32 v124,v124,v43
v_cmp_eq_u32 vcc,-1,v124
s_cbranch_vccnz rfa_100918
buffer_load_dword v125,off,s[20:23],s92 sc1
s_bitset0_b32 s55,6
s_cmp_eq_u32 s55,0
s_cbranch_scc1 segb_100795
s_branch rnx_100919
rdn_100917:
buffer_load_dword v125,off,s[20:23],s92 sc1
s_branch rnx_100919
rfa_100918:
buffer_load_dwordx4 v[40:43],v0,s[20:23],s93 offen offset:2048 sc1
rnx_100919:
s_bitcmp1_b32 s55,7
s_cbranch_scc0 rdn_100920
s_waitcnt vmcnt(6)
v_max3_u32 v124,v44,v45,v46
v_max_u32 v124,v124,v47
v_cmp_eq_u32 vcc,-1,v124
s_cbranch_vccnz rfa_100921
buffer_load_dword v125,off,s[20:23],s92 sc1
s_bitset0_b32 s55,7
s_cmp_eq_u32 s55,0
s_cbranch_scc1 segb_100795
s_branch rnx_100922
rdn_100920:
buffer_load_dword v125,off,s[20:23],s92 sc1
s_branch rnx_100922
rfa_100921:
buffer_load_dwordx4 v[44:47],v0,s[20:23],s93 offen offset:3072 sc1
rnx_100922:
rot_100916:
s_bitcmp1_b32 s55,6
s_cbranch_scc0 rdn_100923
s_waitcnt vmcnt(1)
v_max3_u32 v124,v40,v41,v42
v_max_u32 v124,v124,v43
v_cmp_eq_u32 vcc,-1,v124
s_cbranch_vccnz rfa_100924
buffer_load_dword v125,off,s[20:23],s92 sc1
s_bitset0_b32 s55,6
s_cmp_eq_u32 s55,0
s_cbranch_scc1 segb_100795
s_branch rnx_100925
rdn_100923:
buffer_load_dword v125,off,s[20:23],s92 sc1
s_branch rnx_100925
rfa_100924:
buffer_load_dwordx4 v[40:43],v0,s[20:23],s93 offen offset:2048 sc1
rnx_100925:
s_bitcmp1_b32 s55,7
s_cbranch_scc0 rdn_100926
s_waitcnt vmcnt(1)
v_max3_u32 v124,v44,v45,v46
v_max_u32 v124,v124,v47
v_cmp_eq_u32 vcc,-1,v124
s_cbranch_vccnz rfa_100927
buffer_load_dword v125,off,s[20:23],s92 sc1
s_bitset0_b32 s55,7
s_cmp_eq_u32 s55,0
s_cbranch_scc1 segb_100795
s_branch rnx_100928
rdn_100926:
buffer_load_dword v125,off,s[20:23],s92 sc1
s_branch rnx_100928
rfa_100927:
buffer_load_dwordx4 v[44:47],v0,s[20:23],s93 offen offset:3072 sc1
rnx_100928:
s_sub_u32 s90,s90,1
s_cmp_gt_i32 s90,0
s_cbranch_scc1 rot_100916
s_mov_b32 s55,0
s_branch segb_100795
dfl_100869:
buffer_load_dwordx4 v[20:23],v0,s[20:23],s92 offen offset:1024 sc1
s_bitset1_b32 s55,1
buffer_load_dwordx4 v[36:39],v0,s[20:23],s93 offen offset:1024 sc1
s_waitcnt vmcnt(5)
v_max3_u32 v124,v24,v25,v26
v_max_u32 v124,v124,v27
v_cmp_eq_u32 vcc,-1,v124
s_cbranch_vccnz dfl_100870
s_branch dseg_100873
dfl_100870:
buffer_load_dwordx4 v[24:27],v0,s[20:23],s92 offen offset:2048 sc1
s_bitset1_b32 s55,2
buffer_load_dwordx4 v[40:43],v0,s[20:23],s93 offen offset:2048 sc1
buffer_load_dwordx4 v[44:47],v0,s[20:23],s93 offen offset:3072 sc1
s_waitcnt vmcnt(7)
v_max3_u32 v124,v28,v29,v30
v_max_u32 v124,v124,v31
v_cmp_eq_u32 vcc,-1,v124
s_cbranch_vccnz dfl_100871
s_branch dseg_100874
dfl_100871:
buffer_load_dwordx4 v[28:31],v0,s[20:23],s92 offen offset:3072 sc1
s_bitset1_b32 s55,3
s_branch lap2_100875
dseg_100873:
v_smfmac_f32_16x16x64_bf16 v[48:51],v[24:27],a[128:135],v1
buffer_load_dword v125,off,s[20:23],s92 sc1
v_smfmac_f32_16x16x64_bf16 v[52:55],v[24:27],a[136:143],v1
buffer_load_dwordx4 v[40:43],v0,s[20:23],s93 offen offset:2048 sc1
v_smfmac_f32_16x16x64_bf16 v[56:59],v[24:27],a[144:151],v1
buffer_load_dwordx4 v[44:47],v0,s[20:23],s93 offen offset:3072 sc1
s_waitcnt vmcnt(7)
v_max3_u32 v124,v28,v29,v30
v_smfmac_f32_16x16x64_bf16 v[60:63],v[24:27],a[152:159],v1
v_max_u32 v124,v124,v31
v_smfmac_f32_16x16x64_bf16 v[64:67],v[24:27],a[160:167],v1
v_cmp_eq_u32 vcc,-1,v124
v_smfmac_f32_16x16x64_bf16 v[68:71],v[24:27],a[168:175],v1
v_smfmac_f32_16x16x64_bf16 v[72:75],v[24:27],a[176:183],v1
v_smfmac_f32_16x16x64_bf16 v[76:79],v[24:27],a[184:191],v1
s_cbranch_vccnz dfl_100871
dseg_100874:
v_smfmac_f32_16x16x64_bf16 v[48:51],v[28:31],a[192:199],v1
buffer_load_dword v125,off,s[20:23],s92 sc1
v_smfmac_f32_16x16x64_bf16 v[52:55],v[28:31],a[200:207],v1
v_smfmac_f32_16x16x64_bf16 v[56:59],v[28:31],a[208:215],v1
v_smfmac_f32_16x16x64_bf16 v[60:63],v[28:31],a[216:223],v1
v_smfmac_f32_16x16x64_bf16 v[64:67],v[28:31],a[224:231],v1
v_smfmac_f32_16x16x64_bf16 v[68:71],v[28:31],a[232:239],v1
v_smfmac_f32_16x16x64_bf16 v[72:75],v[28:31],a[240:247],v1
v_smfmac_f32_16x16x64_bf16 v[76:79],v[28:31],a[248:255],v1
lap2_100875:
s_bitcmp1_b32 s55,0
s_cbranch_scc0 l2s_100929
s_waitcnt vmcnt(7)
v_max3_u32 v124,v16,v17,v18
v_max_u32 v124,v124,v19
v_cmp_eq_u32 vcc,-1,v124
s_cbranch_vccnz l2s_100929
s_bitset0_b32 s55,0
v_smfmac_f32_16x16x64_bf16 v[48:51],v[16:19],a[0:7],v1
v_smfmac_f32_16x16x64_bf16 v[52:55],v[16:19],a[8:15],v1
v_smfmac_f32_16x16x64_bf16 v[56:59],v[16:19],a[16:23],v1
v_smfmac_f32_16x16x64_bf16 v[60:63],v[16:19],a[24:31],v1
v_smfmac_f32_16x16x64_bf16 v[64:67],v[16:19],a[32:39],v1
v_smfmac_f32_16x16x64_bf16 v[68:71],v[16:19],a[40:47],v1
v_smfmac_f32_16x16x64_bf16 v[72:75],v[16:19],a[48:55],v1
v_smfmac_f32_16x16x64_bf16 v[76:79],v[16:19],a[56:63],v1
l2s_100929:
s_bitcmp1_b32 s55,1
s_cbranch_scc0 l2s_100931
s_waitcnt vmcnt(5)
v_max3_u32 v124,v20,v21,v22
v_max_u32 v124,v124,v23
v_cmp_eq_u32 vcc,-1,v124
s_cbranch_vccnz l2s_100931
s_bitset0_b32 s55,1
v_smfmac_f32_16x16x64_bf16 v[48:51],v[20:23],a[64:71],v1
v_smfmac_f32_16x16x64_bf16 v[52:55],v[20:23],a[72:79],v1
v_smfmac_f32_16x16x64_bf16 v[56:59],v[20:23],a[80:87],v1
v_smfmac_f32_16x16x64_bf16 v[60:63],v[20:23],a[88:95],v1
v_smfmac_f32_16x16x64_bf16 v[64:67],v[20:23],a[96:103],v1
v_smfmac_f32_16x16x64_bf16 v[68:71],v[20:23],a[104:111],v1
v_smfmac_f32_16x16x64_bf16 v[72:75],v[20:23],a[112:119],v1
v_smfmac_f32_16x16x64_bf16 v[76:79],v[20:23],a[120:127],v1
l2s_100931:
s_bitcmp1_b32 s55,2
s_cbranch_scc0 l2s_100933
s_waitcnt vmcnt(3)
v_max3_u32 v124,v24,v25,v26
v_max_u32 v124,v124,v27
v_cmp_eq_u32 vcc,-1,v124
s_cbranch_vccnz l2s_100933
s_bitset0_b32 s55,2
v_smfmac_f32_16x16x64_bf16 v[48:51],v[24:27],a[128:135],v1
v_smfmac_f32_16x16x64_bf16 v[52:55],v[24:27],a[136:143],v1
v_smfmac_f32_16x16x64_bf16 v[56:59],v[24:27],a[144:151],v1
v_smfmac_f32_16x16x64_bf16 v[60:63],v[24:27],a[152:159],v1
v_smfmac_f32_16x16x64_bf16 v[64:67],v[24:27],a[160:167],v1
v_smfmac_f32_16x16x64_bf16 v[68:71],v[24:27],a[168:175],v1
v_smfmac_f32_16x16x64_bf16 v[72:75],v[24:27],a[176:183],v1
v_smfmac_f32_16x16x64_bf16 v[76:79],v[24:27],a[184:191],v1
l2s_100933:
s_bitcmp1_b32 s55,3
s_cbranch_scc0 l2s_100935
s_waitcnt vmcnt(0)
v_max3_u32 v124,v28,v29,v30
v_max_u32 v124,v124,v31
v_cmp_eq_u32 vcc,-1,v124
s_cbranch_vccnz l2s_100935
s_bitset0_b32 s55,3
v_smfmac_f32_16x16x64_bf16 v[48:51],v[28:31],a[192:199],v1
v_smfmac_f32_16x16x64_bf16 v[52:55],v[28:31],a[200:207],v1
v_smfmac_f32_16x16x64_bf16 v[56:59],v[28:31],a[208:215],v1
v_smfmac_f32_16x16x64_bf16 v[60:63],v[28:31],a[216:223],v1
v_smfmac_f32_16x16x64_bf16 v[64:67],v[28:31],a[224:231],v1
v_smfmac_f32_16x16x64_bf16 v[68:71],v[28:31],a[232:239],v1
v_smfmac_f32_16x16x64_bf16 v[72:75],v[28:31],a[240:247],v1
v_smfmac_f32_16x16x64_bf16 v[76:79],v[28:31],a[248:255],v1
l2s_100935:
s_cmp_eq_u32 s55,0
s_cbranch_scc0 lfb_100876
Ldone_100877:
s_waitcnt vmcnt(6)
v_max3_u32 v124,v32,v33,v34
v_max_u32 v124,v124,v35
v_cmp_eq_u32 vcc,-1,v124
s_cbranch_vccnz flb_100809
s_branch segb_100793
lfb_100876:
s_bitcmp1_b32 s55,0
s_cbranch_scc0 dsk_100937
buffer_load_dwordx4 v[16:19],v0,s[20:23],s92 offen offset:0 sc1
dsk_100937:
s_bitcmp1_b32 s55,1
s_cbranch_scc0 dsk_100938
buffer_load_dwordx4 v[20:23],v0,s[20:23],s92 offen offset:1024 sc1
dsk_100938:
s_bitcmp1_b32 s55,2
s_cbranch_scc0 dsk_100939
buffer_load_dwordx4 v[24:27],v0,s[20:23],s92 offen offset:2048 sc1
dsk_100939:
s_bitcmp1_b32 s55,3
s_cbranch_scc0 dsk_100940
buffer_load_dwordx4 v[28:31],v0,s[20:23],s92 offen offset:3072 sc1
dsk_100940:
s_bitcmp1_b32 s55,0
s_cbranch_scc0 dsk_100941
s_waitcnt vmcnt(2)
v_max3_u32 v124,v16,v17,v18
v_max_u32 v124,v124,v19
v_cmp_eq_u32 vcc,-1,v124
s_cbranch_vccz dgo_100942
s_nop 15
buffer_load_dwordx4 v[104:107],v0,s[20:23],s92 offen offset:0 sc1
s_nop 15
buffer_load_dwordx4 v[108:111],v0,s[20:23],s92 offen offset:0 sc1
dlp_100943:
s_waitcnt vmcnt(2)
v_max3_u32 v124,v16,v17,v18
v_max_u32 v124,v124,v19
v_cmp_eq_u32 vcc,-1,v124
s_cbranch_vccz dgo_100942
buffer_load_dwordx4 v[16:19],v0,s[20:23],s92 offen offset:0 sc1
s_waitcnt vmcnt(2)
v_max3_u32 v124,v104,v105,v106
v_max_u32 v124,v124,v107
v_cmp_eq_u32 vcc,-1,v124
s_cbranch_vccz dcp_100945
buffer_load_dwordx4 v[104:107],v0,s[20:23],s92 offen offset:0 sc1
s_waitcnt vmcnt(2)
v_max3_u32 v124,v108,v109,v110
v_max_u32 v124,v124,v111
v_cmp_eq_u32 vcc,-1,v124
s_cbranch_vccz dcp_100946
buffer_load_dwordx4 v[108:111],v0,s[20:23],s92 offen offset:0 sc1
s_sub_u32 s90,s90,1
s_cmp_gt_i32 s90,0
s_cbranch_scc1 dlp_100943
s_branch dgo_100942
dcp_100945:
v_mov_b32 v16,v104
v_mov_b32 v17,v105
v_mov_b32 v18,v106
v_mov_b32 v19,v107
s_nop 1
s_branch dgo_100942
dcp_100946:
v_mov_b32 v16,v108
v_mov_b32 v17,v109
v_mov_b32 v18,v110
v_mov_b32 v19,v111
s_nop 1
dgo_100942:
v_smfmac_f32_16x16x64_bf16 v[48:51],v[16:19],a[0:7],v1
v_smfmac_f32_16x16x64_bf16 v[52:55],v[16:19],a[8:15],v1
v_smfmac_f32_16x16x64_bf16 v[56:59],v[16:19],a[16:23],v1
v_smfmac_f32_16x16x64_bf16 v[60:63],v[16:19],a[24:31],v1
v_smfmac_f32_16x16x64_bf16 v[64:67],v[16:19],a[32:39],v1
v_smfmac_f32_16x16x64_bf16 v[68:71],v[16:19],a[40:47],v1
v_smfmac_f32_16x16x64_bf16 v[72:75],v[16:19],a[48:55],v1
v_smfmac_f32_16x16x64_bf16 v[76:79],v[16:19],a[56:63],v1
dsk_100941:
s_bitcmp1_b32 s55,1
s_cbranch_scc0 dsk_100947
s_waitcnt vmcnt(2)
v_max3_u32 v124,v20,v21,v22
v_max_u32 v124,v124,v23
v_cmp_eq_u32 vcc,-1,v124
s_cbranch_vccz dgo_100948
s_nop 15
buffer_load_dwordx4 v[104:107],v0,s[20:23],s92 offen offset:1024 sc1
s_nop 15
buffer_load_dwordx4 v[108:111],v0,s[20:23],s92 offen offset:1024 sc1
dlp_100949:
s_waitcnt vmcnt(2)
v_max3_u32 v124,v20,v21,v22
v_max_u32 v124,v124,v23
v_cmp_eq_u32 vcc,-1,v124
s_cbranch_vccz dgo_100948
buffer_load_dwordx4 v[20:23],v0,s[20:23],s92 offen offset:1024 sc1
s_waitcnt vmcnt(2)
v_max3_u32 v124,v104,v105,v106
v_max_u32 v124,v124,v107
v_cmp_eq_u32 vcc,-1,v124
s_cbranch_vccz dcp_100951
buffer_load_dwordx4 v[104:107],v0,s[20:23],s92 offen offset:1024 sc1
s_waitcnt vmcnt(2)
v_max3_u32 v124,v108,v109,v110
v_max_u32 v124,v124,v111
v_cmp_eq_u32 vcc,-1,v124
s_cbranch_vccz dcp_100952
buffer_load_dwordx4 v[108:111],v0,s[20:23],s92 offen offset:1024 sc1
s_sub_u32 s90,s90,1
s_cmp_gt_i32 s90,0
s_cbranch_scc1 dlp_100949
s_branch dgo_100948
dcp_100951:
v_mov_b32 v20,v104
v_mov_b32 v21,v105
v_mov_b32 v22,v106
v_mov_b32 v23,v107
s_nop 1
s_branch dgo_100948
dcp_100952:
v_mov_b32 v20,v108
v_mov_b32 v21,v109
v_mov_b32 v22,v110
v_mov_b32 v23,v111
s_nop 1
dgo_100948:
v_smfmac_f32_16x16x64_bf16 v[48:51],v[20:23],a[64:71],v1
v_smfmac_f32_16x16x64_bf16 v[52:55],v[20:23],a[72:79],v1
v_smfmac_f32_16x16x64_bf16 v[56:59],v[20:23],a[80:87],v1
v_smfmac_f32_16x16x64_bf16 v[60:63],v[20:23],a[88:95],v1
v_smfmac_f32_16x16x64_bf16 v[64:67],v[20:23],a[96:103],v1
v_smfmac_f32_16x16x64_bf16 v[68:71],v[20:23],a[104:111],v1
v_smfmac_f32_16x16x64_bf16 v[72:75],v[20:23],a[112:119],v1
v_smfmac_f32_16x16x64_bf16 v[76:79],v[20:23],a[120:127],v1
dsk_100947:
s_bitcmp1_b32 s55,2
s_cbranch_scc0 dsk_100953
s_waitcnt vmcnt(2)
v_max3_u32 v124,v24,v25,v26
v_max_u32 v124,v124,v27
v_cmp_eq_u32 vcc,-1,v124
s_cbranch_vccz dgo_100954
s_nop 15
buffer_load_dwordx4 v[104:107],v0,s[20:23],s92 offen offset:2048 sc1
s_nop 15
buffer_load_dwordx4 v[108:111],v0,s[20:23],s92 offen offset:2048 sc1
dlp_100955:
s_waitcnt vmcnt(2)
v_max3_u32 v124,v24,v25,v26
v_max_u32 v124,v124,v27
v_cmp_eq_u32 vcc,-1,v124
s_cbranch_vccz dgo_100954
buffer_load_dwordx4 v[24:27],v0,s[20:23],s92 offen offset:2048 sc1
s_waitcnt vmcnt(2)
v_max3_u32 v124,v104,v105,v106
v_max_u32 v124,v124,v107
v_cmp_eq_u32 vcc,-1,v124
s_cbranch_vccz dcp_100957
buffer_load_dwordx4 v[104:107],v0,s[20:23],s92 offen offset:2048 sc1
s_waitcnt vmcnt(2)
v_max3_u32 v124,v108,v109,v110
v_max_u32 v124,v124,v111
v_cmp_eq_u32 vcc,-1,v124
s_cbranch_vccz dcp_100958
buffer_load_dwordx4 v[108:111],v0,s[20:23],s92 offen offset:2048 sc1
s_sub_u32 s90,s90,1
s_cmp_gt_i32 s90,0
s_cbranch_scc1 dlp_100955
s_branch dgo_100954
dcp_100957:
v_mov_b32 v24,v104
v_mov_b32 v25,v105
v_mov_b32 v26,v106
v_mov_b32 v27,v107
s_nop 1
s_branch dgo_100954
dcp_100958:
v_mov_b32 v24,v108
v_mov_b32 v25,v109
v_mov_b32 v26,v110
v_mov_b32 v27,v111
s_nop 1
dgo_100954:
v_smfmac_f32_16x16x64_bf16 v[48:51],v[24:27],a[128:135],v1
v_smfmac_f32_16x16x64_bf16 v[52:55],v[24:27],a[136:143],v1
v_smfmac_f32_16x16x64_bf16 v[56:59],v[24:27],a[144:151],v1
v_smfmac_f32_16x16x64_bf16 v[60:63],v[24:27],a[152:159],v1
v_smfmac_f32_16x16x64_bf16 v[64:67],v[24:27],a[160:167],v1
v_smfmac_f32_16x16x64_bf16 v[68:71],v[24:27],a[168:175],v1
v_smfmac_f32_16x16x64_bf16 v[72:75],v[24:27],a[176:183],v1
v_smfmac_f32_16x16x64_bf16 v[76:79],v[24:27],a[184:191],v1
dsk_100953:
s_bitcmp1_b32 s55,3
s_cbranch_scc0 dsk_100959
s_waitcnt vmcnt(2)
v_max3_u32 v124,v28,v29,v30
v_max_u32 v124,v124,v31
v_cmp_eq_u32 vcc,-1,v124
s_cbranch_vccz dgo_100960
s_nop 15
buffer_load_dwordx4 v[104:107],v0,s[20:23],s92 offen offset:3072 sc1
s_nop 15
buffer_load_dwordx4 v[108:111],v0,s[20:23],s92 offen offset:3072 sc1
dlp_100961:
s_waitcnt vmcnt(2)
v_max3_u32 v124,v28,v29,v30
v_max_u32 v124,v124,v31
v_cmp_eq_u32 vcc,-1,v124
s_cbranch_vccz dgo_100960
buffer_load_dwordx4 v[28:31],v0,s[20:23],s92 offen offset:3072 sc1
s_waitcnt vmcnt(2)
v_max3_u32 v124,v104,v105,v106
v_max_u32 v124,v124,v107
v_cmp_eq_u32 vcc,-1,v124
s_cbranch_vccz dcp_100963
buffer_load_dwordx4 v[104:107],v0,s[20:23],s92 offen offset:3072 sc1
s_waitcnt vmcnt(2)
v_max3_u32 v124,v108,v109,v110
v_max_u32 v124,v124,v111
v_cmp_eq_u32 vcc,-1,v124
s_cbranch_vccz dcp_100964
buffer_load_dwordx4 v[108:111],v0,s[20:23],s92 offen offset:3072 sc1
s_sub_u32 s90,s90,1
s_cmp_gt_i32 s90,0
s_cbranch_scc1 dlp_100961
s_branch dgo_100960
dcp_100963:
v_mov_b32 v28,v104
v_mov_b32 v29,v105
v_mov_b32 v30,v106
v_mov_b32 v31,v107
s_nop 1
s_branch dgo_100960
dcp_100964:
v_mov_b32 v28,v108
v_mov_b32 v29,v109
v_mov_b32 v30,v110
v_mov_b32 v31,v111
s_nop 1
dgo_100960:
v_smfmac_f32_16x16x64_bf16 v[48:51],v[28:31],a[192:199],v1
v_smfmac_f32_16x16x64_bf16 v[52:55],v[28:31],a[200:207],v1
v_smfmac_f32_16x16x64_bf16 v[56:59],v[28:31],a[208:215],v1
v_smfmac_f32_16x16x64_bf16 v[60:63],v[28:31],a[216:223],v1
v_smfmac_f32_16x16x64_bf16 v[64:67],v[28:31],a[224:231],v1
v_smfmac_f32_16x16x64_bf16 v[68:71],v[28:31],a[232:239],v1
v_smfmac_f32_16x16x64_bf16 v[72:75],v[28:31],a[240:247],v1
v_smfmac_f32_16x16x64_bf16 v[76:79],v[28:31],a[248:255],v1
dsk_100959:
s_mov_b32 s55,0
s_branch Ldone_100877
slowA_100813:
buffer_load_dwordx4 v[44:47],v0,s[20:23],s93 offen offset:3072 sc1
dsk_100965:
s_bitcmp1_b32 s55,7
s_cbranch_scc0 dsk_100966
s_waitcnt vmcnt(2)
v_max3_u32 v124,v44,v45,v46
v_max_u32 v124,v124,v47
v_cmp_eq_u32 vcc,-1,v124
s_cbranch_vccz dgo_100967
s_nop 15
s_nop 3
buffer_load_dwordx4 v[104:107],v0,s[20:23],s93 offen offset:3072 sc1
s_nop 15
s_nop 3
buffer_load_dwordx4 v[108:111],v0,s[20:23],s93 offen offset:3072 sc1
dlp_100968:
s_waitcnt vmcnt(2)
v_max3_u32 v124,v44,v45,v46
v_max_u32 v124,v124,v47
v_cmp_eq_u32 vcc,-1,v124
s_cbranch_vccz dgo_100967
buffer_load_dwordx4 v[44:47],v0,s[20:23],s93 offen offset:3072 sc1
s_waitcnt vmcnt(2)
v_max3_u32 v124,v104,v105,v106
v_max_u32 v124,v124,v107
v_cmp_eq_u32 vcc,-1,v124
s_cbranch_vccz dcp_100970
buffer_load_dwordx4 v[104:107],v0,s[20:23],s93 offen offset:3072 sc1
s_waitcnt vmcnt(2)
v_max3_u32 v124,v108,v109,v110
v_max_u32 v124,v124,v111
v_cmp_eq_u32 vcc,-1,v124
s_cbranch_vccz dcp_100971
buffer_load_dwordx4 v[108:111],v0,s[20:23],s93 offen offset:3072 sc1
s_sub_u32 s90,s90,1
s_cmp_gt_i32 s90,0
s_cbranch_scc1 dlp_100968
s_branch dgo_100967
dcp_100970:
v_mov_b32 v44,v104
v_mov_b32 v45,v105
v_mov_b32 v46,v106
v_mov_b32 v47,v107
s_nop 1
s_branch dgo_100967
dcp_100971:
v_mov_b32 v44,v108
v_mov_b32 v45,v109
v_mov_b32 v46,v110
v_mov_b32 v47,v111
s_nop 1
dgo_100967:
dsk_100966:
s_mov_b32 s55,0
s_branch segb_100795
srt_100820:
s_sub_u32 s90,s90,1
s_cmp_gt_i32 s90,0
s_cbranch_scc0 sok_100819
buffer_load_dwordx4 v[16:19],v2,s[20:23],s94 offen offset:0 sc1
buffer_load_dwordx4 v[32:35],v2,s[20:23],s94 offen offset:1536 sc1
buffer_load_dwordx4 v[20:23],v2,s[20:23],s95 offen offset:0 sc1
buffer_load_dwordx4 v[36:39],v2,s[20:23],s95 offen offset:1536 sc1
buffer_load_dword v120,v3,s[20:23],s94 offen offset:0 sc1
buffer_load_dword v121,v3,s[20:23],s94 offen offset:1536 sc1
buffer_load_dword v122,v3,s[20:23],s95 offen offset:0 sc1
buffer_load_dword v123,v3,s[20:23],s95 offen offset:1536 sc1
s_branch sp_100818
of_100821:
s_mov_b32 s55,3
buffer_load_dwordx4 v[16:19],v0,s[20:23],s96 offen offset:0 sc1
buffer_load_dwordx4 v[20:23],v0,s[20:23],s96 offen offset:1024 sc1
v_readfirstlane_b32 s91,v126
s_waitcnt vmcnt(6)
v_max3_u32 v124,v24,v25,v26
v_max3_u32 v124,v124,v27,v28
v_max3_u32 v124,v124,v29,v30
v_max_u32 v124,v124,v31
v_cmp_eq_u32 vcc,-1,v124
s_cbranch_vccnz ost_100973
v_smfmac_f32_16x16x64_bf16 v[96:99],v[24:27],v[80:87],v1
buffer_load_dword v120,off,s[20:23],s96 sc1
v_smfmac_f32_16x16x64_bf16 v[100:103],v[24:27],v[88:95],v1
buffer_load_dword v120,off,s[20:23],s96 sc1
v_smfmac_f32_16x16x64_bf16 v[96:99],v[28:31],v[128:135],v1
v_smfmac_f32_16x16x64_bf16 v[100:103],v[28:31],v[136:143],v1
ort_100974:
s_waitcnt vmcnt(6)
v_max3_u32 v124,v32,v33,v34
v_max3_u32 v124,v124,v35,v36
v_max3_u32 v124,v124,v37,v38
v_max_u32 v124,v124,v39
v_cmp_eq_u32 vcc,-1,v124
s_cbranch_vccnz ost_100975
v_smfmac_f32_16x16x64_bf16 v[96:99],v[32:35],v[144:151],v1
buffer_load_dword v120,off,s[20:23],s96 sc1
v_smfmac_f32_16x16x64_bf16 v[100:103],v[32:35],v[152:159],v1
buffer_load_dword v120,off,s[20:23],s96 sc1
v_smfmac_f32_16x16x64_bf16 v[96:99],v[36:39],v[160:167],v1
v_smfmac_f32_16x16x64_bf16 v[100:103],v[36:39],v[168:175],v1
ort_100976:
s_waitcnt vmcnt(7)
v_max3_u32 v124,v40,v41,v42
v_max_u32 v124,v124,v43
v_cmp_eq_u32 vcc,-1,v124
s_cbranch_vccnz ost_100977
v_smfmac_f32_16x16x64_bf16 v[96:99],v[40:43],v[176:183],v1
buffer_load_dword v120,off,s[20:23],s96 sc1
v_smfmac_f32_16x16x64_bf16 v[100:103],v[40:43],v[184:191],v1
ort_100978:
s_waitcnt vmcnt(7)
v_max3_u32 v124,v44,v45,v46
v_max_u32 v124,v124,v47
v_cmp_eq_u32 vcc,-1,v124
s_cbranch_vccnz ost_100979
v_smfmac_f32_16x16x64_bf16 v[96:99],v[44:47],v[192:199],v1
buffer_load_dword v120,off,s[20:23],s96 sc1
v_smfmac_f32_16x16x64_bf16 v[100:103],v[44:47],v[200:207],v1
ort_100980:
s_waitcnt vmcnt(6)
v_max3_u32 v124,v16,v17,v18
v_max3_u32 v124,v124,v19,v20
v_max3_u32 v124,v124,v21,v22
v_max_u32 v124,v124,v23
v_cmp_eq_u32 vcc,-1,v124
s_cbranch_vccnz olap2_100972
s_andn2_b32 s55,s55,3
v_smfmac_f32_16x16x64_bf16 v[96:99],v[16:19],v[48:55],v1
v_smfmac_f32_16x16x64_bf16 v[100:103],v[16:19],v[56:63],v1
v_smfmac_f32_16x16x64_bf16 v[96:99],v[20:23],v[64:71],v1
v_smfmac_f32_16x16x64_bf16 v[100:103],v[20:23],v[72:79],v1
s_cbranch_scc0 oback_100832
s_branch olap2_100972
ost_100973:
buffer_load_dwordx4 v[24:27],v0,s[20:23],s96 offen offset:2048 sc1
buffer_load_dwordx4 v[28:31],v0,s[20:23],s96 offen offset:3072 sc1
s_or_b32 s55,s55,12
s_branch ort_100974
ost_100975:
buffer_load_dwordx4 v[32:35],v0,s[20:23],s97 offen offset:0 sc1
buffer_load_dwordx4 v[36:39],v0,s[20:23],s97 offen offset:1024 sc1
s_or_b32 s55,s55,48
s_branch ort_100976
ost_100977:
buffer_load_dwordx4 v[40:43],v0,s[20:23],s97 offen offset:2048 sc1
s_or_b32 s55,s55,64
s_branch ort_100978
ost_100979:
buffer_load_dwordx4 v[44:47],v0,s[20:23],s97 offen offset:3072 sc1
s_or_b32 s55,s55,128
s_branch ort_100980
of_100822:
s_mov_b32 s55,12
buffer_load_dwordx4 v[24:27],v0,s[20:23],s96 offen offset:2048 sc1
buffer_load_dwordx4 v[28:31],v0,s[20:23],s96 offen offset:3072 sc1
s_waitcnt vmcnt(4)
v_max3_u32 v124,v32,v33,v34
v_max3_u32 v124,v124,v35,v36
v_max3_u32 v124,v124,v37,v38
v_max_u32 v124,v124,v39
v_cmp_eq_u32 vcc,-1,v124
s_cbranch_vccnz ost_100982
v_smfmac_f32_16x16x64_bf16 v[96:99],v[32:35],v[144:151],v1
buffer_load_dword v120,off,s[20:23],s96 sc1
v_smfmac_f32_16x16x64_bf16 v[100:103],v[32:35],v[152:159],v1
buffer_load_dword v120,off,s[20:23],s96 sc1
v_smfmac_f32_16x16x64_bf16 v[96:99],v[36:39],v[160:167],v1
v_smfmac_f32_16x16x64_bf16 v[100:103],v[36:39],v[168:175],v1
ort_100983:
s_waitcnt vmcnt(5)
v_max3_u32 v124,v40,v41,v42
v_max_u32 v124,v124,v43
v_cmp_eq_u32 vcc,-1,v124
s_cbranch_vccnz ost_100984
v_smfmac_f32_16x16x64_bf16 v[96:99],v[40:43],v[176:183],v1
buffer_load_dword v120,off,s[20:23],s96 sc1
v_smfmac_f32_16x16x64_bf16 v[100:103],v[40:43],v[184:191],v1
ort_100985:
s_waitcnt vmcnt(5)
v_max3_u32 v124,v44,v45,v46
v_max_u32 v124,v124,v47
v_cmp_eq_u32 vcc,-1,v124
s_cbranch_vccnz ost_100986
v_smfmac_f32_16x16x64_bf16 v[96:99],v[44:47],v[192:199],v1
buffer_load_dword v120,off,s[20:23],s96 sc1
v_smfmac_f32_16x16x64_bf16 v[100:103],v[44:47],v[200:207],v1
ort_100987:
s_waitcnt vmcnt(4)
v_max3_u32 v124,v24,v25,v26
v_max3_u32 v124,v124,v27,v28
v_max3_u32 v124,v124,v29,v30
v_max_u32 v124,v124,v31
v_cmp_eq_u32 vcc,-1,v124
s_cbranch_vccnz olap2_100972
s_andn2_b32 s55,s55,12
v_smfmac_f32_16x16x64_bf16 v[96:99],v[24:27],v[80:87],v1
v_smfmac_f32_16x16x64_bf16 v[100:103],v[24:27],v[88:95],v1
v_smfmac_f32_16x16x64_bf16 v[96:99],v[28:31],v[128:135],v1
v_smfmac_f32_16x16x64_bf16 v[100:103],v[28:31],v[136:143],v1
s_cbranch_scc0 oback_100832
s_branch olap2_100972
ost_100982:
buffer_load_dwordx4 v[32:35],v0,s[20:23],s97 offen offset:0 sc1
buffer_load_dwordx4 v[36:39],v0,s[20:23],s97 offen offset:1024 sc1
s_or_b32 s55,s55,48
s_branch ort_100983
ost_100984:
buffer_load_dwordx4 v[40:43],v0,s[20:23],s97 offen offset:2048 sc1
s_or_b32 s55,s55,64
s_branch ort_100985
ost_100986:
buffer_load_dwordx4 v[44:47],v0,s[20:23],s97 offen offset:3072 sc1
s_or_b32 s55,s55,128
s_branch ort_100987
of_100823:
s_mov_b32 s55,48
buffer_load_dwordx4 v[32:35],v0,s[20:23],s97 offen offset:0 sc1
buffer_load_dwordx4 v[36:39],v0,s[20:23],s97 offen offset:1024 sc1
s_waitcnt vmcnt(3)
v_max3_u32 v124,v40,v41,v42
v_max_u32 v124,v124,v43
v_cmp_eq_u32 vcc,-1,v124
s_cbranch_vccnz ost_100989
v_smfmac_f32_16x16x64_bf16 v[96:99],v[40:43],v[176:183],v1
buffer_load_dword v120,off,s[20:23],s96 sc1
v_smfmac_f32_16x16x64_bf16 v[100:103],v[40:43],v[184:191],v1
ort_100990:
s_waitcnt vmcnt(3)
v_max3_u32 v124,v44,v45,v46
v_max_u32 v124,v124,v47
v_cmp_eq_u32 vcc,-1,v124
s_cbranch_vccnz ost_100991
v_smfmac_f32_16x16x64_bf16 v[96:99],v[44:47],v[192:199],v1
buffer_load_dword v120,off,s[20:23],s96 sc1
v_smfmac_f32_16x16x64_bf16 v[100:103],v[44:47],v[200:207],v1
ort_100992:
s_waitcnt vmcnt(2)
v_max3_u32 v124,v32,v33,v34
v_max3_u32 v124,v124,v35,v36
v_max3_u32 v124,v124,v37,v38
v_max_u32 v124,v124,v39
v_cmp_eq_u32 vcc,-1,v124
s_cbranch_vccnz olap2_100972
s_andn2_b32 s55,s55,48
v_smfmac_f32_16x16x64_bf16 v[96:99],v[32:35],v[144:151],v1
v_smfmac_f32_16x16x64_bf16 v[100:103],v[32:35],v[152:159],v1
v_smfmac_f32_16x16x64_bf16 v[96:99],v[36:39],v[160:167],v1
v_smfmac_f32_16x16x64_bf16 v[100:103],v[36:39],v[168:175],v1
s_cbranch_scc0 oback_100832
s_branch olap2_100972
ost_100989:
buffer_load_dwordx4 v[40:43],v0,s[20:23],s97 offen offset:2048 sc1
s_or_b32 s55,s55,64
s_branch ort_100990
ost_100991:
buffer_load_dwordx4 v[44:47],v0,s[20:23],s97 offen offset:3072 sc1
s_or_b32 s55,s55,128
s_branch ort_100992
of_100824:
s_mov_b32 s55,64
buffer_load_dwordx4 v[40:43],v0,s[20:23],s97 offen offset:2048 sc1
s_waitcnt vmcnt(1)
v_max3_u32 v124,v44,v45,v46
v_max_u32 v124,v124,v47
v_cmp_eq_u32 vcc,-1,v124
s_cbranch_vccnz ost_100994
v_smfmac_f32_16x16x64_bf16 v[96:99],v[44:47],v[192:199],v1
buffer_load_dword v120,off,s[20:23],s96 sc1
v_smfmac_f32_16x16x64_bf16 v[100:103],v[44:47],v[200:207],v1
ort_100995:
s_waitcnt vmcnt(1)
v_max3_u32 v124,v40,v41,v42
v_max_u32 v124,v124,v43
v_cmp_eq_u32 vcc,-1,v124
s_cbranch_vccnz olap2_100972
s_andn2_b32 s55,s55,64
v_smfmac_f32_16x16x64_bf16 v[96:99],v[40:43],v[176:183],v1
v_smfmac_f32_16x16x64_bf16 v[100:103],v[40:43],v[184:191],v1
s_cbranch_scc0 oback_100832
s_branch olap2_100972
ost_100994:
buffer_load_dwordx4 v[44:47],v0,s[20:23],s97 offen offset:3072 sc1
s_or_b32 s55,s55,128
s_branch ort_100995
of_100825:
s_mov_b32 s55,128
s_branch oslow_100831
olap2_100972:
s_bitcmp1_b32 s55,0
s_cbranch_scc0 l2s_100997
s_waitcnt vmcnt(6)
v_max3_u32 v124,v16,v17,v18
v_max3_u32 v124,v124,v19,v20
v_max3_u32 v124,v124,v21,v22
v_max_u32 v124,v124,v23
v_cmp_eq_u32 vcc,-1,v124
s_cbranch_vccnz l2s_100997
s_andn2_b32 s55,s55,3
v_smfmac_f32_16x16x64_bf16 v[96:99],v[16:19],v[48:55],v1
v_smfmac_f32_16x16x64_bf16 v[100:103],v[16:19],v[56:63],v1
v_smfmac_f32_16x16x64_bf16 v[96:99],v[20:23],v[64:71],v1
v_smfmac_f32_16x16x64_bf16 v[100:103],v[20:23],v[72:79],v1
l2s_100997:
s_bitcmp1_b32 s55,2
s_cbranch_scc0 l2s_100998
s_waitcnt vmcnt(4)
v_max3_u32 v124,v24,v25,v26
v_max3_u32 v124,v124,v27,v28
v_max3_u32 v124,v124,v29,v30
v_max_u32 v124,v124,v31
v_cmp_eq_u32 vcc,-1,v124
s_cbranch_vccnz l2s_100998
s_andn2_b32 s55,s55,12
v_smfmac_f32_16x16x64_bf16 v[96:99],v[24:27],v[80:87],v1
v_smfmac_f32_16x16x64_bf16 v[100:103],v[24:27],v[88:95],v1
v_smfmac_f32_16x16x64_bf16 v[96:99],v[28:31],v[128:135],v1
v_smfmac_f32_16x16x64_bf16 v[100:103],v[28:31],v[136:143],v1
l2s_100998:
s_bitcmp1_b32 s55,4
s_cbranch_scc0 l2s_100999
s_waitcnt vmcnt(2)
v_max3_u32 v124,v32,v33,v34
v_max3_u32 v124,v124,v35,v36
v_max3_u32 v124,v124,v37,v38
v_max_u32 v124,v124,v39
v_cmp_eq_u32 vcc,-1,v124
s_cbranch_vccnz l2s_100999
s_andn2_b32 s55,s55,48
v_smfmac_f32_16x16x64_bf16 v[96:99],v[32:35],v[144:151],v1
v_smfmac_f32_16x16x64_bf16 v[100:103],v[32:35],v[152:159],v1
v_smfmac_f32_16x16x64_bf16 v[96:99],v[36:39],v[160:167],v1
v_smfmac_f32_16x16x64_bf16 v[100:103],v[36:39],v[168:175],v1
l2s_100999:
s_bitcmp1_b32 s55,6
s_cbranch_scc0 l2s_101000
s_waitcnt vmcnt(1)
v_max3_u32 v124,v40,v41,v42
v_max_u32 v124,v124,v43
v_cmp_eq_u32 vcc,-1,v124
s_cbranch_vccnz l2s_101000
s_andn2_b32 s55,s55,64
v_smfmac_f32_16x16x64_bf16 v[96:99],v[40:43],v[176:183],v1
v_smfmac_f32_16x16x64_bf16 v[100:103],v[40:43],v[184:191],v1
l2s_101000:
s_bitcmp1_b32 s55,7
s_cbranch_scc0 l2s_101001
s_waitcnt vmcnt(0)
v_max3_u32 v124,v44,v45,v46
v_max_u32 v124,v124,v47
v_cmp_eq_u32 vcc,-1,v124
s_cbranch_vccnz l2s_101001
s_andn2_b32 s55,s55,128
v_smfmac_f32_16x16x64_bf16 v[96:99],v[44:47],v[192:199],v1
v_smfmac_f32_16x16x64_bf16 v[100:103],v[44:47],v[200:207],v1
l2s_101001:
s_cmp_eq_u32 s55,0
s_cbranch_scc1 oback_100832
oslow_100831:
s_bitcmp1_b32 s55,0
s_cbranch_scc0 dsk_101002
buffer_load_dwordx4 v[16:19],v0,s[20:23],s96 offen offset:0 sc1
dsk_101002:
s_bitcmp1_b32 s55,1
s_cbranch_scc0 dsk_101003
buffer_load_dwordx4 v[20:23],v0,s[20:23],s96 offen offset:1024 sc1
dsk_101003:
s_bitcmp1_b32 s55,2
s_cbranch_scc0 dsk_101004
buffer_load_dwordx4 v[24:27],v0,s[20:23],s96 offen offset:2048 sc1
dsk_101004:
s_bitcmp1_b32 s55,3
s_cbranch_scc0 dsk_101005
buffer_load_dwordx4 v[28:31],v0,s[20:23],s96 offen offset:3072 sc1
dsk_101005:
s_bitcmp1_b32 s55,4
s_cbranch_scc0 dsk_101006
buffer_load_dwordx4 v[32:35],v0,s[20:23],s97 offen offset:0 sc1
dsk_101006:
s_bitcmp1_b32 s55,5
s_cbranch_scc0 dsk_101007
buffer_load_dwordx4 v[36:39],v0,s[20:23],s97 offen offset:1024 sc1
dsk_101007:
s_bitcmp1_b32 s55,6
s_cbranch_scc0 dsk_101008
buffer_load_dwordx4 v[40:43],v0,s[20:23],s97 offen offset:2048 sc1
dsk_101008:
s_bitcmp1_b32 s55,7
s_cbranch_scc0 dsk_101009
buffer_load_dwordx4 v[44:47],v0,s[20:23],s97 offen offset:3072 sc1
dsk_101009:
s_bitcmp1_b32 s55,0
s_cbranch_scc0 dsk_101010
s_waitcnt vmcnt(2)
v_max3_u32 v124,v16,v17,v18
v_max_u32 v124,v124,v19
v_cmp_eq_u32 vcc,-1,v124
s_cbranch_vccz dgo_101011
s_nop 15
buffer_load_dwordx4 v[116:119],v0,s[20:23],s96 offen offset:0 sc1
s_nop 15
buffer_load_dwordx4 v[120:123],v0,s[20:23],s96 offen offset:0 sc1
dlp_101012:
s_waitcnt vmcnt(2)
v_max3_u32 v124,v16,v17,v18
v_max_u32 v124,v124,v19
v_cmp_eq_u32 vcc,-1,v124
s_cbranch_vccz dgo_101011
buffer_load_dwordx4 v[16:19],v0,s[20:23],s96 offen offset:0 sc1
s_waitcnt vmcnt(2)
v_max3_u32 v124,v116,v117,v118
v_max_u32 v124,v124,v119
v_cmp_eq_u32 vcc,-1,v124
s_cbranch_vccz dcp_101014
buffer_load_dwordx4 v[116:119],v0,s[20:23],s96 offen offset:0 sc1
s_waitcnt vmcnt(2)
v_max3_u32 v124,v120,v121,v122
v_max_u32 v124,v124,v123
v_cmp_eq_u32 vcc,-1,v124
s_cbranch_vccz dcp_101015
buffer_load_dwordx4 v[120:123],v0,s[20:23],s96 offen offset:0 sc1
s_sub_u32 s90,s90,1
s_cmp_gt_i32 s90,0
s_cbranch_scc1 dlp_101012
s_branch dgo_101011
dcp_101014:
v_mov_b32 v16,v116
v_mov_b32 v17,v117
v_mov_b32 v18,v118
v_mov_b32 v19,v119
s_nop 1
s_branch dgo_101011
dcp_101015:
v_mov_b32 v16,v120
v_mov_b32 v17,v121
v_mov_b32 v18,v122
v_mov_b32 v19,v123
s_nop 1
dgo_101011:
v_smfmac_f32_16x16x64_bf16 v[96:99],v[16:19],v[48:55],v1
v_smfmac_f32_16x16x64_bf16 v[100:103],v[16:19],v[56:63],v1
dsk_101010:
s_bitcmp1_b32 s55,1
s_cbranch_scc0 dsk_101016
s_waitcnt vmcnt(2)
v_max3_u32 v124,v20,v21,v22
v_max_u32 v124,v124,v23
v_cmp_eq_u32 vcc,-1,v124
s_cbranch_vccz dgo_101017
s_nop 15
buffer_load_dwordx4 v[116:119],v0,s[20:23],s96 offen offset:1024 sc1
s_nop 15
buffer_load_dwordx4 v[120:123],v0,s[20:23],s96 offen offset:1024 sc1
dlp_101018:
s_waitcnt vmcnt(2)
v_max3_u32 v124,v20,v21,v22
v_max_u32 v124,v124,v23
v_cmp_eq_u32 vcc,-1,v124
s_cbranch_vccz dgo_101017
buffer_load_dwordx4 v[20:23],v0,s[20:23],s96 offen offset:1024 sc1
s_waitcnt vmcnt(2)
v_max3_u32 v124,v116,v117,v118
v_max_u32 v124,v124,v119
v_cmp_eq_u32 vcc,-1,v124
s_cbranch_vccz dcp_101020
buffer_load_dwordx4 v[116:119],v0,s[20:23],s96 offen offset:1024 sc1
s_waitcnt vmcnt(2)
v_max3_u32 v124,v120,v121,v122
v_max_u32 v124,v124,v123
v_cmp_eq_u32 vcc,-1,v124
s_cbranch_vccz dcp_101021
buffer_load_dwordx4 v[120:123],v0,s[20:23],s96 offen offset:1024 sc1
s_sub_u32 s90,s90,1
s_cmp_gt_i32 s90,0
s_cbranch_scc1 dlp_101018
s_branch dgo_101017
dcp_101020:
v_mov_b32 v20,v116
v_mov_b32 v21,v117
v_mov_b32 v22,v118
v_mov_b32 v23,v119
s_nop 1
s_branch dgo_101017
dcp_101021:
v_mov_b32 v20,v120
v_mov_b32 v21,v121
v_mov_b32 v22,v122
v_mov_b32 v23,v123
s_nop 1
dgo_101017:
v_smfmac_f32_16x16x64_bf16 v[96:99],v[20:23],v[64:71],v1
v_smfmac_f32_16x16x64_bf16 v[100:103],v[20:23],v[72:79],v1
dsk_101016:
s_bitcmp1_b32 s55,2
s_cbranch_scc0 dsk_101022
s_waitcnt vmcnt(2)
v_max3_u32 v124,v24,v25,v26
v_max_u32 v124,v124,v27
v_cmp_eq_u32 vcc,-1,v124
s_cbranch_vccz dgo_101023
s_nop 15
buffer_load_dwordx4 v[116:119],v0,s[20:23],s96 offen offset:2048 sc1
s_nop 15
buffer_load_dwordx4 v[120:123],v0,s[20:23],s96 offen offset:2048 sc1
dlp_101024:
s_waitcnt vmcnt(2)
v_max3_u32 v124,v24,v25,v26
v_max_u32 v124,v124,v27
v_cmp_eq_u32 vcc,-1,v124
s_cbranch_vccz dgo_101023
buffer_load_dwordx4 v[24:27],v0,s[20:23],s96 offen offset:2048 sc1
s_waitcnt vmcnt(2)
v_max3_u32 v124,v116,v117,v118
v_max_u32 v124,v124,v119
v_cmp_eq_u32 vcc,-1,v124
s_cbranch_vccz dcp_101026
buffer_load_dwordx4 v[116:119],v0,s[20:23],s96 offen offset:2048 sc1
s_waitcnt vmcnt(2)
v_max3_u32 v124,v120,v121,v122
v_max_u32 v124,v124,v123
v_cmp_eq_u32 vcc,-1,v124
s_cbranch_vccz dcp_101027
buffer_load_dwordx4 v[120:123],v0,s[20:23],s96 offen offset:2048 sc1
s_sub_u32 s90,s90,1
s_cmp_gt_i32 s90,0
s_cbranch_scc1 dlp_101024
s_branch dgo_101023
dcp_101026:
v_mov_b32 v24,v116
v_mov_b32 v25,v117
v_mov_b32 v26,v118
v_mov_b32 v27,v119
s_nop 1
s_branch dgo_101023
dcp_101027:
v_mov_b32 v24,v120
v_mov_b32 v25,v121
v_mov_b32 v26,v122
v_mov_b32 v27,v123
s_nop 1
dgo_101023:
v_smfmac_f32_16x16x64_bf16 v[96:99],v[24:27],v[80:87],v1
v_smfmac_f32_16x16x64_bf16 v[100:103],v[24:27],v[88:95],v1
dsk_101022:
s_bitcmp1_b32 s55,3
s_cbranch_scc0 dsk_101028
s_waitcnt vmcnt(2)
v_max3_u32 v124,v28,v29,v30
v_max_u32 v124,v124,v31
v_cmp_eq_u32 vcc,-1,v124
s_cbranch_vccz dgo_101029
s_nop 15
buffer_load_dwordx4 v[116:119],v0,s[20:23],s96 offen offset:3072 sc1
s_nop 15
buffer_load_dwordx4 v[120:123],v0,s[20:23],s96 offen offset:3072 sc1
dlp_101030:
s_waitcnt vmcnt(2)
v_max3_u32 v124,v28,v29,v30
v_max_u32 v124,v124,v31
v_cmp_eq_u32 vcc,-1,v124
s_cbranch_vccz dgo_101029
buffer_load_dwordx4 v[28:31],v0,s[20:23],s96 offen offset:3072 sc1
s_waitcnt vmcnt(2)
v_max3_u32 v124,v116,v117,v118
v_max_u32 v124,v124,v119
v_cmp_eq_u32 vcc,-1,v124
s_cbranch_vccz dcp_101032
buffer_load_dwordx4 v[116:119],v0,s[20:23],s96 offen offset:3072 sc1
s_waitcnt vmcnt(2)
v_max3_u32 v124,v120,v121,v122
v_max_u32 v124,v124,v123
v_cmp_eq_u32 vcc,-1,v124
s_cbranch_vccz dcp_101033
buffer_load_dwordx4 v[120:123],v0,s[20:23],s96 offen offset:3072 sc1
s_sub_u32 s90,s90,1
s_cmp_gt_i32 s90,0
s_cbranch_scc1 dlp_101030
s_branch dgo_101029
dcp_101032:
v_mov_b32 v28,v116
v_mov_b32 v29,v117
v_mov_b32 v30,v118
v_mov_b32 v31,v119
s_nop 1
s_branch dgo_101029
dcp_101033:
v_mov_b32 v28,v120
v_mov_b32 v29,v121
v_mov_b32 v30,v122
v_mov_b32 v31,v123
s_nop 1
dgo_101029:
v_smfmac_f32_16x16x64_bf16 v[96:99],v[28:31],v[128:135],v1
v_smfmac_f32_16x16x64_bf16 v[100:103],v[28:31],v[136:143],v1
dsk_101028:
s_bitcmp1_b32 s55,4
s_cbranch_scc0 dsk_101034
s_waitcnt vmcnt(2)
v_max3_u32 v124,v32,v33,v34
v_max_u32 v124,v124,v35
v_cmp_eq_u32 vcc,-1,v124
s_cbranch_vccz dgo_101035
s_nop 15
buffer_load_dwordx4 v[116:119],v0,s[20:23],s97 offen offset:0 sc1
s_nop 15
buffer_load_dwordx4 v[120:123],v0,s[20:23],s97 offen offset:0 sc1
dlp_101036:
s_waitcnt vmcnt(2)
v_max3_u32 v124,v32,v33,v34
v_max_u32 v124,v124,v35
v_cmp_eq_u32 vcc,-1,v124
s_cbranch_vccz dgo_101035
buffer_load_dwordx4 v[32:35],v0,s[20:23],s97 offen offset:0 sc1
s_waitcnt vmcnt(2)
v_max3_u32 v124,v116,v117,v118
v_max_u32 v124,v124,v119
v_cmp_eq_u32 vcc,-1,v124
s_cbranch_vccz dcp_101038
buffer_load_dwordx4 v[116:119],v0,s[20:23],s97 offen offset:0 sc1
s_waitcnt vmcnt(2)
v_max3_u32 v124,v120,v121,v122
v_max_u32 v124,v124,v123
v_cmp_eq_u32 vcc,-1,v124
s_cbranch_vccz dcp_101039
buffer_load_dwordx4 v[120:123],v0,s[20:23],s97 offen offset:0 sc1
s_sub_u32 s90,s90,1
s_cmp_gt_i32 s90,0
s_cbranch_scc1 dlp_101036
s_branch dgo_101035
dcp_101038:
v_mov_b32 v32,v116
v_mov_b32 v33,v117
v_mov_b32 v34,v118
v_mov_b32 v35,v119
s_nop 1
s_branch dgo_101035
dcp_101039:
v_mov_b32 v32,v120
v_mov_b32 v33,v121
v_mov_b32 v34,v122
v_mov_b32 v35,v123
s_nop 1
dgo_101035:
v_smfmac_f32_16x16x64_bf16 v[96:99],v[32:35],v[144:151],v1
v_smfmac_f32_16x16x64_bf16 v[100:103],v[32:35],v[152:159],v1
dsk_101034:
s_bitcmp1_b32 s55,5
s_cbranch_scc0 dsk_101040
s_waitcnt vmcnt(2)
v_max3_u32 v124,v36,v37,v38
v_max_u32 v124,v124,v39
v_cmp_eq_u32 vcc,-1,v124
s_cbranch_vccz dgo_101041
s_nop 15
buffer_load_dwordx4 v[116:119],v0,s[20:23],s97 offen offset:1024 sc1
s_nop 15
buffer_load_dwordx4 v[120:123],v0,s[20:23],s97 offen offset:1024 sc1
dlp_101042:
s_waitcnt vmcnt(2)
v_max3_u32 v124,v36,v37,v38
v_max_u32 v124,v124,v39
v_cmp_eq_u32 vcc,-1,v124
s_cbranch_vccz dgo_101041
buffer_load_dwordx4 v[36:39],v0,s[20:23],s97 offen offset:1024 sc1
s_waitcnt vmcnt(2)
v_max3_u32 v124,v116,v117,v118
v_max_u32 v124,v124,v119
v_cmp_eq_u32 vcc,-1,v124
s_cbranch_vccz dcp_101044
buffer_load_dwordx4 v[116:119],v0,s[20:23],s97 offen offset:1024 sc1
s_waitcnt vmcnt(2)
v_max3_u32 v124,v120,v121,v122
v_max_u32 v124,v124,v123
v_cmp_eq_u32 vcc,-1,v124
s_cbranch_vccz dcp_101045
buffer_load_dwordx4 v[120:123],v0,s[20:23],s97 offen offset:1024 sc1
s_sub_u32 s90,s90,1
s_cmp_gt_i32 s90,0
s_cbranch_scc1 dlp_101042
s_branch dgo_101041
dcp_101044:
v_mov_b32 v36,v116
v_mov_b32 v37,v117
v_mov_b32 v38,v118
v_mov_b32 v39,v119
s_nop 1
s_branch dgo_101041
dcp_101045:
v_mov_b32 v36,v120
v_mov_b32 v37,v121
v_mov_b32 v38,v122
v_mov_b32 v39,v123
s_nop 1
dgo_101041:
v_smfmac_f32_16x16x64_bf16 v[96:99],v[36:39],v[160:167],v1
v_smfmac_f32_16x16x64_bf16 v[100:103],v[36:39],v[168:175],v1
dsk_101040:
s_bitcmp1_b32 s55,6
s_cbranch_scc0 dsk_101046
s_waitcnt vmcnt(2)
v_max3_u32 v124,v40,v41,v42
v_max_u32 v124,v124,v43
v_cmp_eq_u32 vcc,-1,v124
s_cbranch_vccz dgo_101047
s_nop 15
buffer_load_dwordx4 v[116:119],v0,s[20:23],s97 offen offset:2048 sc1
s_nop 15
buffer_load_dwordx4 v[120:123],v0,s[20:23],s97 offen offset:2048 sc1
dlp_101048:
s_waitcnt vmcnt(2)
v_max3_u32 v124,v40,v41,v42
v_max_u32 v124,v124,v43
v_cmp_eq_u32 vcc,-1,v124
s_cbranch_vccz dgo_101047
buffer_load_dwordx4 v[40:43],v0,s[20:23],s97 offen offset:2048 sc1
s_waitcnt vmcnt(2)
v_max3_u32 v124,v116,v117,v118
v_max_u32 v124,v124,v119
v_cmp_eq_u32 vcc,-1,v124
s_cbranch_vccz dcp_101050
buffer_load_dwordx4 v[116:119],v0,s[20:23],s97 offen offset:2048 sc1
s_waitcnt vmcnt(2)
v_max3_u32 v124,v120,v121,v122
v_max_u32 v124,v124,v123
v_cmp_eq_u32 vcc,-1,v124
s_cbranch_vccz dcp_101051
buffer_load_dwordx4 v[120:123],v0,s[20:23],s97 offen offset:2048 sc1
s_sub_u32 s90,s90,1
s_cmp_gt_i32 s90,0
s_cbranch_scc1 dlp_101048
s_branch dgo_101047
dcp_101050:
v_mov_b32 v40,v116
v_mov_b32 v41,v117
v_mov_b32 v42,v118
v_mov_b32 v43,v119
s_nop 1
s_branch dgo_101047
dcp_101051:
v_mov_b32 v40,v120
v_mov_b32 v41,v121
v_mov_b32 v42,v122
v_mov_b32 v43,v123
s_nop 1
dgo_101047:
v_smfmac_f32_16x16x64_bf16 v[96:99],v[40:43],v[176:183],v1
v_smfmac_f32_16x16x64_bf16 v[100:103],v[40:43],v[184:191],v1
dsk_101046:
s_bitcmp1_b32 s55,7
s_cbranch_scc0 dsk_101052
s_waitcnt vmcnt(2)
v_max3_u32 v124,v44,v45,v46
v_max_u32 v124,v124,v47
v_cmp_eq_u32 vcc,-1,v124
s_cbranch_vccz dgo_101053
s_nop 15
buffer_load_dwordx4 v[116:119],v0,s[20:23],s97 offen offset:3072 sc1
s_nop 15
buffer_load_dwordx4 v[120:123],v0,s[20:23],s97 offen offset:3072 sc1
dlp_101054:
s_waitcnt vmcnt(2)
v_max3_u32 v124,v44,v45,v46
v_max_u32 v124,v124,v47
v_cmp_eq_u32 vcc,-1,v124
s_cbranch_vccz dgo_101053
buffer_load_dwordx4 v[44:47],v0,s[20:23],s97 offen offset:3072 sc1
s_waitcnt vmcnt(2)
v_max3_u32 v124,v116,v117,v118
v_max_u32 v124,v124,v119
v_cmp_eq_u32 vcc,-1,v124
s_cbranch_vccz dcp_101056
buffer_load_dwordx4 v[116:119],v0,s[20:23],s97 offen offset:3072 sc1
s_waitcnt vmcnt(2)
v_max3_u32 v124,v120,v121,v122
v_max_u32 v124,v124,v123
v_cmp_eq_u32 vcc,-1,v124
s_cbranch_vccz dcp_101057
buffer_load_dwordx4 v[120:123],v0,s[20:23],s97 offen offset:3072 sc1
s_sub_u32 s90,s90,1
s_cmp_gt_i32 s90,0
s_cbranch_scc1 dlp_101054
s_branch dgo_101053
dcp_101056:
v_mov_b32 v44,v116
v_mov_b32 v45,v117
v_mov_b32 v46,v118
v_mov_b32 v47,v119
s_nop 1
s_branch dgo_101053
dcp_101057:
v_mov_b32 v44,v120
v_mov_b32 v45,v121
v_mov_b32 v46,v122
v_mov_b32 v47,v123
s_nop 1
dgo_101053:
v_smfmac_f32_16x16x64_bf16 v[96:99],v[44:47],v[192:199],v1
v_smfmac_f32_16x16x64_bf16 v[100:103],v[44:47],v[200:207],v1
dsk_101052:
s_mov_b32 s55,0
s_branch oback_100832
fl_100849:
flb_100857:
buffer_load_dwordx4 v[16:19],v0,s[20:23],s92 offen offset:0 sc1
s_mov_b32 s55,1
buffer_load_dwordx4 v[32:35],v0,s[20:23],s93 offen offset:0 sc1
s_waitcnt vmcnt(4)
v_max3_u32 v124,v20,v21,v22
v_max_u32 v124,v124,v23
v_cmp_eq_u32 vcc,-1,v124
s_cbranch_vccnz dfl_101058
v_smfmac_f32_16x16x64_bf16 v[64:67],v[20:23],a[96:103],v1
buffer_load_dword v125,off,s[20:23],s92 sc1
buffer_load_dwordx4 v[36:39],v0,s[20:23],s93 offen offset:1024 sc1
s_waitcnt vmcnt(5)
v_max3_u32 v124,v24,v25,v26
v_smfmac_f32_16x16x64_bf16 v[68:71],v[20:23],a[104:111],v1
v_max_u32 v124,v124,v27
v_cmp_eq_u32 vcc,-1,v124
v_smfmac_f32_16x16x64_bf16 v[72:75],v[20:23],a[112:119],v1
v_smfmac_f32_16x16x64_bf16 v[76:79],v[20:23],a[120:127],v1
s_cbranch_vccnz dfl_101059
v_smfmac_f32_16x16x64_bf16 v[64:67],v[24:27],a[160:167],v1
buffer_load_dword v125,off,s[20:23],s92 sc1
buffer_load_dwordx4 v[40:43],v0,s[20:23],s93 offen offset:2048 sc1
buffer_load_dwordx4 v[44:47],v0,s[20:23],s93 offen offset:3072 sc1
s_waitcnt vmcnt(7)
v_max3_u32 v124,v28,v29,v30
v_smfmac_f32_16x16x64_bf16 v[68:71],v[24:27],a[168:175],v1
v_max_u32 v124,v124,v31
v_cmp_eq_u32 vcc,-1,v124
v_smfmac_f32_16x16x64_bf16 v[72:75],v[24:27],a[176:183],v1
v_smfmac_f32_16x16x64_bf16 v[76:79],v[24:27],a[184:191],v1
s_cbranch_vccnz dfl_101060
v_smfmac_f32_16x16x64_bf16 v[64:67],v[28:31],a[224:231],v1
buffer_load_dword v125,off,s[20:23],s92 sc1
s_waitcnt vmcnt(7)
v_max3_u32 v124,v16,v17,v18
v_smfmac_f32_16x16x64_bf16 v[68:71],v[28:31],a[232:239],v1
v_max_u32 v124,v124,v19
v_cmp_eq_u32 vcc,-1,v124
v_smfmac_f32_16x16x64_bf16 v[72:75],v[28:31],a[240:247],v1
v_smfmac_f32_16x16x64_bf16 v[76:79],v[28:31],a[248:255],v1
s_cbranch_vccnz lfb_101065
s_mov_b32 s55,0
v_smfmac_f32_16x16x64_bf16 v[64:67],v[16:19],a[32:39],v1
s_waitcnt vmcnt(6)
v_max3_u32 v124,v32,v33,v34
v_max_u32 v124,v124,v35
v_cmp_eq_u32 vcc,-1,v124
v_smfmac_f32_16x16x64_bf16 v[68:71],v[16:19],a[40:47],v1
v_smfmac_f32_16x16x64_bf16 v[72:75],v[16:19],a[48:55],v1
v_smfmac_f32_16x16x64_bf16 v[76:79],v[16:19],a[56:63],v1
s_cbranch_vccnz flb_100861
s_branch segb_100845
fl_100850:
flb_100858:
buffer_load_dwordx4 v[20:23],v0,s[20:23],s92 offen offset:1024 sc1
s_mov_b32 s55,2
buffer_load_dwordx4 v[36:39],v0,s[20:23],s93 offen offset:1024 sc1
s_waitcnt vmcnt(5)
v_max3_u32 v124,v24,v25,v26
v_max_u32 v124,v124,v27
v_cmp_eq_u32 vcc,-1,v124
s_cbranch_vccnz dfl_101059
v_smfmac_f32_16x16x64_bf16 v[64:67],v[24:27],a[160:167],v1
buffer_load_dword v125,off,s[20:23],s92 sc1
buffer_load_dwordx4 v[40:43],v0,s[20:23],s93 offen offset:2048 sc1
buffer_load_dwordx4 v[44:47],v0,s[20:23],s93 offen offset:3072 sc1
s_waitcnt vmcnt(7)
v_max3_u32 v124,v28,v29,v30
v_smfmac_f32_16x16x64_bf16 v[68:71],v[24:27],a[168:175],v1
v_max_u32 v124,v124,v31
v_cmp_eq_u32 vcc,-1,v124
v_smfmac_f32_16x16x64_bf16 v[72:75],v[24:27],a[176:183],v1
v_smfmac_f32_16x16x64_bf16 v[76:79],v[24:27],a[184:191],v1
s_cbranch_vccnz dfl_101060
v_smfmac_f32_16x16x64_bf16 v[64:67],v[28:31],a[224:231],v1
buffer_load_dword v125,off,s[20:23],s92 sc1
s_waitcnt vmcnt(5)
v_max3_u32 v124,v20,v21,v22
v_smfmac_f32_16x16x64_bf16 v[68:71],v[28:31],a[232:239],v1
v_max_u32 v124,v124,v23
v_cmp_eq_u32 vcc,-1,v124
v_smfmac_f32_16x16x64_bf16 v[72:75],v[28:31],a[240:247],v1
v_smfmac_f32_16x16x64_bf16 v[76:79],v[28:31],a[248:255],v1
s_cbranch_vccnz lfb_101065
s_mov_b32 s55,0
v_smfmac_f32_16x16x64_bf16 v[64:67],v[20:23],a[96:103],v1
s_waitcnt vmcnt(6)
v_max3_u32 v124,v32,v33,v34
v_max_u32 v124,v124,v35
v_cmp_eq_u32 vcc,-1,v124
v_smfmac_f32_16x16x64_bf16 v[68:71],v[20:23],a[104:111],v1
v_smfmac_f32_16x16x64_bf16 v[72:75],v[20:23],a[112:119],v1
v_smfmac_f32_16x16x64_bf16 v[76:79],v[20:23],a[120:127],v1
s_cbranch_vccnz flb_100861
s_branch segb_100845
fl_100851:
flb_100859:
buffer_load_dwordx4 v[24:27],v0,s[20:23],s92 offen offset:2048 sc1
s_mov_b32 s55,4
buffer_load_dwordx4 v[40:43],v0,s[20:23],s93 offen offset:2048 sc1
buffer_load_dwordx4 v[44:47],v0,s[20:23],s93 offen offset:3072 sc1
s_waitcnt vmcnt(7)
v_max3_u32 v124,v28,v29,v30
v_max_u32 v124,v124,v31
v_cmp_eq_u32 vcc,-1,v124
s_cbranch_vccnz dfl_101060
v_smfmac_f32_16x16x64_bf16 v[64:67],v[28:31],a[224:231],v1
buffer_load_dword v125,off,s[20:23],s92 sc1
s_waitcnt vmcnt(3)
v_max3_u32 v124,v24,v25,v26
v_smfmac_f32_16x16x64_bf16 v[68:71],v[28:31],a[232:239],v1
v_max_u32 v124,v124,v27
v_cmp_eq_u32 vcc,-1,v124
v_smfmac_f32_16x16x64_bf16 v[72:75],v[28:31],a[240:247],v1
v_smfmac_f32_16x16x64_bf16 v[76:79],v[28:31],a[248:255],v1
s_cbranch_vccnz lfb_101065
s_mov_b32 s55,0
v_smfmac_f32_16x16x64_bf16 v[64:67],v[24:27],a[160:167],v1
s_waitcnt vmcnt(6)
v_max3_u32 v124,v32,v33,v34
v_max_u32 v124,v124,v35
v_cmp_eq_u32 vcc,-1,v124
v_smfmac_f32_16x16x64_bf16 v[68:71],v[24:27],a[168:175],v1
v_smfmac_f32_16x16x64_bf16 v[72:75],v[24:27],a[176:183],v1
v_smfmac_f32_16x16x64_bf16 v[76:79],v[24:27],a[184:191],v1
s_cbranch_vccnz flb_100861
s_branch segb_100845
fl_100852:
flb_100860:
buffer_load_dwordx4 v[28:31],v0,s[20:23],s92 offen offset:3072 sc1
s_mov_b32 s55,8
s_waitcnt vmcnt(0)
v_max3_u32 v124,v28,v29,v30
v_max_u32 v124,v124,v31
v_cmp_eq_u32 vcc,-1,v124
s_cbranch_vccnz lfb_101065
s_mov_b32 s55,0
v_smfmac_f32_16x16x64_bf16 v[64:67],v[28:31],a[224:231],v1
s_waitcnt vmcnt(6)
v_max3_u32 v124,v32,v33,v34
v_max_u32 v124,v124,v35
v_cmp_eq_u32 vcc,-1,v124
v_smfmac_f32_16x16x64_bf16 v[68:71],v[28:31],a[232:239],v1
v_smfmac_f32_16x16x64_bf16 v[72:75],v[28:31],a[240:247],v1
v_smfmac_f32_16x16x64_bf16 v[76:79],v[28:31],a[248:255],v1
s_cbranch_vccnz flb_100861
s_branch segb_100845
fl_100853:
flb_100861:
buffer_load_dwordx4 v[32:35],v0,s[20:23],s93 offen offset:0 sc1
s_mov_b32 s55,240
buffer_store_dwordx4 v[112:115],v120,s[20:23],s101 offen sc1
buffer_store_dword v126,v121,s[20:23],s69 offen sc1
s_bitcmp1_b32 s55,5
s_cbranch_scc0 rdn_101068
s_waitcnt vmcnt(7)
v_max3_u32 v124,v36,v37,v38
v_max_u32 v124,v124,v39
v_cmp_eq_u32 vcc,-1,v124
s_cbranch_vccnz rfa_101069
buffer_load_dword v125,off,s[20:23],s92 sc1
s_bitset0_b32 s55,5
v_smfmac_f32_16x16x64_bf16 v[64:67],v[36:39],a[96:103],v1
v_smfmac_f32_16x16x64_bf16 v[68:71],v[36:39],a[104:111],v1
v_smfmac_f32_16x16x64_bf16 v[72:75],v[36:39],a[112:119],v1
v_smfmac_f32_16x16x64_bf16 v[76:79],v[36:39],a[120:127],v1
s_cmp_eq_u32 s55,0
s_cbranch_scc1 segb_100847
s_branch rnx_101070
rdn_101068:
buffer_load_dword v125,off,s[20:23],s92 sc1
s_branch rnx_101070
rfa_101069:
buffer_load_dwordx4 v[36:39],v0,s[20:23],s93 offen offset:1024 sc1
rnx_101070:
s_bitcmp1_b32 s55,6
s_cbranch_scc0 rdn_101071
s_waitcnt vmcnt(6)
v_max3_u32 v124,v40,v41,v42
v_max_u32 v124,v124,v43
v_cmp_eq_u32 vcc,-1,v124
s_cbranch_vccnz rfa_101072
buffer_load_dword v125,off,s[20:23],s92 sc1
s_bitset0_b32 s55,6
s_cmp_eq_u32 s55,0
s_cbranch_scc1 segb_100847
s_branch rnx_101073
rdn_101071:
buffer_load_dword v125,off,s[20:23],s92 sc1
s_branch rnx_101073
rfa_101072:
buffer_load_dwordx4 v[40:43],v0,s[20:23],s93 offen offset:2048 sc1
rnx_101073:
s_bitcmp1_b32 s55,7
s_cbranch_scc0 rdn_101074
s_waitcnt vmcnt(6)
v_max3_u32 v124,v44,v45,v46
v_max_u32 v124,v124,v47
v_cmp_eq_u32 vcc,-1,v124
s_cbranch_vccnz rfa_101075
buffer_load_dword v125,off,s[20:23],s92 sc1
s_bitset0_b32 s55,7
s_cmp_eq_u32 s55,0
s_cbranch_scc1 segb_100847
s_branch rnx_101076
rdn_101074:
buffer_load_dword v125,off,s[20:23],s92 sc1
s_branch rnx_101076
rfa_101075:
buffer_load_dwordx4 v[44:47],v0,s[20:23],s93 offen offset:3072 sc1
rnx_101076:
rot_101067:
s_bitcmp1_b32 s55,4
s_cbranch_scc0 rdn_101077
s_waitcnt vmcnt(3)
v_max3_u32 v124,v32,v33,v34
v_max_u32 v124,v124,v35
v_cmp_eq_u32 vcc,-1,v124
s_cbranch_vccnz rfa_101078
buffer_load_dword v125,off,s[20:23],s92 sc1
s_bitset0_b32 s55,4
v_smfmac_f32_16x16x64_bf16 v[64:67],v[32:35],a[32:39],v1
v_smfmac_f32_16x16x64_bf16 v[68:71],v[32:35],a[40:47],v1
v_smfmac_f32_16x16x64_bf16 v[72:75],v[32:35],a[48:55],v1
v_smfmac_f32_16x16x64_bf16 v[76:79],v[32:35],a[56:63],v1
s_cmp_eq_u32 s55,0
s_cbranch_scc1 segb_100847
s_branch rnx_101079
rdn_101077:
buffer_load_dword v125,off,s[20:23],s92 sc1
s_branch rnx_101079
rfa_101078:
buffer_load_dwordx4 v[32:35],v0,s[20:23],s93 offen offset:0 sc1
rnx_101079:
s_bitcmp1_b32 s55,5
s_cbranch_scc0 rdn_101080
s_waitcnt vmcnt(3)
v_max3_u32 v124,v36,v37,v38
v_max_u32 v124,v124,v39
v_cmp_eq_u32 vcc,-1,v124
s_cbranch_vccnz rfa_101081
buffer_load_dword v125,off,s[20:23],s92 sc1
s_bitset0_b32 s55,5
v_smfmac_f32_16x16x64_bf16 v[64:67],v[36:39],a[96:103],v1
v_smfmac_f32_16x16x64_bf16 v[68:71],v[36:39],a[104:111],v1
v_smfmac_f32_16x16x64_bf16 v[72:75],v[36:39],a[112:119],v1
v_smfmac_f32_16x16x64_bf16 v[76:79],v[36:39],a[120:127],v1
s_cmp_eq_u32 s55,0
s_cbranch_scc1 segb_100847
s_branch rnx_101082
rdn_101080:
buffer_load_dword v125,off,s[20:23],s92 sc1
s_branch rnx_101082
rfa_101081:
buffer_load_dwordx4 v[36:39],v0,s[20:23],s93 offen offset:1024 sc1
rnx_101082:
s_bitcmp1_b32 s55,6
s_cbranch_scc0 rdn_101083
s_waitcnt vmcnt(3)
v_max3_u32 v124,v40,v41,v42
v_max_u32 v124,v124,v43
v_cmp_eq_u32 vcc,-1,v124
s_cbranch_vccnz rfa_101084
buffer_load_dword v125,off,s[20:23],s92 sc1
s_bitset0_b32 s55,6
s_cmp_eq_u32 s55,0
s_cbranch_scc1 segb_100847
s_branch rnx_101085
rdn_101083:
buffer_load_dword v125,off,s[20:23],s92 sc1
s_branch rnx_101085
rfa_101084:
buffer_load_dwordx4 v[40:43],v0,s[20:23],s93 offen offset:2048 sc1
rnx_101085:
s_bitcmp1_b32 s55,7
s_cbranch_scc0 rdn_101086
s_waitcnt vmcnt(3)
v_max3_u32 v124,v44,v45,v46
v_max_u32 v124,v124,v47
v_cmp_eq_u32 vcc,-1,v124
s_cbranch_vccnz rfa_101087
buffer_load_dword v125,off,s[20:23],s92 sc1
s_bitset0_b32 s55,7
s_cmp_eq_u32 s55,0
s_cbranch_scc1 segb_100847
s_branch rnx_101088
rdn_101086:
buffer_load_dword v125,off,s[20:23],s92 sc1
s_branch rnx_101088
rfa_101087:
buffer_load_dwordx4 v[44:47],v0,s[20:23],s93 offen offset:3072 sc1
rnx_101088:
s_sub_u32 s90,s90,1
s_cmp_gt_i32 s90,0
s_cbranch_scc1 rot_101067
s_mov_b32 s55,0
s_branch segb_100847
fl_100854:
flb_100862:
buffer_load_dwordx4 v[36:39],v0,s[20:23],s93 offen offset:1024 sc1
s_mov_b32 s55,224
s_bitcmp1_b32 s55,6
s_cbranch_scc0 rdn_101090
s_waitcnt vmcnt(6)
v_max3_u32 v124,v40,v41,v42
v_max_u32 v124,v124,v43
v_cmp_eq_u32 vcc,-1,v124
s_cbranch_vccnz rfa_101091
buffer_load_dword v125,off,s[20:23],s92 sc1
s_bitset0_b32 s55,6
s_cmp_eq_u32 s55,0
s_cbranch_scc1 segb_100847
s_branch rnx_101092
rdn_101090:
buffer_load_dword v125,off,s[20:23],s92 sc1
s_branch rnx_101092
rfa_101091:
buffer_load_dwordx4 v[40:43],v0,s[20:23],s93 offen offset:2048 sc1
rnx_101092:
s_bitcmp1_b32 s55,7
s_cbranch_scc0 rdn_101093
s_waitcnt vmcnt(6)
v_max3_u32 v124,v44,v45,v46
v_max_u32 v124,v124,v47
v_cmp_eq_u32 vcc,-1,v124
s_cbranch_vccnz rfa_101094
buffer_load_dword v125,off,s[20:23],s92 sc1
s_bitset0_b32 s55,7
s_cmp_eq_u32 s55,0
s_cbranch_scc1 segb_100847
s_branch rnx_101095
rdn_101093:
buffer_load_dword v125,off,s[20:23],s92 sc1
s_branch rnx_101095
rfa_101094:
buffer_load_dwordx4 v[44:47],v0,s[20:23],s93 offen offset:3072 sc1
rnx_101095:
rot_101089:
s_bitcmp1_b32 s55,5
s_cbranch_scc0 rdn_101096
s_waitcnt vmcnt(2)
v_max3_u32 v124,v36,v37,v38
v_max_u32 v124,v124,v39
v_cmp_eq_u32 vcc,-1,v124
s_cbranch_vccnz rfa_101097
buffer_load_dword v125,off,s[20:23],s92 sc1
s_bitset0_b32 s55,5
v_smfmac_f32_16x16x64_bf16 v[64:67],v[36:39],a[96:103],v1
v_smfmac_f32_16x16x64_bf16 v[68:71],v[36:39],a[104:111],v1
v_smfmac_f32_16x16x64_bf16 v[72:75],v[36:39],a[112:119],v1
v_smfmac_f32_16x16x64_bf16 v[76:79],v[36:39],a[120:127],v1
s_cmp_eq_u32 s55,0
s_cbranch_scc1 segb_100847
s_branch rnx_101098
rdn_101096:
buffer_load_dword v125,off,s[20:23],s92 sc1
s_branch rnx_101098
rfa_101097:
buffer_load_dwordx4 v[36:39],v0,s[20:23],s93 offen offset:1024 sc1
rnx_101098:
s_bitcmp1_b32 s55,6
s_cbranch_scc0 rdn_101099
s_waitcnt vmcnt(2)
v_max3_u32 v124,v40,v41,v42
v_max_u32 v124,v124,v43
v_cmp_eq_u32 vcc,-1,v124
s_cbranch_vccnz rfa_101100
buffer_load_dword v125,off,s[20:23],s92 sc1
s_bitset0_b32 s55,6
s_cmp_eq_u32 s55,0
s_cbranch_scc1 segb_100847
s_branch rnx_101101
rdn_101099:
buffer_load_dword v125,off,s[20:23],s92 sc1
s_branch rnx_101101
rfa_101100:
buffer_load_dwordx4 v[40:43],v0,s[20:23],s93 offen offset:2048 sc1
rnx_101101:
s_bitcmp1_b32 s55,7
s_cbranch_scc0 rdn_101102
s_waitcnt vmcnt(2)
v_max3_u32 v124,v44,v45,v46
v_max_u32 v124,v124,v47
v_cmp_eq_u32 vcc,-1,v124
s_cbranch_vccnz rfa_101103
buffer_load_dword v125,off,s[20:23],s92 sc1
s_bitset0_b32 s55,7
s_cmp_eq_u32 s55,0
s_cbranch_scc1 segb_100847
s_branch rnx_101104
rdn_101102:
buffer_load_dword v125,off,s[20:23],s92 sc1
s_branch rnx_101104
rfa_101103:
buffer_load_dwordx4 v[44:47],v0,s[20:23],s93 offen offset:3072 sc1
rnx_101104:
s_sub_u32 s90,s90,1
s_cmp_gt_i32 s90,0
s_cbranch_scc1 rot_101089
s_mov_b32 s55,0
s_branch segb_100847
fl_100855:
flb_100863:
s_mov_b32 s55,192
s_bitcmp1_b32 s55,6
s_cbranch_scc0 rdn_101106
s_waitcnt vmcnt(6)
v_max3_u32 v124,v40,v41,v42
v_max_u32 v124,v124,v43
v_cmp_eq_u32 vcc,-1,v124
s_cbranch_vccnz rfa_101107
buffer_load_dword v125,off,s[20:23],s92 sc1
s_bitset0_b32 s55,6
s_cmp_eq_u32 s55,0
s_cbranch_scc1 segb_100847
s_branch rnx_101108
rdn_101106:
buffer_load_dword v125,off,s[20:23],s92 sc1
s_branch rnx_101108
rfa_101107:
buffer_load_dwordx4 v[40:43],v0,s[20:23],s93 offen offset:2048 sc1
rnx_101108:
s_bitcmp1_b32 s55,7
s_cbranch_scc0 rdn_101109
s_waitcnt vmcnt(6)
v_max3_u32 v124,v44,v45,v46
v_max_u32 v124,v124,v47
v_cmp_eq_u32 vcc,-1,v124
s_cbranch_vccnz rfa_101110
buffer_load_dword v125,off,s[20:23],s92 sc1
s_bitset0_b32 s55,7
s_cmp_eq_u32 s55,0
s_cbranch_scc1 segb_100847
s_branch rnx_101111
rdn_101109:
buffer_load_dword v125,off,s[20:23],s92 sc1
s_branch rnx_101111
rfa_101110:
buffer_load_dwordx4 v[44:47],v0,s[20:23],s93 offen offset:3072 sc1
rnx_101111:
rot_101105:
s_bitcmp1_b32 s55,6
s_cbranch_scc0 rdn_101112
s_waitcnt vmcnt(1)
v_max3_u32 v124,v40,v41,v42
v_max_u32 v124,v124,v43
v_cmp_eq_u32 vcc,-1,v124
s_cbranch_vccnz rfa_101113
buffer_load_dword v125,off,s[20:23],s92 sc1
s_bitset0_b32 s55,6
s_cmp_eq_u32 s55,0
s_cbranch_scc1 segb_100847
s_branch rnx_101114
rdn_101112:
buffer_load_dword v125,off,s[20:23],s92 sc1
s_branch rnx_101114
rfa_101113:
buffer_load_dwordx4 v[40:43],v0,s[20:23],s93 offen offset:2048 sc1
rnx_101114:
s_bitcmp1_b32 s55,7
s_cbranch_scc0 rdn_101115
s_waitcnt vmcnt(1)
v_max3_u32 v124,v44,v45,v46
v_max_u32 v124,v124,v47
v_cmp_eq_u32 vcc,-1,v124
s_cbranch_vccnz rfa_101116
buffer_load_dword v125,off,s[20:23],s92 sc1
s_bitset0_b32 s55,7
s_cmp_eq_u32 s55,0
s_cbranch_scc1 segb_100847
s_branch rnx_101117
rdn_101115:
buffer_load_dword v125,off,s[20:23],s92 sc1
s_branch rnx_101117
rfa_101116:
buffer_load_dwordx4 v[44:47],v0,s[20:23],s93 offen offset:3072 sc1
rnx_101117:
s_sub_u32 s90,s90,1
s_cmp_gt_i32 s90,0
s_cbranch_scc1 rot_101105
s_mov_b32 s55,0
s_branch segb_100847
dfl_101058:
buffer_load_dwordx4 v[20:23],v0,s[20:23],s92 offen offset:1024 sc1
s_bitset1_b32 s55,1
buffer_load_dwordx4 v[36:39],v0,s[20:23],s93 offen offset:1024 sc1
s_waitcnt vmcnt(5)
v_max3_u32 v124,v24,v25,v26
v_max_u32 v124,v124,v27
v_cmp_eq_u32 vcc,-1,v124
s_cbranch_vccnz dfl_101059
s_branch dseg_101062
dfl_101059:
buffer_load_dwordx4 v[24:27],v0,s[20:23],s92 offen offset:2048 sc1
s_bitset1_b32 s55,2
buffer_load_dwordx4 v[40:43],v0,s[20:23],s93 offen offset:2048 sc1
buffer_load_dwordx4 v[44:47],v0,s[20:23],s93 offen offset:3072 sc1
s_waitcnt vmcnt(7)
v_max3_u32 v124,v28,v29,v30
v_max_u32 v124,v124,v31
v_cmp_eq_u32 vcc,-1,v124
s_cbranch_vccnz dfl_101060
s_branch dseg_101063
dfl_101060:
buffer_load_dwordx4 v[28:31],v0,s[20:23],s92 offen offset:3072 sc1
s_bitset1_b32 s55,3
s_branch lap2_101064
dseg_101062:
v_smfmac_f32_16x16x64_bf16 v[64:67],v[24:27],a[160:167],v1
buffer_load_dword v125,off,s[20:23],s92 sc1
buffer_load_dwordx4 v[40:43],v0,s[20:23],s93 offen offset:2048 sc1
buffer_load_dwordx4 v[44:47],v0,s[20:23],s93 offen offset:3072 sc1
s_waitcnt vmcnt(7)
v_max3_u32 v124,v28,v29,v30
v_smfmac_f32_16x16x64_bf16 v[68:71],v[24:27],a[168:175],v1
v_max_u32 v124,v124,v31
v_cmp_eq_u32 vcc,-1,v124
v_smfmac_f32_16x16x64_bf16 v[72:75],v[24:27],a[176:183],v1
v_smfmac_f32_16x16x64_bf16 v[76:79],v[24:27],a[184:191],v1
s_cbranch_vccnz dfl_101060
dseg_101063:
v_smfmac_f32_16x16x64_bf16 v[64:67],v[28:31],a[224:231],v1
buffer_load_dword v125,off,s[20:23],s92 sc1
v_smfmac_f32_16x16x64_bf16 v[68:71],v[28:31],a[232:239],v1
v_smfmac_f32_16x16x64_bf16 v[72:75],v[28:31],a[240:247],v1
v_smfmac_f32_16x16x64_bf16 v[76:79],v[28:31],a[248:255],v1
lap2_101064:
s_bitcmp1_b32 s55,0
s_cbranch_scc0 l2s_101118
s_waitcnt vmcnt(7)
v_max3_u32 v124,v16,v17,v18
v_max_u32 v124,v124,v19
v_cmp_eq_u32 vcc,-1,v124
s_cbranch_vccnz l2s_101118
s_bitset0_b32 s55,0
v_smfmac_f32_16x16x64_bf16 v[64:67],v[16:19],a[32:39],v1
v_smfmac_f32_16x16x64_bf16 v[68:71],v[16:19],a[40:47],v1
v_smfmac_f32_16x16x64_bf16 v[72:75],v[16:19],a[48:55],v1
v_smfmac_f32_16x16x64_bf16 v[76:79],v[16:19],a[56:63],v1
l2s_101118:
s_bitcmp1_b32 s55,1
s_cbranch_scc0 l2s_101120
s_waitcnt vmcnt(5)
v_max3_u32 v124,v20,v21,v22
v_max_u32 v124,v124,v23
v_cmp_eq_u32 vcc,-1,v124
s_cbranch_vccnz l2s_101120
s_bitset0_b32 s55,1
v_smfmac_f32_16x16x64_bf16 v[64:67],v[20:23],a[96:103],v1
v_smfmac_f32_16x16x64_bf16 v[68:71],v[20:23],a[104:111],v1
v_smfmac_f32_16x16x64_bf16 v[72:75],v[20:23],a[112:119],v1
v_smfmac_f32_16x16x64_bf16 v[76:79],v[20:23],a[120:127],v1
l2s_101120:
s_bitcmp1_b32 s55,2
s_cbranch_scc0 l2s_101122
s_waitcnt vmcnt(3)
v_max3_u32 v124,v24,v25,v26
v_max_u32 v124,v124,v27
v_cmp_eq_u32 vcc,-1,v124
s_cbranch_vccnz l2s_101122
s_bitset0_b32 s55,2
v_smfmac_f32_16x16x64_bf16 v[64:67],v[24:27],a[160:167],v1
v_smfmac_f32_16x16x64_bf16 v[68:71],v[24:27],a[168:175],v1
v_smfmac_f32_16x16x64_bf16 v[72:75],v[24:27],a[176:183],v1
v_smfmac_f32_16x16x64_bf16 v[76:79],v[24:27],a[184:191],v1
l2s_101122:
s_bitcmp1_b32 s55,3
s_cbranch_scc0 l2s_101124
s_waitcnt vmcnt(0)
v_max3_u32 v124,v28,v29,v30
v_max_u32 v124,v124,v31
v_cmp_eq_u32 vcc,-1,v124
s_cbranch_vccnz l2s_101124
s_bitset0_b32 s55,3
v_smfmac_f32_16x16x64_bf16 v[64:67],v[28:31],a[224:231],v1
v_smfmac_f32_16x16x64_bf16 v[68:71],v[28:31],a[232:239],v1
v_smfmac_f32_16x16x64_bf16 v[72:75],v[28:31],a[240:247],v1
v_smfmac_f32_16x16x64_bf16 v[76:79],v[28:31],a[248:255],v1
l2s_101124:
s_cmp_eq_u32 s55,0
s_cbranch_scc0 lfb_101065
Ldone_101066:
s_waitcnt vmcnt(6)
v_max3_u32 v124,v32,v33,v34
v_max_u32 v124,v124,v35
v_cmp_eq_u32 vcc,-1,v124
s_cbranch_vccnz flb_100861
s_branch segb_100845
lfb_101065:
s_bitcmp1_b32 s55,0
s_cbranch_scc0 dsk_101126
buffer_load_dwordx4 v[16:19],v0,s[20:23],s92 offen offset:0 sc1
dsk_101126:
s_bitcmp1_b32 s55,1
s_cbranch_scc0 dsk_101127
buffer_load_dwordx4 v[20:23],v0,s[20:23],s92 offen offset:1024 sc1
dsk_101127:
s_bitcmp1_b32 s55,2
s_cbranch_scc0 dsk_101128
buffer_load_dwordx4 v[24:27],v0,s[20:23],s92 offen offset:2048 sc1
dsk_101128:
s_bitcmp1_b32 s55,3
s_cbranch_scc0 dsk_101129
buffer_load_dwordx4 v[28:31],v0,s[20:23],s92 offen offset:3072 sc1
dsk_101129:
s_bitcmp1_b32 s55,0
s_cbranch_scc0 dsk_101130
s_waitcnt vmcnt(2)
v_max3_u32 v124,v16,v17,v18
v_max_u32 v124,v124,v19
v_cmp_eq_u32 vcc,-1,v124
s_cbranch_vccz dgo_101131
s_nop 15
buffer_load_dwordx4 v[104:107],v0,s[20:23],s92 offen offset:0 sc1
s_nop 15
buffer_load_dwordx4 v[108:111],v0,s[20:23],s92 offen offset:0 sc1
dlp_101132:
s_waitcnt vmcnt(2)
v_max3_u32 v124,v16,v17,v18
v_max_u32 v124,v124,v19
v_cmp_eq_u32 vcc,-1,v124
s_cbranch_vccz dgo_101131
buffer_load_dwordx4 v[16:19],v0,s[20:23],s92 offen offset:0 sc1
s_waitcnt vmcnt(2)
v_max3_u32 v124,v104,v105,v106
v_max_u32 v124,v124,v107
v_cmp_eq_u32 vcc,-1,v124
s_cbranch_vccz dcp_101134
buffer_load_dwordx4 v[104:107],v0,s[20:23],s92 offen offset:0 sc1
s_waitcnt vmcnt(2)
v_max3_u32 v124,v108,v109,v110
v_max_u32 v124,v124,v111
v_cmp_eq_u32 vcc,-1,v124
s_cbranch_vccz dcp_101135
buffer_load_dwordx4 v[108:111],v0,s[20:23],s92 offen offset:0 sc1
s_sub_u32 s90,s90,1
s_cmp_gt_i32 s90,0
s_cbranch_scc1 dlp_101132
s_branch dgo_101131
dcp_101134:
v_mov_b32 v16,v104
v_mov_b32 v17,v105
v_mov_b32 v18,v106
v_mov_b32 v19,v107
s_nop 1
s_branch dgo_101131
dcp_101135:
v_mov_b32 v16,v108
v_mov_b32 v17,v109
v_mov_b32 v18,v110
v_mov_b32 v19,v111
s_nop 1
dgo_101131:
v_smfmac_f32_16x16x64_bf16 v[64:67],v[16:19],a[32:39],v1
v_smfmac_f32_16x16x64_bf16 v[68:71],v[16:19],a[40:47],v1
v_smfmac_f32_16x16x64_bf16 v[72:75],v[16:19],a[48:55],v1
v_smfmac_f32_16x16x64_bf16 v[76:79],v[16:19],a[56:63],v1
dsk_101130:
s_bitcmp1_b32 s55,1
s_cbranch_scc0 dsk_101136
s_waitcnt vmcnt(2)
v_max3_u32 v124,v20,v21,v22
v_max_u32 v124,v124,v23
v_cmp_eq_u32 vcc,-1,v124
s_cbranch_vccz dgo_101137
s_nop 15
buffer_load_dwordx4 v[104:107],v0,s[20:23],s92 offen offset:1024 sc1
s_nop 15
buffer_load_dwordx4 v[108:111],v0,s[20:23],s92 offen offset:1024 sc1
dlp_101138:
s_waitcnt vmcnt(2)
v_max3_u32 v124,v20,v21,v22
v_max_u32 v124,v124,v23
v_cmp_eq_u32 vcc,-1,v124
s_cbranch_vccz dgo_101137
buffer_load_dwordx4 v[20:23],v0,s[20:23],s92 offen offset:1024 sc1
s_waitcnt vmcnt(2)
v_max3_u32 v124,v104,v105,v106
v_max_u32 v124,v124,v107
v_cmp_eq_u32 vcc,-1,v124
s_cbranch_vccz dcp_101140
buffer_load_dwordx4 v[104:107],v0,s[20:23],s92 offen offset:1024 sc1
s_waitcnt vmcnt(2)
v_max3_u32 v124,v108,v109,v110
v_max_u32 v124,v124,v111
v_cmp_eq_u32 vcc,-1,v124
s_cbranch_vccz dcp_101141
buffer_load_dwordx4 v[108:111],v0,s[20:23],s92 offen offset:1024 sc1
s_sub_u32 s90,s90,1
s_cmp_gt_i32 s90,0
s_cbranch_scc1 dlp_101138
s_branch dgo_101137
dcp_101140:
v_mov_b32 v20,v104
v_mov_b32 v21,v105
v_mov_b32 v22,v106
v_mov_b32 v23,v107
s_nop 1
s_branch dgo_101137
dcp_101141:
v_mov_b32 v20,v108
v_mov_b32 v21,v109
v_mov_b32 v22,v110
v_mov_b32 v23,v111
s_nop 1
dgo_101137:
v_smfmac_f32_16x16x64_bf16 v[64:67],v[20:23],a[96:103],v1
v_smfmac_f32_16x16x64_bf16 v[68:71],v[20:23],a[104:111],v1
v_smfmac_f32_16x16x64_bf16 v[72:75],v[20:23],a[112:119],v1
v_smfmac_f32_16x16x64_bf16 v[76:79],v[20:23],a[120:127],v1
dsk_101136:
s_bitcmp1_b32 s55,2
s_cbranch_scc0 dsk_101142
s_waitcnt vmcnt(2)
v_max3_u32 v124,v24,v25,v26
v_max_u32 v124,v124,v27
v_cmp_eq_u32 vcc,-1,v124
s_cbranch_vccz dgo_101143
s_nop 15
buffer_load_dwordx4 v[104:107],v0,s[20:23],s92 offen offset:2048 sc1
s_nop 15
buffer_load_dwordx4 v[108:111],v0,s[20:23],s92 offen offset:2048 sc1
dlp_101144:
s_waitcnt vmcnt(2)
v_max3_u32 v124,v24,v25,v26
v_max_u32 v124,v124,v27
v_cmp_eq_u32 vcc,-1,v124
s_cbranch_vccz dgo_101143
buffer_load_dwordx4 v[24:27],v0,s[20:23],s92 offen offset:2048 sc1
s_waitcnt vmcnt(2)
v_max3_u32 v124,v104,v105,v106
v_max_u32 v124,v124,v107
v_cmp_eq_u32 vcc,-1,v124
s_cbranch_vccz dcp_101146
buffer_load_dwordx4 v[104:107],v0,s[20:23],s92 offen offset:2048 sc1
s_waitcnt vmcnt(2)
v_max3_u32 v124,v108,v109,v110
v_max_u32 v124,v124,v111
v_cmp_eq_u32 vcc,-1,v124
s_cbranch_vccz dcp_101147
buffer_load_dwordx4 v[108:111],v0,s[20:23],s92 offen offset:2048 sc1
s_sub_u32 s90,s90,1
s_cmp_gt_i32 s90,0
s_cbranch_scc1 dlp_101144
s_branch dgo_101143
dcp_101146:
v_mov_b32 v24,v104
v_mov_b32 v25,v105
v_mov_b32 v26,v106
v_mov_b32 v27,v107
s_nop 1
s_branch dgo_101143
dcp_101147:
v_mov_b32 v24,v108
v_mov_b32 v25,v109
v_mov_b32 v26,v110
v_mov_b32 v27,v111
s_nop 1
dgo_101143:
v_smfmac_f32_16x16x64_bf16 v[64:67],v[24:27],a[160:167],v1
v_smfmac_f32_16x16x64_bf16 v[68:71],v[24:27],a[168:175],v1
v_smfmac_f32_16x16x64_bf16 v[72:75],v[24:27],a[176:183],v1
v_smfmac_f32_16x16x64_bf16 v[76:79],v[24:27],a[184:191],v1
dsk_101142:
s_bitcmp1_b32 s55,3
s_cbranch_scc0 dsk_101148
s_waitcnt vmcnt(2)
v_max3_u32 v124,v28,v29,v30
v_max_u32 v124,v124,v31
v_cmp_eq_u32 vcc,-1,v124
s_cbranch_vccz dgo_101149
s_nop 15
buffer_load_dwordx4 v[104:107],v0,s[20:23],s92 offen offset:3072 sc1
s_nop 15
buffer_load_dwordx4 v[108:111],v0,s[20:23],s92 offen offset:3072 sc1
dlp_101150:
s_waitcnt vmcnt(2)
v_max3_u32 v124,v28,v29,v30
v_max_u32 v124,v124,v31
v_cmp_eq_u32 vcc,-1,v124
s_cbranch_vccz dgo_101149
buffer_load_dwordx4 v[28:31],v0,s[20:23],s92 offen offset:3072 sc1
s_waitcnt vmcnt(2)
v_max3_u32 v124,v104,v105,v106
v_max_u32 v124,v124,v107
v_cmp_eq_u32 vcc,-1,v124
s_cbranch_vccz dcp_101152
buffer_load_dwordx4 v[104:107],v0,s[20:23],s92 offen offset:3072 sc1
s_waitcnt vmcnt(2)
v_max3_u32 v124,v108,v109,v110
v_max_u32 v124,v124,v111
v_cmp_eq_u32 vcc,-1,v124
s_cbranch_vccz dcp_101153
buffer_load_dwordx4 v[108:111],v0,s[20:23],s92 offen offset:3072 sc1
s_sub_u32 s90,s90,1
s_cmp_gt_i32 s90,0
s_cbranch_scc1 dlp_101150
s_branch dgo_101149
dcp_101152:
v_mov_b32 v28,v104
v_mov_b32 v29,v105
v_mov_b32 v30,v106
v_mov_b32 v31,v107
s_nop 1
s_branch dgo_101149
dcp_101153:
v_mov_b32 v28,v108
v_mov_b32 v29,v109
v_mov_b32 v30,v110
v_mov_b32 v31,v111
s_nop 1
dgo_101149:
v_smfmac_f32_16x16x64_bf16 v[64:67],v[28:31],a[224:231],v1
v_smfmac_f32_16x16x64_bf16 v[68:71],v[28:31],a[232:239],v1
v_smfmac_f32_16x16x64_bf16 v[72:75],v[28:31],a[240:247],v1
v_smfmac_f32_16x16x64_bf16 v[76:79],v[28:31],a[248:255],v1
dsk_101148:
s_mov_b32 s55,0
s_branch Ldone_101066
slowA_100865:
buffer_load_dwordx4 v[44:47],v0,s[20:23],s93 offen offset:3072 sc1
dsk_101154:
s_bitcmp1_b32 s55,7
s_cbranch_scc0 dsk_101155
s_waitcnt vmcnt(2)
v_max3_u32 v124,v44,v45,v46
v_max_u32 v124,v124,v47
v_cmp_eq_u32 vcc,-1,v124
s_cbranch_vccz dgo_101156
s_nop 15
s_nop 3
buffer_load_dwordx4 v[104:107],v0,s[20:23],s93 offen offset:3072 sc1
s_nop 15
s_nop 3
buffer_load_dwordx4 v[108:111],v0,s[20:23],s93 offen offset:3072 sc1
dlp_101157:
s_waitcnt vmcnt(2)
v_max3_u32 v124,v44,v45,v46
v_max_u32 v124,v124,v47
v_cmp_eq_u32 vcc,-1,v124
s_cbranch_vccz dgo_101156
buffer_load_dwordx4 v[44:47],v0,s[20:23],s93 offen offset:3072 sc1
s_waitcnt vmcnt(2)
v_max3_u32 v124,v104,v105,v106
v_max_u32 v124,v124,v107
v_cmp_eq_u32 vcc,-1,v124
s_cbranch_vccz dcp_101159
buffer_load_dwordx4 v[104:107],v0,s[20:23],s93 offen offset:3072 sc1
s_waitcnt vmcnt(2)
v_max3_u32 v124,v108,v109,v110
v_max_u32 v124,v124,v111
v_cmp_eq_u32 vcc,-1,v124
s_cbranch_vccz dcp_101160
buffer_load_dwordx4 v[108:111],v0,s[20:23],s93 offen offset:3072 sc1
s_sub_u32 s90,s90,1
s_cmp_gt_i32 s90,0
s_cbranch_scc1 dlp_101157
s_branch dgo_101156
dcp_101159:
v_mov_b32 v44,v104
v_mov_b32 v45,v105
v_mov_b32 v46,v106
v_mov_b32 v47,v107
s_nop 1
s_branch dgo_101156
dcp_101160:
v_mov_b32 v44,v108
v_mov_b32 v45,v109
v_mov_b32 v46,v110
v_mov_b32 v47,v111
s_nop 1
dgo_101156:
dsk_101155:
s_mov_b32 s55,0
s_branch segb_100847
recfin_100374:
s_endpgm
.section .rodata,"a"
.p2align 6
.amdhsa_kernel flow_kernel
  .amdhsa_next_free_vgpr 512
  .amdhsa_next_free_sgpr 102
  .amdhsa_accum_offset 256
  .amdhsa_group_segment_fixed_size 0
  .amdhsa_kernarg_size 136
  .amdhsa_user_sgpr_count 2
  .amdhsa_user_sgpr_kernarg_segment_ptr 1
  .amdhsa_system_sgpr_workgroup_id_x 1
.end_amdhsa_kernel
```

```asm
; @launch kernel=flow_kernel grid=(256,1,1) block=(256,1,1) lds=163840
.amdgcn_target "amdgcn-amd-amdhsa--gfx950"
.text
.globl flow_kernel
.p2align 8
.type flow_kernel,@function
flow_kernel:
s_cmp_ge_u32 s2,256
s_cbranch_scc1 done_1
s_lshr_b32 s49,s2,3
s_load_dwordx2 s[18:19],s[0:1],128
s_load_dwordx2 s[2:3],s[0:1],120
s_load_dwordx2 s[4:5],s[0:1],0
s_getreg_b32 s51,hwreg(HW_REG_XCC_ID)
v_lshrrev_b32 v2,6,v0
v_and_b32 v1,63,v0
s_and_b32 s51,s51,7
v_readfirstlane_b32 s50,v2
s_mov_b32 s90,40000
s_mov_b32 s56,2
s_mov_b32 s88,64
s_lshl_b32 s64,s51,2
s_lshr_b32 s64,0x76325410,s64
s_and_b32 s64,s64,7
s_lshl_b32 s58,s64,5
s_add_u32 s58,s58,s49
s_waitcnt lgkmcnt(0)
s_mov_b32 s20,s18
s_and_b32 s21,s19,0xffff
s_mov_b32 s22,0x10000000
s_mov_b32 s23,0x20000
s_cmp_lg_u32 s50,0
s_cbranch_scc1 fl_disp0
s_mov_b32 s92,s2
s_and_b32 s93,s3,0xffff
s_mov_b32 s94,0x100
s_mov_b32 s95,0x20000
s_lshl_b32 s64,1,s49
v_mov_b32 v2,s64
v_mov_b32 v3,0x100
s_lshl_b32 s64,s51,3
s_mov_b64 exec,1
buffer_atomic_add_x2 v[2:3],off,s[92:95],s64 sc1
s_mov_b64 exec,-1
fl_disp0:
v_mbcnt_lo_u32_b32 v1,-1,0
v_mbcnt_hi_u32_b32 v1,-1,v1
s_sub_u32 s59,s58,64
s_cbranch_scc0 nx_3
s_branch fl_rec
nx_3:
s_cmp_lt_u32 s58,128
s_cbranch_scc0 nx_4
s_branch fl_qkv
nx_4:
s_cmp_ge_u32 s58,192
s_cbranch_scc1 fl_dutb
s_load_dwordx4 s[4:7],s[0:1],96
s_load_dwordx2 s[8:9],s[0:1],0
s_sub_u32 s59,s58,128
s_and_b32 s52,s59,15
s_lshr_b32 s53,s59,4
s_lshl_b32 s64,s50,6
v_add_u32 v14,s64,v1
v_lshrrev_b32 v2,4,v14
v_and_b32 v3,15,v14
v_mul_u32_u24 v13,196608,v2
v_lshl_add_u32 v13,v3,4,v13
s_mul_i32 s54,s53,3145728
s_lshl_b32 s64,s52,8
s_add_u32 s54,s54,s64
s_add_u32 s54,s54,0
v_lshlrev_b32 v15,1,v14
s_lshl_b32 s55,s53,9
s_mov_b32 s60,0
s_mov_b32 s73,0xffff0000
s_sub_u32 s61,s58,128
s_lshl_b32 s61,s61,15
v_lshlrev_b32 v25,6,v2
v_lshlrev_b32 v24,4,v1
v_and_b32 v2,3,v1
v_lshrrev_b32 v3,2,v1
s_lshl_b32 s64,s60,2
v_add_u32 v4,s64,v2
s_lshl_b32 s65,s50,9
v_lshlrev_b32 v5,4,v3
v_add_u32 v5,s65,v5
v_lshl_add_u32 v8,v4,11,v5
v_lshlrev_b32 v9,1,v5
v_lshrrev_b32 v5,2,v3
v_and_b32 v3,3,v3
s_lshl_b32 s65,s50,13
v_lshlrev_b32 v5,10,v5
v_lshl_add_u32 v5,v3,8,v5
v_lshl_add_u32 v5,v4,4,v5
v_add_u32 v10,s65,v5
s_lshl_b32 s65,s50,9
v_lshlrev_b32 v5,3,v1
v_add_u32 v11,s65,v5
v_lshlrev_b32 v12,3,v2
s_waitcnt lgkmcnt(0)
s_mov_b32 s24,s4
s_and_b32 s25,s5,0xffff
s_mov_b32 s26,0x800
s_mov_b32 s27,0x20000
s_mov_b32 s28,s6
s_and_b32 s29,s7,0xffff
s_mov_b32 s30,0xc00000
s_mov_b32 s31,0x20000
s_mov_b32 s32,s8
s_and_b32 s33,s9,0xffff
s_mov_b32 s34,0x400000
s_mov_b32 s35,0x20000
v_mov_b32 v28,-1
v_mov_b32 v20,0
v_mov_b32 v29,-1
v_mov_b32 v21,0
v_mov_b32 v30,-1
v_mov_b32 v22,0
v_mov_b32 v31,-1
v_mov_b32 v23,0
buffer_load_ushort v16,v15,s[24:27],s55 offen
buffer_load_dwordx4 v[96:99],v13,s[28:31],s54 offen offset:0
s_add_u32 s54,s54,12288
buffer_load_dwordx4 v[100:103],v13,s[28:31],s54 offen offset:0
s_add_u32 s54,s54,12288
buffer_load_dwordx4 v[104:107],v13,s[28:31],s54 offen offset:0
s_add_u32 s54,s54,12288
buffer_load_dwordx4 v[108:111],v13,s[28:31],s54 offen offset:0
s_add_u32 s54,s54,12288
buffer_load_dwordx4 v[112:115],v13,s[28:31],s54 offen offset:0
s_add_u32 s54,s54,12288
buffer_load_dwordx4 v[116:119],v13,s[28:31],s54 offen offset:0
s_add_u32 s54,s54,12288
buffer_load_dwordx4 v[120:123],v13,s[28:31],s54 offen offset:0
s_add_u32 s54,s54,12288
buffer_load_dwordx4 v[124:127],v13,s[28:31],s54 offen offset:0
s_add_u32 s54,s54,12288
buffer_load_dwordx4 v[128:131],v13,s[28:31],s54 offen offset:0
s_add_u32 s54,s54,12288
buffer_load_dwordx4 v[132:135],v13,s[28:31],s54 offen offset:0
s_add_u32 s54,s54,12288
buffer_load_dwordx4 v[136:139],v13,s[28:31],s54 offen offset:0
s_add_u32 s54,s54,12288
buffer_load_dwordx4 v[140:143],v13,s[28:31],s54 offen offset:0
s_add_u32 s54,s54,12288
buffer_load_dwordx4 v[144:147],v13,s[28:31],s54 offen offset:0
s_add_u32 s54,s54,12288
buffer_load_dwordx4 v[148:151],v13,s[28:31],s54 offen offset:0
s_add_u32 s54,s54,12288
buffer_load_dwordx4 v[152:155],v13,s[28:31],s54 offen offset:0
s_add_u32 s54,s54,12288
buffer_load_dwordx4 v[156:159],v13,s[28:31],s54 offen offset:0
s_add_u32 s64,s61,0
buffer_load_dwordx4 v[48:51],v8,s[32:35],s64 offen offset:0
buffer_load_dwordx4 v[52:55],v8,s[32:35],s64 offen offset:256
s_add_u32 s64,s61,8192
buffer_load_dwordx4 v[56:59],v8,s[32:35],s64 offen offset:0
buffer_load_dwordx4 v[60:63],v8,s[32:35],s64 offen offset:256
s_add_u32 s64,s61,16384
buffer_load_dwordx4 v[64:67],v8,s[32:35],s64 offen offset:0
buffer_load_dwordx4 v[68:71],v8,s[32:35],s64 offen offset:256
s_add_u32 s64,s61,24576
buffer_load_dwordx4 v[72:75],v8,s[32:35],s64 offen offset:0
buffer_load_dwordx4 v[76:79],v8,s[32:35],s64 offen offset:256
s_waitcnt vmcnt(24)
v_lshlrev_b32 v16,16,v16
v_mul_f32 v17,0xbfb8aa3b,v16
v_exp_f32 v17,v17
s_nop 0
v_add_f32 v17,1.0,v17
v_rcp_f32 v17,v17
s_nop 0
v_mul_f32 v17,v17,v16
v_cvt_pk_bf16_f32 v17,v17,v17
v_and_b32 v17,s73,v17
v_lshlrev_b32 v18,2,v14
ds_write_b32 v18,v17 offset:8192
s_waitcnt lgkmcnt(0)
s_barrier
ds_read_b128 v[32:35],v25 offset:8192
ds_read_b128 v[36:39],v25 offset:8208
ds_read_b128 v[40:43],v25 offset:8224
ds_read_b128 v[44:47],v25 offset:8240
v_mov_b32 v80,0
v_mov_b32 v81,0
v_mov_b32 v82,0
v_mov_b32 v83,0
v_mov_b32 v84,0
v_mov_b32 v85,0
v_mov_b32 v86,0
v_mov_b32 v87,0
s_waitcnt lgkmcnt(0)
s_waitcnt vmcnt(23)
v_lshlrev_b32 v16,16,v96
v_and_b32 v17,s73,v96
v_pk_fma_f32 v[80:81],v[16:17],v[32:33],v[80:81] op_sel:[0,0,0] op_sel_hi:[1,0,1]
v_lshlrev_b32 v18,16,v97
v_and_b32 v19,s73,v97
v_pk_fma_f32 v[82:83],v[18:19],v[32:33],v[82:83] op_sel:[0,0,0] op_sel_hi:[1,0,1]
v_lshlrev_b32 v16,16,v98
v_and_b32 v17,s73,v98
v_pk_fma_f32 v[84:85],v[16:17],v[32:33],v[84:85] op_sel:[0,0,0] op_sel_hi:[1,0,1]
v_lshlrev_b32 v18,16,v99
v_and_b32 v19,s73,v99
v_pk_fma_f32 v[86:87],v[18:19],v[32:33],v[86:87] op_sel:[0,0,0] op_sel_hi:[1,0,1]
s_waitcnt vmcnt(22)
v_lshlrev_b32 v16,16,v100
v_and_b32 v17,s73,v100
v_pk_fma_f32 v[80:81],v[16:17],v[32:33],v[80:81] op_sel:[0,1,0] op_sel_hi:[1,1,1]
v_lshlrev_b32 v18,16,v101
v_and_b32 v19,s73,v101
v_pk_fma_f32 v[82:83],v[18:19],v[32:33],v[82:83] op_sel:[0,1,0] op_sel_hi:[1,1,1]
v_lshlrev_b32 v16,16,v102
v_and_b32 v17,s73,v102
v_pk_fma_f32 v[84:85],v[16:17],v[32:33],v[84:85] op_sel:[0,1,0] op_sel_hi:[1,1,1]
v_lshlrev_b32 v18,16,v103
v_and_b32 v19,s73,v103
v_pk_fma_f32 v[86:87],v[18:19],v[32:33],v[86:87] op_sel:[0,1,0] op_sel_hi:[1,1,1]
s_waitcnt vmcnt(21)
v_lshlrev_b32 v16,16,v104
v_and_b32 v17,s73,v104
v_pk_fma_f32 v[80:81],v[16:17],v[34:35],v[80:81] op_sel:[0,0,0] op_sel_hi:[1,0,1]
v_lshlrev_b32 v18,16,v105
v_and_b32 v19,s73,v105
v_pk_fma_f32 v[82:83],v[18:19],v[34:35],v[82:83] op_sel:[0,0,0] op_sel_hi:[1,0,1]
v_lshlrev_b32 v16,16,v106
v_and_b32 v17,s73,v106
v_pk_fma_f32 v[84:85],v[16:17],v[34:35],v[84:85] op_sel:[0,0,0] op_sel_hi:[1,0,1]
v_lshlrev_b32 v18,16,v107
v_and_b32 v19,s73,v107
v_pk_fma_f32 v[86:87],v[18:19],v[34:35],v[86:87] op_sel:[0,0,0] op_sel_hi:[1,0,1]
s_waitcnt vmcnt(20)
v_lshlrev_b32 v16,16,v108
v_and_b32 v17,s73,v108
v_pk_fma_f32 v[80:81],v[16:17],v[34:35],v[80:81] op_sel:[0,1,0] op_sel_hi:[1,1,1]
v_lshlrev_b32 v18,16,v109
v_and_b32 v19,s73,v109
v_pk_fma_f32 v[82:83],v[18:19],v[34:35],v[82:83] op_sel:[0,1,0] op_sel_hi:[1,1,1]
v_lshlrev_b32 v16,16,v110
v_and_b32 v17,s73,v110
v_pk_fma_f32 v[84:85],v[16:17],v[34:35],v[84:85] op_sel:[0,1,0] op_sel_hi:[1,1,1]
v_lshlrev_b32 v18,16,v111
v_and_b32 v19,s73,v111
v_pk_fma_f32 v[86:87],v[18:19],v[34:35],v[86:87] op_sel:[0,1,0] op_sel_hi:[1,1,1]
s_waitcnt vmcnt(19)
v_lshlrev_b32 v16,16,v112
v_and_b32 v17,s73,v112
v_pk_fma_f32 v[80:81],v[16:17],v[36:37],v[80:81] op_sel:[0,0,0] op_sel_hi:[1,0,1]
v_lshlrev_b32 v18,16,v113
v_and_b32 v19,s73,v113
v_pk_fma_f32 v[82:83],v[18:19],v[36:37],v[82:83] op_sel:[0,0,0] op_sel_hi:[1,0,1]
v_lshlrev_b32 v16,16,v114
v_and_b32 v17,s73,v114
v_pk_fma_f32 v[84:85],v[16:17],v[36:37],v[84:85] op_sel:[0,0,0] op_sel_hi:[1,0,1]
v_lshlrev_b32 v18,16,v115
v_and_b32 v19,s73,v115
v_pk_fma_f32 v[86:87],v[18:19],v[36:37],v[86:87] op_sel:[0,0,0] op_sel_hi:[1,0,1]
s_waitcnt vmcnt(18)
v_lshlrev_b32 v16,16,v116
v_and_b32 v17,s73,v116
v_pk_fma_f32 v[80:81],v[16:17],v[36:37],v[80:81] op_sel:[0,1,0] op_sel_hi:[1,1,1]
v_lshlrev_b32 v18,16,v117
v_and_b32 v19,s73,v117
v_pk_fma_f32 v[82:83],v[18:19],v[36:37],v[82:83] op_sel:[0,1,0] op_sel_hi:[1,1,1]
v_lshlrev_b32 v16,16,v118
v_and_b32 v17,s73,v118
v_pk_fma_f32 v[84:85],v[16:17],v[36:37],v[84:85] op_sel:[0,1,0] op_sel_hi:[1,1,1]
v_lshlrev_b32 v18,16,v119
v_and_b32 v19,s73,v119
v_pk_fma_f32 v[86:87],v[18:19],v[36:37],v[86:87] op_sel:[0,1,0] op_sel_hi:[1,1,1]
s_waitcnt vmcnt(17)
v_lshlrev_b32 v16,16,v120
v_and_b32 v17,s73,v120
v_pk_fma_f32 v[80:81],v[16:17],v[38:39],v[80:81] op_sel:[0,0,0] op_sel_hi:[1,0,1]
v_lshlrev_b32 v18,16,v121
v_and_b32 v19,s73,v121
v_pk_fma_f32 v[82:83],v[18:19],v[38:39],v[82:83] op_sel:[0,0,0] op_sel_hi:[1,0,1]
v_lshlrev_b32 v16,16,v122
v_and_b32 v17,s73,v122
v_pk_fma_f32 v[84:85],v[16:17],v[38:39],v[84:85] op_sel:[0,0,0] op_sel_hi:[1,0,1]
v_lshlrev_b32 v18,16,v123
v_and_b32 v19,s73,v123
v_pk_fma_f32 v[86:87],v[18:19],v[38:39],v[86:87] op_sel:[0,0,0] op_sel_hi:[1,0,1]
s_waitcnt vmcnt(16)
v_lshlrev_b32 v16,16,v124
v_and_b32 v17,s73,v124
v_pk_fma_f32 v[80:81],v[16:17],v[38:39],v[80:81] op_sel:[0,1,0] op_sel_hi:[1,1,1]
v_lshlrev_b32 v18,16,v125
v_and_b32 v19,s73,v125
v_pk_fma_f32 v[82:83],v[18:19],v[38:39],v[82:83] op_sel:[0,1,0] op_sel_hi:[1,1,1]
v_lshlrev_b32 v16,16,v126
v_and_b32 v17,s73,v126
v_pk_fma_f32 v[84:85],v[16:17],v[38:39],v[84:85] op_sel:[0,1,0] op_sel_hi:[1,1,1]
v_lshlrev_b32 v18,16,v127
v_and_b32 v19,s73,v127
v_pk_fma_f32 v[86:87],v[18:19],v[38:39],v[86:87] op_sel:[0,1,0] op_sel_hi:[1,1,1]
s_waitcnt vmcnt(15)
v_lshlrev_b32 v16,16,v128
v_and_b32 v17,s73,v128
v_pk_fma_f32 v[80:81],v[16:17],v[40:41],v[80:81] op_sel:[0,0,0] op_sel_hi:[1,0,1]
v_lshlrev_b32 v18,16,v129
v_and_b32 v19,s73,v129
v_pk_fma_f32 v[82:83],v[18:19],v[40:41],v[82:83] op_sel:[0,0,0] op_sel_hi:[1,0,1]
v_lshlrev_b32 v16,16,v130
v_and_b32 v17,s73,v130
v_pk_fma_f32 v[84:85],v[16:17],v[40:41],v[84:85] op_sel:[0,0,0] op_sel_hi:[1,0,1]
v_lshlrev_b32 v18,16,v131
v_and_b32 v19,s73,v131
v_pk_fma_f32 v[86:87],v[18:19],v[40:41],v[86:87] op_sel:[0,0,0] op_sel_hi:[1,0,1]
s_waitcnt vmcnt(14)
v_lshlrev_b32 v16,16,v132
v_and_b32 v17,s73,v132
v_pk_fma_f32 v[80:81],v[16:17],v[40:41],v[80:81] op_sel:[0,1,0] op_sel_hi:[1,1,1]
v_lshlrev_b32 v18,16,v133
v_and_b32 v19,s73,v133
v_pk_fma_f32 v[82:83],v[18:19],v[40:41],v[82:83] op_sel:[0,1,0] op_sel_hi:[1,1,1]
v_lshlrev_b32 v16,16,v134
v_and_b32 v17,s73,v134
v_pk_fma_f32 v[84:85],v[16:17],v[40:41],v[84:85] op_sel:[0,1,0] op_sel_hi:[1,1,1]
v_lshlrev_b32 v18,16,v135
v_and_b32 v19,s73,v135
v_pk_fma_f32 v[86:87],v[18:19],v[40:41],v[86:87] op_sel:[0,1,0] op_sel_hi:[1,1,1]
s_waitcnt vmcnt(13)
v_lshlrev_b32 v16,16,v136
v_and_b32 v17,s73,v136
v_pk_fma_f32 v[80:81],v[16:17],v[42:43],v[80:81] op_sel:[0,0,0] op_sel_hi:[1,0,1]
v_lshlrev_b32 v18,16,v137
v_and_b32 v19,s73,v137
v_pk_fma_f32 v[82:83],v[18:19],v[42:43],v[82:83] op_sel:[0,0,0] op_sel_hi:[1,0,1]
v_lshlrev_b32 v16,16,v138
v_and_b32 v17,s73,v138
v_pk_fma_f32 v[84:85],v[16:17],v[42:43],v[84:85] op_sel:[0,0,0] op_sel_hi:[1,0,1]
v_lshlrev_b32 v18,16,v139
v_and_b32 v19,s73,v139
v_pk_fma_f32 v[86:87],v[18:19],v[42:43],v[86:87] op_sel:[0,0,0] op_sel_hi:[1,0,1]
s_waitcnt vmcnt(12)
v_lshlrev_b32 v16,16,v140
v_and_b32 v17,s73,v140
v_pk_fma_f32 v[80:81],v[16:17],v[42:43],v[80:81] op_sel:[0,1,0] op_sel_hi:[1,1,1]
v_lshlrev_b32 v18,16,v141
v_and_b32 v19,s73,v141
v_pk_fma_f32 v[82:83],v[18:19],v[42:43],v[82:83] op_sel:[0,1,0] op_sel_hi:[1,1,1]
v_lshlrev_b32 v16,16,v142
v_and_b32 v17,s73,v142
v_pk_fma_f32 v[84:85],v[16:17],v[42:43],v[84:85] op_sel:[0,1,0] op_sel_hi:[1,1,1]
v_lshlrev_b32 v18,16,v143
v_and_b32 v19,s73,v143
v_pk_fma_f32 v[86:87],v[18:19],v[42:43],v[86:87] op_sel:[0,1,0] op_sel_hi:[1,1,1]
s_waitcnt vmcnt(11)
v_lshlrev_b32 v16,16,v144
v_and_b32 v17,s73,v144
v_pk_fma_f32 v[80:81],v[16:17],v[44:45],v[80:81] op_sel:[0,0,0] op_sel_hi:[1,0,1]
v_lshlrev_b32 v18,16,v145
v_and_b32 v19,s73,v145
v_pk_fma_f32 v[82:83],v[18:19],v[44:45],v[82:83] op_sel:[0,0,0] op_sel_hi:[1,0,1]
v_lshlrev_b32 v16,16,v146
v_and_b32 v17,s73,v146
v_pk_fma_f32 v[84:85],v[16:17],v[44:45],v[84:85] op_sel:[0,0,0] op_sel_hi:[1,0,1]
v_lshlrev_b32 v18,16,v147
v_and_b32 v19,s73,v147
v_pk_fma_f32 v[86:87],v[18:19],v[44:45],v[86:87] op_sel:[0,0,0] op_sel_hi:[1,0,1]
s_waitcnt vmcnt(10)
v_lshlrev_b32 v16,16,v148
v_and_b32 v17,s73,v148
v_pk_fma_f32 v[80:81],v[16:17],v[44:45],v[80:81] op_sel:[0,1,0] op_sel_hi:[1,1,1]
v_lshlrev_b32 v18,16,v149
v_and_b32 v19,s73,v149
v_pk_fma_f32 v[82:83],v[18:19],v[44:45],v[82:83] op_sel:[0,1,0] op_sel_hi:[1,1,1]
v_lshlrev_b32 v16,16,v150
v_and_b32 v17,s73,v150
v_pk_fma_f32 v[84:85],v[16:17],v[44:45],v[84:85] op_sel:[0,1,0] op_sel_hi:[1,1,1]
v_lshlrev_b32 v18,16,v151
v_and_b32 v19,s73,v151
v_pk_fma_f32 v[86:87],v[18:19],v[44:45],v[86:87] op_sel:[0,1,0] op_sel_hi:[1,1,1]
s_waitcnt vmcnt(9)
v_lshlrev_b32 v16,16,v152
v_and_b32 v17,s73,v152
v_pk_fma_f32 v[80:81],v[16:17],v[46:47],v[80:81] op_sel:[0,0,0] op_sel_hi:[1,0,1]
v_lshlrev_b32 v18,16,v153
v_and_b32 v19,s73,v153
v_pk_fma_f32 v[82:83],v[18:19],v[46:47],v[82:83] op_sel:[0,0,0] op_sel_hi:[1,0,1]
v_lshlrev_b32 v16,16,v154
v_and_b32 v17,s73,v154
v_pk_fma_f32 v[84:85],v[16:17],v[46:47],v[84:85] op_sel:[0,0,0] op_sel_hi:[1,0,1]
v_lshlrev_b32 v18,16,v155
v_and_b32 v19,s73,v155
v_pk_fma_f32 v[86:87],v[18:19],v[46:47],v[86:87] op_sel:[0,0,0] op_sel_hi:[1,0,1]
s_waitcnt vmcnt(8)
v_lshlrev_b32 v16,16,v156
v_and_b32 v17,s73,v156
v_pk_fma_f32 v[80:81],v[16:17],v[46:47],v[80:81] op_sel:[0,1,0] op_sel_hi:[1,1,1]
v_lshlrev_b32 v18,16,v157
v_and_b32 v19,s73,v157
v_pk_fma_f32 v[82:83],v[18:19],v[46:47],v[82:83] op_sel:[0,1,0] op_sel_hi:[1,1,1]
v_lshlrev_b32 v16,16,v158
v_and_b32 v17,s73,v158
v_pk_fma_f32 v[84:85],v[16:17],v[46:47],v[84:85] op_sel:[0,1,0] op_sel_hi:[1,1,1]
v_lshlrev_b32 v18,16,v159
v_and_b32 v19,s73,v159
v_pk_fma_f32 v[86:87],v[18:19],v[46:47],v[86:87] op_sel:[0,1,0] op_sel_hi:[1,1,1]
v_lshlrev_b32 v18,5,v14
ds_write_b128 v18,v[80:83] offset:16384
ds_write_b128 v18,v[84:87] offset:16400
v_and_b32 v18,127,v14
v_lshlrev_b32 v18,2,v18
v_lshrrev_b32 v19,7,v14
v_mov_b32 v19,v18
s_waitcnt lgkmcnt(0)
s_barrier
ds_read_b32 v32,v19 offset:16384
ds_read_b32 v33,v19 offset:16896
ds_read_b32 v34,v19 offset:17408
ds_read_b32 v35,v19 offset:17920
ds_read_b32 v36,v19 offset:18432
ds_read_b32 v37,v19 offset:18944
ds_read_b32 v38,v19 offset:19456
ds_read_b32 v39,v19 offset:19968
ds_read_b32 v40,v19 offset:20480
ds_read_b32 v41,v19 offset:20992
ds_read_b32 v42,v19 offset:21504
ds_read_b32 v43,v19 offset:22016
s_waitcnt lgkmcnt(4)
ds_read_b32 v44,v19 offset:22528
ds_read_b32 v45,v19 offset:23040
ds_read_b32 v46,v19 offset:23552
ds_read_b32 v47,v19 offset:24064
s_waitcnt lgkmcnt(0)
v_pk_add_f32 v[32:33],v[32:33],v[40:41]
v_pk_add_f32 v[34:35],v[34:35],v[42:43]
v_pk_add_f32 v[36:37],v[36:37],v[44:45]
v_pk_add_f32 v[38:39],v[38:39],v[46:47]
v_pk_add_f32 v[32:33],v[32:33],v[36:37]
v_pk_add_f32 v[34:35],v[34:35],v[38:39]
v_pk_add_f32 v[32:33],v[32:33],v[34:35]
v_add_f32 v32,v32,v33
s_mul_i32 s64,s53,24576
s_lshl_b32 s65,s52,9
s_add_u32 s64,s64,s65
s_add_u32 s64,s64,267386880
buffer_store_dword v32,v18,s[20:23],s64 offen sc1
s_waitcnt vmcnt(0)
s_barrier
s_cmp_lg_u32 s50,0
s_cbranch_scc1 sig_5
s_mov_b32 s92,s2
s_and_b32 s93,s3,0xffff
s_mov_b32 s94,0x100
s_mov_b32 s95,0x20000
s_add_u32 s64,s88,0
v_mov_b32 v16,1
s_mov_b64 exec,1
buffer_atomic_add v16,off,s[92:95],s64 sc1
s_mov_b64 exec,-1
sig_5:
v_lshlrev_b32 v128,16,v48
v_and_b32 v129,s73,v48
v_lshlrev_b32 v130,16,v49
v_and_b32 v131,s73,v49
v_lshlrev_b32 v132,16,v50
v_and_b32 v133,s73,v50
v_lshlrev_b32 v134,16,v51
v_and_b32 v135,s73,v51
v_lshlrev_b32 v136,16,v52
v_and_b32 v137,s73,v52
v_lshlrev_b32 v138,16,v53
v_and_b32 v139,s73,v53
v_lshlrev_b32 v140,16,v54
v_and_b32 v141,s73,v54
v_lshlrev_b32 v142,16,v55
v_and_b32 v143,s73,v55
v_lshlrev_b32 v144,16,v56
v_and_b32 v145,s73,v56
v_lshlrev_b32 v146,16,v57
v_and_b32 v147,s73,v57
v_lshlrev_b32 v148,16,v58
v_and_b32 v149,s73,v58
v_lshlrev_b32 v150,16,v59
v_and_b32 v151,s73,v59
v_lshlrev_b32 v152,16,v60
v_and_b32 v153,s73,v60
v_lshlrev_b32 v154,16,v61
v_and_b32 v155,s73,v61
v_lshlrev_b32 v156,16,v62
v_and_b32 v157,s73,v62
v_lshlrev_b32 v158,16,v63
v_and_b32 v159,s73,v63
v_lshlrev_b32 v160,16,v64
v_and_b32 v161,s73,v64
v_lshlrev_b32 v162,16,v65
v_and_b32 v163,s73,v65
v_lshlrev_b32 v164,16,v66
v_and_b32 v165,s73,v66
v_lshlrev_b32 v166,16,v67
v_and_b32 v167,s73,v67
v_lshlrev_b32 v168,16,v68
v_and_b32 v169,s73,v68
v_lshlrev_b32 v170,16,v69
v_and_b32 v171,s73,v69
v_lshlrev_b32 v172,16,v70
v_and_b32 v173,s73,v70
v_lshlrev_b32 v174,16,v71
v_and_b32 v175,s73,v71
v_lshlrev_b32 v176,16,v72
v_and_b32 v177,s73,v72
v_lshlrev_b32 v178,16,v73
v_and_b32 v179,s73,v73
v_lshlrev_b32 v180,16,v74
v_and_b32 v181,s73,v74
v_lshlrev_b32 v182,16,v75
v_and_b32 v183,s73,v75
v_lshlrev_b32 v184,16,v76
v_and_b32 v185,s73,v76
v_lshlrev_b32 v186,16,v77
v_and_b32 v187,s73,v77
v_lshlrev_b32 v188,16,v78
v_and_b32 v189,s73,v78
v_lshlrev_b32 v190,16,v79
v_and_b32 v191,s73,v79
v_add_f32 v208,v128,v129
v_mul_f32 v209,v128,v128
v_add_f32 v210,v130,v131
v_mul_f32 v211,v129,v129
v_fmac_f32 v209,v130,v130
v_fmac_f32 v211,v131,v131
v_add_f32 v208,v208,v132
v_fmac_f32 v209,v132,v132
v_add_f32 v210,v210,v133
v_fmac_f32 v211,v133,v133
v_add_f32 v208,v208,v134
v_fmac_f32 v209,v134,v134
v_add_f32 v210,v210,v135
v_fmac_f32 v211,v135,v135
v_add_f32 v208,v208,v136
v_fmac_f32 v209,v136,v136
v_add_f32 v210,v210,v137
v_fmac_f32 v211,v137,v137
v_add_f32 v208,v208,v138
v_fmac_f32 v209,v138,v138
v_add_f32 v210,v210,v139
v_fmac_f32 v211,v139,v139
v_add_f32 v208,v208,v140
v_fmac_f32 v209,v140,v140
v_add_f32 v210,v210,v141
v_fmac_f32 v211,v141,v141
v_add_f32 v208,v208,v142
v_fmac_f32 v209,v142,v142
v_add_f32 v210,v210,v143
v_fmac_f32 v211,v143,v143
v_add_f32 v208,v208,v210
v_add_f32 v209,v209,v211
v_add_f32 v212,v144,v145
v_mul_f32 v213,v144,v144
v_add_f32 v214,v146,v147
v_mul_f32 v215,v145,v145
v_fmac_f32 v213,v146,v146
v_fmac_f32 v215,v147,v147
v_add_f32 v212,v212,v148
v_fmac_f32 v213,v148,v148
v_add_f32 v214,v214,v149
v_fmac_f32 v215,v149,v149
v_add_f32 v212,v212,v150
v_fmac_f32 v213,v150,v150
v_add_f32 v214,v214,v151
v_fmac_f32 v215,v151,v151
v_add_f32 v212,v212,v152
v_fmac_f32 v213,v152,v152
v_add_f32 v214,v214,v153
v_fmac_f32 v215,v153,v153
v_add_f32 v212,v212,v154
v_fmac_f32 v213,v154,v154
v_add_f32 v214,v214,v155
v_fmac_f32 v215,v155,v155
v_add_f32 v212,v212,v156
v_fmac_f32 v213,v156,v156
v_add_f32 v214,v214,v157
v_fmac_f32 v215,v157,v157
v_add_f32 v212,v212,v158
v_fmac_f32 v213,v158,v158
v_add_f32 v214,v214,v159
v_fmac_f32 v215,v159,v159
v_add_f32 v212,v212,v214
v_add_f32 v213,v213,v215
v_add_f32 v216,v160,v161
v_mul_f32 v217,v160,v160
v_add_f32 v218,v162,v163
v_mul_f32 v219,v161,v161
v_fmac_f32 v217,v162,v162
v_fmac_f32 v219,v163,v163
v_add_f32 v216,v216,v164
v_fmac_f32 v217,v164,v164
v_add_f32 v218,v218,v165
v_fmac_f32 v219,v165,v165
v_add_f32 v216,v216,v166
v_fmac_f32 v217,v166,v166
v_add_f32 v218,v218,v167
v_fmac_f32 v219,v167,v167
v_add_f32 v216,v216,v168
v_fmac_f32 v217,v168,v168
v_add_f32 v218,v218,v169
v_fmac_f32 v219,v169,v169
v_add_f32 v216,v216,v170
v_fmac_f32 v217,v170,v170
v_add_f32 v218,v218,v171
v_fmac_f32 v219,v171,v171
v_add_f32 v216,v216,v172
v_fmac_f32 v217,v172,v172
v_add_f32 v218,v218,v173
v_fmac_f32 v219,v173,v173
v_add_f32 v216,v216,v174
v_fmac_f32 v217,v174,v174
v_add_f32 v218,v218,v175
v_fmac_f32 v219,v175,v175
v_add_f32 v216,v216,v218
v_add_f32 v217,v217,v219
v_add_f32 v220,v176,v177
v_mul_f32 v221,v176,v176
v_add_f32 v222,v178,v179
v_mul_f32 v223,v177,v177
v_fmac_f32 v221,v178,v178
v_fmac_f32 v223,v179,v179
v_add_f32 v220,v220,v180
v_fmac_f32 v221,v180,v180
v_add_f32 v222,v222,v181
v_fmac_f32 v223,v181,v181
v_add_f32 v220,v220,v182
v_fmac_f32 v221,v182,v182
v_add_f32 v222,v222,v183
v_fmac_f32 v223,v183,v183
v_add_f32 v220,v220,v184
v_fmac_f32 v221,v184,v184
v_add_f32 v222,v222,v185
v_fmac_f32 v223,v185,v185
v_add_f32 v220,v220,v186
v_fmac_f32 v221,v186,v186
v_add_f32 v222,v222,v187
v_fmac_f32 v223,v187,v187
v_add_f32 v220,v220,v188
v_fmac_f32 v221,v188,v188
v_add_f32 v222,v222,v189
v_fmac_f32 v223,v189,v189
v_add_f32 v220,v220,v190
v_fmac_f32 v221,v190,v190
v_add_f32 v222,v222,v191
v_fmac_f32 v223,v191,v191
v_add_f32 v220,v220,v222
v_add_f32 v221,v221,v223
v_add_f32_dpp v208,v208,v208 row_ror:4 row_mask:0xf bank_mask:0xf
v_add_f32_dpp v209,v209,v209 row_ror:4 row_mask:0xf bank_mask:0xf
v_add_f32_dpp v212,v212,v212 row_ror:4 row_mask:0xf bank_mask:0xf
v_add_f32_dpp v213,v213,v213 row_ror:4 row_mask:0xf bank_mask:0xf
v_add_f32_dpp v216,v216,v216 row_ror:4 row_mask:0xf bank_mask:0xf
v_add_f32_dpp v217,v217,v217 row_ror:4 row_mask:0xf bank_mask:0xf
v_add_f32_dpp v220,v220,v220 row_ror:4 row_mask:0xf bank_mask:0xf
v_add_f32_dpp v221,v221,v221 row_ror:4 row_mask:0xf bank_mask:0xf
v_add_f32_dpp v208,v208,v208 row_ror:8 row_mask:0xf bank_mask:0xf
v_add_f32_dpp v209,v209,v209 row_ror:8 row_mask:0xf bank_mask:0xf
v_add_f32_dpp v212,v212,v212 row_ror:8 row_mask:0xf bank_mask:0xf
v_add_f32_dpp v213,v213,v213 row_ror:8 row_mask:0xf bank_mask:0xf
v_add_f32_dpp v216,v216,v216 row_ror:8 row_mask:0xf bank_mask:0xf
v_add_f32_dpp v217,v217,v217 row_ror:8 row_mask:0xf bank_mask:0xf
v_add_f32_dpp v220,v220,v220 row_ror:8 row_mask:0xf bank_mask:0xf
v_add_f32_dpp v221,v221,v221 row_ror:8 row_mask:0xf bank_mask:0xf
v_mov_b32 v210,v208
v_mov_b32 v211,v209
s_nop 0
v_permlane16_swap_b32 v210,v208
v_permlane16_swap_b32 v211,v209
v_add_f32 v208,v208,v210
v_add_f32 v209,v209,v211
v_mov_b32 v214,v212
v_mov_b32 v215,v213
s_nop 0
v_permlane16_swap_b32 v214,v212
v_permlane16_swap_b32 v215,v213
v_add_f32 v212,v212,v214
v_add_f32 v213,v213,v215
v_mov_b32 v218,v216
v_mov_b32 v219,v217
s_nop 0
v_permlane16_swap_b32 v218,v216
v_permlane16_swap_b32 v219,v217
v_add_f32 v216,v216,v218
v_add_f32 v217,v217,v219
v_mov_b32 v222,v220
v_mov_b32 v223,v221
s_nop 0
v_permlane16_swap_b32 v222,v220
v_permlane16_swap_b32 v223,v221
v_add_f32 v220,v220,v222
v_add_f32 v221,v221,v223
v_mov_b32 v210,v208
v_mov_b32 v211,v209
s_nop 0
v_permlane32_swap_b32 v210,v208
v_permlane32_swap_b32 v211,v209
v_add_f32 v208,v208,v210
v_add_f32 v209,v209,v211
v_mov_b32 v214,v212
v_mov_b32 v215,v213
s_nop 0
v_permlane32_swap_b32 v214,v212
v_permlane32_swap_b32 v215,v213
v_add_f32 v212,v212,v214
v_add_f32 v213,v213,v215
v_mov_b32 v218,v216
v_mov_b32 v219,v217
s_nop 0
v_permlane32_swap_b32 v218,v216
v_permlane32_swap_b32 v219,v217
v_add_f32 v216,v216,v218
v_add_f32 v217,v217,v219
v_mov_b32 v222,v220
v_mov_b32 v223,v221
s_nop 0
v_permlane32_swap_b32 v222,v220
v_permlane32_swap_b32 v223,v221
v_add_f32 v220,v220,v222
v_add_f32 v221,v221,v223
ds_write_b64 v11,v[208:209] offset:32768
ds_write_b64 v11,v[212:213] offset:34816
ds_write_b64 v11,v[216:217] offset:36864
ds_write_b64 v11,v[220:221] offset:38912
s_waitcnt lgkmcnt(0)
s_barrier
ds_read_b64 v[32:33],v12 offset:32768
ds_read_b64 v[34:35],v12 offset:33280
ds_read_b64 v[36:37],v12 offset:33792
ds_read_b64 v[38:39],v12 offset:34304
s_waitcnt lgkmcnt(0)
v_add_f32 v32,v32,v34
v_add_f32 v33,v33,v35
v_add_f32 v36,v36,v38
v_add_f32 v37,v37,v39
v_add_f32 v32,v32,v36
v_add_f32 v33,v33,v37
v_mul_f32 v208,0xba800000,v32
v_mul_f32 v34,v208,v208
v_mul_f32 v33,0x3a800000,v33
v_sub_f32 v33,v33,v34
v_max_f32 v33,0,v33
v_add_f32 v33,0x3727c5ac,v33
v_rsq_f32 v209,v33
s_nop 0
v_mul_f32 v208,v208,v209
v_fma_f32 v128,v128,v209,v208
v_fma_f32 v129,v129,v209,v208
v_fma_f32 v130,v130,v209,v208
v_fma_f32 v131,v131,v209,v208
v_fma_f32 v132,v132,v209,v208
v_fma_f32 v133,v133,v209,v208
v_fma_f32 v134,v134,v209,v208
v_fma_f32 v135,v135,v209,v208
v_fma_f32 v136,v136,v209,v208
v_fma_f32 v137,v137,v209,v208
v_fma_f32 v138,v138,v209,v208
v_fma_f32 v139,v139,v209,v208
v_fma_f32 v140,v140,v209,v208
v_fma_f32 v141,v141,v209,v208
v_fma_f32 v142,v142,v209,v208
v_fma_f32 v143,v143,v209,v208
ds_read_b64 v[32:33],v12 offset:34816
ds_read_b64 v[34:35],v12 offset:35328
ds_read_b64 v[36:37],v12 offset:35840
ds_read_b64 v[38:39],v12 offset:36352
s_waitcnt lgkmcnt(0)
v_add_f32 v32,v32,v34
v_add_f32 v33,v33,v35
v_add_f32 v36,v36,v38
v_add_f32 v37,v37,v39
v_add_f32 v32,v32,v36
v_add_f32 v33,v33,v37
v_mul_f32 v208,0xba800000,v32
v_mul_f32 v34,v208,v208
v_mul_f32 v33,0x3a800000,v33
v_sub_f32 v33,v33,v34
v_max_f32 v33,0,v33
v_add_f32 v33,0x3727c5ac,v33
v_rsq_f32 v209,v33
s_nop 0
v_mul_f32 v208,v208,v209
v_fma_f32 v144,v144,v209,v208
v_fma_f32 v145,v145,v209,v208
v_fma_f32 v146,v146,v209,v208
v_fma_f32 v147,v147,v209,v208
v_fma_f32 v148,v148,v209,v208
v_fma_f32 v149,v149,v209,v208
v_fma_f32 v150,v150,v209,v208
v_fma_f32 v151,v151,v209,v208
v_fma_f32 v152,v152,v209,v208
v_fma_f32 v153,v153,v209,v208
v_fma_f32 v154,v154,v209,v208
v_fma_f32 v155,v155,v209,v208
v_fma_f32 v156,v156,v209,v208
v_fma_f32 v157,v157,v209,v208
v_fma_f32 v158,v158,v209,v208
v_fma_f32 v159,v159,v209,v208
ds_read_b64 v[32:33],v12 offset:36864
ds_read_b64 v[34:35],v12 offset:37376
ds_read_b64 v[36:37],v12 offset:37888
ds_read_b64 v[38:39],v12 offset:38400
s_waitcnt lgkmcnt(0)
v_add_f32 v32,v32,v34
v_add_f32 v33,v33,v35
v_add_f32 v36,v36,v38
v_add_f32 v37,v37,v39
v_add_f32 v32,v32,v36
v_add_f32 v33,v33,v37
v_mul_f32 v208,0xba800000,v32
v_mul_f32 v34,v208,v208
v_mul_f32 v33,0x3a800000,v33
v_sub_f32 v33,v33,v34
v_max_f32 v33,0,v33
v_add_f32 v33,0x3727c5ac,v33
v_rsq_f32 v209,v33
s_nop 0
v_mul_f32 v208,v208,v209
v_fma_f32 v160,v160,v209,v208
v_fma_f32 v161,v161,v209,v208
v_fma_f32 v162,v162,v209,v208
v_fma_f32 v163,v163,v209,v208
v_fma_f32 v164,v164,v209,v208
v_fma_f32 v165,v165,v209,v208
v_fma_f32 v166,v166,v209,v208
v_fma_f32 v167,v167,v209,v208
v_fma_f32 v168,v168,v209,v208
v_fma_f32 v169,v169,v209,v208
v_fma_f32 v170,v170,v209,v208
v_fma_f32 v171,v171,v209,v208
v_fma_f32 v172,v172,v209,v208
v_fma_f32 v173,v173,v209,v208
v_fma_f32 v174,v174,v209,v208
v_fma_f32 v175,v175,v209,v208
ds_read_b64 v[32:33],v12 offset:38912
ds_read_b64 v[34:35],v12 offset:39424
ds_read_b64 v[36:37],v12 offset:39936
ds_read_b64 v[38:39],v12 offset:40448
s_waitcnt lgkmcnt(0)
v_add_f32 v32,v32,v34
v_add_f32 v33,v33,v35
v_add_f32 v36,v36,v38
v_add_f32 v37,v37,v39
v_add_f32 v32,v32,v36
v_add_f32 v33,v33,v37
v_mul_f32 v208,0xba800000,v32
v_mul_f32 v34,v208,v208
v_mul_f32 v33,0x3a800000,v33
v_sub_f32 v33,v33,v34
v_max_f32 v33,0,v33
v_add_f32 v33,0x3727c5ac,v33
v_rsq_f32 v209,v33
s_nop 0
v_mul_f32 v208,v208,v209
v_fma_f32 v176,v176,v209,v208
v_fma_f32 v177,v177,v209,v208
v_fma_f32 v178,v178,v209,v208
v_fma_f32 v179,v179,v209,v208
v_fma_f32 v180,v180,v209,v208
v_fma_f32 v181,v181,v209,v208
v_fma_f32 v182,v182,v209,v208
v_fma_f32 v183,v183,v209,v208
v_fma_f32 v184,v184,v209,v208
v_fma_f32 v185,v185,v209,v208
v_fma_f32 v186,v186,v209,v208
v_fma_f32 v187,v187,v209,v208
v_fma_f32 v188,v188,v209,v208
v_fma_f32 v189,v189,v209,v208
v_fma_f32 v190,v190,v209,v208
v_fma_f32 v191,v191,v209,v208
s_mov_b32 s92,s2
s_and_b32 s93,s3,0xffff
s_mov_b32 s94,0x100
s_mov_b32 s95,0x20000
v_mbcnt_lo_u32_b32 v16,-1,0
v_mbcnt_hi_u32_b32 v16,-1,v16
v_mov_b32 v18,0
v_cmp_eq_u32 vcc,16,v16
s_nop 1
v_cndmask_b32 v18,v18,64,vcc
v_and_b32 v19,1,v16
v_cmp_eq_u32 vcc,1,v19
v_mov_b32 v19,8192
s_nop 0
v_cndmask_b32 v19,-1,v19,vcc
v_min_u32 v16,31,v16
v_lshlrev_b32 v16,2,v16
s_sub_u32 s66,s88,64
s_cmp_lg_u32 s50,0
s_cbranch_scc1 vot_10
vpoll_6:
buffer_load_dword v17,v16,s[92:95],s66 offen sc1
s_waitcnt vmcnt(0)
s_cmp_lg_u32 s56,2
s_cbranch_scc1 vck_7
v_cmp_eq_u32 vcc,v17,v19
s_and_b32 s64,vcc_lo,0xffff
s_cmp_eq_u32 s64,65535
s_cbranch_scc1 vck_7
s_mov_b32 s65,0
v_readlane_b32 s64,v17,1
s_lshr_b32 s64,s64,8
s_add_u32 s65,s65,s64
v_readlane_b32 s64,v17,3
s_lshr_b32 s64,s64,8
s_add_u32 s65,s65,s64
v_readlane_b32 s64,v17,5
s_lshr_b32 s64,s64,8
s_add_u32 s65,s65,s64
v_readlane_b32 s64,v17,7
s_lshr_b32 s64,s64,8
s_add_u32 s65,s65,s64
v_readlane_b32 s64,v17,9
s_lshr_b32 s64,s64,8
s_add_u32 s65,s65,s64
v_readlane_b32 s64,v17,11
s_lshr_b32 s64,s64,8
s_add_u32 s65,s65,s64
v_readlane_b32 s64,v17,13
s_lshr_b32 s64,s64,8
s_add_u32 s65,s65,s64
v_readlane_b32 s64,v17,15
s_lshr_b32 s64,s64,8
s_add_u32 s65,s65,s64
s_cmp_ge_u32 s65,256
s_cbranch_scc1 vok_9
s_branch vrt_8
vck_7:
v_cmp_gt_u32 vcc,v18,v17
s_cbranch_vccz vok_9
vrt_8:
s_sleep 8
s_sub_u32 s90,s90,1
s_cmp_gt_i32 s90,0
s_cbranch_scc1 vpoll_6
vok_9:
v_add_u32 v18,160000,v16
ds_write_b32 v18,v17
s_waitcnt lgkmcnt(0)
vot_10:
s_barrier
v_add_u32 v18,160000,v16
ds_read_b32 v17,v18
s_waitcnt lgkmcnt(0)
s_cmp_lg_u32 s56,2
s_cbranch_scc1 vfin_11
v_cmp_eq_u32 vcc,v17,v19
s_and_b32 s64,vcc_lo,0xffff
s_cmp_eq_u32 s64,65535
s_cbranch_scc1 vfin_11
s_mov_b32 s65,0
v_readlane_b32 s64,v17,1
s_lshr_b32 s64,s64,8
s_add_u32 s65,s65,s64
v_readlane_b32 s64,v17,3
s_lshr_b32 s64,s64,8
s_add_u32 s65,s65,s64
v_readlane_b32 s64,v17,5
s_lshr_b32 s64,s64,8
s_add_u32 s65,s65,s64
v_readlane_b32 s64,v17,7
s_lshr_b32 s64,s64,8
s_add_u32 s65,s65,s64
v_readlane_b32 s64,v17,9
s_lshr_b32 s64,s64,8
s_add_u32 s65,s65,s64
v_readlane_b32 s64,v17,11
s_lshr_b32 s64,s64,8
s_add_u32 s65,s65,s64
v_readlane_b32 s64,v17,13
s_lshr_b32 s64,s64,8
s_add_u32 s65,s65,s64
v_readlane_b32 s64,v17,15
s_lshr_b32 s64,s64,8
s_add_u32 s65,s65,s64
s_cmp_ge_u32 s65,256
s_cbranch_scc1 fl_fb
vfin_11:
s_and_b32 s56,s56,1
v_lshlrev_b32 v18,5,v14
s_mov_b32 s64,267386880
buffer_load_dwordx4 v[32:35],v18,s[20:23],s64 offen offset:0 sc1
buffer_load_dwordx4 v[36:39],v18,s[20:23],s64 offen offset:16 sc1
s_mov_b32 s64,267411456
buffer_load_dwordx4 v[40:43],v18,s[20:23],s64 offen offset:0 sc1
buffer_load_dwordx4 v[44:47],v18,s[20:23],s64 offen offset:16 sc1
s_mov_b32 s64,267436032
buffer_load_dwordx4 v[48:51],v18,s[20:23],s64 offen offset:0 sc1
buffer_load_dwordx4 v[52:55],v18,s[20:23],s64 offen offset:16 sc1
s_mov_b32 s64,267460608
buffer_load_dwordx4 v[56:59],v18,s[20:23],s64 offen offset:0 sc1
buffer_load_dwordx4 v[60:63],v18,s[20:23],s64 offen offset:16 sc1
s_cmp_gt_u32 s50,1
s_cselect_b32 s64,1.0,0
s_waitcnt vmcnt(0)
v_pk_add_f32 v[32:33],v[32:33],v[40:41]
v_pk_add_f32 v[48:49],v[48:49],v[56:57]
v_pk_add_f32 v[34:35],v[34:35],v[42:43]
v_pk_add_f32 v[50:51],v[50:51],v[58:59]
v_pk_add_f32 v[36:37],v[36:37],v[44:45]
v_pk_add_f32 v[52:53],v[52:53],v[60:61]
v_pk_add_f32 v[38:39],v[38:39],v[46:47]
v_pk_add_f32 v[54:55],v[54:55],v[62:63]
v_pk_add_f32 v[32:33],v[32:33],v[48:49]
v_pk_add_f32 v[34:35],v[34:35],v[50:51]
v_pk_add_f32 v[36:37],v[36:37],v[52:53]
v_pk_add_f32 v[38:39],v[38:39],v[54:55]
v_cvt_pk_bf16_f32 v40,v32,v33
v_cvt_pk_bf16_f32 v41,v34,v35
v_cvt_pk_bf16_f32 v42,v36,v37
v_cvt_pk_bf16_f32 v43,v38,v39
v_lshlrev_b32 v32,16,v40
v_and_b32 v33,s73,v40
v_lshlrev_b32 v34,16,v41
v_and_b32 v35,s73,v41
v_lshlrev_b32 v36,16,v42
v_and_b32 v37,s73,v42
v_lshlrev_b32 v38,16,v43
v_and_b32 v39,s73,v43
v_add_f32 v32,s64,v32
v_add_f32 v33,s64,v33
v_add_f32 v34,s64,v34
v_add_f32 v35,s64,v35
v_add_f32 v36,s64,v36
v_add_f32 v37,s64,v37
v_add_f32 v38,s64,v38
v_add_f32 v39,s64,v39
ds_write_b128 v18,v[32:35] offset:0
ds_write_b128 v18,v[36:39] offset:16
s_waitcnt lgkmcnt(0)
s_barrier
ds_read_b128 v[112:115],v9 offset:0
ds_read_b128 v[116:119],v9 offset:16
ds_read_b128 v[120:123],v9 offset:512
ds_read_b128 v[124:127],v9 offset:528
ds_read_b128 v[96:99],v9 offset:4096
ds_read_b128 v[100:103],v9 offset:4112
ds_read_b128 v[104:107],v9 offset:4608
ds_read_b128 v[108:111],v9 offset:4624
s_add_u32 s61,s61,146800640
s_add_u32 s62,s61,4096
s_waitcnt lgkmcnt(0)
v_fma_f32 v128,v128,v96,v112
v_fma_f32 v129,v129,v97,v113
v_fma_f32 v130,v130,v98,v114
v_fma_f32 v131,v131,v99,v115
v_fma_f32 v132,v132,v100,v116
v_fma_f32 v133,v133,v101,v117
v_fma_f32 v134,v134,v102,v118
v_fma_f32 v135,v135,v103,v119
v_fma_f32 v136,v136,v104,v120
v_fma_f32 v137,v137,v105,v121
v_fma_f32 v138,v138,v106,v122
v_fma_f32 v139,v139,v107,v123
v_fma_f32 v140,v140,v108,v124
v_fma_f32 v141,v141,v109,v125
v_fma_f32 v142,v142,v110,v126
v_fma_f32 v143,v143,v111,v127
v_cvt_pk_bf16_f32 v48,v128,v129
v_cvt_pk_bf16_f32 v49,v130,v131
v_cvt_pk_bf16_f32 v50,v132,v133
v_cvt_pk_bf16_f32 v51,v134,v135
v_cvt_pk_bf16_f32 v52,v136,v137
v_cvt_pk_bf16_f32 v53,v138,v139
v_cvt_pk_bf16_f32 v54,v140,v141
v_cvt_pk_bf16_f32 v55,v142,v143
buffer_store_dwordx4 v[48:51],v10,s[20:23],s61 offen offset:0 sc1
buffer_store_dwordx4 v[52:55],v10,s[20:23],s62 offen offset:0 sc1
v_fma_f32 v144,v144,v96,v112
v_fma_f32 v145,v145,v97,v113
v_fma_f32 v146,v146,v98,v114
v_fma_f32 v147,v147,v99,v115
v_fma_f32 v148,v148,v100,v116
v_fma_f32 v149,v149,v101,v117
v_fma_f32 v150,v150,v102,v118
v_fma_f32 v151,v151,v103,v119
v_fma_f32 v152,v152,v104,v120
v_fma_f32 v153,v153,v105,v121
v_fma_f32 v154,v154,v106,v122
v_fma_f32 v155,v155,v107,v123
v_fma_f32 v156,v156,v108,v124
v_fma_f32 v157,v157,v109,v125
v_fma_f32 v158,v158,v110,v126
v_fma_f32 v159,v159,v111,v127
v_cvt_pk_bf16_f32 v56,v144,v145
v_cvt_pk_bf16_f32 v57,v146,v147
v_cvt_pk_bf16_f32 v58,v148,v149
v_cvt_pk_bf16_f32 v59,v150,v151
v_cvt_pk_bf16_f32 v60,v152,v153
v_cvt_pk_bf16_f32 v61,v154,v155
v_cvt_pk_bf16_f32 v62,v156,v157
v_cvt_pk_bf16_f32 v63,v158,v159
buffer_store_dwordx4 v[56:59],v10,s[20:23],s61 offen offset:64 sc1
buffer_store_dwordx4 v[60:63],v10,s[20:23],s62 offen offset:64 sc1
v_fma_f32 v160,v160,v96,v112
v_fma_f32 v161,v161,v97,v113
v_fma_f32 v162,v162,v98,v114
v_fma_f32 v163,v163,v99,v115
v_fma_f32 v164,v164,v100,v116
v_fma_f32 v165,v165,v101,v117
v_fma_f32 v166,v166,v102,v118
v_fma_f32 v167,v167,v103,v119
v_fma_f32 v168,v168,v104,v120
v_fma_f32 v169,v169,v105,v121
v_fma_f32 v170,v170,v106,v122
v_fma_f32 v171,v171,v107,v123
v_fma_f32 v172,v172,v108,v124
v_fma_f32 v173,v173,v109,v125
v_fma_f32 v174,v174,v110,v126
v_fma_f32 v175,v175,v111,v127
v_cvt_pk_bf16_f32 v64,v160,v161
v_cvt_pk_bf16_f32 v65,v162,v163
v_cvt_pk_bf16_f32 v66,v164,v165
v_cvt_pk_bf16_f32 v67,v166,v167
v_cvt_pk_bf16_f32 v68,v168,v169
v_cvt_pk_bf16_f32 v69,v170,v171
v_cvt_pk_bf16_f32 v70,v172,v173
v_cvt_pk_bf16_f32 v71,v174,v175
buffer_store_dwordx4 v[64:67],v10,s[20:23],s61 offen offset:128 sc1
buffer_store_dwordx4 v[68:71],v10,s[20:23],s62 offen offset:128 sc1
v_fma_f32 v176,v176,v96,v112
v_fma_f32 v177,v177,v97,v113
v_fma_f32 v178,v178,v98,v114
v_fma_f32 v179,v179,v99,v115
v_fma_f32 v180,v180,v100,v116
v_fma_f32 v181,v181,v101,v117
v_fma_f32 v182,v182,v102,v118
v_fma_f32 v183,v183,v103,v119
v_fma_f32 v184,v184,v104,v120
v_fma_f32 v185,v185,v105,v121
v_fma_f32 v186,v186,v106,v122
v_fma_f32 v187,v187,v107,v123
v_fma_f32 v188,v188,v108,v124
v_fma_f32 v189,v189,v109,v125
v_fma_f32 v190,v190,v110,v126
v_fma_f32 v191,v191,v111,v127
v_cvt_pk_bf16_f32 v72,v176,v177
v_cvt_pk_bf16_f32 v73,v178,v179
v_cvt_pk_bf16_f32 v74,v180,v181
v_cvt_pk_bf16_f32 v75,v182,v183
v_cvt_pk_bf16_f32 v76,v184,v185
v_cvt_pk_bf16_f32 v77,v186,v187
v_cvt_pk_bf16_f32 v78,v188,v189
v_cvt_pk_bf16_f32 v79,v190,v191
buffer_store_dwordx4 v[72:75],v10,s[20:23],s61 offen offset:192 sc1
buffer_store_dwordx4 v[76:79],v10,s[20:23],s62 offen offset:192 sc1
s_waitcnt vmcnt(0)
s_barrier
s_cmp_lg_u32 s50,0
s_cbranch_scc1 sig_12
s_mov_b32 s92,s2
s_and_b32 s93,s3,0xffff
s_mov_b32 s94,0x100
s_mov_b32 s95,0x20000
s_add_u32 s64,s88,12
v_mov_b32 v16,1
s_mov_b64 exec,1
buffer_atomic_add v16,off,s[92:95],s64 sc1
s_mov_b64 exec,-1
sig_12:
s_branch fl_disp
fl_dutb:
s_load_dwordx4 s[4:7],s[0:1],96
s_load_dwordx2 s[8:9],s[0:1],0
s_cmp_lg_u32 s58,220
s_cbranch_scc1 nomeas_13
s_cmp_lg_u32 s50,0
s_cbranch_scc1 nomeas_13
s_mov_b64 exec,1
s_mov_b32 s65,1
s_cmp_eq_u32 s56,1
s_cbranch_scc1 pub_14
s_mov_b32 s66,138526720
s_mov_b32 s67,138534912
s_mov_b32 s70,0x7fffffff
s_mov_b32 s71,0x7fffffff
s_mov_b32 s72,8
mlp_15:
s_memtime s[94:95]
s_waitcnt lgkmcnt(0)
buffer_store_dword v16,off,s[20:23],s66 sc1
s_waitcnt vmcnt(0)
s_memtime s[96:97]
s_waitcnt lgkmcnt(0)
s_sub_u32 s96,s96,s94
s_min_u32 s70,s70,s96
s_memtime s[94:95]
s_waitcnt lgkmcnt(0)
buffer_store_dword v16,off,s[20:23],s67 sc1
s_waitcnt vmcnt(0)
s_memtime s[96:97]
s_waitcnt lgkmcnt(0)
s_sub_u32 s96,s96,s94
s_min_u32 s71,s71,s96
s_sub_u32 s72,s72,1
s_cmp_gt_u32 s72,0
s_cbranch_scc1 mlp_15
s_cmp_gt_u32 s71,s70
s_cselect_b32 s65,2,1
pub_14:
s_mov_b32 s92,s2
s_and_b32 s93,s3,0xffff
s_mov_b32 s94,0x100
s_mov_b32 s95,0x20000
v_mov_b32 v16,s65
s_add_u32 s64,s88,20
buffer_store_dword v16,off,s[92:95],s64 sc1
s_mov_b64 exec,-1
nomeas_13:
s_barrier
s_sub_u32 s59,s58,192
s_and_b32 s52,s59,15
s_lshr_b32 s53,s59,4
s_lshl_b32 s64,s50,6
v_add_u32 v14,s64,v1
v_lshrrev_b32 v2,4,v14
v_and_b32 v3,15,v14
v_mul_u32_u24 v13,196608,v2
v_lshl_add_u32 v13,v3,4,v13
s_mul_i32 s54,s53,3145728
s_lshl_b32 s64,s52,9
s_add_u32 s54,s54,s64
s_add_u32 s54,s54,4096
v_lshlrev_b32 v15,1,v14
s_lshl_b32 s55,s53,9
s_mov_b32 s60,0
s_mov_b32 s73,0xffff0000
s_sub_u32 s61,s58,128
s_lshl_b32 s61,s61,15
v_lshlrev_b32 v25,6,v2
v_lshlrev_b32 v24,4,v1
v_and_b32 v2,3,v1
v_lshrrev_b32 v3,2,v1
s_lshl_b32 s64,s60,2
v_add_u32 v4,s64,v2
s_lshl_b32 s65,s50,9
v_lshlrev_b32 v5,4,v3
v_add_u32 v5,s65,v5
v_lshl_add_u32 v8,v4,11,v5
v_lshlrev_b32 v9,1,v5
v_lshrrev_b32 v5,2,v3
v_and_b32 v3,3,v3
s_lshl_b32 s65,s50,13
v_lshlrev_b32 v5,10,v5
v_lshl_add_u32 v5,v3,8,v5
v_lshl_add_u32 v5,v4,4,v5
v_add_u32 v10,s65,v5
s_lshl_b32 s65,s50,9
v_lshlrev_b32 v5,3,v1
v_add_u32 v11,s65,v5
v_lshlrev_b32 v12,3,v2
s_waitcnt lgkmcnt(0)
s_mov_b32 s24,s4
s_and_b32 s25,s5,0xffff
s_mov_b32 s26,0x800
s_mov_b32 s27,0x20000
s_mov_b32 s28,s6
s_and_b32 s29,s7,0xffff
s_mov_b32 s30,0xc00000
s_mov_b32 s31,0x20000
s_mov_b32 s32,s8
s_and_b32 s33,s9,0xffff
s_mov_b32 s34,0x400000
s_mov_b32 s35,0x20000
v_mov_b32 v28,-1
v_mov_b32 v20,0
v_mov_b32 v29,-1
v_mov_b32 v21,0
v_mov_b32 v30,-1
v_mov_b32 v22,0
v_mov_b32 v31,-1
v_mov_b32 v23,0
s_cmp_eq_u32 s58,220
s_cbranch_scc1 fl2_17
s_mov_b32 s62,s59
fl1_16:
s_lshl_b32 s64,s62,2
s_add_u32 s64,s64,s50
s_mul_i32 s64,s64,2048
s_add_u32 s64,s64,142606336
buffer_store_dwordx4 v[28:31],v24,s[20:23],s64 offen offset:0 sc1
buffer_store_dwordx4 v[28:31],v24,s[20:23],s64 offen offset:1024 sc1
s_lshl_b32 s64,s62,2
s_add_u32 s64,s64,s50
s_lshr_b32 s65,s64,6
s_lshl_b32 s65,s65,19
s_and_b32 s64,s64,63
s_mul_i32 s64,s64,2048
s_add_u32 s64,s64,134217728
s_add_u32 s64,s64,s65
buffer_store_dwordx4 v[28:31],v24,s[20:23],s64 offen offset:0 sc1
buffer_store_dwordx4 v[28:31],v24,s[20:23],s64 offen offset:1024 sc1
s_lshl_b32 s64,s62,2
s_add_u32 s64,s64,s50
s_lshr_b32 s65,s64,6
s_lshl_b32 s65,s65,19
s_and_b32 s64,s64,63
s_mul_i32 s64,s64,4096
s_add_u32 s64,s64,134479872
s_add_u32 s64,s64,s65
buffer_store_dwordx4 v[28:31],v24,s[20:23],s64 offen offset:0 sc1
buffer_store_dwordx4 v[28:31],v24,s[20:23],s64 offen offset:1024 sc1
buffer_store_dwordx4 v[28:31],v24,s[20:23],s64 offen offset:2048 sc1
buffer_store_dwordx4 v[28:31],v24,s[20:23],s64 offen offset:3072 sc1
s_lshl_b32 s64,s62,2
s_add_u32 s64,s64,s50
s_mul_i32 s64,s64,1024
s_add_u32 s64,s64,138412032
buffer_store_dwordx4 v[20:23],v24,s[20:23],s64 offen offset:0 sc1
s_cmp_eq_u32 s62,29
s_mov_b32 s62,28
s_cbranch_scc1 fl1_16
fl2_17:
s_waitcnt vmcnt(0)
s_barrier
s_cmp_lg_u32 s50,0
s_cbranch_scc1 sig_18
s_mov_b32 s92,s2
s_and_b32 s93,s3,0xffff
s_mov_b32 s94,0x100
s_mov_b32 s95,0x20000
s_add_u32 s64,s88,24
s_add_u32 s65,s88,32
s_cmp_eq_u32 s58,220
s_cselect_b32 s64,s65,s64
v_mov_b32 v16,1
s_mov_b64 exec,1
buffer_atomic_add v16,off,s[92:95],s64 sc1
s_mov_b64 exec,-1
sig_18:
s_mov_b32 s92,s2
s_and_b32 s93,s3,0xffff
s_mov_b32 s94,0x100
s_mov_b32 s95,0x20000
v_mbcnt_lo_u32_b32 v16,-1,0
v_mbcnt_hi_u32_b32 v16,-1,v16
v_mov_b32 v18,0
v_and_b32 v19,1,v16
v_cmp_eq_u32 vcc,1,v19
v_mov_b32 v19,8192
s_nop 0
v_cndmask_b32 v19,-1,v19,vcc
v_min_u32 v16,31,v16
v_lshlrev_b32 v16,2,v16
s_sub_u32 s66,s88,64
s_cmp_lg_u32 s50,0
s_cbranch_scc1 vot_23
s_mov_b32 s64,10
pre_25:
s_sleep 32
s_sub_u32 s64,s64,1
s_cmp_gt_i32 s64,0
s_cbranch_scc1 pre_25
vpoll_19:
buffer_load_dword v17,v16,s[92:95],s66 offen sc1
s_waitcnt vmcnt(0)
s_cmp_lg_u32 s56,2
s_cbranch_scc1 vck_20
v_cmp_eq_u32 vcc,v17,v19
s_and_b32 s64,vcc_lo,0xffff
s_cmp_eq_u32 s64,65535
s_cbranch_scc1 vck_20
s_mov_b32 s65,0
v_readlane_b32 s64,v17,1
s_lshr_b32 s64,s64,8
s_add_u32 s65,s65,s64
v_readlane_b32 s64,v17,3
s_lshr_b32 s64,s64,8
s_add_u32 s65,s65,s64
v_readlane_b32 s64,v17,5
s_lshr_b32 s64,s64,8
s_add_u32 s65,s65,s64
v_readlane_b32 s64,v17,7
s_lshr_b32 s64,s64,8
s_add_u32 s65,s65,s64
v_readlane_b32 s64,v17,9
s_lshr_b32 s64,s64,8
s_add_u32 s65,s65,s64
v_readlane_b32 s64,v17,11
s_lshr_b32 s64,s64,8
s_add_u32 s65,s65,s64
v_readlane_b32 s64,v17,13
s_lshr_b32 s64,s64,8
s_add_u32 s65,s65,s64
v_readlane_b32 s64,v17,15
s_lshr_b32 s64,s64,8
s_add_u32 s65,s65,s64
s_cmp_ge_u32 s65,256
s_cbranch_scc1 vok_22
s_branch vrt_21
vck_20:
v_cmp_gt_u32 vcc,v18,v17
s_cbranch_vccz vok_22
vrt_21:
s_sleep 48
s_sub_u32 s90,s90,1
s_cmp_gt_i32 s90,0
s_cbranch_scc1 vpoll_19
vok_22:
v_add_u32 v18,160256,v16
ds_write_b32 v18,v17
s_waitcnt lgkmcnt(0)
vot_23:
s_barrier
v_add_u32 v18,160256,v16
ds_read_b32 v17,v18
s_waitcnt lgkmcnt(0)
s_cmp_lg_u32 s56,2
s_cbranch_scc1 vfin_24
v_cmp_eq_u32 vcc,v17,v19
s_and_b32 s64,vcc_lo,0xffff
s_cmp_eq_u32 s64,65535
s_cbranch_scc1 vfin_24
s_mov_b32 s65,0
v_readlane_b32 s64,v17,1
s_lshr_b32 s64,s64,8
s_add_u32 s65,s65,s64
v_readlane_b32 s64,v17,3
s_lshr_b32 s64,s64,8
s_add_u32 s65,s65,s64
v_readlane_b32 s64,v17,5
s_lshr_b32 s64,s64,8
s_add_u32 s65,s65,s64
v_readlane_b32 s64,v17,7
s_lshr_b32 s64,s64,8
s_add_u32 s65,s65,s64
v_readlane_b32 s64,v17,9
s_lshr_b32 s64,s64,8
s_add_u32 s65,s65,s64
v_readlane_b32 s64,v17,11
s_lshr_b32 s64,s64,8
s_add_u32 s65,s65,s64
v_readlane_b32 s64,v17,13
s_lshr_b32 s64,s64,8
s_add_u32 s65,s65,s64
v_readlane_b32 s64,v17,15
s_lshr_b32 s64,s64,8
s_add_u32 s65,s65,s64
s_cmp_ge_u32 s65,256
s_cbranch_scc1 fl_fb
vfin_24:
s_and_b32 s56,s56,1
buffer_load_ushort v16,v15,s[24:27],s55 offen
buffer_load_dwordx4 v[96:99],v13,s[28:31],s54 offen offset:0
buffer_load_dwordx4 v[160:163],v13,s[28:31],s54 offen offset:256
s_add_u32 s54,s54,12288
s_waitcnt vmcnt(3)
buffer_load_dwordx4 v[100:103],v13,s[28:31],s54 offen offset:0
buffer_load_dwordx4 v[164:167],v13,s[28:31],s54 offen offset:256
s_add_u32 s54,s54,12288
s_waitcnt vmcnt(3)
buffer_load_dwordx4 v[104:107],v13,s[28:31],s54 offen offset:0
buffer_load_dwordx4 v[168:171],v13,s[28:31],s54 offen offset:256
s_add_u32 s54,s54,12288
s_waitcnt vmcnt(3)
buffer_load_dwordx4 v[108:111],v13,s[28:31],s54 offen offset:0
buffer_load_dwordx4 v[172:175],v13,s[28:31],s54 offen offset:256
s_add_u32 s54,s54,12288
s_waitcnt vmcnt(3)
buffer_load_dwordx4 v[112:115],v13,s[28:31],s54 offen offset:0
buffer_load_dwordx4 v[176:179],v13,s[28:31],s54 offen offset:256
s_add_u32 s54,s54,12288
s_waitcnt vmcnt(3)
buffer_load_dwordx4 v[116:119],v13,s[28:31],s54 offen offset:0
buffer_load_dwordx4 v[180:183],v13,s[28:31],s54 offen offset:256
s_add_u32 s54,s54,12288
s_waitcnt vmcnt(3)
buffer_load_dwordx4 v[120:123],v13,s[28:31],s54 offen offset:0
buffer_load_dwordx4 v[184:187],v13,s[28:31],s54 offen offset:256
s_add_u32 s54,s54,12288
s_waitcnt vmcnt(3)
buffer_load_dwordx4 v[124:127],v13,s[28:31],s54 offen offset:0
buffer_load_dwordx4 v[188:191],v13,s[28:31],s54 offen offset:256
s_add_u32 s54,s54,12288
s_waitcnt vmcnt(3)
buffer_load_dwordx4 v[128:131],v13,s[28:31],s54 offen offset:0
buffer_load_dwordx4 v[192:195],v13,s[28:31],s54 offen offset:256
s_add_u32 s54,s54,12288
s_waitcnt vmcnt(3)
buffer_load_dwordx4 v[132:135],v13,s[28:31],s54 offen offset:0
buffer_load_dwordx4 v[196:199],v13,s[28:31],s54 offen offset:256
s_add_u32 s54,s54,12288
s_waitcnt vmcnt(3)
buffer_load_dwordx4 v[136:139],v13,s[28:31],s54 offen offset:0
buffer_load_dwordx4 v[200:203],v13,s[28:31],s54 offen offset:256
s_add_u32 s54,s54,12288
s_waitcnt vmcnt(3)
buffer_load_dwordx4 v[140:143],v13,s[28:31],s54 offen offset:0
buffer_load_dwordx4 v[204:207],v13,s[28:31],s54 offen offset:256
s_add_u32 s54,s54,12288
s_waitcnt vmcnt(3)
buffer_load_dwordx4 v[144:147],v13,s[28:31],s54 offen offset:0
buffer_load_dwordx4 v[208:211],v13,s[28:31],s54 offen offset:256
s_add_u32 s54,s54,12288
s_waitcnt vmcnt(3)
buffer_load_dwordx4 v[148:151],v13,s[28:31],s54 offen offset:0
buffer_load_dwordx4 v[212:215],v13,s[28:31],s54 offen offset:256
s_add_u32 s54,s54,12288
s_waitcnt vmcnt(3)
buffer_load_dwordx4 v[152:155],v13,s[28:31],s54 offen offset:0
buffer_load_dwordx4 v[216:219],v13,s[28:31],s54 offen offset:256
s_add_u32 s54,s54,12288
s_waitcnt vmcnt(3)
buffer_load_dwordx4 v[156:159],v13,s[28:31],s54 offen offset:0
buffer_load_dwordx4 v[220:223],v13,s[28:31],s54 offen offset:256
s_waitcnt vmcnt(3)
s_add_u32 s64,s61,0
buffer_load_dwordx4 v[48:51],v8,s[32:35],s64 offen offset:0
buffer_load_dwordx4 v[52:55],v8,s[32:35],s64 offen offset:256
s_add_u32 s64,s61,8192
buffer_load_dwordx4 v[56:59],v8,s[32:35],s64 offen offset:0
buffer_load_dwordx4 v[60:63],v8,s[32:35],s64 offen offset:256
s_add_u32 s64,s61,16384
buffer_load_dwordx4 v[64:67],v8,s[32:35],s64 offen offset:0
buffer_load_dwordx4 v[68:71],v8,s[32:35],s64 offen offset:256
s_add_u32 s64,s61,24576
buffer_load_dwordx4 v[72:75],v8,s[32:35],s64 offen offset:0
buffer_load_dwordx4 v[76:79],v8,s[32:35],s64 offen offset:256
s_waitcnt vmcnt(40)
v_lshlrev_b32 v16,16,v16
v_mul_f32 v17,0xbfb8aa3b,v16
v_exp_f32 v17,v17
s_nop 0
v_add_f32 v17,1.0,v17
v_rcp_f32 v17,v17
s_nop 0
v_mul_f32 v17,v17,v16
v_cvt_pk_bf16_f32 v17,v17,v17
v_and_b32 v17,s73,v17
v_lshlrev_b32 v18,2,v14
ds_write_b32 v18,v17 offset:8192
s_waitcnt lgkmcnt(0)
s_barrier
ds_read_b128 v[32:35],v25 offset:8192
ds_read_b128 v[36:39],v25 offset:8208
ds_read_b128 v[40:43],v25 offset:8224
ds_read_b128 v[44:47],v25 offset:8240
v_mov_b32 v80,0
v_mov_b32 v81,0
v_mov_b32 v82,0
v_mov_b32 v83,0
v_mov_b32 v84,0
v_mov_b32 v85,0
v_mov_b32 v86,0
v_mov_b32 v87,0
v_mov_b32 v88,0
v_mov_b32 v89,0
v_mov_b32 v90,0
v_mov_b32 v91,0
v_mov_b32 v92,0
v_mov_b32 v93,0
v_mov_b32 v94,0
v_mov_b32 v95,0
s_waitcnt lgkmcnt(0)
s_waitcnt vmcnt(39)
v_lshlrev_b32 v16,16,v96
v_and_b32 v17,s73,v96
v_pk_fma_f32 v[80:81],v[16:17],v[32:33],v[80:81] op_sel:[0,0,0] op_sel_hi:[1,0,1]
v_lshlrev_b32 v18,16,v97
v_and_b32 v19,s73,v97
v_pk_fma_f32 v[82:83],v[18:19],v[32:33],v[82:83] op_sel:[0,0,0] op_sel_hi:[1,0,1]
v_lshlrev_b32 v16,16,v98
v_and_b32 v17,s73,v98
v_pk_fma_f32 v[84:85],v[16:17],v[32:33],v[84:85] op_sel:[0,0,0] op_sel_hi:[1,0,1]
v_lshlrev_b32 v18,16,v99
v_and_b32 v19,s73,v99
v_pk_fma_f32 v[86:87],v[18:19],v[32:33],v[86:87] op_sel:[0,0,0] op_sel_hi:[1,0,1]
s_waitcnt vmcnt(38)
v_lshlrev_b32 v16,16,v160
v_and_b32 v17,s73,v160
v_pk_fma_f32 v[88:89],v[16:17],v[32:33],v[88:89] op_sel:[0,0,0] op_sel_hi:[1,0,1]
v_lshlrev_b32 v18,16,v161
v_and_b32 v19,s73,v161
v_pk_fma_f32 v[90:91],v[18:19],v[32:33],v[90:91] op_sel:[0,0,0] op_sel_hi:[1,0,1]
v_lshlrev_b32 v16,16,v162
v_and_b32 v17,s73,v162
v_pk_fma_f32 v[92:93],v[16:17],v[32:33],v[92:93] op_sel:[0,0,0] op_sel_hi:[1,0,1]
v_lshlrev_b32 v18,16,v163
v_and_b32 v19,s73,v163
v_pk_fma_f32 v[94:95],v[18:19],v[32:33],v[94:95] op_sel:[0,0,0] op_sel_hi:[1,0,1]
s_waitcnt vmcnt(37)
v_lshlrev_b32 v16,16,v100
v_and_b32 v17,s73,v100
v_pk_fma_f32 v[80:81],v[16:17],v[32:33],v[80:81] op_sel:[0,1,0] op_sel_hi:[1,1,1]
v_lshlrev_b32 v18,16,v101
v_and_b32 v19,s73,v101
v_pk_fma_f32 v[82:83],v[18:19],v[32:33],v[82:83] op_sel:[0,1,0] op_sel_hi:[1,1,1]
v_lshlrev_b32 v16,16,v102
v_and_b32 v17,s73,v102
v_pk_fma_f32 v[84:85],v[16:17],v[32:33],v[84:85] op_sel:[0,1,0] op_sel_hi:[1,1,1]
v_lshlrev_b32 v18,16,v103
v_and_b32 v19,s73,v103
v_pk_fma_f32 v[86:87],v[18:19],v[32:33],v[86:87] op_sel:[0,1,0] op_sel_hi:[1,1,1]
s_waitcnt vmcnt(36)
v_lshlrev_b32 v16,16,v164
v_and_b32 v17,s73,v164
v_pk_fma_f32 v[88:89],v[16:17],v[32:33],v[88:89] op_sel:[0,1,0] op_sel_hi:[1,1,1]
v_lshlrev_b32 v18,16,v165
v_and_b32 v19,s73,v165
v_pk_fma_f32 v[90:91],v[18:19],v[32:33],v[90:91] op_sel:[0,1,0] op_sel_hi:[1,1,1]
v_lshlrev_b32 v16,16,v166
v_and_b32 v17,s73,v166
v_pk_fma_f32 v[92:93],v[16:17],v[32:33],v[92:93] op_sel:[0,1,0] op_sel_hi:[1,1,1]
v_lshlrev_b32 v18,16,v167
v_and_b32 v19,s73,v167
v_pk_fma_f32 v[94:95],v[18:19],v[32:33],v[94:95] op_sel:[0,1,0] op_sel_hi:[1,1,1]
s_waitcnt vmcnt(35)
v_lshlrev_b32 v16,16,v104
v_and_b32 v17,s73,v104
v_pk_fma_f32 v[80:81],v[16:17],v[34:35],v[80:81] op_sel:[0,0,0] op_sel_hi:[1,0,1]
v_lshlrev_b32 v18,16,v105
v_and_b32 v19,s73,v105
v_pk_fma_f32 v[82:83],v[18:19],v[34:35],v[82:83] op_sel:[0,0,0] op_sel_hi:[1,0,1]
v_lshlrev_b32 v16,16,v106
v_and_b32 v17,s73,v106
v_pk_fma_f32 v[84:85],v[16:17],v[34:35],v[84:85] op_sel:[0,0,0] op_sel_hi:[1,0,1]
v_lshlrev_b32 v18,16,v107
v_and_b32 v19,s73,v107
v_pk_fma_f32 v[86:87],v[18:19],v[34:35],v[86:87] op_sel:[0,0,0] op_sel_hi:[1,0,1]
s_waitcnt vmcnt(34)
v_lshlrev_b32 v16,16,v168
v_and_b32 v17,s73,v168
v_pk_fma_f32 v[88:89],v[16:17],v[34:35],v[88:89] op_sel:[0,0,0] op_sel_hi:[1,0,1]
v_lshlrev_b32 v18,16,v169
v_and_b32 v19,s73,v169
v_pk_fma_f32 v[90:91],v[18:19],v[34:35],v[90:91] op_sel:[0,0,0] op_sel_hi:[1,0,1]
v_lshlrev_b32 v16,16,v170
v_and_b32 v17,s73,v170
v_pk_fma_f32 v[92:93],v[16:17],v[34:35],v[92:93] op_sel:[0,0,0] op_sel_hi:[1,0,1]
v_lshlrev_b32 v18,16,v171
v_and_b32 v19,s73,v171
v_pk_fma_f32 v[94:95],v[18:19],v[34:35],v[94:95] op_sel:[0,0,0] op_sel_hi:[1,0,1]
s_waitcnt vmcnt(33)
v_lshlrev_b32 v16,16,v108
v_and_b32 v17,s73,v108
v_pk_fma_f32 v[80:81],v[16:17],v[34:35],v[80:81] op_sel:[0,1,0] op_sel_hi:[1,1,1]
v_lshlrev_b32 v18,16,v109
v_and_b32 v19,s73,v109
v_pk_fma_f32 v[82:83],v[18:19],v[34:35],v[82:83] op_sel:[0,1,0] op_sel_hi:[1,1,1]
v_lshlrev_b32 v16,16,v110
v_and_b32 v17,s73,v110
v_pk_fma_f32 v[84:85],v[16:17],v[34:35],v[84:85] op_sel:[0,1,0] op_sel_hi:[1,1,1]
v_lshlrev_b32 v18,16,v111
v_and_b32 v19,s73,v111
v_pk_fma_f32 v[86:87],v[18:19],v[34:35],v[86:87] op_sel:[0,1,0] op_sel_hi:[1,1,1]
s_waitcnt vmcnt(32)
v_lshlrev_b32 v16,16,v172
v_and_b32 v17,s73,v172
v_pk_fma_f32 v[88:89],v[16:17],v[34:35],v[88:89] op_sel:[0,1,0] op_sel_hi:[1,1,1]
v_lshlrev_b32 v18,16,v173
v_and_b32 v19,s73,v173
v_pk_fma_f32 v[90:91],v[18:19],v[34:35],v[90:91] op_sel:[0,1,0] op_sel_hi:[1,1,1]
v_lshlrev_b32 v16,16,v174
v_and_b32 v17,s73,v174
v_pk_fma_f32 v[92:93],v[16:17],v[34:35],v[92:93] op_sel:[0,1,0] op_sel_hi:[1,1,1]
v_lshlrev_b32 v18,16,v175
v_and_b32 v19,s73,v175
v_pk_fma_f32 v[94:95],v[18:19],v[34:35],v[94:95] op_sel:[0,1,0] op_sel_hi:[1,1,1]
s_waitcnt vmcnt(31)
v_lshlrev_b32 v16,16,v112
v_and_b32 v17,s73,v112
v_pk_fma_f32 v[80:81],v[16:17],v[36:37],v[80:81] op_sel:[0,0,0] op_sel_hi:[1,0,1]
v_lshlrev_b32 v18,16,v113
v_and_b32 v19,s73,v113
v_pk_fma_f32 v[82:83],v[18:19],v[36:37],v[82:83] op_sel:[0,0,0] op_sel_hi:[1,0,1]
v_lshlrev_b32 v16,16,v114
v_and_b32 v17,s73,v114
v_pk_fma_f32 v[84:85],v[16:17],v[36:37],v[84:85] op_sel:[0,0,0] op_sel_hi:[1,0,1]
v_lshlrev_b32 v18,16,v115
v_and_b32 v19,s73,v115
v_pk_fma_f32 v[86:87],v[18:19],v[36:37],v[86:87] op_sel:[0,0,0] op_sel_hi:[1,0,1]
s_waitcnt vmcnt(30)
v_lshlrev_b32 v16,16,v176
v_and_b32 v17,s73,v176
v_pk_fma_f32 v[88:89],v[16:17],v[36:37],v[88:89] op_sel:[0,0,0] op_sel_hi:[1,0,1]
v_lshlrev_b32 v18,16,v177
v_and_b32 v19,s73,v177
v_pk_fma_f32 v[90:91],v[18:19],v[36:37],v[90:91] op_sel:[0,0,0] op_sel_hi:[1,0,1]
v_lshlrev_b32 v16,16,v178
v_and_b32 v17,s73,v178
v_pk_fma_f32 v[92:93],v[16:17],v[36:37],v[92:93] op_sel:[0,0,0] op_sel_hi:[1,0,1]
v_lshlrev_b32 v18,16,v179
v_and_b32 v19,s73,v179
v_pk_fma_f32 v[94:95],v[18:19],v[36:37],v[94:95] op_sel:[0,0,0] op_sel_hi:[1,0,1]
s_waitcnt vmcnt(29)
v_lshlrev_b32 v16,16,v116
v_and_b32 v17,s73,v116
v_pk_fma_f32 v[80:81],v[16:17],v[36:37],v[80:81] op_sel:[0,1,0] op_sel_hi:[1,1,1]
v_lshlrev_b32 v18,16,v117
v_and_b32 v19,s73,v117
v_pk_fma_f32 v[82:83],v[18:19],v[36:37],v[82:83] op_sel:[0,1,0] op_sel_hi:[1,1,1]
v_lshlrev_b32 v16,16,v118
v_and_b32 v17,s73,v118
v_pk_fma_f32 v[84:85],v[16:17],v[36:37],v[84:85] op_sel:[0,1,0] op_sel_hi:[1,1,1]
v_lshlrev_b32 v18,16,v119
v_and_b32 v19,s73,v119
v_pk_fma_f32 v[86:87],v[18:19],v[36:37],v[86:87] op_sel:[0,1,0] op_sel_hi:[1,1,1]
s_waitcnt vmcnt(28)
v_lshlrev_b32 v16,16,v180
v_and_b32 v17,s73,v180
v_pk_fma_f32 v[88:89],v[16:17],v[36:37],v[88:89] op_sel:[0,1,0] op_sel_hi:[1,1,1]
v_lshlrev_b32 v18,16,v181
v_and_b32 v19,s73,v181
v_pk_fma_f32 v[90:91],v[18:19],v[36:37],v[90:91] op_sel:[0,1,0] op_sel_hi:[1,1,1]
v_lshlrev_b32 v16,16,v182
v_and_b32 v17,s73,v182
v_pk_fma_f32 v[92:93],v[16:17],v[36:37],v[92:93] op_sel:[0,1,0] op_sel_hi:[1,1,1]
v_lshlrev_b32 v18,16,v183
v_and_b32 v19,s73,v183
v_pk_fma_f32 v[94:95],v[18:19],v[36:37],v[94:95] op_sel:[0,1,0] op_sel_hi:[1,1,1]
s_waitcnt vmcnt(27)
v_lshlrev_b32 v16,16,v120
v_and_b32 v17,s73,v120
v_pk_fma_f32 v[80:81],v[16:17],v[38:39],v[80:81] op_sel:[0,0,0] op_sel_hi:[1,0,1]
v_lshlrev_b32 v18,16,v121
v_and_b32 v19,s73,v121
v_pk_fma_f32 v[82:83],v[18:19],v[38:39],v[82:83] op_sel:[0,0,0] op_sel_hi:[1,0,1]
v_lshlrev_b32 v16,16,v122
v_and_b32 v17,s73,v122
v_pk_fma_f32 v[84:85],v[16:17],v[38:39],v[84:85] op_sel:[0,0,0] op_sel_hi:[1,0,1]
v_lshlrev_b32 v18,16,v123
v_and_b32 v19,s73,v123
v_pk_fma_f32 v[86:87],v[18:19],v[38:39],v[86:87] op_sel:[0,0,0] op_sel_hi:[1,0,1]
s_waitcnt vmcnt(26)
v_lshlrev_b32 v16,16,v184
v_and_b32 v17,s73,v184
v_pk_fma_f32 v[88:89],v[16:17],v[38:39],v[88:89] op_sel:[0,0,0] op_sel_hi:[1,0,1]
v_lshlrev_b32 v18,16,v185
v_and_b32 v19,s73,v185
v_pk_fma_f32 v[90:91],v[18:19],v[38:39],v[90:91] op_sel:[0,0,0] op_sel_hi:[1,0,1]
v_lshlrev_b32 v16,16,v186
v_and_b32 v17,s73,v186
v_pk_fma_f32 v[92:93],v[16:17],v[38:39],v[92:93] op_sel:[0,0,0] op_sel_hi:[1,0,1]
v_lshlrev_b32 v18,16,v187
v_and_b32 v19,s73,v187
v_pk_fma_f32 v[94:95],v[18:19],v[38:39],v[94:95] op_sel:[0,0,0] op_sel_hi:[1,0,1]
s_waitcnt vmcnt(25)
v_lshlrev_b32 v16,16,v124
v_and_b32 v17,s73,v124
v_pk_fma_f32 v[80:81],v[16:17],v[38:39],v[80:81] op_sel:[0,1,0] op_sel_hi:[1,1,1]
v_lshlrev_b32 v18,16,v125
v_and_b32 v19,s73,v125
v_pk_fma_f32 v[82:83],v[18:19],v[38:39],v[82:83] op_sel:[0,1,0] op_sel_hi:[1,1,1]
v_lshlrev_b32 v16,16,v126
v_and_b32 v17,s73,v126
v_pk_fma_f32 v[84:85],v[16:17],v[38:39],v[84:85] op_sel:[0,1,0] op_sel_hi:[1,1,1]
v_lshlrev_b32 v18,16,v127
v_and_b32 v19,s73,v127
v_pk_fma_f32 v[86:87],v[18:19],v[38:39],v[86:87] op_sel:[0,1,0] op_sel_hi:[1,1,1]
s_waitcnt vmcnt(24)
v_lshlrev_b32 v16,16,v188
v_and_b32 v17,s73,v188
v_pk_fma_f32 v[88:89],v[16:17],v[38:39],v[88:89] op_sel:[0,1,0] op_sel_hi:[1,1,1]
v_lshlrev_b32 v18,16,v189
v_and_b32 v19,s73,v189
v_pk_fma_f32 v[90:91],v[18:19],v[38:39],v[90:91] op_sel:[0,1,0] op_sel_hi:[1,1,1]
v_lshlrev_b32 v16,16,v190
v_and_b32 v17,s73,v190
v_pk_fma_f32 v[92:93],v[16:17],v[38:39],v[92:93] op_sel:[0,1,0] op_sel_hi:[1,1,1]
v_lshlrev_b32 v18,16,v191
v_and_b32 v19,s73,v191
v_pk_fma_f32 v[94:95],v[18:19],v[38:39],v[94:95] op_sel:[0,1,0] op_sel_hi:[1,1,1]
s_waitcnt vmcnt(23)
v_lshlrev_b32 v16,16,v128
v_and_b32 v17,s73,v128
v_pk_fma_f32 v[80:81],v[16:17],v[40:41],v[80:81] op_sel:[0,0,0] op_sel_hi:[1,0,1]
v_lshlrev_b32 v18,16,v129
v_and_b32 v19,s73,v129
v_pk_fma_f32 v[82:83],v[18:19],v[40:41],v[82:83] op_sel:[0,0,0] op_sel_hi:[1,0,1]
v_lshlrev_b32 v16,16,v130
v_and_b32 v17,s73,v130
v_pk_fma_f32 v[84:85],v[16:17],v[40:41],v[84:85] op_sel:[0,0,0] op_sel_hi:[1,0,1]
v_lshlrev_b32 v18,16,v131
v_and_b32 v19,s73,v131
v_pk_fma_f32 v[86:87],v[18:19],v[40:41],v[86:87] op_sel:[0,0,0] op_sel_hi:[1,0,1]
s_waitcnt vmcnt(22)
v_lshlrev_b32 v16,16,v192
v_and_b32 v17,s73,v192
v_pk_fma_f32 v[88:89],v[16:17],v[40:41],v[88:89] op_sel:[0,0,0] op_sel_hi:[1,0,1]
v_lshlrev_b32 v18,16,v193
v_and_b32 v19,s73,v193
v_pk_fma_f32 v[90:91],v[18:19],v[40:41],v[90:91] op_sel:[0,0,0] op_sel_hi:[1,0,1]
v_lshlrev_b32 v16,16,v194
v_and_b32 v17,s73,v194
v_pk_fma_f32 v[92:93],v[16:17],v[40:41],v[92:93] op_sel:[0,0,0] op_sel_hi:[1,0,1]
v_lshlrev_b32 v18,16,v195
v_and_b32 v19,s73,v195
v_pk_fma_f32 v[94:95],v[18:19],v[40:41],v[94:95] op_sel:[0,0,0] op_sel_hi:[1,0,1]
s_waitcnt vmcnt(21)
v_lshlrev_b32 v16,16,v132
v_and_b32 v17,s73,v132
v_pk_fma_f32 v[80:81],v[16:17],v[40:41],v[80:81] op_sel:[0,1,0] op_sel_hi:[1,1,1]
v_lshlrev_b32 v18,16,v133
v_and_b32 v19,s73,v133
v_pk_fma_f32 v[82:83],v[18:19],v[40:41],v[82:83] op_sel:[0,1,0] op_sel_hi:[1,1,1]
v_lshlrev_b32 v16,16,v134
v_and_b32 v17,s73,v134
v_pk_fma_f32 v[84:85],v[16:17],v[40:41],v[84:85] op_sel:[0,1,0] op_sel_hi:[1,1,1]
v_lshlrev_b32 v18,16,v135
v_and_b32 v19,s73,v135
v_pk_fma_f32 v[86:87],v[18:19],v[40:41],v[86:87] op_sel:[0,1,0] op_sel_hi:[1,1,1]
s_waitcnt vmcnt(20)
v_lshlrev_b32 v16,16,v196
v_and_b32 v17,s73,v196
v_pk_fma_f32 v[88:89],v[16:17],v[40:41],v[88:89] op_sel:[0,1,0] op_sel_hi:[1,1,1]
v_lshlrev_b32 v18,16,v197
v_and_b32 v19,s73,v197
v_pk_fma_f32 v[90:91],v[18:19],v[40:41],v[90:91] op_sel:[0,1,0] op_sel_hi:[1,1,1]
v_lshlrev_b32 v16,16,v198
v_and_b32 v17,s73,v198
v_pk_fma_f32 v[92:93],v[16:17],v[40:41],v[92:93] op_sel:[0,1,0] op_sel_hi:[1,1,1]
v_lshlrev_b32 v18,16,v199
v_and_b32 v19,s73,v199
v_pk_fma_f32 v[94:95],v[18:19],v[40:41],v[94:95] op_sel:[0,1,0] op_sel_hi:[1,1,1]
s_waitcnt vmcnt(19)
v_lshlrev_b32 v16,16,v136
v_and_b32 v17,s73,v136
v_pk_fma_f32 v[80:81],v[16:17],v[42:43],v[80:81] op_sel:[0,0,0] op_sel_hi:[1,0,1]
v_lshlrev_b32 v18,16,v137
v_and_b32 v19,s73,v137
v_pk_fma_f32 v[82:83],v[18:19],v[42:43],v[82:83] op_sel:[0,0,0] op_sel_hi:[1,0,1]
v_lshlrev_b32 v16,16,v138
v_and_b32 v17,s73,v138
v_pk_fma_f32 v[84:85],v[16:17],v[42:43],v[84:85] op_sel:[0,0,0] op_sel_hi:[1,0,1]
v_lshlrev_b32 v18,16,v139
v_and_b32 v19,s73,v139
v_pk_fma_f32 v[86:87],v[18:19],v[42:43],v[86:87] op_sel:[0,0,0] op_sel_hi:[1,0,1]
s_waitcnt vmcnt(18)
v_lshlrev_b32 v16,16,v200
v_and_b32 v17,s73,v200
v_pk_fma_f32 v[88:89],v[16:17],v[42:43],v[88:89] op_sel:[0,0,0] op_sel_hi:[1,0,1]
v_lshlrev_b32 v18,16,v201
v_and_b32 v19,s73,v201
v_pk_fma_f32 v[90:91],v[18:19],v[42:43],v[90:91] op_sel:[0,0,0] op_sel_hi:[1,0,1]
v_lshlrev_b32 v16,16,v202
v_and_b32 v17,s73,v202
v_pk_fma_f32 v[92:93],v[16:17],v[42:43],v[92:93] op_sel:[0,0,0] op_sel_hi:[1,0,1]
v_lshlrev_b32 v18,16,v203
v_and_b32 v19,s73,v203
v_pk_fma_f32 v[94:95],v[18:19],v[42:43],v[94:95] op_sel:[0,0,0] op_sel_hi:[1,0,1]
s_waitcnt vmcnt(17)
v_lshlrev_b32 v16,16,v140
v_and_b32 v17,s73,v140
v_pk_fma_f32 v[80:81],v[16:17],v[42:43],v[80:81] op_sel:[0,1,0] op_sel_hi:[1,1,1]
v_lshlrev_b32 v18,16,v141
v_and_b32 v19,s73,v141
v_pk_fma_f32 v[82:83],v[18:19],v[42:43],v[82:83] op_sel:[0,1,0] op_sel_hi:[1,1,1]
v_lshlrev_b32 v16,16,v142
v_and_b32 v17,s73,v142
v_pk_fma_f32 v[84:85],v[16:17],v[42:43],v[84:85] op_sel:[0,1,0] op_sel_hi:[1,1,1]
v_lshlrev_b32 v18,16,v143
v_and_b32 v19,s73,v143
v_pk_fma_f32 v[86:87],v[18:19],v[42:43],v[86:87] op_sel:[0,1,0] op_sel_hi:[1,1,1]
s_waitcnt vmcnt(16)
v_lshlrev_b32 v16,16,v204
v_and_b32 v17,s73,v204
v_pk_fma_f32 v[88:89],v[16:17],v[42:43],v[88:89] op_sel:[0,1,0] op_sel_hi:[1,1,1]
v_lshlrev_b32 v18,16,v205
v_and_b32 v19,s73,v205
v_pk_fma_f32 v[90:91],v[18:19],v[42:43],v[90:91] op_sel:[0,1,0] op_sel_hi:[1,1,1]
v_lshlrev_b32 v16,16,v206
v_and_b32 v17,s73,v206
v_pk_fma_f32 v[92:93],v[16:17],v[42:43],v[92:93] op_sel:[0,1,0] op_sel_hi:[1,1,1]
v_lshlrev_b32 v18,16,v207
v_and_b32 v19,s73,v207
v_pk_fma_f32 v[94:95],v[18:19],v[42:43],v[94:95] op_sel:[0,1,0] op_sel_hi:[1,1,1]
s_waitcnt vmcnt(15)
v_lshlrev_b32 v16,16,v144
v_and_b32 v17,s73,v144
v_pk_fma_f32 v[80:81],v[16:17],v[44:45],v[80:81] op_sel:[0,0,0] op_sel_hi:[1,0,1]
v_lshlrev_b32 v18,16,v145
v_and_b32 v19,s73,v145
v_pk_fma_f32 v[82:83],v[18:19],v[44:45],v[82:83] op_sel:[0,0,0] op_sel_hi:[1,0,1]
v_lshlrev_b32 v16,16,v146
v_and_b32 v17,s73,v146
v_pk_fma_f32 v[84:85],v[16:17],v[44:45],v[84:85] op_sel:[0,0,0] op_sel_hi:[1,0,1]
v_lshlrev_b32 v18,16,v147
v_and_b32 v19,s73,v147
v_pk_fma_f32 v[86:87],v[18:19],v[44:45],v[86:87] op_sel:[0,0,0] op_sel_hi:[1,0,1]
s_waitcnt vmcnt(14)
v_lshlrev_b32 v16,16,v208
v_and_b32 v17,s73,v208
v_pk_fma_f32 v[88:89],v[16:17],v[44:45],v[88:89] op_sel:[0,0,0] op_sel_hi:[1,0,1]
v_lshlrev_b32 v18,16,v209
v_and_b32 v19,s73,v209
v_pk_fma_f32 v[90:91],v[18:19],v[44:45],v[90:91] op_sel:[0,0,0] op_sel_hi:[1,0,1]
v_lshlrev_b32 v16,16,v210
v_and_b32 v17,s73,v210
v_pk_fma_f32 v[92:93],v[16:17],v[44:45],v[92:93] op_sel:[0,0,0] op_sel_hi:[1,0,1]
v_lshlrev_b32 v18,16,v211
v_and_b32 v19,s73,v211
v_pk_fma_f32 v[94:95],v[18:19],v[44:45],v[94:95] op_sel:[0,0,0] op_sel_hi:[1,0,1]
s_waitcnt vmcnt(13)
v_lshlrev_b32 v16,16,v148
v_and_b32 v17,s73,v148
v_pk_fma_f32 v[80:81],v[16:17],v[44:45],v[80:81] op_sel:[0,1,0] op_sel_hi:[1,1,1]
v_lshlrev_b32 v18,16,v149
v_and_b32 v19,s73,v149
v_pk_fma_f32 v[82:83],v[18:19],v[44:45],v[82:83] op_sel:[0,1,0] op_sel_hi:[1,1,1]
v_lshlrev_b32 v16,16,v150
v_and_b32 v17,s73,v150
v_pk_fma_f32 v[84:85],v[16:17],v[44:45],v[84:85] op_sel:[0,1,0] op_sel_hi:[1,1,1]
v_lshlrev_b32 v18,16,v151
v_and_b32 v19,s73,v151
v_pk_fma_f32 v[86:87],v[18:19],v[44:45],v[86:87] op_sel:[0,1,0] op_sel_hi:[1,1,1]
s_waitcnt vmcnt(12)
v_lshlrev_b32 v16,16,v212
v_and_b32 v17,s73,v212
v_pk_fma_f32 v[88:89],v[16:17],v[44:45],v[88:89] op_sel:[0,1,0] op_sel_hi:[1,1,1]
v_lshlrev_b32 v18,16,v213
v_and_b32 v19,s73,v213
v_pk_fma_f32 v[90:91],v[18:19],v[44:45],v[90:91] op_sel:[0,1,0] op_sel_hi:[1,1,1]
v_lshlrev_b32 v16,16,v214
v_and_b32 v17,s73,v214
v_pk_fma_f32 v[92:93],v[16:17],v[44:45],v[92:93] op_sel:[0,1,0] op_sel_hi:[1,1,1]
v_lshlrev_b32 v18,16,v215
v_and_b32 v19,s73,v215
v_pk_fma_f32 v[94:95],v[18:19],v[44:45],v[94:95] op_sel:[0,1,0] op_sel_hi:[1,1,1]
s_waitcnt vmcnt(11)
v_lshlrev_b32 v16,16,v152
v_and_b32 v17,s73,v152
v_pk_fma_f32 v[80:81],v[16:17],v[46:47],v[80:81] op_sel:[0,0,0] op_sel_hi:[1,0,1]
v_lshlrev_b32 v18,16,v153
v_and_b32 v19,s73,v153
v_pk_fma_f32 v[82:83],v[18:19],v[46:47],v[82:83] op_sel:[0,0,0] op_sel_hi:[1,0,1]
v_lshlrev_b32 v16,16,v154
v_and_b32 v17,s73,v154
v_pk_fma_f32 v[84:85],v[16:17],v[46:47],v[84:85] op_sel:[0,0,0] op_sel_hi:[1,0,1]
v_lshlrev_b32 v18,16,v155
v_and_b32 v19,s73,v155
v_pk_fma_f32 v[86:87],v[18:19],v[46:47],v[86:87] op_sel:[0,0,0] op_sel_hi:[1,0,1]
s_waitcnt vmcnt(10)
v_lshlrev_b32 v16,16,v216
v_and_b32 v17,s73,v216
v_pk_fma_f32 v[88:89],v[16:17],v[46:47],v[88:89] op_sel:[0,0,0] op_sel_hi:[1,0,1]
v_lshlrev_b32 v18,16,v217
v_and_b32 v19,s73,v217
v_pk_fma_f32 v[90:91],v[18:19],v[46:47],v[90:91] op_sel:[0,0,0] op_sel_hi:[1,0,1]
v_lshlrev_b32 v16,16,v218
v_and_b32 v17,s73,v218
v_pk_fma_f32 v[92:93],v[16:17],v[46:47],v[92:93] op_sel:[0,0,0] op_sel_hi:[1,0,1]
v_lshlrev_b32 v18,16,v219
v_and_b32 v19,s73,v219
v_pk_fma_f32 v[94:95],v[18:19],v[46:47],v[94:95] op_sel:[0,0,0] op_sel_hi:[1,0,1]
s_waitcnt vmcnt(9)
v_lshlrev_b32 v16,16,v156
v_and_b32 v17,s73,v156
v_pk_fma_f32 v[80:81],v[16:17],v[46:47],v[80:81] op_sel:[0,1,0] op_sel_hi:[1,1,1]
v_lshlrev_b32 v18,16,v157
v_and_b32 v19,s73,v157
v_pk_fma_f32 v[82:83],v[18:19],v[46:47],v[82:83] op_sel:[0,1,0] op_sel_hi:[1,1,1]
v_lshlrev_b32 v16,16,v158
v_and_b32 v17,s73,v158
v_pk_fma_f32 v[84:85],v[16:17],v[46:47],v[84:85] op_sel:[0,1,0] op_sel_hi:[1,1,1]
v_lshlrev_b32 v18,16,v159
v_and_b32 v19,s73,v159
v_pk_fma_f32 v[86:87],v[18:19],v[46:47],v[86:87] op_sel:[0,1,0] op_sel_hi:[1,1,1]
s_waitcnt vmcnt(8)
v_lshlrev_b32 v16,16,v220
v_and_b32 v17,s73,v220
v_pk_fma_f32 v[88:89],v[16:17],v[46:47],v[88:89] op_sel:[0,1,0] op_sel_hi:[1,1,1]
v_lshlrev_b32 v18,16,v221
v_and_b32 v19,s73,v221
v_pk_fma_f32 v[90:91],v[18:19],v[46:47],v[90:91] op_sel:[0,1,0] op_sel_hi:[1,1,1]
v_lshlrev_b32 v16,16,v222
v_and_b32 v17,s73,v222
v_pk_fma_f32 v[92:93],v[16:17],v[46:47],v[92:93] op_sel:[0,1,0] op_sel_hi:[1,1,1]
v_lshlrev_b32 v18,16,v223
v_and_b32 v19,s73,v223
v_pk_fma_f32 v[94:95],v[18:19],v[46:47],v[94:95] op_sel:[0,1,0] op_sel_hi:[1,1,1]
v_lshlrev_b32 v18,5,v14
ds_write_b128 v18,v[80:83] offset:16384
ds_write_b128 v18,v[84:87] offset:16400
ds_write_b128 v18,v[88:91] offset:24576
ds_write_b128 v18,v[92:95] offset:24592
v_and_b32 v18,127,v14
v_lshlrev_b32 v18,2,v18
v_lshrrev_b32 v19,7,v14
v_lshl_add_u32 v19,v19,13,v18
s_waitcnt lgkmcnt(0)
s_barrier
ds_read_b32 v32,v19 offset:16384
ds_read_b32 v33,v19 offset:16896
ds_read_b32 v34,v19 offset:17408
ds_read_b32 v35,v19 offset:17920
ds_read_b32 v36,v19 offset:18432
ds_read_b32 v37,v19 offset:18944
ds_read_b32 v38,v19 offset:19456
ds_read_b32 v39,v19 offset:19968
ds_read_b32 v40,v19 offset:20480
ds_read_b32 v41,v19 offset:20992
ds_read_b32 v42,v19 offset:21504
ds_read_b32 v43,v19 offset:22016
s_waitcnt lgkmcnt(4)
ds_read_b32 v44,v19 offset:22528
ds_read_b32 v45,v19 offset:23040
ds_read_b32 v46,v19 offset:23552
ds_read_b32 v47,v19 offset:24064
s_waitcnt lgkmcnt(0)
v_pk_add_f32 v[32:33],v[32:33],v[40:41]
v_pk_add_f32 v[34:35],v[34:35],v[42:43]
v_pk_add_f32 v[36:37],v[36:37],v[44:45]
v_pk_add_f32 v[38:39],v[38:39],v[46:47]
v_pk_add_f32 v[32:33],v[32:33],v[36:37]
v_pk_add_f32 v[34:35],v[34:35],v[38:39]
v_pk_add_f32 v[32:33],v[32:33],v[34:35]
v_add_f32 v32,v32,v33
s_mul_i32 s64,s53,24576
s_lshl_b32 s65,s52,10
s_add_u32 s64,s64,s65
s_add_u32 s64,s64,267395072
v_lshlrev_b32 v18,2,v14
buffer_store_dword v32,v18,s[20:23],s64 offen sc1
s_cmp_eq_u32 s58,220
s_cbranch_scc1 fl2_27
s_mov_b32 s62,s59
fl1_26:
s_lshl_b32 s64,s62,2
s_add_u32 s64,s64,s50
s_mul_i32 s64,s64,14336
s_add_u32 s64,s64,143130624
buffer_store_dwordx4 v[28:31],v24,s[20:23],s64 offen offset:0 sc1
s_waitcnt vmcnt(3)
buffer_store_dwordx4 v[28:31],v24,s[20:23],s64 offen offset:1024 sc1
s_waitcnt vmcnt(3)
buffer_store_dwordx4 v[28:31],v24,s[20:23],s64 offen offset:2048 sc1
s_waitcnt vmcnt(3)
buffer_store_dwordx4 v[28:31],v24,s[20:23],s64 offen offset:3072 sc1
s_waitcnt vmcnt(3)
s_add_u32 s64,s64,4096
buffer_store_dwordx4 v[28:31],v24,s[20:23],s64 offen offset:0 sc1
s_waitcnt vmcnt(3)
buffer_store_dwordx4 v[28:31],v24,s[20:23],s64 offen offset:1024 sc1
s_waitcnt vmcnt(3)
buffer_store_dwordx4 v[28:31],v24,s[20:23],s64 offen offset:2048 sc1
s_waitcnt vmcnt(3)
buffer_store_dwordx4 v[28:31],v24,s[20:23],s64 offen offset:3072 sc1
s_waitcnt vmcnt(3)
s_add_u32 s64,s64,4096
buffer_store_dwordx4 v[28:31],v24,s[20:23],s64 offen offset:0 sc1
s_waitcnt vmcnt(3)
buffer_store_dwordx4 v[28:31],v24,s[20:23],s64 offen offset:1024 sc1
s_waitcnt vmcnt(3)
buffer_store_dwordx4 v[28:31],v24,s[20:23],s64 offen offset:2048 sc1
s_waitcnt vmcnt(3)
buffer_store_dwordx4 v[28:31],v24,s[20:23],s64 offen offset:3072 sc1
s_waitcnt vmcnt(3)
s_add_u32 s64,s64,4096
buffer_store_dwordx4 v[28:31],v24,s[20:23],s64 offen offset:0 sc1
s_waitcnt vmcnt(3)
buffer_store_dwordx4 v[28:31],v24,s[20:23],s64 offen offset:1024 sc1
s_waitcnt vmcnt(3)
s_lshl_b32 s64,s62,2
s_add_u32 s64,s64,s50
s_mul_i32 s64,s64,6144
s_add_u32 s64,s64,167772160
buffer_store_dwordx4 v[28:31],v24,s[20:23],s64 offen offset:0 sc1
s_waitcnt vmcnt(3)
buffer_store_dwordx4 v[28:31],v24,s[20:23],s64 offen offset:1024 sc1
s_waitcnt vmcnt(3)
buffer_store_dwordx4 v[28:31],v24,s[20:23],s64 offen offset:2048 sc1
s_waitcnt vmcnt(3)
buffer_store_dwordx4 v[28:31],v24,s[20:23],s64 offen offset:3072 sc1
s_waitcnt vmcnt(3)
s_add_u32 s64,s64,4096
buffer_store_dwordx4 v[28:31],v24,s[20:23],s64 offen offset:0 sc1
s_waitcnt vmcnt(3)
buffer_store_dwordx4 v[28:31],v24,s[20:23],s64 offen offset:1024 sc1
s_waitcnt vmcnt(3)
s_and_b32 s64,s62,31
s_lshl_b32 s64,s64,10
s_add_u32 s64,s64,209715200
s_bitcmp1_b32 s62,5
s_cselect_b32 s65,4227072,0
s_add_u32 s64,s64,s65
buffer_store_dwordx4 v[20:23],v24,s[20:23],s64 offen sc1
s_cmp_eq_u32 s62,29
s_mov_b32 s62,28
s_cbranch_scc1 fl1_26
fl2_27:
s_waitcnt vmcnt(0)
s_barrier
s_cmp_lg_u32 s50,0
s_cbranch_scc1 sig_28
s_mov_b32 s92,s2
s_and_b32 s93,s3,0xffff
s_mov_b32 s94,0x100
s_mov_b32 s95,0x20000
s_add_u32 s64,s88,4
s_add_u32 s65,s88,8
s_cmp_eq_u32 s58,220
s_cselect_b32 s64,s65,s64
v_mov_b32 v16,1
s_mov_b64 exec,1
buffer_atomic_add v16,off,s[92:95],s64 sc1
s_mov_b64 exec,-1
sig_28:
v_lshlrev_b32 v128,16,v48
v_and_b32 v129,s73,v48
v_lshlrev_b32 v130,16,v49
v_and_b32 v131,s73,v49
v_lshlrev_b32 v132,16,v50
v_and_b32 v133,s73,v50
v_lshlrev_b32 v134,16,v51
v_and_b32 v135,s73,v51
v_lshlrev_b32 v136,16,v52
v_and_b32 v137,s73,v52
v_lshlrev_b32 v138,16,v53
v_and_b32 v139,s73,v53
v_lshlrev_b32 v140,16,v54
v_and_b32 v141,s73,v54
v_lshlrev_b32 v142,16,v55
v_and_b32 v143,s73,v55
v_lshlrev_b32 v144,16,v56
v_and_b32 v145,s73,v56
v_lshlrev_b32 v146,16,v57
v_and_b32 v147,s73,v57
v_lshlrev_b32 v148,16,v58
v_and_b32 v149,s73,v58
v_lshlrev_b32 v150,16,v59
v_and_b32 v151,s73,v59
v_lshlrev_b32 v152,16,v60
v_and_b32 v153,s73,v60
v_lshlrev_b32 v154,16,v61
v_and_b32 v155,s73,v61
v_lshlrev_b32 v156,16,v62
v_and_b32 v157,s73,v62
v_lshlrev_b32 v158,16,v63
v_and_b32 v159,s73,v63
v_lshlrev_b32 v160,16,v64
v_and_b32 v161,s73,v64
v_lshlrev_b32 v162,16,v65
v_and_b32 v163,s73,v65
v_lshlrev_b32 v164,16,v66
v_and_b32 v165,s73,v66
v_lshlrev_b32 v166,16,v67
v_and_b32 v167,s73,v67
v_lshlrev_b32 v168,16,v68
v_and_b32 v169,s73,v68
v_lshlrev_b32 v170,16,v69
v_and_b32 v171,s73,v69
v_lshlrev_b32 v172,16,v70
v_and_b32 v173,s73,v70
v_lshlrev_b32 v174,16,v71
v_and_b32 v175,s73,v71
v_lshlrev_b32 v176,16,v72
v_and_b32 v177,s73,v72
v_lshlrev_b32 v178,16,v73
v_and_b32 v179,s73,v73
v_lshlrev_b32 v180,16,v74
v_and_b32 v181,s73,v74
v_lshlrev_b32 v182,16,v75
v_and_b32 v183,s73,v75
v_lshlrev_b32 v184,16,v76
v_and_b32 v185,s73,v76
v_lshlrev_b32 v186,16,v77
v_and_b32 v187,s73,v77
v_lshlrev_b32 v188,16,v78
v_and_b32 v189,s73,v78
v_lshlrev_b32 v190,16,v79
v_and_b32 v191,s73,v79
v_add_f32 v208,v128,v129
v_mul_f32 v209,v128,v128
v_add_f32 v210,v130,v131
v_mul_f32 v211,v129,v129
v_fmac_f32 v209,v130,v130
v_fmac_f32 v211,v131,v131
v_add_f32 v208,v208,v132
v_fmac_f32 v209,v132,v132
v_add_f32 v210,v210,v133
v_fmac_f32 v211,v133,v133
v_add_f32 v208,v208,v134
v_fmac_f32 v209,v134,v134
v_add_f32 v210,v210,v135
v_fmac_f32 v211,v135,v135
v_add_f32 v208,v208,v136
v_fmac_f32 v209,v136,v136
v_add_f32 v210,v210,v137
v_fmac_f32 v211,v137,v137
v_add_f32 v208,v208,v138
v_fmac_f32 v209,v138,v138
v_add_f32 v210,v210,v139
v_fmac_f32 v211,v139,v139
v_add_f32 v208,v208,v140
v_fmac_f32 v209,v140,v140
v_add_f32 v210,v210,v141
v_fmac_f32 v211,v141,v141
v_add_f32 v208,v208,v142
v_fmac_f32 v209,v142,v142
v_add_f32 v210,v210,v143
v_fmac_f32 v211,v143,v143
v_add_f32 v208,v208,v210
v_add_f32 v209,v209,v211
v_add_f32 v212,v144,v145
v_mul_f32 v213,v144,v144
v_add_f32 v214,v146,v147
v_mul_f32 v215,v145,v145
v_fmac_f32 v213,v146,v146
v_fmac_f32 v215,v147,v147
v_add_f32 v212,v212,v148
v_fmac_f32 v213,v148,v148
v_add_f32 v214,v214,v149
v_fmac_f32 v215,v149,v149
v_add_f32 v212,v212,v150
v_fmac_f32 v213,v150,v150
v_add_f32 v214,v214,v151
v_fmac_f32 v215,v151,v151
v_add_f32 v212,v212,v152
v_fmac_f32 v213,v152,v152
v_add_f32 v214,v214,v153
v_fmac_f32 v215,v153,v153
v_add_f32 v212,v212,v154
v_fmac_f32 v213,v154,v154
v_add_f32 v214,v214,v155
v_fmac_f32 v215,v155,v155
v_add_f32 v212,v212,v156
v_fmac_f32 v213,v156,v156
v_add_f32 v214,v214,v157
v_fmac_f32 v215,v157,v157
v_add_f32 v212,v212,v158
v_fmac_f32 v213,v158,v158
v_add_f32 v214,v214,v159
v_fmac_f32 v215,v159,v159
v_add_f32 v212,v212,v214
v_add_f32 v213,v213,v215
v_add_f32 v216,v160,v161
v_mul_f32 v217,v160,v160
v_add_f32 v218,v162,v163
v_mul_f32 v219,v161,v161
v_fmac_f32 v217,v162,v162
v_fmac_f32 v219,v163,v163
v_add_f32 v216,v216,v164
v_fmac_f32 v217,v164,v164
v_add_f32 v218,v218,v165
v_fmac_f32 v219,v165,v165
v_add_f32 v216,v216,v166
v_fmac_f32 v217,v166,v166
v_add_f32 v218,v218,v167
v_fmac_f32 v219,v167,v167
v_add_f32 v216,v216,v168
v_fmac_f32 v217,v168,v168
v_add_f32 v218,v218,v169
v_fmac_f32 v219,v169,v169
v_add_f32 v216,v216,v170
v_fmac_f32 v217,v170,v170
v_add_f32 v218,v218,v171
v_fmac_f32 v219,v171,v171
v_add_f32 v216,v216,v172
v_fmac_f32 v217,v172,v172
v_add_f32 v218,v218,v173
v_fmac_f32 v219,v173,v173
v_add_f32 v216,v216,v174
v_fmac_f32 v217,v174,v174
v_add_f32 v218,v218,v175
v_fmac_f32 v219,v175,v175
v_add_f32 v216,v216,v218
v_add_f32 v217,v217,v219
v_add_f32 v220,v176,v177
v_mul_f32 v221,v176,v176
v_add_f32 v222,v178,v179
v_mul_f32 v223,v177,v177
v_fmac_f32 v221,v178,v178
v_fmac_f32 v223,v179,v179
v_add_f32 v220,v220,v180
v_fmac_f32 v221,v180,v180
v_add_f32 v222,v222,v181
v_fmac_f32 v223,v181,v181
v_add_f32 v220,v220,v182
v_fmac_f32 v221,v182,v182
v_add_f32 v222,v222,v183
v_fmac_f32 v223,v183,v183
v_add_f32 v220,v220,v184
v_fmac_f32 v221,v184,v184
v_add_f32 v222,v222,v185
v_fmac_f32 v223,v185,v185
v_add_f32 v220,v220,v186
v_fmac_f32 v221,v186,v186
v_add_f32 v222,v222,v187
v_fmac_f32 v223,v187,v187
v_add_f32 v220,v220,v188
v_fmac_f32 v221,v188,v188
v_add_f32 v222,v222,v189
v_fmac_f32 v223,v189,v189
v_add_f32 v220,v220,v190
v_fmac_f32 v221,v190,v190
v_add_f32 v222,v222,v191
v_fmac_f32 v223,v191,v191
v_add_f32 v220,v220,v222
v_add_f32 v221,v221,v223
v_add_f32_dpp v208,v208,v208 row_ror:4 row_mask:0xf bank_mask:0xf
v_add_f32_dpp v209,v209,v209 row_ror:4 row_mask:0xf bank_mask:0xf
v_add_f32_dpp v212,v212,v212 row_ror:4 row_mask:0xf bank_mask:0xf
v_add_f32_dpp v213,v213,v213 row_ror:4 row_mask:0xf bank_mask:0xf
v_add_f32_dpp v216,v216,v216 row_ror:4 row_mask:0xf bank_mask:0xf
v_add_f32_dpp v217,v217,v217 row_ror:4 row_mask:0xf bank_mask:0xf
v_add_f32_dpp v220,v220,v220 row_ror:4 row_mask:0xf bank_mask:0xf
v_add_f32_dpp v221,v221,v221 row_ror:4 row_mask:0xf bank_mask:0xf
v_add_f32_dpp v208,v208,v208 row_ror:8 row_mask:0xf bank_mask:0xf
v_add_f32_dpp v209,v209,v209 row_ror:8 row_mask:0xf bank_mask:0xf
v_add_f32_dpp v212,v212,v212 row_ror:8 row_mask:0xf bank_mask:0xf
v_add_f32_dpp v213,v213,v213 row_ror:8 row_mask:0xf bank_mask:0xf
v_add_f32_dpp v216,v216,v216 row_ror:8 row_mask:0xf bank_mask:0xf
v_add_f32_dpp v217,v217,v217 row_ror:8 row_mask:0xf bank_mask:0xf
v_add_f32_dpp v220,v220,v220 row_ror:8 row_mask:0xf bank_mask:0xf
v_add_f32_dpp v221,v221,v221 row_ror:8 row_mask:0xf bank_mask:0xf
v_mov_b32 v210,v208
v_mov_b32 v211,v209
s_nop 0
v_permlane16_swap_b32 v210,v208
v_permlane16_swap_b32 v211,v209
v_add_f32 v208,v208,v210
v_add_f32 v209,v209,v211
v_mov_b32 v214,v212
v_mov_b32 v215,v213
s_nop 0
v_permlane16_swap_b32 v214,v212
v_permlane16_swap_b32 v215,v213
v_add_f32 v212,v212,v214
v_add_f32 v213,v213,v215
v_mov_b32 v218,v216
v_mov_b32 v219,v217
s_nop 0
v_permlane16_swap_b32 v218,v216
v_permlane16_swap_b32 v219,v217
v_add_f32 v216,v216,v218
v_add_f32 v217,v217,v219
v_mov_b32 v222,v220
v_mov_b32 v223,v221
s_nop 0
v_permlane16_swap_b32 v222,v220
v_permlane16_swap_b32 v223,v221
v_add_f32 v220,v220,v222
v_add_f32 v221,v221,v223
v_mov_b32 v210,v208
v_mov_b32 v211,v209
s_nop 0
v_permlane32_swap_b32 v210,v208
v_permlane32_swap_b32 v211,v209
v_add_f32 v208,v208,v210
v_add_f32 v209,v209,v211
v_mov_b32 v214,v212
v_mov_b32 v215,v213
s_nop 0
v_permlane32_swap_b32 v214,v212
v_permlane32_swap_b32 v215,v213
v_add_f32 v212,v212,v214
v_add_f32 v213,v213,v215
v_mov_b32 v218,v216
v_mov_b32 v219,v217
s_nop 0
v_permlane32_swap_b32 v218,v216
v_permlane32_swap_b32 v219,v217
v_add_f32 v216,v216,v218
v_add_f32 v217,v217,v219
v_mov_b32 v222,v220
v_mov_b32 v223,v221
s_nop 0
v_permlane32_swap_b32 v222,v220
v_permlane32_swap_b32 v223,v221
v_add_f32 v220,v220,v222
v_add_f32 v221,v221,v223
ds_write_b64 v11,v[208:209] offset:32768
ds_write_b64 v11,v[212:213] offset:34816
ds_write_b64 v11,v[216:217] offset:36864
ds_write_b64 v11,v[220:221] offset:38912
s_waitcnt lgkmcnt(0)
s_barrier
ds_read_b64 v[32:33],v12 offset:32768
ds_read_b64 v[34:35],v12 offset:33280
ds_read_b64 v[36:37],v12 offset:33792
ds_read_b64 v[38:39],v12 offset:34304
s_waitcnt lgkmcnt(0)
v_add_f32 v32,v32,v34
v_add_f32 v33,v33,v35
v_add_f32 v36,v36,v38
v_add_f32 v37,v37,v39
v_add_f32 v32,v32,v36
v_add_f32 v33,v33,v37
v_mul_f32 v208,0xba800000,v32
v_mul_f32 v34,v208,v208
v_mul_f32 v33,0x3a800000,v33
v_sub_f32 v33,v33,v34
v_max_f32 v33,0,v33
v_add_f32 v33,0x3727c5ac,v33
v_rsq_f32 v209,v33
s_nop 0
v_mul_f32 v208,v208,v209
v_fma_f32 v128,v128,v209,v208
v_fma_f32 v129,v129,v209,v208
v_fma_f32 v130,v130,v209,v208
v_fma_f32 v131,v131,v209,v208
v_fma_f32 v132,v132,v209,v208
v_fma_f32 v133,v133,v209,v208
v_fma_f32 v134,v134,v209,v208
v_fma_f32 v135,v135,v209,v208
v_fma_f32 v136,v136,v209,v208
v_fma_f32 v137,v137,v209,v208
v_fma_f32 v138,v138,v209,v208
v_fma_f32 v139,v139,v209,v208
v_fma_f32 v140,v140,v209,v208
v_fma_f32 v141,v141,v209,v208
v_fma_f32 v142,v142,v209,v208
v_fma_f32 v143,v143,v209,v208
ds_read_b64 v[32:33],v12 offset:34816
ds_read_b64 v[34:35],v12 offset:35328
ds_read_b64 v[36:37],v12 offset:35840
ds_read_b64 v[38:39],v12 offset:36352
s_waitcnt lgkmcnt(0)
v_add_f32 v32,v32,v34
v_add_f32 v33,v33,v35
v_add_f32 v36,v36,v38
v_add_f32 v37,v37,v39
v_add_f32 v32,v32,v36
v_add_f32 v33,v33,v37
v_mul_f32 v208,0xba800000,v32
v_mul_f32 v34,v208,v208
v_mul_f32 v33,0x3a800000,v33
v_sub_f32 v33,v33,v34
v_max_f32 v33,0,v33
v_add_f32 v33,0x3727c5ac,v33
v_rsq_f32 v209,v33
s_nop 0
v_mul_f32 v208,v208,v209
v_fma_f32 v144,v144,v209,v208
v_fma_f32 v145,v145,v209,v208
v_fma_f32 v146,v146,v209,v208
v_fma_f32 v147,v147,v209,v208
v_fma_f32 v148,v148,v209,v208
v_fma_f32 v149,v149,v209,v208
v_fma_f32 v150,v150,v209,v208
v_fma_f32 v151,v151,v209,v208
v_fma_f32 v152,v152,v209,v208
v_fma_f32 v153,v153,v209,v208
v_fma_f32 v154,v154,v209,v208
v_fma_f32 v155,v155,v209,v208
v_fma_f32 v156,v156,v209,v208
v_fma_f32 v157,v157,v209,v208
v_fma_f32 v158,v158,v209,v208
v_fma_f32 v159,v159,v209,v208
ds_read_b64 v[32:33],v12 offset:36864
ds_read_b64 v[34:35],v12 offset:37376
ds_read_b64 v[36:37],v12 offset:37888
ds_read_b64 v[38:39],v12 offset:38400
s_waitcnt lgkmcnt(0)
v_add_f32 v32,v32,v34
v_add_f32 v33,v33,v35
v_add_f32 v36,v36,v38
v_add_f32 v37,v37,v39
v_add_f32 v32,v32,v36
v_add_f32 v33,v33,v37
v_mul_f32 v208,0xba800000,v32
v_mul_f32 v34,v208,v208
v_mul_f32 v33,0x3a800000,v33
v_sub_f32 v33,v33,v34
v_max_f32 v33,0,v33
v_add_f32 v33,0x3727c5ac,v33
v_rsq_f32 v209,v33
s_nop 0
v_mul_f32 v208,v208,v209
v_fma_f32 v160,v160,v209,v208
v_fma_f32 v161,v161,v209,v208
v_fma_f32 v162,v162,v209,v208
v_fma_f32 v163,v163,v209,v208
v_fma_f32 v164,v164,v209,v208
v_fma_f32 v165,v165,v209,v208
v_fma_f32 v166,v166,v209,v208
v_fma_f32 v167,v167,v209,v208
v_fma_f32 v168,v168,v209,v208
v_fma_f32 v169,v169,v209,v208
v_fma_f32 v170,v170,v209,v208
v_fma_f32 v171,v171,v209,v208
v_fma_f32 v172,v172,v209,v208
v_fma_f32 v173,v173,v209,v208
v_fma_f32 v174,v174,v209,v208
v_fma_f32 v175,v175,v209,v208
ds_read_b64 v[32:33],v12 offset:38912
ds_read_b64 v[34:35],v12 offset:39424
ds_read_b64 v[36:37],v12 offset:39936
ds_read_b64 v[38:39],v12 offset:40448
s_waitcnt lgkmcnt(0)
v_add_f32 v32,v32,v34
v_add_f32 v33,v33,v35
v_add_f32 v36,v36,v38
v_add_f32 v37,v37,v39
v_add_f32 v32,v32,v36
v_add_f32 v33,v33,v37
v_mul_f32 v208,0xba800000,v32
v_mul_f32 v34,v208,v208
v_mul_f32 v33,0x3a800000,v33
v_sub_f32 v33,v33,v34
v_max_f32 v33,0,v33
v_add_f32 v33,0x3727c5ac,v33
v_rsq_f32 v209,v33
s_nop 0
v_mul_f32 v208,v208,v209
v_fma_f32 v176,v176,v209,v208
v_fma_f32 v177,v177,v209,v208
v_fma_f32 v178,v178,v209,v208
v_fma_f32 v179,v179,v209,v208
v_fma_f32 v180,v180,v209,v208
v_fma_f32 v181,v181,v209,v208
v_fma_f32 v182,v182,v209,v208
v_fma_f32 v183,v183,v209,v208
v_fma_f32 v184,v184,v209,v208
v_fma_f32 v185,v185,v209,v208
v_fma_f32 v186,v186,v209,v208
v_fma_f32 v187,v187,v209,v208
v_fma_f32 v188,v188,v209,v208
v_fma_f32 v189,v189,v209,v208
v_fma_f32 v190,v190,v209,v208
v_fma_f32 v191,v191,v209,v208
s_mov_b32 s92,s2
s_and_b32 s93,s3,0xffff
s_mov_b32 s94,0x100
s_mov_b32 s95,0x20000
v_mbcnt_lo_u32_b32 v16,-1,0
v_mbcnt_hi_u32_b32 v16,-1,v16
v_mov_b32 v18,0
v_cmp_eq_u32 vcc,16,v16
s_nop 1
v_cndmask_b32 v18,v18,64,vcc
v_and_b32 v19,1,v16
v_cmp_eq_u32 vcc,1,v19
v_mov_b32 v19,8192
s_nop 0
v_cndmask_b32 v19,-1,v19,vcc
v_min_u32 v16,31,v16
v_lshlrev_b32 v16,2,v16
s_sub_u32 s66,s88,64
s_cmp_lg_u32 s50,0
s_cbranch_scc1 vot_33
vpoll_29:
buffer_load_dword v17,v16,s[92:95],s66 offen sc1
s_waitcnt vmcnt(0)
s_cmp_lg_u32 s56,2
s_cbranch_scc1 vck_30
v_cmp_eq_u32 vcc,v17,v19
s_and_b32 s64,vcc_lo,0xffff
s_cmp_eq_u32 s64,65535
s_cbranch_scc1 vck_30
s_mov_b32 s65,0
v_readlane_b32 s64,v17,1
s_lshr_b32 s64,s64,8
s_add_u32 s65,s65,s64
v_readlane_b32 s64,v17,3
s_lshr_b32 s64,s64,8
s_add_u32 s65,s65,s64
v_readlane_b32 s64,v17,5
s_lshr_b32 s64,s64,8
s_add_u32 s65,s65,s64
v_readlane_b32 s64,v17,7
s_lshr_b32 s64,s64,8
s_add_u32 s65,s65,s64
v_readlane_b32 s64,v17,9
s_lshr_b32 s64,s64,8
s_add_u32 s65,s65,s64
v_readlane_b32 s64,v17,11
s_lshr_b32 s64,s64,8
s_add_u32 s65,s65,s64
v_readlane_b32 s64,v17,13
s_lshr_b32 s64,s64,8
s_add_u32 s65,s65,s64
v_readlane_b32 s64,v17,15
s_lshr_b32 s64,s64,8
s_add_u32 s65,s65,s64
s_cmp_ge_u32 s65,256
s_cbranch_scc1 vok_32
s_branch vrt_31
vck_30:
v_cmp_gt_u32 vcc,v18,v17
s_cbranch_vccz vok_32
vrt_31:
s_sleep 8
s_sub_u32 s90,s90,1
s_cmp_gt_i32 s90,0
s_cbranch_scc1 vpoll_29
vok_32:
v_add_u32 v18,160512,v16
ds_write_b32 v18,v17
s_waitcnt lgkmcnt(0)
vot_33:
s_barrier
v_add_u32 v18,160512,v16
ds_read_b32 v17,v18
s_waitcnt lgkmcnt(0)
s_cmp_lg_u32 s56,2
s_cbranch_scc1 vfin_34
v_cmp_eq_u32 vcc,v17,v19
s_and_b32 s64,vcc_lo,0xffff
s_cmp_eq_u32 s64,65535
s_cbranch_scc1 vfin_34
s_mov_b32 s65,0
v_readlane_b32 s64,v17,1
s_lshr_b32 s64,s64,8
s_add_u32 s65,s65,s64
v_readlane_b32 s64,v17,3
s_lshr_b32 s64,s64,8
s_add_u32 s65,s65,s64
v_readlane_b32 s64,v17,5
s_lshr_b32 s64,s64,8
s_add_u32 s65,s65,s64
v_readlane_b32 s64,v17,7
s_lshr_b32 s64,s64,8
s_add_u32 s65,s65,s64
v_readlane_b32 s64,v17,9
s_lshr_b32 s64,s64,8
s_add_u32 s65,s65,s64
v_readlane_b32 s64,v17,11
s_lshr_b32 s64,s64,8
s_add_u32 s65,s65,s64
v_readlane_b32 s64,v17,13
s_lshr_b32 s64,s64,8
s_add_u32 s65,s65,s64
v_readlane_b32 s64,v17,15
s_lshr_b32 s64,s64,8
s_add_u32 s65,s65,s64
s_cmp_ge_u32 s65,256
s_cbranch_scc1 fl_fb
vfin_34:
s_and_b32 s56,s56,1
v_lshlrev_b32 v18,5,v14
s_mov_b32 s64,267386880
buffer_load_dwordx4 v[32:35],v18,s[20:23],s64 offen offset:0 sc1
buffer_load_dwordx4 v[36:39],v18,s[20:23],s64 offen offset:16 sc1
s_mov_b32 s64,267411456
buffer_load_dwordx4 v[40:43],v18,s[20:23],s64 offen offset:0 sc1
buffer_load_dwordx4 v[44:47],v18,s[20:23],s64 offen offset:16 sc1
s_mov_b32 s64,267436032
buffer_load_dwordx4 v[48:51],v18,s[20:23],s64 offen offset:0 sc1
buffer_load_dwordx4 v[52:55],v18,s[20:23],s64 offen offset:16 sc1
s_mov_b32 s64,267460608
buffer_load_dwordx4 v[56:59],v18,s[20:23],s64 offen offset:0 sc1
buffer_load_dwordx4 v[60:63],v18,s[20:23],s64 offen offset:16 sc1
s_cmp_gt_u32 s50,1
s_cselect_b32 s64,1.0,0
s_waitcnt vmcnt(0)
v_pk_add_f32 v[32:33],v[32:33],v[40:41]
v_pk_add_f32 v[48:49],v[48:49],v[56:57]
v_pk_add_f32 v[34:35],v[34:35],v[42:43]
v_pk_add_f32 v[50:51],v[50:51],v[58:59]
v_pk_add_f32 v[36:37],v[36:37],v[44:45]
v_pk_add_f32 v[52:53],v[52:53],v[60:61]
v_pk_add_f32 v[38:39],v[38:39],v[46:47]
v_pk_add_f32 v[54:55],v[54:55],v[62:63]
v_pk_add_f32 v[32:33],v[32:33],v[48:49]
v_pk_add_f32 v[34:35],v[34:35],v[50:51]
v_pk_add_f32 v[36:37],v[36:37],v[52:53]
v_pk_add_f32 v[38:39],v[38:39],v[54:55]
v_cvt_pk_bf16_f32 v40,v32,v33
v_cvt_pk_bf16_f32 v41,v34,v35
v_cvt_pk_bf16_f32 v42,v36,v37
v_cvt_pk_bf16_f32 v43,v38,v39
v_lshlrev_b32 v32,16,v40
v_and_b32 v33,s73,v40
v_lshlrev_b32 v34,16,v41
v_and_b32 v35,s73,v41
v_lshlrev_b32 v36,16,v42
v_and_b32 v37,s73,v42
v_lshlrev_b32 v38,16,v43
v_and_b32 v39,s73,v43
v_add_f32 v32,s64,v32
v_add_f32 v33,s64,v33
v_add_f32 v34,s64,v34
v_add_f32 v35,s64,v35
v_add_f32 v36,s64,v36
v_add_f32 v37,s64,v37
v_add_f32 v38,s64,v38
v_add_f32 v39,s64,v39
ds_write_b128 v18,v[32:35] offset:0
ds_write_b128 v18,v[36:39] offset:16
s_waitcnt lgkmcnt(0)
s_barrier
ds_read_b128 v[112:115],v9 offset:0
ds_read_b128 v[116:119],v9 offset:16
ds_read_b128 v[120:123],v9 offset:512
ds_read_b128 v[124:127],v9 offset:528
ds_read_b128 v[96:99],v9 offset:4096
ds_read_b128 v[100:103],v9 offset:4112
ds_read_b128 v[104:107],v9 offset:4608
ds_read_b128 v[108:111],v9 offset:4624
s_add_u32 s61,s61,146800640
s_add_u32 s62,s61,4096
s_waitcnt lgkmcnt(0)
v_fma_f32 v128,v128,v96,v112
v_fma_f32 v129,v129,v97,v113
v_fma_f32 v130,v130,v98,v114
v_fma_f32 v131,v131,v99,v115
v_fma_f32 v132,v132,v100,v116
v_fma_f32 v133,v133,v101,v117
v_fma_f32 v134,v134,v102,v118
v_fma_f32 v135,v135,v103,v119
v_fma_f32 v136,v136,v104,v120
v_fma_f32 v137,v137,v105,v121
v_fma_f32 v138,v138,v106,v122
v_fma_f32 v139,v139,v107,v123
v_fma_f32 v140,v140,v108,v124
v_fma_f32 v141,v141,v109,v125
v_fma_f32 v142,v142,v110,v126
v_fma_f32 v143,v143,v111,v127
v_cvt_pk_bf16_f32 v48,v128,v129
v_cvt_pk_bf16_f32 v49,v130,v131
v_cvt_pk_bf16_f32 v50,v132,v133
v_cvt_pk_bf16_f32 v51,v134,v135
v_cvt_pk_bf16_f32 v52,v136,v137
v_cvt_pk_bf16_f32 v53,v138,v139
v_cvt_pk_bf16_f32 v54,v140,v141
v_cvt_pk_bf16_f32 v55,v142,v143
buffer_store_dwordx4 v[48:51],v10,s[20:23],s61 offen offset:0 sc1
buffer_store_dwordx4 v[52:55],v10,s[20:23],s62 offen offset:0 sc1
v_fma_f32 v144,v144,v96,v112
v_fma_f32 v145,v145,v97,v113
v_fma_f32 v146,v146,v98,v114
v_fma_f32 v147,v147,v99,v115
v_fma_f32 v148,v148,v100,v116
v_fma_f32 v149,v149,v101,v117
v_fma_f32 v150,v150,v102,v118
v_fma_f32 v151,v151,v103,v119
v_fma_f32 v152,v152,v104,v120
v_fma_f32 v153,v153,v105,v121
v_fma_f32 v154,v154,v106,v122
v_fma_f32 v155,v155,v107,v123
v_fma_f32 v156,v156,v108,v124
v_fma_f32 v157,v157,v109,v125
v_fma_f32 v158,v158,v110,v126
v_fma_f32 v159,v159,v111,v127
v_cvt_pk_bf16_f32 v56,v144,v145
v_cvt_pk_bf16_f32 v57,v146,v147
v_cvt_pk_bf16_f32 v58,v148,v149
v_cvt_pk_bf16_f32 v59,v150,v151
v_cvt_pk_bf16_f32 v60,v152,v153
v_cvt_pk_bf16_f32 v61,v154,v155
v_cvt_pk_bf16_f32 v62,v156,v157
v_cvt_pk_bf16_f32 v63,v158,v159
buffer_store_dwordx4 v[56:59],v10,s[20:23],s61 offen offset:64 sc1
buffer_store_dwordx4 v[60:63],v10,s[20:23],s62 offen offset:64 sc1
v_fma_f32 v160,v160,v96,v112
v_fma_f32 v161,v161,v97,v113
v_fma_f32 v162,v162,v98,v114
v_fma_f32 v163,v163,v99,v115
v_fma_f32 v164,v164,v100,v116
v_fma_f32 v165,v165,v101,v117
v_fma_f32 v166,v166,v102,v118
v_fma_f32 v167,v167,v103,v119
v_fma_f32 v168,v168,v104,v120
v_fma_f32 v169,v169,v105,v121
v_fma_f32 v170,v170,v106,v122
v_fma_f32 v171,v171,v107,v123
v_fma_f32 v172,v172,v108,v124
v_fma_f32 v173,v173,v109,v125
v_fma_f32 v174,v174,v110,v126
v_fma_f32 v175,v175,v111,v127
v_cvt_pk_bf16_f32 v64,v160,v161
v_cvt_pk_bf16_f32 v65,v162,v163
v_cvt_pk_bf16_f32 v66,v164,v165
v_cvt_pk_bf16_f32 v67,v166,v167
v_cvt_pk_bf16_f32 v68,v168,v169
v_cvt_pk_bf16_f32 v69,v170,v171
v_cvt_pk_bf16_f32 v70,v172,v173
v_cvt_pk_bf16_f32 v71,v174,v175
buffer_store_dwordx4 v[64:67],v10,s[20:23],s61 offen offset:128 sc1
buffer_store_dwordx4 v[68:71],v10,s[20:23],s62 offen offset:128 sc1
v_fma_f32 v176,v176,v96,v112
v_fma_f32 v177,v177,v97,v113
v_fma_f32 v178,v178,v98,v114
v_fma_f32 v179,v179,v99,v115
v_fma_f32 v180,v180,v100,v116
v_fma_f32 v181,v181,v101,v117
v_fma_f32 v182,v182,v102,v118
v_fma_f32 v183,v183,v103,v119
v_fma_f32 v184,v184,v104,v120
v_fma_f32 v185,v185,v105,v121
v_fma_f32 v186,v186,v106,v122
v_fma_f32 v187,v187,v107,v123
v_fma_f32 v188,v188,v108,v124
v_fma_f32 v189,v189,v109,v125
v_fma_f32 v190,v190,v110,v126
v_fma_f32 v191,v191,v111,v127
v_cvt_pk_bf16_f32 v72,v176,v177
v_cvt_pk_bf16_f32 v73,v178,v179
v_cvt_pk_bf16_f32 v74,v180,v181
v_cvt_pk_bf16_f32 v75,v182,v183
v_cvt_pk_bf16_f32 v76,v184,v185
v_cvt_pk_bf16_f32 v77,v186,v187
v_cvt_pk_bf16_f32 v78,v188,v189
v_cvt_pk_bf16_f32 v79,v190,v191
buffer_store_dwordx4 v[72:75],v10,s[20:23],s61 offen offset:192 sc1
buffer_store_dwordx4 v[76:79],v10,s[20:23],s62 offen offset:192 sc1
s_waitcnt vmcnt(0)
s_barrier
s_cmp_lg_u32 s50,0
s_cbranch_scc1 sig_35
s_mov_b32 s92,s2
s_and_b32 s93,s3,0xffff
s_mov_b32 s94,0x100
s_mov_b32 s95,0x20000
s_add_u32 s64,s88,16
v_mov_b32 v16,1
s_mov_b64 exec,1
buffer_atomic_add v16,off,s[92:95],s64 sc1
s_mov_b64 exec,-1
sig_35:
fl_disp:
s_lshr_b32 s64,s58,2
s_sub_u32 s64,s64,55
s_andn2_b32 s64,s64,4
s_cmp_eq_u32 s64,0
s_cselect_b32 s64,48,0
s_xor_b32 s58,s58,s64
s_sub_u32 s59,s58,248
s_cbranch_scc1 nx_36
s_branch fl_w2
nx_36:
s_sub_u32 s59,s58,240
s_cbranch_scc1 nx_37
s_branch fl_w1
nx_37:
s_sub_u32 s59,s58,224
s_cbranch_scc1 nx_38
s_branch fl_att
nx_38:
s_sub_u32 s59,s58,220
s_cbranch_scc1 nx_39
s_branch fl_ln2
nx_39:
s_sub_u32 s59,s58,192
s_cbranch_scc1 nx_40
s_branch fl_w3
nx_40:
s_sub_u32 s59,s58,160
s_cbranch_scc1 nx_41
s_branch fl_w4
nx_41:
s_sub_u32 s59,s58,128
s_branch fl_wo
fl_fb:
s_mov_b32 s92,s2
s_and_b32 s93,s3,0xffff
s_mov_b32 s94,0x100
s_mov_b32 s95,0x20000
s_waitcnt vmcnt(0) lgkmcnt(0)
s_barrier
v_mov_b32 v4,0
s_cmp_lg_u32 s50,0
s_cbranch_scc1 norole_2
s_mov_b64 exec,1
v_mov_b32 v3,1
s_lshl_b32 s52,s51,2
s_add_u32 s52,s52,128
buffer_atomic_add v3,off,s[92:95],s52 sc0 sc1
s_waitcnt vmcnt(0)
ds_write_b32 v4,v3
s_waitcnt lgkmcnt(0)
s_mov_b64 exec,-1
norole_2:
s_barrier
ds_read_b32 v3,v4
v_mbcnt_lo_u32_b32 v16,-1,0
v_and_b32 v16,7,v16
v_lshlrev_b32 v16,2,v16
s_waitcnt lgkmcnt(0)
v_readfirstlane_b32 s49,v3
s_barrier
tp_42:
buffer_load_dword v17,v16,s[92:95],0 offen offset:128 sc1
s_waitcnt vmcnt(0)
v_readlane_b32 s72,v17,0
v_readlane_b32 s73,v17,1
v_readlane_b32 s74,v17,2
v_readlane_b32 s75,v17,3
v_readlane_b32 s76,v17,4
v_readlane_b32 s77,v17,5
v_readlane_b32 s78,v17,6
v_readlane_b32 s79,v17,7
s_add_u32 s65,s72,s73
s_add_u32 s65,s65,s74
s_add_u32 s65,s65,s75
s_add_u32 s65,s65,s76
s_add_u32 s65,s65,s77
s_add_u32 s65,s65,s78
s_add_u32 s65,s65,s79
s_cmp_ge_u32 s65,256
s_cbranch_scc1 tg_43
s_sleep 4
s_sub_u32 s90,s90,1
s_cmp_gt_i32 s90,0
s_cbranch_scc1 tp_42
tg_43:
s_min_u32 s65,s72,s73
s_min_u32 s65,s65,s74
s_min_u32 s65,s65,s75
s_min_u32 s65,s65,s76
s_min_u32 s65,s65,s77
s_min_u32 s65,s65,s78
s_min_u32 s65,s65,s79
s_mov_b32 s88,192
s_cmp_lt_u32 s65,32
s_cbranch_scc1 tsl_44
s_lshl_b32 s64,s51,2
s_lshr_b32 s64,0x76325410,s64
s_and_b32 s64,s64,7
s_lshl_b32 s58,s64,5
s_add_u32 s58,s58,s49
s_mov_b32 s56,0
s_branch fl_disp0
tsl_44:
s_mov_b32 s58,s49
s_cmp_gt_u32 s51,0
s_cselect_b32 s65,s72,0
s_add_u32 s58,s58,s65
s_cmp_gt_u32 s51,1
s_cselect_b32 s65,s73,0
s_add_u32 s58,s58,s65
s_cmp_gt_u32 s51,2
s_cselect_b32 s65,s74,0
s_add_u32 s58,s58,s65
s_cmp_gt_u32 s51,3
s_cselect_b32 s65,s75,0
s_add_u32 s58,s58,s65
s_cmp_gt_u32 s51,4
s_cselect_b32 s65,s76,0
s_add_u32 s58,s58,s65
s_cmp_gt_u32 s51,5
s_cselect_b32 s65,s77,0
s_add_u32 s58,s58,s65
s_cmp_gt_u32 s51,6
s_cselect_b32 s65,s78,0
s_add_u32 s58,s58,s65
s_mov_b32 s56,1
s_cmp_lt_u32 s58,256
s_cbranch_scc1 fl_disp0
done_1:
s_endpgm
fl_qkv:
v_and_b32 v21,15,v1
v_lshrrev_b32 v22,4,v1
v_lshrrev_b32 v23,2,v21
v_and_b32 v24,3,v21
s_lshl_b32 s61,s50,15
v_lshl_add_u32 v25,v22,3,v23
s_load_dwordx4 s[4:7],s[0:1],16
s_load_dwordx2 s[8:9],s[0:1],32
s_lshl_b32 s52,s59,7
s_and_b32 s64,s50,1
s_lshl_b32 s65,s64,6
s_add_u32 s53,s52,s65
s_lshr_b32 s65,s50,1
s_lshl_b32 s65,s65,6
s_add_u32 s52,s52,s65
s_lshl_b32 s54,s64,3
s_waitcnt lgkmcnt(0)
s_cmp_gt_u32 s50,1
s_cselect_b64 s[10:11],s[4:5],s[6:7]
s_mov_b32 s28,s10
s_and_b32 s29,s11,0xffff
s_mov_b32 s30,0x800000
s_mov_b32 s31,0x20000
s_mov_b32 s32,s8
s_and_b32 s33,s9,0xffff
s_mov_b32 s34,0x800000
s_mov_b32 s35,0x20000
s_and_b32 s64,s59,7
s_lshl_b32 s65,s64,3
s_and_b32 s66,s50,1
s_lshl_b32 s55,s66,2
s_add_u32 s65,s65,s55
s_lshl_b32 s66,s66,5
s_lshl_b32 s65,s65,13
s_andn2_b32 s55,s59,7
s_lshl_b32 s55,s55,7
s_add_u32 s65,s65,s55
s_add_u32 s65,s65,384
v_and_b32 v28,3,v1
v_lshlrev_b32 v28,13,v28
v_add_u32 v28,s65,v28
v_and_b32 v15,4,v1
v_lshl_add_u32 v28,v15,4,v28
s_and_b32 s55,s59,31
s_add_u32 s66,s66,s55
s_lshl_b32 s66,s66,13
s_add_u32 s66,s66,8064
v_writelane_b32 v28,s66,8
s_add_u32 s66,s66,64
v_writelane_b32 v28,s66,9
s_cmp_eq_u32 s64,3
s_cselect_b32 s65,0,15
s_sub_u32 s66,s59,32
s_cmp_lt_u32 s66,31
s_cselect_b32 s66,256,0
s_or_b32 vcc_lo,s65,s66
s_mov_b32 vcc_hi,0
v_cndmask_b32 v28,-1,v28,vcc
s_and_b32 s64,s59,7
s_lshl_b32 s65,s64,4
s_lshl_b32 s55,s50,2
s_add_u32 s65,s65,s55
s_lshl_b32 s66,s50,5
s_lshl_b32 s65,s65,13
s_andn2_b32 s55,s59,7
s_lshl_b32 s55,s55,7
s_add_u32 s65,s65,s55
s_add_u32 s65,s65,384
v_and_b32 v31,3,v1
v_lshlrev_b32 v31,13,v31
v_add_u32 v31,s65,v31
v_and_b32 v15,4,v1
v_lshl_add_u32 v31,v15,4,v31
s_and_b32 s55,s59,31
s_add_u32 s66,s66,s55
s_lshl_b32 s66,s66,13
s_add_u32 s66,s66,8064
v_writelane_b32 v31,s66,8
s_add_u32 s66,s66,64
v_writelane_b32 v31,s66,9
s_cmp_eq_u32 s64,3
s_cselect_b32 s65,0,15
s_sub_u32 s66,s59,32
s_cmp_lt_u32 s66,31
s_cselect_b32 s66,256,0
s_or_b32 vcc_lo,s65,s66
s_mov_b32 vcc_hi,0
v_cndmask_b32 v31,-1,v31,vcc
s_and_b32 s60,s50,1
s_lshl_b32 s60,s60,1
v_lshrrev_b32 v26,2,v1
v_and_b32 v27,3,v1
v_mul_u32_u24 v16,8192,v26
v_lshl_add_u32 v16,v27,4,v16
v_lshlrev_b32 v17,6,v25
v_lshl_add_u32 v17,v24,4,v17
v_add_u32 v17,s61,v17
s_mov_b32 s64,1048576
buffer_load_dword v29,v28,s[28:31],s64 offen
s_mov_b32 s64,1572864
buffer_load_dword v29,v28,s[28:31],s64 offen
s_add_u32 s62,s53,0
s_add_u32 m0,s61,0
s_nop 0
buffer_load_dwordx4 v16,s[28:31],s62 offen lds
s_add_u32 s62,s62,131072
s_add_u32 m0,m0,1024
s_waitcnt vmcnt(10)
buffer_load_dwordx4 v16,s[28:31],s62 offen lds
s_add_u32 s62,s62,131072
s_add_u32 m0,m0,1024
s_mov_b32 s64,0
buffer_load_dword v29,v31,s[32:35],s64 offen
s_waitcnt vmcnt(10)
buffer_load_dwordx4 v16,s[28:31],s62 offen lds
s_add_u32 s62,s62,131072
s_add_u32 m0,m0,1024
s_waitcnt vmcnt(10)
buffer_load_dwordx4 v16,s[28:31],s62 offen lds
s_add_u32 s62,s62,131072
s_add_u32 m0,m0,1024
s_waitcnt vmcnt(10)
buffer_load_dwordx4 v16,s[28:31],s62 offen lds
s_add_u32 s62,s62,131072
s_add_u32 m0,m0,1024
s_waitcnt vmcnt(10)
buffer_load_dwordx4 v16,s[28:31],s62 offen lds
s_add_u32 s62,s62,131072
s_add_u32 m0,m0,1024
s_waitcnt vmcnt(10)
buffer_load_dwordx4 v16,s[28:31],s62 offen lds
s_add_u32 s62,s62,131072
s_add_u32 m0,m0,1024
s_waitcnt vmcnt(10)
buffer_load_dwordx4 v16,s[28:31],s62 offen lds
s_add_u32 s62,s62,131072
s_add_u32 m0,m0,1024
s_waitcnt vmcnt(10)
buffer_load_dwordx4 v16,s[28:31],s62 offen lds
s_add_u32 s62,s62,131072
s_add_u32 m0,m0,1024
s_waitcnt vmcnt(10)
buffer_load_dwordx4 v16,s[28:31],s62 offen lds
s_add_u32 s62,s62,131072
s_add_u32 m0,m0,1024
s_mov_b32 s64,1048576
buffer_load_dword v29,v31,s[32:35],s64 offen
s_waitcnt vmcnt(10)
buffer_load_dwordx4 v16,s[28:31],s62 offen lds
s_add_u32 s62,s62,131072
s_add_u32 m0,m0,1024
s_waitcnt vmcnt(10)
buffer_load_dwordx4 v16,s[28:31],s62 offen lds
s_add_u32 s62,s62,131072
s_add_u32 m0,m0,1024
s_waitcnt vmcnt(10)
buffer_load_dwordx4 v16,s[28:31],s62 offen lds
s_add_u32 s62,s62,131072
s_add_u32 m0,m0,1024
s_waitcnt vmcnt(10)
buffer_load_dwordx4 v16,s[28:31],s62 offen lds
s_add_u32 s62,s62,131072
s_add_u32 m0,m0,1024
s_waitcnt vmcnt(10)
buffer_load_dwordx4 v16,s[28:31],s62 offen lds
s_add_u32 s62,s62,131072
s_add_u32 m0,m0,1024
s_waitcnt vmcnt(10)
buffer_load_dwordx4 v16,s[28:31],s62 offen lds
s_waitcnt vmcnt(10)
s_add_u32 s62,s52,0
s_add_u32 m0,s61,16384
s_nop 0
buffer_load_dwordx4 v16,s[32:35],s62 offen lds
s_add_u32 s62,s62,131072
s_add_u32 m0,m0,1024
s_waitcnt vmcnt(10)
buffer_load_dwordx4 v16,s[32:35],s62 offen lds
s_add_u32 s62,s62,131072
s_add_u32 m0,m0,1024
s_mov_b32 s64,2097152
buffer_load_dword v29,v28,s[28:31],s64 offen
s_waitcnt vmcnt(10)
buffer_load_dwordx4 v16,s[32:35],s62 offen lds
s_add_u32 s62,s62,131072
s_add_u32 m0,m0,1024
s_waitcnt vmcnt(10)
buffer_load_dwordx4 v16,s[32:35],s62 offen lds
s_add_u32 s62,s62,131072
s_add_u32 m0,m0,1024
s_waitcnt vmcnt(10)
buffer_load_dwordx4 v16,s[32:35],s62 offen lds
s_add_u32 s62,s62,131072
s_add_u32 m0,m0,1024
s_waitcnt vmcnt(10)
buffer_load_dwordx4 v16,s[32:35],s62 offen lds
s_add_u32 s62,s62,131072
s_add_u32 m0,m0,1024
s_mov_b32 s64,2621440
buffer_load_dword v29,v28,s[28:31],s64 offen
s_waitcnt vmcnt(10)
buffer_load_dwordx4 v16,s[32:35],s62 offen lds
s_add_u32 s62,s62,131072
s_add_u32 m0,m0,1024
s_waitcnt vmcnt(10)
buffer_load_dwordx4 v16,s[32:35],s62 offen lds
s_add_u32 s62,s62,131072
s_add_u32 m0,m0,1024
s_waitcnt vmcnt(10)
buffer_load_dwordx4 v16,s[32:35],s62 offen lds
s_add_u32 s62,s62,131072
s_add_u32 m0,m0,1024
s_waitcnt vmcnt(10)
buffer_load_dwordx4 v16,s[32:35],s62 offen lds
s_add_u32 s62,s62,131072
s_add_u32 m0,m0,1024
s_mov_b32 s64,3145728
buffer_load_dword v29,v28,s[28:31],s64 offen
s_waitcnt vmcnt(10)
buffer_load_dwordx4 v16,s[32:35],s62 offen lds
s_add_u32 s62,s62,131072
s_add_u32 m0,m0,1024
s_waitcnt vmcnt(10)
buffer_load_dwordx4 v16,s[32:35],s62 offen lds
s_add_u32 s62,s62,131072
s_add_u32 m0,m0,1024
s_waitcnt vmcnt(10)
buffer_load_dwordx4 v16,s[32:35],s62 offen lds
s_add_u32 s62,s62,131072
s_add_u32 m0,m0,1024
s_waitcnt vmcnt(10)
buffer_load_dwordx4 v16,s[32:35],s62 offen lds
s_add_u32 s62,s62,131072
s_add_u32 m0,m0,1024
s_mov_b32 s64,3670016
buffer_load_dword v29,v28,s[28:31],s64 offen
s_waitcnt vmcnt(10)
buffer_load_dwordx4 v16,s[32:35],s62 offen lds
s_add_u32 s62,s62,131072
s_add_u32 m0,m0,1024
s_waitcnt vmcnt(10)
buffer_load_dwordx4 v16,s[32:35],s62 offen lds
s_waitcnt vmcnt(10)
s_waitcnt vmcnt(20)
ds_read_b64_tr_b16 a[0:1],v17 offset:0
ds_read_b64_tr_b16 a[2:3],v17 offset:256
ds_read_b64_tr_b16 a[4:5],v17 offset:8
ds_read_b64_tr_b16 a[6:7],v17 offset:264
ds_read_b64_tr_b16 a[12:13],v17 offset:2048
ds_read_b64_tr_b16 a[14:15],v17 offset:2304
ds_read_b64_tr_b16 a[16:17],v17 offset:2056
ds_read_b64_tr_b16 a[18:19],v17 offset:2312
ds_read_b64_tr_b16 a[24:25],v17 offset:4096
ds_read_b64_tr_b16 a[26:27],v17 offset:4352
ds_read_b64_tr_b16 a[28:29],v17 offset:4104
ds_read_b64_tr_b16 a[30:31],v17 offset:4360
s_waitcnt lgkmcnt(0)
ds_read_b64_tr_b16 a[36:37],v17 offset:6144
ds_read_b64_tr_b16 a[38:39],v17 offset:6400
ds_read_b64_tr_b16 a[40:41],v17 offset:6152
ds_read_b64_tr_b16 a[42:43],v17 offset:6408
ds_read_b64_tr_b16 a[48:49],v17 offset:8192
ds_read_b64_tr_b16 a[50:51],v17 offset:8448
ds_read_b64_tr_b16 a[52:53],v17 offset:8200
ds_read_b64_tr_b16 a[54:55],v17 offset:8456
ds_read_b64_tr_b16 a[60:61],v17 offset:10240
ds_read_b64_tr_b16 a[62:63],v17 offset:10496
ds_read_b64_tr_b16 a[64:65],v17 offset:10248
ds_read_b64_tr_b16 a[66:67],v17 offset:10504
s_waitcnt lgkmcnt(0)
ds_read_b64_tr_b16 a[72:73],v17 offset:12288
ds_read_b64_tr_b16 a[74:75],v17 offset:12544
ds_read_b64_tr_b16 a[76:77],v17 offset:12296
ds_read_b64_tr_b16 a[78:79],v17 offset:12552
ds_read_b64_tr_b16 a[84:85],v17 offset:14336
ds_read_b64_tr_b16 a[86:87],v17 offset:14592
ds_read_b64_tr_b16 a[88:89],v17 offset:14344
ds_read_b64_tr_b16 a[90:91],v17 offset:14600
s_waitcnt lgkmcnt(0)
s_add_u32 s62,s53,2097152
s_add_u32 m0,s61,0
s_nop 0
buffer_load_dwordx4 v16,s[28:31],s62 offen lds
s_add_u32 s62,s62,131072
s_add_u32 m0,m0,1024
s_waitcnt vmcnt(10)
buffer_load_dwordx4 v16,s[28:31],s62 offen lds
s_add_u32 s62,s62,131072
s_add_u32 m0,m0,1024
s_mov_b32 s64,2097152
buffer_load_dword v29,v31,s[32:35],s64 offen
s_waitcnt vmcnt(10)
buffer_load_dwordx4 v16,s[28:31],s62 offen lds
s_add_u32 s62,s62,131072
s_add_u32 m0,m0,1024
s_waitcnt vmcnt(10)
buffer_load_dwordx4 v16,s[28:31],s62 offen lds
s_add_u32 s62,s62,131072
s_add_u32 m0,m0,1024
s_waitcnt vmcnt(10)
buffer_load_dwordx4 v16,s[28:31],s62 offen lds
s_add_u32 s62,s62,131072
s_add_u32 m0,m0,1024
s_waitcnt vmcnt(10)
buffer_load_dwordx4 v16,s[28:31],s62 offen lds
s_add_u32 s62,s62,131072
s_add_u32 m0,m0,1024
s_waitcnt vmcnt(10)
buffer_load_dwordx4 v16,s[28:31],s62 offen lds
s_add_u32 s62,s62,131072
s_add_u32 m0,m0,1024
s_waitcnt vmcnt(10)
buffer_load_dwordx4 v16,s[28:31],s62 offen lds
s_add_u32 s62,s62,131072
s_add_u32 m0,m0,1024
s_waitcnt vmcnt(10)
buffer_load_dwordx4 v16,s[28:31],s62 offen lds
s_add_u32 s62,s62,131072
s_add_u32 m0,m0,1024
s_waitcnt vmcnt(10)
buffer_load_dwordx4 v16,s[28:31],s62 offen lds
s_add_u32 s62,s62,131072
s_add_u32 m0,m0,1024
s_mov_b32 s64,3145728
buffer_load_dword v29,v31,s[32:35],s64 offen
s_waitcnt vmcnt(10)
buffer_load_dwordx4 v16,s[28:31],s62 offen lds
s_add_u32 s62,s62,131072
s_add_u32 m0,m0,1024
s_waitcnt vmcnt(10)
buffer_load_dwordx4 v16,s[28:31],s62 offen lds
s_add_u32 s62,s62,131072
s_add_u32 m0,m0,1024
s_waitcnt vmcnt(10)
buffer_load_dwordx4 v16,s[28:31],s62 offen lds
s_add_u32 s62,s62,131072
s_add_u32 m0,m0,1024
s_waitcnt vmcnt(10)
buffer_load_dwordx4 v16,s[28:31],s62 offen lds
s_add_u32 s62,s62,131072
s_add_u32 m0,m0,1024
s_waitcnt vmcnt(10)
buffer_load_dwordx4 v16,s[28:31],s62 offen lds
s_add_u32 s62,s62,131072
s_add_u32 m0,m0,1024
s_waitcnt vmcnt(10)
buffer_load_dwordx4 v16,s[28:31],s62 offen lds
s_waitcnt vmcnt(10)
s_waitcnt vmcnt(18)
v_add_u32 v18,s54,v17
ds_read_b64_tr_b16 a[8:9],v18 offset:16384
ds_read_b64_tr_b16 a[10:11],v18 offset:16640
ds_read_b64_tr_b16 a[20:21],v18 offset:18432
ds_read_b64_tr_b16 a[22:23],v18 offset:18688
ds_read_b64_tr_b16 a[32:33],v18 offset:20480
ds_read_b64_tr_b16 a[34:35],v18 offset:20736
ds_read_b64_tr_b16 a[44:45],v18 offset:22528
ds_read_b64_tr_b16 a[46:47],v18 offset:22784
ds_read_b64_tr_b16 a[56:57],v18 offset:24576
ds_read_b64_tr_b16 a[58:59],v18 offset:24832
ds_read_b64_tr_b16 a[68:69],v18 offset:26624
ds_read_b64_tr_b16 a[70:71],v18 offset:26880
s_waitcnt lgkmcnt(0)
ds_read_b64_tr_b16 a[80:81],v18 offset:28672
ds_read_b64_tr_b16 a[82:83],v18 offset:28928
ds_read_b64_tr_b16 a[92:93],v18 offset:30720
ds_read_b64_tr_b16 a[94:95],v18 offset:30976
s_waitcnt lgkmcnt(0)
s_add_u32 s62,s52,2097152
s_add_u32 m0,s61,16384
s_nop 0
buffer_load_dwordx4 v16,s[32:35],s62 offen lds
s_add_u32 s62,s62,131072
s_add_u32 m0,m0,1024
s_waitcnt vmcnt(10)
buffer_load_dwordx4 v16,s[32:35],s62 offen lds
s_add_u32 s62,s62,131072
s_add_u32 m0,m0,1024
s_mov_b32 s64,4194304
buffer_load_dword v29,v28,s[28:31],s64 offen
s_waitcnt vmcnt(10)
buffer_load_dwordx4 v16,s[32:35],s62 offen lds
s_add_u32 s62,s62,131072
s_add_u32 m0,m0,1024
s_waitcnt vmcnt(10)
buffer_load_dwordx4 v16,s[32:35],s62 offen lds
s_add_u32 s62,s62,131072
s_add_u32 m0,m0,1024
s_waitcnt vmcnt(10)
buffer_load_dwordx4 v16,s[32:35],s62 offen lds
s_add_u32 s62,s62,131072
s_add_u32 m0,m0,1024
s_waitcnt vmcnt(10)
buffer_load_dwordx4 v16,s[32:35],s62 offen lds
s_add_u32 s62,s62,131072
s_add_u32 m0,m0,1024
s_mov_b32 s64,4718592
buffer_load_dword v29,v28,s[28:31],s64 offen
s_waitcnt vmcnt(10)
buffer_load_dwordx4 v16,s[32:35],s62 offen lds
s_add_u32 s62,s62,131072
s_add_u32 m0,m0,1024
s_waitcnt vmcnt(10)
buffer_load_dwordx4 v16,s[32:35],s62 offen lds
s_add_u32 s62,s62,131072
s_add_u32 m0,m0,1024
s_waitcnt vmcnt(10)
buffer_load_dwordx4 v16,s[32:35],s62 offen lds
s_add_u32 s62,s62,131072
s_add_u32 m0,m0,1024
s_waitcnt vmcnt(10)
buffer_load_dwordx4 v16,s[32:35],s62 offen lds
s_add_u32 s62,s62,131072
s_add_u32 m0,m0,1024
s_mov_b32 s64,5242880
buffer_load_dword v29,v28,s[28:31],s64 offen
s_waitcnt vmcnt(10)
buffer_load_dwordx4 v16,s[32:35],s62 offen lds
s_add_u32 s62,s62,131072
s_add_u32 m0,m0,1024
s_waitcnt vmcnt(10)
buffer_load_dwordx4 v16,s[32:35],s62 offen lds
s_add_u32 s62,s62,131072
s_add_u32 m0,m0,1024
s_waitcnt vmcnt(10)
buffer_load_dwordx4 v16,s[32:35],s62 offen lds
s_add_u32 s62,s62,131072
s_add_u32 m0,m0,1024
s_waitcnt vmcnt(10)
buffer_load_dwordx4 v16,s[32:35],s62 offen lds
s_add_u32 s62,s62,131072
s_add_u32 m0,m0,1024
s_mov_b32 s64,5767168
buffer_load_dword v29,v28,s[28:31],s64 offen
s_waitcnt vmcnt(10)
buffer_load_dwordx4 v16,s[32:35],s62 offen lds
s_add_u32 s62,s62,131072
s_add_u32 m0,m0,1024
s_waitcnt vmcnt(10)
buffer_load_dwordx4 v16,s[32:35],s62 offen lds
s_waitcnt vmcnt(10)
s_waitcnt vmcnt(20)
ds_read_b64_tr_b16 a[96:97],v17 offset:0
ds_read_b64_tr_b16 a[98:99],v17 offset:256
ds_read_b64_tr_b16 a[100:101],v17 offset:8
ds_read_b64_tr_b16 a[102:103],v17 offset:264
ds_read_b64_tr_b16 a[108:109],v17 offset:2048
ds_read_b64_tr_b16 a[110:111],v17 offset:2304
ds_read_b64_tr_b16 a[112:113],v17 offset:2056
ds_read_b64_tr_b16 a[114:115],v17 offset:2312
ds_read_b64_tr_b16 a[120:121],v17 offset:4096
ds_read_b64_tr_b16 a[122:123],v17 offset:4352
ds_read_b64_tr_b16 a[124:125],v17 offset:4104
ds_read_b64_tr_b16 a[126:127],v17 offset:4360
s_waitcnt lgkmcnt(0)
ds_read_b64_tr_b16 a[132:133],v17 offset:6144
ds_read_b64_tr_b16 a[134:135],v17 offset:6400
ds_read_b64_tr_b16 a[136:137],v17 offset:6152
ds_read_b64_tr_b16 a[138:139],v17 offset:6408
ds_read_b64_tr_b16 a[144:145],v17 offset:8192
ds_read_b64_tr_b16 a[146:147],v17 offset:8448
ds_read_b64_tr_b16 a[148:149],v17 offset:8200
ds_read_b64_tr_b16 a[150:151],v17 offset:8456
ds_read_b64_tr_b16 a[156:157],v17 offset:10240
ds_read_b64_tr_b16 a[158:159],v17 offset:10496
ds_read_b64_tr_b16 a[160:161],v17 offset:10248
ds_read_b64_tr_b16 a[162:163],v17 offset:10504
s_waitcnt lgkmcnt(0)
ds_read_b64_tr_b16 a[168:169],v17 offset:12288
ds_read_b64_tr_b16 a[170:171],v17 offset:12544
ds_read_b64_tr_b16 a[172:173],v17 offset:12296
ds_read_b64_tr_b16 a[174:175],v17 offset:12552
ds_read_b64_tr_b16 a[180:181],v17 offset:14336
ds_read_b64_tr_b16 a[182:183],v17 offset:14592
ds_read_b64_tr_b16 a[184:185],v17 offset:14344
ds_read_b64_tr_b16 a[186:187],v17 offset:14600
s_waitcnt lgkmcnt(0)
s_add_u32 s62,s53,4194304
s_add_u32 m0,s61,0
s_nop 0
buffer_load_dwordx4 v16,s[28:31],s62 offen lds
s_add_u32 s62,s62,131072
s_add_u32 m0,m0,1024
s_waitcnt vmcnt(10)
buffer_load_dwordx4 v16,s[28:31],s62 offen lds
s_add_u32 s62,s62,131072
s_add_u32 m0,m0,1024
s_mov_b32 s64,4194304
buffer_load_dword v29,v31,s[32:35],s64 offen
s_waitcnt vmcnt(10)
buffer_load_dwordx4 v16,s[28:31],s62 offen lds
s_add_u32 s62,s62,131072
s_add_u32 m0,m0,1024
s_waitcnt vmcnt(10)
buffer_load_dwordx4 v16,s[28:31],s62 offen lds
s_add_u32 s62,s62,131072
s_add_u32 m0,m0,1024
s_waitcnt vmcnt(10)
buffer_load_dwordx4 v16,s[28:31],s62 offen lds
s_add_u32 s62,s62,131072
s_add_u32 m0,m0,1024
s_waitcnt vmcnt(10)
buffer_load_dwordx4 v16,s[28:31],s62 offen lds
s_add_u32 s62,s62,131072
s_add_u32 m0,m0,1024
s_waitcnt vmcnt(10)
buffer_load_dwordx4 v16,s[28:31],s62 offen lds
s_add_u32 s62,s62,131072
s_add_u32 m0,m0,1024
s_waitcnt vmcnt(10)
buffer_load_dwordx4 v16,s[28:31],s62 offen lds
s_add_u32 s62,s62,131072
s_add_u32 m0,m0,1024
s_waitcnt vmcnt(10)
buffer_load_dwordx4 v16,s[28:31],s62 offen lds
s_add_u32 s62,s62,131072
s_add_u32 m0,m0,1024
s_waitcnt vmcnt(10)
buffer_load_dwordx4 v16,s[28:31],s62 offen lds
s_add_u32 s62,s62,131072
s_add_u32 m0,m0,1024
s_mov_b32 s64,5242880
buffer_load_dword v29,v31,s[32:35],s64 offen
s_waitcnt vmcnt(10)
buffer_load_dwordx4 v16,s[28:31],s62 offen lds
s_add_u32 s62,s62,131072
s_add_u32 m0,m0,1024
s_waitcnt vmcnt(10)
buffer_load_dwordx4 v16,s[28:31],s62 offen lds
s_add_u32 s62,s62,131072
s_add_u32 m0,m0,1024
s_waitcnt vmcnt(10)
buffer_load_dwordx4 v16,s[28:31],s62 offen lds
s_add_u32 s62,s62,131072
s_add_u32 m0,m0,1024
s_waitcnt vmcnt(10)
buffer_load_dwordx4 v16,s[28:31],s62 offen lds
s_add_u32 s62,s62,131072
s_add_u32 m0,m0,1024
s_waitcnt vmcnt(10)
buffer_load_dwordx4 v16,s[28:31],s62 offen lds
s_add_u32 s62,s62,131072
s_add_u32 m0,m0,1024
s_waitcnt vmcnt(10)
buffer_load_dwordx4 v16,s[28:31],s62 offen lds
s_waitcnt vmcnt(10)
s_waitcnt vmcnt(18)
ds_read_b64_tr_b16 a[104:105],v18 offset:16384
ds_read_b64_tr_b16 a[106:107],v18 offset:16640
ds_read_b64_tr_b16 a[116:117],v18 offset:18432
ds_read_b64_tr_b16 a[118:119],v18 offset:18688
ds_read_b64_tr_b16 a[128:129],v18 offset:20480
ds_read_b64_tr_b16 a[130:131],v18 offset:20736
ds_read_b64_tr_b16 a[140:141],v18 offset:22528
ds_read_b64_tr_b16 a[142:143],v18 offset:22784
ds_read_b64_tr_b16 a[152:153],v18 offset:24576
ds_read_b64_tr_b16 a[154:155],v18 offset:24832
ds_read_b64_tr_b16 a[164:165],v18 offset:26624
ds_read_b64_tr_b16 a[166:167],v18 offset:26880
s_waitcnt lgkmcnt(0)
ds_read_b64_tr_b16 a[176:177],v18 offset:28672
ds_read_b64_tr_b16 a[178:179],v18 offset:28928
ds_read_b64_tr_b16 a[188:189],v18 offset:30720
ds_read_b64_tr_b16 a[190:191],v18 offset:30976
s_waitcnt lgkmcnt(0)
s_add_u32 s62,s52,4194304
s_add_u32 m0,s61,16384
s_nop 0
buffer_load_dwordx4 v16,s[32:35],s62 offen lds
s_add_u32 s62,s62,131072
s_add_u32 m0,m0,1024
s_waitcnt vmcnt(10)
buffer_load_dwordx4 v16,s[32:35],s62 offen lds
s_add_u32 s62,s62,131072
s_add_u32 m0,m0,1024
s_mov_b32 s64,6291456
buffer_load_dword v29,v28,s[28:31],s64 offen
s_waitcnt vmcnt(10)
buffer_load_dwordx4 v16,s[32:35],s62 offen lds
s_add_u32 s62,s62,131072
s_add_u32 m0,m0,1024
s_waitcnt vmcnt(10)
buffer_load_dwordx4 v16,s[32:35],s62 offen lds
s_add_u32 s62,s62,131072
s_add_u32 m0,m0,1024
s_waitcnt vmcnt(10)
buffer_load_dwordx4 v16,s[32:35],s62 offen lds
s_add_u32 s62,s62,131072
s_add_u32 m0,m0,1024
s_waitcnt vmcnt(10)
buffer_load_dwordx4 v16,s[32:35],s62 offen lds
s_add_u32 s62,s62,131072
s_add_u32 m0,m0,1024
s_mov_b32 s64,6815744
buffer_load_dword v29,v28,s[28:31],s64 offen
s_waitcnt vmcnt(10)
buffer_load_dwordx4 v16,s[32:35],s62 offen lds
s_add_u32 s62,s62,131072
s_add_u32 m0,m0,1024
s_waitcnt vmcnt(10)
buffer_load_dwordx4 v16,s[32:35],s62 offen lds
s_add_u32 s62,s62,131072
s_add_u32 m0,m0,1024
s_waitcnt vmcnt(10)
buffer_load_dwordx4 v16,s[32:35],s62 offen lds
s_add_u32 s62,s62,131072
s_add_u32 m0,m0,1024
s_waitcnt vmcnt(10)
buffer_load_dwordx4 v16,s[32:35],s62 offen lds
s_add_u32 s62,s62,131072
s_add_u32 m0,m0,1024
s_mov_b32 s64,7340032
buffer_load_dword v29,v28,s[28:31],s64 offen
s_waitcnt vmcnt(10)
buffer_load_dwordx4 v16,s[32:35],s62 offen lds
s_add_u32 s62,s62,131072
s_add_u32 m0,m0,1024
s_waitcnt vmcnt(10)
buffer_load_dwordx4 v16,s[32:35],s62 offen lds
s_add_u32 s62,s62,131072
s_add_u32 m0,m0,1024
s_waitcnt vmcnt(10)
buffer_load_dwordx4 v16,s[32:35],s62 offen lds
s_add_u32 s62,s62,131072
s_add_u32 m0,m0,1024
s_waitcnt vmcnt(10)
buffer_load_dwordx4 v16,s[32:35],s62 offen lds
s_add_u32 s62,s62,131072
s_add_u32 m0,m0,1024
s_mov_b32 s64,7864320
buffer_load_dword v29,v28,s[28:31],s64 offen
s_waitcnt vmcnt(10)
buffer_load_dwordx4 v16,s[32:35],s62 offen lds
s_add_u32 s62,s62,131072
s_add_u32 m0,m0,1024
s_waitcnt vmcnt(10)
buffer_load_dwordx4 v16,s[32:35],s62 offen lds
s_waitcnt vmcnt(10)
s_waitcnt vmcnt(20)
ds_read_b64_tr_b16 a[192:193],v17 offset:0
ds_read_b64_tr_b16 a[194:195],v17 offset:256
ds_read_b64_tr_b16 a[196:197],v17 offset:8
ds_read_b64_tr_b16 a[198:199],v17 offset:264
ds_read_b64_tr_b16 a[204:205],v17 offset:2048
ds_read_b64_tr_b16 a[206:207],v17 offset:2304
ds_read_b64_tr_b16 a[208:209],v17 offset:2056
ds_read_b64_tr_b16 a[210:211],v17 offset:2312
ds_read_b64_tr_b16 a[216:217],v17 offset:4096
ds_read_b64_tr_b16 a[218:219],v17 offset:4352
ds_read_b64_tr_b16 a[220:221],v17 offset:4104
ds_read_b64_tr_b16 a[222:223],v17 offset:4360
s_waitcnt lgkmcnt(0)
ds_read_b64_tr_b16 a[228:229],v17 offset:6144
ds_read_b64_tr_b16 a[230:231],v17 offset:6400
ds_read_b64_tr_b16 a[232:233],v17 offset:6152
ds_read_b64_tr_b16 a[234:235],v17 offset:6408
ds_read_b64_tr_b16 a[240:241],v17 offset:8192
ds_read_b64_tr_b16 a[242:243],v17 offset:8448
ds_read_b64_tr_b16 a[244:245],v17 offset:8200
ds_read_b64_tr_b16 a[246:247],v17 offset:8456
ds_read_b64_tr_b16 a[252:253],v17 offset:10240
ds_read_b64_tr_b16 a[254:255],v17 offset:10496
ds_read_b64_tr_b16 v[128:129],v17 offset:10248
ds_read_b64_tr_b16 v[130:131],v17 offset:10504
s_waitcnt lgkmcnt(0)
ds_read_b64_tr_b16 v[136:137],v17 offset:12288
ds_read_b64_tr_b16 v[138:139],v17 offset:12544
ds_read_b64_tr_b16 v[140:141],v17 offset:12296
ds_read_b64_tr_b16 v[142:143],v17 offset:12552
ds_read_b64_tr_b16 v[148:149],v17 offset:14336
ds_read_b64_tr_b16 v[150:151],v17 offset:14592
ds_read_b64_tr_b16 v[152:153],v17 offset:14344
ds_read_b64_tr_b16 v[154:155],v17 offset:14600
s_waitcnt lgkmcnt(0)
s_add_u32 s62,s53,6291456
s_add_u32 m0,s61,0
s_nop 0
buffer_load_dwordx4 v16,s[28:31],s62 offen lds
s_add_u32 s62,s62,131072
s_add_u32 m0,m0,1024
s_waitcnt vmcnt(10)
buffer_load_dwordx4 v16,s[28:31],s62 offen lds
s_add_u32 s62,s62,131072
s_add_u32 m0,m0,1024
s_mov_b32 s64,6291456
buffer_load_dword v29,v31,s[32:35],s64 offen
s_waitcnt vmcnt(10)
buffer_load_dwordx4 v16,s[28:31],s62 offen lds
s_add_u32 s62,s62,131072
s_add_u32 m0,m0,1024
s_waitcnt vmcnt(10)
buffer_load_dwordx4 v16,s[28:31],s62 offen lds
s_add_u32 s62,s62,131072
s_add_u32 m0,m0,1024
s_waitcnt vmcnt(10)
buffer_load_dwordx4 v16,s[28:31],s62 offen lds
s_add_u32 s62,s62,131072
s_add_u32 m0,m0,1024
s_waitcnt vmcnt(10)
buffer_load_dwordx4 v16,s[28:31],s62 offen lds
s_add_u32 s62,s62,131072
s_add_u32 m0,m0,1024
s_waitcnt vmcnt(10)
buffer_load_dwordx4 v16,s[28:31],s62 offen lds
s_add_u32 s62,s62,131072
s_add_u32 m0,m0,1024
s_waitcnt vmcnt(10)
buffer_load_dwordx4 v16,s[28:31],s62 offen lds
s_add_u32 s62,s62,131072
s_add_u32 m0,m0,1024
s_waitcnt vmcnt(10)
buffer_load_dwordx4 v16,s[28:31],s62 offen lds
s_add_u32 s62,s62,131072
s_add_u32 m0,m0,1024
s_waitcnt vmcnt(10)
buffer_load_dwordx4 v16,s[28:31],s62 offen lds
s_add_u32 s62,s62,131072
s_add_u32 m0,m0,1024
s_mov_b32 s64,7340032
buffer_load_dword v29,v31,s[32:35],s64 offen
s_waitcnt vmcnt(10)
buffer_load_dwordx4 v16,s[28:31],s62 offen lds
s_add_u32 s62,s62,131072
s_add_u32 m0,m0,1024
s_waitcnt vmcnt(10)
buffer_load_dwordx4 v16,s[28:31],s62 offen lds
s_add_u32 s62,s62,131072
s_add_u32 m0,m0,1024
s_waitcnt vmcnt(10)
buffer_load_dwordx4 v16,s[28:31],s62 offen lds
s_add_u32 s62,s62,131072
s_add_u32 m0,m0,1024
s_waitcnt vmcnt(10)
buffer_load_dwordx4 v16,s[28:31],s62 offen lds
s_add_u32 s62,s62,131072
s_add_u32 m0,m0,1024
s_waitcnt vmcnt(10)
buffer_load_dwordx4 v16,s[28:31],s62 offen lds
s_add_u32 s62,s62,131072
s_add_u32 m0,m0,1024
s_waitcnt vmcnt(10)
buffer_load_dwordx4 v16,s[28:31],s62 offen lds
s_waitcnt vmcnt(10)
s_waitcnt vmcnt(18)
ds_read_b64_tr_b16 a[200:201],v18 offset:16384
ds_read_b64_tr_b16 a[202:203],v18 offset:16640
ds_read_b64_tr_b16 a[212:213],v18 offset:18432
ds_read_b64_tr_b16 a[214:215],v18 offset:18688
ds_read_b64_tr_b16 a[224:225],v18 offset:20480
ds_read_b64_tr_b16 a[226:227],v18 offset:20736
ds_read_b64_tr_b16 a[236:237],v18 offset:22528
ds_read_b64_tr_b16 a[238:239],v18 offset:22784
ds_read_b64_tr_b16 a[248:249],v18 offset:24576
ds_read_b64_tr_b16 a[250:251],v18 offset:24832
ds_read_b64_tr_b16 v[132:133],v18 offset:26624
ds_read_b64_tr_b16 v[134:135],v18 offset:26880
s_waitcnt lgkmcnt(0)
ds_read_b64_tr_b16 v[144:145],v18 offset:28672
ds_read_b64_tr_b16 v[146:147],v18 offset:28928
ds_read_b64_tr_b16 v[156:157],v18 offset:30720
ds_read_b64_tr_b16 v[158:159],v18 offset:30976
s_waitcnt lgkmcnt(0)
s_add_u32 s62,s52,6291456
s_add_u32 m0,s61,16384
s_nop 0
buffer_load_dwordx4 v16,s[32:35],s62 offen lds
s_add_u32 s62,s62,131072
s_add_u32 m0,m0,1024
s_waitcnt vmcnt(10)
buffer_load_dwordx4 v16,s[32:35],s62 offen lds
s_add_u32 s62,s62,131072
s_add_u32 m0,m0,1024
s_waitcnt vmcnt(10)
buffer_load_dwordx4 v16,s[32:35],s62 offen lds
s_add_u32 s62,s62,131072
s_add_u32 m0,m0,1024
s_waitcnt vmcnt(10)
buffer_load_dwordx4 v16,s[32:35],s62 offen lds
s_add_u32 s62,s62,131072
s_add_u32 m0,m0,1024
s_waitcnt vmcnt(10)
buffer_load_dwordx4 v16,s[32:35],s62 offen lds
s_add_u32 s62,s62,131072
s_add_u32 m0,m0,1024
s_waitcnt vmcnt(10)
buffer_load_dwordx4 v16,s[32:35],s62 offen lds
s_add_u32 s62,s62,131072
s_add_u32 m0,m0,1024
s_waitcnt vmcnt(10)
buffer_load_dwordx4 v16,s[32:35],s62 offen lds
s_add_u32 s62,s62,131072
s_add_u32 m0,m0,1024
s_waitcnt vmcnt(10)
buffer_load_dwordx4 v16,s[32:35],s62 offen lds
s_add_u32 s62,s62,131072
s_add_u32 m0,m0,1024
s_waitcnt vmcnt(10)
buffer_load_dwordx4 v16,s[32:35],s62 offen lds
s_add_u32 s62,s62,131072
s_add_u32 m0,m0,1024
s_waitcnt vmcnt(10)
buffer_load_dwordx4 v16,s[32:35],s62 offen lds
s_add_u32 s62,s62,131072
s_add_u32 m0,m0,1024
s_waitcnt vmcnt(10)
buffer_load_dwordx4 v16,s[32:35],s62 offen lds
s_add_u32 s62,s62,131072
s_add_u32 m0,m0,1024
s_waitcnt vmcnt(10)
buffer_load_dwordx4 v16,s[32:35],s62 offen lds
s_add_u32 s62,s62,131072
s_add_u32 m0,m0,1024
s_waitcnt vmcnt(10)
buffer_load_dwordx4 v16,s[32:35],s62 offen lds
s_add_u32 s62,s62,131072
s_add_u32 m0,m0,1024
s_waitcnt vmcnt(10)
buffer_load_dwordx4 v16,s[32:35],s62 offen lds
s_add_u32 s62,s62,131072
s_add_u32 m0,m0,1024
s_waitcnt vmcnt(10)
buffer_load_dwordx4 v16,s[32:35],s62 offen lds
s_add_u32 s62,s62,131072
s_add_u32 m0,m0,1024
s_waitcnt vmcnt(10)
buffer_load_dwordx4 v16,s[32:35],s62 offen lds
s_waitcnt vmcnt(10)
s_waitcnt vmcnt(16)
ds_read_b64_tr_b16 v[160:161],v17 offset:0
ds_read_b64_tr_b16 v[162:163],v17 offset:256
ds_read_b64_tr_b16 v[164:165],v17 offset:8
ds_read_b64_tr_b16 v[166:167],v17 offset:264
ds_read_b64_tr_b16 v[172:173],v17 offset:2048
ds_read_b64_tr_b16 v[174:175],v17 offset:2304
ds_read_b64_tr_b16 v[176:177],v17 offset:2056
ds_read_b64_tr_b16 v[178:179],v17 offset:2312
ds_read_b64_tr_b16 v[184:185],v17 offset:4096
ds_read_b64_tr_b16 v[186:187],v17 offset:4352
ds_read_b64_tr_b16 v[188:189],v17 offset:4104
ds_read_b64_tr_b16 v[190:191],v17 offset:4360
s_waitcnt lgkmcnt(0)
ds_read_b64_tr_b16 v[196:197],v17 offset:6144
ds_read_b64_tr_b16 v[198:199],v17 offset:6400
ds_read_b64_tr_b16 v[200:201],v17 offset:6152
ds_read_b64_tr_b16 v[202:203],v17 offset:6408
ds_read_b64_tr_b16 v[208:209],v17 offset:8192
ds_read_b64_tr_b16 v[210:211],v17 offset:8448
ds_read_b64_tr_b16 v[212:213],v17 offset:8200
ds_read_b64_tr_b16 v[214:215],v17 offset:8456
ds_read_b64_tr_b16 v[220:221],v17 offset:10240
ds_read_b64_tr_b16 v[222:223],v17 offset:10496
ds_read_b64_tr_b16 v[224:225],v17 offset:10248
ds_read_b64_tr_b16 v[226:227],v17 offset:10504
s_waitcnt lgkmcnt(0)
ds_read_b64_tr_b16 v[232:233],v17 offset:12288
ds_read_b64_tr_b16 v[234:235],v17 offset:12544
ds_read_b64_tr_b16 v[236:237],v17 offset:12296
ds_read_b64_tr_b16 v[238:239],v17 offset:12552
ds_read_b64_tr_b16 v[244:245],v17 offset:14336
ds_read_b64_tr_b16 v[246:247],v17 offset:14592
ds_read_b64_tr_b16 v[248:249],v17 offset:14344
ds_read_b64_tr_b16 v[250:251],v17 offset:14600
s_waitcnt lgkmcnt(0)
s_waitcnt vmcnt(0)
ds_read_b64_tr_b16 v[168:169],v18 offset:16384
ds_read_b64_tr_b16 v[170:171],v18 offset:16640
ds_read_b64_tr_b16 v[180:181],v18 offset:18432
ds_read_b64_tr_b16 v[182:183],v18 offset:18688
ds_read_b64_tr_b16 v[192:193],v18 offset:20480
ds_read_b64_tr_b16 v[194:195],v18 offset:20736
ds_read_b64_tr_b16 v[204:205],v18 offset:22528
ds_read_b64_tr_b16 v[206:207],v18 offset:22784
ds_read_b64_tr_b16 v[216:217],v18 offset:24576
ds_read_b64_tr_b16 v[218:219],v18 offset:24832
ds_read_b64_tr_b16 v[228:229],v18 offset:26624
ds_read_b64_tr_b16 v[230:231],v18 offset:26880
s_waitcnt lgkmcnt(0)
ds_read_b64_tr_b16 v[240:241],v18 offset:28672
ds_read_b64_tr_b16 v[242:243],v18 offset:28928
ds_read_b64_tr_b16 v[252:253],v18 offset:30720
ds_read_b64_tr_b16 v[254:255],v18 offset:30976
s_waitcnt lgkmcnt(0)
s_mov_b32 s92,s2
s_and_b32 s93,s3,0xffff
s_mov_b32 s94,0x100
s_mov_b32 s95,0x20000
v_mbcnt_lo_u32_b32 v16,-1,0
v_mbcnt_hi_u32_b32 v16,-1,v16
v_mov_b32 v18,0
v_cmp_eq_u32 vcc,22,v16
s_nop 1
v_cndmask_b32 v18,v18,63,vcc
v_cmp_eq_u32 vcc,19,v16
s_nop 1
v_cndmask_b32 v18,v18,64,vcc
v_cmp_eq_u32 vcc,21,v16
s_nop 1
v_cndmask_b32 v18,v18,1,vcc
v_and_b32 v19,1,v16
v_cmp_eq_u32 vcc,1,v19
v_mov_b32 v19,8192
s_nop 0
v_cndmask_b32 v19,-1,v19,vcc
v_min_u32 v16,31,v16
v_lshlrev_b32 v16,2,v16
s_sub_u32 s66,s88,64
s_cmp_lg_u32 s50,0
s_cbranch_scc1 vot_50
vpoll_46:
buffer_load_dword v17,v16,s[92:95],s66 offen sc1
s_waitcnt vmcnt(0)
s_cmp_lg_u32 s56,2
s_cbranch_scc1 vck_47
v_cmp_eq_u32 vcc,v17,v19
s_and_b32 s64,vcc_lo,0xffff
s_cmp_eq_u32 s64,65535
s_cbranch_scc1 vck_47
s_mov_b32 s65,0
v_readlane_b32 s64,v17,1
s_lshr_b32 s64,s64,8
s_add_u32 s65,s65,s64
v_readlane_b32 s64,v17,3
s_lshr_b32 s64,s64,8
s_add_u32 s65,s65,s64
v_readlane_b32 s64,v17,5
s_lshr_b32 s64,s64,8
s_add_u32 s65,s65,s64
v_readlane_b32 s64,v17,7
s_lshr_b32 s64,s64,8
s_add_u32 s65,s65,s64
v_readlane_b32 s64,v17,9
s_lshr_b32 s64,s64,8
s_add_u32 s65,s65,s64
v_readlane_b32 s64,v17,11
s_lshr_b32 s64,s64,8
s_add_u32 s65,s65,s64
v_readlane_b32 s64,v17,13
s_lshr_b32 s64,s64,8
s_add_u32 s65,s65,s64
v_readlane_b32 s64,v17,15
s_lshr_b32 s64,s64,8
s_add_u32 s65,s65,s64
s_cmp_ge_u32 s65,256
s_cbranch_scc1 vok_49
s_branch vrt_48
vck_47:
v_cmp_gt_u32 vcc,v18,v17
s_cbranch_vccz vok_49
vrt_48:
s_sleep 8
s_sub_u32 s90,s90,1
s_cmp_gt_i32 s90,0
s_cbranch_scc1 vpoll_46
vok_49:
v_add_u32 v18,160768,v16
ds_write_b32 v18,v17
s_waitcnt lgkmcnt(0)
vot_50:
s_barrier
v_add_u32 v18,160768,v16
ds_read_b32 v17,v18
s_waitcnt lgkmcnt(0)
s_cmp_lg_u32 s56,2
s_cbranch_scc1 vfin_51
v_cmp_eq_u32 vcc,v17,v19
s_and_b32 s64,vcc_lo,0xffff
s_cmp_eq_u32 s64,65535
s_cbranch_scc1 vfin_51
s_mov_b32 s65,0
v_readlane_b32 s64,v17,1
s_lshr_b32 s64,s64,8
s_add_u32 s65,s65,s64
v_readlane_b32 s64,v17,3
s_lshr_b32 s64,s64,8
s_add_u32 s65,s65,s64
v_readlane_b32 s64,v17,5
s_lshr_b32 s64,s64,8
s_add_u32 s65,s65,s64
v_readlane_b32 s64,v17,7
s_lshr_b32 s64,s64,8
s_add_u32 s65,s65,s64
v_readlane_b32 s64,v17,9
s_lshr_b32 s64,s64,8
s_add_u32 s65,s65,s64
v_readlane_b32 s64,v17,11
s_lshr_b32 s64,s64,8
s_add_u32 s65,s65,s64
v_readlane_b32 s64,v17,13
s_lshr_b32 s64,s64,8
s_add_u32 s65,s65,s64
v_readlane_b32 s64,v17,15
s_lshr_b32 s64,s64,8
s_add_u32 s65,s65,s64
s_cmp_ge_u32 s65,256
s_cbranch_scc1 fl_fb
vfin_51:
s_and_b32 s56,s56,1
s_mov_b32 s67,0
v_readlane_b32 s65,v17,21
s_and_b32 s65,s65,2
s_lshl_b32 s67,s65,12
s_barrier
v_lshlrev_b32 v0,4,v1
s_mov_b32 s60,0
s_lshl_b32 s63,s50,13
s_add_u32 s61,s63,146800640
s_mov_b32 s70,0
s_lshl_b32 s52,s59,14
s_and_b32 s64,s50,1
s_lshl_b32 s64,s64,11
s_add_u32 s53,s52,s64
s_lshl_b32 s64,s50,10
s_add_u32 s52,s52,s64
s_add_u32 s52,s52,4096
s_cmp_gt_u32 s50,1
s_cselect_b32 s54,0x2000,0
s_lshl_b32 s69,s59,6
s_add_u32 s69,s69,s67
s_add_u32 s69,s69,138412032
v_mov_b32 v4,v0
v_add_u32 v5,32768,v0
s_add_u32 m0,s70,s63
s_add_u32 s62,s61,4096
buffer_load_dwordx4 v0,s[20:23],s61 offen offset:0 lds
buffer_load_dwordx4 v0,s[20:23],s61 offen offset:1024 lds
buffer_load_dwordx4 v0,s[20:23],s61 offen offset:2048 lds
buffer_load_dwordx4 v0,s[20:23],s61 offen offset:3072 lds
s_add_u32 m0,m0,4096
s_nop 0
buffer_load_dwordx4 v0,s[20:23],s62 offen offset:0 lds
buffer_load_dwordx4 v0,s[20:23],s62 offen offset:1024 lds
buffer_load_dwordx4 v0,s[20:23],s62 offen offset:2048 lds
buffer_load_dwordx4 v0,s[20:23],s62 offen offset:3072 lds
s_add_u32 s61,s61,32768
s_add_u32 s70,s70,32768
s_and_b32 s70,s70,0x1ffff
s_add_u32 m0,s70,s63
s_add_u32 s62,s61,4096
buffer_load_dwordx4 v0,s[20:23],s61 offen offset:0 lds
buffer_load_dwordx4 v0,s[20:23],s61 offen offset:1024 lds
buffer_load_dwordx4 v0,s[20:23],s61 offen offset:2048 lds
buffer_load_dwordx4 v0,s[20:23],s61 offen offset:3072 lds
s_add_u32 m0,m0,4096
s_nop 0
buffer_load_dwordx4 v0,s[20:23],s62 offen offset:0 lds
buffer_load_dwordx4 v0,s[20:23],s62 offen offset:1024 lds
buffer_load_dwordx4 v0,s[20:23],s62 offen offset:2048 lds
buffer_load_dwordx4 v0,s[20:23],s62 offen offset:3072 lds
s_add_u32 s61,s61,32768
s_add_u32 s70,s70,32768
s_and_b32 s70,s70,0x1ffff
s_waitcnt vmcnt(8)
s_barrier
ds_read_b128 v[64:67],v4 offset:0
ds_read_b128 v[68:71],v4 offset:1024
ds_read_b128 v[72:75],v4 offset:2048
ds_read_b128 v[76:79],v4 offset:3072
ds_read_b128 v[80:83],v4 offset:4096
top_52:
s_waitcnt lgkmcnt(4)
v_mfma_f32_16x16x32_bf16 v[32:35],a[0:3],v[64:67],0
ds_read_b128 v[84:87],v4 offset:5120
v_mfma_f32_16x16x32_bf16 v[36:39],a[4:7],v[64:67],0
v_mfma_f32_16x16x32_bf16 v[40:43],v[64:67],a[8:11],0
s_waitcnt lgkmcnt(4)
v_mfma_f32_16x16x32_bf16 v[32:35],a[12:15],v[68:71],v[32:35]
ds_read_b128 v[88:91],v4 offset:6144
s_sub_u32 s66,s60,1
s_lshr_b32 s64,s66,1
v_mfma_f32_16x16x32_bf16 v[36:39],a[16:19],v[68:71],v[36:39]
s_lshl_b32 s65,s64,12
s_and_b32 s65,s65,0x2000
v_mfma_f32_16x16x32_bf16 v[40:43],v[68:71],a[20:23],v[40:43]
s_xor_b32 s65,s65,s67
s_lshl_b32 s64,s64,20
s_waitcnt lgkmcnt(4)
v_mfma_f32_16x16x32_bf16 v[32:35],a[24:27],v[72:75],v[32:35]
ds_read_b128 v[92:95],v4 offset:7168
s_add_u32 s64,s64,s65
s_add_u32 s65,s64,s52
v_mfma_f32_16x16x32_bf16 v[36:39],a[28:31],v[72:75],v[36:39]
s_xor_b32 s64,s64,s54
s_add_u32 s66,s64,s53
v_mfma_f32_16x16x32_bf16 v[40:43],v[72:75],a[32:35],v[40:43]
s_cmp_eq_u32 s60,0
s_cselect_b32 s65,138608640,s65
s_waitcnt lgkmcnt(4)
v_mfma_f32_16x16x32_bf16 v[32:35],a[36:39],v[76:79],v[32:35]
ds_read_b128 v[96:99],v4 offset:8192
s_cselect_b32 s66,138608640,s66
v_mfma_f32_16x16x32_bf16 v[36:39],a[40:43],v[76:79],v[36:39]
v_cvt_pk_bf16_f32 v60,v44,v45
v_mfma_f32_16x16x32_bf16 v[40:43],v[76:79],a[44:47],v[40:43]
v_cvt_pk_bf16_f32 v61,v46,v47
s_waitcnt lgkmcnt(4)
v_mfma_f32_16x16x32_bf16 v[32:35],a[48:51],v[80:83],v[32:35]
ds_read_b128 v[100:103],v4 offset:9216
v_cvt_pk_bf16_f32 v62,v48,v49
v_mfma_f32_16x16x32_bf16 v[36:39],a[52:55],v[80:83],v[36:39]
v_cvt_pk_bf16_f32 v63,v50,v51
v_mfma_f32_16x16x32_bf16 v[40:43],v[80:83],a[56:59],v[40:43]
v_cvt_pk_bf16_f32 v58,v52,v53
s_waitcnt lgkmcnt(4)
v_mfma_f32_16x16x32_bf16 v[32:35],a[60:63],v[84:87],v[32:35]
ds_read_b128 v[104:107],v4 offset:10240
v_cvt_pk_bf16_f32 v59,v54,v55
v_mfma_f32_16x16x32_bf16 v[36:39],a[64:67],v[84:87],v[36:39]
buffer_store_dwordx4 v[60:63],v0,s[20:23],s66 offen offset:1024 sc1
v_mfma_f32_16x16x32_bf16 v[40:43],v[84:87],a[68:71],v[40:43]
buffer_store_dwordx4 v[56:59],v0,s[20:23],s65 offen sc1
s_waitcnt lgkmcnt(4)
v_mfma_f32_16x16x32_bf16 v[32:35],a[72:75],v[88:91],v[32:35]
ds_read_b128 v[108:111],v4 offset:11264
v_mfma_f32_16x16x32_bf16 v[36:39],a[76:79],v[88:91],v[36:39]
v_mfma_f32_16x16x32_bf16 v[40:43],v[88:91],a[80:83],v[40:43]
s_waitcnt lgkmcnt(4)
v_mfma_f32_16x16x32_bf16 v[32:35],a[84:87],v[92:95],v[32:35]
ds_read_b128 v[112:115],v4 offset:12288
v_mfma_f32_16x16x32_bf16 v[36:39],a[88:91],v[92:95],v[36:39]
v_mfma_f32_16x16x32_bf16 v[40:43],v[92:95],a[92:95],v[40:43]
s_waitcnt lgkmcnt(4)
v_mfma_f32_16x16x32_bf16 v[32:35],a[96:99],v[96:99],v[32:35]
ds_read_b128 v[116:119],v4 offset:13312
v_mfma_f32_16x16x32_bf16 v[36:39],a[100:103],v[96:99],v[36:39]
v_mfma_f32_16x16x32_bf16 v[40:43],v[96:99],a[104:107],v[40:43]
s_waitcnt lgkmcnt(4)
v_mfma_f32_16x16x32_bf16 v[32:35],a[108:111],v[100:103],v[32:35]
ds_read_b128 v[120:123],v4 offset:14336
v_mfma_f32_16x16x32_bf16 v[36:39],a[112:115],v[100:103],v[36:39]
v_mfma_f32_16x16x32_bf16 v[40:43],v[100:103],a[116:119],v[40:43]
s_waitcnt lgkmcnt(4)
v_mfma_f32_16x16x32_bf16 v[32:35],a[120:123],v[104:107],v[32:35]
ds_read_b128 v[124:127],v4 offset:15360
v_mfma_f32_16x16x32_bf16 v[36:39],a[124:127],v[104:107],v[36:39]
v_mfma_f32_16x16x32_bf16 v[40:43],v[104:107],a[128:131],v[40:43]
s_waitcnt lgkmcnt(4)
v_mfma_f32_16x16x32_bf16 v[32:35],a[132:135],v[108:111],v[32:35]
ds_read_b128 v[64:67],v4 offset:16384
v_mfma_f32_16x16x32_bf16 v[36:39],a[136:139],v[108:111],v[36:39]
v_mfma_f32_16x16x32_bf16 v[40:43],v[108:111],a[140:143],v[40:43]
s_waitcnt lgkmcnt(4)
v_mfma_f32_16x16x32_bf16 v[32:35],a[144:147],v[112:115],v[32:35]
ds_read_b128 v[68:71],v4 offset:17408
v_mfma_f32_16x16x32_bf16 v[36:39],a[148:151],v[112:115],v[36:39]
v_mfma_f32_16x16x32_bf16 v[40:43],v[112:115],a[152:155],v[40:43]
s_waitcnt lgkmcnt(4)
v_mfma_f32_16x16x32_bf16 v[32:35],a[156:159],v[116:119],v[32:35]
ds_read_b128 v[72:75],v4 offset:18432
v_mfma_f32_16x16x32_bf16 v[36:39],a[160:163],v[116:119],v[36:39]
v_mfma_f32_16x16x32_bf16 v[40:43],v[116:119],a[164:167],v[40:43]
s_waitcnt lgkmcnt(4)
v_mfma_f32_16x16x32_bf16 v[32:35],a[168:171],v[120:123],v[32:35]
ds_read_b128 v[76:79],v4 offset:19456
v_mfma_f32_16x16x32_bf16 v[36:39],a[172:175],v[120:123],v[36:39]
v_mfma_f32_16x16x32_bf16 v[40:43],v[120:123],a[176:179],v[40:43]
s_waitcnt lgkmcnt(4)
v_mfma_f32_16x16x32_bf16 v[32:35],a[180:183],v[124:127],v[32:35]
ds_read_b128 v[80:83],v4 offset:20480
v_mfma_f32_16x16x32_bf16 v[36:39],a[184:187],v[124:127],v[36:39]
s_waitcnt vmcnt(2)
s_cmp_eq_u32 s60,60
s_cbranch_scc1 hb_55
s_cmp_eq_u32 s60,16
s_cbranch_scc1 hc_57
hb2_56:
s_sub_u32 s64,s60,2
s_cmp_gt_u32 s64,2
s_cbranch_scc1 sk_54
s_waitcnt vmcnt(0)
sk_54:
s_cselect_b32 s64,1,s50
s_barrier
s_cmp_ge_u32 s60,126
s_cselect_b32 s61,146800640,s61
s_cmp_lg_u32 s64,0
s_cbranch_scc1 nf_53
s_lshr_b32 s64,s60,1
v_mov_b32 v6,s64
s_mov_b64 exec,1
buffer_store_dword v6,off,s[20:23],s69 sc1
s_mov_b64 exec,-1
nf_53:
v_mfma_f32_16x16x32_bf16 v[40:43],v[124:127],a[188:191],v[40:43]
s_waitcnt lgkmcnt(4)
v_mfma_f32_16x16x32_bf16 v[32:35],a[192:195],v[64:67],v[32:35]
ds_read_b128 v[84:87],v4 offset:21504
s_add_u32 m0,s70,s63
v_mfma_f32_16x16x32_bf16 v[36:39],a[196:199],v[64:67],v[36:39]
v_mfma_f32_16x16x32_bf16 v[40:43],v[64:67],a[200:203],v[40:43]
s_add_u32 s62,s61,4096
s_waitcnt lgkmcnt(4)
v_mfma_f32_16x16x32_bf16 v[32:35],a[204:207],v[68:71],v[32:35]
ds_read_b128 v[88:91],v4 offset:22528
v_mfma_f32_16x16x32_bf16 v[36:39],a[208:211],v[68:71],v[36:39]
buffer_load_dwordx4 v0,s[20:23],s61 offen offset:0 lds
v_mfma_f32_16x16x32_bf16 v[40:43],v[68:71],a[212:215],v[40:43]
s_waitcnt lgkmcnt(4)
v_mfma_f32_16x16x32_bf16 v[32:35],a[216:219],v[72:75],v[32:35]
ds_read_b128 v[92:95],v4 offset:23552
buffer_load_dwordx4 v0,s[20:23],s61 offen offset:1024 lds
v_mfma_f32_16x16x32_bf16 v[36:39],a[220:223],v[72:75],v[36:39]
v_mfma_f32_16x16x32_bf16 v[40:43],v[72:75],a[224:227],v[40:43]
buffer_load_dwordx4 v0,s[20:23],s61 offen offset:2048 lds
s_waitcnt lgkmcnt(4)
v_mfma_f32_16x16x32_bf16 v[32:35],a[228:231],v[76:79],v[32:35]
ds_read_b128 v[96:99],v4 offset:24576
v_mfma_f32_16x16x32_bf16 v[36:39],a[232:235],v[76:79],v[36:39]
buffer_load_dwordx4 v0,s[20:23],s61 offen offset:3072 lds
v_mfma_f32_16x16x32_bf16 v[40:43],v[76:79],a[236:239],v[40:43]
s_waitcnt lgkmcnt(4)
v_mfma_f32_16x16x32_bf16 v[32:35],a[240:243],v[80:83],v[32:35]
ds_read_b128 v[100:103],v4 offset:25600
s_add_u32 m0,m0,4096
v_mfma_f32_16x16x32_bf16 v[36:39],a[244:247],v[80:83],v[36:39]
v_mfma_f32_16x16x32_bf16 v[40:43],v[80:83],a[248:251],v[40:43]
buffer_load_dwordx4 v0,s[20:23],s62 offen offset:0 lds
s_waitcnt lgkmcnt(4)
v_mfma_f32_16x16x32_bf16 v[32:35],a[252:255],v[84:87],v[32:35]
ds_read_b128 v[104:107],v4 offset:26624
v_mfma_f32_16x16x32_bf16 v[36:39],v[128:131],v[84:87],v[36:39]
buffer_load_dwordx4 v0,s[20:23],s62 offen offset:1024 lds
v_mfma_f32_16x16x32_bf16 v[40:43],v[84:87],v[132:135],v[40:43]
s_waitcnt lgkmcnt(4)
v_mfma_f32_16x16x32_bf16 v[32:35],v[136:139],v[88:91],v[32:35]
ds_read_b128 v[108:111],v4 offset:27648
buffer_load_dwordx4 v0,s[20:23],s62 offen offset:2048 lds
v_mfma_f32_16x16x32_bf16 v[36:39],v[140:143],v[88:91],v[36:39]
v_mfma_f32_16x16x32_bf16 v[40:43],v[88:91],v[144:147],v[40:43]
buffer_load_dwordx4 v0,s[20:23],s62 offen offset:3072 lds
s_waitcnt lgkmcnt(4)
v_mfma_f32_16x16x32_bf16 v[32:35],v[148:151],v[92:95],v[32:35]
ds_read_b128 v[112:115],v4 offset:28672
v_mfma_f32_16x16x32_bf16 v[36:39],v[152:155],v[92:95],v[36:39]
s_add_u32 s61,s61,32768
v_mfma_f32_16x16x32_bf16 v[40:43],v[92:95],v[156:159],v[40:43]
s_waitcnt lgkmcnt(4)
v_mfma_f32_16x16x32_bf16 v[32:35],v[160:163],v[96:99],v[32:35]
ds_read_b128 v[116:119],v4 offset:29696
s_add_u32 s70,s70,32768
v_mfma_f32_16x16x32_bf16 v[36:39],v[164:167],v[96:99],v[36:39]
v_mfma_f32_16x16x32_bf16 v[40:43],v[96:99],v[168:171],v[40:43]
s_and_b32 s70,s70,0x1ffff
s_waitcnt lgkmcnt(4)
v_mfma_f32_16x16x32_bf16 v[32:35],v[172:175],v[100:103],v[32:35]
ds_read_b128 v[120:123],v4 offset:30720
v_mfma_f32_16x16x32_bf16 v[36:39],v[176:179],v[100:103],v[36:39]
v_mfma_f32_16x16x32_bf16 v[40:43],v[100:103],v[180:183],v[40:43]
s_waitcnt lgkmcnt(4)
v_mfma_f32_16x16x32_bf16 v[32:35],v[184:187],v[104:107],v[32:35]
ds_read_b128 v[124:127],v4 offset:31744
v_mfma_f32_16x16x32_bf16 v[36:39],v[188:191],v[104:107],v[36:39]
v_mfma_f32_16x16x32_bf16 v[40:43],v[104:107],v[192:195],v[40:43]
s_waitcnt lgkmcnt(4)
v_mfma_f32_16x16x32_bf16 v[32:35],v[196:199],v[108:111],v[32:35]
ds_read_b128 v[64:67],v5 offset:0
v_mfma_f32_16x16x32_bf16 v[36:39],v[200:203],v[108:111],v[36:39]
v_mfma_f32_16x16x32_bf16 v[40:43],v[108:111],v[204:207],v[40:43]
s_waitcnt lgkmcnt(4)
v_mfma_f32_16x16x32_bf16 v[32:35],v[208:211],v[112:115],v[32:35]
ds_read_b128 v[68:71],v5 offset:1024
v_mfma_f32_16x16x32_bf16 v[36:39],v[212:215],v[112:115],v[36:39]
v_mfma_f32_16x16x32_bf16 v[40:43],v[112:115],v[216:219],v[40:43]
s_waitcnt lgkmcnt(4)
v_mfma_f32_16x16x32_bf16 v[32:35],v[220:223],v[116:119],v[32:35]
ds_read_b128 v[72:75],v5 offset:2048
v_mfma_f32_16x16x32_bf16 v[36:39],v[224:227],v[116:119],v[36:39]
v_mfma_f32_16x16x32_bf16 v[40:43],v[116:119],v[228:231],v[40:43]
s_waitcnt lgkmcnt(4)
v_mfma_f32_16x16x32_bf16 v[32:35],v[232:235],v[120:123],v[32:35]
ds_read_b128 v[76:79],v5 offset:3072
v_mfma_f32_16x16x32_bf16 v[36:39],v[236:239],v[120:123],v[36:39]
v_mfma_f32_16x16x32_bf16 v[40:43],v[120:123],v[240:243],v[40:43]
s_waitcnt lgkmcnt(4)
v_mfma_f32_16x16x32_bf16 v[32:35],v[244:247],v[124:127],v[32:35]
ds_read_b128 v[80:83],v5 offset:4096
v_mfma_f32_16x16x32_bf16 v[36:39],v[248:251],v[124:127],v[36:39]
v_mfma_f32_16x16x32_bf16 v[40:43],v[124:127],v[252:255],v[40:43]
v_mov_b32 v4,v5
v_add_u32 v5,32768,v5
v_and_b32 v5,0x1ffff,v5
s_add_u32 s60,s60,1
s_waitcnt lgkmcnt(4)
v_mfma_f32_16x16x32_bf16 v[44:47],a[0:3],v[64:67],0
ds_read_b128 v[84:87],v4 offset:5120
v_mfma_f32_16x16x32_bf16 v[48:51],a[4:7],v[64:67],0
v_mfma_f32_16x16x32_bf16 v[52:55],v[64:67],a[8:11],0
s_waitcnt lgkmcnt(4)
v_mfma_f32_16x16x32_bf16 v[44:47],a[12:15],v[68:71],v[44:47]
ds_read_b128 v[88:91],v4 offset:6144
s_sub_u32 s66,s60,1
s_lshr_b32 s64,s66,1
v_mfma_f32_16x16x32_bf16 v[48:51],a[16:19],v[68:71],v[48:51]
s_lshl_b32 s65,s64,12
s_and_b32 s65,s65,0x2000
v_mfma_f32_16x16x32_bf16 v[52:55],v[68:71],a[20:23],v[52:55]
s_xor_b32 s65,s65,s67
s_lshl_b32 s64,s64,20
s_waitcnt lgkmcnt(4)
v_mfma_f32_16x16x32_bf16 v[44:47],a[24:27],v[72:75],v[44:47]
ds_read_b128 v[92:95],v4 offset:7168
s_add_u32 s64,s64,s65
s_add_u32 s65,s64,s52
v_mfma_f32_16x16x32_bf16 v[48:51],a[28:31],v[72:75],v[48:51]
s_xor_b32 s64,s64,s54
s_add_u32 s66,s64,s53
v_mfma_f32_16x16x32_bf16 v[52:55],v[72:75],a[32:35],v[52:55]
v_cvt_pk_bf16_f32 v60,v32,v33
v_cvt_pk_bf16_f32 v61,v34,v35
s_waitcnt lgkmcnt(4)
v_mfma_f32_16x16x32_bf16 v[44:47],a[36:39],v[76:79],v[44:47]
ds_read_b128 v[96:99],v4 offset:8192
v_cvt_pk_bf16_f32 v62,v36,v37
v_mfma_f32_16x16x32_bf16 v[48:51],a[40:43],v[76:79],v[48:51]
v_cvt_pk_bf16_f32 v63,v38,v39
v_mfma_f32_16x16x32_bf16 v[52:55],v[76:79],a[44:47],v[52:55]
v_cvt_pk_bf16_f32 v56,v40,v41
s_waitcnt lgkmcnt(4)
v_mfma_f32_16x16x32_bf16 v[44:47],a[48:51],v[80:83],v[44:47]
ds_read_b128 v[100:103],v4 offset:9216
v_cvt_pk_bf16_f32 v57,v42,v43
v_mfma_f32_16x16x32_bf16 v[48:51],a[52:55],v[80:83],v[48:51]
buffer_store_dwordx4 v[60:63],v0,s[20:23],s66 offen offset:0 sc1
v_mfma_f32_16x16x32_bf16 v[52:55],v[80:83],a[56:59],v[52:55]
s_waitcnt lgkmcnt(4)
v_mfma_f32_16x16x32_bf16 v[44:47],a[60:63],v[84:87],v[44:47]
ds_read_b128 v[104:107],v4 offset:10240
v_mfma_f32_16x16x32_bf16 v[48:51],a[64:67],v[84:87],v[48:51]
v_mfma_f32_16x16x32_bf16 v[52:55],v[84:87],a[68:71],v[52:55]
s_waitcnt lgkmcnt(4)
v_mfma_f32_16x16x32_bf16 v[44:47],a[72:75],v[88:91],v[44:47]
ds_read_b128 v[108:111],v4 offset:11264
v_mfma_f32_16x16x32_bf16 v[48:51],a[76:79],v[88:91],v[48:51]
v_mfma_f32_16x16x32_bf16 v[52:55],v[88:91],a[80:83],v[52:55]
s_waitcnt lgkmcnt(4)
v_mfma_f32_16x16x32_bf16 v[44:47],a[84:87],v[92:95],v[44:47]
ds_read_b128 v[112:115],v4 offset:12288
v_mfma_f32_16x16x32_bf16 v[48:51],a[88:91],v[92:95],v[48:51]
v_mfma_f32_16x16x32_bf16 v[52:55],v[92:95],a[92:95],v[52:55]
s_waitcnt lgkmcnt(4)
v_mfma_f32_16x16x32_bf16 v[44:47],a[96:99],v[96:99],v[44:47]
ds_read_b128 v[116:119],v4 offset:13312
v_mfma_f32_16x16x32_bf16 v[48:51],a[100:103],v[96:99],v[48:51]
v_mfma_f32_16x16x32_bf16 v[52:55],v[96:99],a[104:107],v[52:55]
s_waitcnt lgkmcnt(4)
v_mfma_f32_16x16x32_bf16 v[44:47],a[108:111],v[100:103],v[44:47]
ds_read_b128 v[120:123],v4 offset:14336
v_mfma_f32_16x16x32_bf16 v[48:51],a[112:115],v[100:103],v[48:51]
v_mfma_f32_16x16x32_bf16 v[52:55],v[100:103],a[116:119],v[52:55]
s_waitcnt lgkmcnt(4)
v_mfma_f32_16x16x32_bf16 v[44:47],a[120:123],v[104:107],v[44:47]
ds_read_b128 v[124:127],v4 offset:15360
v_mfma_f32_16x16x32_bf16 v[48:51],a[124:127],v[104:107],v[48:51]
v_mfma_f32_16x16x32_bf16 v[52:55],v[104:107],a[128:131],v[52:55]
s_waitcnt lgkmcnt(4)
v_mfma_f32_16x16x32_bf16 v[44:47],a[132:135],v[108:111],v[44:47]
ds_read_b128 v[64:67],v4 offset:16384
v_mfma_f32_16x16x32_bf16 v[48:51],a[136:139],v[108:111],v[48:51]
v_mfma_f32_16x16x32_bf16 v[52:55],v[108:111],a[140:143],v[52:55]
s_waitcnt lgkmcnt(4)
v_mfma_f32_16x16x32_bf16 v[44:47],a[144:147],v[112:115],v[44:47]
ds_read_b128 v[68:71],v4 offset:17408
v_mfma_f32_16x16x32_bf16 v[48:51],a[148:151],v[112:115],v[48:51]
v_mfma_f32_16x16x32_bf16 v[52:55],v[112:115],a[152:155],v[52:55]
s_waitcnt lgkmcnt(4)
v_mfma_f32_16x16x32_bf16 v[44:47],a[156:159],v[116:119],v[44:47]
ds_read_b128 v[72:75],v4 offset:18432
v_mfma_f32_16x16x32_bf16 v[48:51],a[160:163],v[116:119],v[48:51]
v_mfma_f32_16x16x32_bf16 v[52:55],v[116:119],a[164:167],v[52:55]
s_waitcnt lgkmcnt(4)
v_mfma_f32_16x16x32_bf16 v[44:47],a[168:171],v[120:123],v[44:47]
ds_read_b128 v[76:79],v4 offset:19456
v_mfma_f32_16x16x32_bf16 v[48:51],a[172:175],v[120:123],v[48:51]
v_mfma_f32_16x16x32_bf16 v[52:55],v[120:123],a[176:179],v[52:55]
s_waitcnt lgkmcnt(4)
v_mfma_f32_16x16x32_bf16 v[44:47],a[180:183],v[124:127],v[44:47]
ds_read_b128 v[80:83],v4 offset:20480
v_mfma_f32_16x16x32_bf16 v[48:51],a[184:187],v[124:127],v[48:51]
s_waitcnt vmcnt(1)
s_mov_b32 s64,s50
s_barrier
s_cmp_ge_u32 s60,126
s_cselect_b32 s61,146800640,s61
s_cmp_lg_u32 s64,0
s_cbranch_scc1 nf_58
s_lshr_b32 s64,s60,1
v_mov_b32 v6,s64
s_mov_b64 exec,1
buffer_store_dword v6,off,s[20:23],s69 sc1
s_mov_b64 exec,-1
nf_58:
v_mfma_f32_16x16x32_bf16 v[52:55],v[124:127],a[188:191],v[52:55]
s_waitcnt lgkmcnt(4)
v_mfma_f32_16x16x32_bf16 v[44:47],a[192:195],v[64:67],v[44:47]
ds_read_b128 v[84:87],v4 offset:21504
s_add_u32 m0,s70,s63
v_mfma_f32_16x16x32_bf16 v[48:51],a[196:199],v[64:67],v[48:51]
v_mfma_f32_16x16x32_bf16 v[52:55],v[64:67],a[200:203],v[52:55]
s_add_u32 s62,s61,4096
s_waitcnt lgkmcnt(4)
v_mfma_f32_16x16x32_bf16 v[44:47],a[204:207],v[68:71],v[44:47]
ds_read_b128 v[88:91],v4 offset:22528
v_mfma_f32_16x16x32_bf16 v[48:51],a[208:211],v[68:71],v[48:51]
buffer_load_dwordx4 v0,s[20:23],s61 offen offset:0 lds
v_mfma_f32_16x16x32_bf16 v[52:55],v[68:71],a[212:215],v[52:55]
s_waitcnt lgkmcnt(4)
v_mfma_f32_16x16x32_bf16 v[44:47],a[216:219],v[72:75],v[44:47]
ds_read_b128 v[92:95],v4 offset:23552
buffer_load_dwordx4 v0,s[20:23],s61 offen offset:1024 lds
v_mfma_f32_16x16x32_bf16 v[48:51],a[220:223],v[72:75],v[48:51]
v_mfma_f32_16x16x32_bf16 v[52:55],v[72:75],a[224:227],v[52:55]
buffer_load_dwordx4 v0,s[20:23],s61 offen offset:2048 lds
s_waitcnt lgkmcnt(4)
v_mfma_f32_16x16x32_bf16 v[44:47],a[228:231],v[76:79],v[44:47]
ds_read_b128 v[96:99],v4 offset:24576
v_mfma_f32_16x16x32_bf16 v[48:51],a[232:235],v[76:79],v[48:51]
buffer_load_dwordx4 v0,s[20:23],s61 offen offset:3072 lds
v_mfma_f32_16x16x32_bf16 v[52:55],v[76:79],a[236:239],v[52:55]
s_waitcnt lgkmcnt(4)
v_mfma_f32_16x16x32_bf16 v[44:47],a[240:243],v[80:83],v[44:47]
ds_read_b128 v[100:103],v4 offset:25600
s_add_u32 m0,m0,4096
v_mfma_f32_16x16x32_bf16 v[48:51],a[244:247],v[80:83],v[48:51]
v_mfma_f32_16x16x32_bf16 v[52:55],v[80:83],a[248:251],v[52:55]
buffer_load_dwordx4 v0,s[20:23],s62 offen offset:0 lds
s_waitcnt lgkmcnt(4)
v_mfma_f32_16x16x32_bf16 v[44:47],a[252:255],v[84:87],v[44:47]
ds_read_b128 v[104:107],v4 offset:26624
v_mfma_f32_16x16x32_bf16 v[48:51],v[128:131],v[84:87],v[48:51]
buffer_load_dwordx4 v0,s[20:23],s62 offen offset:1024 lds
v_mfma_f32_16x16x32_bf16 v[52:55],v[84:87],v[132:135],v[52:55]
s_waitcnt lgkmcnt(4)
v_mfma_f32_16x16x32_bf16 v[44:47],v[136:139],v[88:91],v[44:47]
ds_read_b128 v[108:111],v4 offset:27648
buffer_load_dwordx4 v0,s[20:23],s62 offen offset:2048 lds
v_mfma_f32_16x16x32_bf16 v[48:51],v[140:143],v[88:91],v[48:51]
v_mfma_f32_16x16x32_bf16 v[52:55],v[88:91],v[144:147],v[52:55]
buffer_load_dwordx4 v0,s[20:23],s62 offen offset:3072 lds
s_waitcnt lgkmcnt(4)
v_mfma_f32_16x16x32_bf16 v[44:47],v[148:151],v[92:95],v[44:47]
ds_read_b128 v[112:115],v4 offset:28672
v_mfma_f32_16x16x32_bf16 v[48:51],v[152:155],v[92:95],v[48:51]
s_add_u32 s61,s61,32768
v_mfma_f32_16x16x32_bf16 v[52:55],v[92:95],v[156:159],v[52:55]
s_waitcnt lgkmcnt(4)
v_mfma_f32_16x16x32_bf16 v[44:47],v[160:163],v[96:99],v[44:47]
ds_read_b128 v[116:119],v4 offset:29696
s_add_u32 s70,s70,32768
v_mfma_f32_16x16x32_bf16 v[48:51],v[164:167],v[96:99],v[48:51]
v_mfma_f32_16x16x32_bf16 v[52:55],v[96:99],v[168:171],v[52:55]
s_and_b32 s70,s70,0x1ffff
s_waitcnt lgkmcnt(4)
v_mfma_f32_16x16x32_bf16 v[44:47],v[172:175],v[100:103],v[44:47]
ds_read_b128 v[120:123],v4 offset:30720
v_mfma_f32_16x16x32_bf16 v[48:51],v[176:179],v[100:103],v[48:51]
v_mfma_f32_16x16x32_bf16 v[52:55],v[100:103],v[180:183],v[52:55]
s_waitcnt lgkmcnt(4)
v_mfma_f32_16x16x32_bf16 v[44:47],v[184:187],v[104:107],v[44:47]
ds_read_b128 v[124:127],v4 offset:31744
v_mfma_f32_16x16x32_bf16 v[48:51],v[188:191],v[104:107],v[48:51]
v_mfma_f32_16x16x32_bf16 v[52:55],v[104:107],v[192:195],v[52:55]
s_waitcnt lgkmcnt(4)
v_mfma_f32_16x16x32_bf16 v[44:47],v[196:199],v[108:111],v[44:47]
ds_read_b128 v[64:67],v5 offset:0
v_mfma_f32_16x16x32_bf16 v[48:51],v[200:203],v[108:111],v[48:51]
v_mfma_f32_16x16x32_bf16 v[52:55],v[108:111],v[204:207],v[52:55]
s_waitcnt lgkmcnt(4)
v_mfma_f32_16x16x32_bf16 v[44:47],v[208:211],v[112:115],v[44:47]
ds_read_b128 v[68:71],v5 offset:1024
v_mfma_f32_16x16x32_bf16 v[48:51],v[212:215],v[112:115],v[48:51]
v_mfma_f32_16x16x32_bf16 v[52:55],v[112:115],v[216:219],v[52:55]
s_waitcnt lgkmcnt(4)
v_mfma_f32_16x16x32_bf16 v[44:47],v[220:223],v[116:119],v[44:47]
ds_read_b128 v[72:75],v5 offset:2048
v_mfma_f32_16x16x32_bf16 v[48:51],v[224:227],v[116:119],v[48:51]
v_mfma_f32_16x16x32_bf16 v[52:55],v[116:119],v[228:231],v[52:55]
s_waitcnt lgkmcnt(4)
v_mfma_f32_16x16x32_bf16 v[44:47],v[232:235],v[120:123],v[44:47]
ds_read_b128 v[76:79],v5 offset:3072
v_mfma_f32_16x16x32_bf16 v[48:51],v[236:239],v[120:123],v[48:51]
v_mfma_f32_16x16x32_bf16 v[52:55],v[120:123],v[240:243],v[52:55]
s_waitcnt lgkmcnt(4)
v_mfma_f32_16x16x32_bf16 v[44:47],v[244:247],v[124:127],v[44:47]
ds_read_b128 v[80:83],v5 offset:4096
v_mfma_f32_16x16x32_bf16 v[48:51],v[248:251],v[124:127],v[48:51]
v_mfma_f32_16x16x32_bf16 v[52:55],v[124:127],v[252:255],v[52:55]
v_mov_b32 v4,v5
v_add_u32 v5,32768,v5
v_and_b32 v5,0x1ffff,v5
s_add_u32 s60,s60,1
s_cmp_lt_u32 s60,128
s_cbranch_scc1 top_52
s_sub_u32 s66,s60,1
s_lshr_b32 s64,s66,1
s_lshl_b32 s65,s64,12
s_and_b32 s65,s65,0x2000
s_xor_b32 s65,s65,s67
s_lshl_b32 s64,s64,20
s_add_u32 s64,s64,s65
s_add_u32 s65,s64,s52
s_xor_b32 s64,s64,s54
s_add_u32 s66,s64,s53
s_cmp_eq_u32 s60,0
s_cselect_b32 s65,138608640,s65
s_cselect_b32 s66,138608640,s66
v_cvt_pk_bf16_f32 v60,v44,v45
v_cvt_pk_bf16_f32 v61,v46,v47
v_cvt_pk_bf16_f32 v62,v48,v49
v_cvt_pk_bf16_f32 v63,v50,v51
v_cvt_pk_bf16_f32 v58,v52,v53
v_cvt_pk_bf16_f32 v59,v54,v55
buffer_store_dwordx4 v[60:63],v0,s[20:23],s66 offen offset:1024 sc1
buffer_store_dwordx4 v[56:59],v0,s[20:23],s65 offen sc1
s_waitcnt vmcnt(0) lgkmcnt(0)
s_barrier
s_cmp_lg_u32 s50,0
s_cbranch_scc1 done_45
v_mov_b32 v6,64
s_mov_b64 exec,1
buffer_store_dword v6,off,s[20:23],s69 sc1
s_mov_b64 exec,-1
done_45:
s_cmp_lt_u32 s59,32
s_cbranch_scc1 fl_att2
s_endpgm
hb_55:
s_mov_b32 s28,s2
s_and_b32 s29,s3,0xffff
s_mov_b32 s30,0x100
s_mov_b32 s31,0x20000
v_mbcnt_lo_u32_b32 v12,-1,0
v_mbcnt_hi_u32_b32 v12,-1,v12
v_mov_b32 v14,0
v_cmp_eq_u32 vcc,20,v12
s_nop 1
v_cndmask_b32 v14,v14,64,vcc
v_and_b32 v15,1,v12
v_cmp_eq_u32 vcc,1,v15
v_mov_b32 v15,8192
s_nop 0
v_cndmask_b32 v15,-1,v15,vcc
v_min_u32 v12,31,v12
v_lshlrev_b32 v12,2,v12
s_sub_u32 s66,s88,64
vpoll_59:
buffer_load_dword v13,v12,s[28:31],s66 offen sc1
s_waitcnt vmcnt(0)
vck_60:
v_cmp_gt_u32 vcc,v14,v13
s_cbranch_vccz vok_62
vrt_61:
s_sleep 8
s_sub_u32 s90,s90,1
s_cmp_gt_i32 s90,0
s_cbranch_scc1 vpoll_59
vok_62:
s_branch hb2_56
hc_57:
s_mov_b32 s28,s2
s_and_b32 s29,s3,0xffff
s_mov_b32 s30,0x100
s_mov_b32 s31,0x20000
v_mbcnt_lo_u32_b32 v12,-1,0
v_mbcnt_hi_u32_b32 v12,-1,v12
v_mov_b32 v14,0
v_cmp_eq_u32 vcc,17,v12
s_nop 1
v_cndmask_b32 v14,v14,63,vcc
v_and_b32 v15,1,v12
v_cmp_eq_u32 vcc,1,v15
v_mov_b32 v15,8192
s_nop 0
v_cndmask_b32 v15,-1,v15,vcc
v_min_u32 v12,31,v12
v_lshlrev_b32 v12,2,v12
s_sub_u32 s66,s88,64
vpoll_65:
buffer_load_dword v13,v12,s[28:31],s66 offen sc1
s_waitcnt vmcnt(0)
vck_66:
v_cmp_gt_u32 vcc,v14,v13
s_cbranch_vccz vok_68
vrt_67:
s_sleep 8
s_sub_u32 s90,s90,1
s_cmp_gt_i32 s90,0
s_cbranch_scc1 vpoll_65
vok_68:
s_branch hb2_56
fl_wo:
v_and_b32 v21,15,v1
v_lshrrev_b32 v22,4,v1
v_lshrrev_b32 v23,2,v21
v_and_b32 v24,3,v21
s_lshl_b32 s61,s50,15
v_lshl_add_u32 v25,v22,3,v23
s_load_dwordx2 s[4:5],s[0:1],40
s_load_dwordx2 s[6:7],s[0:1],0
s_lshr_b32 s52,s59,3
s_and_b32 s53,s59,7
s_mul_i32 s54,s52,2097152
s_lshl_b32 s64,s53,8
s_add_u32 s54,s54,s64
s_lshl_b32 s64,s50,6
s_add_u32 s54,s54,s64
s_waitcnt lgkmcnt(0)
s_mov_b32 s28,s4
s_and_b32 s29,s5,0xffff
s_mov_b32 s30,0x800000
s_mov_b32 s31,0x20000
s_mov_b32 s24,s6
s_and_b32 s25,s7,0xffff
s_mov_b32 s26,0x400000
s_mov_b32 s27,0x20000
v_lshrrev_b32 v26,2,v1
v_and_b32 v27,3,v1
v_mul_u32_u24 v16,2048,v26
v_lshl_add_u32 v16,v27,4,v16
v_lshlrev_b32 v17,6,v25
v_lshl_add_u32 v17,v24,4,v17
v_add_u32 v17,s61,v17
s_xor_b32 s62,s50,0
s_mul_i32 s62,s62,524288
s_add_u32 s62,s62,s54
s_add_u32 m0,s61,0
s_nop 0
buffer_load_dwordx4 v16,s[28:31],s62 offen lds
s_add_u32 s62,s62,32768
s_add_u32 m0,m0,1024
s_waitcnt vmcnt(6)
buffer_load_dwordx4 v16,s[28:31],s62 offen lds
s_add_u32 s62,s62,32768
s_add_u32 m0,m0,1024
s_waitcnt vmcnt(6)
buffer_load_dwordx4 v16,s[28:31],s62 offen lds
s_add_u32 s62,s62,32768
s_add_u32 m0,m0,1024
s_waitcnt vmcnt(6)
buffer_load_dwordx4 v16,s[28:31],s62 offen lds
s_add_u32 s62,s62,32768
s_add_u32 m0,m0,1024
s_waitcnt vmcnt(6)
buffer_load_dwordx4 v16,s[28:31],s62 offen lds
s_add_u32 s62,s62,32768
s_add_u32 m0,m0,1024
s_waitcnt vmcnt(6)
buffer_load_dwordx4 v16,s[28:31],s62 offen lds
s_add_u32 s62,s62,32768
s_add_u32 m0,m0,1024
s_waitcnt vmcnt(6)
buffer_load_dwordx4 v16,s[28:31],s62 offen lds
s_add_u32 s62,s62,32768
s_add_u32 m0,m0,1024
s_waitcnt vmcnt(6)
buffer_load_dwordx4 v16,s[28:31],s62 offen lds
s_add_u32 s62,s62,32768
s_add_u32 m0,m0,1024
s_waitcnt vmcnt(6)
buffer_load_dwordx4 v16,s[28:31],s62 offen lds
s_add_u32 s62,s62,32768
s_add_u32 m0,m0,1024
s_waitcnt vmcnt(6)
buffer_load_dwordx4 v16,s[28:31],s62 offen lds
s_add_u32 s62,s62,32768
s_add_u32 m0,m0,1024
s_waitcnt vmcnt(6)
buffer_load_dwordx4 v16,s[28:31],s62 offen lds
s_add_u32 s62,s62,32768
s_add_u32 m0,m0,1024
s_waitcnt vmcnt(6)
buffer_load_dwordx4 v16,s[28:31],s62 offen lds
s_add_u32 s62,s62,32768
s_add_u32 m0,m0,1024
s_waitcnt vmcnt(6)
buffer_load_dwordx4 v16,s[28:31],s62 offen lds
s_add_u32 s62,s62,32768
s_add_u32 m0,m0,1024
s_waitcnt vmcnt(6)
buffer_load_dwordx4 v16,s[28:31],s62 offen lds
s_add_u32 s62,s62,32768
s_add_u32 m0,m0,1024
s_waitcnt vmcnt(6)
buffer_load_dwordx4 v16,s[28:31],s62 offen lds
s_add_u32 s62,s62,32768
s_add_u32 m0,m0,1024
s_waitcnt vmcnt(6)
buffer_load_dwordx4 v16,s[28:31],s62 offen lds
s_waitcnt vmcnt(6)
s_xor_b32 s62,s50,1
s_mul_i32 s62,s62,524288
s_add_u32 s62,s62,s54
s_add_u32 m0,s61,16384
s_nop 0
buffer_load_dwordx4 v16,s[28:31],s62 offen lds
s_add_u32 s62,s62,32768
s_add_u32 m0,m0,1024
s_waitcnt vmcnt(6)
buffer_load_dwordx4 v16,s[28:31],s62 offen lds
s_add_u32 s62,s62,32768
s_add_u32 m0,m0,1024
s_waitcnt vmcnt(6)
buffer_load_dwordx4 v16,s[28:31],s62 offen lds
s_add_u32 s62,s62,32768
s_add_u32 m0,m0,1024
s_waitcnt vmcnt(6)
buffer_load_dwordx4 v16,s[28:31],s62 offen lds
s_add_u32 s62,s62,32768
s_add_u32 m0,m0,1024
s_waitcnt vmcnt(6)
buffer_load_dwordx4 v16,s[28:31],s62 offen lds
s_add_u32 s62,s62,32768
s_add_u32 m0,m0,1024
s_waitcnt vmcnt(6)
buffer_load_dwordx4 v16,s[28:31],s62 offen lds
s_add_u32 s62,s62,32768
s_add_u32 m0,m0,1024
s_waitcnt vmcnt(6)
buffer_load_dwordx4 v16,s[28:31],s62 offen lds
s_add_u32 s62,s62,32768
s_add_u32 m0,m0,1024
s_waitcnt vmcnt(6)
buffer_load_dwordx4 v16,s[28:31],s62 offen lds
s_add_u32 s62,s62,32768
s_add_u32 m0,m0,1024
s_waitcnt vmcnt(6)
buffer_load_dwordx4 v16,s[28:31],s62 offen lds
s_add_u32 s62,s62,32768
s_add_u32 m0,m0,1024
s_waitcnt vmcnt(6)
buffer_load_dwordx4 v16,s[28:31],s62 offen lds
s_add_u32 s62,s62,32768
s_add_u32 m0,m0,1024
s_waitcnt vmcnt(6)
buffer_load_dwordx4 v16,s[28:31],s62 offen lds
s_add_u32 s62,s62,32768
s_add_u32 m0,m0,1024
s_waitcnt vmcnt(6)
buffer_load_dwordx4 v16,s[28:31],s62 offen lds
s_add_u32 s62,s62,32768
s_add_u32 m0,m0,1024
s_waitcnt vmcnt(6)
buffer_load_dwordx4 v16,s[28:31],s62 offen lds
s_add_u32 s62,s62,32768
s_add_u32 m0,m0,1024
s_waitcnt vmcnt(6)
buffer_load_dwordx4 v16,s[28:31],s62 offen lds
s_add_u32 s62,s62,32768
s_add_u32 m0,m0,1024
s_waitcnt vmcnt(6)
buffer_load_dwordx4 v16,s[28:31],s62 offen lds
s_add_u32 s62,s62,32768
s_add_u32 m0,m0,1024
s_waitcnt vmcnt(6)
buffer_load_dwordx4 v16,s[28:31],s62 offen lds
s_waitcnt vmcnt(6)
s_waitcnt vmcnt(16)
ds_read_b64_tr_b16 a[0:1],v17 offset:0
ds_read_b64_tr_b16 a[2:3],v17 offset:256
ds_read_b64_tr_b16 a[4:5],v17 offset:8
ds_read_b64_tr_b16 a[6:7],v17 offset:264
ds_read_b64_tr_b16 a[8:9],v17 offset:2048
ds_read_b64_tr_b16 a[10:11],v17 offset:2304
ds_read_b64_tr_b16 a[12:13],v17 offset:2056
ds_read_b64_tr_b16 a[14:15],v17 offset:2312
ds_read_b64_tr_b16 a[16:17],v17 offset:4096
ds_read_b64_tr_b16 a[18:19],v17 offset:4352
ds_read_b64_tr_b16 a[20:21],v17 offset:4104
ds_read_b64_tr_b16 a[22:23],v17 offset:4360
s_waitcnt lgkmcnt(0)
ds_read_b64_tr_b16 a[24:25],v17 offset:6144
ds_read_b64_tr_b16 a[26:27],v17 offset:6400
ds_read_b64_tr_b16 a[28:29],v17 offset:6152
ds_read_b64_tr_b16 a[30:31],v17 offset:6408
ds_read_b64_tr_b16 a[32:33],v17 offset:8192
ds_read_b64_tr_b16 a[34:35],v17 offset:8448
ds_read_b64_tr_b16 a[36:37],v17 offset:8200
ds_read_b64_tr_b16 a[38:39],v17 offset:8456
ds_read_b64_tr_b16 a[40:41],v17 offset:10240
ds_read_b64_tr_b16 a[42:43],v17 offset:10496
ds_read_b64_tr_b16 a[44:45],v17 offset:10248
ds_read_b64_tr_b16 a[46:47],v17 offset:10504
s_waitcnt lgkmcnt(0)
ds_read_b64_tr_b16 a[48:49],v17 offset:12288
ds_read_b64_tr_b16 a[50:51],v17 offset:12544
ds_read_b64_tr_b16 a[52:53],v17 offset:12296
ds_read_b64_tr_b16 a[54:55],v17 offset:12552
ds_read_b64_tr_b16 a[56:57],v17 offset:14336
ds_read_b64_tr_b16 a[58:59],v17 offset:14592
ds_read_b64_tr_b16 a[60:61],v17 offset:14344
ds_read_b64_tr_b16 a[62:63],v17 offset:14600
s_waitcnt lgkmcnt(0)
s_xor_b32 s62,s50,2
s_mul_i32 s62,s62,524288
s_add_u32 s62,s62,s54
s_add_u32 m0,s61,0
s_nop 0
buffer_load_dwordx4 v16,s[28:31],s62 offen lds
s_add_u32 s62,s62,32768
s_add_u32 m0,m0,1024
s_waitcnt vmcnt(6)
buffer_load_dwordx4 v16,s[28:31],s62 offen lds
s_add_u32 s62,s62,32768
s_add_u32 m0,m0,1024
s_waitcnt vmcnt(6)
buffer_load_dwordx4 v16,s[28:31],s62 offen lds
s_add_u32 s62,s62,32768
s_add_u32 m0,m0,1024
s_waitcnt vmcnt(6)
buffer_load_dwordx4 v16,s[28:31],s62 offen lds
s_add_u32 s62,s62,32768
s_add_u32 m0,m0,1024
s_waitcnt vmcnt(6)
buffer_load_dwordx4 v16,s[28:31],s62 offen lds
s_add_u32 s62,s62,32768
s_add_u32 m0,m0,1024
s_waitcnt vmcnt(6)
buffer_load_dwordx4 v16,s[28:31],s62 offen lds
s_add_u32 s62,s62,32768
s_add_u32 m0,m0,1024
s_waitcnt vmcnt(6)
buffer_load_dwordx4 v16,s[28:31],s62 offen lds
s_add_u32 s62,s62,32768
s_add_u32 m0,m0,1024
s_waitcnt vmcnt(6)
buffer_load_dwordx4 v16,s[28:31],s62 offen lds
s_add_u32 s62,s62,32768
s_add_u32 m0,m0,1024
s_waitcnt vmcnt(6)
buffer_load_dwordx4 v16,s[28:31],s62 offen lds
s_add_u32 s62,s62,32768
s_add_u32 m0,m0,1024
s_waitcnt vmcnt(6)
buffer_load_dwordx4 v16,s[28:31],s62 offen lds
s_add_u32 s62,s62,32768
s_add_u32 m0,m0,1024
s_waitcnt vmcnt(6)
buffer_load_dwordx4 v16,s[28:31],s62 offen lds
s_add_u32 s62,s62,32768
s_add_u32 m0,m0,1024
s_waitcnt vmcnt(6)
buffer_load_dwordx4 v16,s[28:31],s62 offen lds
s_add_u32 s62,s62,32768
s_add_u32 m0,m0,1024
s_waitcnt vmcnt(6)
buffer_load_dwordx4 v16,s[28:31],s62 offen lds
s_add_u32 s62,s62,32768
s_add_u32 m0,m0,1024
s_waitcnt vmcnt(6)
buffer_load_dwordx4 v16,s[28:31],s62 offen lds
s_add_u32 s62,s62,32768
s_add_u32 m0,m0,1024
s_waitcnt vmcnt(6)
buffer_load_dwordx4 v16,s[28:31],s62 offen lds
s_add_u32 s62,s62,32768
s_add_u32 m0,m0,1024
s_waitcnt vmcnt(6)
buffer_load_dwordx4 v16,s[28:31],s62 offen lds
s_waitcnt vmcnt(6)
s_waitcnt vmcnt(16)
ds_read_b64_tr_b16 a[64:65],v17 offset:16384
ds_read_b64_tr_b16 a[66:67],v17 offset:16640
ds_read_b64_tr_b16 a[68:69],v17 offset:16392
ds_read_b64_tr_b16 a[70:71],v17 offset:16648
ds_read_b64_tr_b16 a[72:73],v17 offset:18432
ds_read_b64_tr_b16 a[74:75],v17 offset:18688
ds_read_b64_tr_b16 a[76:77],v17 offset:18440
ds_read_b64_tr_b16 a[78:79],v17 offset:18696
ds_read_b64_tr_b16 a[80:81],v17 offset:20480
ds_read_b64_tr_b16 a[82:83],v17 offset:20736
ds_read_b64_tr_b16 a[84:85],v17 offset:20488
ds_read_b64_tr_b16 a[86:87],v17 offset:20744
s_waitcnt lgkmcnt(0)
ds_read_b64_tr_b16 a[88:89],v17 offset:22528
ds_read_b64_tr_b16 a[90:91],v17 offset:22784
ds_read_b64_tr_b16 a[92:93],v17 offset:22536
ds_read_b64_tr_b16 a[94:95],v17 offset:22792
ds_read_b64_tr_b16 a[96:97],v17 offset:24576
ds_read_b64_tr_b16 a[98:99],v17 offset:24832
ds_read_b64_tr_b16 a[100:101],v17 offset:24584
ds_read_b64_tr_b16 a[102:103],v17 offset:24840
ds_read_b64_tr_b16 a[104:105],v17 offset:26624
ds_read_b64_tr_b16 a[106:107],v17 offset:26880
ds_read_b64_tr_b16 a[108:109],v17 offset:26632
ds_read_b64_tr_b16 a[110:111],v17 offset:26888
s_waitcnt lgkmcnt(0)
ds_read_b64_tr_b16 a[112:113],v17 offset:28672
ds_read_b64_tr_b16 a[114:115],v17 offset:28928
ds_read_b64_tr_b16 a[116:117],v17 offset:28680
ds_read_b64_tr_b16 a[118:119],v17 offset:28936
ds_read_b64_tr_b16 a[120:121],v17 offset:30720
ds_read_b64_tr_b16 a[122:123],v17 offset:30976
ds_read_b64_tr_b16 a[124:125],v17 offset:30728
ds_read_b64_tr_b16 a[126:127],v17 offset:30984
s_waitcnt lgkmcnt(0)
s_xor_b32 s62,s50,3
s_mul_i32 s62,s62,524288
s_add_u32 s62,s62,s54
s_add_u32 m0,s61,16384
s_nop 0
buffer_load_dwordx4 v16,s[28:31],s62 offen lds
s_add_u32 s62,s62,32768
s_add_u32 m0,m0,1024
s_waitcnt vmcnt(6)
buffer_load_dwordx4 v16,s[28:31],s62 offen lds
s_add_u32 s62,s62,32768
s_add_u32 m0,m0,1024
s_waitcnt vmcnt(6)
buffer_load_dwordx4 v16,s[28:31],s62 offen lds
s_add_u32 s62,s62,32768
s_add_u32 m0,m0,1024
s_waitcnt vmcnt(6)
buffer_load_dwordx4 v16,s[28:31],s62 offen lds
s_add_u32 s62,s62,32768
s_add_u32 m0,m0,1024
s_waitcnt vmcnt(6)
buffer_load_dwordx4 v16,s[28:31],s62 offen lds
s_add_u32 s62,s62,32768
s_add_u32 m0,m0,1024
s_waitcnt vmcnt(6)
buffer_load_dwordx4 v16,s[28:31],s62 offen lds
s_add_u32 s62,s62,32768
s_add_u32 m0,m0,1024
s_waitcnt vmcnt(6)
buffer_load_dwordx4 v16,s[28:31],s62 offen lds
s_add_u32 s62,s62,32768
s_add_u32 m0,m0,1024
s_waitcnt vmcnt(6)
buffer_load_dwordx4 v16,s[28:31],s62 offen lds
s_add_u32 s62,s62,32768
s_add_u32 m0,m0,1024
s_waitcnt vmcnt(6)
buffer_load_dwordx4 v16,s[28:31],s62 offen lds
s_add_u32 s62,s62,32768
s_add_u32 m0,m0,1024
s_waitcnt vmcnt(6)
buffer_load_dwordx4 v16,s[28:31],s62 offen lds
s_add_u32 s62,s62,32768
s_add_u32 m0,m0,1024
s_waitcnt vmcnt(6)
buffer_load_dwordx4 v16,s[28:31],s62 offen lds
s_add_u32 s62,s62,32768
s_add_u32 m0,m0,1024
s_waitcnt vmcnt(6)
buffer_load_dwordx4 v16,s[28:31],s62 offen lds
s_add_u32 s62,s62,32768
s_add_u32 m0,m0,1024
s_waitcnt vmcnt(6)
buffer_load_dwordx4 v16,s[28:31],s62 offen lds
s_add_u32 s62,s62,32768
s_add_u32 m0,m0,1024
s_waitcnt vmcnt(6)
buffer_load_dwordx4 v16,s[28:31],s62 offen lds
s_add_u32 s62,s62,32768
s_add_u32 m0,m0,1024
s_waitcnt vmcnt(6)
buffer_load_dwordx4 v16,s[28:31],s62 offen lds
s_add_u32 s62,s62,32768
s_add_u32 m0,m0,1024
s_waitcnt vmcnt(6)
buffer_load_dwordx4 v16,s[28:31],s62 offen lds
s_waitcnt vmcnt(6)
s_waitcnt vmcnt(16)
ds_read_b64_tr_b16 a[128:129],v17 offset:0
ds_read_b64_tr_b16 a[130:131],v17 offset:256
ds_read_b64_tr_b16 a[132:133],v17 offset:8
ds_read_b64_tr_b16 a[134:135],v17 offset:264
ds_read_b64_tr_b16 a[136:137],v17 offset:2048
ds_read_b64_tr_b16 a[138:139],v17 offset:2304
ds_read_b64_tr_b16 a[140:141],v17 offset:2056
ds_read_b64_tr_b16 a[142:143],v17 offset:2312
ds_read_b64_tr_b16 a[144:145],v17 offset:4096
ds_read_b64_tr_b16 a[146:147],v17 offset:4352
ds_read_b64_tr_b16 a[148:149],v17 offset:4104
ds_read_b64_tr_b16 a[150:151],v17 offset:4360
s_waitcnt lgkmcnt(0)
ds_read_b64_tr_b16 a[152:153],v17 offset:6144
ds_read_b64_tr_b16 a[154:155],v17 offset:6400
ds_read_b64_tr_b16 a[156:157],v17 offset:6152
ds_read_b64_tr_b16 a[158:159],v17 offset:6408
ds_read_b64_tr_b16 a[160:161],v17 offset:8192
ds_read_b64_tr_b16 a[162:163],v17 offset:8448
ds_read_b64_tr_b16 a[164:165],v17 offset:8200
ds_read_b64_tr_b16 a[166:167],v17 offset:8456
ds_read_b64_tr_b16 a[168:169],v17 offset:10240
ds_read_b64_tr_b16 a[170:171],v17 offset:10496
ds_read_b64_tr_b16 a[172:173],v17 offset:10248
ds_read_b64_tr_b16 a[174:175],v17 offset:10504
s_waitcnt lgkmcnt(0)
ds_read_b64_tr_b16 a[176:177],v17 offset:12288
ds_read_b64_tr_b16 a[178:179],v17 offset:12544
ds_read_b64_tr_b16 a[180:181],v17 offset:12296
ds_read_b64_tr_b16 a[182:183],v17 offset:12552
ds_read_b64_tr_b16 a[184:185],v17 offset:14336
ds_read_b64_tr_b16 a[186:187],v17 offset:14592
ds_read_b64_tr_b16 a[188:189],v17 offset:14344
ds_read_b64_tr_b16 a[190:191],v17 offset:14600
s_waitcnt lgkmcnt(0)
s_waitcnt vmcnt(0)
ds_read_b64_tr_b16 a[192:193],v17 offset:16384
ds_read_b64_tr_b16 a[194:195],v17 offset:16640
ds_read_b64_tr_b16 a[196:197],v17 offset:16392
ds_read_b64_tr_b16 a[198:199],v17 offset:16648
ds_read_b64_tr_b16 a[200:201],v17 offset:18432
ds_read_b64_tr_b16 a[202:203],v17 offset:18688
ds_read_b64_tr_b16 a[204:205],v17 offset:18440
ds_read_b64_tr_b16 a[206:207],v17 offset:18696
ds_read_b64_tr_b16 a[208:209],v17 offset:20480
ds_read_b64_tr_b16 a[210:211],v17 offset:20736
ds_read_b64_tr_b16 a[212:213],v17 offset:20488
ds_read_b64_tr_b16 a[214:215],v17 offset:20744
s_waitcnt lgkmcnt(0)
ds_read_b64_tr_b16 a[216:217],v17 offset:22528
ds_read_b64_tr_b16 a[218:219],v17 offset:22784
ds_read_b64_tr_b16 a[220:221],v17 offset:22536
ds_read_b64_tr_b16 a[222:223],v17 offset:22792
ds_read_b64_tr_b16 a[224:225],v17 offset:24576
ds_read_b64_tr_b16 a[226:227],v17 offset:24832
ds_read_b64_tr_b16 a[228:229],v17 offset:24584
ds_read_b64_tr_b16 a[230:231],v17 offset:24840
ds_read_b64_tr_b16 a[232:233],v17 offset:26624
ds_read_b64_tr_b16 a[234:235],v17 offset:26880
ds_read_b64_tr_b16 a[236:237],v17 offset:26632
ds_read_b64_tr_b16 a[238:239],v17 offset:26888
s_waitcnt lgkmcnt(0)
ds_read_b64_tr_b16 a[240:241],v17 offset:28672
ds_read_b64_tr_b16 a[242:243],v17 offset:28928
ds_read_b64_tr_b16 a[244:245],v17 offset:28680
ds_read_b64_tr_b16 a[246:247],v17 offset:28936
ds_read_b64_tr_b16 a[248:249],v17 offset:30720
ds_read_b64_tr_b16 a[250:251],v17 offset:30976
ds_read_b64_tr_b16 a[252:253],v17 offset:30728
ds_read_b64_tr_b16 a[254:255],v17 offset:30984
s_waitcnt lgkmcnt(0)
s_mov_b32 s92,s2
s_and_b32 s93,s3,0xffff
s_mov_b32 s94,0x100
s_mov_b32 s95,0x20000
v_mbcnt_lo_u32_b32 v16,-1,0
v_mbcnt_hi_u32_b32 v16,-1,v16
v_mov_b32 v18,0
v_cmp_eq_u32 vcc,22,v16
s_nop 1
v_cndmask_b32 v18,v18,63,vcc
v_cmp_eq_u32 vcc,17,v16
s_nop 1
v_cndmask_b32 v18,v18,63,vcc
v_cmp_eq_u32 vcc,18,v16
s_nop 1
v_cndmask_b32 v18,v18,1,vcc
v_and_b32 v19,1,v16
v_cmp_eq_u32 vcc,1,v19
v_mov_b32 v19,8192
s_nop 0
v_cndmask_b32 v19,-1,v19,vcc
v_min_u32 v16,31,v16
v_lshlrev_b32 v16,2,v16
s_sub_u32 s66,s88,64
s_cmp_lg_u32 s50,0
s_cbranch_scc1 vot_76
vpoll_72:
buffer_load_dword v17,v16,s[92:95],s66 offen sc1
s_waitcnt vmcnt(0)
s_cmp_lg_u32 s56,2
s_cbranch_scc1 vck_73
v_cmp_eq_u32 vcc,v17,v19
s_and_b32 s64,vcc_lo,0xffff
s_cmp_eq_u32 s64,65535
s_cbranch_scc1 vck_73
s_mov_b32 s65,0
v_readlane_b32 s64,v17,1
s_lshr_b32 s64,s64,8
s_add_u32 s65,s65,s64
v_readlane_b32 s64,v17,3
s_lshr_b32 s64,s64,8
s_add_u32 s65,s65,s64
v_readlane_b32 s64,v17,5
s_lshr_b32 s64,s64,8
s_add_u32 s65,s65,s64
v_readlane_b32 s64,v17,7
s_lshr_b32 s64,s64,8
s_add_u32 s65,s65,s64
v_readlane_b32 s64,v17,9
s_lshr_b32 s64,s64,8
s_add_u32 s65,s65,s64
v_readlane_b32 s64,v17,11
s_lshr_b32 s64,s64,8
s_add_u32 s65,s65,s64
v_readlane_b32 s64,v17,13
s_lshr_b32 s64,s64,8
s_add_u32 s65,s65,s64
v_readlane_b32 s64,v17,15
s_lshr_b32 s64,s64,8
s_add_u32 s65,s65,s64
s_cmp_ge_u32 s65,256
s_cbranch_scc1 vok_75
s_branch vrt_74
vck_73:
v_cmp_gt_u32 vcc,v18,v17
s_cbranch_vccz vok_75
vrt_74:
s_sleep 48
s_sub_u32 s90,s90,1
s_cmp_gt_i32 s90,0
s_cbranch_scc1 vpoll_72
vok_75:
v_add_u32 v18,161536,v16
ds_write_b32 v18,v17
s_waitcnt lgkmcnt(0)
vot_76:
s_barrier
v_add_u32 v18,161536,v16
ds_read_b32 v17,v18
s_waitcnt lgkmcnt(0)
s_cmp_lg_u32 s56,2
s_cbranch_scc1 vfin_77
v_cmp_eq_u32 vcc,v17,v19
s_and_b32 s64,vcc_lo,0xffff
s_cmp_eq_u32 s64,65535
s_cbranch_scc1 vfin_77
s_mov_b32 s65,0
v_readlane_b32 s64,v17,1
s_lshr_b32 s64,s64,8
s_add_u32 s65,s65,s64
v_readlane_b32 s64,v17,3
s_lshr_b32 s64,s64,8
s_add_u32 s65,s65,s64
v_readlane_b32 s64,v17,5
s_lshr_b32 s64,s64,8
s_add_u32 s65,s65,s64
v_readlane_b32 s64,v17,7
s_lshr_b32 s64,s64,8
s_add_u32 s65,s65,s64
v_readlane_b32 s64,v17,9
s_lshr_b32 s64,s64,8
s_add_u32 s65,s65,s64
v_readlane_b32 s64,v17,11
s_lshr_b32 s64,s64,8
s_add_u32 s65,s65,s64
v_readlane_b32 s64,v17,13
s_lshr_b32 s64,s64,8
s_add_u32 s65,s65,s64
v_readlane_b32 s64,v17,15
s_lshr_b32 s64,s64,8
s_add_u32 s65,s65,s64
s_cmp_ge_u32 s65,256
s_cbranch_scc1 fl_fb
vfin_77:
s_and_b32 s56,s56,1
s_mov_b32 s67,0
s_barrier
v_lshlrev_b32 v0,4,v1
s_mov_b32 s60,0
s_lshl_b32 s70,s50,13
s_mov_b32 s55,0
v_mov_b32 v3,v0
s_mov_b32 s73,0xffff0000
s_lshl_b32 s64,s52,2
s_add_u32 s64,s64,s50
s_mul_i32 s61,s64,8192
s_add_u32 s61,s61,150994944
s_lshl_b32 s68,s64,8
s_add_u32 s68,s68,138543104
s_lshl_b32 s83,s53,2
s_add_u32 s83,s83,s50
s_mov_b32 s63,0
s_xor_b32 s64,s50,0
s_lshl_b32 s64,s64,13
v_add_u32 v8,s64,v0
v_mov_b32 v4,v8
s_xor_b32 s64,s50,1
s_lshl_b32 s64,s64,13
v_add_u32 v9,s64,v0
v_mov_b32 v5,v9
s_xor_b32 s64,s50,2
s_lshl_b32 s64,s64,13
v_add_u32 v10,s64,v0
v_mov_b32 v6,v10
s_xor_b32 s64,s50,3
s_lshl_b32 s64,s64,13
v_add_u32 v11,s64,v0
v_mov_b32 v7,v11
v_min_u32 v2,11,v1
v_lshlrev_b32 v2,2,v2
s_add_u32 s62,s61,4096
s_lshl_b32 s66,s83,10
s_lshr_b32 s65,s83,3
s_lshl_b32 s65,s65,8
s_and_b32 s64,s83,7
s_lshl_b32 s64,s64,2
s_add_u32 s69,s64,s65
s_add_u32 s69,s69,138547200
s_mov_b32 s82,0
s_lshl_b32 s64,s53,2
s_add_u32 s64,s64,s50
s_mul_i32 s74,s64,24576
s_xor_b32 s64,s50,s52
s_sub_u32 s64,s64,1
s_max_i32 s64,s64,0
s_lshl_b32 s64,s64,11
s_add_u32 s74,s74,s64
s_add_u32 s74,s74,167772160
s_mov_b32 s75,0
s_mov_b32 s77,0
v_lshlrev_b32 v26,11,v21
v_lshl_add_u32 v26,v22,4,v26
s_lshl_b32 s64,s83,6
v_add_u32 v18,s64,v26
v_lshlrev_b32 v26,5,v22
s_lshl_b32 s64,s83,7
s_add_u32 s64,s64,267395072
buffer_load_dwordx4 v[152:155],v26,s[20:23],s64 offen offset:0 sc1
buffer_load_dwordx4 v[156:159],v26,s[20:23],s64 offen offset:16 sc1
s_add_u32 s64,s64,24576
buffer_load_dwordx4 v[128:131],v26,s[20:23],s64 offen offset:0 sc1
buffer_load_dwordx4 v[132:135],v26,s[20:23],s64 offen offset:16 sc1
s_add_u32 s64,s64,24576
buffer_load_dwordx4 v[136:139],v26,s[20:23],s64 offen offset:0 sc1
buffer_load_dwordx4 v[140:143],v26,s[20:23],s64 offen offset:16 sc1
s_add_u32 s64,s64,24576
buffer_load_dwordx4 v[144:147],v26,s[20:23],s64 offen offset:0 sc1
buffer_load_dwordx4 v[148:151],v26,s[20:23],s64 offen offset:16 sc1
s_add_u32 s64,s64,24576
s_waitcnt vmcnt(0)
v_pk_add_f32 v[152:153],v[152:153],v[128:129]
v_pk_add_f32 v[136:137],v[136:137],v[144:145]
v_pk_add_f32 v[154:155],v[154:155],v[130:131]
v_pk_add_f32 v[138:139],v[138:139],v[146:147]
v_pk_add_f32 v[156:157],v[156:157],v[132:133]
v_pk_add_f32 v[140:141],v[140:141],v[148:149]
v_pk_add_f32 v[158:159],v[158:159],v[134:135]
v_pk_add_f32 v[142:143],v[142:143],v[150:151]
v_pk_add_f32 v[152:153],v[152:153],v[136:137]
v_pk_add_f32 v[154:155],v[154:155],v[138:139]
v_pk_add_f32 v[156:157],v[156:157],v[140:141]
v_pk_add_f32 v[158:159],v[158:159],v[142:143]
v_cvt_pk_bf16_f32 v128,v152,v153
v_cvt_pk_bf16_f32 v129,v154,v155
v_cvt_pk_bf16_f32 v130,v156,v157
v_cvt_pk_bf16_f32 v131,v158,v159
v_lshlrev_b32 v152,16,v128
v_and_b32 v153,s73,v128
v_lshlrev_b32 v154,16,v129
v_and_b32 v155,s73,v129
v_lshlrev_b32 v156,16,v130
v_and_b32 v157,s73,v130
v_lshlrev_b32 v158,16,v131
v_and_b32 v159,s73,v131
v_mov_b32 v204,-1
v_mov_b32 v205,-1
v_mov_b32 v206,-1
v_mov_b32 v207,-1
v_cmp_eq_u32 vcc,0,v1
s_nop 1
v_cndmask_b32 v26,2.0,0,vcc
s_cmp_eq_u32 s50,s52
s_cbranch_scc1 lfin_78
s_add_u32 s71,s60,1
s_add_u32 s53,s60,2
plp_88:
buffer_load_dword v16,v2,s[20:23],s68 offen sc1
s_waitcnt vmcnt(0)
v_cmp_gt_u32 vcc,s71,v16
s_cbranch_vccz pok_89
s_sleep 4
s_sub_u32 s90,s90,1
s_cmp_gt_i32 s90,0
s_cbranch_scc1 plp_88
pok_89:
lag_85:
s_mov_b32 m0,s70
s_nop 0
buffer_load_dwordx4 v3,s[20:23],s61 offen offset:0 lds
buffer_load_dwordx4 v3,s[20:23],s61 offen offset:1024 lds
buffer_load_dwordx4 v3,s[20:23],s61 offen offset:2048 lds
buffer_load_dwordx4 v3,s[20:23],s61 offen offset:3072 lds
s_add_u32 m0,s70,4096
s_nop 0
buffer_load_dwordx4 v3,s[20:23],s62 offen offset:0 lds
buffer_load_dwordx4 v3,s[20:23],s62 offen offset:1024 lds
buffer_load_dwordx4 v3,s[20:23],s62 offen offset:2048 lds
buffer_load_dwordx4 v3,s[20:23],s62 offen offset:3072 lds
s_add_u32 s61,s61,131072
s_add_u32 s62,s62,131072
s_add_u32 s70,s70,32768
s_and_b32 s70,s70,0x1ffff
buffer_load_dword v23,off,s[20:23],s66
buffer_load_dword v23,off,s[20:23],s66
dec_86:
v_cmp_gt_u32 vcc,s53,v16
s_cbranch_vccnz BN_84
BR_83:
s_waitcnt vmcnt(9)
ds_read_b128 v[64:67],v4 offset:0
s_waitcnt vmcnt(8)
ds_read_b128 v[68:71],v4 offset:1024
s_waitcnt vmcnt(7)
ds_read_b128 v[72:75],v4 offset:2048
s_waitcnt vmcnt(6)
ds_read_b128 v[76:79],v4 offset:3072
s_waitcnt lgkmcnt(3)
v_mfma_f32_16x16x32_bf16 v[32:35],a[0:3],v[64:67],0
s_add_u32 s71,s60,2
s_add_u32 s53,s60,3
v_mfma_f32_16x16x32_bf16 v[36:39],a[4:7],v[64:67],0
s_waitcnt lgkmcnt(2)
s_waitcnt vmcnt(5)
ds_read_b128 v[80:83],v4 offset:4096
v_mfma_f32_16x16x32_bf16 v[32:35],a[8:11],v[68:71],v[32:35]
v_mfma_f32_16x16x32_bf16 v[36:39],a[12:15],v[68:71],v[36:39]
s_waitcnt lgkmcnt(2)
s_waitcnt vmcnt(4)
s_mov_b32 m0,s70
ds_read_b128 v[84:87],v4 offset:5120
v_mfma_f32_16x16x32_bf16 v[32:35],a[16:19],v[72:75],v[32:35]
buffer_load_dwordx4 v3,s[20:23],s61 offen offset:0 lds
v_mfma_f32_16x16x32_bf16 v[36:39],a[20:23],v[72:75],v[36:39]
s_waitcnt lgkmcnt(2)
s_waitcnt vmcnt(4)
ds_read_b128 v[88:91],v4 offset:6144
v_mfma_f32_16x16x32_bf16 v[32:35],a[24:27],v[76:79],v[32:35]
buffer_load_dwordx4 v3,s[20:23],s61 offen offset:1024 lds
v_mfma_f32_16x16x32_bf16 v[36:39],a[28:31],v[76:79],v[36:39]
s_waitcnt lgkmcnt(2)
s_waitcnt vmcnt(4)
ds_read_b128 v[92:95],v4 offset:7168
v_mfma_f32_16x16x32_bf16 v[32:35],a[32:35],v[80:83],v[32:35]
v_mfma_f32_16x16x32_bf16 v[36:39],a[36:39],v[80:83],v[36:39]
s_waitcnt lgkmcnt(2)
s_barrier
ds_read_b128 v[96:99],v5 offset:0
v_mfma_f32_16x16x32_bf16 v[32:35],a[40:43],v[84:87],v[32:35]
ds_read_b128 v[100:103],v5 offset:1024
buffer_load_dwordx4 v3,s[20:23],s61 offen offset:2048 lds
v_mfma_f32_16x16x32_bf16 v[36:39],a[44:47],v[84:87],v[36:39]
s_waitcnt lgkmcnt(3)
ds_read_b128 v[104:107],v5 offset:2048
v_mfma_f32_16x16x32_bf16 v[32:35],a[48:51],v[88:91],v[32:35]
ds_read_b128 v[108:111],v5 offset:3072
v_mfma_f32_16x16x32_bf16 v[36:39],a[52:55],v[88:91],v[36:39]
s_waitcnt lgkmcnt(4)
ds_read_b128 v[112:115],v5 offset:4096
buffer_load_dwordx4 v3,s[20:23],s61 offen offset:3072 lds
v_mfma_f32_16x16x32_bf16 v[32:35],a[56:59],v[92:95],v[32:35]
ds_read_b128 v[116:119],v5 offset:5120
v_mfma_f32_16x16x32_bf16 v[36:39],a[60:63],v[92:95],v[36:39]
s_waitcnt lgkmcnt(5)
s_add_u32 m0,s70,4096
v_mfma_f32_16x16x32_bf16 v[32:35],a[64:67],v[96:99],v[32:35]
ds_read_b128 v[120:123],v5 offset:6144
buffer_load_dwordx4 v3,s[20:23],s62 offen offset:0 lds
v_mfma_f32_16x16x32_bf16 v[36:39],a[68:71],v[96:99],v[36:39]
s_waitcnt lgkmcnt(5)
v_mfma_f32_16x16x32_bf16 v[32:35],a[72:75],v[100:103],v[32:35]
ds_read_b128 v[124:127],v5 offset:7168
v_mfma_f32_16x16x32_bf16 v[36:39],a[76:79],v[100:103],v[36:39]
s_waitcnt lgkmcnt(5)
buffer_load_dwordx4 v3,s[20:23],s62 offen offset:1024 lds
v_mfma_f32_16x16x32_bf16 v[32:35],a[80:83],v[104:107],v[32:35]
ds_read_b128 v[64:67],v6 offset:0
v_mfma_f32_16x16x32_bf16 v[36:39],a[84:87],v[104:107],v[36:39]
s_waitcnt lgkmcnt(5)
v_mfma_f32_16x16x32_bf16 v[32:35],a[88:91],v[108:111],v[32:35]
ds_read_b128 v[68:71],v6 offset:1024
v_mfma_f32_16x16x32_bf16 v[36:39],a[92:95],v[108:111],v[36:39]
s_waitcnt lgkmcnt(5)
buffer_load_dwordx4 v3,s[20:23],s62 offen offset:2048 lds
v_mfma_f32_16x16x32_bf16 v[32:35],a[96:99],v[112:115],v[32:35]
ds_read_b128 v[72:75],v6 offset:2048
buffer_load_dword v16,v2,s[20:23],s68 offen sc1
v_mfma_f32_16x16x32_bf16 v[36:39],a[100:103],v[112:115],v[36:39]
s_waitcnt lgkmcnt(5)
v_mfma_f32_16x16x32_bf16 v[32:35],a[104:107],v[116:119],v[32:35]
ds_read_b128 v[76:79],v6 offset:3072
buffer_load_dwordx4 v3,s[20:23],s62 offen offset:3072 lds
v_mfma_f32_16x16x32_bf16 v[36:39],a[108:111],v[116:119],v[36:39]
s_waitcnt lgkmcnt(5)
v_mfma_f32_16x16x32_bf16 v[32:35],a[112:115],v[120:123],v[32:35]
ds_read_b128 v[80:83],v6 offset:4096
v_mfma_f32_16x16x32_bf16 v[36:39],a[116:119],v[120:123],v[36:39]
s_waitcnt lgkmcnt(5)
v_mfma_f32_16x16x32_bf16 v[32:35],a[120:123],v[124:127],v[32:35]
ds_read_b128 v[84:87],v6 offset:5120
v_mfma_f32_16x16x32_bf16 v[36:39],a[124:127],v[124:127],v[36:39]
s_waitcnt lgkmcnt(5)
v_mfma_f32_16x16x32_bf16 v[32:35],a[128:131],v[64:67],v[32:35]
ds_read_b128 v[88:91],v6 offset:6144
v_mfma_f32_16x16x32_bf16 v[36:39],a[132:135],v[64:67],v[36:39]
s_waitcnt lgkmcnt(5)
v_mfma_f32_16x16x32_bf16 v[32:35],a[136:139],v[68:71],v[32:35]
ds_read_b128 v[92:95],v6 offset:7168
v_mfma_f32_16x16x32_bf16 v[36:39],a[140:143],v[68:71],v[36:39]
s_waitcnt lgkmcnt(5)
v_mfma_f32_16x16x32_bf16 v[32:35],a[144:147],v[72:75],v[32:35]
ds_read_b128 v[96:99],v7 offset:0
v_mfma_f32_16x16x32_bf16 v[36:39],a[148:151],v[72:75],v[36:39]
s_waitcnt lgkmcnt(5)
v_mfma_f32_16x16x32_bf16 v[32:35],a[152:155],v[76:79],v[32:35]
ds_read_b128 v[100:103],v7 offset:1024
v_mfma_f32_16x16x32_bf16 v[36:39],a[156:159],v[76:79],v[36:39]
s_waitcnt lgkmcnt(5)
v_mfma_f32_16x16x32_bf16 v[32:35],a[160:163],v[80:83],v[32:35]
ds_read_b128 v[104:107],v7 offset:2048
v_mfma_f32_16x16x32_bf16 v[36:39],a[164:167],v[80:83],v[36:39]
s_waitcnt lgkmcnt(5)
v_mfma_f32_16x16x32_bf16 v[32:35],a[168:171],v[84:87],v[32:35]
ds_read_b128 v[108:111],v7 offset:3072
v_mfma_f32_16x16x32_bf16 v[36:39],a[172:175],v[84:87],v[36:39]
s_waitcnt lgkmcnt(5)
v_mfma_f32_16x16x32_bf16 v[32:35],a[176:179],v[88:91],v[32:35]
ds_read_b128 v[112:115],v7 offset:4096
v_mfma_f32_16x16x32_bf16 v[36:39],a[180:183],v[88:91],v[36:39]
s_waitcnt lgkmcnt(5)
v_mfma_f32_16x16x32_bf16 v[32:35],a[184:187],v[92:95],v[32:35]
ds_read_b128 v[116:119],v7 offset:5120
v_mfma_f32_16x16x32_bf16 v[36:39],a[188:191],v[92:95],v[36:39]
s_waitcnt lgkmcnt(5)
v_mfma_f32_16x16x32_bf16 v[32:35],a[192:195],v[96:99],v[32:35]
ds_read_b128 v[120:123],v7 offset:6144
v_mfma_f32_16x16x32_bf16 v[36:39],a[196:199],v[96:99],v[36:39]
s_waitcnt lgkmcnt(5)
v_mfma_f32_16x16x32_bf16 v[32:35],a[200:203],v[100:103],v[32:35]
ds_read_b128 v[124:127],v7 offset:7168
v_mfma_f32_16x16x32_bf16 v[36:39],a[204:207],v[100:103],v[36:39]
s_waitcnt lgkmcnt(5)
s_add_u32 s61,s61,131072
s_add_u32 s62,s62,131072
v_mfma_f32_16x16x32_bf16 v[32:35],a[208:211],v[104:107],v[32:35]
s_add_u32 s70,s70,32768
s_and_b32 s70,s70,0x1ffff
s_add_u32 s55,s55,32768
v_mfma_f32_16x16x32_bf16 v[36:39],a[212:215],v[104:107],v[36:39]
s_waitcnt lgkmcnt(4)
s_and_b32 s55,s55,0x1ffff
v_add_u32 v4,s55,v8
v_mfma_f32_16x16x32_bf16 v[32:35],a[216:219],v[108:111],v[32:35]
v_add_u32 v5,s55,v9
v_add_u32 v6,s55,v10
v_mfma_f32_16x16x32_bf16 v[36:39],a[220:223],v[108:111],v[36:39]
s_waitcnt lgkmcnt(3)
v_add_u32 v7,s55,v11
v_mfma_f32_16x16x32_bf16 v[32:35],a[224:227],v[112:115],v[32:35]
s_waitcnt vmcnt(8)
ds_read_b128 v[64:67],v4 offset:0
v_mfma_f32_16x16x32_bf16 v[36:39],a[228:231],v[112:115],v[36:39]
s_waitcnt lgkmcnt(3)
s_waitcnt vmcnt(7)
ds_read_b128 v[68:71],v4 offset:1024
v_mfma_f32_16x16x32_bf16 v[32:35],a[232:235],v[116:119],v[32:35]
s_waitcnt vmcnt(6)
ds_read_b128 v[72:75],v4 offset:2048
v_mfma_f32_16x16x32_bf16 v[36:39],a[236:239],v[116:119],v[36:39]
s_waitcnt lgkmcnt(4)
v_mfma_f32_16x16x32_bf16 v[32:35],a[240:243],v[120:123],v[32:35]
v_mfma_f32_16x16x32_bf16 v[36:39],a[244:247],v[120:123],v[36:39]
s_waitcnt lgkmcnt(3)
v_mfma_f32_16x16x32_bf16 v[40:43],a[248:251],v[124:127],v[32:35]
v_mfma_f32_16x16x32_bf16 v[44:47],a[252:255],v[124:127],v[36:39]
s_waitcnt vmcnt(1)
v_cmp_gt_u32 vcc,s53,v16
s_add_u32 s60,s60,1
s_cbranch_vccnz WN_82
.p2align 6
WR_81:
s_waitcnt lgkmcnt(2)
v_mfma_f32_16x16x32_bf16 v[32:35],a[0:3],v[64:67],0
s_waitcnt vmcnt(5)
s_add_u32 s71,s60,2
ds_read_b128 v[76:79],v4 offset:3072
v_mfma_f32_16x16x32_bf16 v[36:39],a[4:7],v[64:67],0
s_waitcnt lgkmcnt(2)
s_add_u32 s53,s60,3
v_mfma_f32_16x16x32_bf16 v[32:35],a[8:11],v[68:71],v[32:35]
s_waitcnt vmcnt(4)
s_mov_b32 m0,s70
ds_read_b128 v[80:83],v4 offset:4096
v_mfma_f32_16x16x32_bf16 v[36:39],a[12:15],v[68:71],v[36:39]
s_waitcnt lgkmcnt(2)
buffer_load_dwordx4 v3,s[20:23],s61 offen offset:0 lds
s_add_u32 s64,s74,s75
s_cmp_eq_u32 s56,1
s_cbranch_scc1 b1_90
buffer_store_dwordx4 v[40:43],v0,s[20:23],s64 offen offset:0
buffer_store_dwordx4 v[44:47],v0,s[20:23],s64 offen offset:1024
b2_91:
v_mfma_f32_16x16x32_bf16 v[32:35],a[16:19],v[72:75],v[32:35]
s_waitcnt vmcnt(6)
s_add_u32 s75,s75,6144
ds_read_b128 v[84:87],v4 offset:5120
v_mfma_f32_16x16x32_bf16 v[36:39],a[20:23],v[72:75],v[36:39]
s_waitcnt lgkmcnt(2)
s_cmp_eq_u32 s75,24576
s_cselect_b32 s75,0,s75
v_mfma_f32_16x16x32_bf16 v[32:35],a[24:27],v[76:79],v[32:35]
s_waitcnt vmcnt(5)
ds_read_b128 v[88:91],v4 offset:6144
buffer_load_dwordx4 v3,s[20:23],s61 offen offset:1024 lds
v_mfma_f32_16x16x32_bf16 v[36:39],a[28:31],v[76:79],v[36:39]
s_waitcnt lgkmcnt(2)
v_mfma_f32_16x16x32_bf16 v[32:35],a[32:35],v[80:83],v[32:35]
s_waitcnt vmcnt(4)
ds_read_b128 v[92:95],v4 offset:7168
v_mfma_f32_16x16x32_bf16 v[36:39],a[36:39],v[80:83],v[36:39]
s_waitcnt lgkmcnt(2)
s_barrier
ds_read_b128 v[96:99],v5 offset:0
v_mfma_f32_16x16x32_bf16 v[32:35],a[40:43],v[84:87],v[32:35]
ds_read_b128 v[100:103],v5 offset:1024
buffer_load_dwordx4 v3,s[20:23],s61 offen offset:2048 lds
v_mfma_f32_16x16x32_bf16 v[36:39],a[44:47],v[84:87],v[36:39]
s_waitcnt lgkmcnt(3)
ds_read_b128 v[104:107],v5 offset:2048
v_mfma_f32_16x16x32_bf16 v[32:35],a[48:51],v[88:91],v[32:35]
ds_read_b128 v[108:111],v5 offset:3072
v_mfma_f32_16x16x32_bf16 v[36:39],a[52:55],v[88:91],v[36:39]
s_waitcnt lgkmcnt(4)
ds_read_b128 v[112:115],v5 offset:4096
buffer_load_dwordx4 v3,s[20:23],s61 offen offset:3072 lds
v_mfma_f32_16x16x32_bf16 v[32:35],a[56:59],v[92:95],v[32:35]
ds_read_b128 v[116:119],v5 offset:5120
v_mfma_f32_16x16x32_bf16 v[36:39],a[60:63],v[92:95],v[36:39]
s_waitcnt lgkmcnt(5)
s_add_u32 m0,s70,4096
v_mfma_f32_16x16x32_bf16 v[32:35],a[64:67],v[96:99],v[32:35]
ds_read_b128 v[120:123],v5 offset:6144
buffer_load_dwordx4 v3,s[20:23],s62 offen offset:0 lds
v_mfma_f32_16x16x32_bf16 v[36:39],a[68:71],v[96:99],v[36:39]
s_waitcnt lgkmcnt(5)
v_mfma_f32_16x16x32_bf16 v[32:35],a[72:75],v[100:103],v[32:35]
ds_read_b128 v[124:127],v5 offset:7168
v_mfma_f32_16x16x32_bf16 v[36:39],a[76:79],v[100:103],v[36:39]
s_waitcnt lgkmcnt(5)
buffer_load_dwordx4 v3,s[20:23],s62 offen offset:1024 lds
v_mfma_f32_16x16x32_bf16 v[32:35],a[80:83],v[104:107],v[32:35]
ds_read_b128 v[64:67],v6 offset:0
v_mfma_f32_16x16x32_bf16 v[36:39],a[84:87],v[104:107],v[36:39]
s_waitcnt lgkmcnt(5)
v_mfma_f32_16x16x32_bf16 v[32:35],a[88:91],v[108:111],v[32:35]
ds_read_b128 v[68:71],v6 offset:1024
v_mfma_f32_16x16x32_bf16 v[36:39],a[92:95],v[108:111],v[36:39]
s_waitcnt lgkmcnt(5)
buffer_load_dwordx4 v3,s[20:23],s62 offen offset:2048 lds
v_mfma_f32_16x16x32_bf16 v[32:35],a[96:99],v[112:115],v[32:35]
ds_read_b128 v[72:75],v6 offset:2048
buffer_load_dword v16,v2,s[20:23],s68 offen sc1
v_mfma_f32_16x16x32_bf16 v[36:39],a[100:103],v[112:115],v[36:39]
s_waitcnt lgkmcnt(5)
v_mfma_f32_16x16x32_bf16 v[32:35],a[104:107],v[116:119],v[32:35]
ds_read_b128 v[76:79],v6 offset:3072
buffer_load_dwordx4 v3,s[20:23],s62 offen offset:3072 lds
v_mfma_f32_16x16x32_bf16 v[36:39],a[108:111],v[116:119],v[36:39]
s_waitcnt lgkmcnt(5)
v_mfma_f32_16x16x32_bf16 v[32:35],a[112:115],v[120:123],v[32:35]
ds_read_b128 v[80:83],v6 offset:4096
v_mfma_f32_16x16x32_bf16 v[36:39],a[116:119],v[120:123],v[36:39]
s_waitcnt lgkmcnt(5)
v_mfma_f32_16x16x32_bf16 v[32:35],a[120:123],v[124:127],v[32:35]
ds_read_b128 v[84:87],v6 offset:5120
v_mfma_f32_16x16x32_bf16 v[36:39],a[124:127],v[124:127],v[36:39]
s_waitcnt lgkmcnt(5)
v_mfma_f32_16x16x32_bf16 v[32:35],a[128:131],v[64:67],v[32:35]
ds_read_b128 v[88:91],v6 offset:6144
v_mfma_f32_16x16x32_bf16 v[36:39],a[132:135],v[64:67],v[36:39]
s_waitcnt lgkmcnt(5)
v_mfma_f32_16x16x32_bf16 v[32:35],a[136:139],v[68:71],v[32:35]
ds_read_b128 v[92:95],v6 offset:7168
v_mfma_f32_16x16x32_bf16 v[36:39],a[140:143],v[68:71],v[36:39]
s_waitcnt lgkmcnt(5)
v_mfma_f32_16x16x32_bf16 v[32:35],a[144:147],v[72:75],v[32:35]
ds_read_b128 v[96:99],v7 offset:0
v_mfma_f32_16x16x32_bf16 v[36:39],a[148:151],v[72:75],v[36:39]
s_waitcnt lgkmcnt(5)
v_mfma_f32_16x16x32_bf16 v[32:35],a[152:155],v[76:79],v[32:35]
ds_read_b128 v[100:103],v7 offset:1024
v_mfma_f32_16x16x32_bf16 v[36:39],a[156:159],v[76:79],v[36:39]
s_waitcnt lgkmcnt(5)
v_mfma_f32_16x16x32_bf16 v[32:35],a[160:163],v[80:83],v[32:35]
ds_read_b128 v[104:107],v7 offset:2048
v_mfma_f32_16x16x32_bf16 v[36:39],a[164:167],v[80:83],v[36:39]
s_waitcnt lgkmcnt(5)
v_mfma_f32_16x16x32_bf16 v[32:35],a[168:171],v[84:87],v[32:35]
ds_read_b128 v[108:111],v7 offset:3072
v_mfma_f32_16x16x32_bf16 v[36:39],a[172:175],v[84:87],v[36:39]
s_waitcnt lgkmcnt(5)
v_mfma_f32_16x16x32_bf16 v[32:35],a[176:179],v[88:91],v[32:35]
ds_read_b128 v[112:115],v7 offset:4096
v_mfma_f32_16x16x32_bf16 v[36:39],a[180:183],v[88:91],v[36:39]
s_waitcnt lgkmcnt(5)
v_mfma_f32_16x16x32_bf16 v[32:35],a[184:187],v[92:95],v[32:35]
ds_read_b128 v[116:119],v7 offset:5120
v_mfma_f32_16x16x32_bf16 v[36:39],a[188:191],v[92:95],v[36:39]
s_waitcnt lgkmcnt(5)
v_mfma_f32_16x16x32_bf16 v[32:35],a[192:195],v[96:99],v[32:35]
ds_read_b128 v[120:123],v7 offset:6144
v_mfma_f32_16x16x32_bf16 v[36:39],a[196:199],v[96:99],v[36:39]
s_waitcnt lgkmcnt(5)
v_mfma_f32_16x16x32_bf16 v[32:35],a[200:203],v[100:103],v[32:35]
ds_read_b128 v[124:127],v7 offset:7168
v_mfma_f32_16x16x32_bf16 v[36:39],a[204:207],v[100:103],v[36:39]
s_waitcnt lgkmcnt(5)
s_add_u32 s61,s61,131072
s_add_u32 s62,s62,131072
v_mfma_f32_16x16x32_bf16 v[32:35],a[208:211],v[104:107],v[32:35]
s_add_u32 s70,s70,32768
s_and_b32 s70,s70,0x1ffff
s_add_u32 s55,s55,32768
v_mfma_f32_16x16x32_bf16 v[36:39],a[212:215],v[104:107],v[36:39]
s_waitcnt lgkmcnt(4)
s_and_b32 s55,s55,0x1ffff
v_add_u32 v4,s55,v8
v_mfma_f32_16x16x32_bf16 v[32:35],a[216:219],v[108:111],v[32:35]
v_add_u32 v5,s55,v9
v_add_u32 v6,s55,v10
v_mfma_f32_16x16x32_bf16 v[36:39],a[220:223],v[108:111],v[36:39]
s_waitcnt lgkmcnt(3)
v_add_u32 v7,s55,v11
v_mfma_f32_16x16x32_bf16 v[32:35],a[224:227],v[112:115],v[32:35]
s_waitcnt vmcnt(10)
ds_read_b128 v[64:67],v4 offset:0
v_mfma_f32_16x16x32_bf16 v[36:39],a[228:231],v[112:115],v[36:39]
s_waitcnt lgkmcnt(3)
s_waitcnt vmcnt(7)
ds_read_b128 v[68:71],v4 offset:1024
v_mfma_f32_16x16x32_bf16 v[32:35],a[232:235],v[116:119],v[32:35]
s_waitcnt vmcnt(6)
ds_read_b128 v[72:75],v4 offset:2048
v_mfma_f32_16x16x32_bf16 v[36:39],a[236:239],v[116:119],v[36:39]
s_waitcnt lgkmcnt(4)
v_mfma_f32_16x16x32_bf16 v[32:35],a[240:243],v[120:123],v[32:35]
v_mfma_f32_16x16x32_bf16 v[36:39],a[244:247],v[120:123],v[36:39]
s_waitcnt lgkmcnt(3)
v_mfma_f32_16x16x32_bf16 v[40:43],a[248:251],v[124:127],v[32:35]
v_mfma_f32_16x16x32_bf16 v[44:47],a[252:255],v[124:127],v[36:39]
s_waitcnt vmcnt(1)
v_cmp_gt_u32 vcc,s53,v16
s_add_u32 s60,s60,1
s_cbranch_vccz WR_81
WN_82:
s_waitcnt lgkmcnt(2)
v_mfma_f32_16x16x32_bf16 v[32:35],a[0:3],v[64:67],0
s_waitcnt vmcnt(5)
s_add_u32 s71,s60,2
ds_read_b128 v[76:79],v4 offset:3072
v_mfma_f32_16x16x32_bf16 v[36:39],a[4:7],v[64:67],0
s_waitcnt lgkmcnt(2)
s_add_u32 s53,s60,3
v_mfma_f32_16x16x32_bf16 v[32:35],a[8:11],v[68:71],v[32:35]
s_waitcnt vmcnt(4)
ds_read_b128 v[80:83],v4 offset:4096
v_mfma_f32_16x16x32_bf16 v[36:39],a[12:15],v[68:71],v[36:39]
s_waitcnt lgkmcnt(2)
s_add_u32 s64,s74,s75
s_cmp_eq_u32 s56,1
s_cbranch_scc1 b1_93
buffer_store_dwordx4 v[40:43],v0,s[20:23],s64 offen offset:0
buffer_store_dwordx4 v[44:47],v0,s[20:23],s64 offen offset:1024
b2_94:
v_mfma_f32_16x16x32_bf16 v[32:35],a[16:19],v[72:75],v[32:35]
s_waitcnt vmcnt(5)
s_add_u32 s75,s75,6144
ds_read_b128 v[84:87],v4 offset:5120
v_mfma_f32_16x16x32_bf16 v[36:39],a[20:23],v[72:75],v[36:39]
s_waitcnt lgkmcnt(2)
s_cmp_eq_u32 s75,24576
s_cselect_b32 s75,0,s75
v_mfma_f32_16x16x32_bf16 v[32:35],a[24:27],v[76:79],v[32:35]
s_waitcnt vmcnt(4)
ds_read_b128 v[88:91],v4 offset:6144
v_mfma_f32_16x16x32_bf16 v[36:39],a[28:31],v[76:79],v[36:39]
s_waitcnt lgkmcnt(2)
v_mfma_f32_16x16x32_bf16 v[32:35],a[32:35],v[80:83],v[32:35]
s_waitcnt vmcnt(2)
ds_read_b128 v[92:95],v4 offset:7168
v_mfma_f32_16x16x32_bf16 v[36:39],a[36:39],v[80:83],v[36:39]
s_waitcnt lgkmcnt(2)
s_barrier
ds_read_b128 v[96:99],v5 offset:0
v_mfma_f32_16x16x32_bf16 v[32:35],a[40:43],v[84:87],v[32:35]
ds_read_b128 v[100:103],v5 offset:1024
v_mfma_f32_16x16x32_bf16 v[36:39],a[44:47],v[84:87],v[36:39]
s_waitcnt lgkmcnt(3)
ds_read_b128 v[104:107],v5 offset:2048
v_mfma_f32_16x16x32_bf16 v[32:35],a[48:51],v[88:91],v[32:35]
ds_read_b128 v[108:111],v5 offset:3072
v_mfma_f32_16x16x32_bf16 v[36:39],a[52:55],v[88:91],v[36:39]
s_waitcnt lgkmcnt(4)
ds_read_b128 v[112:115],v5 offset:4096
v_mfma_f32_16x16x32_bf16 v[32:35],a[56:59],v[92:95],v[32:35]
ds_read_b128 v[116:119],v5 offset:5120
v_mfma_f32_16x16x32_bf16 v[36:39],a[60:63],v[92:95],v[36:39]
s_waitcnt lgkmcnt(5)
v_mfma_f32_16x16x32_bf16 v[32:35],a[64:67],v[96:99],v[32:35]
ds_read_b128 v[120:123],v5 offset:6144
v_mfma_f32_16x16x32_bf16 v[36:39],a[68:71],v[96:99],v[36:39]
s_waitcnt lgkmcnt(5)
v_mfma_f32_16x16x32_bf16 v[32:35],a[72:75],v[100:103],v[32:35]
ds_read_b128 v[124:127],v5 offset:7168
v_mfma_f32_16x16x32_bf16 v[36:39],a[76:79],v[100:103],v[36:39]
s_waitcnt lgkmcnt(5)
v_mfma_f32_16x16x32_bf16 v[32:35],a[80:83],v[104:107],v[32:35]
ds_read_b128 v[64:67],v6 offset:0
v_mfma_f32_16x16x32_bf16 v[36:39],a[84:87],v[104:107],v[36:39]
s_waitcnt lgkmcnt(5)
v_mfma_f32_16x16x32_bf16 v[32:35],a[88:91],v[108:111],v[32:35]
ds_read_b128 v[68:71],v6 offset:1024
v_mfma_f32_16x16x32_bf16 v[36:39],a[92:95],v[108:111],v[36:39]
s_waitcnt lgkmcnt(5)
v_mfma_f32_16x16x32_bf16 v[32:35],a[96:99],v[112:115],v[32:35]
ds_read_b128 v[72:75],v6 offset:2048
v_mfma_f32_16x16x32_bf16 v[36:39],a[100:103],v[112:115],v[36:39]
s_waitcnt lgkmcnt(5)
v_mfma_f32_16x16x32_bf16 v[32:35],a[104:107],v[116:119],v[32:35]
ds_read_b128 v[76:79],v6 offset:3072
v_mfma_f32_16x16x32_bf16 v[36:39],a[108:111],v[116:119],v[36:39]
s_waitcnt lgkmcnt(5)
v_mfma_f32_16x16x32_bf16 v[32:35],a[112:115],v[120:123],v[32:35]
ds_read_b128 v[80:83],v6 offset:4096
v_mfma_f32_16x16x32_bf16 v[36:39],a[116:119],v[120:123],v[36:39]
s_waitcnt lgkmcnt(5)
v_mfma_f32_16x16x32_bf16 v[32:35],a[120:123],v[124:127],v[32:35]
ds_read_b128 v[84:87],v6 offset:5120
v_mfma_f32_16x16x32_bf16 v[36:39],a[124:127],v[124:127],v[36:39]
s_waitcnt lgkmcnt(5)
v_mfma_f32_16x16x32_bf16 v[32:35],a[128:131],v[64:67],v[32:35]
ds_read_b128 v[88:91],v6 offset:6144
v_mfma_f32_16x16x32_bf16 v[36:39],a[132:135],v[64:67],v[36:39]
s_waitcnt lgkmcnt(5)
v_mfma_f32_16x16x32_bf16 v[32:35],a[136:139],v[68:71],v[32:35]
ds_read_b128 v[92:95],v6 offset:7168
v_mfma_f32_16x16x32_bf16 v[36:39],a[140:143],v[68:71],v[36:39]
s_waitcnt lgkmcnt(5)
v_mfma_f32_16x16x32_bf16 v[32:35],a[144:147],v[72:75],v[32:35]
ds_read_b128 v[96:99],v7 offset:0
v_mfma_f32_16x16x32_bf16 v[36:39],a[148:151],v[72:75],v[36:39]
s_waitcnt lgkmcnt(5)
v_mfma_f32_16x16x32_bf16 v[32:35],a[152:155],v[76:79],v[32:35]
ds_read_b128 v[100:103],v7 offset:1024
v_mfma_f32_16x16x32_bf16 v[36:39],a[156:159],v[76:79],v[36:39]
s_waitcnt lgkmcnt(5)
v_mfma_f32_16x16x32_bf16 v[32:35],a[160:163],v[80:83],v[32:35]
ds_read_b128 v[104:107],v7 offset:2048
buffer_load_dword v16,v2,s[20:23],s68 offen sc1
v_mfma_f32_16x16x32_bf16 v[36:39],a[164:167],v[80:83],v[36:39]
s_waitcnt lgkmcnt(5)
v_mfma_f32_16x16x32_bf16 v[32:35],a[168:171],v[84:87],v[32:35]
ds_read_b128 v[108:111],v7 offset:3072
v_mfma_f32_16x16x32_bf16 v[36:39],a[172:175],v[84:87],v[36:39]
s_waitcnt lgkmcnt(5)
v_mfma_f32_16x16x32_bf16 v[32:35],a[176:179],v[88:91],v[32:35]
ds_read_b128 v[112:115],v7 offset:4096
v_mfma_f32_16x16x32_bf16 v[36:39],a[180:183],v[88:91],v[36:39]
s_waitcnt lgkmcnt(5)
v_mfma_f32_16x16x32_bf16 v[32:35],a[184:187],v[92:95],v[32:35]
ds_read_b128 v[116:119],v7 offset:5120
v_mfma_f32_16x16x32_bf16 v[36:39],a[188:191],v[92:95],v[36:39]
s_waitcnt lgkmcnt(5)
v_mfma_f32_16x16x32_bf16 v[32:35],a[192:195],v[96:99],v[32:35]
ds_read_b128 v[120:123],v7 offset:6144
v_mfma_f32_16x16x32_bf16 v[36:39],a[196:199],v[96:99],v[36:39]
s_waitcnt lgkmcnt(5)
v_mfma_f32_16x16x32_bf16 v[32:35],a[200:203],v[100:103],v[32:35]
ds_read_b128 v[124:127],v7 offset:7168
v_mfma_f32_16x16x32_bf16 v[36:39],a[204:207],v[100:103],v[36:39]
s_waitcnt lgkmcnt(5)
s_add_u32 s55,s55,32768
s_and_b32 s55,s55,0x1ffff
v_mfma_f32_16x16x32_bf16 v[32:35],a[208:211],v[104:107],v[32:35]
v_add_u32 v4,s55,v8
v_add_u32 v5,s55,v9
v_mfma_f32_16x16x32_bf16 v[36:39],a[212:215],v[104:107],v[36:39]
s_waitcnt lgkmcnt(4)
v_add_u32 v6,s55,v10
v_add_u32 v7,s55,v11
v_mfma_f32_16x16x32_bf16 v[32:35],a[216:219],v[108:111],v[32:35]
v_mfma_f32_16x16x32_bf16 v[36:39],a[220:223],v[108:111],v[36:39]
s_waitcnt lgkmcnt(3)
v_mfma_f32_16x16x32_bf16 v[32:35],a[224:227],v[112:115],v[32:35]
v_mfma_f32_16x16x32_bf16 v[36:39],a[228:231],v[112:115],v[36:39]
s_waitcnt lgkmcnt(2)
v_mfma_f32_16x16x32_bf16 v[32:35],a[232:235],v[116:119],v[32:35]
v_mfma_f32_16x16x32_bf16 v[36:39],a[236:239],v[116:119],v[36:39]
s_waitcnt lgkmcnt(1)
v_mfma_f32_16x16x32_bf16 v[32:35],a[240:243],v[120:123],v[32:35]
v_mfma_f32_16x16x32_bf16 v[36:39],a[244:247],v[120:123],v[36:39]
s_waitcnt lgkmcnt(0)
v_mfma_f32_16x16x32_bf16 v[40:43],a[248:251],v[124:127],v[32:35]
v_mfma_f32_16x16x32_bf16 v[44:47],a[252:255],v[124:127],v[36:39]
s_waitcnt vmcnt(0)
v_cmp_gt_u32 vcc,s71,v16
s_add_u32 s60,s60,1
s_branch endN_92
BN_84:
s_waitcnt vmcnt(9)
ds_read_b128 v[64:67],v4 offset:0
s_waitcnt vmcnt(8)
ds_read_b128 v[68:71],v4 offset:1024
s_waitcnt vmcnt(7)
ds_read_b128 v[72:75],v4 offset:2048
s_waitcnt vmcnt(6)
ds_read_b128 v[76:79],v4 offset:3072
s_waitcnt lgkmcnt(3)
v_mfma_f32_16x16x32_bf16 v[32:35],a[0:3],v[64:67],0
s_add_u32 s71,s60,2
s_add_u32 s53,s60,3
v_mfma_f32_16x16x32_bf16 v[36:39],a[4:7],v[64:67],0
s_waitcnt lgkmcnt(2)
s_waitcnt vmcnt(5)
ds_read_b128 v[80:83],v4 offset:4096
v_mfma_f32_16x16x32_bf16 v[32:35],a[8:11],v[68:71],v[32:35]
v_mfma_f32_16x16x32_bf16 v[36:39],a[12:15],v[68:71],v[36:39]
s_waitcnt lgkmcnt(2)
s_waitcnt vmcnt(4)
ds_read_b128 v[84:87],v4 offset:5120
v_mfma_f32_16x16x32_bf16 v[32:35],a[16:19],v[72:75],v[32:35]
v_mfma_f32_16x16x32_bf16 v[36:39],a[20:23],v[72:75],v[36:39]
s_waitcnt lgkmcnt(2)
s_waitcnt vmcnt(3)
ds_read_b128 v[88:91],v4 offset:6144
v_mfma_f32_16x16x32_bf16 v[32:35],a[24:27],v[76:79],v[32:35]
v_mfma_f32_16x16x32_bf16 v[36:39],a[28:31],v[76:79],v[36:39]
s_waitcnt lgkmcnt(2)
s_waitcnt vmcnt(2)
ds_read_b128 v[92:95],v4 offset:7168
v_mfma_f32_16x16x32_bf16 v[32:35],a[32:35],v[80:83],v[32:35]
v_mfma_f32_16x16x32_bf16 v[36:39],a[36:39],v[80:83],v[36:39]
s_waitcnt lgkmcnt(2)
s_barrier
ds_read_b128 v[96:99],v5 offset:0
v_mfma_f32_16x16x32_bf16 v[32:35],a[40:43],v[84:87],v[32:35]
ds_read_b128 v[100:103],v5 offset:1024
v_mfma_f32_16x16x32_bf16 v[36:39],a[44:47],v[84:87],v[36:39]
s_waitcnt lgkmcnt(3)
ds_read_b128 v[104:107],v5 offset:2048
v_mfma_f32_16x16x32_bf16 v[32:35],a[48:51],v[88:91],v[32:35]
ds_read_b128 v[108:111],v5 offset:3072
v_mfma_f32_16x16x32_bf16 v[36:39],a[52:55],v[88:91],v[36:39]
s_waitcnt lgkmcnt(4)
ds_read_b128 v[112:115],v5 offset:4096
v_mfma_f32_16x16x32_bf16 v[32:35],a[56:59],v[92:95],v[32:35]
ds_read_b128 v[116:119],v5 offset:5120
v_mfma_f32_16x16x32_bf16 v[36:39],a[60:63],v[92:95],v[36:39]
s_waitcnt lgkmcnt(5)
v_mfma_f32_16x16x32_bf16 v[32:35],a[64:67],v[96:99],v[32:35]
ds_read_b128 v[120:123],v5 offset:6144
v_mfma_f32_16x16x32_bf16 v[36:39],a[68:71],v[96:99],v[36:39]
s_waitcnt lgkmcnt(5)
v_mfma_f32_16x16x32_bf16 v[32:35],a[72:75],v[100:103],v[32:35]
ds_read_b128 v[124:127],v5 offset:7168
v_mfma_f32_16x16x32_bf16 v[36:39],a[76:79],v[100:103],v[36:39]
s_waitcnt lgkmcnt(5)
v_mfma_f32_16x16x32_bf16 v[32:35],a[80:83],v[104:107],v[32:35]
ds_read_b128 v[64:67],v6 offset:0
v_mfma_f32_16x16x32_bf16 v[36:39],a[84:87],v[104:107],v[36:39]
s_waitcnt lgkmcnt(5)
v_mfma_f32_16x16x32_bf16 v[32:35],a[88:91],v[108:111],v[32:35]
ds_read_b128 v[68:71],v6 offset:1024
v_mfma_f32_16x16x32_bf16 v[36:39],a[92:95],v[108:111],v[36:39]
s_waitcnt lgkmcnt(5)
v_mfma_f32_16x16x32_bf16 v[32:35],a[96:99],v[112:115],v[32:35]
ds_read_b128 v[72:75],v6 offset:2048
v_mfma_f32_16x16x32_bf16 v[36:39],a[100:103],v[112:115],v[36:39]
s_waitcnt lgkmcnt(5)
v_mfma_f32_16x16x32_bf16 v[32:35],a[104:107],v[116:119],v[32:35]
ds_read_b128 v[76:79],v6 offset:3072
v_mfma_f32_16x16x32_bf16 v[36:39],a[108:111],v[116:119],v[36:39]
s_waitcnt lgkmcnt(5)
v_mfma_f32_16x16x32_bf16 v[32:35],a[112:115],v[120:123],v[32:35]
ds_read_b128 v[80:83],v6 offset:4096
v_mfma_f32_16x16x32_bf16 v[36:39],a[116:119],v[120:123],v[36:39]
s_waitcnt lgkmcnt(5)
v_mfma_f32_16x16x32_bf16 v[32:35],a[120:123],v[124:127],v[32:35]
ds_read_b128 v[84:87],v6 offset:5120
v_mfma_f32_16x16x32_bf16 v[36:39],a[124:127],v[124:127],v[36:39]
s_waitcnt lgkmcnt(5)
v_mfma_f32_16x16x32_bf16 v[32:35],a[128:131],v[64:67],v[32:35]
ds_read_b128 v[88:91],v6 offset:6144
v_mfma_f32_16x16x32_bf16 v[36:39],a[132:135],v[64:67],v[36:39]
s_waitcnt lgkmcnt(5)
v_mfma_f32_16x16x32_bf16 v[32:35],a[136:139],v[68:71],v[32:35]
ds_read_b128 v[92:95],v6 offset:7168
v_mfma_f32_16x16x32_bf16 v[36:39],a[140:143],v[68:71],v[36:39]
s_waitcnt lgkmcnt(5)
v_mfma_f32_16x16x32_bf16 v[32:35],a[144:147],v[72:75],v[32:35]
ds_read_b128 v[96:99],v7 offset:0
v_mfma_f32_16x16x32_bf16 v[36:39],a[148:151],v[72:75],v[36:39]
s_waitcnt lgkmcnt(5)
v_mfma_f32_16x16x32_bf16 v[32:35],a[152:155],v[76:79],v[32:35]
ds_read_b128 v[100:103],v7 offset:1024
v_mfma_f32_16x16x32_bf16 v[36:39],a[156:159],v[76:79],v[36:39]
s_waitcnt lgkmcnt(5)
v_mfma_f32_16x16x32_bf16 v[32:35],a[160:163],v[80:83],v[32:35]
ds_read_b128 v[104:107],v7 offset:2048
buffer_load_dword v16,v2,s[20:23],s68 offen sc1
v_mfma_f32_16x16x32_bf16 v[36:39],a[164:167],v[80:83],v[36:39]
s_waitcnt lgkmcnt(5)
v_mfma_f32_16x16x32_bf16 v[32:35],a[168:171],v[84:87],v[32:35]
ds_read_b128 v[108:111],v7 offset:3072
v_mfma_f32_16x16x32_bf16 v[36:39],a[172:175],v[84:87],v[36:39]
s_waitcnt lgkmcnt(5)
v_mfma_f32_16x16x32_bf16 v[32:35],a[176:179],v[88:91],v[32:35]
ds_read_b128 v[112:115],v7 offset:4096
v_mfma_f32_16x16x32_bf16 v[36:39],a[180:183],v[88:91],v[36:39]
s_waitcnt lgkmcnt(5)
v_mfma_f32_16x16x32_bf16 v[32:35],a[184:187],v[92:95],v[32:35]
ds_read_b128 v[116:119],v7 offset:5120
v_mfma_f32_16x16x32_bf16 v[36:39],a[188:191],v[92:95],v[36:39]
s_waitcnt lgkmcnt(5)
v_mfma_f32_16x16x32_bf16 v[32:35],a[192:195],v[96:99],v[32:35]
ds_read_b128 v[120:123],v7 offset:6144
v_mfma_f32_16x16x32_bf16 v[36:39],a[196:199],v[96:99],v[36:39]
s_waitcnt lgkmcnt(5)
v_mfma_f32_16x16x32_bf16 v[32:35],a[200:203],v[100:103],v[32:35]
ds_read_b128 v[124:127],v7 offset:7168
v_mfma_f32_16x16x32_bf16 v[36:39],a[204:207],v[100:103],v[36:39]
s_waitcnt lgkmcnt(5)
s_add_u32 s55,s55,32768
s_and_b32 s55,s55,0x1ffff
v_mfma_f32_16x16x32_bf16 v[32:35],a[208:211],v[104:107],v[32:35]
v_add_u32 v4,s55,v8
v_add_u32 v5,s55,v9
v_mfma_f32_16x16x32_bf16 v[36:39],a[212:215],v[104:107],v[36:39]
s_waitcnt lgkmcnt(4)
v_add_u32 v6,s55,v10
v_add_u32 v7,s55,v11
v_mfma_f32_16x16x32_bf16 v[32:35],a[216:219],v[108:111],v[32:35]
v_mfma_f32_16x16x32_bf16 v[36:39],a[220:223],v[108:111],v[36:39]
s_waitcnt lgkmcnt(3)
v_mfma_f32_16x16x32_bf16 v[32:35],a[224:227],v[112:115],v[32:35]
v_mfma_f32_16x16x32_bf16 v[36:39],a[228:231],v[112:115],v[36:39]
s_waitcnt lgkmcnt(2)
v_mfma_f32_16x16x32_bf16 v[32:35],a[232:235],v[116:119],v[32:35]
v_mfma_f32_16x16x32_bf16 v[36:39],a[236:239],v[116:119],v[36:39]
s_waitcnt lgkmcnt(1)
v_mfma_f32_16x16x32_bf16 v[32:35],a[240:243],v[120:123],v[32:35]
v_mfma_f32_16x16x32_bf16 v[36:39],a[244:247],v[120:123],v[36:39]
s_waitcnt lgkmcnt(0)
v_mfma_f32_16x16x32_bf16 v[40:43],a[248:251],v[124:127],v[32:35]
v_mfma_f32_16x16x32_bf16 v[44:47],a[252:255],v[124:127],v[36:39]
s_waitcnt vmcnt(0)
v_cmp_gt_u32 vcc,s71,v16
s_add_u32 s60,s60,1
endN_92:
s_cbranch_vccnz nb_87
s_mov_b32 m0,s70
s_nop 0
buffer_load_dwordx4 v3,s[20:23],s61 offen offset:0 lds
buffer_load_dwordx4 v3,s[20:23],s61 offen offset:1024 lds
buffer_load_dwordx4 v3,s[20:23],s61 offen offset:2048 lds
buffer_load_dwordx4 v3,s[20:23],s61 offen offset:3072 lds
s_add_u32 m0,s70,4096
s_nop 0
buffer_load_dwordx4 v3,s[20:23],s62 offen offset:0 lds
buffer_load_dwordx4 v3,s[20:23],s62 offen offset:1024 lds
buffer_load_dwordx4 v3,s[20:23],s62 offen offset:2048 lds
buffer_load_dwordx4 v3,s[20:23],s62 offen offset:3072 lds
s_add_u32 s61,s61,131072
s_add_u32 s62,s62,131072
s_add_u32 s70,s70,32768
s_and_b32 s70,s70,0x1ffff
s_add_u32 s64,s74,s75
s_cmp_eq_u32 s56,1
s_cbranch_scc1 b1_95
buffer_store_dwordx4 v[40:43],v0,s[20:23],s64 offen offset:0
buffer_store_dwordx4 v[44:47],v0,s[20:23],s64 offen offset:1024
b2_96:
s_add_u32 s75,s75,6144
s_cmp_eq_u32 s75,24576
s_cselect_b32 s75,0,s75
s_branch dec_86
nb_87:
buffer_load_dword v16,v2,s[20:23],s68 offen sc1
s_nop 3
s_add_u32 s64,s74,s75
s_cmp_eq_u32 s56,1
s_cbranch_scc1 b1_97
buffer_store_dwordx4 v[40:43],v0,s[20:23],s64 offen offset:0
buffer_store_dwordx4 v[44:47],v0,s[20:23],s64 offen offset:1024
b2_98:
s_add_u32 s75,s75,6144
s_cmp_eq_u32 s75,24576
s_cselect_b32 s75,0,s75
s_waitcnt vmcnt(2)
v_cmp_gt_u32 vcc,s71,v16
s_cbranch_vccz lag_85
s_cmp_ge_u32 s60,128
s_cbranch_scc1 done_71
plp_99:
buffer_load_dword v16,v2,s[20:23],s68 offen sc1
s_waitcnt vmcnt(0)
v_cmp_gt_u32 vcc,s71,v16
s_cbranch_vccz pok_100
s_sleep 4
s_sub_u32 s90,s90,1
s_cmp_gt_i32 s90,0
s_cbranch_scc1 plp_99
pok_100:
s_branch lag_85
lfin_78:
s_add_u32 s71,s60,1
s_add_u32 s53,s60,2
plp_120:
buffer_load_dword v16,v2,s[20:23],s68 offen sc1
s_waitcnt vmcnt(0)
v_cmp_gt_u32 vcc,s71,v16
s_cbranch_vccz pok_121
s_sleep 4
s_sub_u32 s90,s90,1
s_cmp_gt_i32 s90,0
s_cbranch_scc1 plp_120
pok_121:
lag_117:
s_mov_b32 m0,s70
s_nop 0
buffer_load_dwordx4 v3,s[20:23],s61 offen offset:0 lds
buffer_load_dwordx4 v3,s[20:23],s61 offen offset:1024 lds
buffer_load_dwordx4 v3,s[20:23],s61 offen offset:2048 lds
buffer_load_dwordx4 v3,s[20:23],s61 offen offset:3072 lds
s_add_u32 m0,s70,4096
s_nop 0
buffer_load_dwordx4 v3,s[20:23],s62 offen offset:0 lds
buffer_load_dwordx4 v3,s[20:23],s62 offen offset:1024 lds
buffer_load_dwordx4 v3,s[20:23],s62 offen offset:2048 lds
buffer_load_dwordx4 v3,s[20:23],s62 offen offset:3072 lds
s_add_u32 s61,s61,131072
s_add_u32 s62,s62,131072
s_add_u32 s70,s70,32768
s_and_b32 s70,s70,0x1ffff
dec_118:
v_cmp_gt_u32 vcc,s53,v16
s_cbranch_vccnz BN_116
BR_115:
s_waitcnt vmcnt(7)
ds_read_b128 v[64:67],v4 offset:0
s_waitcnt vmcnt(6)
ds_read_b128 v[68:71],v4 offset:1024
s_waitcnt vmcnt(5)
ds_read_b128 v[72:75],v4 offset:2048
s_waitcnt vmcnt(4)
ds_read_b128 v[76:79],v4 offset:3072
s_waitcnt lgkmcnt(3)
v_mfma_f32_16x16x32_bf16 v[32:35],a[0:3],v[64:67],0
s_add_u32 s71,s60,2
s_add_u32 s53,s60,3
v_mfma_f32_16x16x32_bf16 v[36:39],a[4:7],v[64:67],0
s_waitcnt lgkmcnt(2)
s_waitcnt vmcnt(3)
ds_read_b128 v[80:83],v4 offset:4096
v_mfma_f32_16x16x32_bf16 v[32:35],a[8:11],v[68:71],v[32:35]
v_mfma_f32_16x16x32_bf16 v[36:39],a[12:15],v[68:71],v[36:39]
s_waitcnt lgkmcnt(2)
s_waitcnt vmcnt(2)
s_mov_b32 m0,s70
ds_read_b128 v[84:87],v4 offset:5120
v_mfma_f32_16x16x32_bf16 v[32:35],a[16:19],v[72:75],v[32:35]
buffer_load_dwordx4 v3,s[20:23],s61 offen offset:0 lds
v_mfma_f32_16x16x32_bf16 v[36:39],a[20:23],v[72:75],v[36:39]
s_waitcnt lgkmcnt(2)
s_waitcnt vmcnt(2)
ds_read_b128 v[88:91],v4 offset:6144
v_mfma_f32_16x16x32_bf16 v[32:35],a[24:27],v[76:79],v[32:35]
buffer_load_dwordx4 v3,s[20:23],s61 offen offset:1024 lds
v_mfma_f32_16x16x32_bf16 v[36:39],a[28:31],v[76:79],v[36:39]
s_waitcnt lgkmcnt(2)
s_waitcnt vmcnt(2)
ds_read_b128 v[92:95],v4 offset:7168
v_mfma_f32_16x16x32_bf16 v[32:35],a[32:35],v[80:83],v[32:35]
v_mfma_f32_16x16x32_bf16 v[36:39],a[36:39],v[80:83],v[36:39]
s_waitcnt lgkmcnt(2)
s_barrier
ds_read_b128 v[96:99],v5 offset:0
v_mfma_f32_16x16x32_bf16 v[32:35],a[40:43],v[84:87],v[32:35]
ds_read_b128 v[100:103],v5 offset:1024
buffer_load_dwordx4 v3,s[20:23],s61 offen offset:2048 lds
v_mfma_f32_16x16x32_bf16 v[36:39],a[44:47],v[84:87],v[36:39]
s_waitcnt lgkmcnt(3)
ds_read_b128 v[104:107],v5 offset:2048
v_mfma_f32_16x16x32_bf16 v[32:35],a[48:51],v[88:91],v[32:35]
ds_read_b128 v[108:111],v5 offset:3072
v_mfma_f32_16x16x32_bf16 v[36:39],a[52:55],v[88:91],v[36:39]
s_waitcnt lgkmcnt(4)
ds_read_b128 v[112:115],v5 offset:4096
buffer_load_dwordx4 v3,s[20:23],s61 offen offset:3072 lds
v_mfma_f32_16x16x32_bf16 v[32:35],a[56:59],v[92:95],v[32:35]
s_cmp_eq_u32 s77,0
s_cselect_b32 s57,2.0,0
ds_read_b128 v[116:119],v5 offset:5120
v_mfma_f32_16x16x32_bf16 v[36:39],a[60:63],v[92:95],v[36:39]
s_waitcnt lgkmcnt(5)
s_add_u32 m0,s70,4096
v_or_b32 v21,s57,v0
v_mfma_f32_16x16x32_bf16 v[32:35],a[64:67],v[96:99],v[32:35]
ds_read_b128 v[120:123],v5 offset:6144
buffer_load_dwordx4 v3,s[20:23],s62 offen offset:0 lds
v_mfma_f32_16x16x32_bf16 v[36:39],a[68:71],v[96:99],v[36:39]
s_waitcnt lgkmcnt(5)
v_lshlrev_b32 v168,16,v160
v_and_b32 v169,s73,v160
v_mfma_f32_16x16x32_bf16 v[32:35],a[72:75],v[100:103],v[32:35]
ds_read_b128 v[124:127],v5 offset:7168
v_lshlrev_b32 v170,16,v161
v_mfma_f32_16x16x32_bf16 v[36:39],a[76:79],v[100:103],v[36:39]
s_waitcnt lgkmcnt(5)
buffer_load_dwordx4 v3,s[20:23],s62 offen offset:1024 lds
v_and_b32 v171,s73,v161
v_mfma_f32_16x16x32_bf16 v[32:35],a[80:83],v[104:107],v[32:35]
ds_read_b128 v[64:67],v6 offset:0
v_lshlrev_b32 v172,16,v162
v_mfma_f32_16x16x32_bf16 v[36:39],a[84:87],v[104:107],v[36:39]
s_waitcnt lgkmcnt(5)
v_and_b32 v173,s73,v162
v_lshlrev_b32 v174,16,v163
v_mfma_f32_16x16x32_bf16 v[32:35],a[88:91],v[108:111],v[32:35]
ds_read_b128 v[68:71],v6 offset:1024
v_and_b32 v175,s73,v163
v_mfma_f32_16x16x32_bf16 v[36:39],a[92:95],v[108:111],v[36:39]
s_waitcnt lgkmcnt(5)
buffer_load_dwordx4 v3,s[20:23],s62 offen offset:2048 lds
v_fma_f32 v168,v212,v152,v168
v_mfma_f32_16x16x32_bf16 v[32:35],a[96:99],v[112:115],v[32:35]
ds_read_b128 v[72:75],v6 offset:2048
buffer_load_dword v16,v2,s[20:23],s68 offen sc1
v_mfma_f32_16x16x32_bf16 v[36:39],a[100:103],v[112:115],v[36:39]
s_waitcnt lgkmcnt(5)
v_fma_f32 v169,v213,v153,v169
v_fma_f32 v170,v214,v154,v170
v_mfma_f32_16x16x32_bf16 v[32:35],a[104:107],v[116:119],v[32:35]
ds_read_b128 v[76:79],v6 offset:3072
buffer_load_dwordx4 v3,s[20:23],s62 offen offset:3072 lds
v_mfma_f32_16x16x32_bf16 v[36:39],a[108:111],v[116:119],v[36:39]
s_waitcnt lgkmcnt(5)
v_fma_f32 v171,v215,v155,v171
v_fma_f32 v172,v216,v156,v172
v_mfma_f32_16x16x32_bf16 v[32:35],a[112:115],v[120:123],v[32:35]
s_add_u32 s84,s74,s75
s_add_u32 s85,s84,4096
ds_read_b128 v[80:83],v6 offset:4096
v_mfma_f32_16x16x32_bf16 v[36:39],a[116:119],v[120:123],v[36:39]
s_waitcnt lgkmcnt(5)
buffer_load_dwordx4 v[128:131],v0,s[20:23],s84 offen offset:0 sc1
v_fma_f32 v173,v217,v157,v173
v_mfma_f32_16x16x32_bf16 v[32:35],a[120:123],v[124:127],v[32:35]
ds_read_b128 v[84:87],v6 offset:5120
v_fma_f32 v174,v218,v158,v174
v_mfma_f32_16x16x32_bf16 v[36:39],a[124:127],v[124:127],v[36:39]
s_waitcnt lgkmcnt(5)
buffer_load_dwordx4 v[132:135],v0,s[20:23],s84 offen offset:1024 sc1
v_fma_f32 v175,v219,v159,v175
v_mfma_f32_16x16x32_bf16 v[32:35],a[128:131],v[64:67],v[32:35]
ds_read_b128 v[88:91],v6 offset:6144
buffer_load_dwordx4 v[160:163],v18,s[24:27],s82 offen
v_mfma_f32_16x16x32_bf16 v[36:39],a[132:135],v[64:67],v[36:39]
s_waitcnt lgkmcnt(5)
s_add_u32 s82,s82,32768
buffer_load_dwordx4 v[136:139],v0,s[20:23],s84 offen offset:2048 sc1
v_mfma_f32_16x16x32_bf16 v[32:35],a[136:139],v[68:71],v[32:35]
ds_read_b128 v[92:95],v6 offset:7168
v_mfma_f32_16x16x32_bf16 v[36:39],a[140:143],v[68:71],v[36:39]
s_waitcnt lgkmcnt(5)
buffer_load_dwordx4 v[140:143],v0,s[20:23],s84 offen offset:3072 sc1
v_mfma_f32_16x16x32_bf16 v[32:35],a[144:147],v[72:75],v[32:35]
ds_read_b128 v[96:99],v7 offset:0
v_mfma_f32_16x16x32_bf16 v[36:39],a[148:151],v[72:75],v[36:39]
s_waitcnt lgkmcnt(5)
buffer_load_dwordx4 v[144:147],v0,s[20:23],s85 offen offset:0 sc1
v_mfma_f32_16x16x32_bf16 v[32:35],a[152:155],v[76:79],v[32:35]
ds_read_b128 v[100:103],v7 offset:1024
v_mfma_f32_16x16x32_bf16 v[36:39],a[156:159],v[76:79],v[36:39]
s_waitcnt lgkmcnt(5)
buffer_load_dwordx4 v[148:151],v0,s[20:23],s85 offen offset:1024 sc1
v_mfma_f32_16x16x32_bf16 v[32:35],a[160:163],v[80:83],v[32:35]
ds_read_b128 v[104:107],v7 offset:2048
v_mfma_f32_16x16x32_bf16 v[36:39],a[164:167],v[80:83],v[36:39]
s_waitcnt lgkmcnt(5)
v_mfma_f32_16x16x32_bf16 v[32:35],a[168:171],v[84:87],v[32:35]
ds_read_b128 v[108:111],v7 offset:3072
v_mfma_f32_16x16x32_bf16 v[36:39],a[172:175],v[84:87],v[36:39]
s_waitcnt lgkmcnt(5)
v_mfma_f32_16x16x32_bf16 v[32:35],a[176:179],v[88:91],v[32:35]
ds_read_b128 v[112:115],v7 offset:4096
v_mfma_f32_16x16x32_bf16 v[36:39],a[180:183],v[88:91],v[36:39]
s_waitcnt lgkmcnt(5)
v_mfma_f32_16x16x32_bf16 v[32:35],a[184:187],v[92:95],v[32:35]
ds_read_b128 v[116:119],v7 offset:5120
v_mfma_f32_16x16x32_bf16 v[36:39],a[188:191],v[92:95],v[36:39]
s_waitcnt lgkmcnt(5)
v_mfma_f32_16x16x32_bf16 v[32:35],a[192:195],v[96:99],v[32:35]
ds_read_b128 v[120:123],v7 offset:6144
v_mfma_f32_16x16x32_bf16 v[36:39],a[196:199],v[96:99],v[36:39]
s_waitcnt lgkmcnt(5)
v_mfma_f32_16x16x32_bf16 v[32:35],a[200:203],v[100:103],v[32:35]
ds_read_b128 v[124:127],v7 offset:7168
v_mfma_f32_16x16x32_bf16 v[36:39],a[204:207],v[100:103],v[36:39]
s_waitcnt lgkmcnt(5)
s_add_u32 s61,s61,131072
s_add_u32 s62,s62,131072
v_mfma_f32_16x16x32_bf16 v[32:35],a[208:211],v[104:107],v[32:35]
s_add_u32 s70,s70,32768
s_and_b32 s70,s70,0x1ffff
s_add_u32 s55,s55,32768
v_mfma_f32_16x16x32_bf16 v[36:39],a[212:215],v[104:107],v[36:39]
s_waitcnt lgkmcnt(4)
s_and_b32 s55,s55,0x1ffff
v_add_u32 v4,s55,v8
v_mfma_f32_16x16x32_bf16 v[32:35],a[216:219],v[108:111],v[32:35]
v_add_u32 v5,s55,v9
v_add_u32 v6,s55,v10
v_mfma_f32_16x16x32_bf16 v[36:39],a[220:223],v[108:111],v[36:39]
s_waitcnt lgkmcnt(3)
v_add_u32 v7,s55,v11
v_mfma_f32_16x16x32_bf16 v[32:35],a[224:227],v[112:115],v[32:35]
s_waitcnt vmcnt(15)
ds_read_b128 v[64:67],v4 offset:0
v_mfma_f32_16x16x32_bf16 v[36:39],a[228:231],v[112:115],v[36:39]
s_waitcnt lgkmcnt(3)
s_waitcnt vmcnt(14)
ds_read_b128 v[68:71],v4 offset:1024
v_mfma_f32_16x16x32_bf16 v[32:35],a[232:235],v[116:119],v[32:35]
s_waitcnt vmcnt(0)
v_mov_b32 v17,s63
buffer_store_dword v17,v26,s[20:23],s69 offen sc1
s_cmp_eq_u32 s77,0
s_cbranch_scc1 go_130
ck_128:
v_max3_u32 v184,v128,v129,v130
v_max3_u32 v185,v140,v141,v142
v_max3_u32 v184,v184,v131,v132
v_max3_u32 v185,v185,v143,v144
v_max3_u32 v184,v184,v133,v134
v_max3_u32 v185,v185,v145,v146
v_max3_u32 v184,v184,v135,v136
v_max3_u32 v185,v185,v147,v148
v_max3_u32 v184,v184,v137,v138
v_max3_u32 v185,v185,v149,v150
v_max3_u32 v184,v184,v139,v151
v_max_u32 v184,v184,v185
v_cmp_eq_u32 vcc,-1,v184
s_cbranch_vccnz rt_129
go_130:
v_mfma_f32_16x16x32_bf16 v[36:39],a[236:239],v[116:119],v[36:39]
s_waitcnt lgkmcnt(3)
ds_read_b128 v[72:75],v4 offset:2048
v_add_f32 v128,v128,v136
v_mfma_f32_16x16x32_bf16 v[32:35],a[240:243],v[120:123],v[32:35]
v_add_f32 v129,v129,v137
v_add_f32 v130,v130,v138
v_add_f32 v131,v131,v139
v_mfma_f32_16x16x32_bf16 v[36:39],a[244:247],v[120:123],v[36:39]
s_waitcnt lgkmcnt(3)
v_add_f32 v132,v132,v140
v_add_f32 v133,v133,v141
v_add_f32 v134,v134,v142
v_mfma_f32_16x16x32_bf16 v[40:43],a[248:251],v[124:127],v[32:35]
v_add_f32 v135,v135,v143
v_add_f32 v128,v128,v144
v_add_f32 v129,v129,v145
v_mfma_f32_16x16x32_bf16 v[44:47],a[252:255],v[124:127],v[36:39]
v_add_f32 v130,v130,v146
v_add_f32 v131,v131,v147
v_add_f32 v132,v132,v148
v_add_f32 v133,v133,v149
v_add_f32 v134,v134,v150
v_add_f32 v135,v135,v151
v_fma_f32 v168,v128,v152,v168
v_fma_f32 v169,v129,v153,v169
v_fma_f32 v170,v130,v154,v170
v_fma_f32 v171,v131,v155,v171
v_fma_f32 v172,v132,v156,v172
v_fma_f32 v173,v133,v157,v173
v_fma_f32 v174,v134,v158,v174
v_fma_f32 v175,v135,v159,v175
v_cvt_pk_bf16_f32 v176,v168,v169
v_cvt_pk_bf16_f32 v177,v170,v171
v_cvt_pk_bf16_f32 v178,v172,v173
v_cvt_pk_bf16_f32 v179,v174,v175
s_add_u32 s64,s66,201326592
buffer_store_dwordx4 v[176:179],v21,s[20:23],s64 offen sc1
s_cmp_eq_u32 s56,1
s_cbranch_scc1 b1_122
buffer_store_dwordx4 v[204:207],v21,s[20:23],s84 offen offset:0
buffer_store_dwordx4 v[204:207],v21,s[20:23],s84 offen offset:1024
b2_123:
s_cmp_eq_u32 s56,1
s_cbranch_scc1 b1_124
buffer_store_dwordx4 v[204:207],v21,s[20:23],s84 offen offset:2048
buffer_store_dwordx4 v[204:207],v21,s[20:23],s84 offen offset:3072
b2_125:
s_cmp_eq_u32 s56,1
s_cbranch_scc1 b1_126
buffer_store_dwordx4 v[204:207],v21,s[20:23],s85 offen offset:0
buffer_store_dwordx4 v[204:207],v21,s[20:23],s85 offen offset:1024
b2_127:
s_mul_i32 s64,s77,32768
s_add_u32 s66,s66,s64
s_mul_i32 s64,s77,6144
s_add_u32 s75,s75,s64
s_cmp_eq_u32 s75,24576
s_cselect_b32 s75,0,s75
s_add_u32 s63,s63,s77
s_mov_b32 s77,0
v_cmp_gt_u32 vcc,s53,v16
s_add_u32 s60,s60,1
s_cbranch_vccnz WN_114
.p2align 6
WR_113:
s_waitcnt lgkmcnt(2)
v_mfma_f32_16x16x32_bf16 v[32:35],a[0:3],v[64:67],0
s_waitcnt vmcnt(20)
s_add_u32 s71,s60,2
ds_read_b128 v[76:79],v4 offset:3072
v_mfma_f32_16x16x32_bf16 v[36:39],a[4:7],v[64:67],0
s_waitcnt lgkmcnt(2)
s_add_u32 s53,s60,3
v_mfma_f32_16x16x32_bf16 v[32:35],a[8:11],v[68:71],v[32:35]
s_waitcnt vmcnt(19)
s_mov_b32 m0,s70
ds_read_b128 v[80:83],v4 offset:4096
v_mfma_f32_16x16x32_bf16 v[36:39],a[12:15],v[68:71],v[36:39]
s_waitcnt lgkmcnt(2)
buffer_load_dwordx4 v3,s[20:23],s61 offen offset:0 lds
v_mov_b32 v212,v40
v_mfma_f32_16x16x32_bf16 v[32:35],a[16:19],v[72:75],v[32:35]
s_waitcnt vmcnt(19)
ds_read_b128 v[84:87],v4 offset:5120
v_mov_b32 v213,v41
v_mfma_f32_16x16x32_bf16 v[36:39],a[20:23],v[72:75],v[36:39]
s_waitcnt lgkmcnt(2)
v_mov_b32 v214,v42
v_mov_b32 v215,v43
v_mfma_f32_16x16x32_bf16 v[32:35],a[24:27],v[76:79],v[32:35]
s_waitcnt vmcnt(18)
ds_read_b128 v[88:91],v4 offset:6144
buffer_load_dwordx4 v3,s[20:23],s61 offen offset:1024 lds
v_mfma_f32_16x16x32_bf16 v[36:39],a[28:31],v[76:79],v[36:39]
s_waitcnt lgkmcnt(2)
v_mov_b32 v216,v44
v_mov_b32 v217,v45
v_mfma_f32_16x16x32_bf16 v[32:35],a[32:35],v[80:83],v[32:35]
s_waitcnt vmcnt(17)
ds_read_b128 v[92:95],v4 offset:7168
v_mov_b32 v218,v46
v_mfma_f32_16x16x32_bf16 v[36:39],a[36:39],v[80:83],v[36:39]
s_waitcnt lgkmcnt(2)
s_barrier
ds_read_b128 v[96:99],v5 offset:0
v_mfma_f32_16x16x32_bf16 v[32:35],a[40:43],v[84:87],v[32:35]
ds_read_b128 v[100:103],v5 offset:1024
buffer_load_dwordx4 v3,s[20:23],s61 offen offset:2048 lds
v_mfma_f32_16x16x32_bf16 v[36:39],a[44:47],v[84:87],v[36:39]
s_waitcnt lgkmcnt(3)
ds_read_b128 v[104:107],v5 offset:2048
v_mov_b32 v219,v47
v_mfma_f32_16x16x32_bf16 v[32:35],a[48:51],v[88:91],v[32:35]
s_mov_b32 s77,1
ds_read_b128 v[108:111],v5 offset:3072
v_mfma_f32_16x16x32_bf16 v[36:39],a[52:55],v[88:91],v[36:39]
s_waitcnt lgkmcnt(4)
ds_read_b128 v[112:115],v5 offset:4096
buffer_load_dwordx4 v3,s[20:23],s61 offen offset:3072 lds
v_mfma_f32_16x16x32_bf16 v[32:35],a[56:59],v[92:95],v[32:35]
s_waitcnt vmcnt(16)
s_cmp_eq_u32 s77,0
s_cselect_b32 s57,2.0,0
ds_read_b128 v[116:119],v5 offset:5120
v_mfma_f32_16x16x32_bf16 v[36:39],a[60:63],v[92:95],v[36:39]
s_waitcnt lgkmcnt(5)
s_add_u32 m0,s70,4096
v_or_b32 v21,s57,v0
v_mfma_f32_16x16x32_bf16 v[32:35],a[64:67],v[96:99],v[32:35]
ds_read_b128 v[120:123],v5 offset:6144
buffer_load_dwordx4 v3,s[20:23],s62 offen offset:0 lds
v_mfma_f32_16x16x32_bf16 v[36:39],a[68:71],v[96:99],v[36:39]
s_waitcnt lgkmcnt(5)
v_lshlrev_b32 v168,16,v160
v_and_b32 v169,s73,v160
v_mfma_f32_16x16x32_bf16 v[32:35],a[72:75],v[100:103],v[32:35]
ds_read_b128 v[124:127],v5 offset:7168
v_lshlrev_b32 v170,16,v161
v_mfma_f32_16x16x32_bf16 v[36:39],a[76:79],v[100:103],v[36:39]
s_waitcnt lgkmcnt(5)
buffer_load_dwordx4 v3,s[20:23],s62 offen offset:1024 lds
v_and_b32 v171,s73,v161
v_mfma_f32_16x16x32_bf16 v[32:35],a[80:83],v[104:107],v[32:35]
ds_read_b128 v[64:67],v6 offset:0
v_lshlrev_b32 v172,16,v162
v_mfma_f32_16x16x32_bf16 v[36:39],a[84:87],v[104:107],v[36:39]
s_waitcnt lgkmcnt(5)
v_and_b32 v173,s73,v162
v_lshlrev_b32 v174,16,v163
v_mfma_f32_16x16x32_bf16 v[32:35],a[88:91],v[108:111],v[32:35]
ds_read_b128 v[68:71],v6 offset:1024
v_and_b32 v175,s73,v163
v_mfma_f32_16x16x32_bf16 v[36:39],a[92:95],v[108:111],v[36:39]
s_waitcnt lgkmcnt(5)
buffer_load_dwordx4 v3,s[20:23],s62 offen offset:2048 lds
v_fma_f32 v168,v212,v152,v168
v_mfma_f32_16x16x32_bf16 v[32:35],a[96:99],v[112:115],v[32:35]
ds_read_b128 v[72:75],v6 offset:2048
buffer_load_dword v16,v2,s[20:23],s68 offen sc1
v_mfma_f32_16x16x32_bf16 v[36:39],a[100:103],v[112:115],v[36:39]
s_waitcnt lgkmcnt(5)
v_fma_f32 v169,v213,v153,v169
v_fma_f32 v170,v214,v154,v170
v_mfma_f32_16x16x32_bf16 v[32:35],a[104:107],v[116:119],v[32:35]
ds_read_b128 v[76:79],v6 offset:3072
buffer_load_dwordx4 v3,s[20:23],s62 offen offset:3072 lds
v_mfma_f32_16x16x32_bf16 v[36:39],a[108:111],v[116:119],v[36:39]
s_waitcnt lgkmcnt(5)
v_fma_f32 v171,v215,v155,v171
v_fma_f32 v172,v216,v156,v172
v_mfma_f32_16x16x32_bf16 v[32:35],a[112:115],v[120:123],v[32:35]
s_add_u32 s84,s74,s75
s_add_u32 s85,s84,4096
ds_read_b128 v[80:83],v6 offset:4096
v_mfma_f32_16x16x32_bf16 v[36:39],a[116:119],v[120:123],v[36:39]
s_waitcnt lgkmcnt(5)
buffer_load_dwordx4 v[128:131],v0,s[20:23],s84 offen offset:0 sc1
v_fma_f32 v173,v217,v157,v173
v_mfma_f32_16x16x32_bf16 v[32:35],a[120:123],v[124:127],v[32:35]
ds_read_b128 v[84:87],v6 offset:5120
v_fma_f32 v174,v218,v158,v174
v_mfma_f32_16x16x32_bf16 v[36:39],a[124:127],v[124:127],v[36:39]
s_waitcnt lgkmcnt(5)
buffer_load_dwordx4 v[132:135],v0,s[20:23],s84 offen offset:1024 sc1
v_fma_f32 v175,v219,v159,v175
v_mfma_f32_16x16x32_bf16 v[32:35],a[128:131],v[64:67],v[32:35]
ds_read_b128 v[88:91],v6 offset:6144
buffer_load_dwordx4 v[160:163],v18,s[24:27],s82 offen
v_mfma_f32_16x16x32_bf16 v[36:39],a[132:135],v[64:67],v[36:39]
s_waitcnt lgkmcnt(5)
s_add_u32 s82,s82,32768
buffer_load_dwordx4 v[136:139],v0,s[20:23],s84 offen offset:2048 sc1
v_mfma_f32_16x16x32_bf16 v[32:35],a[136:139],v[68:71],v[32:35]
ds_read_b128 v[92:95],v6 offset:7168
v_mfma_f32_16x16x32_bf16 v[36:39],a[140:143],v[68:71],v[36:39]
s_waitcnt lgkmcnt(5)
buffer_load_dwordx4 v[140:143],v0,s[20:23],s84 offen offset:3072 sc1
v_mfma_f32_16x16x32_bf16 v[32:35],a[144:147],v[72:75],v[32:35]
ds_read_b128 v[96:99],v7 offset:0
v_mfma_f32_16x16x32_bf16 v[36:39],a[148:151],v[72:75],v[36:39]
s_waitcnt lgkmcnt(5)
buffer_load_dwordx4 v[144:147],v0,s[20:23],s85 offen offset:0 sc1
v_mfma_f32_16x16x32_bf16 v[32:35],a[152:155],v[76:79],v[32:35]
ds_read_b128 v[100:103],v7 offset:1024
v_mfma_f32_16x16x32_bf16 v[36:39],a[156:159],v[76:79],v[36:39]
s_waitcnt lgkmcnt(5)
buffer_load_dwordx4 v[148:151],v0,s[20:23],s85 offen offset:1024 sc1
v_mfma_f32_16x16x32_bf16 v[32:35],a[160:163],v[80:83],v[32:35]
ds_read_b128 v[104:107],v7 offset:2048
v_mfma_f32_16x16x32_bf16 v[36:39],a[164:167],v[80:83],v[36:39]
s_waitcnt lgkmcnt(5)
v_mfma_f32_16x16x32_bf16 v[32:35],a[168:171],v[84:87],v[32:35]
ds_read_b128 v[108:111],v7 offset:3072
v_mfma_f32_16x16x32_bf16 v[36:39],a[172:175],v[84:87],v[36:39]
s_waitcnt lgkmcnt(5)
v_mfma_f32_16x16x32_bf16 v[32:35],a[176:179],v[88:91],v[32:35]
ds_read_b128 v[112:115],v7 offset:4096
v_mfma_f32_16x16x32_bf16 v[36:39],a[180:183],v[88:91],v[36:39]
s_waitcnt lgkmcnt(5)
v_mfma_f32_16x16x32_bf16 v[32:35],a[184:187],v[92:95],v[32:35]
ds_read_b128 v[116:119],v7 offset:5120
v_mfma_f32_16x16x32_bf16 v[36:39],a[188:191],v[92:95],v[36:39]
s_waitcnt lgkmcnt(5)
v_mfma_f32_16x16x32_bf16 v[32:35],a[192:195],v[96:99],v[32:35]
ds_read_b128 v[120:123],v7 offset:6144
v_mfma_f32_16x16x32_bf16 v[36:39],a[196:199],v[96:99],v[36:39]
s_waitcnt lgkmcnt(5)
v_mfma_f32_16x16x32_bf16 v[32:35],a[200:203],v[100:103],v[32:35]
ds_read_b128 v[124:127],v7 offset:7168
v_mfma_f32_16x16x32_bf16 v[36:39],a[204:207],v[100:103],v[36:39]
s_waitcnt lgkmcnt(5)
s_add_u32 s61,s61,131072
s_add_u32 s62,s62,131072
v_mfma_f32_16x16x32_bf16 v[32:35],a[208:211],v[104:107],v[32:35]
s_add_u32 s70,s70,32768
s_and_b32 s70,s70,0x1ffff
s_add_u32 s55,s55,32768
v_mfma_f32_16x16x32_bf16 v[36:39],a[212:215],v[104:107],v[36:39]
s_waitcnt lgkmcnt(4)
s_and_b32 s55,s55,0x1ffff
v_add_u32 v4,s55,v8
v_mfma_f32_16x16x32_bf16 v[32:35],a[216:219],v[108:111],v[32:35]
v_add_u32 v5,s55,v9
v_add_u32 v6,s55,v10
v_mfma_f32_16x16x32_bf16 v[36:39],a[220:223],v[108:111],v[36:39]
s_waitcnt lgkmcnt(3)
v_add_u32 v7,s55,v11
v_mfma_f32_16x16x32_bf16 v[32:35],a[224:227],v[112:115],v[32:35]
s_waitcnt vmcnt(15)
ds_read_b128 v[64:67],v4 offset:0
v_mfma_f32_16x16x32_bf16 v[36:39],a[228:231],v[112:115],v[36:39]
s_waitcnt lgkmcnt(3)
s_waitcnt vmcnt(14)
ds_read_b128 v[68:71],v4 offset:1024
v_mfma_f32_16x16x32_bf16 v[32:35],a[232:235],v[116:119],v[32:35]
s_waitcnt vmcnt(0)
v_mov_b32 v17,s63
buffer_store_dword v17,v26,s[20:23],s69 offen sc1
s_cmp_eq_u32 s77,0
s_cbranch_scc1 go_139
ck_137:
v_max3_u32 v184,v128,v129,v130
v_max3_u32 v185,v140,v141,v142
v_max3_u32 v184,v184,v131,v132
v_max3_u32 v185,v185,v143,v144
v_max3_u32 v184,v184,v133,v134
v_max3_u32 v185,v185,v145,v146
v_max3_u32 v184,v184,v135,v136
v_max3_u32 v185,v185,v147,v148
v_max3_u32 v184,v184,v137,v138
v_max3_u32 v185,v185,v149,v150
v_max3_u32 v184,v184,v139,v151
v_max_u32 v184,v184,v185
v_cmp_eq_u32 vcc,-1,v184
s_cbranch_vccnz rt_138
go_139:
v_mfma_f32_16x16x32_bf16 v[36:39],a[236:239],v[116:119],v[36:39]
s_waitcnt lgkmcnt(3)
ds_read_b128 v[72:75],v4 offset:2048
v_add_f32 v128,v128,v136
v_mfma_f32_16x16x32_bf16 v[32:35],a[240:243],v[120:123],v[32:35]
v_add_f32 v129,v129,v137
v_add_f32 v130,v130,v138
v_add_f32 v131,v131,v139
v_mfma_f32_16x16x32_bf16 v[36:39],a[244:247],v[120:123],v[36:39]
s_waitcnt lgkmcnt(3)
v_add_f32 v132,v132,v140
v_add_f32 v133,v133,v141
v_add_f32 v134,v134,v142
v_mfma_f32_16x16x32_bf16 v[40:43],a[248:251],v[124:127],v[32:35]
v_add_f32 v135,v135,v143
v_add_f32 v128,v128,v144
v_add_f32 v129,v129,v145
v_mfma_f32_16x16x32_bf16 v[44:47],a[252:255],v[124:127],v[36:39]
v_add_f32 v130,v130,v146
v_add_f32 v131,v131,v147
v_add_f32 v132,v132,v148
v_add_f32 v133,v133,v149
v_add_f32 v134,v134,v150
v_add_f32 v135,v135,v151
v_fma_f32 v168,v128,v152,v168
v_fma_f32 v169,v129,v153,v169
v_fma_f32 v170,v130,v154,v170
v_fma_f32 v171,v131,v155,v171
v_fma_f32 v172,v132,v156,v172
v_fma_f32 v173,v133,v157,v173
v_fma_f32 v174,v134,v158,v174
v_fma_f32 v175,v135,v159,v175
v_cvt_pk_bf16_f32 v176,v168,v169
v_cvt_pk_bf16_f32 v177,v170,v171
v_cvt_pk_bf16_f32 v178,v172,v173
v_cvt_pk_bf16_f32 v179,v174,v175
s_add_u32 s64,s66,201326592
buffer_store_dwordx4 v[176:179],v21,s[20:23],s64 offen sc1
s_cmp_eq_u32 s56,1
s_cbranch_scc1 b1_131
buffer_store_dwordx4 v[204:207],v21,s[20:23],s84 offen offset:0
buffer_store_dwordx4 v[204:207],v21,s[20:23],s84 offen offset:1024
b2_132:
s_cmp_eq_u32 s56,1
s_cbranch_scc1 b1_133
buffer_store_dwordx4 v[204:207],v21,s[20:23],s84 offen offset:2048
buffer_store_dwordx4 v[204:207],v21,s[20:23],s84 offen offset:3072
b2_134:
s_cmp_eq_u32 s56,1
s_cbranch_scc1 b1_135
buffer_store_dwordx4 v[204:207],v21,s[20:23],s85 offen offset:0
buffer_store_dwordx4 v[204:207],v21,s[20:23],s85 offen offset:1024
b2_136:
s_mul_i32 s64,s77,32768
s_add_u32 s66,s66,s64
s_mul_i32 s64,s77,6144
s_add_u32 s75,s75,s64
s_cmp_eq_u32 s75,24576
s_cselect_b32 s75,0,s75
s_add_u32 s63,s63,s77
s_mov_b32 s77,0
v_cmp_gt_u32 vcc,s53,v16
s_add_u32 s60,s60,1
s_cbranch_vccz WR_113
WN_114:
s_waitcnt lgkmcnt(2)
v_mfma_f32_16x16x32_bf16 v[32:35],a[0:3],v[64:67],0
s_waitcnt vmcnt(20)
s_add_u32 s71,s60,2
ds_read_b128 v[76:79],v4 offset:3072
v_mfma_f32_16x16x32_bf16 v[36:39],a[4:7],v[64:67],0
s_waitcnt lgkmcnt(2)
s_add_u32 s53,s60,3
v_mfma_f32_16x16x32_bf16 v[32:35],a[8:11],v[68:71],v[32:35]
s_waitcnt vmcnt(19)
ds_read_b128 v[80:83],v4 offset:4096
v_mov_b32 v212,v40
v_mfma_f32_16x16x32_bf16 v[36:39],a[12:15],v[68:71],v[36:39]
s_waitcnt lgkmcnt(2)
v_mov_b32 v213,v41
v_mov_b32 v214,v42
v_mfma_f32_16x16x32_bf16 v[32:35],a[16:19],v[72:75],v[32:35]
s_waitcnt vmcnt(18)
ds_read_b128 v[84:87],v4 offset:5120
v_mov_b32 v215,v43
v_mfma_f32_16x16x32_bf16 v[36:39],a[20:23],v[72:75],v[36:39]
s_waitcnt lgkmcnt(2)
v_mov_b32 v216,v44
v_mov_b32 v217,v45
v_mfma_f32_16x16x32_bf16 v[32:35],a[24:27],v[76:79],v[32:35]
s_waitcnt vmcnt(17)
ds_read_b128 v[88:91],v4 offset:6144
v_mov_b32 v218,v46
v_mfma_f32_16x16x32_bf16 v[36:39],a[28:31],v[76:79],v[36:39]
s_waitcnt lgkmcnt(2)
v_mov_b32 v219,v47
v_mfma_f32_16x16x32_bf16 v[32:35],a[32:35],v[80:83],v[32:35]
s_waitcnt vmcnt(15)
s_mov_b32 s77,1
ds_read_b128 v[92:95],v4 offset:7168
v_mfma_f32_16x16x32_bf16 v[36:39],a[36:39],v[80:83],v[36:39]
s_waitcnt lgkmcnt(2)
s_barrier
ds_read_b128 v[96:99],v5 offset:0
v_mfma_f32_16x16x32_bf16 v[32:35],a[40:43],v[84:87],v[32:35]
ds_read_b128 v[100:103],v5 offset:1024
v_mfma_f32_16x16x32_bf16 v[36:39],a[44:47],v[84:87],v[36:39]
s_waitcnt lgkmcnt(3)
ds_read_b128 v[104:107],v5 offset:2048
v_mfma_f32_16x16x32_bf16 v[32:35],a[48:51],v[88:91],v[32:35]
ds_read_b128 v[108:111],v5 offset:3072
v_mfma_f32_16x16x32_bf16 v[36:39],a[52:55],v[88:91],v[36:39]
s_waitcnt lgkmcnt(4)
ds_read_b128 v[112:115],v5 offset:4096
v_mfma_f32_16x16x32_bf16 v[32:35],a[56:59],v[92:95],v[32:35]
s_waitcnt vmcnt(12)
s_cmp_eq_u32 s77,0
s_cselect_b32 s57,2.0,0
ds_read_b128 v[116:119],v5 offset:5120
v_mfma_f32_16x16x32_bf16 v[36:39],a[60:63],v[92:95],v[36:39]
s_waitcnt lgkmcnt(5)
v_or_b32 v21,s57,v0
v_lshlrev_b32 v168,16,v160
v_mfma_f32_16x16x32_bf16 v[32:35],a[64:67],v[96:99],v[32:35]
ds_read_b128 v[120:123],v5 offset:6144
v_and_b32 v169,s73,v160
v_mfma_f32_16x16x32_bf16 v[36:39],a[68:71],v[96:99],v[36:39]
s_waitcnt lgkmcnt(5)
v_lshlrev_b32 v170,16,v161
v_and_b32 v171,s73,v161
v_mfma_f32_16x16x32_bf16 v[32:35],a[72:75],v[100:103],v[32:35]
ds_read_b128 v[124:127],v5 offset:7168
v_lshlrev_b32 v172,16,v162
v_mfma_f32_16x16x32_bf16 v[36:39],a[76:79],v[100:103],v[36:39]
s_waitcnt lgkmcnt(5)
v_and_b32 v173,s73,v162
v_lshlrev_b32 v174,16,v163
v_mfma_f32_16x16x32_bf16 v[32:35],a[80:83],v[104:107],v[32:35]
ds_read_b128 v[64:67],v6 offset:0
v_and_b32 v175,s73,v163
v_mfma_f32_16x16x32_bf16 v[36:39],a[84:87],v[104:107],v[36:39]
s_waitcnt lgkmcnt(5)
v_fma_f32 v168,v212,v152,v168
v_fma_f32 v169,v213,v153,v169
v_mfma_f32_16x16x32_bf16 v[32:35],a[88:91],v[108:111],v[32:35]
ds_read_b128 v[68:71],v6 offset:1024
v_fma_f32 v170,v214,v154,v170
v_mfma_f32_16x16x32_bf16 v[36:39],a[92:95],v[108:111],v[36:39]
s_waitcnt lgkmcnt(5)
v_fma_f32 v171,v215,v155,v171
v_fma_f32 v172,v216,v156,v172
v_mfma_f32_16x16x32_bf16 v[32:35],a[96:99],v[112:115],v[32:35]
ds_read_b128 v[72:75],v6 offset:2048
v_fma_f32 v173,v217,v157,v173
v_mfma_f32_16x16x32_bf16 v[36:39],a[100:103],v[112:115],v[36:39]
s_waitcnt lgkmcnt(5)
v_fma_f32 v174,v218,v158,v174
v_fma_f32 v175,v219,v159,v175
v_mfma_f32_16x16x32_bf16 v[32:35],a[104:107],v[116:119],v[32:35]
ds_read_b128 v[76:79],v6 offset:3072
v_mfma_f32_16x16x32_bf16 v[36:39],a[108:111],v[116:119],v[36:39]
s_waitcnt lgkmcnt(5)
buffer_load_dwordx4 v[160:163],v18,s[24:27],s82 offen
v_mfma_f32_16x16x32_bf16 v[32:35],a[112:115],v[120:123],v[32:35]
s_add_u32 s84,s74,s75
s_add_u32 s85,s84,4096
ds_read_b128 v[80:83],v6 offset:4096
v_mfma_f32_16x16x32_bf16 v[36:39],a[116:119],v[120:123],v[36:39]
s_waitcnt lgkmcnt(5)
s_add_u32 s82,s82,32768
buffer_load_dwordx4 v[128:131],v0,s[20:23],s84 offen offset:0 sc1
v_mfma_f32_16x16x32_bf16 v[32:35],a[120:123],v[124:127],v[32:35]
ds_read_b128 v[84:87],v6 offset:5120
v_mfma_f32_16x16x32_bf16 v[36:39],a[124:127],v[124:127],v[36:39]
s_waitcnt lgkmcnt(5)
buffer_load_dwordx4 v[132:135],v0,s[20:23],s84 offen offset:1024 sc1
v_mfma_f32_16x16x32_bf16 v[32:35],a[128:131],v[64:67],v[32:35]
ds_read_b128 v[88:91],v6 offset:6144
v_mfma_f32_16x16x32_bf16 v[36:39],a[132:135],v[64:67],v[36:39]
s_waitcnt lgkmcnt(5)
buffer_load_dwordx4 v[136:139],v0,s[20:23],s84 offen offset:2048 sc1
v_mfma_f32_16x16x32_bf16 v[32:35],a[136:139],v[68:71],v[32:35]
ds_read_b128 v[92:95],v6 offset:7168
v_mfma_f32_16x16x32_bf16 v[36:39],a[140:143],v[68:71],v[36:39]
s_waitcnt lgkmcnt(5)
buffer_load_dwordx4 v[140:143],v0,s[20:23],s84 offen offset:3072 sc1
v_mfma_f32_16x16x32_bf16 v[32:35],a[144:147],v[72:75],v[32:35]
ds_read_b128 v[96:99],v7 offset:0
v_mfma_f32_16x16x32_bf16 v[36:39],a[148:151],v[72:75],v[36:39]
s_waitcnt lgkmcnt(5)
buffer_load_dwordx4 v[144:147],v0,s[20:23],s85 offen offset:0 sc1
v_mfma_f32_16x16x32_bf16 v[32:35],a[152:155],v[76:79],v[32:35]
ds_read_b128 v[100:103],v7 offset:1024
v_mfma_f32_16x16x32_bf16 v[36:39],a[156:159],v[76:79],v[36:39]
s_waitcnt lgkmcnt(5)
buffer_load_dwordx4 v[148:151],v0,s[20:23],s85 offen offset:1024 sc1
v_mfma_f32_16x16x32_bf16 v[32:35],a[160:163],v[80:83],v[32:35]
ds_read_b128 v[104:107],v7 offset:2048
buffer_load_dword v16,v2,s[20:23],s68 offen sc1
v_mfma_f32_16x16x32_bf16 v[36:39],a[164:167],v[80:83],v[36:39]
s_waitcnt lgkmcnt(5)
v_mfma_f32_16x16x32_bf16 v[32:35],a[168:171],v[84:87],v[32:35]
ds_read_b128 v[108:111],v7 offset:3072
v_mfma_f32_16x16x32_bf16 v[36:39],a[172:175],v[84:87],v[36:39]
s_waitcnt lgkmcnt(5)
v_mfma_f32_16x16x32_bf16 v[32:35],a[176:179],v[88:91],v[32:35]
ds_read_b128 v[112:115],v7 offset:4096
v_mfma_f32_16x16x32_bf16 v[36:39],a[180:183],v[88:91],v[36:39]
s_waitcnt lgkmcnt(5)
v_mfma_f32_16x16x32_bf16 v[32:35],a[184:187],v[92:95],v[32:35]
ds_read_b128 v[116:119],v7 offset:5120
v_mfma_f32_16x16x32_bf16 v[36:39],a[188:191],v[92:95],v[36:39]
s_waitcnt lgkmcnt(5)
v_mfma_f32_16x16x32_bf16 v[32:35],a[192:195],v[96:99],v[32:35]
ds_read_b128 v[120:123],v7 offset:6144
v_mfma_f32_16x16x32_bf16 v[36:39],a[196:199],v[96:99],v[36:39]
s_waitcnt lgkmcnt(5)
v_mfma_f32_16x16x32_bf16 v[32:35],a[200:203],v[100:103],v[32:35]
s_waitcnt vmcnt(1)
ds_read_b128 v[124:127],v7 offset:7168
v_mov_b32 v17,s63
buffer_store_dword v17,v26,s[20:23],s69 offen sc1
s_cmp_eq_u32 s77,0
s_cbranch_scc1 go_149
ck_147:
v_max3_u32 v184,v128,v129,v130
v_max3_u32 v185,v140,v141,v142
v_max3_u32 v184,v184,v131,v132
v_max3_u32 v185,v185,v143,v144
v_max3_u32 v184,v184,v133,v134
v_max3_u32 v185,v185,v145,v146
v_max3_u32 v184,v184,v135,v136
v_max3_u32 v185,v185,v147,v148
v_max3_u32 v184,v184,v137,v138
v_max3_u32 v185,v185,v149,v150
v_max3_u32 v184,v184,v139,v151
v_max_u32 v184,v184,v185
v_cmp_eq_u32 vcc,-1,v184
s_cbranch_vccnz rt_148
go_149:
v_mfma_f32_16x16x32_bf16 v[36:39],a[204:207],v[100:103],v[36:39]
s_waitcnt lgkmcnt(5)
s_add_u32 s55,s55,32768
s_and_b32 s55,s55,0x1ffff
v_add_f32 v128,v128,v136
v_mfma_f32_16x16x32_bf16 v[32:35],a[208:211],v[104:107],v[32:35]
v_add_u32 v4,s55,v8
v_add_u32 v5,s55,v9
v_add_f32 v129,v129,v137
v_mfma_f32_16x16x32_bf16 v[36:39],a[212:215],v[104:107],v[36:39]
s_waitcnt lgkmcnt(4)
v_add_u32 v6,s55,v10
v_add_u32 v7,s55,v11
v_add_f32 v130,v130,v138
v_mfma_f32_16x16x32_bf16 v[32:35],a[216:219],v[108:111],v[32:35]
v_add_f32 v131,v131,v139
v_add_f32 v132,v132,v140
v_add_f32 v133,v133,v141
v_mfma_f32_16x16x32_bf16 v[36:39],a[220:223],v[108:111],v[36:39]
s_waitcnt lgkmcnt(3)
v_add_f32 v134,v134,v142
v_add_f32 v135,v135,v143
v_add_f32 v128,v128,v144
v_mfma_f32_16x16x32_bf16 v[32:35],a[224:227],v[112:115],v[32:35]
v_add_f32 v129,v129,v145
v_add_f32 v130,v130,v146
v_add_f32 v131,v131,v147
v_mfma_f32_16x16x32_bf16 v[36:39],a[228:231],v[112:115],v[36:39]
s_waitcnt lgkmcnt(2)
v_add_f32 v132,v132,v148
v_add_f32 v133,v133,v149
v_add_f32 v134,v134,v150
v_mfma_f32_16x16x32_bf16 v[32:35],a[232:235],v[116:119],v[32:35]
v_add_f32 v135,v135,v151
v_fma_f32 v168,v128,v152,v168
v_fma_f32 v169,v129,v153,v169
v_mfma_f32_16x16x32_bf16 v[36:39],a[236:239],v[116:119],v[36:39]
s_waitcnt lgkmcnt(1)
v_fma_f32 v170,v130,v154,v170
v_fma_f32 v171,v131,v155,v171
v_fma_f32 v172,v132,v156,v172
v_mfma_f32_16x16x32_bf16 v[32:35],a[240:243],v[120:123],v[32:35]
v_fma_f32 v173,v133,v157,v173
v_fma_f32 v174,v134,v158,v174
v_fma_f32 v175,v135,v159,v175
v_mfma_f32_16x16x32_bf16 v[36:39],a[244:247],v[120:123],v[36:39]
s_waitcnt lgkmcnt(0)
v_cvt_pk_bf16_f32 v176,v168,v169
v_cvt_pk_bf16_f32 v177,v170,v171
v_cvt_pk_bf16_f32 v178,v172,v173
v_mfma_f32_16x16x32_bf16 v[40:43],a[248:251],v[124:127],v[32:35]
v_cvt_pk_bf16_f32 v179,v174,v175
v_mfma_f32_16x16x32_bf16 v[44:47],a[252:255],v[124:127],v[36:39]
s_waitcnt vmcnt(1)
s_add_u32 s64,s66,201326592
buffer_store_dwordx4 v[176:179],v21,s[20:23],s64 offen sc1
s_cmp_eq_u32 s56,1
s_cbranch_scc1 b1_141
buffer_store_dwordx4 v[204:207],v21,s[20:23],s84 offen offset:0
buffer_store_dwordx4 v[204:207],v21,s[20:23],s84 offen offset:1024
b2_142:
s_cmp_eq_u32 s56,1
s_cbranch_scc1 b1_143
buffer_store_dwordx4 v[204:207],v21,s[20:23],s84 offen offset:2048
buffer_store_dwordx4 v[204:207],v21,s[20:23],s84 offen offset:3072
b2_144:
s_cmp_eq_u32 s56,1
s_cbranch_scc1 b1_145
buffer_store_dwordx4 v[204:207],v21,s[20:23],s85 offen offset:0
buffer_store_dwordx4 v[204:207],v21,s[20:23],s85 offen offset:1024
b2_146:
s_mul_i32 s64,s77,32768
s_add_u32 s66,s66,s64
s_mul_i32 s64,s77,6144
s_add_u32 s75,s75,s64
s_cmp_eq_u32 s75,24576
s_cselect_b32 s75,0,s75
s_add_u32 s63,s63,s77
s_mov_b32 s77,0
v_cmp_gt_u32 vcc,s71,v16
s_add_u32 s60,s60,1
s_branch endN_140
BN_116:
s_waitcnt vmcnt(7)
ds_read_b128 v[64:67],v4 offset:0
s_waitcnt vmcnt(6)
ds_read_b128 v[68:71],v4 offset:1024
s_waitcnt vmcnt(5)
ds_read_b128 v[72:75],v4 offset:2048
s_waitcnt vmcnt(4)
ds_read_b128 v[76:79],v4 offset:3072
s_waitcnt lgkmcnt(3)
v_mfma_f32_16x16x32_bf16 v[32:35],a[0:3],v[64:67],0
s_add_u32 s71,s60,2
s_add_u32 s53,s60,3
v_mfma_f32_16x16x32_bf16 v[36:39],a[4:7],v[64:67],0
s_waitcnt lgkmcnt(2)
s_waitcnt vmcnt(3)
ds_read_b128 v[80:83],v4 offset:4096
v_mfma_f32_16x16x32_bf16 v[32:35],a[8:11],v[68:71],v[32:35]
v_mfma_f32_16x16x32_bf16 v[36:39],a[12:15],v[68:71],v[36:39]
s_waitcnt lgkmcnt(2)
s_waitcnt vmcnt(2)
ds_read_b128 v[84:87],v4 offset:5120
v_mfma_f32_16x16x32_bf16 v[32:35],a[16:19],v[72:75],v[32:35]
v_mfma_f32_16x16x32_bf16 v[36:39],a[20:23],v[72:75],v[36:39]
s_waitcnt lgkmcnt(2)
s_waitcnt vmcnt(1)
ds_read_b128 v[88:91],v4 offset:6144
v_mfma_f32_16x16x32_bf16 v[32:35],a[24:27],v[76:79],v[32:35]
v_mfma_f32_16x16x32_bf16 v[36:39],a[28:31],v[76:79],v[36:39]
s_waitcnt lgkmcnt(2)
s_waitcnt vmcnt(0)
ds_read_b128 v[92:95],v4 offset:7168
v_mfma_f32_16x16x32_bf16 v[32:35],a[32:35],v[80:83],v[32:35]
v_mfma_f32_16x16x32_bf16 v[36:39],a[36:39],v[80:83],v[36:39]
s_waitcnt lgkmcnt(2)
s_barrier
ds_read_b128 v[96:99],v5 offset:0
v_mfma_f32_16x16x32_bf16 v[32:35],a[40:43],v[84:87],v[32:35]
ds_read_b128 v[100:103],v5 offset:1024
v_mfma_f32_16x16x32_bf16 v[36:39],a[44:47],v[84:87],v[36:39]
s_waitcnt lgkmcnt(3)
ds_read_b128 v[104:107],v5 offset:2048
v_mfma_f32_16x16x32_bf16 v[32:35],a[48:51],v[88:91],v[32:35]
ds_read_b128 v[108:111],v5 offset:3072
v_mfma_f32_16x16x32_bf16 v[36:39],a[52:55],v[88:91],v[36:39]
s_waitcnt lgkmcnt(4)
ds_read_b128 v[112:115],v5 offset:4096
v_mfma_f32_16x16x32_bf16 v[32:35],a[56:59],v[92:95],v[32:35]
s_cmp_eq_u32 s77,0
s_cselect_b32 s57,2.0,0
ds_read_b128 v[116:119],v5 offset:5120
v_mfma_f32_16x16x32_bf16 v[36:39],a[60:63],v[92:95],v[36:39]
s_waitcnt lgkmcnt(5)
v_or_b32 v21,s57,v0
v_lshlrev_b32 v168,16,v160
v_mfma_f32_16x16x32_bf16 v[32:35],a[64:67],v[96:99],v[32:35]
ds_read_b128 v[120:123],v5 offset:6144
v_and_b32 v169,s73,v160
v_mfma_f32_16x16x32_bf16 v[36:39],a[68:71],v[96:99],v[36:39]
s_waitcnt lgkmcnt(5)
v_lshlrev_b32 v170,16,v161
v_and_b32 v171,s73,v161
v_mfma_f32_16x16x32_bf16 v[32:35],a[72:75],v[100:103],v[32:35]
ds_read_b128 v[124:127],v5 offset:7168
v_lshlrev_b32 v172,16,v162
v_mfma_f32_16x16x32_bf16 v[36:39],a[76:79],v[100:103],v[36:39]
s_waitcnt lgkmcnt(5)
v_and_b32 v173,s73,v162
v_lshlrev_b32 v174,16,v163
v_mfma_f32_16x16x32_bf16 v[32:35],a[80:83],v[104:107],v[32:35]
ds_read_b128 v[64:67],v6 offset:0
v_and_b32 v175,s73,v163
v_mfma_f32_16x16x32_bf16 v[36:39],a[84:87],v[104:107],v[36:39]
s_waitcnt lgkmcnt(5)
v_fma_f32 v168,v212,v152,v168
v_fma_f32 v169,v213,v153,v169
v_mfma_f32_16x16x32_bf16 v[32:35],a[88:91],v[108:111],v[32:35]
ds_read_b128 v[68:71],v6 offset:1024
v_fma_f32 v170,v214,v154,v170
v_mfma_f32_16x16x32_bf16 v[36:39],a[92:95],v[108:111],v[36:39]
s_waitcnt lgkmcnt(5)
v_fma_f32 v171,v215,v155,v171
v_fma_f32 v172,v216,v156,v172
v_mfma_f32_16x16x32_bf16 v[32:35],a[96:99],v[112:115],v[32:35]
ds_read_b128 v[72:75],v6 offset:2048
v_fma_f32 v173,v217,v157,v173
v_mfma_f32_16x16x32_bf16 v[36:39],a[100:103],v[112:115],v[36:39]
s_waitcnt lgkmcnt(5)
v_fma_f32 v174,v218,v158,v174
v_fma_f32 v175,v219,v159,v175
v_mfma_f32_16x16x32_bf16 v[32:35],a[104:107],v[116:119],v[32:35]
ds_read_b128 v[76:79],v6 offset:3072
v_mfma_f32_16x16x32_bf16 v[36:39],a[108:111],v[116:119],v[36:39]
s_waitcnt lgkmcnt(5)
buffer_load_dwordx4 v[160:163],v18,s[24:27],s82 offen
v_mfma_f32_16x16x32_bf16 v[32:35],a[112:115],v[120:123],v[32:35]
s_add_u32 s84,s74,s75
s_add_u32 s85,s84,4096
ds_read_b128 v[80:83],v6 offset:4096
v_mfma_f32_16x16x32_bf16 v[36:39],a[116:119],v[120:123],v[36:39]
s_waitcnt lgkmcnt(5)
s_add_u32 s82,s82,32768
buffer_load_dwordx4 v[128:131],v0,s[20:23],s84 offen offset:0 sc1
v_mfma_f32_16x16x32_bf16 v[32:35],a[120:123],v[124:127],v[32:35]
ds_read_b128 v[84:87],v6 offset:5120
v_mfma_f32_16x16x32_bf16 v[36:39],a[124:127],v[124:127],v[36:39]
s_waitcnt lgkmcnt(5)
buffer_load_dwordx4 v[132:135],v0,s[20:23],s84 offen offset:1024 sc1
v_mfma_f32_16x16x32_bf16 v[32:35],a[128:131],v[64:67],v[32:35]
ds_read_b128 v[88:91],v6 offset:6144
v_mfma_f32_16x16x32_bf16 v[36:39],a[132:135],v[64:67],v[36:39]
s_waitcnt lgkmcnt(5)
buffer_load_dwordx4 v[136:139],v0,s[20:23],s84 offen offset:2048 sc1
v_mfma_f32_16x16x32_bf16 v[32:35],a[136:139],v[68:71],v[32:35]
ds_read_b128 v[92:95],v6 offset:7168
v_mfma_f32_16x16x32_bf16 v[36:39],a[140:143],v[68:71],v[36:39]
s_waitcnt lgkmcnt(5)
buffer_load_dwordx4 v[140:143],v0,s[20:23],s84 offen offset:3072 sc1
v_mfma_f32_16x16x32_bf16 v[32:35],a[144:147],v[72:75],v[32:35]
ds_read_b128 v[96:99],v7 offset:0
v_mfma_f32_16x16x32_bf16 v[36:39],a[148:151],v[72:75],v[36:39]
s_waitcnt lgkmcnt(5)
buffer_load_dwordx4 v[144:147],v0,s[20:23],s85 offen offset:0 sc1
v_mfma_f32_16x16x32_bf16 v[32:35],a[152:155],v[76:79],v[32:35]
ds_read_b128 v[100:103],v7 offset:1024
v_mfma_f32_16x16x32_bf16 v[36:39],a[156:159],v[76:79],v[36:39]
s_waitcnt lgkmcnt(5)
buffer_load_dwordx4 v[148:151],v0,s[20:23],s85 offen offset:1024 sc1
v_mfma_f32_16x16x32_bf16 v[32:35],a[160:163],v[80:83],v[32:35]
ds_read_b128 v[104:107],v7 offset:2048
buffer_load_dword v16,v2,s[20:23],s68 offen sc1
v_mfma_f32_16x16x32_bf16 v[36:39],a[164:167],v[80:83],v[36:39]
s_waitcnt lgkmcnt(5)
v_mfma_f32_16x16x32_bf16 v[32:35],a[168:171],v[84:87],v[32:35]
ds_read_b128 v[108:111],v7 offset:3072
v_mfma_f32_16x16x32_bf16 v[36:39],a[172:175],v[84:87],v[36:39]
s_waitcnt lgkmcnt(5)
v_mfma_f32_16x16x32_bf16 v[32:35],a[176:179],v[88:91],v[32:35]
ds_read_b128 v[112:115],v7 offset:4096
v_mfma_f32_16x16x32_bf16 v[36:39],a[180:183],v[88:91],v[36:39]
s_waitcnt lgkmcnt(5)
v_mfma_f32_16x16x32_bf16 v[32:35],a[184:187],v[92:95],v[32:35]
ds_read_b128 v[116:119],v7 offset:5120
v_mfma_f32_16x16x32_bf16 v[36:39],a[188:191],v[92:95],v[36:39]
s_waitcnt lgkmcnt(5)
v_mfma_f32_16x16x32_bf16 v[32:35],a[192:195],v[96:99],v[32:35]
ds_read_b128 v[120:123],v7 offset:6144
v_mfma_f32_16x16x32_bf16 v[36:39],a[196:199],v[96:99],v[36:39]
s_waitcnt lgkmcnt(5)
v_mfma_f32_16x16x32_bf16 v[32:35],a[200:203],v[100:103],v[32:35]
s_waitcnt vmcnt(1)
ds_read_b128 v[124:127],v7 offset:7168
v_mov_b32 v17,s63
buffer_store_dword v17,v26,s[20:23],s69 offen sc1
s_cmp_eq_u32 s77,0
s_cbranch_scc1 go_158
ck_156:
v_max3_u32 v184,v128,v129,v130
v_max3_u32 v185,v140,v141,v142
v_max3_u32 v184,v184,v131,v132
v_max3_u32 v185,v185,v143,v144
v_max3_u32 v184,v184,v133,v134
v_max3_u32 v185,v185,v145,v146
v_max3_u32 v184,v184,v135,v136
v_max3_u32 v185,v185,v147,v148
v_max3_u32 v184,v184,v137,v138
v_max3_u32 v185,v185,v149,v150
v_max3_u32 v184,v184,v139,v151
v_max_u32 v184,v184,v185
v_cmp_eq_u32 vcc,-1,v184
s_cbranch_vccnz rt_157
go_158:
v_mfma_f32_16x16x32_bf16 v[36:39],a[204:207],v[100:103],v[36:39]
s_waitcnt lgkmcnt(5)
s_add_u32 s55,s55,32768
s_and_b32 s55,s55,0x1ffff
v_add_f32 v128,v128,v136
v_mfma_f32_16x16x32_bf16 v[32:35],a[208:211],v[104:107],v[32:35]
v_add_u32 v4,s55,v8
v_add_u32 v5,s55,v9
v_add_f32 v129,v129,v137
v_mfma_f32_16x16x32_bf16 v[36:39],a[212:215],v[104:107],v[36:39]
s_waitcnt lgkmcnt(4)
v_add_u32 v6,s55,v10
v_add_u32 v7,s55,v11
v_add_f32 v130,v130,v138
v_mfma_f32_16x16x32_bf16 v[32:35],a[216:219],v[108:111],v[32:35]
v_add_f32 v131,v131,v139
v_add_f32 v132,v132,v140
v_add_f32 v133,v133,v141
v_mfma_f32_16x16x32_bf16 v[36:39],a[220:223],v[108:111],v[36:39]
s_waitcnt lgkmcnt(3)
v_add_f32 v134,v134,v142
v_add_f32 v135,v135,v143
v_add_f32 v128,v128,v144
v_mfma_f32_16x16x32_bf16 v[32:35],a[224:227],v[112:115],v[32:35]
v_add_f32 v129,v129,v145
v_add_f32 v130,v130,v146
v_add_f32 v131,v131,v147
v_mfma_f32_16x16x32_bf16 v[36:39],a[228:231],v[112:115],v[36:39]
s_waitcnt lgkmcnt(2)
v_add_f32 v132,v132,v148
v_add_f32 v133,v133,v149
v_add_f32 v134,v134,v150
v_mfma_f32_16x16x32_bf16 v[32:35],a[232:235],v[116:119],v[32:35]
v_add_f32 v135,v135,v151
v_fma_f32 v168,v128,v152,v168
v_fma_f32 v169,v129,v153,v169
v_mfma_f32_16x16x32_bf16 v[36:39],a[236:239],v[116:119],v[36:39]
s_waitcnt lgkmcnt(1)
v_fma_f32 v170,v130,v154,v170
v_fma_f32 v171,v131,v155,v171
v_fma_f32 v172,v132,v156,v172
v_mfma_f32_16x16x32_bf16 v[32:35],a[240:243],v[120:123],v[32:35]
v_fma_f32 v173,v133,v157,v173
v_fma_f32 v174,v134,v158,v174
v_fma_f32 v175,v135,v159,v175
v_mfma_f32_16x16x32_bf16 v[36:39],a[244:247],v[120:123],v[36:39]
s_waitcnt lgkmcnt(0)
v_cvt_pk_bf16_f32 v176,v168,v169
v_cvt_pk_bf16_f32 v177,v170,v171
v_cvt_pk_bf16_f32 v178,v172,v173
v_mfma_f32_16x16x32_bf16 v[40:43],a[248:251],v[124:127],v[32:35]
v_cvt_pk_bf16_f32 v179,v174,v175
v_mfma_f32_16x16x32_bf16 v[44:47],a[252:255],v[124:127],v[36:39]
s_waitcnt vmcnt(1)
s_add_u32 s64,s66,201326592
buffer_store_dwordx4 v[176:179],v21,s[20:23],s64 offen sc1
s_cmp_eq_u32 s56,1
s_cbranch_scc1 b1_150
buffer_store_dwordx4 v[204:207],v21,s[20:23],s84 offen offset:0
buffer_store_dwordx4 v[204:207],v21,s[20:23],s84 offen offset:1024
b2_151:
s_cmp_eq_u32 s56,1
s_cbranch_scc1 b1_152
buffer_store_dwordx4 v[204:207],v21,s[20:23],s84 offen offset:2048
buffer_store_dwordx4 v[204:207],v21,s[20:23],s84 offen offset:3072
b2_153:
s_cmp_eq_u32 s56,1
s_cbranch_scc1 b1_154
buffer_store_dwordx4 v[204:207],v21,s[20:23],s85 offen offset:0
buffer_store_dwordx4 v[204:207],v21,s[20:23],s85 offen offset:1024
b2_155:
s_mul_i32 s64,s77,32768
s_add_u32 s66,s66,s64
s_mul_i32 s64,s77,6144
s_add_u32 s75,s75,s64
s_cmp_eq_u32 s75,24576
s_cselect_b32 s75,0,s75
s_add_u32 s63,s63,s77
s_mov_b32 s77,0
v_cmp_gt_u32 vcc,s71,v16
s_add_u32 s60,s60,1
endN_140:
s_cbranch_vccnz nb_119
s_mov_b32 m0,s70
s_nop 0
buffer_load_dwordx4 v3,s[20:23],s61 offen offset:0 lds
buffer_load_dwordx4 v3,s[20:23],s61 offen offset:1024 lds
buffer_load_dwordx4 v3,s[20:23],s61 offen offset:2048 lds
buffer_load_dwordx4 v3,s[20:23],s61 offen offset:3072 lds
s_add_u32 m0,s70,4096
s_nop 0
buffer_load_dwordx4 v3,s[20:23],s62 offen offset:0 lds
buffer_load_dwordx4 v3,s[20:23],s62 offen offset:1024 lds
buffer_load_dwordx4 v3,s[20:23],s62 offen offset:2048 lds
buffer_load_dwordx4 v3,s[20:23],s62 offen offset:3072 lds
s_add_u32 s61,s61,131072
s_add_u32 s62,s62,131072
s_add_u32 s70,s70,32768
s_and_b32 s70,s70,0x1ffff
v_mov_b32 v212,v40
v_mov_b32 v213,v41
v_mov_b32 v214,v42
v_mov_b32 v215,v43
v_mov_b32 v216,v44
v_mov_b32 v217,v45
v_mov_b32 v218,v46
v_mov_b32 v219,v47
s_mov_b32 s77,1
s_branch dec_118
nb_119:
s_nop 3
s_mov_b32 s77,1
s_add_u32 s84,s74,s75
s_add_u32 s85,s84,4096
buffer_load_dwordx4 v[128:131],v0,s[20:23],s84 offen offset:0 sc1
buffer_load_dwordx4 v[132:135],v0,s[20:23],s84 offen offset:1024 sc1
buffer_load_dwordx4 v[136:139],v0,s[20:23],s84 offen offset:2048 sc1
buffer_load_dwordx4 v[140:143],v0,s[20:23],s84 offen offset:3072 sc1
buffer_load_dwordx4 v[144:147],v0,s[20:23],s85 offen offset:0 sc1
buffer_load_dwordx4 v[148:151],v0,s[20:23],s85 offen offset:1024 sc1
s_cmp_eq_u32 s77,0
s_cselect_b32 s57,2.0,0
v_or_b32 v21,s57,v0
v_lshlrev_b32 v168,16,v160
v_and_b32 v169,s73,v160
v_lshlrev_b32 v170,16,v161
v_and_b32 v171,s73,v161
v_lshlrev_b32 v172,16,v162
v_and_b32 v173,s73,v162
v_lshlrev_b32 v174,16,v163
v_and_b32 v175,s73,v163
v_pk_fma_f32 v[168:169],v[40:41],v[152:153],v[168:169]
v_pk_fma_f32 v[170:171],v[42:43],v[154:155],v[170:171]
v_pk_fma_f32 v[172:173],v[44:45],v[156:157],v[172:173]
v_pk_fma_f32 v[174:175],v[46:47],v[158:159],v[174:175]
s_waitcnt vmcnt(0)
v_mov_b32 v17,s63
buffer_store_dword v17,v26,s[20:23],s69 offen sc1
s_cmp_eq_u32 s77,0
s_cbranch_scc1 go_167
ck_165:
v_max3_u32 v184,v128,v129,v130
v_max3_u32 v185,v140,v141,v142
v_max3_u32 v184,v184,v131,v132
v_max3_u32 v185,v185,v143,v144
v_max3_u32 v184,v184,v133,v134
v_max3_u32 v185,v185,v145,v146
v_max3_u32 v184,v184,v135,v136
v_max3_u32 v185,v185,v147,v148
v_max3_u32 v184,v184,v137,v138
v_max3_u32 v185,v185,v149,v150
v_max3_u32 v184,v184,v139,v151
v_max_u32 v184,v184,v185
v_cmp_eq_u32 vcc,-1,v184
s_cbranch_vccnz rt_166
go_167:
buffer_load_dword v16,v2,s[20:23],s68 offen sc1
v_pk_add_f32 v[128:129],v[128:129],v[136:137]
v_pk_add_f32 v[130:131],v[130:131],v[138:139]
v_pk_add_f32 v[132:133],v[132:133],v[140:141]
v_pk_add_f32 v[134:135],v[134:135],v[142:143]
v_pk_add_f32 v[128:129],v[128:129],v[144:145]
v_pk_add_f32 v[130:131],v[130:131],v[146:147]
v_pk_add_f32 v[132:133],v[132:133],v[148:149]
v_pk_add_f32 v[134:135],v[134:135],v[150:151]
v_pk_fma_f32 v[168:169],v[128:129],v[152:153],v[168:169]
v_pk_fma_f32 v[170:171],v[130:131],v[154:155],v[170:171]
v_pk_fma_f32 v[172:173],v[132:133],v[156:157],v[172:173]
v_pk_fma_f32 v[174:175],v[134:135],v[158:159],v[174:175]
v_cvt_pk_bf16_f32 v176,v168,v169
v_cvt_pk_bf16_f32 v177,v170,v171
v_cvt_pk_bf16_f32 v178,v172,v173
v_cvt_pk_bf16_f32 v179,v174,v175
s_add_u32 s64,s66,201326592
buffer_store_dwordx4 v[176:179],v21,s[20:23],s64 offen sc1
s_cmp_eq_u32 s56,1
s_cbranch_scc1 b1_159
buffer_store_dwordx4 v[204:207],v21,s[20:23],s84 offen offset:0
buffer_store_dwordx4 v[204:207],v21,s[20:23],s84 offen offset:1024
b2_160:
s_cmp_eq_u32 s56,1
s_cbranch_scc1 b1_161
buffer_store_dwordx4 v[204:207],v21,s[20:23],s84 offen offset:2048
buffer_store_dwordx4 v[204:207],v21,s[20:23],s84 offen offset:3072
b2_162:
s_cmp_eq_u32 s56,1
s_cbranch_scc1 b1_163
buffer_store_dwordx4 v[204:207],v21,s[20:23],s85 offen offset:0
buffer_store_dwordx4 v[204:207],v21,s[20:23],s85 offen offset:1024
b2_164:
s_mul_i32 s64,s77,32768
s_add_u32 s66,s66,s64
s_mul_i32 s64,s77,6144
s_add_u32 s75,s75,s64
s_cmp_eq_u32 s75,24576
s_cselect_b32 s75,0,s75
s_add_u32 s63,s63,s77
s_mov_b32 s77,0
s_waitcnt vmcnt(6)
v_mov_b32 v17,s63
buffer_store_dword v17,v26,s[20:23],s69 offen sc1
v_cmp_gt_u32 vcc,s71,v16
s_cbranch_vccz lag_117
s_cmp_ge_u32 s60,128
s_cbranch_scc1 done_71
plp_168:
buffer_load_dword v16,v2,s[20:23],s68 offen sc1
s_waitcnt vmcnt(0)
v_cmp_gt_u32 vcc,s71,v16
s_cbranch_vccz pok_169
s_sleep 4
s_sub_u32 s90,s90,1
s_cmp_gt_i32 s90,0
s_cbranch_scc1 plp_168
pok_169:
s_branch lag_117
b1_90:
s_nop 7
buffer_store_dwordx4 v[40:43],v0,s[20:23],s64 offen offset:0 sc1
buffer_store_dwordx4 v[44:47],v0,s[20:23],s64 offen offset:1024 sc1
s_branch b2_91
b1_93:
s_nop 7
buffer_store_dwordx4 v[40:43],v0,s[20:23],s64 offen offset:0 sc1
buffer_store_dwordx4 v[44:47],v0,s[20:23],s64 offen offset:1024 sc1
s_branch b2_94
b1_95:
s_nop 7
buffer_store_dwordx4 v[40:43],v0,s[20:23],s64 offen offset:0 sc1
buffer_store_dwordx4 v[44:47],v0,s[20:23],s64 offen offset:1024 sc1
s_branch b2_96
b1_97:
s_nop 7
buffer_store_dwordx4 v[40:43],v0,s[20:23],s64 offen offset:0 sc1
buffer_store_dwordx4 v[44:47],v0,s[20:23],s64 offen offset:1024 sc1
s_branch b2_98
b1_122:
s_nop 7
buffer_store_dwordx4 v[204:207],v21,s[20:23],s84 offen offset:0 sc1
buffer_store_dwordx4 v[204:207],v21,s[20:23],s84 offen offset:1024 sc1
s_branch b2_123
b1_124:
s_nop 7
buffer_store_dwordx4 v[204:207],v21,s[20:23],s84 offen offset:2048 sc1
buffer_store_dwordx4 v[204:207],v21,s[20:23],s84 offen offset:3072 sc1
s_branch b2_125
b1_126:
s_nop 7
buffer_store_dwordx4 v[204:207],v21,s[20:23],s85 offen offset:0 sc1
buffer_store_dwordx4 v[204:207],v21,s[20:23],s85 offen offset:1024 sc1
s_branch b2_127
rt_129:
s_sub_u32 s90,s90,1
s_cmp_gt_i32 s90,0
s_cbranch_scc0 go_130
s_add_u32 s84,s74,s75
s_add_u32 s85,s84,4096
buffer_load_dwordx4 v[128:131],v0,s[20:23],s84 offen offset:0 sc1
buffer_load_dwordx4 v[132:135],v0,s[20:23],s84 offen offset:1024 sc1
buffer_load_dwordx4 v[136:139],v0,s[20:23],s84 offen offset:2048 sc1
buffer_load_dwordx4 v[140:143],v0,s[20:23],s84 offen offset:3072 sc1
buffer_load_dwordx4 v[144:147],v0,s[20:23],s85 offen offset:0 sc1
buffer_load_dwordx4 v[148:151],v0,s[20:23],s85 offen offset:1024 sc1
s_waitcnt vmcnt(0)
s_branch ck_128
b1_131:
s_nop 7
buffer_store_dwordx4 v[204:207],v21,s[20:23],s84 offen offset:0 sc1
buffer_store_dwordx4 v[204:207],v21,s[20:23],s84 offen offset:1024 sc1
s_branch b2_132
b1_133:
s_nop 7
buffer_store_dwordx4 v[204:207],v21,s[20:23],s84 offen offset:2048 sc1
buffer_store_dwordx4 v[204:207],v21,s[20:23],s84 offen offset:3072 sc1
s_branch b2_134
b1_135:
s_nop 7
buffer_store_dwordx4 v[204:207],v21,s[20:23],s85 offen offset:0 sc1
buffer_store_dwordx4 v[204:207],v21,s[20:23],s85 offen offset:1024 sc1
s_branch b2_136
rt_138:
s_sub_u32 s90,s90,1
s_cmp_gt_i32 s90,0
s_cbranch_scc0 go_139
s_add_u32 s84,s74,s75
s_add_u32 s85,s84,4096
buffer_load_dwordx4 v[128:131],v0,s[20:23],s84 offen offset:0 sc1
buffer_load_dwordx4 v[132:135],v0,s[20:23],s84 offen offset:1024 sc1
buffer_load_dwordx4 v[136:139],v0,s[20:23],s84 offen offset:2048 sc1
buffer_load_dwordx4 v[140:143],v0,s[20:23],s84 offen offset:3072 sc1
buffer_load_dwordx4 v[144:147],v0,s[20:23],s85 offen offset:0 sc1
buffer_load_dwordx4 v[148:151],v0,s[20:23],s85 offen offset:1024 sc1
s_waitcnt vmcnt(0)
s_branch ck_137
b1_141:
s_nop 7
buffer_store_dwordx4 v[204:207],v21,s[20:23],s84 offen offset:0 sc1
buffer_store_dwordx4 v[204:207],v21,s[20:23],s84 offen offset:1024 sc1
s_branch b2_142
b1_143:
s_nop 7
buffer_store_dwordx4 v[204:207],v21,s[20:23],s84 offen offset:2048 sc1
buffer_store_dwordx4 v[204:207],v21,s[20:23],s84 offen offset:3072 sc1
s_branch b2_144
b1_145:
s_nop 7
buffer_store_dwordx4 v[204:207],v21,s[20:23],s85 offen offset:0 sc1
buffer_store_dwordx4 v[204:207],v21,s[20:23],s85 offen offset:1024 sc1
s_branch b2_146
rt_148:
s_sub_u32 s90,s90,1
s_cmp_gt_i32 s90,0
s_cbranch_scc0 go_149
s_add_u32 s84,s74,s75
s_add_u32 s85,s84,4096
buffer_load_dwordx4 v[128:131],v0,s[20:23],s84 offen offset:0 sc1
buffer_load_dwordx4 v[132:135],v0,s[20:23],s84 offen offset:1024 sc1
buffer_load_dwordx4 v[136:139],v0,s[20:23],s84 offen offset:2048 sc1
buffer_load_dwordx4 v[140:143],v0,s[20:23],s84 offen offset:3072 sc1
buffer_load_dwordx4 v[144:147],v0,s[20:23],s85 offen offset:0 sc1
buffer_load_dwordx4 v[148:151],v0,s[20:23],s85 offen offset:1024 sc1
s_waitcnt vmcnt(0)
s_branch ck_147
b1_150:
s_nop 7
buffer_store_dwordx4 v[204:207],v21,s[20:23],s84 offen offset:0 sc1
buffer_store_dwordx4 v[204:207],v21,s[20:23],s84 offen offset:1024 sc1
s_branch b2_151
b1_152:
s_nop 7
buffer_store_dwordx4 v[204:207],v21,s[20:23],s84 offen offset:2048 sc1
buffer_store_dwordx4 v[204:207],v21,s[20:23],s84 offen offset:3072 sc1
s_branch b2_153
b1_154:
s_nop 7
buffer_store_dwordx4 v[204:207],v21,s[20:23],s85 offen offset:0 sc1
buffer_store_dwordx4 v[204:207],v21,s[20:23],s85 offen offset:1024 sc1
s_branch b2_155
rt_157:
s_sub_u32 s90,s90,1
s_cmp_gt_i32 s90,0
s_cbranch_scc0 go_158
s_add_u32 s84,s74,s75
s_add_u32 s85,s84,4096
buffer_load_dwordx4 v[128:131],v0,s[20:23],s84 offen offset:0 sc1
buffer_load_dwordx4 v[132:135],v0,s[20:23],s84 offen offset:1024 sc1
buffer_load_dwordx4 v[136:139],v0,s[20:23],s84 offen offset:2048 sc1
buffer_load_dwordx4 v[140:143],v0,s[20:23],s84 offen offset:3072 sc1
buffer_load_dwordx4 v[144:147],v0,s[20:23],s85 offen offset:0 sc1
buffer_load_dwordx4 v[148:151],v0,s[20:23],s85 offen offset:1024 sc1
s_waitcnt vmcnt(0)
s_branch ck_156
b1_159:
s_nop 7
buffer_store_dwordx4 v[204:207],v21,s[20:23],s84 offen offset:0 sc1
buffer_store_dwordx4 v[204:207],v21,s[20:23],s84 offen offset:1024 sc1
s_branch b2_160
b1_161:
s_nop 7
buffer_store_dwordx4 v[204:207],v21,s[20:23],s84 offen offset:2048 sc1
buffer_store_dwordx4 v[204:207],v21,s[20:23],s84 offen offset:3072 sc1
s_branch b2_162
b1_163:
s_nop 7
buffer_store_dwordx4 v[204:207],v21,s[20:23],s85 offen offset:0 sc1
buffer_store_dwordx4 v[204:207],v21,s[20:23],s85 offen offset:1024 sc1
s_branch b2_164
rt_166:
s_sub_u32 s90,s90,1
s_cmp_gt_i32 s90,0
s_cbranch_scc0 go_167
s_add_u32 s84,s74,s75
s_add_u32 s85,s84,4096
buffer_load_dwordx4 v[128:131],v0,s[20:23],s84 offen offset:0 sc1
buffer_load_dwordx4 v[132:135],v0,s[20:23],s84 offen offset:1024 sc1
buffer_load_dwordx4 v[136:139],v0,s[20:23],s84 offen offset:2048 sc1
buffer_load_dwordx4 v[140:143],v0,s[20:23],s84 offen offset:3072 sc1
buffer_load_dwordx4 v[144:147],v0,s[20:23],s85 offen offset:0 sc1
buffer_load_dwordx4 v[148:151],v0,s[20:23],s85 offen offset:1024 sc1
s_waitcnt vmcnt(0)
s_branch ck_165
done_71:
s_endpgm
fl_w4:
v_and_b32 v21,15,v1
v_lshrrev_b32 v22,4,v1
v_lshrrev_b32 v23,2,v21
v_and_b32 v24,3,v21
s_lshl_b32 s61,s50,15
v_lshl_add_u32 v25,v22,3,v23
s_load_dwordx2 s[4:5],s[0:1],88
s_load_dwordx2 s[6:7],s[0:1],112
s_lshr_b32 s52,s59,3
s_and_b32 s53,s59,7
s_mul_i32 s54,s52,1835008
s_lshl_b32 s64,s53,8
s_add_u32 s54,s54,s64
s_lshl_b32 s64,s50,6
s_add_u32 s54,s54,s64
s_waitcnt lgkmcnt(0)
s_mov_b32 s28,s4
s_and_b32 s29,s5,0xffff
s_mov_b32 s30,0x700000
s_mov_b32 s31,0x20000
s_mov_b32 s24,s6
s_and_b32 s25,s7,0xffff
s_mov_b32 s26,0x400000
s_mov_b32 s27,0x20000
s_mov_b32 s92,s2
s_and_b32 s93,s3,0xffff
s_mov_b32 s94,0x100
s_mov_b32 s95,0x20000
v_mbcnt_lo_u32_b32 v16,-1,0
v_mbcnt_hi_u32_b32 v16,-1,v16
v_mov_b32 v18,0
v_cmp_eq_u32 vcc,17,v16
s_nop 1
v_cndmask_b32 v18,v18,63,vcc
v_and_b32 v19,1,v16
v_cmp_eq_u32 vcc,1,v19
v_mov_b32 v19,8192
s_nop 0
v_cndmask_b32 v19,-1,v19,vcc
v_min_u32 v16,31,v16
v_lshlrev_b32 v16,2,v16
s_sub_u32 s66,s88,64
s_cmp_lg_u32 s50,0
s_cbranch_scc1 vot_175
vpoll_171:
buffer_load_dword v17,v16,s[92:95],s66 offen sc1
s_waitcnt vmcnt(0)
s_cmp_lg_u32 s56,2
s_cbranch_scc1 vck_172
v_cmp_eq_u32 vcc,v17,v19
s_and_b32 s64,vcc_lo,0xffff
s_cmp_eq_u32 s64,65535
s_cbranch_scc1 vck_172
s_mov_b32 s65,0
v_readlane_b32 s64,v17,1
s_lshr_b32 s64,s64,8
s_add_u32 s65,s65,s64
v_readlane_b32 s64,v17,3
s_lshr_b32 s64,s64,8
s_add_u32 s65,s65,s64
v_readlane_b32 s64,v17,5
s_lshr_b32 s64,s64,8
s_add_u32 s65,s65,s64
v_readlane_b32 s64,v17,7
s_lshr_b32 s64,s64,8
s_add_u32 s65,s65,s64
v_readlane_b32 s64,v17,9
s_lshr_b32 s64,s64,8
s_add_u32 s65,s65,s64
v_readlane_b32 s64,v17,11
s_lshr_b32 s64,s64,8
s_add_u32 s65,s65,s64
v_readlane_b32 s64,v17,13
s_lshr_b32 s64,s64,8
s_add_u32 s65,s65,s64
v_readlane_b32 s64,v17,15
s_lshr_b32 s64,s64,8
s_add_u32 s65,s65,s64
s_cmp_ge_u32 s65,256
s_cbranch_scc1 vok_174
s_branch vrt_173
vck_172:
v_cmp_gt_u32 vcc,v18,v17
s_cbranch_vccz vok_174
vrt_173:
s_sleep 48
s_sub_u32 s90,s90,1
s_cmp_gt_i32 s90,0
s_cbranch_scc1 vpoll_171
vok_174:
v_add_u32 v18,159744,v16
ds_write_b32 v18,v17
s_waitcnt lgkmcnt(0)
vot_175:
s_barrier
v_add_u32 v18,159744,v16
ds_read_b32 v17,v18
s_waitcnt lgkmcnt(0)
s_cmp_lg_u32 s56,2
s_cbranch_scc1 vfin_176
v_cmp_eq_u32 vcc,v17,v19
s_and_b32 s64,vcc_lo,0xffff
s_cmp_eq_u32 s64,65535
s_cbranch_scc1 vfin_176
s_mov_b32 s65,0
v_readlane_b32 s64,v17,1
s_lshr_b32 s64,s64,8
s_add_u32 s65,s65,s64
v_readlane_b32 s64,v17,3
s_lshr_b32 s64,s64,8
s_add_u32 s65,s65,s64
v_readlane_b32 s64,v17,5
s_lshr_b32 s64,s64,8
s_add_u32 s65,s65,s64
v_readlane_b32 s64,v17,7
s_lshr_b32 s64,s64,8
s_add_u32 s65,s65,s64
v_readlane_b32 s64,v17,9
s_lshr_b32 s64,s64,8
s_add_u32 s65,s65,s64
v_readlane_b32 s64,v17,11
s_lshr_b32 s64,s64,8
s_add_u32 s65,s65,s64
v_readlane_b32 s64,v17,13
s_lshr_b32 s64,s64,8
s_add_u32 s65,s65,s64
v_readlane_b32 s64,v17,15
s_lshr_b32 s64,s64,8
s_add_u32 s65,s65,s64
s_cmp_ge_u32 s65,256
s_cbranch_scc1 fl_fb
vfin_176:
s_and_b32 s56,s56,1
v_lshrrev_b32 v26,2,v1
v_and_b32 v27,3,v1
v_mul_u32_u24 v16,2048,v26
v_lshl_add_u32 v16,v27,4,v16
v_lshlrev_b32 v17,6,v25
v_lshl_add_u32 v17,v24,4,v17
v_add_u32 v17,s61,v17
s_xor_b32 s62,s50,0
s_mul_i32 s62,s62,458752
s_add_u32 s62,s62,s54
s_add_u32 m0,s61,0
s_nop 0
buffer_load_dwordx4 v16,s[28:31],s62 offen lds
s_add_u32 s62,s62,32768
s_add_u32 m0,m0,1024
s_waitcnt vmcnt(6)
buffer_load_dwordx4 v16,s[28:31],s62 offen lds
s_add_u32 s62,s62,32768
s_add_u32 m0,m0,1024
s_waitcnt vmcnt(6)
buffer_load_dwordx4 v16,s[28:31],s62 offen lds
s_add_u32 s62,s62,32768
s_add_u32 m0,m0,1024
s_waitcnt vmcnt(6)
buffer_load_dwordx4 v16,s[28:31],s62 offen lds
s_add_u32 s62,s62,32768
s_add_u32 m0,m0,1024
s_waitcnt vmcnt(6)
buffer_load_dwordx4 v16,s[28:31],s62 offen lds
s_add_u32 s62,s62,32768
s_add_u32 m0,m0,1024
s_waitcnt vmcnt(6)
buffer_load_dwordx4 v16,s[28:31],s62 offen lds
s_add_u32 s62,s62,32768
s_add_u32 m0,m0,1024
s_waitcnt vmcnt(6)
buffer_load_dwordx4 v16,s[28:31],s62 offen lds
s_add_u32 s62,s62,32768
s_add_u32 m0,m0,1024
s_waitcnt vmcnt(6)
buffer_load_dwordx4 v16,s[28:31],s62 offen lds
s_add_u32 s62,s62,32768
s_add_u32 m0,m0,1024
s_waitcnt vmcnt(6)
buffer_load_dwordx4 v16,s[28:31],s62 offen lds
s_add_u32 s62,s62,32768
s_add_u32 m0,m0,1024
s_waitcnt vmcnt(6)
buffer_load_dwordx4 v16,s[28:31],s62 offen lds
s_add_u32 s62,s62,32768
s_add_u32 m0,m0,1024
s_waitcnt vmcnt(6)
buffer_load_dwordx4 v16,s[28:31],s62 offen lds
s_add_u32 s62,s62,32768
s_add_u32 m0,m0,1024
s_waitcnt vmcnt(6)
buffer_load_dwordx4 v16,s[28:31],s62 offen lds
s_add_u32 s62,s62,32768
s_add_u32 m0,m0,1024
s_waitcnt vmcnt(6)
buffer_load_dwordx4 v16,s[28:31],s62 offen lds
s_add_u32 s62,s62,32768
s_add_u32 m0,m0,1024
s_waitcnt vmcnt(6)
buffer_load_dwordx4 v16,s[28:31],s62 offen lds
s_waitcnt vmcnt(6)
s_xor_b32 s62,s50,1
s_mul_i32 s62,s62,458752
s_add_u32 s62,s62,s54
s_add_u32 m0,s61,16384
s_nop 0
buffer_load_dwordx4 v16,s[28:31],s62 offen lds
s_add_u32 s62,s62,32768
s_add_u32 m0,m0,1024
s_waitcnt vmcnt(6)
buffer_load_dwordx4 v16,s[28:31],s62 offen lds
s_add_u32 s62,s62,32768
s_add_u32 m0,m0,1024
s_waitcnt vmcnt(6)
buffer_load_dwordx4 v16,s[28:31],s62 offen lds
s_add_u32 s62,s62,32768
s_add_u32 m0,m0,1024
s_waitcnt vmcnt(6)
buffer_load_dwordx4 v16,s[28:31],s62 offen lds
s_add_u32 s62,s62,32768
s_add_u32 m0,m0,1024
s_waitcnt vmcnt(6)
buffer_load_dwordx4 v16,s[28:31],s62 offen lds
s_add_u32 s62,s62,32768
s_add_u32 m0,m0,1024
s_waitcnt vmcnt(6)
buffer_load_dwordx4 v16,s[28:31],s62 offen lds
s_add_u32 s62,s62,32768
s_add_u32 m0,m0,1024
s_waitcnt vmcnt(6)
buffer_load_dwordx4 v16,s[28:31],s62 offen lds
s_add_u32 s62,s62,32768
s_add_u32 m0,m0,1024
s_waitcnt vmcnt(6)
buffer_load_dwordx4 v16,s[28:31],s62 offen lds
s_add_u32 s62,s62,32768
s_add_u32 m0,m0,1024
s_waitcnt vmcnt(6)
buffer_load_dwordx4 v16,s[28:31],s62 offen lds
s_add_u32 s62,s62,32768
s_add_u32 m0,m0,1024
s_waitcnt vmcnt(6)
buffer_load_dwordx4 v16,s[28:31],s62 offen lds
s_add_u32 s62,s62,32768
s_add_u32 m0,m0,1024
s_waitcnt vmcnt(6)
buffer_load_dwordx4 v16,s[28:31],s62 offen lds
s_add_u32 s62,s62,32768
s_add_u32 m0,m0,1024
s_waitcnt vmcnt(6)
buffer_load_dwordx4 v16,s[28:31],s62 offen lds
s_add_u32 s62,s62,32768
s_add_u32 m0,m0,1024
s_waitcnt vmcnt(6)
buffer_load_dwordx4 v16,s[28:31],s62 offen lds
s_add_u32 s62,s62,32768
s_add_u32 m0,m0,1024
s_waitcnt vmcnt(6)
buffer_load_dwordx4 v16,s[28:31],s62 offen lds
s_waitcnt vmcnt(6)
s_waitcnt vmcnt(14)
ds_read_b64_tr_b16 a[0:1],v17 offset:0
ds_read_b64_tr_b16 a[2:3],v17 offset:256
ds_read_b64_tr_b16 a[4:5],v17 offset:8
ds_read_b64_tr_b16 a[6:7],v17 offset:264
ds_read_b64_tr_b16 a[8:9],v17 offset:2048
ds_read_b64_tr_b16 a[10:11],v17 offset:2304
ds_read_b64_tr_b16 a[12:13],v17 offset:2056
ds_read_b64_tr_b16 a[14:15],v17 offset:2312
ds_read_b64_tr_b16 a[16:17],v17 offset:4096
ds_read_b64_tr_b16 a[18:19],v17 offset:4352
ds_read_b64_tr_b16 a[20:21],v17 offset:4104
ds_read_b64_tr_b16 a[22:23],v17 offset:4360
s_waitcnt lgkmcnt(0)
ds_read_b64_tr_b16 a[24:25],v17 offset:6144
ds_read_b64_tr_b16 a[26:27],v17 offset:6400
ds_read_b64_tr_b16 a[28:29],v17 offset:6152
ds_read_b64_tr_b16 a[30:31],v17 offset:6408
ds_read_b64_tr_b16 a[32:33],v17 offset:8192
ds_read_b64_tr_b16 a[34:35],v17 offset:8448
ds_read_b64_tr_b16 a[36:37],v17 offset:8200
ds_read_b64_tr_b16 a[38:39],v17 offset:8456
ds_read_b64_tr_b16 a[40:41],v17 offset:10240
ds_read_b64_tr_b16 a[42:43],v17 offset:10496
ds_read_b64_tr_b16 a[44:45],v17 offset:10248
ds_read_b64_tr_b16 a[46:47],v17 offset:10504
s_waitcnt lgkmcnt(0)
ds_read_b64_tr_b16 a[48:49],v17 offset:12288
ds_read_b64_tr_b16 a[50:51],v17 offset:12544
ds_read_b64_tr_b16 a[52:53],v17 offset:12296
ds_read_b64_tr_b16 a[54:55],v17 offset:12552
s_waitcnt lgkmcnt(0)
s_xor_b32 s62,s50,2
s_mul_i32 s62,s62,458752
s_add_u32 s62,s62,s54
s_add_u32 m0,s61,0
s_nop 0
buffer_load_dwordx4 v16,s[28:31],s62 offen lds
s_add_u32 s62,s62,32768
s_add_u32 m0,m0,1024
s_waitcnt vmcnt(6)
buffer_load_dwordx4 v16,s[28:31],s62 offen lds
s_add_u32 s62,s62,32768
s_add_u32 m0,m0,1024
s_waitcnt vmcnt(6)
buffer_load_dwordx4 v16,s[28:31],s62 offen lds
s_add_u32 s62,s62,32768
s_add_u32 m0,m0,1024
s_waitcnt vmcnt(6)
buffer_load_dwordx4 v16,s[28:31],s62 offen lds
s_add_u32 s62,s62,32768
s_add_u32 m0,m0,1024
s_waitcnt vmcnt(6)
buffer_load_dwordx4 v16,s[28:31],s62 offen lds
s_add_u32 s62,s62,32768
s_add_u32 m0,m0,1024
s_waitcnt vmcnt(6)
buffer_load_dwordx4 v16,s[28:31],s62 offen lds
s_add_u32 s62,s62,32768
s_add_u32 m0,m0,1024
s_waitcnt vmcnt(6)
buffer_load_dwordx4 v16,s[28:31],s62 offen lds
s_add_u32 s62,s62,32768
s_add_u32 m0,m0,1024
s_waitcnt vmcnt(6)
buffer_load_dwordx4 v16,s[28:31],s62 offen lds
s_add_u32 s62,s62,32768
s_add_u32 m0,m0,1024
s_waitcnt vmcnt(6)
buffer_load_dwordx4 v16,s[28:31],s62 offen lds
s_add_u32 s62,s62,32768
s_add_u32 m0,m0,1024
s_waitcnt vmcnt(6)
buffer_load_dwordx4 v16,s[28:31],s62 offen lds
s_add_u32 s62,s62,32768
s_add_u32 m0,m0,1024
s_waitcnt vmcnt(6)
buffer_load_dwordx4 v16,s[28:31],s62 offen lds
s_add_u32 s62,s62,32768
s_add_u32 m0,m0,1024
s_waitcnt vmcnt(6)
buffer_load_dwordx4 v16,s[28:31],s62 offen lds
s_add_u32 s62,s62,32768
s_add_u32 m0,m0,1024
s_waitcnt vmcnt(6)
buffer_load_dwordx4 v16,s[28:31],s62 offen lds
s_add_u32 s62,s62,32768
s_add_u32 m0,m0,1024
s_waitcnt vmcnt(6)
buffer_load_dwordx4 v16,s[28:31],s62 offen lds
s_waitcnt vmcnt(6)
s_waitcnt vmcnt(14)
ds_read_b64_tr_b16 a[56:57],v17 offset:16384
ds_read_b64_tr_b16 a[58:59],v17 offset:16640
ds_read_b64_tr_b16 a[60:61],v17 offset:16392
ds_read_b64_tr_b16 a[62:63],v17 offset:16648
ds_read_b64_tr_b16 a[64:65],v17 offset:18432
ds_read_b64_tr_b16 a[66:67],v17 offset:18688
ds_read_b64_tr_b16 a[68:69],v17 offset:18440
ds_read_b64_tr_b16 a[70:71],v17 offset:18696
ds_read_b64_tr_b16 a[72:73],v17 offset:20480
ds_read_b64_tr_b16 a[74:75],v17 offset:20736
ds_read_b64_tr_b16 a[76:77],v17 offset:20488
ds_read_b64_tr_b16 a[78:79],v17 offset:20744
s_waitcnt lgkmcnt(0)
ds_read_b64_tr_b16 a[80:81],v17 offset:22528
ds_read_b64_tr_b16 a[82:83],v17 offset:22784
ds_read_b64_tr_b16 a[84:85],v17 offset:22536
ds_read_b64_tr_b16 a[86:87],v17 offset:22792
ds_read_b64_tr_b16 a[88:89],v17 offset:24576
ds_read_b64_tr_b16 a[90:91],v17 offset:24832
ds_read_b64_tr_b16 a[92:93],v17 offset:24584
ds_read_b64_tr_b16 a[94:95],v17 offset:24840
ds_read_b64_tr_b16 a[96:97],v17 offset:26624
ds_read_b64_tr_b16 a[98:99],v17 offset:26880
ds_read_b64_tr_b16 a[100:101],v17 offset:26632
ds_read_b64_tr_b16 a[102:103],v17 offset:26888
s_waitcnt lgkmcnt(0)
ds_read_b64_tr_b16 a[104:105],v17 offset:28672
ds_read_b64_tr_b16 a[106:107],v17 offset:28928
ds_read_b64_tr_b16 a[108:109],v17 offset:28680
ds_read_b64_tr_b16 a[110:111],v17 offset:28936
s_waitcnt lgkmcnt(0)
s_xor_b32 s62,s50,3
s_mul_i32 s62,s62,458752
s_add_u32 s62,s62,s54
s_add_u32 m0,s61,16384
s_nop 0
buffer_load_dwordx4 v16,s[28:31],s62 offen lds
s_add_u32 s62,s62,32768
s_add_u32 m0,m0,1024
s_waitcnt vmcnt(6)
buffer_load_dwordx4 v16,s[28:31],s62 offen lds
s_add_u32 s62,s62,32768
s_add_u32 m0,m0,1024
s_waitcnt vmcnt(6)
buffer_load_dwordx4 v16,s[28:31],s62 offen lds
s_add_u32 s62,s62,32768
s_add_u32 m0,m0,1024
s_waitcnt vmcnt(6)
buffer_load_dwordx4 v16,s[28:31],s62 offen lds
s_add_u32 s62,s62,32768
s_add_u32 m0,m0,1024
s_waitcnt vmcnt(6)
buffer_load_dwordx4 v16,s[28:31],s62 offen lds
s_add_u32 s62,s62,32768
s_add_u32 m0,m0,1024
s_waitcnt vmcnt(6)
buffer_load_dwordx4 v16,s[28:31],s62 offen lds
s_add_u32 s62,s62,32768
s_add_u32 m0,m0,1024
s_waitcnt vmcnt(6)
buffer_load_dwordx4 v16,s[28:31],s62 offen lds
s_add_u32 s62,s62,32768
s_add_u32 m0,m0,1024
s_waitcnt vmcnt(6)
buffer_load_dwordx4 v16,s[28:31],s62 offen lds
s_add_u32 s62,s62,32768
s_add_u32 m0,m0,1024
s_waitcnt vmcnt(6)
buffer_load_dwordx4 v16,s[28:31],s62 offen lds
s_add_u32 s62,s62,32768
s_add_u32 m0,m0,1024
s_waitcnt vmcnt(6)
buffer_load_dwordx4 v16,s[28:31],s62 offen lds
s_add_u32 s62,s62,32768
s_add_u32 m0,m0,1024
s_waitcnt vmcnt(6)
buffer_load_dwordx4 v16,s[28:31],s62 offen lds
s_add_u32 s62,s62,32768
s_add_u32 m0,m0,1024
s_waitcnt vmcnt(6)
buffer_load_dwordx4 v16,s[28:31],s62 offen lds
s_add_u32 s62,s62,32768
s_add_u32 m0,m0,1024
s_waitcnt vmcnt(6)
buffer_load_dwordx4 v16,s[28:31],s62 offen lds
s_add_u32 s62,s62,32768
s_add_u32 m0,m0,1024
s_waitcnt vmcnt(6)
buffer_load_dwordx4 v16,s[28:31],s62 offen lds
s_waitcnt vmcnt(6)
s_waitcnt vmcnt(14)
ds_read_b64_tr_b16 a[112:113],v17 offset:0
ds_read_b64_tr_b16 a[114:115],v17 offset:256
ds_read_b64_tr_b16 a[116:117],v17 offset:8
ds_read_b64_tr_b16 a[118:119],v17 offset:264
ds_read_b64_tr_b16 a[120:121],v17 offset:2048
ds_read_b64_tr_b16 a[122:123],v17 offset:2304
ds_read_b64_tr_b16 a[124:125],v17 offset:2056
ds_read_b64_tr_b16 a[126:127],v17 offset:2312
ds_read_b64_tr_b16 a[128:129],v17 offset:4096
ds_read_b64_tr_b16 a[130:131],v17 offset:4352
ds_read_b64_tr_b16 a[132:133],v17 offset:4104
ds_read_b64_tr_b16 a[134:135],v17 offset:4360
s_waitcnt lgkmcnt(0)
ds_read_b64_tr_b16 a[136:137],v17 offset:6144
ds_read_b64_tr_b16 a[138:139],v17 offset:6400
ds_read_b64_tr_b16 a[140:141],v17 offset:6152
ds_read_b64_tr_b16 a[142:143],v17 offset:6408
ds_read_b64_tr_b16 a[144:145],v17 offset:8192
ds_read_b64_tr_b16 a[146:147],v17 offset:8448
ds_read_b64_tr_b16 a[148:149],v17 offset:8200
ds_read_b64_tr_b16 a[150:151],v17 offset:8456
ds_read_b64_tr_b16 a[152:153],v17 offset:10240
ds_read_b64_tr_b16 a[154:155],v17 offset:10496
ds_read_b64_tr_b16 a[156:157],v17 offset:10248
ds_read_b64_tr_b16 a[158:159],v17 offset:10504
s_waitcnt lgkmcnt(0)
ds_read_b64_tr_b16 a[160:161],v17 offset:12288
ds_read_b64_tr_b16 a[162:163],v17 offset:12544
ds_read_b64_tr_b16 a[164:165],v17 offset:12296
ds_read_b64_tr_b16 a[166:167],v17 offset:12552
s_waitcnt lgkmcnt(0)
s_waitcnt vmcnt(0)
ds_read_b64_tr_b16 a[168:169],v17 offset:16384
ds_read_b64_tr_b16 a[170:171],v17 offset:16640
ds_read_b64_tr_b16 a[172:173],v17 offset:16392
ds_read_b64_tr_b16 a[174:175],v17 offset:16648
ds_read_b64_tr_b16 a[176:177],v17 offset:18432
ds_read_b64_tr_b16 a[178:179],v17 offset:18688
ds_read_b64_tr_b16 a[180:181],v17 offset:18440
ds_read_b64_tr_b16 a[182:183],v17 offset:18696
ds_read_b64_tr_b16 a[184:185],v17 offset:20480
ds_read_b64_tr_b16 a[186:187],v17 offset:20736
ds_read_b64_tr_b16 a[188:189],v17 offset:20488
ds_read_b64_tr_b16 a[190:191],v17 offset:20744
s_waitcnt lgkmcnt(0)
ds_read_b64_tr_b16 a[192:193],v17 offset:22528
ds_read_b64_tr_b16 a[194:195],v17 offset:22784
ds_read_b64_tr_b16 a[196:197],v17 offset:22536
ds_read_b64_tr_b16 a[198:199],v17 offset:22792
ds_read_b64_tr_b16 a[200:201],v17 offset:24576
ds_read_b64_tr_b16 a[202:203],v17 offset:24832
ds_read_b64_tr_b16 a[204:205],v17 offset:24584
ds_read_b64_tr_b16 a[206:207],v17 offset:24840
ds_read_b64_tr_b16 a[208:209],v17 offset:26624
ds_read_b64_tr_b16 a[210:211],v17 offset:26880
ds_read_b64_tr_b16 a[212:213],v17 offset:26632
ds_read_b64_tr_b16 a[214:215],v17 offset:26888
s_waitcnt lgkmcnt(0)
ds_read_b64_tr_b16 a[216:217],v17 offset:28672
ds_read_b64_tr_b16 a[218:219],v17 offset:28928
ds_read_b64_tr_b16 a[220:221],v17 offset:28680
ds_read_b64_tr_b16 a[222:223],v17 offset:28936
s_waitcnt lgkmcnt(0)
s_mov_b32 s92,s2
s_and_b32 s93,s3,0xffff
s_mov_b32 s94,0x100
s_mov_b32 s95,0x20000
v_mbcnt_lo_u32_b32 v16,-1,0
v_mbcnt_hi_u32_b32 v16,-1,v16
v_mov_b32 v18,0
v_cmp_eq_u32 vcc,22,v16
s_nop 1
v_cndmask_b32 v18,v18,63,vcc
v_cmp_eq_u32 vcc,17,v16
s_nop 1
v_cndmask_b32 v18,v18,63,vcc
v_cmp_eq_u32 vcc,18,v16
s_nop 1
v_cndmask_b32 v18,v18,1,vcc
v_and_b32 v19,1,v16
v_cmp_eq_u32 vcc,1,v19
v_mov_b32 v19,8192
s_nop 0
v_cndmask_b32 v19,-1,v19,vcc
v_min_u32 v16,31,v16
v_lshlrev_b32 v16,2,v16
s_sub_u32 s66,s88,64
s_cmp_lg_u32 s50,0
s_cbranch_scc1 vot_181
vpoll_177:
buffer_load_dword v17,v16,s[92:95],s66 offen sc1
s_waitcnt vmcnt(0)
s_cmp_lg_u32 s56,2
s_cbranch_scc1 vck_178
v_cmp_eq_u32 vcc,v17,v19
s_and_b32 s64,vcc_lo,0xffff
s_cmp_eq_u32 s64,65535
s_cbranch_scc1 vck_178
s_mov_b32 s65,0
v_readlane_b32 s64,v17,1
s_lshr_b32 s64,s64,8
s_add_u32 s65,s65,s64
v_readlane_b32 s64,v17,3
s_lshr_b32 s64,s64,8
s_add_u32 s65,s65,s64
v_readlane_b32 s64,v17,5
s_lshr_b32 s64,s64,8
s_add_u32 s65,s65,s64
v_readlane_b32 s64,v17,7
s_lshr_b32 s64,s64,8
s_add_u32 s65,s65,s64
v_readlane_b32 s64,v17,9
s_lshr_b32 s64,s64,8
s_add_u32 s65,s65,s64
v_readlane_b32 s64,v17,11
s_lshr_b32 s64,s64,8
s_add_u32 s65,s65,s64
v_readlane_b32 s64,v17,13
s_lshr_b32 s64,s64,8
s_add_u32 s65,s65,s64
v_readlane_b32 s64,v17,15
s_lshr_b32 s64,s64,8
s_add_u32 s65,s65,s64
s_cmp_ge_u32 s65,256
s_cbranch_scc1 vok_180
s_branch vrt_179
vck_178:
v_cmp_gt_u32 vcc,v18,v17
s_cbranch_vccz vok_180
vrt_179:
s_sleep 48
s_sub_u32 s90,s90,1
s_cmp_gt_i32 s90,0
s_cbranch_scc1 vpoll_177
vok_180:
v_add_u32 v18,160000,v16
ds_write_b32 v18,v17
s_waitcnt lgkmcnt(0)
vot_181:
s_barrier
v_add_u32 v18,160000,v16
ds_read_b32 v17,v18
s_waitcnt lgkmcnt(0)
s_cmp_lg_u32 s56,2
s_cbranch_scc1 vfin_182
v_cmp_eq_u32 vcc,v17,v19
s_and_b32 s64,vcc_lo,0xffff
s_cmp_eq_u32 s64,65535
s_cbranch_scc1 vfin_182
s_mov_b32 s65,0
v_readlane_b32 s64,v17,1
s_lshr_b32 s64,s64,8
s_add_u32 s65,s65,s64
v_readlane_b32 s64,v17,3
s_lshr_b32 s64,s64,8
s_add_u32 s65,s65,s64
v_readlane_b32 s64,v17,5
s_lshr_b32 s64,s64,8
s_add_u32 s65,s65,s64
v_readlane_b32 s64,v17,7
s_lshr_b32 s64,s64,8
s_add_u32 s65,s65,s64
v_readlane_b32 s64,v17,9
s_lshr_b32 s64,s64,8
s_add_u32 s65,s65,s64
v_readlane_b32 s64,v17,11
s_lshr_b32 s64,s64,8
s_add_u32 s65,s65,s64
v_readlane_b32 s64,v17,13
s_lshr_b32 s64,s64,8
s_add_u32 s65,s65,s64
v_readlane_b32 s64,v17,15
s_lshr_b32 s64,s64,8
s_add_u32 s65,s65,s64
s_cmp_ge_u32 s65,256
s_cbranch_scc1 fl_fb
vfin_182:
s_and_b32 s56,s56,1
s_mov_b32 s67,0
s_barrier
v_lshlrev_b32 v0,4,v1
s_mov_b32 s60,0
s_lshl_b32 s70,s50,13
s_mov_b32 s55,0
v_mov_b32 v3,v0
s_mov_b32 s73,0xffff0000
s_lshl_b32 s64,s52,2
s_add_u32 s64,s64,s50
s_mul_i32 s61,s64,7168
s_add_u32 s61,s61,219152384
s_lshl_b32 s68,s64,8
s_add_u32 s68,s68,138551296
s_lshl_b32 s83,s53,2
s_add_u32 s83,s83,s50
s_mov_b32 s63,0
s_xor_b32 s64,s50,0
s_lshl_b32 s64,s64,13
v_add_u32 v8,s64,v0
v_mov_b32 v4,v8
s_xor_b32 s64,s50,1
s_lshl_b32 s64,s64,13
v_add_u32 v9,s64,v0
v_mov_b32 v5,v9
s_xor_b32 s64,s50,2
s_lshl_b32 s64,s64,13
v_add_u32 v10,s64,v0
v_mov_b32 v6,v10
s_xor_b32 s64,s50,3
s_lshl_b32 s64,s64,13
v_add_u32 v11,s64,v0
v_mov_b32 v7,v11
v_min_u32 v2,6,v1
v_lshlrev_b32 v2,2,v2
s_add_u32 s62,s61,4096
s_lshl_b32 s66,s83,10
s_lshr_b32 s65,s83,3
s_lshl_b32 s65,s65,8
s_and_b32 s64,s83,7
s_lshl_b32 s64,s64,2
s_add_u32 s69,s64,s65
s_add_u32 s69,s69,138555392
s_add_u32 s82,s66,201326592
s_lshl_b32 s64,s53,2
s_add_u32 s64,s64,s50
s_mul_i32 s74,s64,24576
s_xor_b32 s64,s50,s52
s_sub_u32 s64,s64,1
s_max_i32 s64,s64,0
s_lshl_b32 s64,s64,11
s_add_u32 s74,s74,s64
s_add_u32 s74,s74,168558592
s_mov_b32 s75,0
s_mov_b32 s77,0
v_lshlrev_b32 v26,11,v21
v_lshl_add_u32 v26,v22,4,v26
s_lshl_b32 s64,s83,6
v_add_u32 v18,s64,v26
v_lshlrev_b32 v26,5,v22
s_lshl_b32 s64,s83,7
s_add_u32 s64,s64,267407360
buffer_load_dwordx4 v[152:155],v26,s[20:23],s64 offen offset:0 sc1
buffer_load_dwordx4 v[156:159],v26,s[20:23],s64 offen offset:16 sc1
s_add_u32 s64,s64,24576
buffer_load_dwordx4 v[128:131],v26,s[20:23],s64 offen offset:0 sc1
buffer_load_dwordx4 v[132:135],v26,s[20:23],s64 offen offset:16 sc1
s_add_u32 s64,s64,24576
buffer_load_dwordx4 v[136:139],v26,s[20:23],s64 offen offset:0 sc1
buffer_load_dwordx4 v[140:143],v26,s[20:23],s64 offen offset:16 sc1
s_add_u32 s64,s64,24576
buffer_load_dwordx4 v[144:147],v26,s[20:23],s64 offen offset:0 sc1
buffer_load_dwordx4 v[148:151],v26,s[20:23],s64 offen offset:16 sc1
s_add_u32 s64,s64,24576
s_waitcnt vmcnt(0)
v_pk_add_f32 v[152:153],v[152:153],v[128:129]
v_pk_add_f32 v[136:137],v[136:137],v[144:145]
v_pk_add_f32 v[154:155],v[154:155],v[130:131]
v_pk_add_f32 v[138:139],v[138:139],v[146:147]
v_pk_add_f32 v[156:157],v[156:157],v[132:133]
v_pk_add_f32 v[140:141],v[140:141],v[148:149]
v_pk_add_f32 v[158:159],v[158:159],v[134:135]
v_pk_add_f32 v[142:143],v[142:143],v[150:151]
v_pk_add_f32 v[152:153],v[152:153],v[136:137]
v_pk_add_f32 v[154:155],v[154:155],v[138:139]
v_pk_add_f32 v[156:157],v[156:157],v[140:141]
v_pk_add_f32 v[158:159],v[158:159],v[142:143]
v_cvt_pk_bf16_f32 v128,v152,v153
v_cvt_pk_bf16_f32 v129,v154,v155
v_cvt_pk_bf16_f32 v130,v156,v157
v_cvt_pk_bf16_f32 v131,v158,v159
v_lshlrev_b32 v152,16,v128
v_and_b32 v153,s73,v128
v_lshlrev_b32 v154,16,v129
v_and_b32 v155,s73,v129
v_lshlrev_b32 v156,16,v130
v_and_b32 v157,s73,v130
v_lshlrev_b32 v158,16,v131
v_and_b32 v159,s73,v131
v_mov_b32 v204,-1
v_mov_b32 v205,-1
v_mov_b32 v206,-1
v_mov_b32 v207,-1
v_cmp_eq_u32 vcc,0,v1
s_nop 1
v_cndmask_b32 v26,2.0,0,vcc
s_cmp_eq_u32 s50,s52
s_cbranch_scc1 lfin_183
s_add_u32 s71,s60,1
s_add_u32 s53,s60,2
plp_193:
buffer_load_dword v16,v2,s[20:23],s68 offen sc1
s_waitcnt vmcnt(0)
v_cmp_gt_u32 vcc,s71,v16
s_cbranch_vccz pok_194
s_sleep 4
s_sub_u32 s90,s90,1
s_cmp_gt_i32 s90,0
s_cbranch_scc1 plp_193
pok_194:
lag_190:
s_mov_b32 m0,s70
s_nop 0
buffer_load_dwordx4 v3,s[20:23],s61 offen offset:0 lds
buffer_load_dwordx4 v3,s[20:23],s61 offen offset:1024 lds
buffer_load_dwordx4 v3,s[20:23],s61 offen offset:2048 lds
buffer_load_dwordx4 v3,s[20:23],s61 offen offset:3072 lds
s_add_u32 m0,s70,4096
s_nop 0
buffer_load_dwordx4 v3,s[20:23],s62 offen offset:0 lds
buffer_load_dwordx4 v3,s[20:23],s62 offen offset:1024 lds
buffer_load_dwordx4 v3,s[20:23],s62 offen offset:2048 lds
s_add_u32 s61,s61,114688
s_add_u32 s62,s62,114688
s_add_u32 s70,s70,32768
s_and_b32 s70,s70,0x1ffff
buffer_load_dword v23,off,s[20:23],s66
buffer_load_dword v23,off,s[20:23],s66
dec_191:
v_cmp_gt_u32 vcc,s53,v16
s_cbranch_vccnz BN_189
BR_188:
s_waitcnt vmcnt(8)
ds_read_b128 v[64:67],v4 offset:0
s_waitcnt vmcnt(7)
ds_read_b128 v[68:71],v4 offset:1024
s_waitcnt vmcnt(6)
ds_read_b128 v[72:75],v4 offset:2048
s_waitcnt vmcnt(5)
ds_read_b128 v[76:79],v4 offset:3072
s_waitcnt lgkmcnt(3)
v_mfma_f32_16x16x32_bf16 v[32:35],a[0:3],v[64:67],0
s_add_u32 s71,s60,2
s_add_u32 s53,s60,3
v_mfma_f32_16x16x32_bf16 v[36:39],a[4:7],v[64:67],0
s_waitcnt lgkmcnt(2)
s_waitcnt vmcnt(4)
ds_read_b128 v[80:83],v4 offset:4096
v_mfma_f32_16x16x32_bf16 v[32:35],a[8:11],v[68:71],v[32:35]
v_mfma_f32_16x16x32_bf16 v[36:39],a[12:15],v[68:71],v[36:39]
s_waitcnt lgkmcnt(2)
s_waitcnt vmcnt(3)
s_mov_b32 m0,s70
ds_read_b128 v[84:87],v4 offset:5120
v_mfma_f32_16x16x32_bf16 v[32:35],a[16:19],v[72:75],v[32:35]
buffer_load_dwordx4 v3,s[20:23],s61 offen offset:0 lds
v_mfma_f32_16x16x32_bf16 v[36:39],a[20:23],v[72:75],v[36:39]
s_waitcnt lgkmcnt(2)
s_waitcnt vmcnt(3)
ds_read_b128 v[88:91],v4 offset:6144
v_mfma_f32_16x16x32_bf16 v[32:35],a[24:27],v[76:79],v[32:35]
buffer_load_dwordx4 v3,s[20:23],s61 offen offset:1024 lds
v_mfma_f32_16x16x32_bf16 v[36:39],a[28:31],v[76:79],v[36:39]
s_waitcnt lgkmcnt(2)
s_barrier
ds_read_b128 v[92:95],v5 offset:0
v_mfma_f32_16x16x32_bf16 v[32:35],a[32:35],v[80:83],v[32:35]
ds_read_b128 v[96:99],v5 offset:1024
v_mfma_f32_16x16x32_bf16 v[36:39],a[36:39],v[80:83],v[36:39]
s_waitcnt lgkmcnt(3)
ds_read_b128 v[100:103],v5 offset:2048
buffer_load_dwordx4 v3,s[20:23],s61 offen offset:2048 lds
v_mfma_f32_16x16x32_bf16 v[32:35],a[40:43],v[84:87],v[32:35]
ds_read_b128 v[104:107],v5 offset:3072
v_mfma_f32_16x16x32_bf16 v[36:39],a[44:47],v[84:87],v[36:39]
s_waitcnt lgkmcnt(4)
ds_read_b128 v[108:111],v5 offset:4096
v_mfma_f32_16x16x32_bf16 v[32:35],a[48:51],v[88:91],v[32:35]
ds_read_b128 v[112:115],v5 offset:5120
buffer_load_dwordx4 v3,s[20:23],s61 offen offset:3072 lds
v_mfma_f32_16x16x32_bf16 v[36:39],a[52:55],v[88:91],v[36:39]
s_waitcnt lgkmcnt(5)
v_mfma_f32_16x16x32_bf16 v[32:35],a[56:59],v[92:95],v[32:35]
ds_read_b128 v[116:119],v5 offset:6144
v_mfma_f32_16x16x32_bf16 v[36:39],a[60:63],v[92:95],v[36:39]
s_waitcnt lgkmcnt(5)
s_add_u32 m0,s70,4096
v_mfma_f32_16x16x32_bf16 v[32:35],a[64:67],v[96:99],v[32:35]
ds_read_b128 v[120:123],v6 offset:0
buffer_load_dwordx4 v3,s[20:23],s62 offen offset:0 lds
v_mfma_f32_16x16x32_bf16 v[36:39],a[68:71],v[96:99],v[36:39]
s_waitcnt lgkmcnt(5)
v_mfma_f32_16x16x32_bf16 v[32:35],a[72:75],v[100:103],v[32:35]
ds_read_b128 v[124:127],v6 offset:1024
v_mfma_f32_16x16x32_bf16 v[36:39],a[76:79],v[100:103],v[36:39]
s_waitcnt lgkmcnt(5)
buffer_load_dwordx4 v3,s[20:23],s62 offen offset:1024 lds
v_mfma_f32_16x16x32_bf16 v[32:35],a[80:83],v[104:107],v[32:35]
ds_read_b128 v[64:67],v6 offset:2048
v_mfma_f32_16x16x32_bf16 v[36:39],a[84:87],v[104:107],v[36:39]
s_waitcnt lgkmcnt(5)
buffer_load_dword v16,v2,s[20:23],s68 offen sc1
v_mfma_f32_16x16x32_bf16 v[32:35],a[88:91],v[108:111],v[32:35]
ds_read_b128 v[68:71],v6 offset:3072
buffer_load_dwordx4 v3,s[20:23],s62 offen offset:2048 lds
v_mfma_f32_16x16x32_bf16 v[36:39],a[92:95],v[108:111],v[36:39]
s_waitcnt lgkmcnt(5)
v_mfma_f32_16x16x32_bf16 v[32:35],a[96:99],v[112:115],v[32:35]
ds_read_b128 v[72:75],v6 offset:4096
v_mfma_f32_16x16x32_bf16 v[36:39],a[100:103],v[112:115],v[36:39]
s_waitcnt lgkmcnt(5)
v_mfma_f32_16x16x32_bf16 v[32:35],a[104:107],v[116:119],v[32:35]
ds_read_b128 v[76:79],v6 offset:5120
v_mfma_f32_16x16x32_bf16 v[36:39],a[108:111],v[116:119],v[36:39]
s_waitcnt lgkmcnt(5)
v_mfma_f32_16x16x32_bf16 v[32:35],a[112:115],v[120:123],v[32:35]
ds_read_b128 v[80:83],v6 offset:6144
v_mfma_f32_16x16x32_bf16 v[36:39],a[116:119],v[120:123],v[36:39]
s_waitcnt lgkmcnt(5)
v_mfma_f32_16x16x32_bf16 v[32:35],a[120:123],v[124:127],v[32:35]
ds_read_b128 v[84:87],v7 offset:0
v_mfma_f32_16x16x32_bf16 v[36:39],a[124:127],v[124:127],v[36:39]
s_waitcnt lgkmcnt(5)
v_mfma_f32_16x16x32_bf16 v[32:35],a[128:131],v[64:67],v[32:35]
ds_read_b128 v[88:91],v7 offset:1024
v_mfma_f32_16x16x32_bf16 v[36:39],a[132:135],v[64:67],v[36:39]
s_waitcnt lgkmcnt(5)
v_mfma_f32_16x16x32_bf16 v[32:35],a[136:139],v[68:71],v[32:35]
ds_read_b128 v[92:95],v7 offset:2048
v_mfma_f32_16x16x32_bf16 v[36:39],a[140:143],v[68:71],v[36:39]
s_waitcnt lgkmcnt(5)
v_mfma_f32_16x16x32_bf16 v[32:35],a[144:147],v[72:75],v[32:35]
ds_read_b128 v[96:99],v7 offset:3072
v_mfma_f32_16x16x32_bf16 v[36:39],a[148:151],v[72:75],v[36:39]
s_waitcnt lgkmcnt(5)
v_mfma_f32_16x16x32_bf16 v[32:35],a[152:155],v[76:79],v[32:35]
ds_read_b128 v[100:103],v7 offset:4096
v_mfma_f32_16x16x32_bf16 v[36:39],a[156:159],v[76:79],v[36:39]
s_waitcnt lgkmcnt(5)
v_mfma_f32_16x16x32_bf16 v[32:35],a[160:163],v[80:83],v[32:35]
ds_read_b128 v[104:107],v7 offset:5120
v_mfma_f32_16x16x32_bf16 v[36:39],a[164:167],v[80:83],v[36:39]
s_waitcnt lgkmcnt(5)
v_mfma_f32_16x16x32_bf16 v[32:35],a[168:171],v[84:87],v[32:35]
ds_read_b128 v[108:111],v7 offset:6144
v_mfma_f32_16x16x32_bf16 v[36:39],a[172:175],v[84:87],v[36:39]
s_waitcnt lgkmcnt(5)
s_add_u32 s61,s61,114688
s_add_u32 s62,s62,114688
v_mfma_f32_16x16x32_bf16 v[32:35],a[176:179],v[88:91],v[32:35]
s_add_u32 s70,s70,32768
s_and_b32 s70,s70,0x1ffff
s_add_u32 s55,s55,32768
v_mfma_f32_16x16x32_bf16 v[36:39],a[180:183],v[88:91],v[36:39]
s_waitcnt lgkmcnt(4)
s_and_b32 s55,s55,0x1ffff
v_add_u32 v4,s55,v8
v_mfma_f32_16x16x32_bf16 v[32:35],a[184:187],v[92:95],v[32:35]
v_add_u32 v5,s55,v9
v_add_u32 v6,s55,v10
v_mfma_f32_16x16x32_bf16 v[36:39],a[188:191],v[92:95],v[36:39]
s_waitcnt lgkmcnt(3)
v_add_u32 v7,s55,v11
v_mfma_f32_16x16x32_bf16 v[32:35],a[192:195],v[96:99],v[32:35]
s_waitcnt vmcnt(7)
ds_read_b128 v[64:67],v4 offset:0
v_mfma_f32_16x16x32_bf16 v[36:39],a[196:199],v[96:99],v[36:39]
s_waitcnt lgkmcnt(3)
s_waitcnt vmcnt(6)
ds_read_b128 v[68:71],v4 offset:1024
v_mfma_f32_16x16x32_bf16 v[32:35],a[200:203],v[100:103],v[32:35]
s_waitcnt vmcnt(5)
ds_read_b128 v[72:75],v4 offset:2048
v_mfma_f32_16x16x32_bf16 v[36:39],a[204:207],v[100:103],v[36:39]
s_waitcnt lgkmcnt(4)
v_mfma_f32_16x16x32_bf16 v[32:35],a[208:211],v[104:107],v[32:35]
v_mfma_f32_16x16x32_bf16 v[36:39],a[212:215],v[104:107],v[36:39]
s_waitcnt lgkmcnt(3)
v_mfma_f32_16x16x32_bf16 v[40:43],a[216:219],v[108:111],v[32:35]
v_mfma_f32_16x16x32_bf16 v[44:47],a[220:223],v[108:111],v[36:39]
s_waitcnt vmcnt(1)
v_cmp_gt_u32 vcc,s53,v16
s_add_u32 s60,s60,1
s_cbranch_vccnz WN_187
.p2align 6
WR_186:
s_waitcnt lgkmcnt(2)
v_mfma_f32_16x16x32_bf16 v[32:35],a[0:3],v[64:67],0
s_waitcnt vmcnt(4)
s_add_u32 s71,s60,2
ds_read_b128 v[76:79],v4 offset:3072
v_mfma_f32_16x16x32_bf16 v[36:39],a[4:7],v[64:67],0
s_waitcnt lgkmcnt(2)
s_add_u32 s53,s60,3
v_mfma_f32_16x16x32_bf16 v[32:35],a[8:11],v[68:71],v[32:35]
s_waitcnt vmcnt(3)
s_mov_b32 m0,s70
ds_read_b128 v[80:83],v4 offset:4096
v_mfma_f32_16x16x32_bf16 v[36:39],a[12:15],v[68:71],v[36:39]
s_waitcnt lgkmcnt(2)
buffer_load_dwordx4 v3,s[20:23],s61 offen offset:0 lds
s_add_u32 s64,s74,s75
s_cmp_eq_u32 s56,1
s_cbranch_scc1 b1_195
buffer_store_dwordx4 v[40:43],v0,s[20:23],s64 offen offset:0
buffer_store_dwordx4 v[44:47],v0,s[20:23],s64 offen offset:1024
b2_196:
v_mfma_f32_16x16x32_bf16 v[32:35],a[16:19],v[72:75],v[32:35]
s_waitcnt vmcnt(5)
s_add_u32 s75,s75,6144
ds_read_b128 v[84:87],v4 offset:5120
v_mfma_f32_16x16x32_bf16 v[36:39],a[20:23],v[72:75],v[36:39]
s_waitcnt lgkmcnt(2)
s_cmp_eq_u32 s75,24576
s_cselect_b32 s75,0,s75
v_mfma_f32_16x16x32_bf16 v[32:35],a[24:27],v[76:79],v[32:35]
s_waitcnt vmcnt(3)
ds_read_b128 v[88:91],v4 offset:6144
buffer_load_dwordx4 v3,s[20:23],s61 offen offset:1024 lds
v_mfma_f32_16x16x32_bf16 v[36:39],a[28:31],v[76:79],v[36:39]
s_waitcnt lgkmcnt(2)
s_barrier
ds_read_b128 v[92:95],v5 offset:0
v_mfma_f32_16x16x32_bf16 v[32:35],a[32:35],v[80:83],v[32:35]
ds_read_b128 v[96:99],v5 offset:1024
v_mfma_f32_16x16x32_bf16 v[36:39],a[36:39],v[80:83],v[36:39]
s_waitcnt lgkmcnt(3)
ds_read_b128 v[100:103],v5 offset:2048
buffer_load_dwordx4 v3,s[20:23],s61 offen offset:2048 lds
v_mfma_f32_16x16x32_bf16 v[32:35],a[40:43],v[84:87],v[32:35]
ds_read_b128 v[104:107],v5 offset:3072
v_mfma_f32_16x16x32_bf16 v[36:39],a[44:47],v[84:87],v[36:39]
s_waitcnt lgkmcnt(4)
ds_read_b128 v[108:111],v5 offset:4096
v_mfma_f32_16x16x32_bf16 v[32:35],a[48:51],v[88:91],v[32:35]
ds_read_b128 v[112:115],v5 offset:5120
buffer_load_dwordx4 v3,s[20:23],s61 offen offset:3072 lds
v_mfma_f32_16x16x32_bf16 v[36:39],a[52:55],v[88:91],v[36:39]
s_waitcnt lgkmcnt(5)
v_mfma_f32_16x16x32_bf16 v[32:35],a[56:59],v[92:95],v[32:35]
ds_read_b128 v[116:119],v5 offset:6144
v_mfma_f32_16x16x32_bf16 v[36:39],a[60:63],v[92:95],v[36:39]
s_waitcnt lgkmcnt(5)
s_add_u32 m0,s70,4096
v_mfma_f32_16x16x32_bf16 v[32:35],a[64:67],v[96:99],v[32:35]
ds_read_b128 v[120:123],v6 offset:0
buffer_load_dwordx4 v3,s[20:23],s62 offen offset:0 lds
v_mfma_f32_16x16x32_bf16 v[36:39],a[68:71],v[96:99],v[36:39]
s_waitcnt lgkmcnt(5)
v_mfma_f32_16x16x32_bf16 v[32:35],a[72:75],v[100:103],v[32:35]
ds_read_b128 v[124:127],v6 offset:1024
v_mfma_f32_16x16x32_bf16 v[36:39],a[76:79],v[100:103],v[36:39]
s_waitcnt lgkmcnt(5)
buffer_load_dwordx4 v3,s[20:23],s62 offen offset:1024 lds
v_mfma_f32_16x16x32_bf16 v[32:35],a[80:83],v[104:107],v[32:35]
ds_read_b128 v[64:67],v6 offset:2048
v_mfma_f32_16x16x32_bf16 v[36:39],a[84:87],v[104:107],v[36:39]
s_waitcnt lgkmcnt(5)
buffer_load_dword v16,v2,s[20:23],s68 offen sc1
v_mfma_f32_16x16x32_bf16 v[32:35],a[88:91],v[108:111],v[32:35]
ds_read_b128 v[68:71],v6 offset:3072
buffer_load_dwordx4 v3,s[20:23],s62 offen offset:2048 lds
v_mfma_f32_16x16x32_bf16 v[36:39],a[92:95],v[108:111],v[36:39]
s_waitcnt lgkmcnt(5)
v_mfma_f32_16x16x32_bf16 v[32:35],a[96:99],v[112:115],v[32:35]
ds_read_b128 v[72:75],v6 offset:4096
v_mfma_f32_16x16x32_bf16 v[36:39],a[100:103],v[112:115],v[36:39]
s_waitcnt lgkmcnt(5)
v_mfma_f32_16x16x32_bf16 v[32:35],a[104:107],v[116:119],v[32:35]
ds_read_b128 v[76:79],v6 offset:5120
v_mfma_f32_16x16x32_bf16 v[36:39],a[108:111],v[116:119],v[36:39]
s_waitcnt lgkmcnt(5)
v_mfma_f32_16x16x32_bf16 v[32:35],a[112:115],v[120:123],v[32:35]
ds_read_b128 v[80:83],v6 offset:6144
v_mfma_f32_16x16x32_bf16 v[36:39],a[116:119],v[120:123],v[36:39]
s_waitcnt lgkmcnt(5)
v_mfma_f32_16x16x32_bf16 v[32:35],a[120:123],v[124:127],v[32:35]
ds_read_b128 v[84:87],v7 offset:0
v_mfma_f32_16x16x32_bf16 v[36:39],a[124:127],v[124:127],v[36:39]
s_waitcnt lgkmcnt(5)
v_mfma_f32_16x16x32_bf16 v[32:35],a[128:131],v[64:67],v[32:35]
ds_read_b128 v[88:91],v7 offset:1024
v_mfma_f32_16x16x32_bf16 v[36:39],a[132:135],v[64:67],v[36:39]
s_waitcnt lgkmcnt(5)
v_mfma_f32_16x16x32_bf16 v[32:35],a[136:139],v[68:71],v[32:35]
ds_read_b128 v[92:95],v7 offset:2048
v_mfma_f32_16x16x32_bf16 v[36:39],a[140:143],v[68:71],v[36:39]
s_waitcnt lgkmcnt(5)
v_mfma_f32_16x16x32_bf16 v[32:35],a[144:147],v[72:75],v[32:35]
ds_read_b128 v[96:99],v7 offset:3072
v_mfma_f32_16x16x32_bf16 v[36:39],a[148:151],v[72:75],v[36:39]
s_waitcnt lgkmcnt(5)
v_mfma_f32_16x16x32_bf16 v[32:35],a[152:155],v[76:79],v[32:35]
ds_read_b128 v[100:103],v7 offset:4096
v_mfma_f32_16x16x32_bf16 v[36:39],a[156:159],v[76:79],v[36:39]
s_waitcnt lgkmcnt(5)
v_mfma_f32_16x16x32_bf16 v[32:35],a[160:163],v[80:83],v[32:35]
ds_read_b128 v[104:107],v7 offset:5120
v_mfma_f32_16x16x32_bf16 v[36:39],a[164:167],v[80:83],v[36:39]
s_waitcnt lgkmcnt(5)
v_mfma_f32_16x16x32_bf16 v[32:35],a[168:171],v[84:87],v[32:35]
ds_read_b128 v[108:111],v7 offset:6144
v_mfma_f32_16x16x32_bf16 v[36:39],a[172:175],v[84:87],v[36:39]
s_waitcnt lgkmcnt(5)
s_add_u32 s61,s61,114688
s_add_u32 s62,s62,114688
v_mfma_f32_16x16x32_bf16 v[32:35],a[176:179],v[88:91],v[32:35]
s_add_u32 s70,s70,32768
s_and_b32 s70,s70,0x1ffff
s_add_u32 s55,s55,32768
v_mfma_f32_16x16x32_bf16 v[36:39],a[180:183],v[88:91],v[36:39]
s_waitcnt lgkmcnt(4)
s_and_b32 s55,s55,0x1ffff
v_add_u32 v4,s55,v8
v_mfma_f32_16x16x32_bf16 v[32:35],a[184:187],v[92:95],v[32:35]
v_add_u32 v5,s55,v9
v_add_u32 v6,s55,v10
v_mfma_f32_16x16x32_bf16 v[36:39],a[188:191],v[92:95],v[36:39]
s_waitcnt lgkmcnt(3)
v_add_u32 v7,s55,v11
v_mfma_f32_16x16x32_bf16 v[32:35],a[192:195],v[96:99],v[32:35]
s_waitcnt vmcnt(9)
ds_read_b128 v[64:67],v4 offset:0
v_mfma_f32_16x16x32_bf16 v[36:39],a[196:199],v[96:99],v[36:39]
s_waitcnt lgkmcnt(3)
s_waitcnt vmcnt(6)
ds_read_b128 v[68:71],v4 offset:1024
v_mfma_f32_16x16x32_bf16 v[32:35],a[200:203],v[100:103],v[32:35]
s_waitcnt vmcnt(5)
ds_read_b128 v[72:75],v4 offset:2048
v_mfma_f32_16x16x32_bf16 v[36:39],a[204:207],v[100:103],v[36:39]
s_waitcnt lgkmcnt(4)
v_mfma_f32_16x16x32_bf16 v[32:35],a[208:211],v[104:107],v[32:35]
v_mfma_f32_16x16x32_bf16 v[36:39],a[212:215],v[104:107],v[36:39]
s_waitcnt lgkmcnt(3)
v_mfma_f32_16x16x32_bf16 v[40:43],a[216:219],v[108:111],v[32:35]
v_mfma_f32_16x16x32_bf16 v[44:47],a[220:223],v[108:111],v[36:39]
s_waitcnt vmcnt(1)
v_cmp_gt_u32 vcc,s53,v16
s_add_u32 s60,s60,1
s_cbranch_vccz WR_186
WN_187:
s_waitcnt lgkmcnt(2)
v_mfma_f32_16x16x32_bf16 v[32:35],a[0:3],v[64:67],0
s_waitcnt vmcnt(4)
s_add_u32 s71,s60,2
ds_read_b128 v[76:79],v4 offset:3072
v_mfma_f32_16x16x32_bf16 v[36:39],a[4:7],v[64:67],0
s_waitcnt lgkmcnt(2)
s_add_u32 s53,s60,3
v_mfma_f32_16x16x32_bf16 v[32:35],a[8:11],v[68:71],v[32:35]
s_waitcnt vmcnt(3)
ds_read_b128 v[80:83],v4 offset:4096
v_mfma_f32_16x16x32_bf16 v[36:39],a[12:15],v[68:71],v[36:39]
s_waitcnt lgkmcnt(2)
s_add_u32 s64,s74,s75
s_cmp_eq_u32 s56,1
s_cbranch_scc1 b1_198
buffer_store_dwordx4 v[40:43],v0,s[20:23],s64 offen offset:0
buffer_store_dwordx4 v[44:47],v0,s[20:23],s64 offen offset:1024
b2_199:
v_mfma_f32_16x16x32_bf16 v[32:35],a[16:19],v[72:75],v[32:35]
s_waitcnt vmcnt(4)
s_add_u32 s75,s75,6144
ds_read_b128 v[84:87],v4 offset:5120
v_mfma_f32_16x16x32_bf16 v[36:39],a[20:23],v[72:75],v[36:39]
s_waitcnt lgkmcnt(2)
s_cmp_eq_u32 s75,24576
s_cselect_b32 s75,0,s75
v_mfma_f32_16x16x32_bf16 v[32:35],a[24:27],v[76:79],v[32:35]
s_waitcnt vmcnt(2)
ds_read_b128 v[88:91],v4 offset:6144
v_mfma_f32_16x16x32_bf16 v[36:39],a[28:31],v[76:79],v[36:39]
s_waitcnt lgkmcnt(2)
s_barrier
ds_read_b128 v[92:95],v5 offset:0
v_mfma_f32_16x16x32_bf16 v[32:35],a[32:35],v[80:83],v[32:35]
ds_read_b128 v[96:99],v5 offset:1024
v_mfma_f32_16x16x32_bf16 v[36:39],a[36:39],v[80:83],v[36:39]
s_waitcnt lgkmcnt(3)
ds_read_b128 v[100:103],v5 offset:2048
v_mfma_f32_16x16x32_bf16 v[32:35],a[40:43],v[84:87],v[32:35]
ds_read_b128 v[104:107],v5 offset:3072
v_mfma_f32_16x16x32_bf16 v[36:39],a[44:47],v[84:87],v[36:39]
s_waitcnt lgkmcnt(4)
ds_read_b128 v[108:111],v5 offset:4096
v_mfma_f32_16x16x32_bf16 v[32:35],a[48:51],v[88:91],v[32:35]
ds_read_b128 v[112:115],v5 offset:5120
v_mfma_f32_16x16x32_bf16 v[36:39],a[52:55],v[88:91],v[36:39]
s_waitcnt lgkmcnt(5)
v_mfma_f32_16x16x32_bf16 v[32:35],a[56:59],v[92:95],v[32:35]
ds_read_b128 v[116:119],v5 offset:6144
v_mfma_f32_16x16x32_bf16 v[36:39],a[60:63],v[92:95],v[36:39]
s_waitcnt lgkmcnt(5)
v_mfma_f32_16x16x32_bf16 v[32:35],a[64:67],v[96:99],v[32:35]
ds_read_b128 v[120:123],v6 offset:0
v_mfma_f32_16x16x32_bf16 v[36:39],a[68:71],v[96:99],v[36:39]
s_waitcnt lgkmcnt(5)
v_mfma_f32_16x16x32_bf16 v[32:35],a[72:75],v[100:103],v[32:35]
ds_read_b128 v[124:127],v6 offset:1024
v_mfma_f32_16x16x32_bf16 v[36:39],a[76:79],v[100:103],v[36:39]
s_waitcnt lgkmcnt(5)
v_mfma_f32_16x16x32_bf16 v[32:35],a[80:83],v[104:107],v[32:35]
ds_read_b128 v[64:67],v6 offset:2048
v_mfma_f32_16x16x32_bf16 v[36:39],a[84:87],v[104:107],v[36:39]
s_waitcnt lgkmcnt(5)
v_mfma_f32_16x16x32_bf16 v[32:35],a[88:91],v[108:111],v[32:35]
ds_read_b128 v[68:71],v6 offset:3072
v_mfma_f32_16x16x32_bf16 v[36:39],a[92:95],v[108:111],v[36:39]
s_waitcnt lgkmcnt(5)
v_mfma_f32_16x16x32_bf16 v[32:35],a[96:99],v[112:115],v[32:35]
ds_read_b128 v[72:75],v6 offset:4096
v_mfma_f32_16x16x32_bf16 v[36:39],a[100:103],v[112:115],v[36:39]
s_waitcnt lgkmcnt(5)
v_mfma_f32_16x16x32_bf16 v[32:35],a[104:107],v[116:119],v[32:35]
ds_read_b128 v[76:79],v6 offset:5120
v_mfma_f32_16x16x32_bf16 v[36:39],a[108:111],v[116:119],v[36:39]
s_waitcnt lgkmcnt(5)
v_mfma_f32_16x16x32_bf16 v[32:35],a[112:115],v[120:123],v[32:35]
ds_read_b128 v[80:83],v6 offset:6144
v_mfma_f32_16x16x32_bf16 v[36:39],a[116:119],v[120:123],v[36:39]
s_waitcnt lgkmcnt(5)
v_mfma_f32_16x16x32_bf16 v[32:35],a[120:123],v[124:127],v[32:35]
ds_read_b128 v[84:87],v7 offset:0
v_mfma_f32_16x16x32_bf16 v[36:39],a[124:127],v[124:127],v[36:39]
s_waitcnt lgkmcnt(5)
v_mfma_f32_16x16x32_bf16 v[32:35],a[128:131],v[64:67],v[32:35]
ds_read_b128 v[88:91],v7 offset:1024
v_mfma_f32_16x16x32_bf16 v[36:39],a[132:135],v[64:67],v[36:39]
s_waitcnt lgkmcnt(5)
v_mfma_f32_16x16x32_bf16 v[32:35],a[136:139],v[68:71],v[32:35]
ds_read_b128 v[92:95],v7 offset:2048
v_mfma_f32_16x16x32_bf16 v[36:39],a[140:143],v[68:71],v[36:39]
s_waitcnt lgkmcnt(5)
buffer_load_dword v16,v2,s[20:23],s68 offen sc1
v_mfma_f32_16x16x32_bf16 v[32:35],a[144:147],v[72:75],v[32:35]
ds_read_b128 v[96:99],v7 offset:3072
v_mfma_f32_16x16x32_bf16 v[36:39],a[148:151],v[72:75],v[36:39]
s_waitcnt lgkmcnt(5)
v_mfma_f32_16x16x32_bf16 v[32:35],a[152:155],v[76:79],v[32:35]
ds_read_b128 v[100:103],v7 offset:4096
v_mfma_f32_16x16x32_bf16 v[36:39],a[156:159],v[76:79],v[36:39]
s_waitcnt lgkmcnt(5)
v_mfma_f32_16x16x32_bf16 v[32:35],a[160:163],v[80:83],v[32:35]
ds_read_b128 v[104:107],v7 offset:5120
v_mfma_f32_16x16x32_bf16 v[36:39],a[164:167],v[80:83],v[36:39]
s_waitcnt lgkmcnt(5)
v_mfma_f32_16x16x32_bf16 v[32:35],a[168:171],v[84:87],v[32:35]
ds_read_b128 v[108:111],v7 offset:6144
v_mfma_f32_16x16x32_bf16 v[36:39],a[172:175],v[84:87],v[36:39]
s_waitcnt lgkmcnt(5)
s_add_u32 s55,s55,32768
s_and_b32 s55,s55,0x1ffff
v_mfma_f32_16x16x32_bf16 v[32:35],a[176:179],v[88:91],v[32:35]
v_add_u32 v4,s55,v8
v_add_u32 v5,s55,v9
v_mfma_f32_16x16x32_bf16 v[36:39],a[180:183],v[88:91],v[36:39]
s_waitcnt lgkmcnt(4)
v_add_u32 v6,s55,v10
v_add_u32 v7,s55,v11
v_mfma_f32_16x16x32_bf16 v[32:35],a[184:187],v[92:95],v[32:35]
v_mfma_f32_16x16x32_bf16 v[36:39],a[188:191],v[92:95],v[36:39]
s_waitcnt lgkmcnt(3)
v_mfma_f32_16x16x32_bf16 v[32:35],a[192:195],v[96:99],v[32:35]
v_mfma_f32_16x16x32_bf16 v[36:39],a[196:199],v[96:99],v[36:39]
s_waitcnt lgkmcnt(2)
v_mfma_f32_16x16x32_bf16 v[32:35],a[200:203],v[100:103],v[32:35]
v_mfma_f32_16x16x32_bf16 v[36:39],a[204:207],v[100:103],v[36:39]
s_waitcnt lgkmcnt(1)
v_mfma_f32_16x16x32_bf16 v[32:35],a[208:211],v[104:107],v[32:35]
v_mfma_f32_16x16x32_bf16 v[36:39],a[212:215],v[104:107],v[36:39]
s_waitcnt lgkmcnt(0)
v_mfma_f32_16x16x32_bf16 v[40:43],a[216:219],v[108:111],v[32:35]
v_mfma_f32_16x16x32_bf16 v[44:47],a[220:223],v[108:111],v[36:39]
s_waitcnt vmcnt(0)
v_cmp_gt_u32 vcc,s71,v16
s_add_u32 s60,s60,1
s_branch endN_197
BN_189:
s_waitcnt vmcnt(8)
ds_read_b128 v[64:67],v4 offset:0
s_waitcnt vmcnt(7)
ds_read_b128 v[68:71],v4 offset:1024
s_waitcnt vmcnt(6)
ds_read_b128 v[72:75],v4 offset:2048
s_waitcnt vmcnt(5)
ds_read_b128 v[76:79],v4 offset:3072
s_waitcnt lgkmcnt(3)
v_mfma_f32_16x16x32_bf16 v[32:35],a[0:3],v[64:67],0
s_add_u32 s71,s60,2
s_add_u32 s53,s60,3
v_mfma_f32_16x16x32_bf16 v[36:39],a[4:7],v[64:67],0
s_waitcnt lgkmcnt(2)
s_waitcnt vmcnt(4)
ds_read_b128 v[80:83],v4 offset:4096
v_mfma_f32_16x16x32_bf16 v[32:35],a[8:11],v[68:71],v[32:35]
v_mfma_f32_16x16x32_bf16 v[36:39],a[12:15],v[68:71],v[36:39]
s_waitcnt lgkmcnt(2)
s_waitcnt vmcnt(3)
ds_read_b128 v[84:87],v4 offset:5120
v_mfma_f32_16x16x32_bf16 v[32:35],a[16:19],v[72:75],v[32:35]
v_mfma_f32_16x16x32_bf16 v[36:39],a[20:23],v[72:75],v[36:39]
s_waitcnt lgkmcnt(2)
s_waitcnt vmcnt(2)
ds_read_b128 v[88:91],v4 offset:6144
v_mfma_f32_16x16x32_bf16 v[32:35],a[24:27],v[76:79],v[32:35]
v_mfma_f32_16x16x32_bf16 v[36:39],a[28:31],v[76:79],v[36:39]
s_waitcnt lgkmcnt(2)
s_barrier
ds_read_b128 v[92:95],v5 offset:0
v_mfma_f32_16x16x32_bf16 v[32:35],a[32:35],v[80:83],v[32:35]
ds_read_b128 v[96:99],v5 offset:1024
v_mfma_f32_16x16x32_bf16 v[36:39],a[36:39],v[80:83],v[36:39]
s_waitcnt lgkmcnt(3)
ds_read_b128 v[100:103],v5 offset:2048
v_mfma_f32_16x16x32_bf16 v[32:35],a[40:43],v[84:87],v[32:35]
ds_read_b128 v[104:107],v5 offset:3072
v_mfma_f32_16x16x32_bf16 v[36:39],a[44:47],v[84:87],v[36:39]
s_waitcnt lgkmcnt(4)
ds_read_b128 v[108:111],v5 offset:4096
v_mfma_f32_16x16x32_bf16 v[32:35],a[48:51],v[88:91],v[32:35]
ds_read_b128 v[112:115],v5 offset:5120
v_mfma_f32_16x16x32_bf16 v[36:39],a[52:55],v[88:91],v[36:39]
s_waitcnt lgkmcnt(5)
v_mfma_f32_16x16x32_bf16 v[32:35],a[56:59],v[92:95],v[32:35]
ds_read_b128 v[116:119],v5 offset:6144
v_mfma_f32_16x16x32_bf16 v[36:39],a[60:63],v[92:95],v[36:39]
s_waitcnt lgkmcnt(5)
v_mfma_f32_16x16x32_bf16 v[32:35],a[64:67],v[96:99],v[32:35]
ds_read_b128 v[120:123],v6 offset:0
v_mfma_f32_16x16x32_bf16 v[36:39],a[68:71],v[96:99],v[36:39]
s_waitcnt lgkmcnt(5)
v_mfma_f32_16x16x32_bf16 v[32:35],a[72:75],v[100:103],v[32:35]
ds_read_b128 v[124:127],v6 offset:1024
v_mfma_f32_16x16x32_bf16 v[36:39],a[76:79],v[100:103],v[36:39]
s_waitcnt lgkmcnt(5)
v_mfma_f32_16x16x32_bf16 v[32:35],a[80:83],v[104:107],v[32:35]
ds_read_b128 v[64:67],v6 offset:2048
v_mfma_f32_16x16x32_bf16 v[36:39],a[84:87],v[104:107],v[36:39]
s_waitcnt lgkmcnt(5)
v_mfma_f32_16x16x32_bf16 v[32:35],a[88:91],v[108:111],v[32:35]
ds_read_b128 v[68:71],v6 offset:3072
v_mfma_f32_16x16x32_bf16 v[36:39],a[92:95],v[108:111],v[36:39]
s_waitcnt lgkmcnt(5)
v_mfma_f32_16x16x32_bf16 v[32:35],a[96:99],v[112:115],v[32:35]
ds_read_b128 v[72:75],v6 offset:4096
v_mfma_f32_16x16x32_bf16 v[36:39],a[100:103],v[112:115],v[36:39]
s_waitcnt lgkmcnt(5)
v_mfma_f32_16x16x32_bf16 v[32:35],a[104:107],v[116:119],v[32:35]
ds_read_b128 v[76:79],v6 offset:5120
v_mfma_f32_16x16x32_bf16 v[36:39],a[108:111],v[116:119],v[36:39]
s_waitcnt lgkmcnt(5)
v_mfma_f32_16x16x32_bf16 v[32:35],a[112:115],v[120:123],v[32:35]
ds_read_b128 v[80:83],v6 offset:6144
v_mfma_f32_16x16x32_bf16 v[36:39],a[116:119],v[120:123],v[36:39]
s_waitcnt lgkmcnt(5)
v_mfma_f32_16x16x32_bf16 v[32:35],a[120:123],v[124:127],v[32:35]
ds_read_b128 v[84:87],v7 offset:0
v_mfma_f32_16x16x32_bf16 v[36:39],a[124:127],v[124:127],v[36:39]
s_waitcnt lgkmcnt(5)
v_mfma_f32_16x16x32_bf16 v[32:35],a[128:131],v[64:67],v[32:35]
ds_read_b128 v[88:91],v7 offset:1024
v_mfma_f32_16x16x32_bf16 v[36:39],a[132:135],v[64:67],v[36:39]
s_waitcnt lgkmcnt(5)
v_mfma_f32_16x16x32_bf16 v[32:35],a[136:139],v[68:71],v[32:35]
ds_read_b128 v[92:95],v7 offset:2048
v_mfma_f32_16x16x32_bf16 v[36:39],a[140:143],v[68:71],v[36:39]
s_waitcnt lgkmcnt(5)
buffer_load_dword v16,v2,s[20:23],s68 offen sc1
v_mfma_f32_16x16x32_bf16 v[32:35],a[144:147],v[72:75],v[32:35]
ds_read_b128 v[96:99],v7 offset:3072
v_mfma_f32_16x16x32_bf16 v[36:39],a[148:151],v[72:75],v[36:39]
s_waitcnt lgkmcnt(5)
v_mfma_f32_16x16x32_bf16 v[32:35],a[152:155],v[76:79],v[32:35]
ds_read_b128 v[100:103],v7 offset:4096
v_mfma_f32_16x16x32_bf16 v[36:39],a[156:159],v[76:79],v[36:39]
s_waitcnt lgkmcnt(5)
v_mfma_f32_16x16x32_bf16 v[32:35],a[160:163],v[80:83],v[32:35]
ds_read_b128 v[104:107],v7 offset:5120
v_mfma_f32_16x16x32_bf16 v[36:39],a[164:167],v[80:83],v[36:39]
s_waitcnt lgkmcnt(5)
v_mfma_f32_16x16x32_bf16 v[32:35],a[168:171],v[84:87],v[32:35]
ds_read_b128 v[108:111],v7 offset:6144
v_mfma_f32_16x16x32_bf16 v[36:39],a[172:175],v[84:87],v[36:39]
s_waitcnt lgkmcnt(5)
s_add_u32 s55,s55,32768
s_and_b32 s55,s55,0x1ffff
v_mfma_f32_16x16x32_bf16 v[32:35],a[176:179],v[88:91],v[32:35]
v_add_u32 v4,s55,v8
v_add_u32 v5,s55,v9
v_mfma_f32_16x16x32_bf16 v[36:39],a[180:183],v[88:91],v[36:39]
s_waitcnt lgkmcnt(4)
v_add_u32 v6,s55,v10
v_add_u32 v7,s55,v11
v_mfma_f32_16x16x32_bf16 v[32:35],a[184:187],v[92:95],v[32:35]
v_mfma_f32_16x16x32_bf16 v[36:39],a[188:191],v[92:95],v[36:39]
s_waitcnt lgkmcnt(3)
v_mfma_f32_16x16x32_bf16 v[32:35],a[192:195],v[96:99],v[32:35]
v_mfma_f32_16x16x32_bf16 v[36:39],a[196:199],v[96:99],v[36:39]
s_waitcnt lgkmcnt(2)
v_mfma_f32_16x16x32_bf16 v[32:35],a[200:203],v[100:103],v[32:35]
v_mfma_f32_16x16x32_bf16 v[36:39],a[204:207],v[100:103],v[36:39]
s_waitcnt lgkmcnt(1)
v_mfma_f32_16x16x32_bf16 v[32:35],a[208:211],v[104:107],v[32:35]
v_mfma_f32_16x16x32_bf16 v[36:39],a[212:215],v[104:107],v[36:39]
s_waitcnt lgkmcnt(0)
v_mfma_f32_16x16x32_bf16 v[40:43],a[216:219],v[108:111],v[32:35]
v_mfma_f32_16x16x32_bf16 v[44:47],a[220:223],v[108:111],v[36:39]
s_waitcnt vmcnt(0)
v_cmp_gt_u32 vcc,s71,v16
s_add_u32 s60,s60,1
endN_197:
s_cbranch_vccnz nb_192
s_mov_b32 m0,s70
s_nop 0
buffer_load_dwordx4 v3,s[20:23],s61 offen offset:0 lds
buffer_load_dwordx4 v3,s[20:23],s61 offen offset:1024 lds
buffer_load_dwordx4 v3,s[20:23],s61 offen offset:2048 lds
buffer_load_dwordx4 v3,s[20:23],s61 offen offset:3072 lds
s_add_u32 m0,s70,4096
s_nop 0
buffer_load_dwordx4 v3,s[20:23],s62 offen offset:0 lds
buffer_load_dwordx4 v3,s[20:23],s62 offen offset:1024 lds
buffer_load_dwordx4 v3,s[20:23],s62 offen offset:2048 lds
s_add_u32 s61,s61,114688
s_add_u32 s62,s62,114688
s_add_u32 s70,s70,32768
s_and_b32 s70,s70,0x1ffff
s_add_u32 s64,s74,s75
s_cmp_eq_u32 s56,1
s_cbranch_scc1 b1_200
buffer_store_dwordx4 v[40:43],v0,s[20:23],s64 offen offset:0
buffer_store_dwordx4 v[44:47],v0,s[20:23],s64 offen offset:1024
b2_201:
s_add_u32 s75,s75,6144
s_cmp_eq_u32 s75,24576
s_cselect_b32 s75,0,s75
s_branch dec_191
nb_192:
buffer_load_dword v16,v2,s[20:23],s68 offen sc1
s_nop 3
s_add_u32 s64,s74,s75
s_cmp_eq_u32 s56,1
s_cbranch_scc1 b1_202
buffer_store_dwordx4 v[40:43],v0,s[20:23],s64 offen offset:0
buffer_store_dwordx4 v[44:47],v0,s[20:23],s64 offen offset:1024
b2_203:
s_add_u32 s75,s75,6144
s_cmp_eq_u32 s75,24576
s_cselect_b32 s75,0,s75
s_waitcnt vmcnt(2)
v_cmp_gt_u32 vcc,s71,v16
s_cbranch_vccz lag_190
s_cmp_ge_u32 s60,128
s_cbranch_scc1 done_170
plp_204:
buffer_load_dword v16,v2,s[20:23],s68 offen sc1
s_waitcnt vmcnt(0)
v_cmp_gt_u32 vcc,s71,v16
s_cbranch_vccz pok_205
s_sleep 4
s_sub_u32 s90,s90,1
s_cmp_gt_i32 s90,0
s_cbranch_scc1 plp_204
pok_205:
s_branch lag_190
lfin_183:
s_add_u32 s71,s60,1
s_add_u32 s53,s60,2
plp_225:
buffer_load_dword v16,v2,s[20:23],s68 offen sc1
s_waitcnt vmcnt(0)
v_cmp_gt_u32 vcc,s71,v16
s_cbranch_vccz pok_226
s_sleep 4
s_sub_u32 s90,s90,1
s_cmp_gt_i32 s90,0
s_cbranch_scc1 plp_225
pok_226:
lag_222:
s_mov_b32 m0,s70
s_nop 0
buffer_load_dwordx4 v3,s[20:23],s61 offen offset:0 lds
buffer_load_dwordx4 v3,s[20:23],s61 offen offset:1024 lds
buffer_load_dwordx4 v3,s[20:23],s61 offen offset:2048 lds
buffer_load_dwordx4 v3,s[20:23],s61 offen offset:3072 lds
s_add_u32 m0,s70,4096
s_nop 0
buffer_load_dwordx4 v3,s[20:23],s62 offen offset:0 lds
buffer_load_dwordx4 v3,s[20:23],s62 offen offset:1024 lds
buffer_load_dwordx4 v3,s[20:23],s62 offen offset:2048 lds
s_add_u32 s61,s61,114688
s_add_u32 s62,s62,114688
s_add_u32 s70,s70,32768
s_and_b32 s70,s70,0x1ffff
dec_223:
v_cmp_gt_u32 vcc,s53,v16
s_cbranch_vccnz BN_221
BR_220:
s_waitcnt vmcnt(6)
ds_read_b128 v[64:67],v4 offset:0
s_waitcnt vmcnt(5)
ds_read_b128 v[68:71],v4 offset:1024
s_waitcnt vmcnt(4)
ds_read_b128 v[72:75],v4 offset:2048
s_waitcnt vmcnt(3)
ds_read_b128 v[76:79],v4 offset:3072
s_waitcnt lgkmcnt(3)
v_mfma_f32_16x16x32_bf16 v[32:35],a[0:3],v[64:67],0
s_add_u32 s71,s60,2
s_add_u32 s53,s60,3
v_mfma_f32_16x16x32_bf16 v[36:39],a[4:7],v[64:67],0
s_waitcnt lgkmcnt(2)
s_waitcnt vmcnt(2)
ds_read_b128 v[80:83],v4 offset:4096
v_mfma_f32_16x16x32_bf16 v[32:35],a[8:11],v[68:71],v[32:35]
v_mfma_f32_16x16x32_bf16 v[36:39],a[12:15],v[68:71],v[36:39]
s_waitcnt lgkmcnt(2)
s_waitcnt vmcnt(1)
s_mov_b32 m0,s70
ds_read_b128 v[84:87],v4 offset:5120
v_mfma_f32_16x16x32_bf16 v[32:35],a[16:19],v[72:75],v[32:35]
buffer_load_dwordx4 v3,s[20:23],s61 offen offset:0 lds
v_mfma_f32_16x16x32_bf16 v[36:39],a[20:23],v[72:75],v[36:39]
s_waitcnt lgkmcnt(2)
s_waitcnt vmcnt(1)
ds_read_b128 v[88:91],v4 offset:6144
v_mfma_f32_16x16x32_bf16 v[32:35],a[24:27],v[76:79],v[32:35]
buffer_load_dwordx4 v3,s[20:23],s61 offen offset:1024 lds
v_mfma_f32_16x16x32_bf16 v[36:39],a[28:31],v[76:79],v[36:39]
s_waitcnt lgkmcnt(2)
s_barrier
ds_read_b128 v[92:95],v5 offset:0
v_mfma_f32_16x16x32_bf16 v[32:35],a[32:35],v[80:83],v[32:35]
ds_read_b128 v[96:99],v5 offset:1024
v_mfma_f32_16x16x32_bf16 v[36:39],a[36:39],v[80:83],v[36:39]
s_waitcnt lgkmcnt(3)
ds_read_b128 v[100:103],v5 offset:2048
buffer_load_dwordx4 v3,s[20:23],s61 offen offset:2048 lds
v_mfma_f32_16x16x32_bf16 v[32:35],a[40:43],v[84:87],v[32:35]
ds_read_b128 v[104:107],v5 offset:3072
v_mfma_f32_16x16x32_bf16 v[36:39],a[44:47],v[84:87],v[36:39]
s_waitcnt lgkmcnt(4)
ds_read_b128 v[108:111],v5 offset:4096
v_mfma_f32_16x16x32_bf16 v[32:35],a[48:51],v[88:91],v[32:35]
ds_read_b128 v[112:115],v5 offset:5120
buffer_load_dwordx4 v3,s[20:23],s61 offen offset:3072 lds
v_mfma_f32_16x16x32_bf16 v[36:39],a[52:55],v[88:91],v[36:39]
s_waitcnt lgkmcnt(5)
v_mfma_f32_16x16x32_bf16 v[32:35],a[56:59],v[92:95],v[32:35]
s_cmp_eq_u32 s77,0
s_cselect_b32 s57,2.0,0
ds_read_b128 v[116:119],v5 offset:6144
v_mfma_f32_16x16x32_bf16 v[36:39],a[60:63],v[92:95],v[36:39]
s_waitcnt lgkmcnt(5)
s_add_u32 m0,s70,4096
v_or_b32 v21,s57,v0
v_mfma_f32_16x16x32_bf16 v[32:35],a[64:67],v[96:99],v[32:35]
ds_read_b128 v[120:123],v6 offset:0
buffer_load_dwordx4 v3,s[20:23],s62 offen offset:0 lds
v_mfma_f32_16x16x32_bf16 v[36:39],a[68:71],v[96:99],v[36:39]
s_waitcnt lgkmcnt(5)
v_or_b32 v22,s57,v18
v_lshlrev_b32 v168,16,v160
v_mfma_f32_16x16x32_bf16 v[32:35],a[72:75],v[100:103],v[32:35]
ds_read_b128 v[124:127],v6 offset:1024
v_and_b32 v169,s73,v160
v_mfma_f32_16x16x32_bf16 v[36:39],a[76:79],v[100:103],v[36:39]
s_waitcnt lgkmcnt(5)
buffer_load_dwordx4 v3,s[20:23],s62 offen offset:1024 lds
v_lshlrev_b32 v170,16,v161
v_mfma_f32_16x16x32_bf16 v[32:35],a[80:83],v[104:107],v[32:35]
ds_read_b128 v[64:67],v6 offset:2048
v_and_b32 v171,s73,v161
v_mfma_f32_16x16x32_bf16 v[36:39],a[84:87],v[104:107],v[36:39]
s_waitcnt lgkmcnt(5)
buffer_load_dword v16,v2,s[20:23],s68 offen sc1
v_lshlrev_b32 v172,16,v162
v_mfma_f32_16x16x32_bf16 v[32:35],a[88:91],v[108:111],v[32:35]
ds_read_b128 v[68:71],v6 offset:3072
buffer_load_dwordx4 v3,s[20:23],s62 offen offset:2048 lds
v_mfma_f32_16x16x32_bf16 v[36:39],a[92:95],v[108:111],v[36:39]
s_waitcnt lgkmcnt(5)
v_and_b32 v173,s73,v162
v_lshlrev_b32 v174,16,v163
v_mfma_f32_16x16x32_bf16 v[32:35],a[96:99],v[112:115],v[32:35]
s_add_u32 s84,s74,s75
s_add_u32 s85,s84,4096
ds_read_b128 v[72:75],v6 offset:4096
v_mfma_f32_16x16x32_bf16 v[36:39],a[100:103],v[112:115],v[36:39]
s_waitcnt lgkmcnt(5)
buffer_load_dwordx4 v[128:131],v0,s[20:23],s84 offen offset:0 sc1
v_and_b32 v175,s73,v163
v_mfma_f32_16x16x32_bf16 v[32:35],a[104:107],v[116:119],v[32:35]
ds_read_b128 v[76:79],v6 offset:5120
v_lshlrev_b32 v176,16,v164
v_mfma_f32_16x16x32_bf16 v[36:39],a[108:111],v[116:119],v[36:39]
s_waitcnt lgkmcnt(5)
buffer_load_dwordx4 v[132:135],v0,s[20:23],s84 offen offset:1024 sc1
v_and_b32 v177,s73,v164
v_mfma_f32_16x16x32_bf16 v[32:35],a[112:115],v[120:123],v[32:35]
ds_read_b128 v[80:83],v6 offset:6144
v_lshlrev_b32 v178,16,v165
v_mfma_f32_16x16x32_bf16 v[36:39],a[116:119],v[120:123],v[36:39]
s_waitcnt lgkmcnt(5)
buffer_load_dwordx4 v[136:139],v0,s[20:23],s84 offen offset:2048 sc1
v_and_b32 v179,s73,v165
v_mfma_f32_16x16x32_bf16 v[32:35],a[120:123],v[124:127],v[32:35]
ds_read_b128 v[84:87],v7 offset:0
v_lshlrev_b32 v180,16,v166
v_mfma_f32_16x16x32_bf16 v[36:39],a[124:127],v[124:127],v[36:39]
s_waitcnt lgkmcnt(5)
buffer_load_dwordx4 v[140:143],v0,s[20:23],s84 offen offset:3072 sc1
v_and_b32 v181,s73,v166
v_mfma_f32_16x16x32_bf16 v[32:35],a[128:131],v[64:67],v[32:35]
ds_read_b128 v[88:91],v7 offset:1024
v_lshlrev_b32 v182,16,v167
v_mfma_f32_16x16x32_bf16 v[36:39],a[132:135],v[64:67],v[36:39]
s_waitcnt lgkmcnt(5)
buffer_load_dwordx4 v[144:147],v0,s[20:23],s85 offen offset:0 sc1
v_and_b32 v183,s73,v167
v_mfma_f32_16x16x32_bf16 v[32:35],a[136:139],v[68:71],v[32:35]
ds_read_b128 v[92:95],v7 offset:2048
v_add_f32 v212,v212,v176
v_mfma_f32_16x16x32_bf16 v[36:39],a[140:143],v[68:71],v[36:39]
s_waitcnt lgkmcnt(5)
buffer_load_dwordx4 v[148:151],v0,s[20:23],s85 offen offset:1024 sc1
v_add_f32 v213,v213,v177
v_mfma_f32_16x16x32_bf16 v[32:35],a[144:147],v[72:75],v[32:35]
ds_read_b128 v[96:99],v7 offset:3072
v_add_f32 v214,v214,v178
v_mfma_f32_16x16x32_bf16 v[36:39],a[148:151],v[72:75],v[36:39]
s_waitcnt lgkmcnt(5)
v_add_f32 v215,v215,v179
v_add_f32 v216,v216,v180
v_mfma_f32_16x16x32_bf16 v[32:35],a[152:155],v[76:79],v[32:35]
ds_read_b128 v[100:103],v7 offset:4096
v_add_f32 v217,v217,v181
v_mfma_f32_16x16x32_bf16 v[36:39],a[156:159],v[76:79],v[36:39]
s_waitcnt lgkmcnt(5)
v_add_f32 v218,v218,v182
v_add_f32 v219,v219,v183
v_mfma_f32_16x16x32_bf16 v[32:35],a[160:163],v[80:83],v[32:35]
ds_read_b128 v[104:107],v7 offset:5120
v_fma_f32 v168,v212,v152,v168
v_mfma_f32_16x16x32_bf16 v[36:39],a[164:167],v[80:83],v[36:39]
s_waitcnt lgkmcnt(5)
v_fma_f32 v169,v213,v153,v169
v_fma_f32 v170,v214,v154,v170
v_mfma_f32_16x16x32_bf16 v[32:35],a[168:171],v[84:87],v[32:35]
ds_read_b128 v[108:111],v7 offset:6144
v_fma_f32 v171,v215,v155,v171
v_mfma_f32_16x16x32_bf16 v[36:39],a[172:175],v[84:87],v[36:39]
s_waitcnt lgkmcnt(5)
v_fma_f32 v172,v216,v156,v172
v_fma_f32 v173,v217,v157,v173
v_mfma_f32_16x16x32_bf16 v[32:35],a[176:179],v[88:91],v[32:35]
s_add_u32 s61,s61,114688
v_fma_f32 v174,v218,v158,v174
v_fma_f32 v175,v219,v159,v175
v_mfma_f32_16x16x32_bf16 v[36:39],a[180:183],v[88:91],v[36:39]
s_waitcnt lgkmcnt(4)
s_add_u32 s62,s62,114688
buffer_load_dwordx4 v[160:163],v0,s[20:23],s82 offen
v_mfma_f32_16x16x32_bf16 v[32:35],a[184:187],v[92:95],v[32:35]
s_add_u32 s70,s70,32768
s_add_u32 s64,s82,13631488
buffer_load_dwordx4 v[164:167],v0,s[20:23],s64 offen
v_mfma_f32_16x16x32_bf16 v[36:39],a[188:191],v[92:95],v[36:39]
s_waitcnt lgkmcnt(3)
s_add_u32 s82,s82,32768
s_and_b32 s70,s70,0x1ffff
v_mfma_f32_16x16x32_bf16 v[32:35],a[192:195],v[96:99],v[32:35]
s_add_u32 s55,s55,32768
s_and_b32 s55,s55,0x1ffff
v_add_u32 v4,s55,v8
v_mfma_f32_16x16x32_bf16 v[36:39],a[196:199],v[96:99],v[36:39]
s_waitcnt lgkmcnt(2)
v_add_u32 v5,s55,v9
v_add_u32 v6,s55,v10
v_mfma_f32_16x16x32_bf16 v[32:35],a[200:203],v[100:103],v[32:35]
s_waitcnt vmcnt(2)
s_cmp_eq_u32 s77,0
s_cbranch_scc1 go_235
ck_233:
v_max3_u32 v184,v128,v129,v130
v_max3_u32 v185,v140,v141,v142
v_max3_u32 v184,v184,v131,v132
v_max3_u32 v185,v185,v143,v144
v_max3_u32 v184,v184,v133,v134
v_max3_u32 v185,v185,v145,v146
v_max3_u32 v184,v184,v135,v136
v_max3_u32 v185,v185,v147,v148
v_max3_u32 v184,v184,v137,v138
v_max3_u32 v185,v185,v149,v150
v_max3_u32 v184,v184,v139,v151
v_max_u32 v184,v184,v185
v_cmp_eq_u32 vcc,-1,v184
s_cbranch_vccnz rt_234
go_235:
v_mfma_f32_16x16x32_bf16 v[36:39],a[204:207],v[100:103],v[36:39]
s_waitcnt lgkmcnt(1)
v_add_u32 v7,s55,v11
v_add_f32 v128,v128,v136
v_add_f32 v129,v129,v137
v_mfma_f32_16x16x32_bf16 v[32:35],a[208:211],v[104:107],v[32:35]
ds_read_b128 v[64:67],v4 offset:0
v_add_f32 v130,v130,v138
v_add_f32 v131,v131,v139
v_mfma_f32_16x16x32_bf16 v[36:39],a[212:215],v[104:107],v[36:39]
s_waitcnt lgkmcnt(1)
ds_read_b128 v[68:71],v4 offset:1024
v_add_f32 v132,v132,v140
v_mfma_f32_16x16x32_bf16 v[40:43],a[216:219],v[108:111],v[32:35]
ds_read_b128 v[72:75],v4 offset:2048
v_add_f32 v133,v133,v141
v_add_f32 v134,v134,v142
v_mfma_f32_16x16x32_bf16 v[44:47],a[220:223],v[108:111],v[36:39]
v_add_f32 v135,v135,v143
v_add_f32 v128,v128,v144
v_add_f32 v129,v129,v145
v_add_f32 v130,v130,v146
v_add_f32 v131,v131,v147
v_add_f32 v132,v132,v148
v_add_f32 v133,v133,v149
v_add_f32 v134,v134,v150
v_add_f32 v135,v135,v151
v_fma_f32 v168,v128,v152,v168
v_fma_f32 v169,v129,v153,v169
v_fma_f32 v170,v130,v154,v170
v_fma_f32 v171,v131,v155,v171
v_fma_f32 v172,v132,v156,v172
v_fma_f32 v173,v133,v157,v173
v_fma_f32 v174,v134,v158,v174
v_fma_f32 v175,v135,v159,v175
v_cvt_pk_bf16_f32 v176,v168,v169
v_cvt_pk_bf16_f32 v177,v170,v171
v_cvt_pk_bf16_f32 v178,v172,v173
v_cvt_pk_bf16_f32 v179,v174,v175
s_and_b32 s64,s66,0xffff8000
buffer_store_dwordx4 v[176:179],v22,s[24:27],s64 offen
s_cmp_eq_u32 s56,1
s_cbranch_scc1 b1_227
buffer_store_dwordx4 v[204:207],v21,s[20:23],s84 offen offset:0
buffer_store_dwordx4 v[204:207],v21,s[20:23],s84 offen offset:1024
b2_228:
s_cmp_eq_u32 s56,1
s_cbranch_scc1 b1_229
buffer_store_dwordx4 v[204:207],v21,s[20:23],s84 offen offset:2048
buffer_store_dwordx4 v[204:207],v21,s[20:23],s84 offen offset:3072
b2_230:
s_cmp_eq_u32 s56,1
s_cbranch_scc1 b1_231
buffer_store_dwordx4 v[204:207],v21,s[20:23],s85 offen offset:0
buffer_store_dwordx4 v[204:207],v21,s[20:23],s85 offen offset:1024
b2_232:
s_mul_i32 s64,s77,32768
s_add_u32 s66,s66,s64
s_mul_i32 s64,s77,6144
s_add_u32 s75,s75,s64
s_cmp_eq_u32 s75,24576
s_cselect_b32 s75,0,s75
s_add_u32 s63,s63,s77
s_mov_b32 s77,0
v_cmp_gt_u32 vcc,s53,v16
s_add_u32 s60,s60,1
s_cbranch_vccnz WN_219
.p2align 6
WR_218:
s_waitcnt lgkmcnt(2)
v_mfma_f32_16x16x32_bf16 v[32:35],a[0:3],v[64:67],0
s_waitcnt vmcnt(19)
s_add_u32 s71,s60,2
ds_read_b128 v[76:79],v4 offset:3072
v_mfma_f32_16x16x32_bf16 v[36:39],a[4:7],v[64:67],0
s_waitcnt lgkmcnt(2)
s_add_u32 s53,s60,3
v_mfma_f32_16x16x32_bf16 v[32:35],a[8:11],v[68:71],v[32:35]
s_waitcnt vmcnt(18)
s_mov_b32 m0,s70
ds_read_b128 v[80:83],v4 offset:4096
v_mfma_f32_16x16x32_bf16 v[36:39],a[12:15],v[68:71],v[36:39]
s_waitcnt lgkmcnt(2)
buffer_load_dwordx4 v3,s[20:23],s61 offen offset:0 lds
v_mov_b32 v212,v40
v_mfma_f32_16x16x32_bf16 v[32:35],a[16:19],v[72:75],v[32:35]
s_waitcnt vmcnt(18)
ds_read_b128 v[84:87],v4 offset:5120
v_mov_b32 v213,v41
v_mfma_f32_16x16x32_bf16 v[36:39],a[20:23],v[72:75],v[36:39]
s_waitcnt lgkmcnt(2)
v_mov_b32 v214,v42
v_mov_b32 v215,v43
v_mfma_f32_16x16x32_bf16 v[32:35],a[24:27],v[76:79],v[32:35]
s_waitcnt vmcnt(16)
ds_read_b128 v[88:91],v4 offset:6144
buffer_load_dwordx4 v3,s[20:23],s61 offen offset:1024 lds
v_mfma_f32_16x16x32_bf16 v[36:39],a[28:31],v[76:79],v[36:39]
s_waitcnt lgkmcnt(2)
s_barrier
ds_read_b128 v[92:95],v5 offset:0
v_mfma_f32_16x16x32_bf16 v[32:35],a[32:35],v[80:83],v[32:35]
ds_read_b128 v[96:99],v5 offset:1024
v_mov_b32 v216,v44
v_mfma_f32_16x16x32_bf16 v[36:39],a[36:39],v[80:83],v[36:39]
s_waitcnt lgkmcnt(3)
ds_read_b128 v[100:103],v5 offset:2048
buffer_load_dwordx4 v3,s[20:23],s61 offen offset:2048 lds
v_mfma_f32_16x16x32_bf16 v[32:35],a[40:43],v[84:87],v[32:35]
ds_read_b128 v[104:107],v5 offset:3072
v_mov_b32 v217,v45
v_mfma_f32_16x16x32_bf16 v[36:39],a[44:47],v[84:87],v[36:39]
s_waitcnt lgkmcnt(4)
ds_read_b128 v[108:111],v5 offset:4096
v_mov_b32 v218,v46
v_mfma_f32_16x16x32_bf16 v[32:35],a[48:51],v[88:91],v[32:35]
ds_read_b128 v[112:115],v5 offset:5120
buffer_load_dwordx4 v3,s[20:23],s61 offen offset:3072 lds
v_mfma_f32_16x16x32_bf16 v[36:39],a[52:55],v[88:91],v[36:39]
s_waitcnt lgkmcnt(5)
v_mov_b32 v219,v47
v_mfma_f32_16x16x32_bf16 v[32:35],a[56:59],v[92:95],v[32:35]
s_mov_b32 s77,1
s_waitcnt vmcnt(11)
s_cmp_eq_u32 s77,0
s_cselect_b32 s57,2.0,0
ds_read_b128 v[116:119],v5 offset:6144
v_mfma_f32_16x16x32_bf16 v[36:39],a[60:63],v[92:95],v[36:39]
s_waitcnt lgkmcnt(5)
s_add_u32 m0,s70,4096
v_or_b32 v21,s57,v0
v_mfma_f32_16x16x32_bf16 v[32:35],a[64:67],v[96:99],v[32:35]
ds_read_b128 v[120:123],v6 offset:0
buffer_load_dwordx4 v3,s[20:23],s62 offen offset:0 lds
v_mfma_f32_16x16x32_bf16 v[36:39],a[68:71],v[96:99],v[36:39]
s_waitcnt lgkmcnt(5)
v_or_b32 v22,s57,v18
v_lshlrev_b32 v168,16,v160
v_mfma_f32_16x16x32_bf16 v[32:35],a[72:75],v[100:103],v[32:35]
ds_read_b128 v[124:127],v6 offset:1024
v_and_b32 v169,s73,v160
v_mfma_f32_16x16x32_bf16 v[36:39],a[76:79],v[100:103],v[36:39]
s_waitcnt lgkmcnt(5)
buffer_load_dwordx4 v3,s[20:23],s62 offen offset:1024 lds
v_lshlrev_b32 v170,16,v161
v_mfma_f32_16x16x32_bf16 v[32:35],a[80:83],v[104:107],v[32:35]
ds_read_b128 v[64:67],v6 offset:2048
v_and_b32 v171,s73,v161
v_mfma_f32_16x16x32_bf16 v[36:39],a[84:87],v[104:107],v[36:39]
s_waitcnt lgkmcnt(5)
buffer_load_dword v16,v2,s[20:23],s68 offen sc1
v_lshlrev_b32 v172,16,v162
v_mfma_f32_16x16x32_bf16 v[32:35],a[88:91],v[108:111],v[32:35]
ds_read_b128 v[68:71],v6 offset:3072
buffer_load_dwordx4 v3,s[20:23],s62 offen offset:2048 lds
v_mfma_f32_16x16x32_bf16 v[36:39],a[92:95],v[108:111],v[36:39]
s_waitcnt lgkmcnt(5)
v_and_b32 v173,s73,v162
v_lshlrev_b32 v174,16,v163
v_mfma_f32_16x16x32_bf16 v[32:35],a[96:99],v[112:115],v[32:35]
s_add_u32 s84,s74,s75
s_add_u32 s85,s84,4096
ds_read_b128 v[72:75],v6 offset:4096
v_mfma_f32_16x16x32_bf16 v[36:39],a[100:103],v[112:115],v[36:39]
s_waitcnt lgkmcnt(5)
buffer_load_dwordx4 v[128:131],v0,s[20:23],s84 offen offset:0 sc1
v_and_b32 v175,s73,v163
v_mfma_f32_16x16x32_bf16 v[32:35],a[104:107],v[116:119],v[32:35]
ds_read_b128 v[76:79],v6 offset:5120
v_lshlrev_b32 v176,16,v164
v_mfma_f32_16x16x32_bf16 v[36:39],a[108:111],v[116:119],v[36:39]
s_waitcnt lgkmcnt(5)
buffer_load_dwordx4 v[132:135],v0,s[20:23],s84 offen offset:1024 sc1
v_and_b32 v177,s73,v164
v_mfma_f32_16x16x32_bf16 v[32:35],a[112:115],v[120:123],v[32:35]
ds_read_b128 v[80:83],v6 offset:6144
v_lshlrev_b32 v178,16,v165
v_mfma_f32_16x16x32_bf16 v[36:39],a[116:119],v[120:123],v[36:39]
s_waitcnt lgkmcnt(5)
buffer_load_dwordx4 v[136:139],v0,s[20:23],s84 offen offset:2048 sc1
v_and_b32 v179,s73,v165
v_mfma_f32_16x16x32_bf16 v[32:35],a[120:123],v[124:127],v[32:35]
ds_read_b128 v[84:87],v7 offset:0
v_lshlrev_b32 v180,16,v166
v_mfma_f32_16x16x32_bf16 v[36:39],a[124:127],v[124:127],v[36:39]
s_waitcnt lgkmcnt(5)
buffer_load_dwordx4 v[140:143],v0,s[20:23],s84 offen offset:3072 sc1
v_and_b32 v181,s73,v166
v_mfma_f32_16x16x32_bf16 v[32:35],a[128:131],v[64:67],v[32:35]
ds_read_b128 v[88:91],v7 offset:1024
v_lshlrev_b32 v182,16,v167
v_mfma_f32_16x16x32_bf16 v[36:39],a[132:135],v[64:67],v[36:39]
s_waitcnt lgkmcnt(5)
buffer_load_dwordx4 v[144:147],v0,s[20:23],s85 offen offset:0 sc1
v_and_b32 v183,s73,v167
v_mfma_f32_16x16x32_bf16 v[32:35],a[136:139],v[68:71],v[32:35]
ds_read_b128 v[92:95],v7 offset:2048
v_add_f32 v212,v212,v176
v_mfma_f32_16x16x32_bf16 v[36:39],a[140:143],v[68:71],v[36:39]
s_waitcnt lgkmcnt(5)
buffer_load_dwordx4 v[148:151],v0,s[20:23],s85 offen offset:1024 sc1
v_add_f32 v213,v213,v177
v_mfma_f32_16x16x32_bf16 v[32:35],a[144:147],v[72:75],v[32:35]
ds_read_b128 v[96:99],v7 offset:3072
v_add_f32 v214,v214,v178
v_mfma_f32_16x16x32_bf16 v[36:39],a[148:151],v[72:75],v[36:39]
s_waitcnt lgkmcnt(5)
v_add_f32 v215,v215,v179
v_add_f32 v216,v216,v180
v_mfma_f32_16x16x32_bf16 v[32:35],a[152:155],v[76:79],v[32:35]
ds_read_b128 v[100:103],v7 offset:4096
v_add_f32 v217,v217,v181
v_mfma_f32_16x16x32_bf16 v[36:39],a[156:159],v[76:79],v[36:39]
s_waitcnt lgkmcnt(5)
v_add_f32 v218,v218,v182
v_add_f32 v219,v219,v183
v_mfma_f32_16x16x32_bf16 v[32:35],a[160:163],v[80:83],v[32:35]
ds_read_b128 v[104:107],v7 offset:5120
v_fma_f32 v168,v212,v152,v168
v_mfma_f32_16x16x32_bf16 v[36:39],a[164:167],v[80:83],v[36:39]
s_waitcnt lgkmcnt(5)
v_fma_f32 v169,v213,v153,v169
v_fma_f32 v170,v214,v154,v170
v_mfma_f32_16x16x32_bf16 v[32:35],a[168:171],v[84:87],v[32:35]
ds_read_b128 v[108:111],v7 offset:6144
v_fma_f32 v171,v215,v155,v171
v_mfma_f32_16x16x32_bf16 v[36:39],a[172:175],v[84:87],v[36:39]
s_waitcnt lgkmcnt(5)
v_fma_f32 v172,v216,v156,v172
v_fma_f32 v173,v217,v157,v173
v_mfma_f32_16x16x32_bf16 v[32:35],a[176:179],v[88:91],v[32:35]
s_add_u32 s61,s61,114688
v_fma_f32 v174,v218,v158,v174
v_fma_f32 v175,v219,v159,v175
v_mfma_f32_16x16x32_bf16 v[36:39],a[180:183],v[88:91],v[36:39]
s_waitcnt lgkmcnt(4)
s_add_u32 s62,s62,114688
buffer_load_dwordx4 v[160:163],v0,s[20:23],s82 offen
v_mfma_f32_16x16x32_bf16 v[32:35],a[184:187],v[92:95],v[32:35]
s_add_u32 s70,s70,32768
s_add_u32 s64,s82,13631488
buffer_load_dwordx4 v[164:167],v0,s[20:23],s64 offen
v_mfma_f32_16x16x32_bf16 v[36:39],a[188:191],v[92:95],v[36:39]
s_waitcnt lgkmcnt(3)
s_add_u32 s82,s82,32768
s_and_b32 s70,s70,0x1ffff
v_mfma_f32_16x16x32_bf16 v[32:35],a[192:195],v[96:99],v[32:35]
s_add_u32 s55,s55,32768
s_and_b32 s55,s55,0x1ffff
v_add_u32 v4,s55,v8
v_mfma_f32_16x16x32_bf16 v[36:39],a[196:199],v[96:99],v[36:39]
s_waitcnt lgkmcnt(2)
v_add_u32 v5,s55,v9
v_add_u32 v6,s55,v10
v_mfma_f32_16x16x32_bf16 v[32:35],a[200:203],v[100:103],v[32:35]
s_waitcnt vmcnt(2)
s_cmp_eq_u32 s77,0
s_cbranch_scc1 go_244
ck_242:
v_max3_u32 v184,v128,v129,v130
v_max3_u32 v185,v140,v141,v142
v_max3_u32 v184,v184,v131,v132
v_max3_u32 v185,v185,v143,v144
v_max3_u32 v184,v184,v133,v134
v_max3_u32 v185,v185,v145,v146
v_max3_u32 v184,v184,v135,v136
v_max3_u32 v185,v185,v147,v148
v_max3_u32 v184,v184,v137,v138
v_max3_u32 v185,v185,v149,v150
v_max3_u32 v184,v184,v139,v151
v_max_u32 v184,v184,v185
v_cmp_eq_u32 vcc,-1,v184
s_cbranch_vccnz rt_243
go_244:
v_mfma_f32_16x16x32_bf16 v[36:39],a[204:207],v[100:103],v[36:39]
s_waitcnt lgkmcnt(1)
v_add_u32 v7,s55,v11
v_add_f32 v128,v128,v136
v_add_f32 v129,v129,v137
v_mfma_f32_16x16x32_bf16 v[32:35],a[208:211],v[104:107],v[32:35]
ds_read_b128 v[64:67],v4 offset:0
v_add_f32 v130,v130,v138
v_add_f32 v131,v131,v139
v_mfma_f32_16x16x32_bf16 v[36:39],a[212:215],v[104:107],v[36:39]
s_waitcnt lgkmcnt(1)
ds_read_b128 v[68:71],v4 offset:1024
v_add_f32 v132,v132,v140
v_mfma_f32_16x16x32_bf16 v[40:43],a[216:219],v[108:111],v[32:35]
ds_read_b128 v[72:75],v4 offset:2048
v_add_f32 v133,v133,v141
v_add_f32 v134,v134,v142
v_mfma_f32_16x16x32_bf16 v[44:47],a[220:223],v[108:111],v[36:39]
v_add_f32 v135,v135,v143
v_add_f32 v128,v128,v144
v_add_f32 v129,v129,v145
v_add_f32 v130,v130,v146
v_add_f32 v131,v131,v147
v_add_f32 v132,v132,v148
v_add_f32 v133,v133,v149
v_add_f32 v134,v134,v150
v_add_f32 v135,v135,v151
v_fma_f32 v168,v128,v152,v168
v_fma_f32 v169,v129,v153,v169
v_fma_f32 v170,v130,v154,v170
v_fma_f32 v171,v131,v155,v171
v_fma_f32 v172,v132,v156,v172
v_fma_f32 v173,v133,v157,v173
v_fma_f32 v174,v134,v158,v174
v_fma_f32 v175,v135,v159,v175
v_cvt_pk_bf16_f32 v176,v168,v169
v_cvt_pk_bf16_f32 v177,v170,v171
v_cvt_pk_bf16_f32 v178,v172,v173
v_cvt_pk_bf16_f32 v179,v174,v175
s_and_b32 s64,s66,0xffff8000
buffer_store_dwordx4 v[176:179],v22,s[24:27],s64 offen
s_cmp_eq_u32 s56,1
s_cbranch_scc1 b1_236
buffer_store_dwordx4 v[204:207],v21,s[20:23],s84 offen offset:0
buffer_store_dwordx4 v[204:207],v21,s[20:23],s84 offen offset:1024
b2_237:
s_cmp_eq_u32 s56,1
s_cbranch_scc1 b1_238
buffer_store_dwordx4 v[204:207],v21,s[20:23],s84 offen offset:2048
buffer_store_dwordx4 v[204:207],v21,s[20:23],s84 offen offset:3072
b2_239:
s_cmp_eq_u32 s56,1
s_cbranch_scc1 b1_240
buffer_store_dwordx4 v[204:207],v21,s[20:23],s85 offen offset:0
buffer_store_dwordx4 v[204:207],v21,s[20:23],s85 offen offset:1024
b2_241:
s_mul_i32 s64,s77,32768
s_add_u32 s66,s66,s64
s_mul_i32 s64,s77,6144
s_add_u32 s75,s75,s64
s_cmp_eq_u32 s75,24576
s_cselect_b32 s75,0,s75
s_add_u32 s63,s63,s77
s_mov_b32 s77,0
v_cmp_gt_u32 vcc,s53,v16
s_add_u32 s60,s60,1
s_cbranch_vccz WR_218
WN_219:
s_waitcnt lgkmcnt(2)
v_mfma_f32_16x16x32_bf16 v[32:35],a[0:3],v[64:67],0
s_waitcnt vmcnt(19)
s_add_u32 s71,s60,2
ds_read_b128 v[76:79],v4 offset:3072
v_mfma_f32_16x16x32_bf16 v[36:39],a[4:7],v[64:67],0
s_waitcnt lgkmcnt(2)
s_add_u32 s53,s60,3
v_mfma_f32_16x16x32_bf16 v[32:35],a[8:11],v[68:71],v[32:35]
s_waitcnt vmcnt(18)
ds_read_b128 v[80:83],v4 offset:4096
v_mov_b32 v212,v40
v_mfma_f32_16x16x32_bf16 v[36:39],a[12:15],v[68:71],v[36:39]
s_waitcnt lgkmcnt(2)
v_mov_b32 v213,v41
v_mov_b32 v214,v42
v_mfma_f32_16x16x32_bf16 v[32:35],a[16:19],v[72:75],v[32:35]
s_waitcnt vmcnt(17)
ds_read_b128 v[84:87],v4 offset:5120
v_mov_b32 v215,v43
v_mfma_f32_16x16x32_bf16 v[36:39],a[20:23],v[72:75],v[36:39]
s_waitcnt lgkmcnt(2)
v_mov_b32 v216,v44
v_mov_b32 v217,v45
v_mfma_f32_16x16x32_bf16 v[32:35],a[24:27],v[76:79],v[32:35]
s_waitcnt vmcnt(15)
ds_read_b128 v[88:91],v4 offset:6144
v_mov_b32 v218,v46
v_mfma_f32_16x16x32_bf16 v[36:39],a[28:31],v[76:79],v[36:39]
s_waitcnt lgkmcnt(2)
s_barrier
ds_read_b128 v[92:95],v5 offset:0
v_mfma_f32_16x16x32_bf16 v[32:35],a[32:35],v[80:83],v[32:35]
ds_read_b128 v[96:99],v5 offset:1024
v_mov_b32 v219,v47
v_mfma_f32_16x16x32_bf16 v[36:39],a[36:39],v[80:83],v[36:39]
s_waitcnt lgkmcnt(3)
s_mov_b32 s77,1
ds_read_b128 v[100:103],v5 offset:2048
v_mfma_f32_16x16x32_bf16 v[32:35],a[40:43],v[84:87],v[32:35]
ds_read_b128 v[104:107],v5 offset:3072
v_mfma_f32_16x16x32_bf16 v[36:39],a[44:47],v[84:87],v[36:39]
s_waitcnt lgkmcnt(4)
ds_read_b128 v[108:111],v5 offset:4096
v_mfma_f32_16x16x32_bf16 v[32:35],a[48:51],v[88:91],v[32:35]
ds_read_b128 v[112:115],v5 offset:5120
v_mfma_f32_16x16x32_bf16 v[36:39],a[52:55],v[88:91],v[36:39]
s_waitcnt lgkmcnt(5)
v_mfma_f32_16x16x32_bf16 v[32:35],a[56:59],v[92:95],v[32:35]
s_waitcnt vmcnt(7)
s_cmp_eq_u32 s77,0
s_cselect_b32 s57,2.0,0
ds_read_b128 v[116:119],v5 offset:6144
v_mfma_f32_16x16x32_bf16 v[36:39],a[60:63],v[92:95],v[36:39]
s_waitcnt lgkmcnt(5)
v_or_b32 v21,s57,v0
v_or_b32 v22,s57,v18
v_mfma_f32_16x16x32_bf16 v[32:35],a[64:67],v[96:99],v[32:35]
ds_read_b128 v[120:123],v6 offset:0
v_lshlrev_b32 v168,16,v160
v_mfma_f32_16x16x32_bf16 v[36:39],a[68:71],v[96:99],v[36:39]
s_waitcnt lgkmcnt(5)
v_and_b32 v169,s73,v160
v_lshlrev_b32 v170,16,v161
v_mfma_f32_16x16x32_bf16 v[32:35],a[72:75],v[100:103],v[32:35]
ds_read_b128 v[124:127],v6 offset:1024
v_and_b32 v171,s73,v161
v_mfma_f32_16x16x32_bf16 v[36:39],a[76:79],v[100:103],v[36:39]
s_waitcnt lgkmcnt(5)
v_lshlrev_b32 v172,16,v162
v_and_b32 v173,s73,v162
v_mfma_f32_16x16x32_bf16 v[32:35],a[80:83],v[104:107],v[32:35]
ds_read_b128 v[64:67],v6 offset:2048
v_lshlrev_b32 v174,16,v163
v_mfma_f32_16x16x32_bf16 v[36:39],a[84:87],v[104:107],v[36:39]
s_waitcnt lgkmcnt(5)
v_and_b32 v175,s73,v163
v_lshlrev_b32 v176,16,v164
v_mfma_f32_16x16x32_bf16 v[32:35],a[88:91],v[108:111],v[32:35]
ds_read_b128 v[68:71],v6 offset:3072
v_and_b32 v177,s73,v164
v_mfma_f32_16x16x32_bf16 v[36:39],a[92:95],v[108:111],v[36:39]
s_waitcnt lgkmcnt(5)
v_lshlrev_b32 v178,16,v165
v_and_b32 v179,s73,v165
v_mfma_f32_16x16x32_bf16 v[32:35],a[96:99],v[112:115],v[32:35]
s_add_u32 s84,s74,s75
s_add_u32 s85,s84,4096
ds_read_b128 v[72:75],v6 offset:4096
buffer_load_dwordx4 v[128:131],v0,s[20:23],s84 offen offset:0 sc1
buffer_load_dwordx4 v[132:135],v0,s[20:23],s84 offen offset:1024 sc1
v_mfma_f32_16x16x32_bf16 v[36:39],a[100:103],v[112:115],v[36:39]
s_waitcnt lgkmcnt(5)
buffer_load_dwordx4 v[136:139],v0,s[20:23],s84 offen offset:2048 sc1
v_lshlrev_b32 v180,16,v166
v_mfma_f32_16x16x32_bf16 v[32:35],a[104:107],v[116:119],v[32:35]
ds_read_b128 v[76:79],v6 offset:5120
v_and_b32 v181,s73,v166
v_mfma_f32_16x16x32_bf16 v[36:39],a[108:111],v[116:119],v[36:39]
s_waitcnt lgkmcnt(5)
buffer_load_dwordx4 v[140:143],v0,s[20:23],s84 offen offset:3072 sc1
v_lshlrev_b32 v182,16,v167
v_mfma_f32_16x16x32_bf16 v[32:35],a[112:115],v[120:123],v[32:35]
ds_read_b128 v[80:83],v6 offset:6144
v_and_b32 v183,s73,v167
v_mfma_f32_16x16x32_bf16 v[36:39],a[116:119],v[120:123],v[36:39]
s_waitcnt lgkmcnt(5)
buffer_load_dwordx4 v[144:147],v0,s[20:23],s85 offen offset:0 sc1
v_add_f32 v212,v212,v176
v_mfma_f32_16x16x32_bf16 v[32:35],a[120:123],v[124:127],v[32:35]
ds_read_b128 v[84:87],v7 offset:0
v_add_f32 v213,v213,v177
v_mfma_f32_16x16x32_bf16 v[36:39],a[124:127],v[124:127],v[36:39]
s_waitcnt lgkmcnt(5)
buffer_load_dwordx4 v[148:151],v0,s[20:23],s85 offen offset:1024 sc1
v_add_f32 v214,v214,v178
v_mfma_f32_16x16x32_bf16 v[32:35],a[128:131],v[64:67],v[32:35]
ds_read_b128 v[88:91],v7 offset:1024
v_add_f32 v215,v215,v179
v_mfma_f32_16x16x32_bf16 v[36:39],a[132:135],v[64:67],v[36:39]
s_waitcnt lgkmcnt(5)
v_add_f32 v216,v216,v180
v_add_f32 v217,v217,v181
v_mfma_f32_16x16x32_bf16 v[32:35],a[136:139],v[68:71],v[32:35]
ds_read_b128 v[92:95],v7 offset:2048
v_add_f32 v218,v218,v182
v_mfma_f32_16x16x32_bf16 v[36:39],a[140:143],v[68:71],v[36:39]
s_waitcnt lgkmcnt(5)
buffer_load_dword v16,v2,s[20:23],s68 offen sc1
v_add_f32 v219,v219,v183
v_mfma_f32_16x16x32_bf16 v[32:35],a[144:147],v[72:75],v[32:35]
ds_read_b128 v[96:99],v7 offset:3072
v_fma_f32 v168,v212,v152,v168
v_mfma_f32_16x16x32_bf16 v[36:39],a[148:151],v[72:75],v[36:39]
s_waitcnt lgkmcnt(5)
v_fma_f32 v169,v213,v153,v169
v_fma_f32 v170,v214,v154,v170
v_mfma_f32_16x16x32_bf16 v[32:35],a[152:155],v[76:79],v[32:35]
ds_read_b128 v[100:103],v7 offset:4096
v_fma_f32 v171,v215,v155,v171
v_mfma_f32_16x16x32_bf16 v[36:39],a[156:159],v[76:79],v[36:39]
s_waitcnt lgkmcnt(5)
v_fma_f32 v172,v216,v156,v172
v_fma_f32 v173,v217,v157,v173
v_mfma_f32_16x16x32_bf16 v[32:35],a[160:163],v[80:83],v[32:35]
ds_read_b128 v[104:107],v7 offset:5120
v_fma_f32 v174,v218,v158,v174
v_mfma_f32_16x16x32_bf16 v[36:39],a[164:167],v[80:83],v[36:39]
s_waitcnt lgkmcnt(5)
v_fma_f32 v175,v219,v159,v175
v_mfma_f32_16x16x32_bf16 v[32:35],a[168:171],v[84:87],v[32:35]
ds_read_b128 v[108:111],v7 offset:6144
v_mfma_f32_16x16x32_bf16 v[36:39],a[172:175],v[84:87],v[36:39]
s_waitcnt lgkmcnt(5)
s_add_u32 s55,s55,32768
buffer_load_dwordx4 v[160:163],v0,s[20:23],s82 offen
v_mfma_f32_16x16x32_bf16 v[32:35],a[176:179],v[88:91],v[32:35]
s_and_b32 s55,s55,0x1ffff
s_add_u32 s64,s82,13631488
buffer_load_dwordx4 v[164:167],v0,s[20:23],s64 offen
v_mfma_f32_16x16x32_bf16 v[36:39],a[180:183],v[88:91],v[36:39]
s_waitcnt lgkmcnt(4)
s_add_u32 s82,s82,32768
v_add_u32 v4,s55,v8
v_mfma_f32_16x16x32_bf16 v[32:35],a[184:187],v[92:95],v[32:35]
s_waitcnt vmcnt(3)
s_cmp_eq_u32 s77,0
s_cbranch_scc1 go_254
ck_252:
v_max3_u32 v184,v128,v129,v130
v_max3_u32 v185,v140,v141,v142
v_max3_u32 v184,v184,v131,v132
v_max3_u32 v185,v185,v143,v144
v_max3_u32 v184,v184,v133,v134
v_max3_u32 v185,v185,v145,v146
v_max3_u32 v184,v184,v135,v136
v_max3_u32 v185,v185,v147,v148
v_max3_u32 v184,v184,v137,v138
v_max3_u32 v185,v185,v149,v150
v_max3_u32 v184,v184,v139,v151
v_max_u32 v184,v184,v185
v_cmp_eq_u32 vcc,-1,v184
s_cbranch_vccnz rt_253
go_254:
v_mfma_f32_16x16x32_bf16 v[36:39],a[188:191],v[92:95],v[36:39]
s_waitcnt lgkmcnt(3)
v_add_u32 v5,s55,v9
v_add_u32 v6,s55,v10
v_add_f32 v128,v128,v136
v_mfma_f32_16x16x32_bf16 v[32:35],a[192:195],v[96:99],v[32:35]
v_add_u32 v7,s55,v11
v_add_f32 v129,v129,v137
v_add_f32 v130,v130,v138
v_mfma_f32_16x16x32_bf16 v[36:39],a[196:199],v[96:99],v[36:39]
s_waitcnt lgkmcnt(2)
v_add_f32 v131,v131,v139
v_add_f32 v132,v132,v140
v_add_f32 v133,v133,v141
v_mfma_f32_16x16x32_bf16 v[32:35],a[200:203],v[100:103],v[32:35]
v_add_f32 v134,v134,v142
v_add_f32 v135,v135,v143
v_add_f32 v128,v128,v144
v_mfma_f32_16x16x32_bf16 v[36:39],a[204:207],v[100:103],v[36:39]
s_waitcnt lgkmcnt(1)
v_add_f32 v129,v129,v145
v_add_f32 v130,v130,v146
v_add_f32 v131,v131,v147
v_mfma_f32_16x16x32_bf16 v[32:35],a[208:211],v[104:107],v[32:35]
v_add_f32 v132,v132,v148
v_add_f32 v133,v133,v149
v_add_f32 v134,v134,v150
v_mfma_f32_16x16x32_bf16 v[36:39],a[212:215],v[104:107],v[36:39]
s_waitcnt lgkmcnt(0)
v_add_f32 v135,v135,v151
v_fma_f32 v168,v128,v152,v168
v_fma_f32 v169,v129,v153,v169
v_mfma_f32_16x16x32_bf16 v[40:43],a[216:219],v[108:111],v[32:35]
v_fma_f32 v170,v130,v154,v170
v_fma_f32 v171,v131,v155,v171
v_fma_f32 v172,v132,v156,v172
v_mfma_f32_16x16x32_bf16 v[44:47],a[220:223],v[108:111],v[36:39]
s_waitcnt vmcnt(2)
v_fma_f32 v173,v133,v157,v173
v_fma_f32 v174,v134,v158,v174
v_fma_f32 v175,v135,v159,v175
v_cvt_pk_bf16_f32 v176,v168,v169
v_cvt_pk_bf16_f32 v177,v170,v171
v_cvt_pk_bf16_f32 v178,v172,v173
v_cvt_pk_bf16_f32 v179,v174,v175
s_and_b32 s64,s66,0xffff8000
buffer_store_dwordx4 v[176:179],v22,s[24:27],s64 offen
s_cmp_eq_u32 s56,1
s_cbranch_scc1 b1_246
buffer_store_dwordx4 v[204:207],v21,s[20:23],s84 offen offset:0
buffer_store_dwordx4 v[204:207],v21,s[20:23],s84 offen offset:1024
b2_247:
s_cmp_eq_u32 s56,1
s_cbranch_scc1 b1_248
buffer_store_dwordx4 v[204:207],v21,s[20:23],s84 offen offset:2048
buffer_store_dwordx4 v[204:207],v21,s[20:23],s84 offen offset:3072
b2_249:
s_cmp_eq_u32 s56,1
s_cbranch_scc1 b1_250
buffer_store_dwordx4 v[204:207],v21,s[20:23],s85 offen offset:0
buffer_store_dwordx4 v[204:207],v21,s[20:23],s85 offen offset:1024
b2_251:
s_mul_i32 s64,s77,32768
s_add_u32 s66,s66,s64
s_mul_i32 s64,s77,6144
s_add_u32 s75,s75,s64
s_cmp_eq_u32 s75,24576
s_cselect_b32 s75,0,s75
s_add_u32 s63,s63,s77
s_mov_b32 s77,0
v_cmp_gt_u32 vcc,s71,v16
s_add_u32 s60,s60,1
s_branch endN_245
BN_221:
s_waitcnt vmcnt(6)
ds_read_b128 v[64:67],v4 offset:0
s_waitcnt vmcnt(5)
ds_read_b128 v[68:71],v4 offset:1024
s_waitcnt vmcnt(4)
ds_read_b128 v[72:75],v4 offset:2048
s_waitcnt vmcnt(3)
ds_read_b128 v[76:79],v4 offset:3072
s_waitcnt lgkmcnt(3)
v_mfma_f32_16x16x32_bf16 v[32:35],a[0:3],v[64:67],0
s_add_u32 s71,s60,2
s_add_u32 s53,s60,3
v_mfma_f32_16x16x32_bf16 v[36:39],a[4:7],v[64:67],0
s_waitcnt lgkmcnt(2)
s_waitcnt vmcnt(2)
ds_read_b128 v[80:83],v4 offset:4096
v_mfma_f32_16x16x32_bf16 v[32:35],a[8:11],v[68:71],v[32:35]
v_mfma_f32_16x16x32_bf16 v[36:39],a[12:15],v[68:71],v[36:39]
s_waitcnt lgkmcnt(2)
s_waitcnt vmcnt(1)
ds_read_b128 v[84:87],v4 offset:5120
v_mfma_f32_16x16x32_bf16 v[32:35],a[16:19],v[72:75],v[32:35]
v_mfma_f32_16x16x32_bf16 v[36:39],a[20:23],v[72:75],v[36:39]
s_waitcnt lgkmcnt(2)
s_waitcnt vmcnt(0)
ds_read_b128 v[88:91],v4 offset:6144
v_mfma_f32_16x16x32_bf16 v[32:35],a[24:27],v[76:79],v[32:35]
v_mfma_f32_16x16x32_bf16 v[36:39],a[28:31],v[76:79],v[36:39]
s_waitcnt lgkmcnt(2)
s_barrier
ds_read_b128 v[92:95],v5 offset:0
v_mfma_f32_16x16x32_bf16 v[32:35],a[32:35],v[80:83],v[32:35]
ds_read_b128 v[96:99],v5 offset:1024
v_mfma_f32_16x16x32_bf16 v[36:39],a[36:39],v[80:83],v[36:39]
s_waitcnt lgkmcnt(3)
ds_read_b128 v[100:103],v5 offset:2048
v_mfma_f32_16x16x32_bf16 v[32:35],a[40:43],v[84:87],v[32:35]
ds_read_b128 v[104:107],v5 offset:3072
v_mfma_f32_16x16x32_bf16 v[36:39],a[44:47],v[84:87],v[36:39]
s_waitcnt lgkmcnt(4)
ds_read_b128 v[108:111],v5 offset:4096
v_mfma_f32_16x16x32_bf16 v[32:35],a[48:51],v[88:91],v[32:35]
ds_read_b128 v[112:115],v5 offset:5120
v_mfma_f32_16x16x32_bf16 v[36:39],a[52:55],v[88:91],v[36:39]
s_waitcnt lgkmcnt(5)
v_mfma_f32_16x16x32_bf16 v[32:35],a[56:59],v[92:95],v[32:35]
s_cmp_eq_u32 s77,0
s_cselect_b32 s57,2.0,0
ds_read_b128 v[116:119],v5 offset:6144
v_mfma_f32_16x16x32_bf16 v[36:39],a[60:63],v[92:95],v[36:39]
s_waitcnt lgkmcnt(5)
v_or_b32 v21,s57,v0
v_or_b32 v22,s57,v18
v_mfma_f32_16x16x32_bf16 v[32:35],a[64:67],v[96:99],v[32:35]
ds_read_b128 v[120:123],v6 offset:0
v_lshlrev_b32 v168,16,v160
v_mfma_f32_16x16x32_bf16 v[36:39],a[68:71],v[96:99],v[36:39]
s_waitcnt lgkmcnt(5)
v_and_b32 v169,s73,v160
v_lshlrev_b32 v170,16,v161
v_mfma_f32_16x16x32_bf16 v[32:35],a[72:75],v[100:103],v[32:35]
ds_read_b128 v[124:127],v6 offset:1024
v_and_b32 v171,s73,v161
v_mfma_f32_16x16x32_bf16 v[36:39],a[76:79],v[100:103],v[36:39]
s_waitcnt lgkmcnt(5)
v_lshlrev_b32 v172,16,v162
v_and_b32 v173,s73,v162
v_mfma_f32_16x16x32_bf16 v[32:35],a[80:83],v[104:107],v[32:35]
ds_read_b128 v[64:67],v6 offset:2048
v_lshlrev_b32 v174,16,v163
v_mfma_f32_16x16x32_bf16 v[36:39],a[84:87],v[104:107],v[36:39]
s_waitcnt lgkmcnt(5)
v_and_b32 v175,s73,v163
v_lshlrev_b32 v176,16,v164
v_mfma_f32_16x16x32_bf16 v[32:35],a[88:91],v[108:111],v[32:35]
ds_read_b128 v[68:71],v6 offset:3072
v_and_b32 v177,s73,v164
v_mfma_f32_16x16x32_bf16 v[36:39],a[92:95],v[108:111],v[36:39]
s_waitcnt lgkmcnt(5)
v_lshlrev_b32 v178,16,v165
v_and_b32 v179,s73,v165
v_mfma_f32_16x16x32_bf16 v[32:35],a[96:99],v[112:115],v[32:35]
s_add_u32 s84,s74,s75
s_add_u32 s85,s84,4096
ds_read_b128 v[72:75],v6 offset:4096
buffer_load_dwordx4 v[128:131],v0,s[20:23],s84 offen offset:0 sc1
buffer_load_dwordx4 v[132:135],v0,s[20:23],s84 offen offset:1024 sc1
v_mfma_f32_16x16x32_bf16 v[36:39],a[100:103],v[112:115],v[36:39]
s_waitcnt lgkmcnt(5)
buffer_load_dwordx4 v[136:139],v0,s[20:23],s84 offen offset:2048 sc1
v_lshlrev_b32 v180,16,v166
v_mfma_f32_16x16x32_bf16 v[32:35],a[104:107],v[116:119],v[32:35]
ds_read_b128 v[76:79],v6 offset:5120
v_and_b32 v181,s73,v166
v_mfma_f32_16x16x32_bf16 v[36:39],a[108:111],v[116:119],v[36:39]
s_waitcnt lgkmcnt(5)
buffer_load_dwordx4 v[140:143],v0,s[20:23],s84 offen offset:3072 sc1
v_lshlrev_b32 v182,16,v167
v_mfma_f32_16x16x32_bf16 v[32:35],a[112:115],v[120:123],v[32:35]
ds_read_b128 v[80:83],v6 offset:6144
v_and_b32 v183,s73,v167
v_mfma_f32_16x16x32_bf16 v[36:39],a[116:119],v[120:123],v[36:39]
s_waitcnt lgkmcnt(5)
buffer_load_dwordx4 v[144:147],v0,s[20:23],s85 offen offset:0 sc1
v_add_f32 v212,v212,v176
v_mfma_f32_16x16x32_bf16 v[32:35],a[120:123],v[124:127],v[32:35]
ds_read_b128 v[84:87],v7 offset:0
v_add_f32 v213,v213,v177
v_mfma_f32_16x16x32_bf16 v[36:39],a[124:127],v[124:127],v[36:39]
s_waitcnt lgkmcnt(5)
buffer_load_dwordx4 v[148:151],v0,s[20:23],s85 offen offset:1024 sc1
v_add_f32 v214,v214,v178
v_mfma_f32_16x16x32_bf16 v[32:35],a[128:131],v[64:67],v[32:35]
ds_read_b128 v[88:91],v7 offset:1024
v_add_f32 v215,v215,v179
v_mfma_f32_16x16x32_bf16 v[36:39],a[132:135],v[64:67],v[36:39]
s_waitcnt lgkmcnt(5)
v_add_f32 v216,v216,v180
v_add_f32 v217,v217,v181
v_mfma_f32_16x16x32_bf16 v[32:35],a[136:139],v[68:71],v[32:35]
ds_read_b128 v[92:95],v7 offset:2048
v_add_f32 v218,v218,v182
v_mfma_f32_16x16x32_bf16 v[36:39],a[140:143],v[68:71],v[36:39]
s_waitcnt lgkmcnt(5)
buffer_load_dword v16,v2,s[20:23],s68 offen sc1
v_add_f32 v219,v219,v183
v_mfma_f32_16x16x32_bf16 v[32:35],a[144:147],v[72:75],v[32:35]
ds_read_b128 v[96:99],v7 offset:3072
v_fma_f32 v168,v212,v152,v168
v_mfma_f32_16x16x32_bf16 v[36:39],a[148:151],v[72:75],v[36:39]
s_waitcnt lgkmcnt(5)
v_fma_f32 v169,v213,v153,v169
v_fma_f32 v170,v214,v154,v170
v_mfma_f32_16x16x32_bf16 v[32:35],a[152:155],v[76:79],v[32:35]
ds_read_b128 v[100:103],v7 offset:4096
v_fma_f32 v171,v215,v155,v171
v_mfma_f32_16x16x32_bf16 v[36:39],a[156:159],v[76:79],v[36:39]
s_waitcnt lgkmcnt(5)
v_fma_f32 v172,v216,v156,v172
v_fma_f32 v173,v217,v157,v173
v_mfma_f32_16x16x32_bf16 v[32:35],a[160:163],v[80:83],v[32:35]
ds_read_b128 v[104:107],v7 offset:5120
v_fma_f32 v174,v218,v158,v174
v_mfma_f32_16x16x32_bf16 v[36:39],a[164:167],v[80:83],v[36:39]
s_waitcnt lgkmcnt(5)
v_fma_f32 v175,v219,v159,v175
v_mfma_f32_16x16x32_bf16 v[32:35],a[168:171],v[84:87],v[32:35]
ds_read_b128 v[108:111],v7 offset:6144
v_mfma_f32_16x16x32_bf16 v[36:39],a[172:175],v[84:87],v[36:39]
s_waitcnt lgkmcnt(5)
s_add_u32 s55,s55,32768
buffer_load_dwordx4 v[160:163],v0,s[20:23],s82 offen
v_mfma_f32_16x16x32_bf16 v[32:35],a[176:179],v[88:91],v[32:35]
s_and_b32 s55,s55,0x1ffff
s_add_u32 s64,s82,13631488
buffer_load_dwordx4 v[164:167],v0,s[20:23],s64 offen
v_mfma_f32_16x16x32_bf16 v[36:39],a[180:183],v[88:91],v[36:39]
s_waitcnt lgkmcnt(4)
s_add_u32 s82,s82,32768
v_add_u32 v4,s55,v8
v_mfma_f32_16x16x32_bf16 v[32:35],a[184:187],v[92:95],v[32:35]
s_waitcnt vmcnt(3)
s_cmp_eq_u32 s77,0
s_cbranch_scc1 go_263
ck_261:
v_max3_u32 v184,v128,v129,v130
v_max3_u32 v185,v140,v141,v142
v_max3_u32 v184,v184,v131,v132
v_max3_u32 v185,v185,v143,v144
v_max3_u32 v184,v184,v133,v134
v_max3_u32 v185,v185,v145,v146
v_max3_u32 v184,v184,v135,v136
v_max3_u32 v185,v185,v147,v148
v_max3_u32 v184,v184,v137,v138
v_max3_u32 v185,v185,v149,v150
v_max3_u32 v184,v184,v139,v151
v_max_u32 v184,v184,v185
v_cmp_eq_u32 vcc,-1,v184
s_cbranch_vccnz rt_262
go_263:
v_mfma_f32_16x16x32_bf16 v[36:39],a[188:191],v[92:95],v[36:39]
s_waitcnt lgkmcnt(3)
v_add_u32 v5,s55,v9
v_add_u32 v6,s55,v10
v_add_f32 v128,v128,v136
v_mfma_f32_16x16x32_bf16 v[32:35],a[192:195],v[96:99],v[32:35]
v_add_u32 v7,s55,v11
v_add_f32 v129,v129,v137
v_add_f32 v130,v130,v138
v_mfma_f32_16x16x32_bf16 v[36:39],a[196:199],v[96:99],v[36:39]
s_waitcnt lgkmcnt(2)
v_add_f32 v131,v131,v139
v_add_f32 v132,v132,v140
v_add_f32 v133,v133,v141
v_mfma_f32_16x16x32_bf16 v[32:35],a[200:203],v[100:103],v[32:35]
v_add_f32 v134,v134,v142
v_add_f32 v135,v135,v143
v_add_f32 v128,v128,v144
v_mfma_f32_16x16x32_bf16 v[36:39],a[204:207],v[100:103],v[36:39]
s_waitcnt lgkmcnt(1)
v_add_f32 v129,v129,v145
v_add_f32 v130,v130,v146
v_add_f32 v131,v131,v147
v_mfma_f32_16x16x32_bf16 v[32:35],a[208:211],v[104:107],v[32:35]
v_add_f32 v132,v132,v148
v_add_f32 v133,v133,v149
v_add_f32 v134,v134,v150
v_mfma_f32_16x16x32_bf16 v[36:39],a[212:215],v[104:107],v[36:39]
s_waitcnt lgkmcnt(0)
v_add_f32 v135,v135,v151
v_fma_f32 v168,v128,v152,v168
v_fma_f32 v169,v129,v153,v169
v_mfma_f32_16x16x32_bf16 v[40:43],a[216:219],v[108:111],v[32:35]
v_fma_f32 v170,v130,v154,v170
v_fma_f32 v171,v131,v155,v171
v_fma_f32 v172,v132,v156,v172
v_mfma_f32_16x16x32_bf16 v[44:47],a[220:223],v[108:111],v[36:39]
s_waitcnt vmcnt(2)
v_fma_f32 v173,v133,v157,v173
v_fma_f32 v174,v134,v158,v174
v_fma_f32 v175,v135,v159,v175
v_cvt_pk_bf16_f32 v176,v168,v169
v_cvt_pk_bf16_f32 v177,v170,v171
v_cvt_pk_bf16_f32 v178,v172,v173
v_cvt_pk_bf16_f32 v179,v174,v175
s_and_b32 s64,s66,0xffff8000
buffer_store_dwordx4 v[176:179],v22,s[24:27],s64 offen
s_cmp_eq_u32 s56,1
s_cbranch_scc1 b1_255
buffer_store_dwordx4 v[204:207],v21,s[20:23],s84 offen offset:0
buffer_store_dwordx4 v[204:207],v21,s[20:23],s84 offen offset:1024
b2_256:
s_cmp_eq_u32 s56,1
s_cbranch_scc1 b1_257
buffer_store_dwordx4 v[204:207],v21,s[20:23],s84 offen offset:2048
buffer_store_dwordx4 v[204:207],v21,s[20:23],s84 offen offset:3072
b2_258:
s_cmp_eq_u32 s56,1
s_cbranch_scc1 b1_259
buffer_store_dwordx4 v[204:207],v21,s[20:23],s85 offen offset:0
buffer_store_dwordx4 v[204:207],v21,s[20:23],s85 offen offset:1024
b2_260:
s_mul_i32 s64,s77,32768
s_add_u32 s66,s66,s64
s_mul_i32 s64,s77,6144
s_add_u32 s75,s75,s64
s_cmp_eq_u32 s75,24576
s_cselect_b32 s75,0,s75
s_add_u32 s63,s63,s77
s_mov_b32 s77,0
v_cmp_gt_u32 vcc,s71,v16
s_add_u32 s60,s60,1
endN_245:
s_cbranch_vccnz nb_224
s_mov_b32 m0,s70
s_nop 0
buffer_load_dwordx4 v3,s[20:23],s61 offen offset:0 lds
buffer_load_dwordx4 v3,s[20:23],s61 offen offset:1024 lds
buffer_load_dwordx4 v3,s[20:23],s61 offen offset:2048 lds
buffer_load_dwordx4 v3,s[20:23],s61 offen offset:3072 lds
s_add_u32 m0,s70,4096
s_nop 0
buffer_load_dwordx4 v3,s[20:23],s62 offen offset:0 lds
buffer_load_dwordx4 v3,s[20:23],s62 offen offset:1024 lds
buffer_load_dwordx4 v3,s[20:23],s62 offen offset:2048 lds
s_add_u32 s61,s61,114688
s_add_u32 s62,s62,114688
s_add_u32 s70,s70,32768
s_and_b32 s70,s70,0x1ffff
v_mov_b32 v212,v40
v_mov_b32 v213,v41
v_mov_b32 v214,v42
v_mov_b32 v215,v43
v_mov_b32 v216,v44
v_mov_b32 v217,v45
v_mov_b32 v218,v46
v_mov_b32 v219,v47
s_mov_b32 s77,1
s_branch dec_223
nb_224:
s_nop 3
s_mov_b32 s77,1
s_add_u32 s84,s74,s75
s_add_u32 s85,s84,4096
buffer_load_dwordx4 v[128:131],v0,s[20:23],s84 offen offset:0 sc1
buffer_load_dwordx4 v[132:135],v0,s[20:23],s84 offen offset:1024 sc1
buffer_load_dwordx4 v[136:139],v0,s[20:23],s84 offen offset:2048 sc1
buffer_load_dwordx4 v[140:143],v0,s[20:23],s84 offen offset:3072 sc1
buffer_load_dwordx4 v[144:147],v0,s[20:23],s85 offen offset:0 sc1
buffer_load_dwordx4 v[148:151],v0,s[20:23],s85 offen offset:1024 sc1
s_waitcnt vmcnt(13)
s_cmp_eq_u32 s77,0
s_cselect_b32 s57,2.0,0
v_or_b32 v21,s57,v0
v_or_b32 v22,s57,v18
v_lshlrev_b32 v168,16,v160
v_and_b32 v169,s73,v160
v_lshlrev_b32 v170,16,v161
v_and_b32 v171,s73,v161
v_lshlrev_b32 v172,16,v162
v_and_b32 v173,s73,v162
v_lshlrev_b32 v174,16,v163
v_and_b32 v175,s73,v163
v_lshlrev_b32 v176,16,v164
v_and_b32 v177,s73,v164
v_lshlrev_b32 v178,16,v165
v_and_b32 v179,s73,v165
v_lshlrev_b32 v180,16,v166
v_and_b32 v181,s73,v166
v_lshlrev_b32 v182,16,v167
v_and_b32 v183,s73,v167
v_pk_add_f32 v[40:41],v[40:41],v[176:177]
v_pk_add_f32 v[42:43],v[42:43],v[178:179]
v_pk_add_f32 v[44:45],v[44:45],v[180:181]
v_pk_add_f32 v[46:47],v[46:47],v[182:183]
v_pk_fma_f32 v[168:169],v[40:41],v[152:153],v[168:169]
v_pk_fma_f32 v[170:171],v[42:43],v[154:155],v[170:171]
v_pk_fma_f32 v[172:173],v[44:45],v[156:157],v[172:173]
v_pk_fma_f32 v[174:175],v[46:47],v[158:159],v[174:175]
s_waitcnt vmcnt(0)
s_cmp_eq_u32 s77,0
s_cbranch_scc1 go_272
ck_270:
v_max3_u32 v184,v128,v129,v130
v_max3_u32 v185,v140,v141,v142
v_max3_u32 v184,v184,v131,v132
v_max3_u32 v185,v185,v143,v144
v_max3_u32 v184,v184,v133,v134
v_max3_u32 v185,v185,v145,v146
v_max3_u32 v184,v184,v135,v136
v_max3_u32 v185,v185,v147,v148
v_max3_u32 v184,v184,v137,v138
v_max3_u32 v185,v185,v149,v150
v_max3_u32 v184,v184,v139,v151
v_max_u32 v184,v184,v185
v_cmp_eq_u32 vcc,-1,v184
s_cbranch_vccnz rt_271
go_272:
buffer_load_dword v16,v2,s[20:23],s68 offen sc1
v_pk_add_f32 v[128:129],v[128:129],v[136:137]
v_pk_add_f32 v[130:131],v[130:131],v[138:139]
v_pk_add_f32 v[132:133],v[132:133],v[140:141]
v_pk_add_f32 v[134:135],v[134:135],v[142:143]
v_pk_add_f32 v[128:129],v[128:129],v[144:145]
v_pk_add_f32 v[130:131],v[130:131],v[146:147]
v_pk_add_f32 v[132:133],v[132:133],v[148:149]
v_pk_add_f32 v[134:135],v[134:135],v[150:151]
v_pk_fma_f32 v[168:169],v[128:129],v[152:153],v[168:169]
v_pk_fma_f32 v[170:171],v[130:131],v[154:155],v[170:171]
v_pk_fma_f32 v[172:173],v[132:133],v[156:157],v[172:173]
v_pk_fma_f32 v[174:175],v[134:135],v[158:159],v[174:175]
v_cvt_pk_bf16_f32 v176,v168,v169
v_cvt_pk_bf16_f32 v177,v170,v171
v_cvt_pk_bf16_f32 v178,v172,v173
v_cvt_pk_bf16_f32 v179,v174,v175
s_and_b32 s64,s66,0xffff8000
buffer_store_dwordx4 v[176:179],v22,s[24:27],s64 offen
s_cmp_eq_u32 s56,1
s_cbranch_scc1 b1_264
buffer_store_dwordx4 v[204:207],v21,s[20:23],s84 offen offset:0
buffer_store_dwordx4 v[204:207],v21,s[20:23],s84 offen offset:1024
b2_265:
s_cmp_eq_u32 s56,1
s_cbranch_scc1 b1_266
buffer_store_dwordx4 v[204:207],v21,s[20:23],s84 offen offset:2048
buffer_store_dwordx4 v[204:207],v21,s[20:23],s84 offen offset:3072
b2_267:
s_cmp_eq_u32 s56,1
s_cbranch_scc1 b1_268
buffer_store_dwordx4 v[204:207],v21,s[20:23],s85 offen offset:0
buffer_store_dwordx4 v[204:207],v21,s[20:23],s85 offen offset:1024
b2_269:
s_mul_i32 s64,s77,32768
s_add_u32 s66,s66,s64
s_mul_i32 s64,s77,6144
s_add_u32 s75,s75,s64
s_cmp_eq_u32 s75,24576
s_cselect_b32 s75,0,s75
s_add_u32 s63,s63,s77
s_mov_b32 s77,0
s_waitcnt vmcnt(7)
v_cmp_gt_u32 vcc,s71,v16
s_cbranch_vccz lag_222
s_cmp_ge_u32 s60,128
s_cbranch_scc1 done_170
plp_273:
buffer_load_dword v16,v2,s[20:23],s68 offen sc1
s_waitcnt vmcnt(0)
v_cmp_gt_u32 vcc,s71,v16
s_cbranch_vccz pok_274
s_sleep 4
s_sub_u32 s90,s90,1
s_cmp_gt_i32 s90,0
s_cbranch_scc1 plp_273
pok_274:
s_branch lag_222
b1_195:
s_nop 7
buffer_store_dwordx4 v[40:43],v0,s[20:23],s64 offen offset:0 sc1
buffer_store_dwordx4 v[44:47],v0,s[20:23],s64 offen offset:1024 sc1
s_branch b2_196
b1_198:
s_nop 7
buffer_store_dwordx4 v[40:43],v0,s[20:23],s64 offen offset:0 sc1
buffer_store_dwordx4 v[44:47],v0,s[20:23],s64 offen offset:1024 sc1
s_branch b2_199
b1_200:
s_nop 7
buffer_store_dwordx4 v[40:43],v0,s[20:23],s64 offen offset:0 sc1
buffer_store_dwordx4 v[44:47],v0,s[20:23],s64 offen offset:1024 sc1
s_branch b2_201
b1_202:
s_nop 7
buffer_store_dwordx4 v[40:43],v0,s[20:23],s64 offen offset:0 sc1
buffer_store_dwordx4 v[44:47],v0,s[20:23],s64 offen offset:1024 sc1
s_branch b2_203
b1_227:
s_nop 7
buffer_store_dwordx4 v[204:207],v21,s[20:23],s84 offen offset:0 sc1
buffer_store_dwordx4 v[204:207],v21,s[20:23],s84 offen offset:1024 sc1
s_branch b2_228
b1_229:
s_nop 7
buffer_store_dwordx4 v[204:207],v21,s[20:23],s84 offen offset:2048 sc1
buffer_store_dwordx4 v[204:207],v21,s[20:23],s84 offen offset:3072 sc1
s_branch b2_230
b1_231:
s_nop 7
buffer_store_dwordx4 v[204:207],v21,s[20:23],s85 offen offset:0 sc1
buffer_store_dwordx4 v[204:207],v21,s[20:23],s85 offen offset:1024 sc1
s_branch b2_232
rt_234:
s_sub_u32 s90,s90,1
s_cmp_gt_i32 s90,0
s_cbranch_scc0 go_235
s_add_u32 s84,s74,s75
s_add_u32 s85,s84,4096
buffer_load_dwordx4 v[128:131],v0,s[20:23],s84 offen offset:0 sc1
buffer_load_dwordx4 v[132:135],v0,s[20:23],s84 offen offset:1024 sc1
buffer_load_dwordx4 v[136:139],v0,s[20:23],s84 offen offset:2048 sc1
buffer_load_dwordx4 v[140:143],v0,s[20:23],s84 offen offset:3072 sc1
buffer_load_dwordx4 v[144:147],v0,s[20:23],s85 offen offset:0 sc1
buffer_load_dwordx4 v[148:151],v0,s[20:23],s85 offen offset:1024 sc1
s_waitcnt vmcnt(0)
s_branch ck_233
b1_236:
s_nop 7
buffer_store_dwordx4 v[204:207],v21,s[20:23],s84 offen offset:0 sc1
buffer_store_dwordx4 v[204:207],v21,s[20:23],s84 offen offset:1024 sc1
s_branch b2_237
b1_238:
s_nop 7
buffer_store_dwordx4 v[204:207],v21,s[20:23],s84 offen offset:2048 sc1
buffer_store_dwordx4 v[204:207],v21,s[20:23],s84 offen offset:3072 sc1
s_branch b2_239
b1_240:
s_nop 7
buffer_store_dwordx4 v[204:207],v21,s[20:23],s85 offen offset:0 sc1
buffer_store_dwordx4 v[204:207],v21,s[20:23],s85 offen offset:1024 sc1
s_branch b2_241
rt_243:
s_sub_u32 s90,s90,1
s_cmp_gt_i32 s90,0
s_cbranch_scc0 go_244
s_add_u32 s84,s74,s75
s_add_u32 s85,s84,4096
buffer_load_dwordx4 v[128:131],v0,s[20:23],s84 offen offset:0 sc1
buffer_load_dwordx4 v[132:135],v0,s[20:23],s84 offen offset:1024 sc1
buffer_load_dwordx4 v[136:139],v0,s[20:23],s84 offen offset:2048 sc1
buffer_load_dwordx4 v[140:143],v0,s[20:23],s84 offen offset:3072 sc1
buffer_load_dwordx4 v[144:147],v0,s[20:23],s85 offen offset:0 sc1
buffer_load_dwordx4 v[148:151],v0,s[20:23],s85 offen offset:1024 sc1
s_waitcnt vmcnt(0)
s_branch ck_242
b1_246:
s_nop 7
buffer_store_dwordx4 v[204:207],v21,s[20:23],s84 offen offset:0 sc1
buffer_store_dwordx4 v[204:207],v21,s[20:23],s84 offen offset:1024 sc1
s_branch b2_247
b1_248:
s_nop 7
buffer_store_dwordx4 v[204:207],v21,s[20:23],s84 offen offset:2048 sc1
buffer_store_dwordx4 v[204:207],v21,s[20:23],s84 offen offset:3072 sc1
s_branch b2_249
b1_250:
s_nop 7
buffer_store_dwordx4 v[204:207],v21,s[20:23],s85 offen offset:0 sc1
buffer_store_dwordx4 v[204:207],v21,s[20:23],s85 offen offset:1024 sc1
s_branch b2_251
rt_253:
s_sub_u32 s90,s90,1
s_cmp_gt_i32 s90,0
s_cbranch_scc0 go_254
s_add_u32 s84,s74,s75
s_add_u32 s85,s84,4096
buffer_load_dwordx4 v[128:131],v0,s[20:23],s84 offen offset:0 sc1
buffer_load_dwordx4 v[132:135],v0,s[20:23],s84 offen offset:1024 sc1
buffer_load_dwordx4 v[136:139],v0,s[20:23],s84 offen offset:2048 sc1
buffer_load_dwordx4 v[140:143],v0,s[20:23],s84 offen offset:3072 sc1
buffer_load_dwordx4 v[144:147],v0,s[20:23],s85 offen offset:0 sc1
buffer_load_dwordx4 v[148:151],v0,s[20:23],s85 offen offset:1024 sc1
s_waitcnt vmcnt(0)
s_branch ck_252
b1_255:
s_nop 7
buffer_store_dwordx4 v[204:207],v21,s[20:23],s84 offen offset:0 sc1
buffer_store_dwordx4 v[204:207],v21,s[20:23],s84 offen offset:1024 sc1
s_branch b2_256
b1_257:
s_nop 7
buffer_store_dwordx4 v[204:207],v21,s[20:23],s84 offen offset:2048 sc1
buffer_store_dwordx4 v[204:207],v21,s[20:23],s84 offen offset:3072 sc1
s_branch b2_258
b1_259:
s_nop 7
buffer_store_dwordx4 v[204:207],v21,s[20:23],s85 offen offset:0 sc1
buffer_store_dwordx4 v[204:207],v21,s[20:23],s85 offen offset:1024 sc1
s_branch b2_260
rt_262:
s_sub_u32 s90,s90,1
s_cmp_gt_i32 s90,0
s_cbranch_scc0 go_263
s_add_u32 s84,s74,s75
s_add_u32 s85,s84,4096
buffer_load_dwordx4 v[128:131],v0,s[20:23],s84 offen offset:0 sc1
buffer_load_dwordx4 v[132:135],v0,s[20:23],s84 offen offset:1024 sc1
buffer_load_dwordx4 v[136:139],v0,s[20:23],s84 offen offset:2048 sc1
buffer_load_dwordx4 v[140:143],v0,s[20:23],s84 offen offset:3072 sc1
buffer_load_dwordx4 v[144:147],v0,s[20:23],s85 offen offset:0 sc1
buffer_load_dwordx4 v[148:151],v0,s[20:23],s85 offen offset:1024 sc1
s_waitcnt vmcnt(0)
s_branch ck_261
b1_264:
s_nop 7
buffer_store_dwordx4 v[204:207],v21,s[20:23],s84 offen offset:0 sc1
buffer_store_dwordx4 v[204:207],v21,s[20:23],s84 offen offset:1024 sc1
s_branch b2_265
b1_266:
s_nop 7
buffer_store_dwordx4 v[204:207],v21,s[20:23],s84 offen offset:2048 sc1
buffer_store_dwordx4 v[204:207],v21,s[20:23],s84 offen offset:3072 sc1
s_branch b2_267
b1_268:
s_nop 7
buffer_store_dwordx4 v[204:207],v21,s[20:23],s85 offen offset:0 sc1
buffer_store_dwordx4 v[204:207],v21,s[20:23],s85 offen offset:1024 sc1
s_branch b2_269
rt_271:
s_sub_u32 s90,s90,1
s_cmp_gt_i32 s90,0
s_cbranch_scc0 go_272
s_add_u32 s84,s74,s75
s_add_u32 s85,s84,4096
buffer_load_dwordx4 v[128:131],v0,s[20:23],s84 offen offset:0 sc1
buffer_load_dwordx4 v[132:135],v0,s[20:23],s84 offen offset:1024 sc1
buffer_load_dwordx4 v[136:139],v0,s[20:23],s84 offen offset:2048 sc1
buffer_load_dwordx4 v[140:143],v0,s[20:23],s84 offen offset:3072 sc1
buffer_load_dwordx4 v[144:147],v0,s[20:23],s85 offen offset:0 sc1
buffer_load_dwordx4 v[148:151],v0,s[20:23],s85 offen offset:1024 sc1
s_waitcnt vmcnt(0)
s_branch ck_270
done_170:
s_endpgm
fl_w3:
v_and_b32 v21,15,v1
v_lshrrev_b32 v22,4,v1
v_lshrrev_b32 v23,2,v21
v_and_b32 v24,3,v21
s_lshl_b32 s61,s50,15
v_lshl_add_u32 v25,v22,3,v23
s_load_dwordx2 s[4:5],s[0:1],80
s_mov_b32 s52,0
s_mov_b32 s53,s59
s_mul_i32 s54,s52,7340032
s_lshl_b32 s64,s53,8
s_add_u32 s54,s54,s64
s_lshl_b32 s64,s50,6
s_add_u32 s54,s54,s64
s_waitcnt lgkmcnt(0)
s_mov_b32 s28,s4
s_and_b32 s29,s5,0xffff
s_mov_b32 s30,0x700000
s_mov_b32 s31,0x20000
v_lshrrev_b32 v26,2,v1
v_and_b32 v27,3,v1
v_mul_u32_u24 v16,7168,v26
v_lshl_add_u32 v16,v27,4,v16
v_lshlrev_b32 v17,6,v25
v_lshl_add_u32 v17,v24,4,v17
v_add_u32 v17,s61,v17
s_xor_b32 s62,s50,0
s_mul_i32 s62,s62,1835008
s_add_u32 s62,s62,s54
s_add_u32 m0,s61,0
s_nop 0
buffer_load_dwordx4 v16,s[28:31],s62 offen lds
s_add_u32 s62,s62,114688
s_add_u32 m0,m0,1024
s_waitcnt vmcnt(6)
buffer_load_dwordx4 v16,s[28:31],s62 offen lds
s_add_u32 s62,s62,114688
s_add_u32 m0,m0,1024
s_waitcnt vmcnt(6)
buffer_load_dwordx4 v16,s[28:31],s62 offen lds
s_add_u32 s62,s62,114688
s_add_u32 m0,m0,1024
s_waitcnt vmcnt(6)
buffer_load_dwordx4 v16,s[28:31],s62 offen lds
s_add_u32 s62,s62,114688
s_add_u32 m0,m0,1024
s_waitcnt vmcnt(6)
buffer_load_dwordx4 v16,s[28:31],s62 offen lds
s_add_u32 s62,s62,114688
s_add_u32 m0,m0,1024
s_waitcnt vmcnt(6)
buffer_load_dwordx4 v16,s[28:31],s62 offen lds
s_add_u32 s62,s62,114688
s_add_u32 m0,m0,1024
s_waitcnt vmcnt(6)
buffer_load_dwordx4 v16,s[28:31],s62 offen lds
s_add_u32 s62,s62,114688
s_add_u32 m0,m0,1024
s_waitcnt vmcnt(6)
buffer_load_dwordx4 v16,s[28:31],s62 offen lds
s_add_u32 s62,s62,114688
s_add_u32 m0,m0,1024
s_waitcnt vmcnt(6)
buffer_load_dwordx4 v16,s[28:31],s62 offen lds
s_add_u32 s62,s62,114688
s_add_u32 m0,m0,1024
s_waitcnt vmcnt(6)
buffer_load_dwordx4 v16,s[28:31],s62 offen lds
s_add_u32 s62,s62,114688
s_add_u32 m0,m0,1024
s_waitcnt vmcnt(6)
buffer_load_dwordx4 v16,s[28:31],s62 offen lds
s_add_u32 s62,s62,114688
s_add_u32 m0,m0,1024
s_waitcnt vmcnt(6)
buffer_load_dwordx4 v16,s[28:31],s62 offen lds
s_add_u32 s62,s62,114688
s_add_u32 m0,m0,1024
s_waitcnt vmcnt(6)
buffer_load_dwordx4 v16,s[28:31],s62 offen lds
s_add_u32 s62,s62,114688
s_add_u32 m0,m0,1024
s_waitcnt vmcnt(6)
buffer_load_dwordx4 v16,s[28:31],s62 offen lds
s_add_u32 s62,s62,114688
s_add_u32 m0,m0,1024
s_waitcnt vmcnt(6)
buffer_load_dwordx4 v16,s[28:31],s62 offen lds
s_add_u32 s62,s62,114688
s_add_u32 m0,m0,1024
s_waitcnt vmcnt(6)
buffer_load_dwordx4 v16,s[28:31],s62 offen lds
s_waitcnt vmcnt(6)
s_xor_b32 s62,s50,1
s_mul_i32 s62,s62,1835008
s_add_u32 s62,s62,s54
s_add_u32 m0,s61,16384
s_nop 0
buffer_load_dwordx4 v16,s[28:31],s62 offen lds
s_add_u32 s62,s62,114688
s_add_u32 m0,m0,1024
s_waitcnt vmcnt(6)
buffer_load_dwordx4 v16,s[28:31],s62 offen lds
s_add_u32 s62,s62,114688
s_add_u32 m0,m0,1024
s_waitcnt vmcnt(6)
buffer_load_dwordx4 v16,s[28:31],s62 offen lds
s_add_u32 s62,s62,114688
s_add_u32 m0,m0,1024
s_waitcnt vmcnt(6)
buffer_load_dwordx4 v16,s[28:31],s62 offen lds
s_add_u32 s62,s62,114688
s_add_u32 m0,m0,1024
s_waitcnt vmcnt(6)
buffer_load_dwordx4 v16,s[28:31],s62 offen lds
s_add_u32 s62,s62,114688
s_add_u32 m0,m0,1024
s_waitcnt vmcnt(6)
buffer_load_dwordx4 v16,s[28:31],s62 offen lds
s_add_u32 s62,s62,114688
s_add_u32 m0,m0,1024
s_waitcnt vmcnt(6)
buffer_load_dwordx4 v16,s[28:31],s62 offen lds
s_add_u32 s62,s62,114688
s_add_u32 m0,m0,1024
s_waitcnt vmcnt(6)
buffer_load_dwordx4 v16,s[28:31],s62 offen lds
s_add_u32 s62,s62,114688
s_add_u32 m0,m0,1024
s_waitcnt vmcnt(6)
buffer_load_dwordx4 v16,s[28:31],s62 offen lds
s_add_u32 s62,s62,114688
s_add_u32 m0,m0,1024
s_waitcnt vmcnt(6)
buffer_load_dwordx4 v16,s[28:31],s62 offen lds
s_add_u32 s62,s62,114688
s_add_u32 m0,m0,1024
s_waitcnt vmcnt(6)
buffer_load_dwordx4 v16,s[28:31],s62 offen lds
s_add_u32 s62,s62,114688
s_add_u32 m0,m0,1024
s_waitcnt vmcnt(6)
buffer_load_dwordx4 v16,s[28:31],s62 offen lds
s_add_u32 s62,s62,114688
s_add_u32 m0,m0,1024
s_waitcnt vmcnt(6)
buffer_load_dwordx4 v16,s[28:31],s62 offen lds
s_add_u32 s62,s62,114688
s_add_u32 m0,m0,1024
s_waitcnt vmcnt(6)
buffer_load_dwordx4 v16,s[28:31],s62 offen lds
s_add_u32 s62,s62,114688
s_add_u32 m0,m0,1024
s_waitcnt vmcnt(6)
buffer_load_dwordx4 v16,s[28:31],s62 offen lds
s_add_u32 s62,s62,114688
s_add_u32 m0,m0,1024
s_waitcnt vmcnt(6)
buffer_load_dwordx4 v16,s[28:31],s62 offen lds
s_waitcnt vmcnt(6)
s_waitcnt vmcnt(16)
ds_read_b64_tr_b16 a[0:1],v17 offset:0
ds_read_b64_tr_b16 a[2:3],v17 offset:256
ds_read_b64_tr_b16 a[4:5],v17 offset:8
ds_read_b64_tr_b16 a[6:7],v17 offset:264
ds_read_b64_tr_b16 a[8:9],v17 offset:2048
ds_read_b64_tr_b16 a[10:11],v17 offset:2304
ds_read_b64_tr_b16 a[12:13],v17 offset:2056
ds_read_b64_tr_b16 a[14:15],v17 offset:2312
ds_read_b64_tr_b16 a[16:17],v17 offset:4096
ds_read_b64_tr_b16 a[18:19],v17 offset:4352
ds_read_b64_tr_b16 a[20:21],v17 offset:4104
ds_read_b64_tr_b16 a[22:23],v17 offset:4360
s_waitcnt lgkmcnt(0)
ds_read_b64_tr_b16 a[24:25],v17 offset:6144
ds_read_b64_tr_b16 a[26:27],v17 offset:6400
ds_read_b64_tr_b16 a[28:29],v17 offset:6152
ds_read_b64_tr_b16 a[30:31],v17 offset:6408
ds_read_b64_tr_b16 a[32:33],v17 offset:8192
ds_read_b64_tr_b16 a[34:35],v17 offset:8448
ds_read_b64_tr_b16 a[36:37],v17 offset:8200
ds_read_b64_tr_b16 a[38:39],v17 offset:8456
ds_read_b64_tr_b16 a[40:41],v17 offset:10240
ds_read_b64_tr_b16 a[42:43],v17 offset:10496
ds_read_b64_tr_b16 a[44:45],v17 offset:10248
ds_read_b64_tr_b16 a[46:47],v17 offset:10504
s_waitcnt lgkmcnt(0)
ds_read_b64_tr_b16 a[48:49],v17 offset:12288
ds_read_b64_tr_b16 a[50:51],v17 offset:12544
ds_read_b64_tr_b16 a[52:53],v17 offset:12296
ds_read_b64_tr_b16 a[54:55],v17 offset:12552
ds_read_b64_tr_b16 a[56:57],v17 offset:14336
ds_read_b64_tr_b16 a[58:59],v17 offset:14592
ds_read_b64_tr_b16 a[60:61],v17 offset:14344
ds_read_b64_tr_b16 a[62:63],v17 offset:14600
s_waitcnt lgkmcnt(0)
s_xor_b32 s62,s50,2
s_mul_i32 s62,s62,1835008
s_add_u32 s62,s62,s54
s_add_u32 m0,s61,0
s_nop 0
buffer_load_dwordx4 v16,s[28:31],s62 offen lds
s_add_u32 s62,s62,114688
s_add_u32 m0,m0,1024
s_waitcnt vmcnt(6)
buffer_load_dwordx4 v16,s[28:31],s62 offen lds
s_add_u32 s62,s62,114688
s_add_u32 m0,m0,1024
s_waitcnt vmcnt(6)
buffer_load_dwordx4 v16,s[28:31],s62 offen lds
s_add_u32 s62,s62,114688
s_add_u32 m0,m0,1024
s_waitcnt vmcnt(6)
buffer_load_dwordx4 v16,s[28:31],s62 offen lds
s_add_u32 s62,s62,114688
s_add_u32 m0,m0,1024
s_waitcnt vmcnt(6)
buffer_load_dwordx4 v16,s[28:31],s62 offen lds
s_add_u32 s62,s62,114688
s_add_u32 m0,m0,1024
s_waitcnt vmcnt(6)
buffer_load_dwordx4 v16,s[28:31],s62 offen lds
s_add_u32 s62,s62,114688
s_add_u32 m0,m0,1024
s_waitcnt vmcnt(6)
buffer_load_dwordx4 v16,s[28:31],s62 offen lds
s_add_u32 s62,s62,114688
s_add_u32 m0,m0,1024
s_waitcnt vmcnt(6)
buffer_load_dwordx4 v16,s[28:31],s62 offen lds
s_add_u32 s62,s62,114688
s_add_u32 m0,m0,1024
s_waitcnt vmcnt(6)
buffer_load_dwordx4 v16,s[28:31],s62 offen lds
s_add_u32 s62,s62,114688
s_add_u32 m0,m0,1024
s_waitcnt vmcnt(6)
buffer_load_dwordx4 v16,s[28:31],s62 offen lds
s_add_u32 s62,s62,114688
s_add_u32 m0,m0,1024
s_waitcnt vmcnt(6)
buffer_load_dwordx4 v16,s[28:31],s62 offen lds
s_add_u32 s62,s62,114688
s_add_u32 m0,m0,1024
s_waitcnt vmcnt(6)
buffer_load_dwordx4 v16,s[28:31],s62 offen lds
s_add_u32 s62,s62,114688
s_add_u32 m0,m0,1024
s_waitcnt vmcnt(6)
buffer_load_dwordx4 v16,s[28:31],s62 offen lds
s_add_u32 s62,s62,114688
s_add_u32 m0,m0,1024
s_waitcnt vmcnt(6)
buffer_load_dwordx4 v16,s[28:31],s62 offen lds
s_add_u32 s62,s62,114688
s_add_u32 m0,m0,1024
s_waitcnt vmcnt(6)
buffer_load_dwordx4 v16,s[28:31],s62 offen lds
s_add_u32 s62,s62,114688
s_add_u32 m0,m0,1024
s_waitcnt vmcnt(6)
buffer_load_dwordx4 v16,s[28:31],s62 offen lds
s_waitcnt vmcnt(6)
s_waitcnt vmcnt(16)
ds_read_b64_tr_b16 a[64:65],v17 offset:16384
ds_read_b64_tr_b16 a[66:67],v17 offset:16640
ds_read_b64_tr_b16 a[68:69],v17 offset:16392
ds_read_b64_tr_b16 a[70:71],v17 offset:16648
ds_read_b64_tr_b16 a[72:73],v17 offset:18432
ds_read_b64_tr_b16 a[74:75],v17 offset:18688
ds_read_b64_tr_b16 a[76:77],v17 offset:18440
ds_read_b64_tr_b16 a[78:79],v17 offset:18696
ds_read_b64_tr_b16 a[80:81],v17 offset:20480
ds_read_b64_tr_b16 a[82:83],v17 offset:20736
ds_read_b64_tr_b16 a[84:85],v17 offset:20488
ds_read_b64_tr_b16 a[86:87],v17 offset:20744
s_waitcnt lgkmcnt(0)
ds_read_b64_tr_b16 a[88:89],v17 offset:22528
ds_read_b64_tr_b16 a[90:91],v17 offset:22784
ds_read_b64_tr_b16 a[92:93],v17 offset:22536
ds_read_b64_tr_b16 a[94:95],v17 offset:22792
ds_read_b64_tr_b16 a[96:97],v17 offset:24576
ds_read_b64_tr_b16 a[98:99],v17 offset:24832
ds_read_b64_tr_b16 a[100:101],v17 offset:24584
ds_read_b64_tr_b16 a[102:103],v17 offset:24840
ds_read_b64_tr_b16 a[104:105],v17 offset:26624
ds_read_b64_tr_b16 a[106:107],v17 offset:26880
ds_read_b64_tr_b16 a[108:109],v17 offset:26632
ds_read_b64_tr_b16 a[110:111],v17 offset:26888
s_waitcnt lgkmcnt(0)
ds_read_b64_tr_b16 a[112:113],v17 offset:28672
ds_read_b64_tr_b16 a[114:115],v17 offset:28928
ds_read_b64_tr_b16 a[116:117],v17 offset:28680
ds_read_b64_tr_b16 a[118:119],v17 offset:28936
ds_read_b64_tr_b16 a[120:121],v17 offset:30720
ds_read_b64_tr_b16 a[122:123],v17 offset:30976
ds_read_b64_tr_b16 a[124:125],v17 offset:30728
ds_read_b64_tr_b16 a[126:127],v17 offset:30984
s_waitcnt lgkmcnt(0)
s_xor_b32 s62,s50,3
s_mul_i32 s62,s62,1835008
s_add_u32 s62,s62,s54
s_add_u32 m0,s61,16384
s_nop 0
buffer_load_dwordx4 v16,s[28:31],s62 offen lds
s_add_u32 s62,s62,114688
s_add_u32 m0,m0,1024
s_waitcnt vmcnt(6)
buffer_load_dwordx4 v16,s[28:31],s62 offen lds
s_add_u32 s62,s62,114688
s_add_u32 m0,m0,1024
s_waitcnt vmcnt(6)
buffer_load_dwordx4 v16,s[28:31],s62 offen lds
s_add_u32 s62,s62,114688
s_add_u32 m0,m0,1024
s_waitcnt vmcnt(6)
buffer_load_dwordx4 v16,s[28:31],s62 offen lds
s_add_u32 s62,s62,114688
s_add_u32 m0,m0,1024
s_waitcnt vmcnt(6)
buffer_load_dwordx4 v16,s[28:31],s62 offen lds
s_add_u32 s62,s62,114688
s_add_u32 m0,m0,1024
s_waitcnt vmcnt(6)
buffer_load_dwordx4 v16,s[28:31],s62 offen lds
s_add_u32 s62,s62,114688
s_add_u32 m0,m0,1024
s_waitcnt vmcnt(6)
buffer_load_dwordx4 v16,s[28:31],s62 offen lds
s_add_u32 s62,s62,114688
s_add_u32 m0,m0,1024
s_waitcnt vmcnt(6)
buffer_load_dwordx4 v16,s[28:31],s62 offen lds
s_add_u32 s62,s62,114688
s_add_u32 m0,m0,1024
s_waitcnt vmcnt(6)
buffer_load_dwordx4 v16,s[28:31],s62 offen lds
s_add_u32 s62,s62,114688
s_add_u32 m0,m0,1024
s_waitcnt vmcnt(6)
buffer_load_dwordx4 v16,s[28:31],s62 offen lds
s_add_u32 s62,s62,114688
s_add_u32 m0,m0,1024
s_waitcnt vmcnt(6)
buffer_load_dwordx4 v16,s[28:31],s62 offen lds
s_add_u32 s62,s62,114688
s_add_u32 m0,m0,1024
s_waitcnt vmcnt(6)
buffer_load_dwordx4 v16,s[28:31],s62 offen lds
s_add_u32 s62,s62,114688
s_add_u32 m0,m0,1024
s_waitcnt vmcnt(6)
buffer_load_dwordx4 v16,s[28:31],s62 offen lds
s_add_u32 s62,s62,114688
s_add_u32 m0,m0,1024
s_waitcnt vmcnt(6)
buffer_load_dwordx4 v16,s[28:31],s62 offen lds
s_add_u32 s62,s62,114688
s_add_u32 m0,m0,1024
s_waitcnt vmcnt(6)
buffer_load_dwordx4 v16,s[28:31],s62 offen lds
s_add_u32 s62,s62,114688
s_add_u32 m0,m0,1024
s_waitcnt vmcnt(6)
buffer_load_dwordx4 v16,s[28:31],s62 offen lds
s_waitcnt vmcnt(6)
s_waitcnt vmcnt(16)
ds_read_b64_tr_b16 a[128:129],v17 offset:0
ds_read_b64_tr_b16 a[130:131],v17 offset:256
ds_read_b64_tr_b16 a[132:133],v17 offset:8
ds_read_b64_tr_b16 a[134:135],v17 offset:264
ds_read_b64_tr_b16 a[136:137],v17 offset:2048
ds_read_b64_tr_b16 a[138:139],v17 offset:2304
ds_read_b64_tr_b16 a[140:141],v17 offset:2056
ds_read_b64_tr_b16 a[142:143],v17 offset:2312
ds_read_b64_tr_b16 a[144:145],v17 offset:4096
ds_read_b64_tr_b16 a[146:147],v17 offset:4352
ds_read_b64_tr_b16 a[148:149],v17 offset:4104
ds_read_b64_tr_b16 a[150:151],v17 offset:4360
s_waitcnt lgkmcnt(0)
ds_read_b64_tr_b16 a[152:153],v17 offset:6144
ds_read_b64_tr_b16 a[154:155],v17 offset:6400
ds_read_b64_tr_b16 a[156:157],v17 offset:6152
ds_read_b64_tr_b16 a[158:159],v17 offset:6408
ds_read_b64_tr_b16 a[160:161],v17 offset:8192
ds_read_b64_tr_b16 a[162:163],v17 offset:8448
ds_read_b64_tr_b16 a[164:165],v17 offset:8200
ds_read_b64_tr_b16 a[166:167],v17 offset:8456
ds_read_b64_tr_b16 a[168:169],v17 offset:10240
ds_read_b64_tr_b16 a[170:171],v17 offset:10496
ds_read_b64_tr_b16 a[172:173],v17 offset:10248
ds_read_b64_tr_b16 a[174:175],v17 offset:10504
s_waitcnt lgkmcnt(0)
ds_read_b64_tr_b16 a[176:177],v17 offset:12288
ds_read_b64_tr_b16 a[178:179],v17 offset:12544
ds_read_b64_tr_b16 a[180:181],v17 offset:12296
ds_read_b64_tr_b16 a[182:183],v17 offset:12552
ds_read_b64_tr_b16 a[184:185],v17 offset:14336
ds_read_b64_tr_b16 a[186:187],v17 offset:14592
ds_read_b64_tr_b16 a[188:189],v17 offset:14344
ds_read_b64_tr_b16 a[190:191],v17 offset:14600
s_waitcnt lgkmcnt(0)
s_waitcnt vmcnt(0)
ds_read_b64_tr_b16 a[192:193],v17 offset:16384
ds_read_b64_tr_b16 a[194:195],v17 offset:16640
ds_read_b64_tr_b16 a[196:197],v17 offset:16392
ds_read_b64_tr_b16 a[198:199],v17 offset:16648
ds_read_b64_tr_b16 a[200:201],v17 offset:18432
ds_read_b64_tr_b16 a[202:203],v17 offset:18688
ds_read_b64_tr_b16 a[204:205],v17 offset:18440
ds_read_b64_tr_b16 a[206:207],v17 offset:18696
ds_read_b64_tr_b16 a[208:209],v17 offset:20480
ds_read_b64_tr_b16 a[210:211],v17 offset:20736
ds_read_b64_tr_b16 a[212:213],v17 offset:20488
ds_read_b64_tr_b16 a[214:215],v17 offset:20744
s_waitcnt lgkmcnt(0)
ds_read_b64_tr_b16 a[216:217],v17 offset:22528
ds_read_b64_tr_b16 a[218:219],v17 offset:22784
ds_read_b64_tr_b16 a[220:221],v17 offset:22536
ds_read_b64_tr_b16 a[222:223],v17 offset:22792
ds_read_b64_tr_b16 a[224:225],v17 offset:24576
ds_read_b64_tr_b16 a[226:227],v17 offset:24832
ds_read_b64_tr_b16 a[228:229],v17 offset:24584
ds_read_b64_tr_b16 a[230:231],v17 offset:24840
ds_read_b64_tr_b16 a[232:233],v17 offset:26624
ds_read_b64_tr_b16 a[234:235],v17 offset:26880
ds_read_b64_tr_b16 a[236:237],v17 offset:26632
ds_read_b64_tr_b16 a[238:239],v17 offset:26888
s_waitcnt lgkmcnt(0)
ds_read_b64_tr_b16 a[240:241],v17 offset:28672
ds_read_b64_tr_b16 a[242:243],v17 offset:28928
ds_read_b64_tr_b16 a[244:245],v17 offset:28680
ds_read_b64_tr_b16 a[246:247],v17 offset:28936
ds_read_b64_tr_b16 a[248:249],v17 offset:30720
ds_read_b64_tr_b16 a[250:251],v17 offset:30976
ds_read_b64_tr_b16 a[252:253],v17 offset:30728
ds_read_b64_tr_b16 a[254:255],v17 offset:30984
s_waitcnt lgkmcnt(0)
s_mov_b32 s92,s2
s_and_b32 s93,s3,0xffff
s_mov_b32 s94,0x100
s_mov_b32 s95,0x20000
v_mbcnt_lo_u32_b32 v16,-1,0
v_mbcnt_hi_u32_b32 v16,-1,v16
v_mov_b32 v18,0
v_cmp_eq_u32 vcc,22,v16
s_nop 1
v_cndmask_b32 v18,v18,63,vcc
v_cmp_eq_u32 vcc,17,v16
s_nop 1
v_cndmask_b32 v18,v18,63,vcc
v_cmp_eq_u32 vcc,18,v16
s_nop 1
v_cndmask_b32 v18,v18,1,vcc
v_and_b32 v19,1,v16
v_cmp_eq_u32 vcc,1,v19
v_mov_b32 v19,8192
s_nop 0
v_cndmask_b32 v19,-1,v19,vcc
v_min_u32 v16,31,v16
v_lshlrev_b32 v16,2,v16
s_sub_u32 s66,s88,64
s_cmp_lg_u32 s50,0
s_cbranch_scc1 vot_280
vpoll_276:
buffer_load_dword v17,v16,s[92:95],s66 offen sc1
s_waitcnt vmcnt(0)
s_cmp_lg_u32 s56,2
s_cbranch_scc1 vck_277
v_cmp_eq_u32 vcc,v17,v19
s_and_b32 s64,vcc_lo,0xffff
s_cmp_eq_u32 s64,65535
s_cbranch_scc1 vck_277
s_mov_b32 s65,0
v_readlane_b32 s64,v17,1
s_lshr_b32 s64,s64,8
s_add_u32 s65,s65,s64
v_readlane_b32 s64,v17,3
s_lshr_b32 s64,s64,8
s_add_u32 s65,s65,s64
v_readlane_b32 s64,v17,5
s_lshr_b32 s64,s64,8
s_add_u32 s65,s65,s64
v_readlane_b32 s64,v17,7
s_lshr_b32 s64,s64,8
s_add_u32 s65,s65,s64
v_readlane_b32 s64,v17,9
s_lshr_b32 s64,s64,8
s_add_u32 s65,s65,s64
v_readlane_b32 s64,v17,11
s_lshr_b32 s64,s64,8
s_add_u32 s65,s65,s64
v_readlane_b32 s64,v17,13
s_lshr_b32 s64,s64,8
s_add_u32 s65,s65,s64
v_readlane_b32 s64,v17,15
s_lshr_b32 s64,s64,8
s_add_u32 s65,s65,s64
s_cmp_ge_u32 s65,256
s_cbranch_scc1 vok_279
s_branch vrt_278
vck_277:
v_cmp_gt_u32 vcc,v18,v17
s_cbranch_vccz vok_279
vrt_278:
s_sleep 48
s_sub_u32 s90,s90,1
s_cmp_gt_i32 s90,0
s_cbranch_scc1 vpoll_276
vok_279:
v_add_u32 v18,160256,v16
ds_write_b32 v18,v17
s_waitcnt lgkmcnt(0)
vot_280:
s_barrier
v_add_u32 v18,160256,v16
ds_read_b32 v17,v18
s_waitcnt lgkmcnt(0)
s_cmp_lg_u32 s56,2
s_cbranch_scc1 vfin_281
v_cmp_eq_u32 vcc,v17,v19
s_and_b32 s64,vcc_lo,0xffff
s_cmp_eq_u32 s64,65535
s_cbranch_scc1 vfin_281
s_mov_b32 s65,0
v_readlane_b32 s64,v17,1
s_lshr_b32 s64,s64,8
s_add_u32 s65,s65,s64
v_readlane_b32 s64,v17,3
s_lshr_b32 s64,s64,8
s_add_u32 s65,s65,s64
v_readlane_b32 s64,v17,5
s_lshr_b32 s64,s64,8
s_add_u32 s65,s65,s64
v_readlane_b32 s64,v17,7
s_lshr_b32 s64,s64,8
s_add_u32 s65,s65,s64
v_readlane_b32 s64,v17,9
s_lshr_b32 s64,s64,8
s_add_u32 s65,s65,s64
v_readlane_b32 s64,v17,11
s_lshr_b32 s64,s64,8
s_add_u32 s65,s65,s64
v_readlane_b32 s64,v17,13
s_lshr_b32 s64,s64,8
s_add_u32 s65,s65,s64
v_readlane_b32 s64,v17,15
s_lshr_b32 s64,s64,8
s_add_u32 s65,s65,s64
s_cmp_ge_u32 s65,256
s_cbranch_scc1 fl_fb
vfin_281:
s_and_b32 s56,s56,1
s_mov_b32 s67,0
s_barrier
v_lshlrev_b32 v0,4,v1
s_mov_b32 s60,0
s_lshl_b32 s70,s50,13
s_mov_b32 s55,0
v_mov_b32 v3,v0
s_mov_b32 s73,0xffff0000
s_lshl_b32 s64,s52,2
s_add_u32 s64,s64,s50
s_mul_i32 s61,s64,8192
s_add_u32 s61,s61,214958080
s_lshl_b32 s68,s64,8
s_add_u32 s68,s68,138550272
s_lshl_b32 s83,s53,2
s_add_u32 s83,s83,s50
s_mov_b32 s63,0
s_xor_b32 s64,s50,0
s_lshl_b32 s64,s64,13
v_add_u32 v8,s64,v0
v_mov_b32 v4,v8
s_xor_b32 s64,s50,1
s_lshl_b32 s64,s64,13
v_add_u32 v9,s64,v0
v_mov_b32 v5,v9
s_xor_b32 s64,s50,2
s_lshl_b32 s64,s64,13
v_add_u32 v10,s64,v0
v_mov_b32 v6,v10
s_xor_b32 s64,s50,3
s_lshl_b32 s64,s64,13
v_add_u32 v11,s64,v0
v_mov_b32 v7,v11
v_min_u32 v2,7,v1
v_lshlrev_b32 v2,2,v2
s_add_u32 s62,s61,4096
s_lshl_b32 s66,s83,10
s_mul_i32 s65,s83,147
s_lshr_b32 s65,s65,10
s_mul_i32 s69,s65,228
s_lshl_b32 s64,s83,2
s_add_u32 s69,s69,s64
s_add_u32 s69,s69,138551296
s_add_u32 s82,s66,201326592
s_add_u32 s66,s66,219152384
s_lshl_b32 s64,s50,9
s_add_u32 s64,s64,131072
v_lshlrev_b32 v26,3,v1
v_add_u32 v19,s64,v26
v_lshl_add_u32 v26,v23,4,v21
v_lshlrev_b32 v26,3,v26
v_add_u32 v20,131072,v26
s_mov_b32 s74,0x22222222
s_mov_b32 s75,0x22222222
s_mov_b32 s76,0x44444444
s_mov_b32 s77,0x44444444
s_mov_b32 s78,0x88888888
s_mov_b32 s79,0x88888888
v_mov_b32 v208,0xbdd2d3e8
v_mov_b32 v209,0xc0135761
v_mov_b32 v210,0x3727c5ac
v_mov_b32 v211,0x3a800000
v_mov_b32 v12,0x3f803f80
v_mov_b32 v13,0x3f803f80
v_mov_b32 v14,0x3f803f80
v_mov_b32 v15,0x3f803f80
s_nop 1
v_mfma_f32_16x16x32_bf16 v[152:155],a[0:3],v[12:15],0
v_mfma_f32_16x16x32_bf16 v[156:159],a[4:7],v[12:15],0
v_mfma_f32_16x16x32_bf16 v[152:155],a[8:11],v[12:15],v[152:155]
v_mfma_f32_16x16x32_bf16 v[156:159],a[12:15],v[12:15],v[156:159]
v_mfma_f32_16x16x32_bf16 v[152:155],a[16:19],v[12:15],v[152:155]
v_mfma_f32_16x16x32_bf16 v[156:159],a[20:23],v[12:15],v[156:159]
v_mfma_f32_16x16x32_bf16 v[152:155],a[24:27],v[12:15],v[152:155]
v_mfma_f32_16x16x32_bf16 v[156:159],a[28:31],v[12:15],v[156:159]
v_mfma_f32_16x16x32_bf16 v[152:155],a[32:35],v[12:15],v[152:155]
v_mfma_f32_16x16x32_bf16 v[156:159],a[36:39],v[12:15],v[156:159]
v_mfma_f32_16x16x32_bf16 v[152:155],a[40:43],v[12:15],v[152:155]
v_mfma_f32_16x16x32_bf16 v[156:159],a[44:47],v[12:15],v[156:159]
v_mfma_f32_16x16x32_bf16 v[152:155],a[48:51],v[12:15],v[152:155]
v_mfma_f32_16x16x32_bf16 v[156:159],a[52:55],v[12:15],v[156:159]
v_mfma_f32_16x16x32_bf16 v[152:155],a[56:59],v[12:15],v[152:155]
v_mfma_f32_16x16x32_bf16 v[156:159],a[60:63],v[12:15],v[156:159]
v_mfma_f32_16x16x32_bf16 v[152:155],a[64:67],v[12:15],v[152:155]
v_mfma_f32_16x16x32_bf16 v[156:159],a[68:71],v[12:15],v[156:159]
v_mfma_f32_16x16x32_bf16 v[152:155],a[72:75],v[12:15],v[152:155]
v_mfma_f32_16x16x32_bf16 v[156:159],a[76:79],v[12:15],v[156:159]
v_mfma_f32_16x16x32_bf16 v[152:155],a[80:83],v[12:15],v[152:155]
v_mfma_f32_16x16x32_bf16 v[156:159],a[84:87],v[12:15],v[156:159]
v_mfma_f32_16x16x32_bf16 v[152:155],a[88:91],v[12:15],v[152:155]
v_mfma_f32_16x16x32_bf16 v[156:159],a[92:95],v[12:15],v[156:159]
v_mfma_f32_16x16x32_bf16 v[152:155],a[96:99],v[12:15],v[152:155]
v_mfma_f32_16x16x32_bf16 v[156:159],a[100:103],v[12:15],v[156:159]
v_mfma_f32_16x16x32_bf16 v[152:155],a[104:107],v[12:15],v[152:155]
v_mfma_f32_16x16x32_bf16 v[156:159],a[108:111],v[12:15],v[156:159]
v_mfma_f32_16x16x32_bf16 v[152:155],a[112:115],v[12:15],v[152:155]
v_mfma_f32_16x16x32_bf16 v[156:159],a[116:119],v[12:15],v[156:159]
v_mfma_f32_16x16x32_bf16 v[152:155],a[120:123],v[12:15],v[152:155]
v_mfma_f32_16x16x32_bf16 v[156:159],a[124:127],v[12:15],v[156:159]
v_mfma_f32_16x16x32_bf16 v[152:155],a[128:131],v[12:15],v[152:155]
v_mfma_f32_16x16x32_bf16 v[156:159],a[132:135],v[12:15],v[156:159]
v_mfma_f32_16x16x32_bf16 v[152:155],a[136:139],v[12:15],v[152:155]
v_mfma_f32_16x16x32_bf16 v[156:159],a[140:143],v[12:15],v[156:159]
v_mfma_f32_16x16x32_bf16 v[152:155],a[144:147],v[12:15],v[152:155]
v_mfma_f32_16x16x32_bf16 v[156:159],a[148:151],v[12:15],v[156:159]
v_mfma_f32_16x16x32_bf16 v[152:155],a[152:155],v[12:15],v[152:155]
v_mfma_f32_16x16x32_bf16 v[156:159],a[156:159],v[12:15],v[156:159]
v_mfma_f32_16x16x32_bf16 v[152:155],a[160:163],v[12:15],v[152:155]
v_mfma_f32_16x16x32_bf16 v[156:159],a[164:167],v[12:15],v[156:159]
v_mfma_f32_16x16x32_bf16 v[152:155],a[168:171],v[12:15],v[152:155]
v_mfma_f32_16x16x32_bf16 v[156:159],a[172:175],v[12:15],v[156:159]
v_mfma_f32_16x16x32_bf16 v[152:155],a[176:179],v[12:15],v[152:155]
v_mfma_f32_16x16x32_bf16 v[156:159],a[180:183],v[12:15],v[156:159]
v_mfma_f32_16x16x32_bf16 v[152:155],a[184:187],v[12:15],v[152:155]
v_mfma_f32_16x16x32_bf16 v[156:159],a[188:191],v[12:15],v[156:159]
v_mfma_f32_16x16x32_bf16 v[152:155],a[192:195],v[12:15],v[152:155]
v_mfma_f32_16x16x32_bf16 v[156:159],a[196:199],v[12:15],v[156:159]
v_mfma_f32_16x16x32_bf16 v[152:155],a[200:203],v[12:15],v[152:155]
v_mfma_f32_16x16x32_bf16 v[156:159],a[204:207],v[12:15],v[156:159]
v_mfma_f32_16x16x32_bf16 v[152:155],a[208:211],v[12:15],v[152:155]
v_mfma_f32_16x16x32_bf16 v[156:159],a[212:215],v[12:15],v[156:159]
v_mfma_f32_16x16x32_bf16 v[152:155],a[216:219],v[12:15],v[152:155]
v_mfma_f32_16x16x32_bf16 v[156:159],a[220:223],v[12:15],v[156:159]
v_mfma_f32_16x16x32_bf16 v[152:155],a[224:227],v[12:15],v[152:155]
v_mfma_f32_16x16x32_bf16 v[156:159],a[228:231],v[12:15],v[156:159]
v_mfma_f32_16x16x32_bf16 v[152:155],a[232:235],v[12:15],v[152:155]
v_mfma_f32_16x16x32_bf16 v[156:159],a[236:239],v[12:15],v[156:159]
v_mfma_f32_16x16x32_bf16 v[152:155],a[240:243],v[12:15],v[152:155]
v_mfma_f32_16x16x32_bf16 v[156:159],a[244:247],v[12:15],v[156:159]
v_mfma_f32_16x16x32_bf16 v[152:155],a[248:251],v[12:15],v[152:155]
v_mfma_f32_16x16x32_bf16 v[156:159],a[252:255],v[12:15],v[156:159]
v_cmp_eq_u32 vcc,0,v1
s_nop 1
v_cndmask_b32 v26,2.0,0,vcc
s_add_u32 s71,s60,1
s_add_u32 s53,s60,2
plp_289:
buffer_load_dword v16,v2,s[20:23],s68 offen sc1
s_waitcnt vmcnt(0)
v_cmp_gt_u32 vcc,s71,v16
s_cbranch_vccz pok_290
s_sleep 4
s_sub_u32 s90,s90,1
s_cmp_gt_i32 s90,0
s_cbranch_scc1 plp_289
pok_290:
lag_286:
s_mov_b32 m0,s70
s_nop 0
buffer_load_dwordx4 v3,s[20:23],s61 offen offset:0 lds
buffer_load_dwordx4 v3,s[20:23],s61 offen offset:1024 lds
buffer_load_dwordx4 v3,s[20:23],s61 offen offset:2048 lds
buffer_load_dwordx4 v3,s[20:23],s61 offen offset:3072 lds
s_add_u32 m0,s70,4096
s_nop 0
buffer_load_dwordx4 v3,s[20:23],s62 offen offset:0 lds
buffer_load_dwordx4 v3,s[20:23],s62 offen offset:1024 lds
buffer_load_dwordx4 v3,s[20:23],s62 offen offset:2048 lds
buffer_load_dwordx4 v3,s[20:23],s62 offen offset:3072 lds
s_add_u32 s61,s61,32768
s_add_u32 s62,s62,32768
s_add_u32 s70,s70,32768
s_and_b32 s70,s70,0x1ffff
buffer_load_dword v23,off,s[20:23],s66
buffer_load_dword v23,off,s[20:23],s66
dec_287:
v_cmp_gt_u32 vcc,s53,v16
s_cbranch_vccnz BN_285
BR_284:
s_waitcnt vmcnt(9)
ds_read_b128 v[64:67],v4 offset:0
s_waitcnt vmcnt(8)
ds_read_b128 v[68:71],v4 offset:1024
s_waitcnt vmcnt(7)
ds_read_b128 v[72:75],v4 offset:2048
s_waitcnt vmcnt(6)
ds_read_b128 v[76:79],v4 offset:3072
s_waitcnt lgkmcnt(3)
v_mfma_f32_16x16x32_bf16 v[32:35],a[0:3],v[64:67],0
s_add_u32 s71,s60,2
s_add_u32 s53,s60,3
s_mov_b32 s57,s63
v_mfma_f32_16x16x32_bf16 v[36:39],a[4:7],v[64:67],0
v_mfma_f32_16x16x32_bf16 v[48:51],v[12:15],v[64:67],0
v_mfma_f32_16x16x32_bf16 v[52:55],v[64:67],v[64:67],0
s_waitcnt lgkmcnt(2)
s_waitcnt vmcnt(5)
s_mov_b32 m0,s70
ds_read_b128 v[80:83],v4 offset:4096
v_mfma_f32_16x16x32_bf16 v[32:35],a[8:11],v[68:71],v[32:35]
buffer_load_dwordx4 v3,s[20:23],s61 offen offset:0 lds
v_mfma_f32_16x16x32_bf16 v[36:39],a[12:15],v[68:71],v[36:39]
v_mfma_f32_16x16x32_bf16 v[48:51],v[12:15],v[68:71],v[48:51]
v_mfma_f32_16x16x32_bf16 v[52:55],v[68:71],v[68:71],v[52:55]
s_waitcnt lgkmcnt(2)
s_waitcnt vmcnt(5)
ds_read_b128 v[84:87],v4 offset:5120
v_mfma_f32_16x16x32_bf16 v[32:35],a[16:19],v[72:75],v[32:35]
buffer_load_dwordx4 v3,s[20:23],s61 offen offset:1024 lds
v_mfma_f32_16x16x32_bf16 v[36:39],a[20:23],v[72:75],v[36:39]
v_mfma_f32_16x16x32_bf16 v[48:51],v[12:15],v[72:75],v[48:51]
v_mfma_f32_16x16x32_bf16 v[52:55],v[72:75],v[72:75],v[52:55]
s_waitcnt lgkmcnt(2)
s_waitcnt vmcnt(5)
ds_read_b128 v[88:91],v4 offset:6144
v_mfma_f32_16x16x32_bf16 v[32:35],a[24:27],v[76:79],v[32:35]
buffer_load_dwordx4 v3,s[20:23],s61 offen offset:2048 lds
v_mfma_f32_16x16x32_bf16 v[36:39],a[28:31],v[76:79],v[36:39]
v_mfma_f32_16x16x32_bf16 v[48:51],v[12:15],v[76:79],v[48:51]
v_mfma_f32_16x16x32_bf16 v[52:55],v[76:79],v[76:79],v[52:55]
s_waitcnt lgkmcnt(2)
s_waitcnt vmcnt(5)
ds_read_b128 v[92:95],v4 offset:7168
v_mfma_f32_16x16x32_bf16 v[32:35],a[32:35],v[80:83],v[32:35]
buffer_load_dwordx4 v3,s[20:23],s61 offen offset:3072 lds
v_mfma_f32_16x16x32_bf16 v[36:39],a[36:39],v[80:83],v[36:39]
v_mfma_f32_16x16x32_bf16 v[48:51],v[12:15],v[80:83],v[48:51]
v_mfma_f32_16x16x32_bf16 v[52:55],v[80:83],v[80:83],v[52:55]
s_waitcnt lgkmcnt(2)
s_barrier
ds_read_b128 v[96:99],v5 offset:0
v_mfma_f32_16x16x32_bf16 v[32:35],a[40:43],v[84:87],v[32:35]
ds_read_b128 v[100:103],v5 offset:1024
v_mfma_f32_16x16x32_bf16 v[36:39],a[44:47],v[84:87],v[36:39]
ds_read_b128 v[104:107],v5 offset:2048
v_mfma_f32_16x16x32_bf16 v[48:51],v[12:15],v[84:87],v[48:51]
s_add_u32 m0,s70,4096
ds_read_b128 v[108:111],v5 offset:3072
v_mfma_f32_16x16x32_bf16 v[52:55],v[84:87],v[84:87],v[52:55]
s_waitcnt lgkmcnt(5)
buffer_load_dwordx4 v3,s[20:23],s62 offen offset:0 lds
v_mfma_f32_16x16x32_bf16 v[32:35],a[48:51],v[88:91],v[32:35]
ds_read_b128 v[112:115],v5 offset:4096
v_mfma_f32_16x16x32_bf16 v[36:39],a[52:55],v[88:91],v[36:39]
buffer_load_dwordx4 v3,s[20:23],s62 offen offset:1024 lds
v_mfma_f32_16x16x32_bf16 v[48:51],v[12:15],v[88:91],v[48:51]
v_mfma_f32_16x16x32_bf16 v[52:55],v[88:91],v[88:91],v[52:55]
s_waitcnt lgkmcnt(5)
v_mfma_f32_16x16x32_bf16 v[32:35],a[56:59],v[92:95],v[32:35]
ds_read_b128 v[116:119],v5 offset:5120
v_mfma_f32_16x16x32_bf16 v[36:39],a[60:63],v[92:95],v[36:39]
buffer_load_dwordx4 v3,s[20:23],s62 offen offset:2048 lds
v_mfma_f32_16x16x32_bf16 v[48:51],v[12:15],v[92:95],v[48:51]
buffer_load_dword v16,v2,s[20:23],s68 offen sc1
v_mfma_f32_16x16x32_bf16 v[52:55],v[92:95],v[92:95],v[52:55]
s_waitcnt lgkmcnt(5)
v_mfma_f32_16x16x32_bf16 v[32:35],a[64:67],v[96:99],v[32:35]
ds_read_b128 v[120:123],v5 offset:6144
v_mfma_f32_16x16x32_bf16 v[36:39],a[68:71],v[96:99],v[36:39]
s_waitcnt lgkmcnt(5)
buffer_load_dwordx4 v3,s[20:23],s62 offen offset:3072 lds
v_mfma_f32_16x16x32_bf16 v[32:35],a[72:75],v[100:103],v[32:35]
ds_read_b128 v[124:127],v5 offset:7168
v_mfma_f32_16x16x32_bf16 v[36:39],a[76:79],v[100:103],v[36:39]
s_waitcnt lgkmcnt(5)
v_mfma_f32_16x16x32_bf16 v[32:35],a[80:83],v[104:107],v[32:35]
ds_read_b128 v[64:67],v6 offset:0
v_cndmask_b32 v49,v52,v53,s[74:75]
v_mfma_f32_16x16x32_bf16 v[36:39],a[84:87],v[104:107],v[36:39]
s_waitcnt lgkmcnt(5)
v_cndmask_b32 v49,v49,v54,s[76:77]
v_cndmask_b32 v49,v49,v55,s[78:79]
v_mfma_f32_16x16x32_bf16 v[32:35],a[88:91],v[108:111],v[32:35]
ds_read_b128 v[68:71],v6 offset:1024
v_mfma_f32_16x16x32_bf16 v[36:39],a[92:95],v[108:111],v[36:39]
s_waitcnt lgkmcnt(5)
ds_write_b64 v19,v[48:49]
v_mfma_f32_16x16x32_bf16 v[32:35],a[96:99],v[112:115],v[32:35]
ds_read_b128 v[72:75],v6 offset:2048
v_mfma_f32_16x16x32_bf16 v[36:39],a[100:103],v[112:115],v[36:39]
s_waitcnt lgkmcnt(6)
v_mfma_f32_16x16x32_bf16 v[32:35],a[104:107],v[116:119],v[32:35]
ds_read_b128 v[76:79],v6 offset:3072
v_mfma_f32_16x16x32_bf16 v[36:39],a[108:111],v[116:119],v[36:39]
s_waitcnt lgkmcnt(6)
v_mfma_f32_16x16x32_bf16 v[32:35],a[112:115],v[120:123],v[32:35]
s_waitcnt lgkmcnt(2)
s_barrier
ds_read_b128 v[80:83],v6 offset:4096
v_mfma_f32_16x16x32_bf16 v[36:39],a[116:119],v[120:123],v[36:39]
ds_read_b64 v[56:57],v20 offset:0
v_mfma_f32_16x16x32_bf16 v[32:35],a[120:123],v[124:127],v[32:35]
ds_read_b128 v[84:87],v6 offset:5120
v_mfma_f32_16x16x32_bf16 v[36:39],a[124:127],v[124:127],v[36:39]
ds_read_b64 v[58:59],v20 offset:512
v_mfma_f32_16x16x32_bf16 v[32:35],a[128:131],v[64:67],v[32:35]
ds_read_b128 v[88:91],v6 offset:6144
v_mfma_f32_16x16x32_bf16 v[36:39],a[132:135],v[64:67],v[36:39]
ds_read_b64 v[60:61],v20 offset:1024
v_mfma_f32_16x16x32_bf16 v[32:35],a[136:139],v[68:71],v[32:35]
ds_read_b128 v[92:95],v6 offset:7168
v_mfma_f32_16x16x32_bf16 v[36:39],a[140:143],v[68:71],v[36:39]
s_waitcnt lgkmcnt(8)
ds_read_b64 v[62:63],v20 offset:1536
v_mfma_f32_16x16x32_bf16 v[32:35],a[144:147],v[72:75],v[32:35]
ds_read_b128 v[96:99],v7 offset:0
v_mfma_f32_16x16x32_bf16 v[36:39],a[148:151],v[72:75],v[36:39]
s_waitcnt lgkmcnt(9)
s_waitcnt vmcnt(10)
v_mov_b32 v17,s57
buffer_store_dword v17,v26,s[20:23],s69 offen sc1
v_mfma_f32_16x16x32_bf16 v[32:35],a[152:155],v[76:79],v[32:35]
ds_read_b128 v[100:103],v7 offset:1024
v_mfma_f32_16x16x32_bf16 v[36:39],a[156:159],v[76:79],v[36:39]
s_waitcnt lgkmcnt(9)
v_mfma_f32_16x16x32_bf16 v[32:35],a[160:163],v[80:83],v[32:35]
ds_read_b128 v[104:107],v7 offset:2048
v_mfma_f32_16x16x32_bf16 v[36:39],a[164:167],v[80:83],v[36:39]
s_waitcnt lgkmcnt(8)
s_waitcnt lgkmcnt(3)
v_add_f32 v56,v56,v58
v_mfma_f32_16x16x32_bf16 v[32:35],a[168:171],v[84:87],v[32:35]
ds_read_b128 v[108:111],v7 offset:3072
v_add_f32 v57,v57,v59
v_mfma_f32_16x16x32_bf16 v[36:39],a[172:175],v[84:87],v[36:39]
v_add_f32 v60,v60,v62
v_add_f32 v61,v61,v63
v_mfma_f32_16x16x32_bf16 v[32:35],a[176:179],v[88:91],v[32:35]
ds_read_b128 v[112:115],v7 offset:4096
v_add_f32 v56,v56,v60
v_mfma_f32_16x16x32_bf16 v[36:39],a[180:183],v[88:91],v[36:39]
v_add_f32 v57,v57,v61
v_mul_f32 v188,0xba800000,v56
v_mfma_f32_16x16x32_bf16 v[32:35],a[184:187],v[92:95],v[32:35]
ds_read_b128 v[116:119],v7 offset:5120
v_fma_f32 v58,v188,v188,-v210
v_mfma_f32_16x16x32_bf16 v[36:39],a[188:191],v[92:95],v[36:39]
s_waitcnt lgkmcnt(5)
v_fma_f32 v57,v57,v211,-v58
v_max_f32 v57,v210,v57
v_mfma_f32_16x16x32_bf16 v[32:35],a[192:195],v[96:99],v[32:35]
ds_read_b128 v[120:123],v7 offset:6144
v_mfma_f32_16x16x32_bf16 v[36:39],a[196:199],v[96:99],v[36:39]
s_waitcnt lgkmcnt(5)
v_rsq_f32 v58,v57
v_mfma_f32_16x16x32_bf16 v[32:35],a[200:203],v[100:103],v[32:35]
ds_read_b128 v[124:127],v7 offset:7168
v_mul_f32 v189,v57,v58
v_mfma_f32_16x16x32_bf16 v[36:39],a[204:207],v[100:103],v[36:39]
s_waitcnt lgkmcnt(5)
v_mul_f32 v190,v209,v58
v_mul_f32 v59,v58,v58
v_mfma_f32_16x16x32_bf16 v[32:35],a[208:211],v[104:107],v[32:35]
s_add_u32 s61,s61,32768
v_mul_f32 v191,v208,v58
v_mul_f32 v191,v191,v59
v_mfma_f32_16x16x32_bf16 v[36:39],a[212:215],v[104:107],v[36:39]
s_waitcnt lgkmcnt(4)
s_add_u32 s62,s62,32768
s_add_u32 s70,s70,32768
v_mfma_f32_16x16x32_bf16 v[32:35],a[216:219],v[108:111],v[32:35]
s_and_b32 s70,s70,0x1ffff
s_add_u32 s55,s55,32768
s_and_b32 s55,s55,0x1ffff
v_mfma_f32_16x16x32_bf16 v[36:39],a[220:223],v[108:111],v[36:39]
s_waitcnt lgkmcnt(3)
v_add_u32 v4,s55,v8
v_add_u32 v5,s55,v9
v_mfma_f32_16x16x32_bf16 v[32:35],a[224:227],v[112:115],v[32:35]
v_add_u32 v6,s55,v10
v_add_u32 v7,s55,v11
v_mfma_f32_16x16x32_bf16 v[36:39],a[228:231],v[112:115],v[36:39]
s_waitcnt lgkmcnt(2)
s_waitcnt vmcnt(9)
ds_read_b128 v[64:67],v4 offset:0
v_mfma_f32_16x16x32_bf16 v[32:35],a[232:235],v[116:119],v[32:35]
s_waitcnt vmcnt(8)
ds_read_b128 v[68:71],v4 offset:1024
v_mfma_f32_16x16x32_bf16 v[36:39],a[236:239],v[116:119],v[36:39]
s_waitcnt lgkmcnt(3)
s_waitcnt vmcnt(7)
ds_read_b128 v[72:75],v4 offset:2048
v_mfma_f32_16x16x32_bf16 v[32:35],a[240:243],v[120:123],v[32:35]
v_mfma_f32_16x16x32_bf16 v[36:39],a[244:247],v[120:123],v[36:39]
s_waitcnt lgkmcnt(3)
v_mfma_f32_16x16x32_bf16 v[40:43],a[248:251],v[124:127],v[32:35]
v_mfma_f32_16x16x32_bf16 v[44:47],a[252:255],v[124:127],v[36:39]
s_waitcnt vmcnt(2)
v_cmp_gt_u32 vcc,s53,v16
s_add_u32 s60,s60,1
s_cbranch_vccnz WN_283
.p2align 6
WR_282:
s_waitcnt lgkmcnt(2)
v_mfma_f32_16x16x32_bf16 v[32:35],a[0:3],v[64:67],0
s_waitcnt vmcnt(6)
s_add_u32 s71,s60,2
ds_read_b128 v[76:79],v4 offset:3072
v_mfma_f32_16x16x32_bf16 v[36:39],a[4:7],v[64:67],0
s_add_u32 s53,s60,3
s_mov_b32 s57,s63
v_mfma_f32_16x16x32_bf16 v[48:51],v[12:15],v[64:67],0
s_mov_b32 m0,s70
v_fma_f32 v40,v152,v188,v40
v_fma_f32 v41,v153,v188,v41
v_mul_f32 v168,v40,v40
v_mfma_f32_16x16x32_bf16 v[52:55],v[64:67],v[64:67],0
s_waitcnt lgkmcnt(2)
buffer_load_dwordx4 v3,s[20:23],s61 offen offset:0 lds
v_mul_f32 v169,v41,v41
v_fma_f32 v168,v168,v191,v190
v_mfma_f32_16x16x32_bf16 v[32:35],a[8:11],v[68:71],v[32:35]
s_waitcnt vmcnt(6)
ds_read_b128 v[80:83],v4 offset:4096
v_fma_f32 v169,v169,v191,v190
v_mul_f32 v168,v168,v40
v_mfma_f32_16x16x32_bf16 v[36:39],a[12:15],v[68:71],v[36:39]
v_exp_f32 v168,v168
v_mul_f32 v169,v169,v41
v_mfma_f32_16x16x32_bf16 v[48:51],v[12:15],v[68:71],v[48:51]
v_exp_f32 v169,v169
v_fma_f32 v168,v168,v189,v189
v_mfma_f32_16x16x32_bf16 v[52:55],v[68:71],v[68:71],v[52:55]
s_waitcnt lgkmcnt(2)
buffer_load_dwordx4 v3,s[20:23],s61 offen offset:1024 lds
v_rcp_f32 v168,v168
v_mfma_f32_16x16x32_bf16 v[32:35],a[16:19],v[72:75],v[32:35]
s_waitcnt vmcnt(6)
ds_read_b128 v[84:87],v4 offset:5120
v_fma_f32 v169,v169,v189,v189
v_mul_f32 v40,v168,v40
v_mfma_f32_16x16x32_bf16 v[36:39],a[20:23],v[72:75],v[36:39]
v_rcp_f32 v169,v169
v_fma_f32 v42,v154,v188,v42
v_mfma_f32_16x16x32_bf16 v[48:51],v[12:15],v[72:75],v[48:51]
v_mul_f32 v41,v169,v41
v_fma_f32 v43,v155,v188,v43
v_mul_f32 v170,v42,v42
v_mfma_f32_16x16x32_bf16 v[52:55],v[72:75],v[72:75],v[52:55]
s_waitcnt lgkmcnt(2)
buffer_load_dwordx4 v3,s[20:23],s61 offen offset:2048 lds
v_mul_f32 v171,v43,v43
v_fma_f32 v170,v170,v191,v190
v_mfma_f32_16x16x32_bf16 v[32:35],a[24:27],v[76:79],v[32:35]
s_waitcnt vmcnt(6)
ds_read_b128 v[88:91],v4 offset:6144
v_fma_f32 v171,v171,v191,v190
v_mfma_f32_16x16x32_bf16 v[36:39],a[28:31],v[76:79],v[36:39]
v_mul_f32 v170,v170,v42
v_mul_f32 v171,v171,v43
v_mfma_f32_16x16x32_bf16 v[48:51],v[12:15],v[76:79],v[48:51]
v_exp_f32 v170,v170
v_mfma_f32_16x16x32_bf16 v[52:55],v[76:79],v[76:79],v[52:55]
s_waitcnt lgkmcnt(2)
buffer_load_dwordx4 v3,s[20:23],s61 offen offset:3072 lds
v_fma_f32 v170,v170,v189,v189
v_mfma_f32_16x16x32_bf16 v[32:35],a[32:35],v[80:83],v[32:35]
s_waitcnt vmcnt(5)
ds_read_b128 v[92:95],v4 offset:7168
v_fma_f32 v44,v156,v188,v44
v_mfma_f32_16x16x32_bf16 v[36:39],a[36:39],v[80:83],v[36:39]
s_barrier
ds_read_b128 v[96:99],v5 offset:0
v_fma_f32 v45,v157,v188,v45
v_mfma_f32_16x16x32_bf16 v[48:51],v[12:15],v[80:83],v[48:51]
ds_read_b128 v[100:103],v5 offset:1024
v_mul_f32 v172,v44,v44
v_mfma_f32_16x16x32_bf16 v[52:55],v[80:83],v[80:83],v[52:55]
s_waitcnt lgkmcnt(4)
ds_read_b128 v[104:107],v5 offset:2048
v_mul_f32 v173,v45,v45
v_mfma_f32_16x16x32_bf16 v[32:35],a[40:43],v[84:87],v[32:35]
s_add_u32 m0,s70,4096
ds_read_b128 v[108:111],v5 offset:3072
v_fma_f32 v172,v172,v191,v190
v_mfma_f32_16x16x32_bf16 v[36:39],a[44:47],v[84:87],v[36:39]
buffer_load_dwordx4 v3,s[20:23],s62 offen offset:0 lds
v_fma_f32 v173,v173,v191,v190
v_mfma_f32_16x16x32_bf16 v[48:51],v[12:15],v[84:87],v[48:51]
s_waitcnt vmcnt(5)
v_mov_b32 v17,s57
buffer_store_dword v17,v26,s[20:23],s69 offen sc1
v_mfma_f32_16x16x32_bf16 v[52:55],v[84:87],v[84:87],v[52:55]
s_waitcnt lgkmcnt(5)
v_exp_f32 v171,v171
v_mfma_f32_16x16x32_bf16 v[32:35],a[48:51],v[88:91],v[32:35]
ds_read_b128 v[112:115],v5 offset:4096
v_fma_f32 v171,v171,v189,v189
v_mfma_f32_16x16x32_bf16 v[36:39],a[52:55],v[88:91],v[36:39]
buffer_load_dwordx4 v3,s[20:23],s62 offen offset:1024 lds
v_mul_f32 v172,v172,v44
v_mfma_f32_16x16x32_bf16 v[48:51],v[12:15],v[88:91],v[48:51]
v_rcp_f32 v170,v170
v_mfma_f32_16x16x32_bf16 v[52:55],v[88:91],v[88:91],v[52:55]
s_waitcnt lgkmcnt(5)
v_rcp_f32 v171,v171
v_mfma_f32_16x16x32_bf16 v[32:35],a[56:59],v[92:95],v[32:35]
ds_read_b128 v[116:119],v5 offset:5120
v_mul_f32 v42,v170,v42
v_mfma_f32_16x16x32_bf16 v[36:39],a[60:63],v[92:95],v[36:39]
buffer_load_dwordx4 v3,s[20:23],s62 offen offset:2048 lds
v_mul_f32 v43,v171,v43
v_mfma_f32_16x16x32_bf16 v[48:51],v[12:15],v[92:95],v[48:51]
buffer_load_dword v16,v2,s[20:23],s68 offen sc1
v_mul_f32 v173,v173,v45
v_mfma_f32_16x16x32_bf16 v[52:55],v[92:95],v[92:95],v[52:55]
s_waitcnt lgkmcnt(5)
v_exp_f32 v172,v172
v_mfma_f32_16x16x32_bf16 v[32:35],a[64:67],v[96:99],v[32:35]
ds_read_b128 v[120:123],v5 offset:6144
v_fma_f32 v172,v172,v189,v189
v_mfma_f32_16x16x32_bf16 v[36:39],a[68:71],v[96:99],v[36:39]
s_waitcnt lgkmcnt(5)
buffer_load_dwordx4 v3,s[20:23],s62 offen offset:3072 lds
v_fma_f32 v46,v158,v188,v46
v_mfma_f32_16x16x32_bf16 v[32:35],a[72:75],v[100:103],v[32:35]
ds_read_b128 v[124:127],v5 offset:7168
v_fma_f32 v47,v159,v188,v47
v_mfma_f32_16x16x32_bf16 v[36:39],a[76:79],v[100:103],v[36:39]
s_waitcnt lgkmcnt(5)
v_exp_f32 v173,v173
v_mfma_f32_16x16x32_bf16 v[32:35],a[80:83],v[104:107],v[32:35]
ds_read_b128 v[64:67],v6 offset:0
v_cndmask_b32 v49,v52,v53,s[74:75]
v_mfma_f32_16x16x32_bf16 v[36:39],a[84:87],v[104:107],v[36:39]
s_waitcnt lgkmcnt(5)
v_cndmask_b32 v49,v49,v54,s[76:77]
v_cndmask_b32 v49,v49,v55,s[78:79]
v_mfma_f32_16x16x32_bf16 v[32:35],a[88:91],v[108:111],v[32:35]
ds_read_b128 v[68:71],v6 offset:1024
v_fma_f32 v173,v173,v189,v189
v_mfma_f32_16x16x32_bf16 v[36:39],a[92:95],v[108:111],v[36:39]
s_waitcnt lgkmcnt(5)
ds_write_b64 v19,v[48:49]
v_mfma_f32_16x16x32_bf16 v[32:35],a[96:99],v[112:115],v[32:35]
ds_read_b128 v[72:75],v6 offset:2048
v_mul_f32 v174,v46,v46
v_mfma_f32_16x16x32_bf16 v[36:39],a[100:103],v[112:115],v[36:39]
s_waitcnt lgkmcnt(6)
v_rcp_f32 v172,v172
v_mfma_f32_16x16x32_bf16 v[32:35],a[104:107],v[116:119],v[32:35]
ds_read_b128 v[76:79],v6 offset:3072
v_mul_f32 v44,v172,v44
v_mfma_f32_16x16x32_bf16 v[36:39],a[108:111],v[116:119],v[36:39]
s_waitcnt lgkmcnt(6)
v_rcp_f32 v173,v173
v_mfma_f32_16x16x32_bf16 v[32:35],a[112:115],v[120:123],v[32:35]
s_waitcnt lgkmcnt(2)
s_barrier
ds_read_b128 v[80:83],v6 offset:4096
v_mfma_f32_16x16x32_bf16 v[36:39],a[116:119],v[120:123],v[36:39]
ds_read_b64 v[56:57],v20 offset:0
v_mul_f32 v45,v173,v45
v_mfma_f32_16x16x32_bf16 v[32:35],a[120:123],v[124:127],v[32:35]
ds_read_b128 v[84:87],v6 offset:5120
v_mul_f32 v175,v47,v47
v_mfma_f32_16x16x32_bf16 v[36:39],a[124:127],v[124:127],v[36:39]
ds_read_b64 v[58:59],v20 offset:512
v_fma_f32 v174,v174,v191,v190
v_mfma_f32_16x16x32_bf16 v[32:35],a[128:131],v[64:67],v[32:35]
ds_read_b128 v[88:91],v6 offset:6144
v_fma_f32 v175,v175,v191,v190
v_mfma_f32_16x16x32_bf16 v[36:39],a[132:135],v[64:67],v[36:39]
ds_read_b64 v[60:61],v20 offset:1024
v_mul_f32 v174,v174,v46
v_mfma_f32_16x16x32_bf16 v[32:35],a[136:139],v[68:71],v[32:35]
ds_read_b128 v[92:95],v6 offset:7168
v_mul_f32 v175,v175,v47
v_mfma_f32_16x16x32_bf16 v[36:39],a[140:143],v[68:71],v[36:39]
s_waitcnt lgkmcnt(8)
ds_read_b64 v[62:63],v20 offset:1536
v_cvt_pk_bf16_f32 v176,v40,v41
v_mfma_f32_16x16x32_bf16 v[32:35],a[144:147],v[72:75],v[32:35]
ds_read_b128 v[96:99],v7 offset:0
v_cvt_pk_bf16_f32 v177,v42,v43
v_mfma_f32_16x16x32_bf16 v[36:39],a[148:151],v[72:75],v[36:39]
s_waitcnt lgkmcnt(9)
v_exp_f32 v174,v174
v_mfma_f32_16x16x32_bf16 v[32:35],a[152:155],v[76:79],v[32:35]
ds_read_b128 v[100:103],v7 offset:1024
v_fma_f32 v174,v174,v189,v189
v_mfma_f32_16x16x32_bf16 v[36:39],a[156:159],v[76:79],v[36:39]
s_waitcnt lgkmcnt(9)
v_exp_f32 v175,v175
v_mfma_f32_16x16x32_bf16 v[32:35],a[160:163],v[80:83],v[32:35]
ds_read_b128 v[104:107],v7 offset:2048
v_fma_f32 v175,v175,v189,v189
v_mfma_f32_16x16x32_bf16 v[36:39],a[164:167],v[80:83],v[36:39]
s_waitcnt lgkmcnt(8)
s_waitcnt lgkmcnt(3)
v_rcp_f32 v174,v174
v_mfma_f32_16x16x32_bf16 v[32:35],a[168:171],v[84:87],v[32:35]
ds_read_b128 v[108:111],v7 offset:3072
v_mul_f32 v46,v174,v46
v_mfma_f32_16x16x32_bf16 v[36:39],a[172:175],v[84:87],v[36:39]
v_rcp_f32 v175,v175
v_mfma_f32_16x16x32_bf16 v[32:35],a[176:179],v[88:91],v[32:35]
ds_read_b128 v[112:115],v7 offset:4096
v_mul_f32 v47,v175,v47
v_mfma_f32_16x16x32_bf16 v[36:39],a[180:183],v[88:91],v[36:39]
v_cvt_pk_bf16_f32 v178,v44,v45
v_cvt_pk_bf16_f32 v179,v46,v47
v_mfma_f32_16x16x32_bf16 v[32:35],a[184:187],v[92:95],v[32:35]
ds_read_b128 v[116:119],v7 offset:5120
v_add_f32 v56,v56,v58
v_mfma_f32_16x16x32_bf16 v[36:39],a[188:191],v[92:95],v[36:39]
s_waitcnt lgkmcnt(5)
buffer_store_dwordx4 v[176:179],v0,s[20:23],s66 offen sc1
v_mfma_f32_16x16x32_bf16 v[32:35],a[192:195],v[96:99],v[32:35]
s_add_u32 s66,s66,114688
s_add_u32 s63,s63,1
ds_read_b128 v[120:123],v7 offset:6144
v_mfma_f32_16x16x32_bf16 v[36:39],a[196:199],v[96:99],v[36:39]
s_waitcnt lgkmcnt(5)
v_add_f32 v57,v57,v59
v_add_f32 v60,v60,v62
v_mfma_f32_16x16x32_bf16 v[32:35],a[200:203],v[100:103],v[32:35]
ds_read_b128 v[124:127],v7 offset:7168
v_add_f32 v61,v61,v63
v_mfma_f32_16x16x32_bf16 v[36:39],a[204:207],v[100:103],v[36:39]
s_waitcnt lgkmcnt(5)
v_add_f32 v56,v56,v60
v_add_f32 v57,v57,v61
v_mfma_f32_16x16x32_bf16 v[32:35],a[208:211],v[104:107],v[32:35]
s_add_u32 s61,s61,32768
v_mul_f32 v188,0xba800000,v56
v_fma_f32 v58,v188,v188,-v210
v_mfma_f32_16x16x32_bf16 v[36:39],a[212:215],v[104:107],v[36:39]
s_waitcnt lgkmcnt(4)
v_fma_f32 v57,v57,v211,-v58
v_max_f32 v57,v210,v57
v_mfma_f32_16x16x32_bf16 v[32:35],a[216:219],v[108:111],v[32:35]
s_add_u32 s62,s62,32768
v_rsq_f32 v58,v57
v_mfma_f32_16x16x32_bf16 v[36:39],a[220:223],v[108:111],v[36:39]
s_waitcnt lgkmcnt(3)
v_mul_f32 v189,v57,v58
v_mul_f32 v190,v209,v58
v_mfma_f32_16x16x32_bf16 v[32:35],a[224:227],v[112:115],v[32:35]
s_add_u32 s70,s70,32768
v_mul_f32 v59,v58,v58
v_mul_f32 v191,v208,v58
v_mfma_f32_16x16x32_bf16 v[36:39],a[228:231],v[112:115],v[36:39]
s_waitcnt lgkmcnt(2)
s_and_b32 s70,s70,0x1ffff
v_mul_f32 v191,v191,v59
v_mfma_f32_16x16x32_bf16 v[32:35],a[232:235],v[116:119],v[32:35]
s_add_u32 s55,s55,32768
s_and_b32 s55,s55,0x1ffff
v_add_u32 v4,s55,v8
v_mfma_f32_16x16x32_bf16 v[36:39],a[236:239],v[116:119],v[36:39]
s_waitcnt lgkmcnt(1)
v_add_u32 v5,s55,v9
v_add_u32 v6,s55,v10
v_mfma_f32_16x16x32_bf16 v[32:35],a[240:243],v[120:123],v[32:35]
v_add_u32 v7,s55,v11
v_mfma_f32_16x16x32_bf16 v[36:39],a[244:247],v[120:123],v[36:39]
s_waitcnt lgkmcnt(0)
s_waitcnt vmcnt(10)
ds_read_b128 v[64:67],v4 offset:0
v_mfma_f32_16x16x32_bf16 v[40:43],a[248:251],v[124:127],v[32:35]
s_waitcnt vmcnt(9)
ds_read_b128 v[68:71],v4 offset:1024
v_mfma_f32_16x16x32_bf16 v[44:47],a[252:255],v[124:127],v[36:39]
s_waitcnt vmcnt(2)
v_cmp_gt_u32 vcc,s53,v16
ds_read_b128 v[72:75],v4 offset:2048
s_add_u32 s60,s60,1
s_cbranch_vccz WR_282
WN_283:
s_waitcnt lgkmcnt(2)
v_mfma_f32_16x16x32_bf16 v[32:35],a[0:3],v[64:67],0
s_waitcnt vmcnt(6)
s_add_u32 s71,s60,2
ds_read_b128 v[76:79],v4 offset:3072
v_mfma_f32_16x16x32_bf16 v[36:39],a[4:7],v[64:67],0
s_add_u32 s53,s60,3
s_mov_b32 s57,s63
v_mfma_f32_16x16x32_bf16 v[48:51],v[12:15],v[64:67],0
v_fma_f32 v40,v152,v188,v40
v_fma_f32 v41,v153,v188,v41
v_mul_f32 v168,v40,v40
v_mfma_f32_16x16x32_bf16 v[52:55],v[64:67],v[64:67],0
s_waitcnt lgkmcnt(2)
v_mul_f32 v169,v41,v41
v_fma_f32 v168,v168,v191,v190
v_fma_f32 v169,v169,v191,v190
v_mfma_f32_16x16x32_bf16 v[32:35],a[8:11],v[68:71],v[32:35]
s_waitcnt vmcnt(5)
ds_read_b128 v[80:83],v4 offset:4096
v_mul_f32 v168,v168,v40
v_mul_f32 v169,v169,v41
v_mfma_f32_16x16x32_bf16 v[36:39],a[12:15],v[68:71],v[36:39]
v_exp_f32 v168,v168
v_fma_f32 v42,v154,v188,v42
v_mfma_f32_16x16x32_bf16 v[48:51],v[12:15],v[68:71],v[48:51]
v_exp_f32 v169,v169
v_fma_f32 v168,v168,v189,v189
v_mfma_f32_16x16x32_bf16 v[52:55],v[68:71],v[68:71],v[52:55]
s_waitcnt lgkmcnt(2)
v_rcp_f32 v168,v168
v_fma_f32 v169,v169,v189,v189
v_mfma_f32_16x16x32_bf16 v[32:35],a[16:19],v[72:75],v[32:35]
s_waitcnt vmcnt(4)
ds_read_b128 v[84:87],v4 offset:5120
v_rcp_f32 v169,v169
v_mfma_f32_16x16x32_bf16 v[36:39],a[20:23],v[72:75],v[36:39]
v_mul_f32 v40,v168,v40
v_mul_f32 v41,v169,v41
v_fma_f32 v43,v155,v188,v43
v_mfma_f32_16x16x32_bf16 v[48:51],v[12:15],v[72:75],v[48:51]
v_mul_f32 v170,v42,v42
v_mul_f32 v171,v43,v43
v_mfma_f32_16x16x32_bf16 v[52:55],v[72:75],v[72:75],v[52:55]
s_waitcnt lgkmcnt(2)
v_fma_f32 v170,v170,v191,v190
v_fma_f32 v171,v171,v191,v190
v_mfma_f32_16x16x32_bf16 v[32:35],a[24:27],v[76:79],v[32:35]
s_waitcnt vmcnt(3)
ds_read_b128 v[88:91],v4 offset:6144
v_mul_f32 v170,v170,v42
v_mfma_f32_16x16x32_bf16 v[36:39],a[28:31],v[76:79],v[36:39]
v_exp_f32 v170,v170
v_mfma_f32_16x16x32_bf16 v[48:51],v[12:15],v[76:79],v[48:51]
v_mul_f32 v171,v171,v43
v_fma_f32 v170,v170,v189,v189
v_mfma_f32_16x16x32_bf16 v[52:55],v[76:79],v[76:79],v[52:55]
s_waitcnt lgkmcnt(2)
v_exp_f32 v171,v171
v_mfma_f32_16x16x32_bf16 v[32:35],a[32:35],v[80:83],v[32:35]
s_waitcnt vmcnt(1)
ds_read_b128 v[92:95],v4 offset:7168
v_fma_f32 v171,v171,v189,v189
v_mfma_f32_16x16x32_bf16 v[36:39],a[36:39],v[80:83],v[36:39]
s_barrier
ds_read_b128 v[96:99],v5 offset:0
v_fma_f32 v44,v156,v188,v44
v_mfma_f32_16x16x32_bf16 v[48:51],v[12:15],v[80:83],v[48:51]
ds_read_b128 v[100:103],v5 offset:1024
v_fma_f32 v45,v157,v188,v45
v_mfma_f32_16x16x32_bf16 v[52:55],v[80:83],v[80:83],v[52:55]
s_waitcnt lgkmcnt(4)
ds_read_b128 v[104:107],v5 offset:2048
v_mul_f32 v172,v44,v44
v_mfma_f32_16x16x32_bf16 v[32:35],a[40:43],v[84:87],v[32:35]
ds_read_b128 v[108:111],v5 offset:3072
v_mul_f32 v173,v45,v45
v_mfma_f32_16x16x32_bf16 v[36:39],a[44:47],v[84:87],v[36:39]
s_waitcnt vmcnt(0)
v_mov_b32 v17,s57
buffer_store_dword v17,v26,s[20:23],s69 offen sc1
v_mfma_f32_16x16x32_bf16 v[48:51],v[12:15],v[84:87],v[48:51]
v_rcp_f32 v170,v170
v_mfma_f32_16x16x32_bf16 v[52:55],v[84:87],v[84:87],v[52:55]
s_waitcnt lgkmcnt(5)
v_rcp_f32 v171,v171
v_mfma_f32_16x16x32_bf16 v[32:35],a[48:51],v[88:91],v[32:35]
ds_read_b128 v[112:115],v5 offset:4096
v_mul_f32 v42,v170,v42
v_mfma_f32_16x16x32_bf16 v[36:39],a[52:55],v[88:91],v[36:39]
v_mul_f32 v43,v171,v43
v_fma_f32 v172,v172,v191,v190
v_mfma_f32_16x16x32_bf16 v[48:51],v[12:15],v[88:91],v[48:51]
v_fma_f32 v173,v173,v191,v190
v_mul_f32 v172,v172,v44
v_mfma_f32_16x16x32_bf16 v[52:55],v[88:91],v[88:91],v[52:55]
s_waitcnt lgkmcnt(5)
v_exp_f32 v172,v172
v_mfma_f32_16x16x32_bf16 v[32:35],a[56:59],v[92:95],v[32:35]
ds_read_b128 v[116:119],v5 offset:5120
v_mul_f32 v173,v173,v45
v_mfma_f32_16x16x32_bf16 v[36:39],a[60:63],v[92:95],v[36:39]
v_exp_f32 v173,v173
v_mfma_f32_16x16x32_bf16 v[48:51],v[12:15],v[92:95],v[48:51]
v_fma_f32 v172,v172,v189,v189
v_fma_f32 v173,v173,v189,v189
v_mfma_f32_16x16x32_bf16 v[52:55],v[92:95],v[92:95],v[52:55]
s_waitcnt lgkmcnt(5)
v_rcp_f32 v172,v172
v_mfma_f32_16x16x32_bf16 v[32:35],a[64:67],v[96:99],v[32:35]
ds_read_b128 v[120:123],v5 offset:6144
v_mul_f32 v44,v172,v44
v_mfma_f32_16x16x32_bf16 v[36:39],a[68:71],v[96:99],v[36:39]
s_waitcnt lgkmcnt(5)
v_rcp_f32 v173,v173
v_mfma_f32_16x16x32_bf16 v[32:35],a[72:75],v[100:103],v[32:35]
ds_read_b128 v[124:127],v5 offset:7168
v_mul_f32 v45,v173,v45
v_mfma_f32_16x16x32_bf16 v[36:39],a[76:79],v[100:103],v[36:39]
s_waitcnt lgkmcnt(5)
v_fma_f32 v46,v158,v188,v46
v_fma_f32 v47,v159,v188,v47
v_mfma_f32_16x16x32_bf16 v[32:35],a[80:83],v[104:107],v[32:35]
ds_read_b128 v[64:67],v6 offset:0
v_cndmask_b32 v49,v52,v53,s[74:75]
v_mfma_f32_16x16x32_bf16 v[36:39],a[84:87],v[104:107],v[36:39]
s_waitcnt lgkmcnt(5)
v_cndmask_b32 v49,v49,v54,s[76:77]
v_cndmask_b32 v49,v49,v55,s[78:79]
v_mfma_f32_16x16x32_bf16 v[32:35],a[88:91],v[108:111],v[32:35]
ds_read_b128 v[68:71],v6 offset:1024
v_mul_f32 v174,v46,v46
v_mfma_f32_16x16x32_bf16 v[36:39],a[92:95],v[108:111],v[36:39]
s_waitcnt lgkmcnt(5)
ds_write_b64 v19,v[48:49]
v_mfma_f32_16x16x32_bf16 v[32:35],a[96:99],v[112:115],v[32:35]
ds_read_b128 v[72:75],v6 offset:2048
v_mul_f32 v175,v47,v47
v_mfma_f32_16x16x32_bf16 v[36:39],a[100:103],v[112:115],v[36:39]
s_waitcnt lgkmcnt(6)
v_fma_f32 v174,v174,v191,v190
v_fma_f32 v175,v175,v191,v190
v_mfma_f32_16x16x32_bf16 v[32:35],a[104:107],v[116:119],v[32:35]
ds_read_b128 v[76:79],v6 offset:3072
v_mul_f32 v174,v174,v46
v_mfma_f32_16x16x32_bf16 v[36:39],a[108:111],v[116:119],v[36:39]
s_waitcnt lgkmcnt(6)
v_exp_f32 v174,v174
v_mfma_f32_16x16x32_bf16 v[32:35],a[112:115],v[120:123],v[32:35]
s_waitcnt lgkmcnt(2)
s_barrier
ds_read_b128 v[80:83],v6 offset:4096
v_mfma_f32_16x16x32_bf16 v[36:39],a[116:119],v[120:123],v[36:39]
ds_read_b64 v[56:57],v20 offset:0
v_mul_f32 v175,v175,v47
v_mfma_f32_16x16x32_bf16 v[32:35],a[120:123],v[124:127],v[32:35]
ds_read_b128 v[84:87],v6 offset:5120
v_fma_f32 v174,v174,v189,v189
v_mfma_f32_16x16x32_bf16 v[36:39],a[124:127],v[124:127],v[36:39]
ds_read_b64 v[58:59],v20 offset:512
v_cvt_pk_bf16_f32 v176,v40,v41
v_mfma_f32_16x16x32_bf16 v[32:35],a[128:131],v[64:67],v[32:35]
ds_read_b128 v[88:91],v6 offset:6144
v_cvt_pk_bf16_f32 v177,v42,v43
v_mfma_f32_16x16x32_bf16 v[36:39],a[132:135],v[64:67],v[36:39]
ds_read_b64 v[60:61],v20 offset:1024
v_cvt_pk_bf16_f32 v178,v44,v45
v_mfma_f32_16x16x32_bf16 v[32:35],a[136:139],v[68:71],v[32:35]
ds_read_b128 v[92:95],v6 offset:7168
v_mfma_f32_16x16x32_bf16 v[36:39],a[140:143],v[68:71],v[36:39]
s_waitcnt lgkmcnt(8)
ds_read_b64 v[62:63],v20 offset:1536
v_mfma_f32_16x16x32_bf16 v[32:35],a[144:147],v[72:75],v[32:35]
ds_read_b128 v[96:99],v7 offset:0
v_mfma_f32_16x16x32_bf16 v[36:39],a[148:151],v[72:75],v[36:39]
s_waitcnt lgkmcnt(9)
buffer_load_dword v16,v2,s[20:23],s68 offen sc1
v_mfma_f32_16x16x32_bf16 v[32:35],a[152:155],v[76:79],v[32:35]
ds_read_b128 v[100:103],v7 offset:1024
v_mfma_f32_16x16x32_bf16 v[36:39],a[156:159],v[76:79],v[36:39]
s_waitcnt lgkmcnt(9)
v_exp_f32 v175,v175
v_mfma_f32_16x16x32_bf16 v[32:35],a[160:163],v[80:83],v[32:35]
ds_read_b128 v[104:107],v7 offset:2048
v_fma_f32 v175,v175,v189,v189
v_mfma_f32_16x16x32_bf16 v[36:39],a[164:167],v[80:83],v[36:39]
s_waitcnt lgkmcnt(8)
s_waitcnt lgkmcnt(3)
v_rcp_f32 v174,v174
v_mfma_f32_16x16x32_bf16 v[32:35],a[168:171],v[84:87],v[32:35]
ds_read_b128 v[108:111],v7 offset:3072
v_mul_f32 v46,v174,v46
v_mfma_f32_16x16x32_bf16 v[36:39],a[172:175],v[84:87],v[36:39]
v_rcp_f32 v175,v175
v_mfma_f32_16x16x32_bf16 v[32:35],a[176:179],v[88:91],v[32:35]
ds_read_b128 v[112:115],v7 offset:4096
v_mul_f32 v47,v175,v47
v_mfma_f32_16x16x32_bf16 v[36:39],a[180:183],v[88:91],v[36:39]
v_cvt_pk_bf16_f32 v179,v46,v47
v_add_f32 v56,v56,v58
v_mfma_f32_16x16x32_bf16 v[32:35],a[184:187],v[92:95],v[32:35]
ds_read_b128 v[116:119],v7 offset:5120
v_add_f32 v57,v57,v59
v_mfma_f32_16x16x32_bf16 v[36:39],a[188:191],v[92:95],v[36:39]
s_waitcnt lgkmcnt(5)
buffer_store_dwordx4 v[176:179],v0,s[20:23],s66 offen sc1
v_mfma_f32_16x16x32_bf16 v[32:35],a[192:195],v[96:99],v[32:35]
s_add_u32 s66,s66,114688
s_add_u32 s63,s63,1
ds_read_b128 v[120:123],v7 offset:6144
v_mfma_f32_16x16x32_bf16 v[36:39],a[196:199],v[96:99],v[36:39]
s_waitcnt lgkmcnt(5)
v_add_f32 v60,v60,v62
v_add_f32 v61,v61,v63
v_mfma_f32_16x16x32_bf16 v[32:35],a[200:203],v[100:103],v[32:35]
ds_read_b128 v[124:127],v7 offset:7168
v_add_f32 v56,v56,v60
v_mfma_f32_16x16x32_bf16 v[36:39],a[204:207],v[100:103],v[36:39]
s_waitcnt lgkmcnt(5)
v_add_f32 v57,v57,v61
v_mul_f32 v188,0xba800000,v56
v_mfma_f32_16x16x32_bf16 v[32:35],a[208:211],v[104:107],v[32:35]
s_add_u32 s55,s55,32768
v_fma_f32 v58,v188,v188,-v210
v_fma_f32 v57,v57,v211,-v58
v_mfma_f32_16x16x32_bf16 v[36:39],a[212:215],v[104:107],v[36:39]
s_waitcnt lgkmcnt(4)
s_and_b32 s55,s55,0x1ffff
v_max_f32 v57,v210,v57
v_mfma_f32_16x16x32_bf16 v[32:35],a[216:219],v[108:111],v[32:35]
v_rsq_f32 v58,v57
v_mfma_f32_16x16x32_bf16 v[36:39],a[220:223],v[108:111],v[36:39]
s_waitcnt lgkmcnt(3)
v_mul_f32 v189,v57,v58
v_mul_f32 v190,v209,v58
v_mfma_f32_16x16x32_bf16 v[32:35],a[224:227],v[112:115],v[32:35]
v_mul_f32 v59,v58,v58
v_mul_f32 v191,v208,v58
v_mfma_f32_16x16x32_bf16 v[36:39],a[228:231],v[112:115],v[36:39]
s_waitcnt lgkmcnt(2)
v_mul_f32 v191,v191,v59
v_add_u32 v4,s55,v8
v_mfma_f32_16x16x32_bf16 v[32:35],a[232:235],v[116:119],v[32:35]
v_add_u32 v5,s55,v9
v_add_u32 v6,s55,v10
v_mfma_f32_16x16x32_bf16 v[36:39],a[236:239],v[116:119],v[36:39]
s_waitcnt lgkmcnt(1)
v_add_u32 v7,s55,v11
v_mfma_f32_16x16x32_bf16 v[32:35],a[240:243],v[120:123],v[32:35]
v_mfma_f32_16x16x32_bf16 v[36:39],a[244:247],v[120:123],v[36:39]
s_waitcnt lgkmcnt(0)
v_mfma_f32_16x16x32_bf16 v[40:43],a[248:251],v[124:127],v[32:35]
v_mfma_f32_16x16x32_bf16 v[44:47],a[252:255],v[124:127],v[36:39]
s_waitcnt vmcnt(1)
v_cmp_gt_u32 vcc,s71,v16
s_add_u32 s60,s60,1
s_branch endN_291
BN_285:
s_waitcnt vmcnt(9)
ds_read_b128 v[64:67],v4 offset:0
s_waitcnt vmcnt(8)
ds_read_b128 v[68:71],v4 offset:1024
s_waitcnt vmcnt(7)
ds_read_b128 v[72:75],v4 offset:2048
s_waitcnt vmcnt(6)
ds_read_b128 v[76:79],v4 offset:3072
s_waitcnt lgkmcnt(3)
v_mfma_f32_16x16x32_bf16 v[32:35],a[0:3],v[64:67],0
s_add_u32 s71,s60,2
s_add_u32 s53,s60,3
s_mov_b32 s57,s63
v_mfma_f32_16x16x32_bf16 v[36:39],a[4:7],v[64:67],0
v_mfma_f32_16x16x32_bf16 v[48:51],v[12:15],v[64:67],0
v_mfma_f32_16x16x32_bf16 v[52:55],v[64:67],v[64:67],0
s_waitcnt lgkmcnt(2)
s_waitcnt vmcnt(5)
ds_read_b128 v[80:83],v4 offset:4096
v_mfma_f32_16x16x32_bf16 v[32:35],a[8:11],v[68:71],v[32:35]
v_mfma_f32_16x16x32_bf16 v[36:39],a[12:15],v[68:71],v[36:39]
v_mfma_f32_16x16x32_bf16 v[48:51],v[12:15],v[68:71],v[48:51]
v_mfma_f32_16x16x32_bf16 v[52:55],v[68:71],v[68:71],v[52:55]
s_waitcnt lgkmcnt(2)
s_waitcnt vmcnt(4)
ds_read_b128 v[84:87],v4 offset:5120
v_mfma_f32_16x16x32_bf16 v[32:35],a[16:19],v[72:75],v[32:35]
v_mfma_f32_16x16x32_bf16 v[36:39],a[20:23],v[72:75],v[36:39]
v_mfma_f32_16x16x32_bf16 v[48:51],v[12:15],v[72:75],v[48:51]
v_mfma_f32_16x16x32_bf16 v[52:55],v[72:75],v[72:75],v[52:55]
s_waitcnt lgkmcnt(2)
s_waitcnt vmcnt(3)
ds_read_b128 v[88:91],v4 offset:6144
v_mfma_f32_16x16x32_bf16 v[32:35],a[24:27],v[76:79],v[32:35]
v_mfma_f32_16x16x32_bf16 v[36:39],a[28:31],v[76:79],v[36:39]
v_mfma_f32_16x16x32_bf16 v[48:51],v[12:15],v[76:79],v[48:51]
v_mfma_f32_16x16x32_bf16 v[52:55],v[76:79],v[76:79],v[52:55]
s_waitcnt lgkmcnt(2)
s_waitcnt vmcnt(2)
ds_read_b128 v[92:95],v4 offset:7168
v_mfma_f32_16x16x32_bf16 v[32:35],a[32:35],v[80:83],v[32:35]
v_mfma_f32_16x16x32_bf16 v[36:39],a[36:39],v[80:83],v[36:39]
v_mfma_f32_16x16x32_bf16 v[48:51],v[12:15],v[80:83],v[48:51]
v_mfma_f32_16x16x32_bf16 v[52:55],v[80:83],v[80:83],v[52:55]
s_waitcnt lgkmcnt(2)
s_barrier
ds_read_b128 v[96:99],v5 offset:0
v_mfma_f32_16x16x32_bf16 v[32:35],a[40:43],v[84:87],v[32:35]
ds_read_b128 v[100:103],v5 offset:1024
v_mfma_f32_16x16x32_bf16 v[36:39],a[44:47],v[84:87],v[36:39]
ds_read_b128 v[104:107],v5 offset:2048
v_mfma_f32_16x16x32_bf16 v[48:51],v[12:15],v[84:87],v[48:51]
ds_read_b128 v[108:111],v5 offset:3072
v_mfma_f32_16x16x32_bf16 v[52:55],v[84:87],v[84:87],v[52:55]
s_waitcnt lgkmcnt(5)
v_mfma_f32_16x16x32_bf16 v[32:35],a[48:51],v[88:91],v[32:35]
ds_read_b128 v[112:115],v5 offset:4096
v_mfma_f32_16x16x32_bf16 v[36:39],a[52:55],v[88:91],v[36:39]
v_mfma_f32_16x16x32_bf16 v[48:51],v[12:15],v[88:91],v[48:51]
v_mfma_f32_16x16x32_bf16 v[52:55],v[88:91],v[88:91],v[52:55]
s_waitcnt lgkmcnt(5)
v_mfma_f32_16x16x32_bf16 v[32:35],a[56:59],v[92:95],v[32:35]
ds_read_b128 v[116:119],v5 offset:5120
v_mfma_f32_16x16x32_bf16 v[36:39],a[60:63],v[92:95],v[36:39]
v_mfma_f32_16x16x32_bf16 v[48:51],v[12:15],v[92:95],v[48:51]
v_mfma_f32_16x16x32_bf16 v[52:55],v[92:95],v[92:95],v[52:55]
s_waitcnt lgkmcnt(5)
v_mfma_f32_16x16x32_bf16 v[32:35],a[64:67],v[96:99],v[32:35]
ds_read_b128 v[120:123],v5 offset:6144
v_mfma_f32_16x16x32_bf16 v[36:39],a[68:71],v[96:99],v[36:39]
s_waitcnt lgkmcnt(5)
v_mfma_f32_16x16x32_bf16 v[32:35],a[72:75],v[100:103],v[32:35]
ds_read_b128 v[124:127],v5 offset:7168
v_mfma_f32_16x16x32_bf16 v[36:39],a[76:79],v[100:103],v[36:39]
s_waitcnt lgkmcnt(5)
v_mfma_f32_16x16x32_bf16 v[32:35],a[80:83],v[104:107],v[32:35]
ds_read_b128 v[64:67],v6 offset:0
v_cndmask_b32 v49,v52,v53,s[74:75]
v_mfma_f32_16x16x32_bf16 v[36:39],a[84:87],v[104:107],v[36:39]
s_waitcnt lgkmcnt(5)
v_cndmask_b32 v49,v49,v54,s[76:77]
v_cndmask_b32 v49,v49,v55,s[78:79]
v_mfma_f32_16x16x32_bf16 v[32:35],a[88:91],v[108:111],v[32:35]
ds_read_b128 v[68:71],v6 offset:1024
v_mfma_f32_16x16x32_bf16 v[36:39],a[92:95],v[108:111],v[36:39]
s_waitcnt lgkmcnt(5)
ds_write_b64 v19,v[48:49]
v_mfma_f32_16x16x32_bf16 v[32:35],a[96:99],v[112:115],v[32:35]
ds_read_b128 v[72:75],v6 offset:2048
v_mfma_f32_16x16x32_bf16 v[36:39],a[100:103],v[112:115],v[36:39]
s_waitcnt lgkmcnt(6)
v_mfma_f32_16x16x32_bf16 v[32:35],a[104:107],v[116:119],v[32:35]
ds_read_b128 v[76:79],v6 offset:3072
v_mfma_f32_16x16x32_bf16 v[36:39],a[108:111],v[116:119],v[36:39]
s_waitcnt lgkmcnt(6)
v_mfma_f32_16x16x32_bf16 v[32:35],a[112:115],v[120:123],v[32:35]
s_waitcnt lgkmcnt(2)
s_barrier
ds_read_b128 v[80:83],v6 offset:4096
v_mfma_f32_16x16x32_bf16 v[36:39],a[116:119],v[120:123],v[36:39]
ds_read_b64 v[56:57],v20 offset:0
v_mfma_f32_16x16x32_bf16 v[32:35],a[120:123],v[124:127],v[32:35]
ds_read_b128 v[84:87],v6 offset:5120
v_mfma_f32_16x16x32_bf16 v[36:39],a[124:127],v[124:127],v[36:39]
ds_read_b64 v[58:59],v20 offset:512
v_mfma_f32_16x16x32_bf16 v[32:35],a[128:131],v[64:67],v[32:35]
ds_read_b128 v[88:91],v6 offset:6144
v_mfma_f32_16x16x32_bf16 v[36:39],a[132:135],v[64:67],v[36:39]
ds_read_b64 v[60:61],v20 offset:1024
v_mfma_f32_16x16x32_bf16 v[32:35],a[136:139],v[68:71],v[32:35]
ds_read_b128 v[92:95],v6 offset:7168
v_mfma_f32_16x16x32_bf16 v[36:39],a[140:143],v[68:71],v[36:39]
s_waitcnt lgkmcnt(8)
ds_read_b64 v[62:63],v20 offset:1536
v_mfma_f32_16x16x32_bf16 v[32:35],a[144:147],v[72:75],v[32:35]
ds_read_b128 v[96:99],v7 offset:0
v_mfma_f32_16x16x32_bf16 v[36:39],a[148:151],v[72:75],v[36:39]
s_waitcnt lgkmcnt(9)
buffer_load_dword v16,v2,s[20:23],s68 offen sc1
v_mfma_f32_16x16x32_bf16 v[32:35],a[152:155],v[76:79],v[32:35]
ds_read_b128 v[100:103],v7 offset:1024
v_mfma_f32_16x16x32_bf16 v[36:39],a[156:159],v[76:79],v[36:39]
s_waitcnt lgkmcnt(9)
s_waitcnt vmcnt(2)
v_mov_b32 v17,s57
buffer_store_dword v17,v26,s[20:23],s69 offen sc1
v_mfma_f32_16x16x32_bf16 v[32:35],a[160:163],v[80:83],v[32:35]
ds_read_b128 v[104:107],v7 offset:2048
v_mfma_f32_16x16x32_bf16 v[36:39],a[164:167],v[80:83],v[36:39]
s_waitcnt lgkmcnt(8)
s_waitcnt lgkmcnt(3)
v_add_f32 v56,v56,v58
v_mfma_f32_16x16x32_bf16 v[32:35],a[168:171],v[84:87],v[32:35]
ds_read_b128 v[108:111],v7 offset:3072
v_add_f32 v57,v57,v59
v_mfma_f32_16x16x32_bf16 v[36:39],a[172:175],v[84:87],v[36:39]
v_add_f32 v60,v60,v62
v_add_f32 v61,v61,v63
v_mfma_f32_16x16x32_bf16 v[32:35],a[176:179],v[88:91],v[32:35]
ds_read_b128 v[112:115],v7 offset:4096
v_add_f32 v56,v56,v60
v_mfma_f32_16x16x32_bf16 v[36:39],a[180:183],v[88:91],v[36:39]
v_add_f32 v57,v57,v61
v_mul_f32 v188,0xba800000,v56
v_mfma_f32_16x16x32_bf16 v[32:35],a[184:187],v[92:95],v[32:35]
ds_read_b128 v[116:119],v7 offset:5120
v_fma_f32 v58,v188,v188,-v210
v_mfma_f32_16x16x32_bf16 v[36:39],a[188:191],v[92:95],v[36:39]
s_waitcnt lgkmcnt(5)
v_fma_f32 v57,v57,v211,-v58
v_max_f32 v57,v210,v57
v_mfma_f32_16x16x32_bf16 v[32:35],a[192:195],v[96:99],v[32:35]
ds_read_b128 v[120:123],v7 offset:6144
v_mfma_f32_16x16x32_bf16 v[36:39],a[196:199],v[96:99],v[36:39]
s_waitcnt lgkmcnt(5)
v_rsq_f32 v58,v57
v_mfma_f32_16x16x32_bf16 v[32:35],a[200:203],v[100:103],v[32:35]
ds_read_b128 v[124:127],v7 offset:7168
v_mul_f32 v189,v57,v58
v_mfma_f32_16x16x32_bf16 v[36:39],a[204:207],v[100:103],v[36:39]
s_waitcnt lgkmcnt(5)
v_mul_f32 v190,v209,v58
v_mul_f32 v59,v58,v58
v_mfma_f32_16x16x32_bf16 v[32:35],a[208:211],v[104:107],v[32:35]
s_add_u32 s55,s55,32768
v_mul_f32 v191,v208,v58
v_mul_f32 v191,v191,v59
v_mfma_f32_16x16x32_bf16 v[36:39],a[212:215],v[104:107],v[36:39]
s_waitcnt lgkmcnt(4)
s_and_b32 s55,s55,0x1ffff
v_add_u32 v4,s55,v8
v_mfma_f32_16x16x32_bf16 v[32:35],a[216:219],v[108:111],v[32:35]
v_add_u32 v5,s55,v9
v_add_u32 v6,s55,v10
v_mfma_f32_16x16x32_bf16 v[36:39],a[220:223],v[108:111],v[36:39]
s_waitcnt lgkmcnt(3)
v_add_u32 v7,s55,v11
v_mfma_f32_16x16x32_bf16 v[32:35],a[224:227],v[112:115],v[32:35]
v_mfma_f32_16x16x32_bf16 v[36:39],a[228:231],v[112:115],v[36:39]
s_waitcnt lgkmcnt(2)
v_mfma_f32_16x16x32_bf16 v[32:35],a[232:235],v[116:119],v[32:35]
v_mfma_f32_16x16x32_bf16 v[36:39],a[236:239],v[116:119],v[36:39]
s_waitcnt lgkmcnt(1)
v_mfma_f32_16x16x32_bf16 v[32:35],a[240:243],v[120:123],v[32:35]
v_mfma_f32_16x16x32_bf16 v[36:39],a[244:247],v[120:123],v[36:39]
s_waitcnt lgkmcnt(0)
v_mfma_f32_16x16x32_bf16 v[40:43],a[248:251],v[124:127],v[32:35]
v_mfma_f32_16x16x32_bf16 v[44:47],a[252:255],v[124:127],v[36:39]
s_waitcnt vmcnt(1)
v_cmp_gt_u32 vcc,s71,v16
s_add_u32 s60,s60,1
endN_291:
s_cbranch_vccnz nb_288
s_mov_b32 m0,s70
s_nop 0
buffer_load_dwordx4 v3,s[20:23],s61 offen offset:0 lds
buffer_load_dwordx4 v3,s[20:23],s61 offen offset:1024 lds
buffer_load_dwordx4 v3,s[20:23],s61 offen offset:2048 lds
buffer_load_dwordx4 v3,s[20:23],s61 offen offset:3072 lds
s_add_u32 m0,s70,4096
s_nop 0
buffer_load_dwordx4 v3,s[20:23],s62 offen offset:0 lds
buffer_load_dwordx4 v3,s[20:23],s62 offen offset:1024 lds
buffer_load_dwordx4 v3,s[20:23],s62 offen offset:2048 lds
buffer_load_dwordx4 v3,s[20:23],s62 offen offset:3072 lds
s_add_u32 s61,s61,32768
s_add_u32 s62,s62,32768
s_add_u32 s70,s70,32768
s_and_b32 s70,s70,0x1ffff
s_mov_b32 s57,s63
v_pk_fma_f32 v[40:41],v[152:153],v[188:189],v[40:41] op_sel_hi:[1,0,1]
v_pk_fma_f32 v[42:43],v[154:155],v[188:189],v[42:43] op_sel_hi:[1,0,1]
v_pk_fma_f32 v[44:45],v[156:157],v[188:189],v[44:45] op_sel_hi:[1,0,1]
v_pk_fma_f32 v[46:47],v[158:159],v[188:189],v[46:47] op_sel_hi:[1,0,1]
v_pk_mul_f32 v[168:169],v[40:41],v[40:41]
v_pk_mul_f32 v[170:171],v[42:43],v[42:43]
v_pk_mul_f32 v[172:173],v[44:45],v[44:45]
v_pk_mul_f32 v[174:175],v[46:47],v[46:47]
v_pk_fma_f32 v[168:169],v[168:169],v[190:191],v[190:191] op_sel:[0,1,0] op_sel_hi:[1,1,0]
v_pk_fma_f32 v[170:171],v[170:171],v[190:191],v[190:191] op_sel:[0,1,0] op_sel_hi:[1,1,0]
v_pk_fma_f32 v[172:173],v[172:173],v[190:191],v[190:191] op_sel:[0,1,0] op_sel_hi:[1,1,0]
v_pk_fma_f32 v[174:175],v[174:175],v[190:191],v[190:191] op_sel:[0,1,0] op_sel_hi:[1,1,0]
v_pk_mul_f32 v[168:169],v[168:169],v[40:41]
v_pk_mul_f32 v[170:171],v[170:171],v[42:43]
v_pk_mul_f32 v[172:173],v[172:173],v[44:45]
v_pk_mul_f32 v[174:175],v[174:175],v[46:47]
v_exp_f32 v168,v168
v_exp_f32 v169,v169
v_exp_f32 v170,v170
v_exp_f32 v171,v171
v_exp_f32 v172,v172
v_exp_f32 v173,v173
v_exp_f32 v174,v174
v_exp_f32 v175,v175
v_pk_fma_f32 v[168:169],v[168:169],v[188:189],v[188:189] op_sel:[0,1,1] op_sel_hi:[1,1,1]
v_pk_fma_f32 v[170:171],v[170:171],v[188:189],v[188:189] op_sel:[0,1,1] op_sel_hi:[1,1,1]
v_pk_fma_f32 v[172:173],v[172:173],v[188:189],v[188:189] op_sel:[0,1,1] op_sel_hi:[1,1,1]
v_pk_fma_f32 v[174:175],v[174:175],v[188:189],v[188:189] op_sel:[0,1,1] op_sel_hi:[1,1,1]
v_rcp_f32 v168,v168
v_rcp_f32 v169,v169
v_rcp_f32 v170,v170
v_rcp_f32 v171,v171
v_rcp_f32 v172,v172
v_rcp_f32 v173,v173
v_rcp_f32 v174,v174
v_rcp_f32 v175,v175
v_pk_mul_f32 v[40:41],v[168:169],v[40:41]
v_pk_mul_f32 v[42:43],v[170:171],v[42:43]
v_pk_mul_f32 v[44:45],v[172:173],v[44:45]
v_pk_mul_f32 v[46:47],v[174:175],v[46:47]
v_cvt_pk_bf16_f32 v176,v40,v41
v_cvt_pk_bf16_f32 v177,v42,v43
v_cvt_pk_bf16_f32 v178,v44,v45
v_cvt_pk_bf16_f32 v179,v46,v47
buffer_store_dwordx4 v[176:179],v0,s[20:23],s66 offen sc1
s_add_u32 s66,s66,114688
s_add_u32 s63,s63,1
s_waitcnt vmcnt(9)
v_mov_b32 v17,s57
buffer_store_dword v17,v26,s[20:23],s69 offen sc1
s_branch dec_287
nb_288:
buffer_load_dword v16,v2,s[20:23],s68 offen sc1
s_nop 3
s_mov_b32 s57,s63
v_pk_fma_f32 v[40:41],v[152:153],v[188:189],v[40:41] op_sel_hi:[1,0,1]
v_pk_fma_f32 v[42:43],v[154:155],v[188:189],v[42:43] op_sel_hi:[1,0,1]
v_pk_fma_f32 v[44:45],v[156:157],v[188:189],v[44:45] op_sel_hi:[1,0,1]
v_pk_fma_f32 v[46:47],v[158:159],v[188:189],v[46:47] op_sel_hi:[1,0,1]
v_pk_mul_f32 v[168:169],v[40:41],v[40:41]
v_pk_mul_f32 v[170:171],v[42:43],v[42:43]
v_pk_mul_f32 v[172:173],v[44:45],v[44:45]
v_pk_mul_f32 v[174:175],v[46:47],v[46:47]
v_pk_fma_f32 v[168:169],v[168:169],v[190:191],v[190:191] op_sel:[0,1,0] op_sel_hi:[1,1,0]
v_pk_fma_f32 v[170:171],v[170:171],v[190:191],v[190:191] op_sel:[0,1,0] op_sel_hi:[1,1,0]
v_pk_fma_f32 v[172:173],v[172:173],v[190:191],v[190:191] op_sel:[0,1,0] op_sel_hi:[1,1,0]
v_pk_fma_f32 v[174:175],v[174:175],v[190:191],v[190:191] op_sel:[0,1,0] op_sel_hi:[1,1,0]
v_pk_mul_f32 v[168:169],v[168:169],v[40:41]
v_pk_mul_f32 v[170:171],v[170:171],v[42:43]
v_pk_mul_f32 v[172:173],v[172:173],v[44:45]
v_pk_mul_f32 v[174:175],v[174:175],v[46:47]
v_exp_f32 v168,v168
v_exp_f32 v169,v169
v_exp_f32 v170,v170
v_exp_f32 v171,v171
v_exp_f32 v172,v172
v_exp_f32 v173,v173
v_exp_f32 v174,v174
v_exp_f32 v175,v175
v_pk_fma_f32 v[168:169],v[168:169],v[188:189],v[188:189] op_sel:[0,1,1] op_sel_hi:[1,1,1]
v_pk_fma_f32 v[170:171],v[170:171],v[188:189],v[188:189] op_sel:[0,1,1] op_sel_hi:[1,1,1]
v_pk_fma_f32 v[172:173],v[172:173],v[188:189],v[188:189] op_sel:[0,1,1] op_sel_hi:[1,1,1]
v_pk_fma_f32 v[174:175],v[174:175],v[188:189],v[188:189] op_sel:[0,1,1] op_sel_hi:[1,1,1]
v_rcp_f32 v168,v168
v_rcp_f32 v169,v169
v_rcp_f32 v170,v170
v_rcp_f32 v171,v171
v_rcp_f32 v172,v172
v_rcp_f32 v173,v173
v_rcp_f32 v174,v174
v_rcp_f32 v175,v175
v_pk_mul_f32 v[40:41],v[168:169],v[40:41]
v_pk_mul_f32 v[42:43],v[170:171],v[42:43]
v_pk_mul_f32 v[44:45],v[172:173],v[44:45]
v_pk_mul_f32 v[46:47],v[174:175],v[46:47]
v_cvt_pk_bf16_f32 v176,v40,v41
v_cvt_pk_bf16_f32 v177,v42,v43
v_cvt_pk_bf16_f32 v178,v44,v45
v_cvt_pk_bf16_f32 v179,v46,v47
buffer_store_dwordx4 v[176:179],v0,s[20:23],s66 offen sc1
s_add_u32 s66,s66,114688
s_add_u32 s63,s63,1
s_waitcnt vmcnt(2)
v_mov_b32 v17,s57
buffer_store_dword v17,v26,s[20:23],s69 offen sc1
s_waitcnt vmcnt(2)
v_cmp_gt_u32 vcc,s71,v16
s_cbranch_vccz lag_286
s_waitcnt vmcnt(1)
v_mov_b32 v17,s63
buffer_store_dword v17,v26,s[20:23],s69 offen sc1
s_cmp_ge_u32 s60,128
s_cbranch_scc1 done_275
plp_292:
buffer_load_dword v16,v2,s[20:23],s68 offen sc1
s_waitcnt vmcnt(0)
v_cmp_gt_u32 vcc,s71,v16
s_cbranch_vccz pok_293
s_sleep 4
s_sub_u32 s90,s90,1
s_cmp_gt_i32 s90,0
s_cbranch_scc1 plp_292
pok_293:
s_branch lag_286
done_275:
s_endpgm
fl_w1:
v_and_b32 v21,15,v1
v_lshrrev_b32 v22,4,v1
v_lshrrev_b32 v23,2,v21
v_and_b32 v24,3,v21
s_lshl_b32 s61,s50,15
v_lshl_add_u32 v25,v22,3,v23
s_load_dwordx2 s[4:5],s[0:1],64
s_mov_b32 s52,0
s_mov_b32 s53,s59
s_mul_i32 s54,s52,2097152
s_lshl_b32 s64,s53,8
s_add_u32 s54,s54,s64
s_lshl_b32 s64,s50,6
s_add_u32 s54,s54,s64
s_waitcnt lgkmcnt(0)
s_mov_b32 s28,s4
s_and_b32 s29,s5,0xffff
s_mov_b32 s30,0x200000
s_mov_b32 s31,0x20000
v_lshrrev_b32 v26,2,v1
v_and_b32 v27,3,v1
v_mul_u32_u24 v16,2048,v26
v_lshl_add_u32 v16,v27,4,v16
v_lshlrev_b32 v17,6,v25
v_lshl_add_u32 v17,v24,4,v17
v_add_u32 v17,s61,v17
s_xor_b32 s62,s50,0
s_mul_i32 s62,s62,524288
s_add_u32 s62,s62,s54
s_add_u32 m0,s61,0
s_nop 0
buffer_load_dwordx4 v16,s[28:31],s62 offen lds
s_add_u32 s62,s62,32768
s_add_u32 m0,m0,1024
s_waitcnt vmcnt(6)
buffer_load_dwordx4 v16,s[28:31],s62 offen lds
s_add_u32 s62,s62,32768
s_add_u32 m0,m0,1024
s_waitcnt vmcnt(6)
buffer_load_dwordx4 v16,s[28:31],s62 offen lds
s_add_u32 s62,s62,32768
s_add_u32 m0,m0,1024
s_waitcnt vmcnt(6)
buffer_load_dwordx4 v16,s[28:31],s62 offen lds
s_add_u32 s62,s62,32768
s_add_u32 m0,m0,1024
s_waitcnt vmcnt(6)
buffer_load_dwordx4 v16,s[28:31],s62 offen lds
s_add_u32 s62,s62,32768
s_add_u32 m0,m0,1024
s_waitcnt vmcnt(6)
buffer_load_dwordx4 v16,s[28:31],s62 offen lds
s_add_u32 s62,s62,32768
s_add_u32 m0,m0,1024
s_waitcnt vmcnt(6)
buffer_load_dwordx4 v16,s[28:31],s62 offen lds
s_add_u32 s62,s62,32768
s_add_u32 m0,m0,1024
s_waitcnt vmcnt(6)
buffer_load_dwordx4 v16,s[28:31],s62 offen lds
s_add_u32 s62,s62,32768
s_add_u32 m0,m0,1024
s_waitcnt vmcnt(6)
buffer_load_dwordx4 v16,s[28:31],s62 offen lds
s_add_u32 s62,s62,32768
s_add_u32 m0,m0,1024
s_waitcnt vmcnt(6)
buffer_load_dwordx4 v16,s[28:31],s62 offen lds
s_add_u32 s62,s62,32768
s_add_u32 m0,m0,1024
s_waitcnt vmcnt(6)
buffer_load_dwordx4 v16,s[28:31],s62 offen lds
s_add_u32 s62,s62,32768
s_add_u32 m0,m0,1024
s_waitcnt vmcnt(6)
buffer_load_dwordx4 v16,s[28:31],s62 offen lds
s_add_u32 s62,s62,32768
s_add_u32 m0,m0,1024
s_waitcnt vmcnt(6)
buffer_load_dwordx4 v16,s[28:31],s62 offen lds
s_add_u32 s62,s62,32768
s_add_u32 m0,m0,1024
s_waitcnt vmcnt(6)
buffer_load_dwordx4 v16,s[28:31],s62 offen lds
s_add_u32 s62,s62,32768
s_add_u32 m0,m0,1024
s_waitcnt vmcnt(6)
buffer_load_dwordx4 v16,s[28:31],s62 offen lds
s_add_u32 s62,s62,32768
s_add_u32 m0,m0,1024
s_waitcnt vmcnt(6)
buffer_load_dwordx4 v16,s[28:31],s62 offen lds
s_waitcnt vmcnt(6)
s_xor_b32 s62,s50,1
s_mul_i32 s62,s62,524288
s_add_u32 s62,s62,s54
s_add_u32 m0,s61,16384
s_nop 0
buffer_load_dwordx4 v16,s[28:31],s62 offen lds
s_add_u32 s62,s62,32768
s_add_u32 m0,m0,1024
s_waitcnt vmcnt(6)
buffer_load_dwordx4 v16,s[28:31],s62 offen lds
s_add_u32 s62,s62,32768
s_add_u32 m0,m0,1024
s_waitcnt vmcnt(6)
buffer_load_dwordx4 v16,s[28:31],s62 offen lds
s_add_u32 s62,s62,32768
s_add_u32 m0,m0,1024
s_waitcnt vmcnt(6)
buffer_load_dwordx4 v16,s[28:31],s62 offen lds
s_add_u32 s62,s62,32768
s_add_u32 m0,m0,1024
s_waitcnt vmcnt(6)
buffer_load_dwordx4 v16,s[28:31],s62 offen lds
s_add_u32 s62,s62,32768
s_add_u32 m0,m0,1024
s_waitcnt vmcnt(6)
buffer_load_dwordx4 v16,s[28:31],s62 offen lds
s_add_u32 s62,s62,32768
s_add_u32 m0,m0,1024
s_waitcnt vmcnt(6)
buffer_load_dwordx4 v16,s[28:31],s62 offen lds
s_add_u32 s62,s62,32768
s_add_u32 m0,m0,1024
s_waitcnt vmcnt(6)
buffer_load_dwordx4 v16,s[28:31],s62 offen lds
s_add_u32 s62,s62,32768
s_add_u32 m0,m0,1024
s_waitcnt vmcnt(6)
buffer_load_dwordx4 v16,s[28:31],s62 offen lds
s_add_u32 s62,s62,32768
s_add_u32 m0,m0,1024
s_waitcnt vmcnt(6)
buffer_load_dwordx4 v16,s[28:31],s62 offen lds
s_add_u32 s62,s62,32768
s_add_u32 m0,m0,1024
s_waitcnt vmcnt(6)
buffer_load_dwordx4 v16,s[28:31],s62 offen lds
s_add_u32 s62,s62,32768
s_add_u32 m0,m0,1024
s_waitcnt vmcnt(6)
buffer_load_dwordx4 v16,s[28:31],s62 offen lds
s_add_u32 s62,s62,32768
s_add_u32 m0,m0,1024
s_waitcnt vmcnt(6)
buffer_load_dwordx4 v16,s[28:31],s62 offen lds
s_add_u32 s62,s62,32768
s_add_u32 m0,m0,1024
s_waitcnt vmcnt(6)
buffer_load_dwordx4 v16,s[28:31],s62 offen lds
s_add_u32 s62,s62,32768
s_add_u32 m0,m0,1024
s_waitcnt vmcnt(6)
buffer_load_dwordx4 v16,s[28:31],s62 offen lds
s_add_u32 s62,s62,32768
s_add_u32 m0,m0,1024
s_waitcnt vmcnt(6)
buffer_load_dwordx4 v16,s[28:31],s62 offen lds
s_waitcnt vmcnt(6)
s_waitcnt vmcnt(16)
ds_read_b64_tr_b16 a[0:1],v17 offset:0
ds_read_b64_tr_b16 a[2:3],v17 offset:256
ds_read_b64_tr_b16 a[4:5],v17 offset:8
ds_read_b64_tr_b16 a[6:7],v17 offset:264
ds_read_b64_tr_b16 a[8:9],v17 offset:2048
ds_read_b64_tr_b16 a[10:11],v17 offset:2304
ds_read_b64_tr_b16 a[12:13],v17 offset:2056
ds_read_b64_tr_b16 a[14:15],v17 offset:2312
ds_read_b64_tr_b16 a[16:17],v17 offset:4096
ds_read_b64_tr_b16 a[18:19],v17 offset:4352
ds_read_b64_tr_b16 a[20:21],v17 offset:4104
ds_read_b64_tr_b16 a[22:23],v17 offset:4360
s_waitcnt lgkmcnt(0)
ds_read_b64_tr_b16 a[24:25],v17 offset:6144
ds_read_b64_tr_b16 a[26:27],v17 offset:6400
ds_read_b64_tr_b16 a[28:29],v17 offset:6152
ds_read_b64_tr_b16 a[30:31],v17 offset:6408
ds_read_b64_tr_b16 a[32:33],v17 offset:8192
ds_read_b64_tr_b16 a[34:35],v17 offset:8448
ds_read_b64_tr_b16 a[36:37],v17 offset:8200
ds_read_b64_tr_b16 a[38:39],v17 offset:8456
ds_read_b64_tr_b16 a[40:41],v17 offset:10240
ds_read_b64_tr_b16 a[42:43],v17 offset:10496
ds_read_b64_tr_b16 a[44:45],v17 offset:10248
ds_read_b64_tr_b16 a[46:47],v17 offset:10504
s_waitcnt lgkmcnt(0)
ds_read_b64_tr_b16 a[48:49],v17 offset:12288
ds_read_b64_tr_b16 a[50:51],v17 offset:12544
ds_read_b64_tr_b16 a[52:53],v17 offset:12296
ds_read_b64_tr_b16 a[54:55],v17 offset:12552
ds_read_b64_tr_b16 a[56:57],v17 offset:14336
ds_read_b64_tr_b16 a[58:59],v17 offset:14592
ds_read_b64_tr_b16 a[60:61],v17 offset:14344
ds_read_b64_tr_b16 a[62:63],v17 offset:14600
s_waitcnt lgkmcnt(0)
s_xor_b32 s62,s50,2
s_mul_i32 s62,s62,524288
s_add_u32 s62,s62,s54
s_add_u32 m0,s61,0
s_nop 0
buffer_load_dwordx4 v16,s[28:31],s62 offen lds
s_add_u32 s62,s62,32768
s_add_u32 m0,m0,1024
s_waitcnt vmcnt(6)
buffer_load_dwordx4 v16,s[28:31],s62 offen lds
s_add_u32 s62,s62,32768
s_add_u32 m0,m0,1024
s_waitcnt vmcnt(6)
buffer_load_dwordx4 v16,s[28:31],s62 offen lds
s_add_u32 s62,s62,32768
s_add_u32 m0,m0,1024
s_waitcnt vmcnt(6)
buffer_load_dwordx4 v16,s[28:31],s62 offen lds
s_add_u32 s62,s62,32768
s_add_u32 m0,m0,1024
s_waitcnt vmcnt(6)
buffer_load_dwordx4 v16,s[28:31],s62 offen lds
s_add_u32 s62,s62,32768
s_add_u32 m0,m0,1024
s_waitcnt vmcnt(6)
buffer_load_dwordx4 v16,s[28:31],s62 offen lds
s_add_u32 s62,s62,32768
s_add_u32 m0,m0,1024
s_waitcnt vmcnt(6)
buffer_load_dwordx4 v16,s[28:31],s62 offen lds
s_add_u32 s62,s62,32768
s_add_u32 m0,m0,1024
s_waitcnt vmcnt(6)
buffer_load_dwordx4 v16,s[28:31],s62 offen lds
s_add_u32 s62,s62,32768
s_add_u32 m0,m0,1024
s_waitcnt vmcnt(6)
buffer_load_dwordx4 v16,s[28:31],s62 offen lds
s_add_u32 s62,s62,32768
s_add_u32 m0,m0,1024
s_waitcnt vmcnt(6)
buffer_load_dwordx4 v16,s[28:31],s62 offen lds
s_add_u32 s62,s62,32768
s_add_u32 m0,m0,1024
s_waitcnt vmcnt(6)
buffer_load_dwordx4 v16,s[28:31],s62 offen lds
s_add_u32 s62,s62,32768
s_add_u32 m0,m0,1024
s_waitcnt vmcnt(6)
buffer_load_dwordx4 v16,s[28:31],s62 offen lds
s_add_u32 s62,s62,32768
s_add_u32 m0,m0,1024
s_waitcnt vmcnt(6)
buffer_load_dwordx4 v16,s[28:31],s62 offen lds
s_add_u32 s62,s62,32768
s_add_u32 m0,m0,1024
s_waitcnt vmcnt(6)
buffer_load_dwordx4 v16,s[28:31],s62 offen lds
s_add_u32 s62,s62,32768
s_add_u32 m0,m0,1024
s_waitcnt vmcnt(6)
buffer_load_dwordx4 v16,s[28:31],s62 offen lds
s_add_u32 s62,s62,32768
s_add_u32 m0,m0,1024
s_waitcnt vmcnt(6)
buffer_load_dwordx4 v16,s[28:31],s62 offen lds
s_waitcnt vmcnt(6)
s_waitcnt vmcnt(16)
ds_read_b64_tr_b16 a[64:65],v17 offset:16384
ds_read_b64_tr_b16 a[66:67],v17 offset:16640
ds_read_b64_tr_b16 a[68:69],v17 offset:16392
ds_read_b64_tr_b16 a[70:71],v17 offset:16648
ds_read_b64_tr_b16 a[72:73],v17 offset:18432
ds_read_b64_tr_b16 a[74:75],v17 offset:18688
ds_read_b64_tr_b16 a[76:77],v17 offset:18440
ds_read_b64_tr_b16 a[78:79],v17 offset:18696
ds_read_b64_tr_b16 a[80:81],v17 offset:20480
ds_read_b64_tr_b16 a[82:83],v17 offset:20736
ds_read_b64_tr_b16 a[84:85],v17 offset:20488
ds_read_b64_tr_b16 a[86:87],v17 offset:20744
s_waitcnt lgkmcnt(0)
ds_read_b64_tr_b16 a[88:89],v17 offset:22528
ds_read_b64_tr_b16 a[90:91],v17 offset:22784
ds_read_b64_tr_b16 a[92:93],v17 offset:22536
ds_read_b64_tr_b16 a[94:95],v17 offset:22792
ds_read_b64_tr_b16 a[96:97],v17 offset:24576
ds_read_b64_tr_b16 a[98:99],v17 offset:24832
ds_read_b64_tr_b16 a[100:101],v17 offset:24584
ds_read_b64_tr_b16 a[102:103],v17 offset:24840
ds_read_b64_tr_b16 a[104:105],v17 offset:26624
ds_read_b64_tr_b16 a[106:107],v17 offset:26880
ds_read_b64_tr_b16 a[108:109],v17 offset:26632
ds_read_b64_tr_b16 a[110:111],v17 offset:26888
s_waitcnt lgkmcnt(0)
ds_read_b64_tr_b16 a[112:113],v17 offset:28672
ds_read_b64_tr_b16 a[114:115],v17 offset:28928
ds_read_b64_tr_b16 a[116:117],v17 offset:28680
ds_read_b64_tr_b16 a[118:119],v17 offset:28936
ds_read_b64_tr_b16 a[120:121],v17 offset:30720
ds_read_b64_tr_b16 a[122:123],v17 offset:30976
ds_read_b64_tr_b16 a[124:125],v17 offset:30728
ds_read_b64_tr_b16 a[126:127],v17 offset:30984
s_waitcnt lgkmcnt(0)
s_xor_b32 s62,s50,3
s_mul_i32 s62,s62,524288
s_add_u32 s62,s62,s54
s_add_u32 m0,s61,16384
s_nop 0
buffer_load_dwordx4 v16,s[28:31],s62 offen lds
s_add_u32 s62,s62,32768
s_add_u32 m0,m0,1024
s_waitcnt vmcnt(6)
buffer_load_dwordx4 v16,s[28:31],s62 offen lds
s_add_u32 s62,s62,32768
s_add_u32 m0,m0,1024
s_waitcnt vmcnt(6)
buffer_load_dwordx4 v16,s[28:31],s62 offen lds
s_add_u32 s62,s62,32768
s_add_u32 m0,m0,1024
s_waitcnt vmcnt(6)
buffer_load_dwordx4 v16,s[28:31],s62 offen lds
s_add_u32 s62,s62,32768
s_add_u32 m0,m0,1024
s_waitcnt vmcnt(6)
buffer_load_dwordx4 v16,s[28:31],s62 offen lds
s_add_u32 s62,s62,32768
s_add_u32 m0,m0,1024
s_waitcnt vmcnt(6)
buffer_load_dwordx4 v16,s[28:31],s62 offen lds
s_add_u32 s62,s62,32768
s_add_u32 m0,m0,1024
s_waitcnt vmcnt(6)
buffer_load_dwordx4 v16,s[28:31],s62 offen lds
s_add_u32 s62,s62,32768
s_add_u32 m0,m0,1024
s_waitcnt vmcnt(6)
buffer_load_dwordx4 v16,s[28:31],s62 offen lds
s_add_u32 s62,s62,32768
s_add_u32 m0,m0,1024
s_waitcnt vmcnt(6)
buffer_load_dwordx4 v16,s[28:31],s62 offen lds
s_add_u32 s62,s62,32768
s_add_u32 m0,m0,1024
s_waitcnt vmcnt(6)
buffer_load_dwordx4 v16,s[28:31],s62 offen lds
s_add_u32 s62,s62,32768
s_add_u32 m0,m0,1024
s_waitcnt vmcnt(6)
buffer_load_dwordx4 v16,s[28:31],s62 offen lds
s_add_u32 s62,s62,32768
s_add_u32 m0,m0,1024
s_waitcnt vmcnt(6)
buffer_load_dwordx4 v16,s[28:31],s62 offen lds
s_add_u32 s62,s62,32768
s_add_u32 m0,m0,1024
s_waitcnt vmcnt(6)
buffer_load_dwordx4 v16,s[28:31],s62 offen lds
s_add_u32 s62,s62,32768
s_add_u32 m0,m0,1024
s_waitcnt vmcnt(6)
buffer_load_dwordx4 v16,s[28:31],s62 offen lds
s_add_u32 s62,s62,32768
s_add_u32 m0,m0,1024
s_waitcnt vmcnt(6)
buffer_load_dwordx4 v16,s[28:31],s62 offen lds
s_add_u32 s62,s62,32768
s_add_u32 m0,m0,1024
s_waitcnt vmcnt(6)
buffer_load_dwordx4 v16,s[28:31],s62 offen lds
s_waitcnt vmcnt(6)
s_waitcnt vmcnt(16)
ds_read_b64_tr_b16 a[128:129],v17 offset:0
ds_read_b64_tr_b16 a[130:131],v17 offset:256
ds_read_b64_tr_b16 a[132:133],v17 offset:8
ds_read_b64_tr_b16 a[134:135],v17 offset:264
ds_read_b64_tr_b16 a[136:137],v17 offset:2048
ds_read_b64_tr_b16 a[138:139],v17 offset:2304
ds_read_b64_tr_b16 a[140:141],v17 offset:2056
ds_read_b64_tr_b16 a[142:143],v17 offset:2312
ds_read_b64_tr_b16 a[144:145],v17 offset:4096
ds_read_b64_tr_b16 a[146:147],v17 offset:4352
ds_read_b64_tr_b16 a[148:149],v17 offset:4104
ds_read_b64_tr_b16 a[150:151],v17 offset:4360
s_waitcnt lgkmcnt(0)
ds_read_b64_tr_b16 a[152:153],v17 offset:6144
ds_read_b64_tr_b16 a[154:155],v17 offset:6400
ds_read_b64_tr_b16 a[156:157],v17 offset:6152
ds_read_b64_tr_b16 a[158:159],v17 offset:6408
ds_read_b64_tr_b16 a[160:161],v17 offset:8192
ds_read_b64_tr_b16 a[162:163],v17 offset:8448
ds_read_b64_tr_b16 a[164:165],v17 offset:8200
ds_read_b64_tr_b16 a[166:167],v17 offset:8456
ds_read_b64_tr_b16 a[168:169],v17 offset:10240
ds_read_b64_tr_b16 a[170:171],v17 offset:10496
ds_read_b64_tr_b16 a[172:173],v17 offset:10248
ds_read_b64_tr_b16 a[174:175],v17 offset:10504
s_waitcnt lgkmcnt(0)
ds_read_b64_tr_b16 a[176:177],v17 offset:12288
ds_read_b64_tr_b16 a[178:179],v17 offset:12544
ds_read_b64_tr_b16 a[180:181],v17 offset:12296
ds_read_b64_tr_b16 a[182:183],v17 offset:12552
ds_read_b64_tr_b16 a[184:185],v17 offset:14336
ds_read_b64_tr_b16 a[186:187],v17 offset:14592
ds_read_b64_tr_b16 a[188:189],v17 offset:14344
ds_read_b64_tr_b16 a[190:191],v17 offset:14600
s_waitcnt lgkmcnt(0)
s_waitcnt vmcnt(0)
ds_read_b64_tr_b16 a[192:193],v17 offset:16384
ds_read_b64_tr_b16 a[194:195],v17 offset:16640
ds_read_b64_tr_b16 a[196:197],v17 offset:16392
ds_read_b64_tr_b16 a[198:199],v17 offset:16648
ds_read_b64_tr_b16 a[200:201],v17 offset:18432
ds_read_b64_tr_b16 a[202:203],v17 offset:18688
ds_read_b64_tr_b16 a[204:205],v17 offset:18440
ds_read_b64_tr_b16 a[206:207],v17 offset:18696
ds_read_b64_tr_b16 a[208:209],v17 offset:20480
ds_read_b64_tr_b16 a[210:211],v17 offset:20736
ds_read_b64_tr_b16 a[212:213],v17 offset:20488
ds_read_b64_tr_b16 a[214:215],v17 offset:20744
s_waitcnt lgkmcnt(0)
ds_read_b64_tr_b16 a[216:217],v17 offset:22528
ds_read_b64_tr_b16 a[218:219],v17 offset:22784
ds_read_b64_tr_b16 a[220:221],v17 offset:22536
ds_read_b64_tr_b16 a[222:223],v17 offset:22792
ds_read_b64_tr_b16 a[224:225],v17 offset:24576
ds_read_b64_tr_b16 a[226:227],v17 offset:24832
ds_read_b64_tr_b16 a[228:229],v17 offset:24584
ds_read_b64_tr_b16 a[230:231],v17 offset:24840
ds_read_b64_tr_b16 a[232:233],v17 offset:26624
ds_read_b64_tr_b16 a[234:235],v17 offset:26880
ds_read_b64_tr_b16 a[236:237],v17 offset:26632
ds_read_b64_tr_b16 a[238:239],v17 offset:26888
s_waitcnt lgkmcnt(0)
ds_read_b64_tr_b16 a[240:241],v17 offset:28672
ds_read_b64_tr_b16 a[242:243],v17 offset:28928
ds_read_b64_tr_b16 a[244:245],v17 offset:28680
ds_read_b64_tr_b16 a[246:247],v17 offset:28936
ds_read_b64_tr_b16 a[248:249],v17 offset:30720
ds_read_b64_tr_b16 a[250:251],v17 offset:30976
ds_read_b64_tr_b16 a[252:253],v17 offset:30728
ds_read_b64_tr_b16 a[254:255],v17 offset:30984
s_waitcnt lgkmcnt(0)
s_mov_b32 s92,s2
s_and_b32 s93,s3,0xffff
s_mov_b32 s94,0x100
s_mov_b32 s95,0x20000
v_mbcnt_lo_u32_b32 v16,-1,0
v_mbcnt_hi_u32_b32 v16,-1,v16
v_mov_b32 v18,0
v_cmp_eq_u32 vcc,22,v16
s_nop 1
v_cndmask_b32 v18,v18,63,vcc
v_cmp_eq_u32 vcc,17,v16
s_nop 1
v_cndmask_b32 v18,v18,63,vcc
v_cmp_eq_u32 vcc,18,v16
s_nop 1
v_cndmask_b32 v18,v18,1,vcc
v_and_b32 v19,1,v16
v_cmp_eq_u32 vcc,1,v19
v_mov_b32 v19,8192
s_nop 0
v_cndmask_b32 v19,-1,v19,vcc
v_min_u32 v16,31,v16
v_lshlrev_b32 v16,2,v16
s_sub_u32 s66,s88,64
s_cmp_lg_u32 s50,0
s_cbranch_scc1 vot_299
vpoll_295:
buffer_load_dword v17,v16,s[92:95],s66 offen sc1
s_waitcnt vmcnt(0)
s_cmp_lg_u32 s56,2
s_cbranch_scc1 vck_296
v_cmp_eq_u32 vcc,v17,v19
s_and_b32 s64,vcc_lo,0xffff
s_cmp_eq_u32 s64,65535
s_cbranch_scc1 vck_296
s_mov_b32 s65,0
v_readlane_b32 s64,v17,1
s_lshr_b32 s64,s64,8
s_add_u32 s65,s65,s64
v_readlane_b32 s64,v17,3
s_lshr_b32 s64,s64,8
s_add_u32 s65,s65,s64
v_readlane_b32 s64,v17,5
s_lshr_b32 s64,s64,8
s_add_u32 s65,s65,s64
v_readlane_b32 s64,v17,7
s_lshr_b32 s64,s64,8
s_add_u32 s65,s65,s64
v_readlane_b32 s64,v17,9
s_lshr_b32 s64,s64,8
s_add_u32 s65,s65,s64
v_readlane_b32 s64,v17,11
s_lshr_b32 s64,s64,8
s_add_u32 s65,s65,s64
v_readlane_b32 s64,v17,13
s_lshr_b32 s64,s64,8
s_add_u32 s65,s65,s64
v_readlane_b32 s64,v17,15
s_lshr_b32 s64,s64,8
s_add_u32 s65,s65,s64
s_cmp_ge_u32 s65,256
s_cbranch_scc1 vok_298
s_branch vrt_297
vck_296:
v_cmp_gt_u32 vcc,v18,v17
s_cbranch_vccz vok_298
vrt_297:
s_sleep 48
s_sub_u32 s90,s90,1
s_cmp_gt_i32 s90,0
s_cbranch_scc1 vpoll_295
vok_298:
v_add_u32 v18,160512,v16
ds_write_b32 v18,v17
s_waitcnt lgkmcnt(0)
vot_299:
s_barrier
v_add_u32 v18,160512,v16
ds_read_b32 v17,v18
s_waitcnt lgkmcnt(0)
s_cmp_lg_u32 s56,2
s_cbranch_scc1 vfin_300
v_cmp_eq_u32 vcc,v17,v19
s_and_b32 s64,vcc_lo,0xffff
s_cmp_eq_u32 s64,65535
s_cbranch_scc1 vfin_300
s_mov_b32 s65,0
v_readlane_b32 s64,v17,1
s_lshr_b32 s64,s64,8
s_add_u32 s65,s65,s64
v_readlane_b32 s64,v17,3
s_lshr_b32 s64,s64,8
s_add_u32 s65,s65,s64
v_readlane_b32 s64,v17,5
s_lshr_b32 s64,s64,8
s_add_u32 s65,s65,s64
v_readlane_b32 s64,v17,7
s_lshr_b32 s64,s64,8
s_add_u32 s65,s65,s64
v_readlane_b32 s64,v17,9
s_lshr_b32 s64,s64,8
s_add_u32 s65,s65,s64
v_readlane_b32 s64,v17,11
s_lshr_b32 s64,s64,8
s_add_u32 s65,s65,s64
v_readlane_b32 s64,v17,13
s_lshr_b32 s64,s64,8
s_add_u32 s65,s65,s64
v_readlane_b32 s64,v17,15
s_lshr_b32 s64,s64,8
s_add_u32 s65,s65,s64
s_cmp_ge_u32 s65,256
s_cbranch_scc1 fl_fb
vfin_300:
s_and_b32 s56,s56,1
s_mov_b32 s67,0
s_barrier
v_lshlrev_b32 v0,4,v1
s_mov_b32 s60,0
s_lshl_b32 s70,s50,13
s_mov_b32 s55,0
v_mov_b32 v3,v0
s_mov_b32 s73,0xffff0000
s_lshl_b32 s64,s52,2
s_add_u32 s64,s64,s50
s_mul_i32 s61,s64,8192
s_add_u32 s61,s61,205520896
s_lshl_b32 s68,s64,8
s_add_u32 s68,s68,138548224
s_lshl_b32 s83,s53,2
s_add_u32 s83,s83,s50
s_mov_b32 s63,0
s_xor_b32 s64,s50,0
s_lshl_b32 s64,s64,13
v_add_u32 v8,s64,v0
v_mov_b32 v4,v8
s_xor_b32 s64,s50,1
s_lshl_b32 s64,s64,13
v_add_u32 v9,s64,v0
v_mov_b32 v5,v9
s_xor_b32 s64,s50,2
s_lshl_b32 s64,s64,13
v_add_u32 v10,s64,v0
v_mov_b32 v6,v10
s_xor_b32 s64,s50,3
s_lshl_b32 s64,s64,13
v_add_u32 v11,s64,v0
v_mov_b32 v7,v11
v_min_u32 v2,3,v1
v_lshlrev_b32 v2,7,v2
s_mul_i32 s68,s50,512
s_add_u32 s68,s68,138567680
s_add_u32 s62,s61,4096
s_lshl_b32 s66,s83,10
s_lshr_b32 s65,s83,3
s_lshl_b32 s65,s65,8
s_and_b32 s64,s83,7
s_lshl_b32 s64,s64,2
s_add_u32 s69,s64,s65
s_add_u32 s69,s69,138549248
s_lshl_b32 s69,s83,7
s_add_u32 s69,s69,138559488
s_add_u32 s82,s66,201326592
s_add_u32 s66,s66,209747968
s_lshl_b32 s64,s50,9
s_add_u32 s64,s64,131072
v_lshlrev_b32 v26,3,v1
v_add_u32 v19,s64,v26
v_lshl_add_u32 v26,v23,4,v21
v_lshlrev_b32 v26,3,v26
v_add_u32 v20,131072,v26
s_mov_b32 s74,0x22222222
s_mov_b32 s75,0x22222222
s_mov_b32 s76,0x44444444
s_mov_b32 s77,0x44444444
s_mov_b32 s78,0x88888888
s_mov_b32 s79,0x88888888
v_mov_b32 v208,0xbdd2d3e8
v_mov_b32 v209,0xc0135761
v_mov_b32 v210,0x3727c5ac
v_mov_b32 v211,0x3a800000
v_mov_b32 v12,0x3f803f80
v_mov_b32 v13,0x3f803f80
v_mov_b32 v14,0x3f803f80
v_mov_b32 v15,0x3f803f80
s_nop 1
v_mfma_f32_16x16x32_bf16 v[152:155],a[0:3],v[12:15],0
v_mfma_f32_16x16x32_bf16 v[156:159],a[4:7],v[12:15],0
v_mfma_f32_16x16x32_bf16 v[152:155],a[8:11],v[12:15],v[152:155]
v_mfma_f32_16x16x32_bf16 v[156:159],a[12:15],v[12:15],v[156:159]
v_mfma_f32_16x16x32_bf16 v[152:155],a[16:19],v[12:15],v[152:155]
v_mfma_f32_16x16x32_bf16 v[156:159],a[20:23],v[12:15],v[156:159]
v_mfma_f32_16x16x32_bf16 v[152:155],a[24:27],v[12:15],v[152:155]
v_mfma_f32_16x16x32_bf16 v[156:159],a[28:31],v[12:15],v[156:159]
v_mfma_f32_16x16x32_bf16 v[152:155],a[32:35],v[12:15],v[152:155]
v_mfma_f32_16x16x32_bf16 v[156:159],a[36:39],v[12:15],v[156:159]
v_mfma_f32_16x16x32_bf16 v[152:155],a[40:43],v[12:15],v[152:155]
v_mfma_f32_16x16x32_bf16 v[156:159],a[44:47],v[12:15],v[156:159]
v_mfma_f32_16x16x32_bf16 v[152:155],a[48:51],v[12:15],v[152:155]
v_mfma_f32_16x16x32_bf16 v[156:159],a[52:55],v[12:15],v[156:159]
v_mfma_f32_16x16x32_bf16 v[152:155],a[56:59],v[12:15],v[152:155]
v_mfma_f32_16x16x32_bf16 v[156:159],a[60:63],v[12:15],v[156:159]
v_mfma_f32_16x16x32_bf16 v[152:155],a[64:67],v[12:15],v[152:155]
v_mfma_f32_16x16x32_bf16 v[156:159],a[68:71],v[12:15],v[156:159]
v_mfma_f32_16x16x32_bf16 v[152:155],a[72:75],v[12:15],v[152:155]
v_mfma_f32_16x16x32_bf16 v[156:159],a[76:79],v[12:15],v[156:159]
v_mfma_f32_16x16x32_bf16 v[152:155],a[80:83],v[12:15],v[152:155]
v_mfma_f32_16x16x32_bf16 v[156:159],a[84:87],v[12:15],v[156:159]
v_mfma_f32_16x16x32_bf16 v[152:155],a[88:91],v[12:15],v[152:155]
v_mfma_f32_16x16x32_bf16 v[156:159],a[92:95],v[12:15],v[156:159]
v_mfma_f32_16x16x32_bf16 v[152:155],a[96:99],v[12:15],v[152:155]
v_mfma_f32_16x16x32_bf16 v[156:159],a[100:103],v[12:15],v[156:159]
v_mfma_f32_16x16x32_bf16 v[152:155],a[104:107],v[12:15],v[152:155]
v_mfma_f32_16x16x32_bf16 v[156:159],a[108:111],v[12:15],v[156:159]
v_mfma_f32_16x16x32_bf16 v[152:155],a[112:115],v[12:15],v[152:155]
v_mfma_f32_16x16x32_bf16 v[156:159],a[116:119],v[12:15],v[156:159]
v_mfma_f32_16x16x32_bf16 v[152:155],a[120:123],v[12:15],v[152:155]
v_mfma_f32_16x16x32_bf16 v[156:159],a[124:127],v[12:15],v[156:159]
v_mfma_f32_16x16x32_bf16 v[152:155],a[128:131],v[12:15],v[152:155]
v_mfma_f32_16x16x32_bf16 v[156:159],a[132:135],v[12:15],v[156:159]
v_mfma_f32_16x16x32_bf16 v[152:155],a[136:139],v[12:15],v[152:155]
v_mfma_f32_16x16x32_bf16 v[156:159],a[140:143],v[12:15],v[156:159]
v_mfma_f32_16x16x32_bf16 v[152:155],a[144:147],v[12:15],v[152:155]
v_mfma_f32_16x16x32_bf16 v[156:159],a[148:151],v[12:15],v[156:159]
v_mfma_f32_16x16x32_bf16 v[152:155],a[152:155],v[12:15],v[152:155]
v_mfma_f32_16x16x32_bf16 v[156:159],a[156:159],v[12:15],v[156:159]
v_mfma_f32_16x16x32_bf16 v[152:155],a[160:163],v[12:15],v[152:155]
v_mfma_f32_16x16x32_bf16 v[156:159],a[164:167],v[12:15],v[156:159]
v_mfma_f32_16x16x32_bf16 v[152:155],a[168:171],v[12:15],v[152:155]
v_mfma_f32_16x16x32_bf16 v[156:159],a[172:175],v[12:15],v[156:159]
v_mfma_f32_16x16x32_bf16 v[152:155],a[176:179],v[12:15],v[152:155]
v_mfma_f32_16x16x32_bf16 v[156:159],a[180:183],v[12:15],v[156:159]
v_mfma_f32_16x16x32_bf16 v[152:155],a[184:187],v[12:15],v[152:155]
v_mfma_f32_16x16x32_bf16 v[156:159],a[188:191],v[12:15],v[156:159]
v_mfma_f32_16x16x32_bf16 v[152:155],a[192:195],v[12:15],v[152:155]
v_mfma_f32_16x16x32_bf16 v[156:159],a[196:199],v[12:15],v[156:159]
v_mfma_f32_16x16x32_bf16 v[152:155],a[200:203],v[12:15],v[152:155]
v_mfma_f32_16x16x32_bf16 v[156:159],a[204:207],v[12:15],v[156:159]
v_mfma_f32_16x16x32_bf16 v[152:155],a[208:211],v[12:15],v[152:155]
v_mfma_f32_16x16x32_bf16 v[156:159],a[212:215],v[12:15],v[156:159]
v_mfma_f32_16x16x32_bf16 v[152:155],a[216:219],v[12:15],v[152:155]
v_mfma_f32_16x16x32_bf16 v[156:159],a[220:223],v[12:15],v[156:159]
v_mfma_f32_16x16x32_bf16 v[152:155],a[224:227],v[12:15],v[152:155]
v_mfma_f32_16x16x32_bf16 v[156:159],a[228:231],v[12:15],v[156:159]
v_mfma_f32_16x16x32_bf16 v[152:155],a[232:235],v[12:15],v[152:155]
v_mfma_f32_16x16x32_bf16 v[156:159],a[236:239],v[12:15],v[156:159]
v_mfma_f32_16x16x32_bf16 v[152:155],a[240:243],v[12:15],v[152:155]
v_mfma_f32_16x16x32_bf16 v[156:159],a[244:247],v[12:15],v[156:159]
v_mfma_f32_16x16x32_bf16 v[152:155],a[248:251],v[12:15],v[152:155]
v_mfma_f32_16x16x32_bf16 v[156:159],a[252:255],v[12:15],v[156:159]
v_lshlrev_b32 v26,2,v1
v_cmp_gt_u32 vcc,32,v1
s_nop 1
v_cndmask_b32 v26,2.0,v26,vcc
s_cmp_eq_u32 s56,1
s_cbranch_scc1 lfar_301
s_add_u32 s71,s60,1
s_add_u32 s53,s60,2
plp_309:
buffer_load_dword v16,v2,s[20:23],s68 offen sc1
s_waitcnt vmcnt(0)
v_cmp_gt_u32 vcc,s71,v16
s_cbranch_vccz pok_310
s_sleep 4
s_sub_u32 s90,s90,1
s_cmp_gt_i32 s90,0
s_cbranch_scc1 plp_309
pok_310:
lag_306:
s_mov_b32 m0,s70
s_nop 0
buffer_load_dwordx4 v3,s[20:23],s61 offen offset:0 lds
buffer_load_dwordx4 v3,s[20:23],s61 offen offset:1024 lds
buffer_load_dwordx4 v3,s[20:23],s61 offen offset:2048 lds
buffer_load_dwordx4 v3,s[20:23],s61 offen offset:3072 lds
s_add_u32 m0,s70,4096
s_nop 0
buffer_load_dwordx4 v3,s[20:23],s62 offen offset:0 lds
buffer_load_dwordx4 v3,s[20:23],s62 offen offset:1024 lds
buffer_load_dwordx4 v3,s[20:23],s62 offen offset:2048 lds
buffer_load_dwordx4 v3,s[20:23],s62 offen offset:3072 lds
s_add_u32 s61,s61,32768
s_add_u32 s62,s62,32768
s_add_u32 s70,s70,32768
s_and_b32 s70,s70,0x1ffff
buffer_load_dword v23,off,s[20:23],s66
buffer_load_dword v23,off,s[20:23],s66
dec_307:
v_cmp_gt_u32 vcc,s53,v16
s_cbranch_vccnz BN_305
BR_304:
s_waitcnt vmcnt(9)
ds_read_b128 v[64:67],v4 offset:0
s_waitcnt vmcnt(8)
ds_read_b128 v[68:71],v4 offset:1024
s_waitcnt vmcnt(7)
ds_read_b128 v[72:75],v4 offset:2048
s_waitcnt vmcnt(6)
ds_read_b128 v[76:79],v4 offset:3072
s_waitcnt lgkmcnt(3)
v_mfma_f32_16x16x32_bf16 v[32:35],a[0:3],v[64:67],0
s_add_u32 s71,s60,2
s_add_u32 s53,s60,3
s_mov_b32 s57,s63
v_mfma_f32_16x16x32_bf16 v[36:39],a[4:7],v[64:67],0
v_mfma_f32_16x16x32_bf16 v[48:51],v[12:15],v[64:67],0
v_mfma_f32_16x16x32_bf16 v[52:55],v[64:67],v[64:67],0
s_waitcnt lgkmcnt(2)
s_waitcnt vmcnt(5)
s_mov_b32 m0,s70
ds_read_b128 v[80:83],v4 offset:4096
v_mfma_f32_16x16x32_bf16 v[32:35],a[8:11],v[68:71],v[32:35]
buffer_load_dwordx4 v3,s[20:23],s61 offen offset:0 lds
v_mfma_f32_16x16x32_bf16 v[36:39],a[12:15],v[68:71],v[36:39]
v_mfma_f32_16x16x32_bf16 v[48:51],v[12:15],v[68:71],v[48:51]
v_mfma_f32_16x16x32_bf16 v[52:55],v[68:71],v[68:71],v[52:55]
s_waitcnt lgkmcnt(2)
s_waitcnt vmcnt(5)
ds_read_b128 v[84:87],v4 offset:5120
v_mfma_f32_16x16x32_bf16 v[32:35],a[16:19],v[72:75],v[32:35]
buffer_load_dwordx4 v3,s[20:23],s61 offen offset:1024 lds
v_mfma_f32_16x16x32_bf16 v[36:39],a[20:23],v[72:75],v[36:39]
v_mfma_f32_16x16x32_bf16 v[48:51],v[12:15],v[72:75],v[48:51]
v_mfma_f32_16x16x32_bf16 v[52:55],v[72:75],v[72:75],v[52:55]
s_waitcnt lgkmcnt(2)
s_waitcnt vmcnt(5)
ds_read_b128 v[88:91],v4 offset:6144
v_mfma_f32_16x16x32_bf16 v[32:35],a[24:27],v[76:79],v[32:35]
buffer_load_dwordx4 v3,s[20:23],s61 offen offset:2048 lds
v_mfma_f32_16x16x32_bf16 v[36:39],a[28:31],v[76:79],v[36:39]
v_mfma_f32_16x16x32_bf16 v[48:51],v[12:15],v[76:79],v[48:51]
v_mfma_f32_16x16x32_bf16 v[52:55],v[76:79],v[76:79],v[52:55]
s_waitcnt lgkmcnt(2)
s_waitcnt vmcnt(5)
ds_read_b128 v[92:95],v4 offset:7168
v_mfma_f32_16x16x32_bf16 v[32:35],a[32:35],v[80:83],v[32:35]
buffer_load_dwordx4 v3,s[20:23],s61 offen offset:3072 lds
v_mfma_f32_16x16x32_bf16 v[36:39],a[36:39],v[80:83],v[36:39]
v_mfma_f32_16x16x32_bf16 v[48:51],v[12:15],v[80:83],v[48:51]
v_mfma_f32_16x16x32_bf16 v[52:55],v[80:83],v[80:83],v[52:55]
s_waitcnt lgkmcnt(2)
s_barrier
ds_read_b128 v[96:99],v5 offset:0
v_mfma_f32_16x16x32_bf16 v[32:35],a[40:43],v[84:87],v[32:35]
ds_read_b128 v[100:103],v5 offset:1024
v_mfma_f32_16x16x32_bf16 v[36:39],a[44:47],v[84:87],v[36:39]
ds_read_b128 v[104:107],v5 offset:2048
v_mfma_f32_16x16x32_bf16 v[48:51],v[12:15],v[84:87],v[48:51]
s_add_u32 m0,s70,4096
ds_read_b128 v[108:111],v5 offset:3072
v_mfma_f32_16x16x32_bf16 v[52:55],v[84:87],v[84:87],v[52:55]
s_waitcnt lgkmcnt(5)
buffer_load_dwordx4 v3,s[20:23],s62 offen offset:0 lds
v_mfma_f32_16x16x32_bf16 v[32:35],a[48:51],v[88:91],v[32:35]
ds_read_b128 v[112:115],v5 offset:4096
v_mfma_f32_16x16x32_bf16 v[36:39],a[52:55],v[88:91],v[36:39]
buffer_load_dwordx4 v3,s[20:23],s62 offen offset:1024 lds
v_mfma_f32_16x16x32_bf16 v[48:51],v[12:15],v[88:91],v[48:51]
v_mfma_f32_16x16x32_bf16 v[52:55],v[88:91],v[88:91],v[52:55]
s_waitcnt lgkmcnt(5)
v_mfma_f32_16x16x32_bf16 v[32:35],a[56:59],v[92:95],v[32:35]
ds_read_b128 v[116:119],v5 offset:5120
v_mfma_f32_16x16x32_bf16 v[36:39],a[60:63],v[92:95],v[36:39]
buffer_load_dwordx4 v3,s[20:23],s62 offen offset:2048 lds
v_mfma_f32_16x16x32_bf16 v[48:51],v[12:15],v[92:95],v[48:51]
buffer_load_dword v16,v2,s[20:23],s68 offen sc1
v_mfma_f32_16x16x32_bf16 v[52:55],v[92:95],v[92:95],v[52:55]
s_waitcnt lgkmcnt(5)
v_mfma_f32_16x16x32_bf16 v[32:35],a[64:67],v[96:99],v[32:35]
ds_read_b128 v[120:123],v5 offset:6144
v_mfma_f32_16x16x32_bf16 v[36:39],a[68:71],v[96:99],v[36:39]
s_waitcnt lgkmcnt(5)
buffer_load_dwordx4 v3,s[20:23],s62 offen offset:3072 lds
v_mfma_f32_16x16x32_bf16 v[32:35],a[72:75],v[100:103],v[32:35]
ds_read_b128 v[124:127],v5 offset:7168
v_mfma_f32_16x16x32_bf16 v[36:39],a[76:79],v[100:103],v[36:39]
s_waitcnt lgkmcnt(5)
v_mfma_f32_16x16x32_bf16 v[32:35],a[80:83],v[104:107],v[32:35]
ds_read_b128 v[64:67],v6 offset:0
v_cndmask_b32 v49,v52,v53,s[74:75]
v_mfma_f32_16x16x32_bf16 v[36:39],a[84:87],v[104:107],v[36:39]
s_waitcnt lgkmcnt(5)
v_cndmask_b32 v49,v49,v54,s[76:77]
v_cndmask_b32 v49,v49,v55,s[78:79]
v_mfma_f32_16x16x32_bf16 v[32:35],a[88:91],v[108:111],v[32:35]
ds_read_b128 v[68:71],v6 offset:1024
v_mfma_f32_16x16x32_bf16 v[36:39],a[92:95],v[108:111],v[36:39]
s_waitcnt lgkmcnt(5)
ds_write_b64 v19,v[48:49]
v_mfma_f32_16x16x32_bf16 v[32:35],a[96:99],v[112:115],v[32:35]
ds_read_b128 v[72:75],v6 offset:2048
v_mfma_f32_16x16x32_bf16 v[36:39],a[100:103],v[112:115],v[36:39]
s_waitcnt lgkmcnt(6)
v_mfma_f32_16x16x32_bf16 v[32:35],a[104:107],v[116:119],v[32:35]
ds_read_b128 v[76:79],v6 offset:3072
v_mfma_f32_16x16x32_bf16 v[36:39],a[108:111],v[116:119],v[36:39]
s_waitcnt lgkmcnt(6)
v_mfma_f32_16x16x32_bf16 v[32:35],a[112:115],v[120:123],v[32:35]
s_waitcnt lgkmcnt(2)
s_barrier
ds_read_b128 v[80:83],v6 offset:4096
v_mfma_f32_16x16x32_bf16 v[36:39],a[116:119],v[120:123],v[36:39]
ds_read_b64 v[56:57],v20 offset:0
v_mfma_f32_16x16x32_bf16 v[32:35],a[120:123],v[124:127],v[32:35]
ds_read_b128 v[84:87],v6 offset:5120
v_mfma_f32_16x16x32_bf16 v[36:39],a[124:127],v[124:127],v[36:39]
ds_read_b64 v[58:59],v20 offset:512
v_mfma_f32_16x16x32_bf16 v[32:35],a[128:131],v[64:67],v[32:35]
ds_read_b128 v[88:91],v6 offset:6144
v_mfma_f32_16x16x32_bf16 v[36:39],a[132:135],v[64:67],v[36:39]
ds_read_b64 v[60:61],v20 offset:1024
v_mfma_f32_16x16x32_bf16 v[32:35],a[136:139],v[68:71],v[32:35]
ds_read_b128 v[92:95],v6 offset:7168
v_mfma_f32_16x16x32_bf16 v[36:39],a[140:143],v[68:71],v[36:39]
s_waitcnt lgkmcnt(8)
ds_read_b64 v[62:63],v20 offset:1536
v_mfma_f32_16x16x32_bf16 v[32:35],a[144:147],v[72:75],v[32:35]
ds_read_b128 v[96:99],v7 offset:0
v_mfma_f32_16x16x32_bf16 v[36:39],a[148:151],v[72:75],v[36:39]
s_waitcnt lgkmcnt(9)
s_waitcnt vmcnt(10)
v_mov_b32 v17,s57
buffer_store_dword v17,v26,s[20:23],s69 offen
v_mfma_f32_16x16x32_bf16 v[32:35],a[152:155],v[76:79],v[32:35]
ds_read_b128 v[100:103],v7 offset:1024
v_mfma_f32_16x16x32_bf16 v[36:39],a[156:159],v[76:79],v[36:39]
s_waitcnt lgkmcnt(9)
v_mfma_f32_16x16x32_bf16 v[32:35],a[160:163],v[80:83],v[32:35]
ds_read_b128 v[104:107],v7 offset:2048
v_mfma_f32_16x16x32_bf16 v[36:39],a[164:167],v[80:83],v[36:39]
s_waitcnt lgkmcnt(8)
s_waitcnt lgkmcnt(3)
v_add_f32 v56,v56,v58
v_mfma_f32_16x16x32_bf16 v[32:35],a[168:171],v[84:87],v[32:35]
ds_read_b128 v[108:111],v7 offset:3072
v_add_f32 v57,v57,v59
v_mfma_f32_16x16x32_bf16 v[36:39],a[172:175],v[84:87],v[36:39]
v_add_f32 v60,v60,v62
v_add_f32 v61,v61,v63
v_mfma_f32_16x16x32_bf16 v[32:35],a[176:179],v[88:91],v[32:35]
ds_read_b128 v[112:115],v7 offset:4096
v_add_f32 v56,v56,v60
v_mfma_f32_16x16x32_bf16 v[36:39],a[180:183],v[88:91],v[36:39]
v_add_f32 v57,v57,v61
v_mul_f32 v188,0xba800000,v56
v_mfma_f32_16x16x32_bf16 v[32:35],a[184:187],v[92:95],v[32:35]
ds_read_b128 v[116:119],v7 offset:5120
v_fma_f32 v58,v188,v188,-v210
v_mfma_f32_16x16x32_bf16 v[36:39],a[188:191],v[92:95],v[36:39]
s_waitcnt lgkmcnt(5)
v_fma_f32 v57,v57,v211,-v58
v_max_f32 v57,v210,v57
v_mfma_f32_16x16x32_bf16 v[32:35],a[192:195],v[96:99],v[32:35]
ds_read_b128 v[120:123],v7 offset:6144
v_mfma_f32_16x16x32_bf16 v[36:39],a[196:199],v[96:99],v[36:39]
s_waitcnt lgkmcnt(5)
v_rsq_f32 v58,v57
v_mfma_f32_16x16x32_bf16 v[32:35],a[200:203],v[100:103],v[32:35]
ds_read_b128 v[124:127],v7 offset:7168
v_mul_f32 v189,v57,v58
v_mfma_f32_16x16x32_bf16 v[36:39],a[204:207],v[100:103],v[36:39]
s_waitcnt lgkmcnt(5)
v_mul_f32 v190,v209,v58
v_mul_f32 v59,v58,v58
v_mfma_f32_16x16x32_bf16 v[32:35],a[208:211],v[104:107],v[32:35]
s_add_u32 s61,s61,32768
v_mul_f32 v191,v208,v58
v_mul_f32 v191,v191,v59
v_mfma_f32_16x16x32_bf16 v[36:39],a[212:215],v[104:107],v[36:39]
s_waitcnt lgkmcnt(4)
s_add_u32 s62,s62,32768
s_add_u32 s70,s70,32768
v_mfma_f32_16x16x32_bf16 v[32:35],a[216:219],v[108:111],v[32:35]
s_and_b32 s70,s70,0x1ffff
s_add_u32 s55,s55,32768
s_and_b32 s55,s55,0x1ffff
v_mfma_f32_16x16x32_bf16 v[36:39],a[220:223],v[108:111],v[36:39]
s_waitcnt lgkmcnt(3)
v_add_u32 v4,s55,v8
v_add_u32 v5,s55,v9
v_mfma_f32_16x16x32_bf16 v[32:35],a[224:227],v[112:115],v[32:35]
v_add_u32 v6,s55,v10
v_add_u32 v7,s55,v11
v_mfma_f32_16x16x32_bf16 v[36:39],a[228:231],v[112:115],v[36:39]
s_waitcnt lgkmcnt(2)
s_waitcnt vmcnt(9)
ds_read_b128 v[64:67],v4 offset:0
v_mfma_f32_16x16x32_bf16 v[32:35],a[232:235],v[116:119],v[32:35]
s_waitcnt vmcnt(8)
ds_read_b128 v[68:71],v4 offset:1024
v_mfma_f32_16x16x32_bf16 v[36:39],a[236:239],v[116:119],v[36:39]
s_waitcnt lgkmcnt(3)
s_waitcnt vmcnt(7)
ds_read_b128 v[72:75],v4 offset:2048
v_mfma_f32_16x16x32_bf16 v[32:35],a[240:243],v[120:123],v[32:35]
v_mfma_f32_16x16x32_bf16 v[36:39],a[244:247],v[120:123],v[36:39]
s_waitcnt lgkmcnt(3)
v_mfma_f32_16x16x32_bf16 v[40:43],a[248:251],v[124:127],v[32:35]
v_mfma_f32_16x16x32_bf16 v[44:47],a[252:255],v[124:127],v[36:39]
s_waitcnt vmcnt(2)
v_cmp_gt_u32 vcc,s53,v16
s_add_u32 s60,s60,1
s_cbranch_vccnz WN_303
.p2align 6
WR_302:
s_waitcnt lgkmcnt(2)
v_mfma_f32_16x16x32_bf16 v[32:35],a[0:3],v[64:67],0
s_waitcnt vmcnt(6)
s_add_u32 s71,s60,2
ds_read_b128 v[76:79],v4 offset:3072
v_mfma_f32_16x16x32_bf16 v[36:39],a[4:7],v[64:67],0
s_add_u32 s53,s60,3
s_mov_b32 s57,s63
v_mfma_f32_16x16x32_bf16 v[48:51],v[12:15],v[64:67],0
s_mov_b32 m0,s70
v_fma_f32 v40,v152,v188,v40
v_fma_f32 v41,v153,v188,v41
v_mul_f32 v168,v40,v40
v_mfma_f32_16x16x32_bf16 v[52:55],v[64:67],v[64:67],0
s_waitcnt lgkmcnt(2)
buffer_load_dwordx4 v3,s[20:23],s61 offen offset:0 lds
v_mul_f32 v169,v41,v41
v_fma_f32 v168,v168,v191,v190
v_mfma_f32_16x16x32_bf16 v[32:35],a[8:11],v[68:71],v[32:35]
s_waitcnt vmcnt(6)
ds_read_b128 v[80:83],v4 offset:4096
v_fma_f32 v169,v169,v191,v190
v_mul_f32 v168,v168,v40
v_mfma_f32_16x16x32_bf16 v[36:39],a[12:15],v[68:71],v[36:39]
v_exp_f32 v168,v168
v_mul_f32 v169,v169,v41
v_mfma_f32_16x16x32_bf16 v[48:51],v[12:15],v[68:71],v[48:51]
v_exp_f32 v169,v169
v_fma_f32 v168,v168,v189,v189
v_mfma_f32_16x16x32_bf16 v[52:55],v[68:71],v[68:71],v[52:55]
s_waitcnt lgkmcnt(2)
buffer_load_dwordx4 v3,s[20:23],s61 offen offset:1024 lds
v_rcp_f32 v168,v168
v_mfma_f32_16x16x32_bf16 v[32:35],a[16:19],v[72:75],v[32:35]
s_waitcnt vmcnt(6)
ds_read_b128 v[84:87],v4 offset:5120
v_fma_f32 v169,v169,v189,v189
v_mul_f32 v40,v168,v40
v_mfma_f32_16x16x32_bf16 v[36:39],a[20:23],v[72:75],v[36:39]
v_rcp_f32 v169,v169
v_fma_f32 v42,v154,v188,v42
v_mfma_f32_16x16x32_bf16 v[48:51],v[12:15],v[72:75],v[48:51]
v_mul_f32 v41,v169,v41
v_fma_f32 v43,v155,v188,v43
v_mul_f32 v170,v42,v42
v_mfma_f32_16x16x32_bf16 v[52:55],v[72:75],v[72:75],v[52:55]
s_waitcnt lgkmcnt(2)
buffer_load_dwordx4 v3,s[20:23],s61 offen offset:2048 lds
v_mul_f32 v171,v43,v43
v_fma_f32 v170,v170,v191,v190
v_mfma_f32_16x16x32_bf16 v[32:35],a[24:27],v[76:79],v[32:35]
s_waitcnt vmcnt(6)
ds_read_b128 v[88:91],v4 offset:6144
v_fma_f32 v171,v171,v191,v190
v_mfma_f32_16x16x32_bf16 v[36:39],a[28:31],v[76:79],v[36:39]
v_mul_f32 v170,v170,v42
v_mul_f32 v171,v171,v43
v_mfma_f32_16x16x32_bf16 v[48:51],v[12:15],v[76:79],v[48:51]
v_exp_f32 v170,v170
v_mfma_f32_16x16x32_bf16 v[52:55],v[76:79],v[76:79],v[52:55]
s_waitcnt lgkmcnt(2)
buffer_load_dwordx4 v3,s[20:23],s61 offen offset:3072 lds
v_fma_f32 v170,v170,v189,v189
v_mfma_f32_16x16x32_bf16 v[32:35],a[32:35],v[80:83],v[32:35]
s_waitcnt vmcnt(5)
ds_read_b128 v[92:95],v4 offset:7168
v_fma_f32 v44,v156,v188,v44
v_mfma_f32_16x16x32_bf16 v[36:39],a[36:39],v[80:83],v[36:39]
s_barrier
ds_read_b128 v[96:99],v5 offset:0
v_fma_f32 v45,v157,v188,v45
v_mfma_f32_16x16x32_bf16 v[48:51],v[12:15],v[80:83],v[48:51]
ds_read_b128 v[100:103],v5 offset:1024
v_mul_f32 v172,v44,v44
v_mfma_f32_16x16x32_bf16 v[52:55],v[80:83],v[80:83],v[52:55]
s_waitcnt lgkmcnt(4)
ds_read_b128 v[104:107],v5 offset:2048
v_mul_f32 v173,v45,v45
v_mfma_f32_16x16x32_bf16 v[32:35],a[40:43],v[84:87],v[32:35]
s_add_u32 m0,s70,4096
ds_read_b128 v[108:111],v5 offset:3072
v_fma_f32 v172,v172,v191,v190
v_mfma_f32_16x16x32_bf16 v[36:39],a[44:47],v[84:87],v[36:39]
buffer_load_dwordx4 v3,s[20:23],s62 offen offset:0 lds
v_fma_f32 v173,v173,v191,v190
v_mfma_f32_16x16x32_bf16 v[48:51],v[12:15],v[84:87],v[48:51]
s_waitcnt vmcnt(5)
v_mov_b32 v17,s57
buffer_store_dword v17,v26,s[20:23],s69 offen
v_mfma_f32_16x16x32_bf16 v[52:55],v[84:87],v[84:87],v[52:55]
s_waitcnt lgkmcnt(5)
v_exp_f32 v171,v171
v_mfma_f32_16x16x32_bf16 v[32:35],a[48:51],v[88:91],v[32:35]
ds_read_b128 v[112:115],v5 offset:4096
v_fma_f32 v171,v171,v189,v189
v_mfma_f32_16x16x32_bf16 v[36:39],a[52:55],v[88:91],v[36:39]
buffer_load_dwordx4 v3,s[20:23],s62 offen offset:1024 lds
v_mul_f32 v172,v172,v44
v_mfma_f32_16x16x32_bf16 v[48:51],v[12:15],v[88:91],v[48:51]
v_rcp_f32 v170,v170
v_mfma_f32_16x16x32_bf16 v[52:55],v[88:91],v[88:91],v[52:55]
s_waitcnt lgkmcnt(5)
v_rcp_f32 v171,v171
v_mfma_f32_16x16x32_bf16 v[32:35],a[56:59],v[92:95],v[32:35]
ds_read_b128 v[116:119],v5 offset:5120
v_mul_f32 v42,v170,v42
v_mfma_f32_16x16x32_bf16 v[36:39],a[60:63],v[92:95],v[36:39]
buffer_load_dwordx4 v3,s[20:23],s62 offen offset:2048 lds
v_mul_f32 v43,v171,v43
v_mfma_f32_16x16x32_bf16 v[48:51],v[12:15],v[92:95],v[48:51]
buffer_load_dword v16,v2,s[20:23],s68 offen sc1
v_mul_f32 v173,v173,v45
v_mfma_f32_16x16x32_bf16 v[52:55],v[92:95],v[92:95],v[52:55]
s_waitcnt lgkmcnt(5)
v_exp_f32 v172,v172
v_mfma_f32_16x16x32_bf16 v[32:35],a[64:67],v[96:99],v[32:35]
ds_read_b128 v[120:123],v5 offset:6144
v_fma_f32 v172,v172,v189,v189
v_mfma_f32_16x16x32_bf16 v[36:39],a[68:71],v[96:99],v[36:39]
s_waitcnt lgkmcnt(5)
buffer_load_dwordx4 v3,s[20:23],s62 offen offset:3072 lds
v_fma_f32 v46,v158,v188,v46
v_mfma_f32_16x16x32_bf16 v[32:35],a[72:75],v[100:103],v[32:35]
ds_read_b128 v[124:127],v5 offset:7168
v_fma_f32 v47,v159,v188,v47
v_mfma_f32_16x16x32_bf16 v[36:39],a[76:79],v[100:103],v[36:39]
s_waitcnt lgkmcnt(5)
v_exp_f32 v173,v173
v_mfma_f32_16x16x32_bf16 v[32:35],a[80:83],v[104:107],v[32:35]
ds_read_b128 v[64:67],v6 offset:0
v_cndmask_b32 v49,v52,v53,s[74:75]
v_mfma_f32_16x16x32_bf16 v[36:39],a[84:87],v[104:107],v[36:39]
s_waitcnt lgkmcnt(5)
v_cndmask_b32 v49,v49,v54,s[76:77]
v_cndmask_b32 v49,v49,v55,s[78:79]
v_mfma_f32_16x16x32_bf16 v[32:35],a[88:91],v[108:111],v[32:35]
ds_read_b128 v[68:71],v6 offset:1024
v_fma_f32 v173,v173,v189,v189
v_mfma_f32_16x16x32_bf16 v[36:39],a[92:95],v[108:111],v[36:39]
s_waitcnt lgkmcnt(5)
ds_write_b64 v19,v[48:49]
v_mfma_f32_16x16x32_bf16 v[32:35],a[96:99],v[112:115],v[32:35]
ds_read_b128 v[72:75],v6 offset:2048
v_mul_f32 v174,v46,v46
v_mfma_f32_16x16x32_bf16 v[36:39],a[100:103],v[112:115],v[36:39]
s_waitcnt lgkmcnt(6)
v_rcp_f32 v172,v172
v_mfma_f32_16x16x32_bf16 v[32:35],a[104:107],v[116:119],v[32:35]
ds_read_b128 v[76:79],v6 offset:3072
v_mul_f32 v44,v172,v44
v_mfma_f32_16x16x32_bf16 v[36:39],a[108:111],v[116:119],v[36:39]
s_waitcnt lgkmcnt(6)
v_rcp_f32 v173,v173
v_mfma_f32_16x16x32_bf16 v[32:35],a[112:115],v[120:123],v[32:35]
s_waitcnt lgkmcnt(2)
s_barrier
ds_read_b128 v[80:83],v6 offset:4096
v_mfma_f32_16x16x32_bf16 v[36:39],a[116:119],v[120:123],v[36:39]
ds_read_b64 v[56:57],v20 offset:0
v_mul_f32 v45,v173,v45
v_mfma_f32_16x16x32_bf16 v[32:35],a[120:123],v[124:127],v[32:35]
ds_read_b128 v[84:87],v6 offset:5120
v_mul_f32 v175,v47,v47
v_mfma_f32_16x16x32_bf16 v[36:39],a[124:127],v[124:127],v[36:39]
ds_read_b64 v[58:59],v20 offset:512
v_fma_f32 v174,v174,v191,v190
v_mfma_f32_16x16x32_bf16 v[32:35],a[128:131],v[64:67],v[32:35]
ds_read_b128 v[88:91],v6 offset:6144
v_fma_f32 v175,v175,v191,v190
v_mfma_f32_16x16x32_bf16 v[36:39],a[132:135],v[64:67],v[36:39]
ds_read_b64 v[60:61],v20 offset:1024
v_mul_f32 v174,v174,v46
v_mfma_f32_16x16x32_bf16 v[32:35],a[136:139],v[68:71],v[32:35]
ds_read_b128 v[92:95],v6 offset:7168
v_mul_f32 v175,v175,v47
v_mfma_f32_16x16x32_bf16 v[36:39],a[140:143],v[68:71],v[36:39]
s_waitcnt lgkmcnt(8)
ds_read_b64 v[62:63],v20 offset:1536
v_cvt_pk_bf16_f32 v176,v40,v41
v_mfma_f32_16x16x32_bf16 v[32:35],a[144:147],v[72:75],v[32:35]
ds_read_b128 v[96:99],v7 offset:0
v_cvt_pk_bf16_f32 v177,v42,v43
v_mfma_f32_16x16x32_bf16 v[36:39],a[148:151],v[72:75],v[36:39]
s_waitcnt lgkmcnt(9)
v_exp_f32 v174,v174
v_mfma_f32_16x16x32_bf16 v[32:35],a[152:155],v[76:79],v[32:35]
ds_read_b128 v[100:103],v7 offset:1024
v_fma_f32 v174,v174,v189,v189
v_mfma_f32_16x16x32_bf16 v[36:39],a[156:159],v[76:79],v[36:39]
s_waitcnt lgkmcnt(9)
v_exp_f32 v175,v175
v_mfma_f32_16x16x32_bf16 v[32:35],a[160:163],v[80:83],v[32:35]
ds_read_b128 v[104:107],v7 offset:2048
v_fma_f32 v175,v175,v189,v189
v_mfma_f32_16x16x32_bf16 v[36:39],a[164:167],v[80:83],v[36:39]
s_waitcnt lgkmcnt(8)
s_waitcnt lgkmcnt(3)
v_rcp_f32 v174,v174
v_mfma_f32_16x16x32_bf16 v[32:35],a[168:171],v[84:87],v[32:35]
ds_read_b128 v[108:111],v7 offset:3072
v_mul_f32 v46,v174,v46
v_mfma_f32_16x16x32_bf16 v[36:39],a[172:175],v[84:87],v[36:39]
v_rcp_f32 v175,v175
v_mfma_f32_16x16x32_bf16 v[32:35],a[176:179],v[88:91],v[32:35]
ds_read_b128 v[112:115],v7 offset:4096
v_mul_f32 v47,v175,v47
v_mfma_f32_16x16x32_bf16 v[36:39],a[180:183],v[88:91],v[36:39]
v_cvt_pk_bf16_f32 v178,v44,v45
v_cvt_pk_bf16_f32 v179,v46,v47
v_mfma_f32_16x16x32_bf16 v[32:35],a[184:187],v[92:95],v[32:35]
ds_read_b128 v[116:119],v7 offset:5120
v_add_f32 v56,v56,v58
v_mfma_f32_16x16x32_bf16 v[36:39],a[188:191],v[92:95],v[36:39]
s_waitcnt lgkmcnt(5)
buffer_store_dwordx4 v[176:179],v0,s[20:23],s66 offen sc1
v_mfma_f32_16x16x32_bf16 v[32:35],a[192:195],v[96:99],v[32:35]
s_add_u32 s66,s66,32768
s_add_u32 s63,s63,1
ds_read_b128 v[120:123],v7 offset:6144
v_mfma_f32_16x16x32_bf16 v[36:39],a[196:199],v[96:99],v[36:39]
s_waitcnt lgkmcnt(5)
v_add_f32 v57,v57,v59
v_add_f32 v60,v60,v62
v_mfma_f32_16x16x32_bf16 v[32:35],a[200:203],v[100:103],v[32:35]
ds_read_b128 v[124:127],v7 offset:7168
v_add_f32 v61,v61,v63
v_mfma_f32_16x16x32_bf16 v[36:39],a[204:207],v[100:103],v[36:39]
s_waitcnt lgkmcnt(5)
v_add_f32 v56,v56,v60
v_add_f32 v57,v57,v61
v_mfma_f32_16x16x32_bf16 v[32:35],a[208:211],v[104:107],v[32:35]
s_add_u32 s61,s61,32768
v_mul_f32 v188,0xba800000,v56
v_fma_f32 v58,v188,v188,-v210
v_mfma_f32_16x16x32_bf16 v[36:39],a[212:215],v[104:107],v[36:39]
s_waitcnt lgkmcnt(4)
v_fma_f32 v57,v57,v211,-v58
v_max_f32 v57,v210,v57
v_mfma_f32_16x16x32_bf16 v[32:35],a[216:219],v[108:111],v[32:35]
s_add_u32 s62,s62,32768
v_rsq_f32 v58,v57
v_mfma_f32_16x16x32_bf16 v[36:39],a[220:223],v[108:111],v[36:39]
s_waitcnt lgkmcnt(3)
v_mul_f32 v189,v57,v58
v_mul_f32 v190,v209,v58
v_mfma_f32_16x16x32_bf16 v[32:35],a[224:227],v[112:115],v[32:35]
s_add_u32 s70,s70,32768
v_mul_f32 v59,v58,v58
v_mul_f32 v191,v208,v58
v_mfma_f32_16x16x32_bf16 v[36:39],a[228:231],v[112:115],v[36:39]
s_waitcnt lgkmcnt(2)
s_and_b32 s70,s70,0x1ffff
v_mul_f32 v191,v191,v59
v_mfma_f32_16x16x32_bf16 v[32:35],a[232:235],v[116:119],v[32:35]
s_add_u32 s55,s55,32768
s_and_b32 s55,s55,0x1ffff
v_add_u32 v4,s55,v8
v_mfma_f32_16x16x32_bf16 v[36:39],a[236:239],v[116:119],v[36:39]
s_waitcnt lgkmcnt(1)
v_add_u32 v5,s55,v9
v_add_u32 v6,s55,v10
v_mfma_f32_16x16x32_bf16 v[32:35],a[240:243],v[120:123],v[32:35]
v_add_u32 v7,s55,v11
v_mfma_f32_16x16x32_bf16 v[36:39],a[244:247],v[120:123],v[36:39]
s_waitcnt lgkmcnt(0)
s_waitcnt vmcnt(10)
ds_read_b128 v[64:67],v4 offset:0
v_mfma_f32_16x16x32_bf16 v[40:43],a[248:251],v[124:127],v[32:35]
s_waitcnt vmcnt(9)
ds_read_b128 v[68:71],v4 offset:1024
v_mfma_f32_16x16x32_bf16 v[44:47],a[252:255],v[124:127],v[36:39]
s_waitcnt vmcnt(2)
v_cmp_gt_u32 vcc,s53,v16
ds_read_b128 v[72:75],v4 offset:2048
s_add_u32 s60,s60,1
s_cbranch_vccz WR_302
WN_303:
s_waitcnt lgkmcnt(2)
v_mfma_f32_16x16x32_bf16 v[32:35],a[0:3],v[64:67],0
s_waitcnt vmcnt(6)
s_add_u32 s71,s60,2
ds_read_b128 v[76:79],v4 offset:3072
v_mfma_f32_16x16x32_bf16 v[36:39],a[4:7],v[64:67],0
s_add_u32 s53,s60,3
s_mov_b32 s57,s63
v_mfma_f32_16x16x32_bf16 v[48:51],v[12:15],v[64:67],0
v_fma_f32 v40,v152,v188,v40
v_fma_f32 v41,v153,v188,v41
v_mul_f32 v168,v40,v40
v_mfma_f32_16x16x32_bf16 v[52:55],v[64:67],v[64:67],0
s_waitcnt lgkmcnt(2)
v_mul_f32 v169,v41,v41
v_fma_f32 v168,v168,v191,v190
v_fma_f32 v169,v169,v191,v190
v_mfma_f32_16x16x32_bf16 v[32:35],a[8:11],v[68:71],v[32:35]
s_waitcnt vmcnt(5)
ds_read_b128 v[80:83],v4 offset:4096
v_mul_f32 v168,v168,v40
v_mul_f32 v169,v169,v41
v_mfma_f32_16x16x32_bf16 v[36:39],a[12:15],v[68:71],v[36:39]
v_exp_f32 v168,v168
v_fma_f32 v42,v154,v188,v42
v_mfma_f32_16x16x32_bf16 v[48:51],v[12:15],v[68:71],v[48:51]
v_exp_f32 v169,v169
v_fma_f32 v168,v168,v189,v189
v_mfma_f32_16x16x32_bf16 v[52:55],v[68:71],v[68:71],v[52:55]
s_waitcnt lgkmcnt(2)
v_rcp_f32 v168,v168
v_fma_f32 v169,v169,v189,v189
v_mfma_f32_16x16x32_bf16 v[32:35],a[16:19],v[72:75],v[32:35]
s_waitcnt vmcnt(4)
ds_read_b128 v[84:87],v4 offset:5120
v_rcp_f32 v169,v169
v_mfma_f32_16x16x32_bf16 v[36:39],a[20:23],v[72:75],v[36:39]
v_mul_f32 v40,v168,v40
v_mul_f32 v41,v169,v41
v_fma_f32 v43,v155,v188,v43
v_mfma_f32_16x16x32_bf16 v[48:51],v[12:15],v[72:75],v[48:51]
v_mul_f32 v170,v42,v42
v_mul_f32 v171,v43,v43
v_mfma_f32_16x16x32_bf16 v[52:55],v[72:75],v[72:75],v[52:55]
s_waitcnt lgkmcnt(2)
v_fma_f32 v170,v170,v191,v190
v_fma_f32 v171,v171,v191,v190
v_mfma_f32_16x16x32_bf16 v[32:35],a[24:27],v[76:79],v[32:35]
s_waitcnt vmcnt(3)
ds_read_b128 v[88:91],v4 offset:6144
v_mul_f32 v170,v170,v42
v_mfma_f32_16x16x32_bf16 v[36:39],a[28:31],v[76:79],v[36:39]
v_exp_f32 v170,v170
v_mfma_f32_16x16x32_bf16 v[48:51],v[12:15],v[76:79],v[48:51]
v_mul_f32 v171,v171,v43
v_fma_f32 v170,v170,v189,v189
v_mfma_f32_16x16x32_bf16 v[52:55],v[76:79],v[76:79],v[52:55]
s_waitcnt lgkmcnt(2)
v_exp_f32 v171,v171
v_mfma_f32_16x16x32_bf16 v[32:35],a[32:35],v[80:83],v[32:35]
s_waitcnt vmcnt(1)
ds_read_b128 v[92:95],v4 offset:7168
v_fma_f32 v171,v171,v189,v189
v_mfma_f32_16x16x32_bf16 v[36:39],a[36:39],v[80:83],v[36:39]
s_barrier
ds_read_b128 v[96:99],v5 offset:0
v_fma_f32 v44,v156,v188,v44
v_mfma_f32_16x16x32_bf16 v[48:51],v[12:15],v[80:83],v[48:51]
ds_read_b128 v[100:103],v5 offset:1024
v_fma_f32 v45,v157,v188,v45
v_mfma_f32_16x16x32_bf16 v[52:55],v[80:83],v[80:83],v[52:55]
s_waitcnt lgkmcnt(4)
ds_read_b128 v[104:107],v5 offset:2048
v_mul_f32 v172,v44,v44
v_mfma_f32_16x16x32_bf16 v[32:35],a[40:43],v[84:87],v[32:35]
ds_read_b128 v[108:111],v5 offset:3072
v_mul_f32 v173,v45,v45
v_mfma_f32_16x16x32_bf16 v[36:39],a[44:47],v[84:87],v[36:39]
s_waitcnt vmcnt(0)
v_mov_b32 v17,s57
buffer_store_dword v17,v26,s[20:23],s69 offen
v_mfma_f32_16x16x32_bf16 v[48:51],v[12:15],v[84:87],v[48:51]
v_rcp_f32 v170,v170
v_mfma_f32_16x16x32_bf16 v[52:55],v[84:87],v[84:87],v[52:55]
s_waitcnt lgkmcnt(5)
v_rcp_f32 v171,v171
v_mfma_f32_16x16x32_bf16 v[32:35],a[48:51],v[88:91],v[32:35]
ds_read_b128 v[112:115],v5 offset:4096
v_mul_f32 v42,v170,v42
v_mfma_f32_16x16x32_bf16 v[36:39],a[52:55],v[88:91],v[36:39]
v_mul_f32 v43,v171,v43
v_fma_f32 v172,v172,v191,v190
v_mfma_f32_16x16x32_bf16 v[48:51],v[12:15],v[88:91],v[48:51]
v_fma_f32 v173,v173,v191,v190
v_mul_f32 v172,v172,v44
v_mfma_f32_16x16x32_bf16 v[52:55],v[88:91],v[88:91],v[52:55]
s_waitcnt lgkmcnt(5)
v_exp_f32 v172,v172
v_mfma_f32_16x16x32_bf16 v[32:35],a[56:59],v[92:95],v[32:35]
ds_read_b128 v[116:119],v5 offset:5120
v_mul_f32 v173,v173,v45
v_mfma_f32_16x16x32_bf16 v[36:39],a[60:63],v[92:95],v[36:39]
v_exp_f32 v173,v173
v_mfma_f32_16x16x32_bf16 v[48:51],v[12:15],v[92:95],v[48:51]
v_fma_f32 v172,v172,v189,v189
v_fma_f32 v173,v173,v189,v189
v_mfma_f32_16x16x32_bf16 v[52:55],v[92:95],v[92:95],v[52:55]
s_waitcnt lgkmcnt(5)
v_rcp_f32 v172,v172
v_mfma_f32_16x16x32_bf16 v[32:35],a[64:67],v[96:99],v[32:35]
ds_read_b128 v[120:123],v5 offset:6144
v_mul_f32 v44,v172,v44
v_mfma_f32_16x16x32_bf16 v[36:39],a[68:71],v[96:99],v[36:39]
s_waitcnt lgkmcnt(5)
v_rcp_f32 v173,v173
v_mfma_f32_16x16x32_bf16 v[32:35],a[72:75],v[100:103],v[32:35]
ds_read_b128 v[124:127],v5 offset:7168
v_mul_f32 v45,v173,v45
v_mfma_f32_16x16x32_bf16 v[36:39],a[76:79],v[100:103],v[36:39]
s_waitcnt lgkmcnt(5)
v_fma_f32 v46,v158,v188,v46
v_fma_f32 v47,v159,v188,v47
v_mfma_f32_16x16x32_bf16 v[32:35],a[80:83],v[104:107],v[32:35]
ds_read_b128 v[64:67],v6 offset:0
v_cndmask_b32 v49,v52,v53,s[74:75]
v_mfma_f32_16x16x32_bf16 v[36:39],a[84:87],v[104:107],v[36:39]
s_waitcnt lgkmcnt(5)
v_cndmask_b32 v49,v49,v54,s[76:77]
v_cndmask_b32 v49,v49,v55,s[78:79]
v_mfma_f32_16x16x32_bf16 v[32:35],a[88:91],v[108:111],v[32:35]
ds_read_b128 v[68:71],v6 offset:1024
v_mul_f32 v174,v46,v46
v_mfma_f32_16x16x32_bf16 v[36:39],a[92:95],v[108:111],v[36:39]
s_waitcnt lgkmcnt(5)
ds_write_b64 v19,v[48:49]
v_mfma_f32_16x16x32_bf16 v[32:35],a[96:99],v[112:115],v[32:35]
ds_read_b128 v[72:75],v6 offset:2048
v_mul_f32 v175,v47,v47
v_mfma_f32_16x16x32_bf16 v[36:39],a[100:103],v[112:115],v[36:39]
s_waitcnt lgkmcnt(6)
v_fma_f32 v174,v174,v191,v190
v_fma_f32 v175,v175,v191,v190
v_mfma_f32_16x16x32_bf16 v[32:35],a[104:107],v[116:119],v[32:35]
ds_read_b128 v[76:79],v6 offset:3072
v_mul_f32 v174,v174,v46
v_mfma_f32_16x16x32_bf16 v[36:39],a[108:111],v[116:119],v[36:39]
s_waitcnt lgkmcnt(6)
v_exp_f32 v174,v174
v_mfma_f32_16x16x32_bf16 v[32:35],a[112:115],v[120:123],v[32:35]
s_waitcnt lgkmcnt(2)
s_barrier
ds_read_b128 v[80:83],v6 offset:4096
v_mfma_f32_16x16x32_bf16 v[36:39],a[116:119],v[120:123],v[36:39]
ds_read_b64 v[56:57],v20 offset:0
v_mul_f32 v175,v175,v47
v_mfma_f32_16x16x32_bf16 v[32:35],a[120:123],v[124:127],v[32:35]
ds_read_b128 v[84:87],v6 offset:5120
v_fma_f32 v174,v174,v189,v189
v_mfma_f32_16x16x32_bf16 v[36:39],a[124:127],v[124:127],v[36:39]
ds_read_b64 v[58:59],v20 offset:512
v_cvt_pk_bf16_f32 v176,v40,v41
v_mfma_f32_16x16x32_bf16 v[32:35],a[128:131],v[64:67],v[32:35]
ds_read_b128 v[88:91],v6 offset:6144
v_cvt_pk_bf16_f32 v177,v42,v43
v_mfma_f32_16x16x32_bf16 v[36:39],a[132:135],v[64:67],v[36:39]
ds_read_b64 v[60:61],v20 offset:1024
v_cvt_pk_bf16_f32 v178,v44,v45
v_mfma_f32_16x16x32_bf16 v[32:35],a[136:139],v[68:71],v[32:35]
ds_read_b128 v[92:95],v6 offset:7168
v_mfma_f32_16x16x32_bf16 v[36:39],a[140:143],v[68:71],v[36:39]
s_waitcnt lgkmcnt(8)
ds_read_b64 v[62:63],v20 offset:1536
v_mfma_f32_16x16x32_bf16 v[32:35],a[144:147],v[72:75],v[32:35]
ds_read_b128 v[96:99],v7 offset:0
v_mfma_f32_16x16x32_bf16 v[36:39],a[148:151],v[72:75],v[36:39]
s_waitcnt lgkmcnt(9)
buffer_load_dword v16,v2,s[20:23],s68 offen sc1
v_mfma_f32_16x16x32_bf16 v[32:35],a[152:155],v[76:79],v[32:35]
ds_read_b128 v[100:103],v7 offset:1024
v_mfma_f32_16x16x32_bf16 v[36:39],a[156:159],v[76:79],v[36:39]
s_waitcnt lgkmcnt(9)
v_exp_f32 v175,v175
v_mfma_f32_16x16x32_bf16 v[32:35],a[160:163],v[80:83],v[32:35]
ds_read_b128 v[104:107],v7 offset:2048
v_fma_f32 v175,v175,v189,v189
v_mfma_f32_16x16x32_bf16 v[36:39],a[164:167],v[80:83],v[36:39]
s_waitcnt lgkmcnt(8)
s_waitcnt lgkmcnt(3)
v_rcp_f32 v174,v174
v_mfma_f32_16x16x32_bf16 v[32:35],a[168:171],v[84:87],v[32:35]
ds_read_b128 v[108:111],v7 offset:3072
v_mul_f32 v46,v174,v46
v_mfma_f32_16x16x32_bf16 v[36:39],a[172:175],v[84:87],v[36:39]
v_rcp_f32 v175,v175
v_mfma_f32_16x16x32_bf16 v[32:35],a[176:179],v[88:91],v[32:35]
ds_read_b128 v[112:115],v7 offset:4096
v_mul_f32 v47,v175,v47
v_mfma_f32_16x16x32_bf16 v[36:39],a[180:183],v[88:91],v[36:39]
v_cvt_pk_bf16_f32 v179,v46,v47
v_add_f32 v56,v56,v58
v_mfma_f32_16x16x32_bf16 v[32:35],a[184:187],v[92:95],v[32:35]
ds_read_b128 v[116:119],v7 offset:5120
v_add_f32 v57,v57,v59
v_mfma_f32_16x16x32_bf16 v[36:39],a[188:191],v[92:95],v[36:39]
s_waitcnt lgkmcnt(5)
buffer_store_dwordx4 v[176:179],v0,s[20:23],s66 offen sc1
v_mfma_f32_16x16x32_bf16 v[32:35],a[192:195],v[96:99],v[32:35]
s_add_u32 s66,s66,32768
s_add_u32 s63,s63,1
ds_read_b128 v[120:123],v7 offset:6144
v_mfma_f32_16x16x32_bf16 v[36:39],a[196:199],v[96:99],v[36:39]
s_waitcnt lgkmcnt(5)
v_add_f32 v60,v60,v62
v_add_f32 v61,v61,v63
v_mfma_f32_16x16x32_bf16 v[32:35],a[200:203],v[100:103],v[32:35]
ds_read_b128 v[124:127],v7 offset:7168
v_add_f32 v56,v56,v60
v_mfma_f32_16x16x32_bf16 v[36:39],a[204:207],v[100:103],v[36:39]
s_waitcnt lgkmcnt(5)
v_add_f32 v57,v57,v61
v_mul_f32 v188,0xba800000,v56
v_mfma_f32_16x16x32_bf16 v[32:35],a[208:211],v[104:107],v[32:35]
s_add_u32 s55,s55,32768
v_fma_f32 v58,v188,v188,-v210
v_fma_f32 v57,v57,v211,-v58
v_mfma_f32_16x16x32_bf16 v[36:39],a[212:215],v[104:107],v[36:39]
s_waitcnt lgkmcnt(4)
s_and_b32 s55,s55,0x1ffff
v_max_f32 v57,v210,v57
v_mfma_f32_16x16x32_bf16 v[32:35],a[216:219],v[108:111],v[32:35]
v_rsq_f32 v58,v57
v_mfma_f32_16x16x32_bf16 v[36:39],a[220:223],v[108:111],v[36:39]
s_waitcnt lgkmcnt(3)
v_mul_f32 v189,v57,v58
v_mul_f32 v190,v209,v58
v_mfma_f32_16x16x32_bf16 v[32:35],a[224:227],v[112:115],v[32:35]
v_mul_f32 v59,v58,v58
v_mul_f32 v191,v208,v58
v_mfma_f32_16x16x32_bf16 v[36:39],a[228:231],v[112:115],v[36:39]
s_waitcnt lgkmcnt(2)
v_mul_f32 v191,v191,v59
v_add_u32 v4,s55,v8
v_mfma_f32_16x16x32_bf16 v[32:35],a[232:235],v[116:119],v[32:35]
v_add_u32 v5,s55,v9
v_add_u32 v6,s55,v10
v_mfma_f32_16x16x32_bf16 v[36:39],a[236:239],v[116:119],v[36:39]
s_waitcnt lgkmcnt(1)
v_add_u32 v7,s55,v11
v_mfma_f32_16x16x32_bf16 v[32:35],a[240:243],v[120:123],v[32:35]
v_mfma_f32_16x16x32_bf16 v[36:39],a[244:247],v[120:123],v[36:39]
s_waitcnt lgkmcnt(0)
v_mfma_f32_16x16x32_bf16 v[40:43],a[248:251],v[124:127],v[32:35]
v_mfma_f32_16x16x32_bf16 v[44:47],a[252:255],v[124:127],v[36:39]
s_waitcnt vmcnt(1)
v_cmp_gt_u32 vcc,s71,v16
s_add_u32 s60,s60,1
s_branch endN_311
BN_305:
s_waitcnt vmcnt(9)
ds_read_b128 v[64:67],v4 offset:0
s_waitcnt vmcnt(8)
ds_read_b128 v[68:71],v4 offset:1024
s_waitcnt vmcnt(7)
ds_read_b128 v[72:75],v4 offset:2048
s_waitcnt vmcnt(6)
ds_read_b128 v[76:79],v4 offset:3072
s_waitcnt lgkmcnt(3)
v_mfma_f32_16x16x32_bf16 v[32:35],a[0:3],v[64:67],0
s_add_u32 s71,s60,2
s_add_u32 s53,s60,3
s_mov_b32 s57,s63
v_mfma_f32_16x16x32_bf16 v[36:39],a[4:7],v[64:67],0
v_mfma_f32_16x16x32_bf16 v[48:51],v[12:15],v[64:67],0
v_mfma_f32_16x16x32_bf16 v[52:55],v[64:67],v[64:67],0
s_waitcnt lgkmcnt(2)
s_waitcnt vmcnt(5)
ds_read_b128 v[80:83],v4 offset:4096
v_mfma_f32_16x16x32_bf16 v[32:35],a[8:11],v[68:71],v[32:35]
v_mfma_f32_16x16x32_bf16 v[36:39],a[12:15],v[68:71],v[36:39]
v_mfma_f32_16x16x32_bf16 v[48:51],v[12:15],v[68:71],v[48:51]
v_mfma_f32_16x16x32_bf16 v[52:55],v[68:71],v[68:71],v[52:55]
s_waitcnt lgkmcnt(2)
s_waitcnt vmcnt(4)
ds_read_b128 v[84:87],v4 offset:5120
v_mfma_f32_16x16x32_bf16 v[32:35],a[16:19],v[72:75],v[32:35]
v_mfma_f32_16x16x32_bf16 v[36:39],a[20:23],v[72:75],v[36:39]
v_mfma_f32_16x16x32_bf16 v[48:51],v[12:15],v[72:75],v[48:51]
v_mfma_f32_16x16x32_bf16 v[52:55],v[72:75],v[72:75],v[52:55]
s_waitcnt lgkmcnt(2)
s_waitcnt vmcnt(3)
ds_read_b128 v[88:91],v4 offset:6144
v_mfma_f32_16x16x32_bf16 v[32:35],a[24:27],v[76:79],v[32:35]
v_mfma_f32_16x16x32_bf16 v[36:39],a[28:31],v[76:79],v[36:39]
v_mfma_f32_16x16x32_bf16 v[48:51],v[12:15],v[76:79],v[48:51]
v_mfma_f32_16x16x32_bf16 v[52:55],v[76:79],v[76:79],v[52:55]
s_waitcnt lgkmcnt(2)
s_waitcnt vmcnt(2)
ds_read_b128 v[92:95],v4 offset:7168
v_mfma_f32_16x16x32_bf16 v[32:35],a[32:35],v[80:83],v[32:35]
v_mfma_f32_16x16x32_bf16 v[36:39],a[36:39],v[80:83],v[36:39]
v_mfma_f32_16x16x32_bf16 v[48:51],v[12:15],v[80:83],v[48:51]
v_mfma_f32_16x16x32_bf16 v[52:55],v[80:83],v[80:83],v[52:55]
s_waitcnt lgkmcnt(2)
s_barrier
ds_read_b128 v[96:99],v5 offset:0
v_mfma_f32_16x16x32_bf16 v[32:35],a[40:43],v[84:87],v[32:35]
ds_read_b128 v[100:103],v5 offset:1024
v_mfma_f32_16x16x32_bf16 v[36:39],a[44:47],v[84:87],v[36:39]
ds_read_b128 v[104:107],v5 offset:2048
v_mfma_f32_16x16x32_bf16 v[48:51],v[12:15],v[84:87],v[48:51]
ds_read_b128 v[108:111],v5 offset:3072
v_mfma_f32_16x16x32_bf16 v[52:55],v[84:87],v[84:87],v[52:55]
s_waitcnt lgkmcnt(5)
v_mfma_f32_16x16x32_bf16 v[32:35],a[48:51],v[88:91],v[32:35]
ds_read_b128 v[112:115],v5 offset:4096
v_mfma_f32_16x16x32_bf16 v[36:39],a[52:55],v[88:91],v[36:39]
v_mfma_f32_16x16x32_bf16 v[48:51],v[12:15],v[88:91],v[48:51]
v_mfma_f32_16x16x32_bf16 v[52:55],v[88:91],v[88:91],v[52:55]
s_waitcnt lgkmcnt(5)
v_mfma_f32_16x16x32_bf16 v[32:35],a[56:59],v[92:95],v[32:35]
ds_read_b128 v[116:119],v5 offset:5120
v_mfma_f32_16x16x32_bf16 v[36:39],a[60:63],v[92:95],v[36:39]
v_mfma_f32_16x16x32_bf16 v[48:51],v[12:15],v[92:95],v[48:51]
v_mfma_f32_16x16x32_bf16 v[52:55],v[92:95],v[92:95],v[52:55]
s_waitcnt lgkmcnt(5)
v_mfma_f32_16x16x32_bf16 v[32:35],a[64:67],v[96:99],v[32:35]
ds_read_b128 v[120:123],v5 offset:6144
v_mfma_f32_16x16x32_bf16 v[36:39],a[68:71],v[96:99],v[36:39]
s_waitcnt lgkmcnt(5)
v_mfma_f32_16x16x32_bf16 v[32:35],a[72:75],v[100:103],v[32:35]
ds_read_b128 v[124:127],v5 offset:7168
v_mfma_f32_16x16x32_bf16 v[36:39],a[76:79],v[100:103],v[36:39]
s_waitcnt lgkmcnt(5)
v_mfma_f32_16x16x32_bf16 v[32:35],a[80:83],v[104:107],v[32:35]
ds_read_b128 v[64:67],v6 offset:0
v_cndmask_b32 v49,v52,v53,s[74:75]
v_mfma_f32_16x16x32_bf16 v[36:39],a[84:87],v[104:107],v[36:39]
s_waitcnt lgkmcnt(5)
v_cndmask_b32 v49,v49,v54,s[76:77]
v_cndmask_b32 v49,v49,v55,s[78:79]
v_mfma_f32_16x16x32_bf16 v[32:35],a[88:91],v[108:111],v[32:35]
ds_read_b128 v[68:71],v6 offset:1024
v_mfma_f32_16x16x32_bf16 v[36:39],a[92:95],v[108:111],v[36:39]
s_waitcnt lgkmcnt(5)
ds_write_b64 v19,v[48:49]
v_mfma_f32_16x16x32_bf16 v[32:35],a[96:99],v[112:115],v[32:35]
ds_read_b128 v[72:75],v6 offset:2048
v_mfma_f32_16x16x32_bf16 v[36:39],a[100:103],v[112:115],v[36:39]
s_waitcnt lgkmcnt(6)
v_mfma_f32_16x16x32_bf16 v[32:35],a[104:107],v[116:119],v[32:35]
ds_read_b128 v[76:79],v6 offset:3072
v_mfma_f32_16x16x32_bf16 v[36:39],a[108:111],v[116:119],v[36:39]
s_waitcnt lgkmcnt(6)
v_mfma_f32_16x16x32_bf16 v[32:35],a[112:115],v[120:123],v[32:35]
s_waitcnt lgkmcnt(2)
s_barrier
ds_read_b128 v[80:83],v6 offset:4096
v_mfma_f32_16x16x32_bf16 v[36:39],a[116:119],v[120:123],v[36:39]
ds_read_b64 v[56:57],v20 offset:0
v_mfma_f32_16x16x32_bf16 v[32:35],a[120:123],v[124:127],v[32:35]
ds_read_b128 v[84:87],v6 offset:5120
v_mfma_f32_16x16x32_bf16 v[36:39],a[124:127],v[124:127],v[36:39]
ds_read_b64 v[58:59],v20 offset:512
v_mfma_f32_16x16x32_bf16 v[32:35],a[128:131],v[64:67],v[32:35]
ds_read_b128 v[88:91],v6 offset:6144
v_mfma_f32_16x16x32_bf16 v[36:39],a[132:135],v[64:67],v[36:39]
ds_read_b64 v[60:61],v20 offset:1024
v_mfma_f32_16x16x32_bf16 v[32:35],a[136:139],v[68:71],v[32:35]
ds_read_b128 v[92:95],v6 offset:7168
v_mfma_f32_16x16x32_bf16 v[36:39],a[140:143],v[68:71],v[36:39]
s_waitcnt lgkmcnt(8)
ds_read_b64 v[62:63],v20 offset:1536
v_mfma_f32_16x16x32_bf16 v[32:35],a[144:147],v[72:75],v[32:35]
ds_read_b128 v[96:99],v7 offset:0
v_mfma_f32_16x16x32_bf16 v[36:39],a[148:151],v[72:75],v[36:39]
s_waitcnt lgkmcnt(9)
buffer_load_dword v16,v2,s[20:23],s68 offen sc1
v_mfma_f32_16x16x32_bf16 v[32:35],a[152:155],v[76:79],v[32:35]
ds_read_b128 v[100:103],v7 offset:1024
v_mfma_f32_16x16x32_bf16 v[36:39],a[156:159],v[76:79],v[36:39]
s_waitcnt lgkmcnt(9)
s_waitcnt vmcnt(2)
v_mov_b32 v17,s57
buffer_store_dword v17,v26,s[20:23],s69 offen
v_mfma_f32_16x16x32_bf16 v[32:35],a[160:163],v[80:83],v[32:35]
ds_read_b128 v[104:107],v7 offset:2048
v_mfma_f32_16x16x32_bf16 v[36:39],a[164:167],v[80:83],v[36:39]
s_waitcnt lgkmcnt(8)
s_waitcnt lgkmcnt(3)
v_add_f32 v56,v56,v58
v_mfma_f32_16x16x32_bf16 v[32:35],a[168:171],v[84:87],v[32:35]
ds_read_b128 v[108:111],v7 offset:3072
v_add_f32 v57,v57,v59
v_mfma_f32_16x16x32_bf16 v[36:39],a[172:175],v[84:87],v[36:39]
v_add_f32 v60,v60,v62
v_add_f32 v61,v61,v63
v_mfma_f32_16x16x32_bf16 v[32:35],a[176:179],v[88:91],v[32:35]
ds_read_b128 v[112:115],v7 offset:4096
v_add_f32 v56,v56,v60
v_mfma_f32_16x16x32_bf16 v[36:39],a[180:183],v[88:91],v[36:39]
v_add_f32 v57,v57,v61
v_mul_f32 v188,0xba800000,v56
v_mfma_f32_16x16x32_bf16 v[32:35],a[184:187],v[92:95],v[32:35]
ds_read_b128 v[116:119],v7 offset:5120
v_fma_f32 v58,v188,v188,-v210
v_mfma_f32_16x16x32_bf16 v[36:39],a[188:191],v[92:95],v[36:39]
s_waitcnt lgkmcnt(5)
v_fma_f32 v57,v57,v211,-v58
v_max_f32 v57,v210,v57
v_mfma_f32_16x16x32_bf16 v[32:35],a[192:195],v[96:99],v[32:35]
ds_read_b128 v[120:123],v7 offset:6144
v_mfma_f32_16x16x32_bf16 v[36:39],a[196:199],v[96:99],v[36:39]
s_waitcnt lgkmcnt(5)
v_rsq_f32 v58,v57
v_mfma_f32_16x16x32_bf16 v[32:35],a[200:203],v[100:103],v[32:35]
ds_read_b128 v[124:127],v7 offset:7168
v_mul_f32 v189,v57,v58
v_mfma_f32_16x16x32_bf16 v[36:39],a[204:207],v[100:103],v[36:39]
s_waitcnt lgkmcnt(5)
v_mul_f32 v190,v209,v58
v_mul_f32 v59,v58,v58
v_mfma_f32_16x16x32_bf16 v[32:35],a[208:211],v[104:107],v[32:35]
s_add_u32 s55,s55,32768
v_mul_f32 v191,v208,v58
v_mul_f32 v191,v191,v59
v_mfma_f32_16x16x32_bf16 v[36:39],a[212:215],v[104:107],v[36:39]
s_waitcnt lgkmcnt(4)
s_and_b32 s55,s55,0x1ffff
v_add_u32 v4,s55,v8
v_mfma_f32_16x16x32_bf16 v[32:35],a[216:219],v[108:111],v[32:35]
v_add_u32 v5,s55,v9
v_add_u32 v6,s55,v10
v_mfma_f32_16x16x32_bf16 v[36:39],a[220:223],v[108:111],v[36:39]
s_waitcnt lgkmcnt(3)
v_add_u32 v7,s55,v11
v_mfma_f32_16x16x32_bf16 v[32:35],a[224:227],v[112:115],v[32:35]
v_mfma_f32_16x16x32_bf16 v[36:39],a[228:231],v[112:115],v[36:39]
s_waitcnt lgkmcnt(2)
v_mfma_f32_16x16x32_bf16 v[32:35],a[232:235],v[116:119],v[32:35]
v_mfma_f32_16x16x32_bf16 v[36:39],a[236:239],v[116:119],v[36:39]
s_waitcnt lgkmcnt(1)
v_mfma_f32_16x16x32_bf16 v[32:35],a[240:243],v[120:123],v[32:35]
v_mfma_f32_16x16x32_bf16 v[36:39],a[244:247],v[120:123],v[36:39]
s_waitcnt lgkmcnt(0)
v_mfma_f32_16x16x32_bf16 v[40:43],a[248:251],v[124:127],v[32:35]
v_mfma_f32_16x16x32_bf16 v[44:47],a[252:255],v[124:127],v[36:39]
s_waitcnt vmcnt(1)
v_cmp_gt_u32 vcc,s71,v16
s_add_u32 s60,s60,1
endN_311:
s_cbranch_vccnz nb_308
s_mov_b32 m0,s70
s_nop 0
buffer_load_dwordx4 v3,s[20:23],s61 offen offset:0 lds
buffer_load_dwordx4 v3,s[20:23],s61 offen offset:1024 lds
buffer_load_dwordx4 v3,s[20:23],s61 offen offset:2048 lds
buffer_load_dwordx4 v3,s[20:23],s61 offen offset:3072 lds
s_add_u32 m0,s70,4096
s_nop 0
buffer_load_dwordx4 v3,s[20:23],s62 offen offset:0 lds
buffer_load_dwordx4 v3,s[20:23],s62 offen offset:1024 lds
buffer_load_dwordx4 v3,s[20:23],s62 offen offset:2048 lds
buffer_load_dwordx4 v3,s[20:23],s62 offen offset:3072 lds
s_add_u32 s61,s61,32768
s_add_u32 s62,s62,32768
s_add_u32 s70,s70,32768
s_and_b32 s70,s70,0x1ffff
s_mov_b32 s57,s63
v_pk_fma_f32 v[40:41],v[152:153],v[188:189],v[40:41] op_sel_hi:[1,0,1]
v_pk_fma_f32 v[42:43],v[154:155],v[188:189],v[42:43] op_sel_hi:[1,0,1]
v_pk_fma_f32 v[44:45],v[156:157],v[188:189],v[44:45] op_sel_hi:[1,0,1]
v_pk_fma_f32 v[46:47],v[158:159],v[188:189],v[46:47] op_sel_hi:[1,0,1]
v_pk_mul_f32 v[168:169],v[40:41],v[40:41]
v_pk_mul_f32 v[170:171],v[42:43],v[42:43]
v_pk_mul_f32 v[172:173],v[44:45],v[44:45]
v_pk_mul_f32 v[174:175],v[46:47],v[46:47]
v_pk_fma_f32 v[168:169],v[168:169],v[190:191],v[190:191] op_sel:[0,1,0] op_sel_hi:[1,1,0]
v_pk_fma_f32 v[170:171],v[170:171],v[190:191],v[190:191] op_sel:[0,1,0] op_sel_hi:[1,1,0]
v_pk_fma_f32 v[172:173],v[172:173],v[190:191],v[190:191] op_sel:[0,1,0] op_sel_hi:[1,1,0]
v_pk_fma_f32 v[174:175],v[174:175],v[190:191],v[190:191] op_sel:[0,1,0] op_sel_hi:[1,1,0]
v_pk_mul_f32 v[168:169],v[168:169],v[40:41]
v_pk_mul_f32 v[170:171],v[170:171],v[42:43]
v_pk_mul_f32 v[172:173],v[172:173],v[44:45]
v_pk_mul_f32 v[174:175],v[174:175],v[46:47]
v_exp_f32 v168,v168
v_exp_f32 v169,v169
v_exp_f32 v170,v170
v_exp_f32 v171,v171
v_exp_f32 v172,v172
v_exp_f32 v173,v173
v_exp_f32 v174,v174
v_exp_f32 v175,v175
v_pk_fma_f32 v[168:169],v[168:169],v[188:189],v[188:189] op_sel:[0,1,1] op_sel_hi:[1,1,1]
v_pk_fma_f32 v[170:171],v[170:171],v[188:189],v[188:189] op_sel:[0,1,1] op_sel_hi:[1,1,1]
v_pk_fma_f32 v[172:173],v[172:173],v[188:189],v[188:189] op_sel:[0,1,1] op_sel_hi:[1,1,1]
v_pk_fma_f32 v[174:175],v[174:175],v[188:189],v[188:189] op_sel:[0,1,1] op_sel_hi:[1,1,1]
v_rcp_f32 v168,v168
v_rcp_f32 v169,v169
v_rcp_f32 v170,v170
v_rcp_f32 v171,v171
v_rcp_f32 v172,v172
v_rcp_f32 v173,v173
v_rcp_f32 v174,v174
v_rcp_f32 v175,v175
v_pk_mul_f32 v[40:41],v[168:169],v[40:41]
v_pk_mul_f32 v[42:43],v[170:171],v[42:43]
v_pk_mul_f32 v[44:45],v[172:173],v[44:45]
v_pk_mul_f32 v[46:47],v[174:175],v[46:47]
v_cvt_pk_bf16_f32 v176,v40,v41
v_cvt_pk_bf16_f32 v177,v42,v43
v_cvt_pk_bf16_f32 v178,v44,v45
v_cvt_pk_bf16_f32 v179,v46,v47
buffer_store_dwordx4 v[176:179],v0,s[20:23],s66 offen sc1
s_add_u32 s66,s66,32768
s_add_u32 s63,s63,1
s_waitcnt vmcnt(9)
v_mov_b32 v17,s57
buffer_store_dword v17,v26,s[20:23],s69 offen
s_branch dec_307
nb_308:
buffer_load_dword v16,v2,s[20:23],s68 offen sc1
s_nop 3
s_mov_b32 s57,s63
v_pk_fma_f32 v[40:41],v[152:153],v[188:189],v[40:41] op_sel_hi:[1,0,1]
v_pk_fma_f32 v[42:43],v[154:155],v[188:189],v[42:43] op_sel_hi:[1,0,1]
v_pk_fma_f32 v[44:45],v[156:157],v[188:189],v[44:45] op_sel_hi:[1,0,1]
v_pk_fma_f32 v[46:47],v[158:159],v[188:189],v[46:47] op_sel_hi:[1,0,1]
v_pk_mul_f32 v[168:169],v[40:41],v[40:41]
v_pk_mul_f32 v[170:171],v[42:43],v[42:43]
v_pk_mul_f32 v[172:173],v[44:45],v[44:45]
v_pk_mul_f32 v[174:175],v[46:47],v[46:47]
v_pk_fma_f32 v[168:169],v[168:169],v[190:191],v[190:191] op_sel:[0,1,0] op_sel_hi:[1,1,0]
v_pk_fma_f32 v[170:171],v[170:171],v[190:191],v[190:191] op_sel:[0,1,0] op_sel_hi:[1,1,0]
v_pk_fma_f32 v[172:173],v[172:173],v[190:191],v[190:191] op_sel:[0,1,0] op_sel_hi:[1,1,0]
v_pk_fma_f32 v[174:175],v[174:175],v[190:191],v[190:191] op_sel:[0,1,0] op_sel_hi:[1,1,0]
v_pk_mul_f32 v[168:169],v[168:169],v[40:41]
v_pk_mul_f32 v[170:171],v[170:171],v[42:43]
v_pk_mul_f32 v[172:173],v[172:173],v[44:45]
v_pk_mul_f32 v[174:175],v[174:175],v[46:47]
v_exp_f32 v168,v168
v_exp_f32 v169,v169
v_exp_f32 v170,v170
v_exp_f32 v171,v171
v_exp_f32 v172,v172
v_exp_f32 v173,v173
v_exp_f32 v174,v174
v_exp_f32 v175,v175
v_pk_fma_f32 v[168:169],v[168:169],v[188:189],v[188:189] op_sel:[0,1,1] op_sel_hi:[1,1,1]
v_pk_fma_f32 v[170:171],v[170:171],v[188:189],v[188:189] op_sel:[0,1,1] op_sel_hi:[1,1,1]
v_pk_fma_f32 v[172:173],v[172:173],v[188:189],v[188:189] op_sel:[0,1,1] op_sel_hi:[1,1,1]
v_pk_fma_f32 v[174:175],v[174:175],v[188:189],v[188:189] op_sel:[0,1,1] op_sel_hi:[1,1,1]
v_rcp_f32 v168,v168
v_rcp_f32 v169,v169
v_rcp_f32 v170,v170
v_rcp_f32 v171,v171
v_rcp_f32 v172,v172
v_rcp_f32 v173,v173
v_rcp_f32 v174,v174
v_rcp_f32 v175,v175
v_pk_mul_f32 v[40:41],v[168:169],v[40:41]
v_pk_mul_f32 v[42:43],v[170:171],v[42:43]
v_pk_mul_f32 v[44:45],v[172:173],v[44:45]
v_pk_mul_f32 v[46:47],v[174:175],v[46:47]
v_cvt_pk_bf16_f32 v176,v40,v41
v_cvt_pk_bf16_f32 v177,v42,v43
v_cvt_pk_bf16_f32 v178,v44,v45
v_cvt_pk_bf16_f32 v179,v46,v47
buffer_store_dwordx4 v[176:179],v0,s[20:23],s66 offen sc1
s_add_u32 s66,s66,32768
s_add_u32 s63,s63,1
s_waitcnt vmcnt(2)
v_mov_b32 v17,s57
buffer_store_dword v17,v26,s[20:23],s69 offen
s_waitcnt vmcnt(2)
v_cmp_gt_u32 vcc,s71,v16
s_cbranch_vccz lag_306
s_waitcnt vmcnt(1)
v_mov_b32 v17,s63
buffer_store_dword v17,v26,s[20:23],s69 offen
s_cmp_ge_u32 s60,128
s_cbranch_scc1 done_294
plp_312:
buffer_load_dword v16,v2,s[20:23],s68 offen sc1
s_waitcnt vmcnt(0)
v_cmp_gt_u32 vcc,s71,v16
s_cbranch_vccz pok_313
s_sleep 4
s_sub_u32 s90,s90,1
s_cmp_gt_i32 s90,0
s_cbranch_scc1 plp_312
pok_313:
s_branch lag_306
lfar_301:
s_add_u32 s71,s60,1
s_add_u32 s53,s60,2
plp_321:
buffer_load_dword v16,v2,s[20:23],s68 offen sc1
s_waitcnt vmcnt(0)
v_cmp_gt_u32 vcc,s71,v16
s_cbranch_vccz pok_322
s_sleep 4
s_sub_u32 s90,s90,1
s_cmp_gt_i32 s90,0
s_cbranch_scc1 plp_321
pok_322:
lag_318:
s_mov_b32 m0,s70
s_nop 0
buffer_load_dwordx4 v3,s[20:23],s61 offen offset:0 lds
buffer_load_dwordx4 v3,s[20:23],s61 offen offset:1024 lds
buffer_load_dwordx4 v3,s[20:23],s61 offen offset:2048 lds
buffer_load_dwordx4 v3,s[20:23],s61 offen offset:3072 lds
s_add_u32 m0,s70,4096
s_nop 0
buffer_load_dwordx4 v3,s[20:23],s62 offen offset:0 lds
buffer_load_dwordx4 v3,s[20:23],s62 offen offset:1024 lds
buffer_load_dwordx4 v3,s[20:23],s62 offen offset:2048 lds
buffer_load_dwordx4 v3,s[20:23],s62 offen offset:3072 lds
s_add_u32 s61,s61,32768
s_add_u32 s62,s62,32768
s_add_u32 s70,s70,32768
s_and_b32 s70,s70,0x1ffff
buffer_load_dword v23,off,s[20:23],s66
buffer_load_dword v23,off,s[20:23],s66
dec_319:
v_cmp_gt_u32 vcc,s53,v16
s_cbranch_vccnz BN_317
BR_316:
s_waitcnt vmcnt(9)
ds_read_b128 v[64:67],v4 offset:0
s_waitcnt vmcnt(8)
ds_read_b128 v[68:71],v4 offset:1024
s_waitcnt vmcnt(7)
ds_read_b128 v[72:75],v4 offset:2048
s_waitcnt vmcnt(6)
ds_read_b128 v[76:79],v4 offset:3072
s_waitcnt lgkmcnt(3)
v_mfma_f32_16x16x32_bf16 v[32:35],a[0:3],v[64:67],0
s_add_u32 s71,s60,2
s_add_u32 s53,s60,3
s_mov_b32 s57,s63
v_mfma_f32_16x16x32_bf16 v[36:39],a[4:7],v[64:67],0
v_mfma_f32_16x16x32_bf16 v[48:51],v[12:15],v[64:67],0
v_mfma_f32_16x16x32_bf16 v[52:55],v[64:67],v[64:67],0
s_waitcnt lgkmcnt(2)
s_waitcnt vmcnt(5)
s_mov_b32 m0,s70
ds_read_b128 v[80:83],v4 offset:4096
v_mfma_f32_16x16x32_bf16 v[32:35],a[8:11],v[68:71],v[32:35]
buffer_load_dwordx4 v3,s[20:23],s61 offen offset:0 lds
v_mfma_f32_16x16x32_bf16 v[36:39],a[12:15],v[68:71],v[36:39]
v_mfma_f32_16x16x32_bf16 v[48:51],v[12:15],v[68:71],v[48:51]
v_mfma_f32_16x16x32_bf16 v[52:55],v[68:71],v[68:71],v[52:55]
s_waitcnt lgkmcnt(2)
s_waitcnt vmcnt(5)
ds_read_b128 v[84:87],v4 offset:5120
v_mfma_f32_16x16x32_bf16 v[32:35],a[16:19],v[72:75],v[32:35]
buffer_load_dwordx4 v3,s[20:23],s61 offen offset:1024 lds
v_mfma_f32_16x16x32_bf16 v[36:39],a[20:23],v[72:75],v[36:39]
v_mfma_f32_16x16x32_bf16 v[48:51],v[12:15],v[72:75],v[48:51]
v_mfma_f32_16x16x32_bf16 v[52:55],v[72:75],v[72:75],v[52:55]
s_waitcnt lgkmcnt(2)
s_waitcnt vmcnt(5)
ds_read_b128 v[88:91],v4 offset:6144
v_mfma_f32_16x16x32_bf16 v[32:35],a[24:27],v[76:79],v[32:35]
buffer_load_dwordx4 v3,s[20:23],s61 offen offset:2048 lds
v_mfma_f32_16x16x32_bf16 v[36:39],a[28:31],v[76:79],v[36:39]
v_mfma_f32_16x16x32_bf16 v[48:51],v[12:15],v[76:79],v[48:51]
v_mfma_f32_16x16x32_bf16 v[52:55],v[76:79],v[76:79],v[52:55]
s_waitcnt lgkmcnt(2)
s_waitcnt vmcnt(5)
ds_read_b128 v[92:95],v4 offset:7168
v_mfma_f32_16x16x32_bf16 v[32:35],a[32:35],v[80:83],v[32:35]
buffer_load_dwordx4 v3,s[20:23],s61 offen offset:3072 lds
v_mfma_f32_16x16x32_bf16 v[36:39],a[36:39],v[80:83],v[36:39]
v_mfma_f32_16x16x32_bf16 v[48:51],v[12:15],v[80:83],v[48:51]
v_mfma_f32_16x16x32_bf16 v[52:55],v[80:83],v[80:83],v[52:55]
s_waitcnt lgkmcnt(2)
s_barrier
ds_read_b128 v[96:99],v5 offset:0
v_mfma_f32_16x16x32_bf16 v[32:35],a[40:43],v[84:87],v[32:35]
ds_read_b128 v[100:103],v5 offset:1024
v_mfma_f32_16x16x32_bf16 v[36:39],a[44:47],v[84:87],v[36:39]
ds_read_b128 v[104:107],v5 offset:2048
v_mfma_f32_16x16x32_bf16 v[48:51],v[12:15],v[84:87],v[48:51]
s_add_u32 m0,s70,4096
ds_read_b128 v[108:111],v5 offset:3072
v_mfma_f32_16x16x32_bf16 v[52:55],v[84:87],v[84:87],v[52:55]
s_waitcnt lgkmcnt(5)
buffer_load_dwordx4 v3,s[20:23],s62 offen offset:0 lds
v_mfma_f32_16x16x32_bf16 v[32:35],a[48:51],v[88:91],v[32:35]
ds_read_b128 v[112:115],v5 offset:4096
v_mfma_f32_16x16x32_bf16 v[36:39],a[52:55],v[88:91],v[36:39]
buffer_load_dwordx4 v3,s[20:23],s62 offen offset:1024 lds
v_mfma_f32_16x16x32_bf16 v[48:51],v[12:15],v[88:91],v[48:51]
v_mfma_f32_16x16x32_bf16 v[52:55],v[88:91],v[88:91],v[52:55]
s_waitcnt lgkmcnt(5)
v_mfma_f32_16x16x32_bf16 v[32:35],a[56:59],v[92:95],v[32:35]
ds_read_b128 v[116:119],v5 offset:5120
v_mfma_f32_16x16x32_bf16 v[36:39],a[60:63],v[92:95],v[36:39]
buffer_load_dwordx4 v3,s[20:23],s62 offen offset:2048 lds
v_mfma_f32_16x16x32_bf16 v[48:51],v[12:15],v[92:95],v[48:51]
buffer_load_dword v16,v2,s[20:23],s68 offen sc1
v_mfma_f32_16x16x32_bf16 v[52:55],v[92:95],v[92:95],v[52:55]
s_waitcnt lgkmcnt(5)
v_mfma_f32_16x16x32_bf16 v[32:35],a[64:67],v[96:99],v[32:35]
ds_read_b128 v[120:123],v5 offset:6144
v_mfma_f32_16x16x32_bf16 v[36:39],a[68:71],v[96:99],v[36:39]
s_waitcnt lgkmcnt(5)
buffer_load_dwordx4 v3,s[20:23],s62 offen offset:3072 lds
v_mfma_f32_16x16x32_bf16 v[32:35],a[72:75],v[100:103],v[32:35]
ds_read_b128 v[124:127],v5 offset:7168
v_mfma_f32_16x16x32_bf16 v[36:39],a[76:79],v[100:103],v[36:39]
s_waitcnt lgkmcnt(5)
v_mfma_f32_16x16x32_bf16 v[32:35],a[80:83],v[104:107],v[32:35]
ds_read_b128 v[64:67],v6 offset:0
v_cndmask_b32 v49,v52,v53,s[74:75]
v_mfma_f32_16x16x32_bf16 v[36:39],a[84:87],v[104:107],v[36:39]
s_waitcnt lgkmcnt(5)
v_cndmask_b32 v49,v49,v54,s[76:77]
v_cndmask_b32 v49,v49,v55,s[78:79]
v_mfma_f32_16x16x32_bf16 v[32:35],a[88:91],v[108:111],v[32:35]
ds_read_b128 v[68:71],v6 offset:1024
v_mfma_f32_16x16x32_bf16 v[36:39],a[92:95],v[108:111],v[36:39]
s_waitcnt lgkmcnt(5)
ds_write_b64 v19,v[48:49]
v_mfma_f32_16x16x32_bf16 v[32:35],a[96:99],v[112:115],v[32:35]
ds_read_b128 v[72:75],v6 offset:2048
v_mfma_f32_16x16x32_bf16 v[36:39],a[100:103],v[112:115],v[36:39]
s_waitcnt lgkmcnt(6)
v_mfma_f32_16x16x32_bf16 v[32:35],a[104:107],v[116:119],v[32:35]
ds_read_b128 v[76:79],v6 offset:3072
v_mfma_f32_16x16x32_bf16 v[36:39],a[108:111],v[116:119],v[36:39]
s_waitcnt lgkmcnt(6)
v_mfma_f32_16x16x32_bf16 v[32:35],a[112:115],v[120:123],v[32:35]
s_waitcnt lgkmcnt(2)
s_barrier
ds_read_b128 v[80:83],v6 offset:4096
v_mfma_f32_16x16x32_bf16 v[36:39],a[116:119],v[120:123],v[36:39]
ds_read_b64 v[56:57],v20 offset:0
v_mfma_f32_16x16x32_bf16 v[32:35],a[120:123],v[124:127],v[32:35]
ds_read_b128 v[84:87],v6 offset:5120
v_mfma_f32_16x16x32_bf16 v[36:39],a[124:127],v[124:127],v[36:39]
ds_read_b64 v[58:59],v20 offset:512
v_mfma_f32_16x16x32_bf16 v[32:35],a[128:131],v[64:67],v[32:35]
ds_read_b128 v[88:91],v6 offset:6144
v_mfma_f32_16x16x32_bf16 v[36:39],a[132:135],v[64:67],v[36:39]
ds_read_b64 v[60:61],v20 offset:1024
v_mfma_f32_16x16x32_bf16 v[32:35],a[136:139],v[68:71],v[32:35]
ds_read_b128 v[92:95],v6 offset:7168
v_mfma_f32_16x16x32_bf16 v[36:39],a[140:143],v[68:71],v[36:39]
s_waitcnt lgkmcnt(8)
ds_read_b64 v[62:63],v20 offset:1536
v_mfma_f32_16x16x32_bf16 v[32:35],a[144:147],v[72:75],v[32:35]
ds_read_b128 v[96:99],v7 offset:0
v_mfma_f32_16x16x32_bf16 v[36:39],a[148:151],v[72:75],v[36:39]
s_waitcnt lgkmcnt(9)
s_waitcnt vmcnt(10)
v_mov_b32 v17,s57
buffer_store_dword v17,v26,s[20:23],s69 offen sc1
v_mfma_f32_16x16x32_bf16 v[32:35],a[152:155],v[76:79],v[32:35]
ds_read_b128 v[100:103],v7 offset:1024
v_mfma_f32_16x16x32_bf16 v[36:39],a[156:159],v[76:79],v[36:39]
s_waitcnt lgkmcnt(9)
v_mfma_f32_16x16x32_bf16 v[32:35],a[160:163],v[80:83],v[32:35]
ds_read_b128 v[104:107],v7 offset:2048
v_mfma_f32_16x16x32_bf16 v[36:39],a[164:167],v[80:83],v[36:39]
s_waitcnt lgkmcnt(8)
s_waitcnt lgkmcnt(3)
v_add_f32 v56,v56,v58
v_mfma_f32_16x16x32_bf16 v[32:35],a[168:171],v[84:87],v[32:35]
ds_read_b128 v[108:111],v7 offset:3072
v_add_f32 v57,v57,v59
v_mfma_f32_16x16x32_bf16 v[36:39],a[172:175],v[84:87],v[36:39]
v_add_f32 v60,v60,v62
v_add_f32 v61,v61,v63
v_mfma_f32_16x16x32_bf16 v[32:35],a[176:179],v[88:91],v[32:35]
ds_read_b128 v[112:115],v7 offset:4096
v_add_f32 v56,v56,v60
v_mfma_f32_16x16x32_bf16 v[36:39],a[180:183],v[88:91],v[36:39]
v_add_f32 v57,v57,v61
v_mul_f32 v188,0xba800000,v56
v_mfma_f32_16x16x32_bf16 v[32:35],a[184:187],v[92:95],v[32:35]
ds_read_b128 v[116:119],v7 offset:5120
v_fma_f32 v58,v188,v188,-v210
v_mfma_f32_16x16x32_bf16 v[36:39],a[188:191],v[92:95],v[36:39]
s_waitcnt lgkmcnt(5)
v_fma_f32 v57,v57,v211,-v58
v_max_f32 v57,v210,v57
v_mfma_f32_16x16x32_bf16 v[32:35],a[192:195],v[96:99],v[32:35]
ds_read_b128 v[120:123],v7 offset:6144
v_mfma_f32_16x16x32_bf16 v[36:39],a[196:199],v[96:99],v[36:39]
s_waitcnt lgkmcnt(5)
v_rsq_f32 v58,v57
v_mfma_f32_16x16x32_bf16 v[32:35],a[200:203],v[100:103],v[32:35]
ds_read_b128 v[124:127],v7 offset:7168
v_mul_f32 v189,v57,v58
v_mfma_f32_16x16x32_bf16 v[36:39],a[204:207],v[100:103],v[36:39]
s_waitcnt lgkmcnt(5)
v_mul_f32 v190,v209,v58
v_mul_f32 v59,v58,v58
v_mfma_f32_16x16x32_bf16 v[32:35],a[208:211],v[104:107],v[32:35]
s_add_u32 s61,s61,32768
v_mul_f32 v191,v208,v58
v_mul_f32 v191,v191,v59
v_mfma_f32_16x16x32_bf16 v[36:39],a[212:215],v[104:107],v[36:39]
s_waitcnt lgkmcnt(4)
s_add_u32 s62,s62,32768
s_add_u32 s70,s70,32768
v_mfma_f32_16x16x32_bf16 v[32:35],a[216:219],v[108:111],v[32:35]
s_and_b32 s70,s70,0x1ffff
s_add_u32 s55,s55,32768
s_and_b32 s55,s55,0x1ffff
v_mfma_f32_16x16x32_bf16 v[36:39],a[220:223],v[108:111],v[36:39]
s_waitcnt lgkmcnt(3)
v_add_u32 v4,s55,v8
v_add_u32 v5,s55,v9
v_mfma_f32_16x16x32_bf16 v[32:35],a[224:227],v[112:115],v[32:35]
v_add_u32 v6,s55,v10
v_add_u32 v7,s55,v11
v_mfma_f32_16x16x32_bf16 v[36:39],a[228:231],v[112:115],v[36:39]
s_waitcnt lgkmcnt(2)
s_waitcnt vmcnt(9)
ds_read_b128 v[64:67],v4 offset:0
v_mfma_f32_16x16x32_bf16 v[32:35],a[232:235],v[116:119],v[32:35]
s_waitcnt vmcnt(8)
ds_read_b128 v[68:71],v4 offset:1024
v_mfma_f32_16x16x32_bf16 v[36:39],a[236:239],v[116:119],v[36:39]
s_waitcnt lgkmcnt(3)
s_waitcnt vmcnt(7)
ds_read_b128 v[72:75],v4 offset:2048
v_mfma_f32_16x16x32_bf16 v[32:35],a[240:243],v[120:123],v[32:35]
v_mfma_f32_16x16x32_bf16 v[36:39],a[244:247],v[120:123],v[36:39]
s_waitcnt lgkmcnt(3)
v_mfma_f32_16x16x32_bf16 v[40:43],a[248:251],v[124:127],v[32:35]
v_mfma_f32_16x16x32_bf16 v[44:47],a[252:255],v[124:127],v[36:39]
s_waitcnt vmcnt(2)
v_cmp_gt_u32 vcc,s53,v16
s_add_u32 s60,s60,1
s_cbranch_vccnz WN_315
.p2align 6
WR_314:
s_waitcnt lgkmcnt(2)
v_mfma_f32_16x16x32_bf16 v[32:35],a[0:3],v[64:67],0
s_waitcnt vmcnt(6)
s_add_u32 s71,s60,2
ds_read_b128 v[76:79],v4 offset:3072
v_mfma_f32_16x16x32_bf16 v[36:39],a[4:7],v[64:67],0
s_add_u32 s53,s60,3
s_mov_b32 s57,s63
v_mfma_f32_16x16x32_bf16 v[48:51],v[12:15],v[64:67],0
s_mov_b32 m0,s70
v_fma_f32 v40,v152,v188,v40
v_fma_f32 v41,v153,v188,v41
v_mul_f32 v168,v40,v40
v_mfma_f32_16x16x32_bf16 v[52:55],v[64:67],v[64:67],0
s_waitcnt lgkmcnt(2)
buffer_load_dwordx4 v3,s[20:23],s61 offen offset:0 lds
v_mul_f32 v169,v41,v41
v_fma_f32 v168,v168,v191,v190
v_mfma_f32_16x16x32_bf16 v[32:35],a[8:11],v[68:71],v[32:35]
s_waitcnt vmcnt(6)
ds_read_b128 v[80:83],v4 offset:4096
v_fma_f32 v169,v169,v191,v190
v_mul_f32 v168,v168,v40
v_mfma_f32_16x16x32_bf16 v[36:39],a[12:15],v[68:71],v[36:39]
v_exp_f32 v168,v168
v_mul_f32 v169,v169,v41
v_mfma_f32_16x16x32_bf16 v[48:51],v[12:15],v[68:71],v[48:51]
v_exp_f32 v169,v169
v_fma_f32 v168,v168,v189,v189
v_mfma_f32_16x16x32_bf16 v[52:55],v[68:71],v[68:71],v[52:55]
s_waitcnt lgkmcnt(2)
buffer_load_dwordx4 v3,s[20:23],s61 offen offset:1024 lds
v_rcp_f32 v168,v168
v_mfma_f32_16x16x32_bf16 v[32:35],a[16:19],v[72:75],v[32:35]
s_waitcnt vmcnt(6)
ds_read_b128 v[84:87],v4 offset:5120
v_fma_f32 v169,v169,v189,v189
v_mul_f32 v40,v168,v40
v_mfma_f32_16x16x32_bf16 v[36:39],a[20:23],v[72:75],v[36:39]
v_rcp_f32 v169,v169
v_fma_f32 v42,v154,v188,v42
v_mfma_f32_16x16x32_bf16 v[48:51],v[12:15],v[72:75],v[48:51]
v_mul_f32 v41,v169,v41
v_fma_f32 v43,v155,v188,v43
v_mul_f32 v170,v42,v42
v_mfma_f32_16x16x32_bf16 v[52:55],v[72:75],v[72:75],v[52:55]
s_waitcnt lgkmcnt(2)
buffer_load_dwordx4 v3,s[20:23],s61 offen offset:2048 lds
v_mul_f32 v171,v43,v43
v_fma_f32 v170,v170,v191,v190
v_mfma_f32_16x16x32_bf16 v[32:35],a[24:27],v[76:79],v[32:35]
s_waitcnt vmcnt(6)
ds_read_b128 v[88:91],v4 offset:6144
v_fma_f32 v171,v171,v191,v190
v_mfma_f32_16x16x32_bf16 v[36:39],a[28:31],v[76:79],v[36:39]
v_mul_f32 v170,v170,v42
v_mul_f32 v171,v171,v43
v_mfma_f32_16x16x32_bf16 v[48:51],v[12:15],v[76:79],v[48:51]
v_exp_f32 v170,v170
v_mfma_f32_16x16x32_bf16 v[52:55],v[76:79],v[76:79],v[52:55]
s_waitcnt lgkmcnt(2)
buffer_load_dwordx4 v3,s[20:23],s61 offen offset:3072 lds
v_fma_f32 v170,v170,v189,v189
v_mfma_f32_16x16x32_bf16 v[32:35],a[32:35],v[80:83],v[32:35]
s_waitcnt vmcnt(5)
ds_read_b128 v[92:95],v4 offset:7168
v_fma_f32 v44,v156,v188,v44
v_mfma_f32_16x16x32_bf16 v[36:39],a[36:39],v[80:83],v[36:39]
s_barrier
ds_read_b128 v[96:99],v5 offset:0
v_fma_f32 v45,v157,v188,v45
v_mfma_f32_16x16x32_bf16 v[48:51],v[12:15],v[80:83],v[48:51]
ds_read_b128 v[100:103],v5 offset:1024
v_mul_f32 v172,v44,v44
v_mfma_f32_16x16x32_bf16 v[52:55],v[80:83],v[80:83],v[52:55]
s_waitcnt lgkmcnt(4)
ds_read_b128 v[104:107],v5 offset:2048
v_mul_f32 v173,v45,v45
v_mfma_f32_16x16x32_bf16 v[32:35],a[40:43],v[84:87],v[32:35]
s_add_u32 m0,s70,4096
ds_read_b128 v[108:111],v5 offset:3072
v_fma_f32 v172,v172,v191,v190
v_mfma_f32_16x16x32_bf16 v[36:39],a[44:47],v[84:87],v[36:39]
buffer_load_dwordx4 v3,s[20:23],s62 offen offset:0 lds
v_fma_f32 v173,v173,v191,v190
v_mfma_f32_16x16x32_bf16 v[48:51],v[12:15],v[84:87],v[48:51]
s_waitcnt vmcnt(5)
v_mov_b32 v17,s57
buffer_store_dword v17,v26,s[20:23],s69 offen sc1
v_mfma_f32_16x16x32_bf16 v[52:55],v[84:87],v[84:87],v[52:55]
s_waitcnt lgkmcnt(5)
v_exp_f32 v171,v171
v_mfma_f32_16x16x32_bf16 v[32:35],a[48:51],v[88:91],v[32:35]
ds_read_b128 v[112:115],v5 offset:4096
v_fma_f32 v171,v171,v189,v189
v_mfma_f32_16x16x32_bf16 v[36:39],a[52:55],v[88:91],v[36:39]
buffer_load_dwordx4 v3,s[20:23],s62 offen offset:1024 lds
v_mul_f32 v172,v172,v44
v_mfma_f32_16x16x32_bf16 v[48:51],v[12:15],v[88:91],v[48:51]
v_rcp_f32 v170,v170
v_mfma_f32_16x16x32_bf16 v[52:55],v[88:91],v[88:91],v[52:55]
s_waitcnt lgkmcnt(5)
v_rcp_f32 v171,v171
v_mfma_f32_16x16x32_bf16 v[32:35],a[56:59],v[92:95],v[32:35]
ds_read_b128 v[116:119],v5 offset:5120
v_mul_f32 v42,v170,v42
v_mfma_f32_16x16x32_bf16 v[36:39],a[60:63],v[92:95],v[36:39]
buffer_load_dwordx4 v3,s[20:23],s62 offen offset:2048 lds
v_mul_f32 v43,v171,v43
v_mfma_f32_16x16x32_bf16 v[48:51],v[12:15],v[92:95],v[48:51]
buffer_load_dword v16,v2,s[20:23],s68 offen sc1
v_mul_f32 v173,v173,v45
v_mfma_f32_16x16x32_bf16 v[52:55],v[92:95],v[92:95],v[52:55]
s_waitcnt lgkmcnt(5)
v_exp_f32 v172,v172
v_mfma_f32_16x16x32_bf16 v[32:35],a[64:67],v[96:99],v[32:35]
ds_read_b128 v[120:123],v5 offset:6144
v_fma_f32 v172,v172,v189,v189
v_mfma_f32_16x16x32_bf16 v[36:39],a[68:71],v[96:99],v[36:39]
s_waitcnt lgkmcnt(5)
buffer_load_dwordx4 v3,s[20:23],s62 offen offset:3072 lds
v_fma_f32 v46,v158,v188,v46
v_mfma_f32_16x16x32_bf16 v[32:35],a[72:75],v[100:103],v[32:35]
ds_read_b128 v[124:127],v5 offset:7168
v_fma_f32 v47,v159,v188,v47
v_mfma_f32_16x16x32_bf16 v[36:39],a[76:79],v[100:103],v[36:39]
s_waitcnt lgkmcnt(5)
v_exp_f32 v173,v173
v_mfma_f32_16x16x32_bf16 v[32:35],a[80:83],v[104:107],v[32:35]
ds_read_b128 v[64:67],v6 offset:0
v_cndmask_b32 v49,v52,v53,s[74:75]
v_mfma_f32_16x16x32_bf16 v[36:39],a[84:87],v[104:107],v[36:39]
s_waitcnt lgkmcnt(5)
v_cndmask_b32 v49,v49,v54,s[76:77]
v_cndmask_b32 v49,v49,v55,s[78:79]
v_mfma_f32_16x16x32_bf16 v[32:35],a[88:91],v[108:111],v[32:35]
ds_read_b128 v[68:71],v6 offset:1024
v_fma_f32 v173,v173,v189,v189
v_mfma_f32_16x16x32_bf16 v[36:39],a[92:95],v[108:111],v[36:39]
s_waitcnt lgkmcnt(5)
ds_write_b64 v19,v[48:49]
v_mfma_f32_16x16x32_bf16 v[32:35],a[96:99],v[112:115],v[32:35]
ds_read_b128 v[72:75],v6 offset:2048
v_mul_f32 v174,v46,v46
v_mfma_f32_16x16x32_bf16 v[36:39],a[100:103],v[112:115],v[36:39]
s_waitcnt lgkmcnt(6)
v_rcp_f32 v172,v172
v_mfma_f32_16x16x32_bf16 v[32:35],a[104:107],v[116:119],v[32:35]
ds_read_b128 v[76:79],v6 offset:3072
v_mul_f32 v44,v172,v44
v_mfma_f32_16x16x32_bf16 v[36:39],a[108:111],v[116:119],v[36:39]
s_waitcnt lgkmcnt(6)
v_rcp_f32 v173,v173
v_mfma_f32_16x16x32_bf16 v[32:35],a[112:115],v[120:123],v[32:35]
s_waitcnt lgkmcnt(2)
s_barrier
ds_read_b128 v[80:83],v6 offset:4096
v_mfma_f32_16x16x32_bf16 v[36:39],a[116:119],v[120:123],v[36:39]
ds_read_b64 v[56:57],v20 offset:0
v_mul_f32 v45,v173,v45
v_mfma_f32_16x16x32_bf16 v[32:35],a[120:123],v[124:127],v[32:35]
ds_read_b128 v[84:87],v6 offset:5120
v_mul_f32 v175,v47,v47
v_mfma_f32_16x16x32_bf16 v[36:39],a[124:127],v[124:127],v[36:39]
ds_read_b64 v[58:59],v20 offset:512
v_fma_f32 v174,v174,v191,v190
v_mfma_f32_16x16x32_bf16 v[32:35],a[128:131],v[64:67],v[32:35]
ds_read_b128 v[88:91],v6 offset:6144
v_fma_f32 v175,v175,v191,v190
v_mfma_f32_16x16x32_bf16 v[36:39],a[132:135],v[64:67],v[36:39]
ds_read_b64 v[60:61],v20 offset:1024
v_mul_f32 v174,v174,v46
v_mfma_f32_16x16x32_bf16 v[32:35],a[136:139],v[68:71],v[32:35]
ds_read_b128 v[92:95],v6 offset:7168
v_mul_f32 v175,v175,v47
v_mfma_f32_16x16x32_bf16 v[36:39],a[140:143],v[68:71],v[36:39]
s_waitcnt lgkmcnt(8)
ds_read_b64 v[62:63],v20 offset:1536
v_cvt_pk_bf16_f32 v176,v40,v41
v_mfma_f32_16x16x32_bf16 v[32:35],a[144:147],v[72:75],v[32:35]
ds_read_b128 v[96:99],v7 offset:0
v_cvt_pk_bf16_f32 v177,v42,v43
v_mfma_f32_16x16x32_bf16 v[36:39],a[148:151],v[72:75],v[36:39]
s_waitcnt lgkmcnt(9)
v_exp_f32 v174,v174
v_mfma_f32_16x16x32_bf16 v[32:35],a[152:155],v[76:79],v[32:35]
ds_read_b128 v[100:103],v7 offset:1024
v_fma_f32 v174,v174,v189,v189
v_mfma_f32_16x16x32_bf16 v[36:39],a[156:159],v[76:79],v[36:39]
s_waitcnt lgkmcnt(9)
v_exp_f32 v175,v175
v_mfma_f32_16x16x32_bf16 v[32:35],a[160:163],v[80:83],v[32:35]
ds_read_b128 v[104:107],v7 offset:2048
v_fma_f32 v175,v175,v189,v189
v_mfma_f32_16x16x32_bf16 v[36:39],a[164:167],v[80:83],v[36:39]
s_waitcnt lgkmcnt(8)
s_waitcnt lgkmcnt(3)
v_rcp_f32 v174,v174
v_mfma_f32_16x16x32_bf16 v[32:35],a[168:171],v[84:87],v[32:35]
ds_read_b128 v[108:111],v7 offset:3072
v_mul_f32 v46,v174,v46
v_mfma_f32_16x16x32_bf16 v[36:39],a[172:175],v[84:87],v[36:39]
v_rcp_f32 v175,v175
v_mfma_f32_16x16x32_bf16 v[32:35],a[176:179],v[88:91],v[32:35]
ds_read_b128 v[112:115],v7 offset:4096
v_mul_f32 v47,v175,v47
v_mfma_f32_16x16x32_bf16 v[36:39],a[180:183],v[88:91],v[36:39]
v_cvt_pk_bf16_f32 v178,v44,v45
v_cvt_pk_bf16_f32 v179,v46,v47
v_mfma_f32_16x16x32_bf16 v[32:35],a[184:187],v[92:95],v[32:35]
ds_read_b128 v[116:119],v7 offset:5120
v_add_f32 v56,v56,v58
v_mfma_f32_16x16x32_bf16 v[36:39],a[188:191],v[92:95],v[36:39]
s_waitcnt lgkmcnt(5)
buffer_store_dwordx4 v[176:179],v0,s[20:23],s66 offen sc1
v_mfma_f32_16x16x32_bf16 v[32:35],a[192:195],v[96:99],v[32:35]
s_add_u32 s66,s66,32768
s_add_u32 s63,s63,1
ds_read_b128 v[120:123],v7 offset:6144
v_mfma_f32_16x16x32_bf16 v[36:39],a[196:199],v[96:99],v[36:39]
s_waitcnt lgkmcnt(5)
v_add_f32 v57,v57,v59
v_add_f32 v60,v60,v62
v_mfma_f32_16x16x32_bf16 v[32:35],a[200:203],v[100:103],v[32:35]
ds_read_b128 v[124:127],v7 offset:7168
v_add_f32 v61,v61,v63
v_mfma_f32_16x16x32_bf16 v[36:39],a[204:207],v[100:103],v[36:39]
s_waitcnt lgkmcnt(5)
v_add_f32 v56,v56,v60
v_add_f32 v57,v57,v61
v_mfma_f32_16x16x32_bf16 v[32:35],a[208:211],v[104:107],v[32:35]
s_add_u32 s61,s61,32768
v_mul_f32 v188,0xba800000,v56
v_fma_f32 v58,v188,v188,-v210
v_mfma_f32_16x16x32_bf16 v[36:39],a[212:215],v[104:107],v[36:39]
s_waitcnt lgkmcnt(4)
v_fma_f32 v57,v57,v211,-v58
v_max_f32 v57,v210,v57
v_mfma_f32_16x16x32_bf16 v[32:35],a[216:219],v[108:111],v[32:35]
s_add_u32 s62,s62,32768
v_rsq_f32 v58,v57
v_mfma_f32_16x16x32_bf16 v[36:39],a[220:223],v[108:111],v[36:39]
s_waitcnt lgkmcnt(3)
v_mul_f32 v189,v57,v58
v_mul_f32 v190,v209,v58
v_mfma_f32_16x16x32_bf16 v[32:35],a[224:227],v[112:115],v[32:35]
s_add_u32 s70,s70,32768
v_mul_f32 v59,v58,v58
v_mul_f32 v191,v208,v58
v_mfma_f32_16x16x32_bf16 v[36:39],a[228:231],v[112:115],v[36:39]
s_waitcnt lgkmcnt(2)
s_and_b32 s70,s70,0x1ffff
v_mul_f32 v191,v191,v59
v_mfma_f32_16x16x32_bf16 v[32:35],a[232:235],v[116:119],v[32:35]
s_add_u32 s55,s55,32768
s_and_b32 s55,s55,0x1ffff
v_add_u32 v4,s55,v8
v_mfma_f32_16x16x32_bf16 v[36:39],a[236:239],v[116:119],v[36:39]
s_waitcnt lgkmcnt(1)
v_add_u32 v5,s55,v9
v_add_u32 v6,s55,v10
v_mfma_f32_16x16x32_bf16 v[32:35],a[240:243],v[120:123],v[32:35]
v_add_u32 v7,s55,v11
v_mfma_f32_16x16x32_bf16 v[36:39],a[244:247],v[120:123],v[36:39]
s_waitcnt lgkmcnt(0)
s_waitcnt vmcnt(10)
ds_read_b128 v[64:67],v4 offset:0
v_mfma_f32_16x16x32_bf16 v[40:43],a[248:251],v[124:127],v[32:35]
s_waitcnt vmcnt(9)
ds_read_b128 v[68:71],v4 offset:1024
v_mfma_f32_16x16x32_bf16 v[44:47],a[252:255],v[124:127],v[36:39]
s_waitcnt vmcnt(2)
v_cmp_gt_u32 vcc,s53,v16
ds_read_b128 v[72:75],v4 offset:2048
s_add_u32 s60,s60,1
s_cbranch_vccz WR_314
WN_315:
s_waitcnt lgkmcnt(2)
v_mfma_f32_16x16x32_bf16 v[32:35],a[0:3],v[64:67],0
s_waitcnt vmcnt(6)
s_add_u32 s71,s60,2
ds_read_b128 v[76:79],v4 offset:3072
v_mfma_f32_16x16x32_bf16 v[36:39],a[4:7],v[64:67],0
s_add_u32 s53,s60,3
s_mov_b32 s57,s63
v_mfma_f32_16x16x32_bf16 v[48:51],v[12:15],v[64:67],0
v_fma_f32 v40,v152,v188,v40
v_fma_f32 v41,v153,v188,v41
v_mul_f32 v168,v40,v40
v_mfma_f32_16x16x32_bf16 v[52:55],v[64:67],v[64:67],0
s_waitcnt lgkmcnt(2)
v_mul_f32 v169,v41,v41
v_fma_f32 v168,v168,v191,v190
v_fma_f32 v169,v169,v191,v190
v_mfma_f32_16x16x32_bf16 v[32:35],a[8:11],v[68:71],v[32:35]
s_waitcnt vmcnt(5)
ds_read_b128 v[80:83],v4 offset:4096
v_mul_f32 v168,v168,v40
v_mul_f32 v169,v169,v41
v_mfma_f32_16x16x32_bf16 v[36:39],a[12:15],v[68:71],v[36:39]
v_exp_f32 v168,v168
v_fma_f32 v42,v154,v188,v42
v_mfma_f32_16x16x32_bf16 v[48:51],v[12:15],v[68:71],v[48:51]
v_exp_f32 v169,v169
v_fma_f32 v168,v168,v189,v189
v_mfma_f32_16x16x32_bf16 v[52:55],v[68:71],v[68:71],v[52:55]
s_waitcnt lgkmcnt(2)
v_rcp_f32 v168,v168
v_fma_f32 v169,v169,v189,v189
v_mfma_f32_16x16x32_bf16 v[32:35],a[16:19],v[72:75],v[32:35]
s_waitcnt vmcnt(4)
ds_read_b128 v[84:87],v4 offset:5120
v_rcp_f32 v169,v169
v_mfma_f32_16x16x32_bf16 v[36:39],a[20:23],v[72:75],v[36:39]
v_mul_f32 v40,v168,v40
v_mul_f32 v41,v169,v41
v_fma_f32 v43,v155,v188,v43
v_mfma_f32_16x16x32_bf16 v[48:51],v[12:15],v[72:75],v[48:51]
v_mul_f32 v170,v42,v42
v_mul_f32 v171,v43,v43
v_mfma_f32_16x16x32_bf16 v[52:55],v[72:75],v[72:75],v[52:55]
s_waitcnt lgkmcnt(2)
v_fma_f32 v170,v170,v191,v190
v_fma_f32 v171,v171,v191,v190
v_mfma_f32_16x16x32_bf16 v[32:35],a[24:27],v[76:79],v[32:35]
s_waitcnt vmcnt(3)
ds_read_b128 v[88:91],v4 offset:6144
v_mul_f32 v170,v170,v42
v_mfma_f32_16x16x32_bf16 v[36:39],a[28:31],v[76:79],v[36:39]
v_exp_f32 v170,v170
v_mfma_f32_16x16x32_bf16 v[48:51],v[12:15],v[76:79],v[48:51]
v_mul_f32 v171,v171,v43
v_fma_f32 v170,v170,v189,v189
v_mfma_f32_16x16x32_bf16 v[52:55],v[76:79],v[76:79],v[52:55]
s_waitcnt lgkmcnt(2)
v_exp_f32 v171,v171
v_mfma_f32_16x16x32_bf16 v[32:35],a[32:35],v[80:83],v[32:35]
s_waitcnt vmcnt(1)
ds_read_b128 v[92:95],v4 offset:7168
v_fma_f32 v171,v171,v189,v189
v_mfma_f32_16x16x32_bf16 v[36:39],a[36:39],v[80:83],v[36:39]
s_barrier
ds_read_b128 v[96:99],v5 offset:0
v_fma_f32 v44,v156,v188,v44
v_mfma_f32_16x16x32_bf16 v[48:51],v[12:15],v[80:83],v[48:51]
ds_read_b128 v[100:103],v5 offset:1024
v_fma_f32 v45,v157,v188,v45
v_mfma_f32_16x16x32_bf16 v[52:55],v[80:83],v[80:83],v[52:55]
s_waitcnt lgkmcnt(4)
ds_read_b128 v[104:107],v5 offset:2048
v_mul_f32 v172,v44,v44
v_mfma_f32_16x16x32_bf16 v[32:35],a[40:43],v[84:87],v[32:35]
ds_read_b128 v[108:111],v5 offset:3072
v_mul_f32 v173,v45,v45
v_mfma_f32_16x16x32_bf16 v[36:39],a[44:47],v[84:87],v[36:39]
s_waitcnt vmcnt(0)
v_mov_b32 v17,s57
buffer_store_dword v17,v26,s[20:23],s69 offen sc1
v_mfma_f32_16x16x32_bf16 v[48:51],v[12:15],v[84:87],v[48:51]
v_rcp_f32 v170,v170
v_mfma_f32_16x16x32_bf16 v[52:55],v[84:87],v[84:87],v[52:55]
s_waitcnt lgkmcnt(5)
v_rcp_f32 v171,v171
v_mfma_f32_16x16x32_bf16 v[32:35],a[48:51],v[88:91],v[32:35]
ds_read_b128 v[112:115],v5 offset:4096
v_mul_f32 v42,v170,v42
v_mfma_f32_16x16x32_bf16 v[36:39],a[52:55],v[88:91],v[36:39]
v_mul_f32 v43,v171,v43
v_fma_f32 v172,v172,v191,v190
v_mfma_f32_16x16x32_bf16 v[48:51],v[12:15],v[88:91],v[48:51]
v_fma_f32 v173,v173,v191,v190
v_mul_f32 v172,v172,v44
v_mfma_f32_16x16x32_bf16 v[52:55],v[88:91],v[88:91],v[52:55]
s_waitcnt lgkmcnt(5)
v_exp_f32 v172,v172
v_mfma_f32_16x16x32_bf16 v[32:35],a[56:59],v[92:95],v[32:35]
ds_read_b128 v[116:119],v5 offset:5120
v_mul_f32 v173,v173,v45
v_mfma_f32_16x16x32_bf16 v[36:39],a[60:63],v[92:95],v[36:39]
v_exp_f32 v173,v173
v_mfma_f32_16x16x32_bf16 v[48:51],v[12:15],v[92:95],v[48:51]
v_fma_f32 v172,v172,v189,v189
v_fma_f32 v173,v173,v189,v189
v_mfma_f32_16x16x32_bf16 v[52:55],v[92:95],v[92:95],v[52:55]
s_waitcnt lgkmcnt(5)
v_rcp_f32 v172,v172
v_mfma_f32_16x16x32_bf16 v[32:35],a[64:67],v[96:99],v[32:35]
ds_read_b128 v[120:123],v5 offset:6144
v_mul_f32 v44,v172,v44
v_mfma_f32_16x16x32_bf16 v[36:39],a[68:71],v[96:99],v[36:39]
s_waitcnt lgkmcnt(5)
v_rcp_f32 v173,v173
v_mfma_f32_16x16x32_bf16 v[32:35],a[72:75],v[100:103],v[32:35]
ds_read_b128 v[124:127],v5 offset:7168
v_mul_f32 v45,v173,v45
v_mfma_f32_16x16x32_bf16 v[36:39],a[76:79],v[100:103],v[36:39]
s_waitcnt lgkmcnt(5)
v_fma_f32 v46,v158,v188,v46
v_fma_f32 v47,v159,v188,v47
v_mfma_f32_16x16x32_bf16 v[32:35],a[80:83],v[104:107],v[32:35]
ds_read_b128 v[64:67],v6 offset:0
v_cndmask_b32 v49,v52,v53,s[74:75]
v_mfma_f32_16x16x32_bf16 v[36:39],a[84:87],v[104:107],v[36:39]
s_waitcnt lgkmcnt(5)
v_cndmask_b32 v49,v49,v54,s[76:77]
v_cndmask_b32 v49,v49,v55,s[78:79]
v_mfma_f32_16x16x32_bf16 v[32:35],a[88:91],v[108:111],v[32:35]
ds_read_b128 v[68:71],v6 offset:1024
v_mul_f32 v174,v46,v46
v_mfma_f32_16x16x32_bf16 v[36:39],a[92:95],v[108:111],v[36:39]
s_waitcnt lgkmcnt(5)
ds_write_b64 v19,v[48:49]
v_mfma_f32_16x16x32_bf16 v[32:35],a[96:99],v[112:115],v[32:35]
ds_read_b128 v[72:75],v6 offset:2048
v_mul_f32 v175,v47,v47
v_mfma_f32_16x16x32_bf16 v[36:39],a[100:103],v[112:115],v[36:39]
s_waitcnt lgkmcnt(6)
v_fma_f32 v174,v174,v191,v190
v_fma_f32 v175,v175,v191,v190
v_mfma_f32_16x16x32_bf16 v[32:35],a[104:107],v[116:119],v[32:35]
ds_read_b128 v[76:79],v6 offset:3072
v_mul_f32 v174,v174,v46
v_mfma_f32_16x16x32_bf16 v[36:39],a[108:111],v[116:119],v[36:39]
s_waitcnt lgkmcnt(6)
v_exp_f32 v174,v174
v_mfma_f32_16x16x32_bf16 v[32:35],a[112:115],v[120:123],v[32:35]
s_waitcnt lgkmcnt(2)
s_barrier
ds_read_b128 v[80:83],v6 offset:4096
v_mfma_f32_16x16x32_bf16 v[36:39],a[116:119],v[120:123],v[36:39]
ds_read_b64 v[56:57],v20 offset:0
v_mul_f32 v175,v175,v47
v_mfma_f32_16x16x32_bf16 v[32:35],a[120:123],v[124:127],v[32:35]
ds_read_b128 v[84:87],v6 offset:5120
v_fma_f32 v174,v174,v189,v189
v_mfma_f32_16x16x32_bf16 v[36:39],a[124:127],v[124:127],v[36:39]
ds_read_b64 v[58:59],v20 offset:512
v_cvt_pk_bf16_f32 v176,v40,v41
v_mfma_f32_16x16x32_bf16 v[32:35],a[128:131],v[64:67],v[32:35]
ds_read_b128 v[88:91],v6 offset:6144
v_cvt_pk_bf16_f32 v177,v42,v43
v_mfma_f32_16x16x32_bf16 v[36:39],a[132:135],v[64:67],v[36:39]
ds_read_b64 v[60:61],v20 offset:1024
v_cvt_pk_bf16_f32 v178,v44,v45
v_mfma_f32_16x16x32_bf16 v[32:35],a[136:139],v[68:71],v[32:35]
ds_read_b128 v[92:95],v6 offset:7168
v_mfma_f32_16x16x32_bf16 v[36:39],a[140:143],v[68:71],v[36:39]
s_waitcnt lgkmcnt(8)
ds_read_b64 v[62:63],v20 offset:1536
v_mfma_f32_16x16x32_bf16 v[32:35],a[144:147],v[72:75],v[32:35]
ds_read_b128 v[96:99],v7 offset:0
v_mfma_f32_16x16x32_bf16 v[36:39],a[148:151],v[72:75],v[36:39]
s_waitcnt lgkmcnt(9)
buffer_load_dword v16,v2,s[20:23],s68 offen sc1
v_mfma_f32_16x16x32_bf16 v[32:35],a[152:155],v[76:79],v[32:35]
ds_read_b128 v[100:103],v7 offset:1024
v_mfma_f32_16x16x32_bf16 v[36:39],a[156:159],v[76:79],v[36:39]
s_waitcnt lgkmcnt(9)
v_exp_f32 v175,v175
v_mfma_f32_16x16x32_bf16 v[32:35],a[160:163],v[80:83],v[32:35]
ds_read_b128 v[104:107],v7 offset:2048
v_fma_f32 v175,v175,v189,v189
v_mfma_f32_16x16x32_bf16 v[36:39],a[164:167],v[80:83],v[36:39]
s_waitcnt lgkmcnt(8)
s_waitcnt lgkmcnt(3)
v_rcp_f32 v174,v174
v_mfma_f32_16x16x32_bf16 v[32:35],a[168:171],v[84:87],v[32:35]
ds_read_b128 v[108:111],v7 offset:3072
v_mul_f32 v46,v174,v46
v_mfma_f32_16x16x32_bf16 v[36:39],a[172:175],v[84:87],v[36:39]
v_rcp_f32 v175,v175
v_mfma_f32_16x16x32_bf16 v[32:35],a[176:179],v[88:91],v[32:35]
ds_read_b128 v[112:115],v7 offset:4096
v_mul_f32 v47,v175,v47
v_mfma_f32_16x16x32_bf16 v[36:39],a[180:183],v[88:91],v[36:39]
v_cvt_pk_bf16_f32 v179,v46,v47
v_add_f32 v56,v56,v58
v_mfma_f32_16x16x32_bf16 v[32:35],a[184:187],v[92:95],v[32:35]
ds_read_b128 v[116:119],v7 offset:5120
v_add_f32 v57,v57,v59
v_mfma_f32_16x16x32_bf16 v[36:39],a[188:191],v[92:95],v[36:39]
s_waitcnt lgkmcnt(5)
buffer_store_dwordx4 v[176:179],v0,s[20:23],s66 offen sc1
v_mfma_f32_16x16x32_bf16 v[32:35],a[192:195],v[96:99],v[32:35]
s_add_u32 s66,s66,32768
s_add_u32 s63,s63,1
ds_read_b128 v[120:123],v7 offset:6144
v_mfma_f32_16x16x32_bf16 v[36:39],a[196:199],v[96:99],v[36:39]
s_waitcnt lgkmcnt(5)
v_add_f32 v60,v60,v62
v_add_f32 v61,v61,v63
v_mfma_f32_16x16x32_bf16 v[32:35],a[200:203],v[100:103],v[32:35]
ds_read_b128 v[124:127],v7 offset:7168
v_add_f32 v56,v56,v60
v_mfma_f32_16x16x32_bf16 v[36:39],a[204:207],v[100:103],v[36:39]
s_waitcnt lgkmcnt(5)
v_add_f32 v57,v57,v61
v_mul_f32 v188,0xba800000,v56
v_mfma_f32_16x16x32_bf16 v[32:35],a[208:211],v[104:107],v[32:35]
s_add_u32 s55,s55,32768
v_fma_f32 v58,v188,v188,-v210
v_fma_f32 v57,v57,v211,-v58
v_mfma_f32_16x16x32_bf16 v[36:39],a[212:215],v[104:107],v[36:39]
s_waitcnt lgkmcnt(4)
s_and_b32 s55,s55,0x1ffff
v_max_f32 v57,v210,v57
v_mfma_f32_16x16x32_bf16 v[32:35],a[216:219],v[108:111],v[32:35]
v_rsq_f32 v58,v57
v_mfma_f32_16x16x32_bf16 v[36:39],a[220:223],v[108:111],v[36:39]
s_waitcnt lgkmcnt(3)
v_mul_f32 v189,v57,v58
v_mul_f32 v190,v209,v58
v_mfma_f32_16x16x32_bf16 v[32:35],a[224:227],v[112:115],v[32:35]
v_mul_f32 v59,v58,v58
v_mul_f32 v191,v208,v58
v_mfma_f32_16x16x32_bf16 v[36:39],a[228:231],v[112:115],v[36:39]
s_waitcnt lgkmcnt(2)
v_mul_f32 v191,v191,v59
v_add_u32 v4,s55,v8
v_mfma_f32_16x16x32_bf16 v[32:35],a[232:235],v[116:119],v[32:35]
v_add_u32 v5,s55,v9
v_add_u32 v6,s55,v10
v_mfma_f32_16x16x32_bf16 v[36:39],a[236:239],v[116:119],v[36:39]
s_waitcnt lgkmcnt(1)
v_add_u32 v7,s55,v11
v_mfma_f32_16x16x32_bf16 v[32:35],a[240:243],v[120:123],v[32:35]
v_mfma_f32_16x16x32_bf16 v[36:39],a[244:247],v[120:123],v[36:39]
s_waitcnt lgkmcnt(0)
v_mfma_f32_16x16x32_bf16 v[40:43],a[248:251],v[124:127],v[32:35]
v_mfma_f32_16x16x32_bf16 v[44:47],a[252:255],v[124:127],v[36:39]
s_waitcnt vmcnt(1)
v_cmp_gt_u32 vcc,s71,v16
s_add_u32 s60,s60,1
s_branch endN_323
BN_317:
s_waitcnt vmcnt(9)
ds_read_b128 v[64:67],v4 offset:0
s_waitcnt vmcnt(8)
ds_read_b128 v[68:71],v4 offset:1024
s_waitcnt vmcnt(7)
ds_read_b128 v[72:75],v4 offset:2048
s_waitcnt vmcnt(6)
ds_read_b128 v[76:79],v4 offset:3072
s_waitcnt lgkmcnt(3)
v_mfma_f32_16x16x32_bf16 v[32:35],a[0:3],v[64:67],0
s_add_u32 s71,s60,2
s_add_u32 s53,s60,3
s_mov_b32 s57,s63
v_mfma_f32_16x16x32_bf16 v[36:39],a[4:7],v[64:67],0
v_mfma_f32_16x16x32_bf16 v[48:51],v[12:15],v[64:67],0
v_mfma_f32_16x16x32_bf16 v[52:55],v[64:67],v[64:67],0
s_waitcnt lgkmcnt(2)
s_waitcnt vmcnt(5)
ds_read_b128 v[80:83],v4 offset:4096
v_mfma_f32_16x16x32_bf16 v[32:35],a[8:11],v[68:71],v[32:35]
v_mfma_f32_16x16x32_bf16 v[36:39],a[12:15],v[68:71],v[36:39]
v_mfma_f32_16x16x32_bf16 v[48:51],v[12:15],v[68:71],v[48:51]
v_mfma_f32_16x16x32_bf16 v[52:55],v[68:71],v[68:71],v[52:55]
s_waitcnt lgkmcnt(2)
s_waitcnt vmcnt(4)
ds_read_b128 v[84:87],v4 offset:5120
v_mfma_f32_16x16x32_bf16 v[32:35],a[16:19],v[72:75],v[32:35]
v_mfma_f32_16x16x32_bf16 v[36:39],a[20:23],v[72:75],v[36:39]
v_mfma_f32_16x16x32_bf16 v[48:51],v[12:15],v[72:75],v[48:51]
v_mfma_f32_16x16x32_bf16 v[52:55],v[72:75],v[72:75],v[52:55]
s_waitcnt lgkmcnt(2)
s_waitcnt vmcnt(3)
ds_read_b128 v[88:91],v4 offset:6144
v_mfma_f32_16x16x32_bf16 v[32:35],a[24:27],v[76:79],v[32:35]
v_mfma_f32_16x16x32_bf16 v[36:39],a[28:31],v[76:79],v[36:39]
v_mfma_f32_16x16x32_bf16 v[48:51],v[12:15],v[76:79],v[48:51]
v_mfma_f32_16x16x32_bf16 v[52:55],v[76:79],v[76:79],v[52:55]
s_waitcnt lgkmcnt(2)
s_waitcnt vmcnt(2)
ds_read_b128 v[92:95],v4 offset:7168
v_mfma_f32_16x16x32_bf16 v[32:35],a[32:35],v[80:83],v[32:35]
v_mfma_f32_16x16x32_bf16 v[36:39],a[36:39],v[80:83],v[36:39]
v_mfma_f32_16x16x32_bf16 v[48:51],v[12:15],v[80:83],v[48:51]
v_mfma_f32_16x16x32_bf16 v[52:55],v[80:83],v[80:83],v[52:55]
s_waitcnt lgkmcnt(2)
s_barrier
ds_read_b128 v[96:99],v5 offset:0
v_mfma_f32_16x16x32_bf16 v[32:35],a[40:43],v[84:87],v[32:35]
ds_read_b128 v[100:103],v5 offset:1024
v_mfma_f32_16x16x32_bf16 v[36:39],a[44:47],v[84:87],v[36:39]
ds_read_b128 v[104:107],v5 offset:2048
v_mfma_f32_16x16x32_bf16 v[48:51],v[12:15],v[84:87],v[48:51]
ds_read_b128 v[108:111],v5 offset:3072
v_mfma_f32_16x16x32_bf16 v[52:55],v[84:87],v[84:87],v[52:55]
s_waitcnt lgkmcnt(5)
v_mfma_f32_16x16x32_bf16 v[32:35],a[48:51],v[88:91],v[32:35]
ds_read_b128 v[112:115],v5 offset:4096
v_mfma_f32_16x16x32_bf16 v[36:39],a[52:55],v[88:91],v[36:39]
v_mfma_f32_16x16x32_bf16 v[48:51],v[12:15],v[88:91],v[48:51]
v_mfma_f32_16x16x32_bf16 v[52:55],v[88:91],v[88:91],v[52:55]
s_waitcnt lgkmcnt(5)
v_mfma_f32_16x16x32_bf16 v[32:35],a[56:59],v[92:95],v[32:35]
ds_read_b128 v[116:119],v5 offset:5120
v_mfma_f32_16x16x32_bf16 v[36:39],a[60:63],v[92:95],v[36:39]
v_mfma_f32_16x16x32_bf16 v[48:51],v[12:15],v[92:95],v[48:51]
v_mfma_f32_16x16x32_bf16 v[52:55],v[92:95],v[92:95],v[52:55]
s_waitcnt lgkmcnt(5)
v_mfma_f32_16x16x32_bf16 v[32:35],a[64:67],v[96:99],v[32:35]
ds_read_b128 v[120:123],v5 offset:6144
v_mfma_f32_16x16x32_bf16 v[36:39],a[68:71],v[96:99],v[36:39]
s_waitcnt lgkmcnt(5)
v_mfma_f32_16x16x32_bf16 v[32:35],a[72:75],v[100:103],v[32:35]
ds_read_b128 v[124:127],v5 offset:7168
v_mfma_f32_16x16x32_bf16 v[36:39],a[76:79],v[100:103],v[36:39]
s_waitcnt lgkmcnt(5)
v_mfma_f32_16x16x32_bf16 v[32:35],a[80:83],v[104:107],v[32:35]
ds_read_b128 v[64:67],v6 offset:0
v_cndmask_b32 v49,v52,v53,s[74:75]
v_mfma_f32_16x16x32_bf16 v[36:39],a[84:87],v[104:107],v[36:39]
s_waitcnt lgkmcnt(5)
v_cndmask_b32 v49,v49,v54,s[76:77]
v_cndmask_b32 v49,v49,v55,s[78:79]
v_mfma_f32_16x16x32_bf16 v[32:35],a[88:91],v[108:111],v[32:35]
ds_read_b128 v[68:71],v6 offset:1024
v_mfma_f32_16x16x32_bf16 v[36:39],a[92:95],v[108:111],v[36:39]
s_waitcnt lgkmcnt(5)
ds_write_b64 v19,v[48:49]
v_mfma_f32_16x16x32_bf16 v[32:35],a[96:99],v[112:115],v[32:35]
ds_read_b128 v[72:75],v6 offset:2048
v_mfma_f32_16x16x32_bf16 v[36:39],a[100:103],v[112:115],v[36:39]
s_waitcnt lgkmcnt(6)
v_mfma_f32_16x16x32_bf16 v[32:35],a[104:107],v[116:119],v[32:35]
ds_read_b128 v[76:79],v6 offset:3072
v_mfma_f32_16x16x32_bf16 v[36:39],a[108:111],v[116:119],v[36:39]
s_waitcnt lgkmcnt(6)
v_mfma_f32_16x16x32_bf16 v[32:35],a[112:115],v[120:123],v[32:35]
s_waitcnt lgkmcnt(2)
s_barrier
ds_read_b128 v[80:83],v6 offset:4096
v_mfma_f32_16x16x32_bf16 v[36:39],a[116:119],v[120:123],v[36:39]
ds_read_b64 v[56:57],v20 offset:0
v_mfma_f32_16x16x32_bf16 v[32:35],a[120:123],v[124:127],v[32:35]
ds_read_b128 v[84:87],v6 offset:5120
v_mfma_f32_16x16x32_bf16 v[36:39],a[124:127],v[124:127],v[36:39]
ds_read_b64 v[58:59],v20 offset:512
v_mfma_f32_16x16x32_bf16 v[32:35],a[128:131],v[64:67],v[32:35]
ds_read_b128 v[88:91],v6 offset:6144
v_mfma_f32_16x16x32_bf16 v[36:39],a[132:135],v[64:67],v[36:39]
ds_read_b64 v[60:61],v20 offset:1024
v_mfma_f32_16x16x32_bf16 v[32:35],a[136:139],v[68:71],v[32:35]
ds_read_b128 v[92:95],v6 offset:7168
v_mfma_f32_16x16x32_bf16 v[36:39],a[140:143],v[68:71],v[36:39]
s_waitcnt lgkmcnt(8)
ds_read_b64 v[62:63],v20 offset:1536
v_mfma_f32_16x16x32_bf16 v[32:35],a[144:147],v[72:75],v[32:35]
ds_read_b128 v[96:99],v7 offset:0
v_mfma_f32_16x16x32_bf16 v[36:39],a[148:151],v[72:75],v[36:39]
s_waitcnt lgkmcnt(9)
buffer_load_dword v16,v2,s[20:23],s68 offen sc1
v_mfma_f32_16x16x32_bf16 v[32:35],a[152:155],v[76:79],v[32:35]
ds_read_b128 v[100:103],v7 offset:1024
v_mfma_f32_16x16x32_bf16 v[36:39],a[156:159],v[76:79],v[36:39]
s_waitcnt lgkmcnt(9)
s_waitcnt vmcnt(2)
v_mov_b32 v17,s57
buffer_store_dword v17,v26,s[20:23],s69 offen sc1
v_mfma_f32_16x16x32_bf16 v[32:35],a[160:163],v[80:83],v[32:35]
ds_read_b128 v[104:107],v7 offset:2048
v_mfma_f32_16x16x32_bf16 v[36:39],a[164:167],v[80:83],v[36:39]
s_waitcnt lgkmcnt(8)
s_waitcnt lgkmcnt(3)
v_add_f32 v56,v56,v58
v_mfma_f32_16x16x32_bf16 v[32:35],a[168:171],v[84:87],v[32:35]
ds_read_b128 v[108:111],v7 offset:3072
v_add_f32 v57,v57,v59
v_mfma_f32_16x16x32_bf16 v[36:39],a[172:175],v[84:87],v[36:39]
v_add_f32 v60,v60,v62
v_add_f32 v61,v61,v63
v_mfma_f32_16x16x32_bf16 v[32:35],a[176:179],v[88:91],v[32:35]
ds_read_b128 v[112:115],v7 offset:4096
v_add_f32 v56,v56,v60
v_mfma_f32_16x16x32_bf16 v[36:39],a[180:183],v[88:91],v[36:39]
v_add_f32 v57,v57,v61
v_mul_f32 v188,0xba800000,v56
v_mfma_f32_16x16x32_bf16 v[32:35],a[184:187],v[92:95],v[32:35]
ds_read_b128 v[116:119],v7 offset:5120
v_fma_f32 v58,v188,v188,-v210
v_mfma_f32_16x16x32_bf16 v[36:39],a[188:191],v[92:95],v[36:39]
s_waitcnt lgkmcnt(5)
v_fma_f32 v57,v57,v211,-v58
v_max_f32 v57,v210,v57
v_mfma_f32_16x16x32_bf16 v[32:35],a[192:195],v[96:99],v[32:35]
ds_read_b128 v[120:123],v7 offset:6144
v_mfma_f32_16x16x32_bf16 v[36:39],a[196:199],v[96:99],v[36:39]
s_waitcnt lgkmcnt(5)
v_rsq_f32 v58,v57
v_mfma_f32_16x16x32_bf16 v[32:35],a[200:203],v[100:103],v[32:35]
ds_read_b128 v[124:127],v7 offset:7168
v_mul_f32 v189,v57,v58
v_mfma_f32_16x16x32_bf16 v[36:39],a[204:207],v[100:103],v[36:39]
s_waitcnt lgkmcnt(5)
v_mul_f32 v190,v209,v58
v_mul_f32 v59,v58,v58
v_mfma_f32_16x16x32_bf16 v[32:35],a[208:211],v[104:107],v[32:35]
s_add_u32 s55,s55,32768
v_mul_f32 v191,v208,v58
v_mul_f32 v191,v191,v59
v_mfma_f32_16x16x32_bf16 v[36:39],a[212:215],v[104:107],v[36:39]
s_waitcnt lgkmcnt(4)
s_and_b32 s55,s55,0x1ffff
v_add_u32 v4,s55,v8
v_mfma_f32_16x16x32_bf16 v[32:35],a[216:219],v[108:111],v[32:35]
v_add_u32 v5,s55,v9
v_add_u32 v6,s55,v10
v_mfma_f32_16x16x32_bf16 v[36:39],a[220:223],v[108:111],v[36:39]
s_waitcnt lgkmcnt(3)
v_add_u32 v7,s55,v11
v_mfma_f32_16x16x32_bf16 v[32:35],a[224:227],v[112:115],v[32:35]
v_mfma_f32_16x16x32_bf16 v[36:39],a[228:231],v[112:115],v[36:39]
s_waitcnt lgkmcnt(2)
v_mfma_f32_16x16x32_bf16 v[32:35],a[232:235],v[116:119],v[32:35]
v_mfma_f32_16x16x32_bf16 v[36:39],a[236:239],v[116:119],v[36:39]
s_waitcnt lgkmcnt(1)
v_mfma_f32_16x16x32_bf16 v[32:35],a[240:243],v[120:123],v[32:35]
v_mfma_f32_16x16x32_bf16 v[36:39],a[244:247],v[120:123],v[36:39]
s_waitcnt lgkmcnt(0)
v_mfma_f32_16x16x32_bf16 v[40:43],a[248:251],v[124:127],v[32:35]
v_mfma_f32_16x16x32_bf16 v[44:47],a[252:255],v[124:127],v[36:39]
s_waitcnt vmcnt(1)
v_cmp_gt_u32 vcc,s71,v16
s_add_u32 s60,s60,1
endN_323:
s_cbranch_vccnz nb_320
s_mov_b32 m0,s70
s_nop 0
buffer_load_dwordx4 v3,s[20:23],s61 offen offset:0 lds
buffer_load_dwordx4 v3,s[20:23],s61 offen offset:1024 lds
buffer_load_dwordx4 v3,s[20:23],s61 offen offset:2048 lds
buffer_load_dwordx4 v3,s[20:23],s61 offen offset:3072 lds
s_add_u32 m0,s70,4096
s_nop 0
buffer_load_dwordx4 v3,s[20:23],s62 offen offset:0 lds
buffer_load_dwordx4 v3,s[20:23],s62 offen offset:1024 lds
buffer_load_dwordx4 v3,s[20:23],s62 offen offset:2048 lds
buffer_load_dwordx4 v3,s[20:23],s62 offen offset:3072 lds
s_add_u32 s61,s61,32768
s_add_u32 s62,s62,32768
s_add_u32 s70,s70,32768
s_and_b32 s70,s70,0x1ffff
s_mov_b32 s57,s63
v_pk_fma_f32 v[40:41],v[152:153],v[188:189],v[40:41] op_sel_hi:[1,0,1]
v_pk_fma_f32 v[42:43],v[154:155],v[188:189],v[42:43] op_sel_hi:[1,0,1]
v_pk_fma_f32 v[44:45],v[156:157],v[188:189],v[44:45] op_sel_hi:[1,0,1]
v_pk_fma_f32 v[46:47],v[158:159],v[188:189],v[46:47] op_sel_hi:[1,0,1]
v_pk_mul_f32 v[168:169],v[40:41],v[40:41]
v_pk_mul_f32 v[170:171],v[42:43],v[42:43]
v_pk_mul_f32 v[172:173],v[44:45],v[44:45]
v_pk_mul_f32 v[174:175],v[46:47],v[46:47]
v_pk_fma_f32 v[168:169],v[168:169],v[190:191],v[190:191] op_sel:[0,1,0] op_sel_hi:[1,1,0]
v_pk_fma_f32 v[170:171],v[170:171],v[190:191],v[190:191] op_sel:[0,1,0] op_sel_hi:[1,1,0]
v_pk_fma_f32 v[172:173],v[172:173],v[190:191],v[190:191] op_sel:[0,1,0] op_sel_hi:[1,1,0]
v_pk_fma_f32 v[174:175],v[174:175],v[190:191],v[190:191] op_sel:[0,1,0] op_sel_hi:[1,1,0]
v_pk_mul_f32 v[168:169],v[168:169],v[40:41]
v_pk_mul_f32 v[170:171],v[170:171],v[42:43]
v_pk_mul_f32 v[172:173],v[172:173],v[44:45]
v_pk_mul_f32 v[174:175],v[174:175],v[46:47]
v_exp_f32 v168,v168
v_exp_f32 v169,v169
v_exp_f32 v170,v170
v_exp_f32 v171,v171
v_exp_f32 v172,v172
v_exp_f32 v173,v173
v_exp_f32 v174,v174
v_exp_f32 v175,v175
v_pk_fma_f32 v[168:169],v[168:169],v[188:189],v[188:189] op_sel:[0,1,1] op_sel_hi:[1,1,1]
v_pk_fma_f32 v[170:171],v[170:171],v[188:189],v[188:189] op_sel:[0,1,1] op_sel_hi:[1,1,1]
v_pk_fma_f32 v[172:173],v[172:173],v[188:189],v[188:189] op_sel:[0,1,1] op_sel_hi:[1,1,1]
v_pk_fma_f32 v[174:175],v[174:175],v[188:189],v[188:189] op_sel:[0,1,1] op_sel_hi:[1,1,1]
v_rcp_f32 v168,v168
v_rcp_f32 v169,v169
v_rcp_f32 v170,v170
v_rcp_f32 v171,v171
v_rcp_f32 v172,v172
v_rcp_f32 v173,v173
v_rcp_f32 v174,v174
v_rcp_f32 v175,v175
v_pk_mul_f32 v[40:41],v[168:169],v[40:41]
v_pk_mul_f32 v[42:43],v[170:171],v[42:43]
v_pk_mul_f32 v[44:45],v[172:173],v[44:45]
v_pk_mul_f32 v[46:47],v[174:175],v[46:47]
v_cvt_pk_bf16_f32 v176,v40,v41
v_cvt_pk_bf16_f32 v177,v42,v43
v_cvt_pk_bf16_f32 v178,v44,v45
v_cvt_pk_bf16_f32 v179,v46,v47
buffer_store_dwordx4 v[176:179],v0,s[20:23],s66 offen sc1
s_add_u32 s66,s66,32768
s_add_u32 s63,s63,1
s_waitcnt vmcnt(9)
v_mov_b32 v17,s57
buffer_store_dword v17,v26,s[20:23],s69 offen sc1
s_branch dec_319
nb_320:
buffer_load_dword v16,v2,s[20:23],s68 offen sc1
s_nop 3
s_mov_b32 s57,s63
v_pk_fma_f32 v[40:41],v[152:153],v[188:189],v[40:41] op_sel_hi:[1,0,1]
v_pk_fma_f32 v[42:43],v[154:155],v[188:189],v[42:43] op_sel_hi:[1,0,1]
v_pk_fma_f32 v[44:45],v[156:157],v[188:189],v[44:45] op_sel_hi:[1,0,1]
v_pk_fma_f32 v[46:47],v[158:159],v[188:189],v[46:47] op_sel_hi:[1,0,1]
v_pk_mul_f32 v[168:169],v[40:41],v[40:41]
v_pk_mul_f32 v[170:171],v[42:43],v[42:43]
v_pk_mul_f32 v[172:173],v[44:45],v[44:45]
v_pk_mul_f32 v[174:175],v[46:47],v[46:47]
v_pk_fma_f32 v[168:169],v[168:169],v[190:191],v[190:191] op_sel:[0,1,0] op_sel_hi:[1,1,0]
v_pk_fma_f32 v[170:171],v[170:171],v[190:191],v[190:191] op_sel:[0,1,0] op_sel_hi:[1,1,0]
v_pk_fma_f32 v[172:173],v[172:173],v[190:191],v[190:191] op_sel:[0,1,0] op_sel_hi:[1,1,0]
v_pk_fma_f32 v[174:175],v[174:175],v[190:191],v[190:191] op_sel:[0,1,0] op_sel_hi:[1,1,0]
v_pk_mul_f32 v[168:169],v[168:169],v[40:41]
v_pk_mul_f32 v[170:171],v[170:171],v[42:43]
v_pk_mul_f32 v[172:173],v[172:173],v[44:45]
v_pk_mul_f32 v[174:175],v[174:175],v[46:47]
v_exp_f32 v168,v168
v_exp_f32 v169,v169
v_exp_f32 v170,v170
v_exp_f32 v171,v171
v_exp_f32 v172,v172
v_exp_f32 v173,v173
v_exp_f32 v174,v174
v_exp_f32 v175,v175
v_pk_fma_f32 v[168:169],v[168:169],v[188:189],v[188:189] op_sel:[0,1,1] op_sel_hi:[1,1,1]
v_pk_fma_f32 v[170:171],v[170:171],v[188:189],v[188:189] op_sel:[0,1,1] op_sel_hi:[1,1,1]
v_pk_fma_f32 v[172:173],v[172:173],v[188:189],v[188:189] op_sel:[0,1,1] op_sel_hi:[1,1,1]
v_pk_fma_f32 v[174:175],v[174:175],v[188:189],v[188:189] op_sel:[0,1,1] op_sel_hi:[1,1,1]
v_rcp_f32 v168,v168
v_rcp_f32 v169,v169
v_rcp_f32 v170,v170
v_rcp_f32 v171,v171
v_rcp_f32 v172,v172
v_rcp_f32 v173,v173
v_rcp_f32 v174,v174
v_rcp_f32 v175,v175
v_pk_mul_f32 v[40:41],v[168:169],v[40:41]
v_pk_mul_f32 v[42:43],v[170:171],v[42:43]
v_pk_mul_f32 v[44:45],v[172:173],v[44:45]
v_pk_mul_f32 v[46:47],v[174:175],v[46:47]
v_cvt_pk_bf16_f32 v176,v40,v41
v_cvt_pk_bf16_f32 v177,v42,v43
v_cvt_pk_bf16_f32 v178,v44,v45
v_cvt_pk_bf16_f32 v179,v46,v47
buffer_store_dwordx4 v[176:179],v0,s[20:23],s66 offen sc1
s_add_u32 s66,s66,32768
s_add_u32 s63,s63,1
s_waitcnt vmcnt(2)
v_mov_b32 v17,s57
buffer_store_dword v17,v26,s[20:23],s69 offen sc1
s_waitcnt vmcnt(2)
v_cmp_gt_u32 vcc,s71,v16
s_cbranch_vccz lag_318
s_waitcnt vmcnt(1)
v_mov_b32 v17,s63
buffer_store_dword v17,v26,s[20:23],s69 offen sc1
s_cmp_ge_u32 s60,128
s_cbranch_scc1 done_294
plp_324:
buffer_load_dword v16,v2,s[20:23],s68 offen sc1
s_waitcnt vmcnt(0)
v_cmp_gt_u32 vcc,s71,v16
s_cbranch_vccz pok_325
s_sleep 4
s_sub_u32 s90,s90,1
s_cmp_gt_i32 s90,0
s_cbranch_scc1 plp_324
pok_325:
s_branch lag_318
done_294:
s_endpgm
fl_w2:
v_and_b32 v21,15,v1
v_lshrrev_b32 v22,4,v1
v_lshrrev_b32 v23,2,v21
v_and_b32 v24,3,v21
s_lshl_b32 s61,s50,15
v_lshl_add_u32 v25,v22,3,v23
s_load_dwordx2 s[4:5],s[0:1],72
s_mov_b32 s52,0
s_mov_b32 s53,s59
s_mul_i32 s54,s52,2097152
s_lshl_b32 s64,s53,8
s_add_u32 s54,s54,s64
s_lshl_b32 s64,s50,6
s_add_u32 s54,s54,s64
s_waitcnt lgkmcnt(0)
s_mov_b32 s28,s4
s_and_b32 s29,s5,0xffff
s_mov_b32 s30,0x200000
s_mov_b32 s31,0x20000
v_lshrrev_b32 v26,2,v1
v_and_b32 v27,3,v1
v_mul_u32_u24 v16,2048,v26
v_lshl_add_u32 v16,v27,4,v16
v_lshlrev_b32 v17,6,v25
v_lshl_add_u32 v17,v24,4,v17
v_add_u32 v17,s61,v17
s_xor_b32 s62,s50,0
s_mul_i32 s62,s62,524288
s_add_u32 s62,s62,s54
s_add_u32 m0,s61,0
s_nop 0
buffer_load_dwordx4 v16,s[28:31],s62 offen lds
s_add_u32 s62,s62,32768
s_add_u32 m0,m0,1024
s_waitcnt vmcnt(6)
buffer_load_dwordx4 v16,s[28:31],s62 offen lds
s_add_u32 s62,s62,32768
s_add_u32 m0,m0,1024
s_waitcnt vmcnt(6)
buffer_load_dwordx4 v16,s[28:31],s62 offen lds
s_add_u32 s62,s62,32768
s_add_u32 m0,m0,1024
s_waitcnt vmcnt(6)
buffer_load_dwordx4 v16,s[28:31],s62 offen lds
s_add_u32 s62,s62,32768
s_add_u32 m0,m0,1024
s_waitcnt vmcnt(6)
buffer_load_dwordx4 v16,s[28:31],s62 offen lds
s_add_u32 s62,s62,32768
s_add_u32 m0,m0,1024
s_waitcnt vmcnt(6)
buffer_load_dwordx4 v16,s[28:31],s62 offen lds
s_add_u32 s62,s62,32768
s_add_u32 m0,m0,1024
s_waitcnt vmcnt(6)
buffer_load_dwordx4 v16,s[28:31],s62 offen lds
s_add_u32 s62,s62,32768
s_add_u32 m0,m0,1024
s_waitcnt vmcnt(6)
buffer_load_dwordx4 v16,s[28:31],s62 offen lds
s_add_u32 s62,s62,32768
s_add_u32 m0,m0,1024
s_waitcnt vmcnt(6)
buffer_load_dwordx4 v16,s[28:31],s62 offen lds
s_add_u32 s62,s62,32768
s_add_u32 m0,m0,1024
s_waitcnt vmcnt(6)
buffer_load_dwordx4 v16,s[28:31],s62 offen lds
s_add_u32 s62,s62,32768
s_add_u32 m0,m0,1024
s_waitcnt vmcnt(6)
buffer_load_dwordx4 v16,s[28:31],s62 offen lds
s_add_u32 s62,s62,32768
s_add_u32 m0,m0,1024
s_waitcnt vmcnt(6)
buffer_load_dwordx4 v16,s[28:31],s62 offen lds
s_add_u32 s62,s62,32768
s_add_u32 m0,m0,1024
s_waitcnt vmcnt(6)
buffer_load_dwordx4 v16,s[28:31],s62 offen lds
s_add_u32 s62,s62,32768
s_add_u32 m0,m0,1024
s_waitcnt vmcnt(6)
buffer_load_dwordx4 v16,s[28:31],s62 offen lds
s_add_u32 s62,s62,32768
s_add_u32 m0,m0,1024
s_waitcnt vmcnt(6)
buffer_load_dwordx4 v16,s[28:31],s62 offen lds
s_add_u32 s62,s62,32768
s_add_u32 m0,m0,1024
s_waitcnt vmcnt(6)
buffer_load_dwordx4 v16,s[28:31],s62 offen lds
s_waitcnt vmcnt(6)
s_xor_b32 s62,s50,1
s_mul_i32 s62,s62,524288
s_add_u32 s62,s62,s54
s_add_u32 m0,s61,16384
s_nop 0
buffer_load_dwordx4 v16,s[28:31],s62 offen lds
s_add_u32 s62,s62,32768
s_add_u32 m0,m0,1024
s_waitcnt vmcnt(6)
buffer_load_dwordx4 v16,s[28:31],s62 offen lds
s_add_u32 s62,s62,32768
s_add_u32 m0,m0,1024
s_waitcnt vmcnt(6)
buffer_load_dwordx4 v16,s[28:31],s62 offen lds
s_add_u32 s62,s62,32768
s_add_u32 m0,m0,1024
s_waitcnt vmcnt(6)
buffer_load_dwordx4 v16,s[28:31],s62 offen lds
s_add_u32 s62,s62,32768
s_add_u32 m0,m0,1024
s_waitcnt vmcnt(6)
buffer_load_dwordx4 v16,s[28:31],s62 offen lds
s_add_u32 s62,s62,32768
s_add_u32 m0,m0,1024
s_waitcnt vmcnt(6)
buffer_load_dwordx4 v16,s[28:31],s62 offen lds
s_add_u32 s62,s62,32768
s_add_u32 m0,m0,1024
s_waitcnt vmcnt(6)
buffer_load_dwordx4 v16,s[28:31],s62 offen lds
s_add_u32 s62,s62,32768
s_add_u32 m0,m0,1024
s_waitcnt vmcnt(6)
buffer_load_dwordx4 v16,s[28:31],s62 offen lds
s_add_u32 s62,s62,32768
s_add_u32 m0,m0,1024
s_waitcnt vmcnt(6)
buffer_load_dwordx4 v16,s[28:31],s62 offen lds
s_add_u32 s62,s62,32768
s_add_u32 m0,m0,1024
s_waitcnt vmcnt(6)
buffer_load_dwordx4 v16,s[28:31],s62 offen lds
s_add_u32 s62,s62,32768
s_add_u32 m0,m0,1024
s_waitcnt vmcnt(6)
buffer_load_dwordx4 v16,s[28:31],s62 offen lds
s_add_u32 s62,s62,32768
s_add_u32 m0,m0,1024
s_waitcnt vmcnt(6)
buffer_load_dwordx4 v16,s[28:31],s62 offen lds
s_add_u32 s62,s62,32768
s_add_u32 m0,m0,1024
s_waitcnt vmcnt(6)
buffer_load_dwordx4 v16,s[28:31],s62 offen lds
s_add_u32 s62,s62,32768
s_add_u32 m0,m0,1024
s_waitcnt vmcnt(6)
buffer_load_dwordx4 v16,s[28:31],s62 offen lds
s_add_u32 s62,s62,32768
s_add_u32 m0,m0,1024
s_waitcnt vmcnt(6)
buffer_load_dwordx4 v16,s[28:31],s62 offen lds
s_add_u32 s62,s62,32768
s_add_u32 m0,m0,1024
s_waitcnt vmcnt(6)
buffer_load_dwordx4 v16,s[28:31],s62 offen lds
s_waitcnt vmcnt(6)
s_waitcnt vmcnt(16)
ds_read_b64_tr_b16 a[0:1],v17 offset:0
ds_read_b64_tr_b16 a[2:3],v17 offset:256
ds_read_b64_tr_b16 a[4:5],v17 offset:8
ds_read_b64_tr_b16 a[6:7],v17 offset:264
ds_read_b64_tr_b16 a[8:9],v17 offset:2048
ds_read_b64_tr_b16 a[10:11],v17 offset:2304
ds_read_b64_tr_b16 a[12:13],v17 offset:2056
ds_read_b64_tr_b16 a[14:15],v17 offset:2312
ds_read_b64_tr_b16 a[16:17],v17 offset:4096
ds_read_b64_tr_b16 a[18:19],v17 offset:4352
ds_read_b64_tr_b16 a[20:21],v17 offset:4104
ds_read_b64_tr_b16 a[22:23],v17 offset:4360
s_waitcnt lgkmcnt(0)
ds_read_b64_tr_b16 a[24:25],v17 offset:6144
ds_read_b64_tr_b16 a[26:27],v17 offset:6400
ds_read_b64_tr_b16 a[28:29],v17 offset:6152
ds_read_b64_tr_b16 a[30:31],v17 offset:6408
ds_read_b64_tr_b16 a[32:33],v17 offset:8192
ds_read_b64_tr_b16 a[34:35],v17 offset:8448
ds_read_b64_tr_b16 a[36:37],v17 offset:8200
ds_read_b64_tr_b16 a[38:39],v17 offset:8456
ds_read_b64_tr_b16 a[40:41],v17 offset:10240
ds_read_b64_tr_b16 a[42:43],v17 offset:10496
ds_read_b64_tr_b16 a[44:45],v17 offset:10248
ds_read_b64_tr_b16 a[46:47],v17 offset:10504
s_waitcnt lgkmcnt(0)
ds_read_b64_tr_b16 a[48:49],v17 offset:12288
ds_read_b64_tr_b16 a[50:51],v17 offset:12544
ds_read_b64_tr_b16 a[52:53],v17 offset:12296
ds_read_b64_tr_b16 a[54:55],v17 offset:12552
ds_read_b64_tr_b16 a[56:57],v17 offset:14336
ds_read_b64_tr_b16 a[58:59],v17 offset:14592
ds_read_b64_tr_b16 a[60:61],v17 offset:14344
ds_read_b64_tr_b16 a[62:63],v17 offset:14600
s_waitcnt lgkmcnt(0)
s_xor_b32 s62,s50,2
s_mul_i32 s62,s62,524288
s_add_u32 s62,s62,s54
s_add_u32 m0,s61,0
s_nop 0
buffer_load_dwordx4 v16,s[28:31],s62 offen lds
s_add_u32 s62,s62,32768
s_add_u32 m0,m0,1024
s_waitcnt vmcnt(6)
buffer_load_dwordx4 v16,s[28:31],s62 offen lds
s_add_u32 s62,s62,32768
s_add_u32 m0,m0,1024
s_waitcnt vmcnt(6)
buffer_load_dwordx4 v16,s[28:31],s62 offen lds
s_add_u32 s62,s62,32768
s_add_u32 m0,m0,1024
s_waitcnt vmcnt(6)
buffer_load_dwordx4 v16,s[28:31],s62 offen lds
s_add_u32 s62,s62,32768
s_add_u32 m0,m0,1024
s_waitcnt vmcnt(6)
buffer_load_dwordx4 v16,s[28:31],s62 offen lds
s_add_u32 s62,s62,32768
s_add_u32 m0,m0,1024
s_waitcnt vmcnt(6)
buffer_load_dwordx4 v16,s[28:31],s62 offen lds
s_add_u32 s62,s62,32768
s_add_u32 m0,m0,1024
s_waitcnt vmcnt(6)
buffer_load_dwordx4 v16,s[28:31],s62 offen lds
s_add_u32 s62,s62,32768
s_add_u32 m0,m0,1024
s_waitcnt vmcnt(6)
buffer_load_dwordx4 v16,s[28:31],s62 offen lds
s_add_u32 s62,s62,32768
s_add_u32 m0,m0,1024
s_waitcnt vmcnt(6)
buffer_load_dwordx4 v16,s[28:31],s62 offen lds
s_add_u32 s62,s62,32768
s_add_u32 m0,m0,1024
s_waitcnt vmcnt(6)
buffer_load_dwordx4 v16,s[28:31],s62 offen lds
s_add_u32 s62,s62,32768
s_add_u32 m0,m0,1024
s_waitcnt vmcnt(6)
buffer_load_dwordx4 v16,s[28:31],s62 offen lds
s_add_u32 s62,s62,32768
s_add_u32 m0,m0,1024
s_waitcnt vmcnt(6)
buffer_load_dwordx4 v16,s[28:31],s62 offen lds
s_add_u32 s62,s62,32768
s_add_u32 m0,m0,1024
s_waitcnt vmcnt(6)
buffer_load_dwordx4 v16,s[28:31],s62 offen lds
s_add_u32 s62,s62,32768
s_add_u32 m0,m0,1024
s_waitcnt vmcnt(6)
buffer_load_dwordx4 v16,s[28:31],s62 offen lds
s_add_u32 s62,s62,32768
s_add_u32 m0,m0,1024
s_waitcnt vmcnt(6)
buffer_load_dwordx4 v16,s[28:31],s62 offen lds
s_add_u32 s62,s62,32768
s_add_u32 m0,m0,1024
s_waitcnt vmcnt(6)
buffer_load_dwordx4 v16,s[28:31],s62 offen lds
s_waitcnt vmcnt(6)
s_waitcnt vmcnt(16)
ds_read_b64_tr_b16 a[64:65],v17 offset:16384
ds_read_b64_tr_b16 a[66:67],v17 offset:16640
ds_read_b64_tr_b16 a[68:69],v17 offset:16392
ds_read_b64_tr_b16 a[70:71],v17 offset:16648
ds_read_b64_tr_b16 a[72:73],v17 offset:18432
ds_read_b64_tr_b16 a[74:75],v17 offset:18688
ds_read_b64_tr_b16 a[76:77],v17 offset:18440
ds_read_b64_tr_b16 a[78:79],v17 offset:18696
ds_read_b64_tr_b16 a[80:81],v17 offset:20480
ds_read_b64_tr_b16 a[82:83],v17 offset:20736
ds_read_b64_tr_b16 a[84:85],v17 offset:20488
ds_read_b64_tr_b16 a[86:87],v17 offset:20744
s_waitcnt lgkmcnt(0)
ds_read_b64_tr_b16 a[88:89],v17 offset:22528
ds_read_b64_tr_b16 a[90:91],v17 offset:22784
ds_read_b64_tr_b16 a[92:93],v17 offset:22536
ds_read_b64_tr_b16 a[94:95],v17 offset:22792
ds_read_b64_tr_b16 a[96:97],v17 offset:24576
ds_read_b64_tr_b16 a[98:99],v17 offset:24832
ds_read_b64_tr_b16 a[100:101],v17 offset:24584
ds_read_b64_tr_b16 a[102:103],v17 offset:24840
ds_read_b64_tr_b16 a[104:105],v17 offset:26624
ds_read_b64_tr_b16 a[106:107],v17 offset:26880
ds_read_b64_tr_b16 a[108:109],v17 offset:26632
ds_read_b64_tr_b16 a[110:111],v17 offset:26888
s_waitcnt lgkmcnt(0)
ds_read_b64_tr_b16 a[112:113],v17 offset:28672
ds_read_b64_tr_b16 a[114:115],v17 offset:28928
ds_read_b64_tr_b16 a[116:117],v17 offset:28680
ds_read_b64_tr_b16 a[118:119],v17 offset:28936
ds_read_b64_tr_b16 a[120:121],v17 offset:30720
ds_read_b64_tr_b16 a[122:123],v17 offset:30976
ds_read_b64_tr_b16 a[124:125],v17 offset:30728
ds_read_b64_tr_b16 a[126:127],v17 offset:30984
s_waitcnt lgkmcnt(0)
s_xor_b32 s62,s50,3
s_mul_i32 s62,s62,524288
s_add_u32 s62,s62,s54
s_add_u32 m0,s61,16384
s_nop 0
buffer_load_dwordx4 v16,s[28:31],s62 offen lds
s_add_u32 s62,s62,32768
s_add_u32 m0,m0,1024
s_waitcnt vmcnt(6)
buffer_load_dwordx4 v16,s[28:31],s62 offen lds
s_add_u32 s62,s62,32768
s_add_u32 m0,m0,1024
s_waitcnt vmcnt(6)
buffer_load_dwordx4 v16,s[28:31],s62 offen lds
s_add_u32 s62,s62,32768
s_add_u32 m0,m0,1024
s_waitcnt vmcnt(6)
buffer_load_dwordx4 v16,s[28:31],s62 offen lds
s_add_u32 s62,s62,32768
s_add_u32 m0,m0,1024
s_waitcnt vmcnt(6)
buffer_load_dwordx4 v16,s[28:31],s62 offen lds
s_add_u32 s62,s62,32768
s_add_u32 m0,m0,1024
s_waitcnt vmcnt(6)
buffer_load_dwordx4 v16,s[28:31],s62 offen lds
s_add_u32 s62,s62,32768
s_add_u32 m0,m0,1024
s_waitcnt vmcnt(6)
buffer_load_dwordx4 v16,s[28:31],s62 offen lds
s_add_u32 s62,s62,32768
s_add_u32 m0,m0,1024
s_waitcnt vmcnt(6)
buffer_load_dwordx4 v16,s[28:31],s62 offen lds
s_add_u32 s62,s62,32768
s_add_u32 m0,m0,1024
s_waitcnt vmcnt(6)
buffer_load_dwordx4 v16,s[28:31],s62 offen lds
s_add_u32 s62,s62,32768
s_add_u32 m0,m0,1024
s_waitcnt vmcnt(6)
buffer_load_dwordx4 v16,s[28:31],s62 offen lds
s_add_u32 s62,s62,32768
s_add_u32 m0,m0,1024
s_waitcnt vmcnt(6)
buffer_load_dwordx4 v16,s[28:31],s62 offen lds
s_add_u32 s62,s62,32768
s_add_u32 m0,m0,1024
s_waitcnt vmcnt(6)
buffer_load_dwordx4 v16,s[28:31],s62 offen lds
s_add_u32 s62,s62,32768
s_add_u32 m0,m0,1024
s_waitcnt vmcnt(6)
buffer_load_dwordx4 v16,s[28:31],s62 offen lds
s_add_u32 s62,s62,32768
s_add_u32 m0,m0,1024
s_waitcnt vmcnt(6)
buffer_load_dwordx4 v16,s[28:31],s62 offen lds
s_add_u32 s62,s62,32768
s_add_u32 m0,m0,1024
s_waitcnt vmcnt(6)
buffer_load_dwordx4 v16,s[28:31],s62 offen lds
s_add_u32 s62,s62,32768
s_add_u32 m0,m0,1024
s_waitcnt vmcnt(6)
buffer_load_dwordx4 v16,s[28:31],s62 offen lds
s_waitcnt vmcnt(6)
s_waitcnt vmcnt(16)
ds_read_b64_tr_b16 a[128:129],v17 offset:0
ds_read_b64_tr_b16 a[130:131],v17 offset:256
ds_read_b64_tr_b16 a[132:133],v17 offset:8
ds_read_b64_tr_b16 a[134:135],v17 offset:264
ds_read_b64_tr_b16 a[136:137],v17 offset:2048
ds_read_b64_tr_b16 a[138:139],v17 offset:2304
ds_read_b64_tr_b16 a[140:141],v17 offset:2056
ds_read_b64_tr_b16 a[142:143],v17 offset:2312
ds_read_b64_tr_b16 a[144:145],v17 offset:4096
ds_read_b64_tr_b16 a[146:147],v17 offset:4352
ds_read_b64_tr_b16 a[148:149],v17 offset:4104
ds_read_b64_tr_b16 a[150:151],v17 offset:4360
s_waitcnt lgkmcnt(0)
ds_read_b64_tr_b16 a[152:153],v17 offset:6144
ds_read_b64_tr_b16 a[154:155],v17 offset:6400
ds_read_b64_tr_b16 a[156:157],v17 offset:6152
ds_read_b64_tr_b16 a[158:159],v17 offset:6408
ds_read_b64_tr_b16 a[160:161],v17 offset:8192
ds_read_b64_tr_b16 a[162:163],v17 offset:8448
ds_read_b64_tr_b16 a[164:165],v17 offset:8200
ds_read_b64_tr_b16 a[166:167],v17 offset:8456
ds_read_b64_tr_b16 a[168:169],v17 offset:10240
ds_read_b64_tr_b16 a[170:171],v17 offset:10496
ds_read_b64_tr_b16 a[172:173],v17 offset:10248
ds_read_b64_tr_b16 a[174:175],v17 offset:10504
s_waitcnt lgkmcnt(0)
ds_read_b64_tr_b16 a[176:177],v17 offset:12288
ds_read_b64_tr_b16 a[178:179],v17 offset:12544
ds_read_b64_tr_b16 a[180:181],v17 offset:12296
ds_read_b64_tr_b16 a[182:183],v17 offset:12552
ds_read_b64_tr_b16 a[184:185],v17 offset:14336
ds_read_b64_tr_b16 a[186:187],v17 offset:14592
ds_read_b64_tr_b16 a[188:189],v17 offset:14344
ds_read_b64_tr_b16 a[190:191],v17 offset:14600
s_waitcnt lgkmcnt(0)
s_waitcnt vmcnt(0)
ds_read_b64_tr_b16 a[192:193],v17 offset:16384
ds_read_b64_tr_b16 a[194:195],v17 offset:16640
ds_read_b64_tr_b16 a[196:197],v17 offset:16392
ds_read_b64_tr_b16 a[198:199],v17 offset:16648
ds_read_b64_tr_b16 a[200:201],v17 offset:18432
ds_read_b64_tr_b16 a[202:203],v17 offset:18688
ds_read_b64_tr_b16 a[204:205],v17 offset:18440
ds_read_b64_tr_b16 a[206:207],v17 offset:18696
ds_read_b64_tr_b16 a[208:209],v17 offset:20480
ds_read_b64_tr_b16 a[210:211],v17 offset:20736
ds_read_b64_tr_b16 a[212:213],v17 offset:20488
ds_read_b64_tr_b16 a[214:215],v17 offset:20744
s_waitcnt lgkmcnt(0)
ds_read_b64_tr_b16 a[216:217],v17 offset:22528
ds_read_b64_tr_b16 a[218:219],v17 offset:22784
ds_read_b64_tr_b16 a[220:221],v17 offset:22536
ds_read_b64_tr_b16 a[222:223],v17 offset:22792
ds_read_b64_tr_b16 a[224:225],v17 offset:24576
ds_read_b64_tr_b16 a[226:227],v17 offset:24832
ds_read_b64_tr_b16 a[228:229],v17 offset:24584
ds_read_b64_tr_b16 a[230:231],v17 offset:24840
ds_read_b64_tr_b16 a[232:233],v17 offset:26624
ds_read_b64_tr_b16 a[234:235],v17 offset:26880
ds_read_b64_tr_b16 a[236:237],v17 offset:26632
ds_read_b64_tr_b16 a[238:239],v17 offset:26888
s_waitcnt lgkmcnt(0)
ds_read_b64_tr_b16 a[240:241],v17 offset:28672
ds_read_b64_tr_b16 a[242:243],v17 offset:28928
ds_read_b64_tr_b16 a[244:245],v17 offset:28680
ds_read_b64_tr_b16 a[246:247],v17 offset:28936
ds_read_b64_tr_b16 a[248:249],v17 offset:30720
ds_read_b64_tr_b16 a[250:251],v17 offset:30976
ds_read_b64_tr_b16 a[252:253],v17 offset:30728
ds_read_b64_tr_b16 a[254:255],v17 offset:30984
s_waitcnt lgkmcnt(0)
s_mov_b32 s92,s2
s_and_b32 s93,s3,0xffff
s_mov_b32 s94,0x100
s_mov_b32 s95,0x20000
v_mbcnt_lo_u32_b32 v16,-1,0
v_mbcnt_hi_u32_b32 v16,-1,v16
v_mov_b32 v18,0
v_cmp_eq_u32 vcc,22,v16
s_nop 1
v_cndmask_b32 v18,v18,63,vcc
v_cmp_eq_u32 vcc,17,v16
s_nop 1
v_cndmask_b32 v18,v18,63,vcc
v_cmp_eq_u32 vcc,18,v16
s_nop 1
v_cndmask_b32 v18,v18,1,vcc
v_and_b32 v19,1,v16
v_cmp_eq_u32 vcc,1,v19
v_mov_b32 v19,8192
s_nop 0
v_cndmask_b32 v19,-1,v19,vcc
v_min_u32 v16,31,v16
v_lshlrev_b32 v16,2,v16
s_sub_u32 s66,s88,64
s_cmp_lg_u32 s50,0
s_cbranch_scc1 vot_331
vpoll_327:
buffer_load_dword v17,v16,s[92:95],s66 offen sc1
s_waitcnt vmcnt(0)
s_cmp_lg_u32 s56,2
s_cbranch_scc1 vck_328
v_cmp_eq_u32 vcc,v17,v19
s_and_b32 s64,vcc_lo,0xffff
s_cmp_eq_u32 s64,65535
s_cbranch_scc1 vck_328
s_mov_b32 s65,0
v_readlane_b32 s64,v17,1
s_lshr_b32 s64,s64,8
s_add_u32 s65,s65,s64
v_readlane_b32 s64,v17,3
s_lshr_b32 s64,s64,8
s_add_u32 s65,s65,s64
v_readlane_b32 s64,v17,5
s_lshr_b32 s64,s64,8
s_add_u32 s65,s65,s64
v_readlane_b32 s64,v17,7
s_lshr_b32 s64,s64,8
s_add_u32 s65,s65,s64
v_readlane_b32 s64,v17,9
s_lshr_b32 s64,s64,8
s_add_u32 s65,s65,s64
v_readlane_b32 s64,v17,11
s_lshr_b32 s64,s64,8
s_add_u32 s65,s65,s64
v_readlane_b32 s64,v17,13
s_lshr_b32 s64,s64,8
s_add_u32 s65,s65,s64
v_readlane_b32 s64,v17,15
s_lshr_b32 s64,s64,8
s_add_u32 s65,s65,s64
s_cmp_ge_u32 s65,256
s_cbranch_scc1 vok_330
s_branch vrt_329
vck_328:
v_cmp_gt_u32 vcc,v18,v17
s_cbranch_vccz vok_330
vrt_329:
s_sleep 48
s_sub_u32 s90,s90,1
s_cmp_gt_i32 s90,0
s_cbranch_scc1 vpoll_327
vok_330:
v_add_u32 v18,160768,v16
ds_write_b32 v18,v17
s_waitcnt lgkmcnt(0)
vot_331:
s_barrier
v_add_u32 v18,160768,v16
ds_read_b32 v17,v18
s_waitcnt lgkmcnt(0)
s_cmp_lg_u32 s56,2
s_cbranch_scc1 vfin_332
v_cmp_eq_u32 vcc,v17,v19
s_and_b32 s64,vcc_lo,0xffff
s_cmp_eq_u32 s64,65535
s_cbranch_scc1 vfin_332
s_mov_b32 s65,0
v_readlane_b32 s64,v17,1
s_lshr_b32 s64,s64,8
s_add_u32 s65,s65,s64
v_readlane_b32 s64,v17,3
s_lshr_b32 s64,s64,8
s_add_u32 s65,s65,s64
v_readlane_b32 s64,v17,5
s_lshr_b32 s64,s64,8
s_add_u32 s65,s65,s64
v_readlane_b32 s64,v17,7
s_lshr_b32 s64,s64,8
s_add_u32 s65,s65,s64
v_readlane_b32 s64,v17,9
s_lshr_b32 s64,s64,8
s_add_u32 s65,s65,s64
v_readlane_b32 s64,v17,11
s_lshr_b32 s64,s64,8
s_add_u32 s65,s65,s64
v_readlane_b32 s64,v17,13
s_lshr_b32 s64,s64,8
s_add_u32 s65,s65,s64
v_readlane_b32 s64,v17,15
s_lshr_b32 s64,s64,8
s_add_u32 s65,s65,s64
s_cmp_ge_u32 s65,256
s_cbranch_scc1 fl_fb
vfin_332:
s_and_b32 s56,s56,1
s_mov_b32 s67,0
s_barrier
v_lshlrev_b32 v0,4,v1
s_mov_b32 s60,0
s_lshl_b32 s70,s50,13
s_mov_b32 s55,0
v_mov_b32 v3,v0
s_mov_b32 s73,0xffff0000
s_lshl_b32 s64,s52,2
s_add_u32 s64,s64,s50
s_mul_i32 s61,s64,8192
s_add_u32 s61,s61,209747968
s_lshl_b32 s68,s64,8
s_add_u32 s68,s68,138549248
s_lshl_b32 s83,s53,2
s_add_u32 s83,s83,s50
s_mov_b32 s63,0
s_xor_b32 s64,s50,0
s_lshl_b32 s64,s64,13
v_add_u32 v8,s64,v0
v_mov_b32 v4,v8
s_xor_b32 s64,s50,1
s_lshl_b32 s64,s64,13
v_add_u32 v9,s64,v0
v_mov_b32 v5,v9
s_xor_b32 s64,s50,2
s_lshl_b32 s64,s64,13
v_add_u32 v10,s64,v0
v_mov_b32 v6,v10
s_xor_b32 s64,s50,3
s_lshl_b32 s64,s64,13
v_add_u32 v11,s64,v0
v_mov_b32 v7,v11
v_min_u32 v2,7,v1
v_lshlrev_b32 v2,7,v2
s_mul_i32 s68,s50,1024
s_add_u32 s68,s68,138559488
s_lshr_b32 s64,s50,1
s_add_u32 s64,s64,1
s_sub_u32 s65,0,s64
s_bitcmp1_b32 s50,0
s_cselect_b32 s64,s64,s65
s_add_u32 s64,s64,16
v_add_u32 v26,s64,v21
v_lshrrev_b32 v27,4,v26
v_and_b32 v26,15,v26
v_lshl_add_u32 v26,v22,4,v26
v_lshlrev_b32 v26,4,v26
v_lshl_add_u32 v3,v27,15,v26
s_sub_u32 s61,s61,32768
s_and_b32 s64,s50,1
s_add_u32 s74,s64,1
s_add_u32 s75,s64,2
s_add_u32 s76,s64,3
s_add_u32 s62,s61,4096
s_lshl_b32 s66,s83,10
s_lshr_b32 s65,s83,3
s_lshl_b32 s65,s65,8
s_and_b32 s64,s83,7
s_lshl_b32 s64,s64,2
s_add_u32 s69,s64,s65
s_add_u32 s69,s69,138550272
s_add_u32 s82,s66,205520896
s_add_u32 s66,s66,214958080
v_cmp_eq_u32 vcc,0,v1
s_nop 1
v_cndmask_b32 v26,2.0,0,vcc
s_add_u32 s71,s60,s74
s_cmp_eq_u32 s60,127
s_cselect_b32 s71,128,s71
s_add_u32 s53,s60,s75
s_cmp_eq_u32 s60,126
s_cselect_b32 s53,128,s53
plp_340:
buffer_load_dword v16,v2,s[20:23],s68 offen sc1
s_waitcnt vmcnt(0)
v_cmp_gt_u32 vcc,s71,v16
s_cbranch_vccz pok_341
s_sleep 4
s_sub_u32 s90,s90,1
s_cmp_gt_i32 s90,0
s_cbranch_scc1 plp_340
pok_341:
lag_337:
s_mov_b32 m0,s70
s_nop 0
buffer_load_dwordx4 v3,s[20:23],s61 offen offset:0 lds
buffer_load_dwordx4 v3,s[20:23],s61 offen offset:1024 lds
buffer_load_dwordx4 v3,s[20:23],s61 offen offset:2048 lds
buffer_load_dwordx4 v3,s[20:23],s61 offen offset:3072 lds
s_add_u32 m0,s70,4096
s_nop 0
buffer_load_dwordx4 v3,s[20:23],s62 offen offset:0 lds
buffer_load_dwordx4 v3,s[20:23],s62 offen offset:1024 lds
buffer_load_dwordx4 v3,s[20:23],s62 offen offset:2048 lds
buffer_load_dwordx4 v3,s[20:23],s62 offen offset:3072 lds
s_add_u32 s61,s61,32768
s_add_u32 s62,s62,32768
s_add_u32 s70,s70,32768
s_and_b32 s70,s70,0x1ffff
buffer_load_dword v23,off,s[20:23],s66
buffer_load_dword v23,off,s[20:23],s66
dec_338:
v_cmp_gt_u32 vcc,s53,v16
s_cbranch_vccnz BN_336
BR_335:
s_waitcnt vmcnt(9)
ds_read_b128 v[64:67],v4 offset:0
s_waitcnt vmcnt(8)
ds_read_b128 v[68:71],v4 offset:1024
s_waitcnt vmcnt(7)
ds_read_b128 v[72:75],v4 offset:2048
s_waitcnt vmcnt(6)
ds_read_b128 v[76:79],v4 offset:3072
s_waitcnt lgkmcnt(3)
v_mfma_f32_16x16x32_bf16 v[32:35],a[0:3],v[64:67],0
s_add_u32 s71,s60,s75
s_cmp_eq_u32 s60,126
s_cselect_b32 s71,128,s71
buffer_load_dwordx4 v[160:163],v0,s[20:23],s82 offen
v_mfma_f32_16x16x32_bf16 v[36:39],a[4:7],v[64:67],0
s_waitcnt lgkmcnt(2)
s_waitcnt vmcnt(6)
s_mov_b32 m0,s70
s_add_u32 s82,s82,32768
ds_read_b128 v[80:83],v4 offset:4096
v_mfma_f32_16x16x32_bf16 v[32:35],a[8:11],v[68:71],v[32:35]
s_add_u32 s53,s60,s76
s_cmp_eq_u32 s60,125
s_cselect_b32 s53,128,s53
buffer_load_dwordx4 v3,s[20:23],s61 offen offset:0 lds
v_mfma_f32_16x16x32_bf16 v[36:39],a[12:15],v[68:71],v[36:39]
s_waitcnt lgkmcnt(2)
s_waitcnt vmcnt(6)
ds_read_b128 v[84:87],v4 offset:5120
v_mfma_f32_16x16x32_bf16 v[32:35],a[16:19],v[72:75],v[32:35]
s_mov_b32 s57,s63
buffer_load_dwordx4 v3,s[20:23],s61 offen offset:1024 lds
v_mfma_f32_16x16x32_bf16 v[36:39],a[20:23],v[72:75],v[36:39]
s_waitcnt lgkmcnt(2)
s_waitcnt vmcnt(6)
ds_read_b128 v[88:91],v4 offset:6144
v_mfma_f32_16x16x32_bf16 v[32:35],a[24:27],v[76:79],v[32:35]
buffer_load_dwordx4 v3,s[20:23],s61 offen offset:2048 lds
v_mfma_f32_16x16x32_bf16 v[36:39],a[28:31],v[76:79],v[36:39]
s_waitcnt lgkmcnt(2)
s_waitcnt vmcnt(6)
ds_read_b128 v[92:95],v4 offset:7168
v_mfma_f32_16x16x32_bf16 v[32:35],a[32:35],v[80:83],v[32:35]
buffer_load_dwordx4 v3,s[20:23],s61 offen offset:3072 lds
v_mfma_f32_16x16x32_bf16 v[36:39],a[36:39],v[80:83],v[36:39]
s_waitcnt lgkmcnt(2)
s_barrier
s_add_u32 m0,s70,4096
ds_read_b128 v[96:99],v5 offset:0
v_mfma_f32_16x16x32_bf16 v[32:35],a[40:43],v[84:87],v[32:35]
ds_read_b128 v[100:103],v5 offset:1024
buffer_load_dwordx4 v3,s[20:23],s62 offen offset:0 lds
v_mfma_f32_16x16x32_bf16 v[36:39],a[44:47],v[84:87],v[36:39]
s_waitcnt lgkmcnt(3)
ds_read_b128 v[104:107],v5 offset:2048
buffer_load_dwordx4 v3,s[20:23],s62 offen offset:1024 lds
v_mfma_f32_16x16x32_bf16 v[32:35],a[48:51],v[88:91],v[32:35]
ds_read_b128 v[108:111],v5 offset:3072
v_mfma_f32_16x16x32_bf16 v[36:39],a[52:55],v[88:91],v[36:39]
s_waitcnt lgkmcnt(4)
ds_read_b128 v[112:115],v5 offset:4096
buffer_load_dwordx4 v3,s[20:23],s62 offen offset:2048 lds
v_mfma_f32_16x16x32_bf16 v[32:35],a[56:59],v[92:95],v[32:35]
ds_read_b128 v[116:119],v5 offset:5120
v_mfma_f32_16x16x32_bf16 v[36:39],a[60:63],v[92:95],v[36:39]
s_waitcnt lgkmcnt(5)
buffer_load_dwordx4 v3,s[20:23],s62 offen offset:3072 lds
v_mfma_f32_16x16x32_bf16 v[32:35],a[64:67],v[96:99],v[32:35]
ds_read_b128 v[120:123],v5 offset:6144
v_mfma_f32_16x16x32_bf16 v[36:39],a[68:71],v[96:99],v[36:39]
s_waitcnt lgkmcnt(5)
v_mfma_f32_16x16x32_bf16 v[32:35],a[72:75],v[100:103],v[32:35]
ds_read_b128 v[124:127],v5 offset:7168
v_mfma_f32_16x16x32_bf16 v[36:39],a[76:79],v[100:103],v[36:39]
s_waitcnt lgkmcnt(5)
v_mfma_f32_16x16x32_bf16 v[32:35],a[80:83],v[104:107],v[32:35]
ds_read_b128 v[64:67],v6 offset:0
v_mfma_f32_16x16x32_bf16 v[36:39],a[84:87],v[104:107],v[36:39]
s_waitcnt lgkmcnt(5)
v_mfma_f32_16x16x32_bf16 v[32:35],a[88:91],v[108:111],v[32:35]
ds_read_b128 v[68:71],v6 offset:1024
v_mfma_f32_16x16x32_bf16 v[36:39],a[92:95],v[108:111],v[36:39]
s_waitcnt lgkmcnt(5)
v_mfma_f32_16x16x32_bf16 v[32:35],a[96:99],v[112:115],v[32:35]
ds_read_b128 v[72:75],v6 offset:2048
buffer_load_dword v16,v2,s[20:23],s68 offen sc1
v_mfma_f32_16x16x32_bf16 v[36:39],a[100:103],v[112:115],v[36:39]
s_waitcnt lgkmcnt(5)
v_mfma_f32_16x16x32_bf16 v[32:35],a[104:107],v[116:119],v[32:35]
ds_read_b128 v[76:79],v6 offset:3072
v_mfma_f32_16x16x32_bf16 v[36:39],a[108:111],v[116:119],v[36:39]
s_waitcnt lgkmcnt(5)
v_mfma_f32_16x16x32_bf16 v[32:35],a[112:115],v[120:123],v[32:35]
ds_read_b128 v[80:83],v6 offset:4096
v_mfma_f32_16x16x32_bf16 v[36:39],a[116:119],v[120:123],v[36:39]
s_waitcnt lgkmcnt(5)
v_mfma_f32_16x16x32_bf16 v[32:35],a[120:123],v[124:127],v[32:35]
ds_read_b128 v[84:87],v6 offset:5120
v_mfma_f32_16x16x32_bf16 v[36:39],a[124:127],v[124:127],v[36:39]
s_waitcnt lgkmcnt(5)
v_mfma_f32_16x16x32_bf16 v[32:35],a[128:131],v[64:67],v[32:35]
ds_read_b128 v[88:91],v6 offset:6144
v_mfma_f32_16x16x32_bf16 v[36:39],a[132:135],v[64:67],v[36:39]
s_waitcnt lgkmcnt(5)
v_mfma_f32_16x16x32_bf16 v[32:35],a[136:139],v[68:71],v[32:35]
ds_read_b128 v[92:95],v6 offset:7168
v_mfma_f32_16x16x32_bf16 v[36:39],a[140:143],v[68:71],v[36:39]
s_waitcnt lgkmcnt(5)
v_mfma_f32_16x16x32_bf16 v[32:35],a[144:147],v[72:75],v[32:35]
ds_read_b128 v[96:99],v7 offset:0
v_mfma_f32_16x16x32_bf16 v[36:39],a[148:151],v[72:75],v[36:39]
s_waitcnt lgkmcnt(5)
s_waitcnt vmcnt(11)
v_mov_b32 v17,s57
buffer_store_dword v17,v26,s[20:23],s69 offen sc1
v_mfma_f32_16x16x32_bf16 v[32:35],a[152:155],v[76:79],v[32:35]
ds_read_b128 v[100:103],v7 offset:1024
v_mfma_f32_16x16x32_bf16 v[36:39],a[156:159],v[76:79],v[36:39]
s_waitcnt lgkmcnt(5)
v_mfma_f32_16x16x32_bf16 v[32:35],a[160:163],v[80:83],v[32:35]
ds_read_b128 v[104:107],v7 offset:2048
v_mfma_f32_16x16x32_bf16 v[36:39],a[164:167],v[80:83],v[36:39]
s_waitcnt lgkmcnt(5)
v_mfma_f32_16x16x32_bf16 v[32:35],a[168:171],v[84:87],v[32:35]
ds_read_b128 v[108:111],v7 offset:3072
v_mfma_f32_16x16x32_bf16 v[36:39],a[172:175],v[84:87],v[36:39]
s_waitcnt lgkmcnt(5)
v_mfma_f32_16x16x32_bf16 v[32:35],a[176:179],v[88:91],v[32:35]
ds_read_b128 v[112:115],v7 offset:4096
v_mfma_f32_16x16x32_bf16 v[36:39],a[180:183],v[88:91],v[36:39]
s_waitcnt lgkmcnt(5)
v_mfma_f32_16x16x32_bf16 v[32:35],a[184:187],v[92:95],v[32:35]
ds_read_b128 v[116:119],v7 offset:5120
v_mfma_f32_16x16x32_bf16 v[36:39],a[188:191],v[92:95],v[36:39]
s_waitcnt lgkmcnt(5)
v_mfma_f32_16x16x32_bf16 v[32:35],a[192:195],v[96:99],v[32:35]
ds_read_b128 v[120:123],v7 offset:6144
v_mfma_f32_16x16x32_bf16 v[36:39],a[196:199],v[96:99],v[36:39]
s_waitcnt lgkmcnt(5)
v_mfma_f32_16x16x32_bf16 v[32:35],a[200:203],v[100:103],v[32:35]
s_waitcnt vmcnt(10)
ds_read_b128 v[124:127],v7 offset:7168
v_lshlrev_b32 v168,16,v160
v_mfma_f32_16x16x32_bf16 v[36:39],a[204:207],v[100:103],v[36:39]
s_waitcnt lgkmcnt(5)
v_and_b32 v169,s73,v160
v_lshlrev_b32 v170,16,v161
v_mfma_f32_16x16x32_bf16 v[32:35],a[208:211],v[104:107],v[32:35]
s_add_u32 s61,s61,32768
v_and_b32 v171,s73,v161
v_lshlrev_b32 v172,16,v162
v_mfma_f32_16x16x32_bf16 v[36:39],a[212:215],v[104:107],v[36:39]
s_waitcnt lgkmcnt(4)
v_and_b32 v173,s73,v162
v_lshlrev_b32 v174,16,v163
v_mfma_f32_16x16x32_bf16 v[32:35],a[216:219],v[108:111],v[32:35]
s_add_u32 s62,s62,32768
s_add_u32 s70,s70,32768
v_and_b32 v175,s73,v163
v_mfma_f32_16x16x32_bf16 v[36:39],a[220:223],v[108:111],v[36:39]
s_waitcnt lgkmcnt(3)
s_and_b32 s70,s70,0x1ffff
s_add_u32 s55,s55,32768
v_mfma_f32_16x16x32_bf16 v[32:35],a[224:227],v[112:115],v[32:35]
s_and_b32 s55,s55,0x1ffff
v_add_u32 v4,s55,v8
v_add_u32 v5,s55,v9
v_mfma_f32_16x16x32_bf16 v[36:39],a[228:231],v[112:115],v[36:39]
s_waitcnt lgkmcnt(2)
v_add_u32 v6,s55,v10
v_add_u32 v7,s55,v11
v_mfma_f32_16x16x32_bf16 v[32:35],a[232:235],v[116:119],v[32:35]
s_waitcnt vmcnt(9)
ds_read_b128 v[64:67],v4 offset:0
v_mfma_f32_16x16x32_bf16 v[36:39],a[236:239],v[116:119],v[36:39]
s_waitcnt lgkmcnt(2)
s_waitcnt vmcnt(8)
ds_read_b128 v[68:71],v4 offset:1024
v_mfma_f32_16x16x32_bf16 v[32:35],a[240:243],v[120:123],v[32:35]
s_waitcnt vmcnt(7)
ds_read_b128 v[72:75],v4 offset:2048
v_mfma_f32_16x16x32_bf16 v[36:39],a[244:247],v[120:123],v[36:39]
s_waitcnt lgkmcnt(3)
v_mfma_f32_16x16x32_bf16 v[40:43],a[248:251],v[124:127],v[32:35]
v_mfma_f32_16x16x32_bf16 v[44:47],a[252:255],v[124:127],v[36:39]
s_waitcnt vmcnt(1)
v_cmp_gt_u32 vcc,s53,v16
s_add_u32 s60,s60,1
s_cbranch_vccnz WN_334
.p2align 6
WR_333:
s_waitcnt lgkmcnt(2)
v_mfma_f32_16x16x32_bf16 v[32:35],a[0:3],v[64:67],0
s_waitcnt vmcnt(6)
s_mov_b32 m0,s70
ds_read_b128 v[76:79],v4 offset:3072
v_mfma_f32_16x16x32_bf16 v[36:39],a[4:7],v[64:67],0
s_waitcnt lgkmcnt(2)
s_add_u32 s71,s60,s75
s_cmp_eq_u32 s60,126
s_cselect_b32 s71,128,s71
buffer_load_dwordx4 v3,s[20:23],s61 offen offset:0 lds
v_mfma_f32_16x16x32_bf16 v[32:35],a[8:11],v[68:71],v[32:35]
s_waitcnt vmcnt(6)
ds_read_b128 v[80:83],v4 offset:4096
buffer_load_dwordx4 v[160:163],v0,s[20:23],s82 offen
v_add_f32 v40,v40,v168
v_mfma_f32_16x16x32_bf16 v[36:39],a[12:15],v[68:71],v[36:39]
s_waitcnt lgkmcnt(2)
s_add_u32 s82,s82,32768
buffer_load_dwordx4 v3,s[20:23],s61 offen offset:1024 lds
v_add_f32 v41,v41,v169
v_mfma_f32_16x16x32_bf16 v[32:35],a[16:19],v[72:75],v[32:35]
s_waitcnt vmcnt(7)
s_add_u32 s53,s60,s76
s_cmp_eq_u32 s60,125
s_cselect_b32 s53,128,s53
ds_read_b128 v[84:87],v4 offset:5120
v_mfma_f32_16x16x32_bf16 v[36:39],a[20:23],v[72:75],v[36:39]
s_waitcnt lgkmcnt(2)
s_mov_b32 s57,s63
buffer_load_dwordx4 v3,s[20:23],s61 offen offset:2048 lds
v_add_f32 v42,v42,v170
v_mfma_f32_16x16x32_bf16 v[32:35],a[24:27],v[76:79],v[32:35]
s_waitcnt vmcnt(7)
ds_read_b128 v[88:91],v4 offset:6144
v_add_f32 v43,v43,v171
v_add_f32 v44,v44,v172
v_mfma_f32_16x16x32_bf16 v[36:39],a[28:31],v[76:79],v[36:39]
s_waitcnt lgkmcnt(2)
buffer_load_dwordx4 v3,s[20:23],s61 offen offset:3072 lds
v_add_f32 v45,v45,v173
v_add_f32 v46,v46,v174
v_mfma_f32_16x16x32_bf16 v[32:35],a[32:35],v[80:83],v[32:35]
s_waitcnt vmcnt(7)
ds_read_b128 v[92:95],v4 offset:7168
v_add_f32 v47,v47,v175
v_cvt_pk_bf16_f32 v176,v40,v41
v_mfma_f32_16x16x32_bf16 v[36:39],a[36:39],v[80:83],v[36:39]
s_waitcnt lgkmcnt(2)
s_barrier
s_add_u32 m0,s70,4096
ds_read_b128 v[96:99],v5 offset:0
v_mfma_f32_16x16x32_bf16 v[32:35],a[40:43],v[84:87],v[32:35]
ds_read_b128 v[100:103],v5 offset:1024
buffer_load_dwordx4 v3,s[20:23],s62 offen offset:0 lds
v_cvt_pk_bf16_f32 v177,v42,v43
v_mfma_f32_16x16x32_bf16 v[36:39],a[44:47],v[84:87],v[36:39]
s_waitcnt lgkmcnt(3)
ds_read_b128 v[104:107],v5 offset:2048
buffer_load_dwordx4 v3,s[20:23],s62 offen offset:1024 lds
v_cvt_pk_bf16_f32 v178,v44,v45
v_mfma_f32_16x16x32_bf16 v[32:35],a[48:51],v[88:91],v[32:35]
ds_read_b128 v[108:111],v5 offset:3072
v_cvt_pk_bf16_f32 v179,v46,v47
v_mfma_f32_16x16x32_bf16 v[36:39],a[52:55],v[88:91],v[36:39]
s_waitcnt lgkmcnt(4)
ds_read_b128 v[112:115],v5 offset:4096
buffer_load_dwordx4 v3,s[20:23],s62 offen offset:2048 lds
v_mfma_f32_16x16x32_bf16 v[32:35],a[56:59],v[92:95],v[32:35]
ds_read_b128 v[116:119],v5 offset:5120
v_mfma_f32_16x16x32_bf16 v[36:39],a[60:63],v[92:95],v[36:39]
s_waitcnt lgkmcnt(5)
buffer_load_dwordx4 v3,s[20:23],s62 offen offset:3072 lds
v_mfma_f32_16x16x32_bf16 v[32:35],a[64:67],v[96:99],v[32:35]
ds_read_b128 v[120:123],v5 offset:6144
v_mfma_f32_16x16x32_bf16 v[36:39],a[68:71],v[96:99],v[36:39]
s_waitcnt lgkmcnt(5)
buffer_load_dword v16,v2,s[20:23],s68 offen sc1
v_mfma_f32_16x16x32_bf16 v[32:35],a[72:75],v[100:103],v[32:35]
ds_read_b128 v[124:127],v5 offset:7168
v_mfma_f32_16x16x32_bf16 v[36:39],a[76:79],v[100:103],v[36:39]
s_waitcnt lgkmcnt(5)
s_waitcnt vmcnt(10)
v_mov_b32 v17,s57
buffer_store_dword v17,v26,s[20:23],s69 offen sc1
v_mfma_f32_16x16x32_bf16 v[32:35],a[80:83],v[104:107],v[32:35]
ds_read_b128 v[64:67],v6 offset:0
v_mfma_f32_16x16x32_bf16 v[36:39],a[84:87],v[104:107],v[36:39]
s_waitcnt lgkmcnt(5)
buffer_store_dwordx4 v[176:179],v0,s[20:23],s66 offen sc1
v_mfma_f32_16x16x32_bf16 v[32:35],a[88:91],v[108:111],v[32:35]
s_add_u32 s66,s66,32768
s_add_u32 s63,s63,1
ds_read_b128 v[68:71],v6 offset:1024
v_mfma_f32_16x16x32_bf16 v[36:39],a[92:95],v[108:111],v[36:39]
s_waitcnt lgkmcnt(5)
v_mfma_f32_16x16x32_bf16 v[32:35],a[96:99],v[112:115],v[32:35]
ds_read_b128 v[72:75],v6 offset:2048
v_mfma_f32_16x16x32_bf16 v[36:39],a[100:103],v[112:115],v[36:39]
s_waitcnt lgkmcnt(5)
v_mfma_f32_16x16x32_bf16 v[32:35],a[104:107],v[116:119],v[32:35]
ds_read_b128 v[76:79],v6 offset:3072
v_mfma_f32_16x16x32_bf16 v[36:39],a[108:111],v[116:119],v[36:39]
s_waitcnt lgkmcnt(5)
v_mfma_f32_16x16x32_bf16 v[32:35],a[112:115],v[120:123],v[32:35]
ds_read_b128 v[80:83],v6 offset:4096
v_mfma_f32_16x16x32_bf16 v[36:39],a[116:119],v[120:123],v[36:39]
s_waitcnt lgkmcnt(5)
v_mfma_f32_16x16x32_bf16 v[32:35],a[120:123],v[124:127],v[32:35]
ds_read_b128 v[84:87],v6 offset:5120
v_mfma_f32_16x16x32_bf16 v[36:39],a[124:127],v[124:127],v[36:39]
s_waitcnt lgkmcnt(5)
v_mfma_f32_16x16x32_bf16 v[32:35],a[128:131],v[64:67],v[32:35]
ds_read_b128 v[88:91],v6 offset:6144
v_mfma_f32_16x16x32_bf16 v[36:39],a[132:135],v[64:67],v[36:39]
s_waitcnt lgkmcnt(5)
v_mfma_f32_16x16x32_bf16 v[32:35],a[136:139],v[68:71],v[32:35]
ds_read_b128 v[92:95],v6 offset:7168
v_mfma_f32_16x16x32_bf16 v[36:39],a[140:143],v[68:71],v[36:39]
s_waitcnt lgkmcnt(5)
v_mfma_f32_16x16x32_bf16 v[32:35],a[144:147],v[72:75],v[32:35]
ds_read_b128 v[96:99],v7 offset:0
v_mfma_f32_16x16x32_bf16 v[36:39],a[148:151],v[72:75],v[36:39]
s_waitcnt lgkmcnt(5)
v_mfma_f32_16x16x32_bf16 v[32:35],a[152:155],v[76:79],v[32:35]
ds_read_b128 v[100:103],v7 offset:1024
v_mfma_f32_16x16x32_bf16 v[36:39],a[156:159],v[76:79],v[36:39]
s_waitcnt lgkmcnt(5)
v_mfma_f32_16x16x32_bf16 v[32:35],a[160:163],v[80:83],v[32:35]
ds_read_b128 v[104:107],v7 offset:2048
v_mfma_f32_16x16x32_bf16 v[36:39],a[164:167],v[80:83],v[36:39]
s_waitcnt lgkmcnt(5)
v_mfma_f32_16x16x32_bf16 v[32:35],a[168:171],v[84:87],v[32:35]
ds_read_b128 v[108:111],v7 offset:3072
v_mfma_f32_16x16x32_bf16 v[36:39],a[172:175],v[84:87],v[36:39]
s_waitcnt lgkmcnt(5)
v_mfma_f32_16x16x32_bf16 v[32:35],a[176:179],v[88:91],v[32:35]
ds_read_b128 v[112:115],v7 offset:4096
v_mfma_f32_16x16x32_bf16 v[36:39],a[180:183],v[88:91],v[36:39]
s_waitcnt lgkmcnt(5)
v_mfma_f32_16x16x32_bf16 v[32:35],a[184:187],v[92:95],v[32:35]
ds_read_b128 v[116:119],v7 offset:5120
v_mfma_f32_16x16x32_bf16 v[36:39],a[188:191],v[92:95],v[36:39]
s_waitcnt lgkmcnt(5)
v_mfma_f32_16x16x32_bf16 v[32:35],a[192:195],v[96:99],v[32:35]
ds_read_b128 v[120:123],v7 offset:6144
v_mfma_f32_16x16x32_bf16 v[36:39],a[196:199],v[96:99],v[36:39]
s_waitcnt lgkmcnt(5)
v_mfma_f32_16x16x32_bf16 v[32:35],a[200:203],v[100:103],v[32:35]
s_waitcnt vmcnt(10)
ds_read_b128 v[124:127],v7 offset:7168
v_lshlrev_b32 v168,16,v160
v_mfma_f32_16x16x32_bf16 v[36:39],a[204:207],v[100:103],v[36:39]
s_waitcnt lgkmcnt(5)
v_and_b32 v169,s73,v160
v_lshlrev_b32 v170,16,v161
v_mfma_f32_16x16x32_bf16 v[32:35],a[208:211],v[104:107],v[32:35]
s_add_u32 s61,s61,32768
v_and_b32 v171,s73,v161
v_lshlrev_b32 v172,16,v162
v_mfma_f32_16x16x32_bf16 v[36:39],a[212:215],v[104:107],v[36:39]
s_waitcnt lgkmcnt(4)
v_and_b32 v173,s73,v162
v_lshlrev_b32 v174,16,v163
v_mfma_f32_16x16x32_bf16 v[32:35],a[216:219],v[108:111],v[32:35]
s_add_u32 s62,s62,32768
s_add_u32 s70,s70,32768
v_and_b32 v175,s73,v163
v_mfma_f32_16x16x32_bf16 v[36:39],a[220:223],v[108:111],v[36:39]
s_waitcnt lgkmcnt(3)
s_and_b32 s70,s70,0x1ffff
s_add_u32 s55,s55,32768
v_mfma_f32_16x16x32_bf16 v[32:35],a[224:227],v[112:115],v[32:35]
s_and_b32 s55,s55,0x1ffff
v_add_u32 v4,s55,v8
v_add_u32 v5,s55,v9
v_mfma_f32_16x16x32_bf16 v[36:39],a[228:231],v[112:115],v[36:39]
s_waitcnt lgkmcnt(2)
v_add_u32 v6,s55,v10
v_add_u32 v7,s55,v11
v_mfma_f32_16x16x32_bf16 v[32:35],a[232:235],v[116:119],v[32:35]
ds_read_b128 v[64:67],v4 offset:0
v_mfma_f32_16x16x32_bf16 v[36:39],a[236:239],v[116:119],v[36:39]
s_waitcnt lgkmcnt(2)
s_waitcnt vmcnt(9)
ds_read_b128 v[68:71],v4 offset:1024
v_mfma_f32_16x16x32_bf16 v[32:35],a[240:243],v[120:123],v[32:35]
s_waitcnt vmcnt(8)
ds_read_b128 v[72:75],v4 offset:2048
v_mfma_f32_16x16x32_bf16 v[36:39],a[244:247],v[120:123],v[36:39]
s_waitcnt lgkmcnt(3)
v_mfma_f32_16x16x32_bf16 v[40:43],a[248:251],v[124:127],v[32:35]
v_mfma_f32_16x16x32_bf16 v[44:47],a[252:255],v[124:127],v[36:39]
s_waitcnt vmcnt(2)
v_cmp_gt_u32 vcc,s53,v16
s_add_u32 s60,s60,1
s_cbranch_vccz WR_333
WN_334:
s_waitcnt lgkmcnt(2)
v_mfma_f32_16x16x32_bf16 v[32:35],a[0:3],v[64:67],0
s_waitcnt vmcnt(6)
ds_read_b128 v[76:79],v4 offset:3072
buffer_load_dwordx4 v[160:163],v0,s[20:23],s82 offen
v_mfma_f32_16x16x32_bf16 v[36:39],a[4:7],v[64:67],0
s_waitcnt lgkmcnt(2)
s_add_u32 s82,s82,32768
v_mfma_f32_16x16x32_bf16 v[32:35],a[8:11],v[68:71],v[32:35]
s_waitcnt vmcnt(6)
ds_read_b128 v[80:83],v4 offset:4096
v_add_f32 v40,v40,v168
v_add_f32 v41,v41,v169
v_mfma_f32_16x16x32_bf16 v[36:39],a[12:15],v[68:71],v[36:39]
s_waitcnt lgkmcnt(2)
s_add_u32 s71,s60,s75
s_cmp_eq_u32 s60,126
s_cselect_b32 s71,128,s71
v_mfma_f32_16x16x32_bf16 v[32:35],a[16:19],v[72:75],v[32:35]
s_waitcnt vmcnt(5)
ds_read_b128 v[84:87],v4 offset:5120
v_add_f32 v42,v42,v170
v_add_f32 v43,v43,v171
v_mfma_f32_16x16x32_bf16 v[36:39],a[20:23],v[72:75],v[36:39]
s_waitcnt lgkmcnt(2)
s_add_u32 s53,s60,s76
s_cmp_eq_u32 s60,125
s_cselect_b32 s53,128,s53
v_mfma_f32_16x16x32_bf16 v[32:35],a[24:27],v[76:79],v[32:35]
s_waitcnt vmcnt(4)
s_mov_b32 s57,s63
ds_read_b128 v[88:91],v4 offset:6144
v_add_f32 v44,v44,v172
v_mfma_f32_16x16x32_bf16 v[36:39],a[28:31],v[76:79],v[36:39]
s_waitcnt lgkmcnt(2)
v_add_f32 v45,v45,v173
v_add_f32 v46,v46,v174
v_mfma_f32_16x16x32_bf16 v[32:35],a[32:35],v[80:83],v[32:35]
s_waitcnt vmcnt(3)
ds_read_b128 v[92:95],v4 offset:7168
v_add_f32 v47,v47,v175
v_mfma_f32_16x16x32_bf16 v[36:39],a[36:39],v[80:83],v[36:39]
s_waitcnt lgkmcnt(2)
s_barrier
ds_read_b128 v[96:99],v5 offset:0
v_mfma_f32_16x16x32_bf16 v[32:35],a[40:43],v[84:87],v[32:35]
ds_read_b128 v[100:103],v5 offset:1024
v_cvt_pk_bf16_f32 v176,v40,v41
v_mfma_f32_16x16x32_bf16 v[36:39],a[44:47],v[84:87],v[36:39]
s_waitcnt lgkmcnt(3)
ds_read_b128 v[104:107],v5 offset:2048
v_cvt_pk_bf16_f32 v177,v42,v43
v_mfma_f32_16x16x32_bf16 v[32:35],a[48:51],v[88:91],v[32:35]
ds_read_b128 v[108:111],v5 offset:3072
v_cvt_pk_bf16_f32 v178,v44,v45
v_mfma_f32_16x16x32_bf16 v[36:39],a[52:55],v[88:91],v[36:39]
s_waitcnt lgkmcnt(4)
ds_read_b128 v[112:115],v5 offset:4096
v_cvt_pk_bf16_f32 v179,v46,v47
v_mfma_f32_16x16x32_bf16 v[32:35],a[56:59],v[92:95],v[32:35]
ds_read_b128 v[116:119],v5 offset:5120
v_mfma_f32_16x16x32_bf16 v[36:39],a[60:63],v[92:95],v[36:39]
s_waitcnt lgkmcnt(5)
v_mfma_f32_16x16x32_bf16 v[32:35],a[64:67],v[96:99],v[32:35]
ds_read_b128 v[120:123],v5 offset:6144
v_mfma_f32_16x16x32_bf16 v[36:39],a[68:71],v[96:99],v[36:39]
s_waitcnt lgkmcnt(5)
buffer_load_dword v16,v2,s[20:23],s68 offen sc1
v_mfma_f32_16x16x32_bf16 v[32:35],a[72:75],v[100:103],v[32:35]
ds_read_b128 v[124:127],v5 offset:7168
v_mfma_f32_16x16x32_bf16 v[36:39],a[76:79],v[100:103],v[36:39]
s_waitcnt lgkmcnt(5)
s_waitcnt vmcnt(2)
v_mov_b32 v17,s57
buffer_store_dword v17,v26,s[20:23],s69 offen sc1
v_mfma_f32_16x16x32_bf16 v[32:35],a[80:83],v[104:107],v[32:35]
ds_read_b128 v[64:67],v6 offset:0
v_mfma_f32_16x16x32_bf16 v[36:39],a[84:87],v[104:107],v[36:39]
s_waitcnt lgkmcnt(5)
buffer_store_dwordx4 v[176:179],v0,s[20:23],s66 offen sc1
v_mfma_f32_16x16x32_bf16 v[32:35],a[88:91],v[108:111],v[32:35]
s_add_u32 s66,s66,32768
s_add_u32 s63,s63,1
ds_read_b128 v[68:71],v6 offset:1024
v_mfma_f32_16x16x32_bf16 v[36:39],a[92:95],v[108:111],v[36:39]
s_waitcnt lgkmcnt(5)
v_mfma_f32_16x16x32_bf16 v[32:35],a[96:99],v[112:115],v[32:35]
ds_read_b128 v[72:75],v6 offset:2048
v_mfma_f32_16x16x32_bf16 v[36:39],a[100:103],v[112:115],v[36:39]
s_waitcnt lgkmcnt(5)
v_mfma_f32_16x16x32_bf16 v[32:35],a[104:107],v[116:119],v[32:35]
ds_read_b128 v[76:79],v6 offset:3072
v_mfma_f32_16x16x32_bf16 v[36:39],a[108:111],v[116:119],v[36:39]
s_waitcnt lgkmcnt(5)
v_mfma_f32_16x16x32_bf16 v[32:35],a[112:115],v[120:123],v[32:35]
ds_read_b128 v[80:83],v6 offset:4096
v_mfma_f32_16x16x32_bf16 v[36:39],a[116:119],v[120:123],v[36:39]
s_waitcnt lgkmcnt(5)
v_mfma_f32_16x16x32_bf16 v[32:35],a[120:123],v[124:127],v[32:35]
ds_read_b128 v[84:87],v6 offset:5120
v_mfma_f32_16x16x32_bf16 v[36:39],a[124:127],v[124:127],v[36:39]
s_waitcnt lgkmcnt(5)
v_mfma_f32_16x16x32_bf16 v[32:35],a[128:131],v[64:67],v[32:35]
ds_read_b128 v[88:91],v6 offset:6144
v_mfma_f32_16x16x32_bf16 v[36:39],a[132:135],v[64:67],v[36:39]
s_waitcnt lgkmcnt(5)
v_mfma_f32_16x16x32_bf16 v[32:35],a[136:139],v[68:71],v[32:35]
ds_read_b128 v[92:95],v6 offset:7168
v_mfma_f32_16x16x32_bf16 v[36:39],a[140:143],v[68:71],v[36:39]
s_waitcnt lgkmcnt(5)
v_mfma_f32_16x16x32_bf16 v[32:35],a[144:147],v[72:75],v[32:35]
ds_read_b128 v[96:99],v7 offset:0
v_mfma_f32_16x16x32_bf16 v[36:39],a[148:151],v[72:75],v[36:39]
s_waitcnt lgkmcnt(5)
v_mfma_f32_16x16x32_bf16 v[32:35],a[152:155],v[76:79],v[32:35]
ds_read_b128 v[100:103],v7 offset:1024
v_mfma_f32_16x16x32_bf16 v[36:39],a[156:159],v[76:79],v[36:39]
s_waitcnt lgkmcnt(5)
v_mfma_f32_16x16x32_bf16 v[32:35],a[160:163],v[80:83],v[32:35]
ds_read_b128 v[104:107],v7 offset:2048
v_mfma_f32_16x16x32_bf16 v[36:39],a[164:167],v[80:83],v[36:39]
s_waitcnt lgkmcnt(5)
v_mfma_f32_16x16x32_bf16 v[32:35],a[168:171],v[84:87],v[32:35]
ds_read_b128 v[108:111],v7 offset:3072
v_mfma_f32_16x16x32_bf16 v[36:39],a[172:175],v[84:87],v[36:39]
s_waitcnt lgkmcnt(5)
v_mfma_f32_16x16x32_bf16 v[32:35],a[176:179],v[88:91],v[32:35]
ds_read_b128 v[112:115],v7 offset:4096
v_mfma_f32_16x16x32_bf16 v[36:39],a[180:183],v[88:91],v[36:39]
s_waitcnt lgkmcnt(5)
v_mfma_f32_16x16x32_bf16 v[32:35],a[184:187],v[92:95],v[32:35]
ds_read_b128 v[116:119],v7 offset:5120
v_mfma_f32_16x16x32_bf16 v[36:39],a[188:191],v[92:95],v[36:39]
s_waitcnt lgkmcnt(5)
v_mfma_f32_16x16x32_bf16 v[32:35],a[192:195],v[96:99],v[32:35]
ds_read_b128 v[120:123],v7 offset:6144
v_mfma_f32_16x16x32_bf16 v[36:39],a[196:199],v[96:99],v[36:39]
s_waitcnt lgkmcnt(5)
v_mfma_f32_16x16x32_bf16 v[32:35],a[200:203],v[100:103],v[32:35]
s_waitcnt vmcnt(3)
ds_read_b128 v[124:127],v7 offset:7168
v_lshlrev_b32 v168,16,v160
v_mfma_f32_16x16x32_bf16 v[36:39],a[204:207],v[100:103],v[36:39]
s_waitcnt lgkmcnt(5)
v_and_b32 v169,s73,v160
v_lshlrev_b32 v170,16,v161
v_mfma_f32_16x16x32_bf16 v[32:35],a[208:211],v[104:107],v[32:35]
s_add_u32 s55,s55,32768
v_and_b32 v171,s73,v161
v_lshlrev_b32 v172,16,v162
v_mfma_f32_16x16x32_bf16 v[36:39],a[212:215],v[104:107],v[36:39]
s_waitcnt lgkmcnt(4)
v_and_b32 v173,s73,v162
v_lshlrev_b32 v174,16,v163
v_mfma_f32_16x16x32_bf16 v[32:35],a[216:219],v[108:111],v[32:35]
s_and_b32 s55,s55,0x1ffff
v_and_b32 v175,s73,v163
v_add_u32 v4,s55,v8
v_mfma_f32_16x16x32_bf16 v[36:39],a[220:223],v[108:111],v[36:39]
s_waitcnt lgkmcnt(3)
v_add_u32 v5,s55,v9
v_add_u32 v6,s55,v10
v_mfma_f32_16x16x32_bf16 v[32:35],a[224:227],v[112:115],v[32:35]
v_add_u32 v7,s55,v11
v_mfma_f32_16x16x32_bf16 v[36:39],a[228:231],v[112:115],v[36:39]
s_waitcnt lgkmcnt(2)
v_mfma_f32_16x16x32_bf16 v[32:35],a[232:235],v[116:119],v[32:35]
v_mfma_f32_16x16x32_bf16 v[36:39],a[236:239],v[116:119],v[36:39]
s_waitcnt lgkmcnt(1)
v_mfma_f32_16x16x32_bf16 v[32:35],a[240:243],v[120:123],v[32:35]
v_mfma_f32_16x16x32_bf16 v[36:39],a[244:247],v[120:123],v[36:39]
s_waitcnt lgkmcnt(0)
v_mfma_f32_16x16x32_bf16 v[40:43],a[248:251],v[124:127],v[32:35]
v_mfma_f32_16x16x32_bf16 v[44:47],a[252:255],v[124:127],v[36:39]
s_waitcnt vmcnt(2)
v_cmp_gt_u32 vcc,s71,v16
s_add_u32 s60,s60,1
s_branch endN_342
BN_336:
s_waitcnt vmcnt(9)
ds_read_b128 v[64:67],v4 offset:0
s_waitcnt vmcnt(8)
ds_read_b128 v[68:71],v4 offset:1024
s_waitcnt vmcnt(7)
ds_read_b128 v[72:75],v4 offset:2048
s_waitcnt vmcnt(6)
ds_read_b128 v[76:79],v4 offset:3072
s_waitcnt lgkmcnt(3)
v_mfma_f32_16x16x32_bf16 v[32:35],a[0:3],v[64:67],0
buffer_load_dwordx4 v[160:163],v0,s[20:23],s82 offen
v_mfma_f32_16x16x32_bf16 v[36:39],a[4:7],v[64:67],0
s_waitcnt lgkmcnt(2)
s_waitcnt vmcnt(6)
s_add_u32 s82,s82,32768
ds_read_b128 v[80:83],v4 offset:4096
v_mfma_f32_16x16x32_bf16 v[32:35],a[8:11],v[68:71],v[32:35]
s_add_u32 s71,s60,s75
s_cmp_eq_u32 s60,126
s_cselect_b32 s71,128,s71
v_mfma_f32_16x16x32_bf16 v[36:39],a[12:15],v[68:71],v[36:39]
s_waitcnt lgkmcnt(2)
s_waitcnt vmcnt(5)
ds_read_b128 v[84:87],v4 offset:5120
v_mfma_f32_16x16x32_bf16 v[32:35],a[16:19],v[72:75],v[32:35]
s_add_u32 s53,s60,s76
s_cmp_eq_u32 s60,125
s_cselect_b32 s53,128,s53
v_mfma_f32_16x16x32_bf16 v[36:39],a[20:23],v[72:75],v[36:39]
s_waitcnt lgkmcnt(2)
s_waitcnt vmcnt(4)
ds_read_b128 v[88:91],v4 offset:6144
v_mfma_f32_16x16x32_bf16 v[32:35],a[24:27],v[76:79],v[32:35]
s_mov_b32 s57,s63
v_mfma_f32_16x16x32_bf16 v[36:39],a[28:31],v[76:79],v[36:39]
s_waitcnt lgkmcnt(2)
s_waitcnt vmcnt(3)
ds_read_b128 v[92:95],v4 offset:7168
v_mfma_f32_16x16x32_bf16 v[32:35],a[32:35],v[80:83],v[32:35]
v_mfma_f32_16x16x32_bf16 v[36:39],a[36:39],v[80:83],v[36:39]
s_waitcnt lgkmcnt(2)
s_barrier
ds_read_b128 v[96:99],v5 offset:0
v_mfma_f32_16x16x32_bf16 v[32:35],a[40:43],v[84:87],v[32:35]
ds_read_b128 v[100:103],v5 offset:1024
v_mfma_f32_16x16x32_bf16 v[36:39],a[44:47],v[84:87],v[36:39]
s_waitcnt lgkmcnt(3)
ds_read_b128 v[104:107],v5 offset:2048
v_mfma_f32_16x16x32_bf16 v[32:35],a[48:51],v[88:91],v[32:35]
ds_read_b128 v[108:111],v5 offset:3072
v_mfma_f32_16x16x32_bf16 v[36:39],a[52:55],v[88:91],v[36:39]
s_waitcnt lgkmcnt(4)
ds_read_b128 v[112:115],v5 offset:4096
v_mfma_f32_16x16x32_bf16 v[32:35],a[56:59],v[92:95],v[32:35]
ds_read_b128 v[116:119],v5 offset:5120
v_mfma_f32_16x16x32_bf16 v[36:39],a[60:63],v[92:95],v[36:39]
s_waitcnt lgkmcnt(5)
v_mfma_f32_16x16x32_bf16 v[32:35],a[64:67],v[96:99],v[32:35]
ds_read_b128 v[120:123],v5 offset:6144
v_mfma_f32_16x16x32_bf16 v[36:39],a[68:71],v[96:99],v[36:39]
s_waitcnt lgkmcnt(5)
v_mfma_f32_16x16x32_bf16 v[32:35],a[72:75],v[100:103],v[32:35]
ds_read_b128 v[124:127],v5 offset:7168
v_mfma_f32_16x16x32_bf16 v[36:39],a[76:79],v[100:103],v[36:39]
s_waitcnt lgkmcnt(5)
v_mfma_f32_16x16x32_bf16 v[32:35],a[80:83],v[104:107],v[32:35]
ds_read_b128 v[64:67],v6 offset:0
v_mfma_f32_16x16x32_bf16 v[36:39],a[84:87],v[104:107],v[36:39]
s_waitcnt lgkmcnt(5)
v_mfma_f32_16x16x32_bf16 v[32:35],a[88:91],v[108:111],v[32:35]
ds_read_b128 v[68:71],v6 offset:1024
v_mfma_f32_16x16x32_bf16 v[36:39],a[92:95],v[108:111],v[36:39]
s_waitcnt lgkmcnt(5)
v_mfma_f32_16x16x32_bf16 v[32:35],a[96:99],v[112:115],v[32:35]
ds_read_b128 v[72:75],v6 offset:2048
v_mfma_f32_16x16x32_bf16 v[36:39],a[100:103],v[112:115],v[36:39]
s_waitcnt lgkmcnt(5)
v_mfma_f32_16x16x32_bf16 v[32:35],a[104:107],v[116:119],v[32:35]
ds_read_b128 v[76:79],v6 offset:3072
v_mfma_f32_16x16x32_bf16 v[36:39],a[108:111],v[116:119],v[36:39]
s_waitcnt lgkmcnt(5)
v_mfma_f32_16x16x32_bf16 v[32:35],a[112:115],v[120:123],v[32:35]
ds_read_b128 v[80:83],v6 offset:4096
v_mfma_f32_16x16x32_bf16 v[36:39],a[116:119],v[120:123],v[36:39]
s_waitcnt lgkmcnt(5)
v_mfma_f32_16x16x32_bf16 v[32:35],a[120:123],v[124:127],v[32:35]
ds_read_b128 v[84:87],v6 offset:5120
v_mfma_f32_16x16x32_bf16 v[36:39],a[124:127],v[124:127],v[36:39]
s_waitcnt lgkmcnt(5)
v_mfma_f32_16x16x32_bf16 v[32:35],a[128:131],v[64:67],v[32:35]
ds_read_b128 v[88:91],v6 offset:6144
v_mfma_f32_16x16x32_bf16 v[36:39],a[132:135],v[64:67],v[36:39]
s_waitcnt lgkmcnt(5)
v_mfma_f32_16x16x32_bf16 v[32:35],a[136:139],v[68:71],v[32:35]
ds_read_b128 v[92:95],v6 offset:7168
v_mfma_f32_16x16x32_bf16 v[36:39],a[140:143],v[68:71],v[36:39]
s_waitcnt lgkmcnt(5)
v_mfma_f32_16x16x32_bf16 v[32:35],a[144:147],v[72:75],v[32:35]
ds_read_b128 v[96:99],v7 offset:0
v_mfma_f32_16x16x32_bf16 v[36:39],a[148:151],v[72:75],v[36:39]
s_waitcnt lgkmcnt(5)
s_waitcnt vmcnt(2)
v_mov_b32 v17,s57
buffer_store_dword v17,v26,s[20:23],s69 offen sc1
v_mfma_f32_16x16x32_bf16 v[32:35],a[152:155],v[76:79],v[32:35]
ds_read_b128 v[100:103],v7 offset:1024
v_mfma_f32_16x16x32_bf16 v[36:39],a[156:159],v[76:79],v[36:39]
s_waitcnt lgkmcnt(5)
v_mfma_f32_16x16x32_bf16 v[32:35],a[160:163],v[80:83],v[32:35]
ds_read_b128 v[104:107],v7 offset:2048
buffer_load_dword v16,v2,s[20:23],s68 offen sc1
v_mfma_f32_16x16x32_bf16 v[36:39],a[164:167],v[80:83],v[36:39]
s_waitcnt lgkmcnt(5)
v_mfma_f32_16x16x32_bf16 v[32:35],a[168:171],v[84:87],v[32:35]
ds_read_b128 v[108:111],v7 offset:3072
v_mfma_f32_16x16x32_bf16 v[36:39],a[172:175],v[84:87],v[36:39]
s_waitcnt lgkmcnt(5)
v_mfma_f32_16x16x32_bf16 v[32:35],a[176:179],v[88:91],v[32:35]
ds_read_b128 v[112:115],v7 offset:4096
v_mfma_f32_16x16x32_bf16 v[36:39],a[180:183],v[88:91],v[36:39]
s_waitcnt lgkmcnt(5)
v_mfma_f32_16x16x32_bf16 v[32:35],a[184:187],v[92:95],v[32:35]
ds_read_b128 v[116:119],v7 offset:5120
v_mfma_f32_16x16x32_bf16 v[36:39],a[188:191],v[92:95],v[36:39]
s_waitcnt lgkmcnt(5)
v_mfma_f32_16x16x32_bf16 v[32:35],a[192:195],v[96:99],v[32:35]
ds_read_b128 v[120:123],v7 offset:6144
v_mfma_f32_16x16x32_bf16 v[36:39],a[196:199],v[96:99],v[36:39]
s_waitcnt lgkmcnt(5)
v_mfma_f32_16x16x32_bf16 v[32:35],a[200:203],v[100:103],v[32:35]
s_waitcnt vmcnt(2)
ds_read_b128 v[124:127],v7 offset:7168
v_lshlrev_b32 v168,16,v160
v_mfma_f32_16x16x32_bf16 v[36:39],a[204:207],v[100:103],v[36:39]
s_waitcnt lgkmcnt(5)
v_and_b32 v169,s73,v160
v_lshlrev_b32 v170,16,v161
v_mfma_f32_16x16x32_bf16 v[32:35],a[208:211],v[104:107],v[32:35]
s_add_u32 s55,s55,32768
v_and_b32 v171,s73,v161
v_lshlrev_b32 v172,16,v162
v_mfma_f32_16x16x32_bf16 v[36:39],a[212:215],v[104:107],v[36:39]
s_waitcnt lgkmcnt(4)
v_and_b32 v173,s73,v162
v_lshlrev_b32 v174,16,v163
v_mfma_f32_16x16x32_bf16 v[32:35],a[216:219],v[108:111],v[32:35]
s_and_b32 s55,s55,0x1ffff
v_and_b32 v175,s73,v163
v_add_u32 v4,s55,v8
v_mfma_f32_16x16x32_bf16 v[36:39],a[220:223],v[108:111],v[36:39]
s_waitcnt lgkmcnt(3)
v_add_u32 v5,s55,v9
v_add_u32 v6,s55,v10
v_mfma_f32_16x16x32_bf16 v[32:35],a[224:227],v[112:115],v[32:35]
v_add_u32 v7,s55,v11
v_mfma_f32_16x16x32_bf16 v[36:39],a[228:231],v[112:115],v[36:39]
s_waitcnt lgkmcnt(2)
v_mfma_f32_16x16x32_bf16 v[32:35],a[232:235],v[116:119],v[32:35]
v_mfma_f32_16x16x32_bf16 v[36:39],a[236:239],v[116:119],v[36:39]
s_waitcnt lgkmcnt(1)
v_mfma_f32_16x16x32_bf16 v[32:35],a[240:243],v[120:123],v[32:35]
v_mfma_f32_16x16x32_bf16 v[36:39],a[244:247],v[120:123],v[36:39]
s_waitcnt lgkmcnt(0)
v_mfma_f32_16x16x32_bf16 v[40:43],a[248:251],v[124:127],v[32:35]
v_mfma_f32_16x16x32_bf16 v[44:47],a[252:255],v[124:127],v[36:39]
s_waitcnt vmcnt(0)
v_cmp_gt_u32 vcc,s71,v16
s_add_u32 s60,s60,1
endN_342:
s_cbranch_vccnz nb_339
s_mov_b32 m0,s70
s_nop 0
buffer_load_dwordx4 v3,s[20:23],s61 offen offset:0 lds
buffer_load_dwordx4 v3,s[20:23],s61 offen offset:1024 lds
buffer_load_dwordx4 v3,s[20:23],s61 offen offset:2048 lds
buffer_load_dwordx4 v3,s[20:23],s61 offen offset:3072 lds
s_add_u32 m0,s70,4096
s_nop 0
buffer_load_dwordx4 v3,s[20:23],s62 offen offset:0 lds
buffer_load_dwordx4 v3,s[20:23],s62 offen offset:1024 lds
buffer_load_dwordx4 v3,s[20:23],s62 offen offset:2048 lds
buffer_load_dwordx4 v3,s[20:23],s62 offen offset:3072 lds
s_add_u32 s61,s61,32768
s_add_u32 s62,s62,32768
s_add_u32 s70,s70,32768
s_and_b32 s70,s70,0x1ffff
s_mov_b32 s57,s63
v_pk_add_f32 v[40:41],v[40:41],v[168:169]
v_pk_add_f32 v[42:43],v[42:43],v[170:171]
v_pk_add_f32 v[44:45],v[44:45],v[172:173]
v_pk_add_f32 v[46:47],v[46:47],v[174:175]
v_cvt_pk_bf16_f32 v176,v40,v41
v_cvt_pk_bf16_f32 v177,v42,v43
v_cvt_pk_bf16_f32 v178,v44,v45
v_cvt_pk_bf16_f32 v179,v46,v47
buffer_store_dwordx4 v[176:179],v0,s[20:23],s66 offen sc1
s_add_u32 s66,s66,32768
s_add_u32 s63,s63,1
s_waitcnt vmcnt(9)
v_mov_b32 v17,s57
buffer_store_dword v17,v26,s[20:23],s69 offen sc1
s_branch dec_338
nb_339:
buffer_load_dword v16,v2,s[20:23],s68 offen sc1
s_nop 3
s_mov_b32 s57,s63
v_pk_add_f32 v[40:41],v[40:41],v[168:169]
v_pk_add_f32 v[42:43],v[42:43],v[170:171]
v_pk_add_f32 v[44:45],v[44:45],v[172:173]
v_pk_add_f32 v[46:47],v[46:47],v[174:175]
v_cvt_pk_bf16_f32 v176,v40,v41
v_cvt_pk_bf16_f32 v177,v42,v43
v_cvt_pk_bf16_f32 v178,v44,v45
v_cvt_pk_bf16_f32 v179,v46,v47
buffer_store_dwordx4 v[176:179],v0,s[20:23],s66 offen sc1
s_add_u32 s66,s66,32768
s_add_u32 s63,s63,1
s_waitcnt vmcnt(2)
v_mov_b32 v17,s57
buffer_store_dword v17,v26,s[20:23],s69 offen sc1
s_waitcnt vmcnt(2)
v_cmp_gt_u32 vcc,s71,v16
s_cbranch_vccz lag_337
s_waitcnt vmcnt(1)
v_mov_b32 v17,s63
buffer_store_dword v17,v26,s[20:23],s69 offen sc1
s_cmp_ge_u32 s60,128
s_cbranch_scc1 done_326
plp_343:
buffer_load_dword v16,v2,s[20:23],s68 offen sc1
s_waitcnt vmcnt(0)
v_cmp_gt_u32 vcc,s71,v16
s_cbranch_vccz pok_344
s_sleep 4
s_sub_u32 s90,s90,1
s_cmp_gt_i32 s90,0
s_cbranch_scc1 plp_343
pok_344:
s_branch lag_337
done_326:
s_endpgm
fl_ln2:
s_mov_b32 s52,s59
s_mov_b32 s60,0
s_mov_b32 s73,0xffff0000
v_and_b32 v2,3,v1
v_lshrrev_b32 v3,2,v1
s_lshl_b32 s64,s52,2
v_add_u32 v4,s64,v2
s_lshl_b32 s65,s50,9
v_lshlrev_b32 v5,4,v3
v_add_u32 v5,s65,v5
v_lshl_add_u32 v8,v4,11,v5
v_lshlrev_b32 v9,1,v5
v_lshrrev_b32 v5,2,v3
v_and_b32 v3,3,v3
s_lshl_b32 s65,s50,13
v_lshlrev_b32 v5,10,v5
v_lshl_add_u32 v5,v3,8,v5
v_lshl_add_u32 v5,v4,4,v5
v_add_u32 v10,s65,v5
s_lshl_b32 s65,s50,9
v_lshlrev_b32 v5,3,v1
v_add_u32 v11,s65,v5
v_lshlrev_b32 v12,3,v2
v_and_b32 v13,7,v1
v_lshlrev_b32 v13,2,v13
s_mov_b32 s92,s2
s_and_b32 s93,s3,0xffff
s_mov_b32 s94,0x100
s_mov_b32 s95,0x20000
v_mbcnt_lo_u32_b32 v16,-1,0
v_mbcnt_hi_u32_b32 v16,-1,v16
v_mov_b32 v18,0
v_cmp_eq_u32 vcc,22,v16
s_nop 1
v_cndmask_b32 v18,v18,63,vcc
v_cmp_eq_u32 vcc,17,v16
s_nop 1
v_cndmask_b32 v18,v18,63,vcc
v_cmp_eq_u32 vcc,18,v16
s_nop 1
v_cndmask_b32 v18,v18,1,vcc
v_and_b32 v19,1,v16
v_cmp_eq_u32 vcc,1,v19
v_mov_b32 v19,8192
s_nop 0
v_cndmask_b32 v19,-1,v19,vcc
v_min_u32 v16,31,v16
v_lshlrev_b32 v16,2,v16
s_sub_u32 s66,s88,64
s_cmp_lg_u32 s50,0
s_cbranch_scc1 vot_350
vpoll_346:
buffer_load_dword v17,v16,s[92:95],s66 offen sc1
s_waitcnt vmcnt(0)
s_cmp_lg_u32 s56,2
s_cbranch_scc1 vck_347
v_cmp_eq_u32 vcc,v17,v19
s_and_b32 s64,vcc_lo,0xffff
s_cmp_eq_u32 s64,65535
s_cbranch_scc1 vck_347
s_mov_b32 s65,0
v_readlane_b32 s64,v17,1
s_lshr_b32 s64,s64,8
s_add_u32 s65,s65,s64
v_readlane_b32 s64,v17,3
s_lshr_b32 s64,s64,8
s_add_u32 s65,s65,s64
v_readlane_b32 s64,v17,5
s_lshr_b32 s64,s64,8
s_add_u32 s65,s65,s64
v_readlane_b32 s64,v17,7
s_lshr_b32 s64,s64,8
s_add_u32 s65,s65,s64
v_readlane_b32 s64,v17,9
s_lshr_b32 s64,s64,8
s_add_u32 s65,s65,s64
v_readlane_b32 s64,v17,11
s_lshr_b32 s64,s64,8
s_add_u32 s65,s65,s64
v_readlane_b32 s64,v17,13
s_lshr_b32 s64,s64,8
s_add_u32 s65,s65,s64
v_readlane_b32 s64,v17,15
s_lshr_b32 s64,s64,8
s_add_u32 s65,s65,s64
s_cmp_ge_u32 s65,256
s_cbranch_scc1 vok_349
s_branch vrt_348
vck_347:
v_cmp_gt_u32 vcc,v18,v17
s_cbranch_vccz vok_349
vrt_348:
s_sleep 48
s_sub_u32 s90,s90,1
s_cmp_gt_i32 s90,0
s_cbranch_scc1 vpoll_346
vok_349:
v_add_u32 v18,161024,v16
ds_write_b32 v18,v17
s_waitcnt lgkmcnt(0)
vot_350:
s_barrier
v_add_u32 v18,161024,v16
ds_read_b32 v17,v18
s_waitcnt lgkmcnt(0)
s_cmp_lg_u32 s56,2
s_cbranch_scc1 vfin_351
v_cmp_eq_u32 vcc,v17,v19
s_and_b32 s64,vcc_lo,0xffff
s_cmp_eq_u32 s64,65535
s_cbranch_scc1 vfin_351
s_mov_b32 s65,0
v_readlane_b32 s64,v17,1
s_lshr_b32 s64,s64,8
s_add_u32 s65,s65,s64
v_readlane_b32 s64,v17,3
s_lshr_b32 s64,s64,8
s_add_u32 s65,s65,s64
v_readlane_b32 s64,v17,5
s_lshr_b32 s64,s64,8
s_add_u32 s65,s65,s64
v_readlane_b32 s64,v17,7
s_lshr_b32 s64,s64,8
s_add_u32 s65,s65,s64
v_readlane_b32 s64,v17,9
s_lshr_b32 s64,s64,8
s_add_u32 s65,s65,s64
v_readlane_b32 s64,v17,11
s_lshr_b32 s64,s64,8
s_add_u32 s65,s65,s64
v_readlane_b32 s64,v17,13
s_lshr_b32 s64,s64,8
s_add_u32 s65,s65,s64
v_readlane_b32 s64,v17,15
s_lshr_b32 s64,s64,8
s_add_u32 s65,s65,s64
s_cmp_ge_u32 s65,256
s_cbranch_scc1 fl_fb
vfin_351:
s_and_b32 s56,s56,1
s_mov_b32 s67,0
s_mov_b32 s64,267403264
buffer_load_dwordx4 v[32:35],v9,s[20:23],s64 offen offset:0 sc1
buffer_load_dwordx4 v[36:39],v9,s[20:23],s64 offen offset:16 sc1
buffer_load_dwordx4 v[40:43],v9,s[20:23],s64 offen offset:512 sc1
buffer_load_dwordx4 v[44:47],v9,s[20:23],s64 offen offset:528 sc1
s_mov_b32 s64,267427840
buffer_load_dwordx4 v[64:67],v9,s[20:23],s64 offen offset:0 sc1
buffer_load_dwordx4 v[68:71],v9,s[20:23],s64 offen offset:16 sc1
buffer_load_dwordx4 v[72:75],v9,s[20:23],s64 offen offset:512 sc1
buffer_load_dwordx4 v[76:79],v9,s[20:23],s64 offen offset:528 sc1
s_mov_b32 s64,267452416
buffer_load_dwordx4 v[80:83],v9,s[20:23],s64 offen offset:0 sc1
buffer_load_dwordx4 v[84:87],v9,s[20:23],s64 offen offset:16 sc1
buffer_load_dwordx4 v[88:91],v9,s[20:23],s64 offen offset:512 sc1
buffer_load_dwordx4 v[92:95],v9,s[20:23],s64 offen offset:528 sc1
s_mov_b32 s64,267476992
buffer_load_dwordx4 v[96:99],v9,s[20:23],s64 offen offset:0 sc1
buffer_load_dwordx4 v[100:103],v9,s[20:23],s64 offen offset:16 sc1
buffer_load_dwordx4 v[104:107],v9,s[20:23],s64 offen offset:512 sc1
buffer_load_dwordx4 v[108:111],v9,s[20:23],s64 offen offset:528 sc1
s_waitcnt vmcnt(0)
v_pk_add_f32 v[32:33],v[32:33],v[64:65]
v_pk_add_f32 v[80:81],v[80:81],v[96:97]
v_pk_add_f32 v[34:35],v[34:35],v[66:67]
v_pk_add_f32 v[82:83],v[82:83],v[98:99]
v_pk_add_f32 v[36:37],v[36:37],v[68:69]
v_pk_add_f32 v[84:85],v[84:85],v[100:101]
v_pk_add_f32 v[38:39],v[38:39],v[70:71]
v_pk_add_f32 v[86:87],v[86:87],v[102:103]
v_pk_add_f32 v[40:41],v[40:41],v[72:73]
v_pk_add_f32 v[88:89],v[88:89],v[104:105]
v_pk_add_f32 v[42:43],v[42:43],v[74:75]
v_pk_add_f32 v[90:91],v[90:91],v[106:107]
v_pk_add_f32 v[44:45],v[44:45],v[76:77]
v_pk_add_f32 v[92:93],v[92:93],v[108:109]
v_pk_add_f32 v[46:47],v[46:47],v[78:79]
v_pk_add_f32 v[94:95],v[94:95],v[110:111]
v_pk_add_f32 v[32:33],v[32:33],v[80:81]
v_pk_add_f32 v[34:35],v[34:35],v[82:83]
v_pk_add_f32 v[36:37],v[36:37],v[84:85]
v_pk_add_f32 v[38:39],v[38:39],v[86:87]
v_pk_add_f32 v[40:41],v[40:41],v[88:89]
v_pk_add_f32 v[42:43],v[42:43],v[90:91]
v_pk_add_f32 v[44:45],v[44:45],v[92:93]
v_pk_add_f32 v[46:47],v[46:47],v[94:95]
v_cvt_pk_bf16_f32 v64,v32,v33
v_cvt_pk_bf16_f32 v65,v34,v35
v_cvt_pk_bf16_f32 v66,v36,v37
v_cvt_pk_bf16_f32 v67,v38,v39
v_cvt_pk_bf16_f32 v68,v40,v41
v_cvt_pk_bf16_f32 v69,v42,v43
v_cvt_pk_bf16_f32 v70,v44,v45
v_cvt_pk_bf16_f32 v71,v46,v47
v_lshlrev_b32 v32,16,v64
v_and_b32 v33,s73,v64
v_lshlrev_b32 v34,16,v65
v_and_b32 v35,s73,v65
v_lshlrev_b32 v36,16,v66
v_and_b32 v37,s73,v66
v_lshlrev_b32 v38,16,v67
v_and_b32 v39,s73,v67
v_lshlrev_b32 v40,16,v68
v_and_b32 v41,s73,v68
v_lshlrev_b32 v42,16,v69
v_and_b32 v43,s73,v69
v_lshlrev_b32 v44,16,v70
v_and_b32 v45,s73,v70
v_lshlrev_b32 v46,16,v71
v_and_b32 v47,s73,v71
v_add_f32 v32,1.0,v32
v_add_f32 v33,1.0,v33
v_add_f32 v34,1.0,v34
v_add_f32 v35,1.0,v35
v_add_f32 v36,1.0,v36
v_add_f32 v37,1.0,v37
v_add_f32 v38,1.0,v38
v_add_f32 v39,1.0,v39
v_add_f32 v40,1.0,v40
v_add_f32 v41,1.0,v41
v_add_f32 v42,1.0,v42
v_add_f32 v43,1.0,v43
v_add_f32 v44,1.0,v44
v_add_f32 v45,1.0,v45
v_add_f32 v46,1.0,v46
v_add_f32 v47,1.0,v47
s_mov_b32 s64,267399168
buffer_load_dwordx4 v[48:51],v9,s[20:23],s64 offen offset:0 sc1
buffer_load_dwordx4 v[52:55],v9,s[20:23],s64 offen offset:16 sc1
buffer_load_dwordx4 v[56:59],v9,s[20:23],s64 offen offset:512 sc1
buffer_load_dwordx4 v[60:63],v9,s[20:23],s64 offen offset:528 sc1
s_mov_b32 s64,267423744
buffer_load_dwordx4 v[64:67],v9,s[20:23],s64 offen offset:0 sc1
buffer_load_dwordx4 v[68:71],v9,s[20:23],s64 offen offset:16 sc1
buffer_load_dwordx4 v[72:75],v9,s[20:23],s64 offen offset:512 sc1
buffer_load_dwordx4 v[76:79],v9,s[20:23],s64 offen offset:528 sc1
s_mov_b32 s64,267448320
buffer_load_dwordx4 v[80:83],v9,s[20:23],s64 offen offset:0 sc1
buffer_load_dwordx4 v[84:87],v9,s[20:23],s64 offen offset:16 sc1
buffer_load_dwordx4 v[88:91],v9,s[20:23],s64 offen offset:512 sc1
buffer_load_dwordx4 v[92:95],v9,s[20:23],s64 offen offset:528 sc1
s_mov_b32 s64,267472896
buffer_load_dwordx4 v[96:99],v9,s[20:23],s64 offen offset:0 sc1
buffer_load_dwordx4 v[100:103],v9,s[20:23],s64 offen offset:16 sc1
buffer_load_dwordx4 v[104:107],v9,s[20:23],s64 offen offset:512 sc1
buffer_load_dwordx4 v[108:111],v9,s[20:23],s64 offen offset:528 sc1
s_waitcnt vmcnt(0)
v_pk_add_f32 v[48:49],v[48:49],v[64:65]
v_pk_add_f32 v[80:81],v[80:81],v[96:97]
v_pk_add_f32 v[50:51],v[50:51],v[66:67]
v_pk_add_f32 v[82:83],v[82:83],v[98:99]
v_pk_add_f32 v[52:53],v[52:53],v[68:69]
v_pk_add_f32 v[84:85],v[84:85],v[100:101]
v_pk_add_f32 v[54:55],v[54:55],v[70:71]
v_pk_add_f32 v[86:87],v[86:87],v[102:103]
v_pk_add_f32 v[56:57],v[56:57],v[72:73]
v_pk_add_f32 v[88:89],v[88:89],v[104:105]
v_pk_add_f32 v[58:59],v[58:59],v[74:75]
v_pk_add_f32 v[90:91],v[90:91],v[106:107]
v_pk_add_f32 v[60:61],v[60:61],v[76:77]
v_pk_add_f32 v[92:93],v[92:93],v[108:109]
v_pk_add_f32 v[62:63],v[62:63],v[78:79]
v_pk_add_f32 v[94:95],v[94:95],v[110:111]
v_pk_add_f32 v[48:49],v[48:49],v[80:81]
v_pk_add_f32 v[50:51],v[50:51],v[82:83]
v_pk_add_f32 v[52:53],v[52:53],v[84:85]
v_pk_add_f32 v[54:55],v[54:55],v[86:87]
v_pk_add_f32 v[56:57],v[56:57],v[88:89]
v_pk_add_f32 v[58:59],v[58:59],v[90:91]
v_pk_add_f32 v[60:61],v[60:61],v[92:93]
v_pk_add_f32 v[62:63],v[62:63],v[94:95]
v_cvt_pk_bf16_f32 v64,v48,v49
v_cvt_pk_bf16_f32 v65,v50,v51
v_cvt_pk_bf16_f32 v66,v52,v53
v_cvt_pk_bf16_f32 v67,v54,v55
v_cvt_pk_bf16_f32 v68,v56,v57
v_cvt_pk_bf16_f32 v69,v58,v59
v_cvt_pk_bf16_f32 v70,v60,v61
v_cvt_pk_bf16_f32 v71,v62,v63
v_lshlrev_b32 v48,16,v64
v_and_b32 v49,s73,v64
v_lshlrev_b32 v50,16,v65
v_and_b32 v51,s73,v65
v_lshlrev_b32 v52,16,v66
v_and_b32 v53,s73,v66
v_lshlrev_b32 v54,16,v67
v_and_b32 v55,s73,v67
v_lshlrev_b32 v56,16,v68
v_and_b32 v57,s73,v68
v_lshlrev_b32 v58,16,v69
v_and_b32 v59,s73,v69
v_lshlrev_b32 v60,16,v70
v_and_b32 v61,s73,v70
v_lshlrev_b32 v62,16,v71
v_and_b32 v63,s73,v71
s_mov_b32 s63,201326592
s_mov_b32 s66,205520896
s_lshl_b32 s64,s50,8
s_add_u32 s68,s64,138547200
s_lshl_b32 s65,s59,2
s_add_u32 s69,s64,s65
s_add_u32 s69,s69,138548224
s_lshl_b32 s64,s50,9
s_lshl_b32 s65,s59,7
s_add_u32 s69,s64,s65
s_add_u32 s69,s69,138567680
v_lshlrev_b32 v16,2,v1
v_cmp_gt_u32 vcc,32,v1
s_nop 1
v_cndmask_b32 v16,2.0,v16,vcc
s_cmp_eq_u32 s56,1
s_cbranch_scc1 lfar_352
s_mov_b32 s71,1
plp_355:
buffer_load_dword v14,v13,s[20:23],s68 offen sc1
s_waitcnt vmcnt(0)
v_cmp_gt_u32 vcc,s71,v14
s_cbranch_vccz pok_356
s_sleep 4
s_sub_u32 s90,s90,1
s_cmp_gt_i32 s90,0
s_cbranch_scc1 plp_355
pok_356:
s_add_u32 s64,s63,4096
buffer_load_dwordx4 v[64:67],v10,s[20:23],s63 offen
buffer_load_dwordx4 v[68:71],v10,s[20:23],s64 offen
s_add_u32 s63,s63,32768
buffer_load_dword v15,off,s[20:23],s68
buffer_load_dword v15,off,s[20:23],s68
top0_353:
buffer_load_dword v14,v13,s[20:23],s68 offen sc1
s_add_u32 s71,s60,2
s_waitcnt vmcnt(3)
v_lshlrev_b32 v80,16,v64
v_and_b32 v81,s73,v64
v_lshlrev_b32 v82,16,v65
v_and_b32 v83,s73,v65
v_lshlrev_b32 v84,16,v66
v_and_b32 v85,s73,v66
v_lshlrev_b32 v86,16,v67
v_and_b32 v87,s73,v67
v_lshlrev_b32 v88,16,v68
v_and_b32 v89,s73,v68
v_lshlrev_b32 v90,16,v69
v_and_b32 v91,s73,v69
v_lshlrev_b32 v92,16,v70
v_and_b32 v93,s73,v70
v_lshlrev_b32 v94,16,v71
v_and_b32 v95,s73,v71
v_add_f32 v96,v80,v81
v_mul_f32 v97,v80,v80
v_add_f32 v98,v82,v83
v_mul_f32 v99,v81,v81
v_fmac_f32 v97,v82,v82
v_fmac_f32 v99,v83,v83
v_add_f32 v96,v96,v84
v_fmac_f32 v97,v84,v84
v_add_f32 v98,v98,v85
v_fmac_f32 v99,v85,v85
v_add_f32 v96,v96,v86
v_fmac_f32 v97,v86,v86
v_add_f32 v98,v98,v87
v_fmac_f32 v99,v87,v87
v_add_f32 v96,v96,v88
v_fmac_f32 v97,v88,v88
v_add_f32 v98,v98,v89
v_fmac_f32 v99,v89,v89
v_add_f32 v96,v96,v90
v_fmac_f32 v97,v90,v90
v_add_f32 v98,v98,v91
v_fmac_f32 v99,v91,v91
v_add_f32 v96,v96,v92
v_fmac_f32 v97,v92,v92
v_add_f32 v98,v98,v93
v_fmac_f32 v99,v93,v93
v_add_f32 v96,v96,v94
v_fmac_f32 v97,v94,v94
v_add_f32 v98,v98,v95
v_fmac_f32 v99,v95,v95
v_add_f32 v96,v96,v98
v_add_f32 v97,v97,v99
s_nop 0
v_add_f32_dpp v96,v96,v96 row_ror:4 row_mask:0xf bank_mask:0xf
v_add_f32_dpp v97,v97,v97 row_ror:4 row_mask:0xf bank_mask:0xf
s_nop 0
v_add_f32_dpp v96,v96,v96 row_ror:8 row_mask:0xf bank_mask:0xf
v_add_f32_dpp v97,v97,v97 row_ror:8 row_mask:0xf bank_mask:0xf
v_mov_b32 v98,v96
v_mov_b32 v99,v97
s_nop 0
v_permlane16_swap_b32 v98,v96
v_permlane16_swap_b32 v99,v97
v_add_f32 v96,v96,v98
v_add_f32 v97,v97,v99
v_mov_b32 v98,v96
v_mov_b32 v99,v97
s_nop 0
v_permlane32_swap_b32 v98,v96
v_permlane32_swap_b32 v99,v97
v_add_f32 v96,v96,v98
v_add_f32 v97,v97,v99
ds_write_b64 v11,v[96:97] offset:0
s_waitcnt lgkmcnt(0)
s_barrier
s_waitcnt vmcnt(0)
v_mov_b32 v15,s60
buffer_store_dword v15,v16,s[20:23],s69 offen
v_cmp_gt_u32 vcc,s71,v14
s_mov_b32 s72,0
s_cbranch_vccnz p2_358
s_mov_b32 s72,1
s_add_u32 s64,s63,4096
buffer_load_dwordx4 v[72:75],v10,s[20:23],s63 offen
buffer_load_dwordx4 v[76:79],v10,s[20:23],s64 offen
s_add_u32 s63,s63,32768
p2_358:
ds_read_b64 v[100:101],v12 offset:0
ds_read_b64 v[102:103],v12 offset:512
ds_read_b64 v[104:105],v12 offset:1024
ds_read_b64 v[106:107],v12 offset:1536
s_waitcnt lgkmcnt(0)
v_add_f32 v100,v100,v102
v_add_f32 v101,v101,v103
v_add_f32 v104,v104,v106
v_add_f32 v105,v105,v107
v_add_f32 v100,v100,v104
v_add_f32 v101,v101,v105
v_mul_f32 v96,0xba800000,v100
v_mul_f32 v102,v96,v96
v_mul_f32 v101,0x3a800000,v101
v_sub_f32 v101,v101,v102
v_max_f32 v101,0,v101
v_add_f32 v101,0x3727c5ac,v101
v_rsq_f32 v97,v101
s_nop 0
v_mul_f32 v96,v96,v97
v_fma_f32 v80,v80,v97,v96
v_fma_f32 v81,v81,v97,v96
v_fma_f32 v82,v82,v97,v96
v_fma_f32 v83,v83,v97,v96
v_fma_f32 v84,v84,v97,v96
v_fma_f32 v85,v85,v97,v96
v_fma_f32 v86,v86,v97,v96
v_fma_f32 v87,v87,v97,v96
v_fma_f32 v88,v88,v97,v96
v_fma_f32 v89,v89,v97,v96
v_fma_f32 v90,v90,v97,v96
v_fma_f32 v91,v91,v97,v96
v_fma_f32 v92,v92,v97,v96
v_fma_f32 v93,v93,v97,v96
v_fma_f32 v94,v94,v97,v96
v_fma_f32 v95,v95,v97,v96
v_fma_f32 v80,v80,v32,v48
v_fma_f32 v81,v81,v33,v49
v_fma_f32 v82,v82,v34,v50
v_fma_f32 v83,v83,v35,v51
v_fma_f32 v84,v84,v36,v52
v_fma_f32 v85,v85,v37,v53
v_fma_f32 v86,v86,v38,v54
v_fma_f32 v87,v87,v39,v55
v_fma_f32 v88,v88,v40,v56
v_fma_f32 v89,v89,v41,v57
v_fma_f32 v90,v90,v42,v58
v_fma_f32 v91,v91,v43,v59
v_fma_f32 v92,v92,v44,v60
v_fma_f32 v93,v93,v45,v61
v_fma_f32 v94,v94,v46,v62
v_fma_f32 v95,v95,v47,v63
v_cvt_pk_bf16_f32 v112,v80,v81
v_cvt_pk_bf16_f32 v113,v82,v83
v_cvt_pk_bf16_f32 v114,v84,v85
v_cvt_pk_bf16_f32 v115,v86,v87
v_cvt_pk_bf16_f32 v116,v88,v89
v_cvt_pk_bf16_f32 v117,v90,v91
v_cvt_pk_bf16_f32 v118,v92,v93
v_cvt_pk_bf16_f32 v119,v94,v95
s_add_u32 s64,s66,4096
buffer_store_dwordx4 v[112:115],v10,s[20:23],s66 offen sc1
buffer_store_dwordx4 v[116:119],v10,s[20:23],s64 offen sc1
s_add_u32 s66,s66,32768
s_add_u32 s60,s60,1
s_cmp_eq_u32 s72,0
s_cbranch_scc1 slowp_357
top1_354:
buffer_load_dword v14,v13,s[20:23],s68 offen sc1
s_add_u32 s71,s60,2
s_waitcnt vmcnt(3)
v_lshlrev_b32 v80,16,v72
v_and_b32 v81,s73,v72
v_lshlrev_b32 v82,16,v73
v_and_b32 v83,s73,v73
v_lshlrev_b32 v84,16,v74
v_and_b32 v85,s73,v74
v_lshlrev_b32 v86,16,v75
v_and_b32 v87,s73,v75
v_lshlrev_b32 v88,16,v76
v_and_b32 v89,s73,v76
v_lshlrev_b32 v90,16,v77
v_and_b32 v91,s73,v77
v_lshlrev_b32 v92,16,v78
v_and_b32 v93,s73,v78
v_lshlrev_b32 v94,16,v79
v_and_b32 v95,s73,v79
v_add_f32 v96,v80,v81
v_mul_f32 v97,v80,v80
v_add_f32 v98,v82,v83
v_mul_f32 v99,v81,v81
v_fmac_f32 v97,v82,v82
v_fmac_f32 v99,v83,v83
v_add_f32 v96,v96,v84
v_fmac_f32 v97,v84,v84
v_add_f32 v98,v98,v85
v_fmac_f32 v99,v85,v85
v_add_f32 v96,v96,v86
v_fmac_f32 v97,v86,v86
v_add_f32 v98,v98,v87
v_fmac_f32 v99,v87,v87
v_add_f32 v96,v96,v88
v_fmac_f32 v97,v88,v88
v_add_f32 v98,v98,v89
v_fmac_f32 v99,v89,v89
v_add_f32 v96,v96,v90
v_fmac_f32 v97,v90,v90
v_add_f32 v98,v98,v91
v_fmac_f32 v99,v91,v91
v_add_f32 v96,v96,v92
v_fmac_f32 v97,v92,v92
v_add_f32 v98,v98,v93
v_fmac_f32 v99,v93,v93
v_add_f32 v96,v96,v94
v_fmac_f32 v97,v94,v94
v_add_f32 v98,v98,v95
v_fmac_f32 v99,v95,v95
v_add_f32 v96,v96,v98
v_add_f32 v97,v97,v99
s_nop 0
v_add_f32_dpp v96,v96,v96 row_ror:4 row_mask:0xf bank_mask:0xf
v_add_f32_dpp v97,v97,v97 row_ror:4 row_mask:0xf bank_mask:0xf
s_nop 0
v_add_f32_dpp v96,v96,v96 row_ror:8 row_mask:0xf bank_mask:0xf
v_add_f32_dpp v97,v97,v97 row_ror:8 row_mask:0xf bank_mask:0xf
v_mov_b32 v98,v96
v_mov_b32 v99,v97
s_nop 0
v_permlane16_swap_b32 v98,v96
v_permlane16_swap_b32 v99,v97
v_add_f32 v96,v96,v98
v_add_f32 v97,v97,v99
v_mov_b32 v98,v96
v_mov_b32 v99,v97
s_nop 0
v_permlane32_swap_b32 v98,v96
v_permlane32_swap_b32 v99,v97
v_add_f32 v96,v96,v98
v_add_f32 v97,v97,v99
ds_write_b64 v11,v[96:97] offset:2048
s_waitcnt lgkmcnt(0)
s_barrier
s_waitcnt vmcnt(0)
v_mov_b32 v15,s60
buffer_store_dword v15,v16,s[20:23],s69 offen
v_cmp_gt_u32 vcc,s71,v14
s_mov_b32 s72,0
s_cbranch_vccnz p2_360
s_mov_b32 s72,1
s_add_u32 s64,s63,4096
buffer_load_dwordx4 v[64:67],v10,s[20:23],s63 offen
buffer_load_dwordx4 v[68:71],v10,s[20:23],s64 offen
s_add_u32 s63,s63,32768
p2_360:
ds_read_b64 v[100:101],v12 offset:2048
ds_read_b64 v[102:103],v12 offset:2560
ds_read_b64 v[104:105],v12 offset:3072
ds_read_b64 v[106:107],v12 offset:3584
s_waitcnt lgkmcnt(0)
v_add_f32 v100,v100,v102
v_add_f32 v101,v101,v103
v_add_f32 v104,v104,v106
v_add_f32 v105,v105,v107
v_add_f32 v100,v100,v104
v_add_f32 v101,v101,v105
v_mul_f32 v96,0xba800000,v100
v_mul_f32 v102,v96,v96
v_mul_f32 v101,0x3a800000,v101
v_sub_f32 v101,v101,v102
v_max_f32 v101,0,v101
v_add_f32 v101,0x3727c5ac,v101
v_rsq_f32 v97,v101
s_nop 0
v_mul_f32 v96,v96,v97
v_fma_f32 v80,v80,v97,v96
v_fma_f32 v81,v81,v97,v96
v_fma_f32 v82,v82,v97,v96
v_fma_f32 v83,v83,v97,v96
v_fma_f32 v84,v84,v97,v96
v_fma_f32 v85,v85,v97,v96
v_fma_f32 v86,v86,v97,v96
v_fma_f32 v87,v87,v97,v96
v_fma_f32 v88,v88,v97,v96
v_fma_f32 v89,v89,v97,v96
v_fma_f32 v90,v90,v97,v96
v_fma_f32 v91,v91,v97,v96
v_fma_f32 v92,v92,v97,v96
v_fma_f32 v93,v93,v97,v96
v_fma_f32 v94,v94,v97,v96
v_fma_f32 v95,v95,v97,v96
v_fma_f32 v80,v80,v32,v48
v_fma_f32 v81,v81,v33,v49
v_fma_f32 v82,v82,v34,v50
v_fma_f32 v83,v83,v35,v51
v_fma_f32 v84,v84,v36,v52
v_fma_f32 v85,v85,v37,v53
v_fma_f32 v86,v86,v38,v54
v_fma_f32 v87,v87,v39,v55
v_fma_f32 v88,v88,v40,v56
v_fma_f32 v89,v89,v41,v57
v_fma_f32 v90,v90,v42,v58
v_fma_f32 v91,v91,v43,v59
v_fma_f32 v92,v92,v44,v60
v_fma_f32 v93,v93,v45,v61
v_fma_f32 v94,v94,v46,v62
v_fma_f32 v95,v95,v47,v63
v_cvt_pk_bf16_f32 v112,v80,v81
v_cvt_pk_bf16_f32 v113,v82,v83
v_cvt_pk_bf16_f32 v114,v84,v85
v_cvt_pk_bf16_f32 v115,v86,v87
v_cvt_pk_bf16_f32 v116,v88,v89
v_cvt_pk_bf16_f32 v117,v90,v91
v_cvt_pk_bf16_f32 v118,v92,v93
v_cvt_pk_bf16_f32 v119,v94,v95
s_add_u32 s64,s66,4096
buffer_store_dwordx4 v[112:115],v10,s[20:23],s66 offen sc1
buffer_store_dwordx4 v[116:119],v10,s[20:23],s64 offen sc1
s_add_u32 s66,s66,32768
s_add_u32 s60,s60,1
s_cmp_eq_u32 s72,0
s_cbranch_scc1 slowp_359
s_branch top0_353
slowp_357:
buffer_load_dword v14,v13,s[20:23],s68 offen sc1
s_waitcnt vmcnt(1)
v_mov_b32 v15,s60
buffer_store_dword v15,v16,s[20:23],s69 offen
s_cmp_ge_u32 s60,128
s_cbranch_scc1 done_345
s_waitcnt vmcnt(1)
v_cmp_gt_u32 vcc,s71,v14
s_cbranch_vccz go_361
plp_362:
buffer_load_dword v14,v13,s[20:23],s68 offen sc1
s_waitcnt vmcnt(0)
v_cmp_gt_u32 vcc,s71,v14
s_cbranch_vccz pok_363
s_sleep 4
s_sub_u32 s90,s90,1
s_cmp_gt_i32 s90,0
s_cbranch_scc1 plp_362
pok_363:
go_361:
s_add_u32 s64,s63,4096
buffer_load_dwordx4 v[72:75],v10,s[20:23],s63 offen
buffer_load_dwordx4 v[76:79],v10,s[20:23],s64 offen
s_add_u32 s63,s63,32768
buffer_load_dword v15,off,s[20:23],s68
buffer_load_dword v15,off,s[20:23],s68
s_branch top1_354
slowp_359:
buffer_load_dword v14,v13,s[20:23],s68 offen sc1
s_waitcnt vmcnt(1)
v_mov_b32 v15,s60
buffer_store_dword v15,v16,s[20:23],s69 offen
s_cmp_ge_u32 s60,128
s_cbranch_scc1 done_345
s_waitcnt vmcnt(1)
v_cmp_gt_u32 vcc,s71,v14
s_cbranch_vccz go_364
plp_365:
buffer_load_dword v14,v13,s[20:23],s68 offen sc1
s_waitcnt vmcnt(0)
v_cmp_gt_u32 vcc,s71,v14
s_cbranch_vccz pok_366
s_sleep 4
s_sub_u32 s90,s90,1
s_cmp_gt_i32 s90,0
s_cbranch_scc1 plp_365
pok_366:
go_364:
s_add_u32 s64,s63,4096
buffer_load_dwordx4 v[64:67],v10,s[20:23],s63 offen
buffer_load_dwordx4 v[68:71],v10,s[20:23],s64 offen
s_add_u32 s63,s63,32768
buffer_load_dword v15,off,s[20:23],s68
buffer_load_dword v15,off,s[20:23],s68
s_branch top0_353
lfar_352:
s_mov_b32 s71,1
plp_369:
buffer_load_dword v14,v13,s[20:23],s68 offen sc1
s_waitcnt vmcnt(0)
v_cmp_gt_u32 vcc,s71,v14
s_cbranch_vccz pok_370
s_sleep 4
s_sub_u32 s90,s90,1
s_cmp_gt_i32 s90,0
s_cbranch_scc1 plp_369
pok_370:
s_add_u32 s64,s63,4096
buffer_load_dwordx4 v[64:67],v10,s[20:23],s63 offen
buffer_load_dwordx4 v[68:71],v10,s[20:23],s64 offen
s_add_u32 s63,s63,32768
buffer_load_dword v15,off,s[20:23],s68
buffer_load_dword v15,off,s[20:23],s68
top0_367:
buffer_load_dword v14,v13,s[20:23],s68 offen sc1
s_add_u32 s71,s60,2
s_waitcnt vmcnt(3)
v_lshlrev_b32 v80,16,v64
v_and_b32 v81,s73,v64
v_lshlrev_b32 v82,16,v65
v_and_b32 v83,s73,v65
v_lshlrev_b32 v84,16,v66
v_and_b32 v85,s73,v66
v_lshlrev_b32 v86,16,v67
v_and_b32 v87,s73,v67
v_lshlrev_b32 v88,16,v68
v_and_b32 v89,s73,v68
v_lshlrev_b32 v90,16,v69
v_and_b32 v91,s73,v69
v_lshlrev_b32 v92,16,v70
v_and_b32 v93,s73,v70
v_lshlrev_b32 v94,16,v71
v_and_b32 v95,s73,v71
v_add_f32 v96,v80,v81
v_mul_f32 v97,v80,v80
v_add_f32 v98,v82,v83
v_mul_f32 v99,v81,v81
v_fmac_f32 v97,v82,v82
v_fmac_f32 v99,v83,v83
v_add_f32 v96,v96,v84
v_fmac_f32 v97,v84,v84
v_add_f32 v98,v98,v85
v_fmac_f32 v99,v85,v85
v_add_f32 v96,v96,v86
v_fmac_f32 v97,v86,v86
v_add_f32 v98,v98,v87
v_fmac_f32 v99,v87,v87
v_add_f32 v96,v96,v88
v_fmac_f32 v97,v88,v88
v_add_f32 v98,v98,v89
v_fmac_f32 v99,v89,v89
v_add_f32 v96,v96,v90
v_fmac_f32 v97,v90,v90
v_add_f32 v98,v98,v91
v_fmac_f32 v99,v91,v91
v_add_f32 v96,v96,v92
v_fmac_f32 v97,v92,v92
v_add_f32 v98,v98,v93
v_fmac_f32 v99,v93,v93
v_add_f32 v96,v96,v94
v_fmac_f32 v97,v94,v94
v_add_f32 v98,v98,v95
v_fmac_f32 v99,v95,v95
v_add_f32 v96,v96,v98
v_add_f32 v97,v97,v99
s_nop 0
v_add_f32_dpp v96,v96,v96 row_ror:4 row_mask:0xf bank_mask:0xf
v_add_f32_dpp v97,v97,v97 row_ror:4 row_mask:0xf bank_mask:0xf
s_nop 0
v_add_f32_dpp v96,v96,v96 row_ror:8 row_mask:0xf bank_mask:0xf
v_add_f32_dpp v97,v97,v97 row_ror:8 row_mask:0xf bank_mask:0xf
v_mov_b32 v98,v96
v_mov_b32 v99,v97
s_nop 0
v_permlane16_swap_b32 v98,v96
v_permlane16_swap_b32 v99,v97
v_add_f32 v96,v96,v98
v_add_f32 v97,v97,v99
v_mov_b32 v98,v96
v_mov_b32 v99,v97
s_nop 0
v_permlane32_swap_b32 v98,v96
v_permlane32_swap_b32 v99,v97
v_add_f32 v96,v96,v98
v_add_f32 v97,v97,v99
ds_write_b64 v11,v[96:97] offset:0
s_waitcnt lgkmcnt(0)
s_barrier
s_waitcnt vmcnt(0)
v_mov_b32 v15,s60
buffer_store_dword v15,v16,s[20:23],s69 offen sc1
v_cmp_gt_u32 vcc,s71,v14
s_mov_b32 s72,0
s_cbranch_vccnz p2_372
s_mov_b32 s72,1
s_add_u32 s64,s63,4096
buffer_load_dwordx4 v[72:75],v10,s[20:23],s63 offen
buffer_load_dwordx4 v[76:79],v10,s[20:23],s64 offen
s_add_u32 s63,s63,32768
p2_372:
ds_read_b64 v[100:101],v12 offset:0
ds_read_b64 v[102:103],v12 offset:512
ds_read_b64 v[104:105],v12 offset:1024
ds_read_b64 v[106:107],v12 offset:1536
s_waitcnt lgkmcnt(0)
v_add_f32 v100,v100,v102
v_add_f32 v101,v101,v103
v_add_f32 v104,v104,v106
v_add_f32 v105,v105,v107
v_add_f32 v100,v100,v104
v_add_f32 v101,v101,v105
v_mul_f32 v96,0xba800000,v100
v_mul_f32 v102,v96,v96
v_mul_f32 v101,0x3a800000,v101
v_sub_f32 v101,v101,v102
v_max_f32 v101,0,v101
v_add_f32 v101,0x3727c5ac,v101
v_rsq_f32 v97,v101
s_nop 0
v_mul_f32 v96,v96,v97
v_fma_f32 v80,v80,v97,v96
v_fma_f32 v81,v81,v97,v96
v_fma_f32 v82,v82,v97,v96
v_fma_f32 v83,v83,v97,v96
v_fma_f32 v84,v84,v97,v96
v_fma_f32 v85,v85,v97,v96
v_fma_f32 v86,v86,v97,v96
v_fma_f32 v87,v87,v97,v96
v_fma_f32 v88,v88,v97,v96
v_fma_f32 v89,v89,v97,v96
v_fma_f32 v90,v90,v97,v96
v_fma_f32 v91,v91,v97,v96
v_fma_f32 v92,v92,v97,v96
v_fma_f32 v93,v93,v97,v96
v_fma_f32 v94,v94,v97,v96
v_fma_f32 v95,v95,v97,v96
v_fma_f32 v80,v80,v32,v48
v_fma_f32 v81,v81,v33,v49
v_fma_f32 v82,v82,v34,v50
v_fma_f32 v83,v83,v35,v51
v_fma_f32 v84,v84,v36,v52
v_fma_f32 v85,v85,v37,v53
v_fma_f32 v86,v86,v38,v54
v_fma_f32 v87,v87,v39,v55
v_fma_f32 v88,v88,v40,v56
v_fma_f32 v89,v89,v41,v57
v_fma_f32 v90,v90,v42,v58
v_fma_f32 v91,v91,v43,v59
v_fma_f32 v92,v92,v44,v60
v_fma_f32 v93,v93,v45,v61
v_fma_f32 v94,v94,v46,v62
v_fma_f32 v95,v95,v47,v63
v_cvt_pk_bf16_f32 v112,v80,v81
v_cvt_pk_bf16_f32 v113,v82,v83
v_cvt_pk_bf16_f32 v114,v84,v85
v_cvt_pk_bf16_f32 v115,v86,v87
v_cvt_pk_bf16_f32 v116,v88,v89
v_cvt_pk_bf16_f32 v117,v90,v91
v_cvt_pk_bf16_f32 v118,v92,v93
v_cvt_pk_bf16_f32 v119,v94,v95
s_add_u32 s64,s66,4096
buffer_store_dwordx4 v[112:115],v10,s[20:23],s66 offen sc1
buffer_store_dwordx4 v[116:119],v10,s[20:23],s64 offen sc1
s_add_u32 s66,s66,32768
s_add_u32 s60,s60,1
s_cmp_eq_u32 s72,0
s_cbranch_scc1 slowp_371
top1_368:
buffer_load_dword v14,v13,s[20:23],s68 offen sc1
s_add_u32 s71,s60,2
s_waitcnt vmcnt(3)
v_lshlrev_b32 v80,16,v72
v_and_b32 v81,s73,v72
v_lshlrev_b32 v82,16,v73
v_and_b32 v83,s73,v73
v_lshlrev_b32 v84,16,v74
v_and_b32 v85,s73,v74
v_lshlrev_b32 v86,16,v75
v_and_b32 v87,s73,v75
v_lshlrev_b32 v88,16,v76
v_and_b32 v89,s73,v76
v_lshlrev_b32 v90,16,v77
v_and_b32 v91,s73,v77
v_lshlrev_b32 v92,16,v78
v_and_b32 v93,s73,v78
v_lshlrev_b32 v94,16,v79
v_and_b32 v95,s73,v79
v_add_f32 v96,v80,v81
v_mul_f32 v97,v80,v80
v_add_f32 v98,v82,v83
v_mul_f32 v99,v81,v81
v_fmac_f32 v97,v82,v82
v_fmac_f32 v99,v83,v83
v_add_f32 v96,v96,v84
v_fmac_f32 v97,v84,v84
v_add_f32 v98,v98,v85
v_fmac_f32 v99,v85,v85
v_add_f32 v96,v96,v86
v_fmac_f32 v97,v86,v86
v_add_f32 v98,v98,v87
v_fmac_f32 v99,v87,v87
v_add_f32 v96,v96,v88
v_fmac_f32 v97,v88,v88
v_add_f32 v98,v98,v89
v_fmac_f32 v99,v89,v89
v_add_f32 v96,v96,v90
v_fmac_f32 v97,v90,v90
v_add_f32 v98,v98,v91
v_fmac_f32 v99,v91,v91
v_add_f32 v96,v96,v92
v_fmac_f32 v97,v92,v92
v_add_f32 v98,v98,v93
v_fmac_f32 v99,v93,v93
v_add_f32 v96,v96,v94
v_fmac_f32 v97,v94,v94
v_add_f32 v98,v98,v95
v_fmac_f32 v99,v95,v95
v_add_f32 v96,v96,v98
v_add_f32 v97,v97,v99
s_nop 0
v_add_f32_dpp v96,v96,v96 row_ror:4 row_mask:0xf bank_mask:0xf
v_add_f32_dpp v97,v97,v97 row_ror:4 row_mask:0xf bank_mask:0xf
s_nop 0
v_add_f32_dpp v96,v96,v96 row_ror:8 row_mask:0xf bank_mask:0xf
v_add_f32_dpp v97,v97,v97 row_ror:8 row_mask:0xf bank_mask:0xf
v_mov_b32 v98,v96
v_mov_b32 v99,v97
s_nop 0
v_permlane16_swap_b32 v98,v96
v_permlane16_swap_b32 v99,v97
v_add_f32 v96,v96,v98
v_add_f32 v97,v97,v99
v_mov_b32 v98,v96
v_mov_b32 v99,v97
s_nop 0
v_permlane32_swap_b32 v98,v96
v_permlane32_swap_b32 v99,v97
v_add_f32 v96,v96,v98
v_add_f32 v97,v97,v99
ds_write_b64 v11,v[96:97] offset:2048
s_waitcnt lgkmcnt(0)
s_barrier
s_waitcnt vmcnt(0)
v_mov_b32 v15,s60
buffer_store_dword v15,v16,s[20:23],s69 offen sc1
v_cmp_gt_u32 vcc,s71,v14
s_mov_b32 s72,0
s_cbranch_vccnz p2_374
s_mov_b32 s72,1
s_add_u32 s64,s63,4096
buffer_load_dwordx4 v[64:67],v10,s[20:23],s63 offen
buffer_load_dwordx4 v[68:71],v10,s[20:23],s64 offen
s_add_u32 s63,s63,32768
p2_374:
ds_read_b64 v[100:101],v12 offset:2048
ds_read_b64 v[102:103],v12 offset:2560
ds_read_b64 v[104:105],v12 offset:3072
ds_read_b64 v[106:107],v12 offset:3584
s_waitcnt lgkmcnt(0)
v_add_f32 v100,v100,v102
v_add_f32 v101,v101,v103
v_add_f32 v104,v104,v106
v_add_f32 v105,v105,v107
v_add_f32 v100,v100,v104
v_add_f32 v101,v101,v105
v_mul_f32 v96,0xba800000,v100
v_mul_f32 v102,v96,v96
v_mul_f32 v101,0x3a800000,v101
v_sub_f32 v101,v101,v102
v_max_f32 v101,0,v101
v_add_f32 v101,0x3727c5ac,v101
v_rsq_f32 v97,v101
s_nop 0
v_mul_f32 v96,v96,v97
v_fma_f32 v80,v80,v97,v96
v_fma_f32 v81,v81,v97,v96
v_fma_f32 v82,v82,v97,v96
v_fma_f32 v83,v83,v97,v96
v_fma_f32 v84,v84,v97,v96
v_fma_f32 v85,v85,v97,v96
v_fma_f32 v86,v86,v97,v96
v_fma_f32 v87,v87,v97,v96
v_fma_f32 v88,v88,v97,v96
v_fma_f32 v89,v89,v97,v96
v_fma_f32 v90,v90,v97,v96
v_fma_f32 v91,v91,v97,v96
v_fma_f32 v92,v92,v97,v96
v_fma_f32 v93,v93,v97,v96
v_fma_f32 v94,v94,v97,v96
v_fma_f32 v95,v95,v97,v96
v_fma_f32 v80,v80,v32,v48
v_fma_f32 v81,v81,v33,v49
v_fma_f32 v82,v82,v34,v50
v_fma_f32 v83,v83,v35,v51
v_fma_f32 v84,v84,v36,v52
v_fma_f32 v85,v85,v37,v53
v_fma_f32 v86,v86,v38,v54
v_fma_f32 v87,v87,v39,v55
v_fma_f32 v88,v88,v40,v56
v_fma_f32 v89,v89,v41,v57
v_fma_f32 v90,v90,v42,v58
v_fma_f32 v91,v91,v43,v59
v_fma_f32 v92,v92,v44,v60
v_fma_f32 v93,v93,v45,v61
v_fma_f32 v94,v94,v46,v62
v_fma_f32 v95,v95,v47,v63
v_cvt_pk_bf16_f32 v112,v80,v81
v_cvt_pk_bf16_f32 v113,v82,v83
v_cvt_pk_bf16_f32 v114,v84,v85
v_cvt_pk_bf16_f32 v115,v86,v87
v_cvt_pk_bf16_f32 v116,v88,v89
v_cvt_pk_bf16_f32 v117,v90,v91
v_cvt_pk_bf16_f32 v118,v92,v93
v_cvt_pk_bf16_f32 v119,v94,v95
s_add_u32 s64,s66,4096
buffer_store_dwordx4 v[112:115],v10,s[20:23],s66 offen sc1
buffer_store_dwordx4 v[116:119],v10,s[20:23],s64 offen sc1
s_add_u32 s66,s66,32768
s_add_u32 s60,s60,1
s_cmp_eq_u32 s72,0
s_cbranch_scc1 slowp_373
s_branch top0_367
slowp_371:
buffer_load_dword v14,v13,s[20:23],s68 offen sc1
s_waitcnt vmcnt(1)
v_mov_b32 v15,s60
buffer_store_dword v15,v16,s[20:23],s69 offen sc1
s_cmp_ge_u32 s60,128
s_cbranch_scc1 done_345
s_waitcnt vmcnt(1)
v_cmp_gt_u32 vcc,s71,v14
s_cbranch_vccz go_375
plp_376:
buffer_load_dword v14,v13,s[20:23],s68 offen sc1
s_waitcnt vmcnt(0)
v_cmp_gt_u32 vcc,s71,v14
s_cbranch_vccz pok_377
s_sleep 4
s_sub_u32 s90,s90,1
s_cmp_gt_i32 s90,0
s_cbranch_scc1 plp_376
pok_377:
go_375:
s_add_u32 s64,s63,4096
buffer_load_dwordx4 v[72:75],v10,s[20:23],s63 offen
buffer_load_dwordx4 v[76:79],v10,s[20:23],s64 offen
s_add_u32 s63,s63,32768
buffer_load_dword v15,off,s[20:23],s68
buffer_load_dword v15,off,s[20:23],s68
s_branch top1_368
slowp_373:
buffer_load_dword v14,v13,s[20:23],s68 offen sc1
s_waitcnt vmcnt(1)
v_mov_b32 v15,s60
buffer_store_dword v15,v16,s[20:23],s69 offen sc1
s_cmp_ge_u32 s60,128
s_cbranch_scc1 done_345
s_waitcnt vmcnt(1)
v_cmp_gt_u32 vcc,s71,v14
s_cbranch_vccz go_378
plp_379:
buffer_load_dword v14,v13,s[20:23],s68 offen sc1
s_waitcnt vmcnt(0)
v_cmp_gt_u32 vcc,s71,v14
s_cbranch_vccz pok_380
s_sleep 4
s_sub_u32 s90,s90,1
s_cmp_gt_i32 s90,0
s_cbranch_scc1 plp_379
pok_380:
go_378:
s_add_u32 s64,s63,4096
buffer_load_dwordx4 v[64:67],v10,s[20:23],s63 offen
buffer_load_dwordx4 v[68:71],v10,s[20:23],s64 offen
s_add_u32 s63,s63,32768
buffer_load_dword v15,off,s[20:23],s68
buffer_load_dword v15,off,s[20:23],s68
s_branch top0_367
done_345:
s_endpgm
fl_att:
s_mov_b32 s92,s2
s_and_b32 s93,s3,0xffff
s_mov_b32 s94,0x100
s_mov_b32 s95,0x20000
v_mbcnt_lo_u32_b32 v16,-1,0
v_mbcnt_hi_u32_b32 v16,-1,v16
v_mov_b32 v18,0
v_cmp_eq_u32 vcc,22,v16
s_nop 1
v_cndmask_b32 v18,v18,63,vcc
v_cmp_eq_u32 vcc,21,v16
s_nop 1
v_cndmask_b32 v18,v18,1,vcc
v_and_b32 v19,1,v16
v_cmp_eq_u32 vcc,1,v19
v_mov_b32 v19,8192
s_nop 0
v_cndmask_b32 v19,-1,v19,vcc
v_min_u32 v16,31,v16
v_lshlrev_b32 v16,2,v16
s_sub_u32 s66,s88,64
s_cmp_lg_u32 s50,0
s_cbranch_scc1 vot_385
vpoll_381:
buffer_load_dword v17,v16,s[92:95],s66 offen sc1
s_waitcnt vmcnt(0)
s_cmp_lg_u32 s56,2
s_cbranch_scc1 vck_382
v_cmp_eq_u32 vcc,v17,v19
s_and_b32 s64,vcc_lo,0xffff
s_cmp_eq_u32 s64,65535
s_cbranch_scc1 vck_382
s_mov_b32 s65,0
v_readlane_b32 s64,v17,1
s_lshr_b32 s64,s64,8
s_add_u32 s65,s65,s64
v_readlane_b32 s64,v17,3
s_lshr_b32 s64,s64,8
s_add_u32 s65,s65,s64
v_readlane_b32 s64,v17,5
s_lshr_b32 s64,s64,8
s_add_u32 s65,s65,s64
v_readlane_b32 s64,v17,7
s_lshr_b32 s64,s64,8
s_add_u32 s65,s65,s64
v_readlane_b32 s64,v17,9
s_lshr_b32 s64,s64,8
s_add_u32 s65,s65,s64
v_readlane_b32 s64,v17,11
s_lshr_b32 s64,s64,8
s_add_u32 s65,s65,s64
v_readlane_b32 s64,v17,13
s_lshr_b32 s64,s64,8
s_add_u32 s65,s65,s64
v_readlane_b32 s64,v17,15
s_lshr_b32 s64,s64,8
s_add_u32 s65,s65,s64
s_cmp_ge_u32 s65,256
s_cbranch_scc1 vok_384
s_branch vrt_383
vck_382:
v_cmp_gt_u32 vcc,v18,v17
s_cbranch_vccz vok_384
vrt_383:
s_sleep 8
s_sub_u32 s90,s90,1
s_cmp_gt_i32 s90,0
s_cbranch_scc1 vpoll_381
vok_384:
v_add_u32 v18,161280,v16
ds_write_b32 v18,v17
s_waitcnt lgkmcnt(0)
vot_385:
s_barrier
v_add_u32 v18,161280,v16
ds_read_b32 v17,v18
s_waitcnt lgkmcnt(0)
s_cmp_lg_u32 s56,2
s_cbranch_scc1 vfin_386
v_cmp_eq_u32 vcc,v17,v19
s_and_b32 s64,vcc_lo,0xffff
s_cmp_eq_u32 s64,65535
s_cbranch_scc1 vfin_386
s_mov_b32 s65,0
v_readlane_b32 s64,v17,1
s_lshr_b32 s64,s64,8
s_add_u32 s65,s65,s64
v_readlane_b32 s64,v17,3
s_lshr_b32 s64,s64,8
s_add_u32 s65,s65,s64
v_readlane_b32 s64,v17,5
s_lshr_b32 s64,s64,8
s_add_u32 s65,s65,s64
v_readlane_b32 s64,v17,7
s_lshr_b32 s64,s64,8
s_add_u32 s65,s65,s64
v_readlane_b32 s64,v17,9
s_lshr_b32 s64,s64,8
s_add_u32 s65,s65,s64
v_readlane_b32 s64,v17,11
s_lshr_b32 s64,s64,8
s_add_u32 s65,s65,s64
v_readlane_b32 s64,v17,13
s_lshr_b32 s64,s64,8
s_add_u32 s65,s65,s64
v_readlane_b32 s64,v17,15
s_lshr_b32 s64,s64,8
s_add_u32 s65,s65,s64
s_cmp_ge_u32 s65,256
s_cbranch_scc1 fl_fb
vfin_386:
s_and_b32 s56,s56,1
s_mov_b32 s67,0
v_readlane_b32 s65,v17,21
s_and_b32 s65,s65,2
s_lshl_b32 s67,s65,12
v_lshlrev_b32 v0,4,v1
v_and_b32 v21,15,v1
v_lshrrev_b32 v22,4,v1
v_and_b32 v23,7,v21
v_lshlrev_b32 v23,4,v23
v_lshl_add_u32 v3,v22,8,v23
v_and_b32 v23,31,v1
v_lshlrev_b32 v4,4,v23
v_and_b32 v23,3,v1
v_bfe_u32 v24,v1,2,1
v_lshlrev_b32 v23,14,v23
v_lshl_add_u32 v2,v24,7,v23
v_mov_b32 v7,0xff800000
s_and_b32 s54,s50,1
s_lshl_b32 s64,s54,4
v_lshlrev_b32 v23,2,v22
v_sub_u32 v23,v21,v23
v_add_u32 v23,s64,v23
v_cmp_le_i32 s[28:29],0,v23
v_cmp_le_i32 s[30:31],1,v23
v_cmp_le_i32 s[32:33],2,v23
v_cmp_le_i32 s[34:35],3,v23
v_cmp_le_i32 s[36:37],16,v23
v_cmp_le_i32 s[38:39],17,v23
v_cmp_le_i32 s[40:41],18,v23
v_cmp_le_i32 s[42:43],19,v23
s_mov_b32 s44,-1
s_mov_b32 s45,0
s_mov_b32 s80,0x3e0293ee
s_lshl_b32 s52,s59,1
s_lshr_b32 s64,s50,1
s_add_u32 s52,s52,s64
s_lshl_b32 s53,s52,15
s_lshl_b32 s68,s52,8
s_add_u32 s68,s68,s67
s_add_u32 s68,s68,138428416
s_lshl_b32 s69,s59,8
s_lshl_b32 s64,s64,2
s_add_u32 s69,s69,s64
s_lshl_b32 s64,s54,3
s_add_u32 s69,s69,s64
s_add_u32 s69,s69,138543104
s_lshl_b32 s66,s52,12
s_lshl_b32 s64,s54,17
s_add_u32 s66,s66,s64
s_add_u32 s66,s66,150994944
s_lshl_b32 s55,s54,10
s_xor_b32 s55,s55,0x2000
s_mov_b32 s60,0
s_add_u32 s64,s69,16
v_mov_b32 v6,124
s_mov_b64 exec,1
buffer_store_dword v6,off,s[20:23],s64 sc1
s_mov_b64 exec,-1
s_add_u32 s64,s69,32
v_mov_b32 v6,126
s_mov_b64 exec,1
buffer_store_dword v6,off,s[20:23],s64 sc1
s_mov_b64 exec,-1
s_mov_b32 s71,1
plp_387:
buffer_load_dword v5,v2,s[20:23],s68 offen sc1
s_waitcnt vmcnt(0)
v_cmp_gt_u32 vcc,s71,v5
s_cbranch_vccz pok_388
s_sleep 4
s_sub_u32 s90,s90,1
s_cmp_gt_i32 s90,0
s_cbranch_scc1 plp_387
pok_388:
s_add_u32 s64,s60,0
s_lshl_b32 s65,s64,11
s_and_b32 s65,s65,0x2000
s_xor_b32 s65,s65,s67
s_lshl_b32 s64,s64,19
s_add_u32 s64,s64,s65
s_add_u32 s92,s64,s53
s_add_u32 s93,s92,16384
s_add_u32 s94,s92,4096
s_add_u32 s95,s93,4096
s_xor_b32 s96,s92,s55
s_xor_b32 s97,s93,s55
buffer_load_dwordx4 a[0:3],v0,s[20:23],s96 offen offset:0
buffer_load_dwordx4 a[16:19],v0,s[20:23],s92 offen offset:0
buffer_load_dwordx4 a[32:35],v0,s[20:23],s92 offen offset:1024
buffer_load_dwordx4 a[4:7],v0,s[20:23],s96 offen offset:2048
buffer_load_dwordx4 a[20:23],v0,s[20:23],s92 offen offset:2048
buffer_load_dwordx4 a[36:39],v0,s[20:23],s92 offen offset:3072
buffer_load_dwordx4 a[8:11],v0,s[20:23],s97 offen offset:0
buffer_load_dwordx4 a[24:27],v0,s[20:23],s93 offen offset:0
buffer_load_dwordx4 a[40:43],v0,s[20:23],s93 offen offset:1024
buffer_load_dwordx4 a[12:15],v0,s[20:23],s97 offen offset:2048
buffer_load_dwordx4 a[28:31],v0,s[20:23],s93 offen offset:2048
buffer_load_dwordx4 a[44:47],v0,s[20:23],s93 offen offset:3072
buffer_load_dwordx4 a[48:51],v0,s[20:23],s94 offen offset:0
buffer_load_dwordx4 a[52:55],v0,s[20:23],s94 offen offset:1024
buffer_load_dwordx4 a[56:59],v0,s[20:23],s94 offen offset:2048
buffer_load_dwordx4 a[60:63],v0,s[20:23],s94 offen offset:3072
buffer_load_dwordx4 a[64:67],v0,s[20:23],s95 offen offset:0
buffer_load_dwordx4 a[68:71],v0,s[20:23],s95 offen offset:1024
buffer_load_dwordx4 a[72:75],v0,s[20:23],s95 offen offset:2048
buffer_load_dwordx4 a[76:79],v0,s[20:23],s95 offen offset:3072
s_waitcnt vmcnt(8)
top0_389:
v_mfma_f32_16x16x32_bf16 v[48:51],a[16:19],a[0:3],0
v_mfma_f32_16x16x32_bf16 v[52:55],a[32:35],a[0:3],0
v_mfma_f32_16x16x32_bf16 v[48:51],a[20:23],a[4:7],v[48:51]
v_mfma_f32_16x16x32_bf16 v[52:55],a[36:39],a[4:7],v[52:55]
v_mfma_f32_16x16x32_bf16 v[48:51],a[24:27],a[8:11],v[48:51]
v_mfma_f32_16x16x32_bf16 v[52:55],a[40:43],a[8:11],v[52:55]
v_mfma_f32_16x16x32_bf16 v[48:51],a[28:31],a[12:15],v[48:51]
v_mfma_f32_16x16x32_bf16 v[52:55],a[44:47],a[12:15],v[52:55]
s_nop 6
v_cndmask_b32 v48,v7,v48,s[28:29]
v_cndmask_b32 v49,v7,v49,s[30:31]
v_cndmask_b32 v50,v7,v50,s[32:33]
v_cndmask_b32 v51,v7,v51,s[34:35]
v_cndmask_b32 v52,v7,v52,s[36:37]
v_cndmask_b32 v53,v7,v53,s[38:39]
v_cndmask_b32 v54,v7,v54,s[40:41]
v_cndmask_b32 v55,v7,v55,s[42:43]
v_max3_f32 v72,v48,v49,v50
v_max3_f32 v72,v72,v51,v52
v_max3_f32 v72,v72,v53,v54
v_max_f32 v72,v72,v55
s_add_u32 s64,s60,0
s_lshl_b32 s65,s64,11
s_and_b32 s65,s65,0x2000
s_xor_b32 s65,s65,s67
s_lshl_b32 s64,s64,19
s_add_u32 s64,s64,s65
s_add_u32 s98,s64,s53
s_add_u32 s98,s98,67108864
s_add_u32 s99,s98,16384
s_lshr_b32 s71,s60,1
s_add_u32 s71,s71,1
s_waitcnt vmcnt(1)
v_cmp_gt_u32 vcc,s71,v5
s_cbranch_vccz ek_391
plp_392:
buffer_load_dword v5,v2,s[20:23],s68 offen sc1
s_waitcnt vmcnt(0)
v_cmp_gt_u32 vcc,s71,v5
s_cbranch_vccz pok_393
s_sleep 4
s_sub_u32 s90,s90,1
s_cmp_gt_i32 s90,0
s_cbranch_scc1 plp_392
pok_393:
ek_391:
buffer_load_dwordx4 v[16:19],v3,s[20:23],s98 offen offset:0
buffer_load_dwordx4 v[20:23],v3,s[20:23],s98 offen offset:128
buffer_load_dwordx4 v[24:27],v3,s[20:23],s99 offen offset:0
buffer_load_dwordx4 v[28:31],v3,s[20:23],s99 offen offset:128
buffer_load_dwordx4 v[32:35],v4,s[20:23],s98 offen offset:1024
buffer_load_dwordx4 v[36:39],v4,s[20:23],s98 offen offset:1536
buffer_load_dwordx4 v[40:43],v4,s[20:23],s99 offen offset:1024
buffer_load_dwordx4 v[44:47],v4,s[20:23],s99 offen offset:1536
s_barrier
s_add_u32 s64,s60,2
s_lshl_b32 s65,s64,11
s_and_b32 s65,s65,0x2000
s_xor_b32 s65,s65,s67
s_lshl_b32 s64,s64,19
s_add_u32 s64,s64,s65
s_add_u32 s92,s64,s53
s_add_u32 s93,s92,16384
s_add_u32 s94,s92,4096
s_add_u32 s95,s93,4096
s_xor_b32 s96,s92,s55
s_xor_b32 s97,s93,s55
buffer_load_dwordx4 a[80:83],v0,s[20:23],s96 offen offset:0
buffer_load_dwordx4 a[96:99],v0,s[20:23],s92 offen offset:0
buffer_load_dwordx4 a[112:115],v0,s[20:23],s92 offen offset:1024
buffer_load_dwordx4 a[84:87],v0,s[20:23],s96 offen offset:2048
buffer_load_dwordx4 a[100:103],v0,s[20:23],s92 offen offset:2048
buffer_load_dwordx4 a[116:119],v0,s[20:23],s92 offen offset:3072
buffer_load_dwordx4 a[88:91],v0,s[20:23],s97 offen offset:0
buffer_load_dwordx4 a[104:107],v0,s[20:23],s93 offen offset:0
buffer_load_dwordx4 a[120:123],v0,s[20:23],s93 offen offset:1024
buffer_load_dwordx4 a[92:95],v0,s[20:23],s97 offen offset:2048
buffer_load_dwordx4 a[108:111],v0,s[20:23],s93 offen offset:2048
buffer_load_dwordx4 a[124:127],v0,s[20:23],s93 offen offset:3072
s_waitcnt vmcnt(16)
v_mfma_f32_16x16x32_bf16 v[56:59],v[16:19],a[0:3],0
v_mfma_f32_16x16x32_bf16 v[56:59],v[20:23],a[4:7],v[56:59]
v_mfma_f32_16x16x32_bf16 v[56:59],v[24:27],a[8:11],v[56:59]
v_mfma_f32_16x16x32_bf16 v[56:59],v[28:31],a[12:15],v[56:59]
s_nop 7
v_cndmask_b32 v56,v7,v56,s[44:45]
v_cndmask_b32 v57,v7,v57,s[44:45]
v_cndmask_b32 v58,v7,v58,s[44:45]
v_cndmask_b32 v59,v7,v59,s[44:45]
v_max3_f32 v72,v72,v56,v57
v_max3_f32 v72,v72,v58,v59
v_mov_b32 v73,v72
s_nop 1
v_permlane16_swap_b32 v73,v72
v_max_f32 v72,v72,v73
v_mov_b32 v73,v72
s_nop 1
v_permlane32_swap_b32 v73,v72
v_max_f32 v72,v72,v73
v_mul_f32 v72,s80,v72
v_fma_f32 v48,v48,s80,-v72
v_fma_f32 v49,v49,s80,-v72
v_fma_f32 v50,v50,s80,-v72
v_fma_f32 v51,v51,s80,-v72
v_fma_f32 v52,v52,s80,-v72
v_fma_f32 v53,v53,s80,-v72
v_fma_f32 v54,v54,s80,-v72
v_fma_f32 v55,v55,s80,-v72
v_fma_f32 v56,v56,s80,-v72
v_fma_f32 v57,v57,s80,-v72
v_fma_f32 v58,v58,s80,-v72
v_fma_f32 v59,v59,s80,-v72
v_exp_f32 v48,v48
v_exp_f32 v49,v49
v_exp_f32 v50,v50
v_exp_f32 v51,v51
v_exp_f32 v52,v52
v_exp_f32 v53,v53
v_exp_f32 v54,v54
v_exp_f32 v55,v55
v_exp_f32 v56,v56
v_exp_f32 v57,v57
v_exp_f32 v58,v58
v_exp_f32 v59,v59
v_add_f32 v74,v48,v49
v_add_f32 v75,v50,v51
v_add_f32 v74,v74,v52
v_add_f32 v75,v75,v53
v_add_f32 v74,v74,v54
v_add_f32 v75,v75,v55
v_add_f32 v74,v74,v56
v_add_f32 v75,v75,v57
v_add_f32 v74,v74,v58
v_add_f32 v75,v75,v59
v_add_f32 v74,v74,v75
v_mov_b32 v73,v74
s_nop 1
v_permlane16_swap_b32 v73,v74
v_add_f32 v74,v74,v73
v_mov_b32 v73,v74
s_nop 1
v_permlane32_swap_b32 v73,v74
v_add_f32 v74,v74,v73
v_rcp_f32 v75,v74
s_nop 0
v_mul_f32 v48,v48,v75
v_mul_f32 v49,v49,v75
v_mul_f32 v50,v50,v75
v_mul_f32 v51,v51,v75
v_mul_f32 v52,v52,v75
v_mul_f32 v53,v53,v75
v_mul_f32 v54,v54,v75
v_mul_f32 v55,v55,v75
v_mul_f32 v56,v56,v75
v_mul_f32 v57,v57,v75
v_mul_f32 v58,v58,v75
v_mul_f32 v59,v59,v75
v_cvt_pk_bf16_f32 v64,v48,v49
v_cvt_pk_bf16_f32 v65,v50,v51
v_cvt_pk_bf16_f32 v66,v52,v53
v_cvt_pk_bf16_f32 v67,v54,v55
v_cvt_pk_bf16_f32 v68,v56,v57
v_cvt_pk_bf16_f32 v69,v58,v59
v_mfma_f32_16x16x32_bf16 v[80:83],a[48:51],v[64:67],0
v_mfma_f32_16x16x32_bf16 v[84:87],a[52:55],v[64:67],0
v_mfma_f32_16x16x32_bf16 v[88:91],a[56:59],v[64:67],0
v_mfma_f32_16x16x32_bf16 v[92:95],a[60:63],v[64:67],0
v_mfma_f32_16x16x32_bf16 v[96:99],a[64:67],v[64:67],0
v_mfma_f32_16x16x32_bf16 v[100:103],a[68:71],v[64:67],0
v_mfma_f32_16x16x32_bf16 v[104:107],a[72:75],v[64:67],0
v_mfma_f32_16x16x32_bf16 v[108:111],a[76:79],v[64:67],0
s_waitcnt vmcnt(12)
v_mfma_f32_16x16x16_bf16 v[80:83],v[32:33],v[68:69],v[80:83]
v_mfma_f32_16x16x16_bf16 v[84:87],v[34:35],v[68:69],v[84:87]
v_mfma_f32_16x16x16_bf16 v[88:91],v[36:37],v[68:69],v[88:91]
v_mfma_f32_16x16x16_bf16 v[92:95],v[38:39],v[68:69],v[92:95]
v_mfma_f32_16x16x16_bf16 v[96:99],v[40:41],v[68:69],v[96:99]
v_mfma_f32_16x16x16_bf16 v[100:103],v[42:43],v[68:69],v[100:103]
v_mfma_f32_16x16x16_bf16 v[104:107],v[44:45],v[68:69],v[104:107]
v_mfma_f32_16x16x16_bf16 v[108:111],v[46:47],v[68:69],v[108:111]
s_nop 0
v_cvt_pk_bf16_f32 v112,v80,v81
v_cvt_pk_bf16_f32 v113,v82,v83
v_cvt_pk_bf16_f32 v114,v84,v85
v_cvt_pk_bf16_f32 v115,v86,v87
buffer_store_dwordx4 v[112:115],v0,s[20:23],s66 offen offset:0 sc1
v_cvt_pk_bf16_f32 v116,v88,v89
v_cvt_pk_bf16_f32 v117,v90,v91
v_cvt_pk_bf16_f32 v118,v92,v93
v_cvt_pk_bf16_f32 v119,v94,v95
buffer_store_dwordx4 v[116:119],v0,s[20:23],s66 offen offset:1024 sc1
v_cvt_pk_bf16_f32 v112,v96,v97
v_cvt_pk_bf16_f32 v113,v98,v99
v_cvt_pk_bf16_f32 v114,v100,v101
v_cvt_pk_bf16_f32 v115,v102,v103
buffer_store_dwordx4 v[112:115],v0,s[20:23],s66 offen offset:2048 sc1
v_cvt_pk_bf16_f32 v116,v104,v105
v_cvt_pk_bf16_f32 v117,v106,v107
v_cvt_pk_bf16_f32 v118,v108,v109
v_cvt_pk_bf16_f32 v119,v110,v111
buffer_store_dwordx4 v[116:119],v0,s[20:23],s66 offen offset:3072 sc1
s_barrier
buffer_load_dwordx4 a[128:131],v0,s[20:23],s94 offen offset:0
buffer_load_dwordx4 a[132:135],v0,s[20:23],s94 offen offset:1024
buffer_load_dwordx4 a[136:139],v0,s[20:23],s94 offen offset:2048
buffer_load_dwordx4 a[140:143],v0,s[20:23],s94 offen offset:3072
buffer_load_dwordx4 a[144:147],v0,s[20:23],s95 offen offset:0
buffer_load_dwordx4 a[148:151],v0,s[20:23],s95 offen offset:1024
buffer_load_dwordx4 a[152:155],v0,s[20:23],s95 offen offset:2048
buffer_load_dwordx4 a[156:159],v0,s[20:23],s95 offen offset:3072
buffer_load_dword v5,v2,s[20:23],s68 offen sc1
s_add_u32 s66,s66,262144
s_add_u32 s60,s60,2
s_add_u32 s72,s60,s54
s_waitcnt vmcnt(9)
v_mov_b32 v6,s72
s_mov_b64 exec,1
buffer_store_dword v6,off,s[20:23],s69 sc1
s_mov_b64 exec,-1
top1_390:
v_mfma_f32_16x16x32_bf16 v[48:51],a[96:99],a[80:83],0
v_mfma_f32_16x16x32_bf16 v[52:55],a[112:115],a[80:83],0
v_mfma_f32_16x16x32_bf16 v[48:51],a[100:103],a[84:87],v[48:51]
v_mfma_f32_16x16x32_bf16 v[52:55],a[116:119],a[84:87],v[52:55]
v_mfma_f32_16x16x32_bf16 v[48:51],a[104:107],a[88:91],v[48:51]
v_mfma_f32_16x16x32_bf16 v[52:55],a[120:123],a[88:91],v[52:55]
v_mfma_f32_16x16x32_bf16 v[48:51],a[108:111],a[92:95],v[48:51]
v_mfma_f32_16x16x32_bf16 v[52:55],a[124:127],a[92:95],v[52:55]
s_nop 6
v_cndmask_b32 v48,v7,v48,s[28:29]
v_cndmask_b32 v49,v7,v49,s[30:31]
v_cndmask_b32 v50,v7,v50,s[32:33]
v_cndmask_b32 v51,v7,v51,s[34:35]
v_cndmask_b32 v52,v7,v52,s[36:37]
v_cndmask_b32 v53,v7,v53,s[38:39]
v_cndmask_b32 v54,v7,v54,s[40:41]
v_cndmask_b32 v55,v7,v55,s[42:43]
v_max3_f32 v72,v48,v49,v50
v_max3_f32 v72,v72,v51,v52
v_max3_f32 v72,v72,v53,v54
v_max_f32 v72,v72,v55
s_add_u32 s64,s60,0
s_lshl_b32 s65,s64,11
s_and_b32 s65,s65,0x2000
s_xor_b32 s65,s65,s67
s_lshl_b32 s64,s64,19
s_add_u32 s64,s64,s65
s_add_u32 s98,s64,s53
s_add_u32 s98,s98,67108864
s_add_u32 s99,s98,16384
s_lshr_b32 s71,s60,1
s_add_u32 s71,s71,1
s_waitcnt vmcnt(1)
v_cmp_gt_u32 vcc,s71,v5
s_cbranch_vccz ek_394
plp_395:
buffer_load_dword v5,v2,s[20:23],s68 offen sc1
s_waitcnt vmcnt(0)
v_cmp_gt_u32 vcc,s71,v5
s_cbranch_vccz pok_396
s_sleep 4
s_sub_u32 s90,s90,1
s_cmp_gt_i32 s90,0
s_cbranch_scc1 plp_395
pok_396:
ek_394:
buffer_load_dwordx4 v[16:19],v3,s[20:23],s98 offen offset:0
buffer_load_dwordx4 v[20:23],v3,s[20:23],s98 offen offset:128
buffer_load_dwordx4 v[24:27],v3,s[20:23],s99 offen offset:0
buffer_load_dwordx4 v[28:31],v3,s[20:23],s99 offen offset:128
buffer_load_dwordx4 v[32:35],v4,s[20:23],s98 offen offset:1024
buffer_load_dwordx4 v[36:39],v4,s[20:23],s98 offen offset:1536
buffer_load_dwordx4 v[40:43],v4,s[20:23],s99 offen offset:1024
buffer_load_dwordx4 v[44:47],v4,s[20:23],s99 offen offset:1536
s_barrier
s_cmp_lt_u32 s60,122
s_cbranch_scc1 pf_397
s_waitcnt vmcnt(0)
s_branch j1_398
pf_397:
s_add_u32 s64,s60,2
s_lshl_b32 s65,s64,11
s_and_b32 s65,s65,0x2000
s_xor_b32 s65,s65,s67
s_lshl_b32 s64,s64,19
s_add_u32 s64,s64,s65
s_add_u32 s92,s64,s53
s_add_u32 s93,s92,16384
s_add_u32 s94,s92,4096
s_add_u32 s95,s93,4096
s_xor_b32 s96,s92,s55
s_xor_b32 s97,s93,s55
buffer_load_dwordx4 a[0:3],v0,s[20:23],s96 offen offset:0
buffer_load_dwordx4 a[16:19],v0,s[20:23],s92 offen offset:0
buffer_load_dwordx4 a[32:35],v0,s[20:23],s92 offen offset:1024
buffer_load_dwordx4 a[4:7],v0,s[20:23],s96 offen offset:2048
buffer_load_dwordx4 a[20:23],v0,s[20:23],s92 offen offset:2048
buffer_load_dwordx4 a[36:39],v0,s[20:23],s92 offen offset:3072
buffer_load_dwordx4 a[8:11],v0,s[20:23],s97 offen offset:0
buffer_load_dwordx4 a[24:27],v0,s[20:23],s93 offen offset:0
buffer_load_dwordx4 a[40:43],v0,s[20:23],s93 offen offset:1024
buffer_load_dwordx4 a[12:15],v0,s[20:23],s97 offen offset:2048
buffer_load_dwordx4 a[28:31],v0,s[20:23],s93 offen offset:2048
buffer_load_dwordx4 a[44:47],v0,s[20:23],s93 offen offset:3072
j1_398:
s_waitcnt vmcnt(16)
v_mfma_f32_16x16x32_bf16 v[56:59],v[16:19],a[80:83],0
v_mfma_f32_16x16x32_bf16 v[56:59],v[20:23],a[84:87],v[56:59]
v_mfma_f32_16x16x32_bf16 v[56:59],v[24:27],a[88:91],v[56:59]
v_mfma_f32_16x16x32_bf16 v[56:59],v[28:31],a[92:95],v[56:59]
s_nop 7
v_cndmask_b32 v56,v7,v56,s[44:45]
v_cndmask_b32 v57,v7,v57,s[44:45]
v_cndmask_b32 v58,v7,v58,s[44:45]
v_cndmask_b32 v59,v7,v59,s[44:45]
v_max3_f32 v72,v72,v56,v57
v_max3_f32 v72,v72,v58,v59
v_mov_b32 v73,v72
s_nop 1
v_permlane16_swap_b32 v73,v72
v_max_f32 v72,v72,v73
v_mov_b32 v73,v72
s_nop 1
v_permlane32_swap_b32 v73,v72
v_max_f32 v72,v72,v73
v_mul_f32 v72,s80,v72
v_fma_f32 v48,v48,s80,-v72
v_fma_f32 v49,v49,s80,-v72
v_fma_f32 v50,v50,s80,-v72
v_fma_f32 v51,v51,s80,-v72
v_fma_f32 v52,v52,s80,-v72
v_fma_f32 v53,v53,s80,-v72
v_fma_f32 v54,v54,s80,-v72
v_fma_f32 v55,v55,s80,-v72
v_fma_f32 v56,v56,s80,-v72
v_fma_f32 v57,v57,s80,-v72
v_fma_f32 v58,v58,s80,-v72
v_fma_f32 v59,v59,s80,-v72
v_exp_f32 v48,v48
v_exp_f32 v49,v49
v_exp_f32 v50,v50
v_exp_f32 v51,v51
v_exp_f32 v52,v52
v_exp_f32 v53,v53
v_exp_f32 v54,v54
v_exp_f32 v55,v55
v_exp_f32 v56,v56
v_exp_f32 v57,v57
v_exp_f32 v58,v58
v_exp_f32 v59,v59
v_add_f32 v74,v48,v49
v_add_f32 v75,v50,v51
v_add_f32 v74,v74,v52
v_add_f32 v75,v75,v53
v_add_f32 v74,v74,v54
v_add_f32 v75,v75,v55
v_add_f32 v74,v74,v56
v_add_f32 v75,v75,v57
v_add_f32 v74,v74,v58
v_add_f32 v75,v75,v59
v_add_f32 v74,v74,v75
v_mov_b32 v73,v74
s_nop 1
v_permlane16_swap_b32 v73,v74
v_add_f32 v74,v74,v73
v_mov_b32 v73,v74
s_nop 1
v_permlane32_swap_b32 v73,v74
v_add_f32 v74,v74,v73
v_rcp_f32 v75,v74
s_nop 0
v_mul_f32 v48,v48,v75
v_mul_f32 v49,v49,v75
v_mul_f32 v50,v50,v75
v_mul_f32 v51,v51,v75
v_mul_f32 v52,v52,v75
v_mul_f32 v53,v53,v75
v_mul_f32 v54,v54,v75
v_mul_f32 v55,v55,v75
v_mul_f32 v56,v56,v75
v_mul_f32 v57,v57,v75
v_mul_f32 v58,v58,v75
v_mul_f32 v59,v59,v75
v_cvt_pk_bf16_f32 v64,v48,v49
v_cvt_pk_bf16_f32 v65,v50,v51
v_cvt_pk_bf16_f32 v66,v52,v53
v_cvt_pk_bf16_f32 v67,v54,v55
v_cvt_pk_bf16_f32 v68,v56,v57
v_cvt_pk_bf16_f32 v69,v58,v59
v_mfma_f32_16x16x32_bf16 v[80:83],a[128:131],v[64:67],0
v_mfma_f32_16x16x32_bf16 v[84:87],a[132:135],v[64:67],0
v_mfma_f32_16x16x32_bf16 v[88:91],a[136:139],v[64:67],0
v_mfma_f32_16x16x32_bf16 v[92:95],a[140:143],v[64:67],0
v_mfma_f32_16x16x32_bf16 v[96:99],a[144:147],v[64:67],0
v_mfma_f32_16x16x32_bf16 v[100:103],a[148:151],v[64:67],0
v_mfma_f32_16x16x32_bf16 v[104:107],a[152:155],v[64:67],0
v_mfma_f32_16x16x32_bf16 v[108:111],a[156:159],v[64:67],0
s_waitcnt vmcnt(12)
v_mfma_f32_16x16x16_bf16 v[80:83],v[32:33],v[68:69],v[80:83]
v_mfma_f32_16x16x16_bf16 v[84:87],v[34:35],v[68:69],v[84:87]
v_mfma_f32_16x16x16_bf16 v[88:91],v[36:37],v[68:69],v[88:91]
v_mfma_f32_16x16x16_bf16 v[92:95],v[38:39],v[68:69],v[92:95]
v_mfma_f32_16x16x16_bf16 v[96:99],v[40:41],v[68:69],v[96:99]
v_mfma_f32_16x16x16_bf16 v[100:103],v[42:43],v[68:69],v[100:103]
v_mfma_f32_16x16x16_bf16 v[104:107],v[44:45],v[68:69],v[104:107]
v_mfma_f32_16x16x16_bf16 v[108:111],v[46:47],v[68:69],v[108:111]
s_nop 0
v_cvt_pk_bf16_f32 v112,v80,v81
v_cvt_pk_bf16_f32 v113,v82,v83
v_cvt_pk_bf16_f32 v114,v84,v85
v_cvt_pk_bf16_f32 v115,v86,v87
buffer_store_dwordx4 v[112:115],v0,s[20:23],s66 offen offset:0 sc1
v_cvt_pk_bf16_f32 v116,v88,v89
v_cvt_pk_bf16_f32 v117,v90,v91
v_cvt_pk_bf16_f32 v118,v92,v93
v_cvt_pk_bf16_f32 v119,v94,v95
buffer_store_dwordx4 v[116:119],v0,s[20:23],s66 offen offset:1024 sc1
v_cvt_pk_bf16_f32 v112,v96,v97
v_cvt_pk_bf16_f32 v113,v98,v99
v_cvt_pk_bf16_f32 v114,v100,v101
v_cvt_pk_bf16_f32 v115,v102,v103
buffer_store_dwordx4 v[112:115],v0,s[20:23],s66 offen offset:2048 sc1
v_cvt_pk_bf16_f32 v116,v104,v105
v_cvt_pk_bf16_f32 v117,v106,v107
v_cvt_pk_bf16_f32 v118,v108,v109
v_cvt_pk_bf16_f32 v119,v110,v111
buffer_store_dwordx4 v[116:119],v0,s[20:23],s66 offen offset:3072 sc1
s_barrier
s_cmp_lt_u32 s60,122
s_cbranch_scc1 pf_399
s_waitcnt vmcnt(0)
s_branch j1_400
pf_399:
buffer_load_dwordx4 a[48:51],v0,s[20:23],s94 offen offset:0
buffer_load_dwordx4 a[52:55],v0,s[20:23],s94 offen offset:1024
buffer_load_dwordx4 a[56:59],v0,s[20:23],s94 offen offset:2048
buffer_load_dwordx4 a[60:63],v0,s[20:23],s94 offen offset:3072
buffer_load_dwordx4 a[64:67],v0,s[20:23],s95 offen offset:0
buffer_load_dwordx4 a[68:71],v0,s[20:23],s95 offen offset:1024
buffer_load_dwordx4 a[72:75],v0,s[20:23],s95 offen offset:2048
buffer_load_dwordx4 a[76:79],v0,s[20:23],s95 offen offset:3072
j1_400:
buffer_load_dword v5,v2,s[20:23],s68 offen sc1
s_add_u32 s66,s66,262144
s_add_u32 s60,s60,2
s_add_u32 s72,s60,s54
s_cmp_eq_u32 s60,124
s_cselect_b32 s72,128,s72
s_waitcnt vmcnt(9)
v_mov_b32 v6,s72
s_mov_b64 exec,1
buffer_store_dword v6,off,s[20:23],s69 sc1
s_mov_b64 exec,-1
s_cmp_lt_u32 s60,124
s_cbranch_scc1 top0_389
s_endpgm
fl_att2:
s_lshr_b32 s46,s59,4
s_and_b32 s59,s59,15
v_mbcnt_lo_u32_b32 v1,-1,0
v_mbcnt_hi_u32_b32 v1,-1,v1
v_lshlrev_b32 v0,4,v1
v_and_b32 v21,15,v1
v_lshrrev_b32 v22,4,v1
v_and_b32 v23,7,v21
v_lshlrev_b32 v23,4,v23
v_lshl_add_u32 v3,v22,8,v23
v_and_b32 v23,31,v1
v_lshlrev_b32 v4,4,v23
v_and_b32 v23,3,v1
v_bfe_u32 v24,v1,2,1
v_lshlrev_b32 v23,14,v23
v_lshl_add_u32 v2,v24,7,v23
v_mov_b32 v7,0xff800000
s_and_b32 s54,s50,1
s_lshl_b32 s64,s54,4
v_lshlrev_b32 v23,2,v22
v_sub_u32 v23,v21,v23
v_add_u32 v23,s64,v23
v_cmp_le_i32 s[28:29],0,v23
v_cmp_le_i32 s[30:31],1,v23
v_cmp_le_i32 s[32:33],2,v23
v_cmp_le_i32 s[34:35],3,v23
v_cmp_le_i32 s[36:37],16,v23
v_cmp_le_i32 s[38:39],17,v23
v_cmp_le_i32 s[40:41],18,v23
v_cmp_le_i32 s[42:43],19,v23
s_mov_b32 s44,-1
s_mov_b32 s45,0
s_mov_b32 s80,0x3e0293ee
s_lshl_b32 s52,s59,1
s_lshr_b32 s64,s50,1
s_add_u32 s52,s52,s64
s_lshl_b32 s53,s52,15
s_lshl_b32 s68,s52,8
s_add_u32 s68,s68,s67
s_add_u32 s68,s68,138428416
s_lshl_b32 s69,s59,8
s_lshl_b32 s64,s64,2
s_add_u32 s69,s69,s64
s_lshl_b32 s64,s54,3
s_add_u32 s69,s69,s64
s_add_u32 s69,s69,138543104
s_lshl_b32 s66,s52,12
s_lshl_b32 s64,s54,17
s_add_u32 s66,s66,s64
s_add_u32 s66,s66,150994944
s_lshl_b32 s55,s54,10
s_xor_b32 s55,s55,0x2000
s_mov_b32 s60,0
s_lshl_b32 s60,s46,1
s_add_u32 s60,s60,124
s_lshl_b32 s64,s60,17
s_add_u32 s66,s66,s64
s_lshl_b32 s47,s52,7
s_add_u32 s47,s47,s67
s_add_u32 s47,s47,138412032
v_and_b32 v23,1,v1
v_lshlrev_b32 v23,6,v23
s_mov_b32 s71,64
plp_401:
buffer_load_dword v5,v23,s[20:23],s47 offen sc1
s_waitcnt vmcnt(0)
v_cmp_gt_u32 vcc,s71,v5
s_cbranch_vccz pok_402
s_sleep 16
s_sub_u32 s90,s90,1
s_cmp_gt_i32 s90,0
s_cbranch_scc1 plp_401
pok_402:
s_add_u32 s64,s60,0
s_lshl_b32 s65,s64,11
s_and_b32 s65,s65,0x2000
s_xor_b32 s65,s65,s67
s_lshl_b32 s64,s64,19
s_add_u32 s64,s64,s65
s_add_u32 s92,s64,s53
s_add_u32 s93,s92,16384
s_add_u32 s94,s92,4096
s_add_u32 s95,s93,4096
s_xor_b32 s96,s92,s55
s_xor_b32 s97,s93,s55
buffer_load_dwordx4 a[0:3],v0,s[20:23],s96 offen offset:0
buffer_load_dwordx4 a[16:19],v0,s[20:23],s92 offen offset:0
buffer_load_dwordx4 a[32:35],v0,s[20:23],s92 offen offset:1024
buffer_load_dwordx4 a[4:7],v0,s[20:23],s96 offen offset:2048
buffer_load_dwordx4 a[20:23],v0,s[20:23],s92 offen offset:2048
buffer_load_dwordx4 a[36:39],v0,s[20:23],s92 offen offset:3072
buffer_load_dwordx4 a[8:11],v0,s[20:23],s97 offen offset:0
buffer_load_dwordx4 a[24:27],v0,s[20:23],s93 offen offset:0
buffer_load_dwordx4 a[40:43],v0,s[20:23],s93 offen offset:1024
buffer_load_dwordx4 a[12:15],v0,s[20:23],s97 offen offset:2048
buffer_load_dwordx4 a[28:31],v0,s[20:23],s93 offen offset:2048
buffer_load_dwordx4 a[44:47],v0,s[20:23],s93 offen offset:3072
buffer_load_dwordx4 a[48:51],v0,s[20:23],s94 offen offset:0
buffer_load_dwordx4 a[52:55],v0,s[20:23],s94 offen offset:1024
buffer_load_dwordx4 a[56:59],v0,s[20:23],s94 offen offset:2048
buffer_load_dwordx4 a[60:63],v0,s[20:23],s94 offen offset:3072
buffer_load_dwordx4 a[64:67],v0,s[20:23],s95 offen offset:0
buffer_load_dwordx4 a[68:71],v0,s[20:23],s95 offen offset:1024
buffer_load_dwordx4 a[72:75],v0,s[20:23],s95 offen offset:2048
buffer_load_dwordx4 a[76:79],v0,s[20:23],s95 offen offset:3072
s_waitcnt vmcnt(8)
top0_403:
v_mfma_f32_16x16x32_bf16 v[48:51],a[16:19],a[0:3],0
v_mfma_f32_16x16x32_bf16 v[52:55],a[32:35],a[0:3],0
v_mfma_f32_16x16x32_bf16 v[48:51],a[20:23],a[4:7],v[48:51]
v_mfma_f32_16x16x32_bf16 v[52:55],a[36:39],a[4:7],v[52:55]
v_mfma_f32_16x16x32_bf16 v[48:51],a[24:27],a[8:11],v[48:51]
v_mfma_f32_16x16x32_bf16 v[52:55],a[40:43],a[8:11],v[52:55]
v_mfma_f32_16x16x32_bf16 v[48:51],a[28:31],a[12:15],v[48:51]
v_mfma_f32_16x16x32_bf16 v[52:55],a[44:47],a[12:15],v[52:55]
s_nop 6
v_cndmask_b32 v48,v7,v48,s[28:29]
v_cndmask_b32 v49,v7,v49,s[30:31]
v_cndmask_b32 v50,v7,v50,s[32:33]
v_cndmask_b32 v51,v7,v51,s[34:35]
v_cndmask_b32 v52,v7,v52,s[36:37]
v_cndmask_b32 v53,v7,v53,s[38:39]
v_cndmask_b32 v54,v7,v54,s[40:41]
v_cndmask_b32 v55,v7,v55,s[42:43]
v_max3_f32 v72,v48,v49,v50
v_max3_f32 v72,v72,v51,v52
v_max3_f32 v72,v72,v53,v54
v_max_f32 v72,v72,v55
s_add_u32 s64,s60,0
s_lshl_b32 s65,s64,11
s_and_b32 s65,s65,0x2000
s_xor_b32 s65,s65,s67
s_lshl_b32 s64,s64,19
s_add_u32 s64,s64,s65
s_add_u32 s98,s64,s53
s_mov_b32 s71,118
plp_405:
buffer_load_dword v5,off,s[20:23],s69 sc1
s_waitcnt vmcnt(0)
v_cmp_gt_u32 vcc,s71,v5
s_cbranch_vccz pok_406
s_sleep 32
s_sub_u32 s90,s90,1
s_cmp_gt_i32 s90,0
s_cbranch_scc1 plp_405
pok_406:
s_lshl_b32 s64,s46,4
s_add_u32 s69,s69,s64
s_add_u32 s69,s69,16
s_add_u32 s98,s98,67108864
s_add_u32 s99,s98,16384
s_lshr_b32 s71,s60,1
s_add_u32 s71,s71,1
plp_408:
buffer_load_dword v5,v2,s[20:23],s68 offen sc1
s_waitcnt vmcnt(0)
v_cmp_gt_u32 vcc,s71,v5
s_cbranch_vccz pok_409
s_sleep 4
s_sub_u32 s90,s90,1
s_cmp_gt_i32 s90,0
s_cbranch_scc1 plp_408
pok_409:
ek_407:
buffer_load_dwordx4 v[16:19],v3,s[20:23],s98 offen offset:0
buffer_load_dwordx4 v[20:23],v3,s[20:23],s98 offen offset:128
buffer_load_dwordx4 v[24:27],v3,s[20:23],s99 offen offset:0
buffer_load_dwordx4 v[28:31],v3,s[20:23],s99 offen offset:128
buffer_load_dwordx4 v[32:35],v4,s[20:23],s98 offen offset:1024
buffer_load_dwordx4 v[36:39],v4,s[20:23],s98 offen offset:1536
buffer_load_dwordx4 v[40:43],v4,s[20:23],s99 offen offset:1024
buffer_load_dwordx4 v[44:47],v4,s[20:23],s99 offen offset:1536
s_waitcnt vmcnt(4)
v_mfma_f32_16x16x32_bf16 v[56:59],v[16:19],a[0:3],0
v_mfma_f32_16x16x32_bf16 v[56:59],v[20:23],a[4:7],v[56:59]
v_mfma_f32_16x16x32_bf16 v[56:59],v[24:27],a[8:11],v[56:59]
v_mfma_f32_16x16x32_bf16 v[56:59],v[28:31],a[12:15],v[56:59]
s_nop 7
v_cndmask_b32 v56,v7,v56,s[44:45]
v_cndmask_b32 v57,v7,v57,s[44:45]
v_cndmask_b32 v58,v7,v58,s[44:45]
v_cndmask_b32 v59,v7,v59,s[44:45]
v_max3_f32 v72,v72,v56,v57
v_max3_f32 v72,v72,v58,v59
v_mov_b32 v73,v72
s_nop 1
v_permlane16_swap_b32 v73,v72
v_max_f32 v72,v72,v73
v_mov_b32 v73,v72
s_nop 1
v_permlane32_swap_b32 v73,v72
v_max_f32 v72,v72,v73
v_mul_f32 v72,s80,v72
v_fma_f32 v48,v48,s80,-v72
v_fma_f32 v49,v49,s80,-v72
v_fma_f32 v50,v50,s80,-v72
v_fma_f32 v51,v51,s80,-v72
v_fma_f32 v52,v52,s80,-v72
v_fma_f32 v53,v53,s80,-v72
v_fma_f32 v54,v54,s80,-v72
v_fma_f32 v55,v55,s80,-v72
v_fma_f32 v56,v56,s80,-v72
v_fma_f32 v57,v57,s80,-v72
v_fma_f32 v58,v58,s80,-v72
v_fma_f32 v59,v59,s80,-v72
v_exp_f32 v48,v48
v_exp_f32 v49,v49
v_exp_f32 v50,v50
v_exp_f32 v51,v51
v_exp_f32 v52,v52
v_exp_f32 v53,v53
v_exp_f32 v54,v54
v_exp_f32 v55,v55
v_exp_f32 v56,v56
v_exp_f32 v57,v57
v_exp_f32 v58,v58
v_exp_f32 v59,v59
v_add_f32 v74,v48,v49
v_add_f32 v75,v50,v51
v_add_f32 v74,v74,v52
v_add_f32 v75,v75,v53
v_add_f32 v74,v74,v54
v_add_f32 v75,v75,v55
v_add_f32 v74,v74,v56
v_add_f32 v75,v75,v57
v_add_f32 v74,v74,v58
v_add_f32 v75,v75,v59
v_add_f32 v74,v74,v75
v_mov_b32 v73,v74
s_nop 1
v_permlane16_swap_b32 v73,v74
v_add_f32 v74,v74,v73
v_mov_b32 v73,v74
s_nop 1
v_permlane32_swap_b32 v73,v74
v_add_f32 v74,v74,v73
v_rcp_f32 v75,v74
s_nop 0
v_mul_f32 v48,v48,v75
v_mul_f32 v49,v49,v75
v_mul_f32 v50,v50,v75
v_mul_f32 v51,v51,v75
v_mul_f32 v52,v52,v75
v_mul_f32 v53,v53,v75
v_mul_f32 v54,v54,v75
v_mul_f32 v55,v55,v75
v_mul_f32 v56,v56,v75
v_mul_f32 v57,v57,v75
v_mul_f32 v58,v58,v75
v_mul_f32 v59,v59,v75
v_cvt_pk_bf16_f32 v64,v48,v49
v_cvt_pk_bf16_f32 v65,v50,v51
v_cvt_pk_bf16_f32 v66,v52,v53
v_cvt_pk_bf16_f32 v67,v54,v55
v_cvt_pk_bf16_f32 v68,v56,v57
v_cvt_pk_bf16_f32 v69,v58,v59
v_mfma_f32_16x16x32_bf16 v[80:83],a[48:51],v[64:67],0
v_mfma_f32_16x16x32_bf16 v[84:87],a[52:55],v[64:67],0
v_mfma_f32_16x16x32_bf16 v[88:91],a[56:59],v[64:67],0
v_mfma_f32_16x16x32_bf16 v[92:95],a[60:63],v[64:67],0
v_mfma_f32_16x16x32_bf16 v[96:99],a[64:67],v[64:67],0
v_mfma_f32_16x16x32_bf16 v[100:103],a[68:71],v[64:67],0
v_mfma_f32_16x16x32_bf16 v[104:107],a[72:75],v[64:67],0
v_mfma_f32_16x16x32_bf16 v[108:111],a[76:79],v[64:67],0
s_waitcnt vmcnt(0)
v_mfma_f32_16x16x16_bf16 v[80:83],v[32:33],v[68:69],v[80:83]
v_mfma_f32_16x16x16_bf16 v[84:87],v[34:35],v[68:69],v[84:87]
v_mfma_f32_16x16x16_bf16 v[88:91],v[36:37],v[68:69],v[88:91]
v_mfma_f32_16x16x16_bf16 v[92:95],v[38:39],v[68:69],v[92:95]
v_mfma_f32_16x16x16_bf16 v[96:99],v[40:41],v[68:69],v[96:99]
v_mfma_f32_16x16x16_bf16 v[100:103],v[42:43],v[68:69],v[100:103]
v_mfma_f32_16x16x16_bf16 v[104:107],v[44:45],v[68:69],v[104:107]
v_mfma_f32_16x16x16_bf16 v[108:111],v[46:47],v[68:69],v[108:111]
s_nop 0
v_cvt_pk_bf16_f32 v112,v80,v81
v_cvt_pk_bf16_f32 v113,v82,v83
v_cvt_pk_bf16_f32 v114,v84,v85
v_cvt_pk_bf16_f32 v115,v86,v87
buffer_store_dwordx4 v[112:115],v0,s[20:23],s66 offen offset:0 sc1
v_cvt_pk_bf16_f32 v116,v88,v89
v_cvt_pk_bf16_f32 v117,v90,v91
v_cvt_pk_bf16_f32 v118,v92,v93
v_cvt_pk_bf16_f32 v119,v94,v95
buffer_store_dwordx4 v[116:119],v0,s[20:23],s66 offen offset:1024 sc1
v_cvt_pk_bf16_f32 v112,v96,v97
v_cvt_pk_bf16_f32 v113,v98,v99
v_cvt_pk_bf16_f32 v114,v100,v101
v_cvt_pk_bf16_f32 v115,v102,v103
buffer_store_dwordx4 v[112:115],v0,s[20:23],s66 offen offset:2048 sc1
v_cvt_pk_bf16_f32 v116,v104,v105
v_cvt_pk_bf16_f32 v117,v106,v107
v_cvt_pk_bf16_f32 v118,v108,v109
v_cvt_pk_bf16_f32 v119,v110,v111
buffer_store_dwordx4 v[116:119],v0,s[20:23],s66 offen offset:3072 sc1
s_waitcnt vmcnt(0)
v_mov_b32 v6,128
s_mov_b64 exec,1
buffer_store_dword v6,off,s[20:23],s69 sc1
s_mov_b64 exec,-1
s_endpgm
fl_rec:
s_load_dwordx8 s[4:11],s[0:1],8
s_load_dwordx2 s[12:13],s[0:1],40
s_mov_b32 s57,s58
v_mov_b32 v0,v1
s_waitcnt lgkmcnt(0)
s_mov_b32 s28,s6
s_and_b32 s29,s7,0xffff
s_mov_b32 s30,0x800000
s_mov_b32 s31,0x20000
s_mov_b32 s32,s8
s_and_b32 s33,s9,0xffff
s_mov_b32 s34,0x800000
s_mov_b32 s35,0x20000
s_mov_b32 s36,s10
s_and_b32 s37,s11,0xffff
s_mov_b32 s38,0x800000
s_mov_b32 s39,0x20000
s_mov_b32 s40,s12
s_and_b32 s41,s13,0xffff
s_mov_b32 s42,0x800000
s_mov_b32 s43,0x20000
s_mov_b32 s44,s4
s_and_b32 s45,s5,0xffff
s_mov_b32 s46,0x4000
s_mov_b32 s47,0x20000
s_lshr_b32 s58,s57,5
s_and_b32 s59,s57,31
v_and_b32 v20,63,v0
v_and_b32 v21,15,v20
v_lshrrev_b32 v22,4,v20
v_lshrrev_b32 v23,3,v20
v_and_b32 v24,7,v20
v_lshlrev_b32 v16,13,v23
v_lshl_add_u32 v16,v24,4,v16
v_lshrrev_b32 v23,2,v20
v_and_b32 v24,3,v20
v_lshlrev_b32 v17,11,v23
v_lshl_add_u32 v17,v24,4,v17
s_lshl_b32 s61,s50,15
s_add_u32 s61,s61,32768
s_lshl_b32 s62,s50,21
s_lshl_b32 s64,s57,7
s_add_u32 s62,s62,s64
s_lshl_b32 s63,s58,22
s_lshl_b32 s64,s50,20
s_add_u32 s63,s63,s64
s_lshl_b32 s64,s59,6
s_add_u32 s63,s63,s64
v_lshrrev_b32 v23,1,v22
v_lshlrev_b32 v25,4,v23
v_and_b32 v23,1,v22
v_lshl_add_u32 v25,v23,2,v25
v_lshrrev_b32 v23,3,v21
v_lshl_add_u32 v25,v23,3,v25
v_bfe_u32 v23,v21,2,1
v_add_u32 v25,v25,v23
v_lshlrev_b32 v28,4,v23
v_lshrrev_b32 v23,1,v22
v_lshl_add_u32 v28,v23,3,v28
v_lshrrev_b32 v23,3,v21
v_lshl_add_u32 v28,v23,2,v28
v_and_b32 v23,1,v22
v_lshl_add_u32 v28,v23,1,v28
v_and_b32 v24,3,v21
v_lshlrev_b32 v26,7,v28
v_add_u32 v26,s61,v26
v_lshl_add_u32 v18,v24,3,v26
v_lshl_add_u32 v19,v24,4,v26
v_lshlrev_b32 v26,6,v25
v_add_u32 v26,s61,v26
v_lshl_add_u32 v27,v24,3,v26
v_lshlrev_b32 v0,4,v20
v_add_u32 v7,s61,v0
s_and_b32 s64,s59,1
s_lshl_b32 s65,s64,18
s_add_u32 s70,s63,s65
s_sub_u32 s71,s63,s65
s_lshl_b32 s65,s64,13
s_add_u32 s72,s61,s65
s_sub_u32 s73,s61,s65
s_and_b32 s64,s57,7
s_lshl_b32 s65,s64,2
s_mov_b32 s66,0
s_lshl_b32 s65,s65,13
s_andn2_b32 s55,s57,7
s_lshl_b32 s55,s55,7
s_add_u32 s65,s65,s55
s_add_u32 s65,s65,384
v_and_b32 v29,3,v20
v_lshlrev_b32 v29,13,v29
v_add_u32 v29,s65,v29
v_and_b32 v15,4,v20
v_lshl_add_u32 v29,v15,4,v29
s_and_b32 s55,s57,31
s_add_u32 s66,s66,s55
s_lshl_b32 s66,s66,13
s_add_u32 s66,s66,8064
v_writelane_b32 v29,s66,8
s_add_u32 s66,s66,64
v_writelane_b32 v29,s66,9
s_cmp_eq_u32 s64,3
s_cselect_b32 s65,0,15
s_sub_u32 s66,s57,32
s_cmp_lt_u32 s66,31
s_cselect_b32 s66,256,0
s_or_b32 vcc_lo,s65,s66
s_mov_b32 vcc_hi,0
v_cndmask_b32 v29,-1,v29,vcc
s_lshl_b32 s68,s50,21
s_lshl_b32 s64,s58,22
s_lshl_b32 s65,s50,20
s_add_u32 s64,s64,s65
s_and_b32 s66,s59,15
s_lshl_b32 s65,s66,13
s_add_u32 s64,s64,s65
s_lshr_b32 s65,s59,4
s_lshl_b32 s65,s65,10
s_add_u32 s69,s64,s65
s_add_u32 s69,s69,384
s_lshr_b32 s66,s66,1
s_cmp_eq_u32 s66,3
s_cselect_b32 s65,0,4
v_and_b32 v30,3,v20
v_lshlrev_b32 v30,11,v30
v_and_b32 v31,4,v20
v_lshl_add_u32 v30,v31,4,v30
v_cmp_gt_u32 vcc,s65,v20
s_nop 1
v_cndmask_b32 v30,-1,v30,vcc
s_add_u32 s64,s68,262144
buffer_load_dword v31,v29,s[28:31],s64 offen
s_add_u32 s64,s68,524288
buffer_load_dword v31,v29,s[28:31],s64 offen
s_add_u32 s64,s68,786432
buffer_load_dword v31,v29,s[28:31],s64 offen
s_add_u32 s64,s62,0
s_add_u32 m0,s61,0
s_nop 0
buffer_load_dwordx4 v16,s[28:31],s64 offen lds
s_waitcnt vmcnt(10)
s_add_u32 s64,s62,65536
s_add_u32 m0,s61,1024
s_nop 0
buffer_load_dwordx4 v16,s[28:31],s64 offen lds
s_add_u32 s64,s68,1048576
buffer_load_dword v31,v29,s[28:31],s64 offen
s_waitcnt vmcnt(10)
s_add_u32 s64,s62,131072
s_add_u32 m0,s61,2048
s_nop 0
buffer_load_dwordx4 v16,s[28:31],s64 offen lds
s_waitcnt vmcnt(10)
s_add_u32 s64,s62,196608
s_add_u32 m0,s61,3072
s_nop 0
buffer_load_dwordx4 v16,s[28:31],s64 offen lds
s_waitcnt vmcnt(10)
s_add_u32 s64,s62,262144
s_add_u32 m0,s61,4096
s_nop 0
buffer_load_dwordx4 v16,s[28:31],s64 offen lds
s_waitcnt vmcnt(10)
s_add_u32 s64,s62,327680
s_add_u32 m0,s61,5120
s_nop 0
buffer_load_dwordx4 v16,s[28:31],s64 offen lds
s_add_u32 s64,s68,1310720
buffer_load_dword v31,v29,s[28:31],s64 offen
s_waitcnt vmcnt(10)
s_add_u32 s64,s62,393216
s_add_u32 m0,s61,6144
s_nop 0
buffer_load_dwordx4 v16,s[28:31],s64 offen lds
s_waitcnt vmcnt(10)
s_add_u32 s64,s62,458752
s_add_u32 m0,s61,7168
s_nop 0
buffer_load_dwordx4 v16,s[28:31],s64 offen lds
s_waitcnt vmcnt(10)
s_add_u32 s64,s62,524288
s_add_u32 m0,s61,8192
s_nop 0
buffer_load_dwordx4 v16,s[28:31],s64 offen lds
s_waitcnt vmcnt(10)
s_add_u32 s64,s62,589824
s_add_u32 m0,s61,9216
s_nop 0
buffer_load_dwordx4 v16,s[28:31],s64 offen lds
s_add_u32 s64,s68,1572864
buffer_load_dword v31,v29,s[28:31],s64 offen
s_waitcnt vmcnt(10)
s_add_u32 s64,s62,655360
s_add_u32 m0,s61,10240
s_nop 0
buffer_load_dwordx4 v16,s[28:31],s64 offen lds
s_waitcnt vmcnt(10)
s_add_u32 s64,s62,720896
s_add_u32 m0,s61,11264
s_nop 0
buffer_load_dwordx4 v16,s[28:31],s64 offen lds
s_waitcnt vmcnt(10)
s_add_u32 s64,s62,786432
s_add_u32 m0,s61,12288
s_nop 0
buffer_load_dwordx4 v16,s[28:31],s64 offen lds
s_waitcnt vmcnt(10)
s_add_u32 s64,s62,851968
s_add_u32 m0,s61,13312
s_nop 0
buffer_load_dwordx4 v16,s[28:31],s64 offen lds
s_add_u32 s64,s68,1835008
buffer_load_dword v31,v29,s[28:31],s64 offen
s_waitcnt vmcnt(10)
s_add_u32 s64,s62,917504
s_add_u32 m0,s61,14336
s_nop 0
buffer_load_dwordx4 v16,s[28:31],s64 offen lds
s_waitcnt vmcnt(10)
s_add_u32 s64,s62,983040
s_add_u32 m0,s61,15360
s_nop 0
buffer_load_dwordx4 v16,s[28:31],s64 offen lds
s_add_u32 s64,s62,1048576
s_add_u32 m0,s61,16384
s_nop 0
buffer_load_dwordx4 v16,s[28:31],s64 offen lds
s_waitcnt vmcnt(10)
s_add_u32 s64,s62,1114112
s_add_u32 m0,s61,17408
s_nop 0
buffer_load_dwordx4 v16,s[28:31],s64 offen lds
s_add_u32 s64,s68,0
buffer_load_dword v31,v29,s[32:35],s64 offen
s_waitcnt vmcnt(10)
s_add_u32 s64,s62,1179648
s_add_u32 m0,s61,18432
s_nop 0
buffer_load_dwordx4 v16,s[28:31],s64 offen lds
s_waitcnt vmcnt(10)
s_add_u32 s64,s62,1245184
s_add_u32 m0,s61,19456
s_nop 0
buffer_load_dwordx4 v16,s[28:31],s64 offen lds
s_waitcnt vmcnt(10)
s_add_u32 s64,s62,1310720
s_add_u32 m0,s61,20480
s_nop 0
buffer_load_dwordx4 v16,s[28:31],s64 offen lds
s_waitcnt vmcnt(10)
s_add_u32 s64,s62,1376256
s_add_u32 m0,s61,21504
s_nop 0
buffer_load_dwordx4 v16,s[28:31],s64 offen lds
s_add_u32 s64,s68,262144
buffer_load_dword v31,v29,s[32:35],s64 offen
s_waitcnt vmcnt(10)
s_add_u32 s64,s62,1441792
s_add_u32 m0,s61,22528
s_nop 0
buffer_load_dwordx4 v16,s[28:31],s64 offen lds
s_waitcnt vmcnt(10)
s_add_u32 s64,s62,1507328
s_add_u32 m0,s61,23552
s_nop 0
buffer_load_dwordx4 v16,s[28:31],s64 offen lds
s_waitcnt vmcnt(10)
s_add_u32 s64,s62,1572864
s_add_u32 m0,s61,24576
s_nop 0
buffer_load_dwordx4 v16,s[28:31],s64 offen lds
s_waitcnt vmcnt(10)
s_add_u32 s64,s62,1638400
s_add_u32 m0,s61,25600
s_nop 0
buffer_load_dwordx4 v16,s[28:31],s64 offen lds
s_add_u32 s64,s68,524288
buffer_load_dword v31,v29,s[32:35],s64 offen
s_waitcnt vmcnt(10)
s_add_u32 s64,s62,1703936
s_add_u32 m0,s61,26624
s_nop 0
buffer_load_dwordx4 v16,s[28:31],s64 offen lds
s_waitcnt vmcnt(10)
s_add_u32 s64,s62,1769472
s_add_u32 m0,s61,27648
s_nop 0
buffer_load_dwordx4 v16,s[28:31],s64 offen lds
s_waitcnt vmcnt(10)
s_add_u32 s64,s62,1835008
s_add_u32 m0,s61,28672
s_nop 0
buffer_load_dwordx4 v16,s[28:31],s64 offen lds
s_waitcnt vmcnt(10)
s_add_u32 s64,s62,1900544
s_add_u32 m0,s61,29696
s_nop 0
buffer_load_dwordx4 v16,s[28:31],s64 offen lds
s_add_u32 s64,s68,786432
buffer_load_dword v31,v29,s[32:35],s64 offen
s_waitcnt vmcnt(10)
s_add_u32 s64,s62,1966080
s_add_u32 m0,s61,30720
s_nop 0
buffer_load_dwordx4 v16,s[28:31],s64 offen lds
s_waitcnt vmcnt(10)
s_add_u32 s64,s62,2031616
s_add_u32 m0,s61,31744
s_nop 0
buffer_load_dwordx4 v16,s[28:31],s64 offen lds
s_waitcnt vmcnt(20)
ds_read_b64_tr_b16 a[0:1],v18 offset:0
ds_read_b64_tr_b16 a[2:3],v18 offset:128
ds_read_b64_tr_b16 a[4:5],v18 offset:4096
ds_read_b64_tr_b16 a[6:7],v18 offset:4224
ds_read_b64_tr_b16 a[8:9],v18 offset:32
ds_read_b64_tr_b16 a[10:11],v18 offset:160
ds_read_b64_tr_b16 a[12:13],v18 offset:4128
ds_read_b64_tr_b16 a[14:15],v18 offset:4256
ds_read_b64_tr_b16 a[16:17],v18 offset:64
ds_read_b64_tr_b16 a[18:19],v18 offset:192
ds_read_b64_tr_b16 a[20:21],v18 offset:4160
ds_read_b64_tr_b16 a[22:23],v18 offset:4288
ds_read_b64_tr_b16 a[24:25],v18 offset:96
ds_read_b64_tr_b16 a[26:27],v18 offset:224
ds_read_b64_tr_b16 a[28:29],v18 offset:4192
ds_read_b64_tr_b16 a[30:31],v18 offset:4320
s_waitcnt lgkmcnt(0)
ds_read_b64_tr_b16 a[64:65],v18 offset:8192
ds_read_b64_tr_b16 a[66:67],v18 offset:8320
ds_read_b64_tr_b16 a[68:69],v18 offset:12288
ds_read_b64_tr_b16 a[70:71],v18 offset:12416
ds_read_b64_tr_b16 a[72:73],v18 offset:8224
ds_read_b64_tr_b16 a[74:75],v18 offset:8352
ds_read_b64_tr_b16 a[76:77],v18 offset:12320
ds_read_b64_tr_b16 a[78:79],v18 offset:12448
ds_read_b64_tr_b16 a[80:81],v18 offset:8256
ds_read_b64_tr_b16 a[82:83],v18 offset:8384
ds_read_b64_tr_b16 a[84:85],v18 offset:12352
ds_read_b64_tr_b16 a[86:87],v18 offset:12480
ds_read_b64_tr_b16 a[88:89],v18 offset:8288
ds_read_b64_tr_b16 a[90:91],v18 offset:8416
ds_read_b64_tr_b16 a[92:93],v18 offset:12384
ds_read_b64_tr_b16 a[94:95],v18 offset:12512
s_waitcnt lgkmcnt(0)
s_add_u32 s64,s62,0
s_add_u32 m0,s61,0
s_nop 0
buffer_load_dwordx4 v16,s[32:35],s64 offen lds
s_waitcnt vmcnt(10)
s_add_u32 s64,s62,65536
s_add_u32 m0,s61,1024
s_nop 0
buffer_load_dwordx4 v16,s[32:35],s64 offen lds
s_add_u32 s64,s68,1048576
buffer_load_dword v31,v29,s[32:35],s64 offen
s_waitcnt vmcnt(10)
s_add_u32 s64,s62,131072
s_add_u32 m0,s61,2048
s_nop 0
buffer_load_dwordx4 v16,s[32:35],s64 offen lds
s_waitcnt vmcnt(10)
s_add_u32 s64,s62,196608
s_add_u32 m0,s61,3072
s_nop 0
buffer_load_dwordx4 v16,s[32:35],s64 offen lds
s_waitcnt vmcnt(10)
s_add_u32 s64,s62,262144
s_add_u32 m0,s61,4096
s_nop 0
buffer_load_dwordx4 v16,s[32:35],s64 offen lds
s_waitcnt vmcnt(10)
s_add_u32 s64,s62,327680
s_add_u32 m0,s61,5120
s_nop 0
buffer_load_dwordx4 v16,s[32:35],s64 offen lds
s_add_u32 s64,s68,1310720
buffer_load_dword v31,v29,s[32:35],s64 offen
s_waitcnt vmcnt(10)
s_add_u32 s64,s62,393216
s_add_u32 m0,s61,6144
s_nop 0
buffer_load_dwordx4 v16,s[32:35],s64 offen lds
s_waitcnt vmcnt(10)
s_add_u32 s64,s62,458752
s_add_u32 m0,s61,7168
s_nop 0
buffer_load_dwordx4 v16,s[32:35],s64 offen lds
s_waitcnt vmcnt(10)
s_add_u32 s64,s62,524288
s_add_u32 m0,s61,8192
s_nop 0
buffer_load_dwordx4 v16,s[32:35],s64 offen lds
s_waitcnt vmcnt(10)
s_add_u32 s64,s62,589824
s_add_u32 m0,s61,9216
s_nop 0
buffer_load_dwordx4 v16,s[32:35],s64 offen lds
s_add_u32 s64,s68,1572864
buffer_load_dword v31,v29,s[32:35],s64 offen
s_waitcnt vmcnt(10)
s_add_u32 s64,s62,655360
s_add_u32 m0,s61,10240
s_nop 0
buffer_load_dwordx4 v16,s[32:35],s64 offen lds
s_waitcnt vmcnt(10)
s_add_u32 s64,s62,720896
s_add_u32 m0,s61,11264
s_nop 0
buffer_load_dwordx4 v16,s[32:35],s64 offen lds
s_waitcnt vmcnt(10)
s_add_u32 s64,s62,786432
s_add_u32 m0,s61,12288
s_nop 0
buffer_load_dwordx4 v16,s[32:35],s64 offen lds
s_waitcnt vmcnt(10)
s_add_u32 s64,s62,851968
s_add_u32 m0,s61,13312
s_nop 0
buffer_load_dwordx4 v16,s[32:35],s64 offen lds
s_add_u32 s64,s68,1835008
buffer_load_dword v31,v29,s[32:35],s64 offen
s_waitcnt vmcnt(10)
s_add_u32 s64,s62,917504
s_add_u32 m0,s61,14336
s_nop 0
buffer_load_dwordx4 v16,s[32:35],s64 offen lds
s_waitcnt vmcnt(10)
s_add_u32 s64,s62,983040
s_add_u32 m0,s61,15360
s_nop 0
buffer_load_dwordx4 v16,s[32:35],s64 offen lds
s_waitcnt vmcnt(20)
ds_read_b64_tr_b16 a[128:129],v18 offset:16384
ds_read_b64_tr_b16 a[130:131],v18 offset:16512
ds_read_b64_tr_b16 a[132:133],v18 offset:20480
ds_read_b64_tr_b16 a[134:135],v18 offset:20608
ds_read_b64_tr_b16 a[136:137],v18 offset:16416
ds_read_b64_tr_b16 a[138:139],v18 offset:16544
ds_read_b64_tr_b16 a[140:141],v18 offset:20512
ds_read_b64_tr_b16 a[142:143],v18 offset:20640
ds_read_b64_tr_b16 a[144:145],v18 offset:16448
ds_read_b64_tr_b16 a[146:147],v18 offset:16576
ds_read_b64_tr_b16 a[148:149],v18 offset:20544
ds_read_b64_tr_b16 a[150:151],v18 offset:20672
ds_read_b64_tr_b16 a[152:153],v18 offset:16480
ds_read_b64_tr_b16 a[154:155],v18 offset:16608
ds_read_b64_tr_b16 a[156:157],v18 offset:20576
ds_read_b64_tr_b16 a[158:159],v18 offset:20704
s_waitcnt lgkmcnt(0)
ds_read_b64_tr_b16 a[192:193],v18 offset:24576
ds_read_b64_tr_b16 a[194:195],v18 offset:24704
ds_read_b64_tr_b16 a[196:197],v18 offset:28672
ds_read_b64_tr_b16 a[198:199],v18 offset:28800
ds_read_b64_tr_b16 a[200:201],v18 offset:24608
ds_read_b64_tr_b16 a[202:203],v18 offset:24736
ds_read_b64_tr_b16 a[204:205],v18 offset:28704
ds_read_b64_tr_b16 a[206:207],v18 offset:28832
ds_read_b64_tr_b16 a[208:209],v18 offset:24640
ds_read_b64_tr_b16 a[210:211],v18 offset:24768
ds_read_b64_tr_b16 a[212:213],v18 offset:28736
ds_read_b64_tr_b16 a[214:215],v18 offset:28864
ds_read_b64_tr_b16 a[216:217],v18 offset:24672
ds_read_b64_tr_b16 a[218:219],v18 offset:24800
ds_read_b64_tr_b16 a[220:221],v18 offset:28768
ds_read_b64_tr_b16 a[222:223],v18 offset:28896
s_waitcnt lgkmcnt(0)
s_add_u32 s64,s62,1048576
s_add_u32 m0,s61,16384
s_nop 0
buffer_load_dwordx4 v16,s[32:35],s64 offen lds
s_waitcnt vmcnt(10)
s_add_u32 s64,s62,1114112
s_add_u32 m0,s61,17408
s_nop 0
buffer_load_dwordx4 v16,s[32:35],s64 offen lds
s_add_u32 s64,s69,0
buffer_load_dword v31,v30,s[40:43],s64 offen
s_waitcnt vmcnt(10)
s_add_u32 s64,s62,1179648
s_add_u32 m0,s61,18432
s_nop 0
buffer_load_dwordx4 v16,s[32:35],s64 offen lds
s_waitcnt vmcnt(10)
s_add_u32 s64,s62,1245184
s_add_u32 m0,s61,19456
s_nop 0
buffer_load_dwordx4 v16,s[32:35],s64 offen lds
s_waitcnt vmcnt(10)
s_add_u32 s64,s62,1310720
s_add_u32 m0,s61,20480
s_nop 0
buffer_load_dwordx4 v16,s[32:35],s64 offen lds
s_waitcnt vmcnt(10)
s_add_u32 s64,s62,1376256
s_add_u32 m0,s61,21504
s_nop 0
buffer_load_dwordx4 v16,s[32:35],s64 offen lds
s_add_u32 s64,s69,131072
buffer_load_dword v31,v30,s[40:43],s64 offen
s_waitcnt vmcnt(10)
s_add_u32 s64,s62,1441792
s_add_u32 m0,s61,22528
s_nop 0
buffer_load_dwordx4 v16,s[32:35],s64 offen lds
s_waitcnt vmcnt(10)
s_add_u32 s64,s62,1507328
s_add_u32 m0,s61,23552
s_nop 0
buffer_load_dwordx4 v16,s[32:35],s64 offen lds
s_waitcnt vmcnt(10)
s_add_u32 s64,s62,1572864
s_add_u32 m0,s61,24576
s_nop 0
buffer_load_dwordx4 v16,s[32:35],s64 offen lds
s_waitcnt vmcnt(10)
s_add_u32 s64,s62,1638400
s_add_u32 m0,s61,25600
s_nop 0
buffer_load_dwordx4 v16,s[32:35],s64 offen lds
s_add_u32 s64,s69,262144
buffer_load_dword v31,v30,s[40:43],s64 offen
s_waitcnt vmcnt(10)
s_add_u32 s64,s62,1703936
s_add_u32 m0,s61,26624
s_nop 0
buffer_load_dwordx4 v16,s[32:35],s64 offen lds
s_waitcnt vmcnt(10)
s_add_u32 s64,s62,1769472
s_add_u32 m0,s61,27648
s_nop 0
buffer_load_dwordx4 v16,s[32:35],s64 offen lds
s_waitcnt vmcnt(10)
s_add_u32 s64,s62,1835008
s_add_u32 m0,s61,28672
s_nop 0
buffer_load_dwordx4 v16,s[32:35],s64 offen lds
s_waitcnt vmcnt(10)
s_add_u32 s64,s62,1900544
s_add_u32 m0,s61,29696
s_nop 0
buffer_load_dwordx4 v16,s[32:35],s64 offen lds
s_add_u32 s64,s69,393216
buffer_load_dword v31,v30,s[40:43],s64 offen
s_waitcnt vmcnt(10)
s_add_u32 s64,s62,1966080
s_add_u32 m0,s61,30720
s_nop 0
buffer_load_dwordx4 v16,s[32:35],s64 offen lds
s_waitcnt vmcnt(10)
s_add_u32 s64,s62,2031616
s_add_u32 m0,s61,31744
s_nop 0
buffer_load_dwordx4 v16,s[32:35],s64 offen lds
s_waitcnt vmcnt(20)
ds_read_b64_tr_b16 a[32:33],v18 offset:0
ds_read_b64_tr_b16 a[34:35],v18 offset:128
ds_read_b64_tr_b16 a[36:37],v18 offset:4096
ds_read_b64_tr_b16 a[38:39],v18 offset:4224
ds_read_b64_tr_b16 a[40:41],v18 offset:32
ds_read_b64_tr_b16 a[42:43],v18 offset:160
ds_read_b64_tr_b16 a[44:45],v18 offset:4128
ds_read_b64_tr_b16 a[46:47],v18 offset:4256
ds_read_b64_tr_b16 a[48:49],v18 offset:64
ds_read_b64_tr_b16 a[50:51],v18 offset:192
ds_read_b64_tr_b16 a[52:53],v18 offset:4160
ds_read_b64_tr_b16 a[54:55],v18 offset:4288
ds_read_b64_tr_b16 a[56:57],v18 offset:96
ds_read_b64_tr_b16 a[58:59],v18 offset:224
ds_read_b64_tr_b16 a[60:61],v18 offset:4192
ds_read_b64_tr_b16 a[62:63],v18 offset:4320
s_waitcnt lgkmcnt(0)
ds_read_b64_tr_b16 a[96:97],v18 offset:8192
ds_read_b64_tr_b16 a[98:99],v18 offset:8320
ds_read_b64_tr_b16 a[100:101],v18 offset:12288
ds_read_b64_tr_b16 a[102:103],v18 offset:12416
ds_read_b64_tr_b16 a[104:105],v18 offset:8224
ds_read_b64_tr_b16 a[106:107],v18 offset:8352
ds_read_b64_tr_b16 a[108:109],v18 offset:12320
ds_read_b64_tr_b16 a[110:111],v18 offset:12448
ds_read_b64_tr_b16 a[112:113],v18 offset:8256
ds_read_b64_tr_b16 a[114:115],v18 offset:8384
ds_read_b64_tr_b16 a[116:117],v18 offset:12352
ds_read_b64_tr_b16 a[118:119],v18 offset:12480
ds_read_b64_tr_b16 a[120:121],v18 offset:8288
ds_read_b64_tr_b16 a[122:123],v18 offset:8416
ds_read_b64_tr_b16 a[124:125],v18 offset:12384
ds_read_b64_tr_b16 a[126:127],v18 offset:12512
s_waitcnt lgkmcnt(0)
s_add_u32 s64,s70,0
s_add_u32 m0,s72,0
s_nop 0
buffer_load_dwordx4 v17,s[40:43],s64 offen lds
s_waitcnt vmcnt(10)
s_add_u32 s64,s70,32768
s_add_u32 m0,s72,1024
s_nop 0
buffer_load_dwordx4 v17,s[40:43],s64 offen lds
s_add_u32 s64,s69,524288
buffer_load_dword v31,v30,s[40:43],s64 offen
s_waitcnt vmcnt(10)
s_add_u32 s64,s70,65536
s_add_u32 m0,s72,2048
s_nop 0
buffer_load_dwordx4 v17,s[40:43],s64 offen lds
s_waitcnt vmcnt(10)
s_add_u32 s64,s70,98304
s_add_u32 m0,s72,3072
s_nop 0
buffer_load_dwordx4 v17,s[40:43],s64 offen lds
s_waitcnt vmcnt(10)
s_add_u32 s64,s70,131072
s_add_u32 m0,s72,4096
s_nop 0
buffer_load_dwordx4 v17,s[40:43],s64 offen lds
s_waitcnt vmcnt(10)
s_add_u32 s64,s70,163840
s_add_u32 m0,s72,5120
s_nop 0
buffer_load_dwordx4 v17,s[40:43],s64 offen lds
s_add_u32 s64,s69,655360
buffer_load_dword v31,v30,s[40:43],s64 offen
s_waitcnt vmcnt(10)
s_add_u32 s64,s70,196608
s_add_u32 m0,s72,6144
s_nop 0
buffer_load_dwordx4 v17,s[40:43],s64 offen lds
s_waitcnt vmcnt(10)
s_add_u32 s64,s70,229376
s_add_u32 m0,s72,7168
s_nop 0
buffer_load_dwordx4 v17,s[40:43],s64 offen lds
s_waitcnt vmcnt(10)
s_add_u32 s64,s71,262144
s_add_u32 m0,s73,8192
s_nop 0
buffer_load_dwordx4 v17,s[40:43],s64 offen lds
s_waitcnt vmcnt(10)
s_add_u32 s64,s71,294912
s_add_u32 m0,s73,9216
s_nop 0
buffer_load_dwordx4 v17,s[40:43],s64 offen lds
s_add_u32 s64,s69,786432
buffer_load_dword v31,v30,s[40:43],s64 offen
s_waitcnt vmcnt(10)
s_add_u32 s64,s71,327680
s_add_u32 m0,s73,10240
s_nop 0
buffer_load_dwordx4 v17,s[40:43],s64 offen lds
s_waitcnt vmcnt(10)
s_add_u32 s64,s71,360448
s_add_u32 m0,s73,11264
s_nop 0
buffer_load_dwordx4 v17,s[40:43],s64 offen lds
s_waitcnt vmcnt(10)
s_add_u32 s64,s71,393216
s_add_u32 m0,s73,12288
s_nop 0
buffer_load_dwordx4 v17,s[40:43],s64 offen lds
s_waitcnt vmcnt(10)
s_add_u32 s64,s71,425984
s_add_u32 m0,s73,13312
s_nop 0
buffer_load_dwordx4 v17,s[40:43],s64 offen lds
s_add_u32 s64,s69,917504
buffer_load_dword v31,v30,s[40:43],s64 offen
s_waitcnt vmcnt(10)
s_add_u32 s64,s71,458752
s_add_u32 m0,s73,14336
s_nop 0
buffer_load_dwordx4 v17,s[40:43],s64 offen lds
s_waitcnt vmcnt(10)
s_add_u32 s64,s71,491520
s_add_u32 m0,s73,15360
s_nop 0
buffer_load_dwordx4 v17,s[40:43],s64 offen lds
s_waitcnt vmcnt(20)
ds_read_b64_tr_b16 a[160:161],v18 offset:16384
ds_read_b64_tr_b16 a[162:163],v18 offset:16512
ds_read_b64_tr_b16 a[164:165],v18 offset:20480
ds_read_b64_tr_b16 a[166:167],v18 offset:20608
ds_read_b64_tr_b16 a[168:169],v18 offset:16416
ds_read_b64_tr_b16 a[170:171],v18 offset:16544
ds_read_b64_tr_b16 a[172:173],v18 offset:20512
ds_read_b64_tr_b16 a[174:175],v18 offset:20640
ds_read_b64_tr_b16 a[176:177],v18 offset:16448
ds_read_b64_tr_b16 a[178:179],v18 offset:16576
ds_read_b64_tr_b16 a[180:181],v18 offset:20544
ds_read_b64_tr_b16 a[182:183],v18 offset:20672
ds_read_b64_tr_b16 a[184:185],v18 offset:16480
ds_read_b64_tr_b16 a[186:187],v18 offset:16608
ds_read_b64_tr_b16 a[188:189],v18 offset:20576
ds_read_b64_tr_b16 a[190:191],v18 offset:20704
s_waitcnt lgkmcnt(0)
ds_read_b64_tr_b16 a[224:225],v18 offset:24576
ds_read_b64_tr_b16 a[226:227],v18 offset:24704
ds_read_b64_tr_b16 a[228:229],v18 offset:28672
ds_read_b64_tr_b16 a[230:231],v18 offset:28800
ds_read_b64_tr_b16 a[232:233],v18 offset:24608
ds_read_b64_tr_b16 a[234:235],v18 offset:24736
ds_read_b64_tr_b16 a[236:237],v18 offset:28704
ds_read_b64_tr_b16 a[238:239],v18 offset:28832
ds_read_b64_tr_b16 a[240:241],v18 offset:24640
ds_read_b64_tr_b16 a[242:243],v18 offset:24768
ds_read_b64_tr_b16 a[244:245],v18 offset:28736
ds_read_b64_tr_b16 a[246:247],v18 offset:28864
ds_read_b64_tr_b16 a[248:249],v18 offset:24672
ds_read_b64_tr_b16 a[250:251],v18 offset:24800
ds_read_b64_tr_b16 a[252:253],v18 offset:28768
ds_read_b64_tr_b16 a[254:255],v18 offset:28896
s_waitcnt lgkmcnt(0)
s_add_u32 s64,s70,524288
s_add_u32 m0,s72,16384
s_nop 0
buffer_load_dwordx4 v17,s[40:43],s64 offen lds
s_waitcnt vmcnt(10)
s_add_u32 s64,s70,557056
s_add_u32 m0,s72,17408
s_nop 0
buffer_load_dwordx4 v17,s[40:43],s64 offen lds
s_add_u32 s64,s68,0
buffer_load_dword v31,v29,s[36:39],s64 offen
s_waitcnt vmcnt(10)
s_add_u32 s64,s70,589824
s_add_u32 m0,s72,18432
s_nop 0
buffer_load_dwordx4 v17,s[40:43],s64 offen lds
s_waitcnt vmcnt(10)
s_add_u32 s64,s70,622592
s_add_u32 m0,s72,19456
s_nop 0
buffer_load_dwordx4 v17,s[40:43],s64 offen lds
s_waitcnt vmcnt(10)
s_add_u32 s64,s70,655360
s_add_u32 m0,s72,20480
s_nop 0
buffer_load_dwordx4 v17,s[40:43],s64 offen lds
s_waitcnt vmcnt(10)
s_add_u32 s64,s70,688128
s_add_u32 m0,s72,21504
s_nop 0
buffer_load_dwordx4 v17,s[40:43],s64 offen lds
s_add_u32 s64,s68,262144
buffer_load_dword v31,v29,s[36:39],s64 offen
s_waitcnt vmcnt(10)
s_add_u32 s64,s70,720896
s_add_u32 m0,s72,22528
s_nop 0
buffer_load_dwordx4 v17,s[40:43],s64 offen lds
s_waitcnt vmcnt(10)
s_add_u32 s64,s70,753664
s_add_u32 m0,s72,23552
s_nop 0
buffer_load_dwordx4 v17,s[40:43],s64 offen lds
s_waitcnt vmcnt(10)
s_add_u32 s64,s71,786432
s_add_u32 m0,s73,24576
s_nop 0
buffer_load_dwordx4 v17,s[40:43],s64 offen lds
s_waitcnt vmcnt(10)
s_add_u32 s64,s71,819200
s_add_u32 m0,s73,25600
s_nop 0
buffer_load_dwordx4 v17,s[40:43],s64 offen lds
s_add_u32 s64,s68,524288
buffer_load_dword v31,v29,s[36:39],s64 offen
s_waitcnt vmcnt(10)
s_add_u32 s64,s71,851968
s_add_u32 m0,s73,26624
s_nop 0
buffer_load_dwordx4 v17,s[40:43],s64 offen lds
s_waitcnt vmcnt(10)
s_add_u32 s64,s71,884736
s_add_u32 m0,s73,27648
s_nop 0
buffer_load_dwordx4 v17,s[40:43],s64 offen lds
s_waitcnt vmcnt(10)
s_add_u32 s64,s71,917504
s_add_u32 m0,s73,28672
s_nop 0
buffer_load_dwordx4 v17,s[40:43],s64 offen lds
s_waitcnt vmcnt(10)
s_add_u32 s64,s71,950272
s_add_u32 m0,s73,29696
s_nop 0
buffer_load_dwordx4 v17,s[40:43],s64 offen lds
s_add_u32 s64,s68,786432
buffer_load_dword v31,v29,s[36:39],s64 offen
s_waitcnt vmcnt(10)
s_add_u32 s64,s71,983040
s_add_u32 m0,s73,30720
s_nop 0
buffer_load_dwordx4 v17,s[40:43],s64 offen lds
s_waitcnt vmcnt(10)
s_add_u32 s64,s71,1015808
s_add_u32 m0,s73,31744
s_nop 0
buffer_load_dwordx4 v17,s[40:43],s64 offen lds
s_waitcnt vmcnt(20)
ds_read_b64_tr_b16 v[48:49],v27 offset:0
ds_read_b64_tr_b16 v[50:51],v27 offset:128
ds_read_b64_tr_b16 v[52:53],v27 offset:2048
ds_read_b64_tr_b16 v[54:55],v27 offset:2176
ds_read_b64_tr_b16 v[56:57],v27 offset:32
ds_read_b64_tr_b16 v[58:59],v27 offset:160
ds_read_b64_tr_b16 v[60:61],v27 offset:2080
ds_read_b64_tr_b16 v[62:63],v27 offset:2208
ds_read_b64_tr_b16 v[64:65],v27 offset:4096
ds_read_b64_tr_b16 v[66:67],v27 offset:4224
ds_read_b64_tr_b16 v[68:69],v27 offset:6144
ds_read_b64_tr_b16 v[70:71],v27 offset:6272
ds_read_b64_tr_b16 v[72:73],v27 offset:4128
ds_read_b64_tr_b16 v[74:75],v27 offset:4256
ds_read_b64_tr_b16 v[76:77],v27 offset:6176
ds_read_b64_tr_b16 v[78:79],v27 offset:6304
s_waitcnt lgkmcnt(0)
ds_read_b64_tr_b16 v[80:81],v27 offset:8192
ds_read_b64_tr_b16 v[82:83],v27 offset:8320
ds_read_b64_tr_b16 v[84:85],v27 offset:10240
ds_read_b64_tr_b16 v[86:87],v27 offset:10368
ds_read_b64_tr_b16 v[88:89],v27 offset:8224
ds_read_b64_tr_b16 v[90:91],v27 offset:8352
ds_read_b64_tr_b16 v[92:93],v27 offset:10272
ds_read_b64_tr_b16 v[94:95],v27 offset:10400
ds_read_b64_tr_b16 v[128:129],v27 offset:12288
ds_read_b64_tr_b16 v[130:131],v27 offset:12416
ds_read_b64_tr_b16 v[132:133],v27 offset:14336
ds_read_b64_tr_b16 v[134:135],v27 offset:14464
ds_read_b64_tr_b16 v[136:137],v27 offset:12320
ds_read_b64_tr_b16 v[138:139],v27 offset:12448
ds_read_b64_tr_b16 v[140:141],v27 offset:14368
ds_read_b64_tr_b16 v[142:143],v27 offset:14496
s_waitcnt lgkmcnt(0)
s_add_u32 s64,s62,0
s_add_u32 m0,s61,0
s_nop 0
buffer_load_dwordx4 v16,s[36:39],s64 offen lds
s_waitcnt vmcnt(10)
s_add_u32 s64,s62,65536
s_add_u32 m0,s61,1024
s_nop 0
buffer_load_dwordx4 v16,s[36:39],s64 offen lds
s_add_u32 s64,s68,1048576
buffer_load_dword v31,v29,s[36:39],s64 offen
s_waitcnt vmcnt(10)
s_add_u32 s64,s62,131072
s_add_u32 m0,s61,2048
s_nop 0
buffer_load_dwordx4 v16,s[36:39],s64 offen lds
s_waitcnt vmcnt(10)
s_add_u32 s64,s62,196608
s_add_u32 m0,s61,3072
s_nop 0
buffer_load_dwordx4 v16,s[36:39],s64 offen lds
s_waitcnt vmcnt(10)
s_add_u32 s64,s62,262144
s_add_u32 m0,s61,4096
s_nop 0
buffer_load_dwordx4 v16,s[36:39],s64 offen lds
s_waitcnt vmcnt(10)
s_add_u32 s64,s62,327680
s_add_u32 m0,s61,5120
s_nop 0
buffer_load_dwordx4 v16,s[36:39],s64 offen lds
s_add_u32 s64,s68,1310720
buffer_load_dword v31,v29,s[36:39],s64 offen
s_waitcnt vmcnt(10)
s_add_u32 s64,s62,393216
s_add_u32 m0,s61,6144
s_nop 0
buffer_load_dwordx4 v16,s[36:39],s64 offen lds
s_waitcnt vmcnt(10)
s_add_u32 s64,s62,458752
s_add_u32 m0,s61,7168
s_nop 0
buffer_load_dwordx4 v16,s[36:39],s64 offen lds
s_waitcnt vmcnt(10)
s_add_u32 s64,s62,524288
s_add_u32 m0,s61,8192
s_nop 0
buffer_load_dwordx4 v16,s[36:39],s64 offen lds
s_waitcnt vmcnt(10)
s_add_u32 s64,s62,589824
s_add_u32 m0,s61,9216
s_nop 0
buffer_load_dwordx4 v16,s[36:39],s64 offen lds
s_add_u32 s64,s68,1572864
buffer_load_dword v31,v29,s[36:39],s64 offen
s_waitcnt vmcnt(10)
s_add_u32 s64,s62,655360
s_add_u32 m0,s61,10240
s_nop 0
buffer_load_dwordx4 v16,s[36:39],s64 offen lds
s_waitcnt vmcnt(10)
s_add_u32 s64,s62,720896
s_add_u32 m0,s61,11264
s_nop 0
buffer_load_dwordx4 v16,s[36:39],s64 offen lds
s_waitcnt vmcnt(10)
s_add_u32 s64,s62,786432
s_add_u32 m0,s61,12288
s_nop 0
buffer_load_dwordx4 v16,s[36:39],s64 offen lds
s_waitcnt vmcnt(10)
s_add_u32 s64,s62,851968
s_add_u32 m0,s61,13312
s_nop 0
buffer_load_dwordx4 v16,s[36:39],s64 offen lds
s_add_u32 s64,s68,1835008
buffer_load_dword v31,v29,s[36:39],s64 offen
s_waitcnt vmcnt(10)
s_add_u32 s64,s62,917504
s_add_u32 m0,s61,14336
s_nop 0
buffer_load_dwordx4 v16,s[36:39],s64 offen lds
s_waitcnt vmcnt(10)
s_add_u32 s64,s62,983040
s_add_u32 m0,s61,15360
s_nop 0
buffer_load_dwordx4 v16,s[36:39],s64 offen lds
s_waitcnt vmcnt(20)
ds_read_b64_tr_b16 v[144:145],v27 offset:16384
ds_read_b64_tr_b16 v[146:147],v27 offset:16512
ds_read_b64_tr_b16 v[148:149],v27 offset:18432
ds_read_b64_tr_b16 v[150:151],v27 offset:18560
ds_read_b64_tr_b16 v[152:153],v27 offset:16416
ds_read_b64_tr_b16 v[154:155],v27 offset:16544
ds_read_b64_tr_b16 v[156:157],v27 offset:18464
ds_read_b64_tr_b16 v[158:159],v27 offset:18592
ds_read_b64_tr_b16 v[160:161],v27 offset:20480
ds_read_b64_tr_b16 v[162:163],v27 offset:20608
ds_read_b64_tr_b16 v[164:165],v27 offset:22528
ds_read_b64_tr_b16 v[166:167],v27 offset:22656
ds_read_b64_tr_b16 v[168:169],v27 offset:20512
ds_read_b64_tr_b16 v[170:171],v27 offset:20640
ds_read_b64_tr_b16 v[172:173],v27 offset:22560
ds_read_b64_tr_b16 v[174:175],v27 offset:22688
s_waitcnt lgkmcnt(0)
ds_read_b64_tr_b16 v[176:177],v27 offset:24576
ds_read_b64_tr_b16 v[178:179],v27 offset:24704
ds_read_b64_tr_b16 v[180:181],v27 offset:26624
ds_read_b64_tr_b16 v[182:183],v27 offset:26752
ds_read_b64_tr_b16 v[184:185],v27 offset:24608
ds_read_b64_tr_b16 v[186:187],v27 offset:24736
ds_read_b64_tr_b16 v[188:189],v27 offset:26656
ds_read_b64_tr_b16 v[190:191],v27 offset:26784
ds_read_b64_tr_b16 v[192:193],v27 offset:28672
ds_read_b64_tr_b16 v[194:195],v27 offset:28800
ds_read_b64_tr_b16 v[196:197],v27 offset:30720
ds_read_b64_tr_b16 v[198:199],v27 offset:30848
ds_read_b64_tr_b16 v[200:201],v27 offset:28704
ds_read_b64_tr_b16 v[202:203],v27 offset:28832
ds_read_b64_tr_b16 v[204:205],v27 offset:30752
ds_read_b64_tr_b16 v[206:207],v27 offset:30880
s_waitcnt lgkmcnt(0)
s_add_u32 s64,s62,1048576
s_add_u32 m0,s61,16384
s_nop 0
buffer_load_dwordx4 v16,s[36:39],s64 offen lds
s_waitcnt vmcnt(10)
s_add_u32 s64,s62,1114112
s_add_u32 m0,s61,17408
s_nop 0
buffer_load_dwordx4 v16,s[36:39],s64 offen lds
s_waitcnt vmcnt(10)
s_add_u32 s64,s62,1179648
s_add_u32 m0,s61,18432
s_nop 0
buffer_load_dwordx4 v16,s[36:39],s64 offen lds
s_waitcnt vmcnt(10)
s_add_u32 s64,s62,1245184
s_add_u32 m0,s61,19456
s_nop 0
buffer_load_dwordx4 v16,s[36:39],s64 offen lds
s_waitcnt vmcnt(10)
s_add_u32 s64,s62,1310720
s_add_u32 m0,s61,20480
s_nop 0
buffer_load_dwordx4 v16,s[36:39],s64 offen lds
s_waitcnt vmcnt(10)
s_add_u32 s64,s62,1376256
s_add_u32 m0,s61,21504
s_nop 0
buffer_load_dwordx4 v16,s[36:39],s64 offen lds
s_waitcnt vmcnt(10)
s_add_u32 s64,s62,1441792
s_add_u32 m0,s61,22528
s_nop 0
buffer_load_dwordx4 v16,s[36:39],s64 offen lds
s_waitcnt vmcnt(10)
s_add_u32 s64,s62,1507328
s_add_u32 m0,s61,23552
s_nop 0
buffer_load_dwordx4 v16,s[36:39],s64 offen lds
s_waitcnt vmcnt(10)
s_add_u32 s64,s62,1572864
s_add_u32 m0,s61,24576
s_nop 0
buffer_load_dwordx4 v16,s[36:39],s64 offen lds
s_waitcnt vmcnt(10)
s_add_u32 s64,s62,1638400
s_add_u32 m0,s61,25600
s_nop 0
buffer_load_dwordx4 v16,s[36:39],s64 offen lds
s_waitcnt vmcnt(10)
s_add_u32 s64,s62,1703936
s_add_u32 m0,s61,26624
s_nop 0
buffer_load_dwordx4 v16,s[36:39],s64 offen lds
s_waitcnt vmcnt(10)
s_add_u32 s64,s62,1769472
s_add_u32 m0,s61,27648
s_nop 0
buffer_load_dwordx4 v16,s[36:39],s64 offen lds
s_waitcnt vmcnt(10)
s_add_u32 s64,s62,1835008
s_add_u32 m0,s61,28672
s_nop 0
buffer_load_dwordx4 v16,s[36:39],s64 offen lds
s_waitcnt vmcnt(10)
s_add_u32 s64,s62,1900544
s_add_u32 m0,s61,29696
s_nop 0
buffer_load_dwordx4 v16,s[36:39],s64 offen lds
s_waitcnt vmcnt(10)
s_add_u32 s64,s62,1966080
s_add_u32 m0,s61,30720
s_nop 0
buffer_load_dwordx4 v16,s[36:39],s64 offen lds
s_waitcnt vmcnt(10)
s_add_u32 s64,s62,2031616
s_add_u32 m0,s61,31744
s_nop 0
buffer_load_dwordx4 v16,s[36:39],s64 offen lds
s_waitcnt vmcnt(16)
ds_read_b64_tr_b16 v[208:209],v19 offset:0
ds_read_b64_tr_b16 v[210:211],v19 offset:128
ds_read_b64_tr_b16 v[212:213],v19 offset:4096
ds_read_b64_tr_b16 v[214:215],v19 offset:4224
ds_read_b64_tr_b16 v[216:217],v19 offset:8
ds_read_b64_tr_b16 v[218:219],v19 offset:136
ds_read_b64_tr_b16 v[220:221],v19 offset:4104
ds_read_b64_tr_b16 v[222:223],v19 offset:4232
ds_read_b64_tr_b16 v[224:225],v19 offset:64
ds_read_b64_tr_b16 v[226:227],v19 offset:192
ds_read_b64_tr_b16 v[228:229],v19 offset:4160
ds_read_b64_tr_b16 v[230:231],v19 offset:4288
ds_read_b64_tr_b16 v[232:233],v19 offset:72
ds_read_b64_tr_b16 v[234:235],v19 offset:200
ds_read_b64_tr_b16 v[236:237],v19 offset:4168
ds_read_b64_tr_b16 v[238:239],v19 offset:4296
s_waitcnt lgkmcnt(0)
ds_read_b64_tr_b16 v[240:241],v19 offset:8192
ds_read_b64_tr_b16 v[242:243],v19 offset:8320
ds_read_b64_tr_b16 v[244:245],v19 offset:12288
ds_read_b64_tr_b16 v[246:247],v19 offset:12416
ds_read_b64_tr_b16 v[248:249],v19 offset:8200
ds_read_b64_tr_b16 v[250:251],v19 offset:8328
ds_read_b64_tr_b16 v[252:253],v19 offset:12296
ds_read_b64_tr_b16 v[254:255],v19 offset:12424
ds_read_b64_tr_b16 v[96:97],v19 offset:8256
ds_read_b64_tr_b16 v[98:99],v19 offset:8384
ds_read_b64_tr_b16 v[100:101],v19 offset:12352
ds_read_b64_tr_b16 v[102:103],v19 offset:12480
ds_read_b64_tr_b16 v[104:105],v19 offset:8264
ds_read_b64_tr_b16 v[106:107],v19 offset:8392
ds_read_b64_tr_b16 v[108:109],v19 offset:12360
ds_read_b64_tr_b16 v[110:111],v19 offset:12488
s_waitcnt lgkmcnt(0)
s_waitcnt vmcnt(0)
ds_write_b128 v7,v[96:99] offset:0
ds_write_b128 v7,v[100:103] offset:1024
ds_write_b128 v7,v[104:107] offset:2048
ds_write_b128 v7,v[108:111] offset:3072
s_waitcnt lgkmcnt(0)
ds_read_b64_tr_b16 v[96:97],v19 offset:16384
ds_read_b64_tr_b16 v[98:99],v19 offset:16512
ds_read_b64_tr_b16 v[100:101],v19 offset:20480
ds_read_b64_tr_b16 v[102:103],v19 offset:20608
ds_read_b64_tr_b16 v[104:105],v19 offset:16392
ds_read_b64_tr_b16 v[106:107],v19 offset:16520
ds_read_b64_tr_b16 v[108:109],v19 offset:20488
ds_read_b64_tr_b16 v[110:111],v19 offset:20616
s_waitcnt lgkmcnt(0)
ds_write_b128 v7,v[96:99] offset:4096
ds_write_b128 v7,v[100:103] offset:5120
ds_write_b128 v7,v[104:107] offset:6144
ds_write_b128 v7,v[108:111] offset:7168
s_waitcnt lgkmcnt(0)
ds_read_b64_tr_b16 v[96:97],v19 offset:16448
ds_read_b64_tr_b16 v[98:99],v19 offset:16576
ds_read_b64_tr_b16 v[100:101],v19 offset:20544
ds_read_b64_tr_b16 v[102:103],v19 offset:20672
ds_read_b64_tr_b16 v[104:105],v19 offset:16456
ds_read_b64_tr_b16 v[106:107],v19 offset:16584
ds_read_b64_tr_b16 v[108:109],v19 offset:20552
ds_read_b64_tr_b16 v[110:111],v19 offset:20680
s_waitcnt lgkmcnt(0)
ds_write_b128 v7,v[96:99] offset:8192
ds_write_b128 v7,v[100:103] offset:9216
ds_write_b128 v7,v[104:107] offset:10240
ds_write_b128 v7,v[108:111] offset:11264
s_waitcnt lgkmcnt(0)
ds_read_b64_tr_b16 v[96:97],v19 offset:24576
ds_read_b64_tr_b16 v[98:99],v19 offset:24704
ds_read_b64_tr_b16 v[100:101],v19 offset:28672
ds_read_b64_tr_b16 v[102:103],v19 offset:28800
ds_read_b64_tr_b16 v[104:105],v19 offset:24584
ds_read_b64_tr_b16 v[106:107],v19 offset:24712
ds_read_b64_tr_b16 v[108:109],v19 offset:28680
ds_read_b64_tr_b16 v[110:111],v19 offset:28808
s_waitcnt lgkmcnt(0)
ds_write_b128 v7,v[96:99] offset:12288
ds_write_b128 v7,v[100:103] offset:13312
ds_write_b128 v7,v[104:107] offset:14336
ds_write_b128 v7,v[108:111] offset:15360
s_waitcnt lgkmcnt(0)
ds_read_b64_tr_b16 v[112:113],v19 offset:24640
ds_read_b64_tr_b16 v[114:115],v19 offset:24768
ds_read_b64_tr_b16 v[116:117],v19 offset:28736
ds_read_b64_tr_b16 v[118:119],v19 offset:28864
ds_read_b64_tr_b16 v[120:121],v19 offset:24648
ds_read_b64_tr_b16 v[122:123],v19 offset:24776
ds_read_b64_tr_b16 v[124:125],v19 offset:28744
ds_read_b64_tr_b16 v[126:127],v19 offset:28872
s_waitcnt lgkmcnt(0)
ds_write_b128 v7,v[112:115] offset:16384
ds_write_b128 v7,v[116:119] offset:17408
ds_write_b128 v7,v[120:123] offset:18432
ds_write_b128 v7,v[124:127] offset:19456
ds_write_b128 v7,v[48:51] offset:20480
ds_write_b128 v7,v[52:55] offset:21504
ds_write_b128 v7,v[56:59] offset:22528
ds_write_b128 v7,v[60:63] offset:23552
ds_write_b128 v7,v[64:67] offset:24576
ds_write_b128 v7,v[68:71] offset:25600
ds_write_b128 v7,v[72:75] offset:26624
ds_write_b128 v7,v[76:79] offset:27648
ds_write_b128 v7,v[80:83] offset:28672
ds_write_b128 v7,v[84:87] offset:29696
ds_write_b128 v7,v[88:91] offset:30720
ds_write_b128 v7,v[92:95] offset:31744
s_waitcnt lgkmcnt(0)
v_and_b32 v23,1,v21
v_mov_b32 v1,0x4444
v_mov_b32 v24,0xeeee
v_cmp_eq_u32 vcc,1,v23
s_nop 1
v_cndmask_b32 v1,v1,v24,vcc
v_lshlrev_b32 v23,1,v22
v_sub_u32 v23,v21,v23
v_mov_b32 v5,0
v_mov_b32 v24,0x3f80
v_cmp_eq_u32 vcc,0,v23
s_nop 1
v_cndmask_b32 v5,v5,v24,vcc
v_mov_b32 v24,0x3f800000
v_cmp_eq_u32 vcc,1,v23
s_nop 1
v_cndmask_b32 v5,v5,v24,vcc
s_and_b32 s64,s50,1
s_lshl_b32 s64,s64,11
v_lshl_add_u32 v127,v20,2,s64
v_and_b32 v23,7,v21
v_lshrrev_b32 v24,3,v21
v_lshlrev_b32 v25,8,v24
v_lshl_add_u32 v25,v22,6,v25
v_lshl_add_u32 v4,v23,2,v25
v_lshrrev_b32 v25,1,v22
v_lshl_add_u32 v25,v25,3,v23
v_lshlrev_b32 v25,5,v25
v_and_b32 v26,1,v22
v_lshl_add_u32 v6,v26,4,v25
v_lshl_add_u32 v27,v22,3,v23
v_lshlrev_b32 v27,4,v27
s_mov_b32 s80,0x3e0293ee
s_mov_b32 s81,0xfffffffe
s_mov_b32 s84,0x00ff00ff
s_mov_b32 s85,0x00ff00ff
s_mov_b32 s86,-1
s_mov_b32 s87,0
s_cmp_gt_u32 s50,1
s_cselect_b32 s82,0xff00ff00,-1
s_cselect_b32 s83,0xff00ff00,0
s_lshl_b32 m0,s50,8
s_cmp_gt_u32 s50,1
s_cbranch_scc1 w23_100410
v_lshl_add_u32 v2,v24,9,v27
v_lshrrev_b32 v25,1,v22
v_lshl_add_u32 v25,v25,3,v23
v_lshlrev_b32 v25,4,v25
v_lshl_add_u32 v26,v26,1,v24
v_lshl_add_u32 v3,v26,2,v25
v_add_u32 v3,1024 + 256,v3
v_cndmask_b32 v6,2.0,v6,s[84:85]
v_mov_b32 v8,0x3f803f80
v_mov_b32 v9,0x3f803f80
v_mov_b32 v10,0x3f803f80
v_mov_b32 v11,0x3f803f80
v_mov_b32 v12,0x3f803f80
v_mov_b32 v13,0
v_mov_b32 v14,0
v_mov_b32 v15,0
s_branch jn_100411
w23_100410:
s_sub_u32 s64,s50,2
s_mul_i32 s64,s64,4160
v_lshrrev_b32 v25,1,v22
v_mul_u32_u24 v25,2080,v25
v_and_b32 v28,1,v23
v_mul_u32_u24 v28,1040,v28
v_add_u32 v25,v25,v28
v_lshrrev_b32 v28,1,v23
v_lshl_add_u32 v25,v28,6,v25
v_lshl_add_u32 v25,v26,5,v25
v_mul_u32_u24 v28,8448,v24
v_add3_u32 v2,v25,v28,s64
v_cndmask_b32 v3,2.0,v27,s[84:85]
v_mov_b32 v8,-1
v_mov_b32 v9,-1
v_mov_b32 v10,-1
v_mov_b32 v11,-1
jn_100411:
s_mov_b32 s92,s2
s_and_b32 s93,s3,0xffff
s_mov_b32 s94,0x100
s_mov_b32 s95,0x20000
v_mbcnt_lo_u32_b32 v16,-1,0
v_mbcnt_hi_u32_b32 v16,-1,v16
v_mov_b32 v18,0
v_cmp_eq_u32 vcc,22,v16
s_nop 1
v_cndmask_b32 v18,v18,63,vcc
v_cmp_eq_u32 vcc,21,v16
s_nop 1
v_cndmask_b32 v18,v18,1,vcc
v_and_b32 v19,1,v16
v_cmp_eq_u32 vcc,1,v19
v_mov_b32 v19,8192
s_nop 0
v_cndmask_b32 v19,-1,v19,vcc
v_min_u32 v16,31,v16
v_lshlrev_b32 v16,2,v16
s_sub_u32 s66,s88,64
s_cmp_lg_u32 s50,0
s_cbranch_scc1 vot_100418
vpoll_100414:
buffer_load_dword v17,v16,s[92:95],s66 offen sc1
s_waitcnt vmcnt(0)
s_cmp_lg_u32 s56,2
s_cbranch_scc1 vck_100415
v_cmp_eq_u32 vcc,v17,v19
s_and_b32 s64,vcc_lo,0xffff
s_cmp_eq_u32 s64,65535
s_cbranch_scc1 vck_100415
s_mov_b32 s65,0
v_readlane_b32 s64,v17,1
s_lshr_b32 s64,s64,8
s_add_u32 s65,s65,s64
v_readlane_b32 s64,v17,3
s_lshr_b32 s64,s64,8
s_add_u32 s65,s65,s64
v_readlane_b32 s64,v17,5
s_lshr_b32 s64,s64,8
s_add_u32 s65,s65,s64
v_readlane_b32 s64,v17,7
s_lshr_b32 s64,s64,8
s_add_u32 s65,s65,s64
v_readlane_b32 s64,v17,9
s_lshr_b32 s64,s64,8
s_add_u32 s65,s65,s64
v_readlane_b32 s64,v17,11
s_lshr_b32 s64,s64,8
s_add_u32 s65,s65,s64
v_readlane_b32 s64,v17,13
s_lshr_b32 s64,s64,8
s_add_u32 s65,s65,s64
v_readlane_b32 s64,v17,15
s_lshr_b32 s64,s64,8
s_add_u32 s65,s65,s64
s_cmp_ge_u32 s65,256
s_cbranch_scc1 vok_100417
s_branch vrt_100416
vck_100415:
v_cmp_gt_u32 vcc,v18,v17
s_cbranch_vccz vok_100417
vrt_100416:
s_sleep 8
s_sub_u32 s90,s90,1
s_cmp_gt_i32 s90,0
s_cbranch_scc1 vpoll_100414
vok_100417:
ds_write_b32 v16,v17 offset:1792
s_waitcnt lgkmcnt(0)
vot_100418:
s_barrier
v_add_u32 v18,1792,v16
ds_read_b32 v17,v18
s_waitcnt lgkmcnt(0)
s_cmp_lg_u32 s56,2
s_cbranch_scc1 vfin_100419
v_cmp_eq_u32 vcc,v17,v19
s_and_b32 s64,vcc_lo,0xffff
s_cmp_eq_u32 s64,65535
s_cbranch_scc1 vfin_100419
s_mov_b32 s65,0
v_readlane_b32 s64,v17,1
s_lshr_b32 s64,s64,8
s_add_u32 s65,s65,s64
v_readlane_b32 s64,v17,3
s_lshr_b32 s64,s64,8
s_add_u32 s65,s65,s64
v_readlane_b32 s64,v17,5
s_lshr_b32 s64,s64,8
s_add_u32 s65,s65,s64
v_readlane_b32 s64,v17,7
s_lshr_b32 s64,s64,8
s_add_u32 s65,s65,s64
v_readlane_b32 s64,v17,9
s_lshr_b32 s64,s64,8
s_add_u32 s65,s65,s64
v_readlane_b32 s64,v17,11
s_lshr_b32 s64,s64,8
s_add_u32 s65,s65,s64
v_readlane_b32 s64,v17,13
s_lshr_b32 s64,s64,8
s_add_u32 s65,s65,s64
v_readlane_b32 s64,v17,15
s_lshr_b32 s64,s64,8
s_add_u32 s65,s65,s64
s_cmp_ge_u32 s65,256
s_cbranch_scc1 fl_fb
vfin_100419:
s_and_b32 s56,s56,1
s_mov_b32 s67,0
v_readlane_b32 s65,v17,21
s_and_b32 s65,s65,2
s_lshl_b32 s67,s65,12
s_lshl_b32 s64,s58,14
s_lshl_b32 s65,s50,12
s_add_u32 s70,s64,s65
s_add_u32 s70,s70,134217728
s_lshl_b32 s65,s59,9
s_add_u32 s71,s64,s65
s_add_u32 s71,s71,134217728
s_xor_b32 s64,s58,1
s_lshl_b32 s64,s64,15
s_lshr_b32 s65,s50,1
s_lshl_b32 s65,s65,14
s_add_u32 s64,s64,s65
s_and_b32 s65,s50,1
s_lshl_b32 s65,s65,12
s_add_u32 s64,s64,s65
s_add_u32 s72,s64,s67
s_add_u32 s72,s72,142606336
s_lshl_b32 s64,s58,15
s_lshr_b32 s65,s59,4
s_lshl_b32 s65,s65,14
s_add_u32 s64,s64,s65
s_and_b32 s65,s59,15
s_lshl_b32 s65,s65,9
s_add_u32 s64,s64,s65
s_add_u32 s73,s64,s67
s_add_u32 s73,s73,142606336
s_cmp_eq_u32 s50,1
s_cselect_b32 s54,2048 - 256,0
s_sub_u32 s71,s71,s54
s_lshl_b32 s64,s58,15
s_lshl_b32 s65,s50,13
s_add_u32 s74,s64,s65
s_add_u32 s74,s74,134250496
s_lshl_b32 s64,s57,10
s_and_b32 s65,s50,1
s_lshl_b32 s65,s65,9
s_cmp_gt_u32 s50,1
s_cselect_b32 s65,0,s65
s_add_u32 s75,s64,s65
s_add_u32 s75,s75,134250496
s_lshl_b32 s64,s57,12
s_and_b32 s65,s64,0xffffe000
s_cmp_eq_u32 s50,3
s_cselect_b32 s66,1536,0
s_add_u32 s64,s64,s66
s_cmp_gt_u32 s50,1
s_cselect_b32 s76,s64,s65
s_add_u32 s76,s76,134479872
s_lshl_b32 s64,s57,14
s_and_b32 s65,s50,1
s_lshl_b32 s66,s65,11
s_add_u32 s77,s64,s66
s_cmp_gt_u32 s50,1
s_cselect_b32 s66,0,4096
s_add_u32 s77,s77,s66
s_add_u32 s77,s77,0
s_lshl_b32 s66,s65,9
s_add_u32 s66,s66,1024 + 128
s_lshl_b32 s65,s65,7
s_cmp_gt_u32 s50,1
s_cselect_b32 s65,s65,s66
s_add_u32 s78,s64,s65
s_add_u32 s78,s78,67108736
s_lshl_b32 s64,s57,6
s_add_u32 s68,s64,s67
s_add_u32 s69,s68,s64
s_add_u32 s69,s69,138428416
s_lshl_b32 s64,s50,14
s_add_u32 s69,s69,s64
s_and_b32 s64,s50,1
s_lshl_b32 s64,s64,11
s_sub_u32 s69,s69,s64
s_add_u32 s68,s68,138412032
s_mov_b32 s79,0
s_mov_b32 s91,0
s_mov_b32 s90,100000
s_barrier
s_cmp_eq_u32 s56,1
s_cbranch_scc1 recslow_100412
s_mov_b32 s55,0
s_cmp_lg_u32 s50,0
s_cbranch_scc1 np0_100422
v_mov_b32 v120,0
v_mov_b32 v121,0
s_cmp_lg_u32 s58,0
s_cbranch_scc1 z1_100423
v_lshrrev_b32 v124,6,v127
v_lshlrev_b32 v124,12,v124
v_bfe_u32 v125,v127,1,5
v_add_u32 v124,v124,v125
s_lshl_b32 s64,s59,6
buffer_load_ushort v120,v124,s[44:47],s64 offen
buffer_load_ushort v122,v124,s[44:47],s64 offen offset:32
buffer_load_ushort v121,v124,s[44:47],s64 offen offset:2048
buffer_load_ushort v123,v124,s[44:47],s64 offen offset:2080
s_waitcnt vmcnt(0)
v_lshl_or_b32 v120,v122,16,v120
v_lshl_or_b32 v121,v123,16,v121
v_min_u32 v120,s81,v120
v_min_u32 v121,s81,v121
z1_100423:
buffer_store_dword v120,v4,s[20:23],s71 offen
buffer_store_dword v121,v4,s[20:23],s71 offen offset:32
buffer_store_dword v120,v4,s[20:23],s73 offen sc1
buffer_store_dword v121,v4,s[20:23],s73 offen offset:32 sc1
np0_100422:
v_lshrrev_b32 v124,2,v0
v_bfe_u32 v125,v124,5,1
v_mul_u32_u24 v125,2048,v125
s_and_b32 s64,s50,1
s_lshl_b32 s64,s64,5
v_add3_u32 v4,v124,v125,s64
s_add_u32 s64,s79,0
s_cmp_gt_u32 s91,s64
s_cbranch_scc0 flp_100426
fok_100425:
s_add_u32 s64,s79,0
s_lshl_b32 s65,s64,12
s_and_b32 s65,s65,0x2000
s_xor_b32 s65,s65,s67
s_lshl_b32 s64,s64,20
s_add_u32 s65,s65,s64
s_add_u32 s99,s65,s77
buffer_load_dwordx4 v[104:107],v0,s[20:23],s99 offen
buffer_load_dwordx4 v[108:111],v0,s[20:23],s99 offen offset:1024
s_waitcnt vmcnt(0)
s_mov_b32 s92,s70
s_mov_b32 s93,s72
s_mov_b32 s94,s76
s_add_u32 s95,s94,4096
s_mov_b32 s96,s74
s_add_u32 s97,s96,4096
s_mov_b32 s98,s75
s_barrier
v_mov_b32 v96,v104
v_mov_b32 v97,v105
v_mov_b32 v98,v106
v_mov_b32 v99,v107
v_mov_b32 v100,v108
v_mov_b32 v101,v109
v_mov_b32 v102,v110
v_mov_b32 v103,v111
v_mov_b32 v48,0
v_mov_b32 v49,0
v_mov_b32 v50,0
v_mov_b32 v51,0
v_mov_b32 v52,0
v_mov_b32 v53,0
v_mov_b32 v54,0
v_mov_b32 v55,0
v_mov_b32 v56,0
v_mov_b32 v57,0
v_mov_b32 v58,0
v_mov_b32 v59,0
v_mov_b32 v60,0
v_mov_b32 v61,0
v_mov_b32 v62,0
v_mov_b32 v63,0
v_mov_b32 v64,0
v_mov_b32 v65,0
v_mov_b32 v66,0
v_mov_b32 v67,0
v_mov_b32 v68,0
v_mov_b32 v69,0
v_mov_b32 v70,0
v_mov_b32 v71,0
v_mov_b32 v72,0
v_mov_b32 v73,0
v_mov_b32 v74,0
v_mov_b32 v75,0
v_mov_b32 v76,0
v_mov_b32 v77,0
v_mov_b32 v78,0
v_mov_b32 v79,0
v_mov_b32 v80,0
v_mov_b32 v81,0
v_mov_b32 v82,0
v_mov_b32 v83,0
v_mov_b32 v84,0
v_mov_b32 v85,0
v_mov_b32 v86,0
v_mov_b32 v87,0
v_mov_b32 v88,0
v_mov_b32 v89,0
v_mov_b32 v90,0
v_mov_b32 v91,0
v_mov_b32 v92,0
v_mov_b32 v93,0
v_mov_b32 v94,0
v_mov_b32 v95,0
s_cmp_gt_u32 s50,1
s_cbranch_scc0 loop0_100424x
.p2align 6
s_nop 0
s_nop 0
s_nop 0
s_nop 0
s_nop 0
s_nop 0
s_nop 0
loop_100420:
v_mov_b32 v125,0
s_nop 1
v_mfma_f32_16x16x1_4b_f32 v[48:63],v125,v125,0
v_mfma_f32_16x16x1_4b_f32 v[64:79],v125,v125,0
v_mfma_f32_16x16x1_4b_f32 v[80:95],v125,v125,0
s_max_u32 s66,s79,1
s_sub_u32 s66,s66,1
v_cndmask_b32 v126,2.0,v0,s[82:83]
s_add_u32 s64,s66,0
s_lshl_b32 s65,s64,12
s_and_b32 s65,s65,0x2000
s_xor_b32 s65,s65,s67
s_lshl_b32 s64,s64,20
s_add_u32 s65,s65,s64
s_add_u32 s101,s65,s78
buffer_store_dwordx4 v[112:115],v126,s[20:23],s101 offen sc1
s_nop 15
s_nop 15
s_nop 15
s_nop 7
buffer_load_dwordx4 v[16:19],v0,s[20:23],s92 offen offset:0 sc1
s_nop 7
buffer_load_dwordx4 v[20:23],v0,s[20:23],s92 offen offset:1024 sc1
s_nop 7
buffer_load_dwordx4 v[24:27],v0,s[20:23],s92 offen offset:2048 sc1
s_nop 7
buffer_load_dwordx4 v[28:31],v0,s[20:23],s92 offen offset:3072 sc1
v_mov_b32 v96,v104
v_mov_b32 v97,v105
v_mov_b32 v98,v106
v_mov_b32 v99,v107
v_mov_b32 v100,v108
v_mov_b32 v101,v109
v_mov_b32 v102,v110
v_mov_b32 v103,v111
s_branch ja_100427
loop0_100424x:
v_mov_b32 v125,0
s_nop 1
v_mfma_f32_16x16x1_4b_f32 v[48:63],v125,v125,0
v_mfma_f32_16x16x1_4b_f32 v[64:79],v125,v125,0
v_mfma_f32_16x16x1_4b_f32 v[80:95],v125,v125,0
s_max_u32 s66,s79,1
s_sub_u32 s66,s66,1
v_cndmask_b32 v126,2.0,v0,s[82:83]
s_add_u32 s64,s66,0
s_lshl_b32 s65,s64,12
s_and_b32 s65,s65,0x2000
s_xor_b32 s65,s65,s67
s_lshl_b32 s64,s64,20
s_add_u32 s65,s65,s64
s_add_u32 s101,s65,s78
buffer_store_dwordx4 v[112:115],v126,s[20:23],s101 offen sc1
s_nop 15
s_nop 3
buffer_load_dwordx4 v[16:19],v0,s[20:23],s92 offen offset:0 sc1
s_nop 7
buffer_load_dwordx4 v[20:23],v0,s[20:23],s92 offen offset:1024 sc1
s_nop 7
buffer_load_dwordx4 v[24:27],v0,s[20:23],s92 offen offset:2048 sc1
s_nop 7
buffer_load_dwordx4 v[28:31],v0,s[20:23],s92 offen offset:3072 sc1
ja_100427:
v_mov_b32 v126,s79
s_cmp_eq_u32 s79,63
s_cbranch_scc1 last_100421
s_add_u32 s64,s79,1
s_lshl_b32 s65,s64,12
s_and_b32 s65,s65,0x2000
s_xor_b32 s65,s65,s67
s_lshl_b32 s64,s64,20
s_add_u32 s65,s65,s64
s_add_u32 s99,s65,s77
s_waitcnt vmcnt(3)
v_max3_u32 v124,v16,v17,v18
v_max_u32 v124,v124,v19
v_cmp_eq_u32 vcc,-1,v124
v_cndmask_b32 v121,2.0,v127,s[86:87]
s_cbranch_vccnz flb_100454
seg_100430:
segb_100438:
v_smfmac_f32_16x16x64_bf16 v[48:51],v[16:19],a[0:7],v1
buffer_load_dword v125,off,s[20:23],s92 sc1
v_smfmac_f32_16x16x64_bf16 v[52:55],v[16:19],a[8:15],v1
buffer_load_dwordx4 v[32:35],v0,s[20:23],s93 offen offset:0 sc1
v_smfmac_f32_16x16x64_bf16 v[56:59],v[16:19],a[16:23],v1
s_waitcnt vmcnt(4)
v_max3_u32 v124,v20,v21,v22
v_smfmac_f32_16x16x64_bf16 v[60:63],v[16:19],a[24:31],v1
v_max_u32 v124,v124,v23
v_smfmac_f32_16x16x64_bf16 v[64:67],v[16:19],a[32:39],v1
v_cmp_eq_u32 vcc,-1,v124
v_smfmac_f32_16x16x64_bf16 v[68:71],v[16:19],a[40:47],v1
v_smfmac_f32_16x16x64_bf16 v[72:75],v[16:19],a[48:55],v1
s_cbranch_vccnz fl_100447
seg_100431:
v_smfmac_f32_16x16x64_bf16 v[76:79],v[16:19],a[56:63],v1
segb_100439:
v_smfmac_f32_16x16x64_bf16 v[48:51],v[20:23],a[64:71],v1
buffer_load_dword v125,off,s[20:23],s92 sc1
v_smfmac_f32_16x16x64_bf16 v[52:55],v[20:23],a[72:79],v1
buffer_load_dwordx4 v[36:39],v0,s[20:23],s93 offen offset:1024 sc1
v_smfmac_f32_16x16x64_bf16 v[56:59],v[20:23],a[80:87],v1
s_waitcnt vmcnt(5)
v_max3_u32 v124,v24,v25,v26
v_smfmac_f32_16x16x64_bf16 v[60:63],v[20:23],a[88:95],v1
v_max_u32 v124,v124,v27
v_smfmac_f32_16x16x64_bf16 v[64:67],v[20:23],a[96:103],v1
v_cmp_eq_u32 vcc,-1,v124
v_smfmac_f32_16x16x64_bf16 v[68:71],v[20:23],a[104:111],v1
v_smfmac_f32_16x16x64_bf16 v[72:75],v[20:23],a[112:119],v1
s_cbranch_vccnz fl_100448
seg_100432:
v_smfmac_f32_16x16x64_bf16 v[76:79],v[20:23],a[120:127],v1
segb_100440:
v_smfmac_f32_16x16x64_bf16 v[48:51],v[24:27],a[128:135],v1
buffer_load_dword v125,off,s[20:23],s92 sc1
v_smfmac_f32_16x16x64_bf16 v[52:55],v[24:27],a[136:143],v1
buffer_load_dwordx4 v[40:43],v0,s[20:23],s93 offen offset:2048 sc1
v_smfmac_f32_16x16x64_bf16 v[56:59],v[24:27],a[144:151],v1
buffer_load_dwordx4 v[44:47],v0,s[20:23],s93 offen offset:3072 sc1
s_waitcnt vmcnt(7)
v_max3_u32 v124,v28,v29,v30
v_smfmac_f32_16x16x64_bf16 v[60:63],v[24:27],a[152:159],v1
v_max_u32 v124,v124,v31
v_smfmac_f32_16x16x64_bf16 v[64:67],v[24:27],a[160:167],v1
v_cmp_eq_u32 vcc,-1,v124
v_smfmac_f32_16x16x64_bf16 v[68:71],v[24:27],a[168:175],v1
v_smfmac_f32_16x16x64_bf16 v[72:75],v[24:27],a[176:183],v1
s_cbranch_vccnz fl_100449
seg_100433:
v_smfmac_f32_16x16x64_bf16 v[76:79],v[24:27],a[184:191],v1
segb_100441:
v_smfmac_f32_16x16x64_bf16 v[48:51],v[28:31],a[192:199],v1
buffer_load_dword v125,off,s[20:23],s92 sc1
v_smfmac_f32_16x16x64_bf16 v[52:55],v[28:31],a[200:207],v1
buffer_store_dword v126,v121,s[20:23],s69 offen sc1
v_smfmac_f32_16x16x64_bf16 v[56:59],v[28:31],a[208:215],v1
s_waitcnt vmcnt(7)
v_max3_u32 v124,v32,v33,v34
v_smfmac_f32_16x16x64_bf16 v[60:63],v[28:31],a[216:223],v1
v_max_u32 v124,v124,v35
v_smfmac_f32_16x16x64_bf16 v[64:67],v[28:31],a[224:231],v1
v_cmp_eq_u32 vcc,-1,v124
v_smfmac_f32_16x16x64_bf16 v[68:71],v[28:31],a[232:239],v1
v_smfmac_f32_16x16x64_bf16 v[72:75],v[28:31],a[240:247],v1
s_cbranch_vccnz fl_100450
seg_100434:
v_smfmac_f32_16x16x64_bf16 v[76:79],v[28:31],a[248:255],v1
segb_100442:
v_smfmac_f32_16x16x64_bf16 v[48:51],v[32:35],a[0:7],v1
buffer_load_dword v125,off,s[20:23],s92 sc1
v_smfmac_f32_16x16x64_bf16 v[52:55],v[32:35],a[8:15],v1
v_smfmac_f32_16x16x64_bf16 v[56:59],v[32:35],a[16:23],v1
s_waitcnt vmcnt(6)
v_max3_u32 v124,v36,v37,v38
v_smfmac_f32_16x16x64_bf16 v[60:63],v[32:35],a[24:31],v1
v_max_u32 v124,v124,v39
v_smfmac_f32_16x16x64_bf16 v[64:67],v[32:35],a[32:39],v1
v_cmp_eq_u32 vcc,-1,v124
v_smfmac_f32_16x16x64_bf16 v[68:71],v[32:35],a[40:47],v1
v_smfmac_f32_16x16x64_bf16 v[72:75],v[32:35],a[48:55],v1
s_cbranch_vccnz fl_100451
seg_100435:
v_smfmac_f32_16x16x64_bf16 v[76:79],v[32:35],a[56:63],v1
segb_100443:
v_smfmac_f32_16x16x64_bf16 v[48:51],v[36:39],a[64:71],v1
buffer_load_dword v125,off,s[20:23],s92 sc1
s_waitcnt vmcnt(4)
v_max3_u32 v124,v40,v41,v42
v_smfmac_f32_16x16x64_bf16 v[52:55],v[36:39],a[72:79],v1
v_max3_u32 v124,v124,v43,v44
v_smfmac_f32_16x16x64_bf16 v[56:59],v[36:39],a[80:87],v1
v_max3_u32 v124,v124,v45,v46
v_smfmac_f32_16x16x64_bf16 v[60:63],v[36:39],a[88:95],v1
v_max_u32 v124,v124,v47
v_smfmac_f32_16x16x64_bf16 v[64:67],v[36:39],a[96:103],v1
v_cmp_eq_u32 vcc,-1,v124
v_smfmac_f32_16x16x64_bf16 v[68:71],v[36:39],a[104:111],v1
v_smfmac_f32_16x16x64_bf16 v[72:75],v[36:39],a[112:119],v1
s_cbranch_vccnz fl_100452
seg_100436:
v_smfmac_f32_16x16x64_bf16 v[76:79],v[36:39],a[120:127],v1
segb_100444:
v_smfmac_f32_16x16x64_bf16 v[48:51],v[40:43],a[128:135],v1
s_add_u32 s64,s79,1
s_cmp_gt_u32 s91,s64
s_cbranch_scc0 flp_100429
fok_100428:
v_smfmac_f32_16x16x64_bf16 v[52:55],v[40:43],a[136:143],v1
buffer_load_dwordx4 v[104:107],v0,s[20:23],s99 offen
buffer_load_dwordx4 v[108:111],v0,s[20:23],s99 offen offset:1024
v_smfmac_f32_16x16x64_bf16 v[48:51],v[44:47],a[192:199],v1
buffer_load_dword v126,off,s[20:23],s68 sc1
s_add_u32 s64,s79,2
v_smfmac_f32_16x16x64_bf16 v[52:55],v[44:47],a[200:207],v1
s_and_b32 s64,s64,3
s_lshl_b32 s100,s64,19
s_nop 0
v_add_f32 v48,v48,v49
v_smfmac_f32_16x16x64_bf16 v[56:59],v[40:43],a[144:151],v1
ds_write_addtid_b32 v48 offset:0
v_add_f32 v50,v50,v51
v_smfmac_f32_16x16x64_bf16 v[60:63],v[40:43],a[152:159],v1
ds_write_addtid_b32 v50 offset:1040
v_add_f32 v52,v52,v53
v_smfmac_f32_16x16x64_bf16 v[56:59],v[44:47],a[208:215],v1
ds_write_addtid_b32 v52 offset:2080
v_add_f32 v54,v54,v55
v_smfmac_f32_16x16x64_bf16 v[60:63],v[44:47],a[216:223],v1
ds_write_addtid_b32 v54 offset:3120
s_nop 1
v_add_f32 v56,v56,v57
v_smfmac_f32_16x16x64_bf16 v[64:67],v[40:43],a[160:167],v1
ds_write_addtid_b32 v56 offset:4160
v_add_f32 v58,v58,v59
v_smfmac_f32_16x16x64_bf16 v[68:71],v[40:43],a[168:175],v1
ds_write_addtid_b32 v58 offset:5200
v_add_f32 v60,v60,v61
v_smfmac_f32_16x16x64_bf16 v[64:67],v[44:47],a[224:231],v1
ds_write_addtid_b32 v60 offset:6240
v_add_f32 v62,v62,v63
v_smfmac_f32_16x16x64_bf16 v[68:71],v[44:47],a[232:239],v1
ds_write_addtid_b32 v62 offset:7280
s_nop 1
v_add_f32 v64,v64,v65
v_smfmac_f32_16x16x64_bf16 v[72:75],v[40:43],a[176:183],v1
ds_write_addtid_b32 v64 offset:8448
v_add_f32 v66,v66,v67
v_smfmac_f32_16x16x64_bf16 v[76:79],v[40:43],a[184:191],v1
ds_write_addtid_b32 v66 offset:9488
v_add_f32 v68,v68,v69
v_smfmac_f32_16x16x64_bf16 v[72:75],v[44:47],a[240:247],v1
ds_write_addtid_b32 v68 offset:10528
v_add_f32 v70,v70,v71
v_smfmac_f32_16x16x64_bf16 v[76:79],v[44:47],a[248:255],v1
ds_write_addtid_b32 v70 offset:11568
s_nop 1
v_add_f32 v72,v72,v73
v_smfmac_f32_16x16x64_bf16 v[80:83],v[16:19],v[208:215],v1
ds_write_addtid_b32 v72 offset:12608
v_add_f32 v74,v74,v75
v_smfmac_f32_16x16x64_bf16 v[80:83],v[32:35],v[208:215],v1
ds_write_addtid_b32 v74 offset:13648
v_add_f32 v76,v76,v77
ds_write_addtid_b32 v76 offset:14688
v_add_f32 v78,v78,v79
ds_write_addtid_b32 v78 offset:15728
doneA_100463:
s_waitcnt lgkmcnt(0)
s_barrier
s_cmp_gt_u32 s50,1
s_cbranch_scc1 w23_100464
v_smfmac_f32_16x16x64_bf16 v[84:87],v[16:19],v[216:223],v1
v_smfmac_f32_16x16x64_bf16 v[84:87],v[32:35],v[216:223],v1
v_smfmac_f32_16x16x64_bf16 v[88:91],v[16:19],v[224:231],v1
v_smfmac_f32_16x16x64_bf16 v[88:91],v[32:35],v[224:231],v1
v_smfmac_f32_16x16x64_bf16 v[92:95],v[16:19],v[232:239],v1
ds_read_b128 v[48:51],v7 offset:0
ds_read_b128 v[52:55],v7 offset:1024
v_smfmac_f32_16x16x64_bf16 v[92:95],v[32:35],v[232:239],v1
ds_read_b128 v[56:59],v7 offset:2048
ds_read_b128 v[60:63],v7 offset:3072
v_smfmac_f32_16x16x64_bf16 v[80:83],v[20:23],v[240:247],v1
ds_read_b128 v[64:67],v7 offset:4096
ds_read_b128 v[68:71],v7 offset:5120
v_smfmac_f32_16x16x64_bf16 v[80:83],v[36:39],v[240:247],v1
ds_read_b128 v[72:75],v7 offset:6144
ds_read_b128 v[76:79],v7 offset:7168
v_smfmac_f32_16x16x64_bf16 v[84:87],v[20:23],v[248:255],v1
v_smfmac_f32_16x16x64_bf16 v[84:87],v[36:39],v[248:255],v1
s_waitcnt lgkmcnt(6)
v_smfmac_f32_16x16x64_bf16 v[88:91],v[20:23],v[48:55],v1
v_smfmac_f32_16x16x64_bf16 v[88:91],v[36:39],v[48:55],v1
ds_read_b128 v[48:51],v7 offset:8192
ds_read_b128 v[52:55],v7 offset:9216
s_waitcnt lgkmcnt(6)
v_smfmac_f32_16x16x64_bf16 v[92:95],v[20:23],v[56:63],v1
v_smfmac_f32_16x16x64_bf16 v[92:95],v[36:39],v[56:63],v1
ds_read_b128 v[56:59],v7 offset:10240
ds_read_b128 v[60:63],v7 offset:11264
s_waitcnt lgkmcnt(6)
v_smfmac_f32_16x16x64_bf16 v[80:83],v[24:27],v[64:71],v1
v_smfmac_f32_16x16x64_bf16 v[80:83],v[40:43],v[64:71],v1
ds_read_b128 v[64:67],v7 offset:12288
ds_read_b128 v[68:71],v7 offset:13312
s_waitcnt lgkmcnt(6)
v_smfmac_f32_16x16x64_bf16 v[84:87],v[24:27],v[72:79],v1
v_smfmac_f32_16x16x64_bf16 v[84:87],v[40:43],v[72:79],v1
ds_read_b128 v[72:75],v7 offset:14336
ds_read_b128 v[76:79],v7 offset:15360
s_waitcnt lgkmcnt(6)
v_smfmac_f32_16x16x64_bf16 v[88:91],v[24:27],v[48:55],v1
v_smfmac_f32_16x16x64_bf16 v[88:91],v[40:43],v[48:55],v1
ds_read_b128 v[48:51],v7 offset:16384
ds_read_b128 v[52:55],v7 offset:17408
s_waitcnt lgkmcnt(6)
v_smfmac_f32_16x16x64_bf16 v[92:95],v[24:27],v[56:63],v1
v_smfmac_f32_16x16x64_bf16 v[92:95],v[40:43],v[56:63],v1
ds_read_b128 v[56:59],v7 offset:18432
ds_read_b128 v[60:63],v7 offset:19456
s_waitcnt lgkmcnt(6)
v_smfmac_f32_16x16x64_bf16 v[80:83],v[28:31],v[64:71],v1
v_smfmac_f32_16x16x64_bf16 v[80:83],v[44:47],v[64:71],v1
s_waitcnt lgkmcnt(4)
v_smfmac_f32_16x16x64_bf16 v[84:87],v[28:31],v[72:79],v1
v_smfmac_f32_16x16x64_bf16 v[84:87],v[44:47],v[72:79],v1
s_waitcnt lgkmcnt(2)
v_smfmac_f32_16x16x64_bf16 v[88:91],v[28:31],v[48:55],v1
v_add_f32 v80,v80,v81
v_smfmac_f32_16x16x64_bf16 v[88:91],v[44:47],v[48:55],v1
v_add_f32 v82,v82,v83
s_waitcnt lgkmcnt(0)
v_smfmac_f32_16x16x64_bf16 v[92:95],v[28:31],v[56:63],v1
v_cvt_pk_bf16_f32 v80,v80,v82
v_smfmac_f32_16x16x64_bf16 v[92:95],v[44:47],v[56:63],v1
buffer_load_dwordx4 v[16:19],v2,s[20:23],s94 offen offset:0 sc1
ds_write_addtid_b32 v80 offset:16896
v_add_f32 v84,v84,v85
buffer_load_dwordx4 v[32:35],v2,s[20:23],s94 offen offset:1536 sc1
buffer_load_dwordx4 v[20:23],v2,s[20:23],s95 offen offset:0 sc1
buffer_load_dwordx4 v[36:39],v2,s[20:23],s95 offen offset:1536 sc1
buffer_load_dword v120,v3,s[20:23],s94 offen offset:0 sc1
buffer_load_dword v121,v3,s[20:23],s94 offen offset:1536 sc1
buffer_load_dword v122,v3,s[20:23],s95 offen offset:0 sc1
buffer_load_dword v123,v3,s[20:23],s95 offen offset:1536 sc1
v_add_f32 v86,v86,v87
v_cvt_pk_bf16_f32 v84,v84,v86
v_add_f32 v88,v88,v89
v_add_f32 v90,v90,v91
v_cvt_pk_bf16_f32 v88,v88,v90
v_add_f32 v92,v92,v93
v_add_f32 v94,v94,v95
v_cvt_pk_bf16_f32 v92,v92,v94
ds_write_addtid_b32 v84 offset:17920
ds_write_addtid_b32 v88 offset:18944
ds_write_addtid_b32 v92 offset:19968
sp_100468:
s_waitcnt vmcnt(6)
v_pk_add_f32 v[16:17],v[16:17],v[32:33]
v_pk_add_f32 v[18:19],v[18:19],v[34:35]
s_waitcnt vmcnt(4)
v_pk_add_f32 v[20:21],v[20:21],v[36:37]
v_pk_add_f32 v[22:23],v[22:23],v[38:39]
v_pk_add_f32 v[16:17],v[16:17],v[20:21]
v_pk_add_f32 v[18:19],v[18:19],v[22:23]
v_max3_f32 v124,v16,v17,v18
v_pk_add_f32 v[20:21],v[16:17],v[18:19]
s_waitcnt vmcnt(0)
v_pk_add_f32 v[120:121],v[120:121],v[122:123]
v_add_f32 v120,v120,v121
v_max3_f32 v124,v124,v19,v120
v_add_f32 v20,v20,v120
v_cmp_u_f32 vcc,v20,v21
v_max_f32_dpp v124,v124,v124 row_ror:8 row_mask:0xf bank_mask:0xf
v_mov_b32 v125,v124
s_cbranch_vccnz srt_100470
sok_100469:
s_nop 0
v_permlane16_swap_b32 v125,v124
v_max_f32 v124,v124,v125
v_mov_b32 v125,v124
s_nop 1
v_permlane32_swap_b32 v125,v124
v_max_f32 v124,v124,v125
v_mul_f32 v124,s80,v124
v_fma_f32 v16,v16,s80,-v124
v_fma_f32 v17,v17,s80,-v124
v_fma_f32 v18,v18,s80,-v124
v_fma_f32 v19,v19,s80,-v124
v_fma_f32 v120,v120,s80,-v124
s_waitcnt lgkmcnt(0)
s_barrier
ds_read2st64_b32 v[112:113],v127 offset0:66 offset1:67
ds_read2st64_b32 v[114:115],v127 offset0:68 offset1:69
ds_read2st64_b32 v[116:117],v127 offset0:70 offset1:71
ds_read2st64_b32 v[118:119],v127 offset0:72 offset1:73
v_exp_f32 v16,v16
v_exp_f32 v17,v17
v_exp_f32 v18,v18
v_exp_f32 v19,v19
v_cvt_pk_bf16_f32 v48,v16,v17
v_cvt_pk_bf16_f32 v49,v18,v19
v_exp_f32 v120,v120
v_mov_b32_dpp v50,v48 row_ror:8 row_mask:0xf bank_mask:0xf
v_mov_b32_dpp v51,v49 row_ror:8 row_mask:0xf bank_mask:0xf
v_mov_b32_dpp v121,v120 row_ror:8 row_mask:0xf bank_mask:0xf
v_cvt_pk_bf16_f32 v52,v120,v121
v_mfma_f32_16x16x32_bf16 v[64:67],v[8:11],v[48:51],0
v_mov_b32 v53,v52
v_mfma_f32_16x16x32_bf16 v[56:59],v[96:99],v[48:51],0
v_mov_b32 v54,v52
v_mov_b32 v55,v52
v_mfma_f32_16x16x32_bf16 v[60:63],v[100:103],v[48:51],0
v_mfma_f32_16x16x32_bf16 v[64:67],v[12:15],v[52:55],v[64:67]
s_waitcnt lgkmcnt(0)
v_mfma_f32_16x16x32_bf16 v[56:59],v[112:115],v[52:55],v[56:59]
v_mfma_f32_16x16x32_bf16 v[60:63],v[116:119],v[52:55],v[60:63]
s_nop 0
v_rcp_f32 v66,v64
s_nop 2
v_pk_mul_f32 v[56:57],v[56:57],v[66:67] op_sel_hi:[1,0]
v_pk_mul_f32 v[58:59],v[58:59],v[66:67] op_sel_hi:[1,0]
s_nop 0
v_pk_mul_f32 v[60:61],v[60:61],v[66:67] op_sel_hi:[1,0]
v_pk_mul_f32 v[62:63],v[62:63],v[66:67] op_sel_hi:[1,0]
v_cvt_pk_bf16_f32 v120,v56,v57
v_cvt_pk_bf16_f32 v121,v58,v59
v_cvt_pk_bf16_f32 v122,v60,v61
v_cvt_pk_bf16_f32 v123,v62,v63
buffer_store_dwordx4 v[120:123],v6,s[20:23],s98 offen
s_barrier
ds_read_b128 v[48:51],v7 offset:20480
ds_read_b128 v[52:55],v7 offset:21504
ds_read_b128 v[56:59],v7 offset:22528
ds_read_b128 v[60:63],v7 offset:23552
ds_read_b128 v[64:67],v7 offset:24576
ds_read_b128 v[68:71],v7 offset:25600
ds_read_b128 v[72:75],v7 offset:26624
ds_read_b128 v[76:79],v7 offset:27648
ds_read_b128 v[80:83],v7 offset:28672
ds_read_b128 v[84:87],v7 offset:29696
ds_read_b128 v[88:91],v7 offset:30720
ds_read_b128 v[92:95],v7 offset:31744
v_mov_b32 v96,0
v_mov_b32 v97,0
v_mov_b32 v98,0
v_mov_b32 v99,0
v_mov_b32 v100,0
v_mov_b32 v101,0
v_mov_b32 v102,0
v_mov_b32 v103,0
s_nop 11
buffer_load_dwordx4 v[16:19],v0,s[20:23],s96 offen offset:0 sc1
v_mov_b32 v120,v5
v_mov_b32 v121,v5
v_mov_b32 v122,v5
v_mov_b32 v123,v5
s_nop 1
v_mfma_f32_16x16x32_bf16 v[112:115],v[120:123],v[112:115],0
buffer_load_dwordx4 v[20:23],v0,s[20:23],s96 offen offset:1024 sc1
v_mfma_f32_16x16x32_bf16 v[116:119],v[120:123],v[116:119],0
s_add_u32 s79,s79,1
s_and_b32 s64,s79,3
s_lshl_b32 s64,s64,19
s_lshl_b32 s65,s79,8
buffer_load_dwordx4 v[24:27],v0,s[20:23],s96 offen offset:2048 sc1
s_and_b32 s65,s65,0x2000
s_lshl_b32 s66,s79,16
s_xor_b32 s88,s73,s65
s_add_u32 s88,s88,s66
s_sub_u32 s88,s88,s54
s_add_u32 s89,s71,s64
s_add_u32 s92,s70,s64
s_xor_b32 s93,s72,s65
buffer_load_dwordx4 v[28:31],v0,s[20:23],s96 offen offset:3072 sc1
s_add_u32 s93,s93,s66
s_add_u32 s94,s76,s64
s_add_u32 s95,s94,4096
s_add_u32 s98,s75,s64
s_add_u32 s60,s74,s64
v_cvt_pk_bf16_f32 v112,v112,v113
v_cvt_pk_bf16_f32 v113,v114,v115
v_cvt_pk_bf16_f32 v114,v116,v117
buffer_load_dwordx4 v[32:35],v0,s[20:23],s97 offen offset:0 sc1
v_cvt_pk_bf16_f32 v115,v118,v119
s_nop 6
buffer_load_dwordx4 v[36:39],v0,s[20:23],s97 offen offset:1024 sc1
s_nop 7
buffer_load_dwordx4 v[40:43],v0,s[20:23],s97 offen offset:2048 sc1
s_nop 7
buffer_load_dwordx4 v[44:47],v0,s[20:23],s97 offen offset:3072 sc1
s_branch ogo_100465
w23_100464:
ds_read_b128 v[48:51],v2 offset:0
ds_read_b128 v[52:55],v2 offset:256
ds_read_b128 v[56:59],v2 offset:512
ds_read_b128 v[60:63],v2 offset:768
ds_read_b128 v[64:67],v2 offset:16
ds_read_b128 v[68:71],v2 offset:272
ds_read_b128 v[72:75],v2 offset:528
ds_read_b128 v[76:79],v2 offset:784
s_waitcnt lgkmcnt(6)
v_pk_add_f32 v[48:49],v[48:49],v[52:53]
v_pk_add_f32 v[50:51],v[50:51],v[54:55]
s_waitcnt lgkmcnt(4)
v_pk_add_f32 v[56:57],v[56:57],v[60:61]
v_pk_add_f32 v[58:59],v[58:59],v[62:63]
v_pk_add_f32 v[48:49],v[48:49],v[56:57]
v_pk_add_f32 v[50:51],v[50:51],v[58:59]
v_cvt_pk_bf16_f32 v112,v48,v49
v_cvt_pk_bf16_f32 v113,v50,v51
s_waitcnt lgkmcnt(2)
v_pk_add_f32 v[64:65],v[64:65],v[68:69]
v_pk_add_f32 v[66:67],v[66:67],v[70:71]
s_waitcnt lgkmcnt(0)
v_pk_add_f32 v[72:73],v[72:73],v[76:77]
v_pk_add_f32 v[74:75],v[74:75],v[78:79]
v_pk_add_f32 v[64:65],v[64:65],v[72:73]
v_pk_add_f32 v[66:67],v[66:67],v[74:75]
v_cvt_pk_bf16_f32 v114,v64,v65
v_cvt_pk_bf16_f32 v115,v66,v67
s_nop 1
v_mfma_f32_16x16x32_bf16 v[116:119],v[96:99],v[112:115],0
v_mfma_f32_16x16x32_bf16 v[120:123],v[100:103],v[112:115],0
v_mfma_f32_16x16x32_bf16 v[12:15],v[112:115],v[112:115],0
ds_read_b128 v[48:51],v7 offset:0
ds_read_b128 v[52:55],v7 offset:1024
ds_read_b128 v[56:59],v7 offset:2048
ds_read_b128 v[60:63],v7 offset:3072
ds_read_b128 v[64:67],v7 offset:4096
buffer_store_dwordx4 v[116:119],v3,s[20:23],s94 offen
buffer_store_dwordx4 v[120:123],v3,s[20:23],s94 offen offset:512
s_nop 0
buffer_store_dwordx4 v[12:15],v3,s[20:23],s94 offen offset:1024
ds_read_b128 v[68:71],v7 offset:5120
ds_read_b128 v[72:75],v7 offset:6144
ds_read_b128 v[76:79],v7 offset:7168
v_smfmac_f32_16x16x64_bf16 v[84:87],v[16:19],v[216:223],v1
v_smfmac_f32_16x16x64_bf16 v[84:87],v[32:35],v[216:223],v1
v_smfmac_f32_16x16x64_bf16 v[88:91],v[16:19],v[224:231],v1
v_smfmac_f32_16x16x64_bf16 v[88:91],v[32:35],v[224:231],v1
v_smfmac_f32_16x16x64_bf16 v[92:95],v[16:19],v[232:239],v1
v_smfmac_f32_16x16x64_bf16 v[92:95],v[32:35],v[232:239],v1
v_smfmac_f32_16x16x64_bf16 v[80:83],v[20:23],v[240:247],v1
v_smfmac_f32_16x16x64_bf16 v[80:83],v[36:39],v[240:247],v1
v_smfmac_f32_16x16x64_bf16 v[84:87],v[20:23],v[248:255],v1
v_smfmac_f32_16x16x64_bf16 v[84:87],v[36:39],v[248:255],v1
s_waitcnt lgkmcnt(6)
v_smfmac_f32_16x16x64_bf16 v[88:91],v[20:23],v[48:55],v1
v_smfmac_f32_16x16x64_bf16 v[88:91],v[36:39],v[48:55],v1
ds_read_b128 v[48:51],v7 offset:8192
ds_read_b128 v[52:55],v7 offset:9216
s_waitcnt lgkmcnt(6)
v_smfmac_f32_16x16x64_bf16 v[92:95],v[20:23],v[56:63],v1
v_smfmac_f32_16x16x64_bf16 v[92:95],v[36:39],v[56:63],v1
ds_read_b128 v[56:59],v7 offset:10240
ds_read_b128 v[60:63],v7 offset:11264
s_waitcnt lgkmcnt(6)
v_smfmac_f32_16x16x64_bf16 v[80:83],v[24:27],v[64:71],v1
v_smfmac_f32_16x16x64_bf16 v[80:83],v[40:43],v[64:71],v1
ds_read_b128 v[64:67],v7 offset:12288
ds_read_b128 v[68:71],v7 offset:13312
s_waitcnt lgkmcnt(6)
v_smfmac_f32_16x16x64_bf16 v[84:87],v[24:27],v[72:79],v1
v_smfmac_f32_16x16x64_bf16 v[84:87],v[40:43],v[72:79],v1
ds_read_b128 v[72:75],v7 offset:14336
ds_read_b128 v[76:79],v7 offset:15360
s_waitcnt lgkmcnt(6)
v_smfmac_f32_16x16x64_bf16 v[88:91],v[24:27],v[48:55],v1
v_smfmac_f32_16x16x64_bf16 v[88:91],v[40:43],v[48:55],v1
ds_read_b128 v[48:51],v7 offset:16384
ds_read_b128 v[52:55],v7 offset:17408
s_waitcnt lgkmcnt(6)
v_smfmac_f32_16x16x64_bf16 v[92:95],v[24:27],v[56:63],v1
v_smfmac_f32_16x16x64_bf16 v[92:95],v[40:43],v[56:63],v1
ds_read_b128 v[56:59],v7 offset:18432
ds_read_b128 v[60:63],v7 offset:19456
s_waitcnt lgkmcnt(6)
v_smfmac_f32_16x16x64_bf16 v[80:83],v[28:31],v[64:71],v1
v_smfmac_f32_16x16x64_bf16 v[80:83],v[44:47],v[64:71],v1
s_waitcnt lgkmcnt(4)
v_smfmac_f32_16x16x64_bf16 v[84:87],v[28:31],v[72:79],v1
v_smfmac_f32_16x16x64_bf16 v[84:87],v[44:47],v[72:79],v1
s_waitcnt lgkmcnt(2)
v_smfmac_f32_16x16x64_bf16 v[88:91],v[28:31],v[48:55],v1
v_add_f32 v80,v80,v81
v_smfmac_f32_16x16x64_bf16 v[88:91],v[44:47],v[48:55],v1
v_add_f32 v82,v82,v83
s_waitcnt lgkmcnt(0)
v_smfmac_f32_16x16x64_bf16 v[92:95],v[28:31],v[56:63],v1
v_cvt_pk_bf16_f32 v80,v80,v82
v_smfmac_f32_16x16x64_bf16 v[92:95],v[44:47],v[56:63],v1
ds_write_addtid_b32 v80 offset:16896
v_add_f32 v84,v84,v85
v_add_f32 v86,v86,v87
v_cvt_pk_bf16_f32 v84,v84,v86
v_add_f32 v88,v88,v89
v_add_f32 v90,v90,v91
v_cvt_pk_bf16_f32 v88,v88,v90
s_nop 0
v_add_f32 v92,v92,v93
v_add_f32 v94,v94,v95
v_cvt_pk_bf16_f32 v92,v92,v94
ds_write_addtid_b32 v84 offset:17920
ds_write_addtid_b32 v88 offset:18944
ds_write_addtid_b32 v92 offset:19968
s_waitcnt lgkmcnt(0)
s_barrier
ds_read_b128 v[48:51],v7 offset:20480
ds_read_b128 v[52:55],v7 offset:21504
ds_read_b128 v[56:59],v7 offset:22528
ds_read_b128 v[60:63],v7 offset:23552
ds_read_b128 v[64:67],v7 offset:24576
ds_read_b128 v[68:71],v7 offset:25600
ds_read_b128 v[72:75],v7 offset:26624
ds_read_b128 v[76:79],v7 offset:27648
ds_read_b128 v[80:83],v7 offset:28672
ds_read_b128 v[84:87],v7 offset:29696
ds_read_b128 v[88:91],v7 offset:30720
ds_read_b128 v[92:95],v7 offset:31744
s_add_u32 s65,s76,s100
s_add_u32 s66,s75,s100
s_add_u32 s64,s71,s100
s_cmp_eq_u32 s50,2
s_cselect_b32 s66,s66,s64
buffer_store_dwordx4 v[8:11],v0,s[20:23],s65 offen
s_cmp_eq_u32 s50,2
s_cselect_b32 exec_hi,-1,0
buffer_store_dwordx4 v[8:11],v0,s[20:23],s66 offen
s_mov_b32 exec_hi,0
buffer_store_dwordx4 v[8:11],v0,s[20:23],s65 offen offset:1024
s_mov_b64 exec,-1
v_mov_b32 v96,0
v_mov_b32 v97,0
v_mov_b32 v98,0
v_mov_b32 v99,0
v_mov_b32 v100,0
v_mov_b32 v101,0
v_mov_b32 v102,0
v_mov_b32 v103,0
s_barrier
s_nop 15
s_nop 15
s_nop 7
buffer_load_dwordx4 v[16:19],v0,s[20:23],s96 offen offset:0 sc1
s_add_u32 s79,s79,1
s_and_b32 s64,s79,3
s_lshl_b32 s64,s64,19
s_lshl_b32 s65,s79,8
s_and_b32 s65,s65,0x2000
s_lshl_b32 s66,s79,16
s_xor_b32 s88,s73,s65
s_add_u32 s88,s88,s66
buffer_load_dwordx4 v[20:23],v0,s[20:23],s96 offen offset:1024 sc1
s_sub_u32 s88,s88,s54
s_add_u32 s89,s71,s64
s_add_u32 s92,s70,s64
s_xor_b32 s93,s72,s65
s_add_u32 s93,s93,s66
s_add_u32 s94,s76,s64
s_add_u32 s95,s94,4096
s_add_u32 s98,s75,s64
buffer_load_dwordx4 v[24:27],v0,s[20:23],s96 offen offset:2048 sc1
s_add_u32 s60,s74,s64
s_nop 6
buffer_load_dwordx4 v[28:31],v0,s[20:23],s96 offen offset:3072 sc1
s_nop 7
buffer_load_dwordx4 v[32:35],v0,s[20:23],s97 offen offset:0 sc1
s_nop 7
buffer_load_dwordx4 v[36:39],v0,s[20:23],s97 offen offset:1024 sc1
s_nop 7
buffer_load_dwordx4 v[40:43],v0,s[20:23],s97 offen offset:2048 sc1
s_nop 7
buffer_load_dwordx4 v[44:47],v0,s[20:23],s97 offen offset:3072 sc1
ogo_100465:
s_waitcnt lgkmcnt(0)
s_waitcnt vmcnt(6)
v_max3_u32 v124,v16,v17,v18
v_max3_u32 v124,v124,v19,v20
v_max3_u32 v124,v124,v21,v22
v_max_u32 v124,v124,v23
v_cmp_eq_u32 vcc,-1,v124
s_cbranch_vccnz of_100471
v_smfmac_f32_16x16x64_bf16 v[96:99],v[16:19],v[48:55],v1
v_smfmac_f32_16x16x64_bf16 v[100:103],v[16:19],v[56:63],v1
v_smfmac_f32_16x16x64_bf16 v[96:99],v[20:23],v[64:71],v1
v_smfmac_f32_16x16x64_bf16 v[100:103],v[20:23],v[72:79],v1
v_readfirstlane_b32 s91,v126
s_waitcnt vmcnt(4)
v_max3_u32 v124,v24,v25,v26
v_max3_u32 v124,v124,v27,v28
v_max3_u32 v124,v124,v29,v30
v_max_u32 v124,v124,v31
v_cmp_eq_u32 vcc,-1,v124
s_cbranch_vccnz of_100472
v_smfmac_f32_16x16x64_bf16 v[96:99],v[24:27],v[80:87],v1
v_smfmac_f32_16x16x64_bf16 v[100:103],v[24:27],v[88:95],v1
v_smfmac_f32_16x16x64_bf16 v[96:99],v[28:31],v[128:135],v1
v_smfmac_f32_16x16x64_bf16 v[100:103],v[28:31],v[136:143],v1
s_waitcnt vmcnt(2)
v_max3_u32 v124,v32,v33,v34
v_max3_u32 v124,v124,v35,v36
v_max3_u32 v124,v124,v37,v38
v_max_u32 v124,v124,v39
v_cmp_eq_u32 vcc,-1,v124
s_cbranch_vccnz of_100473
v_smfmac_f32_16x16x64_bf16 v[96:99],v[32:35],v[144:151],v1
v_smfmac_f32_16x16x64_bf16 v[100:103],v[32:35],v[152:159],v1
v_smfmac_f32_16x16x64_bf16 v[96:99],v[36:39],v[160:167],v1
v_smfmac_f32_16x16x64_bf16 v[100:103],v[36:39],v[168:175],v1
s_waitcnt vmcnt(1)
v_max3_u32 v124,v40,v41,v42
v_max_u32 v124,v124,v43
v_cmp_eq_u32 vcc,-1,v124
s_cbranch_vccnz of_100474
v_smfmac_f32_16x16x64_bf16 v[96:99],v[40:43],v[176:183],v1
v_smfmac_f32_16x16x64_bf16 v[100:103],v[40:43],v[184:191],v1
s_waitcnt vmcnt(0)
v_max3_u32 v124,v44,v45,v46
v_max_u32 v124,v124,v47
v_cmp_eq_u32 vcc,-1,v124
s_cbranch_vccnz of_100475
v_smfmac_f32_16x16x64_bf16 v[96:99],v[44:47],v[192:199],v1
v_smfmac_f32_16x16x64_bf16 v[100:103],v[44:47],v[200:207],v1
oback_100482:
s_nop 4
v_add_f32 v96,v96,v97
v_add_f32 v98,v98,v99
s_nop 0
v_add_f32 v100,v100,v101
v_add_f32 v102,v102,v103
ds_write_addtid_b32 v96 offset:20992
ds_write_addtid_b32 v98 offset:23072
ds_write_addtid_b32 v100 offset:22016
ds_write_addtid_b32 v102 offset:24096
s_mov_b32 s96,s60
s_add_u32 s97,s60,4096
s_cmp_gt_u32 s50,1
s_waitcnt lgkmcnt(0)
s_barrier
s_cbranch_scc1 loop_100420
ds_read2st64_b32 v[48:49],v4 offset0:82 offset1:86
ds_read2st64_b32 v[50:51],v4 offset0:83 offset1:87
ds_read2st64_b32 v[52:53],v4 offset0:84 offset1:88
ds_read2st64_b32 v[54:55],v4 offset0:85 offset1:89
v_mov_b32 v96,v104
v_mov_b32 v97,v105
v_mov_b32 v98,v106
v_mov_b32 v99,v107
v_mov_b32 v100,v108
v_mov_b32 v101,v109
v_mov_b32 v102,v110
v_mov_b32 v103,v111
s_waitcnt lgkmcnt(2)
v_pk_add_f32 v[48:49],v[48:49],v[50:51]
s_waitcnt lgkmcnt(0)
v_pk_add_f32 v[52:53],v[52:53],v[54:55]
v_pk_add_f32 v[48:49],v[48:49],v[52:53]
v_cvt_pk_bf16_f32 v124,v48,v49
buffer_store_dword v124,v127,s[20:23],s89 offen
s_nop 7
buffer_store_dword v124,v127,s[20:23],s88 offen sc1
s_branch loop0_100424x
last_100421:
s_waitcnt vmcnt(3)
v_max3_u32 v124,v16,v17,v18
v_max_u32 v124,v124,v19
v_cmp_eq_u32 vcc,-1,v124
v_cndmask_b32 v121,2.0,v127,s[86:87]
s_cbranch_vccnz flb_100507
seg_100483:
segb_100491:
v_smfmac_f32_16x16x64_bf16 v[64:67],v[16:19],a[32:39],v1
buffer_load_dword v125,off,s[20:23],s92 sc1
buffer_load_dwordx4 v[32:35],v0,s[20:23],s93 offen offset:0 sc1
s_waitcnt vmcnt(4)
v_max3_u32 v124,v20,v21,v22
v_smfmac_f32_16x16x64_bf16 v[68:71],v[16:19],a[40:47],v1
v_max_u32 v124,v124,v23
v_cmp_eq_u32 vcc,-1,v124
v_smfmac_f32_16x16x64_bf16 v[72:75],v[16:19],a[48:55],v1
v_smfmac_f32_16x16x64_bf16 v[76:79],v[16:19],a[56:63],v1
s_cbranch_vccnz fl_100500
seg_100484:
segb_100492:
v_smfmac_f32_16x16x64_bf16 v[64:67],v[20:23],a[96:103],v1
buffer_load_dword v125,off,s[20:23],s92 sc1
buffer_load_dwordx4 v[36:39],v0,s[20:23],s93 offen offset:1024 sc1
s_waitcnt vmcnt(5)
v_max3_u32 v124,v24,v25,v26
v_smfmac_f32_16x16x64_bf16 v[68:71],v[20:23],a[104:111],v1
v_max_u32 v124,v124,v27
v_cmp_eq_u32 vcc,-1,v124
v_smfmac_f32_16x16x64_bf16 v[72:75],v[20:23],a[112:119],v1
v_smfmac_f32_16x16x64_bf16 v[76:79],v[20:23],a[120:127],v1
s_cbranch_vccnz fl_100501
seg_100485:
segb_100493:
v_smfmac_f32_16x16x64_bf16 v[64:67],v[24:27],a[160:167],v1
buffer_load_dword v125,off,s[20:23],s92 sc1
buffer_load_dwordx4 v[40:43],v0,s[20:23],s93 offen offset:2048 sc1
buffer_load_dwordx4 v[44:47],v0,s[20:23],s93 offen offset:3072 sc1
s_waitcnt vmcnt(7)
v_max3_u32 v124,v28,v29,v30
v_smfmac_f32_16x16x64_bf16 v[68:71],v[24:27],a[168:175],v1
v_max_u32 v124,v124,v31
v_cmp_eq_u32 vcc,-1,v124
v_smfmac_f32_16x16x64_bf16 v[72:75],v[24:27],a[176:183],v1
v_smfmac_f32_16x16x64_bf16 v[76:79],v[24:27],a[184:191],v1
s_cbranch_vccnz fl_100502
seg_100486:
segb_100494:
v_smfmac_f32_16x16x64_bf16 v[64:67],v[28:31],a[224:231],v1
buffer_load_dword v125,off,s[20:23],s92 sc1
buffer_store_dword v126,v121,s[20:23],s69 offen sc1
s_waitcnt vmcnt(7)
v_max3_u32 v124,v32,v33,v34
v_smfmac_f32_16x16x64_bf16 v[68:71],v[28:31],a[232:239],v1
v_max_u32 v124,v124,v35
v_cmp_eq_u32 vcc,-1,v124
v_smfmac_f32_16x16x64_bf16 v[72:75],v[28:31],a[240:247],v1
v_smfmac_f32_16x16x64_bf16 v[76:79],v[28:31],a[248:255],v1
s_cbranch_vccnz fl_100503
seg_100487:
segb_100495:
v_smfmac_f32_16x16x64_bf16 v[64:67],v[32:35],a[32:39],v1
buffer_load_dword v125,off,s[20:23],s92 sc1
s_waitcnt vmcnt(6)
v_max3_u32 v124,v36,v37,v38
v_smfmac_f32_16x16x64_bf16 v[68:71],v[32:35],a[40:47],v1
v_max_u32 v124,v124,v39
v_cmp_eq_u32 vcc,-1,v124
v_smfmac_f32_16x16x64_bf16 v[72:75],v[32:35],a[48:55],v1
v_smfmac_f32_16x16x64_bf16 v[76:79],v[32:35],a[56:63],v1
s_cbranch_vccnz fl_100504
seg_100488:
segb_100496:
v_smfmac_f32_16x16x64_bf16 v[64:67],v[36:39],a[96:103],v1
buffer_load_dword v125,off,s[20:23],s92 sc1
s_waitcnt vmcnt(4)
v_max3_u32 v124,v40,v41,v42
v_smfmac_f32_16x16x64_bf16 v[68:71],v[36:39],a[104:111],v1
v_max3_u32 v124,v124,v43,v44
v_max3_u32 v124,v124,v45,v46
v_max_u32 v124,v124,v47
v_cmp_eq_u32 vcc,-1,v124
v_smfmac_f32_16x16x64_bf16 v[72:75],v[36:39],a[112:119],v1
v_smfmac_f32_16x16x64_bf16 v[76:79],v[36:39],a[120:127],v1
s_cbranch_vccnz fl_100505
seg_100489:
segb_100497:
v_smfmac_f32_16x16x64_bf16 v[64:67],v[40:43],a[160:167],v1
v_smfmac_f32_16x16x64_bf16 v[68:71],v[40:43],a[168:175],v1
v_smfmac_f32_16x16x64_bf16 v[64:67],v[44:47],a[224:231],v1
v_smfmac_f32_16x16x64_bf16 v[68:71],v[44:47],a[232:239],v1
v_smfmac_f32_16x16x64_bf16 v[72:75],v[40:43],a[176:183],v1
s_nop 1
v_add_f32 v64,v64,v65
v_smfmac_f32_16x16x64_bf16 v[76:79],v[40:43],a[184:191],v1
ds_write_addtid_b32 v64 offset:8448
v_add_f32 v66,v66,v67
v_smfmac_f32_16x16x64_bf16 v[72:75],v[44:47],a[240:247],v1
ds_write_addtid_b32 v66 offset:9488
v_add_f32 v68,v68,v69
v_smfmac_f32_16x16x64_bf16 v[76:79],v[44:47],a[248:255],v1
ds_write_addtid_b32 v68 offset:10528
v_add_f32 v70,v70,v71
v_smfmac_f32_16x16x64_bf16 v[80:83],v[16:19],v[208:215],v1
ds_write_addtid_b32 v70 offset:11568
v_add_f32 v72,v72,v73
v_smfmac_f32_16x16x64_bf16 v[80:83],v[32:35],v[208:215],v1
ds_write_addtid_b32 v72 offset:12608
v_add_f32 v74,v74,v75
v_smfmac_f32_16x16x64_bf16 v[84:87],v[16:19],v[216:223],v1
ds_write_addtid_b32 v74 offset:13648
v_add_f32 v76,v76,v77
v_smfmac_f32_16x16x64_bf16 v[84:87],v[32:35],v[216:223],v1
ds_write_addtid_b32 v76 offset:14688
v_add_f32 v78,v78,v79
v_smfmac_f32_16x16x64_bf16 v[88:91],v[16:19],v[224:231],v1
ds_write_addtid_b32 v78 offset:15728
v_smfmac_f32_16x16x64_bf16 v[88:91],v[32:35],v[224:231],v1
v_smfmac_f32_16x16x64_bf16 v[92:95],v[16:19],v[232:239],v1
v_smfmac_f32_16x16x64_bf16 v[92:95],v[32:35],v[232:239],v1
doneA_100516:
s_waitcnt vmcnt(0) lgkmcnt(0)
s_add_u32 s64,s79,0
s_lshl_b32 s65,s64,12
s_and_b32 s65,s65,0x2000
s_xor_b32 s65,s65,s67
s_lshl_b32 s64,s64,20
s_add_u32 s65,s65,s64
s_add_u32 s101,s65,s78
v_smfmac_f32_16x16x64_bf16 v[80:83],v[20:23],v[240:247],v1
ds_read_b128 v[48:51],v7 offset:0
ds_read_b128 v[52:55],v7 offset:1024
v_smfmac_f32_16x16x64_bf16 v[80:83],v[36:39],v[240:247],v1
ds_read_b128 v[56:59],v7 offset:2048
ds_read_b128 v[60:63],v7 offset:3072
v_smfmac_f32_16x16x64_bf16 v[84:87],v[20:23],v[248:255],v1
ds_read_b128 v[64:67],v7 offset:4096
ds_read_b128 v[68:71],v7 offset:5120
v_smfmac_f32_16x16x64_bf16 v[84:87],v[36:39],v[248:255],v1
ds_read_b128 v[72:75],v7 offset:6144
ds_read_b128 v[76:79],v7 offset:7168
s_waitcnt lgkmcnt(6)
v_smfmac_f32_16x16x64_bf16 v[88:91],v[20:23],v[48:55],v1
v_smfmac_f32_16x16x64_bf16 v[88:91],v[36:39],v[48:55],v1
ds_read_b128 v[48:51],v7 offset:8192
ds_read_b128 v[52:55],v7 offset:9216
s_waitcnt lgkmcnt(6)
v_smfmac_f32_16x16x64_bf16 v[92:95],v[20:23],v[56:63],v1
v_smfmac_f32_16x16x64_bf16 v[92:95],v[36:39],v[56:63],v1
ds_read_b128 v[56:59],v7 offset:10240
ds_read_b128 v[60:63],v7 offset:11264
s_waitcnt lgkmcnt(6)
v_smfmac_f32_16x16x64_bf16 v[80:83],v[24:27],v[64:71],v1
v_smfmac_f32_16x16x64_bf16 v[80:83],v[40:43],v[64:71],v1
ds_read_b128 v[64:67],v7 offset:12288
ds_read_b128 v[68:71],v7 offset:13312
s_waitcnt lgkmcnt(6)
v_smfmac_f32_16x16x64_bf16 v[84:87],v[24:27],v[72:79],v1
v_smfmac_f32_16x16x64_bf16 v[84:87],v[40:43],v[72:79],v1
ds_read_b128 v[72:75],v7 offset:14336
ds_read_b128 v[76:79],v7 offset:15360
s_waitcnt lgkmcnt(6)
v_smfmac_f32_16x16x64_bf16 v[88:91],v[24:27],v[48:55],v1
v_smfmac_f32_16x16x64_bf16 v[88:91],v[40:43],v[48:55],v1
ds_read_b128 v[48:51],v7 offset:16384
ds_read_b128 v[52:55],v7 offset:17408
s_waitcnt lgkmcnt(6)
v_smfmac_f32_16x16x64_bf16 v[92:95],v[24:27],v[56:63],v1
v_smfmac_f32_16x16x64_bf16 v[92:95],v[40:43],v[56:63],v1
ds_read_b128 v[56:59],v7 offset:18432
ds_read_b128 v[60:63],v7 offset:19456
s_waitcnt lgkmcnt(6)
v_smfmac_f32_16x16x64_bf16 v[80:83],v[28:31],v[64:71],v1
v_smfmac_f32_16x16x64_bf16 v[80:83],v[44:47],v[64:71],v1
s_waitcnt lgkmcnt(4)
v_smfmac_f32_16x16x64_bf16 v[84:87],v[28:31],v[72:79],v1
v_smfmac_f32_16x16x64_bf16 v[84:87],v[44:47],v[72:79],v1
s_waitcnt lgkmcnt(2)
v_smfmac_f32_16x16x64_bf16 v[88:91],v[28:31],v[48:55],v1
v_add_f32 v80,v80,v81
v_smfmac_f32_16x16x64_bf16 v[88:91],v[44:47],v[48:55],v1
v_add_f32 v82,v82,v83
s_waitcnt lgkmcnt(0)
v_smfmac_f32_16x16x64_bf16 v[92:95],v[28:31],v[56:63],v1
v_cvt_pk_bf16_f32 v80,v80,v82
v_smfmac_f32_16x16x64_bf16 v[92:95],v[44:47],v[56:63],v1
ds_write_addtid_b32 v80 offset:16896
v_add_f32 v84,v84,v85
v_add_f32 v86,v86,v87
v_cvt_pk_bf16_f32 v84,v84,v86
v_add_f32 v88,v88,v89
v_add_f32 v90,v90,v91
v_cvt_pk_bf16_f32 v88,v88,v90
s_nop 0
v_add_f32 v92,v92,v93
v_add_f32 v94,v94,v95
v_cvt_pk_bf16_f32 v92,v92,v94
ds_write_addtid_b32 v84 offset:17920
ds_write_addtid_b32 v88 offset:18944
ds_write_addtid_b32 v92 offset:19968
s_waitcnt lgkmcnt(0)
s_barrier
s_cmp_gt_u32 s50,1
s_cbranch_scc1 l23_100517
ds_read2st64_b32 v[112:113],v127 offset0:66 offset1:67
ds_read2st64_b32 v[114:115],v127 offset0:68 offset1:69
ds_read2st64_b32 v[116:117],v127 offset0:70 offset1:71
ds_read2st64_b32 v[118:119],v127 offset0:72 offset1:73
s_waitcnt lgkmcnt(0)
v_mov_b32 v120,v5
v_mov_b32 v121,v5
v_mov_b32 v122,v5
v_mov_b32 v123,v5
s_nop 1
v_mfma_f32_16x16x32_bf16 v[112:115],v[120:123],v[112:115],0
v_mfma_f32_16x16x32_bf16 v[116:119],v[120:123],v[116:119],0
s_nop 4
v_cvt_pk_bf16_f32 v112,v112,v113
v_cvt_pk_bf16_f32 v113,v114,v115
s_nop 0
v_cvt_pk_bf16_f32 v114,v116,v117
v_cvt_pk_bf16_f32 v115,v118,v119
s_branch lj_100518
l23_100517:
ds_read_b128 v[48:51],v2 offset:0
ds_read_b128 v[52:55],v2 offset:256
ds_read_b128 v[56:59],v2 offset:512
ds_read_b128 v[60:63],v2 offset:768
ds_read_b128 v[64:67],v2 offset:16
ds_read_b128 v[68:71],v2 offset:272
ds_read_b128 v[72:75],v2 offset:528
ds_read_b128 v[76:79],v2 offset:784
s_waitcnt lgkmcnt(6)
v_pk_add_f32 v[48:49],v[48:49],v[52:53]
v_pk_add_f32 v[50:51],v[50:51],v[54:55]
s_waitcnt lgkmcnt(4)
v_pk_add_f32 v[56:57],v[56:57],v[60:61]
v_pk_add_f32 v[58:59],v[58:59],v[62:63]
v_pk_add_f32 v[48:49],v[48:49],v[56:57]
v_pk_add_f32 v[50:51],v[50:51],v[58:59]
v_cvt_pk_bf16_f32 v112,v48,v49
v_cvt_pk_bf16_f32 v113,v50,v51
s_waitcnt lgkmcnt(2)
v_pk_add_f32 v[64:65],v[64:65],v[68:69]
v_pk_add_f32 v[66:67],v[66:67],v[70:71]
s_waitcnt lgkmcnt(0)
v_pk_add_f32 v[72:73],v[72:73],v[76:77]
v_pk_add_f32 v[74:75],v[74:75],v[78:79]
v_pk_add_f32 v[64:65],v[64:65],v[72:73]
v_pk_add_f32 v[66:67],v[66:67],v[74:75]
v_cvt_pk_bf16_f32 v114,v64,v65
v_cvt_pk_bf16_f32 v115,v66,v67
lj_100518:
v_cndmask_b32 v120,2.0,v0,s[82:83]
v_cndmask_b32 v121,2.0,v127,s[86:87]
buffer_store_dwordx4 v[112:115],v120,s[20:23],s101 offen sc1
s_waitcnt vmcnt(0)
s_barrier
v_mov_b32 v126,64
buffer_store_dword v126,v121,s[20:23],s69 offen sc1
s_branch recfin_100413
flp_100426:
buffer_load_dword v124,off,s[20:23],s68 sc1
s_waitcnt vmcnt(0)
v_readfirstlane_b32 s91,v124
s_cmp_gt_u32 s91,s64
s_cbranch_scc1 fok_100425
s_sleep 2
s_sub_u32 s90,s90,1
s_cmp_gt_i32 s90,0
s_cbranch_scc1 flp_100426
s_branch fok_100425
flp_100429:
buffer_load_dword v124,off,s[20:23],s68 sc1
s_waitcnt vmcnt(0)
v_readfirstlane_b32 s91,v124
s_cmp_gt_u32 s91,s64
s_cbranch_scc1 fok_100428
s_sleep 2
s_sub_u32 s90,s90,1
s_cmp_gt_i32 s90,0
s_cbranch_scc1 flp_100429
s_branch fok_100428
fl_100446:
flb_100454:
buffer_load_dwordx4 v[16:19],v0,s[20:23],s92 offen offset:0 sc1
s_mov_b32 s55,1
buffer_load_dwordx4 v[32:35],v0,s[20:23],s93 offen offset:0 sc1
s_waitcnt vmcnt(4)
v_max3_u32 v124,v20,v21,v22
v_max_u32 v124,v124,v23
v_cmp_eq_u32 vcc,-1,v124
s_cbranch_vccnz dfl_100519
v_smfmac_f32_16x16x64_bf16 v[48:51],v[20:23],a[64:71],v1
buffer_load_dword v125,off,s[20:23],s92 sc1
v_smfmac_f32_16x16x64_bf16 v[52:55],v[20:23],a[72:79],v1
buffer_load_dwordx4 v[36:39],v0,s[20:23],s93 offen offset:1024 sc1
v_smfmac_f32_16x16x64_bf16 v[56:59],v[20:23],a[80:87],v1
s_waitcnt vmcnt(5)
v_max3_u32 v124,v24,v25,v26
v_smfmac_f32_16x16x64_bf16 v[60:63],v[20:23],a[88:95],v1
v_max_u32 v124,v124,v27
v_smfmac_f32_16x16x64_bf16 v[64:67],v[20:23],a[96:103],v1
v_cmp_eq_u32 vcc,-1,v124
v_smfmac_f32_16x16x64_bf16 v[68:71],v[20:23],a[104:111],v1
v_smfmac_f32_16x16x64_bf16 v[72:75],v[20:23],a[112:119],v1
v_smfmac_f32_16x16x64_bf16 v[76:79],v[20:23],a[120:127],v1
s_cbranch_vccnz dfl_100520
v_smfmac_f32_16x16x64_bf16 v[48:51],v[24:27],a[128:135],v1
buffer_load_dword v125,off,s[20:23],s92 sc1
v_smfmac_f32_16x16x64_bf16 v[52:55],v[24:27],a[136:143],v1
buffer_load_dwordx4 v[40:43],v0,s[20:23],s93 offen offset:2048 sc1
v_smfmac_f32_16x16x64_bf16 v[56:59],v[24:27],a[144:151],v1
buffer_load_dwordx4 v[44:47],v0,s[20:23],s93 offen offset:3072 sc1
s_waitcnt vmcnt(7)
v_max3_u32 v124,v28,v29,v30
v_smfmac_f32_16x16x64_bf16 v[60:63],v[24:27],a[152:159],v1
v_max_u32 v124,v124,v31
v_smfmac_f32_16x16x64_bf16 v[64:67],v[24:27],a[160:167],v1
v_cmp_eq_u32 vcc,-1,v124
v_smfmac_f32_16x16x64_bf16 v[68:71],v[24:27],a[168:175],v1
v_smfmac_f32_16x16x64_bf16 v[72:75],v[24:27],a[176:183],v1
v_smfmac_f32_16x16x64_bf16 v[76:79],v[24:27],a[184:191],v1
s_cbranch_vccnz dfl_100521
v_smfmac_f32_16x16x64_bf16 v[48:51],v[28:31],a[192:199],v1
buffer_load_dword v125,off,s[20:23],s92 sc1
v_smfmac_f32_16x16x64_bf16 v[52:55],v[28:31],a[200:207],v1
buffer_store_dword v126,v121,s[20:23],s69 offen sc1
v_smfmac_f32_16x16x64_bf16 v[56:59],v[28:31],a[208:215],v1
s_waitcnt vmcnt(8)
v_max3_u32 v124,v16,v17,v18
v_smfmac_f32_16x16x64_bf16 v[60:63],v[28:31],a[216:223],v1
v_max_u32 v124,v124,v19
v_smfmac_f32_16x16x64_bf16 v[64:67],v[28:31],a[224:231],v1
v_cmp_eq_u32 vcc,-1,v124
v_smfmac_f32_16x16x64_bf16 v[68:71],v[28:31],a[232:239],v1
v_smfmac_f32_16x16x64_bf16 v[72:75],v[28:31],a[240:247],v1
v_smfmac_f32_16x16x64_bf16 v[76:79],v[28:31],a[248:255],v1
s_cbranch_vccnz lfb_100526
s_mov_b32 s55,0
v_smfmac_f32_16x16x64_bf16 v[48:51],v[16:19],a[0:7],v1
v_smfmac_f32_16x16x64_bf16 v[52:55],v[16:19],a[8:15],v1
v_smfmac_f32_16x16x64_bf16 v[56:59],v[16:19],a[16:23],v1
s_waitcnt vmcnt(7)
v_max3_u32 v124,v32,v33,v34
v_max_u32 v124,v124,v35
v_cmp_eq_u32 vcc,-1,v124
v_smfmac_f32_16x16x64_bf16 v[60:63],v[16:19],a[24:31],v1
v_smfmac_f32_16x16x64_bf16 v[64:67],v[16:19],a[32:39],v1
v_smfmac_f32_16x16x64_bf16 v[68:71],v[16:19],a[40:47],v1
v_smfmac_f32_16x16x64_bf16 v[72:75],v[16:19],a[48:55],v1
v_smfmac_f32_16x16x64_bf16 v[76:79],v[16:19],a[56:63],v1
s_cbranch_vccnz flb_100458
s_branch segb_100442
fl_100447:
v_smfmac_f32_16x16x64_bf16 v[76:79],v[16:19],a[56:63],v1
flb_100455:
buffer_load_dwordx4 v[20:23],v0,s[20:23],s92 offen offset:1024 sc1
s_mov_b32 s55,2
buffer_load_dwordx4 v[36:39],v0,s[20:23],s93 offen offset:1024 sc1
s_waitcnt vmcnt(5)
v_max3_u32 v124,v24,v25,v26
v_max_u32 v124,v124,v27
v_cmp_eq_u32 vcc,-1,v124
s_cbranch_vccnz dfl_100520
v_smfmac_f32_16x16x64_bf16 v[48:51],v[24:27],a[128:135],v1
buffer_load_dword v125,off,s[20:23],s92 sc1
v_smfmac_f32_16x16x64_bf16 v[52:55],v[24:27],a[136:143],v1
buffer_load_dwordx4 v[40:43],v0,s[20:23],s93 offen offset:2048 sc1
v_smfmac_f32_16x16x64_bf16 v[56:59],v[24:27],a[144:151],v1
buffer_load_dwordx4 v[44:47],v0,s[20:23],s93 offen offset:3072 sc1
s_waitcnt vmcnt(7)
v_max3_u32 v124,v28,v29,v30
v_smfmac_f32_16x16x64_bf16 v[60:63],v[24:27],a[152:159],v1
v_max_u32 v124,v124,v31
v_smfmac_f32_16x16x64_bf16 v[64:67],v[24:27],a[160:167],v1
v_cmp_eq_u32 vcc,-1,v124
v_smfmac_f32_16x16x64_bf16 v[68:71],v[24:27],a[168:175],v1
v_smfmac_f32_16x16x64_bf16 v[72:75],v[24:27],a[176:183],v1
v_smfmac_f32_16x16x64_bf16 v[76:79],v[24:27],a[184:191],v1
s_cbranch_vccnz dfl_100521
v_smfmac_f32_16x16x64_bf16 v[48:51],v[28:31],a[192:199],v1
buffer_load_dword v125,off,s[20:23],s92 sc1
v_smfmac_f32_16x16x64_bf16 v[52:55],v[28:31],a[200:207],v1
buffer_store_dword v126,v121,s[20:23],s69 offen sc1
v_smfmac_f32_16x16x64_bf16 v[56:59],v[28:31],a[208:215],v1
s_waitcnt vmcnt(6)
v_max3_u32 v124,v20,v21,v22
v_smfmac_f32_16x16x64_bf16 v[60:63],v[28:31],a[216:223],v1
v_max_u32 v124,v124,v23
v_smfmac_f32_16x16x64_bf16 v[64:67],v[28:31],a[224:231],v1
v_cmp_eq_u32 vcc,-1,v124
v_smfmac_f32_16x16x64_bf16 v[68:71],v[28:31],a[232:239],v1
v_smfmac_f32_16x16x64_bf16 v[72:75],v[28:31],a[240:247],v1
v_smfmac_f32_16x16x64_bf16 v[76:79],v[28:31],a[248:255],v1
s_cbranch_vccnz lfb_100526
s_mov_b32 s55,0
v_smfmac_f32_16x16x64_bf16 v[48:51],v[20:23],a[64:71],v1
v_smfmac_f32_16x16x64_bf16 v[52:55],v[20:23],a[72:79],v1
v_smfmac_f32_16x16x64_bf16 v[56:59],v[20:23],a[80:87],v1
s_waitcnt vmcnt(7)
v_max3_u32 v124,v32,v33,v34
v_max_u32 v124,v124,v35
v_cmp_eq_u32 vcc,-1,v124
v_smfmac_f32_16x16x64_bf16 v[60:63],v[20:23],a[88:95],v1
v_smfmac_f32_16x16x64_bf16 v[64:67],v[20:23],a[96:103],v1
v_smfmac_f32_16x16x64_bf16 v[68:71],v[20:23],a[104:111],v1
v_smfmac_f32_16x16x64_bf16 v[72:75],v[20:23],a[112:119],v1
v_smfmac_f32_16x16x64_bf16 v[76:79],v[20:23],a[120:127],v1
s_cbranch_vccnz flb_100458
s_branch segb_100442
fl_100448:
v_smfmac_f32_16x16x64_bf16 v[76:79],v[20:23],a[120:127],v1
flb_100456:
buffer_load_dwordx4 v[24:27],v0,s[20:23],s92 offen offset:2048 sc1
s_mov_b32 s55,4
buffer_load_dwordx4 v[40:43],v0,s[20:23],s93 offen offset:2048 sc1
buffer_load_dwordx4 v[44:47],v0,s[20:23],s93 offen offset:3072 sc1
s_waitcnt vmcnt(7)
v_max3_u32 v124,v28,v29,v30
v_max_u32 v124,v124,v31
v_cmp_eq_u32 vcc,-1,v124
s_cbranch_vccnz dfl_100521
v_smfmac_f32_16x16x64_bf16 v[48:51],v[28:31],a[192:199],v1
buffer_load_dword v125,off,s[20:23],s92 sc1
v_smfmac_f32_16x16x64_bf16 v[52:55],v[28:31],a[200:207],v1
buffer_store_dword v126,v121,s[20:23],s69 offen sc1
v_smfmac_f32_16x16x64_bf16 v[56:59],v[28:31],a[208:215],v1
s_waitcnt vmcnt(4)
v_max3_u32 v124,v24,v25,v26
v_smfmac_f32_16x16x64_bf16 v[60:63],v[28:31],a[216:223],v1
v_max_u32 v124,v124,v27
v_smfmac_f32_16x16x64_bf16 v[64:67],v[28:31],a[224:231],v1
v_cmp_eq_u32 vcc,-1,v124
v_smfmac_f32_16x16x64_bf16 v[68:71],v[28:31],a[232:239],v1
v_smfmac_f32_16x16x64_bf16 v[72:75],v[28:31],a[240:247],v1
v_smfmac_f32_16x16x64_bf16 v[76:79],v[28:31],a[248:255],v1
s_cbranch_vccnz lfb_100526
s_mov_b32 s55,0
v_smfmac_f32_16x16x64_bf16 v[48:51],v[24:27],a[128:135],v1
v_smfmac_f32_16x16x64_bf16 v[52:55],v[24:27],a[136:143],v1
v_smfmac_f32_16x16x64_bf16 v[56:59],v[24:27],a[144:151],v1
s_waitcnt vmcnt(7)
v_max3_u32 v124,v32,v33,v34
v_max_u32 v124,v124,v35
v_cmp_eq_u32 vcc,-1,v124
v_smfmac_f32_16x16x64_bf16 v[60:63],v[24:27],a[152:159],v1
v_smfmac_f32_16x16x64_bf16 v[64:67],v[24:27],a[160:167],v1
v_smfmac_f32_16x16x64_bf16 v[68:71],v[24:27],a[168:175],v1
v_smfmac_f32_16x16x64_bf16 v[72:75],v[24:27],a[176:183],v1
v_smfmac_f32_16x16x64_bf16 v[76:79],v[24:27],a[184:191],v1
s_cbranch_vccnz flb_100458
s_branch segb_100442
fl_100449:
v_smfmac_f32_16x16x64_bf16 v[76:79],v[24:27],a[184:191],v1
flb_100457:
buffer_load_dwordx4 v[28:31],v0,s[20:23],s92 offen offset:3072 sc1
s_mov_b32 s55,8
buffer_store_dword v126,v121,s[20:23],s69 offen sc1
s_waitcnt vmcnt(1)
v_max3_u32 v124,v28,v29,v30
v_max_u32 v124,v124,v31
v_cmp_eq_u32 vcc,-1,v124
s_cbranch_vccnz lfb_100526
s_mov_b32 s55,0
v_smfmac_f32_16x16x64_bf16 v[48:51],v[28:31],a[192:199],v1
v_smfmac_f32_16x16x64_bf16 v[52:55],v[28:31],a[200:207],v1
v_smfmac_f32_16x16x64_bf16 v[56:59],v[28:31],a[208:215],v1
s_waitcnt vmcnt(7)
v_max3_u32 v124,v32,v33,v34
v_max_u32 v124,v124,v35
v_cmp_eq_u32 vcc,-1,v124
v_smfmac_f32_16x16x64_bf16 v[60:63],v[28:31],a[216:223],v1
v_smfmac_f32_16x16x64_bf16 v[64:67],v[28:31],a[224:231],v1
v_smfmac_f32_16x16x64_bf16 v[68:71],v[28:31],a[232:239],v1
v_smfmac_f32_16x16x64_bf16 v[72:75],v[28:31],a[240:247],v1
v_smfmac_f32_16x16x64_bf16 v[76:79],v[28:31],a[248:255],v1
s_cbranch_vccnz flb_100458
s_branch segb_100442
fl_100450:
v_smfmac_f32_16x16x64_bf16 v[76:79],v[28:31],a[248:255],v1
flb_100458:
buffer_load_dwordx4 v[32:35],v0,s[20:23],s93 offen offset:0 sc1
s_mov_b32 s55,240
s_bitcmp1_b32 s55,5
s_cbranch_scc0 rdn_100529
s_waitcnt vmcnt(6)
v_max3_u32 v124,v36,v37,v38
v_max_u32 v124,v124,v39
v_cmp_eq_u32 vcc,-1,v124
s_cbranch_vccnz rfa_100530
buffer_load_dword v125,off,s[20:23],s92 sc1
s_bitset0_b32 s55,5
v_smfmac_f32_16x16x64_bf16 v[48:51],v[36:39],a[64:71],v1
v_smfmac_f32_16x16x64_bf16 v[52:55],v[36:39],a[72:79],v1
v_smfmac_f32_16x16x64_bf16 v[56:59],v[36:39],a[80:87],v1
v_smfmac_f32_16x16x64_bf16 v[60:63],v[36:39],a[88:95],v1
v_smfmac_f32_16x16x64_bf16 v[64:67],v[36:39],a[96:103],v1
v_smfmac_f32_16x16x64_bf16 v[68:71],v[36:39],a[104:111],v1
v_smfmac_f32_16x16x64_bf16 v[72:75],v[36:39],a[112:119],v1
v_smfmac_f32_16x16x64_bf16 v[76:79],v[36:39],a[120:127],v1
s_cmp_eq_u32 s55,0
s_cbranch_scc1 segb_100444
s_branch rnx_100531
rdn_100529:
buffer_load_dword v125,off,s[20:23],s92 sc1
s_branch rnx_100531
rfa_100530:
buffer_load_dwordx4 v[36:39],v0,s[20:23],s93 offen offset:1024 sc1
rnx_100531:
s_bitcmp1_b32 s55,6
s_cbranch_scc0 rdn_100532
s_waitcnt vmcnt(5)
v_max3_u32 v124,v40,v41,v42
v_max_u32 v124,v124,v43
v_cmp_eq_u32 vcc,-1,v124
s_cbranch_vccnz rfa_100533
buffer_load_dword v125,off,s[20:23],s92 sc1
s_bitset0_b32 s55,6
s_cmp_eq_u32 s55,0
s_cbranch_scc1 segb_100444
s_branch rnx_100534
rdn_100532:
buffer_load_dword v125,off,s[20:23],s92 sc1
s_branch rnx_100534
rfa_100533:
buffer_load_dwordx4 v[40:43],v0,s[20:23],s93 offen offset:2048 sc1
rnx_100534:
s_bitcmp1_b32 s55,7
s_cbranch_scc0 rdn_100535
s_waitcnt vmcnt(5)
v_max3_u32 v124,v44,v45,v46
v_max_u32 v124,v124,v47
v_cmp_eq_u32 vcc,-1,v124
s_cbranch_vccnz rfa_100536
buffer_load_dword v125,off,s[20:23],s92 sc1
s_bitset0_b32 s55,7
s_cmp_eq_u32 s55,0
s_cbranch_scc1 segb_100444
s_branch rnx_100537
rdn_100535:
buffer_load_dword v125,off,s[20:23],s92 sc1
s_branch rnx_100537
rfa_100536:
buffer_load_dwordx4 v[44:47],v0,s[20:23],s93 offen offset:3072 sc1
rnx_100537:
rot_100528:
s_bitcmp1_b32 s55,4
s_cbranch_scc0 rdn_100538
s_waitcnt vmcnt(3)
v_max3_u32 v124,v32,v33,v34
v_max_u32 v124,v124,v35
v_cmp_eq_u32 vcc,-1,v124
s_cbranch_vccnz rfa_100539
buffer_load_dword v125,off,s[20:23],s92 sc1
s_bitset0_b32 s55,4
v_smfmac_f32_16x16x64_bf16 v[48:51],v[32:35],a[0:7],v1
v_smfmac_f32_16x16x64_bf16 v[52:55],v[32:35],a[8:15],v1
v_smfmac_f32_16x16x64_bf16 v[56:59],v[32:35],a[16:23],v1
v_smfmac_f32_16x16x64_bf16 v[60:63],v[32:35],a[24:31],v1
v_smfmac_f32_16x16x64_bf16 v[64:67],v[32:35],a[32:39],v1
v_smfmac_f32_16x16x64_bf16 v[68:71],v[32:35],a[40:47],v1
v_smfmac_f32_16x16x64_bf16 v[72:75],v[32:35],a[48:55],v1
v_smfmac_f32_16x16x64_bf16 v[76:79],v[32:35],a[56:63],v1
s_cmp_eq_u32 s55,0
s_cbranch_scc1 segb_100444
s_branch rnx_100540
rdn_100538:
buffer_load_dword v125,off,s[20:23],s92 sc1
s_branch rnx_100540
rfa_100539:
buffer_load_dwordx4 v[32:35],v0,s[20:23],s93 offen offset:0 sc1
rnx_100540:
s_bitcmp1_b32 s55,5
s_cbranch_scc0 rdn_100541
s_waitcnt vmcnt(3)
v_max3_u32 v124,v36,v37,v38
v_max_u32 v124,v124,v39
v_cmp_eq_u32 vcc,-1,v124
s_cbranch_vccnz rfa_100542
buffer_load_dword v125,off,s[20:23],s92 sc1
s_bitset0_b32 s55,5
v_smfmac_f32_16x16x64_bf16 v[48:51],v[36:39],a[64:71],v1
v_smfmac_f32_16x16x64_bf16 v[52:55],v[36:39],a[72:79],v1
v_smfmac_f32_16x16x64_bf16 v[56:59],v[36:39],a[80:87],v1
v_smfmac_f32_16x16x64_bf16 v[60:63],v[36:39],a[88:95],v1
v_smfmac_f32_16x16x64_bf16 v[64:67],v[36:39],a[96:103],v1
v_smfmac_f32_16x16x64_bf16 v[68:71],v[36:39],a[104:111],v1
v_smfmac_f32_16x16x64_bf16 v[72:75],v[36:39],a[112:119],v1
v_smfmac_f32_16x16x64_bf16 v[76:79],v[36:39],a[120:127],v1
s_cmp_eq_u32 s55,0
s_cbranch_scc1 segb_100444
s_branch rnx_100543
rdn_100541:
buffer_load_dword v125,off,s[20:23],s92 sc1
s_branch rnx_100543
rfa_100542:
buffer_load_dwordx4 v[36:39],v0,s[20:23],s93 offen offset:1024 sc1
rnx_100543:
s_bitcmp1_b32 s55,6
s_cbranch_scc0 rdn_100544
s_waitcnt vmcnt(3)
v_max3_u32 v124,v40,v41,v42
v_max_u32 v124,v124,v43
v_cmp_eq_u32 vcc,-1,v124
s_cbranch_vccnz rfa_100545
buffer_load_dword v125,off,s[20:23],s92 sc1
s_bitset0_b32 s55,6
s_cmp_eq_u32 s55,0
s_cbranch_scc1 segb_100444
s_branch rnx_100546
rdn_100544:
buffer_load_dword v125,off,s[20:23],s92 sc1
s_branch rnx_100546
rfa_100545:
buffer_load_dwordx4 v[40:43],v0,s[20:23],s93 offen offset:2048 sc1
rnx_100546:
s_bitcmp1_b32 s55,7
s_cbranch_scc0 rdn_100547
s_waitcnt vmcnt(3)
v_max3_u32 v124,v44,v45,v46
v_max_u32 v124,v124,v47
v_cmp_eq_u32 vcc,-1,v124
s_cbranch_vccnz rfa_100548
buffer_load_dword v125,off,s[20:23],s92 sc1
s_bitset0_b32 s55,7
s_cmp_eq_u32 s55,0
s_cbranch_scc1 segb_100444
s_branch rnx_100549
rdn_100547:
buffer_load_dword v125,off,s[20:23],s92 sc1
s_branch rnx_100549
rfa_100548:
buffer_load_dwordx4 v[44:47],v0,s[20:23],s93 offen offset:3072 sc1
rnx_100549:
s_sub_u32 s90,s90,1
s_cmp_gt_i32 s90,0
s_cbranch_scc1 rot_100528
s_mov_b32 s55,0
s_branch segb_100444
fl_100451:
v_smfmac_f32_16x16x64_bf16 v[76:79],v[32:35],a[56:63],v1
flb_100459:
buffer_load_dwordx4 v[36:39],v0,s[20:23],s93 offen offset:1024 sc1
s_mov_b32 s55,224
s_bitcmp1_b32 s55,6
s_cbranch_scc0 rdn_100551
s_waitcnt vmcnt(5)
v_max3_u32 v124,v40,v41,v42
v_max_u32 v124,v124,v43
v_cmp_eq_u32 vcc,-1,v124
s_cbranch_vccnz rfa_100552
buffer_load_dword v125,off,s[20:23],s92 sc1
s_bitset0_b32 s55,6
s_cmp_eq_u32 s55,0
s_cbranch_scc1 segb_100444
s_branch rnx_100553
rdn_100551:
buffer_load_dword v125,off,s[20:23],s92 sc1
s_branch rnx_100553
rfa_100552:
buffer_load_dwordx4 v[40:43],v0,s[20:23],s93 offen offset:2048 sc1
rnx_100553:
s_bitcmp1_b32 s55,7
s_cbranch_scc0 rdn_100554
s_waitcnt vmcnt(5)
v_max3_u32 v124,v44,v45,v46
v_max_u32 v124,v124,v47
v_cmp_eq_u32 vcc,-1,v124
s_cbranch_vccnz rfa_100555
buffer_load_dword v125,off,s[20:23],s92 sc1
s_bitset0_b32 s55,7
s_cmp_eq_u32 s55,0
s_cbranch_scc1 segb_100444
s_branch rnx_100556
rdn_100554:
buffer_load_dword v125,off,s[20:23],s92 sc1
s_branch rnx_100556
rfa_100555:
buffer_load_dwordx4 v[44:47],v0,s[20:23],s93 offen offset:3072 sc1
rnx_100556:
rot_100550:
s_bitcmp1_b32 s55,5
s_cbranch_scc0 rdn_100557
s_waitcnt vmcnt(2)
v_max3_u32 v124,v36,v37,v38
v_max_u32 v124,v124,v39
v_cmp_eq_u32 vcc,-1,v124
s_cbranch_vccnz rfa_100558
buffer_load_dword v125,off,s[20:23],s92 sc1
s_bitset0_b32 s55,5
v_smfmac_f32_16x16x64_bf16 v[48:51],v[36:39],a[64:71],v1
v_smfmac_f32_16x16x64_bf16 v[52:55],v[36:39],a[72:79],v1
v_smfmac_f32_16x16x64_bf16 v[56:59],v[36:39],a[80:87],v1
v_smfmac_f32_16x16x64_bf16 v[60:63],v[36:39],a[88:95],v1
v_smfmac_f32_16x16x64_bf16 v[64:67],v[36:39],a[96:103],v1
v_smfmac_f32_16x16x64_bf16 v[68:71],v[36:39],a[104:111],v1
v_smfmac_f32_16x16x64_bf16 v[72:75],v[36:39],a[112:119],v1
v_smfmac_f32_16x16x64_bf16 v[76:79],v[36:39],a[120:127],v1
s_cmp_eq_u32 s55,0
s_cbranch_scc1 segb_100444
s_branch rnx_100559
rdn_100557:
buffer_load_dword v125,off,s[20:23],s92 sc1
s_branch rnx_100559
rfa_100558:
buffer_load_dwordx4 v[36:39],v0,s[20:23],s93 offen offset:1024 sc1
rnx_100559:
s_bitcmp1_b32 s55,6
s_cbranch_scc0 rdn_100560
s_waitcnt vmcnt(2)
v_max3_u32 v124,v40,v41,v42
v_max_u32 v124,v124,v43
v_cmp_eq_u32 vcc,-1,v124
s_cbranch_vccnz rfa_100561
buffer_load_dword v125,off,s[20:23],s92 sc1
s_bitset0_b32 s55,6
s_cmp_eq_u32 s55,0
s_cbranch_scc1 segb_100444
s_branch rnx_100562
rdn_100560:
buffer_load_dword v125,off,s[20:23],s92 sc1
s_branch rnx_100562
rfa_100561:
buffer_load_dwordx4 v[40:43],v0,s[20:23],s93 offen offset:2048 sc1
rnx_100562:
s_bitcmp1_b32 s55,7
s_cbranch_scc0 rdn_100563
s_waitcnt vmcnt(2)
v_max3_u32 v124,v44,v45,v46
v_max_u32 v124,v124,v47
v_cmp_eq_u32 vcc,-1,v124
s_cbranch_vccnz rfa_100564
buffer_load_dword v125,off,s[20:23],s92 sc1
s_bitset0_b32 s55,7
s_cmp_eq_u32 s55,0
s_cbranch_scc1 segb_100444
s_branch rnx_100565
rdn_100563:
buffer_load_dword v125,off,s[20:23],s92 sc1
s_branch rnx_100565
rfa_100564:
buffer_load_dwordx4 v[44:47],v0,s[20:23],s93 offen offset:3072 sc1
rnx_100565:
s_sub_u32 s90,s90,1
s_cmp_gt_i32 s90,0
s_cbranch_scc1 rot_100550
s_mov_b32 s55,0
s_branch segb_100444
fl_100452:
v_smfmac_f32_16x16x64_bf16 v[76:79],v[36:39],a[120:127],v1
flb_100460:
s_mov_b32 s55,192
s_bitcmp1_b32 s55,6
s_cbranch_scc0 rdn_100567
s_waitcnt vmcnt(5)
v_max3_u32 v124,v40,v41,v42
v_max_u32 v124,v124,v43
v_cmp_eq_u32 vcc,-1,v124
s_cbranch_vccnz rfa_100568
buffer_load_dword v125,off,s[20:23],s92 sc1
s_bitset0_b32 s55,6
s_cmp_eq_u32 s55,0
s_cbranch_scc1 segb_100444
s_branch rnx_100569
rdn_100567:
buffer_load_dword v125,off,s[20:23],s92 sc1
s_branch rnx_100569
rfa_100568:
buffer_load_dwordx4 v[40:43],v0,s[20:23],s93 offen offset:2048 sc1
rnx_100569:
s_bitcmp1_b32 s55,7
s_cbranch_scc0 rdn_100570
s_waitcnt vmcnt(5)
v_max3_u32 v124,v44,v45,v46
v_max_u32 v124,v124,v47
v_cmp_eq_u32 vcc,-1,v124
s_cbranch_vccnz rfa_100571
buffer_load_dword v125,off,s[20:23],s92 sc1
s_bitset0_b32 s55,7
s_cmp_eq_u32 s55,0
s_cbranch_scc1 segb_100444
s_branch rnx_100572
rdn_100570:
buffer_load_dword v125,off,s[20:23],s92 sc1
s_branch rnx_100572
rfa_100571:
buffer_load_dwordx4 v[44:47],v0,s[20:23],s93 offen offset:3072 sc1
rnx_100572:
rot_100566:
s_bitcmp1_b32 s55,6
s_cbranch_scc0 rdn_100573
s_waitcnt vmcnt(1)
v_max3_u32 v124,v40,v41,v42
v_max_u32 v124,v124,v43
v_cmp_eq_u32 vcc,-1,v124
s_cbranch_vccnz rfa_100574
buffer_load_dword v125,off,s[20:23],s92 sc1
s_bitset0_b32 s55,6
s_cmp_eq_u32 s55,0
s_cbranch_scc1 segb_100444
s_branch rnx_100575
rdn_100573:
buffer_load_dword v125,off,s[20:23],s92 sc1
s_branch rnx_100575
rfa_100574:
buffer_load_dwordx4 v[40:43],v0,s[20:23],s93 offen offset:2048 sc1
rnx_100575:
s_bitcmp1_b32 s55,7
s_cbranch_scc0 rdn_100576
s_waitcnt vmcnt(1)
v_max3_u32 v124,v44,v45,v46
v_max_u32 v124,v124,v47
v_cmp_eq_u32 vcc,-1,v124
s_cbranch_vccnz rfa_100577
buffer_load_dword v125,off,s[20:23],s92 sc1
s_bitset0_b32 s55,7
s_cmp_eq_u32 s55,0
s_cbranch_scc1 segb_100444
s_branch rnx_100578
rdn_100576:
buffer_load_dword v125,off,s[20:23],s92 sc1
s_branch rnx_100578
rfa_100577:
buffer_load_dwordx4 v[44:47],v0,s[20:23],s93 offen offset:3072 sc1
rnx_100578:
s_sub_u32 s90,s90,1
s_cmp_gt_i32 s90,0
s_cbranch_scc1 rot_100566
s_mov_b32 s55,0
s_branch segb_100444
dfl_100519:
buffer_load_dwordx4 v[20:23],v0,s[20:23],s92 offen offset:1024 sc1
s_bitset1_b32 s55,1
buffer_load_dwordx4 v[36:39],v0,s[20:23],s93 offen offset:1024 sc1
s_waitcnt vmcnt(5)
v_max3_u32 v124,v24,v25,v26
v_max_u32 v124,v124,v27
v_cmp_eq_u32 vcc,-1,v124
s_cbranch_vccnz dfl_100520
s_branch dseg_100523
dfl_100520:
buffer_load_dwordx4 v[24:27],v0,s[20:23],s92 offen offset:2048 sc1
s_bitset1_b32 s55,2
buffer_load_dwordx4 v[40:43],v0,s[20:23],s93 offen offset:2048 sc1
buffer_load_dwordx4 v[44:47],v0,s[20:23],s93 offen offset:3072 sc1
s_waitcnt vmcnt(7)
v_max3_u32 v124,v28,v29,v30
v_max_u32 v124,v124,v31
v_cmp_eq_u32 vcc,-1,v124
s_cbranch_vccnz dfl_100521
s_branch dseg_100524
dfl_100521:
buffer_load_dwordx4 v[28:31],v0,s[20:23],s92 offen offset:3072 sc1
s_bitset1_b32 s55,3
buffer_store_dword v126,v121,s[20:23],s69 offen sc1
s_branch lap2_100525
dseg_100523:
v_smfmac_f32_16x16x64_bf16 v[48:51],v[24:27],a[128:135],v1
buffer_load_dword v125,off,s[20:23],s92 sc1
v_smfmac_f32_16x16x64_bf16 v[52:55],v[24:27],a[136:143],v1
buffer_load_dwordx4 v[40:43],v0,s[20:23],s93 offen offset:2048 sc1
v_smfmac_f32_16x16x64_bf16 v[56:59],v[24:27],a[144:151],v1
buffer_load_dwordx4 v[44:47],v0,s[20:23],s93 offen offset:3072 sc1
s_waitcnt vmcnt(7)
v_max3_u32 v124,v28,v29,v30
v_smfmac_f32_16x16x64_bf16 v[60:63],v[24:27],a[152:159],v1
v_max_u32 v124,v124,v31
v_smfmac_f32_16x16x64_bf16 v[64:67],v[24:27],a[160:167],v1
v_cmp_eq_u32 vcc,-1,v124
v_smfmac_f32_16x16x64_bf16 v[68:71],v[24:27],a[168:175],v1
v_smfmac_f32_16x16x64_bf16 v[72:75],v[24:27],a[176:183],v1
v_smfmac_f32_16x16x64_bf16 v[76:79],v[24:27],a[184:191],v1
s_cbranch_vccnz dfl_100521
dseg_100524:
v_smfmac_f32_16x16x64_bf16 v[48:51],v[28:31],a[192:199],v1
buffer_load_dword v125,off,s[20:23],s92 sc1
v_smfmac_f32_16x16x64_bf16 v[52:55],v[28:31],a[200:207],v1
buffer_store_dword v126,v121,s[20:23],s69 offen sc1
v_smfmac_f32_16x16x64_bf16 v[56:59],v[28:31],a[208:215],v1
v_smfmac_f32_16x16x64_bf16 v[60:63],v[28:31],a[216:223],v1
v_smfmac_f32_16x16x64_bf16 v[64:67],v[28:31],a[224:231],v1
v_smfmac_f32_16x16x64_bf16 v[68:71],v[28:31],a[232:239],v1
v_smfmac_f32_16x16x64_bf16 v[72:75],v[28:31],a[240:247],v1
v_smfmac_f32_16x16x64_bf16 v[76:79],v[28:31],a[248:255],v1
lap2_100525:
s_bitcmp1_b32 s55,0
s_cbranch_scc0 l2s_100579
s_waitcnt vmcnt(8)
v_max3_u32 v124,v16,v17,v18
v_max_u32 v124,v124,v19
v_cmp_eq_u32 vcc,-1,v124
s_cbranch_vccnz l2s_100579
s_bitset0_b32 s55,0
v_smfmac_f32_16x16x64_bf16 v[48:51],v[16:19],a[0:7],v1
v_smfmac_f32_16x16x64_bf16 v[52:55],v[16:19],a[8:15],v1
v_smfmac_f32_16x16x64_bf16 v[56:59],v[16:19],a[16:23],v1
v_smfmac_f32_16x16x64_bf16 v[60:63],v[16:19],a[24:31],v1
v_smfmac_f32_16x16x64_bf16 v[64:67],v[16:19],a[32:39],v1
v_smfmac_f32_16x16x64_bf16 v[68:71],v[16:19],a[40:47],v1
v_smfmac_f32_16x16x64_bf16 v[72:75],v[16:19],a[48:55],v1
v_smfmac_f32_16x16x64_bf16 v[76:79],v[16:19],a[56:63],v1
l2s_100579:
s_bitcmp1_b32 s55,1
s_cbranch_scc0 l2s_100581
s_waitcnt vmcnt(6)
v_max3_u32 v124,v20,v21,v22
v_max_u32 v124,v124,v23
v_cmp_eq_u32 vcc,-1,v124
s_cbranch_vccnz l2s_100581
s_bitset0_b32 s55,1
v_smfmac_f32_16x16x64_bf16 v[48:51],v[20:23],a[64:71],v1
v_smfmac_f32_16x16x64_bf16 v[52:55],v[20:23],a[72:79],v1
v_smfmac_f32_16x16x64_bf16 v[56:59],v[20:23],a[80:87],v1
v_smfmac_f32_16x16x64_bf16 v[60:63],v[20:23],a[88:95],v1
v_smfmac_f32_16x16x64_bf16 v[64:67],v[20:23],a[96:103],v1
v_smfmac_f32_16x16x64_bf16 v[68:71],v[20:23],a[104:111],v1
v_smfmac_f32_16x16x64_bf16 v[72:75],v[20:23],a[112:119],v1
v_smfmac_f32_16x16x64_bf16 v[76:79],v[20:23],a[120:127],v1
l2s_100581:
s_bitcmp1_b32 s55,2
s_cbranch_scc0 l2s_100583
s_waitcnt vmcnt(4)
v_max3_u32 v124,v24,v25,v26
v_max_u32 v124,v124,v27
v_cmp_eq_u32 vcc,-1,v124
s_cbranch_vccnz l2s_100583
s_bitset0_b32 s55,2
v_smfmac_f32_16x16x64_bf16 v[48:51],v[24:27],a[128:135],v1
v_smfmac_f32_16x16x64_bf16 v[52:55],v[24:27],a[136:143],v1
v_smfmac_f32_16x16x64_bf16 v[56:59],v[24:27],a[144:151],v1
v_smfmac_f32_16x16x64_bf16 v[60:63],v[24:27],a[152:159],v1
v_smfmac_f32_16x16x64_bf16 v[64:67],v[24:27],a[160:167],v1
v_smfmac_f32_16x16x64_bf16 v[68:71],v[24:27],a[168:175],v1
v_smfmac_f32_16x16x64_bf16 v[72:75],v[24:27],a[176:183],v1
v_smfmac_f32_16x16x64_bf16 v[76:79],v[24:27],a[184:191],v1
l2s_100583:
s_bitcmp1_b32 s55,3
s_cbranch_scc0 l2s_100585
s_waitcnt vmcnt(1)
v_max3_u32 v124,v28,v29,v30
v_max_u32 v124,v124,v31
v_cmp_eq_u32 vcc,-1,v124
s_cbranch_vccnz l2s_100585
s_bitset0_b32 s55,3
v_smfmac_f32_16x16x64_bf16 v[48:51],v[28:31],a[192:199],v1
v_smfmac_f32_16x16x64_bf16 v[52:55],v[28:31],a[200:207],v1
v_smfmac_f32_16x16x64_bf16 v[56:59],v[28:31],a[208:215],v1
v_smfmac_f32_16x16x64_bf16 v[60:63],v[28:31],a[216:223],v1
v_smfmac_f32_16x16x64_bf16 v[64:67],v[28:31],a[224:231],v1
v_smfmac_f32_16x16x64_bf16 v[68:71],v[28:31],a[232:239],v1
v_smfmac_f32_16x16x64_bf16 v[72:75],v[28:31],a[240:247],v1
v_smfmac_f32_16x16x64_bf16 v[76:79],v[28:31],a[248:255],v1
l2s_100585:
s_cmp_eq_u32 s55,0
s_cbranch_scc0 lfb_100526
Ldone_100527:
s_waitcnt vmcnt(7)
v_max3_u32 v124,v32,v33,v34
v_max_u32 v124,v124,v35
v_cmp_eq_u32 vcc,-1,v124
s_cbranch_vccnz flb_100458
s_branch segb_100442
lfb_100526:
s_bitcmp1_b32 s55,0
s_cbranch_scc0 dsk_100587
buffer_load_dwordx4 v[16:19],v0,s[20:23],s92 offen offset:0 sc1
dsk_100587:
s_bitcmp1_b32 s55,1
s_cbranch_scc0 dsk_100588
buffer_load_dwordx4 v[20:23],v0,s[20:23],s92 offen offset:1024 sc1
dsk_100588:
s_bitcmp1_b32 s55,2
s_cbranch_scc0 dsk_100589
buffer_load_dwordx4 v[24:27],v0,s[20:23],s92 offen offset:2048 sc1
dsk_100589:
s_bitcmp1_b32 s55,3
s_cbranch_scc0 dsk_100590
buffer_load_dwordx4 v[28:31],v0,s[20:23],s92 offen offset:3072 sc1
dsk_100590:
s_bitcmp1_b32 s55,0
s_cbranch_scc0 dsk_100591
s_waitcnt vmcnt(2)
v_max3_u32 v124,v16,v17,v18
v_max_u32 v124,v124,v19
v_cmp_eq_u32 vcc,-1,v124
s_cbranch_vccz dgo_100592
s_nop 15
buffer_load_dwordx4 v[104:107],v0,s[20:23],s92 offen offset:0 sc1
s_nop 15
buffer_load_dwordx4 v[108:111],v0,s[20:23],s92 offen offset:0 sc1
dlp_100593:
s_waitcnt vmcnt(2)
v_max3_u32 v124,v16,v17,v18
v_max_u32 v124,v124,v19
v_cmp_eq_u32 vcc,-1,v124
s_cbranch_vccz dgo_100592
buffer_load_dwordx4 v[16:19],v0,s[20:23],s92 offen offset:0 sc1
s_waitcnt vmcnt(2)
v_max3_u32 v124,v104,v105,v106
v_max_u32 v124,v124,v107
v_cmp_eq_u32 vcc,-1,v124
s_cbranch_vccz dcp_100595
buffer_load_dwordx4 v[104:107],v0,s[20:23],s92 offen offset:0 sc1
s_waitcnt vmcnt(2)
v_max3_u32 v124,v108,v109,v110
v_max_u32 v124,v124,v111
v_cmp_eq_u32 vcc,-1,v124
s_cbranch_vccz dcp_100596
buffer_load_dwordx4 v[108:111],v0,s[20:23],s92 offen offset:0 sc1
s_sub_u32 s90,s90,1
s_cmp_gt_i32 s90,0
s_cbranch_scc1 dlp_100593
s_branch dgo_100592
dcp_100595:
v_mov_b32 v16,v104
v_mov_b32 v17,v105
v_mov_b32 v18,v106
v_mov_b32 v19,v107
s_nop 1
s_branch dgo_100592
dcp_100596:
v_mov_b32 v16,v108
v_mov_b32 v17,v109
v_mov_b32 v18,v110
v_mov_b32 v19,v111
s_nop 1
dgo_100592:
v_smfmac_f32_16x16x64_bf16 v[48:51],v[16:19],a[0:7],v1
v_smfmac_f32_16x16x64_bf16 v[52:55],v[16:19],a[8:15],v1
v_smfmac_f32_16x16x64_bf16 v[56:59],v[16:19],a[16:23],v1
v_smfmac_f32_16x16x64_bf16 v[60:63],v[16:19],a[24:31],v1
v_smfmac_f32_16x16x64_bf16 v[64:67],v[16:19],a[32:39],v1
v_smfmac_f32_16x16x64_bf16 v[68:71],v[16:19],a[40:47],v1
v_smfmac_f32_16x16x64_bf16 v[72:75],v[16:19],a[48:55],v1
v_smfmac_f32_16x16x64_bf16 v[76:79],v[16:19],a[56:63],v1
dsk_100591:
s_bitcmp1_b32 s55,1
s_cbranch_scc0 dsk_100597
s_waitcnt vmcnt(2)
v_max3_u32 v124,v20,v21,v22
v_max_u32 v124,v124,v23
v_cmp_eq_u32 vcc,-1,v124
s_cbranch_vccz dgo_100598
s_nop 15
buffer_load_dwordx4 v[104:107],v0,s[20:23],s92 offen offset:1024 sc1
s_nop 15
buffer_load_dwordx4 v[108:111],v0,s[20:23],s92 offen offset:1024 sc1
dlp_100599:
s_waitcnt vmcnt(2)
v_max3_u32 v124,v20,v21,v22
v_max_u32 v124,v124,v23
v_cmp_eq_u32 vcc,-1,v124
s_cbranch_vccz dgo_100598
buffer_load_dwordx4 v[20:23],v0,s[20:23],s92 offen offset:1024 sc1
s_waitcnt vmcnt(2)
v_max3_u32 v124,v104,v105,v106
v_max_u32 v124,v124,v107
v_cmp_eq_u32 vcc,-1,v124
s_cbranch_vccz dcp_100601
buffer_load_dwordx4 v[104:107],v0,s[20:23],s92 offen offset:1024 sc1
s_waitcnt vmcnt(2)
v_max3_u32 v124,v108,v109,v110
v_max_u32 v124,v124,v111
v_cmp_eq_u32 vcc,-1,v124
s_cbranch_vccz dcp_100602
buffer_load_dwordx4 v[108:111],v0,s[20:23],s92 offen offset:1024 sc1
s_sub_u32 s90,s90,1
s_cmp_gt_i32 s90,0
s_cbranch_scc1 dlp_100599
s_branch dgo_100598
dcp_100601:
v_mov_b32 v20,v104
v_mov_b32 v21,v105
v_mov_b32 v22,v106
v_mov_b32 v23,v107
s_nop 1
s_branch dgo_100598
dcp_100602:
v_mov_b32 v20,v108
v_mov_b32 v21,v109
v_mov_b32 v22,v110
v_mov_b32 v23,v111
s_nop 1
dgo_100598:
v_smfmac_f32_16x16x64_bf16 v[48:51],v[20:23],a[64:71],v1
v_smfmac_f32_16x16x64_bf16 v[52:55],v[20:23],a[72:79],v1
v_smfmac_f32_16x16x64_bf16 v[56:59],v[20:23],a[80:87],v1
v_smfmac_f32_16x16x64_bf16 v[60:63],v[20:23],a[88:95],v1
v_smfmac_f32_16x16x64_bf16 v[64:67],v[20:23],a[96:103],v1
v_smfmac_f32_16x16x64_bf16 v[68:71],v[20:23],a[104:111],v1
v_smfmac_f32_16x16x64_bf16 v[72:75],v[20:23],a[112:119],v1
v_smfmac_f32_16x16x64_bf16 v[76:79],v[20:23],a[120:127],v1
dsk_100597:
s_bitcmp1_b32 s55,2
s_cbranch_scc0 dsk_100603
s_waitcnt vmcnt(2)
v_max3_u32 v124,v24,v25,v26
v_max_u32 v124,v124,v27
v_cmp_eq_u32 vcc,-1,v124
s_cbranch_vccz dgo_100604
s_nop 15
buffer_load_dwordx4 v[104:107],v0,s[20:23],s92 offen offset:2048 sc1
s_nop 15
buffer_load_dwordx4 v[108:111],v0,s[20:23],s92 offen offset:2048 sc1
dlp_100605:
s_waitcnt vmcnt(2)
v_max3_u32 v124,v24,v25,v26
v_max_u32 v124,v124,v27
v_cmp_eq_u32 vcc,-1,v124
s_cbranch_vccz dgo_100604
buffer_load_dwordx4 v[24:27],v0,s[20:23],s92 offen offset:2048 sc1
s_waitcnt vmcnt(2)
v_max3_u32 v124,v104,v105,v106
v_max_u32 v124,v124,v107
v_cmp_eq_u32 vcc,-1,v124
s_cbranch_vccz dcp_100607
buffer_load_dwordx4 v[104:107],v0,s[20:23],s92 offen offset:2048 sc1
s_waitcnt vmcnt(2)
v_max3_u32 v124,v108,v109,v110
v_max_u32 v124,v124,v111
v_cmp_eq_u32 vcc,-1,v124
s_cbranch_vccz dcp_100608
buffer_load_dwordx4 v[108:111],v0,s[20:23],s92 offen offset:2048 sc1
s_sub_u32 s90,s90,1
s_cmp_gt_i32 s90,0
s_cbranch_scc1 dlp_100605
s_branch dgo_100604
dcp_100607:
v_mov_b32 v24,v104
v_mov_b32 v25,v105
v_mov_b32 v26,v106
v_mov_b32 v27,v107
s_nop 1
s_branch dgo_100604
dcp_100608:
v_mov_b32 v24,v108
v_mov_b32 v25,v109
v_mov_b32 v26,v110
v_mov_b32 v27,v111
s_nop 1
dgo_100604:
v_smfmac_f32_16x16x64_bf16 v[48:51],v[24:27],a[128:135],v1
v_smfmac_f32_16x16x64_bf16 v[52:55],v[24:27],a[136:143],v1
v_smfmac_f32_16x16x64_bf16 v[56:59],v[24:27],a[144:151],v1
v_smfmac_f32_16x16x64_bf16 v[60:63],v[24:27],a[152:159],v1
v_smfmac_f32_16x16x64_bf16 v[64:67],v[24:27],a[160:167],v1
v_smfmac_f32_16x16x64_bf16 v[68:71],v[24:27],a[168:175],v1
v_smfmac_f32_16x16x64_bf16 v[72:75],v[24:27],a[176:183],v1
v_smfmac_f32_16x16x64_bf16 v[76:79],v[24:27],a[184:191],v1
dsk_100603:
s_bitcmp1_b32 s55,3
s_cbranch_scc0 dsk_100609
s_waitcnt vmcnt(2)
v_max3_u32 v124,v28,v29,v30
v_max_u32 v124,v124,v31
v_cmp_eq_u32 vcc,-1,v124
s_cbranch_vccz dgo_100610
s_nop 15
buffer_load_dwordx4 v[104:107],v0,s[20:23],s92 offen offset:3072 sc1
s_nop 15
buffer_load_dwordx4 v[108:111],v0,s[20:23],s92 offen offset:3072 sc1
dlp_100611:
s_waitcnt vmcnt(2)
v_max3_u32 v124,v28,v29,v30
v_max_u32 v124,v124,v31
v_cmp_eq_u32 vcc,-1,v124
s_cbranch_vccz dgo_100610
buffer_load_dwordx4 v[28:31],v0,s[20:23],s92 offen offset:3072 sc1
s_waitcnt vmcnt(2)
v_max3_u32 v124,v104,v105,v106
v_max_u32 v124,v124,v107
v_cmp_eq_u32 vcc,-1,v124
s_cbranch_vccz dcp_100613
buffer_load_dwordx4 v[104:107],v0,s[20:23],s92 offen offset:3072 sc1
s_waitcnt vmcnt(2)
v_max3_u32 v124,v108,v109,v110
v_max_u32 v124,v124,v111
v_cmp_eq_u32 vcc,-1,v124
s_cbranch_vccz dcp_100614
buffer_load_dwordx4 v[108:111],v0,s[20:23],s92 offen offset:3072 sc1
s_sub_u32 s90,s90,1
s_cmp_gt_i32 s90,0
s_cbranch_scc1 dlp_100611
s_branch dgo_100610
dcp_100613:
v_mov_b32 v28,v104
v_mov_b32 v29,v105
v_mov_b32 v30,v106
v_mov_b32 v31,v107
s_nop 1
s_branch dgo_100610
dcp_100614:
v_mov_b32 v28,v108
v_mov_b32 v29,v109
v_mov_b32 v30,v110
v_mov_b32 v31,v111
s_nop 1
dgo_100610:
v_smfmac_f32_16x16x64_bf16 v[48:51],v[28:31],a[192:199],v1
v_smfmac_f32_16x16x64_bf16 v[52:55],v[28:31],a[200:207],v1
v_smfmac_f32_16x16x64_bf16 v[56:59],v[28:31],a[208:215],v1
v_smfmac_f32_16x16x64_bf16 v[60:63],v[28:31],a[216:223],v1
v_smfmac_f32_16x16x64_bf16 v[64:67],v[28:31],a[224:231],v1
v_smfmac_f32_16x16x64_bf16 v[68:71],v[28:31],a[232:239],v1
v_smfmac_f32_16x16x64_bf16 v[72:75],v[28:31],a[240:247],v1
v_smfmac_f32_16x16x64_bf16 v[76:79],v[28:31],a[248:255],v1
dsk_100609:
s_mov_b32 s55,0
s_branch Ldone_100527
slowA_100462:
buffer_load_dwordx4 v[44:47],v0,s[20:23],s93 offen offset:3072 sc1
dsk_100615:
s_bitcmp1_b32 s55,7
s_cbranch_scc0 dsk_100616
s_waitcnt vmcnt(2)
v_max3_u32 v124,v44,v45,v46
v_max_u32 v124,v124,v47
v_cmp_eq_u32 vcc,-1,v124
s_cbranch_vccz dgo_100617
s_nop 15
s_nop 3
buffer_load_dwordx4 v[104:107],v0,s[20:23],s93 offen offset:3072 sc1
s_nop 15
s_nop 3
buffer_load_dwordx4 v[108:111],v0,s[20:23],s93 offen offset:3072 sc1
dlp_100618:
s_waitcnt vmcnt(2)
v_max3_u32 v124,v44,v45,v46
v_max_u32 v124,v124,v47
v_cmp_eq_u32 vcc,-1,v124
s_cbranch_vccz dgo_100617
buffer_load_dwordx4 v[44:47],v0,s[20:23],s93 offen offset:3072 sc1
s_waitcnt vmcnt(2)
v_max3_u32 v124,v104,v105,v106
v_max_u32 v124,v124,v107
v_cmp_eq_u32 vcc,-1,v124
s_cbranch_vccz dcp_100620
buffer_load_dwordx4 v[104:107],v0,s[20:23],s93 offen offset:3072 sc1
s_waitcnt vmcnt(2)
v_max3_u32 v124,v108,v109,v110
v_max_u32 v124,v124,v111
v_cmp_eq_u32 vcc,-1,v124
s_cbranch_vccz dcp_100621
buffer_load_dwordx4 v[108:111],v0,s[20:23],s93 offen offset:3072 sc1
s_sub_u32 s90,s90,1
s_cmp_gt_i32 s90,0
s_cbranch_scc1 dlp_100618
s_branch dgo_100617
dcp_100620:
v_mov_b32 v44,v104
v_mov_b32 v45,v105
v_mov_b32 v46,v106
v_mov_b32 v47,v107
s_nop 1
s_branch dgo_100617
dcp_100621:
v_mov_b32 v44,v108
v_mov_b32 v45,v109
v_mov_b32 v46,v110
v_mov_b32 v47,v111
s_nop 1
dgo_100617:
dsk_100616:
s_mov_b32 s55,0
s_branch segb_100444
srt_100470:
s_sub_u32 s90,s90,1
s_cmp_gt_i32 s90,0
s_cbranch_scc0 sok_100469
buffer_load_dwordx4 v[16:19],v2,s[20:23],s94 offen offset:0 sc1
buffer_load_dwordx4 v[32:35],v2,s[20:23],s94 offen offset:1536 sc1
buffer_load_dwordx4 v[20:23],v2,s[20:23],s95 offen offset:0 sc1
buffer_load_dwordx4 v[36:39],v2,s[20:23],s95 offen offset:1536 sc1
buffer_load_dword v120,v3,s[20:23],s94 offen offset:0 sc1
buffer_load_dword v121,v3,s[20:23],s94 offen offset:1536 sc1
buffer_load_dword v122,v3,s[20:23],s95 offen offset:0 sc1
buffer_load_dword v123,v3,s[20:23],s95 offen offset:1536 sc1
s_branch sp_100468
of_100471:
s_mov_b32 s55,3
buffer_load_dwordx4 v[16:19],v0,s[20:23],s96 offen offset:0 sc1
buffer_load_dwordx4 v[20:23],v0,s[20:23],s96 offen offset:1024 sc1
v_readfirstlane_b32 s91,v126
s_waitcnt vmcnt(6)
v_max3_u32 v124,v24,v25,v26
v_max3_u32 v124,v124,v27,v28
v_max3_u32 v124,v124,v29,v30
v_max_u32 v124,v124,v31
v_cmp_eq_u32 vcc,-1,v124
s_cbranch_vccnz ost_100623
v_smfmac_f32_16x16x64_bf16 v[96:99],v[24:27],v[80:87],v1
buffer_load_dword v120,off,s[20:23],s96 sc1
v_smfmac_f32_16x16x64_bf16 v[100:103],v[24:27],v[88:95],v1
buffer_load_dword v120,off,s[20:23],s96 sc1
v_smfmac_f32_16x16x64_bf16 v[96:99],v[28:31],v[128:135],v1
v_smfmac_f32_16x16x64_bf16 v[100:103],v[28:31],v[136:143],v1
ort_100624:
s_waitcnt vmcnt(6)
v_max3_u32 v124,v32,v33,v34
v_max3_u32 v124,v124,v35,v36
v_max3_u32 v124,v124,v37,v38
v_max_u32 v124,v124,v39
v_cmp_eq_u32 vcc,-1,v124
s_cbranch_vccnz ost_100625
v_smfmac_f32_16x16x64_bf16 v[96:99],v[32:35],v[144:151],v1
buffer_load_dword v120,off,s[20:23],s96 sc1
v_smfmac_f32_16x16x64_bf16 v[100:103],v[32:35],v[152:159],v1
buffer_load_dword v120,off,s[20:23],s96 sc1
v_smfmac_f32_16x16x64_bf16 v[96:99],v[36:39],v[160:167],v1
v_smfmac_f32_16x16x64_bf16 v[100:103],v[36:39],v[168:175],v1
ort_100626:
s_waitcnt vmcnt(7)
v_max3_u32 v124,v40,v41,v42
v_max_u32 v124,v124,v43
v_cmp_eq_u32 vcc,-1,v124
s_cbranch_vccnz ost_100627
v_smfmac_f32_16x16x64_bf16 v[96:99],v[40:43],v[176:183],v1
buffer_load_dword v120,off,s[20:23],s96 sc1
v_smfmac_f32_16x16x64_bf16 v[100:103],v[40:43],v[184:191],v1
ort_100628:
s_waitcnt vmcnt(7)
v_max3_u32 v124,v44,v45,v46
v_max_u32 v124,v124,v47
v_cmp_eq_u32 vcc,-1,v124
s_cbranch_vccnz ost_100629
v_smfmac_f32_16x16x64_bf16 v[96:99],v[44:47],v[192:199],v1
buffer_load_dword v120,off,s[20:23],s96 sc1
v_smfmac_f32_16x16x64_bf16 v[100:103],v[44:47],v[200:207],v1
ort_100630:
s_waitcnt vmcnt(6)
v_max3_u32 v124,v16,v17,v18
v_max3_u32 v124,v124,v19,v20
v_max3_u32 v124,v124,v21,v22
v_max_u32 v124,v124,v23
v_cmp_eq_u32 vcc,-1,v124
s_cbranch_vccnz olap2_100622
s_andn2_b32 s55,s55,3
v_smfmac_f32_16x16x64_bf16 v[96:99],v[16:19],v[48:55],v1
v_smfmac_f32_16x16x64_bf16 v[100:103],v[16:19],v[56:63],v1
v_smfmac_f32_16x16x64_bf16 v[96:99],v[20:23],v[64:71],v1
v_smfmac_f32_16x16x64_bf16 v[100:103],v[20:23],v[72:79],v1
s_cbranch_scc0 oback_100482
s_branch olap2_100622
ost_100623:
buffer_load_dwordx4 v[24:27],v0,s[20:23],s96 offen offset:2048 sc1
buffer_load_dwordx4 v[28:31],v0,s[20:23],s96 offen offset:3072 sc1
s_or_b32 s55,s55,12
s_branch ort_100624
ost_100625:
buffer_load_dwordx4 v[32:35],v0,s[20:23],s97 offen offset:0 sc1
buffer_load_dwordx4 v[36:39],v0,s[20:23],s97 offen offset:1024 sc1
s_or_b32 s55,s55,48
s_branch ort_100626
ost_100627:
buffer_load_dwordx4 v[40:43],v0,s[20:23],s97 offen offset:2048 sc1
s_or_b32 s55,s55,64
s_branch ort_100628
ost_100629:
buffer_load_dwordx4 v[44:47],v0,s[20:23],s97 offen offset:3072 sc1
s_or_b32 s55,s55,128
s_branch ort_100630
of_100472:
s_mov_b32 s55,12
buffer_load_dwordx4 v[24:27],v0,s[20:23],s96 offen offset:2048 sc1
buffer_load_dwordx4 v[28:31],v0,s[20:23],s96 offen offset:3072 sc1
s_waitcnt vmcnt(4)
v_max3_u32 v124,v32,v33,v34
v_max3_u32 v124,v124,v35,v36
v_max3_u32 v124,v124,v37,v38
v_max_u32 v124,v124,v39
v_cmp_eq_u32 vcc,-1,v124
s_cbranch_vccnz ost_100632
v_smfmac_f32_16x16x64_bf16 v[96:99],v[32:35],v[144:151],v1
buffer_load_dword v120,off,s[20:23],s96 sc1
v_smfmac_f32_16x16x64_bf16 v[100:103],v[32:35],v[152:159],v1
buffer_load_dword v120,off,s[20:23],s96 sc1
v_smfmac_f32_16x16x64_bf16 v[96:99],v[36:39],v[160:167],v1
v_smfmac_f32_16x16x64_bf16 v[100:103],v[36:39],v[168:175],v1
ort_100633:
s_waitcnt vmcnt(5)
v_max3_u32 v124,v40,v41,v42
v_max_u32 v124,v124,v43
v_cmp_eq_u32 vcc,-1,v124
s_cbranch_vccnz ost_100634
v_smfmac_f32_16x16x64_bf16 v[96:99],v[40:43],v[176:183],v1
buffer_load_dword v120,off,s[20:23],s96 sc1
v_smfmac_f32_16x16x64_bf16 v[100:103],v[40:43],v[184:191],v1
ort_100635:
s_waitcnt vmcnt(5)
v_max3_u32 v124,v44,v45,v46
v_max_u32 v124,v124,v47
v_cmp_eq_u32 vcc,-1,v124
s_cbranch_vccnz ost_100636
v_smfmac_f32_16x16x64_bf16 v[96:99],v[44:47],v[192:199],v1
buffer_load_dword v120,off,s[20:23],s96 sc1
v_smfmac_f32_16x16x64_bf16 v[100:103],v[44:47],v[200:207],v1
ort_100637:
s_waitcnt vmcnt(4)
v_max3_u32 v124,v24,v25,v26
v_max3_u32 v124,v124,v27,v28
v_max3_u32 v124,v124,v29,v30
v_max_u32 v124,v124,v31
v_cmp_eq_u32 vcc,-1,v124
s_cbranch_vccnz olap2_100622
s_andn2_b32 s55,s55,12
v_smfmac_f32_16x16x64_bf16 v[96:99],v[24:27],v[80:87],v1
v_smfmac_f32_16x16x64_bf16 v[100:103],v[24:27],v[88:95],v1
v_smfmac_f32_16x16x64_bf16 v[96:99],v[28:31],v[128:135],v1
v_smfmac_f32_16x16x64_bf16 v[100:103],v[28:31],v[136:143],v1
s_cbranch_scc0 oback_100482
s_branch olap2_100622
ost_100632:
buffer_load_dwordx4 v[32:35],v0,s[20:23],s97 offen offset:0 sc1
buffer_load_dwordx4 v[36:39],v0,s[20:23],s97 offen offset:1024 sc1
s_or_b32 s55,s55,48
s_branch ort_100633
ost_100634:
buffer_load_dwordx4 v[40:43],v0,s[20:23],s97 offen offset:2048 sc1
s_or_b32 s55,s55,64
s_branch ort_100635
ost_100636:
buffer_load_dwordx4 v[44:47],v0,s[20:23],s97 offen offset:3072 sc1
s_or_b32 s55,s55,128
s_branch ort_100637
of_100473:
s_mov_b32 s55,48
buffer_load_dwordx4 v[32:35],v0,s[20:23],s97 offen offset:0 sc1
buffer_load_dwordx4 v[36:39],v0,s[20:23],s97 offen offset:1024 sc1
s_waitcnt vmcnt(3)
v_max3_u32 v124,v40,v41,v42
v_max_u32 v124,v124,v43
v_cmp_eq_u32 vcc,-1,v124
s_cbranch_vccnz ost_100639
v_smfmac_f32_16x16x64_bf16 v[96:99],v[40:43],v[176:183],v1
buffer_load_dword v120,off,s[20:23],s96 sc1
v_smfmac_f32_16x16x64_bf16 v[100:103],v[40:43],v[184:191],v1
ort_100640:
s_waitcnt vmcnt(3)
v_max3_u32 v124,v44,v45,v46
v_max_u32 v124,v124,v47
v_cmp_eq_u32 vcc,-1,v124
s_cbranch_vccnz ost_100641
v_smfmac_f32_16x16x64_bf16 v[96:99],v[44:47],v[192:199],v1
buffer_load_dword v120,off,s[20:23],s96 sc1
v_smfmac_f32_16x16x64_bf16 v[100:103],v[44:47],v[200:207],v1
ort_100642:
s_waitcnt vmcnt(2)
v_max3_u32 v124,v32,v33,v34
v_max3_u32 v124,v124,v35,v36
v_max3_u32 v124,v124,v37,v38
v_max_u32 v124,v124,v39
v_cmp_eq_u32 vcc,-1,v124
s_cbranch_vccnz olap2_100622
s_andn2_b32 s55,s55,48
v_smfmac_f32_16x16x64_bf16 v[96:99],v[32:35],v[144:151],v1
v_smfmac_f32_16x16x64_bf16 v[100:103],v[32:35],v[152:159],v1
v_smfmac_f32_16x16x64_bf16 v[96:99],v[36:39],v[160:167],v1
v_smfmac_f32_16x16x64_bf16 v[100:103],v[36:39],v[168:175],v1
s_cbranch_scc0 oback_100482
s_branch olap2_100622
ost_100639:
buffer_load_dwordx4 v[40:43],v0,s[20:23],s97 offen offset:2048 sc1
s_or_b32 s55,s55,64
s_branch ort_100640
ost_100641:
buffer_load_dwordx4 v[44:47],v0,s[20:23],s97 offen offset:3072 sc1
s_or_b32 s55,s55,128
s_branch ort_100642
of_100474:
s_mov_b32 s55,64
buffer_load_dwordx4 v[40:43],v0,s[20:23],s97 offen offset:2048 sc1
s_waitcnt vmcnt(1)
v_max3_u32 v124,v44,v45,v46
v_max_u32 v124,v124,v47
v_cmp_eq_u32 vcc,-1,v124
s_cbranch_vccnz ost_100644
v_smfmac_f32_16x16x64_bf16 v[96:99],v[44:47],v[192:199],v1
buffer_load_dword v120,off,s[20:23],s96 sc1
v_smfmac_f32_16x16x64_bf16 v[100:103],v[44:47],v[200:207],v1
ort_100645:
s_waitcnt vmcnt(1)
v_max3_u32 v124,v40,v41,v42
v_max_u32 v124,v124,v43
v_cmp_eq_u32 vcc,-1,v124
s_cbranch_vccnz olap2_100622
s_andn2_b32 s55,s55,64
v_smfmac_f32_16x16x64_bf16 v[96:99],v[40:43],v[176:183],v1
v_smfmac_f32_16x16x64_bf16 v[100:103],v[40:43],v[184:191],v1
s_cbranch_scc0 oback_100482
s_branch olap2_100622
ost_100644:
buffer_load_dwordx4 v[44:47],v0,s[20:23],s97 offen offset:3072 sc1
s_or_b32 s55,s55,128
s_branch ort_100645
of_100475:
s_mov_b32 s55,128
s_branch oslow_100481
olap2_100622:
s_bitcmp1_b32 s55,0
s_cbranch_scc0 l2s_100647
s_waitcnt vmcnt(6)
v_max3_u32 v124,v16,v17,v18
v_max3_u32 v124,v124,v19,v20
v_max3_u32 v124,v124,v21,v22
v_max_u32 v124,v124,v23
v_cmp_eq_u32 vcc,-1,v124
s_cbranch_vccnz l2s_100647
s_andn2_b32 s55,s55,3
v_smfmac_f32_16x16x64_bf16 v[96:99],v[16:19],v[48:55],v1
v_smfmac_f32_16x16x64_bf16 v[100:103],v[16:19],v[56:63],v1
v_smfmac_f32_16x16x64_bf16 v[96:99],v[20:23],v[64:71],v1
v_smfmac_f32_16x16x64_bf16 v[100:103],v[20:23],v[72:79],v1
l2s_100647:
s_bitcmp1_b32 s55,2
s_cbranch_scc0 l2s_100648
s_waitcnt vmcnt(4)
v_max3_u32 v124,v24,v25,v26
v_max3_u32 v124,v124,v27,v28
v_max3_u32 v124,v124,v29,v30
v_max_u32 v124,v124,v31
v_cmp_eq_u32 vcc,-1,v124
s_cbranch_vccnz l2s_100648
s_andn2_b32 s55,s55,12
v_smfmac_f32_16x16x64_bf16 v[96:99],v[24:27],v[80:87],v1
v_smfmac_f32_16x16x64_bf16 v[100:103],v[24:27],v[88:95],v1
v_smfmac_f32_16x16x64_bf16 v[96:99],v[28:31],v[128:135],v1
v_smfmac_f32_16x16x64_bf16 v[100:103],v[28:31],v[136:143],v1
l2s_100648:
s_bitcmp1_b32 s55,4
s_cbranch_scc0 l2s_100649
s_waitcnt vmcnt(2)
v_max3_u32 v124,v32,v33,v34
v_max3_u32 v124,v124,v35,v36
v_max3_u32 v124,v124,v37,v38
v_max_u32 v124,v124,v39
v_cmp_eq_u32 vcc,-1,v124
s_cbranch_vccnz l2s_100649
s_andn2_b32 s55,s55,48
v_smfmac_f32_16x16x64_bf16 v[96:99],v[32:35],v[144:151],v1
v_smfmac_f32_16x16x64_bf16 v[100:103],v[32:35],v[152:159],v1
v_smfmac_f32_16x16x64_bf16 v[96:99],v[36:39],v[160:167],v1
v_smfmac_f32_16x16x64_bf16 v[100:103],v[36:39],v[168:175],v1
l2s_100649:
s_bitcmp1_b32 s55,6
s_cbranch_scc0 l2s_100650
s_waitcnt vmcnt(1)
v_max3_u32 v124,v40,v41,v42
v_max_u32 v124,v124,v43
v_cmp_eq_u32 vcc,-1,v124
s_cbranch_vccnz l2s_100650
s_andn2_b32 s55,s55,64
v_smfmac_f32_16x16x64_bf16 v[96:99],v[40:43],v[176:183],v1
v_smfmac_f32_16x16x64_bf16 v[100:103],v[40:43],v[184:191],v1
l2s_100650:
s_bitcmp1_b32 s55,7
s_cbranch_scc0 l2s_100651
s_waitcnt vmcnt(0)
v_max3_u32 v124,v44,v45,v46
v_max_u32 v124,v124,v47
v_cmp_eq_u32 vcc,-1,v124
s_cbranch_vccnz l2s_100651
s_andn2_b32 s55,s55,128
v_smfmac_f32_16x16x64_bf16 v[96:99],v[44:47],v[192:199],v1
v_smfmac_f32_16x16x64_bf16 v[100:103],v[44:47],v[200:207],v1
l2s_100651:
s_cmp_eq_u32 s55,0
s_cbranch_scc1 oback_100482
oslow_100481:
s_bitcmp1_b32 s55,0
s_cbranch_scc0 dsk_100652
buffer_load_dwordx4 v[16:19],v0,s[20:23],s96 offen offset:0 sc1
dsk_100652:
s_bitcmp1_b32 s55,1
s_cbranch_scc0 dsk_100653
buffer_load_dwordx4 v[20:23],v0,s[20:23],s96 offen offset:1024 sc1
dsk_100653:
s_bitcmp1_b32 s55,2
s_cbranch_scc0 dsk_100654
buffer_load_dwordx4 v[24:27],v0,s[20:23],s96 offen offset:2048 sc1
dsk_100654:
s_bitcmp1_b32 s55,3
s_cbranch_scc0 dsk_100655
buffer_load_dwordx4 v[28:31],v0,s[20:23],s96 offen offset:3072 sc1
dsk_100655:
s_bitcmp1_b32 s55,4
s_cbranch_scc0 dsk_100656
buffer_load_dwordx4 v[32:35],v0,s[20:23],s97 offen offset:0 sc1
dsk_100656:
s_bitcmp1_b32 s55,5
s_cbranch_scc0 dsk_100657
buffer_load_dwordx4 v[36:39],v0,s[20:23],s97 offen offset:1024 sc1
dsk_100657:
s_bitcmp1_b32 s55,6
s_cbranch_scc0 dsk_100658
buffer_load_dwordx4 v[40:43],v0,s[20:23],s97 offen offset:2048 sc1
dsk_100658:
s_bitcmp1_b32 s55,7
s_cbranch_scc0 dsk_100659
buffer_load_dwordx4 v[44:47],v0,s[20:23],s97 offen offset:3072 sc1
dsk_100659:
s_bitcmp1_b32 s55,0
s_cbranch_scc0 dsk_100660
s_waitcnt vmcnt(2)
v_max3_u32 v124,v16,v17,v18
v_max_u32 v124,v124,v19
v_cmp_eq_u32 vcc,-1,v124
s_cbranch_vccz dgo_100661
s_nop 15
buffer_load_dwordx4 v[116:119],v0,s[20:23],s96 offen offset:0 sc1
s_nop 15
buffer_load_dwordx4 v[120:123],v0,s[20:23],s96 offen offset:0 sc1
dlp_100662:
s_waitcnt vmcnt(2)
v_max3_u32 v124,v16,v17,v18
v_max_u32 v124,v124,v19
v_cmp_eq_u32 vcc,-1,v124
s_cbranch_vccz dgo_100661
buffer_load_dwordx4 v[16:19],v0,s[20:23],s96 offen offset:0 sc1
s_waitcnt vmcnt(2)
v_max3_u32 v124,v116,v117,v118
v_max_u32 v124,v124,v119
v_cmp_eq_u32 vcc,-1,v124
s_cbranch_vccz dcp_100664
buffer_load_dwordx4 v[116:119],v0,s[20:23],s96 offen offset:0 sc1
s_waitcnt vmcnt(2)
v_max3_u32 v124,v120,v121,v122
v_max_u32 v124,v124,v123
v_cmp_eq_u32 vcc,-1,v124
s_cbranch_vccz dcp_100665
buffer_load_dwordx4 v[120:123],v0,s[20:23],s96 offen offset:0 sc1
s_sub_u32 s90,s90,1
s_cmp_gt_i32 s90,0
s_cbranch_scc1 dlp_100662
s_branch dgo_100661
dcp_100664:
v_mov_b32 v16,v116
v_mov_b32 v17,v117
v_mov_b32 v18,v118
v_mov_b32 v19,v119
s_nop 1
s_branch dgo_100661
dcp_100665:
v_mov_b32 v16,v120
v_mov_b32 v17,v121
v_mov_b32 v18,v122
v_mov_b32 v19,v123
s_nop 1
dgo_100661:
v_smfmac_f32_16x16x64_bf16 v[96:99],v[16:19],v[48:55],v1
v_smfmac_f32_16x16x64_bf16 v[100:103],v[16:19],v[56:63],v1
dsk_100660:
s_bitcmp1_b32 s55,1
s_cbranch_scc0 dsk_100666
s_waitcnt vmcnt(2)
v_max3_u32 v124,v20,v21,v22
v_max_u32 v124,v124,v23
v_cmp_eq_u32 vcc,-1,v124
s_cbranch_vccz dgo_100667
s_nop 15
buffer_load_dwordx4 v[116:119],v0,s[20:23],s96 offen offset:1024 sc1
s_nop 15
buffer_load_dwordx4 v[120:123],v0,s[20:23],s96 offen offset:1024 sc1
dlp_100668:
s_waitcnt vmcnt(2)
v_max3_u32 v124,v20,v21,v22
v_max_u32 v124,v124,v23
v_cmp_eq_u32 vcc,-1,v124
s_cbranch_vccz dgo_100667
buffer_load_dwordx4 v[20:23],v0,s[20:23],s96 offen offset:1024 sc1
s_waitcnt vmcnt(2)
v_max3_u32 v124,v116,v117,v118
v_max_u32 v124,v124,v119
v_cmp_eq_u32 vcc,-1,v124
s_cbranch_vccz dcp_100670
buffer_load_dwordx4 v[116:119],v0,s[20:23],s96 offen offset:1024 sc1
s_waitcnt vmcnt(2)
v_max3_u32 v124,v120,v121,v122
v_max_u32 v124,v124,v123
v_cmp_eq_u32 vcc,-1,v124
s_cbranch_vccz dcp_100671
buffer_load_dwordx4 v[120:123],v0,s[20:23],s96 offen offset:1024 sc1
s_sub_u32 s90,s90,1
s_cmp_gt_i32 s90,0
s_cbranch_scc1 dlp_100668
s_branch dgo_100667
dcp_100670:
v_mov_b32 v20,v116
v_mov_b32 v21,v117
v_mov_b32 v22,v118
v_mov_b32 v23,v119
s_nop 1
s_branch dgo_100667
dcp_100671:
v_mov_b32 v20,v120
v_mov_b32 v21,v121
v_mov_b32 v22,v122
v_mov_b32 v23,v123
s_nop 1
dgo_100667:
v_smfmac_f32_16x16x64_bf16 v[96:99],v[20:23],v[64:71],v1
v_smfmac_f32_16x16x64_bf16 v[100:103],v[20:23],v[72:79],v1
dsk_100666:
s_bitcmp1_b32 s55,2
s_cbranch_scc0 dsk_100672
s_waitcnt vmcnt(2)
v_max3_u32 v124,v24,v25,v26
v_max_u32 v124,v124,v27
v_cmp_eq_u32 vcc,-1,v124
s_cbranch_vccz dgo_100673
s_nop 15
buffer_load_dwordx4 v[116:119],v0,s[20:23],s96 offen offset:2048 sc1
s_nop 15
buffer_load_dwordx4 v[120:123],v0,s[20:23],s96 offen offset:2048 sc1
dlp_100674:
s_waitcnt vmcnt(2)
v_max3_u32 v124,v24,v25,v26
v_max_u32 v124,v124,v27
v_cmp_eq_u32 vcc,-1,v124
s_cbranch_vccz dgo_100673
buffer_load_dwordx4 v[24:27],v0,s[20:23],s96 offen offset:2048 sc1
s_waitcnt vmcnt(2)
v_max3_u32 v124,v116,v117,v118
v_max_u32 v124,v124,v119
v_cmp_eq_u32 vcc,-1,v124
s_cbranch_vccz dcp_100676
buffer_load_dwordx4 v[116:119],v0,s[20:23],s96 offen offset:2048 sc1
s_waitcnt vmcnt(2)
v_max3_u32 v124,v120,v121,v122
v_max_u32 v124,v124,v123
v_cmp_eq_u32 vcc,-1,v124
s_cbranch_vccz dcp_100677
buffer_load_dwordx4 v[120:123],v0,s[20:23],s96 offen offset:2048 sc1
s_sub_u32 s90,s90,1
s_cmp_gt_i32 s90,0
s_cbranch_scc1 dlp_100674
s_branch dgo_100673
dcp_100676:
v_mov_b32 v24,v116
v_mov_b32 v25,v117
v_mov_b32 v26,v118
v_mov_b32 v27,v119
s_nop 1
s_branch dgo_100673
dcp_100677:
v_mov_b32 v24,v120
v_mov_b32 v25,v121
v_mov_b32 v26,v122
v_mov_b32 v27,v123
s_nop 1
dgo_100673:
v_smfmac_f32_16x16x64_bf16 v[96:99],v[24:27],v[80:87],v1
v_smfmac_f32_16x16x64_bf16 v[100:103],v[24:27],v[88:95],v1
dsk_100672:
s_bitcmp1_b32 s55,3
s_cbranch_scc0 dsk_100678
s_waitcnt vmcnt(2)
v_max3_u32 v124,v28,v29,v30
v_max_u32 v124,v124,v31
v_cmp_eq_u32 vcc,-1,v124
s_cbranch_vccz dgo_100679
s_nop 15
buffer_load_dwordx4 v[116:119],v0,s[20:23],s96 offen offset:3072 sc1
s_nop 15
buffer_load_dwordx4 v[120:123],v0,s[20:23],s96 offen offset:3072 sc1
dlp_100680:
s_waitcnt vmcnt(2)
v_max3_u32 v124,v28,v29,v30
v_max_u32 v124,v124,v31
v_cmp_eq_u32 vcc,-1,v124
s_cbranch_vccz dgo_100679
buffer_load_dwordx4 v[28:31],v0,s[20:23],s96 offen offset:3072 sc1
s_waitcnt vmcnt(2)
v_max3_u32 v124,v116,v117,v118
v_max_u32 v124,v124,v119
v_cmp_eq_u32 vcc,-1,v124
s_cbranch_vccz dcp_100682
buffer_load_dwordx4 v[116:119],v0,s[20:23],s96 offen offset:3072 sc1
s_waitcnt vmcnt(2)
v_max3_u32 v124,v120,v121,v122
v_max_u32 v124,v124,v123
v_cmp_eq_u32 vcc,-1,v124
s_cbranch_vccz dcp_100683
buffer_load_dwordx4 v[120:123],v0,s[20:23],s96 offen offset:3072 sc1
s_sub_u32 s90,s90,1
s_cmp_gt_i32 s90,0
s_cbranch_scc1 dlp_100680
s_branch dgo_100679
dcp_100682:
v_mov_b32 v28,v116
v_mov_b32 v29,v117
v_mov_b32 v30,v118
v_mov_b32 v31,v119
s_nop 1
s_branch dgo_100679
dcp_100683:
v_mov_b32 v28,v120
v_mov_b32 v29,v121
v_mov_b32 v30,v122
v_mov_b32 v31,v123
s_nop 1
dgo_100679:
v_smfmac_f32_16x16x64_bf16 v[96:99],v[28:31],v[128:135],v1
v_smfmac_f32_16x16x64_bf16 v[100:103],v[28:31],v[136:143],v1
dsk_100678:
s_bitcmp1_b32 s55,4
s_cbranch_scc0 dsk_100684
s_waitcnt vmcnt(2)
v_max3_u32 v124,v32,v33,v34
v_max_u32 v124,v124,v35
v_cmp_eq_u32 vcc,-1,v124
s_cbranch_vccz dgo_100685
s_nop 15
buffer_load_dwordx4 v[116:119],v0,s[20:23],s97 offen offset:0 sc1
s_nop 15
buffer_load_dwordx4 v[120:123],v0,s[20:23],s97 offen offset:0 sc1
dlp_100686:
s_waitcnt vmcnt(2)
v_max3_u32 v124,v32,v33,v34
v_max_u32 v124,v124,v35
v_cmp_eq_u32 vcc,-1,v124
s_cbranch_vccz dgo_100685
buffer_load_dwordx4 v[32:35],v0,s[20:23],s97 offen offset:0 sc1
s_waitcnt vmcnt(2)
v_max3_u32 v124,v116,v117,v118
v_max_u32 v124,v124,v119
v_cmp_eq_u32 vcc,-1,v124
s_cbranch_vccz dcp_100688
buffer_load_dwordx4 v[116:119],v0,s[20:23],s97 offen offset:0 sc1
s_waitcnt vmcnt(2)
v_max3_u32 v124,v120,v121,v122
v_max_u32 v124,v124,v123
v_cmp_eq_u32 vcc,-1,v124
s_cbranch_vccz dcp_100689
buffer_load_dwordx4 v[120:123],v0,s[20:23],s97 offen offset:0 sc1
s_sub_u32 s90,s90,1
s_cmp_gt_i32 s90,0
s_cbranch_scc1 dlp_100686
s_branch dgo_100685
dcp_100688:
v_mov_b32 v32,v116
v_mov_b32 v33,v117
v_mov_b32 v34,v118
v_mov_b32 v35,v119
s_nop 1
s_branch dgo_100685
dcp_100689:
v_mov_b32 v32,v120
v_mov_b32 v33,v121
v_mov_b32 v34,v122
v_mov_b32 v35,v123
s_nop 1
dgo_100685:
v_smfmac_f32_16x16x64_bf16 v[96:99],v[32:35],v[144:151],v1
v_smfmac_f32_16x16x64_bf16 v[100:103],v[32:35],v[152:159],v1
dsk_100684:
s_bitcmp1_b32 s55,5
s_cbranch_scc0 dsk_100690
s_waitcnt vmcnt(2)
v_max3_u32 v124,v36,v37,v38
v_max_u32 v124,v124,v39
v_cmp_eq_u32 vcc,-1,v124
s_cbranch_vccz dgo_100691
s_nop 15
buffer_load_dwordx4 v[116:119],v0,s[20:23],s97 offen offset:1024 sc1
s_nop 15
buffer_load_dwordx4 v[120:123],v0,s[20:23],s97 offen offset:1024 sc1
dlp_100692:
s_waitcnt vmcnt(2)
v_max3_u32 v124,v36,v37,v38
v_max_u32 v124,v124,v39
v_cmp_eq_u32 vcc,-1,v124
s_cbranch_vccz dgo_100691
buffer_load_dwordx4 v[36:39],v0,s[20:23],s97 offen offset:1024 sc1
s_waitcnt vmcnt(2)
v_max3_u32 v124,v116,v117,v118
v_max_u32 v124,v124,v119
v_cmp_eq_u32 vcc,-1,v124
s_cbranch_vccz dcp_100694
buffer_load_dwordx4 v[116:119],v0,s[20:23],s97 offen offset:1024 sc1
s_waitcnt vmcnt(2)
v_max3_u32 v124,v120,v121,v122
v_max_u32 v124,v124,v123
v_cmp_eq_u32 vcc,-1,v124
s_cbranch_vccz dcp_100695
buffer_load_dwordx4 v[120:123],v0,s[20:23],s97 offen offset:1024 sc1
s_sub_u32 s90,s90,1
s_cmp_gt_i32 s90,0
s_cbranch_scc1 dlp_100692
s_branch dgo_100691
dcp_100694:
v_mov_b32 v36,v116
v_mov_b32 v37,v117
v_mov_b32 v38,v118
v_mov_b32 v39,v119
s_nop 1
s_branch dgo_100691
dcp_100695:
v_mov_b32 v36,v120
v_mov_b32 v37,v121
v_mov_b32 v38,v122
v_mov_b32 v39,v123
s_nop 1
dgo_100691:
v_smfmac_f32_16x16x64_bf16 v[96:99],v[36:39],v[160:167],v1
v_smfmac_f32_16x16x64_bf16 v[100:103],v[36:39],v[168:175],v1
dsk_100690:
s_bitcmp1_b32 s55,6
s_cbranch_scc0 dsk_100696
s_waitcnt vmcnt(2)
v_max3_u32 v124,v40,v41,v42
v_max_u32 v124,v124,v43
v_cmp_eq_u32 vcc,-1,v124
s_cbranch_vccz dgo_100697
s_nop 15
buffer_load_dwordx4 v[116:119],v0,s[20:23],s97 offen offset:2048 sc1
s_nop 15
buffer_load_dwordx4 v[120:123],v0,s[20:23],s97 offen offset:2048 sc1
dlp_100698:
s_waitcnt vmcnt(2)
v_max3_u32 v124,v40,v41,v42
v_max_u32 v124,v124,v43
v_cmp_eq_u32 vcc,-1,v124
s_cbranch_vccz dgo_100697
buffer_load_dwordx4 v[40:43],v0,s[20:23],s97 offen offset:2048 sc1
s_waitcnt vmcnt(2)
v_max3_u32 v124,v116,v117,v118
v_max_u32 v124,v124,v119
v_cmp_eq_u32 vcc,-1,v124
s_cbranch_vccz dcp_100700
buffer_load_dwordx4 v[116:119],v0,s[20:23],s97 offen offset:2048 sc1
s_waitcnt vmcnt(2)
v_max3_u32 v124,v120,v121,v122
v_max_u32 v124,v124,v123
v_cmp_eq_u32 vcc,-1,v124
s_cbranch_vccz dcp_100701
buffer_load_dwordx4 v[120:123],v0,s[20:23],s97 offen offset:2048 sc1
s_sub_u32 s90,s90,1
s_cmp_gt_i32 s90,0
s_cbranch_scc1 dlp_100698
s_branch dgo_100697
dcp_100700:
v_mov_b32 v40,v116
v_mov_b32 v41,v117
v_mov_b32 v42,v118
v_mov_b32 v43,v119
s_nop 1
s_branch dgo_100697
dcp_100701:
v_mov_b32 v40,v120
v_mov_b32 v41,v121
v_mov_b32 v42,v122
v_mov_b32 v43,v123
s_nop 1
dgo_100697:
v_smfmac_f32_16x16x64_bf16 v[96:99],v[40:43],v[176:183],v1
v_smfmac_f32_16x16x64_bf16 v[100:103],v[40:43],v[184:191],v1
dsk_100696:
s_bitcmp1_b32 s55,7
s_cbranch_scc0 dsk_100702
s_waitcnt vmcnt(2)
v_max3_u32 v124,v44,v45,v46
v_max_u32 v124,v124,v47
v_cmp_eq_u32 vcc,-1,v124
s_cbranch_vccz dgo_100703
s_nop 15
buffer_load_dwordx4 v[116:119],v0,s[20:23],s97 offen offset:3072 sc1
s_nop 15
buffer_load_dwordx4 v[120:123],v0,s[20:23],s97 offen offset:3072 sc1
dlp_100704:
s_waitcnt vmcnt(2)
v_max3_u32 v124,v44,v45,v46
v_max_u32 v124,v124,v47
v_cmp_eq_u32 vcc,-1,v124
s_cbranch_vccz dgo_100703
buffer_load_dwordx4 v[44:47],v0,s[20:23],s97 offen offset:3072 sc1
s_waitcnt vmcnt(2)
v_max3_u32 v124,v116,v117,v118
v_max_u32 v124,v124,v119
v_cmp_eq_u32 vcc,-1,v124
s_cbranch_vccz dcp_100706
buffer_load_dwordx4 v[116:119],v0,s[20:23],s97 offen offset:3072 sc1
s_waitcnt vmcnt(2)
v_max3_u32 v124,v120,v121,v122
v_max_u32 v124,v124,v123
v_cmp_eq_u32 vcc,-1,v124
s_cbranch_vccz dcp_100707
buffer_load_dwordx4 v[120:123],v0,s[20:23],s97 offen offset:3072 sc1
s_sub_u32 s90,s90,1
s_cmp_gt_i32 s90,0
s_cbranch_scc1 dlp_100704
s_branch dgo_100703
dcp_100706:
v_mov_b32 v44,v116
v_mov_b32 v45,v117
v_mov_b32 v46,v118
v_mov_b32 v47,v119
s_nop 1
s_branch dgo_100703
dcp_100707:
v_mov_b32 v44,v120
v_mov_b32 v45,v121
v_mov_b32 v46,v122
v_mov_b32 v47,v123
s_nop 1
dgo_100703:
v_smfmac_f32_16x16x64_bf16 v[96:99],v[44:47],v[192:199],v1
v_smfmac_f32_16x16x64_bf16 v[100:103],v[44:47],v[200:207],v1
dsk_100702:
s_mov_b32 s55,0
s_branch oback_100482
fl_100499:
flb_100507:
buffer_load_dwordx4 v[16:19],v0,s[20:23],s92 offen offset:0 sc1
s_mov_b32 s55,1
buffer_load_dwordx4 v[32:35],v0,s[20:23],s93 offen offset:0 sc1
s_waitcnt vmcnt(4)
v_max3_u32 v124,v20,v21,v22
v_max_u32 v124,v124,v23
v_cmp_eq_u32 vcc,-1,v124
s_cbranch_vccnz dfl_100708
v_smfmac_f32_16x16x64_bf16 v[64:67],v[20:23],a[96:103],v1
buffer_load_dword v125,off,s[20:23],s92 sc1
buffer_load_dwordx4 v[36:39],v0,s[20:23],s93 offen offset:1024 sc1
s_waitcnt vmcnt(5)
v_max3_u32 v124,v24,v25,v26
v_smfmac_f32_16x16x64_bf16 v[68:71],v[20:23],a[104:111],v1
v_max_u32 v124,v124,v27
v_cmp_eq_u32 vcc,-1,v124
v_smfmac_f32_16x16x64_bf16 v[72:75],v[20:23],a[112:119],v1
v_smfmac_f32_16x16x64_bf16 v[76:79],v[20:23],a[120:127],v1
s_cbranch_vccnz dfl_100709
v_smfmac_f32_16x16x64_bf16 v[64:67],v[24:27],a[160:167],v1
buffer_load_dword v125,off,s[20:23],s92 sc1
buffer_load_dwordx4 v[40:43],v0,s[20:23],s93 offen offset:2048 sc1
buffer_load_dwordx4 v[44:47],v0,s[20:23],s93 offen offset:3072 sc1
s_waitcnt vmcnt(7)
v_max3_u32 v124,v28,v29,v30
v_smfmac_f32_16x16x64_bf16 v[68:71],v[24:27],a[168:175],v1
v_max_u32 v124,v124,v31
v_cmp_eq_u32 vcc,-1,v124
v_smfmac_f32_16x16x64_bf16 v[72:75],v[24:27],a[176:183],v1
v_smfmac_f32_16x16x64_bf16 v[76:79],v[24:27],a[184:191],v1
s_cbranch_vccnz dfl_100710
v_smfmac_f32_16x16x64_bf16 v[64:67],v[28:31],a[224:231],v1
buffer_load_dword v125,off,s[20:23],s92 sc1
buffer_store_dword v126,v121,s[20:23],s69 offen sc1
s_waitcnt vmcnt(8)
v_max3_u32 v124,v16,v17,v18
v_smfmac_f32_16x16x64_bf16 v[68:71],v[28:31],a[232:239],v1
v_max_u32 v124,v124,v19
v_cmp_eq_u32 vcc,-1,v124
v_smfmac_f32_16x16x64_bf16 v[72:75],v[28:31],a[240:247],v1
v_smfmac_f32_16x16x64_bf16 v[76:79],v[28:31],a[248:255],v1
s_cbranch_vccnz lfb_100715
s_mov_b32 s55,0
v_smfmac_f32_16x16x64_bf16 v[64:67],v[16:19],a[32:39],v1
s_waitcnt vmcnt(7)
v_max3_u32 v124,v32,v33,v34
v_max_u32 v124,v124,v35
v_cmp_eq_u32 vcc,-1,v124
v_smfmac_f32_16x16x64_bf16 v[68:71],v[16:19],a[40:47],v1
v_smfmac_f32_16x16x64_bf16 v[72:75],v[16:19],a[48:55],v1
v_smfmac_f32_16x16x64_bf16 v[76:79],v[16:19],a[56:63],v1
s_cbranch_vccnz flb_100511
s_branch segb_100495
fl_100500:
flb_100508:
buffer_load_dwordx4 v[20:23],v0,s[20:23],s92 offen offset:1024 sc1
s_mov_b32 s55,2
buffer_load_dwordx4 v[36:39],v0,s[20:23],s93 offen offset:1024 sc1
s_waitcnt vmcnt(5)
v_max3_u32 v124,v24,v25,v26
v_max_u32 v124,v124,v27
v_cmp_eq_u32 vcc,-1,v124
s_cbranch_vccnz dfl_100709
v_smfmac_f32_16x16x64_bf16 v[64:67],v[24:27],a[160:167],v1
buffer_load_dword v125,off,s[20:23],s92 sc1
buffer_load_dwordx4 v[40:43],v0,s[20:23],s93 offen offset:2048 sc1
buffer_load_dwordx4 v[44:47],v0,s[20:23],s93 offen offset:3072 sc1
s_waitcnt vmcnt(7)
v_max3_u32 v124,v28,v29,v30
v_smfmac_f32_16x16x64_bf16 v[68:71],v[24:27],a[168:175],v1
v_max_u32 v124,v124,v31
v_cmp_eq_u32 vcc,-1,v124
v_smfmac_f32_16x16x64_bf16 v[72:75],v[24:27],a[176:183],v1
v_smfmac_f32_16x16x64_bf16 v[76:79],v[24:27],a[184:191],v1
s_cbranch_vccnz dfl_100710
v_smfmac_f32_16x16x64_bf16 v[64:67],v[28:31],a[224:231],v1
buffer_load_dword v125,off,s[20:23],s92 sc1
buffer_store_dword v126,v121,s[20:23],s69 offen sc1
s_waitcnt vmcnt(6)
v_max3_u32 v124,v20,v21,v22
v_smfmac_f32_16x16x64_bf16 v[68:71],v[28:31],a[232:239],v1
v_max_u32 v124,v124,v23
v_cmp_eq_u32 vcc,-1,v124
v_smfmac_f32_16x16x64_bf16 v[72:75],v[28:31],a[240:247],v1
v_smfmac_f32_16x16x64_bf16 v[76:79],v[28:31],a[248:255],v1
s_cbranch_vccnz lfb_100715
s_mov_b32 s55,0
v_smfmac_f32_16x16x64_bf16 v[64:67],v[20:23],a[96:103],v1
s_waitcnt vmcnt(7)
v_max3_u32 v124,v32,v33,v34
v_max_u32 v124,v124,v35
v_cmp_eq_u32 vcc,-1,v124
v_smfmac_f32_16x16x64_bf16 v[68:71],v[20:23],a[104:111],v1
v_smfmac_f32_16x16x64_bf16 v[72:75],v[20:23],a[112:119],v1
v_smfmac_f32_16x16x64_bf16 v[76:79],v[20:23],a[120:127],v1
s_cbranch_vccnz flb_100511
s_branch segb_100495
fl_100501:
flb_100509:
buffer_load_dwordx4 v[24:27],v0,s[20:23],s92 offen offset:2048 sc1
s_mov_b32 s55,4
buffer_load_dwordx4 v[40:43],v0,s[20:23],s93 offen offset:2048 sc1
buffer_load_dwordx4 v[44:47],v0,s[20:23],s93 offen offset:3072 sc1
s_waitcnt vmcnt(7)
v_max3_u32 v124,v28,v29,v30
v_max_u32 v124,v124,v31
v_cmp_eq_u32 vcc,-1,v124
s_cbranch_vccnz dfl_100710
v_smfmac_f32_16x16x64_bf16 v[64:67],v[28:31],a[224:231],v1
buffer_load_dword v125,off,s[20:23],s92 sc1
buffer_store_dword v126,v121,s[20:23],s69 offen sc1
s_waitcnt vmcnt(4)
v_max3_u32 v124,v24,v25,v26
v_smfmac_f32_16x16x64_bf16 v[68:71],v[28:31],a[232:239],v1
v_max_u32 v124,v124,v27
v_cmp_eq_u32 vcc,-1,v124
v_smfmac_f32_16x16x64_bf16 v[72:75],v[28:31],a[240:247],v1
v_smfmac_f32_16x16x64_bf16 v[76:79],v[28:31],a[248:255],v1
s_cbranch_vccnz lfb_100715
s_mov_b32 s55,0
v_smfmac_f32_16x16x64_bf16 v[64:67],v[24:27],a[160:167],v1
s_waitcnt vmcnt(7)
v_max3_u32 v124,v32,v33,v34
v_max_u32 v124,v124,v35
v_cmp_eq_u32 vcc,-1,v124
v_smfmac_f32_16x16x64_bf16 v[68:71],v[24:27],a[168:175],v1
v_smfmac_f32_16x16x64_bf16 v[72:75],v[24:27],a[176:183],v1
v_smfmac_f32_16x16x64_bf16 v[76:79],v[24:27],a[184:191],v1
s_cbranch_vccnz flb_100511
s_branch segb_100495
fl_100502:
flb_100510:
buffer_load_dwordx4 v[28:31],v0,s[20:23],s92 offen offset:3072 sc1
s_mov_b32 s55,8
buffer_store_dword v126,v121,s[20:23],s69 offen sc1
s_waitcnt vmcnt(1)
v_max3_u32 v124,v28,v29,v30
v_max_u32 v124,v124,v31
v_cmp_eq_u32 vcc,-1,v124
s_cbranch_vccnz lfb_100715
s_mov_b32 s55,0
v_smfmac_f32_16x16x64_bf16 v[64:67],v[28:31],a[224:231],v1
s_waitcnt vmcnt(7)
v_max3_u32 v124,v32,v33,v34
v_max_u32 v124,v124,v35
v_cmp_eq_u32 vcc,-1,v124
v_smfmac_f32_16x16x64_bf16 v[68:71],v[28:31],a[232:239],v1
v_smfmac_f32_16x16x64_bf16 v[72:75],v[28:31],a[240:247],v1
v_smfmac_f32_16x16x64_bf16 v[76:79],v[28:31],a[248:255],v1
s_cbranch_vccnz flb_100511
s_branch segb_100495
fl_100503:
flb_100511:
buffer_load_dwordx4 v[32:35],v0,s[20:23],s93 offen offset:0 sc1
s_mov_b32 s55,240
s_bitcmp1_b32 s55,5
s_cbranch_scc0 rdn_100718
s_waitcnt vmcnt(6)
v_max3_u32 v124,v36,v37,v38
v_max_u32 v124,v124,v39
v_cmp_eq_u32 vcc,-1,v124
s_cbranch_vccnz rfa_100719
buffer_load_dword v125,off,s[20:23],s92 sc1
s_bitset0_b32 s55,5
v_smfmac_f32_16x16x64_bf16 v[64:67],v[36:39],a[96:103],v1
v_smfmac_f32_16x16x64_bf16 v[68:71],v[36:39],a[104:111],v1
v_smfmac_f32_16x16x64_bf16 v[72:75],v[36:39],a[112:119],v1
v_smfmac_f32_16x16x64_bf16 v[76:79],v[36:39],a[120:127],v1
s_cmp_eq_u32 s55,0
s_cbranch_scc1 segb_100497
s_branch rnx_100720
rdn_100718:
buffer_load_dword v125,off,s[20:23],s92 sc1
s_branch rnx_100720
rfa_100719:
buffer_load_dwordx4 v[36:39],v0,s[20:23],s93 offen offset:1024 sc1
rnx_100720:
s_bitcmp1_b32 s55,6
s_cbranch_scc0 rdn_100721
s_waitcnt vmcnt(5)
v_max3_u32 v124,v40,v41,v42
v_max_u32 v124,v124,v43
v_cmp_eq_u32 vcc,-1,v124
s_cbranch_vccnz rfa_100722
buffer_load_dword v125,off,s[20:23],s92 sc1
s_bitset0_b32 s55,6
s_cmp_eq_u32 s55,0
s_cbranch_scc1 segb_100497
s_branch rnx_100723
rdn_100721:
buffer_load_dword v125,off,s[20:23],s92 sc1
s_branch rnx_100723
rfa_100722:
buffer_load_dwordx4 v[40:43],v0,s[20:23],s93 offen offset:2048 sc1
rnx_100723:
s_bitcmp1_b32 s55,7
s_cbranch_scc0 rdn_100724
s_waitcnt vmcnt(5)
v_max3_u32 v124,v44,v45,v46
v_max_u32 v124,v124,v47
v_cmp_eq_u32 vcc,-1,v124
s_cbranch_vccnz rfa_100725
buffer_load_dword v125,off,s[20:23],s92 sc1
s_bitset0_b32 s55,7
s_cmp_eq_u32 s55,0
s_cbranch_scc1 segb_100497
s_branch rnx_100726
rdn_100724:
buffer_load_dword v125,off,s[20:23],s92 sc1
s_branch rnx_100726
rfa_100725:
buffer_load_dwordx4 v[44:47],v0,s[20:23],s93 offen offset:3072 sc1
rnx_100726:
rot_100717:
s_bitcmp1_b32 s55,4
s_cbranch_scc0 rdn_100727
s_waitcnt vmcnt(3)
v_max3_u32 v124,v32,v33,v34
v_max_u32 v124,v124,v35
v_cmp_eq_u32 vcc,-1,v124
s_cbranch_vccnz rfa_100728
buffer_load_dword v125,off,s[20:23],s92 sc1
s_bitset0_b32 s55,4
v_smfmac_f32_16x16x64_bf16 v[64:67],v[32:35],a[32:39],v1
v_smfmac_f32_16x16x64_bf16 v[68:71],v[32:35],a[40:47],v1
v_smfmac_f32_16x16x64_bf16 v[72:75],v[32:35],a[48:55],v1
v_smfmac_f32_16x16x64_bf16 v[76:79],v[32:35],a[56:63],v1
s_cmp_eq_u32 s55,0
s_cbranch_scc1 segb_100497
s_branch rnx_100729
rdn_100727:
buffer_load_dword v125,off,s[20:23],s92 sc1
s_branch rnx_100729
rfa_100728:
buffer_load_dwordx4 v[32:35],v0,s[20:23],s93 offen offset:0 sc1
rnx_100729:
s_bitcmp1_b32 s55,5
s_cbranch_scc0 rdn_100730
s_waitcnt vmcnt(3)
v_max3_u32 v124,v36,v37,v38
v_max_u32 v124,v124,v39
v_cmp_eq_u32 vcc,-1,v124
s_cbranch_vccnz rfa_100731
buffer_load_dword v125,off,s[20:23],s92 sc1
s_bitset0_b32 s55,5
v_smfmac_f32_16x16x64_bf16 v[64:67],v[36:39],a[96:103],v1
v_smfmac_f32_16x16x64_bf16 v[68:71],v[36:39],a[104:111],v1
v_smfmac_f32_16x16x64_bf16 v[72:75],v[36:39],a[112:119],v1
v_smfmac_f32_16x16x64_bf16 v[76:79],v[36:39],a[120:127],v1
s_cmp_eq_u32 s55,0
s_cbranch_scc1 segb_100497
s_branch rnx_100732
rdn_100730:
buffer_load_dword v125,off,s[20:23],s92 sc1
s_branch rnx_100732
rfa_100731:
buffer_load_dwordx4 v[36:39],v0,s[20:23],s93 offen offset:1024 sc1
rnx_100732:
s_bitcmp1_b32 s55,6
s_cbranch_scc0 rdn_100733
s_waitcnt vmcnt(3)
v_max3_u32 v124,v40,v41,v42
v_max_u32 v124,v124,v43
v_cmp_eq_u32 vcc,-1,v124
s_cbranch_vccnz rfa_100734
buffer_load_dword v125,off,s[20:23],s92 sc1
s_bitset0_b32 s55,6
s_cmp_eq_u32 s55,0
s_cbranch_scc1 segb_100497
s_branch rnx_100735
rdn_100733:
buffer_load_dword v125,off,s[20:23],s92 sc1
s_branch rnx_100735
rfa_100734:
buffer_load_dwordx4 v[40:43],v0,s[20:23],s93 offen offset:2048 sc1
rnx_100735:
s_bitcmp1_b32 s55,7
s_cbranch_scc0 rdn_100736
s_waitcnt vmcnt(3)
v_max3_u32 v124,v44,v45,v46
v_max_u32 v124,v124,v47
v_cmp_eq_u32 vcc,-1,v124
s_cbranch_vccnz rfa_100737
buffer_load_dword v125,off,s[20:23],s92 sc1
s_bitset0_b32 s55,7
s_cmp_eq_u32 s55,0
s_cbranch_scc1 segb_100497
s_branch rnx_100738
rdn_100736:
buffer_load_dword v125,off,s[20:23],s92 sc1
s_branch rnx_100738
rfa_100737:
buffer_load_dwordx4 v[44:47],v0,s[20:23],s93 offen offset:3072 sc1
rnx_100738:
s_sub_u32 s90,s90,1
s_cmp_gt_i32 s90,0
s_cbranch_scc1 rot_100717
s_mov_b32 s55,0
s_branch segb_100497
fl_100504:
flb_100512:
buffer_load_dwordx4 v[36:39],v0,s[20:23],s93 offen offset:1024 sc1
s_mov_b32 s55,224
s_bitcmp1_b32 s55,6
s_cbranch_scc0 rdn_100740
s_waitcnt vmcnt(5)
v_max3_u32 v124,v40,v41,v42
v_max_u32 v124,v124,v43
v_cmp_eq_u32 vcc,-1,v124
s_cbranch_vccnz rfa_100741
buffer_load_dword v125,off,s[20:23],s92 sc1
s_bitset0_b32 s55,6
s_cmp_eq_u32 s55,0
s_cbranch_scc1 segb_100497
s_branch rnx_100742
rdn_100740:
buffer_load_dword v125,off,s[20:23],s92 sc1
s_branch rnx_100742
rfa_100741:
buffer_load_dwordx4 v[40:43],v0,s[20:23],s93 offen offset:2048 sc1
rnx_100742:
s_bitcmp1_b32 s55,7
s_cbranch_scc0 rdn_100743
s_waitcnt vmcnt(5)
v_max3_u32 v124,v44,v45,v46
v_max_u32 v124,v124,v47
v_cmp_eq_u32 vcc,-1,v124
s_cbranch_vccnz rfa_100744
buffer_load_dword v125,off,s[20:23],s92 sc1
s_bitset0_b32 s55,7
s_cmp_eq_u32 s55,0
s_cbranch_scc1 segb_100497
s_branch rnx_100745
rdn_100743:
buffer_load_dword v125,off,s[20:23],s92 sc1
s_branch rnx_100745
rfa_100744:
buffer_load_dwordx4 v[44:47],v0,s[20:23],s93 offen offset:3072 sc1
rnx_100745:
rot_100739:
s_bitcmp1_b32 s55,5
s_cbranch_scc0 rdn_100746
s_waitcnt vmcnt(2)
v_max3_u32 v124,v36,v37,v38
v_max_u32 v124,v124,v39
v_cmp_eq_u32 vcc,-1,v124
s_cbranch_vccnz rfa_100747
buffer_load_dword v125,off,s[20:23],s92 sc1
s_bitset0_b32 s55,5
v_smfmac_f32_16x16x64_bf16 v[64:67],v[36:39],a[96:103],v1
v_smfmac_f32_16x16x64_bf16 v[68:71],v[36:39],a[104:111],v1
v_smfmac_f32_16x16x64_bf16 v[72:75],v[36:39],a[112:119],v1
v_smfmac_f32_16x16x64_bf16 v[76:79],v[36:39],a[120:127],v1
s_cmp_eq_u32 s55,0
s_cbranch_scc1 segb_100497
s_branch rnx_100748
rdn_100746:
buffer_load_dword v125,off,s[20:23],s92 sc1
s_branch rnx_100748
rfa_100747:
buffer_load_dwordx4 v[36:39],v0,s[20:23],s93 offen offset:1024 sc1
rnx_100748:
s_bitcmp1_b32 s55,6
s_cbranch_scc0 rdn_100749
s_waitcnt vmcnt(2)
v_max3_u32 v124,v40,v41,v42
v_max_u32 v124,v124,v43
v_cmp_eq_u32 vcc,-1,v124
s_cbranch_vccnz rfa_100750
buffer_load_dword v125,off,s[20:23],s92 sc1
s_bitset0_b32 s55,6
s_cmp_eq_u32 s55,0
s_cbranch_scc1 segb_100497
s_branch rnx_100751
rdn_100749:
buffer_load_dword v125,off,s[20:23],s92 sc1
s_branch rnx_100751
rfa_100750:
buffer_load_dwordx4 v[40:43],v0,s[20:23],s93 offen offset:2048 sc1
rnx_100751:
s_bitcmp1_b32 s55,7
s_cbranch_scc0 rdn_100752
s_waitcnt vmcnt(2)
v_max3_u32 v124,v44,v45,v46
v_max_u32 v124,v124,v47
v_cmp_eq_u32 vcc,-1,v124
s_cbranch_vccnz rfa_100753
buffer_load_dword v125,off,s[20:23],s92 sc1
s_bitset0_b32 s55,7
s_cmp_eq_u32 s55,0
s_cbranch_scc1 segb_100497
s_branch rnx_100754
rdn_100752:
buffer_load_dword v125,off,s[20:23],s92 sc1
s_branch rnx_100754
rfa_100753:
buffer_load_dwordx4 v[44:47],v0,s[20:23],s93 offen offset:3072 sc1
rnx_100754:
s_sub_u32 s90,s90,1
s_cmp_gt_i32 s90,0
s_cbranch_scc1 rot_100739
s_mov_b32 s55,0
s_branch segb_100497
fl_100505:
flb_100513:
s_mov_b32 s55,192
s_bitcmp1_b32 s55,6
s_cbranch_scc0 rdn_100756
s_waitcnt vmcnt(5)
v_max3_u32 v124,v40,v41,v42
v_max_u32 v124,v124,v43
v_cmp_eq_u32 vcc,-1,v124
s_cbranch_vccnz rfa_100757
buffer_load_dword v125,off,s[20:23],s92 sc1
s_bitset0_b32 s55,6
s_cmp_eq_u32 s55,0
s_cbranch_scc1 segb_100497
s_branch rnx_100758
rdn_100756:
buffer_load_dword v125,off,s[20:23],s92 sc1
s_branch rnx_100758
rfa_100757:
buffer_load_dwordx4 v[40:43],v0,s[20:23],s93 offen offset:2048 sc1
rnx_100758:
s_bitcmp1_b32 s55,7
s_cbranch_scc0 rdn_100759
s_waitcnt vmcnt(5)
v_max3_u32 v124,v44,v45,v46
v_max_u32 v124,v124,v47
v_cmp_eq_u32 vcc,-1,v124
s_cbranch_vccnz rfa_100760
buffer_load_dword v125,off,s[20:23],s92 sc1
s_bitset0_b32 s55,7
s_cmp_eq_u32 s55,0
s_cbranch_scc1 segb_100497
s_branch rnx_100761
rdn_100759:
buffer_load_dword v125,off,s[20:23],s92 sc1
s_branch rnx_100761
rfa_100760:
buffer_load_dwordx4 v[44:47],v0,s[20:23],s93 offen offset:3072 sc1
rnx_100761:
rot_100755:
s_bitcmp1_b32 s55,6
s_cbranch_scc0 rdn_100762
s_waitcnt vmcnt(1)
v_max3_u32 v124,v40,v41,v42
v_max_u32 v124,v124,v43
v_cmp_eq_u32 vcc,-1,v124
s_cbranch_vccnz rfa_100763
buffer_load_dword v125,off,s[20:23],s92 sc1
s_bitset0_b32 s55,6
s_cmp_eq_u32 s55,0
s_cbranch_scc1 segb_100497
s_branch rnx_100764
rdn_100762:
buffer_load_dword v125,off,s[20:23],s92 sc1
s_branch rnx_100764
rfa_100763:
buffer_load_dwordx4 v[40:43],v0,s[20:23],s93 offen offset:2048 sc1
rnx_100764:
s_bitcmp1_b32 s55,7
s_cbranch_scc0 rdn_100765
s_waitcnt vmcnt(1)
v_max3_u32 v124,v44,v45,v46
v_max_u32 v124,v124,v47
v_cmp_eq_u32 vcc,-1,v124
s_cbranch_vccnz rfa_100766
buffer_load_dword v125,off,s[20:23],s92 sc1
s_bitset0_b32 s55,7
s_cmp_eq_u32 s55,0
s_cbranch_scc1 segb_100497
s_branch rnx_100767
rdn_100765:
buffer_load_dword v125,off,s[20:23],s92 sc1
s_branch rnx_100767
rfa_100766:
buffer_load_dwordx4 v[44:47],v0,s[20:23],s93 offen offset:3072 sc1
rnx_100767:
s_sub_u32 s90,s90,1
s_cmp_gt_i32 s90,0
s_cbranch_scc1 rot_100755
s_mov_b32 s55,0
s_branch segb_100497
dfl_100708:
buffer_load_dwordx4 v[20:23],v0,s[20:23],s92 offen offset:1024 sc1
s_bitset1_b32 s55,1
buffer_load_dwordx4 v[36:39],v0,s[20:23],s93 offen offset:1024 sc1
s_waitcnt vmcnt(5)
v_max3_u32 v124,v24,v25,v26
v_max_u32 v124,v124,v27
v_cmp_eq_u32 vcc,-1,v124
s_cbranch_vccnz dfl_100709
s_branch dseg_100712
dfl_100709:
buffer_load_dwordx4 v[24:27],v0,s[20:23],s92 offen offset:2048 sc1
s_bitset1_b32 s55,2
buffer_load_dwordx4 v[40:43],v0,s[20:23],s93 offen offset:2048 sc1
buffer_load_dwordx4 v[44:47],v0,s[20:23],s93 offen offset:3072 sc1
s_waitcnt vmcnt(7)
v_max3_u32 v124,v28,v29,v30
v_max_u32 v124,v124,v31
v_cmp_eq_u32 vcc,-1,v124
s_cbranch_vccnz dfl_100710
s_branch dseg_100713
dfl_100710:
buffer_load_dwordx4 v[28:31],v0,s[20:23],s92 offen offset:3072 sc1
s_bitset1_b32 s55,3
buffer_store_dword v126,v121,s[20:23],s69 offen sc1
s_branch lap2_100714
dseg_100712:
v_smfmac_f32_16x16x64_bf16 v[64:67],v[24:27],a[160:167],v1
buffer_load_dword v125,off,s[20:23],s92 sc1
buffer_load_dwordx4 v[40:43],v0,s[20:23],s93 offen offset:2048 sc1
buffer_load_dwordx4 v[44:47],v0,s[20:23],s93 offen offset:3072 sc1
s_waitcnt vmcnt(7)
v_max3_u32 v124,v28,v29,v30
v_smfmac_f32_16x16x64_bf16 v[68:71],v[24:27],a[168:175],v1
v_max_u32 v124,v124,v31
v_cmp_eq_u32 vcc,-1,v124
v_smfmac_f32_16x16x64_bf16 v[72:75],v[24:27],a[176:183],v1
v_smfmac_f32_16x16x64_bf16 v[76:79],v[24:27],a[184:191],v1
s_cbranch_vccnz dfl_100710
dseg_100713:
v_smfmac_f32_16x16x64_bf16 v[64:67],v[28:31],a[224:231],v1
buffer_load_dword v125,off,s[20:23],s92 sc1
v_smfmac_f32_16x16x64_bf16 v[68:71],v[28:31],a[232:239],v1
buffer_store_dword v126,v121,s[20:23],s69 offen sc1
v_smfmac_f32_16x16x64_bf16 v[72:75],v[28:31],a[240:247],v1
v_smfmac_f32_16x16x64_bf16 v[76:79],v[28:31],a[248:255],v1
lap2_100714:
s_bitcmp1_b32 s55,0
s_cbranch_scc0 l2s_100768
s_waitcnt vmcnt(8)
v_max3_u32 v124,v16,v17,v18
v_max_u32 v124,v124,v19
v_cmp_eq_u32 vcc,-1,v124
s_cbranch_vccnz l2s_100768
s_bitset0_b32 s55,0
v_smfmac_f32_16x16x64_bf16 v[64:67],v[16:19],a[32:39],v1
v_smfmac_f32_16x16x64_bf16 v[68:71],v[16:19],a[40:47],v1
v_smfmac_f32_16x16x64_bf16 v[72:75],v[16:19],a[48:55],v1
v_smfmac_f32_16x16x64_bf16 v[76:79],v[16:19],a[56:63],v1
l2s_100768:
s_bitcmp1_b32 s55,1
s_cbranch_scc0 l2s_100770
s_waitcnt vmcnt(6)
v_max3_u32 v124,v20,v21,v22
v_max_u32 v124,v124,v23
v_cmp_eq_u32 vcc,-1,v124
s_cbranch_vccnz l2s_100770
s_bitset0_b32 s55,1
v_smfmac_f32_16x16x64_bf16 v[64:67],v[20:23],a[96:103],v1
v_smfmac_f32_16x16x64_bf16 v[68:71],v[20:23],a[104:111],v1
v_smfmac_f32_16x16x64_bf16 v[72:75],v[20:23],a[112:119],v1
v_smfmac_f32_16x16x64_bf16 v[76:79],v[20:23],a[120:127],v1
l2s_100770:
s_bitcmp1_b32 s55,2
s_cbranch_scc0 l2s_100772
s_waitcnt vmcnt(4)
v_max3_u32 v124,v24,v25,v26
v_max_u32 v124,v124,v27
v_cmp_eq_u32 vcc,-1,v124
s_cbranch_vccnz l2s_100772
s_bitset0_b32 s55,2
v_smfmac_f32_16x16x64_bf16 v[64:67],v[24:27],a[160:167],v1
v_smfmac_f32_16x16x64_bf16 v[68:71],v[24:27],a[168:175],v1
v_smfmac_f32_16x16x64_bf16 v[72:75],v[24:27],a[176:183],v1
v_smfmac_f32_16x16x64_bf16 v[76:79],v[24:27],a[184:191],v1
l2s_100772:
s_bitcmp1_b32 s55,3
s_cbranch_scc0 l2s_100774
s_waitcnt vmcnt(1)
v_max3_u32 v124,v28,v29,v30
v_max_u32 v124,v124,v31
v_cmp_eq_u32 vcc,-1,v124
s_cbranch_vccnz l2s_100774
s_bitset0_b32 s55,3
v_smfmac_f32_16x16x64_bf16 v[64:67],v[28:31],a[224:231],v1
v_smfmac_f32_16x16x64_bf16 v[68:71],v[28:31],a[232:239],v1
v_smfmac_f32_16x16x64_bf16 v[72:75],v[28:31],a[240:247],v1
v_smfmac_f32_16x16x64_bf16 v[76:79],v[28:31],a[248:255],v1
l2s_100774:
s_cmp_eq_u32 s55,0
s_cbranch_scc0 lfb_100715
Ldone_100716:
s_waitcnt vmcnt(7)
v_max3_u32 v124,v32,v33,v34
v_max_u32 v124,v124,v35
v_cmp_eq_u32 vcc,-1,v124
s_cbranch_vccnz flb_100511
s_branch segb_100495
lfb_100715:
s_bitcmp1_b32 s55,0
s_cbranch_scc0 dsk_100776
buffer_load_dwordx4 v[16:19],v0,s[20:23],s92 offen offset:0 sc1
dsk_100776:
s_bitcmp1_b32 s55,1
s_cbranch_scc0 dsk_100777
buffer_load_dwordx4 v[20:23],v0,s[20:23],s92 offen offset:1024 sc1
dsk_100777:
s_bitcmp1_b32 s55,2
s_cbranch_scc0 dsk_100778
buffer_load_dwordx4 v[24:27],v0,s[20:23],s92 offen offset:2048 sc1
dsk_100778:
s_bitcmp1_b32 s55,3
s_cbranch_scc0 dsk_100779
buffer_load_dwordx4 v[28:31],v0,s[20:23],s92 offen offset:3072 sc1
dsk_100779:
s_bitcmp1_b32 s55,0
s_cbranch_scc0 dsk_100780
s_waitcnt vmcnt(2)
v_max3_u32 v124,v16,v17,v18
v_max_u32 v124,v124,v19
v_cmp_eq_u32 vcc,-1,v124
s_cbranch_vccz dgo_100781
s_nop 15
buffer_load_dwordx4 v[104:107],v0,s[20:23],s92 offen offset:0 sc1
s_nop 15
buffer_load_dwordx4 v[108:111],v0,s[20:23],s92 offen offset:0 sc1
dlp_100782:
s_waitcnt vmcnt(2)
v_max3_u32 v124,v16,v17,v18
v_max_u32 v124,v124,v19
v_cmp_eq_u32 vcc,-1,v124
s_cbranch_vccz dgo_100781
buffer_load_dwordx4 v[16:19],v0,s[20:23],s92 offen offset:0 sc1
s_waitcnt vmcnt(2)
v_max3_u32 v124,v104,v105,v106
v_max_u32 v124,v124,v107
v_cmp_eq_u32 vcc,-1,v124
s_cbranch_vccz dcp_100784
buffer_load_dwordx4 v[104:107],v0,s[20:23],s92 offen offset:0 sc1
s_waitcnt vmcnt(2)
v_max3_u32 v124,v108,v109,v110
v_max_u32 v124,v124,v111
v_cmp_eq_u32 vcc,-1,v124
s_cbranch_vccz dcp_100785
buffer_load_dwordx4 v[108:111],v0,s[20:23],s92 offen offset:0 sc1
s_sub_u32 s90,s90,1
s_cmp_gt_i32 s90,0
s_cbranch_scc1 dlp_100782
s_branch dgo_100781
dcp_100784:
v_mov_b32 v16,v104
v_mov_b32 v17,v105
v_mov_b32 v18,v106
v_mov_b32 v19,v107
s_nop 1
s_branch dgo_100781
dcp_100785:
v_mov_b32 v16,v108
v_mov_b32 v17,v109
v_mov_b32 v18,v110
v_mov_b32 v19,v111
s_nop 1
dgo_100781:
v_smfmac_f32_16x16x64_bf16 v[64:67],v[16:19],a[32:39],v1
v_smfmac_f32_16x16x64_bf16 v[68:71],v[16:19],a[40:47],v1
v_smfmac_f32_16x16x64_bf16 v[72:75],v[16:19],a[48:55],v1
v_smfmac_f32_16x16x64_bf16 v[76:79],v[16:19],a[56:63],v1
dsk_100780:
s_bitcmp1_b32 s55,1
s_cbranch_scc0 dsk_100786
s_waitcnt vmcnt(2)
v_max3_u32 v124,v20,v21,v22
v_max_u32 v124,v124,v23
v_cmp_eq_u32 vcc,-1,v124
s_cbranch_vccz dgo_100787
s_nop 15
buffer_load_dwordx4 v[104:107],v0,s[20:23],s92 offen offset:1024 sc1
s_nop 15
buffer_load_dwordx4 v[108:111],v0,s[20:23],s92 offen offset:1024 sc1
dlp_100788:
s_waitcnt vmcnt(2)
v_max3_u32 v124,v20,v21,v22
v_max_u32 v124,v124,v23
v_cmp_eq_u32 vcc,-1,v124
s_cbranch_vccz dgo_100787
buffer_load_dwordx4 v[20:23],v0,s[20:23],s92 offen offset:1024 sc1
s_waitcnt vmcnt(2)
v_max3_u32 v124,v104,v105,v106
v_max_u32 v124,v124,v107
v_cmp_eq_u32 vcc,-1,v124
s_cbranch_vccz dcp_100790
buffer_load_dwordx4 v[104:107],v0,s[20:23],s92 offen offset:1024 sc1
s_waitcnt vmcnt(2)
v_max3_u32 v124,v108,v109,v110
v_max_u32 v124,v124,v111
v_cmp_eq_u32 vcc,-1,v124
s_cbranch_vccz dcp_100791
buffer_load_dwordx4 v[108:111],v0,s[20:23],s92 offen offset:1024 sc1
s_sub_u32 s90,s90,1
s_cmp_gt_i32 s90,0
s_cbranch_scc1 dlp_100788
s_branch dgo_100787
dcp_100790:
v_mov_b32 v20,v104
v_mov_b32 v21,v105
v_mov_b32 v22,v106
v_mov_b32 v23,v107
s_nop 1
s_branch dgo_100787
dcp_100791:
v_mov_b32 v20,v108
v_mov_b32 v21,v109
v_mov_b32 v22,v110
v_mov_b32 v23,v111
s_nop 1
dgo_100787:
v_smfmac_f32_16x16x64_bf16 v[64:67],v[20:23],a[96:103],v1
v_smfmac_f32_16x16x64_bf16 v[68:71],v[20:23],a[104:111],v1
v_smfmac_f32_16x16x64_bf16 v[72:75],v[20:23],a[112:119],v1
v_smfmac_f32_16x16x64_bf16 v[76:79],v[20:23],a[120:127],v1
dsk_100786:
s_bitcmp1_b32 s55,2
s_cbranch_scc0 dsk_100792
s_waitcnt vmcnt(2)
v_max3_u32 v124,v24,v25,v26
v_max_u32 v124,v124,v27
v_cmp_eq_u32 vcc,-1,v124
s_cbranch_vccz dgo_100793
s_nop 15
buffer_load_dwordx4 v[104:107],v0,s[20:23],s92 offen offset:2048 sc1
s_nop 15
buffer_load_dwordx4 v[108:111],v0,s[20:23],s92 offen offset:2048 sc1
dlp_100794:
s_waitcnt vmcnt(2)
v_max3_u32 v124,v24,v25,v26
v_max_u32 v124,v124,v27
v_cmp_eq_u32 vcc,-1,v124
s_cbranch_vccz dgo_100793
buffer_load_dwordx4 v[24:27],v0,s[20:23],s92 offen offset:2048 sc1
s_waitcnt vmcnt(2)
v_max3_u32 v124,v104,v105,v106
v_max_u32 v124,v124,v107
v_cmp_eq_u32 vcc,-1,v124
s_cbranch_vccz dcp_100796
buffer_load_dwordx4 v[104:107],v0,s[20:23],s92 offen offset:2048 sc1
s_waitcnt vmcnt(2)
v_max3_u32 v124,v108,v109,v110
v_max_u32 v124,v124,v111
v_cmp_eq_u32 vcc,-1,v124
s_cbranch_vccz dcp_100797
buffer_load_dwordx4 v[108:111],v0,s[20:23],s92 offen offset:2048 sc1
s_sub_u32 s90,s90,1
s_cmp_gt_i32 s90,0
s_cbranch_scc1 dlp_100794
s_branch dgo_100793
dcp_100796:
v_mov_b32 v24,v104
v_mov_b32 v25,v105
v_mov_b32 v26,v106
v_mov_b32 v27,v107
s_nop 1
s_branch dgo_100793
dcp_100797:
v_mov_b32 v24,v108
v_mov_b32 v25,v109
v_mov_b32 v26,v110
v_mov_b32 v27,v111
s_nop 1
dgo_100793:
v_smfmac_f32_16x16x64_bf16 v[64:67],v[24:27],a[160:167],v1
v_smfmac_f32_16x16x64_bf16 v[68:71],v[24:27],a[168:175],v1
v_smfmac_f32_16x16x64_bf16 v[72:75],v[24:27],a[176:183],v1
v_smfmac_f32_16x16x64_bf16 v[76:79],v[24:27],a[184:191],v1
dsk_100792:
s_bitcmp1_b32 s55,3
s_cbranch_scc0 dsk_100798
s_waitcnt vmcnt(2)
v_max3_u32 v124,v28,v29,v30
v_max_u32 v124,v124,v31
v_cmp_eq_u32 vcc,-1,v124
s_cbranch_vccz dgo_100799
s_nop 15
buffer_load_dwordx4 v[104:107],v0,s[20:23],s92 offen offset:3072 sc1
s_nop 15
buffer_load_dwordx4 v[108:111],v0,s[20:23],s92 offen offset:3072 sc1
dlp_100800:
s_waitcnt vmcnt(2)
v_max3_u32 v124,v28,v29,v30
v_max_u32 v124,v124,v31
v_cmp_eq_u32 vcc,-1,v124
s_cbranch_vccz dgo_100799
buffer_load_dwordx4 v[28:31],v0,s[20:23],s92 offen offset:3072 sc1
s_waitcnt vmcnt(2)
v_max3_u32 v124,v104,v105,v106
v_max_u32 v124,v124,v107
v_cmp_eq_u32 vcc,-1,v124
s_cbranch_vccz dcp_100802
buffer_load_dwordx4 v[104:107],v0,s[20:23],s92 offen offset:3072 sc1
s_waitcnt vmcnt(2)
v_max3_u32 v124,v108,v109,v110
v_max_u32 v124,v124,v111
v_cmp_eq_u32 vcc,-1,v124
s_cbranch_vccz dcp_100803
buffer_load_dwordx4 v[108:111],v0,s[20:23],s92 offen offset:3072 sc1
s_sub_u32 s90,s90,1
s_cmp_gt_i32 s90,0
s_cbranch_scc1 dlp_100800
s_branch dgo_100799
dcp_100802:
v_mov_b32 v28,v104
v_mov_b32 v29,v105
v_mov_b32 v30,v106
v_mov_b32 v31,v107
s_nop 1
s_branch dgo_100799
dcp_100803:
v_mov_b32 v28,v108
v_mov_b32 v29,v109
v_mov_b32 v30,v110
v_mov_b32 v31,v111
s_nop 1
dgo_100799:
v_smfmac_f32_16x16x64_bf16 v[64:67],v[28:31],a[224:231],v1
v_smfmac_f32_16x16x64_bf16 v[68:71],v[28:31],a[232:239],v1
v_smfmac_f32_16x16x64_bf16 v[72:75],v[28:31],a[240:247],v1
v_smfmac_f32_16x16x64_bf16 v[76:79],v[28:31],a[248:255],v1
dsk_100798:
s_mov_b32 s55,0
s_branch Ldone_100716
slowA_100515:
buffer_load_dwordx4 v[44:47],v0,s[20:23],s93 offen offset:3072 sc1
dsk_100804:
s_bitcmp1_b32 s55,7
s_cbranch_scc0 dsk_100805
s_waitcnt vmcnt(2)
v_max3_u32 v124,v44,v45,v46
v_max_u32 v124,v124,v47
v_cmp_eq_u32 vcc,-1,v124
s_cbranch_vccz dgo_100806
s_nop 15
s_nop 3
buffer_load_dwordx4 v[104:107],v0,s[20:23],s93 offen offset:3072 sc1
s_nop 15
s_nop 3
buffer_load_dwordx4 v[108:111],v0,s[20:23],s93 offen offset:3072 sc1
dlp_100807:
s_waitcnt vmcnt(2)
v_max3_u32 v124,v44,v45,v46
v_max_u32 v124,v124,v47
v_cmp_eq_u32 vcc,-1,v124
s_cbranch_vccz dgo_100806
buffer_load_dwordx4 v[44:47],v0,s[20:23],s93 offen offset:3072 sc1
s_waitcnt vmcnt(2)
v_max3_u32 v124,v104,v105,v106
v_max_u32 v124,v124,v107
v_cmp_eq_u32 vcc,-1,v124
s_cbranch_vccz dcp_100809
buffer_load_dwordx4 v[104:107],v0,s[20:23],s93 offen offset:3072 sc1
s_waitcnt vmcnt(2)
v_max3_u32 v124,v108,v109,v110
v_max_u32 v124,v124,v111
v_cmp_eq_u32 vcc,-1,v124
s_cbranch_vccz dcp_100810
buffer_load_dwordx4 v[108:111],v0,s[20:23],s93 offen offset:3072 sc1
s_sub_u32 s90,s90,1
s_cmp_gt_i32 s90,0
s_cbranch_scc1 dlp_100807
s_branch dgo_100806
dcp_100809:
v_mov_b32 v44,v104
v_mov_b32 v45,v105
v_mov_b32 v46,v106
v_mov_b32 v47,v107
s_nop 1
s_branch dgo_100806
dcp_100810:
v_mov_b32 v44,v108
v_mov_b32 v45,v109
v_mov_b32 v46,v110
v_mov_b32 v47,v111
s_nop 1
dgo_100806:
dsk_100805:
s_mov_b32 s55,0
s_branch segb_100497
recslow_100412:
s_mov_b32 s55,0
s_cmp_lg_u32 s50,0
s_cbranch_scc1 np0_100813
v_mov_b32 v120,0
v_mov_b32 v121,0
s_cmp_lg_u32 s58,0
s_cbranch_scc1 z1_100814
v_lshrrev_b32 v124,6,v127
v_lshlrev_b32 v124,12,v124
v_bfe_u32 v125,v127,1,5
v_add_u32 v124,v124,v125
s_lshl_b32 s64,s59,6
buffer_load_ushort v120,v124,s[44:47],s64 offen
buffer_load_ushort v122,v124,s[44:47],s64 offen offset:32
buffer_load_ushort v121,v124,s[44:47],s64 offen offset:2048
buffer_load_ushort v123,v124,s[44:47],s64 offen offset:2080
s_waitcnt vmcnt(0)
v_lshl_or_b32 v120,v122,16,v120
v_lshl_or_b32 v121,v123,16,v121
v_min_u32 v120,s81,v120
v_min_u32 v121,s81,v121
z1_100814:
buffer_store_dword v120,v4,s[20:23],s71 offen sc1
buffer_store_dword v121,v4,s[20:23],s71 offen offset:32 sc1
buffer_store_dword v120,v4,s[20:23],s73 offen sc1
buffer_store_dword v121,v4,s[20:23],s73 offen offset:32 sc1
np0_100813:
v_lshrrev_b32 v124,2,v0
v_bfe_u32 v125,v124,5,1
v_mul_u32_u24 v125,2048,v125
s_and_b32 s64,s50,1
s_lshl_b32 s64,s64,5
v_add3_u32 v4,v124,v125,s64
s_add_u32 s64,s79,0
s_cmp_gt_u32 s91,s64
s_cbranch_scc0 flp_100817
fok_100816:
s_add_u32 s64,s79,0
s_lshl_b32 s65,s64,12
s_and_b32 s65,s65,0x2000
s_xor_b32 s65,s65,s67
s_lshl_b32 s64,s64,20
s_add_u32 s65,s65,s64
s_add_u32 s99,s65,s77
buffer_load_dwordx4 v[104:107],v0,s[20:23],s99 offen
buffer_load_dwordx4 v[108:111],v0,s[20:23],s99 offen offset:1024
s_waitcnt vmcnt(0)
s_mov_b32 s92,s70
s_mov_b32 s93,s72
s_mov_b32 s94,s76
s_add_u32 s95,s94,4096
s_mov_b32 s96,s74
s_add_u32 s97,s96,4096
s_mov_b32 s98,s75
s_barrier
v_mov_b32 v96,v104
v_mov_b32 v97,v105
v_mov_b32 v98,v106
v_mov_b32 v99,v107
v_mov_b32 v100,v108
v_mov_b32 v101,v109
v_mov_b32 v102,v110
v_mov_b32 v103,v111
v_mov_b32 v48,0
v_mov_b32 v49,0
v_mov_b32 v50,0
v_mov_b32 v51,0
v_mov_b32 v52,0
v_mov_b32 v53,0
v_mov_b32 v54,0
v_mov_b32 v55,0
v_mov_b32 v56,0
v_mov_b32 v57,0
v_mov_b32 v58,0
v_mov_b32 v59,0
v_mov_b32 v60,0
v_mov_b32 v61,0
v_mov_b32 v62,0
v_mov_b32 v63,0
v_mov_b32 v64,0
v_mov_b32 v65,0
v_mov_b32 v66,0
v_mov_b32 v67,0
v_mov_b32 v68,0
v_mov_b32 v69,0
v_mov_b32 v70,0
v_mov_b32 v71,0
v_mov_b32 v72,0
v_mov_b32 v73,0
v_mov_b32 v74,0
v_mov_b32 v75,0
v_mov_b32 v76,0
v_mov_b32 v77,0
v_mov_b32 v78,0
v_mov_b32 v79,0
v_mov_b32 v80,0
v_mov_b32 v81,0
v_mov_b32 v82,0
v_mov_b32 v83,0
v_mov_b32 v84,0
v_mov_b32 v85,0
v_mov_b32 v86,0
v_mov_b32 v87,0
v_mov_b32 v88,0
v_mov_b32 v89,0
v_mov_b32 v90,0
v_mov_b32 v91,0
v_mov_b32 v92,0
v_mov_b32 v93,0
v_mov_b32 v94,0
v_mov_b32 v95,0
s_cmp_gt_u32 s50,1
s_cbranch_scc0 loop0_100815x
.p2align 6
s_nop 0
s_nop 0
s_nop 0
s_nop 0
s_nop 0
s_nop 0
s_nop 0
loop_100811:
v_mov_b32 v125,0
s_nop 1
v_mfma_f32_16x16x1_4b_f32 v[48:63],v125,v125,0
v_mfma_f32_16x16x1_4b_f32 v[64:79],v125,v125,0
v_mfma_f32_16x16x1_4b_f32 v[80:95],v125,v125,0
s_max_u32 s66,s79,1
s_sub_u32 s66,s66,1
v_cndmask_b32 v126,2.0,v0,s[82:83]
s_add_u32 s64,s66,0
s_lshl_b32 s65,s64,12
s_and_b32 s65,s65,0x2000
s_xor_b32 s65,s65,s67
s_lshl_b32 s64,s64,20
s_add_u32 s65,s65,s64
s_add_u32 s101,s65,s78
buffer_store_dwordx4 v[112:115],v126,s[20:23],s101 offen sc1
s_nop 15
s_nop 15
s_nop 15
s_nop 7
buffer_load_dwordx4 v[16:19],v0,s[20:23],s92 offen offset:0 sc1
s_nop 7
buffer_load_dwordx4 v[20:23],v0,s[20:23],s92 offen offset:1024 sc1
s_nop 7
buffer_load_dwordx4 v[24:27],v0,s[20:23],s92 offen offset:2048 sc1
s_nop 7
buffer_load_dwordx4 v[28:31],v0,s[20:23],s92 offen offset:3072 sc1
v_mov_b32 v96,v104
v_mov_b32 v97,v105
v_mov_b32 v98,v106
v_mov_b32 v99,v107
v_mov_b32 v100,v108
v_mov_b32 v101,v109
v_mov_b32 v102,v110
v_mov_b32 v103,v111
s_branch ja_100818
loop0_100815x:
v_mov_b32 v125,0
s_nop 1
v_mfma_f32_16x16x1_4b_f32 v[48:63],v125,v125,0
v_mfma_f32_16x16x1_4b_f32 v[64:79],v125,v125,0
v_mfma_f32_16x16x1_4b_f32 v[80:95],v125,v125,0
s_max_u32 s66,s79,1
s_sub_u32 s66,s66,1
v_cndmask_b32 v126,2.0,v0,s[82:83]
s_add_u32 s64,s66,0
s_lshl_b32 s65,s64,12
s_and_b32 s65,s65,0x2000
s_xor_b32 s65,s65,s67
s_lshl_b32 s64,s64,20
s_add_u32 s65,s65,s64
s_add_u32 s101,s65,s78
buffer_store_dwordx4 v[112:115],v126,s[20:23],s101 offen sc1
s_nop 15
s_nop 3
buffer_load_dwordx4 v[16:19],v0,s[20:23],s92 offen offset:0 sc1
s_nop 7
buffer_load_dwordx4 v[20:23],v0,s[20:23],s92 offen offset:1024 sc1
s_nop 7
buffer_load_dwordx4 v[24:27],v0,s[20:23],s92 offen offset:2048 sc1
s_nop 7
buffer_load_dwordx4 v[28:31],v0,s[20:23],s92 offen offset:3072 sc1
ja_100818:
v_mov_b32 v126,s79
s_cmp_eq_u32 s79,63
s_cbranch_scc1 last_100812
s_add_u32 s64,s79,1
s_lshl_b32 s65,s64,12
s_and_b32 s65,s65,0x2000
s_xor_b32 s65,s65,s67
s_lshl_b32 s64,s64,20
s_add_u32 s65,s65,s64
s_add_u32 s99,s65,s77
s_waitcnt vmcnt(3)
v_max3_u32 v124,v16,v17,v18
v_max_u32 v124,v124,v19
v_cmp_eq_u32 vcc,-1,v124
v_cndmask_b32 v121,2.0,v127,s[86:87]
s_cbranch_vccnz flb_100845
seg_100821:
segb_100829:
v_smfmac_f32_16x16x64_bf16 v[48:51],v[16:19],a[0:7],v1
buffer_load_dword v125,off,s[20:23],s92 sc1
v_smfmac_f32_16x16x64_bf16 v[52:55],v[16:19],a[8:15],v1
buffer_load_dwordx4 v[32:35],v0,s[20:23],s93 offen offset:0 sc1
v_smfmac_f32_16x16x64_bf16 v[56:59],v[16:19],a[16:23],v1
s_waitcnt vmcnt(4)
v_max3_u32 v124,v20,v21,v22
v_smfmac_f32_16x16x64_bf16 v[60:63],v[16:19],a[24:31],v1
v_max_u32 v124,v124,v23
v_smfmac_f32_16x16x64_bf16 v[64:67],v[16:19],a[32:39],v1
v_cmp_eq_u32 vcc,-1,v124
v_smfmac_f32_16x16x64_bf16 v[68:71],v[16:19],a[40:47],v1
v_smfmac_f32_16x16x64_bf16 v[72:75],v[16:19],a[48:55],v1
s_cbranch_vccnz fl_100838
seg_100822:
v_smfmac_f32_16x16x64_bf16 v[76:79],v[16:19],a[56:63],v1
segb_100830:
v_smfmac_f32_16x16x64_bf16 v[48:51],v[20:23],a[64:71],v1
buffer_load_dword v125,off,s[20:23],s92 sc1
v_smfmac_f32_16x16x64_bf16 v[52:55],v[20:23],a[72:79],v1
buffer_load_dwordx4 v[36:39],v0,s[20:23],s93 offen offset:1024 sc1
v_smfmac_f32_16x16x64_bf16 v[56:59],v[20:23],a[80:87],v1
s_waitcnt vmcnt(5)
v_max3_u32 v124,v24,v25,v26
v_smfmac_f32_16x16x64_bf16 v[60:63],v[20:23],a[88:95],v1
v_max_u32 v124,v124,v27
v_smfmac_f32_16x16x64_bf16 v[64:67],v[20:23],a[96:103],v1
v_cmp_eq_u32 vcc,-1,v124
v_smfmac_f32_16x16x64_bf16 v[68:71],v[20:23],a[104:111],v1
v_smfmac_f32_16x16x64_bf16 v[72:75],v[20:23],a[112:119],v1
s_cbranch_vccnz fl_100839
seg_100823:
v_smfmac_f32_16x16x64_bf16 v[76:79],v[20:23],a[120:127],v1
segb_100831:
v_smfmac_f32_16x16x64_bf16 v[48:51],v[24:27],a[128:135],v1
buffer_load_dword v125,off,s[20:23],s92 sc1
v_smfmac_f32_16x16x64_bf16 v[52:55],v[24:27],a[136:143],v1
buffer_load_dwordx4 v[40:43],v0,s[20:23],s93 offen offset:2048 sc1
v_smfmac_f32_16x16x64_bf16 v[56:59],v[24:27],a[144:151],v1
buffer_load_dwordx4 v[44:47],v0,s[20:23],s93 offen offset:3072 sc1
s_waitcnt vmcnt(7)
v_max3_u32 v124,v28,v29,v30
v_smfmac_f32_16x16x64_bf16 v[60:63],v[24:27],a[152:159],v1
v_max_u32 v124,v124,v31
v_smfmac_f32_16x16x64_bf16 v[64:67],v[24:27],a[160:167],v1
v_cmp_eq_u32 vcc,-1,v124
v_smfmac_f32_16x16x64_bf16 v[68:71],v[24:27],a[168:175],v1
v_smfmac_f32_16x16x64_bf16 v[72:75],v[24:27],a[176:183],v1
s_cbranch_vccnz fl_100840
seg_100824:
v_smfmac_f32_16x16x64_bf16 v[76:79],v[24:27],a[184:191],v1
segb_100832:
v_smfmac_f32_16x16x64_bf16 v[48:51],v[28:31],a[192:199],v1
buffer_load_dword v125,off,s[20:23],s92 sc1
v_smfmac_f32_16x16x64_bf16 v[52:55],v[28:31],a[200:207],v1
buffer_store_dword v126,v121,s[20:23],s69 offen sc1
v_smfmac_f32_16x16x64_bf16 v[56:59],v[28:31],a[208:215],v1
s_waitcnt vmcnt(7)
v_max3_u32 v124,v32,v33,v34
v_smfmac_f32_16x16x64_bf16 v[60:63],v[28:31],a[216:223],v1
v_max_u32 v124,v124,v35
v_smfmac_f32_16x16x64_bf16 v[64:67],v[28:31],a[224:231],v1
v_cmp_eq_u32 vcc,-1,v124
v_smfmac_f32_16x16x64_bf16 v[68:71],v[28:31],a[232:239],v1
v_smfmac_f32_16x16x64_bf16 v[72:75],v[28:31],a[240:247],v1
s_cbranch_vccnz fl_100841
seg_100825:
v_smfmac_f32_16x16x64_bf16 v[76:79],v[28:31],a[248:255],v1
segb_100833:
v_smfmac_f32_16x16x64_bf16 v[48:51],v[32:35],a[0:7],v1
buffer_load_dword v125,off,s[20:23],s92 sc1
v_smfmac_f32_16x16x64_bf16 v[52:55],v[32:35],a[8:15],v1
v_smfmac_f32_16x16x64_bf16 v[56:59],v[32:35],a[16:23],v1
s_waitcnt vmcnt(6)
v_max3_u32 v124,v36,v37,v38
v_smfmac_f32_16x16x64_bf16 v[60:63],v[32:35],a[24:31],v1
v_max_u32 v124,v124,v39
v_smfmac_f32_16x16x64_bf16 v[64:67],v[32:35],a[32:39],v1
v_cmp_eq_u32 vcc,-1,v124
v_smfmac_f32_16x16x64_bf16 v[68:71],v[32:35],a[40:47],v1
v_smfmac_f32_16x16x64_bf16 v[72:75],v[32:35],a[48:55],v1
s_cbranch_vccnz fl_100842
seg_100826:
v_smfmac_f32_16x16x64_bf16 v[76:79],v[32:35],a[56:63],v1
segb_100834:
v_smfmac_f32_16x16x64_bf16 v[48:51],v[36:39],a[64:71],v1
buffer_load_dword v125,off,s[20:23],s92 sc1
s_waitcnt vmcnt(4)
v_max3_u32 v124,v40,v41,v42
v_smfmac_f32_16x16x64_bf16 v[52:55],v[36:39],a[72:79],v1
v_max3_u32 v124,v124,v43,v44
v_smfmac_f32_16x16x64_bf16 v[56:59],v[36:39],a[80:87],v1
v_max3_u32 v124,v124,v45,v46
v_smfmac_f32_16x16x64_bf16 v[60:63],v[36:39],a[88:95],v1
v_max_u32 v124,v124,v47
v_smfmac_f32_16x16x64_bf16 v[64:67],v[36:39],a[96:103],v1
v_cmp_eq_u32 vcc,-1,v124
v_smfmac_f32_16x16x64_bf16 v[68:71],v[36:39],a[104:111],v1
v_smfmac_f32_16x16x64_bf16 v[72:75],v[36:39],a[112:119],v1
s_cbranch_vccnz fl_100843
seg_100827:
v_smfmac_f32_16x16x64_bf16 v[76:79],v[36:39],a[120:127],v1
segb_100835:
v_smfmac_f32_16x16x64_bf16 v[48:51],v[40:43],a[128:135],v1
s_add_u32 s64,s79,1
s_cmp_gt_u32 s91,s64
s_cbranch_scc0 flp_100820
fok_100819:
v_smfmac_f32_16x16x64_bf16 v[52:55],v[40:43],a[136:143],v1
buffer_load_dwordx4 v[104:107],v0,s[20:23],s99 offen
buffer_load_dwordx4 v[108:111],v0,s[20:23],s99 offen offset:1024
v_smfmac_f32_16x16x64_bf16 v[48:51],v[44:47],a[192:199],v1
buffer_load_dword v126,off,s[20:23],s68 sc1
s_add_u32 s64,s79,2
v_smfmac_f32_16x16x64_bf16 v[52:55],v[44:47],a[200:207],v1
s_and_b32 s64,s64,3
s_lshl_b32 s100,s64,19
s_nop 0
v_add_f32 v48,v48,v49
v_smfmac_f32_16x16x64_bf16 v[56:59],v[40:43],a[144:151],v1
ds_write_addtid_b32 v48 offset:0
v_add_f32 v50,v50,v51
v_smfmac_f32_16x16x64_bf16 v[60:63],v[40:43],a[152:159],v1
ds_write_addtid_b32 v50 offset:1040
v_add_f32 v52,v52,v53
v_smfmac_f32_16x16x64_bf16 v[56:59],v[44:47],a[208:215],v1
ds_write_addtid_b32 v52 offset:2080
v_add_f32 v54,v54,v55
v_smfmac_f32_16x16x64_bf16 v[60:63],v[44:47],a[216:223],v1
ds_write_addtid_b32 v54 offset:3120
s_nop 1
v_add_f32 v56,v56,v57
v_smfmac_f32_16x16x64_bf16 v[64:67],v[40:43],a[160:167],v1
ds_write_addtid_b32 v56 offset:4160
v_add_f32 v58,v58,v59
v_smfmac_f32_16x16x64_bf16 v[68:71],v[40:43],a[168:175],v1
ds_write_addtid_b32 v58 offset:5200
v_add_f32 v60,v60,v61
v_smfmac_f32_16x16x64_bf16 v[64:67],v[44:47],a[224:231],v1
ds_write_addtid_b32 v60 offset:6240
v_add_f32 v62,v62,v63
v_smfmac_f32_16x16x64_bf16 v[68:71],v[44:47],a[232:239],v1
ds_write_addtid_b32 v62 offset:7280
s_nop 1
v_add_f32 v64,v64,v65
v_smfmac_f32_16x16x64_bf16 v[72:75],v[40:43],a[176:183],v1
ds_write_addtid_b32 v64 offset:8448
v_add_f32 v66,v66,v67
v_smfmac_f32_16x16x64_bf16 v[76:79],v[40:43],a[184:191],v1
ds_write_addtid_b32 v66 offset:9488
v_add_f32 v68,v68,v69
v_smfmac_f32_16x16x64_bf16 v[72:75],v[44:47],a[240:247],v1
ds_write_addtid_b32 v68 offset:10528
v_add_f32 v70,v70,v71
v_smfmac_f32_16x16x64_bf16 v[76:79],v[44:47],a[248:255],v1
ds_write_addtid_b32 v70 offset:11568
s_nop 1
v_add_f32 v72,v72,v73
v_smfmac_f32_16x16x64_bf16 v[80:83],v[16:19],v[208:215],v1
ds_write_addtid_b32 v72 offset:12608
v_add_f32 v74,v74,v75
v_smfmac_f32_16x16x64_bf16 v[80:83],v[32:35],v[208:215],v1
ds_write_addtid_b32 v74 offset:13648
v_add_f32 v76,v76,v77
ds_write_addtid_b32 v76 offset:14688
v_add_f32 v78,v78,v79
ds_write_addtid_b32 v78 offset:15728
doneA_100854:
s_waitcnt lgkmcnt(0)
s_barrier
s_cmp_gt_u32 s50,1
s_cbranch_scc1 w23_100855
v_smfmac_f32_16x16x64_bf16 v[84:87],v[16:19],v[216:223],v1
v_smfmac_f32_16x16x64_bf16 v[84:87],v[32:35],v[216:223],v1
v_smfmac_f32_16x16x64_bf16 v[88:91],v[16:19],v[224:231],v1
v_smfmac_f32_16x16x64_bf16 v[88:91],v[32:35],v[224:231],v1
v_smfmac_f32_16x16x64_bf16 v[92:95],v[16:19],v[232:239],v1
ds_read_b128 v[48:51],v7 offset:0
ds_read_b128 v[52:55],v7 offset:1024
v_smfmac_f32_16x16x64_bf16 v[92:95],v[32:35],v[232:239],v1
ds_read_b128 v[56:59],v7 offset:2048
ds_read_b128 v[60:63],v7 offset:3072
v_smfmac_f32_16x16x64_bf16 v[80:83],v[20:23],v[240:247],v1
ds_read_b128 v[64:67],v7 offset:4096
ds_read_b128 v[68:71],v7 offset:5120
v_smfmac_f32_16x16x64_bf16 v[80:83],v[36:39],v[240:247],v1
ds_read_b128 v[72:75],v7 offset:6144
ds_read_b128 v[76:79],v7 offset:7168
v_smfmac_f32_16x16x64_bf16 v[84:87],v[20:23],v[248:255],v1
v_smfmac_f32_16x16x64_bf16 v[84:87],v[36:39],v[248:255],v1
s_waitcnt lgkmcnt(6)
v_smfmac_f32_16x16x64_bf16 v[88:91],v[20:23],v[48:55],v1
v_smfmac_f32_16x16x64_bf16 v[88:91],v[36:39],v[48:55],v1
ds_read_b128 v[48:51],v7 offset:8192
ds_read_b128 v[52:55],v7 offset:9216
s_waitcnt lgkmcnt(6)
v_smfmac_f32_16x16x64_bf16 v[92:95],v[20:23],v[56:63],v1
v_smfmac_f32_16x16x64_bf16 v[92:95],v[36:39],v[56:63],v1
ds_read_b128 v[56:59],v7 offset:10240
ds_read_b128 v[60:63],v7 offset:11264
s_waitcnt lgkmcnt(6)
v_smfmac_f32_16x16x64_bf16 v[80:83],v[24:27],v[64:71],v1
v_smfmac_f32_16x16x64_bf16 v[80:83],v[40:43],v[64:71],v1
ds_read_b128 v[64:67],v7 offset:12288
ds_read_b128 v[68:71],v7 offset:13312
s_waitcnt lgkmcnt(6)
v_smfmac_f32_16x16x64_bf16 v[84:87],v[24:27],v[72:79],v1
v_smfmac_f32_16x16x64_bf16 v[84:87],v[40:43],v[72:79],v1
ds_read_b128 v[72:75],v7 offset:14336
ds_read_b128 v[76:79],v7 offset:15360
s_waitcnt lgkmcnt(6)
v_smfmac_f32_16x16x64_bf16 v[88:91],v[24:27],v[48:55],v1
v_smfmac_f32_16x16x64_bf16 v[88:91],v[40:43],v[48:55],v1
ds_read_b128 v[48:51],v7 offset:16384
ds_read_b128 v[52:55],v7 offset:17408
s_waitcnt lgkmcnt(6)
v_smfmac_f32_16x16x64_bf16 v[92:95],v[24:27],v[56:63],v1
v_smfmac_f32_16x16x64_bf16 v[92:95],v[40:43],v[56:63],v1
ds_read_b128 v[56:59],v7 offset:18432
ds_read_b128 v[60:63],v7 offset:19456
s_waitcnt lgkmcnt(6)
v_smfmac_f32_16x16x64_bf16 v[80:83],v[28:31],v[64:71],v1
v_smfmac_f32_16x16x64_bf16 v[80:83],v[44:47],v[64:71],v1
s_waitcnt lgkmcnt(4)
v_smfmac_f32_16x16x64_bf16 v[84:87],v[28:31],v[72:79],v1
v_smfmac_f32_16x16x64_bf16 v[84:87],v[44:47],v[72:79],v1
s_waitcnt lgkmcnt(2)
v_smfmac_f32_16x16x64_bf16 v[88:91],v[28:31],v[48:55],v1
v_add_f32 v80,v80,v81
v_smfmac_f32_16x16x64_bf16 v[88:91],v[44:47],v[48:55],v1
v_add_f32 v82,v82,v83
s_waitcnt lgkmcnt(0)
v_smfmac_f32_16x16x64_bf16 v[92:95],v[28:31],v[56:63],v1
v_cvt_pk_bf16_f32 v80,v80,v82
v_smfmac_f32_16x16x64_bf16 v[92:95],v[44:47],v[56:63],v1
buffer_load_dwordx4 v[16:19],v2,s[20:23],s94 offen offset:0 sc1
ds_write_addtid_b32 v80 offset:16896
v_add_f32 v84,v84,v85
buffer_load_dwordx4 v[32:35],v2,s[20:23],s94 offen offset:1536 sc1
buffer_load_dwordx4 v[20:23],v2,s[20:23],s95 offen offset:0 sc1
buffer_load_dwordx4 v[36:39],v2,s[20:23],s95 offen offset:1536 sc1
buffer_load_dword v120,v3,s[20:23],s94 offen offset:0 sc1
buffer_load_dword v121,v3,s[20:23],s94 offen offset:1536 sc1
buffer_load_dword v122,v3,s[20:23],s95 offen offset:0 sc1
buffer_load_dword v123,v3,s[20:23],s95 offen offset:1536 sc1
v_add_f32 v86,v86,v87
v_cvt_pk_bf16_f32 v84,v84,v86
v_add_f32 v88,v88,v89
v_add_f32 v90,v90,v91
v_cvt_pk_bf16_f32 v88,v88,v90
v_add_f32 v92,v92,v93
v_add_f32 v94,v94,v95
v_cvt_pk_bf16_f32 v92,v92,v94
ds_write_addtid_b32 v84 offset:17920
ds_write_addtid_b32 v88 offset:18944
ds_write_addtid_b32 v92 offset:19968
sp_100859:
s_waitcnt vmcnt(6)
v_pk_add_f32 v[16:17],v[16:17],v[32:33]
v_pk_add_f32 v[18:19],v[18:19],v[34:35]
s_waitcnt vmcnt(4)
v_pk_add_f32 v[20:21],v[20:21],v[36:37]
v_pk_add_f32 v[22:23],v[22:23],v[38:39]
v_pk_add_f32 v[16:17],v[16:17],v[20:21]
v_pk_add_f32 v[18:19],v[18:19],v[22:23]
v_max3_f32 v124,v16,v17,v18
v_pk_add_f32 v[20:21],v[16:17],v[18:19]
s_waitcnt vmcnt(0)
v_pk_add_f32 v[120:121],v[120:121],v[122:123]
v_add_f32 v120,v120,v121
v_max3_f32 v124,v124,v19,v120
v_add_f32 v20,v20,v120
v_cmp_u_f32 vcc,v20,v21
v_max_f32_dpp v124,v124,v124 row_ror:8 row_mask:0xf bank_mask:0xf
v_mov_b32 v125,v124
s_cbranch_vccnz srt_100861
sok_100860:
s_nop 0
v_permlane16_swap_b32 v125,v124
v_max_f32 v124,v124,v125
v_mov_b32 v125,v124
s_nop 1
v_permlane32_swap_b32 v125,v124
v_max_f32 v124,v124,v125
v_mul_f32 v124,s80,v124
v_fma_f32 v16,v16,s80,-v124
v_fma_f32 v17,v17,s80,-v124
v_fma_f32 v18,v18,s80,-v124
v_fma_f32 v19,v19,s80,-v124
v_fma_f32 v120,v120,s80,-v124
s_waitcnt lgkmcnt(0)
s_barrier
ds_read2st64_b32 v[112:113],v127 offset0:66 offset1:67
ds_read2st64_b32 v[114:115],v127 offset0:68 offset1:69
ds_read2st64_b32 v[116:117],v127 offset0:70 offset1:71
ds_read2st64_b32 v[118:119],v127 offset0:72 offset1:73
v_exp_f32 v16,v16
v_exp_f32 v17,v17
v_exp_f32 v18,v18
v_exp_f32 v19,v19
v_cvt_pk_bf16_f32 v48,v16,v17
v_cvt_pk_bf16_f32 v49,v18,v19
v_exp_f32 v120,v120
v_mov_b32_dpp v50,v48 row_ror:8 row_mask:0xf bank_mask:0xf
v_mov_b32_dpp v51,v49 row_ror:8 row_mask:0xf bank_mask:0xf
v_mov_b32_dpp v121,v120 row_ror:8 row_mask:0xf bank_mask:0xf
v_cvt_pk_bf16_f32 v52,v120,v121
v_mfma_f32_16x16x32_bf16 v[64:67],v[8:11],v[48:51],0
v_mov_b32 v53,v52
v_mfma_f32_16x16x32_bf16 v[56:59],v[96:99],v[48:51],0
v_mov_b32 v54,v52
v_mov_b32 v55,v52
v_mfma_f32_16x16x32_bf16 v[60:63],v[100:103],v[48:51],0
v_mfma_f32_16x16x32_bf16 v[64:67],v[12:15],v[52:55],v[64:67]
s_waitcnt lgkmcnt(0)
v_mfma_f32_16x16x32_bf16 v[56:59],v[112:115],v[52:55],v[56:59]
v_mfma_f32_16x16x32_bf16 v[60:63],v[116:119],v[52:55],v[60:63]
s_nop 0
v_rcp_f32 v66,v64
s_nop 2
v_pk_mul_f32 v[56:57],v[56:57],v[66:67] op_sel_hi:[1,0]
v_pk_mul_f32 v[58:59],v[58:59],v[66:67] op_sel_hi:[1,0]
s_nop 0
v_pk_mul_f32 v[60:61],v[60:61],v[66:67] op_sel_hi:[1,0]
v_pk_mul_f32 v[62:63],v[62:63],v[66:67] op_sel_hi:[1,0]
v_cvt_pk_bf16_f32 v120,v56,v57
v_cvt_pk_bf16_f32 v121,v58,v59
v_cvt_pk_bf16_f32 v122,v60,v61
v_cvt_pk_bf16_f32 v123,v62,v63
buffer_store_dwordx4 v[120:123],v6,s[20:23],s98 offen sc1
s_barrier
ds_read_b128 v[48:51],v7 offset:20480
ds_read_b128 v[52:55],v7 offset:21504
ds_read_b128 v[56:59],v7 offset:22528
ds_read_b128 v[60:63],v7 offset:23552
ds_read_b128 v[64:67],v7 offset:24576
ds_read_b128 v[68:71],v7 offset:25600
ds_read_b128 v[72:75],v7 offset:26624
ds_read_b128 v[76:79],v7 offset:27648
ds_read_b128 v[80:83],v7 offset:28672
ds_read_b128 v[84:87],v7 offset:29696
ds_read_b128 v[88:91],v7 offset:30720
ds_read_b128 v[92:95],v7 offset:31744
v_mov_b32 v96,0
v_mov_b32 v97,0
v_mov_b32 v98,0
v_mov_b32 v99,0
v_mov_b32 v100,0
v_mov_b32 v101,0
v_mov_b32 v102,0
v_mov_b32 v103,0
s_nop 11
buffer_load_dwordx4 v[16:19],v0,s[20:23],s96 offen offset:0 sc1
v_mov_b32 v120,v5
v_mov_b32 v121,v5
v_mov_b32 v122,v5
v_mov_b32 v123,v5
s_nop 1
v_mfma_f32_16x16x32_bf16 v[112:115],v[120:123],v[112:115],0
buffer_load_dwordx4 v[20:23],v0,s[20:23],s96 offen offset:1024 sc1
v_mfma_f32_16x16x32_bf16 v[116:119],v[120:123],v[116:119],0
s_add_u32 s79,s79,1
s_and_b32 s64,s79,3
s_lshl_b32 s64,s64,19
s_lshl_b32 s65,s79,8
buffer_load_dwordx4 v[24:27],v0,s[20:23],s96 offen offset:2048 sc1
s_and_b32 s65,s65,0x2000
s_lshl_b32 s66,s79,16
s_xor_b32 s88,s73,s65
s_add_u32 s88,s88,s66
s_sub_u32 s88,s88,s54
s_add_u32 s89,s71,s64
s_add_u32 s92,s70,s64
s_xor_b32 s93,s72,s65
buffer_load_dwordx4 v[28:31],v0,s[20:23],s96 offen offset:3072 sc1
s_add_u32 s93,s93,s66
s_add_u32 s94,s76,s64
s_add_u32 s95,s94,4096
s_add_u32 s98,s75,s64
s_add_u32 s60,s74,s64
v_cvt_pk_bf16_f32 v112,v112,v113
v_cvt_pk_bf16_f32 v113,v114,v115
v_cvt_pk_bf16_f32 v114,v116,v117
buffer_load_dwordx4 v[32:35],v0,s[20:23],s97 offen offset:0 sc1
v_cvt_pk_bf16_f32 v115,v118,v119
s_nop 6
buffer_load_dwordx4 v[36:39],v0,s[20:23],s97 offen offset:1024 sc1
s_nop 7
buffer_load_dwordx4 v[40:43],v0,s[20:23],s97 offen offset:2048 sc1
s_nop 7
buffer_load_dwordx4 v[44:47],v0,s[20:23],s97 offen offset:3072 sc1
s_branch ogo_100856
w23_100855:
ds_read_b128 v[48:51],v2 offset:0
ds_read_b128 v[52:55],v2 offset:256
ds_read_b128 v[56:59],v2 offset:512
ds_read_b128 v[60:63],v2 offset:768
ds_read_b128 v[64:67],v2 offset:16
ds_read_b128 v[68:71],v2 offset:272
ds_read_b128 v[72:75],v2 offset:528
ds_read_b128 v[76:79],v2 offset:784
s_waitcnt lgkmcnt(6)
v_pk_add_f32 v[48:49],v[48:49],v[52:53]
v_pk_add_f32 v[50:51],v[50:51],v[54:55]
s_waitcnt lgkmcnt(4)
v_pk_add_f32 v[56:57],v[56:57],v[60:61]
v_pk_add_f32 v[58:59],v[58:59],v[62:63]
v_pk_add_f32 v[48:49],v[48:49],v[56:57]
v_pk_add_f32 v[50:51],v[50:51],v[58:59]
v_cvt_pk_bf16_f32 v112,v48,v49
v_cvt_pk_bf16_f32 v113,v50,v51
s_waitcnt lgkmcnt(2)
v_pk_add_f32 v[64:65],v[64:65],v[68:69]
v_pk_add_f32 v[66:67],v[66:67],v[70:71]
s_waitcnt lgkmcnt(0)
v_pk_add_f32 v[72:73],v[72:73],v[76:77]
v_pk_add_f32 v[74:75],v[74:75],v[78:79]
v_pk_add_f32 v[64:65],v[64:65],v[72:73]
v_pk_add_f32 v[66:67],v[66:67],v[74:75]
v_cvt_pk_bf16_f32 v114,v64,v65
v_cvt_pk_bf16_f32 v115,v66,v67
s_nop 1
v_mfma_f32_16x16x32_bf16 v[116:119],v[96:99],v[112:115],0
v_mfma_f32_16x16x32_bf16 v[120:123],v[100:103],v[112:115],0
v_mfma_f32_16x16x32_bf16 v[12:15],v[112:115],v[112:115],0
ds_read_b128 v[48:51],v7 offset:0
ds_read_b128 v[52:55],v7 offset:1024
ds_read_b128 v[56:59],v7 offset:2048
ds_read_b128 v[60:63],v7 offset:3072
ds_read_b128 v[64:67],v7 offset:4096
buffer_store_dwordx4 v[116:119],v3,s[20:23],s94 offen sc1
buffer_store_dwordx4 v[120:123],v3,s[20:23],s94 offen offset:512 sc1
s_nop 0
buffer_store_dwordx4 v[12:15],v3,s[20:23],s94 offen offset:1024 sc1
ds_read_b128 v[68:71],v7 offset:5120
ds_read_b128 v[72:75],v7 offset:6144
ds_read_b128 v[76:79],v7 offset:7168
v_smfmac_f32_16x16x64_bf16 v[84:87],v[16:19],v[216:223],v1
v_smfmac_f32_16x16x64_bf16 v[84:87],v[32:35],v[216:223],v1
v_smfmac_f32_16x16x64_bf16 v[88:91],v[16:19],v[224:231],v1
v_smfmac_f32_16x16x64_bf16 v[88:91],v[32:35],v[224:231],v1
v_smfmac_f32_16x16x64_bf16 v[92:95],v[16:19],v[232:239],v1
v_smfmac_f32_16x16x64_bf16 v[92:95],v[32:35],v[232:239],v1
v_smfmac_f32_16x16x64_bf16 v[80:83],v[20:23],v[240:247],v1
v_smfmac_f32_16x16x64_bf16 v[80:83],v[36:39],v[240:247],v1
v_smfmac_f32_16x16x64_bf16 v[84:87],v[20:23],v[248:255],v1
v_smfmac_f32_16x16x64_bf16 v[84:87],v[36:39],v[248:255],v1
s_waitcnt lgkmcnt(6)
v_smfmac_f32_16x16x64_bf16 v[88:91],v[20:23],v[48:55],v1
v_smfmac_f32_16x16x64_bf16 v[88:91],v[36:39],v[48:55],v1
ds_read_b128 v[48:51],v7 offset:8192
ds_read_b128 v[52:55],v7 offset:9216
s_waitcnt lgkmcnt(6)
v_smfmac_f32_16x16x64_bf16 v[92:95],v[20:23],v[56:63],v1
v_smfmac_f32_16x16x64_bf16 v[92:95],v[36:39],v[56:63],v1
ds_read_b128 v[56:59],v7 offset:10240
ds_read_b128 v[60:63],v7 offset:11264
s_waitcnt lgkmcnt(6)
v_smfmac_f32_16x16x64_bf16 v[80:83],v[24:27],v[64:71],v1
v_smfmac_f32_16x16x64_bf16 v[80:83],v[40:43],v[64:71],v1
ds_read_b128 v[64:67],v7 offset:12288
ds_read_b128 v[68:71],v7 offset:13312
s_waitcnt lgkmcnt(6)
v_smfmac_f32_16x16x64_bf16 v[84:87],v[24:27],v[72:79],v1
v_smfmac_f32_16x16x64_bf16 v[84:87],v[40:43],v[72:79],v1
ds_read_b128 v[72:75],v7 offset:14336
ds_read_b128 v[76:79],v7 offset:15360
s_waitcnt lgkmcnt(6)
v_smfmac_f32_16x16x64_bf16 v[88:91],v[24:27],v[48:55],v1
v_smfmac_f32_16x16x64_bf16 v[88:91],v[40:43],v[48:55],v1
ds_read_b128 v[48:51],v7 offset:16384
ds_read_b128 v[52:55],v7 offset:17408
s_waitcnt lgkmcnt(6)
v_smfmac_f32_16x16x64_bf16 v[92:95],v[24:27],v[56:63],v1
v_smfmac_f32_16x16x64_bf16 v[92:95],v[40:43],v[56:63],v1
ds_read_b128 v[56:59],v7 offset:18432
ds_read_b128 v[60:63],v7 offset:19456
s_waitcnt lgkmcnt(6)
v_smfmac_f32_16x16x64_bf16 v[80:83],v[28:31],v[64:71],v1
v_smfmac_f32_16x16x64_bf16 v[80:83],v[44:47],v[64:71],v1
s_waitcnt lgkmcnt(4)
v_smfmac_f32_16x16x64_bf16 v[84:87],v[28:31],v[72:79],v1
v_smfmac_f32_16x16x64_bf16 v[84:87],v[44:47],v[72:79],v1
s_waitcnt lgkmcnt(2)
v_smfmac_f32_16x16x64_bf16 v[88:91],v[28:31],v[48:55],v1
v_add_f32 v80,v80,v81
v_smfmac_f32_16x16x64_bf16 v[88:91],v[44:47],v[48:55],v1
v_add_f32 v82,v82,v83
s_waitcnt lgkmcnt(0)
v_smfmac_f32_16x16x64_bf16 v[92:95],v[28:31],v[56:63],v1
v_cvt_pk_bf16_f32 v80,v80,v82
v_smfmac_f32_16x16x64_bf16 v[92:95],v[44:47],v[56:63],v1
ds_write_addtid_b32 v80 offset:16896
v_add_f32 v84,v84,v85
v_add_f32 v86,v86,v87
v_cvt_pk_bf16_f32 v84,v84,v86
v_add_f32 v88,v88,v89
v_add_f32 v90,v90,v91
v_cvt_pk_bf16_f32 v88,v88,v90
s_nop 0
v_add_f32 v92,v92,v93
v_add_f32 v94,v94,v95
v_cvt_pk_bf16_f32 v92,v92,v94
ds_write_addtid_b32 v84 offset:17920
ds_write_addtid_b32 v88 offset:18944
ds_write_addtid_b32 v92 offset:19968
s_waitcnt lgkmcnt(0)
s_barrier
ds_read_b128 v[48:51],v7 offset:20480
ds_read_b128 v[52:55],v7 offset:21504
ds_read_b128 v[56:59],v7 offset:22528
ds_read_b128 v[60:63],v7 offset:23552
ds_read_b128 v[64:67],v7 offset:24576
ds_read_b128 v[68:71],v7 offset:25600
ds_read_b128 v[72:75],v7 offset:26624
ds_read_b128 v[76:79],v7 offset:27648
ds_read_b128 v[80:83],v7 offset:28672
ds_read_b128 v[84:87],v7 offset:29696
ds_read_b128 v[88:91],v7 offset:30720
ds_read_b128 v[92:95],v7 offset:31744
s_add_u32 s65,s76,s100
s_add_u32 s66,s75,s100
s_add_u32 s64,s71,s100
s_cmp_eq_u32 s50,2
s_cselect_b32 s66,s66,s64
buffer_store_dwordx4 v[8:11],v0,s[20:23],s65 offen sc1
s_cmp_eq_u32 s50,2
s_cselect_b32 exec_hi,-1,0
buffer_store_dwordx4 v[8:11],v0,s[20:23],s66 offen sc1
s_mov_b32 exec_hi,0
buffer_store_dwordx4 v[8:11],v0,s[20:23],s65 offen offset:1024 sc1
s_mov_b64 exec,-1
v_mov_b32 v96,0
v_mov_b32 v97,0
v_mov_b32 v98,0
v_mov_b32 v99,0
v_mov_b32 v100,0
v_mov_b32 v101,0
v_mov_b32 v102,0
v_mov_b32 v103,0
s_barrier
s_nop 15
s_nop 15
s_nop 7
buffer_load_dwordx4 v[16:19],v0,s[20:23],s96 offen offset:0 sc1
s_add_u32 s79,s79,1
s_and_b32 s64,s79,3
s_lshl_b32 s64,s64,19
s_lshl_b32 s65,s79,8
s_and_b32 s65,s65,0x2000
s_lshl_b32 s66,s79,16
s_xor_b32 s88,s73,s65
s_add_u32 s88,s88,s66
buffer_load_dwordx4 v[20:23],v0,s[20:23],s96 offen offset:1024 sc1
s_sub_u32 s88,s88,s54
s_add_u32 s89,s71,s64
s_add_u32 s92,s70,s64
s_xor_b32 s93,s72,s65
s_add_u32 s93,s93,s66
s_add_u32 s94,s76,s64
s_add_u32 s95,s94,4096
s_add_u32 s98,s75,s64
buffer_load_dwordx4 v[24:27],v0,s[20:23],s96 offen offset:2048 sc1
s_add_u32 s60,s74,s64
s_nop 6
buffer_load_dwordx4 v[28:31],v0,s[20:23],s96 offen offset:3072 sc1
s_nop 7
buffer_load_dwordx4 v[32:35],v0,s[20:23],s97 offen offset:0 sc1
s_nop 7
buffer_load_dwordx4 v[36:39],v0,s[20:23],s97 offen offset:1024 sc1
s_nop 7
buffer_load_dwordx4 v[40:43],v0,s[20:23],s97 offen offset:2048 sc1
s_nop 7
buffer_load_dwordx4 v[44:47],v0,s[20:23],s97 offen offset:3072 sc1
ogo_100856:
s_waitcnt lgkmcnt(0)
s_waitcnt vmcnt(6)
v_max3_u32 v124,v16,v17,v18
v_max3_u32 v124,v124,v19,v20
v_max3_u32 v124,v124,v21,v22
v_max_u32 v124,v124,v23
v_cmp_eq_u32 vcc,-1,v124
s_cbranch_vccnz of_100862
v_smfmac_f32_16x16x64_bf16 v[96:99],v[16:19],v[48:55],v1
v_smfmac_f32_16x16x64_bf16 v[100:103],v[16:19],v[56:63],v1
v_smfmac_f32_16x16x64_bf16 v[96:99],v[20:23],v[64:71],v1
v_smfmac_f32_16x16x64_bf16 v[100:103],v[20:23],v[72:79],v1
v_readfirstlane_b32 s91,v126
s_waitcnt vmcnt(4)
v_max3_u32 v124,v24,v25,v26
v_max3_u32 v124,v124,v27,v28
v_max3_u32 v124,v124,v29,v30
v_max_u32 v124,v124,v31
v_cmp_eq_u32 vcc,-1,v124
s_cbranch_vccnz of_100863
v_smfmac_f32_16x16x64_bf16 v[96:99],v[24:27],v[80:87],v1
v_smfmac_f32_16x16x64_bf16 v[100:103],v[24:27],v[88:95],v1
v_smfmac_f32_16x16x64_bf16 v[96:99],v[28:31],v[128:135],v1
v_smfmac_f32_16x16x64_bf16 v[100:103],v[28:31],v[136:143],v1
s_waitcnt vmcnt(2)
v_max3_u32 v124,v32,v33,v34
v_max3_u32 v124,v124,v35,v36
v_max3_u32 v124,v124,v37,v38
v_max_u32 v124,v124,v39
v_cmp_eq_u32 vcc,-1,v124
s_cbranch_vccnz of_100864
v_smfmac_f32_16x16x64_bf16 v[96:99],v[32:35],v[144:151],v1
v_smfmac_f32_16x16x64_bf16 v[100:103],v[32:35],v[152:159],v1
v_smfmac_f32_16x16x64_bf16 v[96:99],v[36:39],v[160:167],v1
v_smfmac_f32_16x16x64_bf16 v[100:103],v[36:39],v[168:175],v1
s_waitcnt vmcnt(1)
v_max3_u32 v124,v40,v41,v42
v_max_u32 v124,v124,v43
v_cmp_eq_u32 vcc,-1,v124
s_cbranch_vccnz of_100865
v_smfmac_f32_16x16x64_bf16 v[96:99],v[40:43],v[176:183],v1
v_smfmac_f32_16x16x64_bf16 v[100:103],v[40:43],v[184:191],v1
s_waitcnt vmcnt(0)
v_max3_u32 v124,v44,v45,v46
v_max_u32 v124,v124,v47
v_cmp_eq_u32 vcc,-1,v124
s_cbranch_vccnz of_100866
v_smfmac_f32_16x16x64_bf16 v[96:99],v[44:47],v[192:199],v1
v_smfmac_f32_16x16x64_bf16 v[100:103],v[44:47],v[200:207],v1
oback_100873:
s_nop 4
v_add_f32 v96,v96,v97
v_add_f32 v98,v98,v99
s_nop 0
v_add_f32 v100,v100,v101
v_add_f32 v102,v102,v103
ds_write_addtid_b32 v96 offset:20992
ds_write_addtid_b32 v98 offset:23072
ds_write_addtid_b32 v100 offset:22016
ds_write_addtid_b32 v102 offset:24096
s_mov_b32 s96,s60
s_add_u32 s97,s60,4096
s_cmp_gt_u32 s50,1
s_waitcnt lgkmcnt(0)
s_barrier
s_cbranch_scc1 loop_100811
ds_read2st64_b32 v[48:49],v4 offset0:82 offset1:86
ds_read2st64_b32 v[50:51],v4 offset0:83 offset1:87
ds_read2st64_b32 v[52:53],v4 offset0:84 offset1:88
ds_read2st64_b32 v[54:55],v4 offset0:85 offset1:89
v_mov_b32 v96,v104
v_mov_b32 v97,v105
v_mov_b32 v98,v106
v_mov_b32 v99,v107
v_mov_b32 v100,v108
v_mov_b32 v101,v109
v_mov_b32 v102,v110
v_mov_b32 v103,v111
s_waitcnt lgkmcnt(2)
v_pk_add_f32 v[48:49],v[48:49],v[50:51]
s_waitcnt lgkmcnt(0)
v_pk_add_f32 v[52:53],v[52:53],v[54:55]
v_pk_add_f32 v[48:49],v[48:49],v[52:53]
v_cvt_pk_bf16_f32 v124,v48,v49
buffer_store_dword v124,v127,s[20:23],s89 offen sc1
s_nop 7
buffer_store_dword v124,v127,s[20:23],s88 offen sc1
s_branch loop0_100815x
last_100812:
s_waitcnt vmcnt(3)
v_max3_u32 v124,v16,v17,v18
v_max_u32 v124,v124,v19
v_cmp_eq_u32 vcc,-1,v124
v_cndmask_b32 v121,2.0,v127,s[86:87]
s_cbranch_vccnz flb_100898
seg_100874:
segb_100882:
v_smfmac_f32_16x16x64_bf16 v[64:67],v[16:19],a[32:39],v1
buffer_load_dword v125,off,s[20:23],s92 sc1
buffer_load_dwordx4 v[32:35],v0,s[20:23],s93 offen offset:0 sc1
s_waitcnt vmcnt(4)
v_max3_u32 v124,v20,v21,v22
v_smfmac_f32_16x16x64_bf16 v[68:71],v[16:19],a[40:47],v1
v_max_u32 v124,v124,v23
v_cmp_eq_u32 vcc,-1,v124
v_smfmac_f32_16x16x64_bf16 v[72:75],v[16:19],a[48:55],v1
v_smfmac_f32_16x16x64_bf16 v[76:79],v[16:19],a[56:63],v1
s_cbranch_vccnz fl_100891
seg_100875:
segb_100883:
v_smfmac_f32_16x16x64_bf16 v[64:67],v[20:23],a[96:103],v1
buffer_load_dword v125,off,s[20:23],s92 sc1
buffer_load_dwordx4 v[36:39],v0,s[20:23],s93 offen offset:1024 sc1
s_waitcnt vmcnt(5)
v_max3_u32 v124,v24,v25,v26
v_smfmac_f32_16x16x64_bf16 v[68:71],v[20:23],a[104:111],v1
v_max_u32 v124,v124,v27
v_cmp_eq_u32 vcc,-1,v124
v_smfmac_f32_16x16x64_bf16 v[72:75],v[20:23],a[112:119],v1
v_smfmac_f32_16x16x64_bf16 v[76:79],v[20:23],a[120:127],v1
s_cbranch_vccnz fl_100892
seg_100876:
segb_100884:
v_smfmac_f32_16x16x64_bf16 v[64:67],v[24:27],a[160:167],v1
buffer_load_dword v125,off,s[20:23],s92 sc1
buffer_load_dwordx4 v[40:43],v0,s[20:23],s93 offen offset:2048 sc1
buffer_load_dwordx4 v[44:47],v0,s[20:23],s93 offen offset:3072 sc1
s_waitcnt vmcnt(7)
v_max3_u32 v124,v28,v29,v30
v_smfmac_f32_16x16x64_bf16 v[68:71],v[24:27],a[168:175],v1
v_max_u32 v124,v124,v31
v_cmp_eq_u32 vcc,-1,v124
v_smfmac_f32_16x16x64_bf16 v[72:75],v[24:27],a[176:183],v1
v_smfmac_f32_16x16x64_bf16 v[76:79],v[24:27],a[184:191],v1
s_cbranch_vccnz fl_100893
seg_100877:
segb_100885:
v_smfmac_f32_16x16x64_bf16 v[64:67],v[28:31],a[224:231],v1
buffer_load_dword v125,off,s[20:23],s92 sc1
buffer_store_dword v126,v121,s[20:23],s69 offen sc1
s_waitcnt vmcnt(7)
v_max3_u32 v124,v32,v33,v34
v_smfmac_f32_16x16x64_bf16 v[68:71],v[28:31],a[232:239],v1
v_max_u32 v124,v124,v35
v_cmp_eq_u32 vcc,-1,v124
v_smfmac_f32_16x16x64_bf16 v[72:75],v[28:31],a[240:247],v1
v_smfmac_f32_16x16x64_bf16 v[76:79],v[28:31],a[248:255],v1
s_cbranch_vccnz fl_100894
seg_100878:
segb_100886:
v_smfmac_f32_16x16x64_bf16 v[64:67],v[32:35],a[32:39],v1
buffer_load_dword v125,off,s[20:23],s92 sc1
s_waitcnt vmcnt(6)
v_max3_u32 v124,v36,v37,v38
v_smfmac_f32_16x16x64_bf16 v[68:71],v[32:35],a[40:47],v1
v_max_u32 v124,v124,v39
v_cmp_eq_u32 vcc,-1,v124
v_smfmac_f32_16x16x64_bf16 v[72:75],v[32:35],a[48:55],v1
v_smfmac_f32_16x16x64_bf16 v[76:79],v[32:35],a[56:63],v1
s_cbranch_vccnz fl_100895
seg_100879:
segb_100887:
v_smfmac_f32_16x16x64_bf16 v[64:67],v[36:39],a[96:103],v1
buffer_load_dword v125,off,s[20:23],s92 sc1
s_waitcnt vmcnt(4)
v_max3_u32 v124,v40,v41,v42
v_smfmac_f32_16x16x64_bf16 v[68:71],v[36:39],a[104:111],v1
v_max3_u32 v124,v124,v43,v44
v_max3_u32 v124,v124,v45,v46
v_max_u32 v124,v124,v47
v_cmp_eq_u32 vcc,-1,v124
v_smfmac_f32_16x16x64_bf16 v[72:75],v[36:39],a[112:119],v1
v_smfmac_f32_16x16x64_bf16 v[76:79],v[36:39],a[120:127],v1
s_cbranch_vccnz fl_100896
seg_100880:
segb_100888:
v_smfmac_f32_16x16x64_bf16 v[64:67],v[40:43],a[160:167],v1
v_smfmac_f32_16x16x64_bf16 v[68:71],v[40:43],a[168:175],v1
v_smfmac_f32_16x16x64_bf16 v[64:67],v[44:47],a[224:231],v1
v_smfmac_f32_16x16x64_bf16 v[68:71],v[44:47],a[232:239],v1
v_smfmac_f32_16x16x64_bf16 v[72:75],v[40:43],a[176:183],v1
s_nop 1
v_add_f32 v64,v64,v65
v_smfmac_f32_16x16x64_bf16 v[76:79],v[40:43],a[184:191],v1
ds_write_addtid_b32 v64 offset:8448
v_add_f32 v66,v66,v67
v_smfmac_f32_16x16x64_bf16 v[72:75],v[44:47],a[240:247],v1
ds_write_addtid_b32 v66 offset:9488
v_add_f32 v68,v68,v69
v_smfmac_f32_16x16x64_bf16 v[76:79],v[44:47],a[248:255],v1
ds_write_addtid_b32 v68 offset:10528
v_add_f32 v70,v70,v71
v_smfmac_f32_16x16x64_bf16 v[80:83],v[16:19],v[208:215],v1
ds_write_addtid_b32 v70 offset:11568
v_add_f32 v72,v72,v73
v_smfmac_f32_16x16x64_bf16 v[80:83],v[32:35],v[208:215],v1
ds_write_addtid_b32 v72 offset:12608
v_add_f32 v74,v74,v75
v_smfmac_f32_16x16x64_bf16 v[84:87],v[16:19],v[216:223],v1
ds_write_addtid_b32 v74 offset:13648
v_add_f32 v76,v76,v77
v_smfmac_f32_16x16x64_bf16 v[84:87],v[32:35],v[216:223],v1
ds_write_addtid_b32 v76 offset:14688
v_add_f32 v78,v78,v79
v_smfmac_f32_16x16x64_bf16 v[88:91],v[16:19],v[224:231],v1
ds_write_addtid_b32 v78 offset:15728
v_smfmac_f32_16x16x64_bf16 v[88:91],v[32:35],v[224:231],v1
v_smfmac_f32_16x16x64_bf16 v[92:95],v[16:19],v[232:239],v1
v_smfmac_f32_16x16x64_bf16 v[92:95],v[32:35],v[232:239],v1
doneA_100907:
s_waitcnt vmcnt(0) lgkmcnt(0)
s_add_u32 s64,s79,0
s_lshl_b32 s65,s64,12
s_and_b32 s65,s65,0x2000
s_xor_b32 s65,s65,s67
s_lshl_b32 s64,s64,20
s_add_u32 s65,s65,s64
s_add_u32 s101,s65,s78
v_smfmac_f32_16x16x64_bf16 v[80:83],v[20:23],v[240:247],v1
ds_read_b128 v[48:51],v7 offset:0
ds_read_b128 v[52:55],v7 offset:1024
v_smfmac_f32_16x16x64_bf16 v[80:83],v[36:39],v[240:247],v1
ds_read_b128 v[56:59],v7 offset:2048
ds_read_b128 v[60:63],v7 offset:3072
v_smfmac_f32_16x16x64_bf16 v[84:87],v[20:23],v[248:255],v1
ds_read_b128 v[64:67],v7 offset:4096
ds_read_b128 v[68:71],v7 offset:5120
v_smfmac_f32_16x16x64_bf16 v[84:87],v[36:39],v[248:255],v1
ds_read_b128 v[72:75],v7 offset:6144
ds_read_b128 v[76:79],v7 offset:7168
s_waitcnt lgkmcnt(6)
v_smfmac_f32_16x16x64_bf16 v[88:91],v[20:23],v[48:55],v1
v_smfmac_f32_16x16x64_bf16 v[88:91],v[36:39],v[48:55],v1
ds_read_b128 v[48:51],v7 offset:8192
ds_read_b128 v[52:55],v7 offset:9216
s_waitcnt lgkmcnt(6)
v_smfmac_f32_16x16x64_bf16 v[92:95],v[20:23],v[56:63],v1
v_smfmac_f32_16x16x64_bf16 v[92:95],v[36:39],v[56:63],v1
ds_read_b128 v[56:59],v7 offset:10240
ds_read_b128 v[60:63],v7 offset:11264
s_waitcnt lgkmcnt(6)
v_smfmac_f32_16x16x64_bf16 v[80:83],v[24:27],v[64:71],v1
v_smfmac_f32_16x16x64_bf16 v[80:83],v[40:43],v[64:71],v1
ds_read_b128 v[64:67],v7 offset:12288
ds_read_b128 v[68:71],v7 offset:13312
s_waitcnt lgkmcnt(6)
v_smfmac_f32_16x16x64_bf16 v[84:87],v[24:27],v[72:79],v1
v_smfmac_f32_16x16x64_bf16 v[84:87],v[40:43],v[72:79],v1
ds_read_b128 v[72:75],v7 offset:14336
ds_read_b128 v[76:79],v7 offset:15360
s_waitcnt lgkmcnt(6)
v_smfmac_f32_16x16x64_bf16 v[88:91],v[24:27],v[48:55],v1
v_smfmac_f32_16x16x64_bf16 v[88:91],v[40:43],v[48:55],v1
ds_read_b128 v[48:51],v7 offset:16384
ds_read_b128 v[52:55],v7 offset:17408
s_waitcnt lgkmcnt(6)
v_smfmac_f32_16x16x64_bf16 v[92:95],v[24:27],v[56:63],v1
v_smfmac_f32_16x16x64_bf16 v[92:95],v[40:43],v[56:63],v1
ds_read_b128 v[56:59],v7 offset:18432
ds_read_b128 v[60:63],v7 offset:19456
s_waitcnt lgkmcnt(6)
v_smfmac_f32_16x16x64_bf16 v[80:83],v[28:31],v[64:71],v1
v_smfmac_f32_16x16x64_bf16 v[80:83],v[44:47],v[64:71],v1
s_waitcnt lgkmcnt(4)
v_smfmac_f32_16x16x64_bf16 v[84:87],v[28:31],v[72:79],v1
v_smfmac_f32_16x16x64_bf16 v[84:87],v[44:47],v[72:79],v1
s_waitcnt lgkmcnt(2)
v_smfmac_f32_16x16x64_bf16 v[88:91],v[28:31],v[48:55],v1
v_add_f32 v80,v80,v81
v_smfmac_f32_16x16x64_bf16 v[88:91],v[44:47],v[48:55],v1
v_add_f32 v82,v82,v83
s_waitcnt lgkmcnt(0)
v_smfmac_f32_16x16x64_bf16 v[92:95],v[28:31],v[56:63],v1
v_cvt_pk_bf16_f32 v80,v80,v82
v_smfmac_f32_16x16x64_bf16 v[92:95],v[44:47],v[56:63],v1
ds_write_addtid_b32 v80 offset:16896
v_add_f32 v84,v84,v85
v_add_f32 v86,v86,v87
v_cvt_pk_bf16_f32 v84,v84,v86
v_add_f32 v88,v88,v89
v_add_f32 v90,v90,v91
v_cvt_pk_bf16_f32 v88,v88,v90
s_nop 0
v_add_f32 v92,v92,v93
v_add_f32 v94,v94,v95
v_cvt_pk_bf16_f32 v92,v92,v94
ds_write_addtid_b32 v84 offset:17920
ds_write_addtid_b32 v88 offset:18944
ds_write_addtid_b32 v92 offset:19968
s_waitcnt lgkmcnt(0)
s_barrier
s_cmp_gt_u32 s50,1
s_cbranch_scc1 l23_100908
ds_read2st64_b32 v[112:113],v127 offset0:66 offset1:67
ds_read2st64_b32 v[114:115],v127 offset0:68 offset1:69
ds_read2st64_b32 v[116:117],v127 offset0:70 offset1:71
ds_read2st64_b32 v[118:119],v127 offset0:72 offset1:73
s_waitcnt lgkmcnt(0)
v_mov_b32 v120,v5
v_mov_b32 v121,v5
v_mov_b32 v122,v5
v_mov_b32 v123,v5
s_nop 1
v_mfma_f32_16x16x32_bf16 v[112:115],v[120:123],v[112:115],0
v_mfma_f32_16x16x32_bf16 v[116:119],v[120:123],v[116:119],0
s_nop 4
v_cvt_pk_bf16_f32 v112,v112,v113
v_cvt_pk_bf16_f32 v113,v114,v115
s_nop 0
v_cvt_pk_bf16_f32 v114,v116,v117
v_cvt_pk_bf16_f32 v115,v118,v119
s_branch lj_100909
l23_100908:
ds_read_b128 v[48:51],v2 offset:0
ds_read_b128 v[52:55],v2 offset:256
ds_read_b128 v[56:59],v2 offset:512
ds_read_b128 v[60:63],v2 offset:768
ds_read_b128 v[64:67],v2 offset:16
ds_read_b128 v[68:71],v2 offset:272
ds_read_b128 v[72:75],v2 offset:528
ds_read_b128 v[76:79],v2 offset:784
s_waitcnt lgkmcnt(6)
v_pk_add_f32 v[48:49],v[48:49],v[52:53]
v_pk_add_f32 v[50:51],v[50:51],v[54:55]
s_waitcnt lgkmcnt(4)
v_pk_add_f32 v[56:57],v[56:57],v[60:61]
v_pk_add_f32 v[58:59],v[58:59],v[62:63]
v_pk_add_f32 v[48:49],v[48:49],v[56:57]
v_pk_add_f32 v[50:51],v[50:51],v[58:59]
v_cvt_pk_bf16_f32 v112,v48,v49
v_cvt_pk_bf16_f32 v113,v50,v51
s_waitcnt lgkmcnt(2)
v_pk_add_f32 v[64:65],v[64:65],v[68:69]
v_pk_add_f32 v[66:67],v[66:67],v[70:71]
s_waitcnt lgkmcnt(0)
v_pk_add_f32 v[72:73],v[72:73],v[76:77]
v_pk_add_f32 v[74:75],v[74:75],v[78:79]
v_pk_add_f32 v[64:65],v[64:65],v[72:73]
v_pk_add_f32 v[66:67],v[66:67],v[74:75]
v_cvt_pk_bf16_f32 v114,v64,v65
v_cvt_pk_bf16_f32 v115,v66,v67
lj_100909:
v_cndmask_b32 v120,2.0,v0,s[82:83]
v_cndmask_b32 v121,2.0,v127,s[86:87]
buffer_store_dwordx4 v[112:115],v120,s[20:23],s101 offen sc1
s_waitcnt vmcnt(0)
s_barrier
v_mov_b32 v126,64
buffer_store_dword v126,v121,s[20:23],s69 offen sc1
s_branch recfin_100413
flp_100817:
buffer_load_dword v124,off,s[20:23],s68 sc1
s_waitcnt vmcnt(0)
v_readfirstlane_b32 s91,v124
s_cmp_gt_u32 s91,s64
s_cbranch_scc1 fok_100816
s_sleep 2
s_sub_u32 s90,s90,1
s_cmp_gt_i32 s90,0
s_cbranch_scc1 flp_100817
s_branch fok_100816
flp_100820:
buffer_load_dword v124,off,s[20:23],s68 sc1
s_waitcnt vmcnt(0)
v_readfirstlane_b32 s91,v124
s_cmp_gt_u32 s91,s64
s_cbranch_scc1 fok_100819
s_sleep 2
s_sub_u32 s90,s90,1
s_cmp_gt_i32 s90,0
s_cbranch_scc1 flp_100820
s_branch fok_100819
fl_100837:
flb_100845:
buffer_load_dwordx4 v[16:19],v0,s[20:23],s92 offen offset:0 sc1
s_mov_b32 s55,1
buffer_load_dwordx4 v[32:35],v0,s[20:23],s93 offen offset:0 sc1
s_waitcnt vmcnt(4)
v_max3_u32 v124,v20,v21,v22
v_max_u32 v124,v124,v23
v_cmp_eq_u32 vcc,-1,v124
s_cbranch_vccnz dfl_100910
v_smfmac_f32_16x16x64_bf16 v[48:51],v[20:23],a[64:71],v1
buffer_load_dword v125,off,s[20:23],s92 sc1
v_smfmac_f32_16x16x64_bf16 v[52:55],v[20:23],a[72:79],v1
buffer_load_dwordx4 v[36:39],v0,s[20:23],s93 offen offset:1024 sc1
v_smfmac_f32_16x16x64_bf16 v[56:59],v[20:23],a[80:87],v1
s_waitcnt vmcnt(5)
v_max3_u32 v124,v24,v25,v26
v_smfmac_f32_16x16x64_bf16 v[60:63],v[20:23],a[88:95],v1
v_max_u32 v124,v124,v27
v_smfmac_f32_16x16x64_bf16 v[64:67],v[20:23],a[96:103],v1
v_cmp_eq_u32 vcc,-1,v124
v_smfmac_f32_16x16x64_bf16 v[68:71],v[20:23],a[104:111],v1
v_smfmac_f32_16x16x64_bf16 v[72:75],v[20:23],a[112:119],v1
v_smfmac_f32_16x16x64_bf16 v[76:79],v[20:23],a[120:127],v1
s_cbranch_vccnz dfl_100911
v_smfmac_f32_16x16x64_bf16 v[48:51],v[24:27],a[128:135],v1
buffer_load_dword v125,off,s[20:23],s92 sc1
v_smfmac_f32_16x16x64_bf16 v[52:55],v[24:27],a[136:143],v1
buffer_load_dwordx4 v[40:43],v0,s[20:23],s93 offen offset:2048 sc1
v_smfmac_f32_16x16x64_bf16 v[56:59],v[24:27],a[144:151],v1
buffer_load_dwordx4 v[44:47],v0,s[20:23],s93 offen offset:3072 sc1
s_waitcnt vmcnt(7)
v_max3_u32 v124,v28,v29,v30
v_smfmac_f32_16x16x64_bf16 v[60:63],v[24:27],a[152:159],v1
v_max_u32 v124,v124,v31
v_smfmac_f32_16x16x64_bf16 v[64:67],v[24:27],a[160:167],v1
v_cmp_eq_u32 vcc,-1,v124
v_smfmac_f32_16x16x64_bf16 v[68:71],v[24:27],a[168:175],v1
v_smfmac_f32_16x16x64_bf16 v[72:75],v[24:27],a[176:183],v1
v_smfmac_f32_16x16x64_bf16 v[76:79],v[24:27],a[184:191],v1
s_cbranch_vccnz dfl_100912
v_smfmac_f32_16x16x64_bf16 v[48:51],v[28:31],a[192:199],v1
buffer_load_dword v125,off,s[20:23],s92 sc1
v_smfmac_f32_16x16x64_bf16 v[52:55],v[28:31],a[200:207],v1
buffer_store_dword v126,v121,s[20:23],s69 offen sc1
v_smfmac_f32_16x16x64_bf16 v[56:59],v[28:31],a[208:215],v1
s_waitcnt vmcnt(8)
v_max3_u32 v124,v16,v17,v18
v_smfmac_f32_16x16x64_bf16 v[60:63],v[28:31],a[216:223],v1
v_max_u32 v124,v124,v19
v_smfmac_f32_16x16x64_bf16 v[64:67],v[28:31],a[224:231],v1
v_cmp_eq_u32 vcc,-1,v124
v_smfmac_f32_16x16x64_bf16 v[68:71],v[28:31],a[232:239],v1
v_smfmac_f32_16x16x64_bf16 v[72:75],v[28:31],a[240:247],v1
v_smfmac_f32_16x16x64_bf16 v[76:79],v[28:31],a[248:255],v1
s_cbranch_vccnz lfb_100917
s_mov_b32 s55,0
v_smfmac_f32_16x16x64_bf16 v[48:51],v[16:19],a[0:7],v1
v_smfmac_f32_16x16x64_bf16 v[52:55],v[16:19],a[8:15],v1
v_smfmac_f32_16x16x64_bf16 v[56:59],v[16:19],a[16:23],v1
s_waitcnt vmcnt(7)
v_max3_u32 v124,v32,v33,v34
v_max_u32 v124,v124,v35
v_cmp_eq_u32 vcc,-1,v124
v_smfmac_f32_16x16x64_bf16 v[60:63],v[16:19],a[24:31],v1
v_smfmac_f32_16x16x64_bf16 v[64:67],v[16:19],a[32:39],v1
v_smfmac_f32_16x16x64_bf16 v[68:71],v[16:19],a[40:47],v1
v_smfmac_f32_16x16x64_bf16 v[72:75],v[16:19],a[48:55],v1
v_smfmac_f32_16x16x64_bf16 v[76:79],v[16:19],a[56:63],v1
s_cbranch_vccnz flb_100849
s_branch segb_100833
fl_100838:
v_smfmac_f32_16x16x64_bf16 v[76:79],v[16:19],a[56:63],v1
flb_100846:
buffer_load_dwordx4 v[20:23],v0,s[20:23],s92 offen offset:1024 sc1
s_mov_b32 s55,2
buffer_load_dwordx4 v[36:39],v0,s[20:23],s93 offen offset:1024 sc1
s_waitcnt vmcnt(5)
v_max3_u32 v124,v24,v25,v26
v_max_u32 v124,v124,v27
v_cmp_eq_u32 vcc,-1,v124
s_cbranch_vccnz dfl_100911
v_smfmac_f32_16x16x64_bf16 v[48:51],v[24:27],a[128:135],v1
buffer_load_dword v125,off,s[20:23],s92 sc1
v_smfmac_f32_16x16x64_bf16 v[52:55],v[24:27],a[136:143],v1
buffer_load_dwordx4 v[40:43],v0,s[20:23],s93 offen offset:2048 sc1
v_smfmac_f32_16x16x64_bf16 v[56:59],v[24:27],a[144:151],v1
buffer_load_dwordx4 v[44:47],v0,s[20:23],s93 offen offset:3072 sc1
s_waitcnt vmcnt(7)
v_max3_u32 v124,v28,v29,v30
v_smfmac_f32_16x16x64_bf16 v[60:63],v[24:27],a[152:159],v1
v_max_u32 v124,v124,v31
v_smfmac_f32_16x16x64_bf16 v[64:67],v[24:27],a[160:167],v1
v_cmp_eq_u32 vcc,-1,v124
v_smfmac_f32_16x16x64_bf16 v[68:71],v[24:27],a[168:175],v1
v_smfmac_f32_16x16x64_bf16 v[72:75],v[24:27],a[176:183],v1
v_smfmac_f32_16x16x64_bf16 v[76:79],v[24:27],a[184:191],v1
s_cbranch_vccnz dfl_100912
v_smfmac_f32_16x16x64_bf16 v[48:51],v[28:31],a[192:199],v1
buffer_load_dword v125,off,s[20:23],s92 sc1
v_smfmac_f32_16x16x64_bf16 v[52:55],v[28:31],a[200:207],v1
buffer_store_dword v126,v121,s[20:23],s69 offen sc1
v_smfmac_f32_16x16x64_bf16 v[56:59],v[28:31],a[208:215],v1
s_waitcnt vmcnt(6)
v_max3_u32 v124,v20,v21,v22
v_smfmac_f32_16x16x64_bf16 v[60:63],v[28:31],a[216:223],v1
v_max_u32 v124,v124,v23
v_smfmac_f32_16x16x64_bf16 v[64:67],v[28:31],a[224:231],v1
v_cmp_eq_u32 vcc,-1,v124
v_smfmac_f32_16x16x64_bf16 v[68:71],v[28:31],a[232:239],v1
v_smfmac_f32_16x16x64_bf16 v[72:75],v[28:31],a[240:247],v1
v_smfmac_f32_16x16x64_bf16 v[76:79],v[28:31],a[248:255],v1
s_cbranch_vccnz lfb_100917
s_mov_b32 s55,0
v_smfmac_f32_16x16x64_bf16 v[48:51],v[20:23],a[64:71],v1
v_smfmac_f32_16x16x64_bf16 v[52:55],v[20:23],a[72:79],v1
v_smfmac_f32_16x16x64_bf16 v[56:59],v[20:23],a[80:87],v1
s_waitcnt vmcnt(7)
v_max3_u32 v124,v32,v33,v34
v_max_u32 v124,v124,v35
v_cmp_eq_u32 vcc,-1,v124
v_smfmac_f32_16x16x64_bf16 v[60:63],v[20:23],a[88:95],v1
v_smfmac_f32_16x16x64_bf16 v[64:67],v[20:23],a[96:103],v1
v_smfmac_f32_16x16x64_bf16 v[68:71],v[20:23],a[104:111],v1
v_smfmac_f32_16x16x64_bf16 v[72:75],v[20:23],a[112:119],v1
v_smfmac_f32_16x16x64_bf16 v[76:79],v[20:23],a[120:127],v1
s_cbranch_vccnz flb_100849
s_branch segb_100833
fl_100839:
v_smfmac_f32_16x16x64_bf16 v[76:79],v[20:23],a[120:127],v1
flb_100847:
buffer_load_dwordx4 v[24:27],v0,s[20:23],s92 offen offset:2048 sc1
s_mov_b32 s55,4
buffer_load_dwordx4 v[40:43],v0,s[20:23],s93 offen offset:2048 sc1
buffer_load_dwordx4 v[44:47],v0,s[20:23],s93 offen offset:3072 sc1
s_waitcnt vmcnt(7)
v_max3_u32 v124,v28,v29,v30
v_max_u32 v124,v124,v31
v_cmp_eq_u32 vcc,-1,v124
s_cbranch_vccnz dfl_100912
v_smfmac_f32_16x16x64_bf16 v[48:51],v[28:31],a[192:199],v1
buffer_load_dword v125,off,s[20:23],s92 sc1
v_smfmac_f32_16x16x64_bf16 v[52:55],v[28:31],a[200:207],v1
buffer_store_dword v126,v121,s[20:23],s69 offen sc1
v_smfmac_f32_16x16x64_bf16 v[56:59],v[28:31],a[208:215],v1
s_waitcnt vmcnt(4)
v_max3_u32 v124,v24,v25,v26
v_smfmac_f32_16x16x64_bf16 v[60:63],v[28:31],a[216:223],v1
v_max_u32 v124,v124,v27
v_smfmac_f32_16x16x64_bf16 v[64:67],v[28:31],a[224:231],v1
v_cmp_eq_u32 vcc,-1,v124
v_smfmac_f32_16x16x64_bf16 v[68:71],v[28:31],a[232:239],v1
v_smfmac_f32_16x16x64_bf16 v[72:75],v[28:31],a[240:247],v1
v_smfmac_f32_16x16x64_bf16 v[76:79],v[28:31],a[248:255],v1
s_cbranch_vccnz lfb_100917
s_mov_b32 s55,0
v_smfmac_f32_16x16x64_bf16 v[48:51],v[24:27],a[128:135],v1
v_smfmac_f32_16x16x64_bf16 v[52:55],v[24:27],a[136:143],v1
v_smfmac_f32_16x16x64_bf16 v[56:59],v[24:27],a[144:151],v1
s_waitcnt vmcnt(7)
v_max3_u32 v124,v32,v33,v34
v_max_u32 v124,v124,v35
v_cmp_eq_u32 vcc,-1,v124
v_smfmac_f32_16x16x64_bf16 v[60:63],v[24:27],a[152:159],v1
v_smfmac_f32_16x16x64_bf16 v[64:67],v[24:27],a[160:167],v1
v_smfmac_f32_16x16x64_bf16 v[68:71],v[24:27],a[168:175],v1
v_smfmac_f32_16x16x64_bf16 v[72:75],v[24:27],a[176:183],v1
v_smfmac_f32_16x16x64_bf16 v[76:79],v[24:27],a[184:191],v1
s_cbranch_vccnz flb_100849
s_branch segb_100833
fl_100840:
v_smfmac_f32_16x16x64_bf16 v[76:79],v[24:27],a[184:191],v1
flb_100848:
buffer_load_dwordx4 v[28:31],v0,s[20:23],s92 offen offset:3072 sc1
s_mov_b32 s55,8
buffer_store_dword v126,v121,s[20:23],s69 offen sc1
s_waitcnt vmcnt(1)
v_max3_u32 v124,v28,v29,v30
v_max_u32 v124,v124,v31
v_cmp_eq_u32 vcc,-1,v124
s_cbranch_vccnz lfb_100917
s_mov_b32 s55,0
v_smfmac_f32_16x16x64_bf16 v[48:51],v[28:31],a[192:199],v1
v_smfmac_f32_16x16x64_bf16 v[52:55],v[28:31],a[200:207],v1
v_smfmac_f32_16x16x64_bf16 v[56:59],v[28:31],a[208:215],v1
s_waitcnt vmcnt(7)
v_max3_u32 v124,v32,v33,v34
v_max_u32 v124,v124,v35
v_cmp_eq_u32 vcc,-1,v124
v_smfmac_f32_16x16x64_bf16 v[60:63],v[28:31],a[216:223],v1
v_smfmac_f32_16x16x64_bf16 v[64:67],v[28:31],a[224:231],v1
v_smfmac_f32_16x16x64_bf16 v[68:71],v[28:31],a[232:239],v1
v_smfmac_f32_16x16x64_bf16 v[72:75],v[28:31],a[240:247],v1
v_smfmac_f32_16x16x64_bf16 v[76:79],v[28:31],a[248:255],v1
s_cbranch_vccnz flb_100849
s_branch segb_100833
fl_100841:
v_smfmac_f32_16x16x64_bf16 v[76:79],v[28:31],a[248:255],v1
flb_100849:
buffer_load_dwordx4 v[32:35],v0,s[20:23],s93 offen offset:0 sc1
s_mov_b32 s55,240
s_bitcmp1_b32 s55,5
s_cbranch_scc0 rdn_100920
s_waitcnt vmcnt(6)
v_max3_u32 v124,v36,v37,v38
v_max_u32 v124,v124,v39
v_cmp_eq_u32 vcc,-1,v124
s_cbranch_vccnz rfa_100921
buffer_load_dword v125,off,s[20:23],s92 sc1
s_bitset0_b32 s55,5
v_smfmac_f32_16x16x64_bf16 v[48:51],v[36:39],a[64:71],v1
v_smfmac_f32_16x16x64_bf16 v[52:55],v[36:39],a[72:79],v1
v_smfmac_f32_16x16x64_bf16 v[56:59],v[36:39],a[80:87],v1
v_smfmac_f32_16x16x64_bf16 v[60:63],v[36:39],a[88:95],v1
v_smfmac_f32_16x16x64_bf16 v[64:67],v[36:39],a[96:103],v1
v_smfmac_f32_16x16x64_bf16 v[68:71],v[36:39],a[104:111],v1
v_smfmac_f32_16x16x64_bf16 v[72:75],v[36:39],a[112:119],v1
v_smfmac_f32_16x16x64_bf16 v[76:79],v[36:39],a[120:127],v1
s_cmp_eq_u32 s55,0
s_cbranch_scc1 segb_100835
s_branch rnx_100922
rdn_100920:
buffer_load_dword v125,off,s[20:23],s92 sc1
s_branch rnx_100922
rfa_100921:
buffer_load_dwordx4 v[36:39],v0,s[20:23],s93 offen offset:1024 sc1
rnx_100922:
s_bitcmp1_b32 s55,6
s_cbranch_scc0 rdn_100923
s_waitcnt vmcnt(5)
v_max3_u32 v124,v40,v41,v42
v_max_u32 v124,v124,v43
v_cmp_eq_u32 vcc,-1,v124
s_cbranch_vccnz rfa_100924
buffer_load_dword v125,off,s[20:23],s92 sc1
s_bitset0_b32 s55,6
s_cmp_eq_u32 s55,0
s_cbranch_scc1 segb_100835
s_branch rnx_100925
rdn_100923:
buffer_load_dword v125,off,s[20:23],s92 sc1
s_branch rnx_100925
rfa_100924:
buffer_load_dwordx4 v[40:43],v0,s[20:23],s93 offen offset:2048 sc1
rnx_100925:
s_bitcmp1_b32 s55,7
s_cbranch_scc0 rdn_100926
s_waitcnt vmcnt(5)
v_max3_u32 v124,v44,v45,v46
v_max_u32 v124,v124,v47
v_cmp_eq_u32 vcc,-1,v124
s_cbranch_vccnz rfa_100927
buffer_load_dword v125,off,s[20:23],s92 sc1
s_bitset0_b32 s55,7
s_cmp_eq_u32 s55,0
s_cbranch_scc1 segb_100835
s_branch rnx_100928
rdn_100926:
buffer_load_dword v125,off,s[20:23],s92 sc1
s_branch rnx_100928
rfa_100927:
buffer_load_dwordx4 v[44:47],v0,s[20:23],s93 offen offset:3072 sc1
rnx_100928:
rot_100919:
s_bitcmp1_b32 s55,4
s_cbranch_scc0 rdn_100929
s_waitcnt vmcnt(3)
v_max3_u32 v124,v32,v33,v34
v_max_u32 v124,v124,v35
v_cmp_eq_u32 vcc,-1,v124
s_cbranch_vccnz rfa_100930
buffer_load_dword v125,off,s[20:23],s92 sc1
s_bitset0_b32 s55,4
v_smfmac_f32_16x16x64_bf16 v[48:51],v[32:35],a[0:7],v1
v_smfmac_f32_16x16x64_bf16 v[52:55],v[32:35],a[8:15],v1
v_smfmac_f32_16x16x64_bf16 v[56:59],v[32:35],a[16:23],v1
v_smfmac_f32_16x16x64_bf16 v[60:63],v[32:35],a[24:31],v1
v_smfmac_f32_16x16x64_bf16 v[64:67],v[32:35],a[32:39],v1
v_smfmac_f32_16x16x64_bf16 v[68:71],v[32:35],a[40:47],v1
v_smfmac_f32_16x16x64_bf16 v[72:75],v[32:35],a[48:55],v1
v_smfmac_f32_16x16x64_bf16 v[76:79],v[32:35],a[56:63],v1
s_cmp_eq_u32 s55,0
s_cbranch_scc1 segb_100835
s_branch rnx_100931
rdn_100929:
buffer_load_dword v125,off,s[20:23],s92 sc1
s_branch rnx_100931
rfa_100930:
buffer_load_dwordx4 v[32:35],v0,s[20:23],s93 offen offset:0 sc1
rnx_100931:
s_bitcmp1_b32 s55,5
s_cbranch_scc0 rdn_100932
s_waitcnt vmcnt(3)
v_max3_u32 v124,v36,v37,v38
v_max_u32 v124,v124,v39
v_cmp_eq_u32 vcc,-1,v124
s_cbranch_vccnz rfa_100933
buffer_load_dword v125,off,s[20:23],s92 sc1
s_bitset0_b32 s55,5
v_smfmac_f32_16x16x64_bf16 v[48:51],v[36:39],a[64:71],v1
v_smfmac_f32_16x16x64_bf16 v[52:55],v[36:39],a[72:79],v1
v_smfmac_f32_16x16x64_bf16 v[56:59],v[36:39],a[80:87],v1
v_smfmac_f32_16x16x64_bf16 v[60:63],v[36:39],a[88:95],v1
v_smfmac_f32_16x16x64_bf16 v[64:67],v[36:39],a[96:103],v1
v_smfmac_f32_16x16x64_bf16 v[68:71],v[36:39],a[104:111],v1
v_smfmac_f32_16x16x64_bf16 v[72:75],v[36:39],a[112:119],v1
v_smfmac_f32_16x16x64_bf16 v[76:79],v[36:39],a[120:127],v1
s_cmp_eq_u32 s55,0
s_cbranch_scc1 segb_100835
s_branch rnx_100934
rdn_100932:
buffer_load_dword v125,off,s[20:23],s92 sc1
s_branch rnx_100934
rfa_100933:
buffer_load_dwordx4 v[36:39],v0,s[20:23],s93 offen offset:1024 sc1
rnx_100934:
s_bitcmp1_b32 s55,6
s_cbranch_scc0 rdn_100935
s_waitcnt vmcnt(3)
v_max3_u32 v124,v40,v41,v42
v_max_u32 v124,v124,v43
v_cmp_eq_u32 vcc,-1,v124
s_cbranch_vccnz rfa_100936
buffer_load_dword v125,off,s[20:23],s92 sc1
s_bitset0_b32 s55,6
s_cmp_eq_u32 s55,0
s_cbranch_scc1 segb_100835
s_branch rnx_100937
rdn_100935:
buffer_load_dword v125,off,s[20:23],s92 sc1
s_branch rnx_100937
rfa_100936:
buffer_load_dwordx4 v[40:43],v0,s[20:23],s93 offen offset:2048 sc1
rnx_100937:
s_bitcmp1_b32 s55,7
s_cbranch_scc0 rdn_100938
s_waitcnt vmcnt(3)
v_max3_u32 v124,v44,v45,v46
v_max_u32 v124,v124,v47
v_cmp_eq_u32 vcc,-1,v124
s_cbranch_vccnz rfa_100939
buffer_load_dword v125,off,s[20:23],s92 sc1
s_bitset0_b32 s55,7
s_cmp_eq_u32 s55,0
s_cbranch_scc1 segb_100835
s_branch rnx_100940
rdn_100938:
buffer_load_dword v125,off,s[20:23],s92 sc1
s_branch rnx_100940
rfa_100939:
buffer_load_dwordx4 v[44:47],v0,s[20:23],s93 offen offset:3072 sc1
rnx_100940:
s_sub_u32 s90,s90,1
s_cmp_gt_i32 s90,0
s_cbranch_scc1 rot_100919
s_mov_b32 s55,0
s_branch segb_100835
fl_100842:
v_smfmac_f32_16x16x64_bf16 v[76:79],v[32:35],a[56:63],v1
flb_100850:
buffer_load_dwordx4 v[36:39],v0,s[20:23],s93 offen offset:1024 sc1
s_mov_b32 s55,224
s_bitcmp1_b32 s55,6
s_cbranch_scc0 rdn_100942
s_waitcnt vmcnt(5)
v_max3_u32 v124,v40,v41,v42
v_max_u32 v124,v124,v43
v_cmp_eq_u32 vcc,-1,v124
s_cbranch_vccnz rfa_100943
buffer_load_dword v125,off,s[20:23],s92 sc1
s_bitset0_b32 s55,6
s_cmp_eq_u32 s55,0
s_cbranch_scc1 segb_100835
s_branch rnx_100944
rdn_100942:
buffer_load_dword v125,off,s[20:23],s92 sc1
s_branch rnx_100944
rfa_100943:
buffer_load_dwordx4 v[40:43],v0,s[20:23],s93 offen offset:2048 sc1
rnx_100944:
s_bitcmp1_b32 s55,7
s_cbranch_scc0 rdn_100945
s_waitcnt vmcnt(5)
v_max3_u32 v124,v44,v45,v46
v_max_u32 v124,v124,v47
v_cmp_eq_u32 vcc,-1,v124
s_cbranch_vccnz rfa_100946
buffer_load_dword v125,off,s[20:23],s92 sc1
s_bitset0_b32 s55,7
s_cmp_eq_u32 s55,0
s_cbranch_scc1 segb_100835
s_branch rnx_100947
rdn_100945:
buffer_load_dword v125,off,s[20:23],s92 sc1
s_branch rnx_100947
rfa_100946:
buffer_load_dwordx4 v[44:47],v0,s[20:23],s93 offen offset:3072 sc1
rnx_100947:
rot_100941:
s_bitcmp1_b32 s55,5
s_cbranch_scc0 rdn_100948
s_waitcnt vmcnt(2)
v_max3_u32 v124,v36,v37,v38
v_max_u32 v124,v124,v39
v_cmp_eq_u32 vcc,-1,v124
s_cbranch_vccnz rfa_100949
buffer_load_dword v125,off,s[20:23],s92 sc1
s_bitset0_b32 s55,5
v_smfmac_f32_16x16x64_bf16 v[48:51],v[36:39],a[64:71],v1
v_smfmac_f32_16x16x64_bf16 v[52:55],v[36:39],a[72:79],v1
v_smfmac_f32_16x16x64_bf16 v[56:59],v[36:39],a[80:87],v1
v_smfmac_f32_16x16x64_bf16 v[60:63],v[36:39],a[88:95],v1
v_smfmac_f32_16x16x64_bf16 v[64:67],v[36:39],a[96:103],v1
v_smfmac_f32_16x16x64_bf16 v[68:71],v[36:39],a[104:111],v1
v_smfmac_f32_16x16x64_bf16 v[72:75],v[36:39],a[112:119],v1
v_smfmac_f32_16x16x64_bf16 v[76:79],v[36:39],a[120:127],v1
s_cmp_eq_u32 s55,0
s_cbranch_scc1 segb_100835
s_branch rnx_100950
rdn_100948:
buffer_load_dword v125,off,s[20:23],s92 sc1
s_branch rnx_100950
rfa_100949:
buffer_load_dwordx4 v[36:39],v0,s[20:23],s93 offen offset:1024 sc1
rnx_100950:
s_bitcmp1_b32 s55,6
s_cbranch_scc0 rdn_100951
s_waitcnt vmcnt(2)
v_max3_u32 v124,v40,v41,v42
v_max_u32 v124,v124,v43
v_cmp_eq_u32 vcc,-1,v124
s_cbranch_vccnz rfa_100952
buffer_load_dword v125,off,s[20:23],s92 sc1
s_bitset0_b32 s55,6
s_cmp_eq_u32 s55,0
s_cbranch_scc1 segb_100835
s_branch rnx_100953
rdn_100951:
buffer_load_dword v125,off,s[20:23],s92 sc1
s_branch rnx_100953
rfa_100952:
buffer_load_dwordx4 v[40:43],v0,s[20:23],s93 offen offset:2048 sc1
rnx_100953:
s_bitcmp1_b32 s55,7
s_cbranch_scc0 rdn_100954
s_waitcnt vmcnt(2)
v_max3_u32 v124,v44,v45,v46
v_max_u32 v124,v124,v47
v_cmp_eq_u32 vcc,-1,v124
s_cbranch_vccnz rfa_100955
buffer_load_dword v125,off,s[20:23],s92 sc1
s_bitset0_b32 s55,7
s_cmp_eq_u32 s55,0
s_cbranch_scc1 segb_100835
s_branch rnx_100956
rdn_100954:
buffer_load_dword v125,off,s[20:23],s92 sc1
s_branch rnx_100956
rfa_100955:
buffer_load_dwordx4 v[44:47],v0,s[20:23],s93 offen offset:3072 sc1
rnx_100956:
s_sub_u32 s90,s90,1
s_cmp_gt_i32 s90,0
s_cbranch_scc1 rot_100941
s_mov_b32 s55,0
s_branch segb_100835
fl_100843:
v_smfmac_f32_16x16x64_bf16 v[76:79],v[36:39],a[120:127],v1
flb_100851:
s_mov_b32 s55,192
s_bitcmp1_b32 s55,6
s_cbranch_scc0 rdn_100958
s_waitcnt vmcnt(5)
v_max3_u32 v124,v40,v41,v42
v_max_u32 v124,v124,v43
v_cmp_eq_u32 vcc,-1,v124
s_cbranch_vccnz rfa_100959
buffer_load_dword v125,off,s[20:23],s92 sc1
s_bitset0_b32 s55,6
s_cmp_eq_u32 s55,0
s_cbranch_scc1 segb_100835
s_branch rnx_100960
rdn_100958:
buffer_load_dword v125,off,s[20:23],s92 sc1
s_branch rnx_100960
rfa_100959:
buffer_load_dwordx4 v[40:43],v0,s[20:23],s93 offen offset:2048 sc1
rnx_100960:
s_bitcmp1_b32 s55,7
s_cbranch_scc0 rdn_100961
s_waitcnt vmcnt(5)
v_max3_u32 v124,v44,v45,v46
v_max_u32 v124,v124,v47
v_cmp_eq_u32 vcc,-1,v124
s_cbranch_vccnz rfa_100962
buffer_load_dword v125,off,s[20:23],s92 sc1
s_bitset0_b32 s55,7
s_cmp_eq_u32 s55,0
s_cbranch_scc1 segb_100835
s_branch rnx_100963
rdn_100961:
buffer_load_dword v125,off,s[20:23],s92 sc1
s_branch rnx_100963
rfa_100962:
buffer_load_dwordx4 v[44:47],v0,s[20:23],s93 offen offset:3072 sc1
rnx_100963:
rot_100957:
s_bitcmp1_b32 s55,6
s_cbranch_scc0 rdn_100964
s_waitcnt vmcnt(1)
v_max3_u32 v124,v40,v41,v42
v_max_u32 v124,v124,v43
v_cmp_eq_u32 vcc,-1,v124
s_cbranch_vccnz rfa_100965
buffer_load_dword v125,off,s[20:23],s92 sc1
s_bitset0_b32 s55,6
s_cmp_eq_u32 s55,0
s_cbranch_scc1 segb_100835
s_branch rnx_100966
rdn_100964:
buffer_load_dword v125,off,s[20:23],s92 sc1
s_branch rnx_100966
rfa_100965:
buffer_load_dwordx4 v[40:43],v0,s[20:23],s93 offen offset:2048 sc1
rnx_100966:
s_bitcmp1_b32 s55,7
s_cbranch_scc0 rdn_100967
s_waitcnt vmcnt(1)
v_max3_u32 v124,v44,v45,v46
v_max_u32 v124,v124,v47
v_cmp_eq_u32 vcc,-1,v124
s_cbranch_vccnz rfa_100968
buffer_load_dword v125,off,s[20:23],s92 sc1
s_bitset0_b32 s55,7
s_cmp_eq_u32 s55,0
s_cbranch_scc1 segb_100835
s_branch rnx_100969
rdn_100967:
buffer_load_dword v125,off,s[20:23],s92 sc1
s_branch rnx_100969
rfa_100968:
buffer_load_dwordx4 v[44:47],v0,s[20:23],s93 offen offset:3072 sc1
rnx_100969:
s_sub_u32 s90,s90,1
s_cmp_gt_i32 s90,0
s_cbranch_scc1 rot_100957
s_mov_b32 s55,0
s_branch segb_100835
dfl_100910:
buffer_load_dwordx4 v[20:23],v0,s[20:23],s92 offen offset:1024 sc1
s_bitset1_b32 s55,1
buffer_load_dwordx4 v[36:39],v0,s[20:23],s93 offen offset:1024 sc1
s_waitcnt vmcnt(5)
v_max3_u32 v124,v24,v25,v26
v_max_u32 v124,v124,v27
v_cmp_eq_u32 vcc,-1,v124
s_cbranch_vccnz dfl_100911
s_branch dseg_100914
dfl_100911:
buffer_load_dwordx4 v[24:27],v0,s[20:23],s92 offen offset:2048 sc1
s_bitset1_b32 s55,2
buffer_load_dwordx4 v[40:43],v0,s[20:23],s93 offen offset:2048 sc1
buffer_load_dwordx4 v[44:47],v0,s[20:23],s93 offen offset:3072 sc1
s_waitcnt vmcnt(7)
v_max3_u32 v124,v28,v29,v30
v_max_u32 v124,v124,v31
v_cmp_eq_u32 vcc,-1,v124
s_cbranch_vccnz dfl_100912
s_branch dseg_100915
dfl_100912:
buffer_load_dwordx4 v[28:31],v0,s[20:23],s92 offen offset:3072 sc1
s_bitset1_b32 s55,3
buffer_store_dword v126,v121,s[20:23],s69 offen sc1
s_branch lap2_100916
dseg_100914:
v_smfmac_f32_16x16x64_bf16 v[48:51],v[24:27],a[128:135],v1
buffer_load_dword v125,off,s[20:23],s92 sc1
v_smfmac_f32_16x16x64_bf16 v[52:55],v[24:27],a[136:143],v1
buffer_load_dwordx4 v[40:43],v0,s[20:23],s93 offen offset:2048 sc1
v_smfmac_f32_16x16x64_bf16 v[56:59],v[24:27],a[144:151],v1
buffer_load_dwordx4 v[44:47],v0,s[20:23],s93 offen offset:3072 sc1
s_waitcnt vmcnt(7)
v_max3_u32 v124,v28,v29,v30
v_smfmac_f32_16x16x64_bf16 v[60:63],v[24:27],a[152:159],v1
v_max_u32 v124,v124,v31
v_smfmac_f32_16x16x64_bf16 v[64:67],v[24:27],a[160:167],v1
v_cmp_eq_u32 vcc,-1,v124
v_smfmac_f32_16x16x64_bf16 v[68:71],v[24:27],a[168:175],v1
v_smfmac_f32_16x16x64_bf16 v[72:75],v[24:27],a[176:183],v1
v_smfmac_f32_16x16x64_bf16 v[76:79],v[24:27],a[184:191],v1
s_cbranch_vccnz dfl_100912
dseg_100915:
v_smfmac_f32_16x16x64_bf16 v[48:51],v[28:31],a[192:199],v1
buffer_load_dword v125,off,s[20:23],s92 sc1
v_smfmac_f32_16x16x64_bf16 v[52:55],v[28:31],a[200:207],v1
buffer_store_dword v126,v121,s[20:23],s69 offen sc1
v_smfmac_f32_16x16x64_bf16 v[56:59],v[28:31],a[208:215],v1
v_smfmac_f32_16x16x64_bf16 v[60:63],v[28:31],a[216:223],v1
v_smfmac_f32_16x16x64_bf16 v[64:67],v[28:31],a[224:231],v1
v_smfmac_f32_16x16x64_bf16 v[68:71],v[28:31],a[232:239],v1
v_smfmac_f32_16x16x64_bf16 v[72:75],v[28:31],a[240:247],v1
v_smfmac_f32_16x16x64_bf16 v[76:79],v[28:31],a[248:255],v1
lap2_100916:
s_bitcmp1_b32 s55,0
s_cbranch_scc0 l2s_100970
s_waitcnt vmcnt(8)
v_max3_u32 v124,v16,v17,v18
v_max_u32 v124,v124,v19
v_cmp_eq_u32 vcc,-1,v124
s_cbranch_vccnz l2s_100970
s_bitset0_b32 s55,0
v_smfmac_f32_16x16x64_bf16 v[48:51],v[16:19],a[0:7],v1
v_smfmac_f32_16x16x64_bf16 v[52:55],v[16:19],a[8:15],v1
v_smfmac_f32_16x16x64_bf16 v[56:59],v[16:19],a[16:23],v1
v_smfmac_f32_16x16x64_bf16 v[60:63],v[16:19],a[24:31],v1
v_smfmac_f32_16x16x64_bf16 v[64:67],v[16:19],a[32:39],v1
v_smfmac_f32_16x16x64_bf16 v[68:71],v[16:19],a[40:47],v1
v_smfmac_f32_16x16x64_bf16 v[72:75],v[16:19],a[48:55],v1
v_smfmac_f32_16x16x64_bf16 v[76:79],v[16:19],a[56:63],v1
l2s_100970:
s_bitcmp1_b32 s55,1
s_cbranch_scc0 l2s_100972
s_waitcnt vmcnt(6)
v_max3_u32 v124,v20,v21,v22
v_max_u32 v124,v124,v23
v_cmp_eq_u32 vcc,-1,v124
s_cbranch_vccnz l2s_100972
s_bitset0_b32 s55,1
v_smfmac_f32_16x16x64_bf16 v[48:51],v[20:23],a[64:71],v1
v_smfmac_f32_16x16x64_bf16 v[52:55],v[20:23],a[72:79],v1
v_smfmac_f32_16x16x64_bf16 v[56:59],v[20:23],a[80:87],v1
v_smfmac_f32_16x16x64_bf16 v[60:63],v[20:23],a[88:95],v1
v_smfmac_f32_16x16x64_bf16 v[64:67],v[20:23],a[96:103],v1
v_smfmac_f32_16x16x64_bf16 v[68:71],v[20:23],a[104:111],v1
v_smfmac_f32_16x16x64_bf16 v[72:75],v[20:23],a[112:119],v1
v_smfmac_f32_16x16x64_bf16 v[76:79],v[20:23],a[120:127],v1
l2s_100972:
s_bitcmp1_b32 s55,2
s_cbranch_scc0 l2s_100974
s_waitcnt vmcnt(4)
v_max3_u32 v124,v24,v25,v26
v_max_u32 v124,v124,v27
v_cmp_eq_u32 vcc,-1,v124
s_cbranch_vccnz l2s_100974
s_bitset0_b32 s55,2
v_smfmac_f32_16x16x64_bf16 v[48:51],v[24:27],a[128:135],v1
v_smfmac_f32_16x16x64_bf16 v[52:55],v[24:27],a[136:143],v1
v_smfmac_f32_16x16x64_bf16 v[56:59],v[24:27],a[144:151],v1
v_smfmac_f32_16x16x64_bf16 v[60:63],v[24:27],a[152:159],v1
v_smfmac_f32_16x16x64_bf16 v[64:67],v[24:27],a[160:167],v1
v_smfmac_f32_16x16x64_bf16 v[68:71],v[24:27],a[168:175],v1
v_smfmac_f32_16x16x64_bf16 v[72:75],v[24:27],a[176:183],v1
v_smfmac_f32_16x16x64_bf16 v[76:79],v[24:27],a[184:191],v1
l2s_100974:
s_bitcmp1_b32 s55,3
s_cbranch_scc0 l2s_100976
s_waitcnt vmcnt(1)
v_max3_u32 v124,v28,v29,v30
v_max_u32 v124,v124,v31
v_cmp_eq_u32 vcc,-1,v124
s_cbranch_vccnz l2s_100976
s_bitset0_b32 s55,3
v_smfmac_f32_16x16x64_bf16 v[48:51],v[28:31],a[192:199],v1
v_smfmac_f32_16x16x64_bf16 v[52:55],v[28:31],a[200:207],v1
v_smfmac_f32_16x16x64_bf16 v[56:59],v[28:31],a[208:215],v1
v_smfmac_f32_16x16x64_bf16 v[60:63],v[28:31],a[216:223],v1
v_smfmac_f32_16x16x64_bf16 v[64:67],v[28:31],a[224:231],v1
v_smfmac_f32_16x16x64_bf16 v[68:71],v[28:31],a[232:239],v1
v_smfmac_f32_16x16x64_bf16 v[72:75],v[28:31],a[240:247],v1
v_smfmac_f32_16x16x64_bf16 v[76:79],v[28:31],a[248:255],v1
l2s_100976:
s_cmp_eq_u32 s55,0
s_cbranch_scc0 lfb_100917
Ldone_100918:
s_waitcnt vmcnt(7)
v_max3_u32 v124,v32,v33,v34
v_max_u32 v124,v124,v35
v_cmp_eq_u32 vcc,-1,v124
s_cbranch_vccnz flb_100849
s_branch segb_100833
lfb_100917:
s_bitcmp1_b32 s55,0
s_cbranch_scc0 dsk_100978
buffer_load_dwordx4 v[16:19],v0,s[20:23],s92 offen offset:0 sc1
dsk_100978:
s_bitcmp1_b32 s55,1
s_cbranch_scc0 dsk_100979
buffer_load_dwordx4 v[20:23],v0,s[20:23],s92 offen offset:1024 sc1
dsk_100979:
s_bitcmp1_b32 s55,2
s_cbranch_scc0 dsk_100980
buffer_load_dwordx4 v[24:27],v0,s[20:23],s92 offen offset:2048 sc1
dsk_100980:
s_bitcmp1_b32 s55,3
s_cbranch_scc0 dsk_100981
buffer_load_dwordx4 v[28:31],v0,s[20:23],s92 offen offset:3072 sc1
dsk_100981:
s_bitcmp1_b32 s55,0
s_cbranch_scc0 dsk_100982
s_waitcnt vmcnt(2)
v_max3_u32 v124,v16,v17,v18
v_max_u32 v124,v124,v19
v_cmp_eq_u32 vcc,-1,v124
s_cbranch_vccz dgo_100983
s_nop 15
buffer_load_dwordx4 v[104:107],v0,s[20:23],s92 offen offset:0 sc1
s_nop 15
buffer_load_dwordx4 v[108:111],v0,s[20:23],s92 offen offset:0 sc1
dlp_100984:
s_waitcnt vmcnt(2)
v_max3_u32 v124,v16,v17,v18
v_max_u32 v124,v124,v19
v_cmp_eq_u32 vcc,-1,v124
s_cbranch_vccz dgo_100983
buffer_load_dwordx4 v[16:19],v0,s[20:23],s92 offen offset:0 sc1
s_waitcnt vmcnt(2)
v_max3_u32 v124,v104,v105,v106
v_max_u32 v124,v124,v107
v_cmp_eq_u32 vcc,-1,v124
s_cbranch_vccz dcp_100986
buffer_load_dwordx4 v[104:107],v0,s[20:23],s92 offen offset:0 sc1
s_waitcnt vmcnt(2)
v_max3_u32 v124,v108,v109,v110
v_max_u32 v124,v124,v111
v_cmp_eq_u32 vcc,-1,v124
s_cbranch_vccz dcp_100987
buffer_load_dwordx4 v[108:111],v0,s[20:23],s92 offen offset:0 sc1
s_sub_u32 s90,s90,1
s_cmp_gt_i32 s90,0
s_cbranch_scc1 dlp_100984
s_branch dgo_100983
dcp_100986:
v_mov_b32 v16,v104
v_mov_b32 v17,v105
v_mov_b32 v18,v106
v_mov_b32 v19,v107
s_nop 1
s_branch dgo_100983
dcp_100987:
v_mov_b32 v16,v108
v_mov_b32 v17,v109
v_mov_b32 v18,v110
v_mov_b32 v19,v111
s_nop 1
dgo_100983:
v_smfmac_f32_16x16x64_bf16 v[48:51],v[16:19],a[0:7],v1
v_smfmac_f32_16x16x64_bf16 v[52:55],v[16:19],a[8:15],v1
v_smfmac_f32_16x16x64_bf16 v[56:59],v[16:19],a[16:23],v1
v_smfmac_f32_16x16x64_bf16 v[60:63],v[16:19],a[24:31],v1
v_smfmac_f32_16x16x64_bf16 v[64:67],v[16:19],a[32:39],v1
v_smfmac_f32_16x16x64_bf16 v[68:71],v[16:19],a[40:47],v1
v_smfmac_f32_16x16x64_bf16 v[72:75],v[16:19],a[48:55],v1
v_smfmac_f32_16x16x64_bf16 v[76:79],v[16:19],a[56:63],v1
dsk_100982:
s_bitcmp1_b32 s55,1
s_cbranch_scc0 dsk_100988
s_waitcnt vmcnt(2)
v_max3_u32 v124,v20,v21,v22
v_max_u32 v124,v124,v23
v_cmp_eq_u32 vcc,-1,v124
s_cbranch_vccz dgo_100989
s_nop 15
buffer_load_dwordx4 v[104:107],v0,s[20:23],s92 offen offset:1024 sc1
s_nop 15
buffer_load_dwordx4 v[108:111],v0,s[20:23],s92 offen offset:1024 sc1
dlp_100990:
s_waitcnt vmcnt(2)
v_max3_u32 v124,v20,v21,v22
v_max_u32 v124,v124,v23
v_cmp_eq_u32 vcc,-1,v124
s_cbranch_vccz dgo_100989
buffer_load_dwordx4 v[20:23],v0,s[20:23],s92 offen offset:1024 sc1
s_waitcnt vmcnt(2)
v_max3_u32 v124,v104,v105,v106
v_max_u32 v124,v124,v107
v_cmp_eq_u32 vcc,-1,v124
s_cbranch_vccz dcp_100992
buffer_load_dwordx4 v[104:107],v0,s[20:23],s92 offen offset:1024 sc1
s_waitcnt vmcnt(2)
v_max3_u32 v124,v108,v109,v110
v_max_u32 v124,v124,v111
v_cmp_eq_u32 vcc,-1,v124
s_cbranch_vccz dcp_100993
buffer_load_dwordx4 v[108:111],v0,s[20:23],s92 offen offset:1024 sc1
s_sub_u32 s90,s90,1
s_cmp_gt_i32 s90,0
s_cbranch_scc1 dlp_100990
s_branch dgo_100989
dcp_100992:
v_mov_b32 v20,v104
v_mov_b32 v21,v105
v_mov_b32 v22,v106
v_mov_b32 v23,v107
s_nop 1
s_branch dgo_100989
dcp_100993:
v_mov_b32 v20,v108
v_mov_b32 v21,v109
v_mov_b32 v22,v110
v_mov_b32 v23,v111
s_nop 1
dgo_100989:
v_smfmac_f32_16x16x64_bf16 v[48:51],v[20:23],a[64:71],v1
v_smfmac_f32_16x16x64_bf16 v[52:55],v[20:23],a[72:79],v1
v_smfmac_f32_16x16x64_bf16 v[56:59],v[20:23],a[80:87],v1
v_smfmac_f32_16x16x64_bf16 v[60:63],v[20:23],a[88:95],v1
v_smfmac_f32_16x16x64_bf16 v[64:67],v[20:23],a[96:103],v1
v_smfmac_f32_16x16x64_bf16 v[68:71],v[20:23],a[104:111],v1
v_smfmac_f32_16x16x64_bf16 v[72:75],v[20:23],a[112:119],v1
v_smfmac_f32_16x16x64_bf16 v[76:79],v[20:23],a[120:127],v1
dsk_100988:
s_bitcmp1_b32 s55,2
s_cbranch_scc0 dsk_100994
s_waitcnt vmcnt(2)
v_max3_u32 v124,v24,v25,v26
v_max_u32 v124,v124,v27
v_cmp_eq_u32 vcc,-1,v124
s_cbranch_vccz dgo_100995
s_nop 15
buffer_load_dwordx4 v[104:107],v0,s[20:23],s92 offen offset:2048 sc1
s_nop 15
buffer_load_dwordx4 v[108:111],v0,s[20:23],s92 offen offset:2048 sc1
dlp_100996:
s_waitcnt vmcnt(2)
v_max3_u32 v124,v24,v25,v26
v_max_u32 v124,v124,v27
v_cmp_eq_u32 vcc,-1,v124
s_cbranch_vccz dgo_100995
buffer_load_dwordx4 v[24:27],v0,s[20:23],s92 offen offset:2048 sc1
s_waitcnt vmcnt(2)
v_max3_u32 v124,v104,v105,v106
v_max_u32 v124,v124,v107
v_cmp_eq_u32 vcc,-1,v124
s_cbranch_vccz dcp_100998
buffer_load_dwordx4 v[104:107],v0,s[20:23],s92 offen offset:2048 sc1
s_waitcnt vmcnt(2)
v_max3_u32 v124,v108,v109,v110
v_max_u32 v124,v124,v111
v_cmp_eq_u32 vcc,-1,v124
s_cbranch_vccz dcp_100999
buffer_load_dwordx4 v[108:111],v0,s[20:23],s92 offen offset:2048 sc1
s_sub_u32 s90,s90,1
s_cmp_gt_i32 s90,0
s_cbranch_scc1 dlp_100996
s_branch dgo_100995
dcp_100998:
v_mov_b32 v24,v104
v_mov_b32 v25,v105
v_mov_b32 v26,v106
v_mov_b32 v27,v107
s_nop 1
s_branch dgo_100995
dcp_100999:
v_mov_b32 v24,v108
v_mov_b32 v25,v109
v_mov_b32 v26,v110
v_mov_b32 v27,v111
s_nop 1
dgo_100995:
v_smfmac_f32_16x16x64_bf16 v[48:51],v[24:27],a[128:135],v1
v_smfmac_f32_16x16x64_bf16 v[52:55],v[24:27],a[136:143],v1
v_smfmac_f32_16x16x64_bf16 v[56:59],v[24:27],a[144:151],v1
v_smfmac_f32_16x16x64_bf16 v[60:63],v[24:27],a[152:159],v1
v_smfmac_f32_16x16x64_bf16 v[64:67],v[24:27],a[160:167],v1
v_smfmac_f32_16x16x64_bf16 v[68:71],v[24:27],a[168:175],v1
v_smfmac_f32_16x16x64_bf16 v[72:75],v[24:27],a[176:183],v1
v_smfmac_f32_16x16x64_bf16 v[76:79],v[24:27],a[184:191],v1
dsk_100994:
s_bitcmp1_b32 s55,3
s_cbranch_scc0 dsk_101000
s_waitcnt vmcnt(2)
v_max3_u32 v124,v28,v29,v30
v_max_u32 v124,v124,v31
v_cmp_eq_u32 vcc,-1,v124
s_cbranch_vccz dgo_101001
s_nop 15
buffer_load_dwordx4 v[104:107],v0,s[20:23],s92 offen offset:3072 sc1
s_nop 15
buffer_load_dwordx4 v[108:111],v0,s[20:23],s92 offen offset:3072 sc1
dlp_101002:
s_waitcnt vmcnt(2)
v_max3_u32 v124,v28,v29,v30
v_max_u32 v124,v124,v31
v_cmp_eq_u32 vcc,-1,v124
s_cbranch_vccz dgo_101001
buffer_load_dwordx4 v[28:31],v0,s[20:23],s92 offen offset:3072 sc1
s_waitcnt vmcnt(2)
v_max3_u32 v124,v104,v105,v106
v_max_u32 v124,v124,v107
v_cmp_eq_u32 vcc,-1,v124
s_cbranch_vccz dcp_101004
buffer_load_dwordx4 v[104:107],v0,s[20:23],s92 offen offset:3072 sc1
s_waitcnt vmcnt(2)
v_max3_u32 v124,v108,v109,v110
v_max_u32 v124,v124,v111
v_cmp_eq_u32 vcc,-1,v124
s_cbranch_vccz dcp_101005
buffer_load_dwordx4 v[108:111],v0,s[20:23],s92 offen offset:3072 sc1
s_sub_u32 s90,s90,1
s_cmp_gt_i32 s90,0
s_cbranch_scc1 dlp_101002
s_branch dgo_101001
dcp_101004:
v_mov_b32 v28,v104
v_mov_b32 v29,v105
v_mov_b32 v30,v106
v_mov_b32 v31,v107
s_nop 1
s_branch dgo_101001
dcp_101005:
v_mov_b32 v28,v108
v_mov_b32 v29,v109
v_mov_b32 v30,v110
v_mov_b32 v31,v111
s_nop 1
dgo_101001:
v_smfmac_f32_16x16x64_bf16 v[48:51],v[28:31],a[192:199],v1
v_smfmac_f32_16x16x64_bf16 v[52:55],v[28:31],a[200:207],v1
v_smfmac_f32_16x16x64_bf16 v[56:59],v[28:31],a[208:215],v1
v_smfmac_f32_16x16x64_bf16 v[60:63],v[28:31],a[216:223],v1
v_smfmac_f32_16x16x64_bf16 v[64:67],v[28:31],a[224:231],v1
v_smfmac_f32_16x16x64_bf16 v[68:71],v[28:31],a[232:239],v1
v_smfmac_f32_16x16x64_bf16 v[72:75],v[28:31],a[240:247],v1
v_smfmac_f32_16x16x64_bf16 v[76:79],v[28:31],a[248:255],v1
dsk_101000:
s_mov_b32 s55,0
s_branch Ldone_100918
slowA_100853:
buffer_load_dwordx4 v[44:47],v0,s[20:23],s93 offen offset:3072 sc1
dsk_101006:
s_bitcmp1_b32 s55,7
s_cbranch_scc0 dsk_101007
s_waitcnt vmcnt(2)
v_max3_u32 v124,v44,v45,v46
v_max_u32 v124,v124,v47
v_cmp_eq_u32 vcc,-1,v124
s_cbranch_vccz dgo_101008
s_nop 15
s_nop 3
buffer_load_dwordx4 v[104:107],v0,s[20:23],s93 offen offset:3072 sc1
s_nop 15
s_nop 3
buffer_load_dwordx4 v[108:111],v0,s[20:23],s93 offen offset:3072 sc1
dlp_101009:
s_waitcnt vmcnt(2)
v_max3_u32 v124,v44,v45,v46
v_max_u32 v124,v124,v47
v_cmp_eq_u32 vcc,-1,v124
s_cbranch_vccz dgo_101008
buffer_load_dwordx4 v[44:47],v0,s[20:23],s93 offen offset:3072 sc1
s_waitcnt vmcnt(2)
v_max3_u32 v124,v104,v105,v106
v_max_u32 v124,v124,v107
v_cmp_eq_u32 vcc,-1,v124
s_cbranch_vccz dcp_101011
buffer_load_dwordx4 v[104:107],v0,s[20:23],s93 offen offset:3072 sc1
s_waitcnt vmcnt(2)
v_max3_u32 v124,v108,v109,v110
v_max_u32 v124,v124,v111
v_cmp_eq_u32 vcc,-1,v124
s_cbranch_vccz dcp_101012
buffer_load_dwordx4 v[108:111],v0,s[20:23],s93 offen offset:3072 sc1
s_sub_u32 s90,s90,1
s_cmp_gt_i32 s90,0
s_cbranch_scc1 dlp_101009
s_branch dgo_101008
dcp_101011:
v_mov_b32 v44,v104
v_mov_b32 v45,v105
v_mov_b32 v46,v106
v_mov_b32 v47,v107
s_nop 1
s_branch dgo_101008
dcp_101012:
v_mov_b32 v44,v108
v_mov_b32 v45,v109
v_mov_b32 v46,v110
v_mov_b32 v47,v111
s_nop 1
dgo_101008:
dsk_101007:
s_mov_b32 s55,0
s_branch segb_100835
srt_100861:
s_sub_u32 s90,s90,1
s_cmp_gt_i32 s90,0
s_cbranch_scc0 sok_100860
buffer_load_dwordx4 v[16:19],v2,s[20:23],s94 offen offset:0 sc1
buffer_load_dwordx4 v[32:35],v2,s[20:23],s94 offen offset:1536 sc1
buffer_load_dwordx4 v[20:23],v2,s[20:23],s95 offen offset:0 sc1
buffer_load_dwordx4 v[36:39],v2,s[20:23],s95 offen offset:1536 sc1
buffer_load_dword v120,v3,s[20:23],s94 offen offset:0 sc1
buffer_load_dword v121,v3,s[20:23],s94 offen offset:1536 sc1
buffer_load_dword v122,v3,s[20:23],s95 offen offset:0 sc1
buffer_load_dword v123,v3,s[20:23],s95 offen offset:1536 sc1
s_branch sp_100859
of_100862:
s_mov_b32 s55,3
buffer_load_dwordx4 v[16:19],v0,s[20:23],s96 offen offset:0 sc1
buffer_load_dwordx4 v[20:23],v0,s[20:23],s96 offen offset:1024 sc1
v_readfirstlane_b32 s91,v126
s_waitcnt vmcnt(6)
v_max3_u32 v124,v24,v25,v26
v_max3_u32 v124,v124,v27,v28
v_max3_u32 v124,v124,v29,v30
v_max_u32 v124,v124,v31
v_cmp_eq_u32 vcc,-1,v124
s_cbranch_vccnz ost_101014
v_smfmac_f32_16x16x64_bf16 v[96:99],v[24:27],v[80:87],v1
buffer_load_dword v120,off,s[20:23],s96 sc1
v_smfmac_f32_16x16x64_bf16 v[100:103],v[24:27],v[88:95],v1
buffer_load_dword v120,off,s[20:23],s96 sc1
v_smfmac_f32_16x16x64_bf16 v[96:99],v[28:31],v[128:135],v1
v_smfmac_f32_16x16x64_bf16 v[100:103],v[28:31],v[136:143],v1
ort_101015:
s_waitcnt vmcnt(6)
v_max3_u32 v124,v32,v33,v34
v_max3_u32 v124,v124,v35,v36
v_max3_u32 v124,v124,v37,v38
v_max_u32 v124,v124,v39
v_cmp_eq_u32 vcc,-1,v124
s_cbranch_vccnz ost_101016
v_smfmac_f32_16x16x64_bf16 v[96:99],v[32:35],v[144:151],v1
buffer_load_dword v120,off,s[20:23],s96 sc1
v_smfmac_f32_16x16x64_bf16 v[100:103],v[32:35],v[152:159],v1
buffer_load_dword v120,off,s[20:23],s96 sc1
v_smfmac_f32_16x16x64_bf16 v[96:99],v[36:39],v[160:167],v1
v_smfmac_f32_16x16x64_bf16 v[100:103],v[36:39],v[168:175],v1
ort_101017:
s_waitcnt vmcnt(7)
v_max3_u32 v124,v40,v41,v42
v_max_u32 v124,v124,v43
v_cmp_eq_u32 vcc,-1,v124
s_cbranch_vccnz ost_101018
v_smfmac_f32_16x16x64_bf16 v[96:99],v[40:43],v[176:183],v1
buffer_load_dword v120,off,s[20:23],s96 sc1
v_smfmac_f32_16x16x64_bf16 v[100:103],v[40:43],v[184:191],v1
ort_101019:
s_waitcnt vmcnt(7)
v_max3_u32 v124,v44,v45,v46
v_max_u32 v124,v124,v47
v_cmp_eq_u32 vcc,-1,v124
s_cbranch_vccnz ost_101020
v_smfmac_f32_16x16x64_bf16 v[96:99],v[44:47],v[192:199],v1
buffer_load_dword v120,off,s[20:23],s96 sc1
v_smfmac_f32_16x16x64_bf16 v[100:103],v[44:47],v[200:207],v1
ort_101021:
s_waitcnt vmcnt(6)
v_max3_u32 v124,v16,v17,v18
v_max3_u32 v124,v124,v19,v20
v_max3_u32 v124,v124,v21,v22
v_max_u32 v124,v124,v23
v_cmp_eq_u32 vcc,-1,v124
s_cbranch_vccnz olap2_101013
s_andn2_b32 s55,s55,3
v_smfmac_f32_16x16x64_bf16 v[96:99],v[16:19],v[48:55],v1
v_smfmac_f32_16x16x64_bf16 v[100:103],v[16:19],v[56:63],v1
v_smfmac_f32_16x16x64_bf16 v[96:99],v[20:23],v[64:71],v1
v_smfmac_f32_16x16x64_bf16 v[100:103],v[20:23],v[72:79],v1
s_cbranch_scc0 oback_100873
s_branch olap2_101013
ost_101014:
buffer_load_dwordx4 v[24:27],v0,s[20:23],s96 offen offset:2048 sc1
buffer_load_dwordx4 v[28:31],v0,s[20:23],s96 offen offset:3072 sc1
s_or_b32 s55,s55,12
s_branch ort_101015
ost_101016:
buffer_load_dwordx4 v[32:35],v0,s[20:23],s97 offen offset:0 sc1
buffer_load_dwordx4 v[36:39],v0,s[20:23],s97 offen offset:1024 sc1
s_or_b32 s55,s55,48
s_branch ort_101017
ost_101018:
buffer_load_dwordx4 v[40:43],v0,s[20:23],s97 offen offset:2048 sc1
s_or_b32 s55,s55,64
s_branch ort_101019
ost_101020:
buffer_load_dwordx4 v[44:47],v0,s[20:23],s97 offen offset:3072 sc1
s_or_b32 s55,s55,128
s_branch ort_101021
of_100863:
s_mov_b32 s55,12
buffer_load_dwordx4 v[24:27],v0,s[20:23],s96 offen offset:2048 sc1
buffer_load_dwordx4 v[28:31],v0,s[20:23],s96 offen offset:3072 sc1
s_waitcnt vmcnt(4)
v_max3_u32 v124,v32,v33,v34
v_max3_u32 v124,v124,v35,v36
v_max3_u32 v124,v124,v37,v38
v_max_u32 v124,v124,v39
v_cmp_eq_u32 vcc,-1,v124
s_cbranch_vccnz ost_101023
v_smfmac_f32_16x16x64_bf16 v[96:99],v[32:35],v[144:151],v1
buffer_load_dword v120,off,s[20:23],s96 sc1
v_smfmac_f32_16x16x64_bf16 v[100:103],v[32:35],v[152:159],v1
buffer_load_dword v120,off,s[20:23],s96 sc1
v_smfmac_f32_16x16x64_bf16 v[96:99],v[36:39],v[160:167],v1
v_smfmac_f32_16x16x64_bf16 v[100:103],v[36:39],v[168:175],v1
ort_101024:
s_waitcnt vmcnt(5)
v_max3_u32 v124,v40,v41,v42
v_max_u32 v124,v124,v43
v_cmp_eq_u32 vcc,-1,v124
s_cbranch_vccnz ost_101025
v_smfmac_f32_16x16x64_bf16 v[96:99],v[40:43],v[176:183],v1
buffer_load_dword v120,off,s[20:23],s96 sc1
v_smfmac_f32_16x16x64_bf16 v[100:103],v[40:43],v[184:191],v1
ort_101026:
s_waitcnt vmcnt(5)
v_max3_u32 v124,v44,v45,v46
v_max_u32 v124,v124,v47
v_cmp_eq_u32 vcc,-1,v124
s_cbranch_vccnz ost_101027
v_smfmac_f32_16x16x64_bf16 v[96:99],v[44:47],v[192:199],v1
buffer_load_dword v120,off,s[20:23],s96 sc1
v_smfmac_f32_16x16x64_bf16 v[100:103],v[44:47],v[200:207],v1
ort_101028:
s_waitcnt vmcnt(4)
v_max3_u32 v124,v24,v25,v26
v_max3_u32 v124,v124,v27,v28
v_max3_u32 v124,v124,v29,v30
v_max_u32 v124,v124,v31
v_cmp_eq_u32 vcc,-1,v124
s_cbranch_vccnz olap2_101013
s_andn2_b32 s55,s55,12
v_smfmac_f32_16x16x64_bf16 v[96:99],v[24:27],v[80:87],v1
v_smfmac_f32_16x16x64_bf16 v[100:103],v[24:27],v[88:95],v1
v_smfmac_f32_16x16x64_bf16 v[96:99],v[28:31],v[128:135],v1
v_smfmac_f32_16x16x64_bf16 v[100:103],v[28:31],v[136:143],v1
s_cbranch_scc0 oback_100873
s_branch olap2_101013
ost_101023:
buffer_load_dwordx4 v[32:35],v0,s[20:23],s97 offen offset:0 sc1
buffer_load_dwordx4 v[36:39],v0,s[20:23],s97 offen offset:1024 sc1
s_or_b32 s55,s55,48
s_branch ort_101024
ost_101025:
buffer_load_dwordx4 v[40:43],v0,s[20:23],s97 offen offset:2048 sc1
s_or_b32 s55,s55,64
s_branch ort_101026
ost_101027:
buffer_load_dwordx4 v[44:47],v0,s[20:23],s97 offen offset:3072 sc1
s_or_b32 s55,s55,128
s_branch ort_101028
of_100864:
s_mov_b32 s55,48
buffer_load_dwordx4 v[32:35],v0,s[20:23],s97 offen offset:0 sc1
buffer_load_dwordx4 v[36:39],v0,s[20:23],s97 offen offset:1024 sc1
s_waitcnt vmcnt(3)
v_max3_u32 v124,v40,v41,v42
v_max_u32 v124,v124,v43
v_cmp_eq_u32 vcc,-1,v124
s_cbranch_vccnz ost_101030
v_smfmac_f32_16x16x64_bf16 v[96:99],v[40:43],v[176:183],v1
buffer_load_dword v120,off,s[20:23],s96 sc1
v_smfmac_f32_16x16x64_bf16 v[100:103],v[40:43],v[184:191],v1
ort_101031:
s_waitcnt vmcnt(3)
v_max3_u32 v124,v44,v45,v46
v_max_u32 v124,v124,v47
v_cmp_eq_u32 vcc,-1,v124
s_cbranch_vccnz ost_101032
v_smfmac_f32_16x16x64_bf16 v[96:99],v[44:47],v[192:199],v1
buffer_load_dword v120,off,s[20:23],s96 sc1
v_smfmac_f32_16x16x64_bf16 v[100:103],v[44:47],v[200:207],v1
ort_101033:
s_waitcnt vmcnt(2)
v_max3_u32 v124,v32,v33,v34
v_max3_u32 v124,v124,v35,v36
v_max3_u32 v124,v124,v37,v38
v_max_u32 v124,v124,v39
v_cmp_eq_u32 vcc,-1,v124
s_cbranch_vccnz olap2_101013
s_andn2_b32 s55,s55,48
v_smfmac_f32_16x16x64_bf16 v[96:99],v[32:35],v[144:151],v1
v_smfmac_f32_16x16x64_bf16 v[100:103],v[32:35],v[152:159],v1
v_smfmac_f32_16x16x64_bf16 v[96:99],v[36:39],v[160:167],v1
v_smfmac_f32_16x16x64_bf16 v[100:103],v[36:39],v[168:175],v1
s_cbranch_scc0 oback_100873
s_branch olap2_101013
ost_101030:
buffer_load_dwordx4 v[40:43],v0,s[20:23],s97 offen offset:2048 sc1
s_or_b32 s55,s55,64
s_branch ort_101031
ost_101032:
buffer_load_dwordx4 v[44:47],v0,s[20:23],s97 offen offset:3072 sc1
s_or_b32 s55,s55,128
s_branch ort_101033
of_100865:
s_mov_b32 s55,64
buffer_load_dwordx4 v[40:43],v0,s[20:23],s97 offen offset:2048 sc1
s_waitcnt vmcnt(1)
v_max3_u32 v124,v44,v45,v46
v_max_u32 v124,v124,v47
v_cmp_eq_u32 vcc,-1,v124
s_cbranch_vccnz ost_101035
v_smfmac_f32_16x16x64_bf16 v[96:99],v[44:47],v[192:199],v1
buffer_load_dword v120,off,s[20:23],s96 sc1
v_smfmac_f32_16x16x64_bf16 v[100:103],v[44:47],v[200:207],v1
ort_101036:
s_waitcnt vmcnt(1)
v_max3_u32 v124,v40,v41,v42
v_max_u32 v124,v124,v43
v_cmp_eq_u32 vcc,-1,v124
s_cbranch_vccnz olap2_101013
s_andn2_b32 s55,s55,64
v_smfmac_f32_16x16x64_bf16 v[96:99],v[40:43],v[176:183],v1
v_smfmac_f32_16x16x64_bf16 v[100:103],v[40:43],v[184:191],v1
s_cbranch_scc0 oback_100873
s_branch olap2_101013
ost_101035:
buffer_load_dwordx4 v[44:47],v0,s[20:23],s97 offen offset:3072 sc1
s_or_b32 s55,s55,128
s_branch ort_101036
of_100866:
s_mov_b32 s55,128
s_branch oslow_100872
olap2_101013:
s_bitcmp1_b32 s55,0
s_cbranch_scc0 l2s_101038
s_waitcnt vmcnt(6)
v_max3_u32 v124,v16,v17,v18
v_max3_u32 v124,v124,v19,v20
v_max3_u32 v124,v124,v21,v22
v_max_u32 v124,v124,v23
v_cmp_eq_u32 vcc,-1,v124
s_cbranch_vccnz l2s_101038
s_andn2_b32 s55,s55,3
v_smfmac_f32_16x16x64_bf16 v[96:99],v[16:19],v[48:55],v1
v_smfmac_f32_16x16x64_bf16 v[100:103],v[16:19],v[56:63],v1
v_smfmac_f32_16x16x64_bf16 v[96:99],v[20:23],v[64:71],v1
v_smfmac_f32_16x16x64_bf16 v[100:103],v[20:23],v[72:79],v1
l2s_101038:
s_bitcmp1_b32 s55,2
s_cbranch_scc0 l2s_101039
s_waitcnt vmcnt(4)
v_max3_u32 v124,v24,v25,v26
v_max3_u32 v124,v124,v27,v28
v_max3_u32 v124,v124,v29,v30
v_max_u32 v124,v124,v31
v_cmp_eq_u32 vcc,-1,v124
s_cbranch_vccnz l2s_101039
s_andn2_b32 s55,s55,12
v_smfmac_f32_16x16x64_bf16 v[96:99],v[24:27],v[80:87],v1
v_smfmac_f32_16x16x64_bf16 v[100:103],v[24:27],v[88:95],v1
v_smfmac_f32_16x16x64_bf16 v[96:99],v[28:31],v[128:135],v1
v_smfmac_f32_16x16x64_bf16 v[100:103],v[28:31],v[136:143],v1
l2s_101039:
s_bitcmp1_b32 s55,4
s_cbranch_scc0 l2s_101040
s_waitcnt vmcnt(2)
v_max3_u32 v124,v32,v33,v34
v_max3_u32 v124,v124,v35,v36
v_max3_u32 v124,v124,v37,v38
v_max_u32 v124,v124,v39
v_cmp_eq_u32 vcc,-1,v124
s_cbranch_vccnz l2s_101040
s_andn2_b32 s55,s55,48
v_smfmac_f32_16x16x64_bf16 v[96:99],v[32:35],v[144:151],v1
v_smfmac_f32_16x16x64_bf16 v[100:103],v[32:35],v[152:159],v1
v_smfmac_f32_16x16x64_bf16 v[96:99],v[36:39],v[160:167],v1
v_smfmac_f32_16x16x64_bf16 v[100:103],v[36:39],v[168:175],v1
l2s_101040:
s_bitcmp1_b32 s55,6
s_cbranch_scc0 l2s_101041
s_waitcnt vmcnt(1)
v_max3_u32 v124,v40,v41,v42
v_max_u32 v124,v124,v43
v_cmp_eq_u32 vcc,-1,v124
s_cbranch_vccnz l2s_101041
s_andn2_b32 s55,s55,64
v_smfmac_f32_16x16x64_bf16 v[96:99],v[40:43],v[176:183],v1
v_smfmac_f32_16x16x64_bf16 v[100:103],v[40:43],v[184:191],v1
l2s_101041:
s_bitcmp1_b32 s55,7
s_cbranch_scc0 l2s_101042
s_waitcnt vmcnt(0)
v_max3_u32 v124,v44,v45,v46
v_max_u32 v124,v124,v47
v_cmp_eq_u32 vcc,-1,v124
s_cbranch_vccnz l2s_101042
s_andn2_b32 s55,s55,128
v_smfmac_f32_16x16x64_bf16 v[96:99],v[44:47],v[192:199],v1
v_smfmac_f32_16x16x64_bf16 v[100:103],v[44:47],v[200:207],v1
l2s_101042:
s_cmp_eq_u32 s55,0
s_cbranch_scc1 oback_100873
oslow_100872:
s_bitcmp1_b32 s55,0
s_cbranch_scc0 dsk_101043
buffer_load_dwordx4 v[16:19],v0,s[20:23],s96 offen offset:0 sc1
dsk_101043:
s_bitcmp1_b32 s55,1
s_cbranch_scc0 dsk_101044
buffer_load_dwordx4 v[20:23],v0,s[20:23],s96 offen offset:1024 sc1
dsk_101044:
s_bitcmp1_b32 s55,2
s_cbranch_scc0 dsk_101045
buffer_load_dwordx4 v[24:27],v0,s[20:23],s96 offen offset:2048 sc1
dsk_101045:
s_bitcmp1_b32 s55,3
s_cbranch_scc0 dsk_101046
buffer_load_dwordx4 v[28:31],v0,s[20:23],s96 offen offset:3072 sc1
dsk_101046:
s_bitcmp1_b32 s55,4
s_cbranch_scc0 dsk_101047
buffer_load_dwordx4 v[32:35],v0,s[20:23],s97 offen offset:0 sc1
dsk_101047:
s_bitcmp1_b32 s55,5
s_cbranch_scc0 dsk_101048
buffer_load_dwordx4 v[36:39],v0,s[20:23],s97 offen offset:1024 sc1
dsk_101048:
s_bitcmp1_b32 s55,6
s_cbranch_scc0 dsk_101049
buffer_load_dwordx4 v[40:43],v0,s[20:23],s97 offen offset:2048 sc1
dsk_101049:
s_bitcmp1_b32 s55,7
s_cbranch_scc0 dsk_101050
buffer_load_dwordx4 v[44:47],v0,s[20:23],s97 offen offset:3072 sc1
dsk_101050:
s_bitcmp1_b32 s55,0
s_cbranch_scc0 dsk_101051
s_waitcnt vmcnt(2)
v_max3_u32 v124,v16,v17,v18
v_max_u32 v124,v124,v19
v_cmp_eq_u32 vcc,-1,v124
s_cbranch_vccz dgo_101052
s_nop 15
buffer_load_dwordx4 v[116:119],v0,s[20:23],s96 offen offset:0 sc1
s_nop 15
buffer_load_dwordx4 v[120:123],v0,s[20:23],s96 offen offset:0 sc1
dlp_101053:
s_waitcnt vmcnt(2)
v_max3_u32 v124,v16,v17,v18
v_max_u32 v124,v124,v19
v_cmp_eq_u32 vcc,-1,v124
s_cbranch_vccz dgo_101052
buffer_load_dwordx4 v[16:19],v0,s[20:23],s96 offen offset:0 sc1
s_waitcnt vmcnt(2)
v_max3_u32 v124,v116,v117,v118
v_max_u32 v124,v124,v119
v_cmp_eq_u32 vcc,-1,v124
s_cbranch_vccz dcp_101055
buffer_load_dwordx4 v[116:119],v0,s[20:23],s96 offen offset:0 sc1
s_waitcnt vmcnt(2)
v_max3_u32 v124,v120,v121,v122
v_max_u32 v124,v124,v123
v_cmp_eq_u32 vcc,-1,v124
s_cbranch_vccz dcp_101056
buffer_load_dwordx4 v[120:123],v0,s[20:23],s96 offen offset:0 sc1
s_sub_u32 s90,s90,1
s_cmp_gt_i32 s90,0
s_cbranch_scc1 dlp_101053
s_branch dgo_101052
dcp_101055:
v_mov_b32 v16,v116
v_mov_b32 v17,v117
v_mov_b32 v18,v118
v_mov_b32 v19,v119
s_nop 1
s_branch dgo_101052
dcp_101056:
v_mov_b32 v16,v120
v_mov_b32 v17,v121
v_mov_b32 v18,v122
v_mov_b32 v19,v123
s_nop 1
dgo_101052:
v_smfmac_f32_16x16x64_bf16 v[96:99],v[16:19],v[48:55],v1
v_smfmac_f32_16x16x64_bf16 v[100:103],v[16:19],v[56:63],v1
dsk_101051:
s_bitcmp1_b32 s55,1
s_cbranch_scc0 dsk_101057
s_waitcnt vmcnt(2)
v_max3_u32 v124,v20,v21,v22
v_max_u32 v124,v124,v23
v_cmp_eq_u32 vcc,-1,v124
s_cbranch_vccz dgo_101058
s_nop 15
buffer_load_dwordx4 v[116:119],v0,s[20:23],s96 offen offset:1024 sc1
s_nop 15
buffer_load_dwordx4 v[120:123],v0,s[20:23],s96 offen offset:1024 sc1
dlp_101059:
s_waitcnt vmcnt(2)
v_max3_u32 v124,v20,v21,v22
v_max_u32 v124,v124,v23
v_cmp_eq_u32 vcc,-1,v124
s_cbranch_vccz dgo_101058
buffer_load_dwordx4 v[20:23],v0,s[20:23],s96 offen offset:1024 sc1
s_waitcnt vmcnt(2)
v_max3_u32 v124,v116,v117,v118
v_max_u32 v124,v124,v119
v_cmp_eq_u32 vcc,-1,v124
s_cbranch_vccz dcp_101061
buffer_load_dwordx4 v[116:119],v0,s[20:23],s96 offen offset:1024 sc1
s_waitcnt vmcnt(2)
v_max3_u32 v124,v120,v121,v122
v_max_u32 v124,v124,v123
v_cmp_eq_u32 vcc,-1,v124
s_cbranch_vccz dcp_101062
buffer_load_dwordx4 v[120:123],v0,s[20:23],s96 offen offset:1024 sc1
s_sub_u32 s90,s90,1
s_cmp_gt_i32 s90,0
s_cbranch_scc1 dlp_101059
s_branch dgo_101058
dcp_101061:
v_mov_b32 v20,v116
v_mov_b32 v21,v117
v_mov_b32 v22,v118
v_mov_b32 v23,v119
s_nop 1
s_branch dgo_101058
dcp_101062:
v_mov_b32 v20,v120
v_mov_b32 v21,v121
v_mov_b32 v22,v122
v_mov_b32 v23,v123
s_nop 1
dgo_101058:
v_smfmac_f32_16x16x64_bf16 v[96:99],v[20:23],v[64:71],v1
v_smfmac_f32_16x16x64_bf16 v[100:103],v[20:23],v[72:79],v1
dsk_101057:
s_bitcmp1_b32 s55,2
s_cbranch_scc0 dsk_101063
s_waitcnt vmcnt(2)
v_max3_u32 v124,v24,v25,v26
v_max_u32 v124,v124,v27
v_cmp_eq_u32 vcc,-1,v124
s_cbranch_vccz dgo_101064
s_nop 15
buffer_load_dwordx4 v[116:119],v0,s[20:23],s96 offen offset:2048 sc1
s_nop 15
buffer_load_dwordx4 v[120:123],v0,s[20:23],s96 offen offset:2048 sc1
dlp_101065:
s_waitcnt vmcnt(2)
v_max3_u32 v124,v24,v25,v26
v_max_u32 v124,v124,v27
v_cmp_eq_u32 vcc,-1,v124
s_cbranch_vccz dgo_101064
buffer_load_dwordx4 v[24:27],v0,s[20:23],s96 offen offset:2048 sc1
s_waitcnt vmcnt(2)
v_max3_u32 v124,v116,v117,v118
v_max_u32 v124,v124,v119
v_cmp_eq_u32 vcc,-1,v124
s_cbranch_vccz dcp_101067
buffer_load_dwordx4 v[116:119],v0,s[20:23],s96 offen offset:2048 sc1
s_waitcnt vmcnt(2)
v_max3_u32 v124,v120,v121,v122
v_max_u32 v124,v124,v123
v_cmp_eq_u32 vcc,-1,v124
s_cbranch_vccz dcp_101068
buffer_load_dwordx4 v[120:123],v0,s[20:23],s96 offen offset:2048 sc1
s_sub_u32 s90,s90,1
s_cmp_gt_i32 s90,0
s_cbranch_scc1 dlp_101065
s_branch dgo_101064
dcp_101067:
v_mov_b32 v24,v116
v_mov_b32 v25,v117
v_mov_b32 v26,v118
v_mov_b32 v27,v119
s_nop 1
s_branch dgo_101064
dcp_101068:
v_mov_b32 v24,v120
v_mov_b32 v25,v121
v_mov_b32 v26,v122
v_mov_b32 v27,v123
s_nop 1
dgo_101064:
v_smfmac_f32_16x16x64_bf16 v[96:99],v[24:27],v[80:87],v1
v_smfmac_f32_16x16x64_bf16 v[100:103],v[24:27],v[88:95],v1
dsk_101063:
s_bitcmp1_b32 s55,3
s_cbranch_scc0 dsk_101069
s_waitcnt vmcnt(2)
v_max3_u32 v124,v28,v29,v30
v_max_u32 v124,v124,v31
v_cmp_eq_u32 vcc,-1,v124
s_cbranch_vccz dgo_101070
s_nop 15
buffer_load_dwordx4 v[116:119],v0,s[20:23],s96 offen offset:3072 sc1
s_nop 15
buffer_load_dwordx4 v[120:123],v0,s[20:23],s96 offen offset:3072 sc1
dlp_101071:
s_waitcnt vmcnt(2)
v_max3_u32 v124,v28,v29,v30
v_max_u32 v124,v124,v31
v_cmp_eq_u32 vcc,-1,v124
s_cbranch_vccz dgo_101070
buffer_load_dwordx4 v[28:31],v0,s[20:23],s96 offen offset:3072 sc1
s_waitcnt vmcnt(2)
v_max3_u32 v124,v116,v117,v118
v_max_u32 v124,v124,v119
v_cmp_eq_u32 vcc,-1,v124
s_cbranch_vccz dcp_101073
buffer_load_dwordx4 v[116:119],v0,s[20:23],s96 offen offset:3072 sc1
s_waitcnt vmcnt(2)
v_max3_u32 v124,v120,v121,v122
v_max_u32 v124,v124,v123
v_cmp_eq_u32 vcc,-1,v124
s_cbranch_vccz dcp_101074
buffer_load_dwordx4 v[120:123],v0,s[20:23],s96 offen offset:3072 sc1
s_sub_u32 s90,s90,1
s_cmp_gt_i32 s90,0
s_cbranch_scc1 dlp_101071
s_branch dgo_101070
dcp_101073:
v_mov_b32 v28,v116
v_mov_b32 v29,v117
v_mov_b32 v30,v118
v_mov_b32 v31,v119
s_nop 1
s_branch dgo_101070
dcp_101074:
v_mov_b32 v28,v120
v_mov_b32 v29,v121
v_mov_b32 v30,v122
v_mov_b32 v31,v123
s_nop 1
dgo_101070:
v_smfmac_f32_16x16x64_bf16 v[96:99],v[28:31],v[128:135],v1
v_smfmac_f32_16x16x64_bf16 v[100:103],v[28:31],v[136:143],v1
dsk_101069:
s_bitcmp1_b32 s55,4
s_cbranch_scc0 dsk_101075
s_waitcnt vmcnt(2)
v_max3_u32 v124,v32,v33,v34
v_max_u32 v124,v124,v35
v_cmp_eq_u32 vcc,-1,v124
s_cbranch_vccz dgo_101076
s_nop 15
buffer_load_dwordx4 v[116:119],v0,s[20:23],s97 offen offset:0 sc1
s_nop 15
buffer_load_dwordx4 v[120:123],v0,s[20:23],s97 offen offset:0 sc1
dlp_101077:
s_waitcnt vmcnt(2)
v_max3_u32 v124,v32,v33,v34
v_max_u32 v124,v124,v35
v_cmp_eq_u32 vcc,-1,v124
s_cbranch_vccz dgo_101076
buffer_load_dwordx4 v[32:35],v0,s[20:23],s97 offen offset:0 sc1
s_waitcnt vmcnt(2)
v_max3_u32 v124,v116,v117,v118
v_max_u32 v124,v124,v119
v_cmp_eq_u32 vcc,-1,v124
s_cbranch_vccz dcp_101079
buffer_load_dwordx4 v[116:119],v0,s[20:23],s97 offen offset:0 sc1
s_waitcnt vmcnt(2)
v_max3_u32 v124,v120,v121,v122
v_max_u32 v124,v124,v123
v_cmp_eq_u32 vcc,-1,v124
s_cbranch_vccz dcp_101080
buffer_load_dwordx4 v[120:123],v0,s[20:23],s97 offen offset:0 sc1
s_sub_u32 s90,s90,1
s_cmp_gt_i32 s90,0
s_cbranch_scc1 dlp_101077
s_branch dgo_101076
dcp_101079:
v_mov_b32 v32,v116
v_mov_b32 v33,v117
v_mov_b32 v34,v118
v_mov_b32 v35,v119
s_nop 1
s_branch dgo_101076
dcp_101080:
v_mov_b32 v32,v120
v_mov_b32 v33,v121
v_mov_b32 v34,v122
v_mov_b32 v35,v123
s_nop 1
dgo_101076:
v_smfmac_f32_16x16x64_bf16 v[96:99],v[32:35],v[144:151],v1
v_smfmac_f32_16x16x64_bf16 v[100:103],v[32:35],v[152:159],v1
dsk_101075:
s_bitcmp1_b32 s55,5
s_cbranch_scc0 dsk_101081
s_waitcnt vmcnt(2)
v_max3_u32 v124,v36,v37,v38
v_max_u32 v124,v124,v39
v_cmp_eq_u32 vcc,-1,v124
s_cbranch_vccz dgo_101082
s_nop 15
buffer_load_dwordx4 v[116:119],v0,s[20:23],s97 offen offset:1024 sc1
s_nop 15
buffer_load_dwordx4 v[120:123],v0,s[20:23],s97 offen offset:1024 sc1
dlp_101083:
s_waitcnt vmcnt(2)
v_max3_u32 v124,v36,v37,v38
v_max_u32 v124,v124,v39
v_cmp_eq_u32 vcc,-1,v124
s_cbranch_vccz dgo_101082
buffer_load_dwordx4 v[36:39],v0,s[20:23],s97 offen offset:1024 sc1
s_waitcnt vmcnt(2)
v_max3_u32 v124,v116,v117,v118
v_max_u32 v124,v124,v119
v_cmp_eq_u32 vcc,-1,v124
s_cbranch_vccz dcp_101085
buffer_load_dwordx4 v[116:119],v0,s[20:23],s97 offen offset:1024 sc1
s_waitcnt vmcnt(2)
v_max3_u32 v124,v120,v121,v122
v_max_u32 v124,v124,v123
v_cmp_eq_u32 vcc,-1,v124
s_cbranch_vccz dcp_101086
buffer_load_dwordx4 v[120:123],v0,s[20:23],s97 offen offset:1024 sc1
s_sub_u32 s90,s90,1
s_cmp_gt_i32 s90,0
s_cbranch_scc1 dlp_101083
s_branch dgo_101082
dcp_101085:
v_mov_b32 v36,v116
v_mov_b32 v37,v117
v_mov_b32 v38,v118
v_mov_b32 v39,v119
s_nop 1
s_branch dgo_101082
dcp_101086:
v_mov_b32 v36,v120
v_mov_b32 v37,v121
v_mov_b32 v38,v122
v_mov_b32 v39,v123
s_nop 1
dgo_101082:
v_smfmac_f32_16x16x64_bf16 v[96:99],v[36:39],v[160:167],v1
v_smfmac_f32_16x16x64_bf16 v[100:103],v[36:39],v[168:175],v1
dsk_101081:
s_bitcmp1_b32 s55,6
s_cbranch_scc0 dsk_101087
s_waitcnt vmcnt(2)
v_max3_u32 v124,v40,v41,v42
v_max_u32 v124,v124,v43
v_cmp_eq_u32 vcc,-1,v124
s_cbranch_vccz dgo_101088
s_nop 15
buffer_load_dwordx4 v[116:119],v0,s[20:23],s97 offen offset:2048 sc1
s_nop 15
buffer_load_dwordx4 v[120:123],v0,s[20:23],s97 offen offset:2048 sc1
dlp_101089:
s_waitcnt vmcnt(2)
v_max3_u32 v124,v40,v41,v42
v_max_u32 v124,v124,v43
v_cmp_eq_u32 vcc,-1,v124
s_cbranch_vccz dgo_101088
buffer_load_dwordx4 v[40:43],v0,s[20:23],s97 offen offset:2048 sc1
s_waitcnt vmcnt(2)
v_max3_u32 v124,v116,v117,v118
v_max_u32 v124,v124,v119
v_cmp_eq_u32 vcc,-1,v124
s_cbranch_vccz dcp_101091
buffer_load_dwordx4 v[116:119],v0,s[20:23],s97 offen offset:2048 sc1
s_waitcnt vmcnt(2)
v_max3_u32 v124,v120,v121,v122
v_max_u32 v124,v124,v123
v_cmp_eq_u32 vcc,-1,v124
s_cbranch_vccz dcp_101092
buffer_load_dwordx4 v[120:123],v0,s[20:23],s97 offen offset:2048 sc1
s_sub_u32 s90,s90,1
s_cmp_gt_i32 s90,0
s_cbranch_scc1 dlp_101089
s_branch dgo_101088
dcp_101091:
v_mov_b32 v40,v116
v_mov_b32 v41,v117
v_mov_b32 v42,v118
v_mov_b32 v43,v119
s_nop 1
s_branch dgo_101088
dcp_101092:
v_mov_b32 v40,v120
v_mov_b32 v41,v121
v_mov_b32 v42,v122
v_mov_b32 v43,v123
s_nop 1
dgo_101088:
v_smfmac_f32_16x16x64_bf16 v[96:99],v[40:43],v[176:183],v1
v_smfmac_f32_16x16x64_bf16 v[100:103],v[40:43],v[184:191],v1
dsk_101087:
s_bitcmp1_b32 s55,7
s_cbranch_scc0 dsk_101093
s_waitcnt vmcnt(2)
v_max3_u32 v124,v44,v45,v46
v_max_u32 v124,v124,v47
v_cmp_eq_u32 vcc,-1,v124
s_cbranch_vccz dgo_101094
s_nop 15
buffer_load_dwordx4 v[116:119],v0,s[20:23],s97 offen offset:3072 sc1
s_nop 15
buffer_load_dwordx4 v[120:123],v0,s[20:23],s97 offen offset:3072 sc1
dlp_101095:
s_waitcnt vmcnt(2)
v_max3_u32 v124,v44,v45,v46
v_max_u32 v124,v124,v47
v_cmp_eq_u32 vcc,-1,v124
s_cbranch_vccz dgo_101094
buffer_load_dwordx4 v[44:47],v0,s[20:23],s97 offen offset:3072 sc1
s_waitcnt vmcnt(2)
v_max3_u32 v124,v116,v117,v118
v_max_u32 v124,v124,v119
v_cmp_eq_u32 vcc,-1,v124
s_cbranch_vccz dcp_101097
buffer_load_dwordx4 v[116:119],v0,s[20:23],s97 offen offset:3072 sc1
s_waitcnt vmcnt(2)
v_max3_u32 v124,v120,v121,v122
v_max_u32 v124,v124,v123
v_cmp_eq_u32 vcc,-1,v124
s_cbranch_vccz dcp_101098
buffer_load_dwordx4 v[120:123],v0,s[20:23],s97 offen offset:3072 sc1
s_sub_u32 s90,s90,1
s_cmp_gt_i32 s90,0
s_cbranch_scc1 dlp_101095
s_branch dgo_101094
dcp_101097:
v_mov_b32 v44,v116
v_mov_b32 v45,v117
v_mov_b32 v46,v118
v_mov_b32 v47,v119
s_nop 1
s_branch dgo_101094
dcp_101098:
v_mov_b32 v44,v120
v_mov_b32 v45,v121
v_mov_b32 v46,v122
v_mov_b32 v47,v123
s_nop 1
dgo_101094:
v_smfmac_f32_16x16x64_bf16 v[96:99],v[44:47],v[192:199],v1
v_smfmac_f32_16x16x64_bf16 v[100:103],v[44:47],v[200:207],v1
dsk_101093:
s_mov_b32 s55,0
s_branch oback_100873
fl_100890:
flb_100898:
buffer_load_dwordx4 v[16:19],v0,s[20:23],s92 offen offset:0 sc1
s_mov_b32 s55,1
buffer_load_dwordx4 v[32:35],v0,s[20:23],s93 offen offset:0 sc1
s_waitcnt vmcnt(4)
v_max3_u32 v124,v20,v21,v22
v_max_u32 v124,v124,v23
v_cmp_eq_u32 vcc,-1,v124
s_cbranch_vccnz dfl_101099
v_smfmac_f32_16x16x64_bf16 v[64:67],v[20:23],a[96:103],v1
buffer_load_dword v125,off,s[20:23],s92 sc1
buffer_load_dwordx4 v[36:39],v0,s[20:23],s93 offen offset:1024 sc1
s_waitcnt vmcnt(5)
v_max3_u32 v124,v24,v25,v26
v_smfmac_f32_16x16x64_bf16 v[68:71],v[20:23],a[104:111],v1
v_max_u32 v124,v124,v27
v_cmp_eq_u32 vcc,-1,v124
v_smfmac_f32_16x16x64_bf16 v[72:75],v[20:23],a[112:119],v1
v_smfmac_f32_16x16x64_bf16 v[76:79],v[20:23],a[120:127],v1
s_cbranch_vccnz dfl_101100
v_smfmac_f32_16x16x64_bf16 v[64:67],v[24:27],a[160:167],v1
buffer_load_dword v125,off,s[20:23],s92 sc1
buffer_load_dwordx4 v[40:43],v0,s[20:23],s93 offen offset:2048 sc1
buffer_load_dwordx4 v[44:47],v0,s[20:23],s93 offen offset:3072 sc1
s_waitcnt vmcnt(7)
v_max3_u32 v124,v28,v29,v30
v_smfmac_f32_16x16x64_bf16 v[68:71],v[24:27],a[168:175],v1
v_max_u32 v124,v124,v31
v_cmp_eq_u32 vcc,-1,v124
v_smfmac_f32_16x16x64_bf16 v[72:75],v[24:27],a[176:183],v1
v_smfmac_f32_16x16x64_bf16 v[76:79],v[24:27],a[184:191],v1
s_cbranch_vccnz dfl_101101
v_smfmac_f32_16x16x64_bf16 v[64:67],v[28:31],a[224:231],v1
buffer_load_dword v125,off,s[20:23],s92 sc1
buffer_store_dword v126,v121,s[20:23],s69 offen sc1
s_waitcnt vmcnt(8)
v_max3_u32 v124,v16,v17,v18
v_smfmac_f32_16x16x64_bf16 v[68:71],v[28:31],a[232:239],v1
v_max_u32 v124,v124,v19
v_cmp_eq_u32 vcc,-1,v124
v_smfmac_f32_16x16x64_bf16 v[72:75],v[28:31],a[240:247],v1
v_smfmac_f32_16x16x64_bf16 v[76:79],v[28:31],a[248:255],v1
s_cbranch_vccnz lfb_101106
s_mov_b32 s55,0
v_smfmac_f32_16x16x64_bf16 v[64:67],v[16:19],a[32:39],v1
s_waitcnt vmcnt(7)
v_max3_u32 v124,v32,v33,v34
v_max_u32 v124,v124,v35
v_cmp_eq_u32 vcc,-1,v124
v_smfmac_f32_16x16x64_bf16 v[68:71],v[16:19],a[40:47],v1
v_smfmac_f32_16x16x64_bf16 v[72:75],v[16:19],a[48:55],v1
v_smfmac_f32_16x16x64_bf16 v[76:79],v[16:19],a[56:63],v1
s_cbranch_vccnz flb_100902
s_branch segb_100886
fl_100891:
flb_100899:
buffer_load_dwordx4 v[20:23],v0,s[20:23],s92 offen offset:1024 sc1
s_mov_b32 s55,2
buffer_load_dwordx4 v[36:39],v0,s[20:23],s93 offen offset:1024 sc1
s_waitcnt vmcnt(5)
v_max3_u32 v124,v24,v25,v26
v_max_u32 v124,v124,v27
v_cmp_eq_u32 vcc,-1,v124
s_cbranch_vccnz dfl_101100
v_smfmac_f32_16x16x64_bf16 v[64:67],v[24:27],a[160:167],v1
buffer_load_dword v125,off,s[20:23],s92 sc1
buffer_load_dwordx4 v[40:43],v0,s[20:23],s93 offen offset:2048 sc1
buffer_load_dwordx4 v[44:47],v0,s[20:23],s93 offen offset:3072 sc1
s_waitcnt vmcnt(7)
v_max3_u32 v124,v28,v29,v30
v_smfmac_f32_16x16x64_bf16 v[68:71],v[24:27],a[168:175],v1
v_max_u32 v124,v124,v31
v_cmp_eq_u32 vcc,-1,v124
v_smfmac_f32_16x16x64_bf16 v[72:75],v[24:27],a[176:183],v1
v_smfmac_f32_16x16x64_bf16 v[76:79],v[24:27],a[184:191],v1
s_cbranch_vccnz dfl_101101
v_smfmac_f32_16x16x64_bf16 v[64:67],v[28:31],a[224:231],v1
buffer_load_dword v125,off,s[20:23],s92 sc1
buffer_store_dword v126,v121,s[20:23],s69 offen sc1
s_waitcnt vmcnt(6)
v_max3_u32 v124,v20,v21,v22
v_smfmac_f32_16x16x64_bf16 v[68:71],v[28:31],a[232:239],v1
v_max_u32 v124,v124,v23
v_cmp_eq_u32 vcc,-1,v124
v_smfmac_f32_16x16x64_bf16 v[72:75],v[28:31],a[240:247],v1
v_smfmac_f32_16x16x64_bf16 v[76:79],v[28:31],a[248:255],v1
s_cbranch_vccnz lfb_101106
s_mov_b32 s55,0
v_smfmac_f32_16x16x64_bf16 v[64:67],v[20:23],a[96:103],v1
s_waitcnt vmcnt(7)
v_max3_u32 v124,v32,v33,v34
v_max_u32 v124,v124,v35
v_cmp_eq_u32 vcc,-1,v124
v_smfmac_f32_16x16x64_bf16 v[68:71],v[20:23],a[104:111],v1
v_smfmac_f32_16x16x64_bf16 v[72:75],v[20:23],a[112:119],v1
v_smfmac_f32_16x16x64_bf16 v[76:79],v[20:23],a[120:127],v1
s_cbranch_vccnz flb_100902
s_branch segb_100886
fl_100892:
flb_100900:
buffer_load_dwordx4 v[24:27],v0,s[20:23],s92 offen offset:2048 sc1
s_mov_b32 s55,4
buffer_load_dwordx4 v[40:43],v0,s[20:23],s93 offen offset:2048 sc1
buffer_load_dwordx4 v[44:47],v0,s[20:23],s93 offen offset:3072 sc1
s_waitcnt vmcnt(7)
v_max3_u32 v124,v28,v29,v30
v_max_u32 v124,v124,v31
v_cmp_eq_u32 vcc,-1,v124
s_cbranch_vccnz dfl_101101
v_smfmac_f32_16x16x64_bf16 v[64:67],v[28:31],a[224:231],v1
buffer_load_dword v125,off,s[20:23],s92 sc1
buffer_store_dword v126,v121,s[20:23],s69 offen sc1
s_waitcnt vmcnt(4)
v_max3_u32 v124,v24,v25,v26
v_smfmac_f32_16x16x64_bf16 v[68:71],v[28:31],a[232:239],v1
v_max_u32 v124,v124,v27
v_cmp_eq_u32 vcc,-1,v124
v_smfmac_f32_16x16x64_bf16 v[72:75],v[28:31],a[240:247],v1
v_smfmac_f32_16x16x64_bf16 v[76:79],v[28:31],a[248:255],v1
s_cbranch_vccnz lfb_101106
s_mov_b32 s55,0
v_smfmac_f32_16x16x64_bf16 v[64:67],v[24:27],a[160:167],v1
s_waitcnt vmcnt(7)
v_max3_u32 v124,v32,v33,v34
v_max_u32 v124,v124,v35
v_cmp_eq_u32 vcc,-1,v124
v_smfmac_f32_16x16x64_bf16 v[68:71],v[24:27],a[168:175],v1
v_smfmac_f32_16x16x64_bf16 v[72:75],v[24:27],a[176:183],v1
v_smfmac_f32_16x16x64_bf16 v[76:79],v[24:27],a[184:191],v1
s_cbranch_vccnz flb_100902
s_branch segb_100886
fl_100893:
flb_100901:
buffer_load_dwordx4 v[28:31],v0,s[20:23],s92 offen offset:3072 sc1
s_mov_b32 s55,8
buffer_store_dword v126,v121,s[20:23],s69 offen sc1
s_waitcnt vmcnt(1)
v_max3_u32 v124,v28,v29,v30
v_max_u32 v124,v124,v31
v_cmp_eq_u32 vcc,-1,v124
s_cbranch_vccnz lfb_101106
s_mov_b32 s55,0
v_smfmac_f32_16x16x64_bf16 v[64:67],v[28:31],a[224:231],v1
s_waitcnt vmcnt(7)
v_max3_u32 v124,v32,v33,v34
v_max_u32 v124,v124,v35
v_cmp_eq_u32 vcc,-1,v124
v_smfmac_f32_16x16x64_bf16 v[68:71],v[28:31],a[232:239],v1
v_smfmac_f32_16x16x64_bf16 v[72:75],v[28:31],a[240:247],v1
v_smfmac_f32_16x16x64_bf16 v[76:79],v[28:31],a[248:255],v1
s_cbranch_vccnz flb_100902
s_branch segb_100886
fl_100894:
flb_100902:
buffer_load_dwordx4 v[32:35],v0,s[20:23],s93 offen offset:0 sc1
s_mov_b32 s55,240
s_bitcmp1_b32 s55,5
s_cbranch_scc0 rdn_101109
s_waitcnt vmcnt(6)
v_max3_u32 v124,v36,v37,v38
v_max_u32 v124,v124,v39
v_cmp_eq_u32 vcc,-1,v124
s_cbranch_vccnz rfa_101110
buffer_load_dword v125,off,s[20:23],s92 sc1
s_bitset0_b32 s55,5
v_smfmac_f32_16x16x64_bf16 v[64:67],v[36:39],a[96:103],v1
v_smfmac_f32_16x16x64_bf16 v[68:71],v[36:39],a[104:111],v1
v_smfmac_f32_16x16x64_bf16 v[72:75],v[36:39],a[112:119],v1
v_smfmac_f32_16x16x64_bf16 v[76:79],v[36:39],a[120:127],v1
s_cmp_eq_u32 s55,0
s_cbranch_scc1 segb_100888
s_branch rnx_101111
rdn_101109:
buffer_load_dword v125,off,s[20:23],s92 sc1
s_branch rnx_101111
rfa_101110:
buffer_load_dwordx4 v[36:39],v0,s[20:23],s93 offen offset:1024 sc1
rnx_101111:
s_bitcmp1_b32 s55,6
s_cbranch_scc0 rdn_101112
s_waitcnt vmcnt(5)
v_max3_u32 v124,v40,v41,v42
v_max_u32 v124,v124,v43
v_cmp_eq_u32 vcc,-1,v124
s_cbranch_vccnz rfa_101113
buffer_load_dword v125,off,s[20:23],s92 sc1
s_bitset0_b32 s55,6
s_cmp_eq_u32 s55,0
s_cbranch_scc1 segb_100888
s_branch rnx_101114
rdn_101112:
buffer_load_dword v125,off,s[20:23],s92 sc1
s_branch rnx_101114
rfa_101113:
buffer_load_dwordx4 v[40:43],v0,s[20:23],s93 offen offset:2048 sc1
rnx_101114:
s_bitcmp1_b32 s55,7
s_cbranch_scc0 rdn_101115
s_waitcnt vmcnt(5)
v_max3_u32 v124,v44,v45,v46
v_max_u32 v124,v124,v47
v_cmp_eq_u32 vcc,-1,v124
s_cbranch_vccnz rfa_101116
buffer_load_dword v125,off,s[20:23],s92 sc1
s_bitset0_b32 s55,7
s_cmp_eq_u32 s55,0
s_cbranch_scc1 segb_100888
s_branch rnx_101117
rdn_101115:
buffer_load_dword v125,off,s[20:23],s92 sc1
s_branch rnx_101117
rfa_101116:
buffer_load_dwordx4 v[44:47],v0,s[20:23],s93 offen offset:3072 sc1
rnx_101117:
rot_101108:
s_bitcmp1_b32 s55,4
s_cbranch_scc0 rdn_101118
s_waitcnt vmcnt(3)
v_max3_u32 v124,v32,v33,v34
v_max_u32 v124,v124,v35
v_cmp_eq_u32 vcc,-1,v124
s_cbranch_vccnz rfa_101119
buffer_load_dword v125,off,s[20:23],s92 sc1
s_bitset0_b32 s55,4
v_smfmac_f32_16x16x64_bf16 v[64:67],v[32:35],a[32:39],v1
v_smfmac_f32_16x16x64_bf16 v[68:71],v[32:35],a[40:47],v1
v_smfmac_f32_16x16x64_bf16 v[72:75],v[32:35],a[48:55],v1
v_smfmac_f32_16x16x64_bf16 v[76:79],v[32:35],a[56:63],v1
s_cmp_eq_u32 s55,0
s_cbranch_scc1 segb_100888
s_branch rnx_101120
rdn_101118:
buffer_load_dword v125,off,s[20:23],s92 sc1
s_branch rnx_101120
rfa_101119:
buffer_load_dwordx4 v[32:35],v0,s[20:23],s93 offen offset:0 sc1
rnx_101120:
s_bitcmp1_b32 s55,5
s_cbranch_scc0 rdn_101121
s_waitcnt vmcnt(3)
v_max3_u32 v124,v36,v37,v38
v_max_u32 v124,v124,v39
v_cmp_eq_u32 vcc,-1,v124
s_cbranch_vccnz rfa_101122
buffer_load_dword v125,off,s[20:23],s92 sc1
s_bitset0_b32 s55,5
v_smfmac_f32_16x16x64_bf16 v[64:67],v[36:39],a[96:103],v1
v_smfmac_f32_16x16x64_bf16 v[68:71],v[36:39],a[104:111],v1
v_smfmac_f32_16x16x64_bf16 v[72:75],v[36:39],a[112:119],v1
v_smfmac_f32_16x16x64_bf16 v[76:79],v[36:39],a[120:127],v1
s_cmp_eq_u32 s55,0
s_cbranch_scc1 segb_100888
s_branch rnx_101123
rdn_101121:
buffer_load_dword v125,off,s[20:23],s92 sc1
s_branch rnx_101123
rfa_101122:
buffer_load_dwordx4 v[36:39],v0,s[20:23],s93 offen offset:1024 sc1
rnx_101123:
s_bitcmp1_b32 s55,6
s_cbranch_scc0 rdn_101124
s_waitcnt vmcnt(3)
v_max3_u32 v124,v40,v41,v42
v_max_u32 v124,v124,v43
v_cmp_eq_u32 vcc,-1,v124
s_cbranch_vccnz rfa_101125
buffer_load_dword v125,off,s[20:23],s92 sc1
s_bitset0_b32 s55,6
s_cmp_eq_u32 s55,0
s_cbranch_scc1 segb_100888
s_branch rnx_101126
rdn_101124:
buffer_load_dword v125,off,s[20:23],s92 sc1
s_branch rnx_101126
rfa_101125:
buffer_load_dwordx4 v[40:43],v0,s[20:23],s93 offen offset:2048 sc1
rnx_101126:
s_bitcmp1_b32 s55,7
s_cbranch_scc0 rdn_101127
s_waitcnt vmcnt(3)
v_max3_u32 v124,v44,v45,v46
v_max_u32 v124,v124,v47
v_cmp_eq_u32 vcc,-1,v124
s_cbranch_vccnz rfa_101128
buffer_load_dword v125,off,s[20:23],s92 sc1
s_bitset0_b32 s55,7
s_cmp_eq_u32 s55,0
s_cbranch_scc1 segb_100888
s_branch rnx_101129
rdn_101127:
buffer_load_dword v125,off,s[20:23],s92 sc1
s_branch rnx_101129
rfa_101128:
buffer_load_dwordx4 v[44:47],v0,s[20:23],s93 offen offset:3072 sc1
rnx_101129:
s_sub_u32 s90,s90,1
s_cmp_gt_i32 s90,0
s_cbranch_scc1 rot_101108
s_mov_b32 s55,0
s_branch segb_100888
fl_100895:
flb_100903:
buffer_load_dwordx4 v[36:39],v0,s[20:23],s93 offen offset:1024 sc1
s_mov_b32 s55,224
s_bitcmp1_b32 s55,6
s_cbranch_scc0 rdn_101131
s_waitcnt vmcnt(5)
v_max3_u32 v124,v40,v41,v42
v_max_u32 v124,v124,v43
v_cmp_eq_u32 vcc,-1,v124
s_cbranch_vccnz rfa_101132
buffer_load_dword v125,off,s[20:23],s92 sc1
s_bitset0_b32 s55,6
s_cmp_eq_u32 s55,0
s_cbranch_scc1 segb_100888
s_branch rnx_101133
rdn_101131:
buffer_load_dword v125,off,s[20:23],s92 sc1
s_branch rnx_101133
rfa_101132:
buffer_load_dwordx4 v[40:43],v0,s[20:23],s93 offen offset:2048 sc1
rnx_101133:
s_bitcmp1_b32 s55,7
s_cbranch_scc0 rdn_101134
s_waitcnt vmcnt(5)
v_max3_u32 v124,v44,v45,v46
v_max_u32 v124,v124,v47
v_cmp_eq_u32 vcc,-1,v124
s_cbranch_vccnz rfa_101135
buffer_load_dword v125,off,s[20:23],s92 sc1
s_bitset0_b32 s55,7
s_cmp_eq_u32 s55,0
s_cbranch_scc1 segb_100888
s_branch rnx_101136
rdn_101134:
buffer_load_dword v125,off,s[20:23],s92 sc1
s_branch rnx_101136
rfa_101135:
buffer_load_dwordx4 v[44:47],v0,s[20:23],s93 offen offset:3072 sc1
rnx_101136:
rot_101130:
s_bitcmp1_b32 s55,5
s_cbranch_scc0 rdn_101137
s_waitcnt vmcnt(2)
v_max3_u32 v124,v36,v37,v38
v_max_u32 v124,v124,v39
v_cmp_eq_u32 vcc,-1,v124
s_cbranch_vccnz rfa_101138
buffer_load_dword v125,off,s[20:23],s92 sc1
s_bitset0_b32 s55,5
v_smfmac_f32_16x16x64_bf16 v[64:67],v[36:39],a[96:103],v1
v_smfmac_f32_16x16x64_bf16 v[68:71],v[36:39],a[104:111],v1
v_smfmac_f32_16x16x64_bf16 v[72:75],v[36:39],a[112:119],v1
v_smfmac_f32_16x16x64_bf16 v[76:79],v[36:39],a[120:127],v1
s_cmp_eq_u32 s55,0
s_cbranch_scc1 segb_100888
s_branch rnx_101139
rdn_101137:
buffer_load_dword v125,off,s[20:23],s92 sc1
s_branch rnx_101139
rfa_101138:
buffer_load_dwordx4 v[36:39],v0,s[20:23],s93 offen offset:1024 sc1
rnx_101139:
s_bitcmp1_b32 s55,6
s_cbranch_scc0 rdn_101140
s_waitcnt vmcnt(2)
v_max3_u32 v124,v40,v41,v42
v_max_u32 v124,v124,v43
v_cmp_eq_u32 vcc,-1,v124
s_cbranch_vccnz rfa_101141
buffer_load_dword v125,off,s[20:23],s92 sc1
s_bitset0_b32 s55,6
s_cmp_eq_u32 s55,0
s_cbranch_scc1 segb_100888
s_branch rnx_101142
rdn_101140:
buffer_load_dword v125,off,s[20:23],s92 sc1
s_branch rnx_101142
rfa_101141:
buffer_load_dwordx4 v[40:43],v0,s[20:23],s93 offen offset:2048 sc1
rnx_101142:
s_bitcmp1_b32 s55,7
s_cbranch_scc0 rdn_101143
s_waitcnt vmcnt(2)
v_max3_u32 v124,v44,v45,v46
v_max_u32 v124,v124,v47
v_cmp_eq_u32 vcc,-1,v124
s_cbranch_vccnz rfa_101144
buffer_load_dword v125,off,s[20:23],s92 sc1
s_bitset0_b32 s55,7
s_cmp_eq_u32 s55,0
s_cbranch_scc1 segb_100888
s_branch rnx_101145
rdn_101143:
buffer_load_dword v125,off,s[20:23],s92 sc1
s_branch rnx_101145
rfa_101144:
buffer_load_dwordx4 v[44:47],v0,s[20:23],s93 offen offset:3072 sc1
rnx_101145:
s_sub_u32 s90,s90,1
s_cmp_gt_i32 s90,0
s_cbranch_scc1 rot_101130
s_mov_b32 s55,0
s_branch segb_100888
fl_100896:
flb_100904:
s_mov_b32 s55,192
s_bitcmp1_b32 s55,6
s_cbranch_scc0 rdn_101147
s_waitcnt vmcnt(5)
v_max3_u32 v124,v40,v41,v42
v_max_u32 v124,v124,v43
v_cmp_eq_u32 vcc,-1,v124
s_cbranch_vccnz rfa_101148
buffer_load_dword v125,off,s[20:23],s92 sc1
s_bitset0_b32 s55,6
s_cmp_eq_u32 s55,0
s_cbranch_scc1 segb_100888
s_branch rnx_101149
rdn_101147:
buffer_load_dword v125,off,s[20:23],s92 sc1
s_branch rnx_101149
rfa_101148:
buffer_load_dwordx4 v[40:43],v0,s[20:23],s93 offen offset:2048 sc1
rnx_101149:
s_bitcmp1_b32 s55,7
s_cbranch_scc0 rdn_101150
s_waitcnt vmcnt(5)
v_max3_u32 v124,v44,v45,v46
v_max_u32 v124,v124,v47
v_cmp_eq_u32 vcc,-1,v124
s_cbranch_vccnz rfa_101151
buffer_load_dword v125,off,s[20:23],s92 sc1
s_bitset0_b32 s55,7
s_cmp_eq_u32 s55,0
s_cbranch_scc1 segb_100888
s_branch rnx_101152
rdn_101150:
buffer_load_dword v125,off,s[20:23],s92 sc1
s_branch rnx_101152
rfa_101151:
buffer_load_dwordx4 v[44:47],v0,s[20:23],s93 offen offset:3072 sc1
rnx_101152:
rot_101146:
s_bitcmp1_b32 s55,6
s_cbranch_scc0 rdn_101153
s_waitcnt vmcnt(1)
v_max3_u32 v124,v40,v41,v42
v_max_u32 v124,v124,v43
v_cmp_eq_u32 vcc,-1,v124
s_cbranch_vccnz rfa_101154
buffer_load_dword v125,off,s[20:23],s92 sc1
s_bitset0_b32 s55,6
s_cmp_eq_u32 s55,0
s_cbranch_scc1 segb_100888
s_branch rnx_101155
rdn_101153:
buffer_load_dword v125,off,s[20:23],s92 sc1
s_branch rnx_101155
rfa_101154:
buffer_load_dwordx4 v[40:43],v0,s[20:23],s93 offen offset:2048 sc1
rnx_101155:
s_bitcmp1_b32 s55,7
s_cbranch_scc0 rdn_101156
s_waitcnt vmcnt(1)
v_max3_u32 v124,v44,v45,v46
v_max_u32 v124,v124,v47
v_cmp_eq_u32 vcc,-1,v124
s_cbranch_vccnz rfa_101157
buffer_load_dword v125,off,s[20:23],s92 sc1
s_bitset0_b32 s55,7
s_cmp_eq_u32 s55,0
s_cbranch_scc1 segb_100888
s_branch rnx_101158
rdn_101156:
buffer_load_dword v125,off,s[20:23],s92 sc1
s_branch rnx_101158
rfa_101157:
buffer_load_dwordx4 v[44:47],v0,s[20:23],s93 offen offset:3072 sc1
rnx_101158:
s_sub_u32 s90,s90,1
s_cmp_gt_i32 s90,0
s_cbranch_scc1 rot_101146
s_mov_b32 s55,0
s_branch segb_100888
dfl_101099:
buffer_load_dwordx4 v[20:23],v0,s[20:23],s92 offen offset:1024 sc1
s_bitset1_b32 s55,1
buffer_load_dwordx4 v[36:39],v0,s[20:23],s93 offen offset:1024 sc1
s_waitcnt vmcnt(5)
v_max3_u32 v124,v24,v25,v26
v_max_u32 v124,v124,v27
v_cmp_eq_u32 vcc,-1,v124
s_cbranch_vccnz dfl_101100
s_branch dseg_101103
dfl_101100:
buffer_load_dwordx4 v[24:27],v0,s[20:23],s92 offen offset:2048 sc1
s_bitset1_b32 s55,2
buffer_load_dwordx4 v[40:43],v0,s[20:23],s93 offen offset:2048 sc1
buffer_load_dwordx4 v[44:47],v0,s[20:23],s93 offen offset:3072 sc1
s_waitcnt vmcnt(7)
v_max3_u32 v124,v28,v29,v30
v_max_u32 v124,v124,v31
v_cmp_eq_u32 vcc,-1,v124
s_cbranch_vccnz dfl_101101
s_branch dseg_101104
dfl_101101:
buffer_load_dwordx4 v[28:31],v0,s[20:23],s92 offen offset:3072 sc1
s_bitset1_b32 s55,3
buffer_store_dword v126,v121,s[20:23],s69 offen sc1
s_branch lap2_101105
dseg_101103:
v_smfmac_f32_16x16x64_bf16 v[64:67],v[24:27],a[160:167],v1
buffer_load_dword v125,off,s[20:23],s92 sc1
buffer_load_dwordx4 v[40:43],v0,s[20:23],s93 offen offset:2048 sc1
buffer_load_dwordx4 v[44:47],v0,s[20:23],s93 offen offset:3072 sc1
s_waitcnt vmcnt(7)
v_max3_u32 v124,v28,v29,v30
v_smfmac_f32_16x16x64_bf16 v[68:71],v[24:27],a[168:175],v1
v_max_u32 v124,v124,v31
v_cmp_eq_u32 vcc,-1,v124
v_smfmac_f32_16x16x64_bf16 v[72:75],v[24:27],a[176:183],v1
v_smfmac_f32_16x16x64_bf16 v[76:79],v[24:27],a[184:191],v1
s_cbranch_vccnz dfl_101101
dseg_101104:
v_smfmac_f32_16x16x64_bf16 v[64:67],v[28:31],a[224:231],v1
buffer_load_dword v125,off,s[20:23],s92 sc1
v_smfmac_f32_16x16x64_bf16 v[68:71],v[28:31],a[232:239],v1
buffer_store_dword v126,v121,s[20:23],s69 offen sc1
v_smfmac_f32_16x16x64_bf16 v[72:75],v[28:31],a[240:247],v1
v_smfmac_f32_16x16x64_bf16 v[76:79],v[28:31],a[248:255],v1
lap2_101105:
s_bitcmp1_b32 s55,0
s_cbranch_scc0 l2s_101159
s_waitcnt vmcnt(8)
v_max3_u32 v124,v16,v17,v18
v_max_u32 v124,v124,v19
v_cmp_eq_u32 vcc,-1,v124
s_cbranch_vccnz l2s_101159
s_bitset0_b32 s55,0
v_smfmac_f32_16x16x64_bf16 v[64:67],v[16:19],a[32:39],v1
v_smfmac_f32_16x16x64_bf16 v[68:71],v[16:19],a[40:47],v1
v_smfmac_f32_16x16x64_bf16 v[72:75],v[16:19],a[48:55],v1
v_smfmac_f32_16x16x64_bf16 v[76:79],v[16:19],a[56:63],v1
l2s_101159:
s_bitcmp1_b32 s55,1
s_cbranch_scc0 l2s_101161
s_waitcnt vmcnt(6)
v_max3_u32 v124,v20,v21,v22
v_max_u32 v124,v124,v23
v_cmp_eq_u32 vcc,-1,v124
s_cbranch_vccnz l2s_101161
s_bitset0_b32 s55,1
v_smfmac_f32_16x16x64_bf16 v[64:67],v[20:23],a[96:103],v1
v_smfmac_f32_16x16x64_bf16 v[68:71],v[20:23],a[104:111],v1
v_smfmac_f32_16x16x64_bf16 v[72:75],v[20:23],a[112:119],v1
v_smfmac_f32_16x16x64_bf16 v[76:79],v[20:23],a[120:127],v1
l2s_101161:
s_bitcmp1_b32 s55,2
s_cbranch_scc0 l2s_101163
s_waitcnt vmcnt(4)
v_max3_u32 v124,v24,v25,v26
v_max_u32 v124,v124,v27
v_cmp_eq_u32 vcc,-1,v124
s_cbranch_vccnz l2s_101163
s_bitset0_b32 s55,2
v_smfmac_f32_16x16x64_bf16 v[64:67],v[24:27],a[160:167],v1
v_smfmac_f32_16x16x64_bf16 v[68:71],v[24:27],a[168:175],v1
v_smfmac_f32_16x16x64_bf16 v[72:75],v[24:27],a[176:183],v1
v_smfmac_f32_16x16x64_bf16 v[76:79],v[24:27],a[184:191],v1
l2s_101163:
s_bitcmp1_b32 s55,3
s_cbranch_scc0 l2s_101165
s_waitcnt vmcnt(1)
v_max3_u32 v124,v28,v29,v30
v_max_u32 v124,v124,v31
v_cmp_eq_u32 vcc,-1,v124
s_cbranch_vccnz l2s_101165
s_bitset0_b32 s55,3
v_smfmac_f32_16x16x64_bf16 v[64:67],v[28:31],a[224:231],v1
v_smfmac_f32_16x16x64_bf16 v[68:71],v[28:31],a[232:239],v1
v_smfmac_f32_16x16x64_bf16 v[72:75],v[28:31],a[240:247],v1
v_smfmac_f32_16x16x64_bf16 v[76:79],v[28:31],a[248:255],v1
l2s_101165:
s_cmp_eq_u32 s55,0
s_cbranch_scc0 lfb_101106
Ldone_101107:
s_waitcnt vmcnt(7)
v_max3_u32 v124,v32,v33,v34
v_max_u32 v124,v124,v35
v_cmp_eq_u32 vcc,-1,v124
s_cbranch_vccnz flb_100902
s_branch segb_100886
lfb_101106:
s_bitcmp1_b32 s55,0
s_cbranch_scc0 dsk_101167
buffer_load_dwordx4 v[16:19],v0,s[20:23],s92 offen offset:0 sc1
dsk_101167:
s_bitcmp1_b32 s55,1
s_cbranch_scc0 dsk_101168
buffer_load_dwordx4 v[20:23],v0,s[20:23],s92 offen offset:1024 sc1
dsk_101168:
s_bitcmp1_b32 s55,2
s_cbranch_scc0 dsk_101169
buffer_load_dwordx4 v[24:27],v0,s[20:23],s92 offen offset:2048 sc1
dsk_101169:
s_bitcmp1_b32 s55,3
s_cbranch_scc0 dsk_101170
buffer_load_dwordx4 v[28:31],v0,s[20:23],s92 offen offset:3072 sc1
dsk_101170:
s_bitcmp1_b32 s55,0
s_cbranch_scc0 dsk_101171
s_waitcnt vmcnt(2)
v_max3_u32 v124,v16,v17,v18
v_max_u32 v124,v124,v19
v_cmp_eq_u32 vcc,-1,v124
s_cbranch_vccz dgo_101172
s_nop 15
buffer_load_dwordx4 v[104:107],v0,s[20:23],s92 offen offset:0 sc1
s_nop 15
buffer_load_dwordx4 v[108:111],v0,s[20:23],s92 offen offset:0 sc1
dlp_101173:
s_waitcnt vmcnt(2)
v_max3_u32 v124,v16,v17,v18
v_max_u32 v124,v124,v19
v_cmp_eq_u32 vcc,-1,v124
s_cbranch_vccz dgo_101172
buffer_load_dwordx4 v[16:19],v0,s[20:23],s92 offen offset:0 sc1
s_waitcnt vmcnt(2)
v_max3_u32 v124,v104,v105,v106
v_max_u32 v124,v124,v107
v_cmp_eq_u32 vcc,-1,v124
s_cbranch_vccz dcp_101175
buffer_load_dwordx4 v[104:107],v0,s[20:23],s92 offen offset:0 sc1
s_waitcnt vmcnt(2)
v_max3_u32 v124,v108,v109,v110
v_max_u32 v124,v124,v111
v_cmp_eq_u32 vcc,-1,v124
s_cbranch_vccz dcp_101176
buffer_load_dwordx4 v[108:111],v0,s[20:23],s92 offen offset:0 sc1
s_sub_u32 s90,s90,1
s_cmp_gt_i32 s90,0
s_cbranch_scc1 dlp_101173
s_branch dgo_101172
dcp_101175:
v_mov_b32 v16,v104
v_mov_b32 v17,v105
v_mov_b32 v18,v106
v_mov_b32 v19,v107
s_nop 1
s_branch dgo_101172
dcp_101176:
v_mov_b32 v16,v108
v_mov_b32 v17,v109
v_mov_b32 v18,v110
v_mov_b32 v19,v111
s_nop 1
dgo_101172:
v_smfmac_f32_16x16x64_bf16 v[64:67],v[16:19],a[32:39],v1
v_smfmac_f32_16x16x64_bf16 v[68:71],v[16:19],a[40:47],v1
v_smfmac_f32_16x16x64_bf16 v[72:75],v[16:19],a[48:55],v1
v_smfmac_f32_16x16x64_bf16 v[76:79],v[16:19],a[56:63],v1
dsk_101171:
s_bitcmp1_b32 s55,1
s_cbranch_scc0 dsk_101177
s_waitcnt vmcnt(2)
v_max3_u32 v124,v20,v21,v22
v_max_u32 v124,v124,v23
v_cmp_eq_u32 vcc,-1,v124
s_cbranch_vccz dgo_101178
s_nop 15
buffer_load_dwordx4 v[104:107],v0,s[20:23],s92 offen offset:1024 sc1
s_nop 15
buffer_load_dwordx4 v[108:111],v0,s[20:23],s92 offen offset:1024 sc1
dlp_101179:
s_waitcnt vmcnt(2)
v_max3_u32 v124,v20,v21,v22
v_max_u32 v124,v124,v23
v_cmp_eq_u32 vcc,-1,v124
s_cbranch_vccz dgo_101178
buffer_load_dwordx4 v[20:23],v0,s[20:23],s92 offen offset:1024 sc1
s_waitcnt vmcnt(2)
v_max3_u32 v124,v104,v105,v106
v_max_u32 v124,v124,v107
v_cmp_eq_u32 vcc,-1,v124
s_cbranch_vccz dcp_101181
buffer_load_dwordx4 v[104:107],v0,s[20:23],s92 offen offset:1024 sc1
s_waitcnt vmcnt(2)
v_max3_u32 v124,v108,v109,v110
v_max_u32 v124,v124,v111
v_cmp_eq_u32 vcc,-1,v124
s_cbranch_vccz dcp_101182
buffer_load_dwordx4 v[108:111],v0,s[20:23],s92 offen offset:1024 sc1
s_sub_u32 s90,s90,1
s_cmp_gt_i32 s90,0
s_cbranch_scc1 dlp_101179
s_branch dgo_101178
dcp_101181:
v_mov_b32 v20,v104
v_mov_b32 v21,v105
v_mov_b32 v22,v106
v_mov_b32 v23,v107
s_nop 1
s_branch dgo_101178
dcp_101182:
v_mov_b32 v20,v108
v_mov_b32 v21,v109
v_mov_b32 v22,v110
v_mov_b32 v23,v111
s_nop 1
dgo_101178:
v_smfmac_f32_16x16x64_bf16 v[64:67],v[20:23],a[96:103],v1
v_smfmac_f32_16x16x64_bf16 v[68:71],v[20:23],a[104:111],v1
v_smfmac_f32_16x16x64_bf16 v[72:75],v[20:23],a[112:119],v1
v_smfmac_f32_16x16x64_bf16 v[76:79],v[20:23],a[120:127],v1
dsk_101177:
s_bitcmp1_b32 s55,2
s_cbranch_scc0 dsk_101183
s_waitcnt vmcnt(2)
v_max3_u32 v124,v24,v25,v26
v_max_u32 v124,v124,v27
v_cmp_eq_u32 vcc,-1,v124
s_cbranch_vccz dgo_101184
s_nop 15
buffer_load_dwordx4 v[104:107],v0,s[20:23],s92 offen offset:2048 sc1
s_nop 15
buffer_load_dwordx4 v[108:111],v0,s[20:23],s92 offen offset:2048 sc1
dlp_101185:
s_waitcnt vmcnt(2)
v_max3_u32 v124,v24,v25,v26
v_max_u32 v124,v124,v27
v_cmp_eq_u32 vcc,-1,v124
s_cbranch_vccz dgo_101184
buffer_load_dwordx4 v[24:27],v0,s[20:23],s92 offen offset:2048 sc1
s_waitcnt vmcnt(2)
v_max3_u32 v124,v104,v105,v106
v_max_u32 v124,v124,v107
v_cmp_eq_u32 vcc,-1,v124
s_cbranch_vccz dcp_101187
buffer_load_dwordx4 v[104:107],v0,s[20:23],s92 offen offset:2048 sc1
s_waitcnt vmcnt(2)
v_max3_u32 v124,v108,v109,v110
v_max_u32 v124,v124,v111
v_cmp_eq_u32 vcc,-1,v124
s_cbranch_vccz dcp_101188
buffer_load_dwordx4 v[108:111],v0,s[20:23],s92 offen offset:2048 sc1
s_sub_u32 s90,s90,1
s_cmp_gt_i32 s90,0
s_cbranch_scc1 dlp_101185
s_branch dgo_101184
dcp_101187:
v_mov_b32 v24,v104
v_mov_b32 v25,v105
v_mov_b32 v26,v106
v_mov_b32 v27,v107
s_nop 1
s_branch dgo_101184
dcp_101188:
v_mov_b32 v24,v108
v_mov_b32 v25,v109
v_mov_b32 v26,v110
v_mov_b32 v27,v111
s_nop 1
dgo_101184:
v_smfmac_f32_16x16x64_bf16 v[64:67],v[24:27],a[160:167],v1
v_smfmac_f32_16x16x64_bf16 v[68:71],v[24:27],a[168:175],v1
v_smfmac_f32_16x16x64_bf16 v[72:75],v[24:27],a[176:183],v1
v_smfmac_f32_16x16x64_bf16 v[76:79],v[24:27],a[184:191],v1
dsk_101183:
s_bitcmp1_b32 s55,3
s_cbranch_scc0 dsk_101189
s_waitcnt vmcnt(2)
v_max3_u32 v124,v28,v29,v30
v_max_u32 v124,v124,v31
v_cmp_eq_u32 vcc,-1,v124
s_cbranch_vccz dgo_101190
s_nop 15
buffer_load_dwordx4 v[104:107],v0,s[20:23],s92 offen offset:3072 sc1
s_nop 15
buffer_load_dwordx4 v[108:111],v0,s[20:23],s92 offen offset:3072 sc1
dlp_101191:
s_waitcnt vmcnt(2)
v_max3_u32 v124,v28,v29,v30
v_max_u32 v124,v124,v31
v_cmp_eq_u32 vcc,-1,v124
s_cbranch_vccz dgo_101190
buffer_load_dwordx4 v[28:31],v0,s[20:23],s92 offen offset:3072 sc1
s_waitcnt vmcnt(2)
v_max3_u32 v124,v104,v105,v106
v_max_u32 v124,v124,v107
v_cmp_eq_u32 vcc,-1,v124
s_cbranch_vccz dcp_101193
buffer_load_dwordx4 v[104:107],v0,s[20:23],s92 offen offset:3072 sc1
s_waitcnt vmcnt(2)
v_max3_u32 v124,v108,v109,v110
v_max_u32 v124,v124,v111
v_cmp_eq_u32 vcc,-1,v124
s_cbranch_vccz dcp_101194
buffer_load_dwordx4 v[108:111],v0,s[20:23],s92 offen offset:3072 sc1
s_sub_u32 s90,s90,1
s_cmp_gt_i32 s90,0
s_cbranch_scc1 dlp_101191
s_branch dgo_101190
dcp_101193:
v_mov_b32 v28,v104
v_mov_b32 v29,v105
v_mov_b32 v30,v106
v_mov_b32 v31,v107
s_nop 1
s_branch dgo_101190
dcp_101194:
v_mov_b32 v28,v108
v_mov_b32 v29,v109
v_mov_b32 v30,v110
v_mov_b32 v31,v111
s_nop 1
dgo_101190:
v_smfmac_f32_16x16x64_bf16 v[64:67],v[28:31],a[224:231],v1
v_smfmac_f32_16x16x64_bf16 v[68:71],v[28:31],a[232:239],v1
v_smfmac_f32_16x16x64_bf16 v[72:75],v[28:31],a[240:247],v1
v_smfmac_f32_16x16x64_bf16 v[76:79],v[28:31],a[248:255],v1
dsk_101189:
s_mov_b32 s55,0
s_branch Ldone_101107
slowA_100906:
buffer_load_dwordx4 v[44:47],v0,s[20:23],s93 offen offset:3072 sc1
dsk_101195:
s_bitcmp1_b32 s55,7
s_cbranch_scc0 dsk_101196
s_waitcnt vmcnt(2)
v_max3_u32 v124,v44,v45,v46
v_max_u32 v124,v124,v47
v_cmp_eq_u32 vcc,-1,v124
s_cbranch_vccz dgo_101197
s_nop 15
s_nop 3
buffer_load_dwordx4 v[104:107],v0,s[20:23],s93 offen offset:3072 sc1
s_nop 15
s_nop 3
buffer_load_dwordx4 v[108:111],v0,s[20:23],s93 offen offset:3072 sc1
dlp_101198:
s_waitcnt vmcnt(2)
v_max3_u32 v124,v44,v45,v46
v_max_u32 v124,v124,v47
v_cmp_eq_u32 vcc,-1,v124
s_cbranch_vccz dgo_101197
buffer_load_dwordx4 v[44:47],v0,s[20:23],s93 offen offset:3072 sc1
s_waitcnt vmcnt(2)
v_max3_u32 v124,v104,v105,v106
v_max_u32 v124,v124,v107
v_cmp_eq_u32 vcc,-1,v124
s_cbranch_vccz dcp_101200
buffer_load_dwordx4 v[104:107],v0,s[20:23],s93 offen offset:3072 sc1
s_waitcnt vmcnt(2)
v_max3_u32 v124,v108,v109,v110
v_max_u32 v124,v124,v111
v_cmp_eq_u32 vcc,-1,v124
s_cbranch_vccz dcp_101201
buffer_load_dwordx4 v[108:111],v0,s[20:23],s93 offen offset:3072 sc1
s_sub_u32 s90,s90,1
s_cmp_gt_i32 s90,0
s_cbranch_scc1 dlp_101198
s_branch dgo_101197
dcp_101200:
v_mov_b32 v44,v104
v_mov_b32 v45,v105
v_mov_b32 v46,v106
v_mov_b32 v47,v107
s_nop 1
s_branch dgo_101197
dcp_101201:
v_mov_b32 v44,v108
v_mov_b32 v45,v109
v_mov_b32 v46,v110
v_mov_b32 v47,v111
s_nop 1
dgo_101197:
dsk_101196:
s_mov_b32 s55,0
s_branch segb_100888
recfin_100413:
s_endpgm
.section .rodata,"a"
.p2align 6
.amdhsa_kernel flow_kernel
  .amdhsa_next_free_vgpr 512
  .amdhsa_next_free_sgpr 102
  .amdhsa_accum_offset 256
  .amdhsa_group_segment_fixed_size 0
  .amdhsa_kernarg_size 136
  .amdhsa_user_sgpr_count 2
  .amdhsa_user_sgpr_kernarg_segment_ptr 1
  .amdhsa_system_sgpr_workgroup_id_x 1
.end_amdhsa_kernel
```

```asm
; @launch kernel=flow_kernel grid=(256,1,1) block=(256,1,1) lds=163840
.amdgcn_target "amdgcn-amd-amdhsa--gfx950"
.text
.globl flow_kernel
.p2align 8
.type flow_kernel,@function
flow_kernel:
s_cmp_ge_u32 s2,256
s_cbranch_scc1 done_1
s_lshr_b32 s49,s2,3
s_load_dwordx2 s[18:19],s[0:1],128
s_load_dwordx2 s[2:3],s[0:1],120
s_load_dwordx2 s[4:5],s[0:1],0
s_getreg_b32 s51,hwreg(HW_REG_XCC_ID)
v_lshrrev_b32 v2,6,v0
v_and_b32 v1,63,v0
s_and_b32 s51,s51,7
v_readfirstlane_b32 s50,v2
s_mov_b32 s90,40000
s_mov_b32 s56,2
s_mov_b32 s88,64
s_lshl_b32 s64,s51,2
s_lshr_b32 s64,0x76325410,s64
s_and_b32 s64,s64,7
s_lshl_b32 s58,s64,5
s_add_u32 s58,s58,s49
s_waitcnt lgkmcnt(0)
s_mov_b32 s20,s18
s_and_b32 s21,s19,0xffff
s_mov_b32 s22,0x10000000
s_mov_b32 s23,0x20000
s_cmp_lg_u32 s50,0
s_cbranch_scc1 fl_disp0
s_mov_b32 s92,s2
s_and_b32 s93,s3,0xffff
s_mov_b32 s94,0x100
s_mov_b32 s95,0x20000
s_lshl_b32 s64,1,s49
v_mov_b32 v2,s64
v_mov_b32 v3,0x100
s_lshl_b32 s64,s51,3
s_mov_b64 exec,1
buffer_atomic_add_x2 v[2:3],off,s[92:95],s64 sc1
s_mov_b64 exec,-1
fl_disp0:
v_mbcnt_lo_u32_b32 v1,-1,0
v_mbcnt_hi_u32_b32 v1,-1,v1
s_sub_u32 s59,s58,64
s_cbranch_scc0 nx_3
s_branch fl_rec
nx_3:
s_cmp_lt_u32 s58,128
s_cbranch_scc0 nx_4
s_branch fl_qkv
nx_4:
s_cmp_ge_u32 s58,192
s_cbranch_scc1 fl_dutb
s_load_dwordx4 s[4:7],s[0:1],96
s_load_dwordx2 s[8:9],s[0:1],0
s_sub_u32 s59,s58,128
s_and_b32 s52,s59,15
s_lshr_b32 s53,s59,4
s_lshl_b32 s64,s50,6
v_add_u32 v14,s64,v1
v_lshrrev_b32 v2,4,v14
v_and_b32 v3,15,v14
v_mul_u32_u24 v13,196608,v2
v_lshl_add_u32 v13,v3,4,v13
s_mul_i32 s54,s53,3145728
s_lshl_b32 s64,s52,8
s_add_u32 s54,s54,s64
s_add_u32 s54,s54,0
v_lshlrev_b32 v15,1,v14
s_lshl_b32 s55,s53,9
s_mov_b32 s60,0
s_mov_b32 s73,0xffff0000
s_sub_u32 s61,s58,128
s_lshl_b32 s61,s61,15
v_lshlrev_b32 v25,6,v2
v_lshlrev_b32 v24,4,v1
v_and_b32 v2,3,v1
v_lshrrev_b32 v3,2,v1
s_lshl_b32 s64,s60,2
v_add_u32 v4,s64,v2
s_lshl_b32 s65,s50,9
v_lshlrev_b32 v5,4,v3
v_add_u32 v5,s65,v5
v_lshl_add_u32 v8,v4,11,v5
v_lshlrev_b32 v9,1,v5
v_lshrrev_b32 v5,2,v3
v_and_b32 v3,3,v3
s_lshl_b32 s65,s50,13
v_lshlrev_b32 v5,10,v5
v_lshl_add_u32 v5,v3,8,v5
v_lshl_add_u32 v5,v4,4,v5
v_add_u32 v10,s65,v5
s_lshl_b32 s65,s50,9
v_lshlrev_b32 v5,3,v1
v_add_u32 v11,s65,v5
v_lshlrev_b32 v12,3,v2
s_waitcnt lgkmcnt(0)
s_mov_b32 s24,s4
s_and_b32 s25,s5,0xffff
s_mov_b32 s26,0x800
s_mov_b32 s27,0x20000
s_mov_b32 s28,s6
s_and_b32 s29,s7,0xffff
s_mov_b32 s30,0xc00000
s_mov_b32 s31,0x20000
s_mov_b32 s32,s8
s_and_b32 s33,s9,0xffff
s_mov_b32 s34,0x400000
s_mov_b32 s35,0x20000
v_mov_b32 v28,-1
v_mov_b32 v20,0
v_mov_b32 v29,-1
v_mov_b32 v21,0
v_mov_b32 v30,-1
v_mov_b32 v22,0
v_mov_b32 v31,-1
v_mov_b32 v23,0
buffer_load_ushort v16,v15,s[24:27],s55 offen
buffer_load_dwordx4 v[96:99],v13,s[28:31],s54 offen offset:0
s_add_u32 s54,s54,12288
buffer_load_dwordx4 v[100:103],v13,s[28:31],s54 offen offset:0
s_add_u32 s54,s54,12288
buffer_load_dwordx4 v[104:107],v13,s[28:31],s54 offen offset:0
s_add_u32 s54,s54,12288
buffer_load_dwordx4 v[108:111],v13,s[28:31],s54 offen offset:0
s_add_u32 s54,s54,12288
buffer_load_dwordx4 v[112:115],v13,s[28:31],s54 offen offset:0
s_add_u32 s54,s54,12288
buffer_load_dwordx4 v[116:119],v13,s[28:31],s54 offen offset:0
s_add_u32 s54,s54,12288
buffer_load_dwordx4 v[120:123],v13,s[28:31],s54 offen offset:0
s_add_u32 s54,s54,12288
buffer_load_dwordx4 v[124:127],v13,s[28:31],s54 offen offset:0
s_add_u32 s54,s54,12288
buffer_load_dwordx4 v[128:131],v13,s[28:31],s54 offen offset:0
s_add_u32 s54,s54,12288
buffer_load_dwordx4 v[132:135],v13,s[28:31],s54 offen offset:0
s_add_u32 s54,s54,12288
buffer_load_dwordx4 v[136:139],v13,s[28:31],s54 offen offset:0
s_add_u32 s54,s54,12288
buffer_load_dwordx4 v[140:143],v13,s[28:31],s54 offen offset:0
s_add_u32 s54,s54,12288
buffer_load_dwordx4 v[144:147],v13,s[28:31],s54 offen offset:0
s_add_u32 s54,s54,12288
buffer_load_dwordx4 v[148:151],v13,s[28:31],s54 offen offset:0
s_add_u32 s54,s54,12288
buffer_load_dwordx4 v[152:155],v13,s[28:31],s54 offen offset:0
s_add_u32 s54,s54,12288
buffer_load_dwordx4 v[156:159],v13,s[28:31],s54 offen offset:0
s_add_u32 s64,s61,0
buffer_load_dwordx4 v[48:51],v8,s[32:35],s64 offen offset:0
buffer_load_dwordx4 v[52:55],v8,s[32:35],s64 offen offset:256
s_add_u32 s64,s61,8192
buffer_load_dwordx4 v[56:59],v8,s[32:35],s64 offen offset:0
buffer_load_dwordx4 v[60:63],v8,s[32:35],s64 offen offset:256
s_add_u32 s64,s61,16384
buffer_load_dwordx4 v[64:67],v8,s[32:35],s64 offen offset:0
buffer_load_dwordx4 v[68:71],v8,s[32:35],s64 offen offset:256
s_add_u32 s64,s61,24576
buffer_load_dwordx4 v[72:75],v8,s[32:35],s64 offen offset:0
buffer_load_dwordx4 v[76:79],v8,s[32:35],s64 offen offset:256
s_waitcnt vmcnt(24)
v_lshlrev_b32 v16,16,v16
v_mul_f32 v17,0xbfb8aa3b,v16
v_exp_f32 v17,v17
s_nop 0
v_add_f32 v17,1.0,v17
v_rcp_f32 v17,v17
s_nop 0
v_mul_f32 v17,v17,v16
v_cvt_pk_bf16_f32 v17,v17,v17
v_and_b32 v17,s73,v17
v_lshlrev_b32 v18,2,v14
ds_write_b32 v18,v17 offset:8192
s_waitcnt lgkmcnt(0)
s_barrier
ds_read_b128 v[32:35],v25 offset:8192
ds_read_b128 v[36:39],v25 offset:8208
ds_read_b128 v[40:43],v25 offset:8224
ds_read_b128 v[44:47],v25 offset:8240
v_mov_b32 v80,0
v_mov_b32 v81,0
v_mov_b32 v82,0
v_mov_b32 v83,0
v_mov_b32 v84,0
v_mov_b32 v85,0
v_mov_b32 v86,0
v_mov_b32 v87,0
s_waitcnt lgkmcnt(0)
s_waitcnt vmcnt(23)
v_lshlrev_b32 v16,16,v96
v_and_b32 v17,s73,v96
v_pk_fma_f32 v[80:81],v[16:17],v[32:33],v[80:81] op_sel:[0,0,0] op_sel_hi:[1,0,1]
v_lshlrev_b32 v18,16,v97
v_and_b32 v19,s73,v97
v_pk_fma_f32 v[82:83],v[18:19],v[32:33],v[82:83] op_sel:[0,0,0] op_sel_hi:[1,0,1]
v_lshlrev_b32 v16,16,v98
v_and_b32 v17,s73,v98
v_pk_fma_f32 v[84:85],v[16:17],v[32:33],v[84:85] op_sel:[0,0,0] op_sel_hi:[1,0,1]
v_lshlrev_b32 v18,16,v99
v_and_b32 v19,s73,v99
v_pk_fma_f32 v[86:87],v[18:19],v[32:33],v[86:87] op_sel:[0,0,0] op_sel_hi:[1,0,1]
s_waitcnt vmcnt(22)
v_lshlrev_b32 v16,16,v100
v_and_b32 v17,s73,v100
v_pk_fma_f32 v[80:81],v[16:17],v[32:33],v[80:81] op_sel:[0,1,0] op_sel_hi:[1,1,1]
v_lshlrev_b32 v18,16,v101
v_and_b32 v19,s73,v101
v_pk_fma_f32 v[82:83],v[18:19],v[32:33],v[82:83] op_sel:[0,1,0] op_sel_hi:[1,1,1]
v_lshlrev_b32 v16,16,v102
v_and_b32 v17,s73,v102
v_pk_fma_f32 v[84:85],v[16:17],v[32:33],v[84:85] op_sel:[0,1,0] op_sel_hi:[1,1,1]
v_lshlrev_b32 v18,16,v103
v_and_b32 v19,s73,v103
v_pk_fma_f32 v[86:87],v[18:19],v[32:33],v[86:87] op_sel:[0,1,0] op_sel_hi:[1,1,1]
s_waitcnt vmcnt(21)
v_lshlrev_b32 v16,16,v104
v_and_b32 v17,s73,v104
v_pk_fma_f32 v[80:81],v[16:17],v[34:35],v[80:81] op_sel:[0,0,0] op_sel_hi:[1,0,1]
v_lshlrev_b32 v18,16,v105
v_and_b32 v19,s73,v105
v_pk_fma_f32 v[82:83],v[18:19],v[34:35],v[82:83] op_sel:[0,0,0] op_sel_hi:[1,0,1]
v_lshlrev_b32 v16,16,v106
v_and_b32 v17,s73,v106
v_pk_fma_f32 v[84:85],v[16:17],v[34:35],v[84:85] op_sel:[0,0,0] op_sel_hi:[1,0,1]
v_lshlrev_b32 v18,16,v107
v_and_b32 v19,s73,v107
v_pk_fma_f32 v[86:87],v[18:19],v[34:35],v[86:87] op_sel:[0,0,0] op_sel_hi:[1,0,1]
s_waitcnt vmcnt(20)
v_lshlrev_b32 v16,16,v108
v_and_b32 v17,s73,v108
v_pk_fma_f32 v[80:81],v[16:17],v[34:35],v[80:81] op_sel:[0,1,0] op_sel_hi:[1,1,1]
v_lshlrev_b32 v18,16,v109
v_and_b32 v19,s73,v109
v_pk_fma_f32 v[82:83],v[18:19],v[34:35],v[82:83] op_sel:[0,1,0] op_sel_hi:[1,1,1]
v_lshlrev_b32 v16,16,v110
v_and_b32 v17,s73,v110
v_pk_fma_f32 v[84:85],v[16:17],v[34:35],v[84:85] op_sel:[0,1,0] op_sel_hi:[1,1,1]
v_lshlrev_b32 v18,16,v111
v_and_b32 v19,s73,v111
v_pk_fma_f32 v[86:87],v[18:19],v[34:35],v[86:87] op_sel:[0,1,0] op_sel_hi:[1,1,1]
s_waitcnt vmcnt(19)
v_lshlrev_b32 v16,16,v112
v_and_b32 v17,s73,v112
v_pk_fma_f32 v[80:81],v[16:17],v[36:37],v[80:81] op_sel:[0,0,0] op_sel_hi:[1,0,1]
v_lshlrev_b32 v18,16,v113
v_and_b32 v19,s73,v113
v_pk_fma_f32 v[82:83],v[18:19],v[36:37],v[82:83] op_sel:[0,0,0] op_sel_hi:[1,0,1]
v_lshlrev_b32 v16,16,v114
v_and_b32 v17,s73,v114
v_pk_fma_f32 v[84:85],v[16:17],v[36:37],v[84:85] op_sel:[0,0,0] op_sel_hi:[1,0,1]
v_lshlrev_b32 v18,16,v115
v_and_b32 v19,s73,v115
v_pk_fma_f32 v[86:87],v[18:19],v[36:37],v[86:87] op_sel:[0,0,0] op_sel_hi:[1,0,1]
s_waitcnt vmcnt(18)
v_lshlrev_b32 v16,16,v116
v_and_b32 v17,s73,v116
v_pk_fma_f32 v[80:81],v[16:17],v[36:37],v[80:81] op_sel:[0,1,0] op_sel_hi:[1,1,1]
v_lshlrev_b32 v18,16,v117
v_and_b32 v19,s73,v117
v_pk_fma_f32 v[82:83],v[18:19],v[36:37],v[82:83] op_sel:[0,1,0] op_sel_hi:[1,1,1]
v_lshlrev_b32 v16,16,v118
v_and_b32 v17,s73,v118
v_pk_fma_f32 v[84:85],v[16:17],v[36:37],v[84:85] op_sel:[0,1,0] op_sel_hi:[1,1,1]
v_lshlrev_b32 v18,16,v119
v_and_b32 v19,s73,v119
v_pk_fma_f32 v[86:87],v[18:19],v[36:37],v[86:87] op_sel:[0,1,0] op_sel_hi:[1,1,1]
s_waitcnt vmcnt(17)
v_lshlrev_b32 v16,16,v120
v_and_b32 v17,s73,v120
v_pk_fma_f32 v[80:81],v[16:17],v[38:39],v[80:81] op_sel:[0,0,0] op_sel_hi:[1,0,1]
v_lshlrev_b32 v18,16,v121
v_and_b32 v19,s73,v121
v_pk_fma_f32 v[82:83],v[18:19],v[38:39],v[82:83] op_sel:[0,0,0] op_sel_hi:[1,0,1]
v_lshlrev_b32 v16,16,v122
v_and_b32 v17,s73,v122
v_pk_fma_f32 v[84:85],v[16:17],v[38:39],v[84:85] op_sel:[0,0,0] op_sel_hi:[1,0,1]
v_lshlrev_b32 v18,16,v123
v_and_b32 v19,s73,v123
v_pk_fma_f32 v[86:87],v[18:19],v[38:39],v[86:87] op_sel:[0,0,0] op_sel_hi:[1,0,1]
s_waitcnt vmcnt(16)
v_lshlrev_b32 v16,16,v124
v_and_b32 v17,s73,v124
v_pk_fma_f32 v[80:81],v[16:17],v[38:39],v[80:81] op_sel:[0,1,0] op_sel_hi:[1,1,1]
v_lshlrev_b32 v18,16,v125
v_and_b32 v19,s73,v125
v_pk_fma_f32 v[82:83],v[18:19],v[38:39],v[82:83] op_sel:[0,1,0] op_sel_hi:[1,1,1]
v_lshlrev_b32 v16,16,v126
v_and_b32 v17,s73,v126
v_pk_fma_f32 v[84:85],v[16:17],v[38:39],v[84:85] op_sel:[0,1,0] op_sel_hi:[1,1,1]
v_lshlrev_b32 v18,16,v127
v_and_b32 v19,s73,v127
v_pk_fma_f32 v[86:87],v[18:19],v[38:39],v[86:87] op_sel:[0,1,0] op_sel_hi:[1,1,1]
s_waitcnt vmcnt(15)
v_lshlrev_b32 v16,16,v128
v_and_b32 v17,s73,v128
v_pk_fma_f32 v[80:81],v[16:17],v[40:41],v[80:81] op_sel:[0,0,0] op_sel_hi:[1,0,1]
v_lshlrev_b32 v18,16,v129
v_and_b32 v19,s73,v129
v_pk_fma_f32 v[82:83],v[18:19],v[40:41],v[82:83] op_sel:[0,0,0] op_sel_hi:[1,0,1]
v_lshlrev_b32 v16,16,v130
v_and_b32 v17,s73,v130
v_pk_fma_f32 v[84:85],v[16:17],v[40:41],v[84:85] op_sel:[0,0,0] op_sel_hi:[1,0,1]
v_lshlrev_b32 v18,16,v131
v_and_b32 v19,s73,v131
v_pk_fma_f32 v[86:87],v[18:19],v[40:41],v[86:87] op_sel:[0,0,0] op_sel_hi:[1,0,1]
s_waitcnt vmcnt(14)
v_lshlrev_b32 v16,16,v132
v_and_b32 v17,s73,v132
v_pk_fma_f32 v[80:81],v[16:17],v[40:41],v[80:81] op_sel:[0,1,0] op_sel_hi:[1,1,1]
v_lshlrev_b32 v18,16,v133
v_and_b32 v19,s73,v133
v_pk_fma_f32 v[82:83],v[18:19],v[40:41],v[82:83] op_sel:[0,1,0] op_sel_hi:[1,1,1]
v_lshlrev_b32 v16,16,v134
v_and_b32 v17,s73,v134
v_pk_fma_f32 v[84:85],v[16:17],v[40:41],v[84:85] op_sel:[0,1,0] op_sel_hi:[1,1,1]
v_lshlrev_b32 v18,16,v135
v_and_b32 v19,s73,v135
v_pk_fma_f32 v[86:87],v[18:19],v[40:41],v[86:87] op_sel:[0,1,0] op_sel_hi:[1,1,1]
s_waitcnt vmcnt(13)
v_lshlrev_b32 v16,16,v136
v_and_b32 v17,s73,v136
v_pk_fma_f32 v[80:81],v[16:17],v[42:43],v[80:81] op_sel:[0,0,0] op_sel_hi:[1,0,1]
v_lshlrev_b32 v18,16,v137
v_and_b32 v19,s73,v137
v_pk_fma_f32 v[82:83],v[18:19],v[42:43],v[82:83] op_sel:[0,0,0] op_sel_hi:[1,0,1]
v_lshlrev_b32 v16,16,v138
v_and_b32 v17,s73,v138
v_pk_fma_f32 v[84:85],v[16:17],v[42:43],v[84:85] op_sel:[0,0,0] op_sel_hi:[1,0,1]
v_lshlrev_b32 v18,16,v139
v_and_b32 v19,s73,v139
v_pk_fma_f32 v[86:87],v[18:19],v[42:43],v[86:87] op_sel:[0,0,0] op_sel_hi:[1,0,1]
s_waitcnt vmcnt(12)
v_lshlrev_b32 v16,16,v140
v_and_b32 v17,s73,v140
v_pk_fma_f32 v[80:81],v[16:17],v[42:43],v[80:81] op_sel:[0,1,0] op_sel_hi:[1,1,1]
v_lshlrev_b32 v18,16,v141
v_and_b32 v19,s73,v141
v_pk_fma_f32 v[82:83],v[18:19],v[42:43],v[82:83] op_sel:[0,1,0] op_sel_hi:[1,1,1]
v_lshlrev_b32 v16,16,v142
v_and_b32 v17,s73,v142
v_pk_fma_f32 v[84:85],v[16:17],v[42:43],v[84:85] op_sel:[0,1,0] op_sel_hi:[1,1,1]
v_lshlrev_b32 v18,16,v143
v_and_b32 v19,s73,v143
v_pk_fma_f32 v[86:87],v[18:19],v[42:43],v[86:87] op_sel:[0,1,0] op_sel_hi:[1,1,1]
s_waitcnt vmcnt(11)
v_lshlrev_b32 v16,16,v144
v_and_b32 v17,s73,v144
v_pk_fma_f32 v[80:81],v[16:17],v[44:45],v[80:81] op_sel:[0,0,0] op_sel_hi:[1,0,1]
v_lshlrev_b32 v18,16,v145
v_and_b32 v19,s73,v145
v_pk_fma_f32 v[82:83],v[18:19],v[44:45],v[82:83] op_sel:[0,0,0] op_sel_hi:[1,0,1]
v_lshlrev_b32 v16,16,v146
v_and_b32 v17,s73,v146
v_pk_fma_f32 v[84:85],v[16:17],v[44:45],v[84:85] op_sel:[0,0,0] op_sel_hi:[1,0,1]
v_lshlrev_b32 v18,16,v147
v_and_b32 v19,s73,v147
v_pk_fma_f32 v[86:87],v[18:19],v[44:45],v[86:87] op_sel:[0,0,0] op_sel_hi:[1,0,1]
s_waitcnt vmcnt(10)
v_lshlrev_b32 v16,16,v148
v_and_b32 v17,s73,v148
v_pk_fma_f32 v[80:81],v[16:17],v[44:45],v[80:81] op_sel:[0,1,0] op_sel_hi:[1,1,1]
v_lshlrev_b32 v18,16,v149
v_and_b32 v19,s73,v149
v_pk_fma_f32 v[82:83],v[18:19],v[44:45],v[82:83] op_sel:[0,1,0] op_sel_hi:[1,1,1]
v_lshlrev_b32 v16,16,v150
v_and_b32 v17,s73,v150
v_pk_fma_f32 v[84:85],v[16:17],v[44:45],v[84:85] op_sel:[0,1,0] op_sel_hi:[1,1,1]
v_lshlrev_b32 v18,16,v151
v_and_b32 v19,s73,v151
v_pk_fma_f32 v[86:87],v[18:19],v[44:45],v[86:87] op_sel:[0,1,0] op_sel_hi:[1,1,1]
s_waitcnt vmcnt(9)
v_lshlrev_b32 v16,16,v152
v_and_b32 v17,s73,v152
v_pk_fma_f32 v[80:81],v[16:17],v[46:47],v[80:81] op_sel:[0,0,0] op_sel_hi:[1,0,1]
v_lshlrev_b32 v18,16,v153
v_and_b32 v19,s73,v153
v_pk_fma_f32 v[82:83],v[18:19],v[46:47],v[82:83] op_sel:[0,0,0] op_sel_hi:[1,0,1]
v_lshlrev_b32 v16,16,v154
v_and_b32 v17,s73,v154
v_pk_fma_f32 v[84:85],v[16:17],v[46:47],v[84:85] op_sel:[0,0,0] op_sel_hi:[1,0,1]
v_lshlrev_b32 v18,16,v155
v_and_b32 v19,s73,v155
v_pk_fma_f32 v[86:87],v[18:19],v[46:47],v[86:87] op_sel:[0,0,0] op_sel_hi:[1,0,1]
s_waitcnt vmcnt(8)
v_lshlrev_b32 v16,16,v156
v_and_b32 v17,s73,v156
v_pk_fma_f32 v[80:81],v[16:17],v[46:47],v[80:81] op_sel:[0,1,0] op_sel_hi:[1,1,1]
v_lshlrev_b32 v18,16,v157
v_and_b32 v19,s73,v157
v_pk_fma_f32 v[82:83],v[18:19],v[46:47],v[82:83] op_sel:[0,1,0] op_sel_hi:[1,1,1]
v_lshlrev_b32 v16,16,v158
v_and_b32 v17,s73,v158
v_pk_fma_f32 v[84:85],v[16:17],v[46:47],v[84:85] op_sel:[0,1,0] op_sel_hi:[1,1,1]
v_lshlrev_b32 v18,16,v159
v_and_b32 v19,s73,v159
v_pk_fma_f32 v[86:87],v[18:19],v[46:47],v[86:87] op_sel:[0,1,0] op_sel_hi:[1,1,1]
v_lshlrev_b32 v18,5,v14
ds_write_b128 v18,v[80:83] offset:16384
ds_write_b128 v18,v[84:87] offset:16400
v_and_b32 v18,127,v14
v_lshlrev_b32 v18,2,v18
v_lshrrev_b32 v19,7,v14
v_mov_b32 v19,v18
s_waitcnt lgkmcnt(0)
s_barrier
ds_read_b32 v32,v19 offset:16384
ds_read_b32 v33,v19 offset:16896
ds_read_b32 v34,v19 offset:17408
ds_read_b32 v35,v19 offset:17920
ds_read_b32 v36,v19 offset:18432
ds_read_b32 v37,v19 offset:18944
ds_read_b32 v38,v19 offset:19456
ds_read_b32 v39,v19 offset:19968
ds_read_b32 v40,v19 offset:20480
ds_read_b32 v41,v19 offset:20992
ds_read_b32 v42,v19 offset:21504
ds_read_b32 v43,v19 offset:22016
s_waitcnt lgkmcnt(4)
ds_read_b32 v44,v19 offset:22528
ds_read_b32 v45,v19 offset:23040
ds_read_b32 v46,v19 offset:23552
ds_read_b32 v47,v19 offset:24064
s_waitcnt lgkmcnt(0)
v_pk_add_f32 v[32:33],v[32:33],v[40:41]
v_pk_add_f32 v[34:35],v[34:35],v[42:43]
v_pk_add_f32 v[36:37],v[36:37],v[44:45]
v_pk_add_f32 v[38:39],v[38:39],v[46:47]
v_pk_add_f32 v[32:33],v[32:33],v[36:37]
v_pk_add_f32 v[34:35],v[34:35],v[38:39]
v_pk_add_f32 v[32:33],v[32:33],v[34:35]
v_add_f32 v32,v32,v33
s_mul_i32 s64,s53,24576
s_lshl_b32 s65,s52,9
s_add_u32 s64,s64,s65
s_add_u32 s64,s64,267386880
buffer_store_dword v32,v18,s[20:23],s64 offen sc1
s_waitcnt vmcnt(0)
s_barrier
s_cmp_lg_u32 s50,0
s_cbranch_scc1 sig_5
s_mov_b32 s92,s2
s_and_b32 s93,s3,0xffff
s_mov_b32 s94,0x100
s_mov_b32 s95,0x20000
s_add_u32 s64,s88,0
v_mov_b32 v16,1
s_mov_b64 exec,1
buffer_atomic_add v16,off,s[92:95],s64 sc1
s_mov_b64 exec,-1
sig_5:
v_lshlrev_b32 v128,16,v48
v_and_b32 v129,s73,v48
v_lshlrev_b32 v130,16,v49
v_and_b32 v131,s73,v49
v_lshlrev_b32 v132,16,v50
v_and_b32 v133,s73,v50
v_lshlrev_b32 v134,16,v51
v_and_b32 v135,s73,v51
v_lshlrev_b32 v136,16,v52
v_and_b32 v137,s73,v52
v_lshlrev_b32 v138,16,v53
v_and_b32 v139,s73,v53
v_lshlrev_b32 v140,16,v54
v_and_b32 v141,s73,v54
v_lshlrev_b32 v142,16,v55
v_and_b32 v143,s73,v55
v_lshlrev_b32 v144,16,v56
v_and_b32 v145,s73,v56
v_lshlrev_b32 v146,16,v57
v_and_b32 v147,s73,v57
v_lshlrev_b32 v148,16,v58
v_and_b32 v149,s73,v58
v_lshlrev_b32 v150,16,v59
v_and_b32 v151,s73,v59
v_lshlrev_b32 v152,16,v60
v_and_b32 v153,s73,v60
v_lshlrev_b32 v154,16,v61
v_and_b32 v155,s73,v61
v_lshlrev_b32 v156,16,v62
v_and_b32 v157,s73,v62
v_lshlrev_b32 v158,16,v63
v_and_b32 v159,s73,v63
v_lshlrev_b32 v160,16,v64
v_and_b32 v161,s73,v64
v_lshlrev_b32 v162,16,v65
v_and_b32 v163,s73,v65
v_lshlrev_b32 v164,16,v66
v_and_b32 v165,s73,v66
v_lshlrev_b32 v166,16,v67
v_and_b32 v167,s73,v67
v_lshlrev_b32 v168,16,v68
v_and_b32 v169,s73,v68
v_lshlrev_b32 v170,16,v69
v_and_b32 v171,s73,v69
v_lshlrev_b32 v172,16,v70
v_and_b32 v173,s73,v70
v_lshlrev_b32 v174,16,v71
v_and_b32 v175,s73,v71
v_lshlrev_b32 v176,16,v72
v_and_b32 v177,s73,v72
v_lshlrev_b32 v178,16,v73
v_and_b32 v179,s73,v73
v_lshlrev_b32 v180,16,v74
v_and_b32 v181,s73,v74
v_lshlrev_b32 v182,16,v75
v_and_b32 v183,s73,v75
v_lshlrev_b32 v184,16,v76
v_and_b32 v185,s73,v76
v_lshlrev_b32 v186,16,v77
v_and_b32 v187,s73,v77
v_lshlrev_b32 v188,16,v78
v_and_b32 v189,s73,v78
v_lshlrev_b32 v190,16,v79
v_and_b32 v191,s73,v79
v_add_f32 v208,v128,v129
v_mul_f32 v209,v128,v128
v_add_f32 v210,v130,v131
v_mul_f32 v211,v129,v129
v_fmac_f32 v209,v130,v130
v_fmac_f32 v211,v131,v131
v_add_f32 v208,v208,v132
v_fmac_f32 v209,v132,v132
v_add_f32 v210,v210,v133
v_fmac_f32 v211,v133,v133
v_add_f32 v208,v208,v134
v_fmac_f32 v209,v134,v134
v_add_f32 v210,v210,v135
v_fmac_f32 v211,v135,v135
v_add_f32 v208,v208,v136
v_fmac_f32 v209,v136,v136
v_add_f32 v210,v210,v137
v_fmac_f32 v211,v137,v137
v_add_f32 v208,v208,v138
v_fmac_f32 v209,v138,v138
v_add_f32 v210,v210,v139
v_fmac_f32 v211,v139,v139
v_add_f32 v208,v208,v140
v_fmac_f32 v209,v140,v140
v_add_f32 v210,v210,v141
v_fmac_f32 v211,v141,v141
v_add_f32 v208,v208,v142
v_fmac_f32 v209,v142,v142
v_add_f32 v210,v210,v143
v_fmac_f32 v211,v143,v143
v_add_f32 v208,v208,v210
v_add_f32 v209,v209,v211
v_add_f32 v212,v144,v145
v_mul_f32 v213,v144,v144
v_add_f32 v214,v146,v147
v_mul_f32 v215,v145,v145
v_fmac_f32 v213,v146,v146
v_fmac_f32 v215,v147,v147
v_add_f32 v212,v212,v148
v_fmac_f32 v213,v148,v148
v_add_f32 v214,v214,v149
v_fmac_f32 v215,v149,v149
v_add_f32 v212,v212,v150
v_fmac_f32 v213,v150,v150
v_add_f32 v214,v214,v151
v_fmac_f32 v215,v151,v151
v_add_f32 v212,v212,v152
v_fmac_f32 v213,v152,v152
v_add_f32 v214,v214,v153
v_fmac_f32 v215,v153,v153
v_add_f32 v212,v212,v154
v_fmac_f32 v213,v154,v154
v_add_f32 v214,v214,v155
v_fmac_f32 v215,v155,v155
v_add_f32 v212,v212,v156
v_fmac_f32 v213,v156,v156
v_add_f32 v214,v214,v157
v_fmac_f32 v215,v157,v157
v_add_f32 v212,v212,v158
v_fmac_f32 v213,v158,v158
v_add_f32 v214,v214,v159
v_fmac_f32 v215,v159,v159
v_add_f32 v212,v212,v214
v_add_f32 v213,v213,v215
v_add_f32 v216,v160,v161
v_mul_f32 v217,v160,v160
v_add_f32 v218,v162,v163
v_mul_f32 v219,v161,v161
v_fmac_f32 v217,v162,v162
v_fmac_f32 v219,v163,v163
v_add_f32 v216,v216,v164
v_fmac_f32 v217,v164,v164
v_add_f32 v218,v218,v165
v_fmac_f32 v219,v165,v165
v_add_f32 v216,v216,v166
v_fmac_f32 v217,v166,v166
v_add_f32 v218,v218,v167
v_fmac_f32 v219,v167,v167
v_add_f32 v216,v216,v168
v_fmac_f32 v217,v168,v168
v_add_f32 v218,v218,v169
v_fmac_f32 v219,v169,v169
v_add_f32 v216,v216,v170
v_fmac_f32 v217,v170,v170
v_add_f32 v218,v218,v171
v_fmac_f32 v219,v171,v171
v_add_f32 v216,v216,v172
v_fmac_f32 v217,v172,v172
v_add_f32 v218,v218,v173
v_fmac_f32 v219,v173,v173
v_add_f32 v216,v216,v174
v_fmac_f32 v217,v174,v174
v_add_f32 v218,v218,v175
v_fmac_f32 v219,v175,v175
v_add_f32 v216,v216,v218
v_add_f32 v217,v217,v219
v_add_f32 v220,v176,v177
v_mul_f32 v221,v176,v176
v_add_f32 v222,v178,v179
v_mul_f32 v223,v177,v177
v_fmac_f32 v221,v178,v178
v_fmac_f32 v223,v179,v179
v_add_f32 v220,v220,v180
v_fmac_f32 v221,v180,v180
v_add_f32 v222,v222,v181
v_fmac_f32 v223,v181,v181
v_add_f32 v220,v220,v182
v_fmac_f32 v221,v182,v182
v_add_f32 v222,v222,v183
v_fmac_f32 v223,v183,v183
v_add_f32 v220,v220,v184
v_fmac_f32 v221,v184,v184
v_add_f32 v222,v222,v185
v_fmac_f32 v223,v185,v185
v_add_f32 v220,v220,v186
v_fmac_f32 v221,v186,v186
v_add_f32 v222,v222,v187
v_fmac_f32 v223,v187,v187
v_add_f32 v220,v220,v188
v_fmac_f32 v221,v188,v188
v_add_f32 v222,v222,v189
v_fmac_f32 v223,v189,v189
v_add_f32 v220,v220,v190
v_fmac_f32 v221,v190,v190
v_add_f32 v222,v222,v191
v_fmac_f32 v223,v191,v191
v_add_f32 v220,v220,v222
v_add_f32 v221,v221,v223
v_add_f32_dpp v208,v208,v208 row_ror:4 row_mask:0xf bank_mask:0xf
v_add_f32_dpp v209,v209,v209 row_ror:4 row_mask:0xf bank_mask:0xf
v_add_f32_dpp v212,v212,v212 row_ror:4 row_mask:0xf bank_mask:0xf
v_add_f32_dpp v213,v213,v213 row_ror:4 row_mask:0xf bank_mask:0xf
v_add_f32_dpp v216,v216,v216 row_ror:4 row_mask:0xf bank_mask:0xf
v_add_f32_dpp v217,v217,v217 row_ror:4 row_mask:0xf bank_mask:0xf
v_add_f32_dpp v220,v220,v220 row_ror:4 row_mask:0xf bank_mask:0xf
v_add_f32_dpp v221,v221,v221 row_ror:4 row_mask:0xf bank_mask:0xf
v_add_f32_dpp v208,v208,v208 row_ror:8 row_mask:0xf bank_mask:0xf
v_add_f32_dpp v209,v209,v209 row_ror:8 row_mask:0xf bank_mask:0xf
v_add_f32_dpp v212,v212,v212 row_ror:8 row_mask:0xf bank_mask:0xf
v_add_f32_dpp v213,v213,v213 row_ror:8 row_mask:0xf bank_mask:0xf
v_add_f32_dpp v216,v216,v216 row_ror:8 row_mask:0xf bank_mask:0xf
v_add_f32_dpp v217,v217,v217 row_ror:8 row_mask:0xf bank_mask:0xf
v_add_f32_dpp v220,v220,v220 row_ror:8 row_mask:0xf bank_mask:0xf
v_add_f32_dpp v221,v221,v221 row_ror:8 row_mask:0xf bank_mask:0xf
v_mov_b32 v210,v208
v_mov_b32 v211,v209
s_nop 0
v_permlane16_swap_b32 v210,v208
v_permlane16_swap_b32 v211,v209
v_add_f32 v208,v208,v210
v_add_f32 v209,v209,v211
v_mov_b32 v214,v212
v_mov_b32 v215,v213
s_nop 0
v_permlane16_swap_b32 v214,v212
v_permlane16_swap_b32 v215,v213
v_add_f32 v212,v212,v214
v_add_f32 v213,v213,v215
v_mov_b32 v218,v216
v_mov_b32 v219,v217
s_nop 0
v_permlane16_swap_b32 v218,v216
v_permlane16_swap_b32 v219,v217
v_add_f32 v216,v216,v218
v_add_f32 v217,v217,v219
v_mov_b32 v222,v220
v_mov_b32 v223,v221
s_nop 0
v_permlane16_swap_b32 v222,v220
v_permlane16_swap_b32 v223,v221
v_add_f32 v220,v220,v222
v_add_f32 v221,v221,v223
v_mov_b32 v210,v208
v_mov_b32 v211,v209
s_nop 0
v_permlane32_swap_b32 v210,v208
v_permlane32_swap_b32 v211,v209
v_add_f32 v208,v208,v210
v_add_f32 v209,v209,v211
v_mov_b32 v214,v212
v_mov_b32 v215,v213
s_nop 0
v_permlane32_swap_b32 v214,v212
v_permlane32_swap_b32 v215,v213
v_add_f32 v212,v212,v214
v_add_f32 v213,v213,v215
v_mov_b32 v218,v216
v_mov_b32 v219,v217
s_nop 0
v_permlane32_swap_b32 v218,v216
v_permlane32_swap_b32 v219,v217
v_add_f32 v216,v216,v218
v_add_f32 v217,v217,v219
v_mov_b32 v222,v220
v_mov_b32 v223,v221
s_nop 0
v_permlane32_swap_b32 v222,v220
v_permlane32_swap_b32 v223,v221
v_add_f32 v220,v220,v222
v_add_f32 v221,v221,v223
ds_write_b64 v11,v[208:209] offset:32768
ds_write_b64 v11,v[212:213] offset:34816
ds_write_b64 v11,v[216:217] offset:36864
ds_write_b64 v11,v[220:221] offset:38912
s_waitcnt lgkmcnt(0)
s_barrier
ds_read_b64 v[32:33],v12 offset:32768
ds_read_b64 v[34:35],v12 offset:33280
ds_read_b64 v[36:37],v12 offset:33792
ds_read_b64 v[38:39],v12 offset:34304
s_waitcnt lgkmcnt(0)
v_add_f32 v32,v32,v34
v_add_f32 v33,v33,v35
v_add_f32 v36,v36,v38
v_add_f32 v37,v37,v39
v_add_f32 v32,v32,v36
v_add_f32 v33,v33,v37
v_mul_f32 v208,0xba800000,v32
v_mul_f32 v34,v208,v208
v_mul_f32 v33,0x3a800000,v33
v_sub_f32 v33,v33,v34
v_max_f32 v33,0,v33
v_add_f32 v33,0x3727c5ac,v33
v_rsq_f32 v209,v33
s_nop 0
v_mul_f32 v208,v208,v209
v_fma_f32 v128,v128,v209,v208
v_fma_f32 v129,v129,v209,v208
v_fma_f32 v130,v130,v209,v208
v_fma_f32 v131,v131,v209,v208
v_fma_f32 v132,v132,v209,v208
v_fma_f32 v133,v133,v209,v208
v_fma_f32 v134,v134,v209,v208
v_fma_f32 v135,v135,v209,v208
v_fma_f32 v136,v136,v209,v208
v_fma_f32 v137,v137,v209,v208
v_fma_f32 v138,v138,v209,v208
v_fma_f32 v139,v139,v209,v208
v_fma_f32 v140,v140,v209,v208
v_fma_f32 v141,v141,v209,v208
v_fma_f32 v142,v142,v209,v208
v_fma_f32 v143,v143,v209,v208
ds_read_b64 v[32:33],v12 offset:34816
ds_read_b64 v[34:35],v12 offset:35328
ds_read_b64 v[36:37],v12 offset:35840
ds_read_b64 v[38:39],v12 offset:36352
s_waitcnt lgkmcnt(0)
v_add_f32 v32,v32,v34
v_add_f32 v33,v33,v35
v_add_f32 v36,v36,v38
v_add_f32 v37,v37,v39
v_add_f32 v32,v32,v36
v_add_f32 v33,v33,v37
v_mul_f32 v208,0xba800000,v32
v_mul_f32 v34,v208,v208
v_mul_f32 v33,0x3a800000,v33
v_sub_f32 v33,v33,v34
v_max_f32 v33,0,v33
v_add_f32 v33,0x3727c5ac,v33
v_rsq_f32 v209,v33
s_nop 0
v_mul_f32 v208,v208,v209
v_fma_f32 v144,v144,v209,v208
v_fma_f32 v145,v145,v209,v208
v_fma_f32 v146,v146,v209,v208
v_fma_f32 v147,v147,v209,v208
v_fma_f32 v148,v148,v209,v208
v_fma_f32 v149,v149,v209,v208
v_fma_f32 v150,v150,v209,v208
v_fma_f32 v151,v151,v209,v208
v_fma_f32 v152,v152,v209,v208
v_fma_f32 v153,v153,v209,v208
v_fma_f32 v154,v154,v209,v208
v_fma_f32 v155,v155,v209,v208
v_fma_f32 v156,v156,v209,v208
v_fma_f32 v157,v157,v209,v208
v_fma_f32 v158,v158,v209,v208
v_fma_f32 v159,v159,v209,v208
ds_read_b64 v[32:33],v12 offset:36864
ds_read_b64 v[34:35],v12 offset:37376
ds_read_b64 v[36:37],v12 offset:37888
ds_read_b64 v[38:39],v12 offset:38400
s_waitcnt lgkmcnt(0)
v_add_f32 v32,v32,v34
v_add_f32 v33,v33,v35
v_add_f32 v36,v36,v38
v_add_f32 v37,v37,v39
v_add_f32 v32,v32,v36
v_add_f32 v33,v33,v37
v_mul_f32 v208,0xba800000,v32
v_mul_f32 v34,v208,v208
v_mul_f32 v33,0x3a800000,v33
v_sub_f32 v33,v33,v34
v_max_f32 v33,0,v33
v_add_f32 v33,0x3727c5ac,v33
v_rsq_f32 v209,v33
s_nop 0
v_mul_f32 v208,v208,v209
v_fma_f32 v160,v160,v209,v208
v_fma_f32 v161,v161,v209,v208
v_fma_f32 v162,v162,v209,v208
v_fma_f32 v163,v163,v209,v208
v_fma_f32 v164,v164,v209,v208
v_fma_f32 v165,v165,v209,v208
v_fma_f32 v166,v166,v209,v208
v_fma_f32 v167,v167,v209,v208
v_fma_f32 v168,v168,v209,v208
v_fma_f32 v169,v169,v209,v208
v_fma_f32 v170,v170,v209,v208
v_fma_f32 v171,v171,v209,v208
v_fma_f32 v172,v172,v209,v208
v_fma_f32 v173,v173,v209,v208
v_fma_f32 v174,v174,v209,v208
v_fma_f32 v175,v175,v209,v208
ds_read_b64 v[32:33],v12 offset:38912
ds_read_b64 v[34:35],v12 offset:39424
ds_read_b64 v[36:37],v12 offset:39936
ds_read_b64 v[38:39],v12 offset:40448
s_waitcnt lgkmcnt(0)
v_add_f32 v32,v32,v34
v_add_f32 v33,v33,v35
v_add_f32 v36,v36,v38
v_add_f32 v37,v37,v39
v_add_f32 v32,v32,v36
v_add_f32 v33,v33,v37
v_mul_f32 v208,0xba800000,v32
v_mul_f32 v34,v208,v208
v_mul_f32 v33,0x3a800000,v33
v_sub_f32 v33,v33,v34
v_max_f32 v33,0,v33
v_add_f32 v33,0x3727c5ac,v33
v_rsq_f32 v209,v33
s_nop 0
v_mul_f32 v208,v208,v209
v_fma_f32 v176,v176,v209,v208
v_fma_f32 v177,v177,v209,v208
v_fma_f32 v178,v178,v209,v208
v_fma_f32 v179,v179,v209,v208
v_fma_f32 v180,v180,v209,v208
v_fma_f32 v181,v181,v209,v208
v_fma_f32 v182,v182,v209,v208
v_fma_f32 v183,v183,v209,v208
v_fma_f32 v184,v184,v209,v208
v_fma_f32 v185,v185,v209,v208
v_fma_f32 v186,v186,v209,v208
v_fma_f32 v187,v187,v209,v208
v_fma_f32 v188,v188,v209,v208
v_fma_f32 v189,v189,v209,v208
v_fma_f32 v190,v190,v209,v208
v_fma_f32 v191,v191,v209,v208
s_mov_b32 s92,s2
s_and_b32 s93,s3,0xffff
s_mov_b32 s94,0x100
s_mov_b32 s95,0x20000
v_mbcnt_lo_u32_b32 v16,-1,0
v_mbcnt_hi_u32_b32 v16,-1,v16
v_mov_b32 v18,0
v_cmp_eq_u32 vcc,16,v16
s_nop 1
v_cndmask_b32 v18,v18,64,vcc
v_and_b32 v19,1,v16
v_cmp_eq_u32 vcc,1,v19
v_mov_b32 v19,8192
s_nop 0
v_cndmask_b32 v19,-1,v19,vcc
v_min_u32 v16,31,v16
v_lshlrev_b32 v16,2,v16
s_sub_u32 s66,s88,64
s_cmp_lg_u32 s50,0
s_cbranch_scc1 vot_10
vpoll_6:
buffer_load_dword v17,v16,s[92:95],s66 offen sc1
s_waitcnt vmcnt(0)
s_cmp_lg_u32 s56,2
s_cbranch_scc1 vck_7
v_cmp_eq_u32 vcc,v17,v19
s_and_b32 s64,vcc_lo,0xffff
s_cmp_eq_u32 s64,65535
s_cbranch_scc1 vck_7
s_mov_b32 s65,0
v_readlane_b32 s64,v17,1
s_lshr_b32 s64,s64,8
s_add_u32 s65,s65,s64
v_readlane_b32 s64,v17,3
s_lshr_b32 s64,s64,8
s_add_u32 s65,s65,s64
v_readlane_b32 s64,v17,5
s_lshr_b32 s64,s64,8
s_add_u32 s65,s65,s64
v_readlane_b32 s64,v17,7
s_lshr_b32 s64,s64,8
s_add_u32 s65,s65,s64
v_readlane_b32 s64,v17,9
s_lshr_b32 s64,s64,8
s_add_u32 s65,s65,s64
v_readlane_b32 s64,v17,11
s_lshr_b32 s64,s64,8
s_add_u32 s65,s65,s64
v_readlane_b32 s64,v17,13
s_lshr_b32 s64,s64,8
s_add_u32 s65,s65,s64
v_readlane_b32 s64,v17,15
s_lshr_b32 s64,s64,8
s_add_u32 s65,s65,s64
s_cmp_ge_u32 s65,256
s_cbranch_scc1 vok_9
s_branch vrt_8
vck_7:
v_cmp_gt_u32 vcc,v18,v17
s_cbranch_vccz vok_9
vrt_8:
s_sleep 8
s_sub_u32 s90,s90,1
s_cmp_gt_i32 s90,0
s_cbranch_scc1 vpoll_6
vok_9:
v_add_u32 v18,160000,v16
ds_write_b32 v18,v17
s_waitcnt lgkmcnt(0)
vot_10:
s_barrier
v_add_u32 v18,160000,v16
ds_read_b32 v17,v18
s_waitcnt lgkmcnt(0)
s_cmp_lg_u32 s56,2
s_cbranch_scc1 vfin_11
v_cmp_eq_u32 vcc,v17,v19
s_and_b32 s64,vcc_lo,0xffff
s_cmp_eq_u32 s64,65535
s_cbranch_scc1 vfin_11
s_mov_b32 s65,0
v_readlane_b32 s64,v17,1
s_lshr_b32 s64,s64,8
s_add_u32 s65,s65,s64
v_readlane_b32 s64,v17,3
s_lshr_b32 s64,s64,8
s_add_u32 s65,s65,s64
v_readlane_b32 s64,v17,5
s_lshr_b32 s64,s64,8
s_add_u32 s65,s65,s64
v_readlane_b32 s64,v17,7
s_lshr_b32 s64,s64,8
s_add_u32 s65,s65,s64
v_readlane_b32 s64,v17,9
s_lshr_b32 s64,s64,8
s_add_u32 s65,s65,s64
v_readlane_b32 s64,v17,11
s_lshr_b32 s64,s64,8
s_add_u32 s65,s65,s64
v_readlane_b32 s64,v17,13
s_lshr_b32 s64,s64,8
s_add_u32 s65,s65,s64
v_readlane_b32 s64,v17,15
s_lshr_b32 s64,s64,8
s_add_u32 s65,s65,s64
s_cmp_ge_u32 s65,256
s_cbranch_scc1 fl_fb
vfin_11:
s_and_b32 s56,s56,1
v_lshlrev_b32 v18,5,v14
s_mov_b32 s64,267386880
buffer_load_dwordx4 v[32:35],v18,s[20:23],s64 offen offset:0 sc1
buffer_load_dwordx4 v[36:39],v18,s[20:23],s64 offen offset:16 sc1
s_mov_b32 s64,267411456
buffer_load_dwordx4 v[40:43],v18,s[20:23],s64 offen offset:0 sc1
buffer_load_dwordx4 v[44:47],v18,s[20:23],s64 offen offset:16 sc1
s_mov_b32 s64,267436032
buffer_load_dwordx4 v[48:51],v18,s[20:23],s64 offen offset:0 sc1
buffer_load_dwordx4 v[52:55],v18,s[20:23],s64 offen offset:16 sc1
s_mov_b32 s64,267460608
buffer_load_dwordx4 v[56:59],v18,s[20:23],s64 offen offset:0 sc1
buffer_load_dwordx4 v[60:63],v18,s[20:23],s64 offen offset:16 sc1
s_cmp_gt_u32 s50,1
s_cselect_b32 s64,1.0,0
s_waitcnt vmcnt(0)
v_pk_add_f32 v[32:33],v[32:33],v[40:41]
v_pk_add_f32 v[48:49],v[48:49],v[56:57]
v_pk_add_f32 v[34:35],v[34:35],v[42:43]
v_pk_add_f32 v[50:51],v[50:51],v[58:59]
v_pk_add_f32 v[36:37],v[36:37],v[44:45]
v_pk_add_f32 v[52:53],v[52:53],v[60:61]
v_pk_add_f32 v[38:39],v[38:39],v[46:47]
v_pk_add_f32 v[54:55],v[54:55],v[62:63]
v_pk_add_f32 v[32:33],v[32:33],v[48:49]
v_pk_add_f32 v[34:35],v[34:35],v[50:51]
v_pk_add_f32 v[36:37],v[36:37],v[52:53]
v_pk_add_f32 v[38:39],v[38:39],v[54:55]
v_cvt_pk_bf16_f32 v40,v32,v33
v_cvt_pk_bf16_f32 v41,v34,v35
v_cvt_pk_bf16_f32 v42,v36,v37
v_cvt_pk_bf16_f32 v43,v38,v39
v_lshlrev_b32 v32,16,v40
v_and_b32 v33,s73,v40
v_lshlrev_b32 v34,16,v41
v_and_b32 v35,s73,v41
v_lshlrev_b32 v36,16,v42
v_and_b32 v37,s73,v42
v_lshlrev_b32 v38,16,v43
v_and_b32 v39,s73,v43
v_add_f32 v32,s64,v32
v_add_f32 v33,s64,v33
v_add_f32 v34,s64,v34
v_add_f32 v35,s64,v35
v_add_f32 v36,s64,v36
v_add_f32 v37,s64,v37
v_add_f32 v38,s64,v38
v_add_f32 v39,s64,v39
ds_write_b128 v18,v[32:35] offset:0
ds_write_b128 v18,v[36:39] offset:16
s_waitcnt lgkmcnt(0)
s_barrier
ds_read_b128 v[112:115],v9 offset:0
ds_read_b128 v[116:119],v9 offset:16
ds_read_b128 v[120:123],v9 offset:512
ds_read_b128 v[124:127],v9 offset:528
ds_read_b128 v[96:99],v9 offset:4096
ds_read_b128 v[100:103],v9 offset:4112
ds_read_b128 v[104:107],v9 offset:4608
ds_read_b128 v[108:111],v9 offset:4624
s_add_u32 s61,s61,146800640
s_add_u32 s62,s61,4096
s_waitcnt lgkmcnt(0)
v_fma_f32 v128,v128,v96,v112
v_fma_f32 v129,v129,v97,v113
v_fma_f32 v130,v130,v98,v114
v_fma_f32 v131,v131,v99,v115
v_fma_f32 v132,v132,v100,v116
v_fma_f32 v133,v133,v101,v117
v_fma_f32 v134,v134,v102,v118
v_fma_f32 v135,v135,v103,v119
v_fma_f32 v136,v136,v104,v120
v_fma_f32 v137,v137,v105,v121
v_fma_f32 v138,v138,v106,v122
v_fma_f32 v139,v139,v107,v123
v_fma_f32 v140,v140,v108,v124
v_fma_f32 v141,v141,v109,v125
v_fma_f32 v142,v142,v110,v126
v_fma_f32 v143,v143,v111,v127
v_cvt_pk_bf16_f32 v48,v128,v129
v_cvt_pk_bf16_f32 v49,v130,v131
v_cvt_pk_bf16_f32 v50,v132,v133
v_cvt_pk_bf16_f32 v51,v134,v135
v_cvt_pk_bf16_f32 v52,v136,v137
v_cvt_pk_bf16_f32 v53,v138,v139
v_cvt_pk_bf16_f32 v54,v140,v141
v_cvt_pk_bf16_f32 v55,v142,v143
buffer_store_dwordx4 v[48:51],v10,s[20:23],s61 offen offset:0 sc1
buffer_store_dwordx4 v[52:55],v10,s[20:23],s62 offen offset:0 sc1
v_fma_f32 v144,v144,v96,v112
v_fma_f32 v145,v145,v97,v113
v_fma_f32 v146,v146,v98,v114
v_fma_f32 v147,v147,v99,v115
v_fma_f32 v148,v148,v100,v116
v_fma_f32 v149,v149,v101,v117
v_fma_f32 v150,v150,v102,v118
v_fma_f32 v151,v151,v103,v119
v_fma_f32 v152,v152,v104,v120
v_fma_f32 v153,v153,v105,v121
v_fma_f32 v154,v154,v106,v122
v_fma_f32 v155,v155,v107,v123
v_fma_f32 v156,v156,v108,v124
v_fma_f32 v157,v157,v109,v125
v_fma_f32 v158,v158,v110,v126
v_fma_f32 v159,v159,v111,v127
v_cvt_pk_bf16_f32 v56,v144,v145
v_cvt_pk_bf16_f32 v57,v146,v147
v_cvt_pk_bf16_f32 v58,v148,v149
v_cvt_pk_bf16_f32 v59,v150,v151
v_cvt_pk_bf16_f32 v60,v152,v153
v_cvt_pk_bf16_f32 v61,v154,v155
v_cvt_pk_bf16_f32 v62,v156,v157
v_cvt_pk_bf16_f32 v63,v158,v159
buffer_store_dwordx4 v[56:59],v10,s[20:23],s61 offen offset:64 sc1
buffer_store_dwordx4 v[60:63],v10,s[20:23],s62 offen offset:64 sc1
v_fma_f32 v160,v160,v96,v112
v_fma_f32 v161,v161,v97,v113
v_fma_f32 v162,v162,v98,v114
v_fma_f32 v163,v163,v99,v115
v_fma_f32 v164,v164,v100,v116
v_fma_f32 v165,v165,v101,v117
v_fma_f32 v166,v166,v102,v118
v_fma_f32 v167,v167,v103,v119
v_fma_f32 v168,v168,v104,v120
v_fma_f32 v169,v169,v105,v121
v_fma_f32 v170,v170,v106,v122
v_fma_f32 v171,v171,v107,v123
v_fma_f32 v172,v172,v108,v124
v_fma_f32 v173,v173,v109,v125
v_fma_f32 v174,v174,v110,v126
v_fma_f32 v175,v175,v111,v127
v_cvt_pk_bf16_f32 v64,v160,v161
v_cvt_pk_bf16_f32 v65,v162,v163
v_cvt_pk_bf16_f32 v66,v164,v165
v_cvt_pk_bf16_f32 v67,v166,v167
v_cvt_pk_bf16_f32 v68,v168,v169
v_cvt_pk_bf16_f32 v69,v170,v171
v_cvt_pk_bf16_f32 v70,v172,v173
v_cvt_pk_bf16_f32 v71,v174,v175
buffer_store_dwordx4 v[64:67],v10,s[20:23],s61 offen offset:128 sc1
buffer_store_dwordx4 v[68:71],v10,s[20:23],s62 offen offset:128 sc1
v_fma_f32 v176,v176,v96,v112
v_fma_f32 v177,v177,v97,v113
v_fma_f32 v178,v178,v98,v114
v_fma_f32 v179,v179,v99,v115
v_fma_f32 v180,v180,v100,v116
v_fma_f32 v181,v181,v101,v117
v_fma_f32 v182,v182,v102,v118
v_fma_f32 v183,v183,v103,v119
v_fma_f32 v184,v184,v104,v120
v_fma_f32 v185,v185,v105,v121
v_fma_f32 v186,v186,v106,v122
v_fma_f32 v187,v187,v107,v123
v_fma_f32 v188,v188,v108,v124
v_fma_f32 v189,v189,v109,v125
v_fma_f32 v190,v190,v110,v126
v_fma_f32 v191,v191,v111,v127
v_cvt_pk_bf16_f32 v72,v176,v177
v_cvt_pk_bf16_f32 v73,v178,v179
v_cvt_pk_bf16_f32 v74,v180,v181
v_cvt_pk_bf16_f32 v75,v182,v183
v_cvt_pk_bf16_f32 v76,v184,v185
v_cvt_pk_bf16_f32 v77,v186,v187
v_cvt_pk_bf16_f32 v78,v188,v189
v_cvt_pk_bf16_f32 v79,v190,v191
buffer_store_dwordx4 v[72:75],v10,s[20:23],s61 offen offset:192 sc1
buffer_store_dwordx4 v[76:79],v10,s[20:23],s62 offen offset:192 sc1
s_waitcnt vmcnt(0)
s_barrier
s_cmp_lg_u32 s50,0
s_cbranch_scc1 sig_12
s_mov_b32 s92,s2
s_and_b32 s93,s3,0xffff
s_mov_b32 s94,0x100
s_mov_b32 s95,0x20000
s_add_u32 s64,s88,12
v_mov_b32 v16,1
s_mov_b64 exec,1
buffer_atomic_add v16,off,s[92:95],s64 sc1
s_mov_b64 exec,-1
sig_12:
s_branch fl_disp
fl_dutb:
s_load_dwordx4 s[4:7],s[0:1],96
s_load_dwordx2 s[8:9],s[0:1],0
s_cmp_lg_u32 s58,220
s_cbranch_scc1 nomeas_13
s_cmp_lg_u32 s50,0
s_cbranch_scc1 nomeas_13
s_mov_b64 exec,1
s_mov_b32 s65,1
s_cmp_eq_u32 s56,1
s_cbranch_scc1 pub_14
s_mov_b32 s66,138526720
s_mov_b32 s67,138534912
s_mov_b32 s70,0x7fffffff
s_mov_b32 s71,0x7fffffff
s_mov_b32 s72,8
mlp_15:
s_memtime s[94:95]
s_waitcnt lgkmcnt(0)
buffer_store_dword v16,off,s[20:23],s66 sc1
s_waitcnt vmcnt(0)
s_memtime s[96:97]
s_waitcnt lgkmcnt(0)
s_sub_u32 s96,s96,s94
s_min_u32 s70,s70,s96
s_memtime s[94:95]
s_waitcnt lgkmcnt(0)
buffer_store_dword v16,off,s[20:23],s67 sc1
s_waitcnt vmcnt(0)
s_memtime s[96:97]
s_waitcnt lgkmcnt(0)
s_sub_u32 s96,s96,s94
s_min_u32 s71,s71,s96
s_sub_u32 s72,s72,1
s_cmp_gt_u32 s72,0
s_cbranch_scc1 mlp_15
s_cmp_gt_u32 s71,s70
s_cselect_b32 s65,2,1
pub_14:
s_mov_b32 s92,s2
s_and_b32 s93,s3,0xffff
s_mov_b32 s94,0x100
s_mov_b32 s95,0x20000
v_mov_b32 v16,s65
s_add_u32 s64,s88,20
buffer_store_dword v16,off,s[92:95],s64 sc1
s_mov_b64 exec,-1
nomeas_13:
s_barrier
s_sub_u32 s59,s58,192
s_and_b32 s52,s59,15
s_lshr_b32 s53,s59,4
s_lshl_b32 s64,s50,6
v_add_u32 v14,s64,v1
v_lshrrev_b32 v2,4,v14
v_and_b32 v3,15,v14
v_mul_u32_u24 v13,196608,v2
v_lshl_add_u32 v13,v3,4,v13
s_mul_i32 s54,s53,3145728
s_lshl_b32 s64,s52,9
s_add_u32 s54,s54,s64
s_add_u32 s54,s54,4096
v_lshlrev_b32 v15,1,v14
s_lshl_b32 s55,s53,9
s_mov_b32 s60,0
s_mov_b32 s73,0xffff0000
s_sub_u32 s61,s58,128
s_lshl_b32 s61,s61,15
v_lshlrev_b32 v25,6,v2
v_lshlrev_b32 v24,4,v1
v_and_b32 v2,3,v1
v_lshrrev_b32 v3,2,v1
s_lshl_b32 s64,s60,2
v_add_u32 v4,s64,v2
s_lshl_b32 s65,s50,9
v_lshlrev_b32 v5,4,v3
v_add_u32 v5,s65,v5
v_lshl_add_u32 v8,v4,11,v5
v_lshlrev_b32 v9,1,v5
v_lshrrev_b32 v5,2,v3
v_and_b32 v3,3,v3
s_lshl_b32 s65,s50,13
v_lshlrev_b32 v5,10,v5
v_lshl_add_u32 v5,v3,8,v5
v_lshl_add_u32 v5,v4,4,v5
v_add_u32 v10,s65,v5
s_lshl_b32 s65,s50,9
v_lshlrev_b32 v5,3,v1
v_add_u32 v11,s65,v5
v_lshlrev_b32 v12,3,v2
s_waitcnt lgkmcnt(0)
s_mov_b32 s24,s4
s_and_b32 s25,s5,0xffff
s_mov_b32 s26,0x800
s_mov_b32 s27,0x20000
s_mov_b32 s28,s6
s_and_b32 s29,s7,0xffff
s_mov_b32 s30,0xc00000
s_mov_b32 s31,0x20000
s_mov_b32 s32,s8
s_and_b32 s33,s9,0xffff
s_mov_b32 s34,0x400000
s_mov_b32 s35,0x20000
v_mov_b32 v28,-1
v_mov_b32 v20,0
v_mov_b32 v29,-1
v_mov_b32 v21,0
v_mov_b32 v30,-1
v_mov_b32 v22,0
v_mov_b32 v31,-1
v_mov_b32 v23,0
s_load_dwordx8 s[36:43],s[0:1],16
s_cmp_eq_u32 s58,220
s_cbranch_scc1 npf_16
s_lshl_b32 s64,s59,2
s_add_u32 s64,s64,s50
v_lshlrev_b32 v16,10,v1
v_lshlrev_b32 v17,7,v1
s_waitcnt lgkmcnt(0)
s_mov_b32 s68,s36
s_and_b32 s69,s37,0xffff
s_mov_b32 s70,0x800000
s_mov_b32 s71,0x20000
s_mov_b32 s72,s38
s_and_b32 s73,s39,0xffff
s_mov_b32 s74,0x800000
s_mov_b32 s75,0x20000
s_mov_b32 s76,s40
s_and_b32 s77,s41,0xffff
s_mov_b32 s78,0x800000
s_mov_b32 s79,0x20000
s_mov_b32 s92,s42
s_and_b32 s93,s43,0xffff
s_mov_b32 s94,0x800000
s_mov_b32 s95,0x20000
s_and_b32 s65,s64,127
s_lshl_b32 s65,s65,16
s_add_u32 s65,s65,384
s_cmp_ge_u32 s64,128
s_cselect_b64 s[44:45],s[72:73],s[68:69]
s_cselect_b64 s[46:47],s[74:75],s[70:71]
buffer_load_dword v26,v16,s[44:47],s65 offen
s_cselect_b64 s[44:45],s[92:93],s[76:77]
buffer_load_dword v26,v16,s[44:47],s65 offen
v_lshlrev_b32 v19,13,v1
s_and_b32 s65,s64,15
s_lshl_b32 s65,s65,19
s_add_u32 s65,s65,8064
s_cmp_ge_u32 s64,16
s_cselect_b64 s[44:45],s[72:73],s[68:69]
s_cmp_ge_u32 s64,32
s_cselect_b64 s[44:45],s[76:77],s[44:45]
s_cmp_ge_u32 s64,48
s_cselect_b32 s65,2.0,s65
buffer_load_dword v26,v19,s[44:47],s65 offen
s_lshl_b32 s65,s64,13
npf_16:
s_mov_b32 s73,0xffff0000
s_cmp_eq_u32 s58,220
s_cbranch_scc1 fl2_18
s_mov_b32 s62,s59
fl1_17:
s_lshl_b32 s64,s62,2
s_add_u32 s64,s64,s50
s_mul_i32 s64,s64,2048
s_add_u32 s64,s64,142606336
buffer_store_dwordx4 v[28:31],v24,s[20:23],s64 offen offset:0 sc1
buffer_store_dwordx4 v[28:31],v24,s[20:23],s64 offen offset:1024 sc1
s_lshl_b32 s64,s62,2
s_add_u32 s64,s64,s50
s_lshr_b32 s65,s64,6
s_lshl_b32 s65,s65,19
s_and_b32 s64,s64,63
s_mul_i32 s64,s64,2048
s_add_u32 s64,s64,134217728
s_add_u32 s64,s64,s65
buffer_store_dwordx4 v[28:31],v24,s[20:23],s64 offen offset:0 sc1
buffer_store_dwordx4 v[28:31],v24,s[20:23],s64 offen offset:1024 sc1
s_lshl_b32 s64,s62,2
s_add_u32 s64,s64,s50
s_lshr_b32 s65,s64,6
s_lshl_b32 s65,s65,19
s_and_b32 s64,s64,63
s_mul_i32 s64,s64,4096
s_add_u32 s64,s64,134479872
s_add_u32 s64,s64,s65
buffer_store_dwordx4 v[28:31],v24,s[20:23],s64 offen offset:0 sc1
buffer_store_dwordx4 v[28:31],v24,s[20:23],s64 offen offset:1024 sc1
buffer_store_dwordx4 v[28:31],v24,s[20:23],s64 offen offset:2048 sc1
buffer_store_dwordx4 v[28:31],v24,s[20:23],s64 offen offset:3072 sc1
s_lshl_b32 s64,s62,2
s_add_u32 s64,s64,s50
s_mul_i32 s64,s64,1024
s_add_u32 s64,s64,138412032
buffer_store_dwordx4 v[20:23],v24,s[20:23],s64 offen offset:0 sc1
s_cmp_eq_u32 s62,29
s_mov_b32 s62,28
s_cbranch_scc1 fl1_17
fl2_18:
s_waitcnt vmcnt(0)
s_barrier
s_cmp_lg_u32 s50,0
s_cbranch_scc1 sig_19
s_mov_b32 s92,s2
s_and_b32 s93,s3,0xffff
s_mov_b32 s94,0x100
s_mov_b32 s95,0x20000
s_add_u32 s64,s88,24
s_add_u32 s65,s88,32
s_cmp_eq_u32 s58,220
s_cselect_b32 s64,s65,s64
v_mov_b32 v16,1
s_mov_b64 exec,1
buffer_atomic_add v16,off,s[92:95],s64 sc1
s_mov_b64 exec,-1
sig_19:
s_mov_b32 s92,s2
s_and_b32 s93,s3,0xffff
s_mov_b32 s94,0x100
s_mov_b32 s95,0x20000
v_mbcnt_lo_u32_b32 v16,-1,0
v_mbcnt_hi_u32_b32 v16,-1,v16
v_mov_b32 v18,0
v_and_b32 v19,1,v16
v_cmp_eq_u32 vcc,1,v19
v_mov_b32 v19,8192
s_nop 0
v_cndmask_b32 v19,-1,v19,vcc
v_min_u32 v16,31,v16
v_lshlrev_b32 v16,2,v16
s_sub_u32 s66,s88,64
s_cmp_lg_u32 s50,0
s_cbranch_scc1 vot_24
s_mov_b32 s64,13
pre_26:
s_sleep 32
s_sub_u32 s64,s64,1
s_cmp_gt_i32 s64,0
s_cbranch_scc1 pre_26
vpoll_20:
buffer_load_dword v17,v16,s[92:95],s66 offen sc1
s_waitcnt vmcnt(0)
s_cmp_lg_u32 s56,2
s_cbranch_scc1 vck_21
v_cmp_eq_u32 vcc,v17,v19
s_and_b32 s64,vcc_lo,0xffff
s_cmp_eq_u32 s64,65535
s_cbranch_scc1 vck_21
s_mov_b32 s65,0
v_readlane_b32 s64,v17,1
s_lshr_b32 s64,s64,8
s_add_u32 s65,s65,s64
v_readlane_b32 s64,v17,3
s_lshr_b32 s64,s64,8
s_add_u32 s65,s65,s64
v_readlane_b32 s64,v17,5
s_lshr_b32 s64,s64,8
s_add_u32 s65,s65,s64
v_readlane_b32 s64,v17,7
s_lshr_b32 s64,s64,8
s_add_u32 s65,s65,s64
v_readlane_b32 s64,v17,9
s_lshr_b32 s64,s64,8
s_add_u32 s65,s65,s64
v_readlane_b32 s64,v17,11
s_lshr_b32 s64,s64,8
s_add_u32 s65,s65,s64
v_readlane_b32 s64,v17,13
s_lshr_b32 s64,s64,8
s_add_u32 s65,s65,s64
v_readlane_b32 s64,v17,15
s_lshr_b32 s64,s64,8
s_add_u32 s65,s65,s64
s_cmp_ge_u32 s65,256
s_cbranch_scc1 vok_23
s_branch vrt_22
vck_21:
v_cmp_gt_u32 vcc,v18,v17
s_cbranch_vccz vok_23
vrt_22:
s_sleep 48
s_sub_u32 s90,s90,1
s_cmp_gt_i32 s90,0
s_cbranch_scc1 vpoll_20
vok_23:
v_add_u32 v18,160256,v16
ds_write_b32 v18,v17
s_waitcnt lgkmcnt(0)
vot_24:
s_barrier
v_add_u32 v18,160256,v16
ds_read_b32 v17,v18
s_waitcnt lgkmcnt(0)
s_cmp_lg_u32 s56,2
s_cbranch_scc1 vfin_25
v_cmp_eq_u32 vcc,v17,v19
s_and_b32 s64,vcc_lo,0xffff
s_cmp_eq_u32 s64,65535
s_cbranch_scc1 vfin_25
s_mov_b32 s65,0
v_readlane_b32 s64,v17,1
s_lshr_b32 s64,s64,8
s_add_u32 s65,s65,s64
v_readlane_b32 s64,v17,3
s_lshr_b32 s64,s64,8
s_add_u32 s65,s65,s64
v_readlane_b32 s64,v17,5
s_lshr_b32 s64,s64,8
s_add_u32 s65,s65,s64
v_readlane_b32 s64,v17,7
s_lshr_b32 s64,s64,8
s_add_u32 s65,s65,s64
v_readlane_b32 s64,v17,9
s_lshr_b32 s64,s64,8
s_add_u32 s65,s65,s64
v_readlane_b32 s64,v17,11
s_lshr_b32 s64,s64,8
s_add_u32 s65,s65,s64
v_readlane_b32 s64,v17,13
s_lshr_b32 s64,s64,8
s_add_u32 s65,s65,s64
v_readlane_b32 s64,v17,15
s_lshr_b32 s64,s64,8
s_add_u32 s65,s65,s64
s_cmp_ge_u32 s65,256
s_cbranch_scc1 fl_fb
vfin_25:
s_and_b32 s56,s56,1
buffer_load_ushort v16,v15,s[24:27],s55 offen
buffer_load_dwordx4 v[96:99],v13,s[28:31],s54 offen offset:0
buffer_load_dwordx4 v[160:163],v13,s[28:31],s54 offen offset:256
s_add_u32 s54,s54,12288
s_waitcnt vmcnt(2)
buffer_load_dwordx4 v[100:103],v13,s[28:31],s54 offen offset:0
buffer_load_dwordx4 v[164:167],v13,s[28:31],s54 offen offset:256
s_add_u32 s54,s54,12288
s_waitcnt vmcnt(2)
buffer_load_dwordx4 v[104:107],v13,s[28:31],s54 offen offset:0
buffer_load_dwordx4 v[168:171],v13,s[28:31],s54 offen offset:256
s_add_u32 s54,s54,12288
s_waitcnt vmcnt(2)
buffer_load_dwordx4 v[108:111],v13,s[28:31],s54 offen offset:0
buffer_load_dwordx4 v[172:175],v13,s[28:31],s54 offen offset:256
s_add_u32 s54,s54,12288
s_waitcnt vmcnt(2)
buffer_load_dwordx4 v[112:115],v13,s[28:31],s54 offen offset:0
buffer_load_dwordx4 v[176:179],v13,s[28:31],s54 offen offset:256
s_add_u32 s54,s54,12288
s_waitcnt vmcnt(2)
buffer_load_dwordx4 v[116:119],v13,s[28:31],s54 offen offset:0
buffer_load_dwordx4 v[180:183],v13,s[28:31],s54 offen offset:256
s_add_u32 s54,s54,12288
s_waitcnt vmcnt(2)
buffer_load_dwordx4 v[120:123],v13,s[28:31],s54 offen offset:0
buffer_load_dwordx4 v[184:187],v13,s[28:31],s54 offen offset:256
s_add_u32 s54,s54,12288
s_waitcnt vmcnt(2)
buffer_load_dwordx4 v[124:127],v13,s[28:31],s54 offen offset:0
buffer_load_dwordx4 v[188:191],v13,s[28:31],s54 offen offset:256
s_add_u32 s54,s54,12288
s_waitcnt vmcnt(2)
buffer_load_dwordx4 v[128:131],v13,s[28:31],s54 offen offset:0
buffer_load_dwordx4 v[192:195],v13,s[28:31],s54 offen offset:256
s_add_u32 s54,s54,12288
s_waitcnt vmcnt(2)
buffer_load_dwordx4 v[132:135],v13,s[28:31],s54 offen offset:0
buffer_load_dwordx4 v[196:199],v13,s[28:31],s54 offen offset:256
s_add_u32 s54,s54,12288
s_waitcnt vmcnt(2)
buffer_load_dwordx4 v[136:139],v13,s[28:31],s54 offen offset:0
buffer_load_dwordx4 v[200:203],v13,s[28:31],s54 offen offset:256
s_add_u32 s54,s54,12288
s_waitcnt vmcnt(2)
buffer_load_dwordx4 v[140:143],v13,s[28:31],s54 offen offset:0
buffer_load_dwordx4 v[204:207],v13,s[28:31],s54 offen offset:256
s_add_u32 s54,s54,12288
s_waitcnt vmcnt(2)
buffer_load_dwordx4 v[144:147],v13,s[28:31],s54 offen offset:0
buffer_load_dwordx4 v[208:211],v13,s[28:31],s54 offen offset:256
s_add_u32 s54,s54,12288
s_waitcnt vmcnt(2)
buffer_load_dwordx4 v[148:151],v13,s[28:31],s54 offen offset:0
buffer_load_dwordx4 v[212:215],v13,s[28:31],s54 offen offset:256
s_add_u32 s54,s54,12288
s_waitcnt vmcnt(2)
buffer_load_dwordx4 v[152:155],v13,s[28:31],s54 offen offset:0
buffer_load_dwordx4 v[216:219],v13,s[28:31],s54 offen offset:256
s_add_u32 s54,s54,12288
s_waitcnt vmcnt(2)
buffer_load_dwordx4 v[156:159],v13,s[28:31],s54 offen offset:0
buffer_load_dwordx4 v[220:223],v13,s[28:31],s54 offen offset:256
s_waitcnt vmcnt(2)
s_add_u32 s64,s61,0
buffer_load_dwordx4 v[48:51],v8,s[32:35],s64 offen offset:0
buffer_load_dwordx4 v[52:55],v8,s[32:35],s64 offen offset:256
s_add_u32 s64,s61,8192
buffer_load_dwordx4 v[56:59],v8,s[32:35],s64 offen offset:0
buffer_load_dwordx4 v[60:63],v8,s[32:35],s64 offen offset:256
s_add_u32 s64,s61,16384
buffer_load_dwordx4 v[64:67],v8,s[32:35],s64 offen offset:0
buffer_load_dwordx4 v[68:71],v8,s[32:35],s64 offen offset:256
s_add_u32 s64,s61,24576
buffer_load_dwordx4 v[72:75],v8,s[32:35],s64 offen offset:0
buffer_load_dwordx4 v[76:79],v8,s[32:35],s64 offen offset:256
s_waitcnt vmcnt(40)
v_lshlrev_b32 v16,16,v16
v_mul_f32 v17,0xbfb8aa3b,v16
v_exp_f32 v17,v17
s_nop 0
v_add_f32 v17,1.0,v17
v_rcp_f32 v17,v17
s_nop 0
v_mul_f32 v17,v17,v16
v_cvt_pk_bf16_f32 v17,v17,v17
v_and_b32 v17,s73,v17
v_lshlrev_b32 v18,2,v14
ds_write_b32 v18,v17 offset:8192
s_waitcnt lgkmcnt(0)
s_barrier
ds_read_b128 v[32:35],v25 offset:8192
ds_read_b128 v[36:39],v25 offset:8208
ds_read_b128 v[40:43],v25 offset:8224
ds_read_b128 v[44:47],v25 offset:8240
v_mov_b32 v80,0
v_mov_b32 v81,0
v_mov_b32 v82,0
v_mov_b32 v83,0
v_mov_b32 v84,0
v_mov_b32 v85,0
v_mov_b32 v86,0
v_mov_b32 v87,0
v_mov_b32 v88,0
v_mov_b32 v89,0
v_mov_b32 v90,0
v_mov_b32 v91,0
v_mov_b32 v92,0
v_mov_b32 v93,0
v_mov_b32 v94,0
v_mov_b32 v95,0
s_waitcnt lgkmcnt(0)
s_waitcnt vmcnt(39)
v_lshlrev_b32 v16,16,v96
v_and_b32 v17,s73,v96
v_pk_fma_f32 v[80:81],v[16:17],v[32:33],v[80:81] op_sel:[0,0,0] op_sel_hi:[1,0,1]
v_lshlrev_b32 v18,16,v97
v_and_b32 v19,s73,v97
v_pk_fma_f32 v[82:83],v[18:19],v[32:33],v[82:83] op_sel:[0,0,0] op_sel_hi:[1,0,1]
v_lshlrev_b32 v16,16,v98
v_and_b32 v17,s73,v98
v_pk_fma_f32 v[84:85],v[16:17],v[32:33],v[84:85] op_sel:[0,0,0] op_sel_hi:[1,0,1]
v_lshlrev_b32 v18,16,v99
v_and_b32 v19,s73,v99
v_pk_fma_f32 v[86:87],v[18:19],v[32:33],v[86:87] op_sel:[0,0,0] op_sel_hi:[1,0,1]
s_waitcnt vmcnt(38)
v_lshlrev_b32 v16,16,v160
v_and_b32 v17,s73,v160
v_pk_fma_f32 v[88:89],v[16:17],v[32:33],v[88:89] op_sel:[0,0,0] op_sel_hi:[1,0,1]
v_lshlrev_b32 v18,16,v161
v_and_b32 v19,s73,v161
v_pk_fma_f32 v[90:91],v[18:19],v[32:33],v[90:91] op_sel:[0,0,0] op_sel_hi:[1,0,1]
v_lshlrev_b32 v16,16,v162
v_and_b32 v17,s73,v162
v_pk_fma_f32 v[92:93],v[16:17],v[32:33],v[92:93] op_sel:[0,0,0] op_sel_hi:[1,0,1]
v_lshlrev_b32 v18,16,v163
v_and_b32 v19,s73,v163
v_pk_fma_f32 v[94:95],v[18:19],v[32:33],v[94:95] op_sel:[0,0,0] op_sel_hi:[1,0,1]
s_waitcnt vmcnt(37)
v_lshlrev_b32 v16,16,v100
v_and_b32 v17,s73,v100
v_pk_fma_f32 v[80:81],v[16:17],v[32:33],v[80:81] op_sel:[0,1,0] op_sel_hi:[1,1,1]
v_lshlrev_b32 v18,16,v101
v_and_b32 v19,s73,v101
v_pk_fma_f32 v[82:83],v[18:19],v[32:33],v[82:83] op_sel:[0,1,0] op_sel_hi:[1,1,1]
v_lshlrev_b32 v16,16,v102
v_and_b32 v17,s73,v102
v_pk_fma_f32 v[84:85],v[16:17],v[32:33],v[84:85] op_sel:[0,1,0] op_sel_hi:[1,1,1]
v_lshlrev_b32 v18,16,v103
v_and_b32 v19,s73,v103
v_pk_fma_f32 v[86:87],v[18:19],v[32:33],v[86:87] op_sel:[0,1,0] op_sel_hi:[1,1,1]
s_waitcnt vmcnt(36)
v_lshlrev_b32 v16,16,v164
v_and_b32 v17,s73,v164
v_pk_fma_f32 v[88:89],v[16:17],v[32:33],v[88:89] op_sel:[0,1,0] op_sel_hi:[1,1,1]
v_lshlrev_b32 v18,16,v165
v_and_b32 v19,s73,v165
v_pk_fma_f32 v[90:91],v[18:19],v[32:33],v[90:91] op_sel:[0,1,0] op_sel_hi:[1,1,1]
v_lshlrev_b32 v16,16,v166
v_and_b32 v17,s73,v166
v_pk_fma_f32 v[92:93],v[16:17],v[32:33],v[92:93] op_sel:[0,1,0] op_sel_hi:[1,1,1]
v_lshlrev_b32 v18,16,v167
v_and_b32 v19,s73,v167
v_pk_fma_f32 v[94:95],v[18:19],v[32:33],v[94:95] op_sel:[0,1,0] op_sel_hi:[1,1,1]
s_waitcnt vmcnt(35)
v_lshlrev_b32 v16,16,v104
v_and_b32 v17,s73,v104
v_pk_fma_f32 v[80:81],v[16:17],v[34:35],v[80:81] op_sel:[0,0,0] op_sel_hi:[1,0,1]
v_lshlrev_b32 v18,16,v105
v_and_b32 v19,s73,v105
v_pk_fma_f32 v[82:83],v[18:19],v[34:35],v[82:83] op_sel:[0,0,0] op_sel_hi:[1,0,1]
v_lshlrev_b32 v16,16,v106
v_and_b32 v17,s73,v106
v_pk_fma_f32 v[84:85],v[16:17],v[34:35],v[84:85] op_sel:[0,0,0] op_sel_hi:[1,0,1]
v_lshlrev_b32 v18,16,v107
v_and_b32 v19,s73,v107
v_pk_fma_f32 v[86:87],v[18:19],v[34:35],v[86:87] op_sel:[0,0,0] op_sel_hi:[1,0,1]
s_waitcnt vmcnt(34)
v_lshlrev_b32 v16,16,v168
v_and_b32 v17,s73,v168
v_pk_fma_f32 v[88:89],v[16:17],v[34:35],v[88:89] op_sel:[0,0,0] op_sel_hi:[1,0,1]
v_lshlrev_b32 v18,16,v169
v_and_b32 v19,s73,v169
v_pk_fma_f32 v[90:91],v[18:19],v[34:35],v[90:91] op_sel:[0,0,0] op_sel_hi:[1,0,1]
v_lshlrev_b32 v16,16,v170
v_and_b32 v17,s73,v170
v_pk_fma_f32 v[92:93],v[16:17],v[34:35],v[92:93] op_sel:[0,0,0] op_sel_hi:[1,0,1]
v_lshlrev_b32 v18,16,v171
v_and_b32 v19,s73,v171
v_pk_fma_f32 v[94:95],v[18:19],v[34:35],v[94:95] op_sel:[0,0,0] op_sel_hi:[1,0,1]
s_waitcnt vmcnt(33)
v_lshlrev_b32 v16,16,v108
v_and_b32 v17,s73,v108
v_pk_fma_f32 v[80:81],v[16:17],v[34:35],v[80:81] op_sel:[0,1,0] op_sel_hi:[1,1,1]
v_lshlrev_b32 v18,16,v109
v_and_b32 v19,s73,v109
v_pk_fma_f32 v[82:83],v[18:19],v[34:35],v[82:83] op_sel:[0,1,0] op_sel_hi:[1,1,1]
v_lshlrev_b32 v16,16,v110
v_and_b32 v17,s73,v110
v_pk_fma_f32 v[84:85],v[16:17],v[34:35],v[84:85] op_sel:[0,1,0] op_sel_hi:[1,1,1]
v_lshlrev_b32 v18,16,v111
v_and_b32 v19,s73,v111
v_pk_fma_f32 v[86:87],v[18:19],v[34:35],v[86:87] op_sel:[0,1,0] op_sel_hi:[1,1,1]
s_waitcnt vmcnt(32)
v_lshlrev_b32 v16,16,v172
v_and_b32 v17,s73,v172
v_pk_fma_f32 v[88:89],v[16:17],v[34:35],v[88:89] op_sel:[0,1,0] op_sel_hi:[1,1,1]
v_lshlrev_b32 v18,16,v173
v_and_b32 v19,s73,v173
v_pk_fma_f32 v[90:91],v[18:19],v[34:35],v[90:91] op_sel:[0,1,0] op_sel_hi:[1,1,1]
v_lshlrev_b32 v16,16,v174
v_and_b32 v17,s73,v174
v_pk_fma_f32 v[92:93],v[16:17],v[34:35],v[92:93] op_sel:[0,1,0] op_sel_hi:[1,1,1]
v_lshlrev_b32 v18,16,v175
v_and_b32 v19,s73,v175
v_pk_fma_f32 v[94:95],v[18:19],v[34:35],v[94:95] op_sel:[0,1,0] op_sel_hi:[1,1,1]
s_waitcnt vmcnt(31)
v_lshlrev_b32 v16,16,v112
v_and_b32 v17,s73,v112
v_pk_fma_f32 v[80:81],v[16:17],v[36:37],v[80:81] op_sel:[0,0,0] op_sel_hi:[1,0,1]
v_lshlrev_b32 v18,16,v113
v_and_b32 v19,s73,v113
v_pk_fma_f32 v[82:83],v[18:19],v[36:37],v[82:83] op_sel:[0,0,0] op_sel_hi:[1,0,1]
v_lshlrev_b32 v16,16,v114
v_and_b32 v17,s73,v114
v_pk_fma_f32 v[84:85],v[16:17],v[36:37],v[84:85] op_sel:[0,0,0] op_sel_hi:[1,0,1]
v_lshlrev_b32 v18,16,v115
v_and_b32 v19,s73,v115
v_pk_fma_f32 v[86:87],v[18:19],v[36:37],v[86:87] op_sel:[0,0,0] op_sel_hi:[1,0,1]
s_waitcnt vmcnt(30)
v_lshlrev_b32 v16,16,v176
v_and_b32 v17,s73,v176
v_pk_fma_f32 v[88:89],v[16:17],v[36:37],v[88:89] op_sel:[0,0,0] op_sel_hi:[1,0,1]
v_lshlrev_b32 v18,16,v177
v_and_b32 v19,s73,v177
v_pk_fma_f32 v[90:91],v[18:19],v[36:37],v[90:91] op_sel:[0,0,0] op_sel_hi:[1,0,1]
v_lshlrev_b32 v16,16,v178
v_and_b32 v17,s73,v178
v_pk_fma_f32 v[92:93],v[16:17],v[36:37],v[92:93] op_sel:[0,0,0] op_sel_hi:[1,0,1]
v_lshlrev_b32 v18,16,v179
v_and_b32 v19,s73,v179
v_pk_fma_f32 v[94:95],v[18:19],v[36:37],v[94:95] op_sel:[0,0,0] op_sel_hi:[1,0,1]
s_waitcnt vmcnt(29)
v_lshlrev_b32 v16,16,v116
v_and_b32 v17,s73,v116
v_pk_fma_f32 v[80:81],v[16:17],v[36:37],v[80:81] op_sel:[0,1,0] op_sel_hi:[1,1,1]
v_lshlrev_b32 v18,16,v117
v_and_b32 v19,s73,v117
v_pk_fma_f32 v[82:83],v[18:19],v[36:37],v[82:83] op_sel:[0,1,0] op_sel_hi:[1,1,1]
v_lshlrev_b32 v16,16,v118
v_and_b32 v17,s73,v118
v_pk_fma_f32 v[84:85],v[16:17],v[36:37],v[84:85] op_sel:[0,1,0] op_sel_hi:[1,1,1]
v_lshlrev_b32 v18,16,v119
v_and_b32 v19,s73,v119
v_pk_fma_f32 v[86:87],v[18:19],v[36:37],v[86:87] op_sel:[0,1,0] op_sel_hi:[1,1,1]
s_waitcnt vmcnt(28)
v_lshlrev_b32 v16,16,v180
v_and_b32 v17,s73,v180
v_pk_fma_f32 v[88:89],v[16:17],v[36:37],v[88:89] op_sel:[0,1,0] op_sel_hi:[1,1,1]
v_lshlrev_b32 v18,16,v181
v_and_b32 v19,s73,v181
v_pk_fma_f32 v[90:91],v[18:19],v[36:37],v[90:91] op_sel:[0,1,0] op_sel_hi:[1,1,1]
v_lshlrev_b32 v16,16,v182
v_and_b32 v17,s73,v182
v_pk_fma_f32 v[92:93],v[16:17],v[36:37],v[92:93] op_sel:[0,1,0] op_sel_hi:[1,1,1]
v_lshlrev_b32 v18,16,v183
v_and_b32 v19,s73,v183
v_pk_fma_f32 v[94:95],v[18:19],v[36:37],v[94:95] op_sel:[0,1,0] op_sel_hi:[1,1,1]
s_waitcnt vmcnt(27)
v_lshlrev_b32 v16,16,v120
v_and_b32 v17,s73,v120
v_pk_fma_f32 v[80:81],v[16:17],v[38:39],v[80:81] op_sel:[0,0,0] op_sel_hi:[1,0,1]
v_lshlrev_b32 v18,16,v121
v_and_b32 v19,s73,v121
v_pk_fma_f32 v[82:83],v[18:19],v[38:39],v[82:83] op_sel:[0,0,0] op_sel_hi:[1,0,1]
v_lshlrev_b32 v16,16,v122
v_and_b32 v17,s73,v122
v_pk_fma_f32 v[84:85],v[16:17],v[38:39],v[84:85] op_sel:[0,0,0] op_sel_hi:[1,0,1]
v_lshlrev_b32 v18,16,v123
v_and_b32 v19,s73,v123
v_pk_fma_f32 v[86:87],v[18:19],v[38:39],v[86:87] op_sel:[0,0,0] op_sel_hi:[1,0,1]
s_waitcnt vmcnt(26)
v_lshlrev_b32 v16,16,v184
v_and_b32 v17,s73,v184
v_pk_fma_f32 v[88:89],v[16:17],v[38:39],v[88:89] op_sel:[0,0,0] op_sel_hi:[1,0,1]
v_lshlrev_b32 v18,16,v185
v_and_b32 v19,s73,v185
v_pk_fma_f32 v[90:91],v[18:19],v[38:39],v[90:91] op_sel:[0,0,0] op_sel_hi:[1,0,1]
v_lshlrev_b32 v16,16,v186
v_and_b32 v17,s73,v186
v_pk_fma_f32 v[92:93],v[16:17],v[38:39],v[92:93] op_sel:[0,0,0] op_sel_hi:[1,0,1]
v_lshlrev_b32 v18,16,v187
v_and_b32 v19,s73,v187
v_pk_fma_f32 v[94:95],v[18:19],v[38:39],v[94:95] op_sel:[0,0,0] op_sel_hi:[1,0,1]
s_waitcnt vmcnt(25)
v_lshlrev_b32 v16,16,v124
v_and_b32 v17,s73,v124
v_pk_fma_f32 v[80:81],v[16:17],v[38:39],v[80:81] op_sel:[0,1,0] op_sel_hi:[1,1,1]
v_lshlrev_b32 v18,16,v125
v_and_b32 v19,s73,v125
v_pk_fma_f32 v[82:83],v[18:19],v[38:39],v[82:83] op_sel:[0,1,0] op_sel_hi:[1,1,1]
v_lshlrev_b32 v16,16,v126
v_and_b32 v17,s73,v126
v_pk_fma_f32 v[84:85],v[16:17],v[38:39],v[84:85] op_sel:[0,1,0] op_sel_hi:[1,1,1]
v_lshlrev_b32 v18,16,v127
v_and_b32 v19,s73,v127
v_pk_fma_f32 v[86:87],v[18:19],v[38:39],v[86:87] op_sel:[0,1,0] op_sel_hi:[1,1,1]
s_waitcnt vmcnt(24)
v_lshlrev_b32 v16,16,v188
v_and_b32 v17,s73,v188
v_pk_fma_f32 v[88:89],v[16:17],v[38:39],v[88:89] op_sel:[0,1,0] op_sel_hi:[1,1,1]
v_lshlrev_b32 v18,16,v189
v_and_b32 v19,s73,v189
v_pk_fma_f32 v[90:91],v[18:19],v[38:39],v[90:91] op_sel:[0,1,0] op_sel_hi:[1,1,1]
v_lshlrev_b32 v16,16,v190
v_and_b32 v17,s73,v190
v_pk_fma_f32 v[92:93],v[16:17],v[38:39],v[92:93] op_sel:[0,1,0] op_sel_hi:[1,1,1]
v_lshlrev_b32 v18,16,v191
v_and_b32 v19,s73,v191
v_pk_fma_f32 v[94:95],v[18:19],v[38:39],v[94:95] op_sel:[0,1,0] op_sel_hi:[1,1,1]
s_waitcnt vmcnt(23)
v_lshlrev_b32 v16,16,v128
v_and_b32 v17,s73,v128
v_pk_fma_f32 v[80:81],v[16:17],v[40:41],v[80:81] op_sel:[0,0,0] op_sel_hi:[1,0,1]
v_lshlrev_b32 v18,16,v129
v_and_b32 v19,s73,v129
v_pk_fma_f32 v[82:83],v[18:19],v[40:41],v[82:83] op_sel:[0,0,0] op_sel_hi:[1,0,1]
v_lshlrev_b32 v16,16,v130
v_and_b32 v17,s73,v130
v_pk_fma_f32 v[84:85],v[16:17],v[40:41],v[84:85] op_sel:[0,0,0] op_sel_hi:[1,0,1]
v_lshlrev_b32 v18,16,v131
v_and_b32 v19,s73,v131
v_pk_fma_f32 v[86:87],v[18:19],v[40:41],v[86:87] op_sel:[0,0,0] op_sel_hi:[1,0,1]
s_waitcnt vmcnt(22)
v_lshlrev_b32 v16,16,v192
v_and_b32 v17,s73,v192
v_pk_fma_f32 v[88:89],v[16:17],v[40:41],v[88:89] op_sel:[0,0,0] op_sel_hi:[1,0,1]
v_lshlrev_b32 v18,16,v193
v_and_b32 v19,s73,v193
v_pk_fma_f32 v[90:91],v[18:19],v[40:41],v[90:91] op_sel:[0,0,0] op_sel_hi:[1,0,1]
v_lshlrev_b32 v16,16,v194
v_and_b32 v17,s73,v194
v_pk_fma_f32 v[92:93],v[16:17],v[40:41],v[92:93] op_sel:[0,0,0] op_sel_hi:[1,0,1]
v_lshlrev_b32 v18,16,v195
v_and_b32 v19,s73,v195
v_pk_fma_f32 v[94:95],v[18:19],v[40:41],v[94:95] op_sel:[0,0,0] op_sel_hi:[1,0,1]
s_waitcnt vmcnt(21)
v_lshlrev_b32 v16,16,v132
v_and_b32 v17,s73,v132
v_pk_fma_f32 v[80:81],v[16:17],v[40:41],v[80:81] op_sel:[0,1,0] op_sel_hi:[1,1,1]
v_lshlrev_b32 v18,16,v133
v_and_b32 v19,s73,v133
v_pk_fma_f32 v[82:83],v[18:19],v[40:41],v[82:83] op_sel:[0,1,0] op_sel_hi:[1,1,1]
v_lshlrev_b32 v16,16,v134
v_and_b32 v17,s73,v134
v_pk_fma_f32 v[84:85],v[16:17],v[40:41],v[84:85] op_sel:[0,1,0] op_sel_hi:[1,1,1]
v_lshlrev_b32 v18,16,v135
v_and_b32 v19,s73,v135
v_pk_fma_f32 v[86:87],v[18:19],v[40:41],v[86:87] op_sel:[0,1,0] op_sel_hi:[1,1,1]
s_waitcnt vmcnt(20)
v_lshlrev_b32 v16,16,v196
v_and_b32 v17,s73,v196
v_pk_fma_f32 v[88:89],v[16:17],v[40:41],v[88:89] op_sel:[0,1,0] op_sel_hi:[1,1,1]
v_lshlrev_b32 v18,16,v197
v_and_b32 v19,s73,v197
v_pk_fma_f32 v[90:91],v[18:19],v[40:41],v[90:91] op_sel:[0,1,0] op_sel_hi:[1,1,1]
v_lshlrev_b32 v16,16,v198
v_and_b32 v17,s73,v198
v_pk_fma_f32 v[92:93],v[16:17],v[40:41],v[92:93] op_sel:[0,1,0] op_sel_hi:[1,1,1]
v_lshlrev_b32 v18,16,v199
v_and_b32 v19,s73,v199
v_pk_fma_f32 v[94:95],v[18:19],v[40:41],v[94:95] op_sel:[0,1,0] op_sel_hi:[1,1,1]
s_waitcnt vmcnt(19)
v_lshlrev_b32 v16,16,v136
v_and_b32 v17,s73,v136
v_pk_fma_f32 v[80:81],v[16:17],v[42:43],v[80:81] op_sel:[0,0,0] op_sel_hi:[1,0,1]
v_lshlrev_b32 v18,16,v137
v_and_b32 v19,s73,v137
v_pk_fma_f32 v[82:83],v[18:19],v[42:43],v[82:83] op_sel:[0,0,0] op_sel_hi:[1,0,1]
v_lshlrev_b32 v16,16,v138
v_and_b32 v17,s73,v138
v_pk_fma_f32 v[84:85],v[16:17],v[42:43],v[84:85] op_sel:[0,0,0] op_sel_hi:[1,0,1]
v_lshlrev_b32 v18,16,v139
v_and_b32 v19,s73,v139
v_pk_fma_f32 v[86:87],v[18:19],v[42:43],v[86:87] op_sel:[0,0,0] op_sel_hi:[1,0,1]
s_waitcnt vmcnt(18)
v_lshlrev_b32 v16,16,v200
v_and_b32 v17,s73,v200
v_pk_fma_f32 v[88:89],v[16:17],v[42:43],v[88:89] op_sel:[0,0,0] op_sel_hi:[1,0,1]
v_lshlrev_b32 v18,16,v201
v_and_b32 v19,s73,v201
v_pk_fma_f32 v[90:91],v[18:19],v[42:43],v[90:91] op_sel:[0,0,0] op_sel_hi:[1,0,1]
v_lshlrev_b32 v16,16,v202
v_and_b32 v17,s73,v202
v_pk_fma_f32 v[92:93],v[16:17],v[42:43],v[92:93] op_sel:[0,0,0] op_sel_hi:[1,0,1]
v_lshlrev_b32 v18,16,v203
v_and_b32 v19,s73,v203
v_pk_fma_f32 v[94:95],v[18:19],v[42:43],v[94:95] op_sel:[0,0,0] op_sel_hi:[1,0,1]
s_waitcnt vmcnt(17)
v_lshlrev_b32 v16,16,v140
v_and_b32 v17,s73,v140
v_pk_fma_f32 v[80:81],v[16:17],v[42:43],v[80:81] op_sel:[0,1,0] op_sel_hi:[1,1,1]
v_lshlrev_b32 v18,16,v141
v_and_b32 v19,s73,v141
v_pk_fma_f32 v[82:83],v[18:19],v[42:43],v[82:83] op_sel:[0,1,0] op_sel_hi:[1,1,1]
v_lshlrev_b32 v16,16,v142
v_and_b32 v17,s73,v142
v_pk_fma_f32 v[84:85],v[16:17],v[42:43],v[84:85] op_sel:[0,1,0] op_sel_hi:[1,1,1]
v_lshlrev_b32 v18,16,v143
v_and_b32 v19,s73,v143
v_pk_fma_f32 v[86:87],v[18:19],v[42:43],v[86:87] op_sel:[0,1,0] op_sel_hi:[1,1,1]
s_waitcnt vmcnt(16)
v_lshlrev_b32 v16,16,v204
v_and_b32 v17,s73,v204
v_pk_fma_f32 v[88:89],v[16:17],v[42:43],v[88:89] op_sel:[0,1,0] op_sel_hi:[1,1,1]
v_lshlrev_b32 v18,16,v205
v_and_b32 v19,s73,v205
v_pk_fma_f32 v[90:91],v[18:19],v[42:43],v[90:91] op_sel:[0,1,0] op_sel_hi:[1,1,1]
v_lshlrev_b32 v16,16,v206
v_and_b32 v17,s73,v206
v_pk_fma_f32 v[92:93],v[16:17],v[42:43],v[92:93] op_sel:[0,1,0] op_sel_hi:[1,1,1]
v_lshlrev_b32 v18,16,v207
v_and_b32 v19,s73,v207
v_pk_fma_f32 v[94:95],v[18:19],v[42:43],v[94:95] op_sel:[0,1,0] op_sel_hi:[1,1,1]
s_waitcnt vmcnt(15)
v_lshlrev_b32 v16,16,v144
v_and_b32 v17,s73,v144
v_pk_fma_f32 v[80:81],v[16:17],v[44:45],v[80:81] op_sel:[0,0,0] op_sel_hi:[1,0,1]
v_lshlrev_b32 v18,16,v145
v_and_b32 v19,s73,v145
v_pk_fma_f32 v[82:83],v[18:19],v[44:45],v[82:83] op_sel:[0,0,0] op_sel_hi:[1,0,1]
v_lshlrev_b32 v16,16,v146
v_and_b32 v17,s73,v146
v_pk_fma_f32 v[84:85],v[16:17],v[44:45],v[84:85] op_sel:[0,0,0] op_sel_hi:[1,0,1]
v_lshlrev_b32 v18,16,v147
v_and_b32 v19,s73,v147
v_pk_fma_f32 v[86:87],v[18:19],v[44:45],v[86:87] op_sel:[0,0,0] op_sel_hi:[1,0,1]
s_waitcnt vmcnt(14)
v_lshlrev_b32 v16,16,v208
v_and_b32 v17,s73,v208
v_pk_fma_f32 v[88:89],v[16:17],v[44:45],v[88:89] op_sel:[0,0,0] op_sel_hi:[1,0,1]
v_lshlrev_b32 v18,16,v209
v_and_b32 v19,s73,v209
v_pk_fma_f32 v[90:91],v[18:19],v[44:45],v[90:91] op_sel:[0,0,0] op_sel_hi:[1,0,1]
v_lshlrev_b32 v16,16,v210
v_and_b32 v17,s73,v210
v_pk_fma_f32 v[92:93],v[16:17],v[44:45],v[92:93] op_sel:[0,0,0] op_sel_hi:[1,0,1]
v_lshlrev_b32 v18,16,v211
v_and_b32 v19,s73,v211
v_pk_fma_f32 v[94:95],v[18:19],v[44:45],v[94:95] op_sel:[0,0,0] op_sel_hi:[1,0,1]
s_waitcnt vmcnt(13)
v_lshlrev_b32 v16,16,v148
v_and_b32 v17,s73,v148
v_pk_fma_f32 v[80:81],v[16:17],v[44:45],v[80:81] op_sel:[0,1,0] op_sel_hi:[1,1,1]
v_lshlrev_b32 v18,16,v149
v_and_b32 v19,s73,v149
v_pk_fma_f32 v[82:83],v[18:19],v[44:45],v[82:83] op_sel:[0,1,0] op_sel_hi:[1,1,1]
v_lshlrev_b32 v16,16,v150
v_and_b32 v17,s73,v150
v_pk_fma_f32 v[84:85],v[16:17],v[44:45],v[84:85] op_sel:[0,1,0] op_sel_hi:[1,1,1]
v_lshlrev_b32 v18,16,v151
v_and_b32 v19,s73,v151
v_pk_fma_f32 v[86:87],v[18:19],v[44:45],v[86:87] op_sel:[0,1,0] op_sel_hi:[1,1,1]
s_waitcnt vmcnt(12)
v_lshlrev_b32 v16,16,v212
v_and_b32 v17,s73,v212
v_pk_fma_f32 v[88:89],v[16:17],v[44:45],v[88:89] op_sel:[0,1,0] op_sel_hi:[1,1,1]
v_lshlrev_b32 v18,16,v213
v_and_b32 v19,s73,v213
v_pk_fma_f32 v[90:91],v[18:19],v[44:45],v[90:91] op_sel:[0,1,0] op_sel_hi:[1,1,1]
v_lshlrev_b32 v16,16,v214
v_and_b32 v17,s73,v214
v_pk_fma_f32 v[92:93],v[16:17],v[44:45],v[92:93] op_sel:[0,1,0] op_sel_hi:[1,1,1]
v_lshlrev_b32 v18,16,v215
v_and_b32 v19,s73,v215
v_pk_fma_f32 v[94:95],v[18:19],v[44:45],v[94:95] op_sel:[0,1,0] op_sel_hi:[1,1,1]
s_waitcnt vmcnt(11)
v_lshlrev_b32 v16,16,v152
v_and_b32 v17,s73,v152
v_pk_fma_f32 v[80:81],v[16:17],v[46:47],v[80:81] op_sel:[0,0,0] op_sel_hi:[1,0,1]
v_lshlrev_b32 v18,16,v153
v_and_b32 v19,s73,v153
v_pk_fma_f32 v[82:83],v[18:19],v[46:47],v[82:83] op_sel:[0,0,0] op_sel_hi:[1,0,1]
v_lshlrev_b32 v16,16,v154
v_and_b32 v17,s73,v154
v_pk_fma_f32 v[84:85],v[16:17],v[46:47],v[84:85] op_sel:[0,0,0] op_sel_hi:[1,0,1]
v_lshlrev_b32 v18,16,v155
v_and_b32 v19,s73,v155
v_pk_fma_f32 v[86:87],v[18:19],v[46:47],v[86:87] op_sel:[0,0,0] op_sel_hi:[1,0,1]
s_waitcnt vmcnt(10)
v_lshlrev_b32 v16,16,v216
v_and_b32 v17,s73,v216
v_pk_fma_f32 v[88:89],v[16:17],v[46:47],v[88:89] op_sel:[0,0,0] op_sel_hi:[1,0,1]
v_lshlrev_b32 v18,16,v217
v_and_b32 v19,s73,v217
v_pk_fma_f32 v[90:91],v[18:19],v[46:47],v[90:91] op_sel:[0,0,0] op_sel_hi:[1,0,1]
v_lshlrev_b32 v16,16,v218
v_and_b32 v17,s73,v218
v_pk_fma_f32 v[92:93],v[16:17],v[46:47],v[92:93] op_sel:[0,0,0] op_sel_hi:[1,0,1]
v_lshlrev_b32 v18,16,v219
v_and_b32 v19,s73,v219
v_pk_fma_f32 v[94:95],v[18:19],v[46:47],v[94:95] op_sel:[0,0,0] op_sel_hi:[1,0,1]
s_waitcnt vmcnt(9)
v_lshlrev_b32 v16,16,v156
v_and_b32 v17,s73,v156
v_pk_fma_f32 v[80:81],v[16:17],v[46:47],v[80:81] op_sel:[0,1,0] op_sel_hi:[1,1,1]
v_lshlrev_b32 v18,16,v157
v_and_b32 v19,s73,v157
v_pk_fma_f32 v[82:83],v[18:19],v[46:47],v[82:83] op_sel:[0,1,0] op_sel_hi:[1,1,1]
v_lshlrev_b32 v16,16,v158
v_and_b32 v17,s73,v158
v_pk_fma_f32 v[84:85],v[16:17],v[46:47],v[84:85] op_sel:[0,1,0] op_sel_hi:[1,1,1]
v_lshlrev_b32 v18,16,v159
v_and_b32 v19,s73,v159
v_pk_fma_f32 v[86:87],v[18:19],v[46:47],v[86:87] op_sel:[0,1,0] op_sel_hi:[1,1,1]
s_waitcnt vmcnt(8)
v_lshlrev_b32 v16,16,v220
v_and_b32 v17,s73,v220
v_pk_fma_f32 v[88:89],v[16:17],v[46:47],v[88:89] op_sel:[0,1,0] op_sel_hi:[1,1,1]
v_lshlrev_b32 v18,16,v221
v_and_b32 v19,s73,v221
v_pk_fma_f32 v[90:91],v[18:19],v[46:47],v[90:91] op_sel:[0,1,0] op_sel_hi:[1,1,1]
v_lshlrev_b32 v16,16,v222
v_and_b32 v17,s73,v222
v_pk_fma_f32 v[92:93],v[16:17],v[46:47],v[92:93] op_sel:[0,1,0] op_sel_hi:[1,1,1]
v_lshlrev_b32 v18,16,v223
v_and_b32 v19,s73,v223
v_pk_fma_f32 v[94:95],v[18:19],v[46:47],v[94:95] op_sel:[0,1,0] op_sel_hi:[1,1,1]
v_lshlrev_b32 v18,5,v14
ds_write_b128 v18,v[80:83] offset:16384
ds_write_b128 v18,v[84:87] offset:16400
ds_write_b128 v18,v[88:91] offset:24576
ds_write_b128 v18,v[92:95] offset:24592
v_and_b32 v18,127,v14
v_lshlrev_b32 v18,2,v18
v_lshrrev_b32 v19,7,v14
v_lshl_add_u32 v19,v19,13,v18
s_waitcnt lgkmcnt(0)
s_barrier
ds_read_b32 v32,v19 offset:16384
ds_read_b32 v33,v19 offset:16896
ds_read_b32 v34,v19 offset:17408
ds_read_b32 v35,v19 offset:17920
ds_read_b32 v36,v19 offset:18432
ds_read_b32 v37,v19 offset:18944
ds_read_b32 v38,v19 offset:19456
ds_read_b32 v39,v19 offset:19968
ds_read_b32 v40,v19 offset:20480
ds_read_b32 v41,v19 offset:20992
ds_read_b32 v42,v19 offset:21504
ds_read_b32 v43,v19 offset:22016
s_waitcnt lgkmcnt(4)
ds_read_b32 v44,v19 offset:22528
ds_read_b32 v45,v19 offset:23040
ds_read_b32 v46,v19 offset:23552
ds_read_b32 v47,v19 offset:24064
s_waitcnt lgkmcnt(0)
v_pk_add_f32 v[32:33],v[32:33],v[40:41]
v_pk_add_f32 v[34:35],v[34:35],v[42:43]
v_pk_add_f32 v[36:37],v[36:37],v[44:45]
v_pk_add_f32 v[38:39],v[38:39],v[46:47]
v_pk_add_f32 v[32:33],v[32:33],v[36:37]
v_pk_add_f32 v[34:35],v[34:35],v[38:39]
v_pk_add_f32 v[32:33],v[32:33],v[34:35]
v_add_f32 v32,v32,v33
s_mul_i32 s64,s53,24576
s_lshl_b32 s65,s52,10
s_add_u32 s64,s64,s65
s_add_u32 s64,s64,267395072
v_lshlrev_b32 v18,2,v14
buffer_store_dword v32,v18,s[20:23],s64 offen sc1
s_cmp_eq_u32 s58,220
s_cbranch_scc1 fl2_28
s_mov_b32 s62,s59
fl1_27:
s_lshl_b32 s64,s62,2
s_add_u32 s64,s64,s50
s_mul_i32 s64,s64,14336
s_add_u32 s64,s64,143130624
buffer_store_dwordx4 v[28:31],v24,s[20:23],s64 offen offset:0 sc1
s_waitcnt vmcnt(2)
buffer_store_dwordx4 v[28:31],v24,s[20:23],s64 offen offset:1024 sc1
s_waitcnt vmcnt(2)
buffer_store_dwordx4 v[28:31],v24,s[20:23],s64 offen offset:2048 sc1
s_waitcnt vmcnt(2)
buffer_store_dwordx4 v[28:31],v24,s[20:23],s64 offen offset:3072 sc1
s_waitcnt vmcnt(2)
s_add_u32 s64,s64,4096
buffer_store_dwordx4 v[28:31],v24,s[20:23],s64 offen offset:0 sc1
s_waitcnt vmcnt(2)
buffer_store_dwordx4 v[28:31],v24,s[20:23],s64 offen offset:1024 sc1
s_waitcnt vmcnt(2)
buffer_store_dwordx4 v[28:31],v24,s[20:23],s64 offen offset:2048 sc1
s_waitcnt vmcnt(2)
buffer_store_dwordx4 v[28:31],v24,s[20:23],s64 offen offset:3072 sc1
s_waitcnt vmcnt(2)
s_add_u32 s64,s64,4096
buffer_store_dwordx4 v[28:31],v24,s[20:23],s64 offen offset:0 sc1
s_waitcnt vmcnt(2)
buffer_store_dwordx4 v[28:31],v24,s[20:23],s64 offen offset:1024 sc1
s_waitcnt vmcnt(2)
buffer_store_dwordx4 v[28:31],v24,s[20:23],s64 offen offset:2048 sc1
s_waitcnt vmcnt(2)
buffer_store_dwordx4 v[28:31],v24,s[20:23],s64 offen offset:3072 sc1
s_waitcnt vmcnt(2)
s_add_u32 s64,s64,4096
buffer_store_dwordx4 v[28:31],v24,s[20:23],s64 offen offset:0 sc1
s_waitcnt vmcnt(2)
buffer_store_dwordx4 v[28:31],v24,s[20:23],s64 offen offset:1024 sc1
s_waitcnt vmcnt(2)
s_lshl_b32 s64,s62,2
s_add_u32 s64,s64,s50
s_mul_i32 s64,s64,6144
s_add_u32 s64,s64,167772160
buffer_store_dwordx4 v[28:31],v24,s[20:23],s64 offen offset:0 sc1
s_waitcnt vmcnt(2)
buffer_store_dwordx4 v[28:31],v24,s[20:23],s64 offen offset:1024 sc1
s_waitcnt vmcnt(2)
buffer_store_dwordx4 v[28:31],v24,s[20:23],s64 offen offset:2048 sc1
s_waitcnt vmcnt(2)
buffer_store_dwordx4 v[28:31],v24,s[20:23],s64 offen offset:3072 sc1
s_waitcnt vmcnt(2)
s_add_u32 s64,s64,4096
buffer_store_dwordx4 v[28:31],v24,s[20:23],s64 offen offset:0 sc1
s_waitcnt vmcnt(2)
buffer_store_dwordx4 v[28:31],v24,s[20:23],s64 offen offset:1024 sc1
s_waitcnt vmcnt(2)
s_and_b32 s64,s62,31
s_lshl_b32 s64,s64,10
s_add_u32 s64,s64,209715200
s_bitcmp1_b32 s62,5
s_cselect_b32 s65,4227072,0
s_add_u32 s64,s64,s65
buffer_store_dwordx4 v[20:23],v24,s[20:23],s64 offen sc1
s_lshl_b32 s64,s62,10
s_add_u32 s64,s64,201326592
buffer_store_dwordx4 v[28:31],v24,s[20:23],s64 offen sc1
s_lshl_b32 s64,s62,14
s_lshl_b32 s65,s50,12
s_and_b32 s65,s65,0x2000
s_add_u32 s64,s64,s65
s_and_b32 s65,s50,1
s_lshl_b32 s65,s65,10
s_add_u32 s64,s64,s65
s_add_u32 s64,s64,133169152
buffer_store_dwordx4 v[28:31],v24,s[20:23],s64 offen sc1
s_cmp_eq_u32 s62,29
s_mov_b32 s62,28
s_cbranch_scc1 fl1_27
fl2_28:
s_waitcnt vmcnt(0)
s_barrier
s_cmp_lg_u32 s50,0
s_cbranch_scc1 sig_29
s_mov_b32 s92,s2
s_and_b32 s93,s3,0xffff
s_mov_b32 s94,0x100
s_mov_b32 s95,0x20000
s_add_u32 s64,s88,4
s_add_u32 s65,s88,8
s_cmp_eq_u32 s58,220
s_cselect_b32 s64,s65,s64
v_mov_b32 v16,1
s_mov_b64 exec,1
buffer_atomic_add v16,off,s[92:95],s64 sc1
s_mov_b64 exec,-1
sig_29:
v_lshlrev_b32 v128,16,v48
v_and_b32 v129,s73,v48
v_lshlrev_b32 v130,16,v49
v_and_b32 v131,s73,v49
v_lshlrev_b32 v132,16,v50
v_and_b32 v133,s73,v50
v_lshlrev_b32 v134,16,v51
v_and_b32 v135,s73,v51
v_lshlrev_b32 v136,16,v52
v_and_b32 v137,s73,v52
v_lshlrev_b32 v138,16,v53
v_and_b32 v139,s73,v53
v_lshlrev_b32 v140,16,v54
v_and_b32 v141,s73,v54
v_lshlrev_b32 v142,16,v55
v_and_b32 v143,s73,v55
v_lshlrev_b32 v144,16,v56
v_and_b32 v145,s73,v56
v_lshlrev_b32 v146,16,v57
v_and_b32 v147,s73,v57
v_lshlrev_b32 v148,16,v58
v_and_b32 v149,s73,v58
v_lshlrev_b32 v150,16,v59
v_and_b32 v151,s73,v59
v_lshlrev_b32 v152,16,v60
v_and_b32 v153,s73,v60
v_lshlrev_b32 v154,16,v61
v_and_b32 v155,s73,v61
v_lshlrev_b32 v156,16,v62
v_and_b32 v157,s73,v62
v_lshlrev_b32 v158,16,v63
v_and_b32 v159,s73,v63
v_lshlrev_b32 v160,16,v64
v_and_b32 v161,s73,v64
v_lshlrev_b32 v162,16,v65
v_and_b32 v163,s73,v65
v_lshlrev_b32 v164,16,v66
v_and_b32 v165,s73,v66
v_lshlrev_b32 v166,16,v67
v_and_b32 v167,s73,v67
v_lshlrev_b32 v168,16,v68
v_and_b32 v169,s73,v68
v_lshlrev_b32 v170,16,v69
v_and_b32 v171,s73,v69
v_lshlrev_b32 v172,16,v70
v_and_b32 v173,s73,v70
v_lshlrev_b32 v174,16,v71
v_and_b32 v175,s73,v71
v_lshlrev_b32 v176,16,v72
v_and_b32 v177,s73,v72
v_lshlrev_b32 v178,16,v73
v_and_b32 v179,s73,v73
v_lshlrev_b32 v180,16,v74
v_and_b32 v181,s73,v74
v_lshlrev_b32 v182,16,v75
v_and_b32 v183,s73,v75
v_lshlrev_b32 v184,16,v76
v_and_b32 v185,s73,v76
v_lshlrev_b32 v186,16,v77
v_and_b32 v187,s73,v77
v_lshlrev_b32 v188,16,v78
v_and_b32 v189,s73,v78
v_lshlrev_b32 v190,16,v79
v_and_b32 v191,s73,v79
v_add_f32 v208,v128,v129
v_mul_f32 v209,v128,v128
v_add_f32 v210,v130,v131
v_mul_f32 v211,v129,v129
v_fmac_f32 v209,v130,v130
v_fmac_f32 v211,v131,v131
v_add_f32 v208,v208,v132
v_fmac_f32 v209,v132,v132
v_add_f32 v210,v210,v133
v_fmac_f32 v211,v133,v133
v_add_f32 v208,v208,v134
v_fmac_f32 v209,v134,v134
v_add_f32 v210,v210,v135
v_fmac_f32 v211,v135,v135
v_add_f32 v208,v208,v136
v_fmac_f32 v209,v136,v136
v_add_f32 v210,v210,v137
v_fmac_f32 v211,v137,v137
v_add_f32 v208,v208,v138
v_fmac_f32 v209,v138,v138
v_add_f32 v210,v210,v139
v_fmac_f32 v211,v139,v139
v_add_f32 v208,v208,v140
v_fmac_f32 v209,v140,v140
v_add_f32 v210,v210,v141
v_fmac_f32 v211,v141,v141
v_add_f32 v208,v208,v142
v_fmac_f32 v209,v142,v142
v_add_f32 v210,v210,v143
v_fmac_f32 v211,v143,v143
v_add_f32 v208,v208,v210
v_add_f32 v209,v209,v211
v_add_f32 v212,v144,v145
v_mul_f32 v213,v144,v144
v_add_f32 v214,v146,v147
v_mul_f32 v215,v145,v145
v_fmac_f32 v213,v146,v146
v_fmac_f32 v215,v147,v147
v_add_f32 v212,v212,v148
v_fmac_f32 v213,v148,v148
v_add_f32 v214,v214,v149
v_fmac_f32 v215,v149,v149
v_add_f32 v212,v212,v150
v_fmac_f32 v213,v150,v150
v_add_f32 v214,v214,v151
v_fmac_f32 v215,v151,v151
v_add_f32 v212,v212,v152
v_fmac_f32 v213,v152,v152
v_add_f32 v214,v214,v153
v_fmac_f32 v215,v153,v153
v_add_f32 v212,v212,v154
v_fmac_f32 v213,v154,v154
v_add_f32 v214,v214,v155
v_fmac_f32 v215,v155,v155
v_add_f32 v212,v212,v156
v_fmac_f32 v213,v156,v156
v_add_f32 v214,v214,v157
v_fmac_f32 v215,v157,v157
v_add_f32 v212,v212,v158
v_fmac_f32 v213,v158,v158
v_add_f32 v214,v214,v159
v_fmac_f32 v215,v159,v159
v_add_f32 v212,v212,v214
v_add_f32 v213,v213,v215
v_add_f32 v216,v160,v161
v_mul_f32 v217,v160,v160
v_add_f32 v218,v162,v163
v_mul_f32 v219,v161,v161
v_fmac_f32 v217,v162,v162
v_fmac_f32 v219,v163,v163
v_add_f32 v216,v216,v164
v_fmac_f32 v217,v164,v164
v_add_f32 v218,v218,v165
v_fmac_f32 v219,v165,v165
v_add_f32 v216,v216,v166
v_fmac_f32 v217,v166,v166
v_add_f32 v218,v218,v167
v_fmac_f32 v219,v167,v167
v_add_f32 v216,v216,v168
v_fmac_f32 v217,v168,v168
v_add_f32 v218,v218,v169
v_fmac_f32 v219,v169,v169
v_add_f32 v216,v216,v170
v_fmac_f32 v217,v170,v170
v_add_f32 v218,v218,v171
v_fmac_f32 v219,v171,v171
v_add_f32 v216,v216,v172
v_fmac_f32 v217,v172,v172
v_add_f32 v218,v218,v173
v_fmac_f32 v219,v173,v173
v_add_f32 v216,v216,v174
v_fmac_f32 v217,v174,v174
v_add_f32 v218,v218,v175
v_fmac_f32 v219,v175,v175
v_add_f32 v216,v216,v218
v_add_f32 v217,v217,v219
v_add_f32 v220,v176,v177
v_mul_f32 v221,v176,v176
v_add_f32 v222,v178,v179
v_mul_f32 v223,v177,v177
v_fmac_f32 v221,v178,v178
v_fmac_f32 v223,v179,v179
v_add_f32 v220,v220,v180
v_fmac_f32 v221,v180,v180
v_add_f32 v222,v222,v181
v_fmac_f32 v223,v181,v181
v_add_f32 v220,v220,v182
v_fmac_f32 v221,v182,v182
v_add_f32 v222,v222,v183
v_fmac_f32 v223,v183,v183
v_add_f32 v220,v220,v184
v_fmac_f32 v221,v184,v184
v_add_f32 v222,v222,v185
v_fmac_f32 v223,v185,v185
v_add_f32 v220,v220,v186
v_fmac_f32 v221,v186,v186
v_add_f32 v222,v222,v187
v_fmac_f32 v223,v187,v187
v_add_f32 v220,v220,v188
v_fmac_f32 v221,v188,v188
v_add_f32 v222,v222,v189
v_fmac_f32 v223,v189,v189
v_add_f32 v220,v220,v190
v_fmac_f32 v221,v190,v190
v_add_f32 v222,v222,v191
v_fmac_f32 v223,v191,v191
v_add_f32 v220,v220,v222
v_add_f32 v221,v221,v223
v_add_f32_dpp v208,v208,v208 row_ror:4 row_mask:0xf bank_mask:0xf
v_add_f32_dpp v209,v209,v209 row_ror:4 row_mask:0xf bank_mask:0xf
v_add_f32_dpp v212,v212,v212 row_ror:4 row_mask:0xf bank_mask:0xf
v_add_f32_dpp v213,v213,v213 row_ror:4 row_mask:0xf bank_mask:0xf
v_add_f32_dpp v216,v216,v216 row_ror:4 row_mask:0xf bank_mask:0xf
v_add_f32_dpp v217,v217,v217 row_ror:4 row_mask:0xf bank_mask:0xf
v_add_f32_dpp v220,v220,v220 row_ror:4 row_mask:0xf bank_mask:0xf
v_add_f32_dpp v221,v221,v221 row_ror:4 row_mask:0xf bank_mask:0xf
v_add_f32_dpp v208,v208,v208 row_ror:8 row_mask:0xf bank_mask:0xf
v_add_f32_dpp v209,v209,v209 row_ror:8 row_mask:0xf bank_mask:0xf
v_add_f32_dpp v212,v212,v212 row_ror:8 row_mask:0xf bank_mask:0xf
v_add_f32_dpp v213,v213,v213 row_ror:8 row_mask:0xf bank_mask:0xf
v_add_f32_dpp v216,v216,v216 row_ror:8 row_mask:0xf bank_mask:0xf
v_add_f32_dpp v217,v217,v217 row_ror:8 row_mask:0xf bank_mask:0xf
v_add_f32_dpp v220,v220,v220 row_ror:8 row_mask:0xf bank_mask:0xf
v_add_f32_dpp v221,v221,v221 row_ror:8 row_mask:0xf bank_mask:0xf
v_mov_b32 v210,v208
v_mov_b32 v211,v209
s_nop 0
v_permlane16_swap_b32 v210,v208
v_permlane16_swap_b32 v211,v209
v_add_f32 v208,v208,v210
v_add_f32 v209,v209,v211
v_mov_b32 v214,v212
v_mov_b32 v215,v213
s_nop 0
v_permlane16_swap_b32 v214,v212
v_permlane16_swap_b32 v215,v213
v_add_f32 v212,v212,v214
v_add_f32 v213,v213,v215
v_mov_b32 v218,v216
v_mov_b32 v219,v217
s_nop 0
v_permlane16_swap_b32 v218,v216
v_permlane16_swap_b32 v219,v217
v_add_f32 v216,v216,v218
v_add_f32 v217,v217,v219
v_mov_b32 v222,v220
v_mov_b32 v223,v221
s_nop 0
v_permlane16_swap_b32 v222,v220
v_permlane16_swap_b32 v223,v221
v_add_f32 v220,v220,v222
v_add_f32 v221,v221,v223
v_mov_b32 v210,v208
v_mov_b32 v211,v209
s_nop 0
v_permlane32_swap_b32 v210,v208
v_permlane32_swap_b32 v211,v209
v_add_f32 v208,v208,v210
v_add_f32 v209,v209,v211
v_mov_b32 v214,v212
v_mov_b32 v215,v213
s_nop 0
v_permlane32_swap_b32 v214,v212
v_permlane32_swap_b32 v215,v213
v_add_f32 v212,v212,v214
v_add_f32 v213,v213,v215
v_mov_b32 v218,v216
v_mov_b32 v219,v217
s_nop 0
v_permlane32_swap_b32 v218,v216
v_permlane32_swap_b32 v219,v217
v_add_f32 v216,v216,v218
v_add_f32 v217,v217,v219
v_mov_b32 v222,v220
v_mov_b32 v223,v221
s_nop 0
v_permlane32_swap_b32 v222,v220
v_permlane32_swap_b32 v223,v221
v_add_f32 v220,v220,v222
v_add_f32 v221,v221,v223
ds_write_b64 v11,v[208:209] offset:32768
ds_write_b64 v11,v[212:213] offset:34816
ds_write_b64 v11,v[216:217] offset:36864
ds_write_b64 v11,v[220:221] offset:38912
s_waitcnt lgkmcnt(0)
s_barrier
ds_read_b64 v[32:33],v12 offset:32768
ds_read_b64 v[34:35],v12 offset:33280
ds_read_b64 v[36:37],v12 offset:33792
ds_read_b64 v[38:39],v12 offset:34304
s_waitcnt lgkmcnt(0)
v_add_f32 v32,v32,v34
v_add_f32 v33,v33,v35
v_add_f32 v36,v36,v38
v_add_f32 v37,v37,v39
v_add_f32 v32,v32,v36
v_add_f32 v33,v33,v37
v_mul_f32 v208,0xba800000,v32
v_mul_f32 v34,v208,v208
v_mul_f32 v33,0x3a800000,v33
v_sub_f32 v33,v33,v34
v_max_f32 v33,0,v33
v_add_f32 v33,0x3727c5ac,v33
v_rsq_f32 v209,v33
s_nop 0
v_mul_f32 v208,v208,v209
v_fma_f32 v128,v128,v209,v208
v_fma_f32 v129,v129,v209,v208
v_fma_f32 v130,v130,v209,v208
v_fma_f32 v131,v131,v209,v208
v_fma_f32 v132,v132,v209,v208
v_fma_f32 v133,v133,v209,v208
v_fma_f32 v134,v134,v209,v208
v_fma_f32 v135,v135,v209,v208
v_fma_f32 v136,v136,v209,v208
v_fma_f32 v137,v137,v209,v208
v_fma_f32 v138,v138,v209,v208
v_fma_f32 v139,v139,v209,v208
v_fma_f32 v140,v140,v209,v208
v_fma_f32 v141,v141,v209,v208
v_fma_f32 v142,v142,v209,v208
v_fma_f32 v143,v143,v209,v208
ds_read_b64 v[32:33],v12 offset:34816
ds_read_b64 v[34:35],v12 offset:35328
ds_read_b64 v[36:37],v12 offset:35840
ds_read_b64 v[38:39],v12 offset:36352
s_waitcnt lgkmcnt(0)
v_add_f32 v32,v32,v34
v_add_f32 v33,v33,v35
v_add_f32 v36,v36,v38
v_add_f32 v37,v37,v39
v_add_f32 v32,v32,v36
v_add_f32 v33,v33,v37
v_mul_f32 v208,0xba800000,v32
v_mul_f32 v34,v208,v208
v_mul_f32 v33,0x3a800000,v33
v_sub_f32 v33,v33,v34
v_max_f32 v33,0,v33
v_add_f32 v33,0x3727c5ac,v33
v_rsq_f32 v209,v33
s_nop 0
v_mul_f32 v208,v208,v209
v_fma_f32 v144,v144,v209,v208
v_fma_f32 v145,v145,v209,v208
v_fma_f32 v146,v146,v209,v208
v_fma_f32 v147,v147,v209,v208
v_fma_f32 v148,v148,v209,v208
v_fma_f32 v149,v149,v209,v208
v_fma_f32 v150,v150,v209,v208
v_fma_f32 v151,v151,v209,v208
v_fma_f32 v152,v152,v209,v208
v_fma_f32 v153,v153,v209,v208
v_fma_f32 v154,v154,v209,v208
v_fma_f32 v155,v155,v209,v208
v_fma_f32 v156,v156,v209,v208
v_fma_f32 v157,v157,v209,v208
v_fma_f32 v158,v158,v209,v208
v_fma_f32 v159,v159,v209,v208
ds_read_b64 v[32:33],v12 offset:36864
ds_read_b64 v[34:35],v12 offset:37376
ds_read_b64 v[36:37],v12 offset:37888
ds_read_b64 v[38:39],v12 offset:38400
s_waitcnt lgkmcnt(0)
v_add_f32 v32,v32,v34
v_add_f32 v33,v33,v35
v_add_f32 v36,v36,v38
v_add_f32 v37,v37,v39
v_add_f32 v32,v32,v36
v_add_f32 v33,v33,v37
v_mul_f32 v208,0xba800000,v32
v_mul_f32 v34,v208,v208
v_mul_f32 v33,0x3a800000,v33
v_sub_f32 v33,v33,v34
v_max_f32 v33,0,v33
v_add_f32 v33,0x3727c5ac,v33
v_rsq_f32 v209,v33
s_nop 0
v_mul_f32 v208,v208,v209
v_fma_f32 v160,v160,v209,v208
v_fma_f32 v161,v161,v209,v208
v_fma_f32 v162,v162,v209,v208
v_fma_f32 v163,v163,v209,v208
v_fma_f32 v164,v164,v209,v208
v_fma_f32 v165,v165,v209,v208
v_fma_f32 v166,v166,v209,v208
v_fma_f32 v167,v167,v209,v208
v_fma_f32 v168,v168,v209,v208
v_fma_f32 v169,v169,v209,v208
v_fma_f32 v170,v170,v209,v208
v_fma_f32 v171,v171,v209,v208
v_fma_f32 v172,v172,v209,v208
v_fma_f32 v173,v173,v209,v208
v_fma_f32 v174,v174,v209,v208
v_fma_f32 v175,v175,v209,v208
ds_read_b64 v[32:33],v12 offset:38912
ds_read_b64 v[34:35],v12 offset:39424
ds_read_b64 v[36:37],v12 offset:39936
ds_read_b64 v[38:39],v12 offset:40448
s_waitcnt lgkmcnt(0)
v_add_f32 v32,v32,v34
v_add_f32 v33,v33,v35
v_add_f32 v36,v36,v38
v_add_f32 v37,v37,v39
v_add_f32 v32,v32,v36
v_add_f32 v33,v33,v37
v_mul_f32 v208,0xba800000,v32
v_mul_f32 v34,v208,v208
v_mul_f32 v33,0x3a800000,v33
v_sub_f32 v33,v33,v34
v_max_f32 v33,0,v33
v_add_f32 v33,0x3727c5ac,v33
v_rsq_f32 v209,v33
s_nop 0
v_mul_f32 v208,v208,v209
v_fma_f32 v176,v176,v209,v208
v_fma_f32 v177,v177,v209,v208
v_fma_f32 v178,v178,v209,v208
v_fma_f32 v179,v179,v209,v208
v_fma_f32 v180,v180,v209,v208
v_fma_f32 v181,v181,v209,v208
v_fma_f32 v182,v182,v209,v208
v_fma_f32 v183,v183,v209,v208
v_fma_f32 v184,v184,v209,v208
v_fma_f32 v185,v185,v209,v208
v_fma_f32 v186,v186,v209,v208
v_fma_f32 v187,v187,v209,v208
v_fma_f32 v188,v188,v209,v208
v_fma_f32 v189,v189,v209,v208
v_fma_f32 v190,v190,v209,v208
v_fma_f32 v191,v191,v209,v208
s_mov_b32 s92,s2
s_and_b32 s93,s3,0xffff
s_mov_b32 s94,0x100
s_mov_b32 s95,0x20000
v_mbcnt_lo_u32_b32 v16,-1,0
v_mbcnt_hi_u32_b32 v16,-1,v16
v_mov_b32 v18,0
v_cmp_eq_u32 vcc,16,v16
s_nop 1
v_cndmask_b32 v18,v18,64,vcc
v_and_b32 v19,1,v16
v_cmp_eq_u32 vcc,1,v19
v_mov_b32 v19,8192
s_nop 0
v_cndmask_b32 v19,-1,v19,vcc
v_min_u32 v16,31,v16
v_lshlrev_b32 v16,2,v16
s_sub_u32 s66,s88,64
s_cmp_lg_u32 s50,0
s_cbranch_scc1 vot_34
vpoll_30:
buffer_load_dword v17,v16,s[92:95],s66 offen sc1
s_waitcnt vmcnt(0)
s_cmp_lg_u32 s56,2
s_cbranch_scc1 vck_31
v_cmp_eq_u32 vcc,v17,v19
s_and_b32 s64,vcc_lo,0xffff
s_cmp_eq_u32 s64,65535
s_cbranch_scc1 vck_31
s_mov_b32 s65,0
v_readlane_b32 s64,v17,1
s_lshr_b32 s64,s64,8
s_add_u32 s65,s65,s64
v_readlane_b32 s64,v17,3
s_lshr_b32 s64,s64,8
s_add_u32 s65,s65,s64
v_readlane_b32 s64,v17,5
s_lshr_b32 s64,s64,8
s_add_u32 s65,s65,s64
v_readlane_b32 s64,v17,7
s_lshr_b32 s64,s64,8
s_add_u32 s65,s65,s64
v_readlane_b32 s64,v17,9
s_lshr_b32 s64,s64,8
s_add_u32 s65,s65,s64
v_readlane_b32 s64,v17,11
s_lshr_b32 s64,s64,8
s_add_u32 s65,s65,s64
v_readlane_b32 s64,v17,13
s_lshr_b32 s64,s64,8
s_add_u32 s65,s65,s64
v_readlane_b32 s64,v17,15
s_lshr_b32 s64,s64,8
s_add_u32 s65,s65,s64
s_cmp_ge_u32 s65,256
s_cbranch_scc1 vok_33
s_branch vrt_32
vck_31:
v_cmp_gt_u32 vcc,v18,v17
s_cbranch_vccz vok_33
vrt_32:
s_sleep 8
s_sub_u32 s90,s90,1
s_cmp_gt_i32 s90,0
s_cbranch_scc1 vpoll_30
vok_33:
v_add_u32 v18,160512,v16
ds_write_b32 v18,v17
s_waitcnt lgkmcnt(0)
vot_34:
s_barrier
v_add_u32 v18,160512,v16
ds_read_b32 v17,v18
s_waitcnt lgkmcnt(0)
s_cmp_lg_u32 s56,2
s_cbranch_scc1 vfin_35
v_cmp_eq_u32 vcc,v17,v19
s_and_b32 s64,vcc_lo,0xffff
s_cmp_eq_u32 s64,65535
s_cbranch_scc1 vfin_35
s_mov_b32 s65,0
v_readlane_b32 s64,v17,1
s_lshr_b32 s64,s64,8
s_add_u32 s65,s65,s64
v_readlane_b32 s64,v17,3
s_lshr_b32 s64,s64,8
s_add_u32 s65,s65,s64
v_readlane_b32 s64,v17,5
s_lshr_b32 s64,s64,8
s_add_u32 s65,s65,s64
v_readlane_b32 s64,v17,7
s_lshr_b32 s64,s64,8
s_add_u32 s65,s65,s64
v_readlane_b32 s64,v17,9
s_lshr_b32 s64,s64,8
s_add_u32 s65,s65,s64
v_readlane_b32 s64,v17,11
s_lshr_b32 s64,s64,8
s_add_u32 s65,s65,s64
v_readlane_b32 s64,v17,13
s_lshr_b32 s64,s64,8
s_add_u32 s65,s65,s64
v_readlane_b32 s64,v17,15
s_lshr_b32 s64,s64,8
s_add_u32 s65,s65,s64
s_cmp_ge_u32 s65,256
s_cbranch_scc1 fl_fb
vfin_35:
s_and_b32 s56,s56,1
v_lshlrev_b32 v18,5,v14
s_mov_b32 s64,267386880
buffer_load_dwordx4 v[32:35],v18,s[20:23],s64 offen offset:0 sc1
buffer_load_dwordx4 v[36:39],v18,s[20:23],s64 offen offset:16 sc1
s_mov_b32 s64,267411456
buffer_load_dwordx4 v[40:43],v18,s[20:23],s64 offen offset:0 sc1
buffer_load_dwordx4 v[44:47],v18,s[20:23],s64 offen offset:16 sc1
s_mov_b32 s64,267436032
buffer_load_dwordx4 v[48:51],v18,s[20:23],s64 offen offset:0 sc1
buffer_load_dwordx4 v[52:55],v18,s[20:23],s64 offen offset:16 sc1
s_mov_b32 s64,267460608
buffer_load_dwordx4 v[56:59],v18,s[20:23],s64 offen offset:0 sc1
buffer_load_dwordx4 v[60:63],v18,s[20:23],s64 offen offset:16 sc1
s_cmp_gt_u32 s50,1
s_cselect_b32 s64,1.0,0
s_waitcnt vmcnt(0)
v_pk_add_f32 v[32:33],v[32:33],v[40:41]
v_pk_add_f32 v[48:49],v[48:49],v[56:57]
v_pk_add_f32 v[34:35],v[34:35],v[42:43]
v_pk_add_f32 v[50:51],v[50:51],v[58:59]
v_pk_add_f32 v[36:37],v[36:37],v[44:45]
v_pk_add_f32 v[52:53],v[52:53],v[60:61]
v_pk_add_f32 v[38:39],v[38:39],v[46:47]
v_pk_add_f32 v[54:55],v[54:55],v[62:63]
v_pk_add_f32 v[32:33],v[32:33],v[48:49]
v_pk_add_f32 v[34:35],v[34:35],v[50:51]
v_pk_add_f32 v[36:37],v[36:37],v[52:53]
v_pk_add_f32 v[38:39],v[38:39],v[54:55]
v_cvt_pk_bf16_f32 v40,v32,v33
v_cvt_pk_bf16_f32 v41,v34,v35
v_cvt_pk_bf16_f32 v42,v36,v37
v_cvt_pk_bf16_f32 v43,v38,v39
v_lshlrev_b32 v32,16,v40
v_and_b32 v33,s73,v40
v_lshlrev_b32 v34,16,v41
v_and_b32 v35,s73,v41
v_lshlrev_b32 v36,16,v42
v_and_b32 v37,s73,v42
v_lshlrev_b32 v38,16,v43
v_and_b32 v39,s73,v43
v_add_f32 v32,s64,v32
v_add_f32 v33,s64,v33
v_add_f32 v34,s64,v34
v_add_f32 v35,s64,v35
v_add_f32 v36,s64,v36
v_add_f32 v37,s64,v37
v_add_f32 v38,s64,v38
v_add_f32 v39,s64,v39
ds_write_b128 v18,v[32:35] offset:0
ds_write_b128 v18,v[36:39] offset:16
s_waitcnt lgkmcnt(0)
s_barrier
ds_read_b128 v[112:115],v9 offset:0
ds_read_b128 v[116:119],v9 offset:16
ds_read_b128 v[120:123],v9 offset:512
ds_read_b128 v[124:127],v9 offset:528
ds_read_b128 v[96:99],v9 offset:4096
ds_read_b128 v[100:103],v9 offset:4112
ds_read_b128 v[104:107],v9 offset:4608
ds_read_b128 v[108:111],v9 offset:4624
s_add_u32 s61,s61,146800640
s_add_u32 s62,s61,4096
s_waitcnt lgkmcnt(0)
v_fma_f32 v128,v128,v96,v112
v_fma_f32 v129,v129,v97,v113
v_fma_f32 v130,v130,v98,v114
v_fma_f32 v131,v131,v99,v115
v_fma_f32 v132,v132,v100,v116
v_fma_f32 v133,v133,v101,v117
v_fma_f32 v134,v134,v102,v118
v_fma_f32 v135,v135,v103,v119
v_fma_f32 v136,v136,v104,v120
v_fma_f32 v137,v137,v105,v121
v_fma_f32 v138,v138,v106,v122
v_fma_f32 v139,v139,v107,v123
v_fma_f32 v140,v140,v108,v124
v_fma_f32 v141,v141,v109,v125
v_fma_f32 v142,v142,v110,v126
v_fma_f32 v143,v143,v111,v127
v_cvt_pk_bf16_f32 v48,v128,v129
v_cvt_pk_bf16_f32 v49,v130,v131
v_cvt_pk_bf16_f32 v50,v132,v133
v_cvt_pk_bf16_f32 v51,v134,v135
v_cvt_pk_bf16_f32 v52,v136,v137
v_cvt_pk_bf16_f32 v53,v138,v139
v_cvt_pk_bf16_f32 v54,v140,v141
v_cvt_pk_bf16_f32 v55,v142,v143
buffer_store_dwordx4 v[48:51],v10,s[20:23],s61 offen offset:0 sc1
buffer_store_dwordx4 v[52:55],v10,s[20:23],s62 offen offset:0 sc1
v_fma_f32 v144,v144,v96,v112
v_fma_f32 v145,v145,v97,v113
v_fma_f32 v146,v146,v98,v114
v_fma_f32 v147,v147,v99,v115
v_fma_f32 v148,v148,v100,v116
v_fma_f32 v149,v149,v101,v117
v_fma_f32 v150,v150,v102,v118
v_fma_f32 v151,v151,v103,v119
v_fma_f32 v152,v152,v104,v120
v_fma_f32 v153,v153,v105,v121
v_fma_f32 v154,v154,v106,v122
v_fma_f32 v155,v155,v107,v123
v_fma_f32 v156,v156,v108,v124
v_fma_f32 v157,v157,v109,v125
v_fma_f32 v158,v158,v110,v126
v_fma_f32 v159,v159,v111,v127
v_cvt_pk_bf16_f32 v56,v144,v145
v_cvt_pk_bf16_f32 v57,v146,v147
v_cvt_pk_bf16_f32 v58,v148,v149
v_cvt_pk_bf16_f32 v59,v150,v151
v_cvt_pk_bf16_f32 v60,v152,v153
v_cvt_pk_bf16_f32 v61,v154,v155
v_cvt_pk_bf16_f32 v62,v156,v157
v_cvt_pk_bf16_f32 v63,v158,v159
buffer_store_dwordx4 v[56:59],v10,s[20:23],s61 offen offset:64 sc1
buffer_store_dwordx4 v[60:63],v10,s[20:23],s62 offen offset:64 sc1
v_fma_f32 v160,v160,v96,v112
v_fma_f32 v161,v161,v97,v113
v_fma_f32 v162,v162,v98,v114
v_fma_f32 v163,v163,v99,v115
v_fma_f32 v164,v164,v100,v116
v_fma_f32 v165,v165,v101,v117
v_fma_f32 v166,v166,v102,v118
v_fma_f32 v167,v167,v103,v119
v_fma_f32 v168,v168,v104,v120
v_fma_f32 v169,v169,v105,v121
v_fma_f32 v170,v170,v106,v122
v_fma_f32 v171,v171,v107,v123
v_fma_f32 v172,v172,v108,v124
v_fma_f32 v173,v173,v109,v125
v_fma_f32 v174,v174,v110,v126
v_fma_f32 v175,v175,v111,v127
v_cvt_pk_bf16_f32 v64,v160,v161
v_cvt_pk_bf16_f32 v65,v162,v163
v_cvt_pk_bf16_f32 v66,v164,v165
v_cvt_pk_bf16_f32 v67,v166,v167
v_cvt_pk_bf16_f32 v68,v168,v169
v_cvt_pk_bf16_f32 v69,v170,v171
v_cvt_pk_bf16_f32 v70,v172,v173
v_cvt_pk_bf16_f32 v71,v174,v175
buffer_store_dwordx4 v[64:67],v10,s[20:23],s61 offen offset:128 sc1
buffer_store_dwordx4 v[68:71],v10,s[20:23],s62 offen offset:128 sc1
v_fma_f32 v176,v176,v96,v112
v_fma_f32 v177,v177,v97,v113
v_fma_f32 v178,v178,v98,v114
v_fma_f32 v179,v179,v99,v115
v_fma_f32 v180,v180,v100,v116
v_fma_f32 v181,v181,v101,v117
v_fma_f32 v182,v182,v102,v118
v_fma_f32 v183,v183,v103,v119
v_fma_f32 v184,v184,v104,v120
v_fma_f32 v185,v185,v105,v121
v_fma_f32 v186,v186,v106,v122
v_fma_f32 v187,v187,v107,v123
v_fma_f32 v188,v188,v108,v124
v_fma_f32 v189,v189,v109,v125
v_fma_f32 v190,v190,v110,v126
v_fma_f32 v191,v191,v111,v127
v_cvt_pk_bf16_f32 v72,v176,v177
v_cvt_pk_bf16_f32 v73,v178,v179
v_cvt_pk_bf16_f32 v74,v180,v181
v_cvt_pk_bf16_f32 v75,v182,v183
v_cvt_pk_bf16_f32 v76,v184,v185
v_cvt_pk_bf16_f32 v77,v186,v187
v_cvt_pk_bf16_f32 v78,v188,v189
v_cvt_pk_bf16_f32 v79,v190,v191
buffer_store_dwordx4 v[72:75],v10,s[20:23],s61 offen offset:192 sc1
buffer_store_dwordx4 v[76:79],v10,s[20:23],s62 offen offset:192 sc1
s_waitcnt vmcnt(0)
s_barrier
s_cmp_lg_u32 s50,0
s_cbranch_scc1 sig_36
s_mov_b32 s92,s2
s_and_b32 s93,s3,0xffff
s_mov_b32 s94,0x100
s_mov_b32 s95,0x20000
s_add_u32 s64,s88,16
v_mov_b32 v16,1
s_mov_b64 exec,1
buffer_atomic_add v16,off,s[92:95],s64 sc1
s_mov_b64 exec,-1
sig_36:
fl_disp:
s_lshr_b32 s64,s58,2
s_sub_u32 s64,s64,55
s_andn2_b32 s64,s64,4
s_cmp_eq_u32 s64,0
s_cselect_b32 s64,48,0
s_xor_b32 s58,s58,s64
s_sub_u32 s59,s58,248
s_cbranch_scc1 nx_37
s_branch fl_w2
nx_37:
s_sub_u32 s59,s58,240
s_cbranch_scc1 nx_38
s_branch fl_w1
nx_38:
s_sub_u32 s59,s58,224
s_cbranch_scc1 nx_39
s_branch fl_att
nx_39:
s_sub_u32 s59,s58,220
s_cbranch_scc1 nx_40
s_branch fl_ln2
nx_40:
s_sub_u32 s59,s58,192
s_cbranch_scc1 nx_41
s_branch fl_w3
nx_41:
s_sub_u32 s59,s58,160
s_cbranch_scc1 nx_42
s_branch fl_w4
nx_42:
s_sub_u32 s59,s58,128
s_branch fl_wo
fl_fb:
s_mov_b32 s92,s2
s_and_b32 s93,s3,0xffff
s_mov_b32 s94,0x100
s_mov_b32 s95,0x20000
s_waitcnt vmcnt(0) lgkmcnt(0)
s_barrier
v_mov_b32 v4,0
s_cmp_lg_u32 s50,0
s_cbranch_scc1 norole_2
s_mov_b64 exec,1
v_mov_b32 v3,1
s_lshl_b32 s52,s51,2
s_add_u32 s52,s52,128
buffer_atomic_add v3,off,s[92:95],s52 sc0 sc1
s_waitcnt vmcnt(0)
ds_write_b32 v4,v3
s_waitcnt lgkmcnt(0)
s_mov_b64 exec,-1
norole_2:
s_barrier
ds_read_b32 v3,v4
v_mbcnt_lo_u32_b32 v16,-1,0
v_and_b32 v16,7,v16
v_lshlrev_b32 v16,2,v16
s_waitcnt lgkmcnt(0)
v_readfirstlane_b32 s49,v3
s_barrier
tp_43:
buffer_load_dword v17,v16,s[92:95],0 offen offset:128 sc1
s_waitcnt vmcnt(0)
v_readlane_b32 s72,v17,0
v_readlane_b32 s73,v17,1
v_readlane_b32 s74,v17,2
v_readlane_b32 s75,v17,3
v_readlane_b32 s76,v17,4
v_readlane_b32 s77,v17,5
v_readlane_b32 s78,v17,6
v_readlane_b32 s79,v17,7
s_add_u32 s65,s72,s73
s_add_u32 s65,s65,s74
s_add_u32 s65,s65,s75
s_add_u32 s65,s65,s76
s_add_u32 s65,s65,s77
s_add_u32 s65,s65,s78
s_add_u32 s65,s65,s79
s_cmp_ge_u32 s65,256
s_cbranch_scc1 tg_44
s_sleep 4
s_sub_u32 s90,s90,1
s_cmp_gt_i32 s90,0
s_cbranch_scc1 tp_43
tg_44:
s_min_u32 s65,s72,s73
s_min_u32 s65,s65,s74
s_min_u32 s65,s65,s75
s_min_u32 s65,s65,s76
s_min_u32 s65,s65,s77
s_min_u32 s65,s65,s78
s_min_u32 s65,s65,s79
s_mov_b32 s88,192
s_cmp_lt_u32 s65,32
s_cbranch_scc1 tsl_45
s_lshl_b32 s64,s51,2
s_lshr_b32 s64,0x76325410,s64
s_and_b32 s64,s64,7
s_lshl_b32 s58,s64,5
s_add_u32 s58,s58,s49
s_mov_b32 s56,0
s_branch fl_disp0
tsl_45:
s_mov_b32 s58,s49
s_cmp_gt_u32 s51,0
s_cselect_b32 s65,s72,0
s_add_u32 s58,s58,s65
s_cmp_gt_u32 s51,1
s_cselect_b32 s65,s73,0
s_add_u32 s58,s58,s65
s_cmp_gt_u32 s51,2
s_cselect_b32 s65,s74,0
s_add_u32 s58,s58,s65
s_cmp_gt_u32 s51,3
s_cselect_b32 s65,s75,0
s_add_u32 s58,s58,s65
s_cmp_gt_u32 s51,4
s_cselect_b32 s65,s76,0
s_add_u32 s58,s58,s65
s_cmp_gt_u32 s51,5
s_cselect_b32 s65,s77,0
s_add_u32 s58,s58,s65
s_cmp_gt_u32 s51,6
s_cselect_b32 s65,s78,0
s_add_u32 s58,s58,s65
s_mov_b32 s56,1
s_cmp_lt_u32 s58,256
s_cbranch_scc1 fl_disp0
done_1:
s_endpgm
fl_qkv:
v_and_b32 v21,15,v1
v_lshrrev_b32 v22,4,v1
v_lshrrev_b32 v23,2,v21
v_and_b32 v24,3,v21
s_lshl_b32 s61,s50,15
v_lshl_add_u32 v25,v22,3,v23
s_load_dwordx4 s[4:7],s[0:1],16
s_load_dwordx2 s[8:9],s[0:1],32
s_lshl_b32 s52,s59,7
s_and_b32 s64,s50,1
s_lshl_b32 s65,s64,6
s_add_u32 s53,s52,s65
s_lshr_b32 s65,s50,1
s_lshl_b32 s65,s65,6
s_add_u32 s52,s52,s65
s_lshl_b32 s54,s64,3
s_waitcnt lgkmcnt(0)
s_cmp_gt_u32 s50,1
s_cselect_b64 s[10:11],s[4:5],s[6:7]
s_mov_b32 s28,s10
s_and_b32 s29,s11,0xffff
s_mov_b32 s30,0x800000
s_mov_b32 s31,0x20000
s_mov_b32 s32,s8
s_and_b32 s33,s9,0xffff
s_mov_b32 s34,0x800000
s_mov_b32 s35,0x20000
s_and_b32 s64,s59,7
s_lshl_b32 s65,s64,3
s_and_b32 s66,s50,1
s_lshl_b32 s55,s66,2
s_add_u32 s65,s65,s55
s_lshl_b32 s66,s66,5
s_lshl_b32 s65,s65,13
s_andn2_b32 s55,s59,7
s_lshl_b32 s55,s55,7
s_add_u32 s65,s65,s55
s_add_u32 s65,s65,384
v_and_b32 v28,3,v1
v_lshlrev_b32 v28,13,v28
v_add_u32 v28,s65,v28
v_and_b32 v15,4,v1
v_lshl_add_u32 v28,v15,4,v28
s_and_b32 s55,s59,31
s_add_u32 s66,s66,s55
s_lshl_b32 s66,s66,13
s_add_u32 s66,s66,8064
v_writelane_b32 v28,s66,8
s_add_u32 s66,s66,64
v_writelane_b32 v28,s66,9
s_cmp_eq_u32 s64,3
s_cselect_b32 s65,0,15
s_sub_u32 s66,s59,32
s_cmp_lt_u32 s66,31
s_cselect_b32 s66,256,0
s_or_b32 vcc_lo,s65,s66
s_mov_b32 vcc_hi,0
v_cndmask_b32 v28,-1,v28,vcc
s_and_b32 s64,s59,7
s_lshl_b32 s65,s64,4
s_lshl_b32 s55,s50,2
s_add_u32 s65,s65,s55
s_lshl_b32 s66,s50,5
s_lshl_b32 s65,s65,13
s_andn2_b32 s55,s59,7
s_lshl_b32 s55,s55,7
s_add_u32 s65,s65,s55
s_add_u32 s65,s65,384
v_and_b32 v31,3,v1
v_lshlrev_b32 v31,13,v31
v_add_u32 v31,s65,v31
v_and_b32 v15,4,v1
v_lshl_add_u32 v31,v15,4,v31
s_and_b32 s55,s59,31
s_add_u32 s66,s66,s55
s_lshl_b32 s66,s66,13
s_add_u32 s66,s66,8064
v_writelane_b32 v31,s66,8
s_add_u32 s66,s66,64
v_writelane_b32 v31,s66,9
s_cmp_eq_u32 s64,3
s_cselect_b32 s65,0,15
s_sub_u32 s66,s59,32
s_cmp_lt_u32 s66,31
s_cselect_b32 s66,256,0
s_or_b32 vcc_lo,s65,s66
s_mov_b32 vcc_hi,0
v_cndmask_b32 v31,-1,v31,vcc
s_and_b32 s60,s50,1
s_lshl_b32 s60,s60,1
v_lshrrev_b32 v26,2,v1
v_and_b32 v27,3,v1
v_mul_u32_u24 v16,8192,v26
v_lshl_add_u32 v16,v27,4,v16
v_lshlrev_b32 v17,6,v25
v_lshl_add_u32 v17,v24,4,v17
v_add_u32 v17,s61,v17
s_mov_b32 s64,1048576
buffer_load_dword v29,v28,s[28:31],s64 offen
s_mov_b32 s64,1572864
buffer_load_dword v29,v28,s[28:31],s64 offen
s_add_u32 s62,s53,0
s_add_u32 m0,s61,0
s_nop 0
buffer_load_dwordx4 v16,s[28:31],s62 offen lds
s_add_u32 s62,s62,131072
s_add_u32 m0,m0,1024
s_waitcnt vmcnt(10)
buffer_load_dwordx4 v16,s[28:31],s62 offen lds
s_add_u32 s62,s62,131072
s_add_u32 m0,m0,1024
s_mov_b32 s64,0
buffer_load_dword v29,v31,s[32:35],s64 offen
s_waitcnt vmcnt(10)
buffer_load_dwordx4 v16,s[28:31],s62 offen lds
s_add_u32 s62,s62,131072
s_add_u32 m0,m0,1024
s_waitcnt vmcnt(10)
buffer_load_dwordx4 v16,s[28:31],s62 offen lds
s_add_u32 s62,s62,131072
s_add_u32 m0,m0,1024
s_waitcnt vmcnt(10)
buffer_load_dwordx4 v16,s[28:31],s62 offen lds
s_add_u32 s62,s62,131072
s_add_u32 m0,m0,1024
s_waitcnt vmcnt(10)
buffer_load_dwordx4 v16,s[28:31],s62 offen lds
s_add_u32 s62,s62,131072
s_add_u32 m0,m0,1024
s_waitcnt vmcnt(10)
buffer_load_dwordx4 v16,s[28:31],s62 offen lds
s_add_u32 s62,s62,131072
s_add_u32 m0,m0,1024
s_waitcnt vmcnt(10)
buffer_load_dwordx4 v16,s[28:31],s62 offen lds
s_add_u32 s62,s62,131072
s_add_u32 m0,m0,1024
s_waitcnt vmcnt(10)
buffer_load_dwordx4 v16,s[28:31],s62 offen lds
s_add_u32 s62,s62,131072
s_add_u32 m0,m0,1024
s_waitcnt vmcnt(10)
buffer_load_dwordx4 v16,s[28:31],s62 offen lds
s_add_u32 s62,s62,131072
s_add_u32 m0,m0,1024
s_mov_b32 s64,1048576
buffer_load_dword v29,v31,s[32:35],s64 offen
s_waitcnt vmcnt(10)
buffer_load_dwordx4 v16,s[28:31],s62 offen lds
s_add_u32 s62,s62,131072
s_add_u32 m0,m0,1024
s_waitcnt vmcnt(10)
buffer_load_dwordx4 v16,s[28:31],s62 offen lds
s_add_u32 s62,s62,131072
s_add_u32 m0,m0,1024
s_waitcnt vmcnt(10)
buffer_load_dwordx4 v16,s[28:31],s62 offen lds
s_add_u32 s62,s62,131072
s_add_u32 m0,m0,1024
s_waitcnt vmcnt(10)
buffer_load_dwordx4 v16,s[28:31],s62 offen lds
s_add_u32 s62,s62,131072
s_add_u32 m0,m0,1024
s_waitcnt vmcnt(10)
buffer_load_dwordx4 v16,s[28:31],s62 offen lds
s_add_u32 s62,s62,131072
s_add_u32 m0,m0,1024
s_waitcnt vmcnt(10)
buffer_load_dwordx4 v16,s[28:31],s62 offen lds
s_waitcnt vmcnt(10)
s_add_u32 s62,s52,0
s_add_u32 m0,s61,16384
s_nop 0
buffer_load_dwordx4 v16,s[32:35],s62 offen lds
s_add_u32 s62,s62,131072
s_add_u32 m0,m0,1024
s_waitcnt vmcnt(10)
buffer_load_dwordx4 v16,s[32:35],s62 offen lds
s_add_u32 s62,s62,131072
s_add_u32 m0,m0,1024
s_mov_b32 s64,2097152
buffer_load_dword v29,v28,s[28:31],s64 offen
s_waitcnt vmcnt(10)
buffer_load_dwordx4 v16,s[32:35],s62 offen lds
s_add_u32 s62,s62,131072
s_add_u32 m0,m0,1024
s_waitcnt vmcnt(10)
buffer_load_dwordx4 v16,s[32:35],s62 offen lds
s_add_u32 s62,s62,131072
s_add_u32 m0,m0,1024
s_waitcnt vmcnt(10)
buffer_load_dwordx4 v16,s[32:35],s62 offen lds
s_add_u32 s62,s62,131072
s_add_u32 m0,m0,1024
s_waitcnt vmcnt(10)
buffer_load_dwordx4 v16,s[32:35],s62 offen lds
s_add_u32 s62,s62,131072
s_add_u32 m0,m0,1024
s_mov_b32 s64,2621440
buffer_load_dword v29,v28,s[28:31],s64 offen
s_waitcnt vmcnt(10)
buffer_load_dwordx4 v16,s[32:35],s62 offen lds
s_add_u32 s62,s62,131072
s_add_u32 m0,m0,1024
s_waitcnt vmcnt(10)
buffer_load_dwordx4 v16,s[32:35],s62 offen lds
s_add_u32 s62,s62,131072
s_add_u32 m0,m0,1024
s_waitcnt vmcnt(10)
buffer_load_dwordx4 v16,s[32:35],s62 offen lds
s_add_u32 s62,s62,131072
s_add_u32 m0,m0,1024
s_waitcnt vmcnt(10)
buffer_load_dwordx4 v16,s[32:35],s62 offen lds
s_add_u32 s62,s62,131072
s_add_u32 m0,m0,1024
s_mov_b32 s64,3145728
buffer_load_dword v29,v28,s[28:31],s64 offen
s_waitcnt vmcnt(10)
buffer_load_dwordx4 v16,s[32:35],s62 offen lds
s_add_u32 s62,s62,131072
s_add_u32 m0,m0,1024
s_waitcnt vmcnt(10)
buffer_load_dwordx4 v16,s[32:35],s62 offen lds
s_add_u32 s62,s62,131072
s_add_u32 m0,m0,1024
s_waitcnt vmcnt(10)
buffer_load_dwordx4 v16,s[32:35],s62 offen lds
s_add_u32 s62,s62,131072
s_add_u32 m0,m0,1024
s_waitcnt vmcnt(10)
buffer_load_dwordx4 v16,s[32:35],s62 offen lds
s_add_u32 s62,s62,131072
s_add_u32 m0,m0,1024
s_mov_b32 s64,3670016
buffer_load_dword v29,v28,s[28:31],s64 offen
s_waitcnt vmcnt(10)
buffer_load_dwordx4 v16,s[32:35],s62 offen lds
s_add_u32 s62,s62,131072
s_add_u32 m0,m0,1024
s_waitcnt vmcnt(10)
buffer_load_dwordx4 v16,s[32:35],s62 offen lds
s_waitcnt vmcnt(10)
s_waitcnt vmcnt(20)
ds_read_b64_tr_b16 a[0:1],v17 offset:0
ds_read_b64_tr_b16 a[2:3],v17 offset:256
ds_read_b64_tr_b16 a[4:5],v17 offset:8
ds_read_b64_tr_b16 a[6:7],v17 offset:264
ds_read_b64_tr_b16 a[12:13],v17 offset:2048
ds_read_b64_tr_b16 a[14:15],v17 offset:2304
ds_read_b64_tr_b16 a[16:17],v17 offset:2056
ds_read_b64_tr_b16 a[18:19],v17 offset:2312
ds_read_b64_tr_b16 a[24:25],v17 offset:4096
ds_read_b64_tr_b16 a[26:27],v17 offset:4352
ds_read_b64_tr_b16 a[28:29],v17 offset:4104
ds_read_b64_tr_b16 a[30:31],v17 offset:4360
s_waitcnt lgkmcnt(0)
ds_read_b64_tr_b16 a[36:37],v17 offset:6144
ds_read_b64_tr_b16 a[38:39],v17 offset:6400
ds_read_b64_tr_b16 a[40:41],v17 offset:6152
ds_read_b64_tr_b16 a[42:43],v17 offset:6408
ds_read_b64_tr_b16 a[48:49],v17 offset:8192
ds_read_b64_tr_b16 a[50:51],v17 offset:8448
ds_read_b64_tr_b16 a[52:53],v17 offset:8200
ds_read_b64_tr_b16 a[54:55],v17 offset:8456
ds_read_b64_tr_b16 a[60:61],v17 offset:10240
ds_read_b64_tr_b16 a[62:63],v17 offset:10496
ds_read_b64_tr_b16 a[64:65],v17 offset:10248
ds_read_b64_tr_b16 a[66:67],v17 offset:10504
s_waitcnt lgkmcnt(0)
ds_read_b64_tr_b16 a[72:73],v17 offset:12288
ds_read_b64_tr_b16 a[74:75],v17 offset:12544
ds_read_b64_tr_b16 a[76:77],v17 offset:12296
ds_read_b64_tr_b16 a[78:79],v17 offset:12552
ds_read_b64_tr_b16 a[84:85],v17 offset:14336
ds_read_b64_tr_b16 a[86:87],v17 offset:14592
ds_read_b64_tr_b16 a[88:89],v17 offset:14344
ds_read_b64_tr_b16 a[90:91],v17 offset:14600
s_waitcnt lgkmcnt(0)
s_add_u32 s62,s53,2097152
s_add_u32 m0,s61,0
s_nop 0
buffer_load_dwordx4 v16,s[28:31],s62 offen lds
s_add_u32 s62,s62,131072
s_add_u32 m0,m0,1024
s_waitcnt vmcnt(10)
buffer_load_dwordx4 v16,s[28:31],s62 offen lds
s_add_u32 s62,s62,131072
s_add_u32 m0,m0,1024
s_mov_b32 s64,2097152
buffer_load_dword v29,v31,s[32:35],s64 offen
s_waitcnt vmcnt(10)
buffer_load_dwordx4 v16,s[28:31],s62 offen lds
s_add_u32 s62,s62,131072
s_add_u32 m0,m0,1024
s_waitcnt vmcnt(10)
buffer_load_dwordx4 v16,s[28:31],s62 offen lds
s_add_u32 s62,s62,131072
s_add_u32 m0,m0,1024
s_waitcnt vmcnt(10)
buffer_load_dwordx4 v16,s[28:31],s62 offen lds
s_add_u32 s62,s62,131072
s_add_u32 m0,m0,1024
s_waitcnt vmcnt(10)
buffer_load_dwordx4 v16,s[28:31],s62 offen lds
s_add_u32 s62,s62,131072
s_add_u32 m0,m0,1024
s_waitcnt vmcnt(10)
buffer_load_dwordx4 v16,s[28:31],s62 offen lds
s_add_u32 s62,s62,131072
s_add_u32 m0,m0,1024
s_waitcnt vmcnt(10)
buffer_load_dwordx4 v16,s[28:31],s62 offen lds
s_add_u32 s62,s62,131072
s_add_u32 m0,m0,1024
s_waitcnt vmcnt(10)
buffer_load_dwordx4 v16,s[28:31],s62 offen lds
s_add_u32 s62,s62,131072
s_add_u32 m0,m0,1024
s_waitcnt vmcnt(10)
buffer_load_dwordx4 v16,s[28:31],s62 offen lds
s_add_u32 s62,s62,131072
s_add_u32 m0,m0,1024
s_mov_b32 s64,3145728
buffer_load_dword v29,v31,s[32:35],s64 offen
s_waitcnt vmcnt(10)
buffer_load_dwordx4 v16,s[28:31],s62 offen lds
s_add_u32 s62,s62,131072
s_add_u32 m0,m0,1024
s_waitcnt vmcnt(10)
buffer_load_dwordx4 v16,s[28:31],s62 offen lds
s_add_u32 s62,s62,131072
s_add_u32 m0,m0,1024
s_waitcnt vmcnt(10)
buffer_load_dwordx4 v16,s[28:31],s62 offen lds
s_add_u32 s62,s62,131072
s_add_u32 m0,m0,1024
s_waitcnt vmcnt(10)
buffer_load_dwordx4 v16,s[28:31],s62 offen lds
s_add_u32 s62,s62,131072
s_add_u32 m0,m0,1024
s_waitcnt vmcnt(10)
buffer_load_dwordx4 v16,s[28:31],s62 offen lds
s_add_u32 s62,s62,131072
s_add_u32 m0,m0,1024
s_waitcnt vmcnt(10)
buffer_load_dwordx4 v16,s[28:31],s62 offen lds
s_waitcnt vmcnt(10)
s_waitcnt vmcnt(18)
v_add_u32 v18,s54,v17
ds_read_b64_tr_b16 a[8:9],v18 offset:16384
ds_read_b64_tr_b16 a[10:11],v18 offset:16640
ds_read_b64_tr_b16 a[20:21],v18 offset:18432
ds_read_b64_tr_b16 a[22:23],v18 offset:18688
ds_read_b64_tr_b16 a[32:33],v18 offset:20480
ds_read_b64_tr_b16 a[34:35],v18 offset:20736
ds_read_b64_tr_b16 a[44:45],v18 offset:22528
ds_read_b64_tr_b16 a[46:47],v18 offset:22784
ds_read_b64_tr_b16 a[56:57],v18 offset:24576
ds_read_b64_tr_b16 a[58:59],v18 offset:24832
ds_read_b64_tr_b16 a[68:69],v18 offset:26624
ds_read_b64_tr_b16 a[70:71],v18 offset:26880
s_waitcnt lgkmcnt(0)
ds_read_b64_tr_b16 a[80:81],v18 offset:28672
ds_read_b64_tr_b16 a[82:83],v18 offset:28928
ds_read_b64_tr_b16 a[92:93],v18 offset:30720
ds_read_b64_tr_b16 a[94:95],v18 offset:30976
s_waitcnt lgkmcnt(0)
s_add_u32 s62,s52,2097152
s_add_u32 m0,s61,16384
s_nop 0
buffer_load_dwordx4 v16,s[32:35],s62 offen lds
s_add_u32 s62,s62,131072
s_add_u32 m0,m0,1024
s_waitcnt vmcnt(10)
buffer_load_dwordx4 v16,s[32:35],s62 offen lds
s_add_u32 s62,s62,131072
s_add_u32 m0,m0,1024
s_mov_b32 s64,4194304
buffer_load_dword v29,v28,s[28:31],s64 offen
s_waitcnt vmcnt(10)
buffer_load_dwordx4 v16,s[32:35],s62 offen lds
s_add_u32 s62,s62,131072
s_add_u32 m0,m0,1024
s_waitcnt vmcnt(10)
buffer_load_dwordx4 v16,s[32:35],s62 offen lds
s_add_u32 s62,s62,131072
s_add_u32 m0,m0,1024
s_waitcnt vmcnt(10)
buffer_load_dwordx4 v16,s[32:35],s62 offen lds
s_add_u32 s62,s62,131072
s_add_u32 m0,m0,1024
s_waitcnt vmcnt(10)
buffer_load_dwordx4 v16,s[32:35],s62 offen lds
s_add_u32 s62,s62,131072
s_add_u32 m0,m0,1024
s_mov_b32 s64,4718592
buffer_load_dword v29,v28,s[28:31],s64 offen
s_waitcnt vmcnt(10)
buffer_load_dwordx4 v16,s[32:35],s62 offen lds
s_add_u32 s62,s62,131072
s_add_u32 m0,m0,1024
s_waitcnt vmcnt(10)
buffer_load_dwordx4 v16,s[32:35],s62 offen lds
s_add_u32 s62,s62,131072
s_add_u32 m0,m0,1024
s_waitcnt vmcnt(10)
buffer_load_dwordx4 v16,s[32:35],s62 offen lds
s_add_u32 s62,s62,131072
s_add_u32 m0,m0,1024
s_waitcnt vmcnt(10)
buffer_load_dwordx4 v16,s[32:35],s62 offen lds
s_add_u32 s62,s62,131072
s_add_u32 m0,m0,1024
s_mov_b32 s64,5242880
buffer_load_dword v29,v28,s[28:31],s64 offen
s_waitcnt vmcnt(10)
buffer_load_dwordx4 v16,s[32:35],s62 offen lds
s_add_u32 s62,s62,131072
s_add_u32 m0,m0,1024
s_waitcnt vmcnt(10)
buffer_load_dwordx4 v16,s[32:35],s62 offen lds
s_add_u32 s62,s62,131072
s_add_u32 m0,m0,1024
s_waitcnt vmcnt(10)
buffer_load_dwordx4 v16,s[32:35],s62 offen lds
s_add_u32 s62,s62,131072
s_add_u32 m0,m0,1024
s_waitcnt vmcnt(10)
buffer_load_dwordx4 v16,s[32:35],s62 offen lds
s_add_u32 s62,s62,131072
s_add_u32 m0,m0,1024
s_mov_b32 s64,5767168
buffer_load_dword v29,v28,s[28:31],s64 offen
s_waitcnt vmcnt(10)
buffer_load_dwordx4 v16,s[32:35],s62 offen lds
s_add_u32 s62,s62,131072
s_add_u32 m0,m0,1024
s_waitcnt vmcnt(10)
buffer_load_dwordx4 v16,s[32:35],s62 offen lds
s_waitcnt vmcnt(10)
s_waitcnt vmcnt(20)
ds_read_b64_tr_b16 a[96:97],v17 offset:0
ds_read_b64_tr_b16 a[98:99],v17 offset:256
ds_read_b64_tr_b16 a[100:101],v17 offset:8
ds_read_b64_tr_b16 a[102:103],v17 offset:264
ds_read_b64_tr_b16 a[108:109],v17 offset:2048
ds_read_b64_tr_b16 a[110:111],v17 offset:2304
ds_read_b64_tr_b16 a[112:113],v17 offset:2056
ds_read_b64_tr_b16 a[114:115],v17 offset:2312
ds_read_b64_tr_b16 a[120:121],v17 offset:4096
ds_read_b64_tr_b16 a[122:123],v17 offset:4352
ds_read_b64_tr_b16 a[124:125],v17 offset:4104
ds_read_b64_tr_b16 a[126:127],v17 offset:4360
s_waitcnt lgkmcnt(0)
ds_read_b64_tr_b16 a[132:133],v17 offset:6144
ds_read_b64_tr_b16 a[134:135],v17 offset:6400
ds_read_b64_tr_b16 a[136:137],v17 offset:6152
ds_read_b64_tr_b16 a[138:139],v17 offset:6408
ds_read_b64_tr_b16 a[144:145],v17 offset:8192
ds_read_b64_tr_b16 a[146:147],v17 offset:8448
ds_read_b64_tr_b16 a[148:149],v17 offset:8200
ds_read_b64_tr_b16 a[150:151],v17 offset:8456
ds_read_b64_tr_b16 a[156:157],v17 offset:10240
ds_read_b64_tr_b16 a[158:159],v17 offset:10496
ds_read_b64_tr_b16 a[160:161],v17 offset:10248
ds_read_b64_tr_b16 a[162:163],v17 offset:10504
s_waitcnt lgkmcnt(0)
ds_read_b64_tr_b16 a[168:169],v17 offset:12288
ds_read_b64_tr_b16 a[170:171],v17 offset:12544
ds_read_b64_tr_b16 a[172:173],v17 offset:12296
ds_read_b64_tr_b16 a[174:175],v17 offset:12552
ds_read_b64_tr_b16 a[180:181],v17 offset:14336
ds_read_b64_tr_b16 a[182:183],v17 offset:14592
ds_read_b64_tr_b16 a[184:185],v17 offset:14344
ds_read_b64_tr_b16 a[186:187],v17 offset:14600
s_waitcnt lgkmcnt(0)
s_add_u32 s62,s53,4194304
s_add_u32 m0,s61,0
s_nop 0
buffer_load_dwordx4 v16,s[28:31],s62 offen lds
s_add_u32 s62,s62,131072
s_add_u32 m0,m0,1024
s_waitcnt vmcnt(10)
buffer_load_dwordx4 v16,s[28:31],s62 offen lds
s_add_u32 s62,s62,131072
s_add_u32 m0,m0,1024
s_mov_b32 s64,4194304
buffer_load_dword v29,v31,s[32:35],s64 offen
s_waitcnt vmcnt(10)
buffer_load_dwordx4 v16,s[28:31],s62 offen lds
s_add_u32 s62,s62,131072
s_add_u32 m0,m0,1024
s_waitcnt vmcnt(10)
buffer_load_dwordx4 v16,s[28:31],s62 offen lds
s_add_u32 s62,s62,131072
s_add_u32 m0,m0,1024
s_waitcnt vmcnt(10)
buffer_load_dwordx4 v16,s[28:31],s62 offen lds
s_add_u32 s62,s62,131072
s_add_u32 m0,m0,1024
s_waitcnt vmcnt(10)
buffer_load_dwordx4 v16,s[28:31],s62 offen lds
s_add_u32 s62,s62,131072
s_add_u32 m0,m0,1024
s_waitcnt vmcnt(10)
buffer_load_dwordx4 v16,s[28:31],s62 offen lds
s_add_u32 s62,s62,131072
s_add_u32 m0,m0,1024
s_waitcnt vmcnt(10)
buffer_load_dwordx4 v16,s[28:31],s62 offen lds
s_add_u32 s62,s62,131072
s_add_u32 m0,m0,1024
s_waitcnt vmcnt(10)
buffer_load_dwordx4 v16,s[28:31],s62 offen lds
s_add_u32 s62,s62,131072
s_add_u32 m0,m0,1024
s_waitcnt vmcnt(10)
buffer_load_dwordx4 v16,s[28:31],s62 offen lds
s_add_u32 s62,s62,131072
s_add_u32 m0,m0,1024
s_mov_b32 s64,5242880
buffer_load_dword v29,v31,s[32:35],s64 offen
s_waitcnt vmcnt(10)
buffer_load_dwordx4 v16,s[28:31],s62 offen lds
s_add_u32 s62,s62,131072
s_add_u32 m0,m0,1024
s_waitcnt vmcnt(10)
buffer_load_dwordx4 v16,s[28:31],s62 offen lds
s_add_u32 s62,s62,131072
s_add_u32 m0,m0,1024
s_waitcnt vmcnt(10)
buffer_load_dwordx4 v16,s[28:31],s62 offen lds
s_add_u32 s62,s62,131072
s_add_u32 m0,m0,1024
s_waitcnt vmcnt(10)
buffer_load_dwordx4 v16,s[28:31],s62 offen lds
s_add_u32 s62,s62,131072
s_add_u32 m0,m0,1024
s_waitcnt vmcnt(10)
buffer_load_dwordx4 v16,s[28:31],s62 offen lds
s_add_u32 s62,s62,131072
s_add_u32 m0,m0,1024
s_waitcnt vmcnt(10)
buffer_load_dwordx4 v16,s[28:31],s62 offen lds
s_waitcnt vmcnt(10)
s_waitcnt vmcnt(18)
ds_read_b64_tr_b16 a[104:105],v18 offset:16384
ds_read_b64_tr_b16 a[106:107],v18 offset:16640
ds_read_b64_tr_b16 a[116:117],v18 offset:18432
ds_read_b64_tr_b16 a[118:119],v18 offset:18688
ds_read_b64_tr_b16 a[128:129],v18 offset:20480
ds_read_b64_tr_b16 a[130:131],v18 offset:20736
ds_read_b64_tr_b16 a[140:141],v18 offset:22528
ds_read_b64_tr_b16 a[142:143],v18 offset:22784
ds_read_b64_tr_b16 a[152:153],v18 offset:24576
ds_read_b64_tr_b16 a[154:155],v18 offset:24832
ds_read_b64_tr_b16 a[164:165],v18 offset:26624
ds_read_b64_tr_b16 a[166:167],v18 offset:26880
s_waitcnt lgkmcnt(0)
ds_read_b64_tr_b16 a[176:177],v18 offset:28672
ds_read_b64_tr_b16 a[178:179],v18 offset:28928
ds_read_b64_tr_b16 a[188:189],v18 offset:30720
ds_read_b64_tr_b16 a[190:191],v18 offset:30976
s_waitcnt lgkmcnt(0)
s_add_u32 s62,s52,4194304
s_add_u32 m0,s61,16384
s_nop 0
buffer_load_dwordx4 v16,s[32:35],s62 offen lds
s_add_u32 s62,s62,131072
s_add_u32 m0,m0,1024
s_waitcnt vmcnt(10)
buffer_load_dwordx4 v16,s[32:35],s62 offen lds
s_add_u32 s62,s62,131072
s_add_u32 m0,m0,1024
s_mov_b32 s64,6291456
buffer_load_dword v29,v28,s[28:31],s64 offen
s_waitcnt vmcnt(10)
buffer_load_dwordx4 v16,s[32:35],s62 offen lds
s_add_u32 s62,s62,131072
s_add_u32 m0,m0,1024
s_waitcnt vmcnt(10)
buffer_load_dwordx4 v16,s[32:35],s62 offen lds
s_add_u32 s62,s62,131072
s_add_u32 m0,m0,1024
s_waitcnt vmcnt(10)
buffer_load_dwordx4 v16,s[32:35],s62 offen lds
s_add_u32 s62,s62,131072
s_add_u32 m0,m0,1024
s_waitcnt vmcnt(10)
buffer_load_dwordx4 v16,s[32:35],s62 offen lds
s_add_u32 s62,s62,131072
s_add_u32 m0,m0,1024
s_mov_b32 s64,6815744
buffer_load_dword v29,v28,s[28:31],s64 offen
s_waitcnt vmcnt(10)
buffer_load_dwordx4 v16,s[32:35],s62 offen lds
s_add_u32 s62,s62,131072
s_add_u32 m0,m0,1024
s_waitcnt vmcnt(10)
buffer_load_dwordx4 v16,s[32:35],s62 offen lds
s_add_u32 s62,s62,131072
s_add_u32 m0,m0,1024
s_waitcnt vmcnt(10)
buffer_load_dwordx4 v16,s[32:35],s62 offen lds
s_add_u32 s62,s62,131072
s_add_u32 m0,m0,1024
s_waitcnt vmcnt(10)
buffer_load_dwordx4 v16,s[32:35],s62 offen lds
s_add_u32 s62,s62,131072
s_add_u32 m0,m0,1024
s_mov_b32 s64,7340032
buffer_load_dword v29,v28,s[28:31],s64 offen
s_waitcnt vmcnt(10)
buffer_load_dwordx4 v16,s[32:35],s62 offen lds
s_add_u32 s62,s62,131072
s_add_u32 m0,m0,1024
s_waitcnt vmcnt(10)
buffer_load_dwordx4 v16,s[32:35],s62 offen lds
s_add_u32 s62,s62,131072
s_add_u32 m0,m0,1024
s_waitcnt vmcnt(10)
buffer_load_dwordx4 v16,s[32:35],s62 offen lds
s_add_u32 s62,s62,131072
s_add_u32 m0,m0,1024
s_waitcnt vmcnt(10)
buffer_load_dwordx4 v16,s[32:35],s62 offen lds
s_add_u32 s62,s62,131072
s_add_u32 m0,m0,1024
s_mov_b32 s64,7864320
buffer_load_dword v29,v28,s[28:31],s64 offen
s_waitcnt vmcnt(10)
buffer_load_dwordx4 v16,s[32:35],s62 offen lds
s_add_u32 s62,s62,131072
s_add_u32 m0,m0,1024
s_waitcnt vmcnt(10)
buffer_load_dwordx4 v16,s[32:35],s62 offen lds
s_waitcnt vmcnt(10)
s_waitcnt vmcnt(20)
ds_read_b64_tr_b16 a[192:193],v17 offset:0
ds_read_b64_tr_b16 a[194:195],v17 offset:256
ds_read_b64_tr_b16 a[196:197],v17 offset:8
ds_read_b64_tr_b16 a[198:199],v17 offset:264
ds_read_b64_tr_b16 a[204:205],v17 offset:2048
ds_read_b64_tr_b16 a[206:207],v17 offset:2304
ds_read_b64_tr_b16 a[208:209],v17 offset:2056
ds_read_b64_tr_b16 a[210:211],v17 offset:2312
ds_read_b64_tr_b16 a[216:217],v17 offset:4096
ds_read_b64_tr_b16 a[218:219],v17 offset:4352
ds_read_b64_tr_b16 a[220:221],v17 offset:4104
ds_read_b64_tr_b16 a[222:223],v17 offset:4360
s_waitcnt lgkmcnt(0)
ds_read_b64_tr_b16 a[228:229],v17 offset:6144
ds_read_b64_tr_b16 a[230:231],v17 offset:6400
ds_read_b64_tr_b16 a[232:233],v17 offset:6152
ds_read_b64_tr_b16 a[234:235],v17 offset:6408
ds_read_b64_tr_b16 a[240:241],v17 offset:8192
ds_read_b64_tr_b16 a[242:243],v17 offset:8448
ds_read_b64_tr_b16 a[244:245],v17 offset:8200
ds_read_b64_tr_b16 a[246:247],v17 offset:8456
ds_read_b64_tr_b16 a[252:253],v17 offset:10240
ds_read_b64_tr_b16 a[254:255],v17 offset:10496
ds_read_b64_tr_b16 v[128:129],v17 offset:10248
ds_read_b64_tr_b16 v[130:131],v17 offset:10504
s_waitcnt lgkmcnt(0)
ds_read_b64_tr_b16 v[136:137],v17 offset:12288
ds_read_b64_tr_b16 v[138:139],v17 offset:12544
ds_read_b64_tr_b16 v[140:141],v17 offset:12296
ds_read_b64_tr_b16 v[142:143],v17 offset:12552
ds_read_b64_tr_b16 v[148:149],v17 offset:14336
ds_read_b64_tr_b16 v[150:151],v17 offset:14592
ds_read_b64_tr_b16 v[152:153],v17 offset:14344
ds_read_b64_tr_b16 v[154:155],v17 offset:14600
s_waitcnt lgkmcnt(0)
s_add_u32 s62,s53,6291456
s_add_u32 m0,s61,0
s_nop 0
buffer_load_dwordx4 v16,s[28:31],s62 offen lds
s_add_u32 s62,s62,131072
s_add_u32 m0,m0,1024
s_waitcnt vmcnt(10)
buffer_load_dwordx4 v16,s[28:31],s62 offen lds
s_add_u32 s62,s62,131072
s_add_u32 m0,m0,1024
s_mov_b32 s64,6291456
buffer_load_dword v29,v31,s[32:35],s64 offen
s_waitcnt vmcnt(10)
buffer_load_dwordx4 v16,s[28:31],s62 offen lds
s_add_u32 s62,s62,131072
s_add_u32 m0,m0,1024
s_waitcnt vmcnt(10)
buffer_load_dwordx4 v16,s[28:31],s62 offen lds
s_add_u32 s62,s62,131072
s_add_u32 m0,m0,1024
s_waitcnt vmcnt(10)
buffer_load_dwordx4 v16,s[28:31],s62 offen lds
s_add_u32 s62,s62,131072
s_add_u32 m0,m0,1024
s_waitcnt vmcnt(10)
buffer_load_dwordx4 v16,s[28:31],s62 offen lds
s_add_u32 s62,s62,131072
s_add_u32 m0,m0,1024
s_waitcnt vmcnt(10)
buffer_load_dwordx4 v16,s[28:31],s62 offen lds
s_add_u32 s62,s62,131072
s_add_u32 m0,m0,1024
s_waitcnt vmcnt(10)
buffer_load_dwordx4 v16,s[28:31],s62 offen lds
s_add_u32 s62,s62,131072
s_add_u32 m0,m0,1024
s_waitcnt vmcnt(10)
buffer_load_dwordx4 v16,s[28:31],s62 offen lds
s_add_u32 s62,s62,131072
s_add_u32 m0,m0,1024
s_waitcnt vmcnt(10)
buffer_load_dwordx4 v16,s[28:31],s62 offen lds
s_add_u32 s62,s62,131072
s_add_u32 m0,m0,1024
s_mov_b32 s64,7340032
buffer_load_dword v29,v31,s[32:35],s64 offen
s_waitcnt vmcnt(10)
buffer_load_dwordx4 v16,s[28:31],s62 offen lds
s_add_u32 s62,s62,131072
s_add_u32 m0,m0,1024
s_waitcnt vmcnt(10)
buffer_load_dwordx4 v16,s[28:31],s62 offen lds
s_add_u32 s62,s62,131072
s_add_u32 m0,m0,1024
s_waitcnt vmcnt(10)
buffer_load_dwordx4 v16,s[28:31],s62 offen lds
s_add_u32 s62,s62,131072
s_add_u32 m0,m0,1024
s_waitcnt vmcnt(10)
buffer_load_dwordx4 v16,s[28:31],s62 offen lds
s_add_u32 s62,s62,131072
s_add_u32 m0,m0,1024
s_waitcnt vmcnt(10)
buffer_load_dwordx4 v16,s[28:31],s62 offen lds
s_add_u32 s62,s62,131072
s_add_u32 m0,m0,1024
s_waitcnt vmcnt(10)
buffer_load_dwordx4 v16,s[28:31],s62 offen lds
s_waitcnt vmcnt(10)
s_waitcnt vmcnt(18)
ds_read_b64_tr_b16 a[200:201],v18 offset:16384
ds_read_b64_tr_b16 a[202:203],v18 offset:16640
ds_read_b64_tr_b16 a[212:213],v18 offset:18432
ds_read_b64_tr_b16 a[214:215],v18 offset:18688
ds_read_b64_tr_b16 a[224:225],v18 offset:20480
ds_read_b64_tr_b16 a[226:227],v18 offset:20736
ds_read_b64_tr_b16 a[236:237],v18 offset:22528
ds_read_b64_tr_b16 a[238:239],v18 offset:22784
ds_read_b64_tr_b16 a[248:249],v18 offset:24576
ds_read_b64_tr_b16 a[250:251],v18 offset:24832
ds_read_b64_tr_b16 v[132:133],v18 offset:26624
ds_read_b64_tr_b16 v[134:135],v18 offset:26880
s_waitcnt lgkmcnt(0)
ds_read_b64_tr_b16 v[144:145],v18 offset:28672
ds_read_b64_tr_b16 v[146:147],v18 offset:28928
ds_read_b64_tr_b16 v[156:157],v18 offset:30720
ds_read_b64_tr_b16 v[158:159],v18 offset:30976
s_waitcnt lgkmcnt(0)
s_add_u32 s62,s52,6291456
s_add_u32 m0,s61,16384
s_nop 0
buffer_load_dwordx4 v16,s[32:35],s62 offen lds
s_add_u32 s62,s62,131072
s_add_u32 m0,m0,1024
s_waitcnt vmcnt(10)
buffer_load_dwordx4 v16,s[32:35],s62 offen lds
s_add_u32 s62,s62,131072
s_add_u32 m0,m0,1024
s_waitcnt vmcnt(10)
buffer_load_dwordx4 v16,s[32:35],s62 offen lds
s_add_u32 s62,s62,131072
s_add_u32 m0,m0,1024
s_waitcnt vmcnt(10)
buffer_load_dwordx4 v16,s[32:35],s62 offen lds
s_add_u32 s62,s62,131072
s_add_u32 m0,m0,1024
s_waitcnt vmcnt(10)
buffer_load_dwordx4 v16,s[32:35],s62 offen lds
s_add_u32 s62,s62,131072
s_add_u32 m0,m0,1024
s_waitcnt vmcnt(10)
buffer_load_dwordx4 v16,s[32:35],s62 offen lds
s_add_u32 s62,s62,131072
s_add_u32 m0,m0,1024
s_waitcnt vmcnt(10)
buffer_load_dwordx4 v16,s[32:35],s62 offen lds
s_add_u32 s62,s62,131072
s_add_u32 m0,m0,1024
s_waitcnt vmcnt(10)
buffer_load_dwordx4 v16,s[32:35],s62 offen lds
s_add_u32 s62,s62,131072
s_add_u32 m0,m0,1024
s_waitcnt vmcnt(10)
buffer_load_dwordx4 v16,s[32:35],s62 offen lds
s_add_u32 s62,s62,131072
s_add_u32 m0,m0,1024
s_waitcnt vmcnt(10)
buffer_load_dwordx4 v16,s[32:35],s62 offen lds
s_add_u32 s62,s62,131072
s_add_u32 m0,m0,1024
s_waitcnt vmcnt(10)
buffer_load_dwordx4 v16,s[32:35],s62 offen lds
s_add_u32 s62,s62,131072
s_add_u32 m0,m0,1024
s_waitcnt vmcnt(10)
buffer_load_dwordx4 v16,s[32:35],s62 offen lds
s_add_u32 s62,s62,131072
s_add_u32 m0,m0,1024
s_waitcnt vmcnt(10)
buffer_load_dwordx4 v16,s[32:35],s62 offen lds
s_add_u32 s62,s62,131072
s_add_u32 m0,m0,1024
s_waitcnt vmcnt(10)
buffer_load_dwordx4 v16,s[32:35],s62 offen lds
s_add_u32 s62,s62,131072
s_add_u32 m0,m0,1024
s_waitcnt vmcnt(10)
buffer_load_dwordx4 v16,s[32:35],s62 offen lds
s_add_u32 s62,s62,131072
s_add_u32 m0,m0,1024
s_waitcnt vmcnt(10)
buffer_load_dwordx4 v16,s[32:35],s62 offen lds
s_waitcnt vmcnt(10)
s_waitcnt vmcnt(16)
ds_read_b64_tr_b16 v[160:161],v17 offset:0
ds_read_b64_tr_b16 v[162:163],v17 offset:256
ds_read_b64_tr_b16 v[164:165],v17 offset:8
ds_read_b64_tr_b16 v[166:167],v17 offset:264
ds_read_b64_tr_b16 v[172:173],v17 offset:2048
ds_read_b64_tr_b16 v[174:175],v17 offset:2304
ds_read_b64_tr_b16 v[176:177],v17 offset:2056
ds_read_b64_tr_b16 v[178:179],v17 offset:2312
ds_read_b64_tr_b16 v[184:185],v17 offset:4096
ds_read_b64_tr_b16 v[186:187],v17 offset:4352
ds_read_b64_tr_b16 v[188:189],v17 offset:4104
ds_read_b64_tr_b16 v[190:191],v17 offset:4360
s_waitcnt lgkmcnt(0)
ds_read_b64_tr_b16 v[196:197],v17 offset:6144
ds_read_b64_tr_b16 v[198:199],v17 offset:6400
ds_read_b64_tr_b16 v[200:201],v17 offset:6152
ds_read_b64_tr_b16 v[202:203],v17 offset:6408
ds_read_b64_tr_b16 v[208:209],v17 offset:8192
ds_read_b64_tr_b16 v[210:211],v17 offset:8448
ds_read_b64_tr_b16 v[212:213],v17 offset:8200
ds_read_b64_tr_b16 v[214:215],v17 offset:8456
ds_read_b64_tr_b16 v[220:221],v17 offset:10240
ds_read_b64_tr_b16 v[222:223],v17 offset:10496
ds_read_b64_tr_b16 v[224:225],v17 offset:10248
ds_read_b64_tr_b16 v[226:227],v17 offset:10504
s_waitcnt lgkmcnt(0)
ds_read_b64_tr_b16 v[232:233],v17 offset:12288
ds_read_b64_tr_b16 v[234:235],v17 offset:12544
ds_read_b64_tr_b16 v[236:237],v17 offset:12296
ds_read_b64_tr_b16 v[238:239],v17 offset:12552
ds_read_b64_tr_b16 v[244:245],v17 offset:14336
ds_read_b64_tr_b16 v[246:247],v17 offset:14592
ds_read_b64_tr_b16 v[248:249],v17 offset:14344
ds_read_b64_tr_b16 v[250:251],v17 offset:14600
s_waitcnt lgkmcnt(0)
s_waitcnt vmcnt(0)
ds_read_b64_tr_b16 v[168:169],v18 offset:16384
ds_read_b64_tr_b16 v[170:171],v18 offset:16640
ds_read_b64_tr_b16 v[180:181],v18 offset:18432
ds_read_b64_tr_b16 v[182:183],v18 offset:18688
ds_read_b64_tr_b16 v[192:193],v18 offset:20480
ds_read_b64_tr_b16 v[194:195],v18 offset:20736
ds_read_b64_tr_b16 v[204:205],v18 offset:22528
ds_read_b64_tr_b16 v[206:207],v18 offset:22784
ds_read_b64_tr_b16 v[216:217],v18 offset:24576
ds_read_b64_tr_b16 v[218:219],v18 offset:24832
ds_read_b64_tr_b16 v[228:229],v18 offset:26624
ds_read_b64_tr_b16 v[230:231],v18 offset:26880
s_waitcnt lgkmcnt(0)
ds_read_b64_tr_b16 v[240:241],v18 offset:28672
ds_read_b64_tr_b16 v[242:243],v18 offset:28928
ds_read_b64_tr_b16 v[252:253],v18 offset:30720
ds_read_b64_tr_b16 v[254:255],v18 offset:30976
s_waitcnt lgkmcnt(0)
s_mov_b32 s92,s2
s_and_b32 s93,s3,0xffff
s_mov_b32 s94,0x100
s_mov_b32 s95,0x20000
v_mbcnt_lo_u32_b32 v16,-1,0
v_mbcnt_hi_u32_b32 v16,-1,v16
v_mov_b32 v18,0
v_cmp_eq_u32 vcc,22,v16
s_nop 1
v_cndmask_b32 v18,v18,63,vcc
v_cmp_eq_u32 vcc,19,v16
s_nop 1
v_cndmask_b32 v18,v18,64,vcc
v_cmp_eq_u32 vcc,21,v16
s_nop 1
v_cndmask_b32 v18,v18,1,vcc
v_and_b32 v19,1,v16
v_cmp_eq_u32 vcc,1,v19
v_mov_b32 v19,8192
s_nop 0
v_cndmask_b32 v19,-1,v19,vcc
v_min_u32 v16,31,v16
v_lshlrev_b32 v16,2,v16
s_sub_u32 s66,s88,64
s_cmp_lg_u32 s50,0
s_cbranch_scc1 vot_51
vpoll_47:
buffer_load_dword v17,v16,s[92:95],s66 offen sc1
s_waitcnt vmcnt(0)
s_cmp_lg_u32 s56,2
s_cbranch_scc1 vck_48
v_cmp_eq_u32 vcc,v17,v19
s_and_b32 s64,vcc_lo,0xffff
s_cmp_eq_u32 s64,65535
s_cbranch_scc1 vck_48
s_mov_b32 s65,0
v_readlane_b32 s64,v17,1
s_lshr_b32 s64,s64,8
s_add_u32 s65,s65,s64
v_readlane_b32 s64,v17,3
s_lshr_b32 s64,s64,8
s_add_u32 s65,s65,s64
v_readlane_b32 s64,v17,5
s_lshr_b32 s64,s64,8
s_add_u32 s65,s65,s64
v_readlane_b32 s64,v17,7
s_lshr_b32 s64,s64,8
s_add_u32 s65,s65,s64
v_readlane_b32 s64,v17,9
s_lshr_b32 s64,s64,8
s_add_u32 s65,s65,s64
v_readlane_b32 s64,v17,11
s_lshr_b32 s64,s64,8
s_add_u32 s65,s65,s64
v_readlane_b32 s64,v17,13
s_lshr_b32 s64,s64,8
s_add_u32 s65,s65,s64
v_readlane_b32 s64,v17,15
s_lshr_b32 s64,s64,8
s_add_u32 s65,s65,s64
s_cmp_ge_u32 s65,256
s_cbranch_scc1 vok_50
s_branch vrt_49
vck_48:
v_cmp_gt_u32 vcc,v18,v17
s_cbranch_vccz vok_50
vrt_49:
s_sleep 8
s_sub_u32 s90,s90,1
s_cmp_gt_i32 s90,0
s_cbranch_scc1 vpoll_47
vok_50:
v_add_u32 v18,160768,v16
ds_write_b32 v18,v17
s_waitcnt lgkmcnt(0)
vot_51:
s_barrier
v_add_u32 v18,160768,v16
ds_read_b32 v17,v18
s_waitcnt lgkmcnt(0)
s_cmp_lg_u32 s56,2
s_cbranch_scc1 vfin_52
v_cmp_eq_u32 vcc,v17,v19
s_and_b32 s64,vcc_lo,0xffff
s_cmp_eq_u32 s64,65535
s_cbranch_scc1 vfin_52
s_mov_b32 s65,0
v_readlane_b32 s64,v17,1
s_lshr_b32 s64,s64,8
s_add_u32 s65,s65,s64
v_readlane_b32 s64,v17,3
s_lshr_b32 s64,s64,8
s_add_u32 s65,s65,s64
v_readlane_b32 s64,v17,5
s_lshr_b32 s64,s64,8
s_add_u32 s65,s65,s64
v_readlane_b32 s64,v17,7
s_lshr_b32 s64,s64,8
s_add_u32 s65,s65,s64
v_readlane_b32 s64,v17,9
s_lshr_b32 s64,s64,8
s_add_u32 s65,s65,s64
v_readlane_b32 s64,v17,11
s_lshr_b32 s64,s64,8
s_add_u32 s65,s65,s64
v_readlane_b32 s64,v17,13
s_lshr_b32 s64,s64,8
s_add_u32 s65,s65,s64
v_readlane_b32 s64,v17,15
s_lshr_b32 s64,s64,8
s_add_u32 s65,s65,s64
s_cmp_ge_u32 s65,256
s_cbranch_scc1 fl_fb
vfin_52:
s_and_b32 s56,s56,1
s_mov_b32 s67,0
v_readlane_b32 s65,v17,21
s_and_b32 s65,s65,2
s_lshl_b32 s67,s65,12
s_barrier
v_lshlrev_b32 v0,4,v1
s_mov_b32 s60,0
s_lshl_b32 s63,s50,13
s_add_u32 s61,s63,146800640
s_mov_b32 s70,0
s_lshl_b32 s52,s59,14
s_and_b32 s64,s50,1
s_lshl_b32 s64,s64,11
s_add_u32 s53,s52,s64
s_lshl_b32 s64,s50,10
s_add_u32 s52,s52,s64
s_add_u32 s52,s52,4096
s_cmp_gt_u32 s50,1
s_cselect_b32 s54,0x2000,0
s_lshl_b32 s69,s59,6
s_add_u32 s69,s69,s67
s_add_u32 s69,s69,138412032
v_mov_b32 v4,v0
v_add_u32 v5,32768,v0
s_add_u32 m0,s70,s63
s_add_u32 s62,s61,4096
buffer_load_dwordx4 v0,s[20:23],s61 offen offset:0 lds
buffer_load_dwordx4 v0,s[20:23],s61 offen offset:1024 lds
buffer_load_dwordx4 v0,s[20:23],s61 offen offset:2048 lds
buffer_load_dwordx4 v0,s[20:23],s61 offen offset:3072 lds
s_add_u32 m0,m0,4096
s_nop 0
buffer_load_dwordx4 v0,s[20:23],s62 offen offset:0 lds
buffer_load_dwordx4 v0,s[20:23],s62 offen offset:1024 lds
buffer_load_dwordx4 v0,s[20:23],s62 offen offset:2048 lds
buffer_load_dwordx4 v0,s[20:23],s62 offen offset:3072 lds
s_add_u32 s61,s61,32768
s_add_u32 s70,s70,32768
s_and_b32 s70,s70,0x1ffff
s_add_u32 m0,s70,s63
s_add_u32 s62,s61,4096
buffer_load_dwordx4 v0,s[20:23],s61 offen offset:0 lds
buffer_load_dwordx4 v0,s[20:23],s61 offen offset:1024 lds
buffer_load_dwordx4 v0,s[20:23],s61 offen offset:2048 lds
buffer_load_dwordx4 v0,s[20:23],s61 offen offset:3072 lds
s_add_u32 m0,m0,4096
s_nop 0
buffer_load_dwordx4 v0,s[20:23],s62 offen offset:0 lds
buffer_load_dwordx4 v0,s[20:23],s62 offen offset:1024 lds
buffer_load_dwordx4 v0,s[20:23],s62 offen offset:2048 lds
buffer_load_dwordx4 v0,s[20:23],s62 offen offset:3072 lds
s_add_u32 s61,s61,32768
s_add_u32 s70,s70,32768
s_and_b32 s70,s70,0x1ffff
s_waitcnt vmcnt(8)
s_barrier
ds_read_b128 v[64:67],v4 offset:0
ds_read_b128 v[68:71],v4 offset:1024
ds_read_b128 v[72:75],v4 offset:2048
ds_read_b128 v[76:79],v4 offset:3072
ds_read_b128 v[80:83],v4 offset:4096
top_53:
s_waitcnt lgkmcnt(4)
v_mfma_f32_16x16x32_bf16 v[32:35],a[0:3],v[64:67],0
ds_read_b128 v[84:87],v4 offset:5120
v_mfma_f32_16x16x32_bf16 v[36:39],a[4:7],v[64:67],0
v_mfma_f32_16x16x32_bf16 v[40:43],v[64:67],a[8:11],0
s_waitcnt lgkmcnt(4)
v_mfma_f32_16x16x32_bf16 v[32:35],a[12:15],v[68:71],v[32:35]
ds_read_b128 v[88:91],v4 offset:6144
s_sub_u32 s66,s60,1
s_lshr_b32 s64,s66,1
v_mfma_f32_16x16x32_bf16 v[36:39],a[16:19],v[68:71],v[36:39]
s_lshl_b32 s65,s64,12
s_and_b32 s65,s65,0x2000
v_mfma_f32_16x16x32_bf16 v[40:43],v[68:71],a[20:23],v[40:43]
s_xor_b32 s65,s65,s67
s_lshl_b32 s64,s64,20
s_waitcnt lgkmcnt(4)
v_mfma_f32_16x16x32_bf16 v[32:35],a[24:27],v[72:75],v[32:35]
ds_read_b128 v[92:95],v4 offset:7168
s_add_u32 s64,s64,s65
s_add_u32 s65,s64,s52
v_mfma_f32_16x16x32_bf16 v[36:39],a[28:31],v[72:75],v[36:39]
s_xor_b32 s64,s64,s54
s_add_u32 s66,s64,s53
v_mfma_f32_16x16x32_bf16 v[40:43],v[72:75],a[32:35],v[40:43]
s_cmp_eq_u32 s60,0
s_cselect_b32 s65,138608640,s65
s_waitcnt lgkmcnt(4)
v_mfma_f32_16x16x32_bf16 v[32:35],a[36:39],v[76:79],v[32:35]
ds_read_b128 v[96:99],v4 offset:8192
s_cselect_b32 s66,138608640,s66
v_mfma_f32_16x16x32_bf16 v[36:39],a[40:43],v[76:79],v[36:39]
v_cvt_pk_bf16_f32 v60,v44,v45
v_mfma_f32_16x16x32_bf16 v[40:43],v[76:79],a[44:47],v[40:43]
v_cvt_pk_bf16_f32 v61,v46,v47
s_waitcnt lgkmcnt(4)
v_mfma_f32_16x16x32_bf16 v[32:35],a[48:51],v[80:83],v[32:35]
ds_read_b128 v[100:103],v4 offset:9216
v_cvt_pk_bf16_f32 v62,v48,v49
v_mfma_f32_16x16x32_bf16 v[36:39],a[52:55],v[80:83],v[36:39]
v_cvt_pk_bf16_f32 v63,v50,v51
v_mfma_f32_16x16x32_bf16 v[40:43],v[80:83],a[56:59],v[40:43]
v_cvt_pk_bf16_f32 v58,v52,v53
s_waitcnt lgkmcnt(4)
v_mfma_f32_16x16x32_bf16 v[32:35],a[60:63],v[84:87],v[32:35]
ds_read_b128 v[104:107],v4 offset:10240
v_cvt_pk_bf16_f32 v59,v54,v55
v_mfma_f32_16x16x32_bf16 v[36:39],a[64:67],v[84:87],v[36:39]
buffer_store_dwordx4 v[60:63],v0,s[20:23],s66 offen offset:1024 sc1
v_mfma_f32_16x16x32_bf16 v[40:43],v[84:87],a[68:71],v[40:43]
buffer_store_dwordx4 v[56:59],v0,s[20:23],s65 offen sc1
s_waitcnt lgkmcnt(4)
v_mfma_f32_16x16x32_bf16 v[32:35],a[72:75],v[88:91],v[32:35]
ds_read_b128 v[108:111],v4 offset:11264
v_mfma_f32_16x16x32_bf16 v[36:39],a[76:79],v[88:91],v[36:39]
v_mfma_f32_16x16x32_bf16 v[40:43],v[88:91],a[80:83],v[40:43]
s_waitcnt lgkmcnt(4)
v_mfma_f32_16x16x32_bf16 v[32:35],a[84:87],v[92:95],v[32:35]
ds_read_b128 v[112:115],v4 offset:12288
v_mfma_f32_16x16x32_bf16 v[36:39],a[88:91],v[92:95],v[36:39]
v_mfma_f32_16x16x32_bf16 v[40:43],v[92:95],a[92:95],v[40:43]
s_waitcnt lgkmcnt(4)
v_mfma_f32_16x16x32_bf16 v[32:35],a[96:99],v[96:99],v[32:35]
ds_read_b128 v[116:119],v4 offset:13312
v_mfma_f32_16x16x32_bf16 v[36:39],a[100:103],v[96:99],v[36:39]
v_mfma_f32_16x16x32_bf16 v[40:43],v[96:99],a[104:107],v[40:43]
s_waitcnt lgkmcnt(4)
v_mfma_f32_16x16x32_bf16 v[32:35],a[108:111],v[100:103],v[32:35]
ds_read_b128 v[120:123],v4 offset:14336
v_mfma_f32_16x16x32_bf16 v[36:39],a[112:115],v[100:103],v[36:39]
v_mfma_f32_16x16x32_bf16 v[40:43],v[100:103],a[116:119],v[40:43]
s_waitcnt lgkmcnt(4)
v_mfma_f32_16x16x32_bf16 v[32:35],a[120:123],v[104:107],v[32:35]
ds_read_b128 v[124:127],v4 offset:15360
v_mfma_f32_16x16x32_bf16 v[36:39],a[124:127],v[104:107],v[36:39]
v_mfma_f32_16x16x32_bf16 v[40:43],v[104:107],a[128:131],v[40:43]
s_waitcnt lgkmcnt(4)
v_mfma_f32_16x16x32_bf16 v[32:35],a[132:135],v[108:111],v[32:35]
ds_read_b128 v[64:67],v4 offset:16384
v_mfma_f32_16x16x32_bf16 v[36:39],a[136:139],v[108:111],v[36:39]
v_mfma_f32_16x16x32_bf16 v[40:43],v[108:111],a[140:143],v[40:43]
s_waitcnt lgkmcnt(4)
v_mfma_f32_16x16x32_bf16 v[32:35],a[144:147],v[112:115],v[32:35]
ds_read_b128 v[68:71],v4 offset:17408
v_mfma_f32_16x16x32_bf16 v[36:39],a[148:151],v[112:115],v[36:39]
v_mfma_f32_16x16x32_bf16 v[40:43],v[112:115],a[152:155],v[40:43]
s_waitcnt lgkmcnt(4)
v_mfma_f32_16x16x32_bf16 v[32:35],a[156:159],v[116:119],v[32:35]
ds_read_b128 v[72:75],v4 offset:18432
v_mfma_f32_16x16x32_bf16 v[36:39],a[160:163],v[116:119],v[36:39]
v_mfma_f32_16x16x32_bf16 v[40:43],v[116:119],a[164:167],v[40:43]
s_waitcnt lgkmcnt(4)
v_mfma_f32_16x16x32_bf16 v[32:35],a[168:171],v[120:123],v[32:35]
ds_read_b128 v[76:79],v4 offset:19456
v_mfma_f32_16x16x32_bf16 v[36:39],a[172:175],v[120:123],v[36:39]
v_mfma_f32_16x16x32_bf16 v[40:43],v[120:123],a[176:179],v[40:43]
s_waitcnt lgkmcnt(4)
v_mfma_f32_16x16x32_bf16 v[32:35],a[180:183],v[124:127],v[32:35]
ds_read_b128 v[80:83],v4 offset:20480
v_mfma_f32_16x16x32_bf16 v[36:39],a[184:187],v[124:127],v[36:39]
s_waitcnt vmcnt(2)
s_cmp_eq_u32 s60,60
s_cbranch_scc1 hb_56
s_cmp_eq_u32 s60,16
s_cbranch_scc1 hc_58
hb2_57:
s_sub_u32 s64,s60,2
s_cmp_gt_u32 s64,128
s_cbranch_scc1 sk_55
s_waitcnt vmcnt(0)
sk_55:
s_cselect_b32 s64,1,s50
s_barrier
s_cmp_ge_u32 s60,126
s_cselect_b32 s61,146800640,s61
s_cmp_lg_u32 s64,0
s_cbranch_scc1 nf_54
s_lshr_b32 s64,s60,1
v_mov_b32 v6,s64
s_mov_b64 exec,1
buffer_store_dword v6,off,s[20:23],s69 sc1
s_mov_b64 exec,-1
nf_54:
v_mfma_f32_16x16x32_bf16 v[40:43],v[124:127],a[188:191],v[40:43]
s_waitcnt lgkmcnt(4)
v_mfma_f32_16x16x32_bf16 v[32:35],a[192:195],v[64:67],v[32:35]
ds_read_b128 v[84:87],v4 offset:21504
s_add_u32 m0,s70,s63
v_mfma_f32_16x16x32_bf16 v[36:39],a[196:199],v[64:67],v[36:39]
v_mfma_f32_16x16x32_bf16 v[40:43],v[64:67],a[200:203],v[40:43]
s_add_u32 s62,s61,4096
s_waitcnt lgkmcnt(4)
v_mfma_f32_16x16x32_bf16 v[32:35],a[204:207],v[68:71],v[32:35]
ds_read_b128 v[88:91],v4 offset:22528
v_mfma_f32_16x16x32_bf16 v[36:39],a[208:211],v[68:71],v[36:39]
buffer_load_dwordx4 v0,s[20:23],s61 offen offset:0 lds
v_mfma_f32_16x16x32_bf16 v[40:43],v[68:71],a[212:215],v[40:43]
s_waitcnt lgkmcnt(4)
v_mfma_f32_16x16x32_bf16 v[32:35],a[216:219],v[72:75],v[32:35]
ds_read_b128 v[92:95],v4 offset:23552
buffer_load_dwordx4 v0,s[20:23],s61 offen offset:1024 lds
v_mfma_f32_16x16x32_bf16 v[36:39],a[220:223],v[72:75],v[36:39]
v_mfma_f32_16x16x32_bf16 v[40:43],v[72:75],a[224:227],v[40:43]
buffer_load_dwordx4 v0,s[20:23],s61 offen offset:2048 lds
s_waitcnt lgkmcnt(4)
v_mfma_f32_16x16x32_bf16 v[32:35],a[228:231],v[76:79],v[32:35]
ds_read_b128 v[96:99],v4 offset:24576
v_mfma_f32_16x16x32_bf16 v[36:39],a[232:235],v[76:79],v[36:39]
buffer_load_dwordx4 v0,s[20:23],s61 offen offset:3072 lds
v_mfma_f32_16x16x32_bf16 v[40:43],v[76:79],a[236:239],v[40:43]
s_waitcnt lgkmcnt(4)
v_mfma_f32_16x16x32_bf16 v[32:35],a[240:243],v[80:83],v[32:35]
ds_read_b128 v[100:103],v4 offset:25600
s_add_u32 m0,m0,4096
v_mfma_f32_16x16x32_bf16 v[36:39],a[244:247],v[80:83],v[36:39]
v_mfma_f32_16x16x32_bf16 v[40:43],v[80:83],a[248:251],v[40:43]
buffer_load_dwordx4 v0,s[20:23],s62 offen offset:0 lds
s_waitcnt lgkmcnt(4)
v_mfma_f32_16x16x32_bf16 v[32:35],a[252:255],v[84:87],v[32:35]
ds_read_b128 v[104:107],v4 offset:26624
v_mfma_f32_16x16x32_bf16 v[36:39],v[128:131],v[84:87],v[36:39]
buffer_load_dwordx4 v0,s[20:23],s62 offen offset:1024 lds
v_mfma_f32_16x16x32_bf16 v[40:43],v[84:87],v[132:135],v[40:43]
s_waitcnt lgkmcnt(4)
v_mfma_f32_16x16x32_bf16 v[32:35],v[136:139],v[88:91],v[32:35]
ds_read_b128 v[108:111],v4 offset:27648
buffer_load_dwordx4 v0,s[20:23],s62 offen offset:2048 lds
v_mfma_f32_16x16x32_bf16 v[36:39],v[140:143],v[88:91],v[36:39]
v_mfma_f32_16x16x32_bf16 v[40:43],v[88:91],v[144:147],v[40:43]
buffer_load_dwordx4 v0,s[20:23],s62 offen offset:3072 lds
s_waitcnt lgkmcnt(4)
v_mfma_f32_16x16x32_bf16 v[32:35],v[148:151],v[92:95],v[32:35]
ds_read_b128 v[112:115],v4 offset:28672
v_mfma_f32_16x16x32_bf16 v[36:39],v[152:155],v[92:95],v[36:39]
s_add_u32 s61,s61,32768
v_mfma_f32_16x16x32_bf16 v[40:43],v[92:95],v[156:159],v[40:43]
s_waitcnt lgkmcnt(4)
v_mfma_f32_16x16x32_bf16 v[32:35],v[160:163],v[96:99],v[32:35]
ds_read_b128 v[116:119],v4 offset:29696
s_add_u32 s70,s70,32768
v_mfma_f32_16x16x32_bf16 v[36:39],v[164:167],v[96:99],v[36:39]
v_mfma_f32_16x16x32_bf16 v[40:43],v[96:99],v[168:171],v[40:43]
s_and_b32 s70,s70,0x1ffff
s_waitcnt lgkmcnt(4)
v_mfma_f32_16x16x32_bf16 v[32:35],v[172:175],v[100:103],v[32:35]
ds_read_b128 v[120:123],v4 offset:30720
v_mfma_f32_16x16x32_bf16 v[36:39],v[176:179],v[100:103],v[36:39]
v_mfma_f32_16x16x32_bf16 v[40:43],v[100:103],v[180:183],v[40:43]
s_waitcnt lgkmcnt(4)
v_mfma_f32_16x16x32_bf16 v[32:35],v[184:187],v[104:107],v[32:35]
ds_read_b128 v[124:127],v4 offset:31744
v_mfma_f32_16x16x32_bf16 v[36:39],v[188:191],v[104:107],v[36:39]
v_mfma_f32_16x16x32_bf16 v[40:43],v[104:107],v[192:195],v[40:43]
s_waitcnt lgkmcnt(4)
v_mfma_f32_16x16x32_bf16 v[32:35],v[196:199],v[108:111],v[32:35]
ds_read_b128 v[64:67],v5 offset:0
v_mfma_f32_16x16x32_bf16 v[36:39],v[200:203],v[108:111],v[36:39]
v_mfma_f32_16x16x32_bf16 v[40:43],v[108:111],v[204:207],v[40:43]
s_waitcnt lgkmcnt(4)
v_mfma_f32_16x16x32_bf16 v[32:35],v[208:211],v[112:115],v[32:35]
ds_read_b128 v[68:71],v5 offset:1024
v_mfma_f32_16x16x32_bf16 v[36:39],v[212:215],v[112:115],v[36:39]
v_mfma_f32_16x16x32_bf16 v[40:43],v[112:115],v[216:219],v[40:43]
s_waitcnt lgkmcnt(4)
v_mfma_f32_16x16x32_bf16 v[32:35],v[220:223],v[116:119],v[32:35]
ds_read_b128 v[72:75],v5 offset:2048
v_mfma_f32_16x16x32_bf16 v[36:39],v[224:227],v[116:119],v[36:39]
v_mfma_f32_16x16x32_bf16 v[40:43],v[116:119],v[228:231],v[40:43]
s_waitcnt lgkmcnt(4)
v_mfma_f32_16x16x32_bf16 v[32:35],v[232:235],v[120:123],v[32:35]
ds_read_b128 v[76:79],v5 offset:3072
v_mfma_f32_16x16x32_bf16 v[36:39],v[236:239],v[120:123],v[36:39]
v_mfma_f32_16x16x32_bf16 v[40:43],v[120:123],v[240:243],v[40:43]
s_waitcnt lgkmcnt(4)
v_mfma_f32_16x16x32_bf16 v[32:35],v[244:247],v[124:127],v[32:35]
ds_read_b128 v[80:83],v5 offset:4096
v_mfma_f32_16x16x32_bf16 v[36:39],v[248:251],v[124:127],v[36:39]
v_mfma_f32_16x16x32_bf16 v[40:43],v[124:127],v[252:255],v[40:43]
v_mov_b32 v4,v5
v_add_u32 v5,32768,v5
v_and_b32 v5,0x1ffff,v5
s_add_u32 s60,s60,1
s_waitcnt lgkmcnt(4)
v_mfma_f32_16x16x32_bf16 v[44:47],a[0:3],v[64:67],0
ds_read_b128 v[84:87],v4 offset:5120
v_mfma_f32_16x16x32_bf16 v[48:51],a[4:7],v[64:67],0
v_mfma_f32_16x16x32_bf16 v[52:55],v[64:67],a[8:11],0
s_waitcnt lgkmcnt(4)
v_mfma_f32_16x16x32_bf16 v[44:47],a[12:15],v[68:71],v[44:47]
ds_read_b128 v[88:91],v4 offset:6144
s_sub_u32 s66,s60,1
s_lshr_b32 s64,s66,1
v_mfma_f32_16x16x32_bf16 v[48:51],a[16:19],v[68:71],v[48:51]
s_lshl_b32 s65,s64,12
s_and_b32 s65,s65,0x2000
v_mfma_f32_16x16x32_bf16 v[52:55],v[68:71],a[20:23],v[52:55]
s_xor_b32 s65,s65,s67
s_lshl_b32 s64,s64,20
s_waitcnt lgkmcnt(4)
v_mfma_f32_16x16x32_bf16 v[44:47],a[24:27],v[72:75],v[44:47]
ds_read_b128 v[92:95],v4 offset:7168
s_add_u32 s64,s64,s65
s_add_u32 s65,s64,s52
v_mfma_f32_16x16x32_bf16 v[48:51],a[28:31],v[72:75],v[48:51]
s_xor_b32 s64,s64,s54
s_add_u32 s66,s64,s53
v_mfma_f32_16x16x32_bf16 v[52:55],v[72:75],a[32:35],v[52:55]
v_cvt_pk_bf16_f32 v60,v32,v33
v_cvt_pk_bf16_f32 v61,v34,v35
s_waitcnt lgkmcnt(4)
v_mfma_f32_16x16x32_bf16 v[44:47],a[36:39],v[76:79],v[44:47]
ds_read_b128 v[96:99],v4 offset:8192
v_cvt_pk_bf16_f32 v62,v36,v37
v_mfma_f32_16x16x32_bf16 v[48:51],a[40:43],v[76:79],v[48:51]
v_cvt_pk_bf16_f32 v63,v38,v39
v_mfma_f32_16x16x32_bf16 v[52:55],v[76:79],a[44:47],v[52:55]
v_cvt_pk_bf16_f32 v56,v40,v41
s_waitcnt lgkmcnt(4)
v_mfma_f32_16x16x32_bf16 v[44:47],a[48:51],v[80:83],v[44:47]
ds_read_b128 v[100:103],v4 offset:9216
v_cvt_pk_bf16_f32 v57,v42,v43
v_mfma_f32_16x16x32_bf16 v[48:51],a[52:55],v[80:83],v[48:51]
buffer_store_dwordx4 v[60:63],v0,s[20:23],s66 offen offset:0 sc1
v_mfma_f32_16x16x32_bf16 v[52:55],v[80:83],a[56:59],v[52:55]
s_waitcnt lgkmcnt(4)
v_mfma_f32_16x16x32_bf16 v[44:47],a[60:63],v[84:87],v[44:47]
ds_read_b128 v[104:107],v4 offset:10240
v_mfma_f32_16x16x32_bf16 v[48:51],a[64:67],v[84:87],v[48:51]
v_mfma_f32_16x16x32_bf16 v[52:55],v[84:87],a[68:71],v[52:55]
s_waitcnt lgkmcnt(4)
v_mfma_f32_16x16x32_bf16 v[44:47],a[72:75],v[88:91],v[44:47]
ds_read_b128 v[108:111],v4 offset:11264
v_mfma_f32_16x16x32_bf16 v[48:51],a[76:79],v[88:91],v[48:51]
v_mfma_f32_16x16x32_bf16 v[52:55],v[88:91],a[80:83],v[52:55]
s_waitcnt lgkmcnt(4)
v_mfma_f32_16x16x32_bf16 v[44:47],a[84:87],v[92:95],v[44:47]
ds_read_b128 v[112:115],v4 offset:12288
v_mfma_f32_16x16x32_bf16 v[48:51],a[88:91],v[92:95],v[48:51]
v_mfma_f32_16x16x32_bf16 v[52:55],v[92:95],a[92:95],v[52:55]
s_waitcnt lgkmcnt(4)
v_mfma_f32_16x16x32_bf16 v[44:47],a[96:99],v[96:99],v[44:47]
ds_read_b128 v[116:119],v4 offset:13312
v_mfma_f32_16x16x32_bf16 v[48:51],a[100:103],v[96:99],v[48:51]
v_mfma_f32_16x16x32_bf16 v[52:55],v[96:99],a[104:107],v[52:55]
s_waitcnt lgkmcnt(4)
v_mfma_f32_16x16x32_bf16 v[44:47],a[108:111],v[100:103],v[44:47]
ds_read_b128 v[120:123],v4 offset:14336
v_mfma_f32_16x16x32_bf16 v[48:51],a[112:115],v[100:103],v[48:51]
v_mfma_f32_16x16x32_bf16 v[52:55],v[100:103],a[116:119],v[52:55]
s_waitcnt lgkmcnt(4)
v_mfma_f32_16x16x32_bf16 v[44:47],a[120:123],v[104:107],v[44:47]
ds_read_b128 v[124:127],v4 offset:15360
v_mfma_f32_16x16x32_bf16 v[48:51],a[124:127],v[104:107],v[48:51]
v_mfma_f32_16x16x32_bf16 v[52:55],v[104:107],a[128:131],v[52:55]
s_waitcnt lgkmcnt(4)
v_mfma_f32_16x16x32_bf16 v[44:47],a[132:135],v[108:111],v[44:47]
ds_read_b128 v[64:67],v4 offset:16384
v_mfma_f32_16x16x32_bf16 v[48:51],a[136:139],v[108:111],v[48:51]
v_mfma_f32_16x16x32_bf16 v[52:55],v[108:111],a[140:143],v[52:55]
s_waitcnt lgkmcnt(4)
v_mfma_f32_16x16x32_bf16 v[44:47],a[144:147],v[112:115],v[44:47]
ds_read_b128 v[68:71],v4 offset:17408
v_mfma_f32_16x16x32_bf16 v[48:51],a[148:151],v[112:115],v[48:51]
v_mfma_f32_16x16x32_bf16 v[52:55],v[112:115],a[152:155],v[52:55]
s_waitcnt lgkmcnt(4)
v_mfma_f32_16x16x32_bf16 v[44:47],a[156:159],v[116:119],v[44:47]
ds_read_b128 v[72:75],v4 offset:18432
v_mfma_f32_16x16x32_bf16 v[48:51],a[160:163],v[116:119],v[48:51]
v_mfma_f32_16x16x32_bf16 v[52:55],v[116:119],a[164:167],v[52:55]
s_waitcnt lgkmcnt(4)
v_mfma_f32_16x16x32_bf16 v[44:47],a[168:171],v[120:123],v[44:47]
ds_read_b128 v[76:79],v4 offset:19456
v_mfma_f32_16x16x32_bf16 v[48:51],a[172:175],v[120:123],v[48:51]
v_mfma_f32_16x16x32_bf16 v[52:55],v[120:123],a[176:179],v[52:55]
s_waitcnt lgkmcnt(4)
v_mfma_f32_16x16x32_bf16 v[44:47],a[180:183],v[124:127],v[44:47]
ds_read_b128 v[80:83],v4 offset:20480
v_mfma_f32_16x16x32_bf16 v[48:51],a[184:187],v[124:127],v[48:51]
s_waitcnt vmcnt(1)
s_mov_b32 s64,s50
s_barrier
s_cmp_ge_u32 s60,126
s_cselect_b32 s61,146800640,s61
s_cmp_lg_u32 s64,0
s_cbranch_scc1 nf_59
s_lshr_b32 s64,s60,1
v_mov_b32 v6,s64
s_mov_b64 exec,1
buffer_store_dword v6,off,s[20:23],s69 sc1
s_mov_b64 exec,-1
nf_59:
v_mfma_f32_16x16x32_bf16 v[52:55],v[124:127],a[188:191],v[52:55]
s_waitcnt lgkmcnt(4)
v_mfma_f32_16x16x32_bf16 v[44:47],a[192:195],v[64:67],v[44:47]
ds_read_b128 v[84:87],v4 offset:21504
s_add_u32 m0,s70,s63
v_mfma_f32_16x16x32_bf16 v[48:51],a[196:199],v[64:67],v[48:51]
v_mfma_f32_16x16x32_bf16 v[52:55],v[64:67],a[200:203],v[52:55]
s_add_u32 s62,s61,4096
s_waitcnt lgkmcnt(4)
v_mfma_f32_16x16x32_bf16 v[44:47],a[204:207],v[68:71],v[44:47]
ds_read_b128 v[88:91],v4 offset:22528
v_mfma_f32_16x16x32_bf16 v[48:51],a[208:211],v[68:71],v[48:51]
buffer_load_dwordx4 v0,s[20:23],s61 offen offset:0 lds
v_mfma_f32_16x16x32_bf16 v[52:55],v[68:71],a[212:215],v[52:55]
s_waitcnt lgkmcnt(4)
v_mfma_f32_16x16x32_bf16 v[44:47],a[216:219],v[72:75],v[44:47]
ds_read_b128 v[92:95],v4 offset:23552
buffer_load_dwordx4 v0,s[20:23],s61 offen offset:1024 lds
v_mfma_f32_16x16x32_bf16 v[48:51],a[220:223],v[72:75],v[48:51]
v_mfma_f32_16x16x32_bf16 v[52:55],v[72:75],a[224:227],v[52:55]
buffer_load_dwordx4 v0,s[20:23],s61 offen offset:2048 lds
s_waitcnt lgkmcnt(4)
v_mfma_f32_16x16x32_bf16 v[44:47],a[228:231],v[76:79],v[44:47]
ds_read_b128 v[96:99],v4 offset:24576
v_mfma_f32_16x16x32_bf16 v[48:51],a[232:235],v[76:79],v[48:51]
buffer_load_dwordx4 v0,s[20:23],s61 offen offset:3072 lds
v_mfma_f32_16x16x32_bf16 v[52:55],v[76:79],a[236:239],v[52:55]
s_waitcnt lgkmcnt(4)
v_mfma_f32_16x16x32_bf16 v[44:47],a[240:243],v[80:83],v[44:47]
ds_read_b128 v[100:103],v4 offset:25600
s_add_u32 m0,m0,4096
v_mfma_f32_16x16x32_bf16 v[48:51],a[244:247],v[80:83],v[48:51]
v_mfma_f32_16x16x32_bf16 v[52:55],v[80:83],a[248:251],v[52:55]
buffer_load_dwordx4 v0,s[20:23],s62 offen offset:0 lds
s_waitcnt lgkmcnt(4)
v_mfma_f32_16x16x32_bf16 v[44:47],a[252:255],v[84:87],v[44:47]
ds_read_b128 v[104:107],v4 offset:26624
v_mfma_f32_16x16x32_bf16 v[48:51],v[128:131],v[84:87],v[48:51]
buffer_load_dwordx4 v0,s[20:23],s62 offen offset:1024 lds
v_mfma_f32_16x16x32_bf16 v[52:55],v[84:87],v[132:135],v[52:55]
s_waitcnt lgkmcnt(4)
v_mfma_f32_16x16x32_bf16 v[44:47],v[136:139],v[88:91],v[44:47]
ds_read_b128 v[108:111],v4 offset:27648
buffer_load_dwordx4 v0,s[20:23],s62 offen offset:2048 lds
v_mfma_f32_16x16x32_bf16 v[48:51],v[140:143],v[88:91],v[48:51]
v_mfma_f32_16x16x32_bf16 v[52:55],v[88:91],v[144:147],v[52:55]
buffer_load_dwordx4 v0,s[20:23],s62 offen offset:3072 lds
s_waitcnt lgkmcnt(4)
v_mfma_f32_16x16x32_bf16 v[44:47],v[148:151],v[92:95],v[44:47]
ds_read_b128 v[112:115],v4 offset:28672
v_mfma_f32_16x16x32_bf16 v[48:51],v[152:155],v[92:95],v[48:51]
s_add_u32 s61,s61,32768
v_mfma_f32_16x16x32_bf16 v[52:55],v[92:95],v[156:159],v[52:55]
s_waitcnt lgkmcnt(4)
v_mfma_f32_16x16x32_bf16 v[44:47],v[160:163],v[96:99],v[44:47]
ds_read_b128 v[116:119],v4 offset:29696
s_add_u32 s70,s70,32768
v_mfma_f32_16x16x32_bf16 v[48:51],v[164:167],v[96:99],v[48:51]
v_mfma_f32_16x16x32_bf16 v[52:55],v[96:99],v[168:171],v[52:55]
s_and_b32 s70,s70,0x1ffff
s_waitcnt lgkmcnt(4)
v_mfma_f32_16x16x32_bf16 v[44:47],v[172:175],v[100:103],v[44:47]
ds_read_b128 v[120:123],v4 offset:30720
v_mfma_f32_16x16x32_bf16 v[48:51],v[176:179],v[100:103],v[48:51]
v_mfma_f32_16x16x32_bf16 v[52:55],v[100:103],v[180:183],v[52:55]
s_waitcnt lgkmcnt(4)
v_mfma_f32_16x16x32_bf16 v[44:47],v[184:187],v[104:107],v[44:47]
ds_read_b128 v[124:127],v4 offset:31744
v_mfma_f32_16x16x32_bf16 v[48:51],v[188:191],v[104:107],v[48:51]
v_mfma_f32_16x16x32_bf16 v[52:55],v[104:107],v[192:195],v[52:55]
s_waitcnt lgkmcnt(4)
v_mfma_f32_16x16x32_bf16 v[44:47],v[196:199],v[108:111],v[44:47]
ds_read_b128 v[64:67],v5 offset:0
v_mfma_f32_16x16x32_bf16 v[48:51],v[200:203],v[108:111],v[48:51]
v_mfma_f32_16x16x32_bf16 v[52:55],v[108:111],v[204:207],v[52:55]
s_waitcnt lgkmcnt(4)
v_mfma_f32_16x16x32_bf16 v[44:47],v[208:211],v[112:115],v[44:47]
ds_read_b128 v[68:71],v5 offset:1024
v_mfma_f32_16x16x32_bf16 v[48:51],v[212:215],v[112:115],v[48:51]
v_mfma_f32_16x16x32_bf16 v[52:55],v[112:115],v[216:219],v[52:55]
s_waitcnt lgkmcnt(4)
v_mfma_f32_16x16x32_bf16 v[44:47],v[220:223],v[116:119],v[44:47]
ds_read_b128 v[72:75],v5 offset:2048
v_mfma_f32_16x16x32_bf16 v[48:51],v[224:227],v[116:119],v[48:51]
v_mfma_f32_16x16x32_bf16 v[52:55],v[116:119],v[228:231],v[52:55]
s_waitcnt lgkmcnt(4)
v_mfma_f32_16x16x32_bf16 v[44:47],v[232:235],v[120:123],v[44:47]
ds_read_b128 v[76:79],v5 offset:3072
v_mfma_f32_16x16x32_bf16 v[48:51],v[236:239],v[120:123],v[48:51]
v_mfma_f32_16x16x32_bf16 v[52:55],v[120:123],v[240:243],v[52:55]
s_waitcnt lgkmcnt(4)
v_mfma_f32_16x16x32_bf16 v[44:47],v[244:247],v[124:127],v[44:47]
ds_read_b128 v[80:83],v5 offset:4096
v_mfma_f32_16x16x32_bf16 v[48:51],v[248:251],v[124:127],v[48:51]
v_mfma_f32_16x16x32_bf16 v[52:55],v[124:127],v[252:255],v[52:55]
v_mov_b32 v4,v5
v_add_u32 v5,32768,v5
v_and_b32 v5,0x1ffff,v5
s_add_u32 s60,s60,1
s_cmp_lt_u32 s60,128
s_cbranch_scc1 top_53
s_sub_u32 s66,s60,1
s_lshr_b32 s64,s66,1
s_lshl_b32 s65,s64,12
s_and_b32 s65,s65,0x2000
s_xor_b32 s65,s65,s67
s_lshl_b32 s64,s64,20
s_add_u32 s64,s64,s65
s_add_u32 s65,s64,s52
s_xor_b32 s64,s64,s54
s_add_u32 s66,s64,s53
s_cmp_eq_u32 s60,0
s_cselect_b32 s65,138608640,s65
s_cselect_b32 s66,138608640,s66
v_cvt_pk_bf16_f32 v60,v44,v45
v_cvt_pk_bf16_f32 v61,v46,v47
v_cvt_pk_bf16_f32 v62,v48,v49
v_cvt_pk_bf16_f32 v63,v50,v51
v_cvt_pk_bf16_f32 v58,v52,v53
v_cvt_pk_bf16_f32 v59,v54,v55
buffer_store_dwordx4 v[60:63],v0,s[20:23],s66 offen offset:1024 sc1
buffer_store_dwordx4 v[56:59],v0,s[20:23],s65 offen sc1
s_waitcnt vmcnt(0) lgkmcnt(0)
s_barrier
s_cmp_lg_u32 s50,0
s_cbranch_scc1 done_46
v_mov_b32 v6,64
s_mov_b64 exec,1
buffer_store_dword v6,off,s[20:23],s69 sc1
s_mov_b64 exec,-1
done_46:
s_cmp_lt_u32 s59,32
s_cbranch_scc1 fl_att2
s_endpgm
hb_56:
s_mov_b32 s28,s2
s_and_b32 s29,s3,0xffff
s_mov_b32 s30,0x100
s_mov_b32 s31,0x20000
v_mbcnt_lo_u32_b32 v12,-1,0
v_mbcnt_hi_u32_b32 v12,-1,v12
v_mov_b32 v14,0
v_cmp_eq_u32 vcc,20,v12
s_nop 1
v_cndmask_b32 v14,v14,64,vcc
v_and_b32 v15,1,v12
v_cmp_eq_u32 vcc,1,v15
v_mov_b32 v15,8192
s_nop 0
v_cndmask_b32 v15,-1,v15,vcc
v_min_u32 v12,31,v12
v_lshlrev_b32 v12,2,v12
s_sub_u32 s66,s88,64
vpoll_60:
buffer_load_dword v13,v12,s[28:31],s66 offen sc1
s_waitcnt vmcnt(0)
vck_61:
v_cmp_gt_u32 vcc,v14,v13
s_cbranch_vccz vok_63
vrt_62:
s_sleep 8
s_sub_u32 s90,s90,1
s_cmp_gt_i32 s90,0
s_cbranch_scc1 vpoll_60
vok_63:
s_branch hb2_57
hc_58:
s_mov_b32 s28,s2
s_and_b32 s29,s3,0xffff
s_mov_b32 s30,0x100
s_mov_b32 s31,0x20000
v_mbcnt_lo_u32_b32 v12,-1,0
v_mbcnt_hi_u32_b32 v12,-1,v12
v_mov_b32 v14,0
v_cmp_eq_u32 vcc,17,v12
s_nop 1
v_cndmask_b32 v14,v14,63,vcc
v_and_b32 v15,1,v12
v_cmp_eq_u32 vcc,1,v15
v_mov_b32 v15,8192
s_nop 0
v_cndmask_b32 v15,-1,v15,vcc
v_min_u32 v12,31,v12
v_lshlrev_b32 v12,2,v12
s_sub_u32 s66,s88,64
vpoll_66:
buffer_load_dword v13,v12,s[28:31],s66 offen sc1
s_waitcnt vmcnt(0)
vck_67:
v_cmp_gt_u32 vcc,v14,v13
s_cbranch_vccz vok_69
vrt_68:
s_sleep 8
s_sub_u32 s90,s90,1
s_cmp_gt_i32 s90,0
s_cbranch_scc1 vpoll_66
vok_69:
s_branch hb2_57
fl_wo:
v_and_b32 v21,15,v1
v_lshrrev_b32 v22,4,v1
v_lshrrev_b32 v23,2,v21
v_and_b32 v24,3,v21
s_lshl_b32 s61,s50,15
v_lshl_add_u32 v25,v22,3,v23
s_load_dwordx2 s[4:5],s[0:1],40
s_load_dwordx2 s[6:7],s[0:1],0
s_lshr_b32 s52,s59,3
s_and_b32 s53,s59,7
s_mul_i32 s54,s52,2097152
s_lshl_b32 s64,s53,8
s_add_u32 s54,s54,s64
s_lshl_b32 s64,s50,6
s_add_u32 s54,s54,s64
s_waitcnt lgkmcnt(0)
s_mov_b32 s28,s4
s_and_b32 s29,s5,0xffff
s_mov_b32 s30,0x800000
s_mov_b32 s31,0x20000
s_mov_b32 s24,s6
s_and_b32 s25,s7,0xffff
s_mov_b32 s26,0x400000
s_mov_b32 s27,0x20000
v_lshrrev_b32 v26,2,v1
v_and_b32 v27,3,v1
v_mul_u32_u24 v16,2048,v26
v_lshl_add_u32 v16,v27,4,v16
v_lshlrev_b32 v17,6,v25
v_lshl_add_u32 v17,v24,4,v17
v_add_u32 v17,s61,v17
s_xor_b32 s62,s50,0
s_mul_i32 s62,s62,524288
s_add_u32 s62,s62,s54
s_add_u32 m0,s61,0
s_nop 0
buffer_load_dwordx4 v16,s[28:31],s62 offen lds
s_add_u32 s62,s62,32768
s_add_u32 m0,m0,1024
s_waitcnt vmcnt(2)
buffer_load_dwordx4 v16,s[28:31],s62 offen lds
s_add_u32 s62,s62,32768
s_add_u32 m0,m0,1024
s_waitcnt vmcnt(2)
buffer_load_dwordx4 v16,s[28:31],s62 offen lds
s_add_u32 s62,s62,32768
s_add_u32 m0,m0,1024
s_waitcnt vmcnt(2)
buffer_load_dwordx4 v16,s[28:31],s62 offen lds
s_add_u32 s62,s62,32768
s_add_u32 m0,m0,1024
s_waitcnt vmcnt(2)
buffer_load_dwordx4 v16,s[28:31],s62 offen lds
s_add_u32 s62,s62,32768
s_add_u32 m0,m0,1024
s_waitcnt vmcnt(2)
buffer_load_dwordx4 v16,s[28:31],s62 offen lds
s_add_u32 s62,s62,32768
s_add_u32 m0,m0,1024
s_waitcnt vmcnt(2)
buffer_load_dwordx4 v16,s[28:31],s62 offen lds
s_add_u32 s62,s62,32768
s_add_u32 m0,m0,1024
s_waitcnt vmcnt(2)
buffer_load_dwordx4 v16,s[28:31],s62 offen lds
s_add_u32 s62,s62,32768
s_add_u32 m0,m0,1024
s_waitcnt vmcnt(2)
buffer_load_dwordx4 v16,s[28:31],s62 offen lds
s_add_u32 s62,s62,32768
s_add_u32 m0,m0,1024
s_waitcnt vmcnt(2)
buffer_load_dwordx4 v16,s[28:31],s62 offen lds
s_add_u32 s62,s62,32768
s_add_u32 m0,m0,1024
s_waitcnt vmcnt(2)
buffer_load_dwordx4 v16,s[28:31],s62 offen lds
s_add_u32 s62,s62,32768
s_add_u32 m0,m0,1024
s_waitcnt vmcnt(2)
buffer_load_dwordx4 v16,s[28:31],s62 offen lds
s_add_u32 s62,s62,32768
s_add_u32 m0,m0,1024
s_waitcnt vmcnt(2)
buffer_load_dwordx4 v16,s[28:31],s62 offen lds
s_add_u32 s62,s62,32768
s_add_u32 m0,m0,1024
s_waitcnt vmcnt(2)
buffer_load_dwordx4 v16,s[28:31],s62 offen lds
s_add_u32 s62,s62,32768
s_add_u32 m0,m0,1024
s_waitcnt vmcnt(2)
buffer_load_dwordx4 v16,s[28:31],s62 offen lds
s_add_u32 s62,s62,32768
s_add_u32 m0,m0,1024
s_waitcnt vmcnt(2)
buffer_load_dwordx4 v16,s[28:31],s62 offen lds
s_waitcnt vmcnt(2)
s_xor_b32 s62,s50,1
s_mul_i32 s62,s62,524288
s_add_u32 s62,s62,s54
s_add_u32 m0,s61,16384
s_nop 0
buffer_load_dwordx4 v16,s[28:31],s62 offen lds
s_add_u32 s62,s62,32768
s_add_u32 m0,m0,1024
s_waitcnt vmcnt(2)
buffer_load_dwordx4 v16,s[28:31],s62 offen lds
s_add_u32 s62,s62,32768
s_add_u32 m0,m0,1024
s_waitcnt vmcnt(2)
buffer_load_dwordx4 v16,s[28:31],s62 offen lds
s_add_u32 s62,s62,32768
s_add_u32 m0,m0,1024
s_waitcnt vmcnt(2)
buffer_load_dwordx4 v16,s[28:31],s62 offen lds
s_add_u32 s62,s62,32768
s_add_u32 m0,m0,1024
s_waitcnt vmcnt(2)
buffer_load_dwordx4 v16,s[28:31],s62 offen lds
s_add_u32 s62,s62,32768
s_add_u32 m0,m0,1024
s_waitcnt vmcnt(2)
buffer_load_dwordx4 v16,s[28:31],s62 offen lds
s_add_u32 s62,s62,32768
s_add_u32 m0,m0,1024
s_waitcnt vmcnt(2)
buffer_load_dwordx4 v16,s[28:31],s62 offen lds
s_add_u32 s62,s62,32768
s_add_u32 m0,m0,1024
s_waitcnt vmcnt(2)
buffer_load_dwordx4 v16,s[28:31],s62 offen lds
s_add_u32 s62,s62,32768
s_add_u32 m0,m0,1024
s_waitcnt vmcnt(2)
buffer_load_dwordx4 v16,s[28:31],s62 offen lds
s_add_u32 s62,s62,32768
s_add_u32 m0,m0,1024
s_waitcnt vmcnt(2)
buffer_load_dwordx4 v16,s[28:31],s62 offen lds
s_add_u32 s62,s62,32768
s_add_u32 m0,m0,1024
s_waitcnt vmcnt(2)
buffer_load_dwordx4 v16,s[28:31],s62 offen lds
s_add_u32 s62,s62,32768
s_add_u32 m0,m0,1024
s_waitcnt vmcnt(2)
buffer_load_dwordx4 v16,s[28:31],s62 offen lds
s_add_u32 s62,s62,32768
s_add_u32 m0,m0,1024
s_waitcnt vmcnt(2)
buffer_load_dwordx4 v16,s[28:31],s62 offen lds
s_add_u32 s62,s62,32768
s_add_u32 m0,m0,1024
s_waitcnt vmcnt(2)
buffer_load_dwordx4 v16,s[28:31],s62 offen lds
s_add_u32 s62,s62,32768
s_add_u32 m0,m0,1024
s_waitcnt vmcnt(2)
buffer_load_dwordx4 v16,s[28:31],s62 offen lds
s_add_u32 s62,s62,32768
s_add_u32 m0,m0,1024
s_waitcnt vmcnt(2)
buffer_load_dwordx4 v16,s[28:31],s62 offen lds
s_waitcnt vmcnt(2)
s_waitcnt vmcnt(16)
ds_read_b64_tr_b16 a[0:1],v17 offset:0
ds_read_b64_tr_b16 a[2:3],v17 offset:256
ds_read_b64_tr_b16 a[4:5],v17 offset:8
ds_read_b64_tr_b16 a[6:7],v17 offset:264
ds_read_b64_tr_b16 a[8:9],v17 offset:2048
ds_read_b64_tr_b16 a[10:11],v17 offset:2304
ds_read_b64_tr_b16 a[12:13],v17 offset:2056
ds_read_b64_tr_b16 a[14:15],v17 offset:2312
ds_read_b64_tr_b16 a[16:17],v17 offset:4096
ds_read_b64_tr_b16 a[18:19],v17 offset:4352
ds_read_b64_tr_b16 a[20:21],v17 offset:4104
ds_read_b64_tr_b16 a[22:23],v17 offset:4360
s_waitcnt lgkmcnt(0)
ds_read_b64_tr_b16 a[24:25],v17 offset:6144
ds_read_b64_tr_b16 a[26:27],v17 offset:6400
ds_read_b64_tr_b16 a[28:29],v17 offset:6152
ds_read_b64_tr_b16 a[30:31],v17 offset:6408
ds_read_b64_tr_b16 a[32:33],v17 offset:8192
ds_read_b64_tr_b16 a[34:35],v17 offset:8448
ds_read_b64_tr_b16 a[36:37],v17 offset:8200
ds_read_b64_tr_b16 a[38:39],v17 offset:8456
ds_read_b64_tr_b16 a[40:41],v17 offset:10240
ds_read_b64_tr_b16 a[42:43],v17 offset:10496
ds_read_b64_tr_b16 a[44:45],v17 offset:10248
ds_read_b64_tr_b16 a[46:47],v17 offset:10504
s_waitcnt lgkmcnt(0)
ds_read_b64_tr_b16 a[48:49],v17 offset:12288
ds_read_b64_tr_b16 a[50:51],v17 offset:12544
ds_read_b64_tr_b16 a[52:53],v17 offset:12296
ds_read_b64_tr_b16 a[54:55],v17 offset:12552
ds_read_b64_tr_b16 a[56:57],v17 offset:14336
ds_read_b64_tr_b16 a[58:59],v17 offset:14592
ds_read_b64_tr_b16 a[60:61],v17 offset:14344
ds_read_b64_tr_b16 a[62:63],v17 offset:14600
s_waitcnt lgkmcnt(0)
s_xor_b32 s62,s50,2
s_mul_i32 s62,s62,524288
s_add_u32 s62,s62,s54
s_add_u32 m0,s61,0
s_nop 0
buffer_load_dwordx4 v16,s[28:31],s62 offen lds
s_add_u32 s62,s62,32768
s_add_u32 m0,m0,1024
s_waitcnt vmcnt(2)
buffer_load_dwordx4 v16,s[28:31],s62 offen lds
s_add_u32 s62,s62,32768
s_add_u32 m0,m0,1024
s_waitcnt vmcnt(2)
buffer_load_dwordx4 v16,s[28:31],s62 offen lds
s_add_u32 s62,s62,32768
s_add_u32 m0,m0,1024
s_waitcnt vmcnt(2)
buffer_load_dwordx4 v16,s[28:31],s62 offen lds
s_add_u32 s62,s62,32768
s_add_u32 m0,m0,1024
s_waitcnt vmcnt(2)
buffer_load_dwordx4 v16,s[28:31],s62 offen lds
s_add_u32 s62,s62,32768
s_add_u32 m0,m0,1024
s_waitcnt vmcnt(2)
buffer_load_dwordx4 v16,s[28:31],s62 offen lds
s_add_u32 s62,s62,32768
s_add_u32 m0,m0,1024
s_waitcnt vmcnt(2)
buffer_load_dwordx4 v16,s[28:31],s62 offen lds
s_add_u32 s62,s62,32768
s_add_u32 m0,m0,1024
s_waitcnt vmcnt(2)
buffer_load_dwordx4 v16,s[28:31],s62 offen lds
s_add_u32 s62,s62,32768
s_add_u32 m0,m0,1024
s_waitcnt vmcnt(2)
buffer_load_dwordx4 v16,s[28:31],s62 offen lds
s_add_u32 s62,s62,32768
s_add_u32 m0,m0,1024
s_waitcnt vmcnt(2)
buffer_load_dwordx4 v16,s[28:31],s62 offen lds
s_add_u32 s62,s62,32768
s_add_u32 m0,m0,1024
s_waitcnt vmcnt(2)
buffer_load_dwordx4 v16,s[28:31],s62 offen lds
s_add_u32 s62,s62,32768
s_add_u32 m0,m0,1024
s_waitcnt vmcnt(2)
buffer_load_dwordx4 v16,s[28:31],s62 offen lds
s_add_u32 s62,s62,32768
s_add_u32 m0,m0,1024
s_waitcnt vmcnt(2)
buffer_load_dwordx4 v16,s[28:31],s62 offen lds
s_add_u32 s62,s62,32768
s_add_u32 m0,m0,1024
s_waitcnt vmcnt(2)
buffer_load_dwordx4 v16,s[28:31],s62 offen lds
s_add_u32 s62,s62,32768
s_add_u32 m0,m0,1024
s_waitcnt vmcnt(2)
buffer_load_dwordx4 v16,s[28:31],s62 offen lds
s_add_u32 s62,s62,32768
s_add_u32 m0,m0,1024
s_waitcnt vmcnt(2)
buffer_load_dwordx4 v16,s[28:31],s62 offen lds
s_waitcnt vmcnt(2)
s_waitcnt vmcnt(16)
ds_read_b64_tr_b16 a[64:65],v17 offset:16384
ds_read_b64_tr_b16 a[66:67],v17 offset:16640
ds_read_b64_tr_b16 a[68:69],v17 offset:16392
ds_read_b64_tr_b16 a[70:71],v17 offset:16648
ds_read_b64_tr_b16 a[72:73],v17 offset:18432
ds_read_b64_tr_b16 a[74:75],v17 offset:18688
ds_read_b64_tr_b16 a[76:77],v17 offset:18440
ds_read_b64_tr_b16 a[78:79],v17 offset:18696
ds_read_b64_tr_b16 a[80:81],v17 offset:20480
ds_read_b64_tr_b16 a[82:83],v17 offset:20736
ds_read_b64_tr_b16 a[84:85],v17 offset:20488
ds_read_b64_tr_b16 a[86:87],v17 offset:20744
s_waitcnt lgkmcnt(0)
ds_read_b64_tr_b16 a[88:89],v17 offset:22528
ds_read_b64_tr_b16 a[90:91],v17 offset:22784
ds_read_b64_tr_b16 a[92:93],v17 offset:22536
ds_read_b64_tr_b16 a[94:95],v17 offset:22792
ds_read_b64_tr_b16 a[96:97],v17 offset:24576
ds_read_b64_tr_b16 a[98:99],v17 offset:24832
ds_read_b64_tr_b16 a[100:101],v17 offset:24584
ds_read_b64_tr_b16 a[102:103],v17 offset:24840
ds_read_b64_tr_b16 a[104:105],v17 offset:26624
ds_read_b64_tr_b16 a[106:107],v17 offset:26880
ds_read_b64_tr_b16 a[108:109],v17 offset:26632
ds_read_b64_tr_b16 a[110:111],v17 offset:26888
s_waitcnt lgkmcnt(0)
ds_read_b64_tr_b16 a[112:113],v17 offset:28672
ds_read_b64_tr_b16 a[114:115],v17 offset:28928
ds_read_b64_tr_b16 a[116:117],v17 offset:28680
ds_read_b64_tr_b16 a[118:119],v17 offset:28936
ds_read_b64_tr_b16 a[120:121],v17 offset:30720
ds_read_b64_tr_b16 a[122:123],v17 offset:30976
ds_read_b64_tr_b16 a[124:125],v17 offset:30728
ds_read_b64_tr_b16 a[126:127],v17 offset:30984
s_waitcnt lgkmcnt(0)
s_xor_b32 s62,s50,3
s_mul_i32 s62,s62,524288
s_add_u32 s62,s62,s54
s_add_u32 m0,s61,16384
s_nop 0
buffer_load_dwordx4 v16,s[28:31],s62 offen lds
s_add_u32 s62,s62,32768
s_add_u32 m0,m0,1024
s_waitcnt vmcnt(2)
buffer_load_dwordx4 v16,s[28:31],s62 offen lds
s_add_u32 s62,s62,32768
s_add_u32 m0,m0,1024
s_waitcnt vmcnt(2)
buffer_load_dwordx4 v16,s[28:31],s62 offen lds
s_add_u32 s62,s62,32768
s_add_u32 m0,m0,1024
s_waitcnt vmcnt(2)
buffer_load_dwordx4 v16,s[28:31],s62 offen lds
s_add_u32 s62,s62,32768
s_add_u32 m0,m0,1024
s_waitcnt vmcnt(2)
buffer_load_dwordx4 v16,s[28:31],s62 offen lds
s_add_u32 s62,s62,32768
s_add_u32 m0,m0,1024
s_waitcnt vmcnt(2)
buffer_load_dwordx4 v16,s[28:31],s62 offen lds
s_add_u32 s62,s62,32768
s_add_u32 m0,m0,1024
s_waitcnt vmcnt(2)
buffer_load_dwordx4 v16,s[28:31],s62 offen lds
s_add_u32 s62,s62,32768
s_add_u32 m0,m0,1024
s_waitcnt vmcnt(2)
buffer_load_dwordx4 v16,s[28:31],s62 offen lds
s_add_u32 s62,s62,32768
s_add_u32 m0,m0,1024
s_waitcnt vmcnt(2)
buffer_load_dwordx4 v16,s[28:31],s62 offen lds
s_add_u32 s62,s62,32768
s_add_u32 m0,m0,1024
s_waitcnt vmcnt(2)
buffer_load_dwordx4 v16,s[28:31],s62 offen lds
s_add_u32 s62,s62,32768
s_add_u32 m0,m0,1024
s_waitcnt vmcnt(2)
buffer_load_dwordx4 v16,s[28:31],s62 offen lds
s_add_u32 s62,s62,32768
s_add_u32 m0,m0,1024
s_waitcnt vmcnt(2)
buffer_load_dwordx4 v16,s[28:31],s62 offen lds
s_add_u32 s62,s62,32768
s_add_u32 m0,m0,1024
s_waitcnt vmcnt(2)
buffer_load_dwordx4 v16,s[28:31],s62 offen lds
s_add_u32 s62,s62,32768
s_add_u32 m0,m0,1024
s_waitcnt vmcnt(2)
buffer_load_dwordx4 v16,s[28:31],s62 offen lds
s_add_u32 s62,s62,32768
s_add_u32 m0,m0,1024
s_waitcnt vmcnt(2)
buffer_load_dwordx4 v16,s[28:31],s62 offen lds
s_add_u32 s62,s62,32768
s_add_u32 m0,m0,1024
s_waitcnt vmcnt(2)
buffer_load_dwordx4 v16,s[28:31],s62 offen lds
s_waitcnt vmcnt(2)
s_waitcnt vmcnt(16)
ds_read_b64_tr_b16 a[128:129],v17 offset:0
ds_read_b64_tr_b16 a[130:131],v17 offset:256
ds_read_b64_tr_b16 a[132:133],v17 offset:8
ds_read_b64_tr_b16 a[134:135],v17 offset:264
ds_read_b64_tr_b16 a[136:137],v17 offset:2048
ds_read_b64_tr_b16 a[138:139],v17 offset:2304
ds_read_b64_tr_b16 a[140:141],v17 offset:2056
ds_read_b64_tr_b16 a[142:143],v17 offset:2312
ds_read_b64_tr_b16 a[144:145],v17 offset:4096
ds_read_b64_tr_b16 a[146:147],v17 offset:4352
ds_read_b64_tr_b16 a[148:149],v17 offset:4104
ds_read_b64_tr_b16 a[150:151],v17 offset:4360
s_waitcnt lgkmcnt(0)
ds_read_b64_tr_b16 a[152:153],v17 offset:6144
ds_read_b64_tr_b16 a[154:155],v17 offset:6400
ds_read_b64_tr_b16 a[156:157],v17 offset:6152
ds_read_b64_tr_b16 a[158:159],v17 offset:6408
ds_read_b64_tr_b16 a[160:161],v17 offset:8192
ds_read_b64_tr_b16 a[162:163],v17 offset:8448
ds_read_b64_tr_b16 a[164:165],v17 offset:8200
ds_read_b64_tr_b16 a[166:167],v17 offset:8456
ds_read_b64_tr_b16 a[168:169],v17 offset:10240
ds_read_b64_tr_b16 a[170:171],v17 offset:10496
ds_read_b64_tr_b16 a[172:173],v17 offset:10248
ds_read_b64_tr_b16 a[174:175],v17 offset:10504
s_waitcnt lgkmcnt(0)
ds_read_b64_tr_b16 a[176:177],v17 offset:12288
ds_read_b64_tr_b16 a[178:179],v17 offset:12544
ds_read_b64_tr_b16 a[180:181],v17 offset:12296
ds_read_b64_tr_b16 a[182:183],v17 offset:12552
ds_read_b64_tr_b16 a[184:185],v17 offset:14336
ds_read_b64_tr_b16 a[186:187],v17 offset:14592
ds_read_b64_tr_b16 a[188:189],v17 offset:14344
ds_read_b64_tr_b16 a[190:191],v17 offset:14600
s_waitcnt lgkmcnt(0)
s_waitcnt vmcnt(0)
ds_read_b64_tr_b16 a[192:193],v17 offset:16384
ds_read_b64_tr_b16 a[194:195],v17 offset:16640
ds_read_b64_tr_b16 a[196:197],v17 offset:16392
ds_read_b64_tr_b16 a[198:199],v17 offset:16648
ds_read_b64_tr_b16 a[200:201],v17 offset:18432
ds_read_b64_tr_b16 a[202:203],v17 offset:18688
ds_read_b64_tr_b16 a[204:205],v17 offset:18440
ds_read_b64_tr_b16 a[206:207],v17 offset:18696
ds_read_b64_tr_b16 a[208:209],v17 offset:20480
ds_read_b64_tr_b16 a[210:211],v17 offset:20736
ds_read_b64_tr_b16 a[212:213],v17 offset:20488
ds_read_b64_tr_b16 a[214:215],v17 offset:20744
s_waitcnt lgkmcnt(0)
ds_read_b64_tr_b16 a[216:217],v17 offset:22528
ds_read_b64_tr_b16 a[218:219],v17 offset:22784
ds_read_b64_tr_b16 a[220:221],v17 offset:22536
ds_read_b64_tr_b16 a[222:223],v17 offset:22792
ds_read_b64_tr_b16 a[224:225],v17 offset:24576
ds_read_b64_tr_b16 a[226:227],v17 offset:24832
ds_read_b64_tr_b16 a[228:229],v17 offset:24584
ds_read_b64_tr_b16 a[230:231],v17 offset:24840
ds_read_b64_tr_b16 a[232:233],v17 offset:26624
ds_read_b64_tr_b16 a[234:235],v17 offset:26880
ds_read_b64_tr_b16 a[236:237],v17 offset:26632
ds_read_b64_tr_b16 a[238:239],v17 offset:26888
s_waitcnt lgkmcnt(0)
ds_read_b64_tr_b16 a[240:241],v17 offset:28672
ds_read_b64_tr_b16 a[242:243],v17 offset:28928
ds_read_b64_tr_b16 a[244:245],v17 offset:28680
ds_read_b64_tr_b16 a[246:247],v17 offset:28936
ds_read_b64_tr_b16 a[248:249],v17 offset:30720
ds_read_b64_tr_b16 a[250:251],v17 offset:30976
ds_read_b64_tr_b16 a[252:253],v17 offset:30728
ds_read_b64_tr_b16 a[254:255],v17 offset:30984
s_waitcnt lgkmcnt(0)
s_mov_b32 s92,s2
s_and_b32 s93,s3,0xffff
s_mov_b32 s94,0x100
s_mov_b32 s95,0x20000
v_mbcnt_lo_u32_b32 v16,-1,0
v_mbcnt_hi_u32_b32 v16,-1,v16
v_mov_b32 v18,0
v_cmp_eq_u32 vcc,22,v16
s_nop 1
v_cndmask_b32 v18,v18,63,vcc
v_cmp_eq_u32 vcc,17,v16
s_nop 1
v_cndmask_b32 v18,v18,63,vcc
v_cmp_eq_u32 vcc,18,v16
s_nop 1
v_cndmask_b32 v18,v18,1,vcc
v_and_b32 v19,1,v16
v_cmp_eq_u32 vcc,1,v19
v_mov_b32 v19,8192
s_nop 0
v_cndmask_b32 v19,-1,v19,vcc
v_min_u32 v16,31,v16
v_lshlrev_b32 v16,2,v16
s_sub_u32 s66,s88,64
s_cmp_lg_u32 s50,0
s_cbranch_scc1 vot_77
vpoll_73:
buffer_load_dword v17,v16,s[92:95],s66 offen sc1
s_waitcnt vmcnt(0)
s_cmp_lg_u32 s56,2
s_cbranch_scc1 vck_74
v_cmp_eq_u32 vcc,v17,v19
s_and_b32 s64,vcc_lo,0xffff
s_cmp_eq_u32 s64,65535
s_cbranch_scc1 vck_74
s_mov_b32 s65,0
v_readlane_b32 s64,v17,1
s_lshr_b32 s64,s64,8
s_add_u32 s65,s65,s64
v_readlane_b32 s64,v17,3
s_lshr_b32 s64,s64,8
s_add_u32 s65,s65,s64
v_readlane_b32 s64,v17,5
s_lshr_b32 s64,s64,8
s_add_u32 s65,s65,s64
v_readlane_b32 s64,v17,7
s_lshr_b32 s64,s64,8
s_add_u32 s65,s65,s64
v_readlane_b32 s64,v17,9
s_lshr_b32 s64,s64,8
s_add_u32 s65,s65,s64
v_readlane_b32 s64,v17,11
s_lshr_b32 s64,s64,8
s_add_u32 s65,s65,s64
v_readlane_b32 s64,v17,13
s_lshr_b32 s64,s64,8
s_add_u32 s65,s65,s64
v_readlane_b32 s64,v17,15
s_lshr_b32 s64,s64,8
s_add_u32 s65,s65,s64
s_cmp_ge_u32 s65,256
s_cbranch_scc1 vok_76
s_branch vrt_75
vck_74:
v_cmp_gt_u32 vcc,v18,v17
s_cbranch_vccz vok_76
vrt_75:
s_sleep 48
s_sub_u32 s90,s90,1
s_cmp_gt_i32 s90,0
s_cbranch_scc1 vpoll_73
vok_76:
v_add_u32 v18,161536,v16
ds_write_b32 v18,v17
s_waitcnt lgkmcnt(0)
vot_77:
s_barrier
v_add_u32 v18,161536,v16
ds_read_b32 v17,v18
s_waitcnt lgkmcnt(0)
s_cmp_lg_u32 s56,2
s_cbranch_scc1 vfin_78
v_cmp_eq_u32 vcc,v17,v19
s_and_b32 s64,vcc_lo,0xffff
s_cmp_eq_u32 s64,65535
s_cbranch_scc1 vfin_78
s_mov_b32 s65,0
v_readlane_b32 s64,v17,1
s_lshr_b32 s64,s64,8
s_add_u32 s65,s65,s64
v_readlane_b32 s64,v17,3
s_lshr_b32 s64,s64,8
s_add_u32 s65,s65,s64
v_readlane_b32 s64,v17,5
s_lshr_b32 s64,s64,8
s_add_u32 s65,s65,s64
v_readlane_b32 s64,v17,7
s_lshr_b32 s64,s64,8
s_add_u32 s65,s65,s64
v_readlane_b32 s64,v17,9
s_lshr_b32 s64,s64,8
s_add_u32 s65,s65,s64
v_readlane_b32 s64,v17,11
s_lshr_b32 s64,s64,8
s_add_u32 s65,s65,s64
v_readlane_b32 s64,v17,13
s_lshr_b32 s64,s64,8
s_add_u32 s65,s65,s64
v_readlane_b32 s64,v17,15
s_lshr_b32 s64,s64,8
s_add_u32 s65,s65,s64
s_cmp_ge_u32 s65,256
s_cbranch_scc1 fl_fb
vfin_78:
s_and_b32 s56,s56,1
s_mov_b32 s67,0
s_barrier
v_lshlrev_b32 v0,4,v1
s_mov_b32 s60,0
s_lshl_b32 s70,s50,13
s_mov_b32 s55,0
v_mov_b32 v3,v0
s_mov_b32 s73,0xffff0000
s_lshl_b32 s64,s52,2
s_add_u32 s64,s64,s50
s_mul_i32 s61,s64,8192
s_add_u32 s61,s61,150994944
s_lshl_b32 s68,s64,8
s_add_u32 s68,s68,138543104
s_lshl_b32 s83,s53,2
s_add_u32 s83,s83,s50
s_mov_b32 s63,0
s_xor_b32 s64,s50,0
s_lshl_b32 s64,s64,13
v_add_u32 v8,s64,v0
v_mov_b32 v4,v8
s_xor_b32 s64,s50,1
s_lshl_b32 s64,s64,13
v_add_u32 v9,s64,v0
v_mov_b32 v5,v9
s_xor_b32 s64,s50,2
s_lshl_b32 s64,s64,13
v_add_u32 v10,s64,v0
v_mov_b32 v6,v10
s_xor_b32 s64,s50,3
s_lshl_b32 s64,s64,13
v_add_u32 v11,s64,v0
v_mov_b32 v7,v11
v_min_u32 v2,11,v1
v_lshlrev_b32 v2,2,v2
s_add_u32 s62,s61,4096
s_lshl_b32 s66,s83,10
s_lshr_b32 s65,s83,3
s_lshl_b32 s65,s65,8
s_and_b32 s64,s83,7
s_lshl_b32 s64,s64,2
s_add_u32 s69,s64,s65
s_add_u32 s69,s69,138547200
s_mov_b32 s82,0
s_lshl_b32 s64,s53,2
s_add_u32 s64,s64,s50
s_mul_i32 s74,s64,24576
s_xor_b32 s64,s50,s52
s_sub_u32 s64,s64,1
s_max_i32 s64,s64,0
s_lshl_b32 s64,s64,11
s_add_u32 s74,s74,s64
s_add_u32 s74,s74,167772160
s_mov_b32 s75,0
s_mov_b32 s77,0
v_lshlrev_b32 v26,11,v21
v_lshl_add_u32 v26,v22,4,v26
s_lshl_b32 s64,s83,6
v_add_u32 v18,s64,v26
v_lshlrev_b32 v26,5,v22
s_lshl_b32 s64,s83,7
s_add_u32 s64,s64,267395072
buffer_load_dwordx4 v[152:155],v26,s[20:23],s64 offen offset:0 sc1
buffer_load_dwordx4 v[156:159],v26,s[20:23],s64 offen offset:16 sc1
s_add_u32 s64,s64,24576
buffer_load_dwordx4 v[128:131],v26,s[20:23],s64 offen offset:0 sc1
buffer_load_dwordx4 v[132:135],v26,s[20:23],s64 offen offset:16 sc1
s_add_u32 s64,s64,24576
buffer_load_dwordx4 v[136:139],v26,s[20:23],s64 offen offset:0 sc1
buffer_load_dwordx4 v[140:143],v26,s[20:23],s64 offen offset:16 sc1
s_add_u32 s64,s64,24576
buffer_load_dwordx4 v[144:147],v26,s[20:23],s64 offen offset:0 sc1
buffer_load_dwordx4 v[148:151],v26,s[20:23],s64 offen offset:16 sc1
s_add_u32 s64,s64,24576
s_waitcnt vmcnt(0)
v_pk_add_f32 v[152:153],v[152:153],v[128:129]
v_pk_add_f32 v[136:137],v[136:137],v[144:145]
v_pk_add_f32 v[154:155],v[154:155],v[130:131]
v_pk_add_f32 v[138:139],v[138:139],v[146:147]
v_pk_add_f32 v[156:157],v[156:157],v[132:133]
v_pk_add_f32 v[140:141],v[140:141],v[148:149]
v_pk_add_f32 v[158:159],v[158:159],v[134:135]
v_pk_add_f32 v[142:143],v[142:143],v[150:151]
v_pk_add_f32 v[152:153],v[152:153],v[136:137]
v_pk_add_f32 v[154:155],v[154:155],v[138:139]
v_pk_add_f32 v[156:157],v[156:157],v[140:141]
v_pk_add_f32 v[158:159],v[158:159],v[142:143]
v_cvt_pk_bf16_f32 v128,v152,v153
v_cvt_pk_bf16_f32 v129,v154,v155
v_cvt_pk_bf16_f32 v130,v156,v157
v_cvt_pk_bf16_f32 v131,v158,v159
v_lshlrev_b32 v152,16,v128
v_and_b32 v153,s73,v128
v_lshlrev_b32 v154,16,v129
v_and_b32 v155,s73,v129
v_lshlrev_b32 v156,16,v130
v_and_b32 v157,s73,v130
v_lshlrev_b32 v158,16,v131
v_and_b32 v159,s73,v131
v_mov_b32 v204,-1
v_mov_b32 v205,-1
v_mov_b32 v206,-1
v_mov_b32 v207,-1
v_cmp_eq_u32 vcc,0,v1
s_nop 1
v_cndmask_b32 v26,2.0,0,vcc
s_cmp_eq_u32 s50,s52
s_cbranch_scc1 lfin_79
s_add_u32 s71,s60,1
s_add_u32 s53,s60,2
plp_89:
buffer_load_dword v16,v2,s[20:23],s68 offen sc1
s_waitcnt vmcnt(0)
v_cmp_gt_u32 vcc,s71,v16
s_cbranch_vccz pok_90
s_sleep 4
s_sub_u32 s90,s90,1
s_cmp_gt_i32 s90,0
s_cbranch_scc1 plp_89
pok_90:
lag_86:
s_mov_b32 m0,s70
s_nop 0
buffer_load_dwordx4 v3,s[20:23],s61 offen offset:0 lds
buffer_load_dwordx4 v3,s[20:23],s61 offen offset:1024 lds
buffer_load_dwordx4 v3,s[20:23],s61 offen offset:2048 lds
buffer_load_dwordx4 v3,s[20:23],s61 offen offset:3072 lds
s_add_u32 m0,s70,4096
s_nop 0
buffer_load_dwordx4 v3,s[20:23],s62 offen offset:0 lds
buffer_load_dwordx4 v3,s[20:23],s62 offen offset:1024 lds
buffer_load_dwordx4 v3,s[20:23],s62 offen offset:2048 lds
buffer_load_dwordx4 v3,s[20:23],s62 offen offset:3072 lds
s_add_u32 s61,s61,131072
s_add_u32 s62,s62,131072
s_add_u32 s70,s70,32768
s_and_b32 s70,s70,0x1ffff
buffer_load_dword v23,off,s[20:23],s66
buffer_load_dword v23,off,s[20:23],s66
dec_87:
v_cmp_gt_u32 vcc,s53,v16
s_cbranch_vccnz BN_85
BR_84:
s_waitcnt vmcnt(9)
ds_read_b128 v[64:67],v4 offset:0
s_waitcnt vmcnt(8)
ds_read_b128 v[68:71],v4 offset:1024
s_waitcnt vmcnt(7)
ds_read_b128 v[72:75],v4 offset:2048
s_waitcnt vmcnt(6)
ds_read_b128 v[76:79],v4 offset:3072
s_waitcnt lgkmcnt(3)
v_mfma_f32_16x16x32_bf16 v[32:35],a[0:3],v[64:67],0
s_add_u32 s71,s60,2
s_add_u32 s53,s60,3
v_mfma_f32_16x16x32_bf16 v[36:39],a[4:7],v[64:67],0
s_waitcnt lgkmcnt(2)
s_waitcnt vmcnt(5)
ds_read_b128 v[80:83],v4 offset:4096
v_mfma_f32_16x16x32_bf16 v[32:35],a[8:11],v[68:71],v[32:35]
v_mfma_f32_16x16x32_bf16 v[36:39],a[12:15],v[68:71],v[36:39]
s_waitcnt lgkmcnt(2)
s_waitcnt vmcnt(4)
s_mov_b32 m0,s70
ds_read_b128 v[84:87],v4 offset:5120
v_mfma_f32_16x16x32_bf16 v[32:35],a[16:19],v[72:75],v[32:35]
buffer_load_dwordx4 v3,s[20:23],s61 offen offset:0 lds
v_mfma_f32_16x16x32_bf16 v[36:39],a[20:23],v[72:75],v[36:39]
s_waitcnt lgkmcnt(2)
s_waitcnt vmcnt(4)
ds_read_b128 v[88:91],v4 offset:6144
v_mfma_f32_16x16x32_bf16 v[32:35],a[24:27],v[76:79],v[32:35]
buffer_load_dwordx4 v3,s[20:23],s61 offen offset:1024 lds
v_mfma_f32_16x16x32_bf16 v[36:39],a[28:31],v[76:79],v[36:39]
s_waitcnt lgkmcnt(2)
s_waitcnt vmcnt(4)
ds_read_b128 v[92:95],v4 offset:7168
v_mfma_f32_16x16x32_bf16 v[32:35],a[32:35],v[80:83],v[32:35]
v_mfma_f32_16x16x32_bf16 v[36:39],a[36:39],v[80:83],v[36:39]
s_waitcnt lgkmcnt(2)
s_barrier
ds_read_b128 v[96:99],v5 offset:0
v_mfma_f32_16x16x32_bf16 v[32:35],a[40:43],v[84:87],v[32:35]
ds_read_b128 v[100:103],v5 offset:1024
buffer_load_dwordx4 v3,s[20:23],s61 offen offset:2048 lds
v_mfma_f32_16x16x32_bf16 v[36:39],a[44:47],v[84:87],v[36:39]
s_waitcnt lgkmcnt(3)
ds_read_b128 v[104:107],v5 offset:2048
v_mfma_f32_16x16x32_bf16 v[32:35],a[48:51],v[88:91],v[32:35]
ds_read_b128 v[108:111],v5 offset:3072
v_mfma_f32_16x16x32_bf16 v[36:39],a[52:55],v[88:91],v[36:39]
s_waitcnt lgkmcnt(4)
ds_read_b128 v[112:115],v5 offset:4096
buffer_load_dwordx4 v3,s[20:23],s61 offen offset:3072 lds
v_mfma_f32_16x16x32_bf16 v[32:35],a[56:59],v[92:95],v[32:35]
ds_read_b128 v[116:119],v5 offset:5120
v_mfma_f32_16x16x32_bf16 v[36:39],a[60:63],v[92:95],v[36:39]
s_waitcnt lgkmcnt(5)
s_add_u32 m0,s70,4096
v_mfma_f32_16x16x32_bf16 v[32:35],a[64:67],v[96:99],v[32:35]
ds_read_b128 v[120:123],v5 offset:6144
buffer_load_dwordx4 v3,s[20:23],s62 offen offset:0 lds
v_mfma_f32_16x16x32_bf16 v[36:39],a[68:71],v[96:99],v[36:39]
s_waitcnt lgkmcnt(5)
v_mfma_f32_16x16x32_bf16 v[32:35],a[72:75],v[100:103],v[32:35]
ds_read_b128 v[124:127],v5 offset:7168
v_mfma_f32_16x16x32_bf16 v[36:39],a[76:79],v[100:103],v[36:39]
s_waitcnt lgkmcnt(5)
buffer_load_dwordx4 v3,s[20:23],s62 offen offset:1024 lds
v_mfma_f32_16x16x32_bf16 v[32:35],a[80:83],v[104:107],v[32:35]
ds_read_b128 v[64:67],v6 offset:0
v_mfma_f32_16x16x32_bf16 v[36:39],a[84:87],v[104:107],v[36:39]
s_waitcnt lgkmcnt(5)
v_mfma_f32_16x16x32_bf16 v[32:35],a[88:91],v[108:111],v[32:35]
ds_read_b128 v[68:71],v6 offset:1024
v_mfma_f32_16x16x32_bf16 v[36:39],a[92:95],v[108:111],v[36:39]
s_waitcnt lgkmcnt(5)
buffer_load_dwordx4 v3,s[20:23],s62 offen offset:2048 lds
v_mfma_f32_16x16x32_bf16 v[32:35],a[96:99],v[112:115],v[32:35]
ds_read_b128 v[72:75],v6 offset:2048
buffer_load_dword v16,v2,s[20:23],s68 offen sc1
v_mfma_f32_16x16x32_bf16 v[36:39],a[100:103],v[112:115],v[36:39]
s_waitcnt lgkmcnt(5)
v_mfma_f32_16x16x32_bf16 v[32:35],a[104:107],v[116:119],v[32:35]
ds_read_b128 v[76:79],v6 offset:3072
buffer_load_dwordx4 v3,s[20:23],s62 offen offset:3072 lds
v_mfma_f32_16x16x32_bf16 v[36:39],a[108:111],v[116:119],v[36:39]
s_waitcnt lgkmcnt(5)
v_mfma_f32_16x16x32_bf16 v[32:35],a[112:115],v[120:123],v[32:35]
ds_read_b128 v[80:83],v6 offset:4096
v_mfma_f32_16x16x32_bf16 v[36:39],a[116:119],v[120:123],v[36:39]
s_waitcnt lgkmcnt(5)
v_mfma_f32_16x16x32_bf16 v[32:35],a[120:123],v[124:127],v[32:35]
ds_read_b128 v[84:87],v6 offset:5120
v_mfma_f32_16x16x32_bf16 v[36:39],a[124:127],v[124:127],v[36:39]
s_waitcnt lgkmcnt(5)
v_mfma_f32_16x16x32_bf16 v[32:35],a[128:131],v[64:67],v[32:35]
ds_read_b128 v[88:91],v6 offset:6144
v_mfma_f32_16x16x32_bf16 v[36:39],a[132:135],v[64:67],v[36:39]
s_waitcnt lgkmcnt(5)
v_mfma_f32_16x16x32_bf16 v[32:35],a[136:139],v[68:71],v[32:35]
ds_read_b128 v[92:95],v6 offset:7168
v_mfma_f32_16x16x32_bf16 v[36:39],a[140:143],v[68:71],v[36:39]
s_waitcnt lgkmcnt(5)
v_mfma_f32_16x16x32_bf16 v[32:35],a[144:147],v[72:75],v[32:35]
ds_read_b128 v[96:99],v7 offset:0
v_mfma_f32_16x16x32_bf16 v[36:39],a[148:151],v[72:75],v[36:39]
s_waitcnt lgkmcnt(5)
v_mfma_f32_16x16x32_bf16 v[32:35],a[152:155],v[76:79],v[32:35]
ds_read_b128 v[100:103],v7 offset:1024
v_mfma_f32_16x16x32_bf16 v[36:39],a[156:159],v[76:79],v[36:39]
s_waitcnt lgkmcnt(5)
v_mfma_f32_16x16x32_bf16 v[32:35],a[160:163],v[80:83],v[32:35]
ds_read_b128 v[104:107],v7 offset:2048
v_mfma_f32_16x16x32_bf16 v[36:39],a[164:167],v[80:83],v[36:39]
s_waitcnt lgkmcnt(5)
v_mfma_f32_16x16x32_bf16 v[32:35],a[168:171],v[84:87],v[32:35]
ds_read_b128 v[108:111],v7 offset:3072
v_mfma_f32_16x16x32_bf16 v[36:39],a[172:175],v[84:87],v[36:39]
s_waitcnt lgkmcnt(5)
v_mfma_f32_16x16x32_bf16 v[32:35],a[176:179],v[88:91],v[32:35]
ds_read_b128 v[112:115],v7 offset:4096
v_mfma_f32_16x16x32_bf16 v[36:39],a[180:183],v[88:91],v[36:39]
s_waitcnt lgkmcnt(5)
v_mfma_f32_16x16x32_bf16 v[32:35],a[184:187],v[92:95],v[32:35]
ds_read_b128 v[116:119],v7 offset:5120
v_mfma_f32_16x16x32_bf16 v[36:39],a[188:191],v[92:95],v[36:39]
s_waitcnt lgkmcnt(5)
v_mfma_f32_16x16x32_bf16 v[32:35],a[192:195],v[96:99],v[32:35]
ds_read_b128 v[120:123],v7 offset:6144
v_mfma_f32_16x16x32_bf16 v[36:39],a[196:199],v[96:99],v[36:39]
s_waitcnt lgkmcnt(5)
v_mfma_f32_16x16x32_bf16 v[32:35],a[200:203],v[100:103],v[32:35]
ds_read_b128 v[124:127],v7 offset:7168
v_mfma_f32_16x16x32_bf16 v[36:39],a[204:207],v[100:103],v[36:39]
s_waitcnt lgkmcnt(5)
s_add_u32 s61,s61,131072
s_add_u32 s62,s62,131072
v_mfma_f32_16x16x32_bf16 v[32:35],a[208:211],v[104:107],v[32:35]
s_add_u32 s70,s70,32768
s_and_b32 s70,s70,0x1ffff
s_add_u32 s55,s55,32768
v_mfma_f32_16x16x32_bf16 v[36:39],a[212:215],v[104:107],v[36:39]
s_waitcnt lgkmcnt(4)
s_and_b32 s55,s55,0x1ffff
v_add_u32 v4,s55,v8
v_mfma_f32_16x16x32_bf16 v[32:35],a[216:219],v[108:111],v[32:35]
v_add_u32 v5,s55,v9
v_add_u32 v6,s55,v10
v_mfma_f32_16x16x32_bf16 v[36:39],a[220:223],v[108:111],v[36:39]
s_waitcnt lgkmcnt(3)
v_add_u32 v7,s55,v11
v_mfma_f32_16x16x32_bf16 v[32:35],a[224:227],v[112:115],v[32:35]
s_waitcnt vmcnt(8)
ds_read_b128 v[64:67],v4 offset:0
v_mfma_f32_16x16x32_bf16 v[36:39],a[228:231],v[112:115],v[36:39]
s_waitcnt lgkmcnt(3)
s_waitcnt vmcnt(7)
ds_read_b128 v[68:71],v4 offset:1024
v_mfma_f32_16x16x32_bf16 v[32:35],a[232:235],v[116:119],v[32:35]
s_waitcnt vmcnt(6)
ds_read_b128 v[72:75],v4 offset:2048
v_mfma_f32_16x16x32_bf16 v[36:39],a[236:239],v[116:119],v[36:39]
s_waitcnt lgkmcnt(4)
v_mfma_f32_16x16x32_bf16 v[32:35],a[240:243],v[120:123],v[32:35]
v_mfma_f32_16x16x32_bf16 v[36:39],a[244:247],v[120:123],v[36:39]
s_waitcnt lgkmcnt(3)
v_mfma_f32_16x16x32_bf16 v[40:43],a[248:251],v[124:127],v[32:35]
v_mfma_f32_16x16x32_bf16 v[44:47],a[252:255],v[124:127],v[36:39]
s_waitcnt vmcnt(1)
v_cmp_gt_u32 vcc,s53,v16
s_add_u32 s60,s60,1
s_cbranch_vccnz WN_83
.p2align 6
WR_82:
s_waitcnt lgkmcnt(2)
v_mfma_f32_16x16x32_bf16 v[32:35],a[0:3],v[64:67],0
s_waitcnt vmcnt(5)
s_add_u32 s71,s60,2
ds_read_b128 v[76:79],v4 offset:3072
v_mfma_f32_16x16x32_bf16 v[36:39],a[4:7],v[64:67],0
s_waitcnt lgkmcnt(2)
s_add_u32 s53,s60,3
v_mfma_f32_16x16x32_bf16 v[32:35],a[8:11],v[68:71],v[32:35]
s_waitcnt vmcnt(4)
s_mov_b32 m0,s70
ds_read_b128 v[80:83],v4 offset:4096
v_mfma_f32_16x16x32_bf16 v[36:39],a[12:15],v[68:71],v[36:39]
s_waitcnt lgkmcnt(2)
buffer_load_dwordx4 v3,s[20:23],s61 offen offset:0 lds
s_add_u32 s64,s74,s75
s_cmp_eq_u32 s56,1
s_cbranch_scc1 b1_91
buffer_store_dwordx4 v[40:43],v0,s[20:23],s64 offen offset:0
buffer_store_dwordx4 v[44:47],v0,s[20:23],s64 offen offset:1024
b2_92:
v_mfma_f32_16x16x32_bf16 v[32:35],a[16:19],v[72:75],v[32:35]
s_waitcnt vmcnt(6)
s_add_u32 s75,s75,6144
ds_read_b128 v[84:87],v4 offset:5120
v_mfma_f32_16x16x32_bf16 v[36:39],a[20:23],v[72:75],v[36:39]
s_waitcnt lgkmcnt(2)
s_cmp_eq_u32 s75,24576
s_cselect_b32 s75,0,s75
v_mfma_f32_16x16x32_bf16 v[32:35],a[24:27],v[76:79],v[32:35]
s_waitcnt vmcnt(5)
ds_read_b128 v[88:91],v4 offset:6144
buffer_load_dwordx4 v3,s[20:23],s61 offen offset:1024 lds
v_mfma_f32_16x16x32_bf16 v[36:39],a[28:31],v[76:79],v[36:39]
s_waitcnt lgkmcnt(2)
v_mfma_f32_16x16x32_bf16 v[32:35],a[32:35],v[80:83],v[32:35]
s_waitcnt vmcnt(4)
ds_read_b128 v[92:95],v4 offset:7168
v_mfma_f32_16x16x32_bf16 v[36:39],a[36:39],v[80:83],v[36:39]
s_waitcnt lgkmcnt(2)
s_barrier
ds_read_b128 v[96:99],v5 offset:0
v_mfma_f32_16x16x32_bf16 v[32:35],a[40:43],v[84:87],v[32:35]
ds_read_b128 v[100:103],v5 offset:1024
buffer_load_dwordx4 v3,s[20:23],s61 offen offset:2048 lds
v_mfma_f32_16x16x32_bf16 v[36:39],a[44:47],v[84:87],v[36:39]
s_waitcnt lgkmcnt(3)
ds_read_b128 v[104:107],v5 offset:2048
v_mfma_f32_16x16x32_bf16 v[32:35],a[48:51],v[88:91],v[32:35]
ds_read_b128 v[108:111],v5 offset:3072
v_mfma_f32_16x16x32_bf16 v[36:39],a[52:55],v[88:91],v[36:39]
s_waitcnt lgkmcnt(4)
ds_read_b128 v[112:115],v5 offset:4096
buffer_load_dwordx4 v3,s[20:23],s61 offen offset:3072 lds
v_mfma_f32_16x16x32_bf16 v[32:35],a[56:59],v[92:95],v[32:35]
ds_read_b128 v[116:119],v5 offset:5120
v_mfma_f32_16x16x32_bf16 v[36:39],a[60:63],v[92:95],v[36:39]
s_waitcnt lgkmcnt(5)
s_add_u32 m0,s70,4096
v_mfma_f32_16x16x32_bf16 v[32:35],a[64:67],v[96:99],v[32:35]
ds_read_b128 v[120:123],v5 offset:6144
buffer_load_dwordx4 v3,s[20:23],s62 offen offset:0 lds
v_mfma_f32_16x16x32_bf16 v[36:39],a[68:71],v[96:99],v[36:39]
s_waitcnt lgkmcnt(5)
v_mfma_f32_16x16x32_bf16 v[32:35],a[72:75],v[100:103],v[32:35]
ds_read_b128 v[124:127],v5 offset:7168
v_mfma_f32_16x16x32_bf16 v[36:39],a[76:79],v[100:103],v[36:39]
s_waitcnt lgkmcnt(5)
buffer_load_dwordx4 v3,s[20:23],s62 offen offset:1024 lds
v_mfma_f32_16x16x32_bf16 v[32:35],a[80:83],v[104:107],v[32:35]
ds_read_b128 v[64:67],v6 offset:0
v_mfma_f32_16x16x32_bf16 v[36:39],a[84:87],v[104:107],v[36:39]
s_waitcnt lgkmcnt(5)
v_mfma_f32_16x16x32_bf16 v[32:35],a[88:91],v[108:111],v[32:35]
ds_read_b128 v[68:71],v6 offset:1024
v_mfma_f32_16x16x32_bf16 v[36:39],a[92:95],v[108:111],v[36:39]
s_waitcnt lgkmcnt(5)
buffer_load_dwordx4 v3,s[20:23],s62 offen offset:2048 lds
v_mfma_f32_16x16x32_bf16 v[32:35],a[96:99],v[112:115],v[32:35]
ds_read_b128 v[72:75],v6 offset:2048
buffer_load_dword v16,v2,s[20:23],s68 offen sc1
v_mfma_f32_16x16x32_bf16 v[36:39],a[100:103],v[112:115],v[36:39]
s_waitcnt lgkmcnt(5)
v_mfma_f32_16x16x32_bf16 v[32:35],a[104:107],v[116:119],v[32:35]
ds_read_b128 v[76:79],v6 offset:3072
buffer_load_dwordx4 v3,s[20:23],s62 offen offset:3072 lds
v_mfma_f32_16x16x32_bf16 v[36:39],a[108:111],v[116:119],v[36:39]
s_waitcnt lgkmcnt(5)
v_mfma_f32_16x16x32_bf16 v[32:35],a[112:115],v[120:123],v[32:35]
ds_read_b128 v[80:83],v6 offset:4096
v_mfma_f32_16x16x32_bf16 v[36:39],a[116:119],v[120:123],v[36:39]
s_waitcnt lgkmcnt(5)
v_mfma_f32_16x16x32_bf16 v[32:35],a[120:123],v[124:127],v[32:35]
ds_read_b128 v[84:87],v6 offset:5120
v_mfma_f32_16x16x32_bf16 v[36:39],a[124:127],v[124:127],v[36:39]
s_waitcnt lgkmcnt(5)
v_mfma_f32_16x16x32_bf16 v[32:35],a[128:131],v[64:67],v[32:35]
ds_read_b128 v[88:91],v6 offset:6144
v_mfma_f32_16x16x32_bf16 v[36:39],a[132:135],v[64:67],v[36:39]
s_waitcnt lgkmcnt(5)
v_mfma_f32_16x16x32_bf16 v[32:35],a[136:139],v[68:71],v[32:35]
ds_read_b128 v[92:95],v6 offset:7168
v_mfma_f32_16x16x32_bf16 v[36:39],a[140:143],v[68:71],v[36:39]
s_waitcnt lgkmcnt(5)
v_mfma_f32_16x16x32_bf16 v[32:35],a[144:147],v[72:75],v[32:35]
ds_read_b128 v[96:99],v7 offset:0
v_mfma_f32_16x16x32_bf16 v[36:39],a[148:151],v[72:75],v[36:39]
s_waitcnt lgkmcnt(5)
v_mfma_f32_16x16x32_bf16 v[32:35],a[152:155],v[76:79],v[32:35]
ds_read_b128 v[100:103],v7 offset:1024
v_mfma_f32_16x16x32_bf16 v[36:39],a[156:159],v[76:79],v[36:39]
s_waitcnt lgkmcnt(5)
v_mfma_f32_16x16x32_bf16 v[32:35],a[160:163],v[80:83],v[32:35]
ds_read_b128 v[104:107],v7 offset:2048
v_mfma_f32_16x16x32_bf16 v[36:39],a[164:167],v[80:83],v[36:39]
s_waitcnt lgkmcnt(5)
v_mfma_f32_16x16x32_bf16 v[32:35],a[168:171],v[84:87],v[32:35]
ds_read_b128 v[108:111],v7 offset:3072
v_mfma_f32_16x16x32_bf16 v[36:39],a[172:175],v[84:87],v[36:39]
s_waitcnt lgkmcnt(5)
v_mfma_f32_16x16x32_bf16 v[32:35],a[176:179],v[88:91],v[32:35]
ds_read_b128 v[112:115],v7 offset:4096
v_mfma_f32_16x16x32_bf16 v[36:39],a[180:183],v[88:91],v[36:39]
s_waitcnt lgkmcnt(5)
v_mfma_f32_16x16x32_bf16 v[32:35],a[184:187],v[92:95],v[32:35]
ds_read_b128 v[116:119],v7 offset:5120
v_mfma_f32_16x16x32_bf16 v[36:39],a[188:191],v[92:95],v[36:39]
s_waitcnt lgkmcnt(5)
v_mfma_f32_16x16x32_bf16 v[32:35],a[192:195],v[96:99],v[32:35]
ds_read_b128 v[120:123],v7 offset:6144
v_mfma_f32_16x16x32_bf16 v[36:39],a[196:199],v[96:99],v[36:39]
s_waitcnt lgkmcnt(5)
v_mfma_f32_16x16x32_bf16 v[32:35],a[200:203],v[100:103],v[32:35]
ds_read_b128 v[124:127],v7 offset:7168
v_mfma_f32_16x16x32_bf16 v[36:39],a[204:207],v[100:103],v[36:39]
s_waitcnt lgkmcnt(5)
s_add_u32 s61,s61,131072
s_add_u32 s62,s62,131072
v_mfma_f32_16x16x32_bf16 v[32:35],a[208:211],v[104:107],v[32:35]
s_add_u32 s70,s70,32768
s_and_b32 s70,s70,0x1ffff
s_add_u32 s55,s55,32768
v_mfma_f32_16x16x32_bf16 v[36:39],a[212:215],v[104:107],v[36:39]
s_waitcnt lgkmcnt(4)
s_and_b32 s55,s55,0x1ffff
v_add_u32 v4,s55,v8
v_mfma_f32_16x16x32_bf16 v[32:35],a[216:219],v[108:111],v[32:35]
v_add_u32 v5,s55,v9
v_add_u32 v6,s55,v10
v_mfma_f32_16x16x32_bf16 v[36:39],a[220:223],v[108:111],v[36:39]
s_waitcnt lgkmcnt(3)
v_add_u32 v7,s55,v11
v_mfma_f32_16x16x32_bf16 v[32:35],a[224:227],v[112:115],v[32:35]
s_waitcnt vmcnt(10)
ds_read_b128 v[64:67],v4 offset:0
v_mfma_f32_16x16x32_bf16 v[36:39],a[228:231],v[112:115],v[36:39]
s_waitcnt lgkmcnt(3)
s_waitcnt vmcnt(7)
ds_read_b128 v[68:71],v4 offset:1024
v_mfma_f32_16x16x32_bf16 v[32:35],a[232:235],v[116:119],v[32:35]
s_waitcnt vmcnt(6)
ds_read_b128 v[72:75],v4 offset:2048
v_mfma_f32_16x16x32_bf16 v[36:39],a[236:239],v[116:119],v[36:39]
s_waitcnt lgkmcnt(4)
v_mfma_f32_16x16x32_bf16 v[32:35],a[240:243],v[120:123],v[32:35]
v_mfma_f32_16x16x32_bf16 v[36:39],a[244:247],v[120:123],v[36:39]
s_waitcnt lgkmcnt(3)
v_mfma_f32_16x16x32_bf16 v[40:43],a[248:251],v[124:127],v[32:35]
v_mfma_f32_16x16x32_bf16 v[44:47],a[252:255],v[124:127],v[36:39]
s_waitcnt vmcnt(1)
v_cmp_gt_u32 vcc,s53,v16
s_add_u32 s60,s60,1
s_cbranch_vccz WR_82
WN_83:
s_waitcnt lgkmcnt(2)
v_mfma_f32_16x16x32_bf16 v[32:35],a[0:3],v[64:67],0
s_waitcnt vmcnt(5)
s_add_u32 s71,s60,2
ds_read_b128 v[76:79],v4 offset:3072
v_mfma_f32_16x16x32_bf16 v[36:39],a[4:7],v[64:67],0
s_waitcnt lgkmcnt(2)
s_add_u32 s53,s60,3
v_mfma_f32_16x16x32_bf16 v[32:35],a[8:11],v[68:71],v[32:35]
s_waitcnt vmcnt(4)
ds_read_b128 v[80:83],v4 offset:4096
v_mfma_f32_16x16x32_bf16 v[36:39],a[12:15],v[68:71],v[36:39]
s_waitcnt lgkmcnt(2)
s_add_u32 s64,s74,s75
s_cmp_eq_u32 s56,1
s_cbranch_scc1 b1_94
buffer_store_dwordx4 v[40:43],v0,s[20:23],s64 offen offset:0
buffer_store_dwordx4 v[44:47],v0,s[20:23],s64 offen offset:1024
b2_95:
v_mfma_f32_16x16x32_bf16 v[32:35],a[16:19],v[72:75],v[32:35]
s_waitcnt vmcnt(5)
s_add_u32 s75,s75,6144
ds_read_b128 v[84:87],v4 offset:5120
v_mfma_f32_16x16x32_bf16 v[36:39],a[20:23],v[72:75],v[36:39]
s_waitcnt lgkmcnt(2)
s_cmp_eq_u32 s75,24576
s_cselect_b32 s75,0,s75
v_mfma_f32_16x16x32_bf16 v[32:35],a[24:27],v[76:79],v[32:35]
s_waitcnt vmcnt(4)
ds_read_b128 v[88:91],v4 offset:6144
v_mfma_f32_16x16x32_bf16 v[36:39],a[28:31],v[76:79],v[36:39]
s_waitcnt lgkmcnt(2)
v_mfma_f32_16x16x32_bf16 v[32:35],a[32:35],v[80:83],v[32:35]
s_waitcnt vmcnt(2)
ds_read_b128 v[92:95],v4 offset:7168
v_mfma_f32_16x16x32_bf16 v[36:39],a[36:39],v[80:83],v[36:39]
s_waitcnt lgkmcnt(2)
s_barrier
ds_read_b128 v[96:99],v5 offset:0
v_mfma_f32_16x16x32_bf16 v[32:35],a[40:43],v[84:87],v[32:35]
ds_read_b128 v[100:103],v5 offset:1024
v_mfma_f32_16x16x32_bf16 v[36:39],a[44:47],v[84:87],v[36:39]
s_waitcnt lgkmcnt(3)
ds_read_b128 v[104:107],v5 offset:2048
v_mfma_f32_16x16x32_bf16 v[32:35],a[48:51],v[88:91],v[32:35]
ds_read_b128 v[108:111],v5 offset:3072
v_mfma_f32_16x16x32_bf16 v[36:39],a[52:55],v[88:91],v[36:39]
s_waitcnt lgkmcnt(4)
ds_read_b128 v[112:115],v5 offset:4096
v_mfma_f32_16x16x32_bf16 v[32:35],a[56:59],v[92:95],v[32:35]
ds_read_b128 v[116:119],v5 offset:5120
v_mfma_f32_16x16x32_bf16 v[36:39],a[60:63],v[92:95],v[36:39]
s_waitcnt lgkmcnt(5)
v_mfma_f32_16x16x32_bf16 v[32:35],a[64:67],v[96:99],v[32:35]
ds_read_b128 v[120:123],v5 offset:6144
v_mfma_f32_16x16x32_bf16 v[36:39],a[68:71],v[96:99],v[36:39]
s_waitcnt lgkmcnt(5)
v_mfma_f32_16x16x32_bf16 v[32:35],a[72:75],v[100:103],v[32:35]
ds_read_b128 v[124:127],v5 offset:7168
v_mfma_f32_16x16x32_bf16 v[36:39],a[76:79],v[100:103],v[36:39]
s_waitcnt lgkmcnt(5)
v_mfma_f32_16x16x32_bf16 v[32:35],a[80:83],v[104:107],v[32:35]
ds_read_b128 v[64:67],v6 offset:0
v_mfma_f32_16x16x32_bf16 v[36:39],a[84:87],v[104:107],v[36:39]
s_waitcnt lgkmcnt(5)
v_mfma_f32_16x16x32_bf16 v[32:35],a[88:91],v[108:111],v[32:35]
ds_read_b128 v[68:71],v6 offset:1024
v_mfma_f32_16x16x32_bf16 v[36:39],a[92:95],v[108:111],v[36:39]
s_waitcnt lgkmcnt(5)
v_mfma_f32_16x16x32_bf16 v[32:35],a[96:99],v[112:115],v[32:35]
ds_read_b128 v[72:75],v6 offset:2048
v_mfma_f32_16x16x32_bf16 v[36:39],a[100:103],v[112:115],v[36:39]
s_waitcnt lgkmcnt(5)
v_mfma_f32_16x16x32_bf16 v[32:35],a[104:107],v[116:119],v[32:35]
ds_read_b128 v[76:79],v6 offset:3072
v_mfma_f32_16x16x32_bf16 v[36:39],a[108:111],v[116:119],v[36:39]
s_waitcnt lgkmcnt(5)
v_mfma_f32_16x16x32_bf16 v[32:35],a[112:115],v[120:123],v[32:35]
ds_read_b128 v[80:83],v6 offset:4096
v_mfma_f32_16x16x32_bf16 v[36:39],a[116:119],v[120:123],v[36:39]
s_waitcnt lgkmcnt(5)
v_mfma_f32_16x16x32_bf16 v[32:35],a[120:123],v[124:127],v[32:35]
ds_read_b128 v[84:87],v6 offset:5120
v_mfma_f32_16x16x32_bf16 v[36:39],a[124:127],v[124:127],v[36:39]
s_waitcnt lgkmcnt(5)
v_mfma_f32_16x16x32_bf16 v[32:35],a[128:131],v[64:67],v[32:35]
ds_read_b128 v[88:91],v6 offset:6144
v_mfma_f32_16x16x32_bf16 v[36:39],a[132:135],v[64:67],v[36:39]
s_waitcnt lgkmcnt(5)
v_mfma_f32_16x16x32_bf16 v[32:35],a[136:139],v[68:71],v[32:35]
ds_read_b128 v[92:95],v6 offset:7168
v_mfma_f32_16x16x32_bf16 v[36:39],a[140:143],v[68:71],v[36:39]
s_waitcnt lgkmcnt(5)
v_mfma_f32_16x16x32_bf16 v[32:35],a[144:147],v[72:75],v[32:35]
ds_read_b128 v[96:99],v7 offset:0
v_mfma_f32_16x16x32_bf16 v[36:39],a[148:151],v[72:75],v[36:39]
s_waitcnt lgkmcnt(5)
v_mfma_f32_16x16x32_bf16 v[32:35],a[152:155],v[76:79],v[32:35]
ds_read_b128 v[100:103],v7 offset:1024
v_mfma_f32_16x16x32_bf16 v[36:39],a[156:159],v[76:79],v[36:39]
s_waitcnt lgkmcnt(5)
v_mfma_f32_16x16x32_bf16 v[32:35],a[160:163],v[80:83],v[32:35]
ds_read_b128 v[104:107],v7 offset:2048
buffer_load_dword v16,v2,s[20:23],s68 offen sc1
v_mfma_f32_16x16x32_bf16 v[36:39],a[164:167],v[80:83],v[36:39]
s_waitcnt lgkmcnt(5)
v_mfma_f32_16x16x32_bf16 v[32:35],a[168:171],v[84:87],v[32:35]
ds_read_b128 v[108:111],v7 offset:3072
v_mfma_f32_16x16x32_bf16 v[36:39],a[172:175],v[84:87],v[36:39]
s_waitcnt lgkmcnt(5)
v_mfma_f32_16x16x32_bf16 v[32:35],a[176:179],v[88:91],v[32:35]
ds_read_b128 v[112:115],v7 offset:4096
v_mfma_f32_16x16x32_bf16 v[36:39],a[180:183],v[88:91],v[36:39]
s_waitcnt lgkmcnt(5)
v_mfma_f32_16x16x32_bf16 v[32:35],a[184:187],v[92:95],v[32:35]
ds_read_b128 v[116:119],v7 offset:5120
v_mfma_f32_16x16x32_bf16 v[36:39],a[188:191],v[92:95],v[36:39]
s_waitcnt lgkmcnt(5)
v_mfma_f32_16x16x32_bf16 v[32:35],a[192:195],v[96:99],v[32:35]
ds_read_b128 v[120:123],v7 offset:6144
v_mfma_f32_16x16x32_bf16 v[36:39],a[196:199],v[96:99],v[36:39]
s_waitcnt lgkmcnt(5)
v_mfma_f32_16x16x32_bf16 v[32:35],a[200:203],v[100:103],v[32:35]
ds_read_b128 v[124:127],v7 offset:7168
v_mfma_f32_16x16x32_bf16 v[36:39],a[204:207],v[100:103],v[36:39]
s_waitcnt lgkmcnt(5)
s_add_u32 s55,s55,32768
s_and_b32 s55,s55,0x1ffff
v_mfma_f32_16x16x32_bf16 v[32:35],a[208:211],v[104:107],v[32:35]
v_add_u32 v4,s55,v8
v_add_u32 v5,s55,v9
v_mfma_f32_16x16x32_bf16 v[36:39],a[212:215],v[104:107],v[36:39]
s_waitcnt lgkmcnt(4)
v_add_u32 v6,s55,v10
v_add_u32 v7,s55,v11
v_mfma_f32_16x16x32_bf16 v[32:35],a[216:219],v[108:111],v[32:35]
v_mfma_f32_16x16x32_bf16 v[36:39],a[220:223],v[108:111],v[36:39]
s_waitcnt lgkmcnt(3)
v_mfma_f32_16x16x32_bf16 v[32:35],a[224:227],v[112:115],v[32:35]
v_mfma_f32_16x16x32_bf16 v[36:39],a[228:231],v[112:115],v[36:39]
s_waitcnt lgkmcnt(2)
v_mfma_f32_16x16x32_bf16 v[32:35],a[232:235],v[116:119],v[32:35]
v_mfma_f32_16x16x32_bf16 v[36:39],a[236:239],v[116:119],v[36:39]
s_waitcnt lgkmcnt(1)
v_mfma_f32_16x16x32_bf16 v[32:35],a[240:243],v[120:123],v[32:35]
v_mfma_f32_16x16x32_bf16 v[36:39],a[244:247],v[120:123],v[36:39]
s_waitcnt lgkmcnt(0)
v_mfma_f32_16x16x32_bf16 v[40:43],a[248:251],v[124:127],v[32:35]
v_mfma_f32_16x16x32_bf16 v[44:47],a[252:255],v[124:127],v[36:39]
s_waitcnt vmcnt(0)
v_cmp_gt_u32 vcc,s71,v16
s_add_u32 s60,s60,1
s_branch endN_93
BN_85:
s_waitcnt vmcnt(9)
ds_read_b128 v[64:67],v4 offset:0
s_waitcnt vmcnt(8)
ds_read_b128 v[68:71],v4 offset:1024
s_waitcnt vmcnt(7)
ds_read_b128 v[72:75],v4 offset:2048
s_waitcnt vmcnt(6)
ds_read_b128 v[76:79],v4 offset:3072
s_waitcnt lgkmcnt(3)
v_mfma_f32_16x16x32_bf16 v[32:35],a[0:3],v[64:67],0
s_add_u32 s71,s60,2
s_add_u32 s53,s60,3
v_mfma_f32_16x16x32_bf16 v[36:39],a[4:7],v[64:67],0
s_waitcnt lgkmcnt(2)
s_waitcnt vmcnt(5)
ds_read_b128 v[80:83],v4 offset:4096
v_mfma_f32_16x16x32_bf16 v[32:35],a[8:11],v[68:71],v[32:35]
v_mfma_f32_16x16x32_bf16 v[36:39],a[12:15],v[68:71],v[36:39]
s_waitcnt lgkmcnt(2)
s_waitcnt vmcnt(4)
ds_read_b128 v[84:87],v4 offset:5120
v_mfma_f32_16x16x32_bf16 v[32:35],a[16:19],v[72:75],v[32:35]
v_mfma_f32_16x16x32_bf16 v[36:39],a[20:23],v[72:75],v[36:39]
s_waitcnt lgkmcnt(2)
s_waitcnt vmcnt(3)
ds_read_b128 v[88:91],v4 offset:6144
v_mfma_f32_16x16x32_bf16 v[32:35],a[24:27],v[76:79],v[32:35]
v_mfma_f32_16x16x32_bf16 v[36:39],a[28:31],v[76:79],v[36:39]
s_waitcnt lgkmcnt(2)
s_waitcnt vmcnt(2)
ds_read_b128 v[92:95],v4 offset:7168
v_mfma_f32_16x16x32_bf16 v[32:35],a[32:35],v[80:83],v[32:35]
v_mfma_f32_16x16x32_bf16 v[36:39],a[36:39],v[80:83],v[36:39]
s_waitcnt lgkmcnt(2)
s_barrier
ds_read_b128 v[96:99],v5 offset:0
v_mfma_f32_16x16x32_bf16 v[32:35],a[40:43],v[84:87],v[32:35]
ds_read_b128 v[100:103],v5 offset:1024
v_mfma_f32_16x16x32_bf16 v[36:39],a[44:47],v[84:87],v[36:39]
s_waitcnt lgkmcnt(3)
ds_read_b128 v[104:107],v5 offset:2048
v_mfma_f32_16x16x32_bf16 v[32:35],a[48:51],v[88:91],v[32:35]
ds_read_b128 v[108:111],v5 offset:3072
v_mfma_f32_16x16x32_bf16 v[36:39],a[52:55],v[88:91],v[36:39]
s_waitcnt lgkmcnt(4)
ds_read_b128 v[112:115],v5 offset:4096
v_mfma_f32_16x16x32_bf16 v[32:35],a[56:59],v[92:95],v[32:35]
ds_read_b128 v[116:119],v5 offset:5120
v_mfma_f32_16x16x32_bf16 v[36:39],a[60:63],v[92:95],v[36:39]
s_waitcnt lgkmcnt(5)
v_mfma_f32_16x16x32_bf16 v[32:35],a[64:67],v[96:99],v[32:35]
ds_read_b128 v[120:123],v5 offset:6144
v_mfma_f32_16x16x32_bf16 v[36:39],a[68:71],v[96:99],v[36:39]
s_waitcnt lgkmcnt(5)
v_mfma_f32_16x16x32_bf16 v[32:35],a[72:75],v[100:103],v[32:35]
ds_read_b128 v[124:127],v5 offset:7168
v_mfma_f32_16x16x32_bf16 v[36:39],a[76:79],v[100:103],v[36:39]
s_waitcnt lgkmcnt(5)
v_mfma_f32_16x16x32_bf16 v[32:35],a[80:83],v[104:107],v[32:35]
ds_read_b128 v[64:67],v6 offset:0
v_mfma_f32_16x16x32_bf16 v[36:39],a[84:87],v[104:107],v[36:39]
s_waitcnt lgkmcnt(5)
v_mfma_f32_16x16x32_bf16 v[32:35],a[88:91],v[108:111],v[32:35]
ds_read_b128 v[68:71],v6 offset:1024
v_mfma_f32_16x16x32_bf16 v[36:39],a[92:95],v[108:111],v[36:39]
s_waitcnt lgkmcnt(5)
v_mfma_f32_16x16x32_bf16 v[32:35],a[96:99],v[112:115],v[32:35]
ds_read_b128 v[72:75],v6 offset:2048
v_mfma_f32_16x16x32_bf16 v[36:39],a[100:103],v[112:115],v[36:39]
s_waitcnt lgkmcnt(5)
v_mfma_f32_16x16x32_bf16 v[32:35],a[104:107],v[116:119],v[32:35]
ds_read_b128 v[76:79],v6 offset:3072
v_mfma_f32_16x16x32_bf16 v[36:39],a[108:111],v[116:119],v[36:39]
s_waitcnt lgkmcnt(5)
v_mfma_f32_16x16x32_bf16 v[32:35],a[112:115],v[120:123],v[32:35]
ds_read_b128 v[80:83],v6 offset:4096
v_mfma_f32_16x16x32_bf16 v[36:39],a[116:119],v[120:123],v[36:39]
s_waitcnt lgkmcnt(5)
v_mfma_f32_16x16x32_bf16 v[32:35],a[120:123],v[124:127],v[32:35]
ds_read_b128 v[84:87],v6 offset:5120
v_mfma_f32_16x16x32_bf16 v[36:39],a[124:127],v[124:127],v[36:39]
s_waitcnt lgkmcnt(5)
v_mfma_f32_16x16x32_bf16 v[32:35],a[128:131],v[64:67],v[32:35]
ds_read_b128 v[88:91],v6 offset:6144
v_mfma_f32_16x16x32_bf16 v[36:39],a[132:135],v[64:67],v[36:39]
s_waitcnt lgkmcnt(5)
v_mfma_f32_16x16x32_bf16 v[32:35],a[136:139],v[68:71],v[32:35]
ds_read_b128 v[92:95],v6 offset:7168
v_mfma_f32_16x16x32_bf16 v[36:39],a[140:143],v[68:71],v[36:39]
s_waitcnt lgkmcnt(5)
v_mfma_f32_16x16x32_bf16 v[32:35],a[144:147],v[72:75],v[32:35]
ds_read_b128 v[96:99],v7 offset:0
v_mfma_f32_16x16x32_bf16 v[36:39],a[148:151],v[72:75],v[36:39]
s_waitcnt lgkmcnt(5)
v_mfma_f32_16x16x32_bf16 v[32:35],a[152:155],v[76:79],v[32:35]
ds_read_b128 v[100:103],v7 offset:1024
v_mfma_f32_16x16x32_bf16 v[36:39],a[156:159],v[76:79],v[36:39]
s_waitcnt lgkmcnt(5)
v_mfma_f32_16x16x32_bf16 v[32:35],a[160:163],v[80:83],v[32:35]
ds_read_b128 v[104:107],v7 offset:2048
buffer_load_dword v16,v2,s[20:23],s68 offen sc1
v_mfma_f32_16x16x32_bf16 v[36:39],a[164:167],v[80:83],v[36:39]
s_waitcnt lgkmcnt(5)
v_mfma_f32_16x16x32_bf16 v[32:35],a[168:171],v[84:87],v[32:35]
ds_read_b128 v[108:111],v7 offset:3072
v_mfma_f32_16x16x32_bf16 v[36:39],a[172:175],v[84:87],v[36:39]
s_waitcnt lgkmcnt(5)
v_mfma_f32_16x16x32_bf16 v[32:35],a[176:179],v[88:91],v[32:35]
ds_read_b128 v[112:115],v7 offset:4096
v_mfma_f32_16x16x32_bf16 v[36:39],a[180:183],v[88:91],v[36:39]
s_waitcnt lgkmcnt(5)
v_mfma_f32_16x16x32_bf16 v[32:35],a[184:187],v[92:95],v[32:35]
ds_read_b128 v[116:119],v7 offset:5120
v_mfma_f32_16x16x32_bf16 v[36:39],a[188:191],v[92:95],v[36:39]
s_waitcnt lgkmcnt(5)
v_mfma_f32_16x16x32_bf16 v[32:35],a[192:195],v[96:99],v[32:35]
ds_read_b128 v[120:123],v7 offset:6144
v_mfma_f32_16x16x32_bf16 v[36:39],a[196:199],v[96:99],v[36:39]
s_waitcnt lgkmcnt(5)
v_mfma_f32_16x16x32_bf16 v[32:35],a[200:203],v[100:103],v[32:35]
ds_read_b128 v[124:127],v7 offset:7168
v_mfma_f32_16x16x32_bf16 v[36:39],a[204:207],v[100:103],v[36:39]
s_waitcnt lgkmcnt(5)
s_add_u32 s55,s55,32768
s_and_b32 s55,s55,0x1ffff
v_mfma_f32_16x16x32_bf16 v[32:35],a[208:211],v[104:107],v[32:35]
v_add_u32 v4,s55,v8
v_add_u32 v5,s55,v9
v_mfma_f32_16x16x32_bf16 v[36:39],a[212:215],v[104:107],v[36:39]
s_waitcnt lgkmcnt(4)
v_add_u32 v6,s55,v10
v_add_u32 v7,s55,v11
v_mfma_f32_16x16x32_bf16 v[32:35],a[216:219],v[108:111],v[32:35]
v_mfma_f32_16x16x32_bf16 v[36:39],a[220:223],v[108:111],v[36:39]
s_waitcnt lgkmcnt(3)
v_mfma_f32_16x16x32_bf16 v[32:35],a[224:227],v[112:115],v[32:35]
v_mfma_f32_16x16x32_bf16 v[36:39],a[228:231],v[112:115],v[36:39]
s_waitcnt lgkmcnt(2)
v_mfma_f32_16x16x32_bf16 v[32:35],a[232:235],v[116:119],v[32:35]
v_mfma_f32_16x16x32_bf16 v[36:39],a[236:239],v[116:119],v[36:39]
s_waitcnt lgkmcnt(1)
v_mfma_f32_16x16x32_bf16 v[32:35],a[240:243],v[120:123],v[32:35]
v_mfma_f32_16x16x32_bf16 v[36:39],a[244:247],v[120:123],v[36:39]
s_waitcnt lgkmcnt(0)
v_mfma_f32_16x16x32_bf16 v[40:43],a[248:251],v[124:127],v[32:35]
v_mfma_f32_16x16x32_bf16 v[44:47],a[252:255],v[124:127],v[36:39]
s_waitcnt vmcnt(0)
v_cmp_gt_u32 vcc,s71,v16
s_add_u32 s60,s60,1
endN_93:
s_cbranch_vccnz nb_88
s_mov_b32 m0,s70
s_nop 0
buffer_load_dwordx4 v3,s[20:23],s61 offen offset:0 lds
buffer_load_dwordx4 v3,s[20:23],s61 offen offset:1024 lds
buffer_load_dwordx4 v3,s[20:23],s61 offen offset:2048 lds
buffer_load_dwordx4 v3,s[20:23],s61 offen offset:3072 lds
s_add_u32 m0,s70,4096
s_nop 0
buffer_load_dwordx4 v3,s[20:23],s62 offen offset:0 lds
buffer_load_dwordx4 v3,s[20:23],s62 offen offset:1024 lds
buffer_load_dwordx4 v3,s[20:23],s62 offen offset:2048 lds
buffer_load_dwordx4 v3,s[20:23],s62 offen offset:3072 lds
s_add_u32 s61,s61,131072
s_add_u32 s62,s62,131072
s_add_u32 s70,s70,32768
s_and_b32 s70,s70,0x1ffff
s_add_u32 s64,s74,s75
s_cmp_eq_u32 s56,1
s_cbranch_scc1 b1_96
buffer_store_dwordx4 v[40:43],v0,s[20:23],s64 offen offset:0
buffer_store_dwordx4 v[44:47],v0,s[20:23],s64 offen offset:1024
b2_97:
s_add_u32 s75,s75,6144
s_cmp_eq_u32 s75,24576
s_cselect_b32 s75,0,s75
s_branch dec_87
nb_88:
buffer_load_dword v16,v2,s[20:23],s68 offen sc1
s_nop 3
s_add_u32 s64,s74,s75
s_cmp_eq_u32 s56,1
s_cbranch_scc1 b1_98
buffer_store_dwordx4 v[40:43],v0,s[20:23],s64 offen offset:0
buffer_store_dwordx4 v[44:47],v0,s[20:23],s64 offen offset:1024
b2_99:
s_add_u32 s75,s75,6144
s_cmp_eq_u32 s75,24576
s_cselect_b32 s75,0,s75
s_waitcnt vmcnt(2)
v_cmp_gt_u32 vcc,s71,v16
s_cbranch_vccz lag_86
s_cmp_ge_u32 s60,128
s_cbranch_scc1 done_72
plp_100:
buffer_load_dword v16,v2,s[20:23],s68 offen sc1
s_waitcnt vmcnt(0)
v_cmp_gt_u32 vcc,s71,v16
s_cbranch_vccz pok_101
s_sleep 4
s_sub_u32 s90,s90,1
s_cmp_gt_i32 s90,0
s_cbranch_scc1 plp_100
pok_101:
s_branch lag_86
lfin_79:
s_add_u32 s71,s60,1
s_add_u32 s53,s60,2
plp_121:
buffer_load_dword v16,v2,s[20:23],s68 offen sc1
s_waitcnt vmcnt(0)
v_cmp_gt_u32 vcc,s71,v16
s_cbranch_vccz pok_122
s_sleep 4
s_sub_u32 s90,s90,1
s_cmp_gt_i32 s90,0
s_cbranch_scc1 plp_121
pok_122:
lag_118:
s_mov_b32 m0,s70
s_nop 0
buffer_load_dwordx4 v3,s[20:23],s61 offen offset:0 lds
buffer_load_dwordx4 v3,s[20:23],s61 offen offset:1024 lds
buffer_load_dwordx4 v3,s[20:23],s61 offen offset:2048 lds
buffer_load_dwordx4 v3,s[20:23],s61 offen offset:3072 lds
s_add_u32 m0,s70,4096
s_nop 0
buffer_load_dwordx4 v3,s[20:23],s62 offen offset:0 lds
buffer_load_dwordx4 v3,s[20:23],s62 offen offset:1024 lds
buffer_load_dwordx4 v3,s[20:23],s62 offen offset:2048 lds
buffer_load_dwordx4 v3,s[20:23],s62 offen offset:3072 lds
s_add_u32 s61,s61,131072
s_add_u32 s62,s62,131072
s_add_u32 s70,s70,32768
s_and_b32 s70,s70,0x1ffff
dec_119:
v_cmp_gt_u32 vcc,s53,v16
s_cbranch_vccnz BN_117
BR_116:
s_waitcnt vmcnt(7)
ds_read_b128 v[64:67],v4 offset:0
s_waitcnt vmcnt(6)
ds_read_b128 v[68:71],v4 offset:1024
s_waitcnt vmcnt(5)
ds_read_b128 v[72:75],v4 offset:2048
s_waitcnt vmcnt(4)
ds_read_b128 v[76:79],v4 offset:3072
s_waitcnt lgkmcnt(3)
v_mfma_f32_16x16x32_bf16 v[32:35],a[0:3],v[64:67],0
s_add_u32 s71,s60,2
s_add_u32 s53,s60,3
v_mfma_f32_16x16x32_bf16 v[36:39],a[4:7],v[64:67],0
s_waitcnt lgkmcnt(2)
s_waitcnt vmcnt(3)
ds_read_b128 v[80:83],v4 offset:4096
v_mfma_f32_16x16x32_bf16 v[32:35],a[8:11],v[68:71],v[32:35]
v_mfma_f32_16x16x32_bf16 v[36:39],a[12:15],v[68:71],v[36:39]
s_waitcnt lgkmcnt(2)
s_waitcnt vmcnt(2)
s_mov_b32 m0,s70
ds_read_b128 v[84:87],v4 offset:5120
v_mfma_f32_16x16x32_bf16 v[32:35],a[16:19],v[72:75],v[32:35]
buffer_load_dwordx4 v3,s[20:23],s61 offen offset:0 lds
v_mfma_f32_16x16x32_bf16 v[36:39],a[20:23],v[72:75],v[36:39]
s_waitcnt lgkmcnt(2)
s_waitcnt vmcnt(2)
ds_read_b128 v[88:91],v4 offset:6144
v_mfma_f32_16x16x32_bf16 v[32:35],a[24:27],v[76:79],v[32:35]
buffer_load_dwordx4 v3,s[20:23],s61 offen offset:1024 lds
v_mfma_f32_16x16x32_bf16 v[36:39],a[28:31],v[76:79],v[36:39]
s_waitcnt lgkmcnt(2)
s_waitcnt vmcnt(2)
ds_read_b128 v[92:95],v4 offset:7168
v_mfma_f32_16x16x32_bf16 v[32:35],a[32:35],v[80:83],v[32:35]
v_mfma_f32_16x16x32_bf16 v[36:39],a[36:39],v[80:83],v[36:39]
s_waitcnt lgkmcnt(2)
s_barrier
ds_read_b128 v[96:99],v5 offset:0
v_mfma_f32_16x16x32_bf16 v[32:35],a[40:43],v[84:87],v[32:35]
ds_read_b128 v[100:103],v5 offset:1024
buffer_load_dwordx4 v3,s[20:23],s61 offen offset:2048 lds
v_mfma_f32_16x16x32_bf16 v[36:39],a[44:47],v[84:87],v[36:39]
s_waitcnt lgkmcnt(3)
ds_read_b128 v[104:107],v5 offset:2048
v_mfma_f32_16x16x32_bf16 v[32:35],a[48:51],v[88:91],v[32:35]
ds_read_b128 v[108:111],v5 offset:3072
v_mfma_f32_16x16x32_bf16 v[36:39],a[52:55],v[88:91],v[36:39]
s_waitcnt lgkmcnt(4)
ds_read_b128 v[112:115],v5 offset:4096
buffer_load_dwordx4 v3,s[20:23],s61 offen offset:3072 lds
v_mfma_f32_16x16x32_bf16 v[32:35],a[56:59],v[92:95],v[32:35]
s_cmp_eq_u32 s77,0
s_cselect_b32 s57,2.0,0
ds_read_b128 v[116:119],v5 offset:5120
v_mfma_f32_16x16x32_bf16 v[36:39],a[60:63],v[92:95],v[36:39]
s_waitcnt lgkmcnt(5)
s_add_u32 m0,s70,4096
v_or_b32 v21,s57,v0
v_mfma_f32_16x16x32_bf16 v[32:35],a[64:67],v[96:99],v[32:35]
ds_read_b128 v[120:123],v5 offset:6144
buffer_load_dwordx4 v3,s[20:23],s62 offen offset:0 lds
v_mfma_f32_16x16x32_bf16 v[36:39],a[68:71],v[96:99],v[36:39]
s_waitcnt lgkmcnt(5)
v_lshlrev_b32 v168,16,v160
v_and_b32 v169,s73,v160
v_mfma_f32_16x16x32_bf16 v[32:35],a[72:75],v[100:103],v[32:35]
ds_read_b128 v[124:127],v5 offset:7168
v_lshlrev_b32 v170,16,v161
v_mfma_f32_16x16x32_bf16 v[36:39],a[76:79],v[100:103],v[36:39]
s_waitcnt lgkmcnt(5)
buffer_load_dwordx4 v3,s[20:23],s62 offen offset:1024 lds
v_and_b32 v171,s73,v161
v_mfma_f32_16x16x32_bf16 v[32:35],a[80:83],v[104:107],v[32:35]
ds_read_b128 v[64:67],v6 offset:0
v_lshlrev_b32 v172,16,v162
v_mfma_f32_16x16x32_bf16 v[36:39],a[84:87],v[104:107],v[36:39]
s_waitcnt lgkmcnt(5)
v_and_b32 v173,s73,v162
v_lshlrev_b32 v174,16,v163
v_mfma_f32_16x16x32_bf16 v[32:35],a[88:91],v[108:111],v[32:35]
ds_read_b128 v[68:71],v6 offset:1024
v_and_b32 v175,s73,v163
v_mfma_f32_16x16x32_bf16 v[36:39],a[92:95],v[108:111],v[36:39]
s_waitcnt lgkmcnt(5)
buffer_load_dwordx4 v3,s[20:23],s62 offen offset:2048 lds
v_fma_f32 v168,v212,v152,v168
v_mfma_f32_16x16x32_bf16 v[32:35],a[96:99],v[112:115],v[32:35]
ds_read_b128 v[72:75],v6 offset:2048
buffer_load_dword v16,v2,s[20:23],s68 offen sc1
v_mfma_f32_16x16x32_bf16 v[36:39],a[100:103],v[112:115],v[36:39]
s_waitcnt lgkmcnt(5)
v_fma_f32 v169,v213,v153,v169
v_fma_f32 v170,v214,v154,v170
v_mfma_f32_16x16x32_bf16 v[32:35],a[104:107],v[116:119],v[32:35]
ds_read_b128 v[76:79],v6 offset:3072
buffer_load_dwordx4 v3,s[20:23],s62 offen offset:3072 lds
v_mfma_f32_16x16x32_bf16 v[36:39],a[108:111],v[116:119],v[36:39]
s_waitcnt lgkmcnt(5)
v_fma_f32 v171,v215,v155,v171
v_fma_f32 v172,v216,v156,v172
v_mfma_f32_16x16x32_bf16 v[32:35],a[112:115],v[120:123],v[32:35]
s_add_u32 s84,s74,s75
s_add_u32 s85,s84,4096
ds_read_b128 v[80:83],v6 offset:4096
v_mfma_f32_16x16x32_bf16 v[36:39],a[116:119],v[120:123],v[36:39]
s_waitcnt lgkmcnt(5)
buffer_load_dwordx4 v[128:131],v0,s[20:23],s84 offen offset:0 sc1
v_fma_f32 v173,v217,v157,v173
v_mfma_f32_16x16x32_bf16 v[32:35],a[120:123],v[124:127],v[32:35]
ds_read_b128 v[84:87],v6 offset:5120
v_fma_f32 v174,v218,v158,v174
v_mfma_f32_16x16x32_bf16 v[36:39],a[124:127],v[124:127],v[36:39]
s_waitcnt lgkmcnt(5)
buffer_load_dwordx4 v[132:135],v0,s[20:23],s84 offen offset:1024 sc1
v_fma_f32 v175,v219,v159,v175
v_mfma_f32_16x16x32_bf16 v[32:35],a[128:131],v[64:67],v[32:35]
ds_read_b128 v[88:91],v6 offset:6144
buffer_load_dwordx4 v[160:163],v18,s[24:27],s82 offen
v_mfma_f32_16x16x32_bf16 v[36:39],a[132:135],v[64:67],v[36:39]
s_waitcnt lgkmcnt(5)
s_add_u32 s82,s82,32768
buffer_load_dwordx4 v[136:139],v0,s[20:23],s84 offen offset:2048 sc1
v_mfma_f32_16x16x32_bf16 v[32:35],a[136:139],v[68:71],v[32:35]
ds_read_b128 v[92:95],v6 offset:7168
v_mfma_f32_16x16x32_bf16 v[36:39],a[140:143],v[68:71],v[36:39]
s_waitcnt lgkmcnt(5)
buffer_load_dwordx4 v[140:143],v0,s[20:23],s84 offen offset:3072 sc1
v_mfma_f32_16x16x32_bf16 v[32:35],a[144:147],v[72:75],v[32:35]
ds_read_b128 v[96:99],v7 offset:0
v_mfma_f32_16x16x32_bf16 v[36:39],a[148:151],v[72:75],v[36:39]
s_waitcnt lgkmcnt(5)
buffer_load_dwordx4 v[144:147],v0,s[20:23],s85 offen offset:0 sc1
v_mfma_f32_16x16x32_bf16 v[32:35],a[152:155],v[76:79],v[32:35]
ds_read_b128 v[100:103],v7 offset:1024
v_mfma_f32_16x16x32_bf16 v[36:39],a[156:159],v[76:79],v[36:39]
s_waitcnt lgkmcnt(5)
buffer_load_dwordx4 v[148:151],v0,s[20:23],s85 offen offset:1024 sc1
v_mfma_f32_16x16x32_bf16 v[32:35],a[160:163],v[80:83],v[32:35]
ds_read_b128 v[104:107],v7 offset:2048
v_mfma_f32_16x16x32_bf16 v[36:39],a[164:167],v[80:83],v[36:39]
s_waitcnt lgkmcnt(5)
v_mfma_f32_16x16x32_bf16 v[32:35],a[168:171],v[84:87],v[32:35]
ds_read_b128 v[108:111],v7 offset:3072
v_mfma_f32_16x16x32_bf16 v[36:39],a[172:175],v[84:87],v[36:39]
s_waitcnt lgkmcnt(5)
v_mfma_f32_16x16x32_bf16 v[32:35],a[176:179],v[88:91],v[32:35]
ds_read_b128 v[112:115],v7 offset:4096
v_mfma_f32_16x16x32_bf16 v[36:39],a[180:183],v[88:91],v[36:39]
s_waitcnt lgkmcnt(5)
v_mfma_f32_16x16x32_bf16 v[32:35],a[184:187],v[92:95],v[32:35]
ds_read_b128 v[116:119],v7 offset:5120
v_mfma_f32_16x16x32_bf16 v[36:39],a[188:191],v[92:95],v[36:39]
s_waitcnt lgkmcnt(5)
v_mfma_f32_16x16x32_bf16 v[32:35],a[192:195],v[96:99],v[32:35]
ds_read_b128 v[120:123],v7 offset:6144
v_mfma_f32_16x16x32_bf16 v[36:39],a[196:199],v[96:99],v[36:39]
s_waitcnt lgkmcnt(5)
v_mfma_f32_16x16x32_bf16 v[32:35],a[200:203],v[100:103],v[32:35]
ds_read_b128 v[124:127],v7 offset:7168
v_mfma_f32_16x16x32_bf16 v[36:39],a[204:207],v[100:103],v[36:39]
s_waitcnt lgkmcnt(5)
s_add_u32 s61,s61,131072
s_add_u32 s62,s62,131072
v_mfma_f32_16x16x32_bf16 v[32:35],a[208:211],v[104:107],v[32:35]
s_add_u32 s70,s70,32768
s_and_b32 s70,s70,0x1ffff
s_add_u32 s55,s55,32768
v_mfma_f32_16x16x32_bf16 v[36:39],a[212:215],v[104:107],v[36:39]
s_waitcnt lgkmcnt(4)
s_and_b32 s55,s55,0x1ffff
v_add_u32 v4,s55,v8
v_mfma_f32_16x16x32_bf16 v[32:35],a[216:219],v[108:111],v[32:35]
v_add_u32 v5,s55,v9
v_add_u32 v6,s55,v10
v_mfma_f32_16x16x32_bf16 v[36:39],a[220:223],v[108:111],v[36:39]
s_waitcnt lgkmcnt(3)
v_add_u32 v7,s55,v11
v_mfma_f32_16x16x32_bf16 v[32:35],a[224:227],v[112:115],v[32:35]
s_waitcnt vmcnt(15)
ds_read_b128 v[64:67],v4 offset:0
v_mfma_f32_16x16x32_bf16 v[36:39],a[228:231],v[112:115],v[36:39]
s_waitcnt lgkmcnt(3)
s_waitcnt vmcnt(14)
ds_read_b128 v[68:71],v4 offset:1024
v_mfma_f32_16x16x32_bf16 v[32:35],a[232:235],v[116:119],v[32:35]
s_waitcnt vmcnt(0)
s_cmp_eq_u32 s77,0
s_cbranch_scc1 go_131
ck_129:
v_max3_u32 v184,v128,v129,v130
v_max3_u32 v185,v140,v141,v142
v_max3_u32 v184,v184,v131,v132
v_max3_u32 v185,v185,v143,v144
v_max3_u32 v184,v184,v133,v134
v_max3_u32 v185,v185,v145,v146
v_max3_u32 v184,v184,v135,v136
v_max3_u32 v185,v185,v147,v148
v_max3_u32 v184,v184,v137,v138
v_max3_u32 v185,v185,v149,v150
v_max3_u32 v184,v184,v139,v151
v_max_u32 v184,v184,v185
v_cmp_eq_u32 vcc,-1,v184
s_cbranch_vccnz rt_130
go_131:
v_mfma_f32_16x16x32_bf16 v[36:39],a[236:239],v[116:119],v[36:39]
s_waitcnt lgkmcnt(3)
ds_read_b128 v[72:75],v4 offset:2048
v_add_f32 v128,v128,v136
v_mfma_f32_16x16x32_bf16 v[32:35],a[240:243],v[120:123],v[32:35]
v_add_f32 v129,v129,v137
v_add_f32 v130,v130,v138
v_add_f32 v131,v131,v139
v_mfma_f32_16x16x32_bf16 v[36:39],a[244:247],v[120:123],v[36:39]
s_waitcnt lgkmcnt(3)
v_add_f32 v132,v132,v140
v_add_f32 v133,v133,v141
v_add_f32 v134,v134,v142
v_mfma_f32_16x16x32_bf16 v[40:43],a[248:251],v[124:127],v[32:35]
v_add_f32 v135,v135,v143
v_add_f32 v128,v128,v144
v_add_f32 v129,v129,v145
v_mfma_f32_16x16x32_bf16 v[44:47],a[252:255],v[124:127],v[36:39]
v_add_f32 v130,v130,v146
v_add_f32 v131,v131,v147
v_add_f32 v132,v132,v148
v_add_f32 v133,v133,v149
v_add_f32 v134,v134,v150
v_add_f32 v135,v135,v151
v_fma_f32 v168,v128,v152,v168
v_fma_f32 v169,v129,v153,v169
v_fma_f32 v170,v130,v154,v170
v_fma_f32 v171,v131,v155,v171
v_fma_f32 v172,v132,v156,v172
v_fma_f32 v173,v133,v157,v173
v_fma_f32 v174,v134,v158,v174
v_fma_f32 v175,v135,v159,v175
v_cvt_pk_bf16_f32 v176,v168,v169
v_cvt_pk_bf16_f32 v177,v170,v171
v_cvt_pk_bf16_f32 v178,v172,v173
v_cvt_pk_bf16_f32 v179,v174,v175
s_add_u32 s64,s66,201326592
buffer_store_dwordx4 v[176:179],v21,s[20:23],s64 offen sc1
s_add_u32 s79,s66,201392128
s_cmp_ge_u32 s63,126
s_cselect_b32 s79,138641408,s79
buffer_store_dwordx4 v[204:207],v21,s[20:23],s79 offen sc1
s_cmp_eq_u32 s56,1
s_cbranch_scc1 b1_123
buffer_store_dwordx4 v[204:207],v21,s[20:23],s84 offen offset:0
buffer_store_dwordx4 v[204:207],v21,s[20:23],s84 offen offset:1024
b2_124:
s_cmp_eq_u32 s56,1
s_cbranch_scc1 b1_125
buffer_store_dwordx4 v[204:207],v21,s[20:23],s84 offen offset:2048
buffer_store_dwordx4 v[204:207],v21,s[20:23],s84 offen offset:3072
b2_126:
s_cmp_eq_u32 s56,1
s_cbranch_scc1 b1_127
buffer_store_dwordx4 v[204:207],v21,s[20:23],s85 offen offset:0
buffer_store_dwordx4 v[204:207],v21,s[20:23],s85 offen offset:1024
b2_128:
s_mul_i32 s64,s77,32768
s_add_u32 s66,s66,s64
s_mul_i32 s64,s77,6144
s_add_u32 s75,s75,s64
s_cmp_eq_u32 s75,24576
s_cselect_b32 s75,0,s75
s_add_u32 s63,s63,s77
s_mov_b32 s77,0
v_cmp_gt_u32 vcc,s53,v16
s_add_u32 s60,s60,1
s_cbranch_vccnz WN_115
.p2align 6
WR_114:
s_waitcnt lgkmcnt(2)
v_mfma_f32_16x16x32_bf16 v[32:35],a[0:3],v[64:67],0
s_waitcnt vmcnt(20)
s_add_u32 s71,s60,2
ds_read_b128 v[76:79],v4 offset:3072
v_mfma_f32_16x16x32_bf16 v[36:39],a[4:7],v[64:67],0
s_waitcnt lgkmcnt(2)
s_add_u32 s53,s60,3
v_mfma_f32_16x16x32_bf16 v[32:35],a[8:11],v[68:71],v[32:35]
s_waitcnt vmcnt(19)
s_mov_b32 m0,s70
ds_read_b128 v[80:83],v4 offset:4096
v_mfma_f32_16x16x32_bf16 v[36:39],a[12:15],v[68:71],v[36:39]
s_waitcnt lgkmcnt(2)
buffer_load_dwordx4 v3,s[20:23],s61 offen offset:0 lds
v_mov_b32 v212,v40
v_mfma_f32_16x16x32_bf16 v[32:35],a[16:19],v[72:75],v[32:35]
s_waitcnt vmcnt(19)
ds_read_b128 v[84:87],v4 offset:5120
v_mov_b32 v213,v41
v_mfma_f32_16x16x32_bf16 v[36:39],a[20:23],v[72:75],v[36:39]
s_waitcnt lgkmcnt(2)
v_mov_b32 v214,v42
v_mov_b32 v215,v43
v_mfma_f32_16x16x32_bf16 v[32:35],a[24:27],v[76:79],v[32:35]
s_waitcnt vmcnt(18)
ds_read_b128 v[88:91],v4 offset:6144
buffer_load_dwordx4 v3,s[20:23],s61 offen offset:1024 lds
v_mfma_f32_16x16x32_bf16 v[36:39],a[28:31],v[76:79],v[36:39]
s_waitcnt lgkmcnt(2)
v_mov_b32 v216,v44
v_mov_b32 v217,v45
v_mfma_f32_16x16x32_bf16 v[32:35],a[32:35],v[80:83],v[32:35]
s_waitcnt vmcnt(17)
ds_read_b128 v[92:95],v4 offset:7168
v_mov_b32 v218,v46
v_mfma_f32_16x16x32_bf16 v[36:39],a[36:39],v[80:83],v[36:39]
s_waitcnt lgkmcnt(2)
s_barrier
ds_read_b128 v[96:99],v5 offset:0
v_mfma_f32_16x16x32_bf16 v[32:35],a[40:43],v[84:87],v[32:35]
ds_read_b128 v[100:103],v5 offset:1024
buffer_load_dwordx4 v3,s[20:23],s61 offen offset:2048 lds
v_mfma_f32_16x16x32_bf16 v[36:39],a[44:47],v[84:87],v[36:39]
s_waitcnt lgkmcnt(3)
ds_read_b128 v[104:107],v5 offset:2048
v_mov_b32 v219,v47
v_mfma_f32_16x16x32_bf16 v[32:35],a[48:51],v[88:91],v[32:35]
s_mov_b32 s77,1
ds_read_b128 v[108:111],v5 offset:3072
v_mfma_f32_16x16x32_bf16 v[36:39],a[52:55],v[88:91],v[36:39]
s_waitcnt lgkmcnt(4)
ds_read_b128 v[112:115],v5 offset:4096
buffer_load_dwordx4 v3,s[20:23],s61 offen offset:3072 lds
v_mfma_f32_16x16x32_bf16 v[32:35],a[56:59],v[92:95],v[32:35]
s_waitcnt vmcnt(16)
s_cmp_eq_u32 s77,0
s_cselect_b32 s57,2.0,0
ds_read_b128 v[116:119],v5 offset:5120
v_mfma_f32_16x16x32_bf16 v[36:39],a[60:63],v[92:95],v[36:39]
s_waitcnt lgkmcnt(5)
s_add_u32 m0,s70,4096
v_or_b32 v21,s57,v0
v_mfma_f32_16x16x32_bf16 v[32:35],a[64:67],v[96:99],v[32:35]
ds_read_b128 v[120:123],v5 offset:6144
buffer_load_dwordx4 v3,s[20:23],s62 offen offset:0 lds
v_mfma_f32_16x16x32_bf16 v[36:39],a[68:71],v[96:99],v[36:39]
s_waitcnt lgkmcnt(5)
v_lshlrev_b32 v168,16,v160
v_and_b32 v169,s73,v160
v_mfma_f32_16x16x32_bf16 v[32:35],a[72:75],v[100:103],v[32:35]
ds_read_b128 v[124:127],v5 offset:7168
v_lshlrev_b32 v170,16,v161
v_mfma_f32_16x16x32_bf16 v[36:39],a[76:79],v[100:103],v[36:39]
s_waitcnt lgkmcnt(5)
buffer_load_dwordx4 v3,s[20:23],s62 offen offset:1024 lds
v_and_b32 v171,s73,v161
v_mfma_f32_16x16x32_bf16 v[32:35],a[80:83],v[104:107],v[32:35]
ds_read_b128 v[64:67],v6 offset:0
v_lshlrev_b32 v172,16,v162
v_mfma_f32_16x16x32_bf16 v[36:39],a[84:87],v[104:107],v[36:39]
s_waitcnt lgkmcnt(5)
v_and_b32 v173,s73,v162
v_lshlrev_b32 v174,16,v163
v_mfma_f32_16x16x32_bf16 v[32:35],a[88:91],v[108:111],v[32:35]
ds_read_b128 v[68:71],v6 offset:1024
v_and_b32 v175,s73,v163
v_mfma_f32_16x16x32_bf16 v[36:39],a[92:95],v[108:111],v[36:39]
s_waitcnt lgkmcnt(5)
buffer_load_dwordx4 v3,s[20:23],s62 offen offset:2048 lds
v_fma_f32 v168,v212,v152,v168
v_mfma_f32_16x16x32_bf16 v[32:35],a[96:99],v[112:115],v[32:35]
ds_read_b128 v[72:75],v6 offset:2048
buffer_load_dword v16,v2,s[20:23],s68 offen sc1
v_mfma_f32_16x16x32_bf16 v[36:39],a[100:103],v[112:115],v[36:39]
s_waitcnt lgkmcnt(5)
v_fma_f32 v169,v213,v153,v169
v_fma_f32 v170,v214,v154,v170
v_mfma_f32_16x16x32_bf16 v[32:35],a[104:107],v[116:119],v[32:35]
ds_read_b128 v[76:79],v6 offset:3072
buffer_load_dwordx4 v3,s[20:23],s62 offen offset:3072 lds
v_mfma_f32_16x16x32_bf16 v[36:39],a[108:111],v[116:119],v[36:39]
s_waitcnt lgkmcnt(5)
v_fma_f32 v171,v215,v155,v171
v_fma_f32 v172,v216,v156,v172
v_mfma_f32_16x16x32_bf16 v[32:35],a[112:115],v[120:123],v[32:35]
s_add_u32 s84,s74,s75
s_add_u32 s85,s84,4096
ds_read_b128 v[80:83],v6 offset:4096
v_mfma_f32_16x16x32_bf16 v[36:39],a[116:119],v[120:123],v[36:39]
s_waitcnt lgkmcnt(5)
buffer_load_dwordx4 v[128:131],v0,s[20:23],s84 offen offset:0 sc1
v_fma_f32 v173,v217,v157,v173
v_mfma_f32_16x16x32_bf16 v[32:35],a[120:123],v[124:127],v[32:35]
ds_read_b128 v[84:87],v6 offset:5120
v_fma_f32 v174,v218,v158,v174
v_mfma_f32_16x16x32_bf16 v[36:39],a[124:127],v[124:127],v[36:39]
s_waitcnt lgkmcnt(5)
buffer_load_dwordx4 v[132:135],v0,s[20:23],s84 offen offset:1024 sc1
v_fma_f32 v175,v219,v159,v175
v_mfma_f32_16x16x32_bf16 v[32:35],a[128:131],v[64:67],v[32:35]
ds_read_b128 v[88:91],v6 offset:6144
buffer_load_dwordx4 v[160:163],v18,s[24:27],s82 offen
v_mfma_f32_16x16x32_bf16 v[36:39],a[132:135],v[64:67],v[36:39]
s_waitcnt lgkmcnt(5)
s_add_u32 s82,s82,32768
buffer_load_dwordx4 v[136:139],v0,s[20:23],s84 offen offset:2048 sc1
v_mfma_f32_16x16x32_bf16 v[32:35],a[136:139],v[68:71],v[32:35]
ds_read_b128 v[92:95],v6 offset:7168
v_mfma_f32_16x16x32_bf16 v[36:39],a[140:143],v[68:71],v[36:39]
s_waitcnt lgkmcnt(5)
buffer_load_dwordx4 v[140:143],v0,s[20:23],s84 offen offset:3072 sc1
v_mfma_f32_16x16x32_bf16 v[32:35],a[144:147],v[72:75],v[32:35]
ds_read_b128 v[96:99],v7 offset:0
v_mfma_f32_16x16x32_bf16 v[36:39],a[148:151],v[72:75],v[36:39]
s_waitcnt lgkmcnt(5)
buffer_load_dwordx4 v[144:147],v0,s[20:23],s85 offen offset:0 sc1
v_mfma_f32_16x16x32_bf16 v[32:35],a[152:155],v[76:79],v[32:35]
ds_read_b128 v[100:103],v7 offset:1024
v_mfma_f32_16x16x32_bf16 v[36:39],a[156:159],v[76:79],v[36:39]
s_waitcnt lgkmcnt(5)
buffer_load_dwordx4 v[148:151],v0,s[20:23],s85 offen offset:1024 sc1
v_mfma_f32_16x16x32_bf16 v[32:35],a[160:163],v[80:83],v[32:35]
ds_read_b128 v[104:107],v7 offset:2048
v_mfma_f32_16x16x32_bf16 v[36:39],a[164:167],v[80:83],v[36:39]
s_waitcnt lgkmcnt(5)
v_mfma_f32_16x16x32_bf16 v[32:35],a[168:171],v[84:87],v[32:35]
ds_read_b128 v[108:111],v7 offset:3072
v_mfma_f32_16x16x32_bf16 v[36:39],a[172:175],v[84:87],v[36:39]
s_waitcnt lgkmcnt(5)
v_mfma_f32_16x16x32_bf16 v[32:35],a[176:179],v[88:91],v[32:35]
ds_read_b128 v[112:115],v7 offset:4096
v_mfma_f32_16x16x32_bf16 v[36:39],a[180:183],v[88:91],v[36:39]
s_waitcnt lgkmcnt(5)
v_mfma_f32_16x16x32_bf16 v[32:35],a[184:187],v[92:95],v[32:35]
ds_read_b128 v[116:119],v7 offset:5120
v_mfma_f32_16x16x32_bf16 v[36:39],a[188:191],v[92:95],v[36:39]
s_waitcnt lgkmcnt(5)
v_mfma_f32_16x16x32_bf16 v[32:35],a[192:195],v[96:99],v[32:35]
ds_read_b128 v[120:123],v7 offset:6144
v_mfma_f32_16x16x32_bf16 v[36:39],a[196:199],v[96:99],v[36:39]
s_waitcnt lgkmcnt(5)
v_mfma_f32_16x16x32_bf16 v[32:35],a[200:203],v[100:103],v[32:35]
ds_read_b128 v[124:127],v7 offset:7168
v_mfma_f32_16x16x32_bf16 v[36:39],a[204:207],v[100:103],v[36:39]
s_waitcnt lgkmcnt(5)
s_add_u32 s61,s61,131072
s_add_u32 s62,s62,131072
v_mfma_f32_16x16x32_bf16 v[32:35],a[208:211],v[104:107],v[32:35]
s_add_u32 s70,s70,32768
s_and_b32 s70,s70,0x1ffff
s_add_u32 s55,s55,32768
v_mfma_f32_16x16x32_bf16 v[36:39],a[212:215],v[104:107],v[36:39]
s_waitcnt lgkmcnt(4)
s_and_b32 s55,s55,0x1ffff
v_add_u32 v4,s55,v8
v_mfma_f32_16x16x32_bf16 v[32:35],a[216:219],v[108:111],v[32:35]
v_add_u32 v5,s55,v9
v_add_u32 v6,s55,v10
v_mfma_f32_16x16x32_bf16 v[36:39],a[220:223],v[108:111],v[36:39]
s_waitcnt lgkmcnt(3)
v_add_u32 v7,s55,v11
v_mfma_f32_16x16x32_bf16 v[32:35],a[224:227],v[112:115],v[32:35]
s_waitcnt vmcnt(15)
ds_read_b128 v[64:67],v4 offset:0
v_mfma_f32_16x16x32_bf16 v[36:39],a[228:231],v[112:115],v[36:39]
s_waitcnt lgkmcnt(3)
s_waitcnt vmcnt(14)
ds_read_b128 v[68:71],v4 offset:1024
v_mfma_f32_16x16x32_bf16 v[32:35],a[232:235],v[116:119],v[32:35]
s_waitcnt vmcnt(0)
s_cmp_eq_u32 s77,0
s_cbranch_scc1 go_140
ck_138:
v_max3_u32 v184,v128,v129,v130
v_max3_u32 v185,v140,v141,v142
v_max3_u32 v184,v184,v131,v132
v_max3_u32 v185,v185,v143,v144
v_max3_u32 v184,v184,v133,v134
v_max3_u32 v185,v185,v145,v146
v_max3_u32 v184,v184,v135,v136
v_max3_u32 v185,v185,v147,v148
v_max3_u32 v184,v184,v137,v138
v_max3_u32 v185,v185,v149,v150
v_max3_u32 v184,v184,v139,v151
v_max_u32 v184,v184,v185
v_cmp_eq_u32 vcc,-1,v184
s_cbranch_vccnz rt_139
go_140:
v_mfma_f32_16x16x32_bf16 v[36:39],a[236:239],v[116:119],v[36:39]
s_waitcnt lgkmcnt(3)
ds_read_b128 v[72:75],v4 offset:2048
v_add_f32 v128,v128,v136
v_mfma_f32_16x16x32_bf16 v[32:35],a[240:243],v[120:123],v[32:35]
v_add_f32 v129,v129,v137
v_add_f32 v130,v130,v138
v_add_f32 v131,v131,v139
v_mfma_f32_16x16x32_bf16 v[36:39],a[244:247],v[120:123],v[36:39]
s_waitcnt lgkmcnt(3)
v_add_f32 v132,v132,v140
v_add_f32 v133,v133,v141
v_add_f32 v134,v134,v142
v_mfma_f32_16x16x32_bf16 v[40:43],a[248:251],v[124:127],v[32:35]
v_add_f32 v135,v135,v143
v_add_f32 v128,v128,v144
v_add_f32 v129,v129,v145
v_mfma_f32_16x16x32_bf16 v[44:47],a[252:255],v[124:127],v[36:39]
v_add_f32 v130,v130,v146
v_add_f32 v131,v131,v147
v_add_f32 v132,v132,v148
v_add_f32 v133,v133,v149
v_add_f32 v134,v134,v150
v_add_f32 v135,v135,v151
v_fma_f32 v168,v128,v152,v168
v_fma_f32 v169,v129,v153,v169
v_fma_f32 v170,v130,v154,v170
v_fma_f32 v171,v131,v155,v171
v_fma_f32 v172,v132,v156,v172
v_fma_f32 v173,v133,v157,v173
v_fma_f32 v174,v134,v158,v174
v_fma_f32 v175,v135,v159,v175
v_cvt_pk_bf16_f32 v176,v168,v169
v_cvt_pk_bf16_f32 v177,v170,v171
v_cvt_pk_bf16_f32 v178,v172,v173
v_cvt_pk_bf16_f32 v179,v174,v175
s_add_u32 s64,s66,201326592
buffer_store_dwordx4 v[176:179],v21,s[20:23],s64 offen sc1
s_add_u32 s79,s66,201392128
s_cmp_ge_u32 s63,126
s_cselect_b32 s79,138641408,s79
buffer_store_dwordx4 v[204:207],v21,s[20:23],s79 offen sc1
s_cmp_eq_u32 s56,1
s_cbranch_scc1 b1_132
buffer_store_dwordx4 v[204:207],v21,s[20:23],s84 offen offset:0
buffer_store_dwordx4 v[204:207],v21,s[20:23],s84 offen offset:1024
b2_133:
s_cmp_eq_u32 s56,1
s_cbranch_scc1 b1_134
buffer_store_dwordx4 v[204:207],v21,s[20:23],s84 offen offset:2048
buffer_store_dwordx4 v[204:207],v21,s[20:23],s84 offen offset:3072
b2_135:
s_cmp_eq_u32 s56,1
s_cbranch_scc1 b1_136
buffer_store_dwordx4 v[204:207],v21,s[20:23],s85 offen offset:0
buffer_store_dwordx4 v[204:207],v21,s[20:23],s85 offen offset:1024
b2_137:
s_mul_i32 s64,s77,32768
s_add_u32 s66,s66,s64
s_mul_i32 s64,s77,6144
s_add_u32 s75,s75,s64
s_cmp_eq_u32 s75,24576
s_cselect_b32 s75,0,s75
s_add_u32 s63,s63,s77
s_mov_b32 s77,0
v_cmp_gt_u32 vcc,s53,v16
s_add_u32 s60,s60,1
s_cbranch_vccz WR_114
WN_115:
s_waitcnt lgkmcnt(2)
v_mfma_f32_16x16x32_bf16 v[32:35],a[0:3],v[64:67],0
s_waitcnt vmcnt(20)
s_add_u32 s71,s60,2
ds_read_b128 v[76:79],v4 offset:3072
v_mfma_f32_16x16x32_bf16 v[36:39],a[4:7],v[64:67],0
s_waitcnt lgkmcnt(2)
s_add_u32 s53,s60,3
v_mfma_f32_16x16x32_bf16 v[32:35],a[8:11],v[68:71],v[32:35]
s_waitcnt vmcnt(19)
ds_read_b128 v[80:83],v4 offset:4096
v_mov_b32 v212,v40
v_mfma_f32_16x16x32_bf16 v[36:39],a[12:15],v[68:71],v[36:39]
s_waitcnt lgkmcnt(2)
v_mov_b32 v213,v41
v_mov_b32 v214,v42
v_mfma_f32_16x16x32_bf16 v[32:35],a[16:19],v[72:75],v[32:35]
s_waitcnt vmcnt(18)
ds_read_b128 v[84:87],v4 offset:5120
v_mov_b32 v215,v43
v_mfma_f32_16x16x32_bf16 v[36:39],a[20:23],v[72:75],v[36:39]
s_waitcnt lgkmcnt(2)
v_mov_b32 v216,v44
v_mov_b32 v217,v45
v_mfma_f32_16x16x32_bf16 v[32:35],a[24:27],v[76:79],v[32:35]
s_waitcnt vmcnt(17)
ds_read_b128 v[88:91],v4 offset:6144
v_mov_b32 v218,v46
v_mfma_f32_16x16x32_bf16 v[36:39],a[28:31],v[76:79],v[36:39]
s_waitcnt lgkmcnt(2)
v_mov_b32 v219,v47
v_mfma_f32_16x16x32_bf16 v[32:35],a[32:35],v[80:83],v[32:35]
s_waitcnt vmcnt(15)
s_mov_b32 s77,1
ds_read_b128 v[92:95],v4 offset:7168
v_mfma_f32_16x16x32_bf16 v[36:39],a[36:39],v[80:83],v[36:39]
s_waitcnt lgkmcnt(2)
s_barrier
ds_read_b128 v[96:99],v5 offset:0
v_mfma_f32_16x16x32_bf16 v[32:35],a[40:43],v[84:87],v[32:35]
ds_read_b128 v[100:103],v5 offset:1024
v_mfma_f32_16x16x32_bf16 v[36:39],a[44:47],v[84:87],v[36:39]
s_waitcnt lgkmcnt(3)
ds_read_b128 v[104:107],v5 offset:2048
v_mfma_f32_16x16x32_bf16 v[32:35],a[48:51],v[88:91],v[32:35]
ds_read_b128 v[108:111],v5 offset:3072
v_mfma_f32_16x16x32_bf16 v[36:39],a[52:55],v[88:91],v[36:39]
s_waitcnt lgkmcnt(4)
ds_read_b128 v[112:115],v5 offset:4096
v_mfma_f32_16x16x32_bf16 v[32:35],a[56:59],v[92:95],v[32:35]
s_waitcnt vmcnt(12)
s_cmp_eq_u32 s77,0
s_cselect_b32 s57,2.0,0
ds_read_b128 v[116:119],v5 offset:5120
v_mfma_f32_16x16x32_bf16 v[36:39],a[60:63],v[92:95],v[36:39]
s_waitcnt lgkmcnt(5)
v_or_b32 v21,s57,v0
v_lshlrev_b32 v168,16,v160
v_mfma_f32_16x16x32_bf16 v[32:35],a[64:67],v[96:99],v[32:35]
ds_read_b128 v[120:123],v5 offset:6144
v_and_b32 v169,s73,v160
v_mfma_f32_16x16x32_bf16 v[36:39],a[68:71],v[96:99],v[36:39]
s_waitcnt lgkmcnt(5)
v_lshlrev_b32 v170,16,v161
v_and_b32 v171,s73,v161
v_mfma_f32_16x16x32_bf16 v[32:35],a[72:75],v[100:103],v[32:35]
ds_read_b128 v[124:127],v5 offset:7168
v_lshlrev_b32 v172,16,v162
v_mfma_f32_16x16x32_bf16 v[36:39],a[76:79],v[100:103],v[36:39]
s_waitcnt lgkmcnt(5)
v_and_b32 v173,s73,v162
v_lshlrev_b32 v174,16,v163
v_mfma_f32_16x16x32_bf16 v[32:35],a[80:83],v[104:107],v[32:35]
ds_read_b128 v[64:67],v6 offset:0
v_and_b32 v175,s73,v163
v_mfma_f32_16x16x32_bf16 v[36:39],a[84:87],v[104:107],v[36:39]
s_waitcnt lgkmcnt(5)
v_fma_f32 v168,v212,v152,v168
v_fma_f32 v169,v213,v153,v169
v_mfma_f32_16x16x32_bf16 v[32:35],a[88:91],v[108:111],v[32:35]
ds_read_b128 v[68:71],v6 offset:1024
v_fma_f32 v170,v214,v154,v170
v_mfma_f32_16x16x32_bf16 v[36:39],a[92:95],v[108:111],v[36:39]
s_waitcnt lgkmcnt(5)
v_fma_f32 v171,v215,v155,v171
v_fma_f32 v172,v216,v156,v172
v_mfma_f32_16x16x32_bf16 v[32:35],a[96:99],v[112:115],v[32:35]
ds_read_b128 v[72:75],v6 offset:2048
v_fma_f32 v173,v217,v157,v173
v_mfma_f32_16x16x32_bf16 v[36:39],a[100:103],v[112:115],v[36:39]
s_waitcnt lgkmcnt(5)
v_fma_f32 v174,v218,v158,v174
v_fma_f32 v175,v219,v159,v175
v_mfma_f32_16x16x32_bf16 v[32:35],a[104:107],v[116:119],v[32:35]
ds_read_b128 v[76:79],v6 offset:3072
v_mfma_f32_16x16x32_bf16 v[36:39],a[108:111],v[116:119],v[36:39]
s_waitcnt lgkmcnt(5)
buffer_load_dwordx4 v[160:163],v18,s[24:27],s82 offen
v_mfma_f32_16x16x32_bf16 v[32:35],a[112:115],v[120:123],v[32:35]
s_add_u32 s84,s74,s75
s_add_u32 s85,s84,4096
ds_read_b128 v[80:83],v6 offset:4096
v_mfma_f32_16x16x32_bf16 v[36:39],a[116:119],v[120:123],v[36:39]
s_waitcnt lgkmcnt(5)
s_add_u32 s82,s82,32768
buffer_load_dwordx4 v[128:131],v0,s[20:23],s84 offen offset:0 sc1
v_mfma_f32_16x16x32_bf16 v[32:35],a[120:123],v[124:127],v[32:35]
ds_read_b128 v[84:87],v6 offset:5120
v_mfma_f32_16x16x32_bf16 v[36:39],a[124:127],v[124:127],v[36:39]
s_waitcnt lgkmcnt(5)
buffer_load_dwordx4 v[132:135],v0,s[20:23],s84 offen offset:1024 sc1
v_mfma_f32_16x16x32_bf16 v[32:35],a[128:131],v[64:67],v[32:35]
ds_read_b128 v[88:91],v6 offset:6144
v_mfma_f32_16x16x32_bf16 v[36:39],a[132:135],v[64:67],v[36:39]
s_waitcnt lgkmcnt(5)
buffer_load_dwordx4 v[136:139],v0,s[20:23],s84 offen offset:2048 sc1
v_mfma_f32_16x16x32_bf16 v[32:35],a[136:139],v[68:71],v[32:35]
ds_read_b128 v[92:95],v6 offset:7168
v_mfma_f32_16x16x32_bf16 v[36:39],a[140:143],v[68:71],v[36:39]
s_waitcnt lgkmcnt(5)
buffer_load_dwordx4 v[140:143],v0,s[20:23],s84 offen offset:3072 sc1
v_mfma_f32_16x16x32_bf16 v[32:35],a[144:147],v[72:75],v[32:35]
ds_read_b128 v[96:99],v7 offset:0
v_mfma_f32_16x16x32_bf16 v[36:39],a[148:151],v[72:75],v[36:39]
s_waitcnt lgkmcnt(5)
buffer_load_dwordx4 v[144:147],v0,s[20:23],s85 offen offset:0 sc1
v_mfma_f32_16x16x32_bf16 v[32:35],a[152:155],v[76:79],v[32:35]
ds_read_b128 v[100:103],v7 offset:1024
v_mfma_f32_16x16x32_bf16 v[36:39],a[156:159],v[76:79],v[36:39]
s_waitcnt lgkmcnt(5)
buffer_load_dwordx4 v[148:151],v0,s[20:23],s85 offen offset:1024 sc1
v_mfma_f32_16x16x32_bf16 v[32:35],a[160:163],v[80:83],v[32:35]
ds_read_b128 v[104:107],v7 offset:2048
buffer_load_dword v16,v2,s[20:23],s68 offen sc1
v_mfma_f32_16x16x32_bf16 v[36:39],a[164:167],v[80:83],v[36:39]
s_waitcnt lgkmcnt(5)
v_mfma_f32_16x16x32_bf16 v[32:35],a[168:171],v[84:87],v[32:35]
ds_read_b128 v[108:111],v7 offset:3072
v_mfma_f32_16x16x32_bf16 v[36:39],a[172:175],v[84:87],v[36:39]
s_waitcnt lgkmcnt(5)
v_mfma_f32_16x16x32_bf16 v[32:35],a[176:179],v[88:91],v[32:35]
ds_read_b128 v[112:115],v7 offset:4096
v_mfma_f32_16x16x32_bf16 v[36:39],a[180:183],v[88:91],v[36:39]
s_waitcnt lgkmcnt(5)
v_mfma_f32_16x16x32_bf16 v[32:35],a[184:187],v[92:95],v[32:35]
ds_read_b128 v[116:119],v7 offset:5120
v_mfma_f32_16x16x32_bf16 v[36:39],a[188:191],v[92:95],v[36:39]
s_waitcnt lgkmcnt(5)
v_mfma_f32_16x16x32_bf16 v[32:35],a[192:195],v[96:99],v[32:35]
ds_read_b128 v[120:123],v7 offset:6144
v_mfma_f32_16x16x32_bf16 v[36:39],a[196:199],v[96:99],v[36:39]
s_waitcnt lgkmcnt(5)
v_mfma_f32_16x16x32_bf16 v[32:35],a[200:203],v[100:103],v[32:35]
s_waitcnt vmcnt(1)
ds_read_b128 v[124:127],v7 offset:7168
s_cmp_eq_u32 s77,0
s_cbranch_scc1 go_150
ck_148:
v_max3_u32 v184,v128,v129,v130
v_max3_u32 v185,v140,v141,v142
v_max3_u32 v184,v184,v131,v132
v_max3_u32 v185,v185,v143,v144
v_max3_u32 v184,v184,v133,v134
v_max3_u32 v185,v185,v145,v146
v_max3_u32 v184,v184,v135,v136
v_max3_u32 v185,v185,v147,v148
v_max3_u32 v184,v184,v137,v138
v_max3_u32 v185,v185,v149,v150
v_max3_u32 v184,v184,v139,v151
v_max_u32 v184,v184,v185
v_cmp_eq_u32 vcc,-1,v184
s_cbranch_vccnz rt_149
go_150:
v_mfma_f32_16x16x32_bf16 v[36:39],a[204:207],v[100:103],v[36:39]
s_waitcnt lgkmcnt(5)
s_add_u32 s55,s55,32768
s_and_b32 s55,s55,0x1ffff
v_add_f32 v128,v128,v136
v_mfma_f32_16x16x32_bf16 v[32:35],a[208:211],v[104:107],v[32:35]
v_add_u32 v4,s55,v8
v_add_u32 v5,s55,v9
v_add_f32 v129,v129,v137
v_mfma_f32_16x16x32_bf16 v[36:39],a[212:215],v[104:107],v[36:39]
s_waitcnt lgkmcnt(4)
v_add_u32 v6,s55,v10
v_add_u32 v7,s55,v11
v_add_f32 v130,v130,v138
v_mfma_f32_16x16x32_bf16 v[32:35],a[216:219],v[108:111],v[32:35]
v_add_f32 v131,v131,v139
v_add_f32 v132,v132,v140
v_add_f32 v133,v133,v141
v_mfma_f32_16x16x32_bf16 v[36:39],a[220:223],v[108:111],v[36:39]
s_waitcnt lgkmcnt(3)
v_add_f32 v134,v134,v142
v_add_f32 v135,v135,v143
v_add_f32 v128,v128,v144
v_mfma_f32_16x16x32_bf16 v[32:35],a[224:227],v[112:115],v[32:35]
v_add_f32 v129,v129,v145
v_add_f32 v130,v130,v146
v_add_f32 v131,v131,v147
v_mfma_f32_16x16x32_bf16 v[36:39],a[228:231],v[112:115],v[36:39]
s_waitcnt lgkmcnt(2)
v_add_f32 v132,v132,v148
v_add_f32 v133,v133,v149
v_add_f32 v134,v134,v150
v_mfma_f32_16x16x32_bf16 v[32:35],a[232:235],v[116:119],v[32:35]
v_add_f32 v135,v135,v151
v_fma_f32 v168,v128,v152,v168
v_fma_f32 v169,v129,v153,v169
v_mfma_f32_16x16x32_bf16 v[36:39],a[236:239],v[116:119],v[36:39]
s_waitcnt lgkmcnt(1)
v_fma_f32 v170,v130,v154,v170
v_fma_f32 v171,v131,v155,v171
v_fma_f32 v172,v132,v156,v172
v_mfma_f32_16x16x32_bf16 v[32:35],a[240:243],v[120:123],v[32:35]
v_fma_f32 v173,v133,v157,v173
v_fma_f32 v174,v134,v158,v174
v_fma_f32 v175,v135,v159,v175
v_mfma_f32_16x16x32_bf16 v[36:39],a[244:247],v[120:123],v[36:39]
s_waitcnt lgkmcnt(0)
v_cvt_pk_bf16_f32 v176,v168,v169
v_cvt_pk_bf16_f32 v177,v170,v171
v_cvt_pk_bf16_f32 v178,v172,v173
v_mfma_f32_16x16x32_bf16 v[40:43],a[248:251],v[124:127],v[32:35]
v_cvt_pk_bf16_f32 v179,v174,v175
v_mfma_f32_16x16x32_bf16 v[44:47],a[252:255],v[124:127],v[36:39]
s_waitcnt vmcnt(0)
s_add_u32 s64,s66,201326592
buffer_store_dwordx4 v[176:179],v21,s[20:23],s64 offen sc1
s_add_u32 s79,s66,201392128
s_cmp_ge_u32 s63,126
s_cselect_b32 s79,138641408,s79
buffer_store_dwordx4 v[204:207],v21,s[20:23],s79 offen sc1
s_cmp_eq_u32 s56,1
s_cbranch_scc1 b1_142
buffer_store_dwordx4 v[204:207],v21,s[20:23],s84 offen offset:0
buffer_store_dwordx4 v[204:207],v21,s[20:23],s84 offen offset:1024
b2_143:
s_cmp_eq_u32 s56,1
s_cbranch_scc1 b1_144
buffer_store_dwordx4 v[204:207],v21,s[20:23],s84 offen offset:2048
buffer_store_dwordx4 v[204:207],v21,s[20:23],s84 offen offset:3072
b2_145:
s_cmp_eq_u32 s56,1
s_cbranch_scc1 b1_146
buffer_store_dwordx4 v[204:207],v21,s[20:23],s85 offen offset:0
buffer_store_dwordx4 v[204:207],v21,s[20:23],s85 offen offset:1024
b2_147:
s_mul_i32 s64,s77,32768
s_add_u32 s66,s66,s64
s_mul_i32 s64,s77,6144
s_add_u32 s75,s75,s64
s_cmp_eq_u32 s75,24576
s_cselect_b32 s75,0,s75
s_add_u32 s63,s63,s77
s_mov_b32 s77,0
v_cmp_gt_u32 vcc,s71,v16
s_add_u32 s60,s60,1
s_branch endN_141
BN_117:
s_waitcnt vmcnt(7)
ds_read_b128 v[64:67],v4 offset:0
s_waitcnt vmcnt(6)
ds_read_b128 v[68:71],v4 offset:1024
s_waitcnt vmcnt(5)
ds_read_b128 v[72:75],v4 offset:2048
s_waitcnt vmcnt(4)
ds_read_b128 v[76:79],v4 offset:3072
s_waitcnt lgkmcnt(3)
v_mfma_f32_16x16x32_bf16 v[32:35],a[0:3],v[64:67],0
s_add_u32 s71,s60,2
s_add_u32 s53,s60,3
v_mfma_f32_16x16x32_bf16 v[36:39],a[4:7],v[64:67],0
s_waitcnt lgkmcnt(2)
s_waitcnt vmcnt(3)
ds_read_b128 v[80:83],v4 offset:4096
v_mfma_f32_16x16x32_bf16 v[32:35],a[8:11],v[68:71],v[32:35]
v_mfma_f32_16x16x32_bf16 v[36:39],a[12:15],v[68:71],v[36:39]
s_waitcnt lgkmcnt(2)
s_waitcnt vmcnt(2)
ds_read_b128 v[84:87],v4 offset:5120
v_mfma_f32_16x16x32_bf16 v[32:35],a[16:19],v[72:75],v[32:35]
v_mfma_f32_16x16x32_bf16 v[36:39],a[20:23],v[72:75],v[36:39]
s_waitcnt lgkmcnt(2)
s_waitcnt vmcnt(1)
ds_read_b128 v[88:91],v4 offset:6144
v_mfma_f32_16x16x32_bf16 v[32:35],a[24:27],v[76:79],v[32:35]
v_mfma_f32_16x16x32_bf16 v[36:39],a[28:31],v[76:79],v[36:39]
s_waitcnt lgkmcnt(2)
s_waitcnt vmcnt(0)
ds_read_b128 v[92:95],v4 offset:7168
v_mfma_f32_16x16x32_bf16 v[32:35],a[32:35],v[80:83],v[32:35]
v_mfma_f32_16x16x32_bf16 v[36:39],a[36:39],v[80:83],v[36:39]
s_waitcnt lgkmcnt(2)
s_barrier
ds_read_b128 v[96:99],v5 offset:0
v_mfma_f32_16x16x32_bf16 v[32:35],a[40:43],v[84:87],v[32:35]
ds_read_b128 v[100:103],v5 offset:1024
v_mfma_f32_16x16x32_bf16 v[36:39],a[44:47],v[84:87],v[36:39]
s_waitcnt lgkmcnt(3)
ds_read_b128 v[104:107],v5 offset:2048
v_mfma_f32_16x16x32_bf16 v[32:35],a[48:51],v[88:91],v[32:35]
ds_read_b128 v[108:111],v5 offset:3072
v_mfma_f32_16x16x32_bf16 v[36:39],a[52:55],v[88:91],v[36:39]
s_waitcnt lgkmcnt(4)
ds_read_b128 v[112:115],v5 offset:4096
v_mfma_f32_16x16x32_bf16 v[32:35],a[56:59],v[92:95],v[32:35]
s_cmp_eq_u32 s77,0
s_cselect_b32 s57,2.0,0
ds_read_b128 v[116:119],v5 offset:5120
v_mfma_f32_16x16x32_bf16 v[36:39],a[60:63],v[92:95],v[36:39]
s_waitcnt lgkmcnt(5)
v_or_b32 v21,s57,v0
v_lshlrev_b32 v168,16,v160
v_mfma_f32_16x16x32_bf16 v[32:35],a[64:67],v[96:99],v[32:35]
ds_read_b128 v[120:123],v5 offset:6144
v_and_b32 v169,s73,v160
v_mfma_f32_16x16x32_bf16 v[36:39],a[68:71],v[96:99],v[36:39]
s_waitcnt lgkmcnt(5)
v_lshlrev_b32 v170,16,v161
v_and_b32 v171,s73,v161
v_mfma_f32_16x16x32_bf16 v[32:35],a[72:75],v[100:103],v[32:35]
ds_read_b128 v[124:127],v5 offset:7168
v_lshlrev_b32 v172,16,v162
v_mfma_f32_16x16x32_bf16 v[36:39],a[76:79],v[100:103],v[36:39]
s_waitcnt lgkmcnt(5)
v_and_b32 v173,s73,v162
v_lshlrev_b32 v174,16,v163
v_mfma_f32_16x16x32_bf16 v[32:35],a[80:83],v[104:107],v[32:35]
ds_read_b128 v[64:67],v6 offset:0
v_and_b32 v175,s73,v163
v_mfma_f32_16x16x32_bf16 v[36:39],a[84:87],v[104:107],v[36:39]
s_waitcnt lgkmcnt(5)
v_fma_f32 v168,v212,v152,v168
v_fma_f32 v169,v213,v153,v169
v_mfma_f32_16x16x32_bf16 v[32:35],a[88:91],v[108:111],v[32:35]
ds_read_b128 v[68:71],v6 offset:1024
v_fma_f32 v170,v214,v154,v170
v_mfma_f32_16x16x32_bf16 v[36:39],a[92:95],v[108:111],v[36:39]
s_waitcnt lgkmcnt(5)
v_fma_f32 v171,v215,v155,v171
v_fma_f32 v172,v216,v156,v172
v_mfma_f32_16x16x32_bf16 v[32:35],a[96:99],v[112:115],v[32:35]
ds_read_b128 v[72:75],v6 offset:2048
v_fma_f32 v173,v217,v157,v173
v_mfma_f32_16x16x32_bf16 v[36:39],a[100:103],v[112:115],v[36:39]
s_waitcnt lgkmcnt(5)
v_fma_f32 v174,v218,v158,v174
v_fma_f32 v175,v219,v159,v175
v_mfma_f32_16x16x32_bf16 v[32:35],a[104:107],v[116:119],v[32:35]
ds_read_b128 v[76:79],v6 offset:3072
v_mfma_f32_16x16x32_bf16 v[36:39],a[108:111],v[116:119],v[36:39]
s_waitcnt lgkmcnt(5)
buffer_load_dwordx4 v[160:163],v18,s[24:27],s82 offen
v_mfma_f32_16x16x32_bf16 v[32:35],a[112:115],v[120:123],v[32:35]
s_add_u32 s84,s74,s75
s_add_u32 s85,s84,4096
ds_read_b128 v[80:83],v6 offset:4096
v_mfma_f32_16x16x32_bf16 v[36:39],a[116:119],v[120:123],v[36:39]
s_waitcnt lgkmcnt(5)
s_add_u32 s82,s82,32768
buffer_load_dwordx4 v[128:131],v0,s[20:23],s84 offen offset:0 sc1
v_mfma_f32_16x16x32_bf16 v[32:35],a[120:123],v[124:127],v[32:35]
ds_read_b128 v[84:87],v6 offset:5120
v_mfma_f32_16x16x32_bf16 v[36:39],a[124:127],v[124:127],v[36:39]
s_waitcnt lgkmcnt(5)
buffer_load_dwordx4 v[132:135],v0,s[20:23],s84 offen offset:1024 sc1
v_mfma_f32_16x16x32_bf16 v[32:35],a[128:131],v[64:67],v[32:35]
ds_read_b128 v[88:91],v6 offset:6144
v_mfma_f32_16x16x32_bf16 v[36:39],a[132:135],v[64:67],v[36:39]
s_waitcnt lgkmcnt(5)
buffer_load_dwordx4 v[136:139],v0,s[20:23],s84 offen offset:2048 sc1
v_mfma_f32_16x16x32_bf16 v[32:35],a[136:139],v[68:71],v[32:35]
ds_read_b128 v[92:95],v6 offset:7168
v_mfma_f32_16x16x32_bf16 v[36:39],a[140:143],v[68:71],v[36:39]
s_waitcnt lgkmcnt(5)
buffer_load_dwordx4 v[140:143],v0,s[20:23],s84 offen offset:3072 sc1
v_mfma_f32_16x16x32_bf16 v[32:35],a[144:147],v[72:75],v[32:35]
ds_read_b128 v[96:99],v7 offset:0
v_mfma_f32_16x16x32_bf16 v[36:39],a[148:151],v[72:75],v[36:39]
s_waitcnt lgkmcnt(5)
buffer_load_dwordx4 v[144:147],v0,s[20:23],s85 offen offset:0 sc1
v_mfma_f32_16x16x32_bf16 v[32:35],a[152:155],v[76:79],v[32:35]
ds_read_b128 v[100:103],v7 offset:1024
v_mfma_f32_16x16x32_bf16 v[36:39],a[156:159],v[76:79],v[36:39]
s_waitcnt lgkmcnt(5)
buffer_load_dwordx4 v[148:151],v0,s[20:23],s85 offen offset:1024 sc1
v_mfma_f32_16x16x32_bf16 v[32:35],a[160:163],v[80:83],v[32:35]
ds_read_b128 v[104:107],v7 offset:2048
buffer_load_dword v16,v2,s[20:23],s68 offen sc1
v_mfma_f32_16x16x32_bf16 v[36:39],a[164:167],v[80:83],v[36:39]
s_waitcnt lgkmcnt(5)
v_mfma_f32_16x16x32_bf16 v[32:35],a[168:171],v[84:87],v[32:35]
ds_read_b128 v[108:111],v7 offset:3072
v_mfma_f32_16x16x32_bf16 v[36:39],a[172:175],v[84:87],v[36:39]
s_waitcnt lgkmcnt(5)
v_mfma_f32_16x16x32_bf16 v[32:35],a[176:179],v[88:91],v[32:35]
ds_read_b128 v[112:115],v7 offset:4096
v_mfma_f32_16x16x32_bf16 v[36:39],a[180:183],v[88:91],v[36:39]
s_waitcnt lgkmcnt(5)
v_mfma_f32_16x16x32_bf16 v[32:35],a[184:187],v[92:95],v[32:35]
ds_read_b128 v[116:119],v7 offset:5120
v_mfma_f32_16x16x32_bf16 v[36:39],a[188:191],v[92:95],v[36:39]
s_waitcnt lgkmcnt(5)
v_mfma_f32_16x16x32_bf16 v[32:35],a[192:195],v[96:99],v[32:35]
ds_read_b128 v[120:123],v7 offset:6144
v_mfma_f32_16x16x32_bf16 v[36:39],a[196:199],v[96:99],v[36:39]
s_waitcnt lgkmcnt(5)
v_mfma_f32_16x16x32_bf16 v[32:35],a[200:203],v[100:103],v[32:35]
s_waitcnt vmcnt(1)
ds_read_b128 v[124:127],v7 offset:7168
s_cmp_eq_u32 s77,0
s_cbranch_scc1 go_159
ck_157:
v_max3_u32 v184,v128,v129,v130
v_max3_u32 v185,v140,v141,v142
v_max3_u32 v184,v184,v131,v132
v_max3_u32 v185,v185,v143,v144
v_max3_u32 v184,v184,v133,v134
v_max3_u32 v185,v185,v145,v146
v_max3_u32 v184,v184,v135,v136
v_max3_u32 v185,v185,v147,v148
v_max3_u32 v184,v184,v137,v138
v_max3_u32 v185,v185,v149,v150
v_max3_u32 v184,v184,v139,v151
v_max_u32 v184,v184,v185
v_cmp_eq_u32 vcc,-1,v184
s_cbranch_vccnz rt_158
go_159:
v_mfma_f32_16x16x32_bf16 v[36:39],a[204:207],v[100:103],v[36:39]
s_waitcnt lgkmcnt(5)
s_add_u32 s55,s55,32768
s_and_b32 s55,s55,0x1ffff
v_add_f32 v128,v128,v136
v_mfma_f32_16x16x32_bf16 v[32:35],a[208:211],v[104:107],v[32:35]
v_add_u32 v4,s55,v8
v_add_u32 v5,s55,v9
v_add_f32 v129,v129,v137
v_mfma_f32_16x16x32_bf16 v[36:39],a[212:215],v[104:107],v[36:39]
s_waitcnt lgkmcnt(4)
v_add_u32 v6,s55,v10
v_add_u32 v7,s55,v11
v_add_f32 v130,v130,v138
v_mfma_f32_16x16x32_bf16 v[32:35],a[216:219],v[108:111],v[32:35]
v_add_f32 v131,v131,v139
v_add_f32 v132,v132,v140
v_add_f32 v133,v133,v141
v_mfma_f32_16x16x32_bf16 v[36:39],a[220:223],v[108:111],v[36:39]
s_waitcnt lgkmcnt(3)
v_add_f32 v134,v134,v142
v_add_f32 v135,v135,v143
v_add_f32 v128,v128,v144
v_mfma_f32_16x16x32_bf16 v[32:35],a[224:227],v[112:115],v[32:35]
v_add_f32 v129,v129,v145
v_add_f32 v130,v130,v146
v_add_f32 v131,v131,v147
v_mfma_f32_16x16x32_bf16 v[36:39],a[228:231],v[112:115],v[36:39]
s_waitcnt lgkmcnt(2)
v_add_f32 v132,v132,v148
v_add_f32 v133,v133,v149
v_add_f32 v134,v134,v150
v_mfma_f32_16x16x32_bf16 v[32:35],a[232:235],v[116:119],v[32:35]
v_add_f32 v135,v135,v151
v_fma_f32 v168,v128,v152,v168
v_fma_f32 v169,v129,v153,v169
v_mfma_f32_16x16x32_bf16 v[36:39],a[236:239],v[116:119],v[36:39]
s_waitcnt lgkmcnt(1)
v_fma_f32 v170,v130,v154,v170
v_fma_f32 v171,v131,v155,v171
v_fma_f32 v172,v132,v156,v172
v_mfma_f32_16x16x32_bf16 v[32:35],a[240:243],v[120:123],v[32:35]
v_fma_f32 v173,v133,v157,v173
v_fma_f32 v174,v134,v158,v174
v_fma_f32 v175,v135,v159,v175
v_mfma_f32_16x16x32_bf16 v[36:39],a[244:247],v[120:123],v[36:39]
s_waitcnt lgkmcnt(0)
v_cvt_pk_bf16_f32 v176,v168,v169
v_cvt_pk_bf16_f32 v177,v170,v171
v_cvt_pk_bf16_f32 v178,v172,v173
v_mfma_f32_16x16x32_bf16 v[40:43],a[248:251],v[124:127],v[32:35]
v_cvt_pk_bf16_f32 v179,v174,v175
v_mfma_f32_16x16x32_bf16 v[44:47],a[252:255],v[124:127],v[36:39]
s_waitcnt vmcnt(0)
s_add_u32 s64,s66,201326592
buffer_store_dwordx4 v[176:179],v21,s[20:23],s64 offen sc1
s_add_u32 s79,s66,201392128
s_cmp_ge_u32 s63,126
s_cselect_b32 s79,138641408,s79
buffer_store_dwordx4 v[204:207],v21,s[20:23],s79 offen sc1
s_cmp_eq_u32 s56,1
s_cbranch_scc1 b1_151
buffer_store_dwordx4 v[204:207],v21,s[20:23],s84 offen offset:0
buffer_store_dwordx4 v[204:207],v21,s[20:23],s84 offen offset:1024
b2_152:
s_cmp_eq_u32 s56,1
s_cbranch_scc1 b1_153
buffer_store_dwordx4 v[204:207],v21,s[20:23],s84 offen offset:2048
buffer_store_dwordx4 v[204:207],v21,s[20:23],s84 offen offset:3072
b2_154:
s_cmp_eq_u32 s56,1
s_cbranch_scc1 b1_155
buffer_store_dwordx4 v[204:207],v21,s[20:23],s85 offen offset:0
buffer_store_dwordx4 v[204:207],v21,s[20:23],s85 offen offset:1024
b2_156:
s_mul_i32 s64,s77,32768
s_add_u32 s66,s66,s64
s_mul_i32 s64,s77,6144
s_add_u32 s75,s75,s64
s_cmp_eq_u32 s75,24576
s_cselect_b32 s75,0,s75
s_add_u32 s63,s63,s77
s_mov_b32 s77,0
v_cmp_gt_u32 vcc,s71,v16
s_add_u32 s60,s60,1
endN_141:
s_cbranch_vccnz nb_120
s_mov_b32 m0,s70
s_nop 0
buffer_load_dwordx4 v3,s[20:23],s61 offen offset:0 lds
buffer_load_dwordx4 v3,s[20:23],s61 offen offset:1024 lds
buffer_load_dwordx4 v3,s[20:23],s61 offen offset:2048 lds
buffer_load_dwordx4 v3,s[20:23],s61 offen offset:3072 lds
s_add_u32 m0,s70,4096
s_nop 0
buffer_load_dwordx4 v3,s[20:23],s62 offen offset:0 lds
buffer_load_dwordx4 v3,s[20:23],s62 offen offset:1024 lds
buffer_load_dwordx4 v3,s[20:23],s62 offen offset:2048 lds
buffer_load_dwordx4 v3,s[20:23],s62 offen offset:3072 lds
s_add_u32 s61,s61,131072
s_add_u32 s62,s62,131072
s_add_u32 s70,s70,32768
s_and_b32 s70,s70,0x1ffff
v_mov_b32 v212,v40
v_mov_b32 v213,v41
v_mov_b32 v214,v42
v_mov_b32 v215,v43
v_mov_b32 v216,v44
v_mov_b32 v217,v45
v_mov_b32 v218,v46
v_mov_b32 v219,v47
s_mov_b32 s77,1
s_branch dec_119
nb_120:
s_nop 3
s_mov_b32 s77,1
s_add_u32 s84,s74,s75
s_add_u32 s85,s84,4096
buffer_load_dwordx4 v[128:131],v0,s[20:23],s84 offen offset:0 sc1
buffer_load_dwordx4 v[132:135],v0,s[20:23],s84 offen offset:1024 sc1
buffer_load_dwordx4 v[136:139],v0,s[20:23],s84 offen offset:2048 sc1
buffer_load_dwordx4 v[140:143],v0,s[20:23],s84 offen offset:3072 sc1
buffer_load_dwordx4 v[144:147],v0,s[20:23],s85 offen offset:0 sc1
buffer_load_dwordx4 v[148:151],v0,s[20:23],s85 offen offset:1024 sc1
s_cmp_eq_u32 s77,0
s_cselect_b32 s57,2.0,0
v_or_b32 v21,s57,v0
v_lshlrev_b32 v168,16,v160
v_and_b32 v169,s73,v160
v_lshlrev_b32 v170,16,v161
v_and_b32 v171,s73,v161
v_lshlrev_b32 v172,16,v162
v_and_b32 v173,s73,v162
v_lshlrev_b32 v174,16,v163
v_and_b32 v175,s73,v163
v_pk_fma_f32 v[168:169],v[40:41],v[152:153],v[168:169]
v_pk_fma_f32 v[170:171],v[42:43],v[154:155],v[170:171]
v_pk_fma_f32 v[172:173],v[44:45],v[156:157],v[172:173]
v_pk_fma_f32 v[174:175],v[46:47],v[158:159],v[174:175]
s_waitcnt vmcnt(0)
s_cmp_eq_u32 s77,0
s_cbranch_scc1 go_168
ck_166:
v_max3_u32 v184,v128,v129,v130
v_max3_u32 v185,v140,v141,v142
v_max3_u32 v184,v184,v131,v132
v_max3_u32 v185,v185,v143,v144
v_max3_u32 v184,v184,v133,v134
v_max3_u32 v185,v185,v145,v146
v_max3_u32 v184,v184,v135,v136
v_max3_u32 v185,v185,v147,v148
v_max3_u32 v184,v184,v137,v138
v_max3_u32 v185,v185,v149,v150
v_max3_u32 v184,v184,v139,v151
v_max_u32 v184,v184,v185
v_cmp_eq_u32 vcc,-1,v184
s_cbranch_vccnz rt_167
go_168:
buffer_load_dword v16,v2,s[20:23],s68 offen sc1
v_pk_add_f32 v[128:129],v[128:129],v[136:137]
v_pk_add_f32 v[130:131],v[130:131],v[138:139]
v_pk_add_f32 v[132:133],v[132:133],v[140:141]
v_pk_add_f32 v[134:135],v[134:135],v[142:143]
v_pk_add_f32 v[128:129],v[128:129],v[144:145]
v_pk_add_f32 v[130:131],v[130:131],v[146:147]
v_pk_add_f32 v[132:133],v[132:133],v[148:149]
v_pk_add_f32 v[134:135],v[134:135],v[150:151]
v_pk_fma_f32 v[168:169],v[128:129],v[152:153],v[168:169]
v_pk_fma_f32 v[170:171],v[130:131],v[154:155],v[170:171]
v_pk_fma_f32 v[172:173],v[132:133],v[156:157],v[172:173]
v_pk_fma_f32 v[174:175],v[134:135],v[158:159],v[174:175]
v_cvt_pk_bf16_f32 v176,v168,v169
v_cvt_pk_bf16_f32 v177,v170,v171
v_cvt_pk_bf16_f32 v178,v172,v173
v_cvt_pk_bf16_f32 v179,v174,v175
s_add_u32 s64,s66,201326592
buffer_store_dwordx4 v[176:179],v21,s[20:23],s64 offen sc1
s_add_u32 s79,s66,201392128
s_cmp_ge_u32 s63,126
s_cselect_b32 s79,138641408,s79
buffer_store_dwordx4 v[204:207],v21,s[20:23],s79 offen sc1
s_cmp_eq_u32 s56,1
s_cbranch_scc1 b1_160
buffer_store_dwordx4 v[204:207],v21,s[20:23],s84 offen offset:0
buffer_store_dwordx4 v[204:207],v21,s[20:23],s84 offen offset:1024
b2_161:
s_cmp_eq_u32 s56,1
s_cbranch_scc1 b1_162
buffer_store_dwordx4 v[204:207],v21,s[20:23],s84 offen offset:2048
buffer_store_dwordx4 v[204:207],v21,s[20:23],s84 offen offset:3072
b2_163:
s_cmp_eq_u32 s56,1
s_cbranch_scc1 b1_164
buffer_store_dwordx4 v[204:207],v21,s[20:23],s85 offen offset:0
buffer_store_dwordx4 v[204:207],v21,s[20:23],s85 offen offset:1024
b2_165:
s_mul_i32 s64,s77,32768
s_add_u32 s66,s66,s64
s_mul_i32 s64,s77,6144
s_add_u32 s75,s75,s64
s_cmp_eq_u32 s75,24576
s_cselect_b32 s75,0,s75
s_add_u32 s63,s63,s77
s_mov_b32 s77,0
s_waitcnt vmcnt(8)
v_cmp_gt_u32 vcc,s71,v16
s_cbranch_vccz lag_118
s_cmp_ge_u32 s60,128
s_cbranch_scc1 done_72
plp_169:
buffer_load_dword v16,v2,s[20:23],s68 offen sc1
s_waitcnt vmcnt(0)
v_cmp_gt_u32 vcc,s71,v16
s_cbranch_vccz pok_170
s_sleep 4
s_sub_u32 s90,s90,1
s_cmp_gt_i32 s90,0
s_cbranch_scc1 plp_169
pok_170:
s_branch lag_118
b1_91:
s_nop 7
buffer_store_dwordx4 v[40:43],v0,s[20:23],s64 offen offset:0 sc1
buffer_store_dwordx4 v[44:47],v0,s[20:23],s64 offen offset:1024 sc1
s_branch b2_92
b1_94:
s_nop 7
buffer_store_dwordx4 v[40:43],v0,s[20:23],s64 offen offset:0 sc1
buffer_store_dwordx4 v[44:47],v0,s[20:23],s64 offen offset:1024 sc1
s_branch b2_95
b1_96:
s_nop 7
buffer_store_dwordx4 v[40:43],v0,s[20:23],s64 offen offset:0 sc1
buffer_store_dwordx4 v[44:47],v0,s[20:23],s64 offen offset:1024 sc1
s_branch b2_97
b1_98:
s_nop 7
buffer_store_dwordx4 v[40:43],v0,s[20:23],s64 offen offset:0 sc1
buffer_store_dwordx4 v[44:47],v0,s[20:23],s64 offen offset:1024 sc1
s_branch b2_99
b1_123:
s_nop 7
buffer_store_dwordx4 v[204:207],v21,s[20:23],s84 offen offset:0 sc1
buffer_store_dwordx4 v[204:207],v21,s[20:23],s84 offen offset:1024 sc1
s_branch b2_124
b1_125:
s_nop 7
buffer_store_dwordx4 v[204:207],v21,s[20:23],s84 offen offset:2048 sc1
buffer_store_dwordx4 v[204:207],v21,s[20:23],s84 offen offset:3072 sc1
s_branch b2_126
b1_127:
s_nop 7
buffer_store_dwordx4 v[204:207],v21,s[20:23],s85 offen offset:0 sc1
buffer_store_dwordx4 v[204:207],v21,s[20:23],s85 offen offset:1024 sc1
s_branch b2_128
rt_130:
s_sub_u32 s90,s90,1
s_cmp_gt_i32 s90,0
s_cbranch_scc0 go_131
s_add_u32 s84,s74,s75
s_add_u32 s85,s84,4096
buffer_load_dwordx4 v[128:131],v0,s[20:23],s84 offen offset:0 sc1
buffer_load_dwordx4 v[132:135],v0,s[20:23],s84 offen offset:1024 sc1
buffer_load_dwordx4 v[136:139],v0,s[20:23],s84 offen offset:2048 sc1
buffer_load_dwordx4 v[140:143],v0,s[20:23],s84 offen offset:3072 sc1
buffer_load_dwordx4 v[144:147],v0,s[20:23],s85 offen offset:0 sc1
buffer_load_dwordx4 v[148:151],v0,s[20:23],s85 offen offset:1024 sc1
s_waitcnt vmcnt(0)
s_branch ck_129
b1_132:
s_nop 7
buffer_store_dwordx4 v[204:207],v21,s[20:23],s84 offen offset:0 sc1
buffer_store_dwordx4 v[204:207],v21,s[20:23],s84 offen offset:1024 sc1
s_branch b2_133
b1_134:
s_nop 7
buffer_store_dwordx4 v[204:207],v21,s[20:23],s84 offen offset:2048 sc1
buffer_store_dwordx4 v[204:207],v21,s[20:23],s84 offen offset:3072 sc1
s_branch b2_135
b1_136:
s_nop 7
buffer_store_dwordx4 v[204:207],v21,s[20:23],s85 offen offset:0 sc1
buffer_store_dwordx4 v[204:207],v21,s[20:23],s85 offen offset:1024 sc1
s_branch b2_137
rt_139:
s_sub_u32 s90,s90,1
s_cmp_gt_i32 s90,0
s_cbranch_scc0 go_140
s_add_u32 s84,s74,s75
s_add_u32 s85,s84,4096
buffer_load_dwordx4 v[128:131],v0,s[20:23],s84 offen offset:0 sc1
buffer_load_dwordx4 v[132:135],v0,s[20:23],s84 offen offset:1024 sc1
buffer_load_dwordx4 v[136:139],v0,s[20:23],s84 offen offset:2048 sc1
buffer_load_dwordx4 v[140:143],v0,s[20:23],s84 offen offset:3072 sc1
buffer_load_dwordx4 v[144:147],v0,s[20:23],s85 offen offset:0 sc1
buffer_load_dwordx4 v[148:151],v0,s[20:23],s85 offen offset:1024 sc1
s_waitcnt vmcnt(0)
s_branch ck_138
b1_142:
s_nop 7
buffer_store_dwordx4 v[204:207],v21,s[20:23],s84 offen offset:0 sc1
buffer_store_dwordx4 v[204:207],v21,s[20:23],s84 offen offset:1024 sc1
s_branch b2_143
b1_144:
s_nop 7
buffer_store_dwordx4 v[204:207],v21,s[20:23],s84 offen offset:2048 sc1
buffer_store_dwordx4 v[204:207],v21,s[20:23],s84 offen offset:3072 sc1
s_branch b2_145
b1_146:
s_nop 7
buffer_store_dwordx4 v[204:207],v21,s[20:23],s85 offen offset:0 sc1
buffer_store_dwordx4 v[204:207],v21,s[20:23],s85 offen offset:1024 sc1
s_branch b2_147
rt_149:
s_sub_u32 s90,s90,1
s_cmp_gt_i32 s90,0
s_cbranch_scc0 go_150
s_add_u32 s84,s74,s75
s_add_u32 s85,s84,4096
buffer_load_dwordx4 v[128:131],v0,s[20:23],s84 offen offset:0 sc1
buffer_load_dwordx4 v[132:135],v0,s[20:23],s84 offen offset:1024 sc1
buffer_load_dwordx4 v[136:139],v0,s[20:23],s84 offen offset:2048 sc1
buffer_load_dwordx4 v[140:143],v0,s[20:23],s84 offen offset:3072 sc1
buffer_load_dwordx4 v[144:147],v0,s[20:23],s85 offen offset:0 sc1
buffer_load_dwordx4 v[148:151],v0,s[20:23],s85 offen offset:1024 sc1
s_waitcnt vmcnt(0)
s_branch ck_148
b1_151:
s_nop 7
buffer_store_dwordx4 v[204:207],v21,s[20:23],s84 offen offset:0 sc1
buffer_store_dwordx4 v[204:207],v21,s[20:23],s84 offen offset:1024 sc1
s_branch b2_152
b1_153:
s_nop 7
buffer_store_dwordx4 v[204:207],v21,s[20:23],s84 offen offset:2048 sc1
buffer_store_dwordx4 v[204:207],v21,s[20:23],s84 offen offset:3072 sc1
s_branch b2_154
b1_155:
s_nop 7
buffer_store_dwordx4 v[204:207],v21,s[20:23],s85 offen offset:0 sc1
buffer_store_dwordx4 v[204:207],v21,s[20:23],s85 offen offset:1024 sc1
s_branch b2_156
rt_158:
s_sub_u32 s90,s90,1
s_cmp_gt_i32 s90,0
s_cbranch_scc0 go_159
s_add_u32 s84,s74,s75
s_add_u32 s85,s84,4096
buffer_load_dwordx4 v[128:131],v0,s[20:23],s84 offen offset:0 sc1
buffer_load_dwordx4 v[132:135],v0,s[20:23],s84 offen offset:1024 sc1
buffer_load_dwordx4 v[136:139],v0,s[20:23],s84 offen offset:2048 sc1
buffer_load_dwordx4 v[140:143],v0,s[20:23],s84 offen offset:3072 sc1
buffer_load_dwordx4 v[144:147],v0,s[20:23],s85 offen offset:0 sc1
buffer_load_dwordx4 v[148:151],v0,s[20:23],s85 offen offset:1024 sc1
s_waitcnt vmcnt(0)
s_branch ck_157
b1_160:
s_nop 7
buffer_store_dwordx4 v[204:207],v21,s[20:23],s84 offen offset:0 sc1
buffer_store_dwordx4 v[204:207],v21,s[20:23],s84 offen offset:1024 sc1
s_branch b2_161
b1_162:
s_nop 7
buffer_store_dwordx4 v[204:207],v21,s[20:23],s84 offen offset:2048 sc1
buffer_store_dwordx4 v[204:207],v21,s[20:23],s84 offen offset:3072 sc1
s_branch b2_163
b1_164:
s_nop 7
buffer_store_dwordx4 v[204:207],v21,s[20:23],s85 offen offset:0 sc1
buffer_store_dwordx4 v[204:207],v21,s[20:23],s85 offen offset:1024 sc1
s_branch b2_165
rt_167:
s_sub_u32 s90,s90,1
s_cmp_gt_i32 s90,0
s_cbranch_scc0 go_168
s_add_u32 s84,s74,s75
s_add_u32 s85,s84,4096
buffer_load_dwordx4 v[128:131],v0,s[20:23],s84 offen offset:0 sc1
buffer_load_dwordx4 v[132:135],v0,s[20:23],s84 offen offset:1024 sc1
buffer_load_dwordx4 v[136:139],v0,s[20:23],s84 offen offset:2048 sc1
buffer_load_dwordx4 v[140:143],v0,s[20:23],s84 offen offset:3072 sc1
buffer_load_dwordx4 v[144:147],v0,s[20:23],s85 offen offset:0 sc1
buffer_load_dwordx4 v[148:151],v0,s[20:23],s85 offen offset:1024 sc1
s_waitcnt vmcnt(0)
s_branch ck_166
done_72:
s_endpgm
fl_w4:
v_and_b32 v21,15,v1
v_lshrrev_b32 v22,4,v1
v_lshrrev_b32 v23,2,v21
v_and_b32 v24,3,v21
s_lshl_b32 s61,s50,15
v_lshl_add_u32 v25,v22,3,v23
s_load_dwordx2 s[4:5],s[0:1],88
s_load_dwordx2 s[6:7],s[0:1],112
s_lshr_b32 s52,s59,3
s_and_b32 s53,s59,7
s_mul_i32 s54,s52,1835008
s_lshl_b32 s64,s53,8
s_add_u32 s54,s54,s64
s_lshl_b32 s64,s50,6
s_add_u32 s54,s54,s64
s_waitcnt lgkmcnt(0)
s_mov_b32 s28,s4
s_and_b32 s29,s5,0xffff
s_mov_b32 s30,0x700000
s_mov_b32 s31,0x20000
s_mov_b32 s24,s6
s_and_b32 s25,s7,0xffff
s_mov_b32 s26,0x400000
s_mov_b32 s27,0x20000
s_mov_b32 s92,s2
s_and_b32 s93,s3,0xffff
s_mov_b32 s94,0x100
s_mov_b32 s95,0x20000
v_mbcnt_lo_u32_b32 v16,-1,0
v_mbcnt_hi_u32_b32 v16,-1,v16
v_mov_b32 v18,0
v_cmp_eq_u32 vcc,17,v16
s_nop 1
v_cndmask_b32 v18,v18,63,vcc
v_and_b32 v19,1,v16
v_cmp_eq_u32 vcc,1,v19
v_mov_b32 v19,8192
s_nop 0
v_cndmask_b32 v19,-1,v19,vcc
v_min_u32 v16,31,v16
v_lshlrev_b32 v16,2,v16
s_sub_u32 s66,s88,64
s_cmp_lg_u32 s50,0
s_cbranch_scc1 vot_176
vpoll_172:
buffer_load_dword v17,v16,s[92:95],s66 offen sc1
s_waitcnt vmcnt(0)
s_cmp_lg_u32 s56,2
s_cbranch_scc1 vck_173
v_cmp_eq_u32 vcc,v17,v19
s_and_b32 s64,vcc_lo,0xffff
s_cmp_eq_u32 s64,65535
s_cbranch_scc1 vck_173
s_mov_b32 s65,0
v_readlane_b32 s64,v17,1
s_lshr_b32 s64,s64,8
s_add_u32 s65,s65,s64
v_readlane_b32 s64,v17,3
s_lshr_b32 s64,s64,8
s_add_u32 s65,s65,s64
v_readlane_b32 s64,v17,5
s_lshr_b32 s64,s64,8
s_add_u32 s65,s65,s64
v_readlane_b32 s64,v17,7
s_lshr_b32 s64,s64,8
s_add_u32 s65,s65,s64
v_readlane_b32 s64,v17,9
s_lshr_b32 s64,s64,8
s_add_u32 s65,s65,s64
v_readlane_b32 s64,v17,11
s_lshr_b32 s64,s64,8
s_add_u32 s65,s65,s64
v_readlane_b32 s64,v17,13
s_lshr_b32 s64,s64,8
s_add_u32 s65,s65,s64
v_readlane_b32 s64,v17,15
s_lshr_b32 s64,s64,8
s_add_u32 s65,s65,s64
s_cmp_ge_u32 s65,256
s_cbranch_scc1 vok_175
s_branch vrt_174
vck_173:
v_cmp_gt_u32 vcc,v18,v17
s_cbranch_vccz vok_175
vrt_174:
s_sleep 48
s_sub_u32 s90,s90,1
s_cmp_gt_i32 s90,0
s_cbranch_scc1 vpoll_172
vok_175:
v_add_u32 v18,159744,v16
ds_write_b32 v18,v17
s_waitcnt lgkmcnt(0)
vot_176:
s_barrier
v_add_u32 v18,159744,v16
ds_read_b32 v17,v18
s_waitcnt lgkmcnt(0)
s_cmp_lg_u32 s56,2
s_cbranch_scc1 vfin_177
v_cmp_eq_u32 vcc,v17,v19
s_and_b32 s64,vcc_lo,0xffff
s_cmp_eq_u32 s64,65535
s_cbranch_scc1 vfin_177
s_mov_b32 s65,0
v_readlane_b32 s64,v17,1
s_lshr_b32 s64,s64,8
s_add_u32 s65,s65,s64
v_readlane_b32 s64,v17,3
s_lshr_b32 s64,s64,8
s_add_u32 s65,s65,s64
v_readlane_b32 s64,v17,5
s_lshr_b32 s64,s64,8
s_add_u32 s65,s65,s64
v_readlane_b32 s64,v17,7
s_lshr_b32 s64,s64,8
s_add_u32 s65,s65,s64
v_readlane_b32 s64,v17,9
s_lshr_b32 s64,s64,8
s_add_u32 s65,s65,s64
v_readlane_b32 s64,v17,11
s_lshr_b32 s64,s64,8
s_add_u32 s65,s65,s64
v_readlane_b32 s64,v17,13
s_lshr_b32 s64,s64,8
s_add_u32 s65,s65,s64
v_readlane_b32 s64,v17,15
s_lshr_b32 s64,s64,8
s_add_u32 s65,s65,s64
s_cmp_ge_u32 s65,256
s_cbranch_scc1 fl_fb
vfin_177:
s_and_b32 s56,s56,1
v_lshrrev_b32 v26,2,v1
v_and_b32 v27,3,v1
v_mul_u32_u24 v16,2048,v26
v_lshl_add_u32 v16,v27,4,v16
v_lshlrev_b32 v17,6,v25
v_lshl_add_u32 v17,v24,4,v17
v_add_u32 v17,s61,v17
s_xor_b32 s62,s50,0
s_mul_i32 s62,s62,458752
s_add_u32 s62,s62,s54
s_add_u32 m0,s61,0
s_nop 0
buffer_load_dwordx4 v16,s[28:31],s62 offen lds
s_add_u32 s62,s62,32768
s_add_u32 m0,m0,1024
s_waitcnt vmcnt(2)
buffer_load_dwordx4 v16,s[28:31],s62 offen lds
s_add_u32 s62,s62,32768
s_add_u32 m0,m0,1024
s_waitcnt vmcnt(2)
buffer_load_dwordx4 v16,s[28:31],s62 offen lds
s_add_u32 s62,s62,32768
s_add_u32 m0,m0,1024
s_waitcnt vmcnt(2)
buffer_load_dwordx4 v16,s[28:31],s62 offen lds
s_add_u32 s62,s62,32768
s_add_u32 m0,m0,1024
s_waitcnt vmcnt(2)
buffer_load_dwordx4 v16,s[28:31],s62 offen lds
s_add_u32 s62,s62,32768
s_add_u32 m0,m0,1024
s_waitcnt vmcnt(2)
buffer_load_dwordx4 v16,s[28:31],s62 offen lds
s_add_u32 s62,s62,32768
s_add_u32 m0,m0,1024
s_waitcnt vmcnt(2)
buffer_load_dwordx4 v16,s[28:31],s62 offen lds
s_add_u32 s62,s62,32768
s_add_u32 m0,m0,1024
s_waitcnt vmcnt(2)
buffer_load_dwordx4 v16,s[28:31],s62 offen lds
s_add_u32 s62,s62,32768
s_add_u32 m0,m0,1024
s_waitcnt vmcnt(2)
buffer_load_dwordx4 v16,s[28:31],s62 offen lds
s_add_u32 s62,s62,32768
s_add_u32 m0,m0,1024
s_waitcnt vmcnt(2)
buffer_load_dwordx4 v16,s[28:31],s62 offen lds
s_add_u32 s62,s62,32768
s_add_u32 m0,m0,1024
s_waitcnt vmcnt(2)
buffer_load_dwordx4 v16,s[28:31],s62 offen lds
s_add_u32 s62,s62,32768
s_add_u32 m0,m0,1024
s_waitcnt vmcnt(2)
buffer_load_dwordx4 v16,s[28:31],s62 offen lds
s_add_u32 s62,s62,32768
s_add_u32 m0,m0,1024
s_waitcnt vmcnt(2)
buffer_load_dwordx4 v16,s[28:31],s62 offen lds
s_add_u32 s62,s62,32768
s_add_u32 m0,m0,1024
s_waitcnt vmcnt(2)
buffer_load_dwordx4 v16,s[28:31],s62 offen lds
s_waitcnt vmcnt(2)
s_xor_b32 s62,s50,1
s_mul_i32 s62,s62,458752
s_add_u32 s62,s62,s54
s_add_u32 m0,s61,16384
s_nop 0
buffer_load_dwordx4 v16,s[28:31],s62 offen lds
s_add_u32 s62,s62,32768
s_add_u32 m0,m0,1024
s_waitcnt vmcnt(2)
buffer_load_dwordx4 v16,s[28:31],s62 offen lds
s_add_u32 s62,s62,32768
s_add_u32 m0,m0,1024
s_waitcnt vmcnt(2)
buffer_load_dwordx4 v16,s[28:31],s62 offen lds
s_add_u32 s62,s62,32768
s_add_u32 m0,m0,1024
s_waitcnt vmcnt(2)
buffer_load_dwordx4 v16,s[28:31],s62 offen lds
s_add_u32 s62,s62,32768
s_add_u32 m0,m0,1024
s_waitcnt vmcnt(2)
buffer_load_dwordx4 v16,s[28:31],s62 offen lds
s_add_u32 s62,s62,32768
s_add_u32 m0,m0,1024
s_waitcnt vmcnt(2)
buffer_load_dwordx4 v16,s[28:31],s62 offen lds
s_add_u32 s62,s62,32768
s_add_u32 m0,m0,1024
s_waitcnt vmcnt(2)
buffer_load_dwordx4 v16,s[28:31],s62 offen lds
s_add_u32 s62,s62,32768
s_add_u32 m0,m0,1024
s_waitcnt vmcnt(2)
buffer_load_dwordx4 v16,s[28:31],s62 offen lds
s_add_u32 s62,s62,32768
s_add_u32 m0,m0,1024
s_waitcnt vmcnt(2)
buffer_load_dwordx4 v16,s[28:31],s62 offen lds
s_add_u32 s62,s62,32768
s_add_u32 m0,m0,1024
s_waitcnt vmcnt(2)
buffer_load_dwordx4 v16,s[28:31],s62 offen lds
s_add_u32 s62,s62,32768
s_add_u32 m0,m0,1024
s_waitcnt vmcnt(2)
buffer_load_dwordx4 v16,s[28:31],s62 offen lds
s_add_u32 s62,s62,32768
s_add_u32 m0,m0,1024
s_waitcnt vmcnt(2)
buffer_load_dwordx4 v16,s[28:31],s62 offen lds
s_add_u32 s62,s62,32768
s_add_u32 m0,m0,1024
s_waitcnt vmcnt(2)
buffer_load_dwordx4 v16,s[28:31],s62 offen lds
s_add_u32 s62,s62,32768
s_add_u32 m0,m0,1024
s_waitcnt vmcnt(2)
buffer_load_dwordx4 v16,s[28:31],s62 offen lds
s_waitcnt vmcnt(2)
s_waitcnt vmcnt(14)
ds_read_b64_tr_b16 a[0:1],v17 offset:0
ds_read_b64_tr_b16 a[2:3],v17 offset:256
ds_read_b64_tr_b16 a[4:5],v17 offset:8
ds_read_b64_tr_b16 a[6:7],v17 offset:264
ds_read_b64_tr_b16 a[8:9],v17 offset:2048
ds_read_b64_tr_b16 a[10:11],v17 offset:2304
ds_read_b64_tr_b16 a[12:13],v17 offset:2056
ds_read_b64_tr_b16 a[14:15],v17 offset:2312
ds_read_b64_tr_b16 a[16:17],v17 offset:4096
ds_read_b64_tr_b16 a[18:19],v17 offset:4352
ds_read_b64_tr_b16 a[20:21],v17 offset:4104
ds_read_b64_tr_b16 a[22:23],v17 offset:4360
s_waitcnt lgkmcnt(0)
ds_read_b64_tr_b16 a[24:25],v17 offset:6144
ds_read_b64_tr_b16 a[26:27],v17 offset:6400
ds_read_b64_tr_b16 a[28:29],v17 offset:6152
ds_read_b64_tr_b16 a[30:31],v17 offset:6408
ds_read_b64_tr_b16 a[32:33],v17 offset:8192
ds_read_b64_tr_b16 a[34:35],v17 offset:8448
ds_read_b64_tr_b16 a[36:37],v17 offset:8200
ds_read_b64_tr_b16 a[38:39],v17 offset:8456
ds_read_b64_tr_b16 a[40:41],v17 offset:10240
ds_read_b64_tr_b16 a[42:43],v17 offset:10496
ds_read_b64_tr_b16 a[44:45],v17 offset:10248
ds_read_b64_tr_b16 a[46:47],v17 offset:10504
s_waitcnt lgkmcnt(0)
ds_read_b64_tr_b16 a[48:49],v17 offset:12288
ds_read_b64_tr_b16 a[50:51],v17 offset:12544
ds_read_b64_tr_b16 a[52:53],v17 offset:12296
ds_read_b64_tr_b16 a[54:55],v17 offset:12552
s_waitcnt lgkmcnt(0)
s_xor_b32 s62,s50,2
s_mul_i32 s62,s62,458752
s_add_u32 s62,s62,s54
s_add_u32 m0,s61,0
s_nop 0
buffer_load_dwordx4 v16,s[28:31],s62 offen lds
s_add_u32 s62,s62,32768
s_add_u32 m0,m0,1024
s_waitcnt vmcnt(2)
buffer_load_dwordx4 v16,s[28:31],s62 offen lds
s_add_u32 s62,s62,32768
s_add_u32 m0,m0,1024
s_waitcnt vmcnt(2)
buffer_load_dwordx4 v16,s[28:31],s62 offen lds
s_add_u32 s62,s62,32768
s_add_u32 m0,m0,1024
s_waitcnt vmcnt(2)
buffer_load_dwordx4 v16,s[28:31],s62 offen lds
s_add_u32 s62,s62,32768
s_add_u32 m0,m0,1024
s_waitcnt vmcnt(2)
buffer_load_dwordx4 v16,s[28:31],s62 offen lds
s_add_u32 s62,s62,32768
s_add_u32 m0,m0,1024
s_waitcnt vmcnt(2)
buffer_load_dwordx4 v16,s[28:31],s62 offen lds
s_add_u32 s62,s62,32768
s_add_u32 m0,m0,1024
s_waitcnt vmcnt(2)
buffer_load_dwordx4 v16,s[28:31],s62 offen lds
s_add_u32 s62,s62,32768
s_add_u32 m0,m0,1024
s_waitcnt vmcnt(2)
buffer_load_dwordx4 v16,s[28:31],s62 offen lds
s_add_u32 s62,s62,32768
s_add_u32 m0,m0,1024
s_waitcnt vmcnt(2)
buffer_load_dwordx4 v16,s[28:31],s62 offen lds
s_add_u32 s62,s62,32768
s_add_u32 m0,m0,1024
s_waitcnt vmcnt(2)
buffer_load_dwordx4 v16,s[28:31],s62 offen lds
s_add_u32 s62,s62,32768
s_add_u32 m0,m0,1024
s_waitcnt vmcnt(2)
buffer_load_dwordx4 v16,s[28:31],s62 offen lds
s_add_u32 s62,s62,32768
s_add_u32 m0,m0,1024
s_waitcnt vmcnt(2)
buffer_load_dwordx4 v16,s[28:31],s62 offen lds
s_add_u32 s62,s62,32768
s_add_u32 m0,m0,1024
s_waitcnt vmcnt(2)
buffer_load_dwordx4 v16,s[28:31],s62 offen lds
s_add_u32 s62,s62,32768
s_add_u32 m0,m0,1024
s_waitcnt vmcnt(2)
buffer_load_dwordx4 v16,s[28:31],s62 offen lds
s_waitcnt vmcnt(2)
s_waitcnt vmcnt(14)
ds_read_b64_tr_b16 a[56:57],v17 offset:16384
ds_read_b64_tr_b16 a[58:59],v17 offset:16640
ds_read_b64_tr_b16 a[60:61],v17 offset:16392
ds_read_b64_tr_b16 a[62:63],v17 offset:16648
ds_read_b64_tr_b16 a[64:65],v17 offset:18432
ds_read_b64_tr_b16 a[66:67],v17 offset:18688
ds_read_b64_tr_b16 a[68:69],v17 offset:18440
ds_read_b64_tr_b16 a[70:71],v17 offset:18696
ds_read_b64_tr_b16 a[72:73],v17 offset:20480
ds_read_b64_tr_b16 a[74:75],v17 offset:20736
ds_read_b64_tr_b16 a[76:77],v17 offset:20488
ds_read_b64_tr_b16 a[78:79],v17 offset:20744
s_waitcnt lgkmcnt(0)
ds_read_b64_tr_b16 a[80:81],v17 offset:22528
ds_read_b64_tr_b16 a[82:83],v17 offset:22784
ds_read_b64_tr_b16 a[84:85],v17 offset:22536
ds_read_b64_tr_b16 a[86:87],v17 offset:22792
ds_read_b64_tr_b16 a[88:89],v17 offset:24576
ds_read_b64_tr_b16 a[90:91],v17 offset:24832
ds_read_b64_tr_b16 a[92:93],v17 offset:24584
ds_read_b64_tr_b16 a[94:95],v17 offset:24840
ds_read_b64_tr_b16 a[96:97],v17 offset:26624
ds_read_b64_tr_b16 a[98:99],v17 offset:26880
ds_read_b64_tr_b16 a[100:101],v17 offset:26632
ds_read_b64_tr_b16 a[102:103],v17 offset:26888
s_waitcnt lgkmcnt(0)
ds_read_b64_tr_b16 a[104:105],v17 offset:28672
ds_read_b64_tr_b16 a[106:107],v17 offset:28928
ds_read_b64_tr_b16 a[108:109],v17 offset:28680
ds_read_b64_tr_b16 a[110:111],v17 offset:28936
s_waitcnt lgkmcnt(0)
s_xor_b32 s62,s50,3
s_mul_i32 s62,s62,458752
s_add_u32 s62,s62,s54
s_add_u32 m0,s61,16384
s_nop 0
buffer_load_dwordx4 v16,s[28:31],s62 offen lds
s_add_u32 s62,s62,32768
s_add_u32 m0,m0,1024
s_waitcnt vmcnt(2)
buffer_load_dwordx4 v16,s[28:31],s62 offen lds
s_add_u32 s62,s62,32768
s_add_u32 m0,m0,1024
s_waitcnt vmcnt(2)
buffer_load_dwordx4 v16,s[28:31],s62 offen lds
s_add_u32 s62,s62,32768
s_add_u32 m0,m0,1024
s_waitcnt vmcnt(2)
buffer_load_dwordx4 v16,s[28:31],s62 offen lds
s_add_u32 s62,s62,32768
s_add_u32 m0,m0,1024
s_waitcnt vmcnt(2)
buffer_load_dwordx4 v16,s[28:31],s62 offen lds
s_add_u32 s62,s62,32768
s_add_u32 m0,m0,1024
s_waitcnt vmcnt(2)
buffer_load_dwordx4 v16,s[28:31],s62 offen lds
s_add_u32 s62,s62,32768
s_add_u32 m0,m0,1024
s_waitcnt vmcnt(2)
buffer_load_dwordx4 v16,s[28:31],s62 offen lds
s_add_u32 s62,s62,32768
s_add_u32 m0,m0,1024
s_waitcnt vmcnt(2)
buffer_load_dwordx4 v16,s[28:31],s62 offen lds
s_add_u32 s62,s62,32768
s_add_u32 m0,m0,1024
s_waitcnt vmcnt(2)
buffer_load_dwordx4 v16,s[28:31],s62 offen lds
s_add_u32 s62,s62,32768
s_add_u32 m0,m0,1024
s_waitcnt vmcnt(2)
buffer_load_dwordx4 v16,s[28:31],s62 offen lds
s_add_u32 s62,s62,32768
s_add_u32 m0,m0,1024
s_waitcnt vmcnt(2)
buffer_load_dwordx4 v16,s[28:31],s62 offen lds
s_add_u32 s62,s62,32768
s_add_u32 m0,m0,1024
s_waitcnt vmcnt(2)
buffer_load_dwordx4 v16,s[28:31],s62 offen lds
s_add_u32 s62,s62,32768
s_add_u32 m0,m0,1024
s_waitcnt vmcnt(2)
buffer_load_dwordx4 v16,s[28:31],s62 offen lds
s_add_u32 s62,s62,32768
s_add_u32 m0,m0,1024
s_waitcnt vmcnt(2)
buffer_load_dwordx4 v16,s[28:31],s62 offen lds
s_waitcnt vmcnt(2)
s_waitcnt vmcnt(14)
ds_read_b64_tr_b16 a[112:113],v17 offset:0
ds_read_b64_tr_b16 a[114:115],v17 offset:256
ds_read_b64_tr_b16 a[116:117],v17 offset:8
ds_read_b64_tr_b16 a[118:119],v17 offset:264
ds_read_b64_tr_b16 a[120:121],v17 offset:2048
ds_read_b64_tr_b16 a[122:123],v17 offset:2304
ds_read_b64_tr_b16 a[124:125],v17 offset:2056
ds_read_b64_tr_b16 a[126:127],v17 offset:2312
ds_read_b64_tr_b16 a[128:129],v17 offset:4096
ds_read_b64_tr_b16 a[130:131],v17 offset:4352
ds_read_b64_tr_b16 a[132:133],v17 offset:4104
ds_read_b64_tr_b16 a[134:135],v17 offset:4360
s_waitcnt lgkmcnt(0)
ds_read_b64_tr_b16 a[136:137],v17 offset:6144
ds_read_b64_tr_b16 a[138:139],v17 offset:6400
ds_read_b64_tr_b16 a[140:141],v17 offset:6152
ds_read_b64_tr_b16 a[142:143],v17 offset:6408
ds_read_b64_tr_b16 a[144:145],v17 offset:8192
ds_read_b64_tr_b16 a[146:147],v17 offset:8448
ds_read_b64_tr_b16 a[148:149],v17 offset:8200
ds_read_b64_tr_b16 a[150:151],v17 offset:8456
ds_read_b64_tr_b16 a[152:153],v17 offset:10240
ds_read_b64_tr_b16 a[154:155],v17 offset:10496
ds_read_b64_tr_b16 a[156:157],v17 offset:10248
ds_read_b64_tr_b16 a[158:159],v17 offset:10504
s_waitcnt lgkmcnt(0)
ds_read_b64_tr_b16 a[160:161],v17 offset:12288
ds_read_b64_tr_b16 a[162:163],v17 offset:12544
ds_read_b64_tr_b16 a[164:165],v17 offset:12296
ds_read_b64_tr_b16 a[166:167],v17 offset:12552
s_waitcnt lgkmcnt(0)
s_waitcnt vmcnt(0)
ds_read_b64_tr_b16 a[168:169],v17 offset:16384
ds_read_b64_tr_b16 a[170:171],v17 offset:16640
ds_read_b64_tr_b16 a[172:173],v17 offset:16392
ds_read_b64_tr_b16 a[174:175],v17 offset:16648
ds_read_b64_tr_b16 a[176:177],v17 offset:18432
ds_read_b64_tr_b16 a[178:179],v17 offset:18688
ds_read_b64_tr_b16 a[180:181],v17 offset:18440
ds_read_b64_tr_b16 a[182:183],v17 offset:18696
ds_read_b64_tr_b16 a[184:185],v17 offset:20480
ds_read_b64_tr_b16 a[186:187],v17 offset:20736
ds_read_b64_tr_b16 a[188:189],v17 offset:20488
ds_read_b64_tr_b16 a[190:191],v17 offset:20744
s_waitcnt lgkmcnt(0)
ds_read_b64_tr_b16 a[192:193],v17 offset:22528
ds_read_b64_tr_b16 a[194:195],v17 offset:22784
ds_read_b64_tr_b16 a[196:197],v17 offset:22536
ds_read_b64_tr_b16 a[198:199],v17 offset:22792
ds_read_b64_tr_b16 a[200:201],v17 offset:24576
ds_read_b64_tr_b16 a[202:203],v17 offset:24832
ds_read_b64_tr_b16 a[204:205],v17 offset:24584
ds_read_b64_tr_b16 a[206:207],v17 offset:24840
ds_read_b64_tr_b16 a[208:209],v17 offset:26624
ds_read_b64_tr_b16 a[210:211],v17 offset:26880
ds_read_b64_tr_b16 a[212:213],v17 offset:26632
ds_read_b64_tr_b16 a[214:215],v17 offset:26888
s_waitcnt lgkmcnt(0)
ds_read_b64_tr_b16 a[216:217],v17 offset:28672
ds_read_b64_tr_b16 a[218:219],v17 offset:28928
ds_read_b64_tr_b16 a[220:221],v17 offset:28680
ds_read_b64_tr_b16 a[222:223],v17 offset:28936
s_waitcnt lgkmcnt(0)
s_mov_b32 s92,s2
s_and_b32 s93,s3,0xffff
s_mov_b32 s94,0x100
s_mov_b32 s95,0x20000
v_mbcnt_lo_u32_b32 v16,-1,0
v_mbcnt_hi_u32_b32 v16,-1,v16
v_mov_b32 v18,0
v_cmp_eq_u32 vcc,22,v16
s_nop 1
v_cndmask_b32 v18,v18,63,vcc
v_cmp_eq_u32 vcc,17,v16
s_nop 1
v_cndmask_b32 v18,v18,63,vcc
v_cmp_eq_u32 vcc,18,v16
s_nop 1
v_cndmask_b32 v18,v18,1,vcc
v_and_b32 v19,1,v16
v_cmp_eq_u32 vcc,1,v19
v_mov_b32 v19,8192
s_nop 0
v_cndmask_b32 v19,-1,v19,vcc
v_min_u32 v16,31,v16
v_lshlrev_b32 v16,2,v16
s_sub_u32 s66,s88,64
s_cmp_lg_u32 s50,0
s_cbranch_scc1 vot_182
vpoll_178:
buffer_load_dword v17,v16,s[92:95],s66 offen sc1
s_waitcnt vmcnt(0)
s_cmp_lg_u32 s56,2
s_cbranch_scc1 vck_179
v_cmp_eq_u32 vcc,v17,v19
s_and_b32 s64,vcc_lo,0xffff
s_cmp_eq_u32 s64,65535
s_cbranch_scc1 vck_179
s_mov_b32 s65,0
v_readlane_b32 s64,v17,1
s_lshr_b32 s64,s64,8
s_add_u32 s65,s65,s64
v_readlane_b32 s64,v17,3
s_lshr_b32 s64,s64,8
s_add_u32 s65,s65,s64
v_readlane_b32 s64,v17,5
s_lshr_b32 s64,s64,8
s_add_u32 s65,s65,s64
v_readlane_b32 s64,v17,7
s_lshr_b32 s64,s64,8
s_add_u32 s65,s65,s64
v_readlane_b32 s64,v17,9
s_lshr_b32 s64,s64,8
s_add_u32 s65,s65,s64
v_readlane_b32 s64,v17,11
s_lshr_b32 s64,s64,8
s_add_u32 s65,s65,s64
v_readlane_b32 s64,v17,13
s_lshr_b32 s64,s64,8
s_add_u32 s65,s65,s64
v_readlane_b32 s64,v17,15
s_lshr_b32 s64,s64,8
s_add_u32 s65,s65,s64
s_cmp_ge_u32 s65,256
s_cbranch_scc1 vok_181
s_branch vrt_180
vck_179:
v_cmp_gt_u32 vcc,v18,v17
s_cbranch_vccz vok_181
vrt_180:
s_sleep 48
s_sub_u32 s90,s90,1
s_cmp_gt_i32 s90,0
s_cbranch_scc1 vpoll_178
vok_181:
v_add_u32 v18,160000,v16
ds_write_b32 v18,v17
s_waitcnt lgkmcnt(0)
vot_182:
s_barrier
v_add_u32 v18,160000,v16
ds_read_b32 v17,v18
s_waitcnt lgkmcnt(0)
s_cmp_lg_u32 s56,2
s_cbranch_scc1 vfin_183
v_cmp_eq_u32 vcc,v17,v19
s_and_b32 s64,vcc_lo,0xffff
s_cmp_eq_u32 s64,65535
s_cbranch_scc1 vfin_183
s_mov_b32 s65,0
v_readlane_b32 s64,v17,1
s_lshr_b32 s64,s64,8
s_add_u32 s65,s65,s64
v_readlane_b32 s64,v17,3
s_lshr_b32 s64,s64,8
s_add_u32 s65,s65,s64
v_readlane_b32 s64,v17,5
s_lshr_b32 s64,s64,8
s_add_u32 s65,s65,s64
v_readlane_b32 s64,v17,7
s_lshr_b32 s64,s64,8
s_add_u32 s65,s65,s64
v_readlane_b32 s64,v17,9
s_lshr_b32 s64,s64,8
s_add_u32 s65,s65,s64
v_readlane_b32 s64,v17,11
s_lshr_b32 s64,s64,8
s_add_u32 s65,s65,s64
v_readlane_b32 s64,v17,13
s_lshr_b32 s64,s64,8
s_add_u32 s65,s65,s64
v_readlane_b32 s64,v17,15
s_lshr_b32 s64,s64,8
s_add_u32 s65,s65,s64
s_cmp_ge_u32 s65,256
s_cbranch_scc1 fl_fb
vfin_183:
s_and_b32 s56,s56,1
s_mov_b32 s67,0
s_barrier
v_lshlrev_b32 v0,4,v1
s_mov_b32 s60,0
s_lshl_b32 s70,s50,13
s_mov_b32 s55,0
v_mov_b32 v3,v0
s_mov_b32 s73,0xffff0000
s_lshl_b32 s64,s52,2
s_add_u32 s64,s64,s50
s_mul_i32 s61,s64,7168
s_add_u32 s61,s61,219152384
s_lshl_b32 s68,s64,8
s_add_u32 s68,s68,138551296
s_lshl_b32 s83,s53,2
s_add_u32 s83,s83,s50
s_mov_b32 s63,0
s_xor_b32 s64,s50,0
s_lshl_b32 s64,s64,13
v_add_u32 v8,s64,v0
v_mov_b32 v4,v8
s_xor_b32 s64,s50,1
s_lshl_b32 s64,s64,13
v_add_u32 v9,s64,v0
v_mov_b32 v5,v9
s_xor_b32 s64,s50,2
s_lshl_b32 s64,s64,13
v_add_u32 v10,s64,v0
v_mov_b32 v6,v10
s_xor_b32 s64,s50,3
s_lshl_b32 s64,s64,13
v_add_u32 v11,s64,v0
v_mov_b32 v7,v11
v_min_u32 v2,6,v1
v_lshlrev_b32 v2,2,v2
s_add_u32 s62,s61,4096
s_lshl_b32 s66,s83,10
s_lshr_b32 s65,s83,3
s_lshl_b32 s65,s65,8
s_and_b32 s64,s83,7
s_lshl_b32 s64,s64,2
s_add_u32 s69,s64,s65
s_add_u32 s69,s69,138555392
s_add_u32 s82,s66,201326592
s_lshl_b32 s64,s53,2
s_add_u32 s64,s64,s50
s_mul_i32 s74,s64,24576
s_xor_b32 s64,s50,s52
s_sub_u32 s64,s64,1
s_max_i32 s64,s64,0
s_lshl_b32 s64,s64,11
s_add_u32 s74,s74,s64
s_add_u32 s74,s74,168558592
s_mov_b32 s75,0
s_mov_b32 s77,0
v_lshlrev_b32 v26,11,v21
v_lshl_add_u32 v26,v22,4,v26
s_lshl_b32 s64,s83,6
v_add_u32 v18,s64,v26
v_lshlrev_b32 v26,5,v22
s_lshl_b32 s64,s83,7
s_add_u32 s64,s64,267407360
buffer_load_dwordx4 v[152:155],v26,s[20:23],s64 offen offset:0 sc1
buffer_load_dwordx4 v[156:159],v26,s[20:23],s64 offen offset:16 sc1
s_add_u32 s64,s64,24576
buffer_load_dwordx4 v[128:131],v26,s[20:23],s64 offen offset:0 sc1
buffer_load_dwordx4 v[132:135],v26,s[20:23],s64 offen offset:16 sc1
s_add_u32 s64,s64,24576
buffer_load_dwordx4 v[136:139],v26,s[20:23],s64 offen offset:0 sc1
buffer_load_dwordx4 v[140:143],v26,s[20:23],s64 offen offset:16 sc1
s_add_u32 s64,s64,24576
buffer_load_dwordx4 v[144:147],v26,s[20:23],s64 offen offset:0 sc1
buffer_load_dwordx4 v[148:151],v26,s[20:23],s64 offen offset:16 sc1
s_add_u32 s64,s64,24576
s_waitcnt vmcnt(0)
v_pk_add_f32 v[152:153],v[152:153],v[128:129]
v_pk_add_f32 v[136:137],v[136:137],v[144:145]
v_pk_add_f32 v[154:155],v[154:155],v[130:131]
v_pk_add_f32 v[138:139],v[138:139],v[146:147]
v_pk_add_f32 v[156:157],v[156:157],v[132:133]
v_pk_add_f32 v[140:141],v[140:141],v[148:149]
v_pk_add_f32 v[158:159],v[158:159],v[134:135]
v_pk_add_f32 v[142:143],v[142:143],v[150:151]
v_pk_add_f32 v[152:153],v[152:153],v[136:137]
v_pk_add_f32 v[154:155],v[154:155],v[138:139]
v_pk_add_f32 v[156:157],v[156:157],v[140:141]
v_pk_add_f32 v[158:159],v[158:159],v[142:143]
v_cvt_pk_bf16_f32 v128,v152,v153
v_cvt_pk_bf16_f32 v129,v154,v155
v_cvt_pk_bf16_f32 v130,v156,v157
v_cvt_pk_bf16_f32 v131,v158,v159
v_lshlrev_b32 v152,16,v128
v_and_b32 v153,s73,v128
v_lshlrev_b32 v154,16,v129
v_and_b32 v155,s73,v129
v_lshlrev_b32 v156,16,v130
v_and_b32 v157,s73,v130
v_lshlrev_b32 v158,16,v131
v_and_b32 v159,s73,v131
v_mov_b32 v204,-1
v_mov_b32 v205,-1
v_mov_b32 v206,-1
v_mov_b32 v207,-1
v_cmp_eq_u32 vcc,0,v1
s_nop 1
v_cndmask_b32 v26,2.0,0,vcc
s_cmp_eq_u32 s50,s52
s_cbranch_scc1 lfin_184
s_add_u32 s71,s60,1
s_add_u32 s53,s60,2
plp_194:
buffer_load_dword v16,v2,s[20:23],s68 offen sc1
s_waitcnt vmcnt(0)
v_cmp_gt_u32 vcc,s71,v16
s_cbranch_vccz pok_195
s_sleep 4
s_sub_u32 s90,s90,1
s_cmp_gt_i32 s90,0
s_cbranch_scc1 plp_194
pok_195:
lag_191:
s_mov_b32 m0,s70
s_nop 0
buffer_load_dwordx4 v3,s[20:23],s61 offen offset:0 lds
buffer_load_dwordx4 v3,s[20:23],s61 offen offset:1024 lds
buffer_load_dwordx4 v3,s[20:23],s61 offen offset:2048 lds
buffer_load_dwordx4 v3,s[20:23],s61 offen offset:3072 lds
s_add_u32 m0,s70,4096
s_nop 0
buffer_load_dwordx4 v3,s[20:23],s62 offen offset:0 lds
buffer_load_dwordx4 v3,s[20:23],s62 offen offset:1024 lds
buffer_load_dwordx4 v3,s[20:23],s62 offen offset:2048 lds
s_add_u32 s61,s61,114688
s_add_u32 s62,s62,114688
s_add_u32 s70,s70,32768
s_and_b32 s70,s70,0x1ffff
buffer_load_dword v23,off,s[20:23],s66
buffer_load_dword v23,off,s[20:23],s66
dec_192:
v_cmp_gt_u32 vcc,s53,v16
s_cbranch_vccnz BN_190
BR_189:
s_waitcnt vmcnt(8)
ds_read_b128 v[64:67],v4 offset:0
s_waitcnt vmcnt(7)
ds_read_b128 v[68:71],v4 offset:1024
s_waitcnt vmcnt(6)
ds_read_b128 v[72:75],v4 offset:2048
s_waitcnt vmcnt(5)
ds_read_b128 v[76:79],v4 offset:3072
s_waitcnt lgkmcnt(3)
v_mfma_f32_16x16x32_bf16 v[32:35],a[0:3],v[64:67],0
s_add_u32 s71,s60,2
s_add_u32 s53,s60,3
v_mfma_f32_16x16x32_bf16 v[36:39],a[4:7],v[64:67],0
s_waitcnt lgkmcnt(2)
s_waitcnt vmcnt(4)
ds_read_b128 v[80:83],v4 offset:4096
v_mfma_f32_16x16x32_bf16 v[32:35],a[8:11],v[68:71],v[32:35]
v_mfma_f32_16x16x32_bf16 v[36:39],a[12:15],v[68:71],v[36:39]
s_waitcnt lgkmcnt(2)
s_waitcnt vmcnt(3)
s_mov_b32 m0,s70
ds_read_b128 v[84:87],v4 offset:5120
v_mfma_f32_16x16x32_bf16 v[32:35],a[16:19],v[72:75],v[32:35]
buffer_load_dwordx4 v3,s[20:23],s61 offen offset:0 lds
v_mfma_f32_16x16x32_bf16 v[36:39],a[20:23],v[72:75],v[36:39]
s_waitcnt lgkmcnt(2)
s_waitcnt vmcnt(3)
ds_read_b128 v[88:91],v4 offset:6144
v_mfma_f32_16x16x32_bf16 v[32:35],a[24:27],v[76:79],v[32:35]
buffer_load_dwordx4 v3,s[20:23],s61 offen offset:1024 lds
v_mfma_f32_16x16x32_bf16 v[36:39],a[28:31],v[76:79],v[36:39]
s_waitcnt lgkmcnt(2)
s_barrier
ds_read_b128 v[92:95],v5 offset:0
v_mfma_f32_16x16x32_bf16 v[32:35],a[32:35],v[80:83],v[32:35]
ds_read_b128 v[96:99],v5 offset:1024
v_mfma_f32_16x16x32_bf16 v[36:39],a[36:39],v[80:83],v[36:39]
s_waitcnt lgkmcnt(3)
ds_read_b128 v[100:103],v5 offset:2048
buffer_load_dwordx4 v3,s[20:23],s61 offen offset:2048 lds
v_mfma_f32_16x16x32_bf16 v[32:35],a[40:43],v[84:87],v[32:35]
ds_read_b128 v[104:107],v5 offset:3072
v_mfma_f32_16x16x32_bf16 v[36:39],a[44:47],v[84:87],v[36:39]
s_waitcnt lgkmcnt(4)
ds_read_b128 v[108:111],v5 offset:4096
v_mfma_f32_16x16x32_bf16 v[32:35],a[48:51],v[88:91],v[32:35]
ds_read_b128 v[112:115],v5 offset:5120
buffer_load_dwordx4 v3,s[20:23],s61 offen offset:3072 lds
v_mfma_f32_16x16x32_bf16 v[36:39],a[52:55],v[88:91],v[36:39]
s_waitcnt lgkmcnt(5)
v_mfma_f32_16x16x32_bf16 v[32:35],a[56:59],v[92:95],v[32:35]
ds_read_b128 v[116:119],v5 offset:6144
v_mfma_f32_16x16x32_bf16 v[36:39],a[60:63],v[92:95],v[36:39]
s_waitcnt lgkmcnt(5)
s_add_u32 m0,s70,4096
v_mfma_f32_16x16x32_bf16 v[32:35],a[64:67],v[96:99],v[32:35]
ds_read_b128 v[120:123],v6 offset:0
buffer_load_dwordx4 v3,s[20:23],s62 offen offset:0 lds
v_mfma_f32_16x16x32_bf16 v[36:39],a[68:71],v[96:99],v[36:39]
s_waitcnt lgkmcnt(5)
v_mfma_f32_16x16x32_bf16 v[32:35],a[72:75],v[100:103],v[32:35]
ds_read_b128 v[124:127],v6 offset:1024
v_mfma_f32_16x16x32_bf16 v[36:39],a[76:79],v[100:103],v[36:39]
s_waitcnt lgkmcnt(5)
buffer_load_dwordx4 v3,s[20:23],s62 offen offset:1024 lds
v_mfma_f32_16x16x32_bf16 v[32:35],a[80:83],v[104:107],v[32:35]
ds_read_b128 v[64:67],v6 offset:2048
v_mfma_f32_16x16x32_bf16 v[36:39],a[84:87],v[104:107],v[36:39]
s_waitcnt lgkmcnt(5)
buffer_load_dword v16,v2,s[20:23],s68 offen sc1
v_mfma_f32_16x16x32_bf16 v[32:35],a[88:91],v[108:111],v[32:35]
ds_read_b128 v[68:71],v6 offset:3072
buffer_load_dwordx4 v3,s[20:23],s62 offen offset:2048 lds
v_mfma_f32_16x16x32_bf16 v[36:39],a[92:95],v[108:111],v[36:39]
s_waitcnt lgkmcnt(5)
v_mfma_f32_16x16x32_bf16 v[32:35],a[96:99],v[112:115],v[32:35]
ds_read_b128 v[72:75],v6 offset:4096
v_mfma_f32_16x16x32_bf16 v[36:39],a[100:103],v[112:115],v[36:39]
s_waitcnt lgkmcnt(5)
v_mfma_f32_16x16x32_bf16 v[32:35],a[104:107],v[116:119],v[32:35]
ds_read_b128 v[76:79],v6 offset:5120
v_mfma_f32_16x16x32_bf16 v[36:39],a[108:111],v[116:119],v[36:39]
s_waitcnt lgkmcnt(5)
v_mfma_f32_16x16x32_bf16 v[32:35],a[112:115],v[120:123],v[32:35]
ds_read_b128 v[80:83],v6 offset:6144
v_mfma_f32_16x16x32_bf16 v[36:39],a[116:119],v[120:123],v[36:39]
s_waitcnt lgkmcnt(5)
v_mfma_f32_16x16x32_bf16 v[32:35],a[120:123],v[124:127],v[32:35]
ds_read_b128 v[84:87],v7 offset:0
v_mfma_f32_16x16x32_bf16 v[36:39],a[124:127],v[124:127],v[36:39]
s_waitcnt lgkmcnt(5)
v_mfma_f32_16x16x32_bf16 v[32:35],a[128:131],v[64:67],v[32:35]
ds_read_b128 v[88:91],v7 offset:1024
v_mfma_f32_16x16x32_bf16 v[36:39],a[132:135],v[64:67],v[36:39]
s_waitcnt lgkmcnt(5)
v_mfma_f32_16x16x32_bf16 v[32:35],a[136:139],v[68:71],v[32:35]
ds_read_b128 v[92:95],v7 offset:2048
v_mfma_f32_16x16x32_bf16 v[36:39],a[140:143],v[68:71],v[36:39]
s_waitcnt lgkmcnt(5)
v_mfma_f32_16x16x32_bf16 v[32:35],a[144:147],v[72:75],v[32:35]
ds_read_b128 v[96:99],v7 offset:3072
v_mfma_f32_16x16x32_bf16 v[36:39],a[148:151],v[72:75],v[36:39]
s_waitcnt lgkmcnt(5)
v_mfma_f32_16x16x32_bf16 v[32:35],a[152:155],v[76:79],v[32:35]
ds_read_b128 v[100:103],v7 offset:4096
v_mfma_f32_16x16x32_bf16 v[36:39],a[156:159],v[76:79],v[36:39]
s_waitcnt lgkmcnt(5)
v_mfma_f32_16x16x32_bf16 v[32:35],a[160:163],v[80:83],v[32:35]
ds_read_b128 v[104:107],v7 offset:5120
v_mfma_f32_16x16x32_bf16 v[36:39],a[164:167],v[80:83],v[36:39]
s_waitcnt lgkmcnt(5)
v_mfma_f32_16x16x32_bf16 v[32:35],a[168:171],v[84:87],v[32:35]
ds_read_b128 v[108:111],v7 offset:6144
v_mfma_f32_16x16x32_bf16 v[36:39],a[172:175],v[84:87],v[36:39]
s_waitcnt lgkmcnt(5)
s_add_u32 s61,s61,114688
s_add_u32 s62,s62,114688
v_mfma_f32_16x16x32_bf16 v[32:35],a[176:179],v[88:91],v[32:35]
s_add_u32 s70,s70,32768
s_and_b32 s70,s70,0x1ffff
s_add_u32 s55,s55,32768
v_mfma_f32_16x16x32_bf16 v[36:39],a[180:183],v[88:91],v[36:39]
s_waitcnt lgkmcnt(4)
s_and_b32 s55,s55,0x1ffff
v_add_u32 v4,s55,v8
v_mfma_f32_16x16x32_bf16 v[32:35],a[184:187],v[92:95],v[32:35]
v_add_u32 v5,s55,v9
v_add_u32 v6,s55,v10
v_mfma_f32_16x16x32_bf16 v[36:39],a[188:191],v[92:95],v[36:39]
s_waitcnt lgkmcnt(3)
v_add_u32 v7,s55,v11
v_mfma_f32_16x16x32_bf16 v[32:35],a[192:195],v[96:99],v[32:35]
s_waitcnt vmcnt(7)
ds_read_b128 v[64:67],v4 offset:0
v_mfma_f32_16x16x32_bf16 v[36:39],a[196:199],v[96:99],v[36:39]
s_waitcnt lgkmcnt(3)
s_waitcnt vmcnt(6)
ds_read_b128 v[68:71],v4 offset:1024
v_mfma_f32_16x16x32_bf16 v[32:35],a[200:203],v[100:103],v[32:35]
s_waitcnt vmcnt(5)
ds_read_b128 v[72:75],v4 offset:2048
v_mfma_f32_16x16x32_bf16 v[36:39],a[204:207],v[100:103],v[36:39]
s_waitcnt lgkmcnt(4)
v_mfma_f32_16x16x32_bf16 v[32:35],a[208:211],v[104:107],v[32:35]
v_mfma_f32_16x16x32_bf16 v[36:39],a[212:215],v[104:107],v[36:39]
s_waitcnt lgkmcnt(3)
v_mfma_f32_16x16x32_bf16 v[40:43],a[216:219],v[108:111],v[32:35]
v_mfma_f32_16x16x32_bf16 v[44:47],a[220:223],v[108:111],v[36:39]
s_waitcnt vmcnt(1)
v_cmp_gt_u32 vcc,s53,v16
s_add_u32 s60,s60,1
s_cbranch_vccnz WN_188
.p2align 6
WR_187:
s_waitcnt lgkmcnt(2)
v_mfma_f32_16x16x32_bf16 v[32:35],a[0:3],v[64:67],0
s_waitcnt vmcnt(4)
s_add_u32 s71,s60,2
ds_read_b128 v[76:79],v4 offset:3072
v_mfma_f32_16x16x32_bf16 v[36:39],a[4:7],v[64:67],0
s_waitcnt lgkmcnt(2)
s_add_u32 s53,s60,3
v_mfma_f32_16x16x32_bf16 v[32:35],a[8:11],v[68:71],v[32:35]
s_waitcnt vmcnt(3)
s_mov_b32 m0,s70
ds_read_b128 v[80:83],v4 offset:4096
v_mfma_f32_16x16x32_bf16 v[36:39],a[12:15],v[68:71],v[36:39]
s_waitcnt lgkmcnt(2)
buffer_load_dwordx4 v3,s[20:23],s61 offen offset:0 lds
s_add_u32 s64,s74,s75
s_cmp_eq_u32 s56,1
s_cbranch_scc1 b1_196
buffer_store_dwordx4 v[40:43],v0,s[20:23],s64 offen offset:0
buffer_store_dwordx4 v[44:47],v0,s[20:23],s64 offen offset:1024
b2_197:
v_mfma_f32_16x16x32_bf16 v[32:35],a[16:19],v[72:75],v[32:35]
s_waitcnt vmcnt(5)
s_add_u32 s75,s75,6144
ds_read_b128 v[84:87],v4 offset:5120
v_mfma_f32_16x16x32_bf16 v[36:39],a[20:23],v[72:75],v[36:39]
s_waitcnt lgkmcnt(2)
s_cmp_eq_u32 s75,24576
s_cselect_b32 s75,0,s75
v_mfma_f32_16x16x32_bf16 v[32:35],a[24:27],v[76:79],v[32:35]
s_waitcnt vmcnt(3)
ds_read_b128 v[88:91],v4 offset:6144
buffer_load_dwordx4 v3,s[20:23],s61 offen offset:1024 lds
v_mfma_f32_16x16x32_bf16 v[36:39],a[28:31],v[76:79],v[36:39]
s_waitcnt lgkmcnt(2)
s_barrier
ds_read_b128 v[92:95],v5 offset:0
v_mfma_f32_16x16x32_bf16 v[32:35],a[32:35],v[80:83],v[32:35]
ds_read_b128 v[96:99],v5 offset:1024
v_mfma_f32_16x16x32_bf16 v[36:39],a[36:39],v[80:83],v[36:39]
s_waitcnt lgkmcnt(3)
ds_read_b128 v[100:103],v5 offset:2048
buffer_load_dwordx4 v3,s[20:23],s61 offen offset:2048 lds
v_mfma_f32_16x16x32_bf16 v[32:35],a[40:43],v[84:87],v[32:35]
ds_read_b128 v[104:107],v5 offset:3072
v_mfma_f32_16x16x32_bf16 v[36:39],a[44:47],v[84:87],v[36:39]
s_waitcnt lgkmcnt(4)
ds_read_b128 v[108:111],v5 offset:4096
v_mfma_f32_16x16x32_bf16 v[32:35],a[48:51],v[88:91],v[32:35]
ds_read_b128 v[112:115],v5 offset:5120
buffer_load_dwordx4 v3,s[20:23],s61 offen offset:3072 lds
v_mfma_f32_16x16x32_bf16 v[36:39],a[52:55],v[88:91],v[36:39]
s_waitcnt lgkmcnt(5)
v_mfma_f32_16x16x32_bf16 v[32:35],a[56:59],v[92:95],v[32:35]
ds_read_b128 v[116:119],v5 offset:6144
v_mfma_f32_16x16x32_bf16 v[36:39],a[60:63],v[92:95],v[36:39]
s_waitcnt lgkmcnt(5)
s_add_u32 m0,s70,4096
v_mfma_f32_16x16x32_bf16 v[32:35],a[64:67],v[96:99],v[32:35]
ds_read_b128 v[120:123],v6 offset:0
buffer_load_dwordx4 v3,s[20:23],s62 offen offset:0 lds
v_mfma_f32_16x16x32_bf16 v[36:39],a[68:71],v[96:99],v[36:39]
s_waitcnt lgkmcnt(5)
v_mfma_f32_16x16x32_bf16 v[32:35],a[72:75],v[100:103],v[32:35]
ds_read_b128 v[124:127],v6 offset:1024
v_mfma_f32_16x16x32_bf16 v[36:39],a[76:79],v[100:103],v[36:39]
s_waitcnt lgkmcnt(5)
buffer_load_dwordx4 v3,s[20:23],s62 offen offset:1024 lds
v_mfma_f32_16x16x32_bf16 v[32:35],a[80:83],v[104:107],v[32:35]
ds_read_b128 v[64:67],v6 offset:2048
v_mfma_f32_16x16x32_bf16 v[36:39],a[84:87],v[104:107],v[36:39]
s_waitcnt lgkmcnt(5)
buffer_load_dword v16,v2,s[20:23],s68 offen sc1
v_mfma_f32_16x16x32_bf16 v[32:35],a[88:91],v[108:111],v[32:35]
ds_read_b128 v[68:71],v6 offset:3072
buffer_load_dwordx4 v3,s[20:23],s62 offen offset:2048 lds
v_mfma_f32_16x16x32_bf16 v[36:39],a[92:95],v[108:111],v[36:39]
s_waitcnt lgkmcnt(5)
v_mfma_f32_16x16x32_bf16 v[32:35],a[96:99],v[112:115],v[32:35]
ds_read_b128 v[72:75],v6 offset:4096
v_mfma_f32_16x16x32_bf16 v[36:39],a[100:103],v[112:115],v[36:39]
s_waitcnt lgkmcnt(5)
v_mfma_f32_16x16x32_bf16 v[32:35],a[104:107],v[116:119],v[32:35]
ds_read_b128 v[76:79],v6 offset:5120
v_mfma_f32_16x16x32_bf16 v[36:39],a[108:111],v[116:119],v[36:39]
s_waitcnt lgkmcnt(5)
v_mfma_f32_16x16x32_bf16 v[32:35],a[112:115],v[120:123],v[32:35]
ds_read_b128 v[80:83],v6 offset:6144
v_mfma_f32_16x16x32_bf16 v[36:39],a[116:119],v[120:123],v[36:39]
s_waitcnt lgkmcnt(5)
v_mfma_f32_16x16x32_bf16 v[32:35],a[120:123],v[124:127],v[32:35]
ds_read_b128 v[84:87],v7 offset:0
v_mfma_f32_16x16x32_bf16 v[36:39],a[124:127],v[124:127],v[36:39]
s_waitcnt lgkmcnt(5)
v_mfma_f32_16x16x32_bf16 v[32:35],a[128:131],v[64:67],v[32:35]
ds_read_b128 v[88:91],v7 offset:1024
v_mfma_f32_16x16x32_bf16 v[36:39],a[132:135],v[64:67],v[36:39]
s_waitcnt lgkmcnt(5)
v_mfma_f32_16x16x32_bf16 v[32:35],a[136:139],v[68:71],v[32:35]
ds_read_b128 v[92:95],v7 offset:2048
v_mfma_f32_16x16x32_bf16 v[36:39],a[140:143],v[68:71],v[36:39]
s_waitcnt lgkmcnt(5)
v_mfma_f32_16x16x32_bf16 v[32:35],a[144:147],v[72:75],v[32:35]
ds_read_b128 v[96:99],v7 offset:3072
v_mfma_f32_16x16x32_bf16 v[36:39],a[148:151],v[72:75],v[36:39]
s_waitcnt lgkmcnt(5)
v_mfma_f32_16x16x32_bf16 v[32:35],a[152:155],v[76:79],v[32:35]
ds_read_b128 v[100:103],v7 offset:4096
v_mfma_f32_16x16x32_bf16 v[36:39],a[156:159],v[76:79],v[36:39]
s_waitcnt lgkmcnt(5)
v_mfma_f32_16x16x32_bf16 v[32:35],a[160:163],v[80:83],v[32:35]
ds_read_b128 v[104:107],v7 offset:5120
v_mfma_f32_16x16x32_bf16 v[36:39],a[164:167],v[80:83],v[36:39]
s_waitcnt lgkmcnt(5)
v_mfma_f32_16x16x32_bf16 v[32:35],a[168:171],v[84:87],v[32:35]
ds_read_b128 v[108:111],v7 offset:6144
v_mfma_f32_16x16x32_bf16 v[36:39],a[172:175],v[84:87],v[36:39]
s_waitcnt lgkmcnt(5)
s_add_u32 s61,s61,114688
s_add_u32 s62,s62,114688
v_mfma_f32_16x16x32_bf16 v[32:35],a[176:179],v[88:91],v[32:35]
s_add_u32 s70,s70,32768
s_and_b32 s70,s70,0x1ffff
s_add_u32 s55,s55,32768
v_mfma_f32_16x16x32_bf16 v[36:39],a[180:183],v[88:91],v[36:39]
s_waitcnt lgkmcnt(4)
s_and_b32 s55,s55,0x1ffff
v_add_u32 v4,s55,v8
v_mfma_f32_16x16x32_bf16 v[32:35],a[184:187],v[92:95],v[32:35]
v_add_u32 v5,s55,v9
v_add_u32 v6,s55,v10
v_mfma_f32_16x16x32_bf16 v[36:39],a[188:191],v[92:95],v[36:39]
s_waitcnt lgkmcnt(3)
v_add_u32 v7,s55,v11
v_mfma_f32_16x16x32_bf16 v[32:35],a[192:195],v[96:99],v[32:35]
s_waitcnt vmcnt(9)
ds_read_b128 v[64:67],v4 offset:0
v_mfma_f32_16x16x32_bf16 v[36:39],a[196:199],v[96:99],v[36:39]
s_waitcnt lgkmcnt(3)
s_waitcnt vmcnt(6)
ds_read_b128 v[68:71],v4 offset:1024
v_mfma_f32_16x16x32_bf16 v[32:35],a[200:203],v[100:103],v[32:35]
s_waitcnt vmcnt(5)
ds_read_b128 v[72:75],v4 offset:2048
v_mfma_f32_16x16x32_bf16 v[36:39],a[204:207],v[100:103],v[36:39]
s_waitcnt lgkmcnt(4)
v_mfma_f32_16x16x32_bf16 v[32:35],a[208:211],v[104:107],v[32:35]
v_mfma_f32_16x16x32_bf16 v[36:39],a[212:215],v[104:107],v[36:39]
s_waitcnt lgkmcnt(3)
v_mfma_f32_16x16x32_bf16 v[40:43],a[216:219],v[108:111],v[32:35]
v_mfma_f32_16x16x32_bf16 v[44:47],a[220:223],v[108:111],v[36:39]
s_waitcnt vmcnt(1)
v_cmp_gt_u32 vcc,s53,v16
s_add_u32 s60,s60,1
s_cbranch_vccz WR_187
WN_188:
s_waitcnt lgkmcnt(2)
v_mfma_f32_16x16x32_bf16 v[32:35],a[0:3],v[64:67],0
s_waitcnt vmcnt(4)
s_add_u32 s71,s60,2
ds_read_b128 v[76:79],v4 offset:3072
v_mfma_f32_16x16x32_bf16 v[36:39],a[4:7],v[64:67],0
s_waitcnt lgkmcnt(2)
s_add_u32 s53,s60,3
v_mfma_f32_16x16x32_bf16 v[32:35],a[8:11],v[68:71],v[32:35]
s_waitcnt vmcnt(3)
ds_read_b128 v[80:83],v4 offset:4096
v_mfma_f32_16x16x32_bf16 v[36:39],a[12:15],v[68:71],v[36:39]
s_waitcnt lgkmcnt(2)
s_add_u32 s64,s74,s75
s_cmp_eq_u32 s56,1
s_cbranch_scc1 b1_199
buffer_store_dwordx4 v[40:43],v0,s[20:23],s64 offen offset:0
buffer_store_dwordx4 v[44:47],v0,s[20:23],s64 offen offset:1024
b2_200:
v_mfma_f32_16x16x32_bf16 v[32:35],a[16:19],v[72:75],v[32:35]
s_waitcnt vmcnt(4)
s_add_u32 s75,s75,6144
ds_read_b128 v[84:87],v4 offset:5120
v_mfma_f32_16x16x32_bf16 v[36:39],a[20:23],v[72:75],v[36:39]
s_waitcnt lgkmcnt(2)
s_cmp_eq_u32 s75,24576
s_cselect_b32 s75,0,s75
v_mfma_f32_16x16x32_bf16 v[32:35],a[24:27],v[76:79],v[32:35]
s_waitcnt vmcnt(2)
ds_read_b128 v[88:91],v4 offset:6144
v_mfma_f32_16x16x32_bf16 v[36:39],a[28:31],v[76:79],v[36:39]
s_waitcnt lgkmcnt(2)
s_barrier
ds_read_b128 v[92:95],v5 offset:0
v_mfma_f32_16x16x32_bf16 v[32:35],a[32:35],v[80:83],v[32:35]
ds_read_b128 v[96:99],v5 offset:1024
v_mfma_f32_16x16x32_bf16 v[36:39],a[36:39],v[80:83],v[36:39]
s_waitcnt lgkmcnt(3)
ds_read_b128 v[100:103],v5 offset:2048
v_mfma_f32_16x16x32_bf16 v[32:35],a[40:43],v[84:87],v[32:35]
ds_read_b128 v[104:107],v5 offset:3072
v_mfma_f32_16x16x32_bf16 v[36:39],a[44:47],v[84:87],v[36:39]
s_waitcnt lgkmcnt(4)
ds_read_b128 v[108:111],v5 offset:4096
v_mfma_f32_16x16x32_bf16 v[32:35],a[48:51],v[88:91],v[32:35]
ds_read_b128 v[112:115],v5 offset:5120
v_mfma_f32_16x16x32_bf16 v[36:39],a[52:55],v[88:91],v[36:39]
s_waitcnt lgkmcnt(5)
v_mfma_f32_16x16x32_bf16 v[32:35],a[56:59],v[92:95],v[32:35]
ds_read_b128 v[116:119],v5 offset:6144
v_mfma_f32_16x16x32_bf16 v[36:39],a[60:63],v[92:95],v[36:39]
s_waitcnt lgkmcnt(5)
v_mfma_f32_16x16x32_bf16 v[32:35],a[64:67],v[96:99],v[32:35]
ds_read_b128 v[120:123],v6 offset:0
v_mfma_f32_16x16x32_bf16 v[36:39],a[68:71],v[96:99],v[36:39]
s_waitcnt lgkmcnt(5)
v_mfma_f32_16x16x32_bf16 v[32:35],a[72:75],v[100:103],v[32:35]
ds_read_b128 v[124:127],v6 offset:1024
v_mfma_f32_16x16x32_bf16 v[36:39],a[76:79],v[100:103],v[36:39]
s_waitcnt lgkmcnt(5)
v_mfma_f32_16x16x32_bf16 v[32:35],a[80:83],v[104:107],v[32:35]
ds_read_b128 v[64:67],v6 offset:2048
v_mfma_f32_16x16x32_bf16 v[36:39],a[84:87],v[104:107],v[36:39]
s_waitcnt lgkmcnt(5)
v_mfma_f32_16x16x32_bf16 v[32:35],a[88:91],v[108:111],v[32:35]
ds_read_b128 v[68:71],v6 offset:3072
v_mfma_f32_16x16x32_bf16 v[36:39],a[92:95],v[108:111],v[36:39]
s_waitcnt lgkmcnt(5)
v_mfma_f32_16x16x32_bf16 v[32:35],a[96:99],v[112:115],v[32:35]
ds_read_b128 v[72:75],v6 offset:4096
v_mfma_f32_16x16x32_bf16 v[36:39],a[100:103],v[112:115],v[36:39]
s_waitcnt lgkmcnt(5)
v_mfma_f32_16x16x32_bf16 v[32:35],a[104:107],v[116:119],v[32:35]
ds_read_b128 v[76:79],v6 offset:5120
v_mfma_f32_16x16x32_bf16 v[36:39],a[108:111],v[116:119],v[36:39]
s_waitcnt lgkmcnt(5)
v_mfma_f32_16x16x32_bf16 v[32:35],a[112:115],v[120:123],v[32:35]
ds_read_b128 v[80:83],v6 offset:6144
v_mfma_f32_16x16x32_bf16 v[36:39],a[116:119],v[120:123],v[36:39]
s_waitcnt lgkmcnt(5)
v_mfma_f32_16x16x32_bf16 v[32:35],a[120:123],v[124:127],v[32:35]
ds_read_b128 v[84:87],v7 offset:0
v_mfma_f32_16x16x32_bf16 v[36:39],a[124:127],v[124:127],v[36:39]
s_waitcnt lgkmcnt(5)
v_mfma_f32_16x16x32_bf16 v[32:35],a[128:131],v[64:67],v[32:35]
ds_read_b128 v[88:91],v7 offset:1024
v_mfma_f32_16x16x32_bf16 v[36:39],a[132:135],v[64:67],v[36:39]
s_waitcnt lgkmcnt(5)
v_mfma_f32_16x16x32_bf16 v[32:35],a[136:139],v[68:71],v[32:35]
ds_read_b128 v[92:95],v7 offset:2048
v_mfma_f32_16x16x32_bf16 v[36:39],a[140:143],v[68:71],v[36:39]
s_waitcnt lgkmcnt(5)
buffer_load_dword v16,v2,s[20:23],s68 offen sc1
v_mfma_f32_16x16x32_bf16 v[32:35],a[144:147],v[72:75],v[32:35]
ds_read_b128 v[96:99],v7 offset:3072
v_mfma_f32_16x16x32_bf16 v[36:39],a[148:151],v[72:75],v[36:39]
s_waitcnt lgkmcnt(5)
v_mfma_f32_16x16x32_bf16 v[32:35],a[152:155],v[76:79],v[32:35]
ds_read_b128 v[100:103],v7 offset:4096
v_mfma_f32_16x16x32_bf16 v[36:39],a[156:159],v[76:79],v[36:39]
s_waitcnt lgkmcnt(5)
v_mfma_f32_16x16x32_bf16 v[32:35],a[160:163],v[80:83],v[32:35]
ds_read_b128 v[104:107],v7 offset:5120
v_mfma_f32_16x16x32_bf16 v[36:39],a[164:167],v[80:83],v[36:39]
s_waitcnt lgkmcnt(5)
v_mfma_f32_16x16x32_bf16 v[32:35],a[168:171],v[84:87],v[32:35]
ds_read_b128 v[108:111],v7 offset:6144
v_mfma_f32_16x16x32_bf16 v[36:39],a[172:175],v[84:87],v[36:39]
s_waitcnt lgkmcnt(5)
s_add_u32 s55,s55,32768
s_and_b32 s55,s55,0x1ffff
v_mfma_f32_16x16x32_bf16 v[32:35],a[176:179],v[88:91],v[32:35]
v_add_u32 v4,s55,v8
v_add_u32 v5,s55,v9
v_mfma_f32_16x16x32_bf16 v[36:39],a[180:183],v[88:91],v[36:39]
s_waitcnt lgkmcnt(4)
v_add_u32 v6,s55,v10
v_add_u32 v7,s55,v11
v_mfma_f32_16x16x32_bf16 v[32:35],a[184:187],v[92:95],v[32:35]
v_mfma_f32_16x16x32_bf16 v[36:39],a[188:191],v[92:95],v[36:39]
s_waitcnt lgkmcnt(3)
v_mfma_f32_16x16x32_bf16 v[32:35],a[192:195],v[96:99],v[32:35]
v_mfma_f32_16x16x32_bf16 v[36:39],a[196:199],v[96:99],v[36:39]
s_waitcnt lgkmcnt(2)
v_mfma_f32_16x16x32_bf16 v[32:35],a[200:203],v[100:103],v[32:35]
v_mfma_f32_16x16x32_bf16 v[36:39],a[204:207],v[100:103],v[36:39]
s_waitcnt lgkmcnt(1)
v_mfma_f32_16x16x32_bf16 v[32:35],a[208:211],v[104:107],v[32:35]
v_mfma_f32_16x16x32_bf16 v[36:39],a[212:215],v[104:107],v[36:39]
s_waitcnt lgkmcnt(0)
v_mfma_f32_16x16x32_bf16 v[40:43],a[216:219],v[108:111],v[32:35]
v_mfma_f32_16x16x32_bf16 v[44:47],a[220:223],v[108:111],v[36:39]
s_waitcnt vmcnt(0)
v_cmp_gt_u32 vcc,s71,v16
s_add_u32 s60,s60,1
s_branch endN_198
BN_190:
s_waitcnt vmcnt(8)
ds_read_b128 v[64:67],v4 offset:0
s_waitcnt vmcnt(7)
ds_read_b128 v[68:71],v4 offset:1024
s_waitcnt vmcnt(6)
ds_read_b128 v[72:75],v4 offset:2048
s_waitcnt vmcnt(5)
ds_read_b128 v[76:79],v4 offset:3072
s_waitcnt lgkmcnt(3)
v_mfma_f32_16x16x32_bf16 v[32:35],a[0:3],v[64:67],0
s_add_u32 s71,s60,2
s_add_u32 s53,s60,3
v_mfma_f32_16x16x32_bf16 v[36:39],a[4:7],v[64:67],0
s_waitcnt lgkmcnt(2)
s_waitcnt vmcnt(4)
ds_read_b128 v[80:83],v4 offset:4096
v_mfma_f32_16x16x32_bf16 v[32:35],a[8:11],v[68:71],v[32:35]
v_mfma_f32_16x16x32_bf16 v[36:39],a[12:15],v[68:71],v[36:39]
s_waitcnt lgkmcnt(2)
s_waitcnt vmcnt(3)
ds_read_b128 v[84:87],v4 offset:5120
v_mfma_f32_16x16x32_bf16 v[32:35],a[16:19],v[72:75],v[32:35]
v_mfma_f32_16x16x32_bf16 v[36:39],a[20:23],v[72:75],v[36:39]
s_waitcnt lgkmcnt(2)
s_waitcnt vmcnt(2)
ds_read_b128 v[88:91],v4 offset:6144
v_mfma_f32_16x16x32_bf16 v[32:35],a[24:27],v[76:79],v[32:35]
v_mfma_f32_16x16x32_bf16 v[36:39],a[28:31],v[76:79],v[36:39]
s_waitcnt lgkmcnt(2)
s_barrier
ds_read_b128 v[92:95],v5 offset:0
v_mfma_f32_16x16x32_bf16 v[32:35],a[32:35],v[80:83],v[32:35]
ds_read_b128 v[96:99],v5 offset:1024
v_mfma_f32_16x16x32_bf16 v[36:39],a[36:39],v[80:83],v[36:39]
s_waitcnt lgkmcnt(3)
ds_read_b128 v[100:103],v5 offset:2048
v_mfma_f32_16x16x32_bf16 v[32:35],a[40:43],v[84:87],v[32:35]
ds_read_b128 v[104:107],v5 offset:3072
v_mfma_f32_16x16x32_bf16 v[36:39],a[44:47],v[84:87],v[36:39]
s_waitcnt lgkmcnt(4)
ds_read_b128 v[108:111],v5 offset:4096
v_mfma_f32_16x16x32_bf16 v[32:35],a[48:51],v[88:91],v[32:35]
ds_read_b128 v[112:115],v5 offset:5120
v_mfma_f32_16x16x32_bf16 v[36:39],a[52:55],v[88:91],v[36:39]
s_waitcnt lgkmcnt(5)
v_mfma_f32_16x16x32_bf16 v[32:35],a[56:59],v[92:95],v[32:35]
ds_read_b128 v[116:119],v5 offset:6144
v_mfma_f32_16x16x32_bf16 v[36:39],a[60:63],v[92:95],v[36:39]
s_waitcnt lgkmcnt(5)
v_mfma_f32_16x16x32_bf16 v[32:35],a[64:67],v[96:99],v[32:35]
ds_read_b128 v[120:123],v6 offset:0
v_mfma_f32_16x16x32_bf16 v[36:39],a[68:71],v[96:99],v[36:39]
s_waitcnt lgkmcnt(5)
v_mfma_f32_16x16x32_bf16 v[32:35],a[72:75],v[100:103],v[32:35]
ds_read_b128 v[124:127],v6 offset:1024
v_mfma_f32_16x16x32_bf16 v[36:39],a[76:79],v[100:103],v[36:39]
s_waitcnt lgkmcnt(5)
v_mfma_f32_16x16x32_bf16 v[32:35],a[80:83],v[104:107],v[32:35]
ds_read_b128 v[64:67],v6 offset:2048
v_mfma_f32_16x16x32_bf16 v[36:39],a[84:87],v[104:107],v[36:39]
s_waitcnt lgkmcnt(5)
v_mfma_f32_16x16x32_bf16 v[32:35],a[88:91],v[108:111],v[32:35]
ds_read_b128 v[68:71],v6 offset:3072
v_mfma_f32_16x16x32_bf16 v[36:39],a[92:95],v[108:111],v[36:39]
s_waitcnt lgkmcnt(5)
v_mfma_f32_16x16x32_bf16 v[32:35],a[96:99],v[112:115],v[32:35]
ds_read_b128 v[72:75],v6 offset:4096
v_mfma_f32_16x16x32_bf16 v[36:39],a[100:103],v[112:115],v[36:39]
s_waitcnt lgkmcnt(5)
v_mfma_f32_16x16x32_bf16 v[32:35],a[104:107],v[116:119],v[32:35]
ds_read_b128 v[76:79],v6 offset:5120
v_mfma_f32_16x16x32_bf16 v[36:39],a[108:111],v[116:119],v[36:39]
s_waitcnt lgkmcnt(5)
v_mfma_f32_16x16x32_bf16 v[32:35],a[112:115],v[120:123],v[32:35]
ds_read_b128 v[80:83],v6 offset:6144
v_mfma_f32_16x16x32_bf16 v[36:39],a[116:119],v[120:123],v[36:39]
s_waitcnt lgkmcnt(5)
v_mfma_f32_16x16x32_bf16 v[32:35],a[120:123],v[124:127],v[32:35]
ds_read_b128 v[84:87],v7 offset:0
v_mfma_f32_16x16x32_bf16 v[36:39],a[124:127],v[124:127],v[36:39]
s_waitcnt lgkmcnt(5)
v_mfma_f32_16x16x32_bf16 v[32:35],a[128:131],v[64:67],v[32:35]
ds_read_b128 v[88:91],v7 offset:1024
v_mfma_f32_16x16x32_bf16 v[36:39],a[132:135],v[64:67],v[36:39]
s_waitcnt lgkmcnt(5)
v_mfma_f32_16x16x32_bf16 v[32:35],a[136:139],v[68:71],v[32:35]
ds_read_b128 v[92:95],v7 offset:2048
v_mfma_f32_16x16x32_bf16 v[36:39],a[140:143],v[68:71],v[36:39]
s_waitcnt lgkmcnt(5)
buffer_load_dword v16,v2,s[20:23],s68 offen sc1
v_mfma_f32_16x16x32_bf16 v[32:35],a[144:147],v[72:75],v[32:35]
ds_read_b128 v[96:99],v7 offset:3072
v_mfma_f32_16x16x32_bf16 v[36:39],a[148:151],v[72:75],v[36:39]
s_waitcnt lgkmcnt(5)
v_mfma_f32_16x16x32_bf16 v[32:35],a[152:155],v[76:79],v[32:35]
ds_read_b128 v[100:103],v7 offset:4096
v_mfma_f32_16x16x32_bf16 v[36:39],a[156:159],v[76:79],v[36:39]
s_waitcnt lgkmcnt(5)
v_mfma_f32_16x16x32_bf16 v[32:35],a[160:163],v[80:83],v[32:35]
ds_read_b128 v[104:107],v7 offset:5120
v_mfma_f32_16x16x32_bf16 v[36:39],a[164:167],v[80:83],v[36:39]
s_waitcnt lgkmcnt(5)
v_mfma_f32_16x16x32_bf16 v[32:35],a[168:171],v[84:87],v[32:35]
ds_read_b128 v[108:111],v7 offset:6144
v_mfma_f32_16x16x32_bf16 v[36:39],a[172:175],v[84:87],v[36:39]
s_waitcnt lgkmcnt(5)
s_add_u32 s55,s55,32768
s_and_b32 s55,s55,0x1ffff
v_mfma_f32_16x16x32_bf16 v[32:35],a[176:179],v[88:91],v[32:35]
v_add_u32 v4,s55,v8
v_add_u32 v5,s55,v9
v_mfma_f32_16x16x32_bf16 v[36:39],a[180:183],v[88:91],v[36:39]
s_waitcnt lgkmcnt(4)
v_add_u32 v6,s55,v10
v_add_u32 v7,s55,v11
v_mfma_f32_16x16x32_bf16 v[32:35],a[184:187],v[92:95],v[32:35]
v_mfma_f32_16x16x32_bf16 v[36:39],a[188:191],v[92:95],v[36:39]
s_waitcnt lgkmcnt(3)
v_mfma_f32_16x16x32_bf16 v[32:35],a[192:195],v[96:99],v[32:35]
v_mfma_f32_16x16x32_bf16 v[36:39],a[196:199],v[96:99],v[36:39]
s_waitcnt lgkmcnt(2)
v_mfma_f32_16x16x32_bf16 v[32:35],a[200:203],v[100:103],v[32:35]
v_mfma_f32_16x16x32_bf16 v[36:39],a[204:207],v[100:103],v[36:39]
s_waitcnt lgkmcnt(1)
v_mfma_f32_16x16x32_bf16 v[32:35],a[208:211],v[104:107],v[32:35]
v_mfma_f32_16x16x32_bf16 v[36:39],a[212:215],v[104:107],v[36:39]
s_waitcnt lgkmcnt(0)
v_mfma_f32_16x16x32_bf16 v[40:43],a[216:219],v[108:111],v[32:35]
v_mfma_f32_16x16x32_bf16 v[44:47],a[220:223],v[108:111],v[36:39]
s_waitcnt vmcnt(0)
v_cmp_gt_u32 vcc,s71,v16
s_add_u32 s60,s60,1
endN_198:
s_cbranch_vccnz nb_193
s_mov_b32 m0,s70
s_nop 0
buffer_load_dwordx4 v3,s[20:23],s61 offen offset:0 lds
buffer_load_dwordx4 v3,s[20:23],s61 offen offset:1024 lds
buffer_load_dwordx4 v3,s[20:23],s61 offen offset:2048 lds
buffer_load_dwordx4 v3,s[20:23],s61 offen offset:3072 lds
s_add_u32 m0,s70,4096
s_nop 0
buffer_load_dwordx4 v3,s[20:23],s62 offen offset:0 lds
buffer_load_dwordx4 v3,s[20:23],s62 offen offset:1024 lds
buffer_load_dwordx4 v3,s[20:23],s62 offen offset:2048 lds
s_add_u32 s61,s61,114688
s_add_u32 s62,s62,114688
s_add_u32 s70,s70,32768
s_and_b32 s70,s70,0x1ffff
s_add_u32 s64,s74,s75
s_cmp_eq_u32 s56,1
s_cbranch_scc1 b1_201
buffer_store_dwordx4 v[40:43],v0,s[20:23],s64 offen offset:0
buffer_store_dwordx4 v[44:47],v0,s[20:23],s64 offen offset:1024
b2_202:
s_add_u32 s75,s75,6144
s_cmp_eq_u32 s75,24576
s_cselect_b32 s75,0,s75
s_branch dec_192
nb_193:
buffer_load_dword v16,v2,s[20:23],s68 offen sc1
s_nop 3
s_add_u32 s64,s74,s75
s_cmp_eq_u32 s56,1
s_cbranch_scc1 b1_203
buffer_store_dwordx4 v[40:43],v0,s[20:23],s64 offen offset:0
buffer_store_dwordx4 v[44:47],v0,s[20:23],s64 offen offset:1024
b2_204:
s_add_u32 s75,s75,6144
s_cmp_eq_u32 s75,24576
s_cselect_b32 s75,0,s75
s_waitcnt vmcnt(2)
v_cmp_gt_u32 vcc,s71,v16
s_cbranch_vccz lag_191
s_cmp_ge_u32 s60,128
s_cbranch_scc1 done_171
plp_205:
buffer_load_dword v16,v2,s[20:23],s68 offen sc1
s_waitcnt vmcnt(0)
v_cmp_gt_u32 vcc,s71,v16
s_cbranch_vccz pok_206
s_sleep 4
s_sub_u32 s90,s90,1
s_cmp_gt_i32 s90,0
s_cbranch_scc1 plp_205
pok_206:
s_branch lag_191
lfin_184:
s_add_u32 s71,s60,1
s_add_u32 s53,s60,2
plp_226:
buffer_load_dword v16,v2,s[20:23],s68 offen sc1
s_waitcnt vmcnt(0)
v_cmp_gt_u32 vcc,s71,v16
s_cbranch_vccz pok_227
s_sleep 4
s_sub_u32 s90,s90,1
s_cmp_gt_i32 s90,0
s_cbranch_scc1 plp_226
pok_227:
lag_223:
s_mov_b32 m0,s70
s_nop 0
buffer_load_dwordx4 v3,s[20:23],s61 offen offset:0 lds
buffer_load_dwordx4 v3,s[20:23],s61 offen offset:1024 lds
buffer_load_dwordx4 v3,s[20:23],s61 offen offset:2048 lds
buffer_load_dwordx4 v3,s[20:23],s61 offen offset:3072 lds
s_add_u32 m0,s70,4096
s_nop 0
buffer_load_dwordx4 v3,s[20:23],s62 offen offset:0 lds
buffer_load_dwordx4 v3,s[20:23],s62 offen offset:1024 lds
buffer_load_dwordx4 v3,s[20:23],s62 offen offset:2048 lds
s_add_u32 s61,s61,114688
s_add_u32 s62,s62,114688
s_add_u32 s70,s70,32768
s_and_b32 s70,s70,0x1ffff
dec_224:
v_cmp_gt_u32 vcc,s53,v16
s_cbranch_vccnz BN_222
BR_221:
s_waitcnt vmcnt(6)
ds_read_b128 v[64:67],v4 offset:0
s_waitcnt vmcnt(5)
ds_read_b128 v[68:71],v4 offset:1024
s_waitcnt vmcnt(4)
ds_read_b128 v[72:75],v4 offset:2048
s_waitcnt vmcnt(3)
ds_read_b128 v[76:79],v4 offset:3072
s_waitcnt lgkmcnt(3)
v_mfma_f32_16x16x32_bf16 v[32:35],a[0:3],v[64:67],0
s_add_u32 s71,s60,2
s_add_u32 s53,s60,3
v_mfma_f32_16x16x32_bf16 v[36:39],a[4:7],v[64:67],0
s_waitcnt lgkmcnt(2)
s_waitcnt vmcnt(2)
ds_read_b128 v[80:83],v4 offset:4096
v_mfma_f32_16x16x32_bf16 v[32:35],a[8:11],v[68:71],v[32:35]
v_mfma_f32_16x16x32_bf16 v[36:39],a[12:15],v[68:71],v[36:39]
s_waitcnt lgkmcnt(2)
s_waitcnt vmcnt(1)
s_mov_b32 m0,s70
ds_read_b128 v[84:87],v4 offset:5120
v_mfma_f32_16x16x32_bf16 v[32:35],a[16:19],v[72:75],v[32:35]
buffer_load_dwordx4 v3,s[20:23],s61 offen offset:0 lds
v_mfma_f32_16x16x32_bf16 v[36:39],a[20:23],v[72:75],v[36:39]
s_waitcnt lgkmcnt(2)
s_waitcnt vmcnt(1)
ds_read_b128 v[88:91],v4 offset:6144
v_mfma_f32_16x16x32_bf16 v[32:35],a[24:27],v[76:79],v[32:35]
buffer_load_dwordx4 v3,s[20:23],s61 offen offset:1024 lds
v_mfma_f32_16x16x32_bf16 v[36:39],a[28:31],v[76:79],v[36:39]
s_waitcnt lgkmcnt(2)
s_barrier
ds_read_b128 v[92:95],v5 offset:0
v_mfma_f32_16x16x32_bf16 v[32:35],a[32:35],v[80:83],v[32:35]
ds_read_b128 v[96:99],v5 offset:1024
v_mfma_f32_16x16x32_bf16 v[36:39],a[36:39],v[80:83],v[36:39]
s_waitcnt lgkmcnt(3)
ds_read_b128 v[100:103],v5 offset:2048
buffer_load_dwordx4 v3,s[20:23],s61 offen offset:2048 lds
v_mfma_f32_16x16x32_bf16 v[32:35],a[40:43],v[84:87],v[32:35]
ds_read_b128 v[104:107],v5 offset:3072
v_mfma_f32_16x16x32_bf16 v[36:39],a[44:47],v[84:87],v[36:39]
s_waitcnt lgkmcnt(4)
ds_read_b128 v[108:111],v5 offset:4096
v_mfma_f32_16x16x32_bf16 v[32:35],a[48:51],v[88:91],v[32:35]
ds_read_b128 v[112:115],v5 offset:5120
buffer_load_dwordx4 v3,s[20:23],s61 offen offset:3072 lds
v_mfma_f32_16x16x32_bf16 v[36:39],a[52:55],v[88:91],v[36:39]
s_waitcnt lgkmcnt(5)
v_mfma_f32_16x16x32_bf16 v[32:35],a[56:59],v[92:95],v[32:35]
s_cmp_eq_u32 s77,0
s_cselect_b32 s57,2.0,0
ds_read_b128 v[116:119],v5 offset:6144
v_mfma_f32_16x16x32_bf16 v[36:39],a[60:63],v[92:95],v[36:39]
s_waitcnt lgkmcnt(5)
s_add_u32 m0,s70,4096
v_or_b32 v21,s57,v0
v_mfma_f32_16x16x32_bf16 v[32:35],a[64:67],v[96:99],v[32:35]
ds_read_b128 v[120:123],v6 offset:0
buffer_load_dwordx4 v3,s[20:23],s62 offen offset:0 lds
v_mfma_f32_16x16x32_bf16 v[36:39],a[68:71],v[96:99],v[36:39]
s_waitcnt lgkmcnt(5)
v_or_b32 v22,s57,v18
v_lshlrev_b32 v168,16,v160
v_mfma_f32_16x16x32_bf16 v[32:35],a[72:75],v[100:103],v[32:35]
ds_read_b128 v[124:127],v6 offset:1024
v_and_b32 v169,s73,v160
v_mfma_f32_16x16x32_bf16 v[36:39],a[76:79],v[100:103],v[36:39]
s_waitcnt lgkmcnt(5)
buffer_load_dwordx4 v3,s[20:23],s62 offen offset:1024 lds
v_lshlrev_b32 v170,16,v161
v_mfma_f32_16x16x32_bf16 v[32:35],a[80:83],v[104:107],v[32:35]
ds_read_b128 v[64:67],v6 offset:2048
v_and_b32 v171,s73,v161
v_mfma_f32_16x16x32_bf16 v[36:39],a[84:87],v[104:107],v[36:39]
s_waitcnt lgkmcnt(5)
buffer_load_dword v16,v2,s[20:23],s68 offen sc1
v_lshlrev_b32 v172,16,v162
v_mfma_f32_16x16x32_bf16 v[32:35],a[88:91],v[108:111],v[32:35]
ds_read_b128 v[68:71],v6 offset:3072
buffer_load_dwordx4 v3,s[20:23],s62 offen offset:2048 lds
v_mfma_f32_16x16x32_bf16 v[36:39],a[92:95],v[108:111],v[36:39]
s_waitcnt lgkmcnt(5)
v_and_b32 v173,s73,v162
v_lshlrev_b32 v174,16,v163
v_mfma_f32_16x16x32_bf16 v[32:35],a[96:99],v[112:115],v[32:35]
s_add_u32 s84,s74,s75
s_add_u32 s85,s84,4096
ds_read_b128 v[72:75],v6 offset:4096
v_mfma_f32_16x16x32_bf16 v[36:39],a[100:103],v[112:115],v[36:39]
s_waitcnt lgkmcnt(5)
buffer_load_dwordx4 v[128:131],v0,s[20:23],s84 offen offset:0 sc1
v_and_b32 v175,s73,v163
v_mfma_f32_16x16x32_bf16 v[32:35],a[104:107],v[116:119],v[32:35]
ds_read_b128 v[76:79],v6 offset:5120
v_lshlrev_b32 v176,16,v164
v_mfma_f32_16x16x32_bf16 v[36:39],a[108:111],v[116:119],v[36:39]
s_waitcnt lgkmcnt(5)
buffer_load_dwordx4 v[132:135],v0,s[20:23],s84 offen offset:1024 sc1
v_and_b32 v177,s73,v164
v_mfma_f32_16x16x32_bf16 v[32:35],a[112:115],v[120:123],v[32:35]
ds_read_b128 v[80:83],v6 offset:6144
v_lshlrev_b32 v178,16,v165
v_mfma_f32_16x16x32_bf16 v[36:39],a[116:119],v[120:123],v[36:39]
s_waitcnt lgkmcnt(5)
buffer_load_dwordx4 v[136:139],v0,s[20:23],s84 offen offset:2048 sc1
v_and_b32 v179,s73,v165
v_mfma_f32_16x16x32_bf16 v[32:35],a[120:123],v[124:127],v[32:35]
ds_read_b128 v[84:87],v7 offset:0
v_lshlrev_b32 v180,16,v166
v_mfma_f32_16x16x32_bf16 v[36:39],a[124:127],v[124:127],v[36:39]
s_waitcnt lgkmcnt(5)
buffer_load_dwordx4 v[140:143],v0,s[20:23],s84 offen offset:3072 sc1
v_and_b32 v181,s73,v166
v_mfma_f32_16x16x32_bf16 v[32:35],a[128:131],v[64:67],v[32:35]
ds_read_b128 v[88:91],v7 offset:1024
v_lshlrev_b32 v182,16,v167
v_mfma_f32_16x16x32_bf16 v[36:39],a[132:135],v[64:67],v[36:39]
s_waitcnt lgkmcnt(5)
buffer_load_dwordx4 v[144:147],v0,s[20:23],s85 offen offset:0 sc1
v_and_b32 v183,s73,v167
v_mfma_f32_16x16x32_bf16 v[32:35],a[136:139],v[68:71],v[32:35]
ds_read_b128 v[92:95],v7 offset:2048
v_add_f32 v212,v212,v176
v_mfma_f32_16x16x32_bf16 v[36:39],a[140:143],v[68:71],v[36:39]
s_waitcnt lgkmcnt(5)
buffer_load_dwordx4 v[148:151],v0,s[20:23],s85 offen offset:1024 sc1
v_add_f32 v213,v213,v177
v_mfma_f32_16x16x32_bf16 v[32:35],a[144:147],v[72:75],v[32:35]
ds_read_b128 v[96:99],v7 offset:3072
v_add_f32 v214,v214,v178
v_mfma_f32_16x16x32_bf16 v[36:39],a[148:151],v[72:75],v[36:39]
s_waitcnt lgkmcnt(5)
v_add_f32 v215,v215,v179
v_add_f32 v216,v216,v180
v_mfma_f32_16x16x32_bf16 v[32:35],a[152:155],v[76:79],v[32:35]
ds_read_b128 v[100:103],v7 offset:4096
v_add_f32 v217,v217,v181
v_mfma_f32_16x16x32_bf16 v[36:39],a[156:159],v[76:79],v[36:39]
s_waitcnt lgkmcnt(5)
v_add_f32 v218,v218,v182
v_add_f32 v219,v219,v183
v_mfma_f32_16x16x32_bf16 v[32:35],a[160:163],v[80:83],v[32:35]
ds_read_b128 v[104:107],v7 offset:5120
v_fma_f32 v168,v212,v152,v168
v_mfma_f32_16x16x32_bf16 v[36:39],a[164:167],v[80:83],v[36:39]
s_waitcnt lgkmcnt(5)
v_fma_f32 v169,v213,v153,v169
v_fma_f32 v170,v214,v154,v170
v_mfma_f32_16x16x32_bf16 v[32:35],a[168:171],v[84:87],v[32:35]
ds_read_b128 v[108:111],v7 offset:6144
v_fma_f32 v171,v215,v155,v171
v_mfma_f32_16x16x32_bf16 v[36:39],a[172:175],v[84:87],v[36:39]
s_waitcnt lgkmcnt(5)
v_fma_f32 v172,v216,v156,v172
v_fma_f32 v173,v217,v157,v173
v_mfma_f32_16x16x32_bf16 v[32:35],a[176:179],v[88:91],v[32:35]
s_add_u32 s61,s61,114688
v_fma_f32 v174,v218,v158,v174
v_fma_f32 v175,v219,v159,v175
v_mfma_f32_16x16x32_bf16 v[36:39],a[180:183],v[88:91],v[36:39]
s_waitcnt lgkmcnt(4)
s_add_u32 s62,s62,114688
buffer_load_dwordx4 v[160:163],v0,s[20:23],s82 offen
v_mfma_f32_16x16x32_bf16 v[32:35],a[184:187],v[92:95],v[32:35]
s_add_u32 s70,s70,32768
s_add_u32 s64,s82,13631488
buffer_load_dwordx4 v[164:167],v0,s[20:23],s64 offen
v_mfma_f32_16x16x32_bf16 v[36:39],a[188:191],v[92:95],v[36:39]
s_waitcnt lgkmcnt(3)
s_add_u32 s82,s82,32768
s_and_b32 s70,s70,0x1ffff
v_mfma_f32_16x16x32_bf16 v[32:35],a[192:195],v[96:99],v[32:35]
s_add_u32 s55,s55,32768
s_and_b32 s55,s55,0x1ffff
v_add_u32 v4,s55,v8
v_mfma_f32_16x16x32_bf16 v[36:39],a[196:199],v[96:99],v[36:39]
s_waitcnt lgkmcnt(2)
v_add_u32 v5,s55,v9
v_add_u32 v6,s55,v10
v_mfma_f32_16x16x32_bf16 v[32:35],a[200:203],v[100:103],v[32:35]
s_waitcnt vmcnt(2)
s_cmp_eq_u32 s77,0
s_cbranch_scc1 go_236
ck_234:
v_max3_u32 v184,v128,v129,v130
v_max3_u32 v185,v140,v141,v142
v_max3_u32 v184,v184,v131,v132
v_max3_u32 v185,v185,v143,v144
v_max3_u32 v184,v184,v133,v134
v_max3_u32 v185,v185,v145,v146
v_max3_u32 v184,v184,v135,v136
v_max3_u32 v185,v185,v147,v148
v_max3_u32 v184,v184,v137,v138
v_max3_u32 v185,v185,v149,v150
v_max3_u32 v184,v184,v139,v151
v_max_u32 v184,v184,v185
v_cmp_eq_u32 vcc,-1,v184
s_cbranch_vccnz rt_235
go_236:
v_mfma_f32_16x16x32_bf16 v[36:39],a[204:207],v[100:103],v[36:39]
s_waitcnt lgkmcnt(1)
v_add_u32 v7,s55,v11
v_add_f32 v128,v128,v136
v_add_f32 v129,v129,v137
v_mfma_f32_16x16x32_bf16 v[32:35],a[208:211],v[104:107],v[32:35]
ds_read_b128 v[64:67],v4 offset:0
v_add_f32 v130,v130,v138
v_add_f32 v131,v131,v139
v_mfma_f32_16x16x32_bf16 v[36:39],a[212:215],v[104:107],v[36:39]
s_waitcnt lgkmcnt(1)
ds_read_b128 v[68:71],v4 offset:1024
v_add_f32 v132,v132,v140
v_mfma_f32_16x16x32_bf16 v[40:43],a[216:219],v[108:111],v[32:35]
ds_read_b128 v[72:75],v4 offset:2048
v_add_f32 v133,v133,v141
v_add_f32 v134,v134,v142
v_mfma_f32_16x16x32_bf16 v[44:47],a[220:223],v[108:111],v[36:39]
v_add_f32 v135,v135,v143
v_add_f32 v128,v128,v144
v_add_f32 v129,v129,v145
v_add_f32 v130,v130,v146
v_add_f32 v131,v131,v147
v_add_f32 v132,v132,v148
v_add_f32 v133,v133,v149
v_add_f32 v134,v134,v150
v_add_f32 v135,v135,v151
v_fma_f32 v168,v128,v152,v168
v_fma_f32 v169,v129,v153,v169
v_fma_f32 v170,v130,v154,v170
v_fma_f32 v171,v131,v155,v171
v_fma_f32 v172,v132,v156,v172
v_fma_f32 v173,v133,v157,v173
v_fma_f32 v174,v134,v158,v174
v_fma_f32 v175,v135,v159,v175
v_cvt_pk_bf16_f32 v176,v168,v169
v_cvt_pk_bf16_f32 v177,v170,v171
v_cvt_pk_bf16_f32 v178,v172,v173
v_cvt_pk_bf16_f32 v179,v174,v175
s_and_b32 s64,s66,0xffff8000
buffer_store_dwordx4 v[176:179],v22,s[24:27],s64 offen
s_cmp_eq_u32 s56,1
s_cbranch_scc1 b1_228
buffer_store_dwordx4 v[204:207],v21,s[20:23],s84 offen offset:0
buffer_store_dwordx4 v[204:207],v21,s[20:23],s84 offen offset:1024
b2_229:
s_cmp_eq_u32 s56,1
s_cbranch_scc1 b1_230
buffer_store_dwordx4 v[204:207],v21,s[20:23],s84 offen offset:2048
buffer_store_dwordx4 v[204:207],v21,s[20:23],s84 offen offset:3072
b2_231:
s_cmp_eq_u32 s56,1
s_cbranch_scc1 b1_232
buffer_store_dwordx4 v[204:207],v21,s[20:23],s85 offen offset:0
buffer_store_dwordx4 v[204:207],v21,s[20:23],s85 offen offset:1024
b2_233:
s_mul_i32 s64,s77,32768
s_add_u32 s66,s66,s64
s_mul_i32 s64,s77,6144
s_add_u32 s75,s75,s64
s_cmp_eq_u32 s75,24576
s_cselect_b32 s75,0,s75
s_add_u32 s63,s63,s77
s_mov_b32 s77,0
v_cmp_gt_u32 vcc,s53,v16
s_add_u32 s60,s60,1
s_cbranch_vccnz WN_220
.p2align 6
WR_219:
s_waitcnt lgkmcnt(2)
v_mfma_f32_16x16x32_bf16 v[32:35],a[0:3],v[64:67],0
s_waitcnt vmcnt(19)
s_add_u32 s71,s60,2
ds_read_b128 v[76:79],v4 offset:3072
v_mfma_f32_16x16x32_bf16 v[36:39],a[4:7],v[64:67],0
s_waitcnt lgkmcnt(2)
s_add_u32 s53,s60,3
v_mfma_f32_16x16x32_bf16 v[32:35],a[8:11],v[68:71],v[32:35]
s_waitcnt vmcnt(18)
s_mov_b32 m0,s70
ds_read_b128 v[80:83],v4 offset:4096
v_mfma_f32_16x16x32_bf16 v[36:39],a[12:15],v[68:71],v[36:39]
s_waitcnt lgkmcnt(2)
buffer_load_dwordx4 v3,s[20:23],s61 offen offset:0 lds
v_mov_b32 v212,v40
v_mfma_f32_16x16x32_bf16 v[32:35],a[16:19],v[72:75],v[32:35]
s_waitcnt vmcnt(18)
ds_read_b128 v[84:87],v4 offset:5120
v_mov_b32 v213,v41
v_mfma_f32_16x16x32_bf16 v[36:39],a[20:23],v[72:75],v[36:39]
s_waitcnt lgkmcnt(2)
v_mov_b32 v214,v42
v_mov_b32 v215,v43
v_mfma_f32_16x16x32_bf16 v[32:35],a[24:27],v[76:79],v[32:35]
s_waitcnt vmcnt(16)
ds_read_b128 v[88:91],v4 offset:6144
buffer_load_dwordx4 v3,s[20:23],s61 offen offset:1024 lds
v_mfma_f32_16x16x32_bf16 v[36:39],a[28:31],v[76:79],v[36:39]
s_waitcnt lgkmcnt(2)
s_barrier
ds_read_b128 v[92:95],v5 offset:0
v_mfma_f32_16x16x32_bf16 v[32:35],a[32:35],v[80:83],v[32:35]
ds_read_b128 v[96:99],v5 offset:1024
v_mov_b32 v216,v44
v_mfma_f32_16x16x32_bf16 v[36:39],a[36:39],v[80:83],v[36:39]
s_waitcnt lgkmcnt(3)
ds_read_b128 v[100:103],v5 offset:2048
buffer_load_dwordx4 v3,s[20:23],s61 offen offset:2048 lds
v_mfma_f32_16x16x32_bf16 v[32:35],a[40:43],v[84:87],v[32:35]
ds_read_b128 v[104:107],v5 offset:3072
v_mov_b32 v217,v45
v_mfma_f32_16x16x32_bf16 v[36:39],a[44:47],v[84:87],v[36:39]
s_waitcnt lgkmcnt(4)
ds_read_b128 v[108:111],v5 offset:4096
v_mov_b32 v218,v46
v_mfma_f32_16x16x32_bf16 v[32:35],a[48:51],v[88:91],v[32:35]
ds_read_b128 v[112:115],v5 offset:5120
buffer_load_dwordx4 v3,s[20:23],s61 offen offset:3072 lds
v_mfma_f32_16x16x32_bf16 v[36:39],a[52:55],v[88:91],v[36:39]
s_waitcnt lgkmcnt(5)
v_mov_b32 v219,v47
v_mfma_f32_16x16x32_bf16 v[32:35],a[56:59],v[92:95],v[32:35]
s_mov_b32 s77,1
s_waitcnt vmcnt(11)
s_cmp_eq_u32 s77,0
s_cselect_b32 s57,2.0,0
ds_read_b128 v[116:119],v5 offset:6144
v_mfma_f32_16x16x32_bf16 v[36:39],a[60:63],v[92:95],v[36:39]
s_waitcnt lgkmcnt(5)
s_add_u32 m0,s70,4096
v_or_b32 v21,s57,v0
v_mfma_f32_16x16x32_bf16 v[32:35],a[64:67],v[96:99],v[32:35]
ds_read_b128 v[120:123],v6 offset:0
buffer_load_dwordx4 v3,s[20:23],s62 offen offset:0 lds
v_mfma_f32_16x16x32_bf16 v[36:39],a[68:71],v[96:99],v[36:39]
s_waitcnt lgkmcnt(5)
v_or_b32 v22,s57,v18
v_lshlrev_b32 v168,16,v160
v_mfma_f32_16x16x32_bf16 v[32:35],a[72:75],v[100:103],v[32:35]
ds_read_b128 v[124:127],v6 offset:1024
v_and_b32 v169,s73,v160
v_mfma_f32_16x16x32_bf16 v[36:39],a[76:79],v[100:103],v[36:39]
s_waitcnt lgkmcnt(5)
buffer_load_dwordx4 v3,s[20:23],s62 offen offset:1024 lds
v_lshlrev_b32 v170,16,v161
v_mfma_f32_16x16x32_bf16 v[32:35],a[80:83],v[104:107],v[32:35]
ds_read_b128 v[64:67],v6 offset:2048
v_and_b32 v171,s73,v161
v_mfma_f32_16x16x32_bf16 v[36:39],a[84:87],v[104:107],v[36:39]
s_waitcnt lgkmcnt(5)
buffer_load_dword v16,v2,s[20:23],s68 offen sc1
v_lshlrev_b32 v172,16,v162
v_mfma_f32_16x16x32_bf16 v[32:35],a[88:91],v[108:111],v[32:35]
ds_read_b128 v[68:71],v6 offset:3072
buffer_load_dwordx4 v3,s[20:23],s62 offen offset:2048 lds
v_mfma_f32_16x16x32_bf16 v[36:39],a[92:95],v[108:111],v[36:39]
s_waitcnt lgkmcnt(5)
v_and_b32 v173,s73,v162
v_lshlrev_b32 v174,16,v163
v_mfma_f32_16x16x32_bf16 v[32:35],a[96:99],v[112:115],v[32:35]
s_add_u32 s84,s74,s75
s_add_u32 s85,s84,4096
ds_read_b128 v[72:75],v6 offset:4096
v_mfma_f32_16x16x32_bf16 v[36:39],a[100:103],v[112:115],v[36:39]
s_waitcnt lgkmcnt(5)
buffer_load_dwordx4 v[128:131],v0,s[20:23],s84 offen offset:0 sc1
v_and_b32 v175,s73,v163
v_mfma_f32_16x16x32_bf16 v[32:35],a[104:107],v[116:119],v[32:35]
ds_read_b128 v[76:79],v6 offset:5120
v_lshlrev_b32 v176,16,v164
v_mfma_f32_16x16x32_bf16 v[36:39],a[108:111],v[116:119],v[36:39]
s_waitcnt lgkmcnt(5)
buffer_load_dwordx4 v[132:135],v0,s[20:23],s84 offen offset:1024 sc1
v_and_b32 v177,s73,v164
v_mfma_f32_16x16x32_bf16 v[32:35],a[112:115],v[120:123],v[32:35]
ds_read_b128 v[80:83],v6 offset:6144
v_lshlrev_b32 v178,16,v165
v_mfma_f32_16x16x32_bf16 v[36:39],a[116:119],v[120:123],v[36:39]
s_waitcnt lgkmcnt(5)
buffer_load_dwordx4 v[136:139],v0,s[20:23],s84 offen offset:2048 sc1
v_and_b32 v179,s73,v165
v_mfma_f32_16x16x32_bf16 v[32:35],a[120:123],v[124:127],v[32:35]
ds_read_b128 v[84:87],v7 offset:0
v_lshlrev_b32 v180,16,v166
v_mfma_f32_16x16x32_bf16 v[36:39],a[124:127],v[124:127],v[36:39]
s_waitcnt lgkmcnt(5)
buffer_load_dwordx4 v[140:143],v0,s[20:23],s84 offen offset:3072 sc1
v_and_b32 v181,s73,v166
v_mfma_f32_16x16x32_bf16 v[32:35],a[128:131],v[64:67],v[32:35]
ds_read_b128 v[88:91],v7 offset:1024
v_lshlrev_b32 v182,16,v167
v_mfma_f32_16x16x32_bf16 v[36:39],a[132:135],v[64:67],v[36:39]
s_waitcnt lgkmcnt(5)
buffer_load_dwordx4 v[144:147],v0,s[20:23],s85 offen offset:0 sc1
v_and_b32 v183,s73,v167
v_mfma_f32_16x16x32_bf16 v[32:35],a[136:139],v[68:71],v[32:35]
ds_read_b128 v[92:95],v7 offset:2048
v_add_f32 v212,v212,v176
v_mfma_f32_16x16x32_bf16 v[36:39],a[140:143],v[68:71],v[36:39]
s_waitcnt lgkmcnt(5)
buffer_load_dwordx4 v[148:151],v0,s[20:23],s85 offen offset:1024 sc1
v_add_f32 v213,v213,v177
v_mfma_f32_16x16x32_bf16 v[32:35],a[144:147],v[72:75],v[32:35]
ds_read_b128 v[96:99],v7 offset:3072
v_add_f32 v214,v214,v178
v_mfma_f32_16x16x32_bf16 v[36:39],a[148:151],v[72:75],v[36:39]
s_waitcnt lgkmcnt(5)
v_add_f32 v215,v215,v179
v_add_f32 v216,v216,v180
v_mfma_f32_16x16x32_bf16 v[32:35],a[152:155],v[76:79],v[32:35]
ds_read_b128 v[100:103],v7 offset:4096
v_add_f32 v217,v217,v181
v_mfma_f32_16x16x32_bf16 v[36:39],a[156:159],v[76:79],v[36:39]
s_waitcnt lgkmcnt(5)
v_add_f32 v218,v218,v182
v_add_f32 v219,v219,v183
v_mfma_f32_16x16x32_bf16 v[32:35],a[160:163],v[80:83],v[32:35]
ds_read_b128 v[104:107],v7 offset:5120
v_fma_f32 v168,v212,v152,v168
v_mfma_f32_16x16x32_bf16 v[36:39],a[164:167],v[80:83],v[36:39]
s_waitcnt lgkmcnt(5)
v_fma_f32 v169,v213,v153,v169
v_fma_f32 v170,v214,v154,v170
v_mfma_f32_16x16x32_bf16 v[32:35],a[168:171],v[84:87],v[32:35]
ds_read_b128 v[108:111],v7 offset:6144
v_fma_f32 v171,v215,v155,v171
v_mfma_f32_16x16x32_bf16 v[36:39],a[172:175],v[84:87],v[36:39]
s_waitcnt lgkmcnt(5)
v_fma_f32 v172,v216,v156,v172
v_fma_f32 v173,v217,v157,v173
v_mfma_f32_16x16x32_bf16 v[32:35],a[176:179],v[88:91],v[32:35]
s_add_u32 s61,s61,114688
v_fma_f32 v174,v218,v158,v174
v_fma_f32 v175,v219,v159,v175
v_mfma_f32_16x16x32_bf16 v[36:39],a[180:183],v[88:91],v[36:39]
s_waitcnt lgkmcnt(4)
s_add_u32 s62,s62,114688
buffer_load_dwordx4 v[160:163],v0,s[20:23],s82 offen
v_mfma_f32_16x16x32_bf16 v[32:35],a[184:187],v[92:95],v[32:35]
s_add_u32 s70,s70,32768
s_add_u32 s64,s82,13631488
buffer_load_dwordx4 v[164:167],v0,s[20:23],s64 offen
v_mfma_f32_16x16x32_bf16 v[36:39],a[188:191],v[92:95],v[36:39]
s_waitcnt lgkmcnt(3)
s_add_u32 s82,s82,32768
s_and_b32 s70,s70,0x1ffff
v_mfma_f32_16x16x32_bf16 v[32:35],a[192:195],v[96:99],v[32:35]
s_add_u32 s55,s55,32768
s_and_b32 s55,s55,0x1ffff
v_add_u32 v4,s55,v8
v_mfma_f32_16x16x32_bf16 v[36:39],a[196:199],v[96:99],v[36:39]
s_waitcnt lgkmcnt(2)
v_add_u32 v5,s55,v9
v_add_u32 v6,s55,v10
v_mfma_f32_16x16x32_bf16 v[32:35],a[200:203],v[100:103],v[32:35]
s_waitcnt vmcnt(2)
s_cmp_eq_u32 s77,0
s_cbranch_scc1 go_245
ck_243:
v_max3_u32 v184,v128,v129,v130
v_max3_u32 v185,v140,v141,v142
v_max3_u32 v184,v184,v131,v132
v_max3_u32 v185,v185,v143,v144
v_max3_u32 v184,v184,v133,v134
v_max3_u32 v185,v185,v145,v146
v_max3_u32 v184,v184,v135,v136
v_max3_u32 v185,v185,v147,v148
v_max3_u32 v184,v184,v137,v138
v_max3_u32 v185,v185,v149,v150
v_max3_u32 v184,v184,v139,v151
v_max_u32 v184,v184,v185
v_cmp_eq_u32 vcc,-1,v184
s_cbranch_vccnz rt_244
go_245:
v_mfma_f32_16x16x32_bf16 v[36:39],a[204:207],v[100:103],v[36:39]
s_waitcnt lgkmcnt(1)
v_add_u32 v7,s55,v11
v_add_f32 v128,v128,v136
v_add_f32 v129,v129,v137
v_mfma_f32_16x16x32_bf16 v[32:35],a[208:211],v[104:107],v[32:35]
ds_read_b128 v[64:67],v4 offset:0
v_add_f32 v130,v130,v138
v_add_f32 v131,v131,v139
v_mfma_f32_16x16x32_bf16 v[36:39],a[212:215],v[104:107],v[36:39]
s_waitcnt lgkmcnt(1)
ds_read_b128 v[68:71],v4 offset:1024
v_add_f32 v132,v132,v140
v_mfma_f32_16x16x32_bf16 v[40:43],a[216:219],v[108:111],v[32:35]
ds_read_b128 v[72:75],v4 offset:2048
v_add_f32 v133,v133,v141
v_add_f32 v134,v134,v142
v_mfma_f32_16x16x32_bf16 v[44:47],a[220:223],v[108:111],v[36:39]
v_add_f32 v135,v135,v143
v_add_f32 v128,v128,v144
v_add_f32 v129,v129,v145
v_add_f32 v130,v130,v146
v_add_f32 v131,v131,v147
v_add_f32 v132,v132,v148
v_add_f32 v133,v133,v149
v_add_f32 v134,v134,v150
v_add_f32 v135,v135,v151
v_fma_f32 v168,v128,v152,v168
v_fma_f32 v169,v129,v153,v169
v_fma_f32 v170,v130,v154,v170
v_fma_f32 v171,v131,v155,v171
v_fma_f32 v172,v132,v156,v172
v_fma_f32 v173,v133,v157,v173
v_fma_f32 v174,v134,v158,v174
v_fma_f32 v175,v135,v159,v175
v_cvt_pk_bf16_f32 v176,v168,v169
v_cvt_pk_bf16_f32 v177,v170,v171
v_cvt_pk_bf16_f32 v178,v172,v173
v_cvt_pk_bf16_f32 v179,v174,v175
s_and_b32 s64,s66,0xffff8000
buffer_store_dwordx4 v[176:179],v22,s[24:27],s64 offen
s_cmp_eq_u32 s56,1
s_cbranch_scc1 b1_237
buffer_store_dwordx4 v[204:207],v21,s[20:23],s84 offen offset:0
buffer_store_dwordx4 v[204:207],v21,s[20:23],s84 offen offset:1024
b2_238:
s_cmp_eq_u32 s56,1
s_cbranch_scc1 b1_239
buffer_store_dwordx4 v[204:207],v21,s[20:23],s84 offen offset:2048
buffer_store_dwordx4 v[204:207],v21,s[20:23],s84 offen offset:3072
b2_240:
s_cmp_eq_u32 s56,1
s_cbranch_scc1 b1_241
buffer_store_dwordx4 v[204:207],v21,s[20:23],s85 offen offset:0
buffer_store_dwordx4 v[204:207],v21,s[20:23],s85 offen offset:1024
b2_242:
s_mul_i32 s64,s77,32768
s_add_u32 s66,s66,s64
s_mul_i32 s64,s77,6144
s_add_u32 s75,s75,s64
s_cmp_eq_u32 s75,24576
s_cselect_b32 s75,0,s75
s_add_u32 s63,s63,s77
s_mov_b32 s77,0
v_cmp_gt_u32 vcc,s53,v16
s_add_u32 s60,s60,1
s_cbranch_vccz WR_219
WN_220:
s_waitcnt lgkmcnt(2)
v_mfma_f32_16x16x32_bf16 v[32:35],a[0:3],v[64:67],0
s_waitcnt vmcnt(19)
s_add_u32 s71,s60,2
ds_read_b128 v[76:79],v4 offset:3072
v_mfma_f32_16x16x32_bf16 v[36:39],a[4:7],v[64:67],0
s_waitcnt lgkmcnt(2)
s_add_u32 s53,s60,3
v_mfma_f32_16x16x32_bf16 v[32:35],a[8:11],v[68:71],v[32:35]
s_waitcnt vmcnt(18)
ds_read_b128 v[80:83],v4 offset:4096
v_mov_b32 v212,v40
v_mfma_f32_16x16x32_bf16 v[36:39],a[12:15],v[68:71],v[36:39]
s_waitcnt lgkmcnt(2)
v_mov_b32 v213,v41
v_mov_b32 v214,v42
v_mfma_f32_16x16x32_bf16 v[32:35],a[16:19],v[72:75],v[32:35]
s_waitcnt vmcnt(17)
ds_read_b128 v[84:87],v4 offset:5120
v_mov_b32 v215,v43
v_mfma_f32_16x16x32_bf16 v[36:39],a[20:23],v[72:75],v[36:39]
s_waitcnt lgkmcnt(2)
v_mov_b32 v216,v44
v_mov_b32 v217,v45
v_mfma_f32_16x16x32_bf16 v[32:35],a[24:27],v[76:79],v[32:35]
s_waitcnt vmcnt(15)
ds_read_b128 v[88:91],v4 offset:6144
v_mov_b32 v218,v46
v_mfma_f32_16x16x32_bf16 v[36:39],a[28:31],v[76:79],v[36:39]
s_waitcnt lgkmcnt(2)
s_barrier
ds_read_b128 v[92:95],v5 offset:0
v_mfma_f32_16x16x32_bf16 v[32:35],a[32:35],v[80:83],v[32:35]
ds_read_b128 v[96:99],v5 offset:1024
v_mov_b32 v219,v47
v_mfma_f32_16x16x32_bf16 v[36:39],a[36:39],v[80:83],v[36:39]
s_waitcnt lgkmcnt(3)
s_mov_b32 s77,1
ds_read_b128 v[100:103],v5 offset:2048
v_mfma_f32_16x16x32_bf16 v[32:35],a[40:43],v[84:87],v[32:35]
ds_read_b128 v[104:107],v5 offset:3072
v_mfma_f32_16x16x32_bf16 v[36:39],a[44:47],v[84:87],v[36:39]
s_waitcnt lgkmcnt(4)
ds_read_b128 v[108:111],v5 offset:4096
v_mfma_f32_16x16x32_bf16 v[32:35],a[48:51],v[88:91],v[32:35]
ds_read_b128 v[112:115],v5 offset:5120
v_mfma_f32_16x16x32_bf16 v[36:39],a[52:55],v[88:91],v[36:39]
s_waitcnt lgkmcnt(5)
v_mfma_f32_16x16x32_bf16 v[32:35],a[56:59],v[92:95],v[32:35]
s_waitcnt vmcnt(7)
s_cmp_eq_u32 s77,0
s_cselect_b32 s57,2.0,0
ds_read_b128 v[116:119],v5 offset:6144
v_mfma_f32_16x16x32_bf16 v[36:39],a[60:63],v[92:95],v[36:39]
s_waitcnt lgkmcnt(5)
v_or_b32 v21,s57,v0
v_or_b32 v22,s57,v18
v_mfma_f32_16x16x32_bf16 v[32:35],a[64:67],v[96:99],v[32:35]
ds_read_b128 v[120:123],v6 offset:0
v_lshlrev_b32 v168,16,v160
v_mfma_f32_16x16x32_bf16 v[36:39],a[68:71],v[96:99],v[36:39]
s_waitcnt lgkmcnt(5)
v_and_b32 v169,s73,v160
v_lshlrev_b32 v170,16,v161
v_mfma_f32_16x16x32_bf16 v[32:35],a[72:75],v[100:103],v[32:35]
ds_read_b128 v[124:127],v6 offset:1024
v_and_b32 v171,s73,v161
v_mfma_f32_16x16x32_bf16 v[36:39],a[76:79],v[100:103],v[36:39]
s_waitcnt lgkmcnt(5)
v_lshlrev_b32 v172,16,v162
v_and_b32 v173,s73,v162
v_mfma_f32_16x16x32_bf16 v[32:35],a[80:83],v[104:107],v[32:35]
ds_read_b128 v[64:67],v6 offset:2048
v_lshlrev_b32 v174,16,v163
v_mfma_f32_16x16x32_bf16 v[36:39],a[84:87],v[104:107],v[36:39]
s_waitcnt lgkmcnt(5)
v_and_b32 v175,s73,v163
v_lshlrev_b32 v176,16,v164
v_mfma_f32_16x16x32_bf16 v[32:35],a[88:91],v[108:111],v[32:35]
ds_read_b128 v[68:71],v6 offset:3072
v_and_b32 v177,s73,v164
v_mfma_f32_16x16x32_bf16 v[36:39],a[92:95],v[108:111],v[36:39]
s_waitcnt lgkmcnt(5)
v_lshlrev_b32 v178,16,v165
v_and_b32 v179,s73,v165
v_mfma_f32_16x16x32_bf16 v[32:35],a[96:99],v[112:115],v[32:35]
s_add_u32 s84,s74,s75
s_add_u32 s85,s84,4096
ds_read_b128 v[72:75],v6 offset:4096
buffer_load_dwordx4 v[128:131],v0,s[20:23],s84 offen offset:0 sc1
buffer_load_dwordx4 v[132:135],v0,s[20:23],s84 offen offset:1024 sc1
v_mfma_f32_16x16x32_bf16 v[36:39],a[100:103],v[112:115],v[36:39]
s_waitcnt lgkmcnt(5)
buffer_load_dwordx4 v[136:139],v0,s[20:23],s84 offen offset:2048 sc1
v_lshlrev_b32 v180,16,v166
v_mfma_f32_16x16x32_bf16 v[32:35],a[104:107],v[116:119],v[32:35]
ds_read_b128 v[76:79],v6 offset:5120
v_and_b32 v181,s73,v166
v_mfma_f32_16x16x32_bf16 v[36:39],a[108:111],v[116:119],v[36:39]
s_waitcnt lgkmcnt(5)
buffer_load_dwordx4 v[140:143],v0,s[20:23],s84 offen offset:3072 sc1
v_lshlrev_b32 v182,16,v167
v_mfma_f32_16x16x32_bf16 v[32:35],a[112:115],v[120:123],v[32:35]
ds_read_b128 v[80:83],v6 offset:6144
v_and_b32 v183,s73,v167
v_mfma_f32_16x16x32_bf16 v[36:39],a[116:119],v[120:123],v[36:39]
s_waitcnt lgkmcnt(5)
buffer_load_dwordx4 v[144:147],v0,s[20:23],s85 offen offset:0 sc1
v_add_f32 v212,v212,v176
v_mfma_f32_16x16x32_bf16 v[32:35],a[120:123],v[124:127],v[32:35]
ds_read_b128 v[84:87],v7 offset:0
v_add_f32 v213,v213,v177
v_mfma_f32_16x16x32_bf16 v[36:39],a[124:127],v[124:127],v[36:39]
s_waitcnt lgkmcnt(5)
buffer_load_dwordx4 v[148:151],v0,s[20:23],s85 offen offset:1024 sc1
v_add_f32 v214,v214,v178
v_mfma_f32_16x16x32_bf16 v[32:35],a[128:131],v[64:67],v[32:35]
ds_read_b128 v[88:91],v7 offset:1024
v_add_f32 v215,v215,v179
v_mfma_f32_16x16x32_bf16 v[36:39],a[132:135],v[64:67],v[36:39]
s_waitcnt lgkmcnt(5)
v_add_f32 v216,v216,v180
v_add_f32 v217,v217,v181
v_mfma_f32_16x16x32_bf16 v[32:35],a[136:139],v[68:71],v[32:35]
ds_read_b128 v[92:95],v7 offset:2048
v_add_f32 v218,v218,v182
v_mfma_f32_16x16x32_bf16 v[36:39],a[140:143],v[68:71],v[36:39]
s_waitcnt lgkmcnt(5)
buffer_load_dword v16,v2,s[20:23],s68 offen sc1
v_add_f32 v219,v219,v183
v_mfma_f32_16x16x32_bf16 v[32:35],a[144:147],v[72:75],v[32:35]
ds_read_b128 v[96:99],v7 offset:3072
v_fma_f32 v168,v212,v152,v168
v_mfma_f32_16x16x32_bf16 v[36:39],a[148:151],v[72:75],v[36:39]
s_waitcnt lgkmcnt(5)
v_fma_f32 v169,v213,v153,v169
v_fma_f32 v170,v214,v154,v170
v_mfma_f32_16x16x32_bf16 v[32:35],a[152:155],v[76:79],v[32:35]
ds_read_b128 v[100:103],v7 offset:4096
v_fma_f32 v171,v215,v155,v171
v_mfma_f32_16x16x32_bf16 v[36:39],a[156:159],v[76:79],v[36:39]
s_waitcnt lgkmcnt(5)
v_fma_f32 v172,v216,v156,v172
v_fma_f32 v173,v217,v157,v173
v_mfma_f32_16x16x32_bf16 v[32:35],a[160:163],v[80:83],v[32:35]
ds_read_b128 v[104:107],v7 offset:5120
v_fma_f32 v174,v218,v158,v174
v_mfma_f32_16x16x32_bf16 v[36:39],a[164:167],v[80:83],v[36:39]
s_waitcnt lgkmcnt(5)
v_fma_f32 v175,v219,v159,v175
v_mfma_f32_16x16x32_bf16 v[32:35],a[168:171],v[84:87],v[32:35]
ds_read_b128 v[108:111],v7 offset:6144
v_mfma_f32_16x16x32_bf16 v[36:39],a[172:175],v[84:87],v[36:39]
s_waitcnt lgkmcnt(5)
s_add_u32 s55,s55,32768
buffer_load_dwordx4 v[160:163],v0,s[20:23],s82 offen
v_mfma_f32_16x16x32_bf16 v[32:35],a[176:179],v[88:91],v[32:35]
s_and_b32 s55,s55,0x1ffff
s_add_u32 s64,s82,13631488
buffer_load_dwordx4 v[164:167],v0,s[20:23],s64 offen
v_mfma_f32_16x16x32_bf16 v[36:39],a[180:183],v[88:91],v[36:39]
s_waitcnt lgkmcnt(4)
s_add_u32 s82,s82,32768
v_add_u32 v4,s55,v8
v_mfma_f32_16x16x32_bf16 v[32:35],a[184:187],v[92:95],v[32:35]
s_waitcnt vmcnt(3)
s_cmp_eq_u32 s77,0
s_cbranch_scc1 go_255
ck_253:
v_max3_u32 v184,v128,v129,v130
v_max3_u32 v185,v140,v141,v142
v_max3_u32 v184,v184,v131,v132
v_max3_u32 v185,v185,v143,v144
v_max3_u32 v184,v184,v133,v134
v_max3_u32 v185,v185,v145,v146
v_max3_u32 v184,v184,v135,v136
v_max3_u32 v185,v185,v147,v148
v_max3_u32 v184,v184,v137,v138
v_max3_u32 v185,v185,v149,v150
v_max3_u32 v184,v184,v139,v151
v_max_u32 v184,v184,v185
v_cmp_eq_u32 vcc,-1,v184
s_cbranch_vccnz rt_254
go_255:
v_mfma_f32_16x16x32_bf16 v[36:39],a[188:191],v[92:95],v[36:39]
s_waitcnt lgkmcnt(3)
v_add_u32 v5,s55,v9
v_add_u32 v6,s55,v10
v_add_f32 v128,v128,v136
v_mfma_f32_16x16x32_bf16 v[32:35],a[192:195],v[96:99],v[32:35]
v_add_u32 v7,s55,v11
v_add_f32 v129,v129,v137
v_add_f32 v130,v130,v138
v_mfma_f32_16x16x32_bf16 v[36:39],a[196:199],v[96:99],v[36:39]
s_waitcnt lgkmcnt(2)
v_add_f32 v131,v131,v139
v_add_f32 v132,v132,v140
v_add_f32 v133,v133,v141
v_mfma_f32_16x16x32_bf16 v[32:35],a[200:203],v[100:103],v[32:35]
v_add_f32 v134,v134,v142
v_add_f32 v135,v135,v143
v_add_f32 v128,v128,v144
v_mfma_f32_16x16x32_bf16 v[36:39],a[204:207],v[100:103],v[36:39]
s_waitcnt lgkmcnt(1)
v_add_f32 v129,v129,v145
v_add_f32 v130,v130,v146
v_add_f32 v131,v131,v147
v_mfma_f32_16x16x32_bf16 v[32:35],a[208:211],v[104:107],v[32:35]
v_add_f32 v132,v132,v148
v_add_f32 v133,v133,v149
v_add_f32 v134,v134,v150
v_mfma_f32_16x16x32_bf16 v[36:39],a[212:215],v[104:107],v[36:39]
s_waitcnt lgkmcnt(0)
v_add_f32 v135,v135,v151
v_fma_f32 v168,v128,v152,v168
v_fma_f32 v169,v129,v153,v169
v_mfma_f32_16x16x32_bf16 v[40:43],a[216:219],v[108:111],v[32:35]
v_fma_f32 v170,v130,v154,v170
v_fma_f32 v171,v131,v155,v171
v_fma_f32 v172,v132,v156,v172
v_mfma_f32_16x16x32_bf16 v[44:47],a[220:223],v[108:111],v[36:39]
s_waitcnt vmcnt(2)
v_fma_f32 v173,v133,v157,v173
v_fma_f32 v174,v134,v158,v174
v_fma_f32 v175,v135,v159,v175
v_cvt_pk_bf16_f32 v176,v168,v169
v_cvt_pk_bf16_f32 v177,v170,v171
v_cvt_pk_bf16_f32 v178,v172,v173
v_cvt_pk_bf16_f32 v179,v174,v175
s_and_b32 s64,s66,0xffff8000
buffer_store_dwordx4 v[176:179],v22,s[24:27],s64 offen
s_cmp_eq_u32 s56,1
s_cbranch_scc1 b1_247
buffer_store_dwordx4 v[204:207],v21,s[20:23],s84 offen offset:0
buffer_store_dwordx4 v[204:207],v21,s[20:23],s84 offen offset:1024
b2_248:
s_cmp_eq_u32 s56,1
s_cbranch_scc1 b1_249
buffer_store_dwordx4 v[204:207],v21,s[20:23],s84 offen offset:2048
buffer_store_dwordx4 v[204:207],v21,s[20:23],s84 offen offset:3072
b2_250:
s_cmp_eq_u32 s56,1
s_cbranch_scc1 b1_251
buffer_store_dwordx4 v[204:207],v21,s[20:23],s85 offen offset:0
buffer_store_dwordx4 v[204:207],v21,s[20:23],s85 offen offset:1024
b2_252:
s_mul_i32 s64,s77,32768
s_add_u32 s66,s66,s64
s_mul_i32 s64,s77,6144
s_add_u32 s75,s75,s64
s_cmp_eq_u32 s75,24576
s_cselect_b32 s75,0,s75
s_add_u32 s63,s63,s77
s_mov_b32 s77,0
v_cmp_gt_u32 vcc,s71,v16
s_add_u32 s60,s60,1
s_branch endN_246
BN_222:
s_waitcnt vmcnt(6)
ds_read_b128 v[64:67],v4 offset:0
s_waitcnt vmcnt(5)
ds_read_b128 v[68:71],v4 offset:1024
s_waitcnt vmcnt(4)
ds_read_b128 v[72:75],v4 offset:2048
s_waitcnt vmcnt(3)
ds_read_b128 v[76:79],v4 offset:3072
s_waitcnt lgkmcnt(3)
v_mfma_f32_16x16x32_bf16 v[32:35],a[0:3],v[64:67],0
s_add_u32 s71,s60,2
s_add_u32 s53,s60,3
v_mfma_f32_16x16x32_bf16 v[36:39],a[4:7],v[64:67],0
s_waitcnt lgkmcnt(2)
s_waitcnt vmcnt(2)
ds_read_b128 v[80:83],v4 offset:4096
v_mfma_f32_16x16x32_bf16 v[32:35],a[8:11],v[68:71],v[32:35]
v_mfma_f32_16x16x32_bf16 v[36:39],a[12:15],v[68:71],v[36:39]
s_waitcnt lgkmcnt(2)
s_waitcnt vmcnt(1)
ds_read_b128 v[84:87],v4 offset:5120
v_mfma_f32_16x16x32_bf16 v[32:35],a[16:19],v[72:75],v[32:35]
v_mfma_f32_16x16x32_bf16 v[36:39],a[20:23],v[72:75],v[36:39]
s_waitcnt lgkmcnt(2)
s_waitcnt vmcnt(0)
ds_read_b128 v[88:91],v4 offset:6144
v_mfma_f32_16x16x32_bf16 v[32:35],a[24:27],v[76:79],v[32:35]
v_mfma_f32_16x16x32_bf16 v[36:39],a[28:31],v[76:79],v[36:39]
s_waitcnt lgkmcnt(2)
s_barrier
ds_read_b128 v[92:95],v5 offset:0
v_mfma_f32_16x16x32_bf16 v[32:35],a[32:35],v[80:83],v[32:35]
ds_read_b128 v[96:99],v5 offset:1024
v_mfma_f32_16x16x32_bf16 v[36:39],a[36:39],v[80:83],v[36:39]
s_waitcnt lgkmcnt(3)
ds_read_b128 v[100:103],v5 offset:2048
v_mfma_f32_16x16x32_bf16 v[32:35],a[40:43],v[84:87],v[32:35]
ds_read_b128 v[104:107],v5 offset:3072
v_mfma_f32_16x16x32_bf16 v[36:39],a[44:47],v[84:87],v[36:39]
s_waitcnt lgkmcnt(4)
ds_read_b128 v[108:111],v5 offset:4096
v_mfma_f32_16x16x32_bf16 v[32:35],a[48:51],v[88:91],v[32:35]
ds_read_b128 v[112:115],v5 offset:5120
v_mfma_f32_16x16x32_bf16 v[36:39],a[52:55],v[88:91],v[36:39]
s_waitcnt lgkmcnt(5)
v_mfma_f32_16x16x32_bf16 v[32:35],a[56:59],v[92:95],v[32:35]
s_cmp_eq_u32 s77,0
s_cselect_b32 s57,2.0,0
ds_read_b128 v[116:119],v5 offset:6144
v_mfma_f32_16x16x32_bf16 v[36:39],a[60:63],v[92:95],v[36:39]
s_waitcnt lgkmcnt(5)
v_or_b32 v21,s57,v0
v_or_b32 v22,s57,v18
v_mfma_f32_16x16x32_bf16 v[32:35],a[64:67],v[96:99],v[32:35]
ds_read_b128 v[120:123],v6 offset:0
v_lshlrev_b32 v168,16,v160
v_mfma_f32_16x16x32_bf16 v[36:39],a[68:71],v[96:99],v[36:39]
s_waitcnt lgkmcnt(5)
v_and_b32 v169,s73,v160
v_lshlrev_b32 v170,16,v161
v_mfma_f32_16x16x32_bf16 v[32:35],a[72:75],v[100:103],v[32:35]
ds_read_b128 v[124:127],v6 offset:1024
v_and_b32 v171,s73,v161
v_mfma_f32_16x16x32_bf16 v[36:39],a[76:79],v[100:103],v[36:39]
s_waitcnt lgkmcnt(5)
v_lshlrev_b32 v172,16,v162
v_and_b32 v173,s73,v162
v_mfma_f32_16x16x32_bf16 v[32:35],a[80:83],v[104:107],v[32:35]
ds_read_b128 v[64:67],v6 offset:2048
v_lshlrev_b32 v174,16,v163
v_mfma_f32_16x16x32_bf16 v[36:39],a[84:87],v[104:107],v[36:39]
s_waitcnt lgkmcnt(5)
v_and_b32 v175,s73,v163
v_lshlrev_b32 v176,16,v164
v_mfma_f32_16x16x32_bf16 v[32:35],a[88:91],v[108:111],v[32:35]
ds_read_b128 v[68:71],v6 offset:3072
v_and_b32 v177,s73,v164
v_mfma_f32_16x16x32_bf16 v[36:39],a[92:95],v[108:111],v[36:39]
s_waitcnt lgkmcnt(5)
v_lshlrev_b32 v178,16,v165
v_and_b32 v179,s73,v165
v_mfma_f32_16x16x32_bf16 v[32:35],a[96:99],v[112:115],v[32:35]
s_add_u32 s84,s74,s75
s_add_u32 s85,s84,4096
ds_read_b128 v[72:75],v6 offset:4096
buffer_load_dwordx4 v[128:131],v0,s[20:23],s84 offen offset:0 sc1
buffer_load_dwordx4 v[132:135],v0,s[20:23],s84 offen offset:1024 sc1
v_mfma_f32_16x16x32_bf16 v[36:39],a[100:103],v[112:115],v[36:39]
s_waitcnt lgkmcnt(5)
buffer_load_dwordx4 v[136:139],v0,s[20:23],s84 offen offset:2048 sc1
v_lshlrev_b32 v180,16,v166
v_mfma_f32_16x16x32_bf16 v[32:35],a[104:107],v[116:119],v[32:35]
ds_read_b128 v[76:79],v6 offset:5120
v_and_b32 v181,s73,v166
v_mfma_f32_16x16x32_bf16 v[36:39],a[108:111],v[116:119],v[36:39]
s_waitcnt lgkmcnt(5)
buffer_load_dwordx4 v[140:143],v0,s[20:23],s84 offen offset:3072 sc1
v_lshlrev_b32 v182,16,v167
v_mfma_f32_16x16x32_bf16 v[32:35],a[112:115],v[120:123],v[32:35]
ds_read_b128 v[80:83],v6 offset:6144
v_and_b32 v183,s73,v167
v_mfma_f32_16x16x32_bf16 v[36:39],a[116:119],v[120:123],v[36:39]
s_waitcnt lgkmcnt(5)
buffer_load_dwordx4 v[144:147],v0,s[20:23],s85 offen offset:0 sc1
v_add_f32 v212,v212,v176
v_mfma_f32_16x16x32_bf16 v[32:35],a[120:123],v[124:127],v[32:35]
ds_read_b128 v[84:87],v7 offset:0
v_add_f32 v213,v213,v177
v_mfma_f32_16x16x32_bf16 v[36:39],a[124:127],v[124:127],v[36:39]
s_waitcnt lgkmcnt(5)
buffer_load_dwordx4 v[148:151],v0,s[20:23],s85 offen offset:1024 sc1
v_add_f32 v214,v214,v178
v_mfma_f32_16x16x32_bf16 v[32:35],a[128:131],v[64:67],v[32:35]
ds_read_b128 v[88:91],v7 offset:1024
v_add_f32 v215,v215,v179
v_mfma_f32_16x16x32_bf16 v[36:39],a[132:135],v[64:67],v[36:39]
s_waitcnt lgkmcnt(5)
v_add_f32 v216,v216,v180
v_add_f32 v217,v217,v181
v_mfma_f32_16x16x32_bf16 v[32:35],a[136:139],v[68:71],v[32:35]
ds_read_b128 v[92:95],v7 offset:2048
v_add_f32 v218,v218,v182
v_mfma_f32_16x16x32_bf16 v[36:39],a[140:143],v[68:71],v[36:39]
s_waitcnt lgkmcnt(5)
buffer_load_dword v16,v2,s[20:23],s68 offen sc1
v_add_f32 v219,v219,v183
v_mfma_f32_16x16x32_bf16 v[32:35],a[144:147],v[72:75],v[32:35]
ds_read_b128 v[96:99],v7 offset:3072
v_fma_f32 v168,v212,v152,v168
v_mfma_f32_16x16x32_bf16 v[36:39],a[148:151],v[72:75],v[36:39]
s_waitcnt lgkmcnt(5)
v_fma_f32 v169,v213,v153,v169
v_fma_f32 v170,v214,v154,v170
v_mfma_f32_16x16x32_bf16 v[32:35],a[152:155],v[76:79],v[32:35]
ds_read_b128 v[100:103],v7 offset:4096
v_fma_f32 v171,v215,v155,v171
v_mfma_f32_16x16x32_bf16 v[36:39],a[156:159],v[76:79],v[36:39]
s_waitcnt lgkmcnt(5)
v_fma_f32 v172,v216,v156,v172
v_fma_f32 v173,v217,v157,v173
v_mfma_f32_16x16x32_bf16 v[32:35],a[160:163],v[80:83],v[32:35]
ds_read_b128 v[104:107],v7 offset:5120
v_fma_f32 v174,v218,v158,v174
v_mfma_f32_16x16x32_bf16 v[36:39],a[164:167],v[80:83],v[36:39]
s_waitcnt lgkmcnt(5)
v_fma_f32 v175,v219,v159,v175
v_mfma_f32_16x16x32_bf16 v[32:35],a[168:171],v[84:87],v[32:35]
ds_read_b128 v[108:111],v7 offset:6144
v_mfma_f32_16x16x32_bf16 v[36:39],a[172:175],v[84:87],v[36:39]
s_waitcnt lgkmcnt(5)
s_add_u32 s55,s55,32768
buffer_load_dwordx4 v[160:163],v0,s[20:23],s82 offen
v_mfma_f32_16x16x32_bf16 v[32:35],a[176:179],v[88:91],v[32:35]
s_and_b32 s55,s55,0x1ffff
s_add_u32 s64,s82,13631488
buffer_load_dwordx4 v[164:167],v0,s[20:23],s64 offen
v_mfma_f32_16x16x32_bf16 v[36:39],a[180:183],v[88:91],v[36:39]
s_waitcnt lgkmcnt(4)
s_add_u32 s82,s82,32768
v_add_u32 v4,s55,v8
v_mfma_f32_16x16x32_bf16 v[32:35],a[184:187],v[92:95],v[32:35]
s_waitcnt vmcnt(3)
s_cmp_eq_u32 s77,0
s_cbranch_scc1 go_264
ck_262:
v_max3_u32 v184,v128,v129,v130
v_max3_u32 v185,v140,v141,v142
v_max3_u32 v184,v184,v131,v132
v_max3_u32 v185,v185,v143,v144
v_max3_u32 v184,v184,v133,v134
v_max3_u32 v185,v185,v145,v146
v_max3_u32 v184,v184,v135,v136
v_max3_u32 v185,v185,v147,v148
v_max3_u32 v184,v184,v137,v138
v_max3_u32 v185,v185,v149,v150
v_max3_u32 v184,v184,v139,v151
v_max_u32 v184,v184,v185
v_cmp_eq_u32 vcc,-1,v184
s_cbranch_vccnz rt_263
go_264:
v_mfma_f32_16x16x32_bf16 v[36:39],a[188:191],v[92:95],v[36:39]
s_waitcnt lgkmcnt(3)
v_add_u32 v5,s55,v9
v_add_u32 v6,s55,v10
v_add_f32 v128,v128,v136
v_mfma_f32_16x16x32_bf16 v[32:35],a[192:195],v[96:99],v[32:35]
v_add_u32 v7,s55,v11
v_add_f32 v129,v129,v137
v_add_f32 v130,v130,v138
v_mfma_f32_16x16x32_bf16 v[36:39],a[196:199],v[96:99],v[36:39]
s_waitcnt lgkmcnt(2)
v_add_f32 v131,v131,v139
v_add_f32 v132,v132,v140
v_add_f32 v133,v133,v141
v_mfma_f32_16x16x32_bf16 v[32:35],a[200:203],v[100:103],v[32:35]
v_add_f32 v134,v134,v142
v_add_f32 v135,v135,v143
v_add_f32 v128,v128,v144
v_mfma_f32_16x16x32_bf16 v[36:39],a[204:207],v[100:103],v[36:39]
s_waitcnt lgkmcnt(1)
v_add_f32 v129,v129,v145
v_add_f32 v130,v130,v146
v_add_f32 v131,v131,v147
v_mfma_f32_16x16x32_bf16 v[32:35],a[208:211],v[104:107],v[32:35]
v_add_f32 v132,v132,v148
v_add_f32 v133,v133,v149
v_add_f32 v134,v134,v150
v_mfma_f32_16x16x32_bf16 v[36:39],a[212:215],v[104:107],v[36:39]
s_waitcnt lgkmcnt(0)
v_add_f32 v135,v135,v151
v_fma_f32 v168,v128,v152,v168
v_fma_f32 v169,v129,v153,v169
v_mfma_f32_16x16x32_bf16 v[40:43],a[216:219],v[108:111],v[32:35]
v_fma_f32 v170,v130,v154,v170
v_fma_f32 v171,v131,v155,v171
v_fma_f32 v172,v132,v156,v172
v_mfma_f32_16x16x32_bf16 v[44:47],a[220:223],v[108:111],v[36:39]
s_waitcnt vmcnt(2)
v_fma_f32 v173,v133,v157,v173
v_fma_f32 v174,v134,v158,v174
v_fma_f32 v175,v135,v159,v175
v_cvt_pk_bf16_f32 v176,v168,v169
v_cvt_pk_bf16_f32 v177,v170,v171
v_cvt_pk_bf16_f32 v178,v172,v173
v_cvt_pk_bf16_f32 v179,v174,v175
s_and_b32 s64,s66,0xffff8000
buffer_store_dwordx4 v[176:179],v22,s[24:27],s64 offen
s_cmp_eq_u32 s56,1
s_cbranch_scc1 b1_256
buffer_store_dwordx4 v[204:207],v21,s[20:23],s84 offen offset:0
buffer_store_dwordx4 v[204:207],v21,s[20:23],s84 offen offset:1024
b2_257:
s_cmp_eq_u32 s56,1
s_cbranch_scc1 b1_258
buffer_store_dwordx4 v[204:207],v21,s[20:23],s84 offen offset:2048
buffer_store_dwordx4 v[204:207],v21,s[20:23],s84 offen offset:3072
b2_259:
s_cmp_eq_u32 s56,1
s_cbranch_scc1 b1_260
buffer_store_dwordx4 v[204:207],v21,s[20:23],s85 offen offset:0
buffer_store_dwordx4 v[204:207],v21,s[20:23],s85 offen offset:1024
b2_261:
s_mul_i32 s64,s77,32768
s_add_u32 s66,s66,s64
s_mul_i32 s64,s77,6144
s_add_u32 s75,s75,s64
s_cmp_eq_u32 s75,24576
s_cselect_b32 s75,0,s75
s_add_u32 s63,s63,s77
s_mov_b32 s77,0
v_cmp_gt_u32 vcc,s71,v16
s_add_u32 s60,s60,1
endN_246:
s_cbranch_vccnz nb_225
s_mov_b32 m0,s70
s_nop 0
buffer_load_dwordx4 v3,s[20:23],s61 offen offset:0 lds
buffer_load_dwordx4 v3,s[20:23],s61 offen offset:1024 lds
buffer_load_dwordx4 v3,s[20:23],s61 offen offset:2048 lds
buffer_load_dwordx4 v3,s[20:23],s61 offen offset:3072 lds
s_add_u32 m0,s70,4096
s_nop 0
buffer_load_dwordx4 v3,s[20:23],s62 offen offset:0 lds
buffer_load_dwordx4 v3,s[20:23],s62 offen offset:1024 lds
buffer_load_dwordx4 v3,s[20:23],s62 offen offset:2048 lds
s_add_u32 s61,s61,114688
s_add_u32 s62,s62,114688
s_add_u32 s70,s70,32768
s_and_b32 s70,s70,0x1ffff
v_mov_b32 v212,v40
v_mov_b32 v213,v41
v_mov_b32 v214,v42
v_mov_b32 v215,v43
v_mov_b32 v216,v44
v_mov_b32 v217,v45
v_mov_b32 v218,v46
v_mov_b32 v219,v47
s_mov_b32 s77,1
s_branch dec_224
nb_225:
s_nop 3
s_mov_b32 s77,1
s_add_u32 s84,s74,s75
s_add_u32 s85,s84,4096
buffer_load_dwordx4 v[128:131],v0,s[20:23],s84 offen offset:0 sc1
buffer_load_dwordx4 v[132:135],v0,s[20:23],s84 offen offset:1024 sc1
buffer_load_dwordx4 v[136:139],v0,s[20:23],s84 offen offset:2048 sc1
buffer_load_dwordx4 v[140:143],v0,s[20:23],s84 offen offset:3072 sc1
buffer_load_dwordx4 v[144:147],v0,s[20:23],s85 offen offset:0 sc1
buffer_load_dwordx4 v[148:151],v0,s[20:23],s85 offen offset:1024 sc1
s_waitcnt vmcnt(13)
s_cmp_eq_u32 s77,0
s_cselect_b32 s57,2.0,0
v_or_b32 v21,s57,v0
v_or_b32 v22,s57,v18
v_lshlrev_b32 v168,16,v160
v_and_b32 v169,s73,v160
v_lshlrev_b32 v170,16,v161
v_and_b32 v171,s73,v161
v_lshlrev_b32 v172,16,v162
v_and_b32 v173,s73,v162
v_lshlrev_b32 v174,16,v163
v_and_b32 v175,s73,v163
v_lshlrev_b32 v176,16,v164
v_and_b32 v177,s73,v164
v_lshlrev_b32 v178,16,v165
v_and_b32 v179,s73,v165
v_lshlrev_b32 v180,16,v166
v_and_b32 v181,s73,v166
v_lshlrev_b32 v182,16,v167
v_and_b32 v183,s73,v167
v_pk_add_f32 v[40:41],v[40:41],v[176:177]
v_pk_add_f32 v[42:43],v[42:43],v[178:179]
v_pk_add_f32 v[44:45],v[44:45],v[180:181]
v_pk_add_f32 v[46:47],v[46:47],v[182:183]
v_pk_fma_f32 v[168:169],v[40:41],v[152:153],v[168:169]
v_pk_fma_f32 v[170:171],v[42:43],v[154:155],v[170:171]
v_pk_fma_f32 v[172:173],v[44:45],v[156:157],v[172:173]
v_pk_fma_f32 v[174:175],v[46:47],v[158:159],v[174:175]
s_waitcnt vmcnt(0)
s_cmp_eq_u32 s77,0
s_cbranch_scc1 go_273
ck_271:
v_max3_u32 v184,v128,v129,v130
v_max3_u32 v185,v140,v141,v142
v_max3_u32 v184,v184,v131,v132
v_max3_u32 v185,v185,v143,v144
v_max3_u32 v184,v184,v133,v134
v_max3_u32 v185,v185,v145,v146
v_max3_u32 v184,v184,v135,v136
v_max3_u32 v185,v185,v147,v148
v_max3_u32 v184,v184,v137,v138
v_max3_u32 v185,v185,v149,v150
v_max3_u32 v184,v184,v139,v151
v_max_u32 v184,v184,v185
v_cmp_eq_u32 vcc,-1,v184
s_cbranch_vccnz rt_272
go_273:
buffer_load_dword v16,v2,s[20:23],s68 offen sc1
v_pk_add_f32 v[128:129],v[128:129],v[136:137]
v_pk_add_f32 v[130:131],v[130:131],v[138:139]
v_pk_add_f32 v[132:133],v[132:133],v[140:141]
v_pk_add_f32 v[134:135],v[134:135],v[142:143]
v_pk_add_f32 v[128:129],v[128:129],v[144:145]
v_pk_add_f32 v[130:131],v[130:131],v[146:147]
v_pk_add_f32 v[132:133],v[132:133],v[148:149]
v_pk_add_f32 v[134:135],v[134:135],v[150:151]
v_pk_fma_f32 v[168:169],v[128:129],v[152:153],v[168:169]
v_pk_fma_f32 v[170:171],v[130:131],v[154:155],v[170:171]
v_pk_fma_f32 v[172:173],v[132:133],v[156:157],v[172:173]
v_pk_fma_f32 v[174:175],v[134:135],v[158:159],v[174:175]
v_cvt_pk_bf16_f32 v176,v168,v169
v_cvt_pk_bf16_f32 v177,v170,v171
v_cvt_pk_bf16_f32 v178,v172,v173
v_cvt_pk_bf16_f32 v179,v174,v175
s_and_b32 s64,s66,0xffff8000
buffer_store_dwordx4 v[176:179],v22,s[24:27],s64 offen
s_cmp_eq_u32 s56,1
s_cbranch_scc1 b1_265
buffer_store_dwordx4 v[204:207],v21,s[20:23],s84 offen offset:0
buffer_store_dwordx4 v[204:207],v21,s[20:23],s84 offen offset:1024
b2_266:
s_cmp_eq_u32 s56,1
s_cbranch_scc1 b1_267
buffer_store_dwordx4 v[204:207],v21,s[20:23],s84 offen offset:2048
buffer_store_dwordx4 v[204:207],v21,s[20:23],s84 offen offset:3072
b2_268:
s_cmp_eq_u32 s56,1
s_cbranch_scc1 b1_269
buffer_store_dwordx4 v[204:207],v21,s[20:23],s85 offen offset:0
buffer_store_dwordx4 v[204:207],v21,s[20:23],s85 offen offset:1024
b2_270:
s_mul_i32 s64,s77,32768
s_add_u32 s66,s66,s64
s_mul_i32 s64,s77,6144
s_add_u32 s75,s75,s64
s_cmp_eq_u32 s75,24576
s_cselect_b32 s75,0,s75
s_add_u32 s63,s63,s77
s_mov_b32 s77,0
s_waitcnt vmcnt(7)
v_cmp_gt_u32 vcc,s71,v16
s_cbranch_vccz lag_223
s_cmp_ge_u32 s60,128
s_cbranch_scc1 done_171
plp_274:
buffer_load_dword v16,v2,s[20:23],s68 offen sc1
s_waitcnt vmcnt(0)
v_cmp_gt_u32 vcc,s71,v16
s_cbranch_vccz pok_275
s_sleep 4
s_sub_u32 s90,s90,1
s_cmp_gt_i32 s90,0
s_cbranch_scc1 plp_274
pok_275:
s_branch lag_223
b1_196:
s_nop 7
buffer_store_dwordx4 v[40:43],v0,s[20:23],s64 offen offset:0 sc1
buffer_store_dwordx4 v[44:47],v0,s[20:23],s64 offen offset:1024 sc1
s_branch b2_197
b1_199:
s_nop 7
buffer_store_dwordx4 v[40:43],v0,s[20:23],s64 offen offset:0 sc1
buffer_store_dwordx4 v[44:47],v0,s[20:23],s64 offen offset:1024 sc1
s_branch b2_200
b1_201:
s_nop 7
buffer_store_dwordx4 v[40:43],v0,s[20:23],s64 offen offset:0 sc1
buffer_store_dwordx4 v[44:47],v0,s[20:23],s64 offen offset:1024 sc1
s_branch b2_202
b1_203:
s_nop 7
buffer_store_dwordx4 v[40:43],v0,s[20:23],s64 offen offset:0 sc1
buffer_store_dwordx4 v[44:47],v0,s[20:23],s64 offen offset:1024 sc1
s_branch b2_204
b1_228:
s_nop 7
buffer_store_dwordx4 v[204:207],v21,s[20:23],s84 offen offset:0 sc1
buffer_store_dwordx4 v[204:207],v21,s[20:23],s84 offen offset:1024 sc1
s_branch b2_229
b1_230:
s_nop 7
buffer_store_dwordx4 v[204:207],v21,s[20:23],s84 offen offset:2048 sc1
buffer_store_dwordx4 v[204:207],v21,s[20:23],s84 offen offset:3072 sc1
s_branch b2_231
b1_232:
s_nop 7
buffer_store_dwordx4 v[204:207],v21,s[20:23],s85 offen offset:0 sc1
buffer_store_dwordx4 v[204:207],v21,s[20:23],s85 offen offset:1024 sc1
s_branch b2_233
rt_235:
s_sub_u32 s90,s90,1
s_cmp_gt_i32 s90,0
s_cbranch_scc0 go_236
s_add_u32 s84,s74,s75
s_add_u32 s85,s84,4096
buffer_load_dwordx4 v[128:131],v0,s[20:23],s84 offen offset:0 sc1
buffer_load_dwordx4 v[132:135],v0,s[20:23],s84 offen offset:1024 sc1
buffer_load_dwordx4 v[136:139],v0,s[20:23],s84 offen offset:2048 sc1
buffer_load_dwordx4 v[140:143],v0,s[20:23],s84 offen offset:3072 sc1
buffer_load_dwordx4 v[144:147],v0,s[20:23],s85 offen offset:0 sc1
buffer_load_dwordx4 v[148:151],v0,s[20:23],s85 offen offset:1024 sc1
s_waitcnt vmcnt(0)
s_branch ck_234
b1_237:
s_nop 7
buffer_store_dwordx4 v[204:207],v21,s[20:23],s84 offen offset:0 sc1
buffer_store_dwordx4 v[204:207],v21,s[20:23],s84 offen offset:1024 sc1
s_branch b2_238
b1_239:
s_nop 7
buffer_store_dwordx4 v[204:207],v21,s[20:23],s84 offen offset:2048 sc1
buffer_store_dwordx4 v[204:207],v21,s[20:23],s84 offen offset:3072 sc1
s_branch b2_240
b1_241:
s_nop 7
buffer_store_dwordx4 v[204:207],v21,s[20:23],s85 offen offset:0 sc1
buffer_store_dwordx4 v[204:207],v21,s[20:23],s85 offen offset:1024 sc1
s_branch b2_242
rt_244:
s_sub_u32 s90,s90,1
s_cmp_gt_i32 s90,0
s_cbranch_scc0 go_245
s_add_u32 s84,s74,s75
s_add_u32 s85,s84,4096
buffer_load_dwordx4 v[128:131],v0,s[20:23],s84 offen offset:0 sc1
buffer_load_dwordx4 v[132:135],v0,s[20:23],s84 offen offset:1024 sc1
buffer_load_dwordx4 v[136:139],v0,s[20:23],s84 offen offset:2048 sc1
buffer_load_dwordx4 v[140:143],v0,s[20:23],s84 offen offset:3072 sc1
buffer_load_dwordx4 v[144:147],v0,s[20:23],s85 offen offset:0 sc1
buffer_load_dwordx4 v[148:151],v0,s[20:23],s85 offen offset:1024 sc1
s_waitcnt vmcnt(0)
s_branch ck_243
b1_247:
s_nop 7
buffer_store_dwordx4 v[204:207],v21,s[20:23],s84 offen offset:0 sc1
buffer_store_dwordx4 v[204:207],v21,s[20:23],s84 offen offset:1024 sc1
s_branch b2_248
b1_249:
s_nop 7
buffer_store_dwordx4 v[204:207],v21,s[20:23],s84 offen offset:2048 sc1
buffer_store_dwordx4 v[204:207],v21,s[20:23],s84 offen offset:3072 sc1
s_branch b2_250
b1_251:
s_nop 7
buffer_store_dwordx4 v[204:207],v21,s[20:23],s85 offen offset:0 sc1
buffer_store_dwordx4 v[204:207],v21,s[20:23],s85 offen offset:1024 sc1
s_branch b2_252
rt_254:
s_sub_u32 s90,s90,1
s_cmp_gt_i32 s90,0
s_cbranch_scc0 go_255
s_add_u32 s84,s74,s75
s_add_u32 s85,s84,4096
buffer_load_dwordx4 v[128:131],v0,s[20:23],s84 offen offset:0 sc1
buffer_load_dwordx4 v[132:135],v0,s[20:23],s84 offen offset:1024 sc1
buffer_load_dwordx4 v[136:139],v0,s[20:23],s84 offen offset:2048 sc1
buffer_load_dwordx4 v[140:143],v0,s[20:23],s84 offen offset:3072 sc1
buffer_load_dwordx4 v[144:147],v0,s[20:23],s85 offen offset:0 sc1
buffer_load_dwordx4 v[148:151],v0,s[20:23],s85 offen offset:1024 sc1
s_waitcnt vmcnt(0)
s_branch ck_253
b1_256:
s_nop 7
buffer_store_dwordx4 v[204:207],v21,s[20:23],s84 offen offset:0 sc1
buffer_store_dwordx4 v[204:207],v21,s[20:23],s84 offen offset:1024 sc1
s_branch b2_257
b1_258:
s_nop 7
buffer_store_dwordx4 v[204:207],v21,s[20:23],s84 offen offset:2048 sc1
buffer_store_dwordx4 v[204:207],v21,s[20:23],s84 offen offset:3072 sc1
s_branch b2_259
b1_260:
s_nop 7
buffer_store_dwordx4 v[204:207],v21,s[20:23],s85 offen offset:0 sc1
buffer_store_dwordx4 v[204:207],v21,s[20:23],s85 offen offset:1024 sc1
s_branch b2_261
rt_263:
s_sub_u32 s90,s90,1
s_cmp_gt_i32 s90,0
s_cbranch_scc0 go_264
s_add_u32 s84,s74,s75
s_add_u32 s85,s84,4096
buffer_load_dwordx4 v[128:131],v0,s[20:23],s84 offen offset:0 sc1
buffer_load_dwordx4 v[132:135],v0,s[20:23],s84 offen offset:1024 sc1
buffer_load_dwordx4 v[136:139],v0,s[20:23],s84 offen offset:2048 sc1
buffer_load_dwordx4 v[140:143],v0,s[20:23],s84 offen offset:3072 sc1
buffer_load_dwordx4 v[144:147],v0,s[20:23],s85 offen offset:0 sc1
buffer_load_dwordx4 v[148:151],v0,s[20:23],s85 offen offset:1024 sc1
s_waitcnt vmcnt(0)
s_branch ck_262
b1_265:
s_nop 7
buffer_store_dwordx4 v[204:207],v21,s[20:23],s84 offen offset:0 sc1
buffer_store_dwordx4 v[204:207],v21,s[20:23],s84 offen offset:1024 sc1
s_branch b2_266
b1_267:
s_nop 7
buffer_store_dwordx4 v[204:207],v21,s[20:23],s84 offen offset:2048 sc1
buffer_store_dwordx4 v[204:207],v21,s[20:23],s84 offen offset:3072 sc1
s_branch b2_268
b1_269:
s_nop 7
buffer_store_dwordx4 v[204:207],v21,s[20:23],s85 offen offset:0 sc1
buffer_store_dwordx4 v[204:207],v21,s[20:23],s85 offen offset:1024 sc1
s_branch b2_270
rt_272:
s_sub_u32 s90,s90,1
s_cmp_gt_i32 s90,0
s_cbranch_scc0 go_273
s_add_u32 s84,s74,s75
s_add_u32 s85,s84,4096
buffer_load_dwordx4 v[128:131],v0,s[20:23],s84 offen offset:0 sc1
buffer_load_dwordx4 v[132:135],v0,s[20:23],s84 offen offset:1024 sc1
buffer_load_dwordx4 v[136:139],v0,s[20:23],s84 offen offset:2048 sc1
buffer_load_dwordx4 v[140:143],v0,s[20:23],s84 offen offset:3072 sc1
buffer_load_dwordx4 v[144:147],v0,s[20:23],s85 offen offset:0 sc1
buffer_load_dwordx4 v[148:151],v0,s[20:23],s85 offen offset:1024 sc1
s_waitcnt vmcnt(0)
s_branch ck_271
done_171:
s_endpgm
fl_w3:
v_and_b32 v21,15,v1
v_lshrrev_b32 v22,4,v1
v_lshrrev_b32 v23,2,v21
v_and_b32 v24,3,v21
s_lshl_b32 s61,s50,15
v_lshl_add_u32 v25,v22,3,v23
s_load_dwordx2 s[4:5],s[0:1],80
s_mov_b32 s52,0
s_mov_b32 s53,s59
s_mul_i32 s54,s52,7340032
s_lshl_b32 s64,s53,8
s_add_u32 s54,s54,s64
s_lshl_b32 s64,s50,6
s_add_u32 s54,s54,s64
s_waitcnt lgkmcnt(0)
s_mov_b32 s28,s4
s_and_b32 s29,s5,0xffff
s_mov_b32 s30,0x700000
s_mov_b32 s31,0x20000
v_lshrrev_b32 v26,2,v1
v_and_b32 v27,3,v1
v_mul_u32_u24 v16,7168,v26
v_lshl_add_u32 v16,v27,4,v16
v_lshlrev_b32 v17,6,v25
v_lshl_add_u32 v17,v24,4,v17
v_add_u32 v17,s61,v17
s_xor_b32 s62,s50,0
s_mul_i32 s62,s62,1835008
s_add_u32 s62,s62,s54
s_add_u32 m0,s61,0
s_nop 0
buffer_load_dwordx4 v16,s[28:31],s62 offen lds
s_add_u32 s62,s62,114688
s_add_u32 m0,m0,1024
s_waitcnt vmcnt(2)
buffer_load_dwordx4 v16,s[28:31],s62 offen lds
s_add_u32 s62,s62,114688
s_add_u32 m0,m0,1024
s_waitcnt vmcnt(2)
buffer_load_dwordx4 v16,s[28:31],s62 offen lds
s_add_u32 s62,s62,114688
s_add_u32 m0,m0,1024
s_waitcnt vmcnt(2)
buffer_load_dwordx4 v16,s[28:31],s62 offen lds
s_add_u32 s62,s62,114688
s_add_u32 m0,m0,1024
s_waitcnt vmcnt(2)
buffer_load_dwordx4 v16,s[28:31],s62 offen lds
s_add_u32 s62,s62,114688
s_add_u32 m0,m0,1024
s_waitcnt vmcnt(2)
buffer_load_dwordx4 v16,s[28:31],s62 offen lds
s_add_u32 s62,s62,114688
s_add_u32 m0,m0,1024
s_waitcnt vmcnt(2)
buffer_load_dwordx4 v16,s[28:31],s62 offen lds
s_add_u32 s62,s62,114688
s_add_u32 m0,m0,1024
s_waitcnt vmcnt(2)
buffer_load_dwordx4 v16,s[28:31],s62 offen lds
s_add_u32 s62,s62,114688
s_add_u32 m0,m0,1024
s_waitcnt vmcnt(2)
buffer_load_dwordx4 v16,s[28:31],s62 offen lds
s_add_u32 s62,s62,114688
s_add_u32 m0,m0,1024
s_waitcnt vmcnt(2)
buffer_load_dwordx4 v16,s[28:31],s62 offen lds
s_add_u32 s62,s62,114688
s_add_u32 m0,m0,1024
s_waitcnt vmcnt(2)
buffer_load_dwordx4 v16,s[28:31],s62 offen lds
s_add_u32 s62,s62,114688
s_add_u32 m0,m0,1024
s_waitcnt vmcnt(2)
buffer_load_dwordx4 v16,s[28:31],s62 offen lds
s_add_u32 s62,s62,114688
s_add_u32 m0,m0,1024
s_waitcnt vmcnt(2)
buffer_load_dwordx4 v16,s[28:31],s62 offen lds
s_add_u32 s62,s62,114688
s_add_u32 m0,m0,1024
s_waitcnt vmcnt(2)
buffer_load_dwordx4 v16,s[28:31],s62 offen lds
s_add_u32 s62,s62,114688
s_add_u32 m0,m0,1024
s_waitcnt vmcnt(2)
buffer_load_dwordx4 v16,s[28:31],s62 offen lds
s_add_u32 s62,s62,114688
s_add_u32 m0,m0,1024
s_waitcnt vmcnt(2)
buffer_load_dwordx4 v16,s[28:31],s62 offen lds
s_waitcnt vmcnt(2)
s_xor_b32 s62,s50,1
s_mul_i32 s62,s62,1835008
s_add_u32 s62,s62,s54
s_add_u32 m0,s61,16384
s_nop 0
buffer_load_dwordx4 v16,s[28:31],s62 offen lds
s_add_u32 s62,s62,114688
s_add_u32 m0,m0,1024
s_waitcnt vmcnt(2)
buffer_load_dwordx4 v16,s[28:31],s62 offen lds
s_add_u32 s62,s62,114688
s_add_u32 m0,m0,1024
s_waitcnt vmcnt(2)
buffer_load_dwordx4 v16,s[28:31],s62 offen lds
s_add_u32 s62,s62,114688
s_add_u32 m0,m0,1024
s_waitcnt vmcnt(2)
buffer_load_dwordx4 v16,s[28:31],s62 offen lds
s_add_u32 s62,s62,114688
s_add_u32 m0,m0,1024
s_waitcnt vmcnt(2)
buffer_load_dwordx4 v16,s[28:31],s62 offen lds
s_add_u32 s62,s62,114688
s_add_u32 m0,m0,1024
s_waitcnt vmcnt(2)
buffer_load_dwordx4 v16,s[28:31],s62 offen lds
s_add_u32 s62,s62,114688
s_add_u32 m0,m0,1024
s_waitcnt vmcnt(2)
buffer_load_dwordx4 v16,s[28:31],s62 offen lds
s_add_u32 s62,s62,114688
s_add_u32 m0,m0,1024
s_waitcnt vmcnt(2)
buffer_load_dwordx4 v16,s[28:31],s62 offen lds
s_add_u32 s62,s62,114688
s_add_u32 m0,m0,1024
s_waitcnt vmcnt(2)
buffer_load_dwordx4 v16,s[28:31],s62 offen lds
s_add_u32 s62,s62,114688
s_add_u32 m0,m0,1024
s_waitcnt vmcnt(2)
buffer_load_dwordx4 v16,s[28:31],s62 offen lds
s_add_u32 s62,s62,114688
s_add_u32 m0,m0,1024
s_waitcnt vmcnt(2)
buffer_load_dwordx4 v16,s[28:31],s62 offen lds
s_add_u32 s62,s62,114688
s_add_u32 m0,m0,1024
s_waitcnt vmcnt(2)
buffer_load_dwordx4 v16,s[28:31],s62 offen lds
s_add_u32 s62,s62,114688
s_add_u32 m0,m0,1024
s_waitcnt vmcnt(2)
buffer_load_dwordx4 v16,s[28:31],s62 offen lds
s_add_u32 s62,s62,114688
s_add_u32 m0,m0,1024
s_waitcnt vmcnt(2)
buffer_load_dwordx4 v16,s[28:31],s62 offen lds
s_add_u32 s62,s62,114688
s_add_u32 m0,m0,1024
s_waitcnt vmcnt(2)
buffer_load_dwordx4 v16,s[28:31],s62 offen lds
s_add_u32 s62,s62,114688
s_add_u32 m0,m0,1024
s_waitcnt vmcnt(2)
buffer_load_dwordx4 v16,s[28:31],s62 offen lds
s_waitcnt vmcnt(2)
s_waitcnt vmcnt(16)
ds_read_b64_tr_b16 a[0:1],v17 offset:0
ds_read_b64_tr_b16 a[2:3],v17 offset:256
ds_read_b64_tr_b16 a[4:5],v17 offset:8
ds_read_b64_tr_b16 a[6:7],v17 offset:264
ds_read_b64_tr_b16 a[8:9],v17 offset:2048
ds_read_b64_tr_b16 a[10:11],v17 offset:2304
ds_read_b64_tr_b16 a[12:13],v17 offset:2056
ds_read_b64_tr_b16 a[14:15],v17 offset:2312
ds_read_b64_tr_b16 a[16:17],v17 offset:4096
ds_read_b64_tr_b16 a[18:19],v17 offset:4352
ds_read_b64_tr_b16 a[20:21],v17 offset:4104
ds_read_b64_tr_b16 a[22:23],v17 offset:4360
s_waitcnt lgkmcnt(0)
ds_read_b64_tr_b16 a[24:25],v17 offset:6144
ds_read_b64_tr_b16 a[26:27],v17 offset:6400
ds_read_b64_tr_b16 a[28:29],v17 offset:6152
ds_read_b64_tr_b16 a[30:31],v17 offset:6408
ds_read_b64_tr_b16 a[32:33],v17 offset:8192
ds_read_b64_tr_b16 a[34:35],v17 offset:8448
ds_read_b64_tr_b16 a[36:37],v17 offset:8200
ds_read_b64_tr_b16 a[38:39],v17 offset:8456
ds_read_b64_tr_b16 a[40:41],v17 offset:10240
ds_read_b64_tr_b16 a[42:43],v17 offset:10496
ds_read_b64_tr_b16 a[44:45],v17 offset:10248
ds_read_b64_tr_b16 a[46:47],v17 offset:10504
s_waitcnt lgkmcnt(0)
ds_read_b64_tr_b16 a[48:49],v17 offset:12288
ds_read_b64_tr_b16 a[50:51],v17 offset:12544
ds_read_b64_tr_b16 a[52:53],v17 offset:12296
ds_read_b64_tr_b16 a[54:55],v17 offset:12552
ds_read_b64_tr_b16 a[56:57],v17 offset:14336
ds_read_b64_tr_b16 a[58:59],v17 offset:14592
ds_read_b64_tr_b16 a[60:61],v17 offset:14344
ds_read_b64_tr_b16 a[62:63],v17 offset:14600
s_waitcnt lgkmcnt(0)
s_xor_b32 s62,s50,2
s_mul_i32 s62,s62,1835008
s_add_u32 s62,s62,s54
s_add_u32 m0,s61,0
s_nop 0
buffer_load_dwordx4 v16,s[28:31],s62 offen lds
s_add_u32 s62,s62,114688
s_add_u32 m0,m0,1024
s_waitcnt vmcnt(2)
buffer_load_dwordx4 v16,s[28:31],s62 offen lds
s_add_u32 s62,s62,114688
s_add_u32 m0,m0,1024
s_waitcnt vmcnt(2)
buffer_load_dwordx4 v16,s[28:31],s62 offen lds
s_add_u32 s62,s62,114688
s_add_u32 m0,m0,1024
s_waitcnt vmcnt(2)
buffer_load_dwordx4 v16,s[28:31],s62 offen lds
s_add_u32 s62,s62,114688
s_add_u32 m0,m0,1024
s_waitcnt vmcnt(2)
buffer_load_dwordx4 v16,s[28:31],s62 offen lds
s_add_u32 s62,s62,114688
s_add_u32 m0,m0,1024
s_waitcnt vmcnt(2)
buffer_load_dwordx4 v16,s[28:31],s62 offen lds
s_add_u32 s62,s62,114688
s_add_u32 m0,m0,1024
s_waitcnt vmcnt(2)
buffer_load_dwordx4 v16,s[28:31],s62 offen lds
s_add_u32 s62,s62,114688
s_add_u32 m0,m0,1024
s_waitcnt vmcnt(2)
buffer_load_dwordx4 v16,s[28:31],s62 offen lds
s_add_u32 s62,s62,114688
s_add_u32 m0,m0,1024
s_waitcnt vmcnt(2)
buffer_load_dwordx4 v16,s[28:31],s62 offen lds
s_add_u32 s62,s62,114688
s_add_u32 m0,m0,1024
s_waitcnt vmcnt(2)
buffer_load_dwordx4 v16,s[28:31],s62 offen lds
s_add_u32 s62,s62,114688
s_add_u32 m0,m0,1024
s_waitcnt vmcnt(2)
buffer_load_dwordx4 v16,s[28:31],s62 offen lds
s_add_u32 s62,s62,114688
s_add_u32 m0,m0,1024
s_waitcnt vmcnt(2)
buffer_load_dwordx4 v16,s[28:31],s62 offen lds
s_add_u32 s62,s62,114688
s_add_u32 m0,m0,1024
s_waitcnt vmcnt(2)
buffer_load_dwordx4 v16,s[28:31],s62 offen lds
s_add_u32 s62,s62,114688
s_add_u32 m0,m0,1024
s_waitcnt vmcnt(2)
buffer_load_dwordx4 v16,s[28:31],s62 offen lds
s_add_u32 s62,s62,114688
s_add_u32 m0,m0,1024
s_waitcnt vmcnt(2)
buffer_load_dwordx4 v16,s[28:31],s62 offen lds
s_add_u32 s62,s62,114688
s_add_u32 m0,m0,1024
s_waitcnt vmcnt(2)
buffer_load_dwordx4 v16,s[28:31],s62 offen lds
s_waitcnt vmcnt(2)
s_waitcnt vmcnt(16)
ds_read_b64_tr_b16 a[64:65],v17 offset:16384
ds_read_b64_tr_b16 a[66:67],v17 offset:16640
ds_read_b64_tr_b16 a[68:69],v17 offset:16392
ds_read_b64_tr_b16 a[70:71],v17 offset:16648
ds_read_b64_tr_b16 a[72:73],v17 offset:18432
ds_read_b64_tr_b16 a[74:75],v17 offset:18688
ds_read_b64_tr_b16 a[76:77],v17 offset:18440
ds_read_b64_tr_b16 a[78:79],v17 offset:18696
ds_read_b64_tr_b16 a[80:81],v17 offset:20480
ds_read_b64_tr_b16 a[82:83],v17 offset:20736
ds_read_b64_tr_b16 a[84:85],v17 offset:20488
ds_read_b64_tr_b16 a[86:87],v17 offset:20744
s_waitcnt lgkmcnt(0)
ds_read_b64_tr_b16 a[88:89],v17 offset:22528
ds_read_b64_tr_b16 a[90:91],v17 offset:22784
ds_read_b64_tr_b16 a[92:93],v17 offset:22536
ds_read_b64_tr_b16 a[94:95],v17 offset:22792
ds_read_b64_tr_b16 a[96:97],v17 offset:24576
ds_read_b64_tr_b16 a[98:99],v17 offset:24832
ds_read_b64_tr_b16 a[100:101],v17 offset:24584
ds_read_b64_tr_b16 a[102:103],v17 offset:24840
ds_read_b64_tr_b16 a[104:105],v17 offset:26624
ds_read_b64_tr_b16 a[106:107],v17 offset:26880
ds_read_b64_tr_b16 a[108:109],v17 offset:26632
ds_read_b64_tr_b16 a[110:111],v17 offset:26888
s_waitcnt lgkmcnt(0)
ds_read_b64_tr_b16 a[112:113],v17 offset:28672
ds_read_b64_tr_b16 a[114:115],v17 offset:28928
ds_read_b64_tr_b16 a[116:117],v17 offset:28680
ds_read_b64_tr_b16 a[118:119],v17 offset:28936
ds_read_b64_tr_b16 a[120:121],v17 offset:30720
ds_read_b64_tr_b16 a[122:123],v17 offset:30976
ds_read_b64_tr_b16 a[124:125],v17 offset:30728
ds_read_b64_tr_b16 a[126:127],v17 offset:30984
s_waitcnt lgkmcnt(0)
s_xor_b32 s62,s50,3
s_mul_i32 s62,s62,1835008
s_add_u32 s62,s62,s54
s_add_u32 m0,s61,16384
s_nop 0
buffer_load_dwordx4 v16,s[28:31],s62 offen lds
s_add_u32 s62,s62,114688
s_add_u32 m0,m0,1024
s_waitcnt vmcnt(2)
buffer_load_dwordx4 v16,s[28:31],s62 offen lds
s_add_u32 s62,s62,114688
s_add_u32 m0,m0,1024
s_waitcnt vmcnt(2)
buffer_load_dwordx4 v16,s[28:31],s62 offen lds
s_add_u32 s62,s62,114688
s_add_u32 m0,m0,1024
s_waitcnt vmcnt(2)
buffer_load_dwordx4 v16,s[28:31],s62 offen lds
s_add_u32 s62,s62,114688
s_add_u32 m0,m0,1024
s_waitcnt vmcnt(2)
buffer_load_dwordx4 v16,s[28:31],s62 offen lds
s_add_u32 s62,s62,114688
s_add_u32 m0,m0,1024
s_waitcnt vmcnt(2)
buffer_load_dwordx4 v16,s[28:31],s62 offen lds
s_add_u32 s62,s62,114688
s_add_u32 m0,m0,1024
s_waitcnt vmcnt(2)
buffer_load_dwordx4 v16,s[28:31],s62 offen lds
s_add_u32 s62,s62,114688
s_add_u32 m0,m0,1024
s_waitcnt vmcnt(2)
buffer_load_dwordx4 v16,s[28:31],s62 offen lds
s_add_u32 s62,s62,114688
s_add_u32 m0,m0,1024
s_waitcnt vmcnt(2)
buffer_load_dwordx4 v16,s[28:31],s62 offen lds
s_add_u32 s62,s62,114688
s_add_u32 m0,m0,1024
s_waitcnt vmcnt(2)
buffer_load_dwordx4 v16,s[28:31],s62 offen lds
s_add_u32 s62,s62,114688
s_add_u32 m0,m0,1024
s_waitcnt vmcnt(2)
buffer_load_dwordx4 v16,s[28:31],s62 offen lds
s_add_u32 s62,s62,114688
s_add_u32 m0,m0,1024
s_waitcnt vmcnt(2)
buffer_load_dwordx4 v16,s[28:31],s62 offen lds
s_add_u32 s62,s62,114688
s_add_u32 m0,m0,1024
s_waitcnt vmcnt(2)
buffer_load_dwordx4 v16,s[28:31],s62 offen lds
s_add_u32 s62,s62,114688
s_add_u32 m0,m0,1024
s_waitcnt vmcnt(2)
buffer_load_dwordx4 v16,s[28:31],s62 offen lds
s_add_u32 s62,s62,114688
s_add_u32 m0,m0,1024
s_waitcnt vmcnt(2)
buffer_load_dwordx4 v16,s[28:31],s62 offen lds
s_add_u32 s62,s62,114688
s_add_u32 m0,m0,1024
s_waitcnt vmcnt(2)
buffer_load_dwordx4 v16,s[28:31],s62 offen lds
s_waitcnt vmcnt(2)
s_waitcnt vmcnt(16)
ds_read_b64_tr_b16 a[128:129],v17 offset:0
ds_read_b64_tr_b16 a[130:131],v17 offset:256
ds_read_b64_tr_b16 a[132:133],v17 offset:8
ds_read_b64_tr_b16 a[134:135],v17 offset:264
ds_read_b64_tr_b16 a[136:137],v17 offset:2048
ds_read_b64_tr_b16 a[138:139],v17 offset:2304
ds_read_b64_tr_b16 a[140:141],v17 offset:2056
ds_read_b64_tr_b16 a[142:143],v17 offset:2312
ds_read_b64_tr_b16 a[144:145],v17 offset:4096
ds_read_b64_tr_b16 a[146:147],v17 offset:4352
ds_read_b64_tr_b16 a[148:149],v17 offset:4104
ds_read_b64_tr_b16 a[150:151],v17 offset:4360
s_waitcnt lgkmcnt(0)
ds_read_b64_tr_b16 a[152:153],v17 offset:6144
ds_read_b64_tr_b16 a[154:155],v17 offset:6400
ds_read_b64_tr_b16 a[156:157],v17 offset:6152
ds_read_b64_tr_b16 a[158:159],v17 offset:6408
ds_read_b64_tr_b16 a[160:161],v17 offset:8192
ds_read_b64_tr_b16 a[162:163],v17 offset:8448
ds_read_b64_tr_b16 a[164:165],v17 offset:8200
ds_read_b64_tr_b16 a[166:167],v17 offset:8456
ds_read_b64_tr_b16 a[168:169],v17 offset:10240
ds_read_b64_tr_b16 a[170:171],v17 offset:10496
ds_read_b64_tr_b16 a[172:173],v17 offset:10248
ds_read_b64_tr_b16 a[174:175],v17 offset:10504
s_waitcnt lgkmcnt(0)
ds_read_b64_tr_b16 a[176:177],v17 offset:12288
ds_read_b64_tr_b16 a[178:179],v17 offset:12544
ds_read_b64_tr_b16 a[180:181],v17 offset:12296
ds_read_b64_tr_b16 a[182:183],v17 offset:12552
ds_read_b64_tr_b16 a[184:185],v17 offset:14336
ds_read_b64_tr_b16 a[186:187],v17 offset:14592
ds_read_b64_tr_b16 a[188:189],v17 offset:14344
ds_read_b64_tr_b16 a[190:191],v17 offset:14600
s_waitcnt lgkmcnt(0)
s_waitcnt vmcnt(0)
ds_read_b64_tr_b16 a[192:193],v17 offset:16384
ds_read_b64_tr_b16 a[194:195],v17 offset:16640
ds_read_b64_tr_b16 a[196:197],v17 offset:16392
ds_read_b64_tr_b16 a[198:199],v17 offset:16648
ds_read_b64_tr_b16 a[200:201],v17 offset:18432
ds_read_b64_tr_b16 a[202:203],v17 offset:18688
ds_read_b64_tr_b16 a[204:205],v17 offset:18440
ds_read_b64_tr_b16 a[206:207],v17 offset:18696
ds_read_b64_tr_b16 a[208:209],v17 offset:20480
ds_read_b64_tr_b16 a[210:211],v17 offset:20736
ds_read_b64_tr_b16 a[212:213],v17 offset:20488
ds_read_b64_tr_b16 a[214:215],v17 offset:20744
s_waitcnt lgkmcnt(0)
ds_read_b64_tr_b16 a[216:217],v17 offset:22528
ds_read_b64_tr_b16 a[218:219],v17 offset:22784
ds_read_b64_tr_b16 a[220:221],v17 offset:22536
ds_read_b64_tr_b16 a[222:223],v17 offset:22792
ds_read_b64_tr_b16 a[224:225],v17 offset:24576
ds_read_b64_tr_b16 a[226:227],v17 offset:24832
ds_read_b64_tr_b16 a[228:229],v17 offset:24584
ds_read_b64_tr_b16 a[230:231],v17 offset:24840
ds_read_b64_tr_b16 a[232:233],v17 offset:26624
ds_read_b64_tr_b16 a[234:235],v17 offset:26880
ds_read_b64_tr_b16 a[236:237],v17 offset:26632
ds_read_b64_tr_b16 a[238:239],v17 offset:26888
s_waitcnt lgkmcnt(0)
ds_read_b64_tr_b16 a[240:241],v17 offset:28672
ds_read_b64_tr_b16 a[242:243],v17 offset:28928
ds_read_b64_tr_b16 a[244:245],v17 offset:28680
ds_read_b64_tr_b16 a[246:247],v17 offset:28936
ds_read_b64_tr_b16 a[248:249],v17 offset:30720
ds_read_b64_tr_b16 a[250:251],v17 offset:30976
ds_read_b64_tr_b16 a[252:253],v17 offset:30728
ds_read_b64_tr_b16 a[254:255],v17 offset:30984
s_waitcnt lgkmcnt(0)
s_mov_b32 s92,s2
s_and_b32 s93,s3,0xffff
s_mov_b32 s94,0x100
s_mov_b32 s95,0x20000
v_mbcnt_lo_u32_b32 v16,-1,0
v_mbcnt_hi_u32_b32 v16,-1,v16
v_mov_b32 v18,0
v_cmp_eq_u32 vcc,22,v16
s_nop 1
v_cndmask_b32 v18,v18,63,vcc
v_cmp_eq_u32 vcc,17,v16
s_nop 1
v_cndmask_b32 v18,v18,63,vcc
v_cmp_eq_u32 vcc,18,v16
s_nop 1
v_cndmask_b32 v18,v18,1,vcc
v_and_b32 v19,1,v16
v_cmp_eq_u32 vcc,1,v19
v_mov_b32 v19,8192
s_nop 0
v_cndmask_b32 v19,-1,v19,vcc
v_min_u32 v16,31,v16
v_lshlrev_b32 v16,2,v16
s_sub_u32 s66,s88,64
s_cmp_lg_u32 s50,0
s_cbranch_scc1 vot_281
vpoll_277:
buffer_load_dword v17,v16,s[92:95],s66 offen sc1
s_waitcnt vmcnt(0)
s_cmp_lg_u32 s56,2
s_cbranch_scc1 vck_278
v_cmp_eq_u32 vcc,v17,v19
s_and_b32 s64,vcc_lo,0xffff
s_cmp_eq_u32 s64,65535
s_cbranch_scc1 vck_278
s_mov_b32 s65,0
v_readlane_b32 s64,v17,1
s_lshr_b32 s64,s64,8
s_add_u32 s65,s65,s64
v_readlane_b32 s64,v17,3
s_lshr_b32 s64,s64,8
s_add_u32 s65,s65,s64
v_readlane_b32 s64,v17,5
s_lshr_b32 s64,s64,8
s_add_u32 s65,s65,s64
v_readlane_b32 s64,v17,7
s_lshr_b32 s64,s64,8
s_add_u32 s65,s65,s64
v_readlane_b32 s64,v17,9
s_lshr_b32 s64,s64,8
s_add_u32 s65,s65,s64
v_readlane_b32 s64,v17,11
s_lshr_b32 s64,s64,8
s_add_u32 s65,s65,s64
v_readlane_b32 s64,v17,13
s_lshr_b32 s64,s64,8
s_add_u32 s65,s65,s64
v_readlane_b32 s64,v17,15
s_lshr_b32 s64,s64,8
s_add_u32 s65,s65,s64
s_cmp_ge_u32 s65,256
s_cbranch_scc1 vok_280
s_branch vrt_279
vck_278:
v_cmp_gt_u32 vcc,v18,v17
s_cbranch_vccz vok_280
vrt_279:
s_sleep 48
s_sub_u32 s90,s90,1
s_cmp_gt_i32 s90,0
s_cbranch_scc1 vpoll_277
vok_280:
v_add_u32 v18,160256,v16
ds_write_b32 v18,v17
s_waitcnt lgkmcnt(0)
vot_281:
s_barrier
v_add_u32 v18,160256,v16
ds_read_b32 v17,v18
s_waitcnt lgkmcnt(0)
s_cmp_lg_u32 s56,2
s_cbranch_scc1 vfin_282
v_cmp_eq_u32 vcc,v17,v19
s_and_b32 s64,vcc_lo,0xffff
s_cmp_eq_u32 s64,65535
s_cbranch_scc1 vfin_282
s_mov_b32 s65,0
v_readlane_b32 s64,v17,1
s_lshr_b32 s64,s64,8
s_add_u32 s65,s65,s64
v_readlane_b32 s64,v17,3
s_lshr_b32 s64,s64,8
s_add_u32 s65,s65,s64
v_readlane_b32 s64,v17,5
s_lshr_b32 s64,s64,8
s_add_u32 s65,s65,s64
v_readlane_b32 s64,v17,7
s_lshr_b32 s64,s64,8
s_add_u32 s65,s65,s64
v_readlane_b32 s64,v17,9
s_lshr_b32 s64,s64,8
s_add_u32 s65,s65,s64
v_readlane_b32 s64,v17,11
s_lshr_b32 s64,s64,8
s_add_u32 s65,s65,s64
v_readlane_b32 s64,v17,13
s_lshr_b32 s64,s64,8
s_add_u32 s65,s65,s64
v_readlane_b32 s64,v17,15
s_lshr_b32 s64,s64,8
s_add_u32 s65,s65,s64
s_cmp_ge_u32 s65,256
s_cbranch_scc1 fl_fb
vfin_282:
s_and_b32 s56,s56,1
s_mov_b32 s67,0
s_barrier
v_lshlrev_b32 v0,4,v1
s_mov_b32 s60,0
s_lshl_b32 s70,s50,13
s_mov_b32 s55,0
v_mov_b32 v3,v0
s_mov_b32 s73,0xffff0000
s_lshl_b32 s64,s52,2
s_add_u32 s64,s64,s50
s_mul_i32 s61,s64,8192
s_add_u32 s61,s61,214958080
s_lshl_b32 s68,s64,8
s_add_u32 s68,s68,138550272
s_lshl_b32 s83,s53,2
s_add_u32 s83,s83,s50
s_mov_b32 s63,0
s_xor_b32 s64,s50,0
s_lshl_b32 s64,s64,13
v_add_u32 v8,s64,v0
v_mov_b32 v4,v8
s_xor_b32 s64,s50,1
s_lshl_b32 s64,s64,13
v_add_u32 v9,s64,v0
v_mov_b32 v5,v9
s_xor_b32 s64,s50,2
s_lshl_b32 s64,s64,13
v_add_u32 v10,s64,v0
v_mov_b32 v6,v10
s_xor_b32 s64,s50,3
s_lshl_b32 s64,s64,13
v_add_u32 v11,s64,v0
v_mov_b32 v7,v11
v_min_u32 v2,7,v1
v_lshlrev_b32 v2,2,v2
s_add_u32 s62,s61,4096
s_lshl_b32 s66,s83,10
s_mul_i32 s65,s83,147
s_lshr_b32 s65,s65,10
s_mul_i32 s69,s65,228
s_lshl_b32 s64,s83,2
s_add_u32 s69,s69,s64
s_add_u32 s69,s69,138551296
s_add_u32 s82,s66,201326592
s_add_u32 s66,s66,219152384
s_lshl_b32 s64,s50,9
s_add_u32 s64,s64,131072
v_lshlrev_b32 v26,3,v1
v_add_u32 v19,s64,v26
v_lshl_add_u32 v26,v23,4,v21
v_lshlrev_b32 v26,3,v26
v_add_u32 v20,131072,v26
s_mov_b32 s74,0x22222222
s_mov_b32 s75,0x22222222
s_mov_b32 s76,0x44444444
s_mov_b32 s77,0x44444444
s_mov_b32 s78,0x88888888
s_mov_b32 s79,0x88888888
v_mov_b32 v208,0xbdd2d3e8
v_mov_b32 v209,0xc0135761
v_mov_b32 v210,0x3727c5ac
v_mov_b32 v211,0x3a800000
v_mov_b32 v12,0x3f803f80
v_mov_b32 v13,0x3f803f80
v_mov_b32 v14,0x3f803f80
v_mov_b32 v15,0x3f803f80
s_nop 1
v_mfma_f32_16x16x32_bf16 v[152:155],a[0:3],v[12:15],0
v_mfma_f32_16x16x32_bf16 v[156:159],a[4:7],v[12:15],0
v_mfma_f32_16x16x32_bf16 v[152:155],a[8:11],v[12:15],v[152:155]
v_mfma_f32_16x16x32_bf16 v[156:159],a[12:15],v[12:15],v[156:159]
v_mfma_f32_16x16x32_bf16 v[152:155],a[16:19],v[12:15],v[152:155]
v_mfma_f32_16x16x32_bf16 v[156:159],a[20:23],v[12:15],v[156:159]
v_mfma_f32_16x16x32_bf16 v[152:155],a[24:27],v[12:15],v[152:155]
v_mfma_f32_16x16x32_bf16 v[156:159],a[28:31],v[12:15],v[156:159]
v_mfma_f32_16x16x32_bf16 v[152:155],a[32:35],v[12:15],v[152:155]
v_mfma_f32_16x16x32_bf16 v[156:159],a[36:39],v[12:15],v[156:159]
v_mfma_f32_16x16x32_bf16 v[152:155],a[40:43],v[12:15],v[152:155]
v_mfma_f32_16x16x32_bf16 v[156:159],a[44:47],v[12:15],v[156:159]
v_mfma_f32_16x16x32_bf16 v[152:155],a[48:51],v[12:15],v[152:155]
v_mfma_f32_16x16x32_bf16 v[156:159],a[52:55],v[12:15],v[156:159]
v_mfma_f32_16x16x32_bf16 v[152:155],a[56:59],v[12:15],v[152:155]
v_mfma_f32_16x16x32_bf16 v[156:159],a[60:63],v[12:15],v[156:159]
v_mfma_f32_16x16x32_bf16 v[152:155],a[64:67],v[12:15],v[152:155]
v_mfma_f32_16x16x32_bf16 v[156:159],a[68:71],v[12:15],v[156:159]
v_mfma_f32_16x16x32_bf16 v[152:155],a[72:75],v[12:15],v[152:155]
v_mfma_f32_16x16x32_bf16 v[156:159],a[76:79],v[12:15],v[156:159]
v_mfma_f32_16x16x32_bf16 v[152:155],a[80:83],v[12:15],v[152:155]
v_mfma_f32_16x16x32_bf16 v[156:159],a[84:87],v[12:15],v[156:159]
v_mfma_f32_16x16x32_bf16 v[152:155],a[88:91],v[12:15],v[152:155]
v_mfma_f32_16x16x32_bf16 v[156:159],a[92:95],v[12:15],v[156:159]
v_mfma_f32_16x16x32_bf16 v[152:155],a[96:99],v[12:15],v[152:155]
v_mfma_f32_16x16x32_bf16 v[156:159],a[100:103],v[12:15],v[156:159]
v_mfma_f32_16x16x32_bf16 v[152:155],a[104:107],v[12:15],v[152:155]
v_mfma_f32_16x16x32_bf16 v[156:159],a[108:111],v[12:15],v[156:159]
v_mfma_f32_16x16x32_bf16 v[152:155],a[112:115],v[12:15],v[152:155]
v_mfma_f32_16x16x32_bf16 v[156:159],a[116:119],v[12:15],v[156:159]
v_mfma_f32_16x16x32_bf16 v[152:155],a[120:123],v[12:15],v[152:155]
v_mfma_f32_16x16x32_bf16 v[156:159],a[124:127],v[12:15],v[156:159]
v_mfma_f32_16x16x32_bf16 v[152:155],a[128:131],v[12:15],v[152:155]
v_mfma_f32_16x16x32_bf16 v[156:159],a[132:135],v[12:15],v[156:159]
v_mfma_f32_16x16x32_bf16 v[152:155],a[136:139],v[12:15],v[152:155]
v_mfma_f32_16x16x32_bf16 v[156:159],a[140:143],v[12:15],v[156:159]
v_mfma_f32_16x16x32_bf16 v[152:155],a[144:147],v[12:15],v[152:155]
v_mfma_f32_16x16x32_bf16 v[156:159],a[148:151],v[12:15],v[156:159]
v_mfma_f32_16x16x32_bf16 v[152:155],a[152:155],v[12:15],v[152:155]
v_mfma_f32_16x16x32_bf16 v[156:159],a[156:159],v[12:15],v[156:159]
v_mfma_f32_16x16x32_bf16 v[152:155],a[160:163],v[12:15],v[152:155]
v_mfma_f32_16x16x32_bf16 v[156:159],a[164:167],v[12:15],v[156:159]
v_mfma_f32_16x16x32_bf16 v[152:155],a[168:171],v[12:15],v[152:155]
v_mfma_f32_16x16x32_bf16 v[156:159],a[172:175],v[12:15],v[156:159]
v_mfma_f32_16x16x32_bf16 v[152:155],a[176:179],v[12:15],v[152:155]
v_mfma_f32_16x16x32_bf16 v[156:159],a[180:183],v[12:15],v[156:159]
v_mfma_f32_16x16x32_bf16 v[152:155],a[184:187],v[12:15],v[152:155]
v_mfma_f32_16x16x32_bf16 v[156:159],a[188:191],v[12:15],v[156:159]
v_mfma_f32_16x16x32_bf16 v[152:155],a[192:195],v[12:15],v[152:155]
v_mfma_f32_16x16x32_bf16 v[156:159],a[196:199],v[12:15],v[156:159]
v_mfma_f32_16x16x32_bf16 v[152:155],a[200:203],v[12:15],v[152:155]
v_mfma_f32_16x16x32_bf16 v[156:159],a[204:207],v[12:15],v[156:159]
v_mfma_f32_16x16x32_bf16 v[152:155],a[208:211],v[12:15],v[152:155]
v_mfma_f32_16x16x32_bf16 v[156:159],a[212:215],v[12:15],v[156:159]
v_mfma_f32_16x16x32_bf16 v[152:155],a[216:219],v[12:15],v[152:155]
v_mfma_f32_16x16x32_bf16 v[156:159],a[220:223],v[12:15],v[156:159]
v_mfma_f32_16x16x32_bf16 v[152:155],a[224:227],v[12:15],v[152:155]
v_mfma_f32_16x16x32_bf16 v[156:159],a[228:231],v[12:15],v[156:159]
v_mfma_f32_16x16x32_bf16 v[152:155],a[232:235],v[12:15],v[152:155]
v_mfma_f32_16x16x32_bf16 v[156:159],a[236:239],v[12:15],v[156:159]
v_mfma_f32_16x16x32_bf16 v[152:155],a[240:243],v[12:15],v[152:155]
v_mfma_f32_16x16x32_bf16 v[156:159],a[244:247],v[12:15],v[156:159]
v_mfma_f32_16x16x32_bf16 v[152:155],a[248:251],v[12:15],v[152:155]
v_mfma_f32_16x16x32_bf16 v[156:159],a[252:255],v[12:15],v[156:159]
v_cmp_eq_u32 vcc,0,v1
s_nop 1
v_cndmask_b32 v26,2.0,0,vcc
s_add_u32 s71,s60,1
s_add_u32 s53,s60,2
plp_290:
buffer_load_dword v16,v2,s[20:23],s68 offen sc1
s_waitcnt vmcnt(0)
v_cmp_gt_u32 vcc,s71,v16
s_cbranch_vccz pok_291
s_sleep 4
s_sub_u32 s90,s90,1
s_cmp_gt_i32 s90,0
s_cbranch_scc1 plp_290
pok_291:
lag_287:
s_mov_b32 m0,s70
s_nop 0
buffer_load_dwordx4 v3,s[20:23],s61 offen offset:0 lds
buffer_load_dwordx4 v3,s[20:23],s61 offen offset:1024 lds
buffer_load_dwordx4 v3,s[20:23],s61 offen offset:2048 lds
buffer_load_dwordx4 v3,s[20:23],s61 offen offset:3072 lds
s_add_u32 m0,s70,4096
s_nop 0
buffer_load_dwordx4 v3,s[20:23],s62 offen offset:0 lds
buffer_load_dwordx4 v3,s[20:23],s62 offen offset:1024 lds
buffer_load_dwordx4 v3,s[20:23],s62 offen offset:2048 lds
buffer_load_dwordx4 v3,s[20:23],s62 offen offset:3072 lds
s_add_u32 s61,s61,32768
s_add_u32 s62,s62,32768
s_add_u32 s70,s70,32768
s_and_b32 s70,s70,0x1ffff
buffer_load_dword v23,off,s[20:23],s66
buffer_load_dword v23,off,s[20:23],s66
dec_288:
v_cmp_gt_u32 vcc,s53,v16
s_cbranch_vccnz BN_286
BR_285:
s_waitcnt vmcnt(9)
ds_read_b128 v[64:67],v4 offset:0
s_waitcnt vmcnt(8)
ds_read_b128 v[68:71],v4 offset:1024
s_waitcnt vmcnt(7)
ds_read_b128 v[72:75],v4 offset:2048
s_waitcnt vmcnt(6)
ds_read_b128 v[76:79],v4 offset:3072
s_waitcnt lgkmcnt(3)
v_mfma_f32_16x16x32_bf16 v[32:35],a[0:3],v[64:67],0
s_add_u32 s71,s60,2
s_add_u32 s53,s60,3
s_mov_b32 s57,s63
v_mfma_f32_16x16x32_bf16 v[36:39],a[4:7],v[64:67],0
v_mfma_f32_16x16x32_bf16 v[48:51],v[12:15],v[64:67],0
v_mfma_f32_16x16x32_bf16 v[52:55],v[64:67],v[64:67],0
s_waitcnt lgkmcnt(2)
s_waitcnt vmcnt(5)
s_mov_b32 m0,s70
ds_read_b128 v[80:83],v4 offset:4096
v_mfma_f32_16x16x32_bf16 v[32:35],a[8:11],v[68:71],v[32:35]
buffer_load_dwordx4 v3,s[20:23],s61 offen offset:0 lds
v_mfma_f32_16x16x32_bf16 v[36:39],a[12:15],v[68:71],v[36:39]
v_mfma_f32_16x16x32_bf16 v[48:51],v[12:15],v[68:71],v[48:51]
v_mfma_f32_16x16x32_bf16 v[52:55],v[68:71],v[68:71],v[52:55]
s_waitcnt lgkmcnt(2)
s_waitcnt vmcnt(5)
ds_read_b128 v[84:87],v4 offset:5120
v_mfma_f32_16x16x32_bf16 v[32:35],a[16:19],v[72:75],v[32:35]
buffer_load_dwordx4 v3,s[20:23],s61 offen offset:1024 lds
v_mfma_f32_16x16x32_bf16 v[36:39],a[20:23],v[72:75],v[36:39]
v_mfma_f32_16x16x32_bf16 v[48:51],v[12:15],v[72:75],v[48:51]
v_mfma_f32_16x16x32_bf16 v[52:55],v[72:75],v[72:75],v[52:55]
s_waitcnt lgkmcnt(2)
s_waitcnt vmcnt(5)
ds_read_b128 v[88:91],v4 offset:6144
v_mfma_f32_16x16x32_bf16 v[32:35],a[24:27],v[76:79],v[32:35]
buffer_load_dwordx4 v3,s[20:23],s61 offen offset:2048 lds
v_mfma_f32_16x16x32_bf16 v[36:39],a[28:31],v[76:79],v[36:39]
v_mfma_f32_16x16x32_bf16 v[48:51],v[12:15],v[76:79],v[48:51]
v_mfma_f32_16x16x32_bf16 v[52:55],v[76:79],v[76:79],v[52:55]
s_waitcnt lgkmcnt(2)
s_waitcnt vmcnt(5)
ds_read_b128 v[92:95],v4 offset:7168
v_mfma_f32_16x16x32_bf16 v[32:35],a[32:35],v[80:83],v[32:35]
buffer_load_dwordx4 v3,s[20:23],s61 offen offset:3072 lds
v_mfma_f32_16x16x32_bf16 v[36:39],a[36:39],v[80:83],v[36:39]
v_mfma_f32_16x16x32_bf16 v[48:51],v[12:15],v[80:83],v[48:51]
v_mfma_f32_16x16x32_bf16 v[52:55],v[80:83],v[80:83],v[52:55]
s_waitcnt lgkmcnt(2)
s_barrier
ds_read_b128 v[96:99],v5 offset:0
v_mfma_f32_16x16x32_bf16 v[32:35],a[40:43],v[84:87],v[32:35]
ds_read_b128 v[100:103],v5 offset:1024
v_mfma_f32_16x16x32_bf16 v[36:39],a[44:47],v[84:87],v[36:39]
ds_read_b128 v[104:107],v5 offset:2048
v_mfma_f32_16x16x32_bf16 v[48:51],v[12:15],v[84:87],v[48:51]
s_add_u32 m0,s70,4096
ds_read_b128 v[108:111],v5 offset:3072
v_mfma_f32_16x16x32_bf16 v[52:55],v[84:87],v[84:87],v[52:55]
s_waitcnt lgkmcnt(5)
buffer_load_dwordx4 v3,s[20:23],s62 offen offset:0 lds
v_mfma_f32_16x16x32_bf16 v[32:35],a[48:51],v[88:91],v[32:35]
ds_read_b128 v[112:115],v5 offset:4096
v_mfma_f32_16x16x32_bf16 v[36:39],a[52:55],v[88:91],v[36:39]
buffer_load_dwordx4 v3,s[20:23],s62 offen offset:1024 lds
v_mfma_f32_16x16x32_bf16 v[48:51],v[12:15],v[88:91],v[48:51]
v_mfma_f32_16x16x32_bf16 v[52:55],v[88:91],v[88:91],v[52:55]
s_waitcnt lgkmcnt(5)
v_mfma_f32_16x16x32_bf16 v[32:35],a[56:59],v[92:95],v[32:35]
ds_read_b128 v[116:119],v5 offset:5120
v_mfma_f32_16x16x32_bf16 v[36:39],a[60:63],v[92:95],v[36:39]
buffer_load_dwordx4 v3,s[20:23],s62 offen offset:2048 lds
v_mfma_f32_16x16x32_bf16 v[48:51],v[12:15],v[92:95],v[48:51]
buffer_load_dword v16,v2,s[20:23],s68 offen sc1
v_mfma_f32_16x16x32_bf16 v[52:55],v[92:95],v[92:95],v[52:55]
s_waitcnt lgkmcnt(5)
v_mfma_f32_16x16x32_bf16 v[32:35],a[64:67],v[96:99],v[32:35]
ds_read_b128 v[120:123],v5 offset:6144
v_mfma_f32_16x16x32_bf16 v[36:39],a[68:71],v[96:99],v[36:39]
s_waitcnt lgkmcnt(5)
buffer_load_dwordx4 v3,s[20:23],s62 offen offset:3072 lds
v_mfma_f32_16x16x32_bf16 v[32:35],a[72:75],v[100:103],v[32:35]
ds_read_b128 v[124:127],v5 offset:7168
v_mfma_f32_16x16x32_bf16 v[36:39],a[76:79],v[100:103],v[36:39]
s_waitcnt lgkmcnt(5)
v_mfma_f32_16x16x32_bf16 v[32:35],a[80:83],v[104:107],v[32:35]
ds_read_b128 v[64:67],v6 offset:0
v_cndmask_b32 v49,v52,v53,s[74:75]
v_mfma_f32_16x16x32_bf16 v[36:39],a[84:87],v[104:107],v[36:39]
s_waitcnt lgkmcnt(5)
v_cndmask_b32 v49,v49,v54,s[76:77]
v_cndmask_b32 v49,v49,v55,s[78:79]
v_mfma_f32_16x16x32_bf16 v[32:35],a[88:91],v[108:111],v[32:35]
ds_read_b128 v[68:71],v6 offset:1024
v_mfma_f32_16x16x32_bf16 v[36:39],a[92:95],v[108:111],v[36:39]
s_waitcnt lgkmcnt(5)
ds_write_b64 v19,v[48:49]
v_mfma_f32_16x16x32_bf16 v[32:35],a[96:99],v[112:115],v[32:35]
ds_read_b128 v[72:75],v6 offset:2048
v_mfma_f32_16x16x32_bf16 v[36:39],a[100:103],v[112:115],v[36:39]
s_waitcnt lgkmcnt(6)
v_mfma_f32_16x16x32_bf16 v[32:35],a[104:107],v[116:119],v[32:35]
ds_read_b128 v[76:79],v6 offset:3072
v_mfma_f32_16x16x32_bf16 v[36:39],a[108:111],v[116:119],v[36:39]
s_waitcnt lgkmcnt(6)
v_mfma_f32_16x16x32_bf16 v[32:35],a[112:115],v[120:123],v[32:35]
s_waitcnt lgkmcnt(2)
s_barrier
ds_read_b128 v[80:83],v6 offset:4096
v_mfma_f32_16x16x32_bf16 v[36:39],a[116:119],v[120:123],v[36:39]
ds_read_b64 v[56:57],v20 offset:0
v_mfma_f32_16x16x32_bf16 v[32:35],a[120:123],v[124:127],v[32:35]
ds_read_b128 v[84:87],v6 offset:5120
v_mfma_f32_16x16x32_bf16 v[36:39],a[124:127],v[124:127],v[36:39]
ds_read_b64 v[58:59],v20 offset:512
v_mfma_f32_16x16x32_bf16 v[32:35],a[128:131],v[64:67],v[32:35]
ds_read_b128 v[88:91],v6 offset:6144
v_mfma_f32_16x16x32_bf16 v[36:39],a[132:135],v[64:67],v[36:39]
ds_read_b64 v[60:61],v20 offset:1024
v_mfma_f32_16x16x32_bf16 v[32:35],a[136:139],v[68:71],v[32:35]
ds_read_b128 v[92:95],v6 offset:7168
v_mfma_f32_16x16x32_bf16 v[36:39],a[140:143],v[68:71],v[36:39]
s_waitcnt lgkmcnt(8)
ds_read_b64 v[62:63],v20 offset:1536
v_mfma_f32_16x16x32_bf16 v[32:35],a[144:147],v[72:75],v[32:35]
ds_read_b128 v[96:99],v7 offset:0
v_mfma_f32_16x16x32_bf16 v[36:39],a[148:151],v[72:75],v[36:39]
s_waitcnt lgkmcnt(9)
s_waitcnt vmcnt(10)
v_mov_b32 v17,s57
buffer_store_dword v17,v26,s[20:23],s69 offen sc1
v_mfma_f32_16x16x32_bf16 v[32:35],a[152:155],v[76:79],v[32:35]
ds_read_b128 v[100:103],v7 offset:1024
v_mfma_f32_16x16x32_bf16 v[36:39],a[156:159],v[76:79],v[36:39]
s_waitcnt lgkmcnt(9)
v_mfma_f32_16x16x32_bf16 v[32:35],a[160:163],v[80:83],v[32:35]
ds_read_b128 v[104:107],v7 offset:2048
v_mfma_f32_16x16x32_bf16 v[36:39],a[164:167],v[80:83],v[36:39]
s_waitcnt lgkmcnt(8)
s_waitcnt lgkmcnt(3)
v_add_f32 v56,v56,v58
v_mfma_f32_16x16x32_bf16 v[32:35],a[168:171],v[84:87],v[32:35]
ds_read_b128 v[108:111],v7 offset:3072
v_add_f32 v57,v57,v59
v_mfma_f32_16x16x32_bf16 v[36:39],a[172:175],v[84:87],v[36:39]
v_add_f32 v60,v60,v62
v_add_f32 v61,v61,v63
v_mfma_f32_16x16x32_bf16 v[32:35],a[176:179],v[88:91],v[32:35]
ds_read_b128 v[112:115],v7 offset:4096
v_add_f32 v56,v56,v60
v_mfma_f32_16x16x32_bf16 v[36:39],a[180:183],v[88:91],v[36:39]
v_add_f32 v57,v57,v61
v_mul_f32 v188,0xba800000,v56
v_mfma_f32_16x16x32_bf16 v[32:35],a[184:187],v[92:95],v[32:35]
ds_read_b128 v[116:119],v7 offset:5120
v_fma_f32 v58,v188,v188,-v210
v_mfma_f32_16x16x32_bf16 v[36:39],a[188:191],v[92:95],v[36:39]
s_waitcnt lgkmcnt(5)
v_fma_f32 v57,v57,v211,-v58
v_max_f32 v57,v210,v57
v_mfma_f32_16x16x32_bf16 v[32:35],a[192:195],v[96:99],v[32:35]
ds_read_b128 v[120:123],v7 offset:6144
v_mfma_f32_16x16x32_bf16 v[36:39],a[196:199],v[96:99],v[36:39]
s_waitcnt lgkmcnt(5)
v_rsq_f32 v58,v57
v_mfma_f32_16x16x32_bf16 v[32:35],a[200:203],v[100:103],v[32:35]
ds_read_b128 v[124:127],v7 offset:7168
v_mul_f32 v189,v57,v58
v_mfma_f32_16x16x32_bf16 v[36:39],a[204:207],v[100:103],v[36:39]
s_waitcnt lgkmcnt(5)
v_mul_f32 v190,v209,v58
v_mul_f32 v59,v58,v58
v_mfma_f32_16x16x32_bf16 v[32:35],a[208:211],v[104:107],v[32:35]
s_add_u32 s61,s61,32768
v_mul_f32 v191,v208,v58
v_mul_f32 v191,v191,v59
v_mfma_f32_16x16x32_bf16 v[36:39],a[212:215],v[104:107],v[36:39]
s_waitcnt lgkmcnt(4)
s_add_u32 s62,s62,32768
s_add_u32 s70,s70,32768
v_mfma_f32_16x16x32_bf16 v[32:35],a[216:219],v[108:111],v[32:35]
s_and_b32 s70,s70,0x1ffff
s_add_u32 s55,s55,32768
s_and_b32 s55,s55,0x1ffff
v_mfma_f32_16x16x32_bf16 v[36:39],a[220:223],v[108:111],v[36:39]
s_waitcnt lgkmcnt(3)
v_add_u32 v4,s55,v8
v_add_u32 v5,s55,v9
v_mfma_f32_16x16x32_bf16 v[32:35],a[224:227],v[112:115],v[32:35]
v_add_u32 v6,s55,v10
v_add_u32 v7,s55,v11
v_mfma_f32_16x16x32_bf16 v[36:39],a[228:231],v[112:115],v[36:39]
s_waitcnt lgkmcnt(2)
s_waitcnt vmcnt(9)
ds_read_b128 v[64:67],v4 offset:0
v_mfma_f32_16x16x32_bf16 v[32:35],a[232:235],v[116:119],v[32:35]
s_waitcnt vmcnt(8)
ds_read_b128 v[68:71],v4 offset:1024
v_mfma_f32_16x16x32_bf16 v[36:39],a[236:239],v[116:119],v[36:39]
s_waitcnt lgkmcnt(3)
s_waitcnt vmcnt(7)
ds_read_b128 v[72:75],v4 offset:2048
v_mfma_f32_16x16x32_bf16 v[32:35],a[240:243],v[120:123],v[32:35]
v_mfma_f32_16x16x32_bf16 v[36:39],a[244:247],v[120:123],v[36:39]
s_waitcnt lgkmcnt(3)
v_mfma_f32_16x16x32_bf16 v[40:43],a[248:251],v[124:127],v[32:35]
v_mfma_f32_16x16x32_bf16 v[44:47],a[252:255],v[124:127],v[36:39]
s_waitcnt vmcnt(2)
v_cmp_gt_u32 vcc,s53,v16
s_add_u32 s60,s60,1
s_cbranch_vccnz WN_284
.p2align 6
WR_283:
s_waitcnt lgkmcnt(2)
v_mfma_f32_16x16x32_bf16 v[32:35],a[0:3],v[64:67],0
s_waitcnt vmcnt(6)
s_add_u32 s71,s60,2
ds_read_b128 v[76:79],v4 offset:3072
v_mfma_f32_16x16x32_bf16 v[36:39],a[4:7],v[64:67],0
s_add_u32 s53,s60,3
s_mov_b32 s57,s63
v_mfma_f32_16x16x32_bf16 v[48:51],v[12:15],v[64:67],0
s_mov_b32 m0,s70
v_fma_f32 v40,v152,v188,v40
v_fma_f32 v41,v153,v188,v41
v_mul_f32 v168,v40,v40
v_mfma_f32_16x16x32_bf16 v[52:55],v[64:67],v[64:67],0
s_waitcnt lgkmcnt(2)
buffer_load_dwordx4 v3,s[20:23],s61 offen offset:0 lds
v_mul_f32 v169,v41,v41
v_fma_f32 v168,v168,v191,v190
v_mfma_f32_16x16x32_bf16 v[32:35],a[8:11],v[68:71],v[32:35]
s_waitcnt vmcnt(6)
ds_read_b128 v[80:83],v4 offset:4096
v_fma_f32 v169,v169,v191,v190
v_mul_f32 v168,v168,v40
v_mfma_f32_16x16x32_bf16 v[36:39],a[12:15],v[68:71],v[36:39]
v_exp_f32 v168,v168
v_mul_f32 v169,v169,v41
v_mfma_f32_16x16x32_bf16 v[48:51],v[12:15],v[68:71],v[48:51]
v_exp_f32 v169,v169
v_fma_f32 v168,v168,v189,v189
v_mfma_f32_16x16x32_bf16 v[52:55],v[68:71],v[68:71],v[52:55]
s_waitcnt lgkmcnt(2)
buffer_load_dwordx4 v3,s[20:23],s61 offen offset:1024 lds
v_rcp_f32 v168,v168
v_mfma_f32_16x16x32_bf16 v[32:35],a[16:19],v[72:75],v[32:35]
s_waitcnt vmcnt(6)
ds_read_b128 v[84:87],v4 offset:5120
v_fma_f32 v169,v169,v189,v189
v_mul_f32 v40,v168,v40
v_mfma_f32_16x16x32_bf16 v[36:39],a[20:23],v[72:75],v[36:39]
v_rcp_f32 v169,v169
v_fma_f32 v42,v154,v188,v42
v_mfma_f32_16x16x32_bf16 v[48:51],v[12:15],v[72:75],v[48:51]
v_mul_f32 v41,v169,v41
v_fma_f32 v43,v155,v188,v43
v_mul_f32 v170,v42,v42
v_mfma_f32_16x16x32_bf16 v[52:55],v[72:75],v[72:75],v[52:55]
s_waitcnt lgkmcnt(2)
buffer_load_dwordx4 v3,s[20:23],s61 offen offset:2048 lds
v_mul_f32 v171,v43,v43
v_fma_f32 v170,v170,v191,v190
v_mfma_f32_16x16x32_bf16 v[32:35],a[24:27],v[76:79],v[32:35]
s_waitcnt vmcnt(6)
ds_read_b128 v[88:91],v4 offset:6144
v_fma_f32 v171,v171,v191,v190
v_mfma_f32_16x16x32_bf16 v[36:39],a[28:31],v[76:79],v[36:39]
v_mul_f32 v170,v170,v42
v_mul_f32 v171,v171,v43
v_mfma_f32_16x16x32_bf16 v[48:51],v[12:15],v[76:79],v[48:51]
v_exp_f32 v170,v170
v_mfma_f32_16x16x32_bf16 v[52:55],v[76:79],v[76:79],v[52:55]
s_waitcnt lgkmcnt(2)
buffer_load_dwordx4 v3,s[20:23],s61 offen offset:3072 lds
v_fma_f32 v170,v170,v189,v189
v_mfma_f32_16x16x32_bf16 v[32:35],a[32:35],v[80:83],v[32:35]
s_waitcnt vmcnt(5)
ds_read_b128 v[92:95],v4 offset:7168
v_fma_f32 v44,v156,v188,v44
v_mfma_f32_16x16x32_bf16 v[36:39],a[36:39],v[80:83],v[36:39]
s_barrier
ds_read_b128 v[96:99],v5 offset:0
v_fma_f32 v45,v157,v188,v45
v_mfma_f32_16x16x32_bf16 v[48:51],v[12:15],v[80:83],v[48:51]
ds_read_b128 v[100:103],v5 offset:1024
v_mul_f32 v172,v44,v44
v_mfma_f32_16x16x32_bf16 v[52:55],v[80:83],v[80:83],v[52:55]
s_waitcnt lgkmcnt(4)
ds_read_b128 v[104:107],v5 offset:2048
v_mul_f32 v173,v45,v45
v_mfma_f32_16x16x32_bf16 v[32:35],a[40:43],v[84:87],v[32:35]
s_add_u32 m0,s70,4096
ds_read_b128 v[108:111],v5 offset:3072
v_fma_f32 v172,v172,v191,v190
v_mfma_f32_16x16x32_bf16 v[36:39],a[44:47],v[84:87],v[36:39]
buffer_load_dwordx4 v3,s[20:23],s62 offen offset:0 lds
v_fma_f32 v173,v173,v191,v190
v_mfma_f32_16x16x32_bf16 v[48:51],v[12:15],v[84:87],v[48:51]
s_waitcnt vmcnt(5)
v_mov_b32 v17,s57
buffer_store_dword v17,v26,s[20:23],s69 offen sc1
v_mfma_f32_16x16x32_bf16 v[52:55],v[84:87],v[84:87],v[52:55]
s_waitcnt lgkmcnt(5)
v_exp_f32 v171,v171
v_mfma_f32_16x16x32_bf16 v[32:35],a[48:51],v[88:91],v[32:35]
ds_read_b128 v[112:115],v5 offset:4096
v_fma_f32 v171,v171,v189,v189
v_mfma_f32_16x16x32_bf16 v[36:39],a[52:55],v[88:91],v[36:39]
buffer_load_dwordx4 v3,s[20:23],s62 offen offset:1024 lds
v_mul_f32 v172,v172,v44
v_mfma_f32_16x16x32_bf16 v[48:51],v[12:15],v[88:91],v[48:51]
v_rcp_f32 v170,v170
v_mfma_f32_16x16x32_bf16 v[52:55],v[88:91],v[88:91],v[52:55]
s_waitcnt lgkmcnt(5)
v_rcp_f32 v171,v171
v_mfma_f32_16x16x32_bf16 v[32:35],a[56:59],v[92:95],v[32:35]
ds_read_b128 v[116:119],v5 offset:5120
v_mul_f32 v42,v170,v42
v_mfma_f32_16x16x32_bf16 v[36:39],a[60:63],v[92:95],v[36:39]
buffer_load_dwordx4 v3,s[20:23],s62 offen offset:2048 lds
v_mul_f32 v43,v171,v43
v_mfma_f32_16x16x32_bf16 v[48:51],v[12:15],v[92:95],v[48:51]
buffer_load_dword v16,v2,s[20:23],s68 offen sc1
v_mul_f32 v173,v173,v45
v_mfma_f32_16x16x32_bf16 v[52:55],v[92:95],v[92:95],v[52:55]
s_waitcnt lgkmcnt(5)
v_exp_f32 v172,v172
v_mfma_f32_16x16x32_bf16 v[32:35],a[64:67],v[96:99],v[32:35]
ds_read_b128 v[120:123],v5 offset:6144
v_fma_f32 v172,v172,v189,v189
v_mfma_f32_16x16x32_bf16 v[36:39],a[68:71],v[96:99],v[36:39]
s_waitcnt lgkmcnt(5)
buffer_load_dwordx4 v3,s[20:23],s62 offen offset:3072 lds
v_fma_f32 v46,v158,v188,v46
v_mfma_f32_16x16x32_bf16 v[32:35],a[72:75],v[100:103],v[32:35]
ds_read_b128 v[124:127],v5 offset:7168
v_fma_f32 v47,v159,v188,v47
v_mfma_f32_16x16x32_bf16 v[36:39],a[76:79],v[100:103],v[36:39]
s_waitcnt lgkmcnt(5)
v_exp_f32 v173,v173
v_mfma_f32_16x16x32_bf16 v[32:35],a[80:83],v[104:107],v[32:35]
ds_read_b128 v[64:67],v6 offset:0
v_cndmask_b32 v49,v52,v53,s[74:75]
v_mfma_f32_16x16x32_bf16 v[36:39],a[84:87],v[104:107],v[36:39]
s_waitcnt lgkmcnt(5)
v_cndmask_b32 v49,v49,v54,s[76:77]
v_cndmask_b32 v49,v49,v55,s[78:79]
v_mfma_f32_16x16x32_bf16 v[32:35],a[88:91],v[108:111],v[32:35]
ds_read_b128 v[68:71],v6 offset:1024
v_fma_f32 v173,v173,v189,v189
v_mfma_f32_16x16x32_bf16 v[36:39],a[92:95],v[108:111],v[36:39]
s_waitcnt lgkmcnt(5)
ds_write_b64 v19,v[48:49]
v_mfma_f32_16x16x32_bf16 v[32:35],a[96:99],v[112:115],v[32:35]
ds_read_b128 v[72:75],v6 offset:2048
v_mul_f32 v174,v46,v46
v_mfma_f32_16x16x32_bf16 v[36:39],a[100:103],v[112:115],v[36:39]
s_waitcnt lgkmcnt(6)
v_rcp_f32 v172,v172
v_mfma_f32_16x16x32_bf16 v[32:35],a[104:107],v[116:119],v[32:35]
ds_read_b128 v[76:79],v6 offset:3072
v_mul_f32 v44,v172,v44
v_mfma_f32_16x16x32_bf16 v[36:39],a[108:111],v[116:119],v[36:39]
s_waitcnt lgkmcnt(6)
v_rcp_f32 v173,v173
v_mfma_f32_16x16x32_bf16 v[32:35],a[112:115],v[120:123],v[32:35]
s_waitcnt lgkmcnt(2)
s_barrier
ds_read_b128 v[80:83],v6 offset:4096
v_mfma_f32_16x16x32_bf16 v[36:39],a[116:119],v[120:123],v[36:39]
ds_read_b64 v[56:57],v20 offset:0
v_mul_f32 v45,v173,v45
v_mfma_f32_16x16x32_bf16 v[32:35],a[120:123],v[124:127],v[32:35]
ds_read_b128 v[84:87],v6 offset:5120
v_mul_f32 v175,v47,v47
v_mfma_f32_16x16x32_bf16 v[36:39],a[124:127],v[124:127],v[36:39]
ds_read_b64 v[58:59],v20 offset:512
v_fma_f32 v174,v174,v191,v190
v_mfma_f32_16x16x32_bf16 v[32:35],a[128:131],v[64:67],v[32:35]
ds_read_b128 v[88:91],v6 offset:6144
v_fma_f32 v175,v175,v191,v190
v_mfma_f32_16x16x32_bf16 v[36:39],a[132:135],v[64:67],v[36:39]
ds_read_b64 v[60:61],v20 offset:1024
v_mul_f32 v174,v174,v46
v_mfma_f32_16x16x32_bf16 v[32:35],a[136:139],v[68:71],v[32:35]
ds_read_b128 v[92:95],v6 offset:7168
v_mul_f32 v175,v175,v47
v_mfma_f32_16x16x32_bf16 v[36:39],a[140:143],v[68:71],v[36:39]
s_waitcnt lgkmcnt(8)
ds_read_b64 v[62:63],v20 offset:1536
v_cvt_pk_bf16_f32 v176,v40,v41
v_mfma_f32_16x16x32_bf16 v[32:35],a[144:147],v[72:75],v[32:35]
ds_read_b128 v[96:99],v7 offset:0
v_cvt_pk_bf16_f32 v177,v42,v43
v_mfma_f32_16x16x32_bf16 v[36:39],a[148:151],v[72:75],v[36:39]
s_waitcnt lgkmcnt(9)
v_exp_f32 v174,v174
v_mfma_f32_16x16x32_bf16 v[32:35],a[152:155],v[76:79],v[32:35]
ds_read_b128 v[100:103],v7 offset:1024
v_fma_f32 v174,v174,v189,v189
v_mfma_f32_16x16x32_bf16 v[36:39],a[156:159],v[76:79],v[36:39]
s_waitcnt lgkmcnt(9)
v_exp_f32 v175,v175
v_mfma_f32_16x16x32_bf16 v[32:35],a[160:163],v[80:83],v[32:35]
ds_read_b128 v[104:107],v7 offset:2048
v_fma_f32 v175,v175,v189,v189
v_mfma_f32_16x16x32_bf16 v[36:39],a[164:167],v[80:83],v[36:39]
s_waitcnt lgkmcnt(8)
s_waitcnt lgkmcnt(3)
v_rcp_f32 v174,v174
v_mfma_f32_16x16x32_bf16 v[32:35],a[168:171],v[84:87],v[32:35]
ds_read_b128 v[108:111],v7 offset:3072
v_mul_f32 v46,v174,v46
v_mfma_f32_16x16x32_bf16 v[36:39],a[172:175],v[84:87],v[36:39]
v_rcp_f32 v175,v175
v_mfma_f32_16x16x32_bf16 v[32:35],a[176:179],v[88:91],v[32:35]
ds_read_b128 v[112:115],v7 offset:4096
v_mul_f32 v47,v175,v47
v_mfma_f32_16x16x32_bf16 v[36:39],a[180:183],v[88:91],v[36:39]
v_cvt_pk_bf16_f32 v178,v44,v45
v_cvt_pk_bf16_f32 v179,v46,v47
v_mfma_f32_16x16x32_bf16 v[32:35],a[184:187],v[92:95],v[32:35]
ds_read_b128 v[116:119],v7 offset:5120
v_add_f32 v56,v56,v58
v_mfma_f32_16x16x32_bf16 v[36:39],a[188:191],v[92:95],v[36:39]
s_waitcnt lgkmcnt(5)
buffer_store_dwordx4 v[176:179],v0,s[20:23],s66 offen sc1
v_mfma_f32_16x16x32_bf16 v[32:35],a[192:195],v[96:99],v[32:35]
s_add_u32 s66,s66,114688
s_add_u32 s63,s63,1
ds_read_b128 v[120:123],v7 offset:6144
v_mfma_f32_16x16x32_bf16 v[36:39],a[196:199],v[96:99],v[36:39]
s_waitcnt lgkmcnt(5)
v_add_f32 v57,v57,v59
v_add_f32 v60,v60,v62
v_mfma_f32_16x16x32_bf16 v[32:35],a[200:203],v[100:103],v[32:35]
ds_read_b128 v[124:127],v7 offset:7168
v_add_f32 v61,v61,v63
v_mfma_f32_16x16x32_bf16 v[36:39],a[204:207],v[100:103],v[36:39]
s_waitcnt lgkmcnt(5)
v_add_f32 v56,v56,v60
v_add_f32 v57,v57,v61
v_mfma_f32_16x16x32_bf16 v[32:35],a[208:211],v[104:107],v[32:35]
s_add_u32 s61,s61,32768
v_mul_f32 v188,0xba800000,v56
v_fma_f32 v58,v188,v188,-v210
v_mfma_f32_16x16x32_bf16 v[36:39],a[212:215],v[104:107],v[36:39]
s_waitcnt lgkmcnt(4)
v_fma_f32 v57,v57,v211,-v58
v_max_f32 v57,v210,v57
v_mfma_f32_16x16x32_bf16 v[32:35],a[216:219],v[108:111],v[32:35]
s_add_u32 s62,s62,32768
v_rsq_f32 v58,v57
v_mfma_f32_16x16x32_bf16 v[36:39],a[220:223],v[108:111],v[36:39]
s_waitcnt lgkmcnt(3)
v_mul_f32 v189,v57,v58
v_mul_f32 v190,v209,v58
v_mfma_f32_16x16x32_bf16 v[32:35],a[224:227],v[112:115],v[32:35]
s_add_u32 s70,s70,32768
v_mul_f32 v59,v58,v58
v_mul_f32 v191,v208,v58
v_mfma_f32_16x16x32_bf16 v[36:39],a[228:231],v[112:115],v[36:39]
s_waitcnt lgkmcnt(2)
s_and_b32 s70,s70,0x1ffff
v_mul_f32 v191,v191,v59
v_mfma_f32_16x16x32_bf16 v[32:35],a[232:235],v[116:119],v[32:35]
s_add_u32 s55,s55,32768
s_and_b32 s55,s55,0x1ffff
v_add_u32 v4,s55,v8
v_mfma_f32_16x16x32_bf16 v[36:39],a[236:239],v[116:119],v[36:39]
s_waitcnt lgkmcnt(1)
v_add_u32 v5,s55,v9
v_add_u32 v6,s55,v10
v_mfma_f32_16x16x32_bf16 v[32:35],a[240:243],v[120:123],v[32:35]
v_add_u32 v7,s55,v11
v_mfma_f32_16x16x32_bf16 v[36:39],a[244:247],v[120:123],v[36:39]
s_waitcnt lgkmcnt(0)
s_waitcnt vmcnt(10)
ds_read_b128 v[64:67],v4 offset:0
v_mfma_f32_16x16x32_bf16 v[40:43],a[248:251],v[124:127],v[32:35]
s_waitcnt vmcnt(9)
ds_read_b128 v[68:71],v4 offset:1024
v_mfma_f32_16x16x32_bf16 v[44:47],a[252:255],v[124:127],v[36:39]
s_waitcnt vmcnt(2)
v_cmp_gt_u32 vcc,s53,v16
ds_read_b128 v[72:75],v4 offset:2048
s_add_u32 s60,s60,1
s_cbranch_vccz WR_283
WN_284:
s_waitcnt lgkmcnt(2)
v_mfma_f32_16x16x32_bf16 v[32:35],a[0:3],v[64:67],0
s_waitcnt vmcnt(6)
s_add_u32 s71,s60,2
ds_read_b128 v[76:79],v4 offset:3072
v_mfma_f32_16x16x32_bf16 v[36:39],a[4:7],v[64:67],0
s_add_u32 s53,s60,3
s_mov_b32 s57,s63
v_mfma_f32_16x16x32_bf16 v[48:51],v[12:15],v[64:67],0
v_fma_f32 v40,v152,v188,v40
v_fma_f32 v41,v153,v188,v41
v_mul_f32 v168,v40,v40
v_mfma_f32_16x16x32_bf16 v[52:55],v[64:67],v[64:67],0
s_waitcnt lgkmcnt(2)
v_mul_f32 v169,v41,v41
v_fma_f32 v168,v168,v191,v190
v_fma_f32 v169,v169,v191,v190
v_mfma_f32_16x16x32_bf16 v[32:35],a[8:11],v[68:71],v[32:35]
s_waitcnt vmcnt(5)
ds_read_b128 v[80:83],v4 offset:4096
v_mul_f32 v168,v168,v40
v_mul_f32 v169,v169,v41
v_mfma_f32_16x16x32_bf16 v[36:39],a[12:15],v[68:71],v[36:39]
v_exp_f32 v168,v168
v_fma_f32 v42,v154,v188,v42
v_mfma_f32_16x16x32_bf16 v[48:51],v[12:15],v[68:71],v[48:51]
v_exp_f32 v169,v169
v_fma_f32 v168,v168,v189,v189
v_mfma_f32_16x16x32_bf16 v[52:55],v[68:71],v[68:71],v[52:55]
s_waitcnt lgkmcnt(2)
v_rcp_f32 v168,v168
v_fma_f32 v169,v169,v189,v189
v_mfma_f32_16x16x32_bf16 v[32:35],a[16:19],v[72:75],v[32:35]
s_waitcnt vmcnt(4)
ds_read_b128 v[84:87],v4 offset:5120
v_rcp_f32 v169,v169
v_mfma_f32_16x16x32_bf16 v[36:39],a[20:23],v[72:75],v[36:39]
v_mul_f32 v40,v168,v40
v_mul_f32 v41,v169,v41
v_fma_f32 v43,v155,v188,v43
v_mfma_f32_16x16x32_bf16 v[48:51],v[12:15],v[72:75],v[48:51]
v_mul_f32 v170,v42,v42
v_mul_f32 v171,v43,v43
v_mfma_f32_16x16x32_bf16 v[52:55],v[72:75],v[72:75],v[52:55]
s_waitcnt lgkmcnt(2)
v_fma_f32 v170,v170,v191,v190
v_fma_f32 v171,v171,v191,v190
v_mfma_f32_16x16x32_bf16 v[32:35],a[24:27],v[76:79],v[32:35]
s_waitcnt vmcnt(3)
ds_read_b128 v[88:91],v4 offset:6144
v_mul_f32 v170,v170,v42
v_mfma_f32_16x16x32_bf16 v[36:39],a[28:31],v[76:79],v[36:39]
v_exp_f32 v170,v170
v_mfma_f32_16x16x32_bf16 v[48:51],v[12:15],v[76:79],v[48:51]
v_mul_f32 v171,v171,v43
v_fma_f32 v170,v170,v189,v189
v_mfma_f32_16x16x32_bf16 v[52:55],v[76:79],v[76:79],v[52:55]
s_waitcnt lgkmcnt(2)
v_exp_f32 v171,v171
v_mfma_f32_16x16x32_bf16 v[32:35],a[32:35],v[80:83],v[32:35]
s_waitcnt vmcnt(1)
ds_read_b128 v[92:95],v4 offset:7168
v_fma_f32 v171,v171,v189,v189
v_mfma_f32_16x16x32_bf16 v[36:39],a[36:39],v[80:83],v[36:39]
s_barrier
ds_read_b128 v[96:99],v5 offset:0
v_fma_f32 v44,v156,v188,v44
v_mfma_f32_16x16x32_bf16 v[48:51],v[12:15],v[80:83],v[48:51]
ds_read_b128 v[100:103],v5 offset:1024
v_fma_f32 v45,v157,v188,v45
v_mfma_f32_16x16x32_bf16 v[52:55],v[80:83],v[80:83],v[52:55]
s_waitcnt lgkmcnt(4)
ds_read_b128 v[104:107],v5 offset:2048
v_mul_f32 v172,v44,v44
v_mfma_f32_16x16x32_bf16 v[32:35],a[40:43],v[84:87],v[32:35]
ds_read_b128 v[108:111],v5 offset:3072
v_mul_f32 v173,v45,v45
v_mfma_f32_16x16x32_bf16 v[36:39],a[44:47],v[84:87],v[36:39]
s_waitcnt vmcnt(0)
v_mov_b32 v17,s57
buffer_store_dword v17,v26,s[20:23],s69 offen sc1
v_mfma_f32_16x16x32_bf16 v[48:51],v[12:15],v[84:87],v[48:51]
v_rcp_f32 v170,v170
v_mfma_f32_16x16x32_bf16 v[52:55],v[84:87],v[84:87],v[52:55]
s_waitcnt lgkmcnt(5)
v_rcp_f32 v171,v171
v_mfma_f32_16x16x32_bf16 v[32:35],a[48:51],v[88:91],v[32:35]
ds_read_b128 v[112:115],v5 offset:4096
v_mul_f32 v42,v170,v42
v_mfma_f32_16x16x32_bf16 v[36:39],a[52:55],v[88:91],v[36:39]
v_mul_f32 v43,v171,v43
v_fma_f32 v172,v172,v191,v190
v_mfma_f32_16x16x32_bf16 v[48:51],v[12:15],v[88:91],v[48:51]
v_fma_f32 v173,v173,v191,v190
v_mul_f32 v172,v172,v44
v_mfma_f32_16x16x32_bf16 v[52:55],v[88:91],v[88:91],v[52:55]
s_waitcnt lgkmcnt(5)
v_exp_f32 v172,v172
v_mfma_f32_16x16x32_bf16 v[32:35],a[56:59],v[92:95],v[32:35]
ds_read_b128 v[116:119],v5 offset:5120
v_mul_f32 v173,v173,v45
v_mfma_f32_16x16x32_bf16 v[36:39],a[60:63],v[92:95],v[36:39]
v_exp_f32 v173,v173
v_mfma_f32_16x16x32_bf16 v[48:51],v[12:15],v[92:95],v[48:51]
v_fma_f32 v172,v172,v189,v189
v_fma_f32 v173,v173,v189,v189
v_mfma_f32_16x16x32_bf16 v[52:55],v[92:95],v[92:95],v[52:55]
s_waitcnt lgkmcnt(5)
v_rcp_f32 v172,v172
v_mfma_f32_16x16x32_bf16 v[32:35],a[64:67],v[96:99],v[32:35]
ds_read_b128 v[120:123],v5 offset:6144
v_mul_f32 v44,v172,v44
v_mfma_f32_16x16x32_bf16 v[36:39],a[68:71],v[96:99],v[36:39]
s_waitcnt lgkmcnt(5)
v_rcp_f32 v173,v173
v_mfma_f32_16x16x32_bf16 v[32:35],a[72:75],v[100:103],v[32:35]
ds_read_b128 v[124:127],v5 offset:7168
v_mul_f32 v45,v173,v45
v_mfma_f32_16x16x32_bf16 v[36:39],a[76:79],v[100:103],v[36:39]
s_waitcnt lgkmcnt(5)
v_fma_f32 v46,v158,v188,v46
v_fma_f32 v47,v159,v188,v47
v_mfma_f32_16x16x32_bf16 v[32:35],a[80:83],v[104:107],v[32:35]
ds_read_b128 v[64:67],v6 offset:0
v_cndmask_b32 v49,v52,v53,s[74:75]
v_mfma_f32_16x16x32_bf16 v[36:39],a[84:87],v[104:107],v[36:39]
s_waitcnt lgkmcnt(5)
v_cndmask_b32 v49,v49,v54,s[76:77]
v_cndmask_b32 v49,v49,v55,s[78:79]
v_mfma_f32_16x16x32_bf16 v[32:35],a[88:91],v[108:111],v[32:35]
ds_read_b128 v[68:71],v6 offset:1024
v_mul_f32 v174,v46,v46
v_mfma_f32_16x16x32_bf16 v[36:39],a[92:95],v[108:111],v[36:39]
s_waitcnt lgkmcnt(5)
ds_write_b64 v19,v[48:49]
v_mfma_f32_16x16x32_bf16 v[32:35],a[96:99],v[112:115],v[32:35]
ds_read_b128 v[72:75],v6 offset:2048
v_mul_f32 v175,v47,v47
v_mfma_f32_16x16x32_bf16 v[36:39],a[100:103],v[112:115],v[36:39]
s_waitcnt lgkmcnt(6)
v_fma_f32 v174,v174,v191,v190
v_fma_f32 v175,v175,v191,v190
v_mfma_f32_16x16x32_bf16 v[32:35],a[104:107],v[116:119],v[32:35]
ds_read_b128 v[76:79],v6 offset:3072
v_mul_f32 v174,v174,v46
v_mfma_f32_16x16x32_bf16 v[36:39],a[108:111],v[116:119],v[36:39]
s_waitcnt lgkmcnt(6)
v_exp_f32 v174,v174
v_mfma_f32_16x16x32_bf16 v[32:35],a[112:115],v[120:123],v[32:35]
s_waitcnt lgkmcnt(2)
s_barrier
ds_read_b128 v[80:83],v6 offset:4096
v_mfma_f32_16x16x32_bf16 v[36:39],a[116:119],v[120:123],v[36:39]
ds_read_b64 v[56:57],v20 offset:0
v_mul_f32 v175,v175,v47
v_mfma_f32_16x16x32_bf16 v[32:35],a[120:123],v[124:127],v[32:35]
ds_read_b128 v[84:87],v6 offset:5120
v_fma_f32 v174,v174,v189,v189
v_mfma_f32_16x16x32_bf16 v[36:39],a[124:127],v[124:127],v[36:39]
ds_read_b64 v[58:59],v20 offset:512
v_cvt_pk_bf16_f32 v176,v40,v41
v_mfma_f32_16x16x32_bf16 v[32:35],a[128:131],v[64:67],v[32:35]
ds_read_b128 v[88:91],v6 offset:6144
v_cvt_pk_bf16_f32 v177,v42,v43
v_mfma_f32_16x16x32_bf16 v[36:39],a[132:135],v[64:67],v[36:39]
ds_read_b64 v[60:61],v20 offset:1024
v_cvt_pk_bf16_f32 v178,v44,v45
v_mfma_f32_16x16x32_bf16 v[32:35],a[136:139],v[68:71],v[32:35]
ds_read_b128 v[92:95],v6 offset:7168
v_mfma_f32_16x16x32_bf16 v[36:39],a[140:143],v[68:71],v[36:39]
s_waitcnt lgkmcnt(8)
ds_read_b64 v[62:63],v20 offset:1536
v_mfma_f32_16x16x32_bf16 v[32:35],a[144:147],v[72:75],v[32:35]
ds_read_b128 v[96:99],v7 offset:0
v_mfma_f32_16x16x32_bf16 v[36:39],a[148:151],v[72:75],v[36:39]
s_waitcnt lgkmcnt(9)
buffer_load_dword v16,v2,s[20:23],s68 offen sc1
v_mfma_f32_16x16x32_bf16 v[32:35],a[152:155],v[76:79],v[32:35]
ds_read_b128 v[100:103],v7 offset:1024
v_mfma_f32_16x16x32_bf16 v[36:39],a[156:159],v[76:79],v[36:39]
s_waitcnt lgkmcnt(9)
v_exp_f32 v175,v175
v_mfma_f32_16x16x32_bf16 v[32:35],a[160:163],v[80:83],v[32:35]
ds_read_b128 v[104:107],v7 offset:2048
v_fma_f32 v175,v175,v189,v189
v_mfma_f32_16x16x32_bf16 v[36:39],a[164:167],v[80:83],v[36:39]
s_waitcnt lgkmcnt(8)
s_waitcnt lgkmcnt(3)
v_rcp_f32 v174,v174
v_mfma_f32_16x16x32_bf16 v[32:35],a[168:171],v[84:87],v[32:35]
ds_read_b128 v[108:111],v7 offset:3072
v_mul_f32 v46,v174,v46
v_mfma_f32_16x16x32_bf16 v[36:39],a[172:175],v[84:87],v[36:39]
v_rcp_f32 v175,v175
v_mfma_f32_16x16x32_bf16 v[32:35],a[176:179],v[88:91],v[32:35]
ds_read_b128 v[112:115],v7 offset:4096
v_mul_f32 v47,v175,v47
v_mfma_f32_16x16x32_bf16 v[36:39],a[180:183],v[88:91],v[36:39]
v_cvt_pk_bf16_f32 v179,v46,v47
v_add_f32 v56,v56,v58
v_mfma_f32_16x16x32_bf16 v[32:35],a[184:187],v[92:95],v[32:35]
ds_read_b128 v[116:119],v7 offset:5120
v_add_f32 v57,v57,v59
v_mfma_f32_16x16x32_bf16 v[36:39],a[188:191],v[92:95],v[36:39]
s_waitcnt lgkmcnt(5)
buffer_store_dwordx4 v[176:179],v0,s[20:23],s66 offen sc1
v_mfma_f32_16x16x32_bf16 v[32:35],a[192:195],v[96:99],v[32:35]
s_add_u32 s66,s66,114688
s_add_u32 s63,s63,1
ds_read_b128 v[120:123],v7 offset:6144
v_mfma_f32_16x16x32_bf16 v[36:39],a[196:199],v[96:99],v[36:39]
s_waitcnt lgkmcnt(5)
v_add_f32 v60,v60,v62
v_add_f32 v61,v61,v63
v_mfma_f32_16x16x32_bf16 v[32:35],a[200:203],v[100:103],v[32:35]
ds_read_b128 v[124:127],v7 offset:7168
v_add_f32 v56,v56,v60
v_mfma_f32_16x16x32_bf16 v[36:39],a[204:207],v[100:103],v[36:39]
s_waitcnt lgkmcnt(5)
v_add_f32 v57,v57,v61
v_mul_f32 v188,0xba800000,v56
v_mfma_f32_16x16x32_bf16 v[32:35],a[208:211],v[104:107],v[32:35]
s_add_u32 s55,s55,32768
v_fma_f32 v58,v188,v188,-v210
v_fma_f32 v57,v57,v211,-v58
v_mfma_f32_16x16x32_bf16 v[36:39],a[212:215],v[104:107],v[36:39]
s_waitcnt lgkmcnt(4)
s_and_b32 s55,s55,0x1ffff
v_max_f32 v57,v210,v57
v_mfma_f32_16x16x32_bf16 v[32:35],a[216:219],v[108:111],v[32:35]
v_rsq_f32 v58,v57
v_mfma_f32_16x16x32_bf16 v[36:39],a[220:223],v[108:111],v[36:39]
s_waitcnt lgkmcnt(3)
v_mul_f32 v189,v57,v58
v_mul_f32 v190,v209,v58
v_mfma_f32_16x16x32_bf16 v[32:35],a[224:227],v[112:115],v[32:35]
v_mul_f32 v59,v58,v58
v_mul_f32 v191,v208,v58
v_mfma_f32_16x16x32_bf16 v[36:39],a[228:231],v[112:115],v[36:39]
s_waitcnt lgkmcnt(2)
v_mul_f32 v191,v191,v59
v_add_u32 v4,s55,v8
v_mfma_f32_16x16x32_bf16 v[32:35],a[232:235],v[116:119],v[32:35]
v_add_u32 v5,s55,v9
v_add_u32 v6,s55,v10
v_mfma_f32_16x16x32_bf16 v[36:39],a[236:239],v[116:119],v[36:39]
s_waitcnt lgkmcnt(1)
v_add_u32 v7,s55,v11
v_mfma_f32_16x16x32_bf16 v[32:35],a[240:243],v[120:123],v[32:35]
v_mfma_f32_16x16x32_bf16 v[36:39],a[244:247],v[120:123],v[36:39]
s_waitcnt lgkmcnt(0)
v_mfma_f32_16x16x32_bf16 v[40:43],a[248:251],v[124:127],v[32:35]
v_mfma_f32_16x16x32_bf16 v[44:47],a[252:255],v[124:127],v[36:39]
s_waitcnt vmcnt(1)
v_cmp_gt_u32 vcc,s71,v16
s_add_u32 s60,s60,1
s_branch endN_292
BN_286:
s_waitcnt vmcnt(9)
ds_read_b128 v[64:67],v4 offset:0
s_waitcnt vmcnt(8)
ds_read_b128 v[68:71],v4 offset:1024
s_waitcnt vmcnt(7)
ds_read_b128 v[72:75],v4 offset:2048
s_waitcnt vmcnt(6)
ds_read_b128 v[76:79],v4 offset:3072
s_waitcnt lgkmcnt(3)
v_mfma_f32_16x16x32_bf16 v[32:35],a[0:3],v[64:67],0
s_add_u32 s71,s60,2
s_add_u32 s53,s60,3
s_mov_b32 s57,s63
v_mfma_f32_16x16x32_bf16 v[36:39],a[4:7],v[64:67],0
v_mfma_f32_16x16x32_bf16 v[48:51],v[12:15],v[64:67],0
v_mfma_f32_16x16x32_bf16 v[52:55],v[64:67],v[64:67],0
s_waitcnt lgkmcnt(2)
s_waitcnt vmcnt(5)
ds_read_b128 v[80:83],v4 offset:4096
v_mfma_f32_16x16x32_bf16 v[32:35],a[8:11],v[68:71],v[32:35]
v_mfma_f32_16x16x32_bf16 v[36:39],a[12:15],v[68:71],v[36:39]
v_mfma_f32_16x16x32_bf16 v[48:51],v[12:15],v[68:71],v[48:51]
v_mfma_f32_16x16x32_bf16 v[52:55],v[68:71],v[68:71],v[52:55]
s_waitcnt lgkmcnt(2)
s_waitcnt vmcnt(4)
ds_read_b128 v[84:87],v4 offset:5120
v_mfma_f32_16x16x32_bf16 v[32:35],a[16:19],v[72:75],v[32:35]
v_mfma_f32_16x16x32_bf16 v[36:39],a[20:23],v[72:75],v[36:39]
v_mfma_f32_16x16x32_bf16 v[48:51],v[12:15],v[72:75],v[48:51]
v_mfma_f32_16x16x32_bf16 v[52:55],v[72:75],v[72:75],v[52:55]
s_waitcnt lgkmcnt(2)
s_waitcnt vmcnt(3)
ds_read_b128 v[88:91],v4 offset:6144
v_mfma_f32_16x16x32_bf16 v[32:35],a[24:27],v[76:79],v[32:35]
v_mfma_f32_16x16x32_bf16 v[36:39],a[28:31],v[76:79],v[36:39]
v_mfma_f32_16x16x32_bf16 v[48:51],v[12:15],v[76:79],v[48:51]
v_mfma_f32_16x16x32_bf16 v[52:55],v[76:79],v[76:79],v[52:55]
s_waitcnt lgkmcnt(2)
s_waitcnt vmcnt(2)
ds_read_b128 v[92:95],v4 offset:7168
v_mfma_f32_16x16x32_bf16 v[32:35],a[32:35],v[80:83],v[32:35]
v_mfma_f32_16x16x32_bf16 v[36:39],a[36:39],v[80:83],v[36:39]
v_mfma_f32_16x16x32_bf16 v[48:51],v[12:15],v[80:83],v[48:51]
v_mfma_f32_16x16x32_bf16 v[52:55],v[80:83],v[80:83],v[52:55]
s_waitcnt lgkmcnt(2)
s_barrier
ds_read_b128 v[96:99],v5 offset:0
v_mfma_f32_16x16x32_bf16 v[32:35],a[40:43],v[84:87],v[32:35]
ds_read_b128 v[100:103],v5 offset:1024
v_mfma_f32_16x16x32_bf16 v[36:39],a[44:47],v[84:87],v[36:39]
ds_read_b128 v[104:107],v5 offset:2048
v_mfma_f32_16x16x32_bf16 v[48:51],v[12:15],v[84:87],v[48:51]
ds_read_b128 v[108:111],v5 offset:3072
v_mfma_f32_16x16x32_bf16 v[52:55],v[84:87],v[84:87],v[52:55]
s_waitcnt lgkmcnt(5)
v_mfma_f32_16x16x32_bf16 v[32:35],a[48:51],v[88:91],v[32:35]
ds_read_b128 v[112:115],v5 offset:4096
v_mfma_f32_16x16x32_bf16 v[36:39],a[52:55],v[88:91],v[36:39]
v_mfma_f32_16x16x32_bf16 v[48:51],v[12:15],v[88:91],v[48:51]
v_mfma_f32_16x16x32_bf16 v[52:55],v[88:91],v[88:91],v[52:55]
s_waitcnt lgkmcnt(5)
v_mfma_f32_16x16x32_bf16 v[32:35],a[56:59],v[92:95],v[32:35]
ds_read_b128 v[116:119],v5 offset:5120
v_mfma_f32_16x16x32_bf16 v[36:39],a[60:63],v[92:95],v[36:39]
v_mfma_f32_16x16x32_bf16 v[48:51],v[12:15],v[92:95],v[48:51]
v_mfma_f32_16x16x32_bf16 v[52:55],v[92:95],v[92:95],v[52:55]
s_waitcnt lgkmcnt(5)
v_mfma_f32_16x16x32_bf16 v[32:35],a[64:67],v[96:99],v[32:35]
ds_read_b128 v[120:123],v5 offset:6144
v_mfma_f32_16x16x32_bf16 v[36:39],a[68:71],v[96:99],v[36:39]
s_waitcnt lgkmcnt(5)
v_mfma_f32_16x16x32_bf16 v[32:35],a[72:75],v[100:103],v[32:35]
ds_read_b128 v[124:127],v5 offset:7168
v_mfma_f32_16x16x32_bf16 v[36:39],a[76:79],v[100:103],v[36:39]
s_waitcnt lgkmcnt(5)
v_mfma_f32_16x16x32_bf16 v[32:35],a[80:83],v[104:107],v[32:35]
ds_read_b128 v[64:67],v6 offset:0
v_cndmask_b32 v49,v52,v53,s[74:75]
v_mfma_f32_16x16x32_bf16 v[36:39],a[84:87],v[104:107],v[36:39]
s_waitcnt lgkmcnt(5)
v_cndmask_b32 v49,v49,v54,s[76:77]
v_cndmask_b32 v49,v49,v55,s[78:79]
v_mfma_f32_16x16x32_bf16 v[32:35],a[88:91],v[108:111],v[32:35]
ds_read_b128 v[68:71],v6 offset:1024
v_mfma_f32_16x16x32_bf16 v[36:39],a[92:95],v[108:111],v[36:39]
s_waitcnt lgkmcnt(5)
ds_write_b64 v19,v[48:49]
v_mfma_f32_16x16x32_bf16 v[32:35],a[96:99],v[112:115],v[32:35]
ds_read_b128 v[72:75],v6 offset:2048
v_mfma_f32_16x16x32_bf16 v[36:39],a[100:103],v[112:115],v[36:39]
s_waitcnt lgkmcnt(6)
v_mfma_f32_16x16x32_bf16 v[32:35],a[104:107],v[116:119],v[32:35]
ds_read_b128 v[76:79],v6 offset:3072
v_mfma_f32_16x16x32_bf16 v[36:39],a[108:111],v[116:119],v[36:39]
s_waitcnt lgkmcnt(6)
v_mfma_f32_16x16x32_bf16 v[32:35],a[112:115],v[120:123],v[32:35]
s_waitcnt lgkmcnt(2)
s_barrier
ds_read_b128 v[80:83],v6 offset:4096
v_mfma_f32_16x16x32_bf16 v[36:39],a[116:119],v[120:123],v[36:39]
ds_read_b64 v[56:57],v20 offset:0
v_mfma_f32_16x16x32_bf16 v[32:35],a[120:123],v[124:127],v[32:35]
ds_read_b128 v[84:87],v6 offset:5120
v_mfma_f32_16x16x32_bf16 v[36:39],a[124:127],v[124:127],v[36:39]
ds_read_b64 v[58:59],v20 offset:512
v_mfma_f32_16x16x32_bf16 v[32:35],a[128:131],v[64:67],v[32:35]
ds_read_b128 v[88:91],v6 offset:6144
v_mfma_f32_16x16x32_bf16 v[36:39],a[132:135],v[64:67],v[36:39]
ds_read_b64 v[60:61],v20 offset:1024
v_mfma_f32_16x16x32_bf16 v[32:35],a[136:139],v[68:71],v[32:35]
ds_read_b128 v[92:95],v6 offset:7168
v_mfma_f32_16x16x32_bf16 v[36:39],a[140:143],v[68:71],v[36:39]
s_waitcnt lgkmcnt(8)
ds_read_b64 v[62:63],v20 offset:1536
v_mfma_f32_16x16x32_bf16 v[32:35],a[144:147],v[72:75],v[32:35]
ds_read_b128 v[96:99],v7 offset:0
v_mfma_f32_16x16x32_bf16 v[36:39],a[148:151],v[72:75],v[36:39]
s_waitcnt lgkmcnt(9)
buffer_load_dword v16,v2,s[20:23],s68 offen sc1
v_mfma_f32_16x16x32_bf16 v[32:35],a[152:155],v[76:79],v[32:35]
ds_read_b128 v[100:103],v7 offset:1024
v_mfma_f32_16x16x32_bf16 v[36:39],a[156:159],v[76:79],v[36:39]
s_waitcnt lgkmcnt(9)
s_waitcnt vmcnt(2)
v_mov_b32 v17,s57
buffer_store_dword v17,v26,s[20:23],s69 offen sc1
v_mfma_f32_16x16x32_bf16 v[32:35],a[160:163],v[80:83],v[32:35]
ds_read_b128 v[104:107],v7 offset:2048
v_mfma_f32_16x16x32_bf16 v[36:39],a[164:167],v[80:83],v[36:39]
s_waitcnt lgkmcnt(8)
s_waitcnt lgkmcnt(3)
v_add_f32 v56,v56,v58
v_mfma_f32_16x16x32_bf16 v[32:35],a[168:171],v[84:87],v[32:35]
ds_read_b128 v[108:111],v7 offset:3072
v_add_f32 v57,v57,v59
v_mfma_f32_16x16x32_bf16 v[36:39],a[172:175],v[84:87],v[36:39]
v_add_f32 v60,v60,v62
v_add_f32 v61,v61,v63
v_mfma_f32_16x16x32_bf16 v[32:35],a[176:179],v[88:91],v[32:35]
ds_read_b128 v[112:115],v7 offset:4096
v_add_f32 v56,v56,v60
v_mfma_f32_16x16x32_bf16 v[36:39],a[180:183],v[88:91],v[36:39]
v_add_f32 v57,v57,v61
v_mul_f32 v188,0xba800000,v56
v_mfma_f32_16x16x32_bf16 v[32:35],a[184:187],v[92:95],v[32:35]
ds_read_b128 v[116:119],v7 offset:5120
v_fma_f32 v58,v188,v188,-v210
v_mfma_f32_16x16x32_bf16 v[36:39],a[188:191],v[92:95],v[36:39]
s_waitcnt lgkmcnt(5)
v_fma_f32 v57,v57,v211,-v58
v_max_f32 v57,v210,v57
v_mfma_f32_16x16x32_bf16 v[32:35],a[192:195],v[96:99],v[32:35]
ds_read_b128 v[120:123],v7 offset:6144
v_mfma_f32_16x16x32_bf16 v[36:39],a[196:199],v[96:99],v[36:39]
s_waitcnt lgkmcnt(5)
v_rsq_f32 v58,v57
v_mfma_f32_16x16x32_bf16 v[32:35],a[200:203],v[100:103],v[32:35]
ds_read_b128 v[124:127],v7 offset:7168
v_mul_f32 v189,v57,v58
v_mfma_f32_16x16x32_bf16 v[36:39],a[204:207],v[100:103],v[36:39]
s_waitcnt lgkmcnt(5)
v_mul_f32 v190,v209,v58
v_mul_f32 v59,v58,v58
v_mfma_f32_16x16x32_bf16 v[32:35],a[208:211],v[104:107],v[32:35]
s_add_u32 s55,s55,32768
v_mul_f32 v191,v208,v58
v_mul_f32 v191,v191,v59
v_mfma_f32_16x16x32_bf16 v[36:39],a[212:215],v[104:107],v[36:39]
s_waitcnt lgkmcnt(4)
s_and_b32 s55,s55,0x1ffff
v_add_u32 v4,s55,v8
v_mfma_f32_16x16x32_bf16 v[32:35],a[216:219],v[108:111],v[32:35]
v_add_u32 v5,s55,v9
v_add_u32 v6,s55,v10
v_mfma_f32_16x16x32_bf16 v[36:39],a[220:223],v[108:111],v[36:39]
s_waitcnt lgkmcnt(3)
v_add_u32 v7,s55,v11
v_mfma_f32_16x16x32_bf16 v[32:35],a[224:227],v[112:115],v[32:35]
v_mfma_f32_16x16x32_bf16 v[36:39],a[228:231],v[112:115],v[36:39]
s_waitcnt lgkmcnt(2)
v_mfma_f32_16x16x32_bf16 v[32:35],a[232:235],v[116:119],v[32:35]
v_mfma_f32_16x16x32_bf16 v[36:39],a[236:239],v[116:119],v[36:39]
s_waitcnt lgkmcnt(1)
v_mfma_f32_16x16x32_bf16 v[32:35],a[240:243],v[120:123],v[32:35]
v_mfma_f32_16x16x32_bf16 v[36:39],a[244:247],v[120:123],v[36:39]
s_waitcnt lgkmcnt(0)
v_mfma_f32_16x16x32_bf16 v[40:43],a[248:251],v[124:127],v[32:35]
v_mfma_f32_16x16x32_bf16 v[44:47],a[252:255],v[124:127],v[36:39]
s_waitcnt vmcnt(1)
v_cmp_gt_u32 vcc,s71,v16
s_add_u32 s60,s60,1
endN_292:
s_cbranch_vccnz nb_289
s_mov_b32 m0,s70
s_nop 0
buffer_load_dwordx4 v3,s[20:23],s61 offen offset:0 lds
buffer_load_dwordx4 v3,s[20:23],s61 offen offset:1024 lds
buffer_load_dwordx4 v3,s[20:23],s61 offen offset:2048 lds
buffer_load_dwordx4 v3,s[20:23],s61 offen offset:3072 lds
s_add_u32 m0,s70,4096
s_nop 0
buffer_load_dwordx4 v3,s[20:23],s62 offen offset:0 lds
buffer_load_dwordx4 v3,s[20:23],s62 offen offset:1024 lds
buffer_load_dwordx4 v3,s[20:23],s62 offen offset:2048 lds
buffer_load_dwordx4 v3,s[20:23],s62 offen offset:3072 lds
s_add_u32 s61,s61,32768
s_add_u32 s62,s62,32768
s_add_u32 s70,s70,32768
s_and_b32 s70,s70,0x1ffff
s_mov_b32 s57,s63
v_pk_fma_f32 v[40:41],v[152:153],v[188:189],v[40:41] op_sel_hi:[1,0,1]
v_pk_fma_f32 v[42:43],v[154:155],v[188:189],v[42:43] op_sel_hi:[1,0,1]
v_pk_fma_f32 v[44:45],v[156:157],v[188:189],v[44:45] op_sel_hi:[1,0,1]
v_pk_fma_f32 v[46:47],v[158:159],v[188:189],v[46:47] op_sel_hi:[1,0,1]
v_pk_mul_f32 v[168:169],v[40:41],v[40:41]
v_pk_mul_f32 v[170:171],v[42:43],v[42:43]
v_pk_mul_f32 v[172:173],v[44:45],v[44:45]
v_pk_mul_f32 v[174:175],v[46:47],v[46:47]
v_pk_fma_f32 v[168:169],v[168:169],v[190:191],v[190:191] op_sel:[0,1,0] op_sel_hi:[1,1,0]
v_pk_fma_f32 v[170:171],v[170:171],v[190:191],v[190:191] op_sel:[0,1,0] op_sel_hi:[1,1,0]
v_pk_fma_f32 v[172:173],v[172:173],v[190:191],v[190:191] op_sel:[0,1,0] op_sel_hi:[1,1,0]
v_pk_fma_f32 v[174:175],v[174:175],v[190:191],v[190:191] op_sel:[0,1,0] op_sel_hi:[1,1,0]
v_pk_mul_f32 v[168:169],v[168:169],v[40:41]
v_pk_mul_f32 v[170:171],v[170:171],v[42:43]
v_pk_mul_f32 v[172:173],v[172:173],v[44:45]
v_pk_mul_f32 v[174:175],v[174:175],v[46:47]
v_exp_f32 v168,v168
v_exp_f32 v169,v169
v_exp_f32 v170,v170
v_exp_f32 v171,v171
v_exp_f32 v172,v172
v_exp_f32 v173,v173
v_exp_f32 v174,v174
v_exp_f32 v175,v175
v_pk_fma_f32 v[168:169],v[168:169],v[188:189],v[188:189] op_sel:[0,1,1] op_sel_hi:[1,1,1]
v_pk_fma_f32 v[170:171],v[170:171],v[188:189],v[188:189] op_sel:[0,1,1] op_sel_hi:[1,1,1]
v_pk_fma_f32 v[172:173],v[172:173],v[188:189],v[188:189] op_sel:[0,1,1] op_sel_hi:[1,1,1]
v_pk_fma_f32 v[174:175],v[174:175],v[188:189],v[188:189] op_sel:[0,1,1] op_sel_hi:[1,1,1]
v_rcp_f32 v168,v168
v_rcp_f32 v169,v169
v_rcp_f32 v170,v170
v_rcp_f32 v171,v171
v_rcp_f32 v172,v172
v_rcp_f32 v173,v173
v_rcp_f32 v174,v174
v_rcp_f32 v175,v175
v_pk_mul_f32 v[40:41],v[168:169],v[40:41]
v_pk_mul_f32 v[42:43],v[170:171],v[42:43]
v_pk_mul_f32 v[44:45],v[172:173],v[44:45]
v_pk_mul_f32 v[46:47],v[174:175],v[46:47]
v_cvt_pk_bf16_f32 v176,v40,v41
v_cvt_pk_bf16_f32 v177,v42,v43
v_cvt_pk_bf16_f32 v178,v44,v45
v_cvt_pk_bf16_f32 v179,v46,v47
buffer_store_dwordx4 v[176:179],v0,s[20:23],s66 offen sc1
s_add_u32 s66,s66,114688
s_add_u32 s63,s63,1
s_waitcnt vmcnt(9)
v_mov_b32 v17,s57
buffer_store_dword v17,v26,s[20:23],s69 offen sc1
s_branch dec_288
nb_289:
buffer_load_dword v16,v2,s[20:23],s68 offen sc1
s_nop 3
s_mov_b32 s57,s63
v_pk_fma_f32 v[40:41],v[152:153],v[188:189],v[40:41] op_sel_hi:[1,0,1]
v_pk_fma_f32 v[42:43],v[154:155],v[188:189],v[42:43] op_sel_hi:[1,0,1]
v_pk_fma_f32 v[44:45],v[156:157],v[188:189],v[44:45] op_sel_hi:[1,0,1]
v_pk_fma_f32 v[46:47],v[158:159],v[188:189],v[46:47] op_sel_hi:[1,0,1]
v_pk_mul_f32 v[168:169],v[40:41],v[40:41]
v_pk_mul_f32 v[170:171],v[42:43],v[42:43]
v_pk_mul_f32 v[172:173],v[44:45],v[44:45]
v_pk_mul_f32 v[174:175],v[46:47],v[46:47]
v_pk_fma_f32 v[168:169],v[168:169],v[190:191],v[190:191] op_sel:[0,1,0] op_sel_hi:[1,1,0]
v_pk_fma_f32 v[170:171],v[170:171],v[190:191],v[190:191] op_sel:[0,1,0] op_sel_hi:[1,1,0]
v_pk_fma_f32 v[172:173],v[172:173],v[190:191],v[190:191] op_sel:[0,1,0] op_sel_hi:[1,1,0]
v_pk_fma_f32 v[174:175],v[174:175],v[190:191],v[190:191] op_sel:[0,1,0] op_sel_hi:[1,1,0]
v_pk_mul_f32 v[168:169],v[168:169],v[40:41]
v_pk_mul_f32 v[170:171],v[170:171],v[42:43]
v_pk_mul_f32 v[172:173],v[172:173],v[44:45]
v_pk_mul_f32 v[174:175],v[174:175],v[46:47]
v_exp_f32 v168,v168
v_exp_f32 v169,v169
v_exp_f32 v170,v170
v_exp_f32 v171,v171
v_exp_f32 v172,v172
v_exp_f32 v173,v173
v_exp_f32 v174,v174
v_exp_f32 v175,v175
v_pk_fma_f32 v[168:169],v[168:169],v[188:189],v[188:189] op_sel:[0,1,1] op_sel_hi:[1,1,1]
v_pk_fma_f32 v[170:171],v[170:171],v[188:189],v[188:189] op_sel:[0,1,1] op_sel_hi:[1,1,1]
v_pk_fma_f32 v[172:173],v[172:173],v[188:189],v[188:189] op_sel:[0,1,1] op_sel_hi:[1,1,1]
v_pk_fma_f32 v[174:175],v[174:175],v[188:189],v[188:189] op_sel:[0,1,1] op_sel_hi:[1,1,1]
v_rcp_f32 v168,v168
v_rcp_f32 v169,v169
v_rcp_f32 v170,v170
v_rcp_f32 v171,v171
v_rcp_f32 v172,v172
v_rcp_f32 v173,v173
v_rcp_f32 v174,v174
v_rcp_f32 v175,v175
v_pk_mul_f32 v[40:41],v[168:169],v[40:41]
v_pk_mul_f32 v[42:43],v[170:171],v[42:43]
v_pk_mul_f32 v[44:45],v[172:173],v[44:45]
v_pk_mul_f32 v[46:47],v[174:175],v[46:47]
v_cvt_pk_bf16_f32 v176,v40,v41
v_cvt_pk_bf16_f32 v177,v42,v43
v_cvt_pk_bf16_f32 v178,v44,v45
v_cvt_pk_bf16_f32 v179,v46,v47
buffer_store_dwordx4 v[176:179],v0,s[20:23],s66 offen sc1
s_add_u32 s66,s66,114688
s_add_u32 s63,s63,1
s_waitcnt vmcnt(2)
v_mov_b32 v17,s57
buffer_store_dword v17,v26,s[20:23],s69 offen sc1
s_waitcnt vmcnt(2)
v_cmp_gt_u32 vcc,s71,v16
s_cbranch_vccz lag_287
s_waitcnt vmcnt(1)
v_mov_b32 v17,s63
buffer_store_dword v17,v26,s[20:23],s69 offen sc1
s_cmp_ge_u32 s60,128
s_cbranch_scc1 done_276
plp_293:
buffer_load_dword v16,v2,s[20:23],s68 offen sc1
s_waitcnt vmcnt(0)
v_cmp_gt_u32 vcc,s71,v16
s_cbranch_vccz pok_294
s_sleep 4
s_sub_u32 s90,s90,1
s_cmp_gt_i32 s90,0
s_cbranch_scc1 plp_293
pok_294:
s_branch lag_287
done_276:
s_endpgm
fl_w1:
v_and_b32 v21,15,v1
v_lshrrev_b32 v22,4,v1
v_lshrrev_b32 v23,2,v21
v_and_b32 v24,3,v21
s_lshl_b32 s61,s50,15
v_lshl_add_u32 v25,v22,3,v23
s_load_dwordx2 s[4:5],s[0:1],64
s_mov_b32 s52,0
s_mov_b32 s53,s59
s_mul_i32 s54,s52,2097152
s_lshl_b32 s64,s53,8
s_add_u32 s54,s54,s64
s_lshl_b32 s64,s50,6
s_add_u32 s54,s54,s64
s_waitcnt lgkmcnt(0)
s_mov_b32 s28,s4
s_and_b32 s29,s5,0xffff
s_mov_b32 s30,0x200000
s_mov_b32 s31,0x20000
v_lshrrev_b32 v26,2,v1
v_and_b32 v27,3,v1
v_mul_u32_u24 v16,2048,v26
v_lshl_add_u32 v16,v27,4,v16
v_lshlrev_b32 v17,6,v25
v_lshl_add_u32 v17,v24,4,v17
v_add_u32 v17,s61,v17
s_xor_b32 s62,s50,0
s_mul_i32 s62,s62,524288
s_add_u32 s62,s62,s54
s_add_u32 m0,s61,0
s_nop 0
buffer_load_dwordx4 v16,s[28:31],s62 offen lds
s_add_u32 s62,s62,32768
s_add_u32 m0,m0,1024
s_waitcnt vmcnt(2)
buffer_load_dwordx4 v16,s[28:31],s62 offen lds
s_add_u32 s62,s62,32768
s_add_u32 m0,m0,1024
s_waitcnt vmcnt(2)
buffer_load_dwordx4 v16,s[28:31],s62 offen lds
s_add_u32 s62,s62,32768
s_add_u32 m0,m0,1024
s_waitcnt vmcnt(2)
buffer_load_dwordx4 v16,s[28:31],s62 offen lds
s_add_u32 s62,s62,32768
s_add_u32 m0,m0,1024
s_waitcnt vmcnt(2)
buffer_load_dwordx4 v16,s[28:31],s62 offen lds
s_add_u32 s62,s62,32768
s_add_u32 m0,m0,1024
s_waitcnt vmcnt(2)
buffer_load_dwordx4 v16,s[28:31],s62 offen lds
s_add_u32 s62,s62,32768
s_add_u32 m0,m0,1024
s_waitcnt vmcnt(2)
buffer_load_dwordx4 v16,s[28:31],s62 offen lds
s_add_u32 s62,s62,32768
s_add_u32 m0,m0,1024
s_waitcnt vmcnt(2)
buffer_load_dwordx4 v16,s[28:31],s62 offen lds
s_add_u32 s62,s62,32768
s_add_u32 m0,m0,1024
s_waitcnt vmcnt(2)
buffer_load_dwordx4 v16,s[28:31],s62 offen lds
s_add_u32 s62,s62,32768
s_add_u32 m0,m0,1024
s_waitcnt vmcnt(2)
buffer_load_dwordx4 v16,s[28:31],s62 offen lds
s_add_u32 s62,s62,32768
s_add_u32 m0,m0,1024
s_waitcnt vmcnt(2)
buffer_load_dwordx4 v16,s[28:31],s62 offen lds
s_add_u32 s62,s62,32768
s_add_u32 m0,m0,1024
s_waitcnt vmcnt(2)
buffer_load_dwordx4 v16,s[28:31],s62 offen lds
s_add_u32 s62,s62,32768
s_add_u32 m0,m0,1024
s_waitcnt vmcnt(2)
buffer_load_dwordx4 v16,s[28:31],s62 offen lds
s_add_u32 s62,s62,32768
s_add_u32 m0,m0,1024
s_waitcnt vmcnt(2)
buffer_load_dwordx4 v16,s[28:31],s62 offen lds
s_add_u32 s62,s62,32768
s_add_u32 m0,m0,1024
s_waitcnt vmcnt(2)
buffer_load_dwordx4 v16,s[28:31],s62 offen lds
s_add_u32 s62,s62,32768
s_add_u32 m0,m0,1024
s_waitcnt vmcnt(2)
buffer_load_dwordx4 v16,s[28:31],s62 offen lds
s_waitcnt vmcnt(2)
s_xor_b32 s62,s50,1
s_mul_i32 s62,s62,524288
s_add_u32 s62,s62,s54
s_add_u32 m0,s61,16384
s_nop 0
buffer_load_dwordx4 v16,s[28:31],s62 offen lds
s_add_u32 s62,s62,32768
s_add_u32 m0,m0,1024
s_waitcnt vmcnt(2)
buffer_load_dwordx4 v16,s[28:31],s62 offen lds
s_add_u32 s62,s62,32768
s_add_u32 m0,m0,1024
s_waitcnt vmcnt(2)
buffer_load_dwordx4 v16,s[28:31],s62 offen lds
s_add_u32 s62,s62,32768
s_add_u32 m0,m0,1024
s_waitcnt vmcnt(2)
buffer_load_dwordx4 v16,s[28:31],s62 offen lds
s_add_u32 s62,s62,32768
s_add_u32 m0,m0,1024
s_waitcnt vmcnt(2)
buffer_load_dwordx4 v16,s[28:31],s62 offen lds
s_add_u32 s62,s62,32768
s_add_u32 m0,m0,1024
s_waitcnt vmcnt(2)
buffer_load_dwordx4 v16,s[28:31],s62 offen lds
s_add_u32 s62,s62,32768
s_add_u32 m0,m0,1024
s_waitcnt vmcnt(2)
buffer_load_dwordx4 v16,s[28:31],s62 offen lds
s_add_u32 s62,s62,32768
s_add_u32 m0,m0,1024
s_waitcnt vmcnt(2)
buffer_load_dwordx4 v16,s[28:31],s62 offen lds
s_add_u32 s62,s62,32768
s_add_u32 m0,m0,1024
s_waitcnt vmcnt(2)
buffer_load_dwordx4 v16,s[28:31],s62 offen lds
s_add_u32 s62,s62,32768
s_add_u32 m0,m0,1024
s_waitcnt vmcnt(2)
buffer_load_dwordx4 v16,s[28:31],s62 offen lds
s_add_u32 s62,s62,32768
s_add_u32 m0,m0,1024
s_waitcnt vmcnt(2)
buffer_load_dwordx4 v16,s[28:31],s62 offen lds
s_add_u32 s62,s62,32768
s_add_u32 m0,m0,1024
s_waitcnt vmcnt(2)
buffer_load_dwordx4 v16,s[28:31],s62 offen lds
s_add_u32 s62,s62,32768
s_add_u32 m0,m0,1024
s_waitcnt vmcnt(2)
buffer_load_dwordx4 v16,s[28:31],s62 offen lds
s_add_u32 s62,s62,32768
s_add_u32 m0,m0,1024
s_waitcnt vmcnt(2)
buffer_load_dwordx4 v16,s[28:31],s62 offen lds
s_add_u32 s62,s62,32768
s_add_u32 m0,m0,1024
s_waitcnt vmcnt(2)
buffer_load_dwordx4 v16,s[28:31],s62 offen lds
s_add_u32 s62,s62,32768
s_add_u32 m0,m0,1024
s_waitcnt vmcnt(2)
buffer_load_dwordx4 v16,s[28:31],s62 offen lds
s_waitcnt vmcnt(2)
s_waitcnt vmcnt(16)
ds_read_b64_tr_b16 a[0:1],v17 offset:0
ds_read_b64_tr_b16 a[2:3],v17 offset:256
ds_read_b64_tr_b16 a[4:5],v17 offset:8
ds_read_b64_tr_b16 a[6:7],v17 offset:264
ds_read_b64_tr_b16 a[8:9],v17 offset:2048
ds_read_b64_tr_b16 a[10:11],v17 offset:2304
ds_read_b64_tr_b16 a[12:13],v17 offset:2056
ds_read_b64_tr_b16 a[14:15],v17 offset:2312
ds_read_b64_tr_b16 a[16:17],v17 offset:4096
ds_read_b64_tr_b16 a[18:19],v17 offset:4352
ds_read_b64_tr_b16 a[20:21],v17 offset:4104
ds_read_b64_tr_b16 a[22:23],v17 offset:4360
s_waitcnt lgkmcnt(0)
ds_read_b64_tr_b16 a[24:25],v17 offset:6144
ds_read_b64_tr_b16 a[26:27],v17 offset:6400
ds_read_b64_tr_b16 a[28:29],v17 offset:6152
ds_read_b64_tr_b16 a[30:31],v17 offset:6408
ds_read_b64_tr_b16 a[32:33],v17 offset:8192
ds_read_b64_tr_b16 a[34:35],v17 offset:8448
ds_read_b64_tr_b16 a[36:37],v17 offset:8200
ds_read_b64_tr_b16 a[38:39],v17 offset:8456
ds_read_b64_tr_b16 a[40:41],v17 offset:10240
ds_read_b64_tr_b16 a[42:43],v17 offset:10496
ds_read_b64_tr_b16 a[44:45],v17 offset:10248
ds_read_b64_tr_b16 a[46:47],v17 offset:10504
s_waitcnt lgkmcnt(0)
ds_read_b64_tr_b16 a[48:49],v17 offset:12288
ds_read_b64_tr_b16 a[50:51],v17 offset:12544
ds_read_b64_tr_b16 a[52:53],v17 offset:12296
ds_read_b64_tr_b16 a[54:55],v17 offset:12552
ds_read_b64_tr_b16 a[56:57],v17 offset:14336
ds_read_b64_tr_b16 a[58:59],v17 offset:14592
ds_read_b64_tr_b16 a[60:61],v17 offset:14344
ds_read_b64_tr_b16 a[62:63],v17 offset:14600
s_waitcnt lgkmcnt(0)
s_xor_b32 s62,s50,2
s_mul_i32 s62,s62,524288
s_add_u32 s62,s62,s54
s_add_u32 m0,s61,0
s_nop 0
buffer_load_dwordx4 v16,s[28:31],s62 offen lds
s_add_u32 s62,s62,32768
s_add_u32 m0,m0,1024
s_waitcnt vmcnt(2)
buffer_load_dwordx4 v16,s[28:31],s62 offen lds
s_add_u32 s62,s62,32768
s_add_u32 m0,m0,1024
s_waitcnt vmcnt(2)
buffer_load_dwordx4 v16,s[28:31],s62 offen lds
s_add_u32 s62,s62,32768
s_add_u32 m0,m0,1024
s_waitcnt vmcnt(2)
buffer_load_dwordx4 v16,s[28:31],s62 offen lds
s_add_u32 s62,s62,32768
s_add_u32 m0,m0,1024
s_waitcnt vmcnt(2)
buffer_load_dwordx4 v16,s[28:31],s62 offen lds
s_add_u32 s62,s62,32768
s_add_u32 m0,m0,1024
s_waitcnt vmcnt(2)
buffer_load_dwordx4 v16,s[28:31],s62 offen lds
s_add_u32 s62,s62,32768
s_add_u32 m0,m0,1024
s_waitcnt vmcnt(2)
buffer_load_dwordx4 v16,s[28:31],s62 offen lds
s_add_u32 s62,s62,32768
s_add_u32 m0,m0,1024
s_waitcnt vmcnt(2)
buffer_load_dwordx4 v16,s[28:31],s62 offen lds
s_add_u32 s62,s62,32768
s_add_u32 m0,m0,1024
s_waitcnt vmcnt(2)
buffer_load_dwordx4 v16,s[28:31],s62 offen lds
s_add_u32 s62,s62,32768
s_add_u32 m0,m0,1024
s_waitcnt vmcnt(2)
buffer_load_dwordx4 v16,s[28:31],s62 offen lds
s_add_u32 s62,s62,32768
s_add_u32 m0,m0,1024
s_waitcnt vmcnt(2)
buffer_load_dwordx4 v16,s[28:31],s62 offen lds
s_add_u32 s62,s62,32768
s_add_u32 m0,m0,1024
s_waitcnt vmcnt(2)
buffer_load_dwordx4 v16,s[28:31],s62 offen lds
s_add_u32 s62,s62,32768
s_add_u32 m0,m0,1024
s_waitcnt vmcnt(2)
buffer_load_dwordx4 v16,s[28:31],s62 offen lds
s_add_u32 s62,s62,32768
s_add_u32 m0,m0,1024
s_waitcnt vmcnt(2)
buffer_load_dwordx4 v16,s[28:31],s62 offen lds
s_add_u32 s62,s62,32768
s_add_u32 m0,m0,1024
s_waitcnt vmcnt(2)
buffer_load_dwordx4 v16,s[28:31],s62 offen lds
s_add_u32 s62,s62,32768
s_add_u32 m0,m0,1024
s_waitcnt vmcnt(2)
buffer_load_dwordx4 v16,s[28:31],s62 offen lds
s_waitcnt vmcnt(2)
s_waitcnt vmcnt(16)
ds_read_b64_tr_b16 a[64:65],v17 offset:16384
ds_read_b64_tr_b16 a[66:67],v17 offset:16640
ds_read_b64_tr_b16 a[68:69],v17 offset:16392
ds_read_b64_tr_b16 a[70:71],v17 offset:16648
ds_read_b64_tr_b16 a[72:73],v17 offset:18432
ds_read_b64_tr_b16 a[74:75],v17 offset:18688
ds_read_b64_tr_b16 a[76:77],v17 offset:18440
ds_read_b64_tr_b16 a[78:79],v17 offset:18696
ds_read_b64_tr_b16 a[80:81],v17 offset:20480
ds_read_b64_tr_b16 a[82:83],v17 offset:20736
ds_read_b64_tr_b16 a[84:85],v17 offset:20488
ds_read_b64_tr_b16 a[86:87],v17 offset:20744
s_waitcnt lgkmcnt(0)
ds_read_b64_tr_b16 a[88:89],v17 offset:22528
ds_read_b64_tr_b16 a[90:91],v17 offset:22784
ds_read_b64_tr_b16 a[92:93],v17 offset:22536
ds_read_b64_tr_b16 a[94:95],v17 offset:22792
ds_read_b64_tr_b16 a[96:97],v17 offset:24576
ds_read_b64_tr_b16 a[98:99],v17 offset:24832
ds_read_b64_tr_b16 a[100:101],v17 offset:24584
ds_read_b64_tr_b16 a[102:103],v17 offset:24840
ds_read_b64_tr_b16 a[104:105],v17 offset:26624
ds_read_b64_tr_b16 a[106:107],v17 offset:26880
ds_read_b64_tr_b16 a[108:109],v17 offset:26632
ds_read_b64_tr_b16 a[110:111],v17 offset:26888
s_waitcnt lgkmcnt(0)
ds_read_b64_tr_b16 a[112:113],v17 offset:28672
ds_read_b64_tr_b16 a[114:115],v17 offset:28928
ds_read_b64_tr_b16 a[116:117],v17 offset:28680
ds_read_b64_tr_b16 a[118:119],v17 offset:28936
ds_read_b64_tr_b16 a[120:121],v17 offset:30720
ds_read_b64_tr_b16 a[122:123],v17 offset:30976
ds_read_b64_tr_b16 a[124:125],v17 offset:30728
ds_read_b64_tr_b16 a[126:127],v17 offset:30984
s_waitcnt lgkmcnt(0)
s_xor_b32 s62,s50,3
s_mul_i32 s62,s62,524288
s_add_u32 s62,s62,s54
s_add_u32 m0,s61,16384
s_nop 0
buffer_load_dwordx4 v16,s[28:31],s62 offen lds
s_add_u32 s62,s62,32768
s_add_u32 m0,m0,1024
s_waitcnt vmcnt(2)
buffer_load_dwordx4 v16,s[28:31],s62 offen lds
s_add_u32 s62,s62,32768
s_add_u32 m0,m0,1024
s_waitcnt vmcnt(2)
buffer_load_dwordx4 v16,s[28:31],s62 offen lds
s_add_u32 s62,s62,32768
s_add_u32 m0,m0,1024
s_waitcnt vmcnt(2)
buffer_load_dwordx4 v16,s[28:31],s62 offen lds
s_add_u32 s62,s62,32768
s_add_u32 m0,m0,1024
s_waitcnt vmcnt(2)
buffer_load_dwordx4 v16,s[28:31],s62 offen lds
s_add_u32 s62,s62,32768
s_add_u32 m0,m0,1024
s_waitcnt vmcnt(2)
buffer_load_dwordx4 v16,s[28:31],s62 offen lds
s_add_u32 s62,s62,32768
s_add_u32 m0,m0,1024
s_waitcnt vmcnt(2)
buffer_load_dwordx4 v16,s[28:31],s62 offen lds
s_add_u32 s62,s62,32768
s_add_u32 m0,m0,1024
s_waitcnt vmcnt(2)
buffer_load_dwordx4 v16,s[28:31],s62 offen lds
s_add_u32 s62,s62,32768
s_add_u32 m0,m0,1024
s_waitcnt vmcnt(2)
buffer_load_dwordx4 v16,s[28:31],s62 offen lds
s_add_u32 s62,s62,32768
s_add_u32 m0,m0,1024
s_waitcnt vmcnt(2)
buffer_load_dwordx4 v16,s[28:31],s62 offen lds
s_add_u32 s62,s62,32768
s_add_u32 m0,m0,1024
s_waitcnt vmcnt(2)
buffer_load_dwordx4 v16,s[28:31],s62 offen lds
s_add_u32 s62,s62,32768
s_add_u32 m0,m0,1024
s_waitcnt vmcnt(2)
buffer_load_dwordx4 v16,s[28:31],s62 offen lds
s_add_u32 s62,s62,32768
s_add_u32 m0,m0,1024
s_waitcnt vmcnt(2)
buffer_load_dwordx4 v16,s[28:31],s62 offen lds
s_add_u32 s62,s62,32768
s_add_u32 m0,m0,1024
s_waitcnt vmcnt(2)
buffer_load_dwordx4 v16,s[28:31],s62 offen lds
s_add_u32 s62,s62,32768
s_add_u32 m0,m0,1024
s_waitcnt vmcnt(2)
buffer_load_dwordx4 v16,s[28:31],s62 offen lds
s_add_u32 s62,s62,32768
s_add_u32 m0,m0,1024
s_waitcnt vmcnt(2)
buffer_load_dwordx4 v16,s[28:31],s62 offen lds
s_waitcnt vmcnt(2)
s_waitcnt vmcnt(16)
ds_read_b64_tr_b16 a[128:129],v17 offset:0
ds_read_b64_tr_b16 a[130:131],v17 offset:256
ds_read_b64_tr_b16 a[132:133],v17 offset:8
ds_read_b64_tr_b16 a[134:135],v17 offset:264
ds_read_b64_tr_b16 a[136:137],v17 offset:2048
ds_read_b64_tr_b16 a[138:139],v17 offset:2304
ds_read_b64_tr_b16 a[140:141],v17 offset:2056
ds_read_b64_tr_b16 a[142:143],v17 offset:2312
ds_read_b64_tr_b16 a[144:145],v17 offset:4096
ds_read_b64_tr_b16 a[146:147],v17 offset:4352
ds_read_b64_tr_b16 a[148:149],v17 offset:4104
ds_read_b64_tr_b16 a[150:151],v17 offset:4360
s_waitcnt lgkmcnt(0)
ds_read_b64_tr_b16 a[152:153],v17 offset:6144
ds_read_b64_tr_b16 a[154:155],v17 offset:6400
ds_read_b64_tr_b16 a[156:157],v17 offset:6152
ds_read_b64_tr_b16 a[158:159],v17 offset:6408
ds_read_b64_tr_b16 a[160:161],v17 offset:8192
ds_read_b64_tr_b16 a[162:163],v17 offset:8448
ds_read_b64_tr_b16 a[164:165],v17 offset:8200
ds_read_b64_tr_b16 a[166:167],v17 offset:8456
ds_read_b64_tr_b16 a[168:169],v17 offset:10240
ds_read_b64_tr_b16 a[170:171],v17 offset:10496
ds_read_b64_tr_b16 a[172:173],v17 offset:10248
ds_read_b64_tr_b16 a[174:175],v17 offset:10504
s_waitcnt lgkmcnt(0)
ds_read_b64_tr_b16 a[176:177],v17 offset:12288
ds_read_b64_tr_b16 a[178:179],v17 offset:12544
ds_read_b64_tr_b16 a[180:181],v17 offset:12296
ds_read_b64_tr_b16 a[182:183],v17 offset:12552
ds_read_b64_tr_b16 a[184:185],v17 offset:14336
ds_read_b64_tr_b16 a[186:187],v17 offset:14592
ds_read_b64_tr_b16 a[188:189],v17 offset:14344
ds_read_b64_tr_b16 a[190:191],v17 offset:14600
s_waitcnt lgkmcnt(0)
s_waitcnt vmcnt(0)
ds_read_b64_tr_b16 a[192:193],v17 offset:16384
ds_read_b64_tr_b16 a[194:195],v17 offset:16640
ds_read_b64_tr_b16 a[196:197],v17 offset:16392
ds_read_b64_tr_b16 a[198:199],v17 offset:16648
ds_read_b64_tr_b16 a[200:201],v17 offset:18432
ds_read_b64_tr_b16 a[202:203],v17 offset:18688
ds_read_b64_tr_b16 a[204:205],v17 offset:18440
ds_read_b64_tr_b16 a[206:207],v17 offset:18696
ds_read_b64_tr_b16 a[208:209],v17 offset:20480
ds_read_b64_tr_b16 a[210:211],v17 offset:20736
ds_read_b64_tr_b16 a[212:213],v17 offset:20488
ds_read_b64_tr_b16 a[214:215],v17 offset:20744
s_waitcnt lgkmcnt(0)
ds_read_b64_tr_b16 a[216:217],v17 offset:22528
ds_read_b64_tr_b16 a[218:219],v17 offset:22784
ds_read_b64_tr_b16 a[220:221],v17 offset:22536
ds_read_b64_tr_b16 a[222:223],v17 offset:22792
ds_read_b64_tr_b16 a[224:225],v17 offset:24576
ds_read_b64_tr_b16 a[226:227],v17 offset:24832
ds_read_b64_tr_b16 a[228:229],v17 offset:24584
ds_read_b64_tr_b16 a[230:231],v17 offset:24840
ds_read_b64_tr_b16 a[232:233],v17 offset:26624
ds_read_b64_tr_b16 a[234:235],v17 offset:26880
ds_read_b64_tr_b16 a[236:237],v17 offset:26632
ds_read_b64_tr_b16 a[238:239],v17 offset:26888
s_waitcnt lgkmcnt(0)
ds_read_b64_tr_b16 a[240:241],v17 offset:28672
ds_read_b64_tr_b16 a[242:243],v17 offset:28928
ds_read_b64_tr_b16 a[244:245],v17 offset:28680
ds_read_b64_tr_b16 a[246:247],v17 offset:28936
ds_read_b64_tr_b16 a[248:249],v17 offset:30720
ds_read_b64_tr_b16 a[250:251],v17 offset:30976
ds_read_b64_tr_b16 a[252:253],v17 offset:30728
ds_read_b64_tr_b16 a[254:255],v17 offset:30984
s_waitcnt lgkmcnt(0)
s_mov_b32 s92,s2
s_and_b32 s93,s3,0xffff
s_mov_b32 s94,0x100
s_mov_b32 s95,0x20000
v_mbcnt_lo_u32_b32 v16,-1,0
v_mbcnt_hi_u32_b32 v16,-1,v16
v_mov_b32 v18,0
v_cmp_eq_u32 vcc,22,v16
s_nop 1
v_cndmask_b32 v18,v18,63,vcc
v_cmp_eq_u32 vcc,17,v16
s_nop 1
v_cndmask_b32 v18,v18,63,vcc
v_cmp_eq_u32 vcc,18,v16
s_nop 1
v_cndmask_b32 v18,v18,1,vcc
v_and_b32 v19,1,v16
v_cmp_eq_u32 vcc,1,v19
v_mov_b32 v19,8192
s_nop 0
v_cndmask_b32 v19,-1,v19,vcc
v_min_u32 v16,31,v16
v_lshlrev_b32 v16,2,v16
s_sub_u32 s66,s88,64
s_cmp_lg_u32 s50,0
s_cbranch_scc1 vot_300
vpoll_296:
buffer_load_dword v17,v16,s[92:95],s66 offen sc1
s_waitcnt vmcnt(0)
s_cmp_lg_u32 s56,2
s_cbranch_scc1 vck_297
v_cmp_eq_u32 vcc,v17,v19
s_and_b32 s64,vcc_lo,0xffff
s_cmp_eq_u32 s64,65535
s_cbranch_scc1 vck_297
s_mov_b32 s65,0
v_readlane_b32 s64,v17,1
s_lshr_b32 s64,s64,8
s_add_u32 s65,s65,s64
v_readlane_b32 s64,v17,3
s_lshr_b32 s64,s64,8
s_add_u32 s65,s65,s64
v_readlane_b32 s64,v17,5
s_lshr_b32 s64,s64,8
s_add_u32 s65,s65,s64
v_readlane_b32 s64,v17,7
s_lshr_b32 s64,s64,8
s_add_u32 s65,s65,s64
v_readlane_b32 s64,v17,9
s_lshr_b32 s64,s64,8
s_add_u32 s65,s65,s64
v_readlane_b32 s64,v17,11
s_lshr_b32 s64,s64,8
s_add_u32 s65,s65,s64
v_readlane_b32 s64,v17,13
s_lshr_b32 s64,s64,8
s_add_u32 s65,s65,s64
v_readlane_b32 s64,v17,15
s_lshr_b32 s64,s64,8
s_add_u32 s65,s65,s64
s_cmp_ge_u32 s65,256
s_cbranch_scc1 vok_299
s_branch vrt_298
vck_297:
v_cmp_gt_u32 vcc,v18,v17
s_cbranch_vccz vok_299
vrt_298:
s_sleep 48
s_sub_u32 s90,s90,1
s_cmp_gt_i32 s90,0
s_cbranch_scc1 vpoll_296
vok_299:
v_add_u32 v18,160512,v16
ds_write_b32 v18,v17
s_waitcnt lgkmcnt(0)
vot_300:
s_barrier
v_add_u32 v18,160512,v16
ds_read_b32 v17,v18
s_waitcnt lgkmcnt(0)
s_cmp_lg_u32 s56,2
s_cbranch_scc1 vfin_301
v_cmp_eq_u32 vcc,v17,v19
s_and_b32 s64,vcc_lo,0xffff
s_cmp_eq_u32 s64,65535
s_cbranch_scc1 vfin_301
s_mov_b32 s65,0
v_readlane_b32 s64,v17,1
s_lshr_b32 s64,s64,8
s_add_u32 s65,s65,s64
v_readlane_b32 s64,v17,3
s_lshr_b32 s64,s64,8
s_add_u32 s65,s65,s64
v_readlane_b32 s64,v17,5
s_lshr_b32 s64,s64,8
s_add_u32 s65,s65,s64
v_readlane_b32 s64,v17,7
s_lshr_b32 s64,s64,8
s_add_u32 s65,s65,s64
v_readlane_b32 s64,v17,9
s_lshr_b32 s64,s64,8
s_add_u32 s65,s65,s64
v_readlane_b32 s64,v17,11
s_lshr_b32 s64,s64,8
s_add_u32 s65,s65,s64
v_readlane_b32 s64,v17,13
s_lshr_b32 s64,s64,8
s_add_u32 s65,s65,s64
v_readlane_b32 s64,v17,15
s_lshr_b32 s64,s64,8
s_add_u32 s65,s65,s64
s_cmp_ge_u32 s65,256
s_cbranch_scc1 fl_fb
vfin_301:
s_and_b32 s56,s56,1
s_mov_b32 s67,0
s_barrier
v_lshlrev_b32 v0,4,v1
s_mov_b32 s60,0
s_lshl_b32 s70,s50,13
s_mov_b32 s55,0
v_mov_b32 v3,v0
s_mov_b32 s73,0xffff0000
s_lshl_b32 s64,s52,2
s_add_u32 s64,s64,s50
s_mul_i32 s61,s64,8192
s_add_u32 s61,s61,205520896
s_lshl_b32 s68,s64,8
s_add_u32 s68,s68,138548224
s_lshl_b32 s83,s53,2
s_add_u32 s83,s83,s50
s_mov_b32 s63,0
s_xor_b32 s64,s50,0
s_lshl_b32 s64,s64,13
v_add_u32 v8,s64,v0
v_mov_b32 v4,v8
s_xor_b32 s64,s50,1
s_lshl_b32 s64,s64,13
v_add_u32 v9,s64,v0
v_mov_b32 v5,v9
s_xor_b32 s64,s50,2
s_lshl_b32 s64,s64,13
v_add_u32 v10,s64,v0
v_mov_b32 v6,v10
s_xor_b32 s64,s50,3
s_lshl_b32 s64,s64,13
v_add_u32 v11,s64,v0
v_mov_b32 v7,v11
v_min_u32 v2,3,v1
v_lshlrev_b32 v2,7,v2
s_mul_i32 s68,s50,512
s_add_u32 s68,s68,138567680
s_add_u32 s62,s61,4096
s_lshl_b32 s66,s83,10
s_lshr_b32 s65,s83,3
s_lshl_b32 s65,s65,8
s_and_b32 s64,s83,7
s_lshl_b32 s64,s64,2
s_add_u32 s69,s64,s65
s_add_u32 s69,s69,138549248
s_lshl_b32 s69,s83,7
s_add_u32 s69,s69,138559488
s_add_u32 s82,s66,201326592
s_add_u32 s66,s66,209747968
s_lshl_b32 s64,s50,9
s_add_u32 s64,s64,131072
v_lshlrev_b32 v26,3,v1
v_add_u32 v19,s64,v26
v_lshl_add_u32 v26,v23,4,v21
v_lshlrev_b32 v26,3,v26
v_add_u32 v20,131072,v26
s_mov_b32 s74,0x22222222
s_mov_b32 s75,0x22222222
s_mov_b32 s76,0x44444444
s_mov_b32 s77,0x44444444
s_mov_b32 s78,0x88888888
s_mov_b32 s79,0x88888888
v_mov_b32 v208,0xbdd2d3e8
v_mov_b32 v209,0xc0135761
v_mov_b32 v210,0x3727c5ac
v_mov_b32 v211,0x3a800000
v_mov_b32 v12,0x3f803f80
v_mov_b32 v13,0x3f803f80
v_mov_b32 v14,0x3f803f80
v_mov_b32 v15,0x3f803f80
s_nop 1
v_mfma_f32_16x16x32_bf16 v[152:155],a[0:3],v[12:15],0
v_mfma_f32_16x16x32_bf16 v[156:159],a[4:7],v[12:15],0
v_mfma_f32_16x16x32_bf16 v[152:155],a[8:11],v[12:15],v[152:155]
v_mfma_f32_16x16x32_bf16 v[156:159],a[12:15],v[12:15],v[156:159]
v_mfma_f32_16x16x32_bf16 v[152:155],a[16:19],v[12:15],v[152:155]
v_mfma_f32_16x16x32_bf16 v[156:159],a[20:23],v[12:15],v[156:159]
v_mfma_f32_16x16x32_bf16 v[152:155],a[24:27],v[12:15],v[152:155]
v_mfma_f32_16x16x32_bf16 v[156:159],a[28:31],v[12:15],v[156:159]
v_mfma_f32_16x16x32_bf16 v[152:155],a[32:35],v[12:15],v[152:155]
v_mfma_f32_16x16x32_bf16 v[156:159],a[36:39],v[12:15],v[156:159]
v_mfma_f32_16x16x32_bf16 v[152:155],a[40:43],v[12:15],v[152:155]
v_mfma_f32_16x16x32_bf16 v[156:159],a[44:47],v[12:15],v[156:159]
v_mfma_f32_16x16x32_bf16 v[152:155],a[48:51],v[12:15],v[152:155]
v_mfma_f32_16x16x32_bf16 v[156:159],a[52:55],v[12:15],v[156:159]
v_mfma_f32_16x16x32_bf16 v[152:155],a[56:59],v[12:15],v[152:155]
v_mfma_f32_16x16x32_bf16 v[156:159],a[60:63],v[12:15],v[156:159]
v_mfma_f32_16x16x32_bf16 v[152:155],a[64:67],v[12:15],v[152:155]
v_mfma_f32_16x16x32_bf16 v[156:159],a[68:71],v[12:15],v[156:159]
v_mfma_f32_16x16x32_bf16 v[152:155],a[72:75],v[12:15],v[152:155]
v_mfma_f32_16x16x32_bf16 v[156:159],a[76:79],v[12:15],v[156:159]
v_mfma_f32_16x16x32_bf16 v[152:155],a[80:83],v[12:15],v[152:155]
v_mfma_f32_16x16x32_bf16 v[156:159],a[84:87],v[12:15],v[156:159]
v_mfma_f32_16x16x32_bf16 v[152:155],a[88:91],v[12:15],v[152:155]
v_mfma_f32_16x16x32_bf16 v[156:159],a[92:95],v[12:15],v[156:159]
v_mfma_f32_16x16x32_bf16 v[152:155],a[96:99],v[12:15],v[152:155]
v_mfma_f32_16x16x32_bf16 v[156:159],a[100:103],v[12:15],v[156:159]
v_mfma_f32_16x16x32_bf16 v[152:155],a[104:107],v[12:15],v[152:155]
v_mfma_f32_16x16x32_bf16 v[156:159],a[108:111],v[12:15],v[156:159]
v_mfma_f32_16x16x32_bf16 v[152:155],a[112:115],v[12:15],v[152:155]
v_mfma_f32_16x16x32_bf16 v[156:159],a[116:119],v[12:15],v[156:159]
v_mfma_f32_16x16x32_bf16 v[152:155],a[120:123],v[12:15],v[152:155]
v_mfma_f32_16x16x32_bf16 v[156:159],a[124:127],v[12:15],v[156:159]
v_mfma_f32_16x16x32_bf16 v[152:155],a[128:131],v[12:15],v[152:155]
v_mfma_f32_16x16x32_bf16 v[156:159],a[132:135],v[12:15],v[156:159]
v_mfma_f32_16x16x32_bf16 v[152:155],a[136:139],v[12:15],v[152:155]
v_mfma_f32_16x16x32_bf16 v[156:159],a[140:143],v[12:15],v[156:159]
v_mfma_f32_16x16x32_bf16 v[152:155],a[144:147],v[12:15],v[152:155]
v_mfma_f32_16x16x32_bf16 v[156:159],a[148:151],v[12:15],v[156:159]
v_mfma_f32_16x16x32_bf16 v[152:155],a[152:155],v[12:15],v[152:155]
v_mfma_f32_16x16x32_bf16 v[156:159],a[156:159],v[12:15],v[156:159]
v_mfma_f32_16x16x32_bf16 v[152:155],a[160:163],v[12:15],v[152:155]
v_mfma_f32_16x16x32_bf16 v[156:159],a[164:167],v[12:15],v[156:159]
v_mfma_f32_16x16x32_bf16 v[152:155],a[168:171],v[12:15],v[152:155]
v_mfma_f32_16x16x32_bf16 v[156:159],a[172:175],v[12:15],v[156:159]
v_mfma_f32_16x16x32_bf16 v[152:155],a[176:179],v[12:15],v[152:155]
v_mfma_f32_16x16x32_bf16 v[156:159],a[180:183],v[12:15],v[156:159]
v_mfma_f32_16x16x32_bf16 v[152:155],a[184:187],v[12:15],v[152:155]
v_mfma_f32_16x16x32_bf16 v[156:159],a[188:191],v[12:15],v[156:159]
v_mfma_f32_16x16x32_bf16 v[152:155],a[192:195],v[12:15],v[152:155]
v_mfma_f32_16x16x32_bf16 v[156:159],a[196:199],v[12:15],v[156:159]
v_mfma_f32_16x16x32_bf16 v[152:155],a[200:203],v[12:15],v[152:155]
v_mfma_f32_16x16x32_bf16 v[156:159],a[204:207],v[12:15],v[156:159]
v_mfma_f32_16x16x32_bf16 v[152:155],a[208:211],v[12:15],v[152:155]
v_mfma_f32_16x16x32_bf16 v[156:159],a[212:215],v[12:15],v[156:159]
v_mfma_f32_16x16x32_bf16 v[152:155],a[216:219],v[12:15],v[152:155]
v_mfma_f32_16x16x32_bf16 v[156:159],a[220:223],v[12:15],v[156:159]
v_mfma_f32_16x16x32_bf16 v[152:155],a[224:227],v[12:15],v[152:155]
v_mfma_f32_16x16x32_bf16 v[156:159],a[228:231],v[12:15],v[156:159]
v_mfma_f32_16x16x32_bf16 v[152:155],a[232:235],v[12:15],v[152:155]
v_mfma_f32_16x16x32_bf16 v[156:159],a[236:239],v[12:15],v[156:159]
v_mfma_f32_16x16x32_bf16 v[152:155],a[240:243],v[12:15],v[152:155]
v_mfma_f32_16x16x32_bf16 v[156:159],a[244:247],v[12:15],v[156:159]
v_mfma_f32_16x16x32_bf16 v[152:155],a[248:251],v[12:15],v[152:155]
v_mfma_f32_16x16x32_bf16 v[156:159],a[252:255],v[12:15],v[156:159]
v_lshlrev_b32 v26,2,v1
v_cmp_gt_u32 vcc,32,v1
s_nop 1
v_cndmask_b32 v26,2.0,v26,vcc
s_cmp_eq_u32 s56,1
s_cbranch_scc1 lfar_302
s_add_u32 s71,s60,1
s_add_u32 s53,s60,2
plp_310:
buffer_load_dword v16,v2,s[20:23],s68 offen sc1
s_waitcnt vmcnt(0)
v_cmp_gt_u32 vcc,s71,v16
s_cbranch_vccz pok_311
s_sleep 4
s_sub_u32 s90,s90,1
s_cmp_gt_i32 s90,0
s_cbranch_scc1 plp_310
pok_311:
lag_307:
s_mov_b32 m0,s70
s_nop 0
buffer_load_dwordx4 v3,s[20:23],s61 offen offset:0 lds
buffer_load_dwordx4 v3,s[20:23],s61 offen offset:1024 lds
buffer_load_dwordx4 v3,s[20:23],s61 offen offset:2048 lds
buffer_load_dwordx4 v3,s[20:23],s61 offen offset:3072 lds
s_add_u32 m0,s70,4096
s_nop 0
buffer_load_dwordx4 v3,s[20:23],s62 offen offset:0 lds
buffer_load_dwordx4 v3,s[20:23],s62 offen offset:1024 lds
buffer_load_dwordx4 v3,s[20:23],s62 offen offset:2048 lds
buffer_load_dwordx4 v3,s[20:23],s62 offen offset:3072 lds
s_add_u32 s61,s61,32768
s_add_u32 s62,s62,32768
s_add_u32 s70,s70,32768
s_and_b32 s70,s70,0x1ffff
buffer_load_dword v23,off,s[20:23],s66
buffer_load_dword v23,off,s[20:23],s66
dec_308:
v_cmp_gt_u32 vcc,s53,v16
s_cbranch_vccnz BN_306
BR_305:
s_waitcnt vmcnt(9)
ds_read_b128 v[64:67],v4 offset:0
s_waitcnt vmcnt(8)
ds_read_b128 v[68:71],v4 offset:1024
s_waitcnt vmcnt(7)
ds_read_b128 v[72:75],v4 offset:2048
s_waitcnt vmcnt(6)
ds_read_b128 v[76:79],v4 offset:3072
s_waitcnt lgkmcnt(3)
v_mfma_f32_16x16x32_bf16 v[32:35],a[0:3],v[64:67],0
s_add_u32 s71,s60,2
s_add_u32 s53,s60,3
s_mov_b32 s57,s63
v_mfma_f32_16x16x32_bf16 v[36:39],a[4:7],v[64:67],0
v_mfma_f32_16x16x32_bf16 v[48:51],v[12:15],v[64:67],0
v_mfma_f32_16x16x32_bf16 v[52:55],v[64:67],v[64:67],0
s_waitcnt lgkmcnt(2)
s_waitcnt vmcnt(5)
s_mov_b32 m0,s70
ds_read_b128 v[80:83],v4 offset:4096
v_mfma_f32_16x16x32_bf16 v[32:35],a[8:11],v[68:71],v[32:35]
buffer_load_dwordx4 v3,s[20:23],s61 offen offset:0 lds
v_mfma_f32_16x16x32_bf16 v[36:39],a[12:15],v[68:71],v[36:39]
v_mfma_f32_16x16x32_bf16 v[48:51],v[12:15],v[68:71],v[48:51]
v_mfma_f32_16x16x32_bf16 v[52:55],v[68:71],v[68:71],v[52:55]
s_waitcnt lgkmcnt(2)
s_waitcnt vmcnt(5)
ds_read_b128 v[84:87],v4 offset:5120
v_mfma_f32_16x16x32_bf16 v[32:35],a[16:19],v[72:75],v[32:35]
buffer_load_dwordx4 v3,s[20:23],s61 offen offset:1024 lds
v_mfma_f32_16x16x32_bf16 v[36:39],a[20:23],v[72:75],v[36:39]
v_mfma_f32_16x16x32_bf16 v[48:51],v[12:15],v[72:75],v[48:51]
v_mfma_f32_16x16x32_bf16 v[52:55],v[72:75],v[72:75],v[52:55]
s_waitcnt lgkmcnt(2)
s_waitcnt vmcnt(5)
ds_read_b128 v[88:91],v4 offset:6144
v_mfma_f32_16x16x32_bf16 v[32:35],a[24:27],v[76:79],v[32:35]
buffer_load_dwordx4 v3,s[20:23],s61 offen offset:2048 lds
v_mfma_f32_16x16x32_bf16 v[36:39],a[28:31],v[76:79],v[36:39]
v_mfma_f32_16x16x32_bf16 v[48:51],v[12:15],v[76:79],v[48:51]
v_mfma_f32_16x16x32_bf16 v[52:55],v[76:79],v[76:79],v[52:55]
s_waitcnt lgkmcnt(2)
s_waitcnt vmcnt(5)
ds_read_b128 v[92:95],v4 offset:7168
v_mfma_f32_16x16x32_bf16 v[32:35],a[32:35],v[80:83],v[32:35]
buffer_load_dwordx4 v3,s[20:23],s61 offen offset:3072 lds
v_mfma_f32_16x16x32_bf16 v[36:39],a[36:39],v[80:83],v[36:39]
v_mfma_f32_16x16x32_bf16 v[48:51],v[12:15],v[80:83],v[48:51]
v_mfma_f32_16x16x32_bf16 v[52:55],v[80:83],v[80:83],v[52:55]
s_waitcnt lgkmcnt(2)
s_barrier
ds_read_b128 v[96:99],v5 offset:0
v_mfma_f32_16x16x32_bf16 v[32:35],a[40:43],v[84:87],v[32:35]
ds_read_b128 v[100:103],v5 offset:1024
v_mfma_f32_16x16x32_bf16 v[36:39],a[44:47],v[84:87],v[36:39]
ds_read_b128 v[104:107],v5 offset:2048
v_mfma_f32_16x16x32_bf16 v[48:51],v[12:15],v[84:87],v[48:51]
s_add_u32 m0,s70,4096
ds_read_b128 v[108:111],v5 offset:3072
v_mfma_f32_16x16x32_bf16 v[52:55],v[84:87],v[84:87],v[52:55]
s_waitcnt lgkmcnt(5)
buffer_load_dwordx4 v3,s[20:23],s62 offen offset:0 lds
v_mfma_f32_16x16x32_bf16 v[32:35],a[48:51],v[88:91],v[32:35]
ds_read_b128 v[112:115],v5 offset:4096
v_mfma_f32_16x16x32_bf16 v[36:39],a[52:55],v[88:91],v[36:39]
buffer_load_dwordx4 v3,s[20:23],s62 offen offset:1024 lds
v_mfma_f32_16x16x32_bf16 v[48:51],v[12:15],v[88:91],v[48:51]
v_mfma_f32_16x16x32_bf16 v[52:55],v[88:91],v[88:91],v[52:55]
s_waitcnt lgkmcnt(5)
v_mfma_f32_16x16x32_bf16 v[32:35],a[56:59],v[92:95],v[32:35]
ds_read_b128 v[116:119],v5 offset:5120
v_mfma_f32_16x16x32_bf16 v[36:39],a[60:63],v[92:95],v[36:39]
buffer_load_dwordx4 v3,s[20:23],s62 offen offset:2048 lds
v_mfma_f32_16x16x32_bf16 v[48:51],v[12:15],v[92:95],v[48:51]
buffer_load_dword v16,v2,s[20:23],s68 offen sc1
v_mfma_f32_16x16x32_bf16 v[52:55],v[92:95],v[92:95],v[52:55]
s_waitcnt lgkmcnt(5)
v_mfma_f32_16x16x32_bf16 v[32:35],a[64:67],v[96:99],v[32:35]
ds_read_b128 v[120:123],v5 offset:6144
v_mfma_f32_16x16x32_bf16 v[36:39],a[68:71],v[96:99],v[36:39]
s_waitcnt lgkmcnt(5)
buffer_load_dwordx4 v3,s[20:23],s62 offen offset:3072 lds
v_mfma_f32_16x16x32_bf16 v[32:35],a[72:75],v[100:103],v[32:35]
ds_read_b128 v[124:127],v5 offset:7168
v_mfma_f32_16x16x32_bf16 v[36:39],a[76:79],v[100:103],v[36:39]
s_waitcnt lgkmcnt(5)
v_mfma_f32_16x16x32_bf16 v[32:35],a[80:83],v[104:107],v[32:35]
ds_read_b128 v[64:67],v6 offset:0
v_cndmask_b32 v49,v52,v53,s[74:75]
v_mfma_f32_16x16x32_bf16 v[36:39],a[84:87],v[104:107],v[36:39]
s_waitcnt lgkmcnt(5)
v_cndmask_b32 v49,v49,v54,s[76:77]
v_cndmask_b32 v49,v49,v55,s[78:79]
v_mfma_f32_16x16x32_bf16 v[32:35],a[88:91],v[108:111],v[32:35]
ds_read_b128 v[68:71],v6 offset:1024
v_mfma_f32_16x16x32_bf16 v[36:39],a[92:95],v[108:111],v[36:39]
s_waitcnt lgkmcnt(5)
ds_write_b64 v19,v[48:49]
v_mfma_f32_16x16x32_bf16 v[32:35],a[96:99],v[112:115],v[32:35]
ds_read_b128 v[72:75],v6 offset:2048
v_mfma_f32_16x16x32_bf16 v[36:39],a[100:103],v[112:115],v[36:39]
s_waitcnt lgkmcnt(6)
v_mfma_f32_16x16x32_bf16 v[32:35],a[104:107],v[116:119],v[32:35]
ds_read_b128 v[76:79],v6 offset:3072
v_mfma_f32_16x16x32_bf16 v[36:39],a[108:111],v[116:119],v[36:39]
s_waitcnt lgkmcnt(6)
v_mfma_f32_16x16x32_bf16 v[32:35],a[112:115],v[120:123],v[32:35]
s_waitcnt lgkmcnt(2)
s_barrier
ds_read_b128 v[80:83],v6 offset:4096
v_mfma_f32_16x16x32_bf16 v[36:39],a[116:119],v[120:123],v[36:39]
ds_read_b64 v[56:57],v20 offset:0
v_mfma_f32_16x16x32_bf16 v[32:35],a[120:123],v[124:127],v[32:35]
ds_read_b128 v[84:87],v6 offset:5120
v_mfma_f32_16x16x32_bf16 v[36:39],a[124:127],v[124:127],v[36:39]
ds_read_b64 v[58:59],v20 offset:512
v_mfma_f32_16x16x32_bf16 v[32:35],a[128:131],v[64:67],v[32:35]
ds_read_b128 v[88:91],v6 offset:6144
v_mfma_f32_16x16x32_bf16 v[36:39],a[132:135],v[64:67],v[36:39]
ds_read_b64 v[60:61],v20 offset:1024
v_mfma_f32_16x16x32_bf16 v[32:35],a[136:139],v[68:71],v[32:35]
ds_read_b128 v[92:95],v6 offset:7168
v_mfma_f32_16x16x32_bf16 v[36:39],a[140:143],v[68:71],v[36:39]
s_waitcnt lgkmcnt(8)
ds_read_b64 v[62:63],v20 offset:1536
v_mfma_f32_16x16x32_bf16 v[32:35],a[144:147],v[72:75],v[32:35]
ds_read_b128 v[96:99],v7 offset:0
v_mfma_f32_16x16x32_bf16 v[36:39],a[148:151],v[72:75],v[36:39]
s_waitcnt lgkmcnt(9)
s_waitcnt vmcnt(10)
v_mov_b32 v17,s57
buffer_store_dword v17,v26,s[20:23],s69 offen
v_mfma_f32_16x16x32_bf16 v[32:35],a[152:155],v[76:79],v[32:35]
ds_read_b128 v[100:103],v7 offset:1024
v_mfma_f32_16x16x32_bf16 v[36:39],a[156:159],v[76:79],v[36:39]
s_waitcnt lgkmcnt(9)
v_mfma_f32_16x16x32_bf16 v[32:35],a[160:163],v[80:83],v[32:35]
ds_read_b128 v[104:107],v7 offset:2048
v_mfma_f32_16x16x32_bf16 v[36:39],a[164:167],v[80:83],v[36:39]
s_waitcnt lgkmcnt(8)
s_waitcnt lgkmcnt(3)
v_add_f32 v56,v56,v58
v_mfma_f32_16x16x32_bf16 v[32:35],a[168:171],v[84:87],v[32:35]
ds_read_b128 v[108:111],v7 offset:3072
v_add_f32 v57,v57,v59
v_mfma_f32_16x16x32_bf16 v[36:39],a[172:175],v[84:87],v[36:39]
v_add_f32 v60,v60,v62
v_add_f32 v61,v61,v63
v_mfma_f32_16x16x32_bf16 v[32:35],a[176:179],v[88:91],v[32:35]
ds_read_b128 v[112:115],v7 offset:4096
v_add_f32 v56,v56,v60
v_mfma_f32_16x16x32_bf16 v[36:39],a[180:183],v[88:91],v[36:39]
v_add_f32 v57,v57,v61
v_mul_f32 v188,0xba800000,v56
v_mfma_f32_16x16x32_bf16 v[32:35],a[184:187],v[92:95],v[32:35]
ds_read_b128 v[116:119],v7 offset:5120
v_fma_f32 v58,v188,v188,-v210
v_mfma_f32_16x16x32_bf16 v[36:39],a[188:191],v[92:95],v[36:39]
s_waitcnt lgkmcnt(5)
v_fma_f32 v57,v57,v211,-v58
v_max_f32 v57,v210,v57
v_mfma_f32_16x16x32_bf16 v[32:35],a[192:195],v[96:99],v[32:35]
ds_read_b128 v[120:123],v7 offset:6144
v_mfma_f32_16x16x32_bf16 v[36:39],a[196:199],v[96:99],v[36:39]
s_waitcnt lgkmcnt(5)
v_rsq_f32 v58,v57
v_mfma_f32_16x16x32_bf16 v[32:35],a[200:203],v[100:103],v[32:35]
ds_read_b128 v[124:127],v7 offset:7168
v_mul_f32 v189,v57,v58
v_mfma_f32_16x16x32_bf16 v[36:39],a[204:207],v[100:103],v[36:39]
s_waitcnt lgkmcnt(5)
v_mul_f32 v190,v209,v58
v_mul_f32 v59,v58,v58
v_mfma_f32_16x16x32_bf16 v[32:35],a[208:211],v[104:107],v[32:35]
s_add_u32 s61,s61,32768
v_mul_f32 v191,v208,v58
v_mul_f32 v191,v191,v59
v_mfma_f32_16x16x32_bf16 v[36:39],a[212:215],v[104:107],v[36:39]
s_waitcnt lgkmcnt(4)
s_add_u32 s62,s62,32768
s_add_u32 s70,s70,32768
v_mfma_f32_16x16x32_bf16 v[32:35],a[216:219],v[108:111],v[32:35]
s_and_b32 s70,s70,0x1ffff
s_add_u32 s55,s55,32768
s_and_b32 s55,s55,0x1ffff
v_mfma_f32_16x16x32_bf16 v[36:39],a[220:223],v[108:111],v[36:39]
s_waitcnt lgkmcnt(3)
v_add_u32 v4,s55,v8
v_add_u32 v5,s55,v9
v_mfma_f32_16x16x32_bf16 v[32:35],a[224:227],v[112:115],v[32:35]
v_add_u32 v6,s55,v10
v_add_u32 v7,s55,v11
v_mfma_f32_16x16x32_bf16 v[36:39],a[228:231],v[112:115],v[36:39]
s_waitcnt lgkmcnt(2)
s_waitcnt vmcnt(9)
ds_read_b128 v[64:67],v4 offset:0
v_mfma_f32_16x16x32_bf16 v[32:35],a[232:235],v[116:119],v[32:35]
s_waitcnt vmcnt(8)
ds_read_b128 v[68:71],v4 offset:1024
v_mfma_f32_16x16x32_bf16 v[36:39],a[236:239],v[116:119],v[36:39]
s_waitcnt lgkmcnt(3)
s_waitcnt vmcnt(7)
ds_read_b128 v[72:75],v4 offset:2048
v_mfma_f32_16x16x32_bf16 v[32:35],a[240:243],v[120:123],v[32:35]
v_mfma_f32_16x16x32_bf16 v[36:39],a[244:247],v[120:123],v[36:39]
s_waitcnt lgkmcnt(3)
v_mfma_f32_16x16x32_bf16 v[40:43],a[248:251],v[124:127],v[32:35]
v_mfma_f32_16x16x32_bf16 v[44:47],a[252:255],v[124:127],v[36:39]
s_waitcnt vmcnt(2)
v_cmp_gt_u32 vcc,s53,v16
s_add_u32 s60,s60,1
s_cbranch_vccnz WN_304
.p2align 6
WR_303:
s_waitcnt lgkmcnt(2)
v_mfma_f32_16x16x32_bf16 v[32:35],a[0:3],v[64:67],0
s_waitcnt vmcnt(6)
s_add_u32 s71,s60,2
ds_read_b128 v[76:79],v4 offset:3072
v_mfma_f32_16x16x32_bf16 v[36:39],a[4:7],v[64:67],0
s_add_u32 s53,s60,3
s_mov_b32 s57,s63
v_mfma_f32_16x16x32_bf16 v[48:51],v[12:15],v[64:67],0
s_mov_b32 m0,s70
v_fma_f32 v40,v152,v188,v40
v_fma_f32 v41,v153,v188,v41
v_mul_f32 v168,v40,v40
v_mfma_f32_16x16x32_bf16 v[52:55],v[64:67],v[64:67],0
s_waitcnt lgkmcnt(2)
buffer_load_dwordx4 v3,s[20:23],s61 offen offset:0 lds
v_mul_f32 v169,v41,v41
v_fma_f32 v168,v168,v191,v190
v_mfma_f32_16x16x32_bf16 v[32:35],a[8:11],v[68:71],v[32:35]
s_waitcnt vmcnt(6)
ds_read_b128 v[80:83],v4 offset:4096
v_fma_f32 v169,v169,v191,v190
v_mul_f32 v168,v168,v40
v_mfma_f32_16x16x32_bf16 v[36:39],a[12:15],v[68:71],v[36:39]
v_exp_f32 v168,v168
v_mul_f32 v169,v169,v41
v_mfma_f32_16x16x32_bf16 v[48:51],v[12:15],v[68:71],v[48:51]
v_exp_f32 v169,v169
v_fma_f32 v168,v168,v189,v189
v_mfma_f32_16x16x32_bf16 v[52:55],v[68:71],v[68:71],v[52:55]
s_waitcnt lgkmcnt(2)
buffer_load_dwordx4 v3,s[20:23],s61 offen offset:1024 lds
v_rcp_f32 v168,v168
v_mfma_f32_16x16x32_bf16 v[32:35],a[16:19],v[72:75],v[32:35]
s_waitcnt vmcnt(6)
ds_read_b128 v[84:87],v4 offset:5120
v_fma_f32 v169,v169,v189,v189
v_mul_f32 v40,v168,v40
v_mfma_f32_16x16x32_bf16 v[36:39],a[20:23],v[72:75],v[36:39]
v_rcp_f32 v169,v169
v_fma_f32 v42,v154,v188,v42
v_mfma_f32_16x16x32_bf16 v[48:51],v[12:15],v[72:75],v[48:51]
v_mul_f32 v41,v169,v41
v_fma_f32 v43,v155,v188,v43
v_mul_f32 v170,v42,v42
v_mfma_f32_16x16x32_bf16 v[52:55],v[72:75],v[72:75],v[52:55]
s_waitcnt lgkmcnt(2)
buffer_load_dwordx4 v3,s[20:23],s61 offen offset:2048 lds
v_mul_f32 v171,v43,v43
v_fma_f32 v170,v170,v191,v190
v_mfma_f32_16x16x32_bf16 v[32:35],a[24:27],v[76:79],v[32:35]
s_waitcnt vmcnt(6)
ds_read_b128 v[88:91],v4 offset:6144
v_fma_f32 v171,v171,v191,v190
v_mfma_f32_16x16x32_bf16 v[36:39],a[28:31],v[76:79],v[36:39]
v_mul_f32 v170,v170,v42
v_mul_f32 v171,v171,v43
v_mfma_f32_16x16x32_bf16 v[48:51],v[12:15],v[76:79],v[48:51]
v_exp_f32 v170,v170
v_mfma_f32_16x16x32_bf16 v[52:55],v[76:79],v[76:79],v[52:55]
s_waitcnt lgkmcnt(2)
buffer_load_dwordx4 v3,s[20:23],s61 offen offset:3072 lds
v_fma_f32 v170,v170,v189,v189
v_mfma_f32_16x16x32_bf16 v[32:35],a[32:35],v[80:83],v[32:35]
s_waitcnt vmcnt(5)
ds_read_b128 v[92:95],v4 offset:7168
v_fma_f32 v44,v156,v188,v44
v_mfma_f32_16x16x32_bf16 v[36:39],a[36:39],v[80:83],v[36:39]
s_barrier
ds_read_b128 v[96:99],v5 offset:0
v_fma_f32 v45,v157,v188,v45
v_mfma_f32_16x16x32_bf16 v[48:51],v[12:15],v[80:83],v[48:51]
ds_read_b128 v[100:103],v5 offset:1024
v_mul_f32 v172,v44,v44
v_mfma_f32_16x16x32_bf16 v[52:55],v[80:83],v[80:83],v[52:55]
s_waitcnt lgkmcnt(4)
ds_read_b128 v[104:107],v5 offset:2048
v_mul_f32 v173,v45,v45
v_mfma_f32_16x16x32_bf16 v[32:35],a[40:43],v[84:87],v[32:35]
s_add_u32 m0,s70,4096
ds_read_b128 v[108:111],v5 offset:3072
v_fma_f32 v172,v172,v191,v190
v_mfma_f32_16x16x32_bf16 v[36:39],a[44:47],v[84:87],v[36:39]
buffer_load_dwordx4 v3,s[20:23],s62 offen offset:0 lds
v_fma_f32 v173,v173,v191,v190
v_mfma_f32_16x16x32_bf16 v[48:51],v[12:15],v[84:87],v[48:51]
s_waitcnt vmcnt(5)
v_mov_b32 v17,s57
buffer_store_dword v17,v26,s[20:23],s69 offen
v_mfma_f32_16x16x32_bf16 v[52:55],v[84:87],v[84:87],v[52:55]
s_waitcnt lgkmcnt(5)
v_exp_f32 v171,v171
v_mfma_f32_16x16x32_bf16 v[32:35],a[48:51],v[88:91],v[32:35]
ds_read_b128 v[112:115],v5 offset:4096
v_fma_f32 v171,v171,v189,v189
v_mfma_f32_16x16x32_bf16 v[36:39],a[52:55],v[88:91],v[36:39]
buffer_load_dwordx4 v3,s[20:23],s62 offen offset:1024 lds
v_mul_f32 v172,v172,v44
v_mfma_f32_16x16x32_bf16 v[48:51],v[12:15],v[88:91],v[48:51]
v_rcp_f32 v170,v170
v_mfma_f32_16x16x32_bf16 v[52:55],v[88:91],v[88:91],v[52:55]
s_waitcnt lgkmcnt(5)
v_rcp_f32 v171,v171
v_mfma_f32_16x16x32_bf16 v[32:35],a[56:59],v[92:95],v[32:35]
ds_read_b128 v[116:119],v5 offset:5120
v_mul_f32 v42,v170,v42
v_mfma_f32_16x16x32_bf16 v[36:39],a[60:63],v[92:95],v[36:39]
buffer_load_dwordx4 v3,s[20:23],s62 offen offset:2048 lds
v_mul_f32 v43,v171,v43
v_mfma_f32_16x16x32_bf16 v[48:51],v[12:15],v[92:95],v[48:51]
buffer_load_dword v16,v2,s[20:23],s68 offen sc1
v_mul_f32 v173,v173,v45
v_mfma_f32_16x16x32_bf16 v[52:55],v[92:95],v[92:95],v[52:55]
s_waitcnt lgkmcnt(5)
v_exp_f32 v172,v172
v_mfma_f32_16x16x32_bf16 v[32:35],a[64:67],v[96:99],v[32:35]
ds_read_b128 v[120:123],v5 offset:6144
v_fma_f32 v172,v172,v189,v189
v_mfma_f32_16x16x32_bf16 v[36:39],a[68:71],v[96:99],v[36:39]
s_waitcnt lgkmcnt(5)
buffer_load_dwordx4 v3,s[20:23],s62 offen offset:3072 lds
v_fma_f32 v46,v158,v188,v46
v_mfma_f32_16x16x32_bf16 v[32:35],a[72:75],v[100:103],v[32:35]
ds_read_b128 v[124:127],v5 offset:7168
v_fma_f32 v47,v159,v188,v47
v_mfma_f32_16x16x32_bf16 v[36:39],a[76:79],v[100:103],v[36:39]
s_waitcnt lgkmcnt(5)
v_exp_f32 v173,v173
v_mfma_f32_16x16x32_bf16 v[32:35],a[80:83],v[104:107],v[32:35]
ds_read_b128 v[64:67],v6 offset:0
v_cndmask_b32 v49,v52,v53,s[74:75]
v_mfma_f32_16x16x32_bf16 v[36:39],a[84:87],v[104:107],v[36:39]
s_waitcnt lgkmcnt(5)
v_cndmask_b32 v49,v49,v54,s[76:77]
v_cndmask_b32 v49,v49,v55,s[78:79]
v_mfma_f32_16x16x32_bf16 v[32:35],a[88:91],v[108:111],v[32:35]
ds_read_b128 v[68:71],v6 offset:1024
v_fma_f32 v173,v173,v189,v189
v_mfma_f32_16x16x32_bf16 v[36:39],a[92:95],v[108:111],v[36:39]
s_waitcnt lgkmcnt(5)
ds_write_b64 v19,v[48:49]
v_mfma_f32_16x16x32_bf16 v[32:35],a[96:99],v[112:115],v[32:35]
ds_read_b128 v[72:75],v6 offset:2048
v_mul_f32 v174,v46,v46
v_mfma_f32_16x16x32_bf16 v[36:39],a[100:103],v[112:115],v[36:39]
s_waitcnt lgkmcnt(6)
v_rcp_f32 v172,v172
v_mfma_f32_16x16x32_bf16 v[32:35],a[104:107],v[116:119],v[32:35]
ds_read_b128 v[76:79],v6 offset:3072
v_mul_f32 v44,v172,v44
v_mfma_f32_16x16x32_bf16 v[36:39],a[108:111],v[116:119],v[36:39]
s_waitcnt lgkmcnt(6)
v_rcp_f32 v173,v173
v_mfma_f32_16x16x32_bf16 v[32:35],a[112:115],v[120:123],v[32:35]
s_waitcnt lgkmcnt(2)
s_barrier
ds_read_b128 v[80:83],v6 offset:4096
v_mfma_f32_16x16x32_bf16 v[36:39],a[116:119],v[120:123],v[36:39]
ds_read_b64 v[56:57],v20 offset:0
v_mul_f32 v45,v173,v45
v_mfma_f32_16x16x32_bf16 v[32:35],a[120:123],v[124:127],v[32:35]
ds_read_b128 v[84:87],v6 offset:5120
v_mul_f32 v175,v47,v47
v_mfma_f32_16x16x32_bf16 v[36:39],a[124:127],v[124:127],v[36:39]
ds_read_b64 v[58:59],v20 offset:512
v_fma_f32 v174,v174,v191,v190
v_mfma_f32_16x16x32_bf16 v[32:35],a[128:131],v[64:67],v[32:35]
ds_read_b128 v[88:91],v6 offset:6144
v_fma_f32 v175,v175,v191,v190
v_mfma_f32_16x16x32_bf16 v[36:39],a[132:135],v[64:67],v[36:39]
ds_read_b64 v[60:61],v20 offset:1024
v_mul_f32 v174,v174,v46
v_mfma_f32_16x16x32_bf16 v[32:35],a[136:139],v[68:71],v[32:35]
ds_read_b128 v[92:95],v6 offset:7168
v_mul_f32 v175,v175,v47
v_mfma_f32_16x16x32_bf16 v[36:39],a[140:143],v[68:71],v[36:39]
s_waitcnt lgkmcnt(8)
ds_read_b64 v[62:63],v20 offset:1536
v_cvt_pk_bf16_f32 v176,v40,v41
v_mfma_f32_16x16x32_bf16 v[32:35],a[144:147],v[72:75],v[32:35]
ds_read_b128 v[96:99],v7 offset:0
v_cvt_pk_bf16_f32 v177,v42,v43
v_mfma_f32_16x16x32_bf16 v[36:39],a[148:151],v[72:75],v[36:39]
s_waitcnt lgkmcnt(9)
v_exp_f32 v174,v174
v_mfma_f32_16x16x32_bf16 v[32:35],a[152:155],v[76:79],v[32:35]
ds_read_b128 v[100:103],v7 offset:1024
v_fma_f32 v174,v174,v189,v189
v_mfma_f32_16x16x32_bf16 v[36:39],a[156:159],v[76:79],v[36:39]
s_waitcnt lgkmcnt(9)
v_exp_f32 v175,v175
v_mfma_f32_16x16x32_bf16 v[32:35],a[160:163],v[80:83],v[32:35]
ds_read_b128 v[104:107],v7 offset:2048
v_fma_f32 v175,v175,v189,v189
v_mfma_f32_16x16x32_bf16 v[36:39],a[164:167],v[80:83],v[36:39]
s_waitcnt lgkmcnt(8)
s_waitcnt lgkmcnt(3)
v_rcp_f32 v174,v174
v_mfma_f32_16x16x32_bf16 v[32:35],a[168:171],v[84:87],v[32:35]
ds_read_b128 v[108:111],v7 offset:3072
v_mul_f32 v46,v174,v46
v_mfma_f32_16x16x32_bf16 v[36:39],a[172:175],v[84:87],v[36:39]
v_rcp_f32 v175,v175
v_mfma_f32_16x16x32_bf16 v[32:35],a[176:179],v[88:91],v[32:35]
ds_read_b128 v[112:115],v7 offset:4096
v_mul_f32 v47,v175,v47
v_mfma_f32_16x16x32_bf16 v[36:39],a[180:183],v[88:91],v[36:39]
v_cvt_pk_bf16_f32 v178,v44,v45
v_cvt_pk_bf16_f32 v179,v46,v47
v_mfma_f32_16x16x32_bf16 v[32:35],a[184:187],v[92:95],v[32:35]
ds_read_b128 v[116:119],v7 offset:5120
v_add_f32 v56,v56,v58
v_mfma_f32_16x16x32_bf16 v[36:39],a[188:191],v[92:95],v[36:39]
s_waitcnt lgkmcnt(5)
buffer_store_dwordx4 v[176:179],v0,s[20:23],s66 offen sc1
v_mfma_f32_16x16x32_bf16 v[32:35],a[192:195],v[96:99],v[32:35]
s_add_u32 s66,s66,32768
s_add_u32 s63,s63,1
ds_read_b128 v[120:123],v7 offset:6144
v_mfma_f32_16x16x32_bf16 v[36:39],a[196:199],v[96:99],v[36:39]
s_waitcnt lgkmcnt(5)
v_add_f32 v57,v57,v59
v_add_f32 v60,v60,v62
v_mfma_f32_16x16x32_bf16 v[32:35],a[200:203],v[100:103],v[32:35]
ds_read_b128 v[124:127],v7 offset:7168
v_add_f32 v61,v61,v63
v_mfma_f32_16x16x32_bf16 v[36:39],a[204:207],v[100:103],v[36:39]
s_waitcnt lgkmcnt(5)
v_add_f32 v56,v56,v60
v_add_f32 v57,v57,v61
v_mfma_f32_16x16x32_bf16 v[32:35],a[208:211],v[104:107],v[32:35]
s_add_u32 s61,s61,32768
v_mul_f32 v188,0xba800000,v56
v_fma_f32 v58,v188,v188,-v210
v_mfma_f32_16x16x32_bf16 v[36:39],a[212:215],v[104:107],v[36:39]
s_waitcnt lgkmcnt(4)
v_fma_f32 v57,v57,v211,-v58
v_max_f32 v57,v210,v57
v_mfma_f32_16x16x32_bf16 v[32:35],a[216:219],v[108:111],v[32:35]
s_add_u32 s62,s62,32768
v_rsq_f32 v58,v57
v_mfma_f32_16x16x32_bf16 v[36:39],a[220:223],v[108:111],v[36:39]
s_waitcnt lgkmcnt(3)
v_mul_f32 v189,v57,v58
v_mul_f32 v190,v209,v58
v_mfma_f32_16x16x32_bf16 v[32:35],a[224:227],v[112:115],v[32:35]
s_add_u32 s70,s70,32768
v_mul_f32 v59,v58,v58
v_mul_f32 v191,v208,v58
v_mfma_f32_16x16x32_bf16 v[36:39],a[228:231],v[112:115],v[36:39]
s_waitcnt lgkmcnt(2)
s_and_b32 s70,s70,0x1ffff
v_mul_f32 v191,v191,v59
v_mfma_f32_16x16x32_bf16 v[32:35],a[232:235],v[116:119],v[32:35]
s_add_u32 s55,s55,32768
s_and_b32 s55,s55,0x1ffff
v_add_u32 v4,s55,v8
v_mfma_f32_16x16x32_bf16 v[36:39],a[236:239],v[116:119],v[36:39]
s_waitcnt lgkmcnt(1)
v_add_u32 v5,s55,v9
v_add_u32 v6,s55,v10
v_mfma_f32_16x16x32_bf16 v[32:35],a[240:243],v[120:123],v[32:35]
v_add_u32 v7,s55,v11
v_mfma_f32_16x16x32_bf16 v[36:39],a[244:247],v[120:123],v[36:39]
s_waitcnt lgkmcnt(0)
s_waitcnt vmcnt(10)
ds_read_b128 v[64:67],v4 offset:0
v_mfma_f32_16x16x32_bf16 v[40:43],a[248:251],v[124:127],v[32:35]
s_waitcnt vmcnt(9)
ds_read_b128 v[68:71],v4 offset:1024
v_mfma_f32_16x16x32_bf16 v[44:47],a[252:255],v[124:127],v[36:39]
s_waitcnt vmcnt(2)
v_cmp_gt_u32 vcc,s53,v16
ds_read_b128 v[72:75],v4 offset:2048
s_add_u32 s60,s60,1
s_cbranch_vccz WR_303
WN_304:
s_waitcnt lgkmcnt(2)
v_mfma_f32_16x16x32_bf16 v[32:35],a[0:3],v[64:67],0
s_waitcnt vmcnt(6)
s_add_u32 s71,s60,2
ds_read_b128 v[76:79],v4 offset:3072
v_mfma_f32_16x16x32_bf16 v[36:39],a[4:7],v[64:67],0
s_add_u32 s53,s60,3
s_mov_b32 s57,s63
v_mfma_f32_16x16x32_bf16 v[48:51],v[12:15],v[64:67],0
v_fma_f32 v40,v152,v188,v40
v_fma_f32 v41,v153,v188,v41
v_mul_f32 v168,v40,v40
v_mfma_f32_16x16x32_bf16 v[52:55],v[64:67],v[64:67],0
s_waitcnt lgkmcnt(2)
v_mul_f32 v169,v41,v41
v_fma_f32 v168,v168,v191,v190
v_fma_f32 v169,v169,v191,v190
v_mfma_f32_16x16x32_bf16 v[32:35],a[8:11],v[68:71],v[32:35]
s_waitcnt vmcnt(5)
ds_read_b128 v[80:83],v4 offset:4096
v_mul_f32 v168,v168,v40
v_mul_f32 v169,v169,v41
v_mfma_f32_16x16x32_bf16 v[36:39],a[12:15],v[68:71],v[36:39]
v_exp_f32 v168,v168
v_fma_f32 v42,v154,v188,v42
v_mfma_f32_16x16x32_bf16 v[48:51],v[12:15],v[68:71],v[48:51]
v_exp_f32 v169,v169
v_fma_f32 v168,v168,v189,v189
v_mfma_f32_16x16x32_bf16 v[52:55],v[68:71],v[68:71],v[52:55]
s_waitcnt lgkmcnt(2)
v_rcp_f32 v168,v168
v_fma_f32 v169,v169,v189,v189
v_mfma_f32_16x16x32_bf16 v[32:35],a[16:19],v[72:75],v[32:35]
s_waitcnt vmcnt(4)
ds_read_b128 v[84:87],v4 offset:5120
v_rcp_f32 v169,v169
v_mfma_f32_16x16x32_bf16 v[36:39],a[20:23],v[72:75],v[36:39]
v_mul_f32 v40,v168,v40
v_mul_f32 v41,v169,v41
v_fma_f32 v43,v155,v188,v43
v_mfma_f32_16x16x32_bf16 v[48:51],v[12:15],v[72:75],v[48:51]
v_mul_f32 v170,v42,v42
v_mul_f32 v171,v43,v43
v_mfma_f32_16x16x32_bf16 v[52:55],v[72:75],v[72:75],v[52:55]
s_waitcnt lgkmcnt(2)
v_fma_f32 v170,v170,v191,v190
v_fma_f32 v171,v171,v191,v190
v_mfma_f32_16x16x32_bf16 v[32:35],a[24:27],v[76:79],v[32:35]
s_waitcnt vmcnt(3)
ds_read_b128 v[88:91],v4 offset:6144
v_mul_f32 v170,v170,v42
v_mfma_f32_16x16x32_bf16 v[36:39],a[28:31],v[76:79],v[36:39]
v_exp_f32 v170,v170
v_mfma_f32_16x16x32_bf16 v[48:51],v[12:15],v[76:79],v[48:51]
v_mul_f32 v171,v171,v43
v_fma_f32 v170,v170,v189,v189
v_mfma_f32_16x16x32_bf16 v[52:55],v[76:79],v[76:79],v[52:55]
s_waitcnt lgkmcnt(2)
v_exp_f32 v171,v171
v_mfma_f32_16x16x32_bf16 v[32:35],a[32:35],v[80:83],v[32:35]
s_waitcnt vmcnt(1)
ds_read_b128 v[92:95],v4 offset:7168
v_fma_f32 v171,v171,v189,v189
v_mfma_f32_16x16x32_bf16 v[36:39],a[36:39],v[80:83],v[36:39]
s_barrier
ds_read_b128 v[96:99],v5 offset:0
v_fma_f32 v44,v156,v188,v44
v_mfma_f32_16x16x32_bf16 v[48:51],v[12:15],v[80:83],v[48:51]
ds_read_b128 v[100:103],v5 offset:1024
v_fma_f32 v45,v157,v188,v45
v_mfma_f32_16x16x32_bf16 v[52:55],v[80:83],v[80:83],v[52:55]
s_waitcnt lgkmcnt(4)
ds_read_b128 v[104:107],v5 offset:2048
v_mul_f32 v172,v44,v44
v_mfma_f32_16x16x32_bf16 v[32:35],a[40:43],v[84:87],v[32:35]
ds_read_b128 v[108:111],v5 offset:3072
v_mul_f32 v173,v45,v45
v_mfma_f32_16x16x32_bf16 v[36:39],a[44:47],v[84:87],v[36:39]
s_waitcnt vmcnt(0)
v_mov_b32 v17,s57
buffer_store_dword v17,v26,s[20:23],s69 offen
v_mfma_f32_16x16x32_bf16 v[48:51],v[12:15],v[84:87],v[48:51]
v_rcp_f32 v170,v170
v_mfma_f32_16x16x32_bf16 v[52:55],v[84:87],v[84:87],v[52:55]
s_waitcnt lgkmcnt(5)
v_rcp_f32 v171,v171
v_mfma_f32_16x16x32_bf16 v[32:35],a[48:51],v[88:91],v[32:35]
ds_read_b128 v[112:115],v5 offset:4096
v_mul_f32 v42,v170,v42
v_mfma_f32_16x16x32_bf16 v[36:39],a[52:55],v[88:91],v[36:39]
v_mul_f32 v43,v171,v43
v_fma_f32 v172,v172,v191,v190
v_mfma_f32_16x16x32_bf16 v[48:51],v[12:15],v[88:91],v[48:51]
v_fma_f32 v173,v173,v191,v190
v_mul_f32 v172,v172,v44
v_mfma_f32_16x16x32_bf16 v[52:55],v[88:91],v[88:91],v[52:55]
s_waitcnt lgkmcnt(5)
v_exp_f32 v172,v172
v_mfma_f32_16x16x32_bf16 v[32:35],a[56:59],v[92:95],v[32:35]
ds_read_b128 v[116:119],v5 offset:5120
v_mul_f32 v173,v173,v45
v_mfma_f32_16x16x32_bf16 v[36:39],a[60:63],v[92:95],v[36:39]
v_exp_f32 v173,v173
v_mfma_f32_16x16x32_bf16 v[48:51],v[12:15],v[92:95],v[48:51]
v_fma_f32 v172,v172,v189,v189
v_fma_f32 v173,v173,v189,v189
v_mfma_f32_16x16x32_bf16 v[52:55],v[92:95],v[92:95],v[52:55]
s_waitcnt lgkmcnt(5)
v_rcp_f32 v172,v172
v_mfma_f32_16x16x32_bf16 v[32:35],a[64:67],v[96:99],v[32:35]
ds_read_b128 v[120:123],v5 offset:6144
v_mul_f32 v44,v172,v44
v_mfma_f32_16x16x32_bf16 v[36:39],a[68:71],v[96:99],v[36:39]
s_waitcnt lgkmcnt(5)
v_rcp_f32 v173,v173
v_mfma_f32_16x16x32_bf16 v[32:35],a[72:75],v[100:103],v[32:35]
ds_read_b128 v[124:127],v5 offset:7168
v_mul_f32 v45,v173,v45
v_mfma_f32_16x16x32_bf16 v[36:39],a[76:79],v[100:103],v[36:39]
s_waitcnt lgkmcnt(5)
v_fma_f32 v46,v158,v188,v46
v_fma_f32 v47,v159,v188,v47
v_mfma_f32_16x16x32_bf16 v[32:35],a[80:83],v[104:107],v[32:35]
ds_read_b128 v[64:67],v6 offset:0
v_cndmask_b32 v49,v52,v53,s[74:75]
v_mfma_f32_16x16x32_bf16 v[36:39],a[84:87],v[104:107],v[36:39]
s_waitcnt lgkmcnt(5)
v_cndmask_b32 v49,v49,v54,s[76:77]
v_cndmask_b32 v49,v49,v55,s[78:79]
v_mfma_f32_16x16x32_bf16 v[32:35],a[88:91],v[108:111],v[32:35]
ds_read_b128 v[68:71],v6 offset:1024
v_mul_f32 v174,v46,v46
v_mfma_f32_16x16x32_bf16 v[36:39],a[92:95],v[108:111],v[36:39]
s_waitcnt lgkmcnt(5)
ds_write_b64 v19,v[48:49]
v_mfma_f32_16x16x32_bf16 v[32:35],a[96:99],v[112:115],v[32:35]
ds_read_b128 v[72:75],v6 offset:2048
v_mul_f32 v175,v47,v47
v_mfma_f32_16x16x32_bf16 v[36:39],a[100:103],v[112:115],v[36:39]
s_waitcnt lgkmcnt(6)
v_fma_f32 v174,v174,v191,v190
v_fma_f32 v175,v175,v191,v190
v_mfma_f32_16x16x32_bf16 v[32:35],a[104:107],v[116:119],v[32:35]
ds_read_b128 v[76:79],v6 offset:3072
v_mul_f32 v174,v174,v46
v_mfma_f32_16x16x32_bf16 v[36:39],a[108:111],v[116:119],v[36:39]
s_waitcnt lgkmcnt(6)
v_exp_f32 v174,v174
v_mfma_f32_16x16x32_bf16 v[32:35],a[112:115],v[120:123],v[32:35]
s_waitcnt lgkmcnt(2)
s_barrier
ds_read_b128 v[80:83],v6 offset:4096
v_mfma_f32_16x16x32_bf16 v[36:39],a[116:119],v[120:123],v[36:39]
ds_read_b64 v[56:57],v20 offset:0
v_mul_f32 v175,v175,v47
v_mfma_f32_16x16x32_bf16 v[32:35],a[120:123],v[124:127],v[32:35]
ds_read_b128 v[84:87],v6 offset:5120
v_fma_f32 v174,v174,v189,v189
v_mfma_f32_16x16x32_bf16 v[36:39],a[124:127],v[124:127],v[36:39]
ds_read_b64 v[58:59],v20 offset:512
v_cvt_pk_bf16_f32 v176,v40,v41
v_mfma_f32_16x16x32_bf16 v[32:35],a[128:131],v[64:67],v[32:35]
ds_read_b128 v[88:91],v6 offset:6144
v_cvt_pk_bf16_f32 v177,v42,v43
v_mfma_f32_16x16x32_bf16 v[36:39],a[132:135],v[64:67],v[36:39]
ds_read_b64 v[60:61],v20 offset:1024
v_cvt_pk_bf16_f32 v178,v44,v45
v_mfma_f32_16x16x32_bf16 v[32:35],a[136:139],v[68:71],v[32:35]
ds_read_b128 v[92:95],v6 offset:7168
v_mfma_f32_16x16x32_bf16 v[36:39],a[140:143],v[68:71],v[36:39]
s_waitcnt lgkmcnt(8)
ds_read_b64 v[62:63],v20 offset:1536
v_mfma_f32_16x16x32_bf16 v[32:35],a[144:147],v[72:75],v[32:35]
ds_read_b128 v[96:99],v7 offset:0
v_mfma_f32_16x16x32_bf16 v[36:39],a[148:151],v[72:75],v[36:39]
s_waitcnt lgkmcnt(9)
buffer_load_dword v16,v2,s[20:23],s68 offen sc1
v_mfma_f32_16x16x32_bf16 v[32:35],a[152:155],v[76:79],v[32:35]
ds_read_b128 v[100:103],v7 offset:1024
v_mfma_f32_16x16x32_bf16 v[36:39],a[156:159],v[76:79],v[36:39]
s_waitcnt lgkmcnt(9)
v_exp_f32 v175,v175
v_mfma_f32_16x16x32_bf16 v[32:35],a[160:163],v[80:83],v[32:35]
ds_read_b128 v[104:107],v7 offset:2048
v_fma_f32 v175,v175,v189,v189
v_mfma_f32_16x16x32_bf16 v[36:39],a[164:167],v[80:83],v[36:39]
s_waitcnt lgkmcnt(8)
s_waitcnt lgkmcnt(3)
v_rcp_f32 v174,v174
v_mfma_f32_16x16x32_bf16 v[32:35],a[168:171],v[84:87],v[32:35]
ds_read_b128 v[108:111],v7 offset:3072
v_mul_f32 v46,v174,v46
v_mfma_f32_16x16x32_bf16 v[36:39],a[172:175],v[84:87],v[36:39]
v_rcp_f32 v175,v175
v_mfma_f32_16x16x32_bf16 v[32:35],a[176:179],v[88:91],v[32:35]
ds_read_b128 v[112:115],v7 offset:4096
v_mul_f32 v47,v175,v47
v_mfma_f32_16x16x32_bf16 v[36:39],a[180:183],v[88:91],v[36:39]
v_cvt_pk_bf16_f32 v179,v46,v47
v_add_f32 v56,v56,v58
v_mfma_f32_16x16x32_bf16 v[32:35],a[184:187],v[92:95],v[32:35]
ds_read_b128 v[116:119],v7 offset:5120
v_add_f32 v57,v57,v59
v_mfma_f32_16x16x32_bf16 v[36:39],a[188:191],v[92:95],v[36:39]
s_waitcnt lgkmcnt(5)
buffer_store_dwordx4 v[176:179],v0,s[20:23],s66 offen sc1
v_mfma_f32_16x16x32_bf16 v[32:35],a[192:195],v[96:99],v[32:35]
s_add_u32 s66,s66,32768
s_add_u32 s63,s63,1
ds_read_b128 v[120:123],v7 offset:6144
v_mfma_f32_16x16x32_bf16 v[36:39],a[196:199],v[96:99],v[36:39]
s_waitcnt lgkmcnt(5)
v_add_f32 v60,v60,v62
v_add_f32 v61,v61,v63
v_mfma_f32_16x16x32_bf16 v[32:35],a[200:203],v[100:103],v[32:35]
ds_read_b128 v[124:127],v7 offset:7168
v_add_f32 v56,v56,v60
v_mfma_f32_16x16x32_bf16 v[36:39],a[204:207],v[100:103],v[36:39]
s_waitcnt lgkmcnt(5)
v_add_f32 v57,v57,v61
v_mul_f32 v188,0xba800000,v56
v_mfma_f32_16x16x32_bf16 v[32:35],a[208:211],v[104:107],v[32:35]
s_add_u32 s55,s55,32768
v_fma_f32 v58,v188,v188,-v210
v_fma_f32 v57,v57,v211,-v58
v_mfma_f32_16x16x32_bf16 v[36:39],a[212:215],v[104:107],v[36:39]
s_waitcnt lgkmcnt(4)
s_and_b32 s55,s55,0x1ffff
v_max_f32 v57,v210,v57
v_mfma_f32_16x16x32_bf16 v[32:35],a[216:219],v[108:111],v[32:35]
v_rsq_f32 v58,v57
v_mfma_f32_16x16x32_bf16 v[36:39],a[220:223],v[108:111],v[36:39]
s_waitcnt lgkmcnt(3)
v_mul_f32 v189,v57,v58
v_mul_f32 v190,v209,v58
v_mfma_f32_16x16x32_bf16 v[32:35],a[224:227],v[112:115],v[32:35]
v_mul_f32 v59,v58,v58
v_mul_f32 v191,v208,v58
v_mfma_f32_16x16x32_bf16 v[36:39],a[228:231],v[112:115],v[36:39]
s_waitcnt lgkmcnt(2)
v_mul_f32 v191,v191,v59
v_add_u32 v4,s55,v8
v_mfma_f32_16x16x32_bf16 v[32:35],a[232:235],v[116:119],v[32:35]
v_add_u32 v5,s55,v9
v_add_u32 v6,s55,v10
v_mfma_f32_16x16x32_bf16 v[36:39],a[236:239],v[116:119],v[36:39]
s_waitcnt lgkmcnt(1)
v_add_u32 v7,s55,v11
v_mfma_f32_16x16x32_bf16 v[32:35],a[240:243],v[120:123],v[32:35]
v_mfma_f32_16x16x32_bf16 v[36:39],a[244:247],v[120:123],v[36:39]
s_waitcnt lgkmcnt(0)
v_mfma_f32_16x16x32_bf16 v[40:43],a[248:251],v[124:127],v[32:35]
v_mfma_f32_16x16x32_bf16 v[44:47],a[252:255],v[124:127],v[36:39]
s_waitcnt vmcnt(1)
v_cmp_gt_u32 vcc,s71,v16
s_add_u32 s60,s60,1
s_branch endN_312
BN_306:
s_waitcnt vmcnt(9)
ds_read_b128 v[64:67],v4 offset:0
s_waitcnt vmcnt(8)
ds_read_b128 v[68:71],v4 offset:1024
s_waitcnt vmcnt(7)
ds_read_b128 v[72:75],v4 offset:2048
s_waitcnt vmcnt(6)
ds_read_b128 v[76:79],v4 offset:3072
s_waitcnt lgkmcnt(3)
v_mfma_f32_16x16x32_bf16 v[32:35],a[0:3],v[64:67],0
s_add_u32 s71,s60,2
s_add_u32 s53,s60,3
s_mov_b32 s57,s63
v_mfma_f32_16x16x32_bf16 v[36:39],a[4:7],v[64:67],0
v_mfma_f32_16x16x32_bf16 v[48:51],v[12:15],v[64:67],0
v_mfma_f32_16x16x32_bf16 v[52:55],v[64:67],v[64:67],0
s_waitcnt lgkmcnt(2)
s_waitcnt vmcnt(5)
ds_read_b128 v[80:83],v4 offset:4096
v_mfma_f32_16x16x32_bf16 v[32:35],a[8:11],v[68:71],v[32:35]
v_mfma_f32_16x16x32_bf16 v[36:39],a[12:15],v[68:71],v[36:39]
v_mfma_f32_16x16x32_bf16 v[48:51],v[12:15],v[68:71],v[48:51]
v_mfma_f32_16x16x32_bf16 v[52:55],v[68:71],v[68:71],v[52:55]
s_waitcnt lgkmcnt(2)
s_waitcnt vmcnt(4)
ds_read_b128 v[84:87],v4 offset:5120
v_mfma_f32_16x16x32_bf16 v[32:35],a[16:19],v[72:75],v[32:35]
v_mfma_f32_16x16x32_bf16 v[36:39],a[20:23],v[72:75],v[36:39]
v_mfma_f32_16x16x32_bf16 v[48:51],v[12:15],v[72:75],v[48:51]
v_mfma_f32_16x16x32_bf16 v[52:55],v[72:75],v[72:75],v[52:55]
s_waitcnt lgkmcnt(2)
s_waitcnt vmcnt(3)
ds_read_b128 v[88:91],v4 offset:6144
v_mfma_f32_16x16x32_bf16 v[32:35],a[24:27],v[76:79],v[32:35]
v_mfma_f32_16x16x32_bf16 v[36:39],a[28:31],v[76:79],v[36:39]
v_mfma_f32_16x16x32_bf16 v[48:51],v[12:15],v[76:79],v[48:51]
v_mfma_f32_16x16x32_bf16 v[52:55],v[76:79],v[76:79],v[52:55]
s_waitcnt lgkmcnt(2)
s_waitcnt vmcnt(2)
ds_read_b128 v[92:95],v4 offset:7168
v_mfma_f32_16x16x32_bf16 v[32:35],a[32:35],v[80:83],v[32:35]
v_mfma_f32_16x16x32_bf16 v[36:39],a[36:39],v[80:83],v[36:39]
v_mfma_f32_16x16x32_bf16 v[48:51],v[12:15],v[80:83],v[48:51]
v_mfma_f32_16x16x32_bf16 v[52:55],v[80:83],v[80:83],v[52:55]
s_waitcnt lgkmcnt(2)
s_barrier
ds_read_b128 v[96:99],v5 offset:0
v_mfma_f32_16x16x32_bf16 v[32:35],a[40:43],v[84:87],v[32:35]
ds_read_b128 v[100:103],v5 offset:1024
v_mfma_f32_16x16x32_bf16 v[36:39],a[44:47],v[84:87],v[36:39]
ds_read_b128 v[104:107],v5 offset:2048
v_mfma_f32_16x16x32_bf16 v[48:51],v[12:15],v[84:87],v[48:51]
ds_read_b128 v[108:111],v5 offset:3072
v_mfma_f32_16x16x32_bf16 v[52:55],v[84:87],v[84:87],v[52:55]
s_waitcnt lgkmcnt(5)
v_mfma_f32_16x16x32_bf16 v[32:35],a[48:51],v[88:91],v[32:35]
ds_read_b128 v[112:115],v5 offset:4096
v_mfma_f32_16x16x32_bf16 v[36:39],a[52:55],v[88:91],v[36:39]
v_mfma_f32_16x16x32_bf16 v[48:51],v[12:15],v[88:91],v[48:51]
v_mfma_f32_16x16x32_bf16 v[52:55],v[88:91],v[88:91],v[52:55]
s_waitcnt lgkmcnt(5)
v_mfma_f32_16x16x32_bf16 v[32:35],a[56:59],v[92:95],v[32:35]
ds_read_b128 v[116:119],v5 offset:5120
v_mfma_f32_16x16x32_bf16 v[36:39],a[60:63],v[92:95],v[36:39]
v_mfma_f32_16x16x32_bf16 v[48:51],v[12:15],v[92:95],v[48:51]
v_mfma_f32_16x16x32_bf16 v[52:55],v[92:95],v[92:95],v[52:55]
s_waitcnt lgkmcnt(5)
v_mfma_f32_16x16x32_bf16 v[32:35],a[64:67],v[96:99],v[32:35]
ds_read_b128 v[120:123],v5 offset:6144
v_mfma_f32_16x16x32_bf16 v[36:39],a[68:71],v[96:99],v[36:39]
s_waitcnt lgkmcnt(5)
v_mfma_f32_16x16x32_bf16 v[32:35],a[72:75],v[100:103],v[32:35]
ds_read_b128 v[124:127],v5 offset:7168
v_mfma_f32_16x16x32_bf16 v[36:39],a[76:79],v[100:103],v[36:39]
s_waitcnt lgkmcnt(5)
v_mfma_f32_16x16x32_bf16 v[32:35],a[80:83],v[104:107],v[32:35]
ds_read_b128 v[64:67],v6 offset:0
v_cndmask_b32 v49,v52,v53,s[74:75]
v_mfma_f32_16x16x32_bf16 v[36:39],a[84:87],v[104:107],v[36:39]
s_waitcnt lgkmcnt(5)
v_cndmask_b32 v49,v49,v54,s[76:77]
v_cndmask_b32 v49,v49,v55,s[78:79]
v_mfma_f32_16x16x32_bf16 v[32:35],a[88:91],v[108:111],v[32:35]
ds_read_b128 v[68:71],v6 offset:1024
v_mfma_f32_16x16x32_bf16 v[36:39],a[92:95],v[108:111],v[36:39]
s_waitcnt lgkmcnt(5)
ds_write_b64 v19,v[48:49]
v_mfma_f32_16x16x32_bf16 v[32:35],a[96:99],v[112:115],v[32:35]
ds_read_b128 v[72:75],v6 offset:2048
v_mfma_f32_16x16x32_bf16 v[36:39],a[100:103],v[112:115],v[36:39]
s_waitcnt lgkmcnt(6)
v_mfma_f32_16x16x32_bf16 v[32:35],a[104:107],v[116:119],v[32:35]
ds_read_b128 v[76:79],v6 offset:3072
v_mfma_f32_16x16x32_bf16 v[36:39],a[108:111],v[116:119],v[36:39]
s_waitcnt lgkmcnt(6)
v_mfma_f32_16x16x32_bf16 v[32:35],a[112:115],v[120:123],v[32:35]
s_waitcnt lgkmcnt(2)
s_barrier
ds_read_b128 v[80:83],v6 offset:4096
v_mfma_f32_16x16x32_bf16 v[36:39],a[116:119],v[120:123],v[36:39]
ds_read_b64 v[56:57],v20 offset:0
v_mfma_f32_16x16x32_bf16 v[32:35],a[120:123],v[124:127],v[32:35]
ds_read_b128 v[84:87],v6 offset:5120
v_mfma_f32_16x16x32_bf16 v[36:39],a[124:127],v[124:127],v[36:39]
ds_read_b64 v[58:59],v20 offset:512
v_mfma_f32_16x16x32_bf16 v[32:35],a[128:131],v[64:67],v[32:35]
ds_read_b128 v[88:91],v6 offset:6144
v_mfma_f32_16x16x32_bf16 v[36:39],a[132:135],v[64:67],v[36:39]
ds_read_b64 v[60:61],v20 offset:1024
v_mfma_f32_16x16x32_bf16 v[32:35],a[136:139],v[68:71],v[32:35]
ds_read_b128 v[92:95],v6 offset:7168
v_mfma_f32_16x16x32_bf16 v[36:39],a[140:143],v[68:71],v[36:39]
s_waitcnt lgkmcnt(8)
ds_read_b64 v[62:63],v20 offset:1536
v_mfma_f32_16x16x32_bf16 v[32:35],a[144:147],v[72:75],v[32:35]
ds_read_b128 v[96:99],v7 offset:0
v_mfma_f32_16x16x32_bf16 v[36:39],a[148:151],v[72:75],v[36:39]
s_waitcnt lgkmcnt(9)
buffer_load_dword v16,v2,s[20:23],s68 offen sc1
v_mfma_f32_16x16x32_bf16 v[32:35],a[152:155],v[76:79],v[32:35]
ds_read_b128 v[100:103],v7 offset:1024
v_mfma_f32_16x16x32_bf16 v[36:39],a[156:159],v[76:79],v[36:39]
s_waitcnt lgkmcnt(9)
s_waitcnt vmcnt(2)
v_mov_b32 v17,s57
buffer_store_dword v17,v26,s[20:23],s69 offen
v_mfma_f32_16x16x32_bf16 v[32:35],a[160:163],v[80:83],v[32:35]
ds_read_b128 v[104:107],v7 offset:2048
v_mfma_f32_16x16x32_bf16 v[36:39],a[164:167],v[80:83],v[36:39]
s_waitcnt lgkmcnt(8)
s_waitcnt lgkmcnt(3)
v_add_f32 v56,v56,v58
v_mfma_f32_16x16x32_bf16 v[32:35],a[168:171],v[84:87],v[32:35]
ds_read_b128 v[108:111],v7 offset:3072
v_add_f32 v57,v57,v59
v_mfma_f32_16x16x32_bf16 v[36:39],a[172:175],v[84:87],v[36:39]
v_add_f32 v60,v60,v62
v_add_f32 v61,v61,v63
v_mfma_f32_16x16x32_bf16 v[32:35],a[176:179],v[88:91],v[32:35]
ds_read_b128 v[112:115],v7 offset:4096
v_add_f32 v56,v56,v60
v_mfma_f32_16x16x32_bf16 v[36:39],a[180:183],v[88:91],v[36:39]
v_add_f32 v57,v57,v61
v_mul_f32 v188,0xba800000,v56
v_mfma_f32_16x16x32_bf16 v[32:35],a[184:187],v[92:95],v[32:35]
ds_read_b128 v[116:119],v7 offset:5120
v_fma_f32 v58,v188,v188,-v210
v_mfma_f32_16x16x32_bf16 v[36:39],a[188:191],v[92:95],v[36:39]
s_waitcnt lgkmcnt(5)
v_fma_f32 v57,v57,v211,-v58
v_max_f32 v57,v210,v57
v_mfma_f32_16x16x32_bf16 v[32:35],a[192:195],v[96:99],v[32:35]
ds_read_b128 v[120:123],v7 offset:6144
v_mfma_f32_16x16x32_bf16 v[36:39],a[196:199],v[96:99],v[36:39]
s_waitcnt lgkmcnt(5)
v_rsq_f32 v58,v57
v_mfma_f32_16x16x32_bf16 v[32:35],a[200:203],v[100:103],v[32:35]
ds_read_b128 v[124:127],v7 offset:7168
v_mul_f32 v189,v57,v58
v_mfma_f32_16x16x32_bf16 v[36:39],a[204:207],v[100:103],v[36:39]
s_waitcnt lgkmcnt(5)
v_mul_f32 v190,v209,v58
v_mul_f32 v59,v58,v58
v_mfma_f32_16x16x32_bf16 v[32:35],a[208:211],v[104:107],v[32:35]
s_add_u32 s55,s55,32768
v_mul_f32 v191,v208,v58
v_mul_f32 v191,v191,v59
v_mfma_f32_16x16x32_bf16 v[36:39],a[212:215],v[104:107],v[36:39]
s_waitcnt lgkmcnt(4)
s_and_b32 s55,s55,0x1ffff
v_add_u32 v4,s55,v8
v_mfma_f32_16x16x32_bf16 v[32:35],a[216:219],v[108:111],v[32:35]
v_add_u32 v5,s55,v9
v_add_u32 v6,s55,v10
v_mfma_f32_16x16x32_bf16 v[36:39],a[220:223],v[108:111],v[36:39]
s_waitcnt lgkmcnt(3)
v_add_u32 v7,s55,v11
v_mfma_f32_16x16x32_bf16 v[32:35],a[224:227],v[112:115],v[32:35]
v_mfma_f32_16x16x32_bf16 v[36:39],a[228:231],v[112:115],v[36:39]
s_waitcnt lgkmcnt(2)
v_mfma_f32_16x16x32_bf16 v[32:35],a[232:235],v[116:119],v[32:35]
v_mfma_f32_16x16x32_bf16 v[36:39],a[236:239],v[116:119],v[36:39]
s_waitcnt lgkmcnt(1)
v_mfma_f32_16x16x32_bf16 v[32:35],a[240:243],v[120:123],v[32:35]
v_mfma_f32_16x16x32_bf16 v[36:39],a[244:247],v[120:123],v[36:39]
s_waitcnt lgkmcnt(0)
v_mfma_f32_16x16x32_bf16 v[40:43],a[248:251],v[124:127],v[32:35]
v_mfma_f32_16x16x32_bf16 v[44:47],a[252:255],v[124:127],v[36:39]
s_waitcnt vmcnt(1)
v_cmp_gt_u32 vcc,s71,v16
s_add_u32 s60,s60,1
endN_312:
s_cbranch_vccnz nb_309
s_mov_b32 m0,s70
s_nop 0
buffer_load_dwordx4 v3,s[20:23],s61 offen offset:0 lds
buffer_load_dwordx4 v3,s[20:23],s61 offen offset:1024 lds
buffer_load_dwordx4 v3,s[20:23],s61 offen offset:2048 lds
buffer_load_dwordx4 v3,s[20:23],s61 offen offset:3072 lds
s_add_u32 m0,s70,4096
s_nop 0
buffer_load_dwordx4 v3,s[20:23],s62 offen offset:0 lds
buffer_load_dwordx4 v3,s[20:23],s62 offen offset:1024 lds
buffer_load_dwordx4 v3,s[20:23],s62 offen offset:2048 lds
buffer_load_dwordx4 v3,s[20:23],s62 offen offset:3072 lds
s_add_u32 s61,s61,32768
s_add_u32 s62,s62,32768
s_add_u32 s70,s70,32768
s_and_b32 s70,s70,0x1ffff
s_mov_b32 s57,s63
v_pk_fma_f32 v[40:41],v[152:153],v[188:189],v[40:41] op_sel_hi:[1,0,1]
v_pk_fma_f32 v[42:43],v[154:155],v[188:189],v[42:43] op_sel_hi:[1,0,1]
v_pk_fma_f32 v[44:45],v[156:157],v[188:189],v[44:45] op_sel_hi:[1,0,1]
v_pk_fma_f32 v[46:47],v[158:159],v[188:189],v[46:47] op_sel_hi:[1,0,1]
v_pk_mul_f32 v[168:169],v[40:41],v[40:41]
v_pk_mul_f32 v[170:171],v[42:43],v[42:43]
v_pk_mul_f32 v[172:173],v[44:45],v[44:45]
v_pk_mul_f32 v[174:175],v[46:47],v[46:47]
v_pk_fma_f32 v[168:169],v[168:169],v[190:191],v[190:191] op_sel:[0,1,0] op_sel_hi:[1,1,0]
v_pk_fma_f32 v[170:171],v[170:171],v[190:191],v[190:191] op_sel:[0,1,0] op_sel_hi:[1,1,0]
v_pk_fma_f32 v[172:173],v[172:173],v[190:191],v[190:191] op_sel:[0,1,0] op_sel_hi:[1,1,0]
v_pk_fma_f32 v[174:175],v[174:175],v[190:191],v[190:191] op_sel:[0,1,0] op_sel_hi:[1,1,0]
v_pk_mul_f32 v[168:169],v[168:169],v[40:41]
v_pk_mul_f32 v[170:171],v[170:171],v[42:43]
v_pk_mul_f32 v[172:173],v[172:173],v[44:45]
v_pk_mul_f32 v[174:175],v[174:175],v[46:47]
v_exp_f32 v168,v168
v_exp_f32 v169,v169
v_exp_f32 v170,v170
v_exp_f32 v171,v171
v_exp_f32 v172,v172
v_exp_f32 v173,v173
v_exp_f32 v174,v174
v_exp_f32 v175,v175
v_pk_fma_f32 v[168:169],v[168:169],v[188:189],v[188:189] op_sel:[0,1,1] op_sel_hi:[1,1,1]
v_pk_fma_f32 v[170:171],v[170:171],v[188:189],v[188:189] op_sel:[0,1,1] op_sel_hi:[1,1,1]
v_pk_fma_f32 v[172:173],v[172:173],v[188:189],v[188:189] op_sel:[0,1,1] op_sel_hi:[1,1,1]
v_pk_fma_f32 v[174:175],v[174:175],v[188:189],v[188:189] op_sel:[0,1,1] op_sel_hi:[1,1,1]
v_rcp_f32 v168,v168
v_rcp_f32 v169,v169
v_rcp_f32 v170,v170
v_rcp_f32 v171,v171
v_rcp_f32 v172,v172
v_rcp_f32 v173,v173
v_rcp_f32 v174,v174
v_rcp_f32 v175,v175
v_pk_mul_f32 v[40:41],v[168:169],v[40:41]
v_pk_mul_f32 v[42:43],v[170:171],v[42:43]
v_pk_mul_f32 v[44:45],v[172:173],v[44:45]
v_pk_mul_f32 v[46:47],v[174:175],v[46:47]
v_cvt_pk_bf16_f32 v176,v40,v41
v_cvt_pk_bf16_f32 v177,v42,v43
v_cvt_pk_bf16_f32 v178,v44,v45
v_cvt_pk_bf16_f32 v179,v46,v47
buffer_store_dwordx4 v[176:179],v0,s[20:23],s66 offen sc1
s_add_u32 s66,s66,32768
s_add_u32 s63,s63,1
s_waitcnt vmcnt(9)
v_mov_b32 v17,s57
buffer_store_dword v17,v26,s[20:23],s69 offen
s_branch dec_308
nb_309:
buffer_load_dword v16,v2,s[20:23],s68 offen sc1
s_nop 3
s_mov_b32 s57,s63
v_pk_fma_f32 v[40:41],v[152:153],v[188:189],v[40:41] op_sel_hi:[1,0,1]
v_pk_fma_f32 v[42:43],v[154:155],v[188:189],v[42:43] op_sel_hi:[1,0,1]
v_pk_fma_f32 v[44:45],v[156:157],v[188:189],v[44:45] op_sel_hi:[1,0,1]
v_pk_fma_f32 v[46:47],v[158:159],v[188:189],v[46:47] op_sel_hi:[1,0,1]
v_pk_mul_f32 v[168:169],v[40:41],v[40:41]
v_pk_mul_f32 v[170:171],v[42:43],v[42:43]
v_pk_mul_f32 v[172:173],v[44:45],v[44:45]
v_pk_mul_f32 v[174:175],v[46:47],v[46:47]
v_pk_fma_f32 v[168:169],v[168:169],v[190:191],v[190:191] op_sel:[0,1,0] op_sel_hi:[1,1,0]
v_pk_fma_f32 v[170:171],v[170:171],v[190:191],v[190:191] op_sel:[0,1,0] op_sel_hi:[1,1,0]
v_pk_fma_f32 v[172:173],v[172:173],v[190:191],v[190:191] op_sel:[0,1,0] op_sel_hi:[1,1,0]
v_pk_fma_f32 v[174:175],v[174:175],v[190:191],v[190:191] op_sel:[0,1,0] op_sel_hi:[1,1,0]
v_pk_mul_f32 v[168:169],v[168:169],v[40:41]
v_pk_mul_f32 v[170:171],v[170:171],v[42:43]
v_pk_mul_f32 v[172:173],v[172:173],v[44:45]
v_pk_mul_f32 v[174:175],v[174:175],v[46:47]
v_exp_f32 v168,v168
v_exp_f32 v169,v169
v_exp_f32 v170,v170
v_exp_f32 v171,v171
v_exp_f32 v172,v172
v_exp_f32 v173,v173
v_exp_f32 v174,v174
v_exp_f32 v175,v175
v_pk_fma_f32 v[168:169],v[168:169],v[188:189],v[188:189] op_sel:[0,1,1] op_sel_hi:[1,1,1]
v_pk_fma_f32 v[170:171],v[170:171],v[188:189],v[188:189] op_sel:[0,1,1] op_sel_hi:[1,1,1]
v_pk_fma_f32 v[172:173],v[172:173],v[188:189],v[188:189] op_sel:[0,1,1] op_sel_hi:[1,1,1]
v_pk_fma_f32 v[174:175],v[174:175],v[188:189],v[188:189] op_sel:[0,1,1] op_sel_hi:[1,1,1]
v_rcp_f32 v168,v168
v_rcp_f32 v169,v169
v_rcp_f32 v170,v170
v_rcp_f32 v171,v171
v_rcp_f32 v172,v172
v_rcp_f32 v173,v173
v_rcp_f32 v174,v174
v_rcp_f32 v175,v175
v_pk_mul_f32 v[40:41],v[168:169],v[40:41]
v_pk_mul_f32 v[42:43],v[170:171],v[42:43]
v_pk_mul_f32 v[44:45],v[172:173],v[44:45]
v_pk_mul_f32 v[46:47],v[174:175],v[46:47]
v_cvt_pk_bf16_f32 v176,v40,v41
v_cvt_pk_bf16_f32 v177,v42,v43
v_cvt_pk_bf16_f32 v178,v44,v45
v_cvt_pk_bf16_f32 v179,v46,v47
buffer_store_dwordx4 v[176:179],v0,s[20:23],s66 offen sc1
s_add_u32 s66,s66,32768
s_add_u32 s63,s63,1
s_waitcnt vmcnt(2)
v_mov_b32 v17,s57
buffer_store_dword v17,v26,s[20:23],s69 offen
s_waitcnt vmcnt(2)
v_cmp_gt_u32 vcc,s71,v16
s_cbranch_vccz lag_307
s_waitcnt vmcnt(1)
v_mov_b32 v17,s63
buffer_store_dword v17,v26,s[20:23],s69 offen
s_cmp_ge_u32 s60,128
s_cbranch_scc1 done_295
plp_313:
buffer_load_dword v16,v2,s[20:23],s68 offen sc1
s_waitcnt vmcnt(0)
v_cmp_gt_u32 vcc,s71,v16
s_cbranch_vccz pok_314
s_sleep 4
s_sub_u32 s90,s90,1
s_cmp_gt_i32 s90,0
s_cbranch_scc1 plp_313
pok_314:
s_branch lag_307
lfar_302:
s_add_u32 s71,s60,1
s_add_u32 s53,s60,2
plp_322:
buffer_load_dword v16,v2,s[20:23],s68 offen sc1
s_waitcnt vmcnt(0)
v_cmp_gt_u32 vcc,s71,v16
s_cbranch_vccz pok_323
s_sleep 4
s_sub_u32 s90,s90,1
s_cmp_gt_i32 s90,0
s_cbranch_scc1 plp_322
pok_323:
lag_319:
s_mov_b32 m0,s70
s_nop 0
buffer_load_dwordx4 v3,s[20:23],s61 offen offset:0 lds
buffer_load_dwordx4 v3,s[20:23],s61 offen offset:1024 lds
buffer_load_dwordx4 v3,s[20:23],s61 offen offset:2048 lds
buffer_load_dwordx4 v3,s[20:23],s61 offen offset:3072 lds
s_add_u32 m0,s70,4096
s_nop 0
buffer_load_dwordx4 v3,s[20:23],s62 offen offset:0 lds
buffer_load_dwordx4 v3,s[20:23],s62 offen offset:1024 lds
buffer_load_dwordx4 v3,s[20:23],s62 offen offset:2048 lds
buffer_load_dwordx4 v3,s[20:23],s62 offen offset:3072 lds
s_add_u32 s61,s61,32768
s_add_u32 s62,s62,32768
s_add_u32 s70,s70,32768
s_and_b32 s70,s70,0x1ffff
buffer_load_dword v23,off,s[20:23],s66
buffer_load_dword v23,off,s[20:23],s66
dec_320:
v_cmp_gt_u32 vcc,s53,v16
s_cbranch_vccnz BN_318
BR_317:
s_waitcnt vmcnt(9)
ds_read_b128 v[64:67],v4 offset:0
s_waitcnt vmcnt(8)
ds_read_b128 v[68:71],v4 offset:1024
s_waitcnt vmcnt(7)
ds_read_b128 v[72:75],v4 offset:2048
s_waitcnt vmcnt(6)
ds_read_b128 v[76:79],v4 offset:3072
s_waitcnt lgkmcnt(3)
v_mfma_f32_16x16x32_bf16 v[32:35],a[0:3],v[64:67],0
s_add_u32 s71,s60,2
s_add_u32 s53,s60,3
s_mov_b32 s57,s63
v_mfma_f32_16x16x32_bf16 v[36:39],a[4:7],v[64:67],0
v_mfma_f32_16x16x32_bf16 v[48:51],v[12:15],v[64:67],0
v_mfma_f32_16x16x32_bf16 v[52:55],v[64:67],v[64:67],0
s_waitcnt lgkmcnt(2)
s_waitcnt vmcnt(5)
s_mov_b32 m0,s70
ds_read_b128 v[80:83],v4 offset:4096
v_mfma_f32_16x16x32_bf16 v[32:35],a[8:11],v[68:71],v[32:35]
buffer_load_dwordx4 v3,s[20:23],s61 offen offset:0 lds
v_mfma_f32_16x16x32_bf16 v[36:39],a[12:15],v[68:71],v[36:39]
v_mfma_f32_16x16x32_bf16 v[48:51],v[12:15],v[68:71],v[48:51]
v_mfma_f32_16x16x32_bf16 v[52:55],v[68:71],v[68:71],v[52:55]
s_waitcnt lgkmcnt(2)
s_waitcnt vmcnt(5)
ds_read_b128 v[84:87],v4 offset:5120
v_mfma_f32_16x16x32_bf16 v[32:35],a[16:19],v[72:75],v[32:35]
buffer_load_dwordx4 v3,s[20:23],s61 offen offset:1024 lds
v_mfma_f32_16x16x32_bf16 v[36:39],a[20:23],v[72:75],v[36:39]
v_mfma_f32_16x16x32_bf16 v[48:51],v[12:15],v[72:75],v[48:51]
v_mfma_f32_16x16x32_bf16 v[52:55],v[72:75],v[72:75],v[52:55]
s_waitcnt lgkmcnt(2)
s_waitcnt vmcnt(5)
ds_read_b128 v[88:91],v4 offset:6144
v_mfma_f32_16x16x32_bf16 v[32:35],a[24:27],v[76:79],v[32:35]
buffer_load_dwordx4 v3,s[20:23],s61 offen offset:2048 lds
v_mfma_f32_16x16x32_bf16 v[36:39],a[28:31],v[76:79],v[36:39]
v_mfma_f32_16x16x32_bf16 v[48:51],v[12:15],v[76:79],v[48:51]
v_mfma_f32_16x16x32_bf16 v[52:55],v[76:79],v[76:79],v[52:55]
s_waitcnt lgkmcnt(2)
s_waitcnt vmcnt(5)
ds_read_b128 v[92:95],v4 offset:7168
v_mfma_f32_16x16x32_bf16 v[32:35],a[32:35],v[80:83],v[32:35]
buffer_load_dwordx4 v3,s[20:23],s61 offen offset:3072 lds
v_mfma_f32_16x16x32_bf16 v[36:39],a[36:39],v[80:83],v[36:39]
v_mfma_f32_16x16x32_bf16 v[48:51],v[12:15],v[80:83],v[48:51]
v_mfma_f32_16x16x32_bf16 v[52:55],v[80:83],v[80:83],v[52:55]
s_waitcnt lgkmcnt(2)
s_barrier
ds_read_b128 v[96:99],v5 offset:0
v_mfma_f32_16x16x32_bf16 v[32:35],a[40:43],v[84:87],v[32:35]
ds_read_b128 v[100:103],v5 offset:1024
v_mfma_f32_16x16x32_bf16 v[36:39],a[44:47],v[84:87],v[36:39]
ds_read_b128 v[104:107],v5 offset:2048
v_mfma_f32_16x16x32_bf16 v[48:51],v[12:15],v[84:87],v[48:51]
s_add_u32 m0,s70,4096
ds_read_b128 v[108:111],v5 offset:3072
v_mfma_f32_16x16x32_bf16 v[52:55],v[84:87],v[84:87],v[52:55]
s_waitcnt lgkmcnt(5)
buffer_load_dwordx4 v3,s[20:23],s62 offen offset:0 lds
v_mfma_f32_16x16x32_bf16 v[32:35],a[48:51],v[88:91],v[32:35]
ds_read_b128 v[112:115],v5 offset:4096
v_mfma_f32_16x16x32_bf16 v[36:39],a[52:55],v[88:91],v[36:39]
buffer_load_dwordx4 v3,s[20:23],s62 offen offset:1024 lds
v_mfma_f32_16x16x32_bf16 v[48:51],v[12:15],v[88:91],v[48:51]
v_mfma_f32_16x16x32_bf16 v[52:55],v[88:91],v[88:91],v[52:55]
s_waitcnt lgkmcnt(5)
v_mfma_f32_16x16x32_bf16 v[32:35],a[56:59],v[92:95],v[32:35]
ds_read_b128 v[116:119],v5 offset:5120
v_mfma_f32_16x16x32_bf16 v[36:39],a[60:63],v[92:95],v[36:39]
buffer_load_dwordx4 v3,s[20:23],s62 offen offset:2048 lds
v_mfma_f32_16x16x32_bf16 v[48:51],v[12:15],v[92:95],v[48:51]
buffer_load_dword v16,v2,s[20:23],s68 offen sc1
v_mfma_f32_16x16x32_bf16 v[52:55],v[92:95],v[92:95],v[52:55]
s_waitcnt lgkmcnt(5)
v_mfma_f32_16x16x32_bf16 v[32:35],a[64:67],v[96:99],v[32:35]
ds_read_b128 v[120:123],v5 offset:6144
v_mfma_f32_16x16x32_bf16 v[36:39],a[68:71],v[96:99],v[36:39]
s_waitcnt lgkmcnt(5)
buffer_load_dwordx4 v3,s[20:23],s62 offen offset:3072 lds
v_mfma_f32_16x16x32_bf16 v[32:35],a[72:75],v[100:103],v[32:35]
ds_read_b128 v[124:127],v5 offset:7168
v_mfma_f32_16x16x32_bf16 v[36:39],a[76:79],v[100:103],v[36:39]
s_waitcnt lgkmcnt(5)
v_mfma_f32_16x16x32_bf16 v[32:35],a[80:83],v[104:107],v[32:35]
ds_read_b128 v[64:67],v6 offset:0
v_cndmask_b32 v49,v52,v53,s[74:75]
v_mfma_f32_16x16x32_bf16 v[36:39],a[84:87],v[104:107],v[36:39]
s_waitcnt lgkmcnt(5)
v_cndmask_b32 v49,v49,v54,s[76:77]
v_cndmask_b32 v49,v49,v55,s[78:79]
v_mfma_f32_16x16x32_bf16 v[32:35],a[88:91],v[108:111],v[32:35]
ds_read_b128 v[68:71],v6 offset:1024
v_mfma_f32_16x16x32_bf16 v[36:39],a[92:95],v[108:111],v[36:39]
s_waitcnt lgkmcnt(5)
ds_write_b64 v19,v[48:49]
v_mfma_f32_16x16x32_bf16 v[32:35],a[96:99],v[112:115],v[32:35]
ds_read_b128 v[72:75],v6 offset:2048
v_mfma_f32_16x16x32_bf16 v[36:39],a[100:103],v[112:115],v[36:39]
s_waitcnt lgkmcnt(6)
v_mfma_f32_16x16x32_bf16 v[32:35],a[104:107],v[116:119],v[32:35]
ds_read_b128 v[76:79],v6 offset:3072
v_mfma_f32_16x16x32_bf16 v[36:39],a[108:111],v[116:119],v[36:39]
s_waitcnt lgkmcnt(6)
v_mfma_f32_16x16x32_bf16 v[32:35],a[112:115],v[120:123],v[32:35]
s_waitcnt lgkmcnt(2)
s_barrier
ds_read_b128 v[80:83],v6 offset:4096
v_mfma_f32_16x16x32_bf16 v[36:39],a[116:119],v[120:123],v[36:39]
ds_read_b64 v[56:57],v20 offset:0
v_mfma_f32_16x16x32_bf16 v[32:35],a[120:123],v[124:127],v[32:35]
ds_read_b128 v[84:87],v6 offset:5120
v_mfma_f32_16x16x32_bf16 v[36:39],a[124:127],v[124:127],v[36:39]
ds_read_b64 v[58:59],v20 offset:512
v_mfma_f32_16x16x32_bf16 v[32:35],a[128:131],v[64:67],v[32:35]
ds_read_b128 v[88:91],v6 offset:6144
v_mfma_f32_16x16x32_bf16 v[36:39],a[132:135],v[64:67],v[36:39]
ds_read_b64 v[60:61],v20 offset:1024
v_mfma_f32_16x16x32_bf16 v[32:35],a[136:139],v[68:71],v[32:35]
ds_read_b128 v[92:95],v6 offset:7168
v_mfma_f32_16x16x32_bf16 v[36:39],a[140:143],v[68:71],v[36:39]
s_waitcnt lgkmcnt(8)
ds_read_b64 v[62:63],v20 offset:1536
v_mfma_f32_16x16x32_bf16 v[32:35],a[144:147],v[72:75],v[32:35]
ds_read_b128 v[96:99],v7 offset:0
v_mfma_f32_16x16x32_bf16 v[36:39],a[148:151],v[72:75],v[36:39]
s_waitcnt lgkmcnt(9)
s_waitcnt vmcnt(10)
v_mov_b32 v17,s57
buffer_store_dword v17,v26,s[20:23],s69 offen sc1
v_mfma_f32_16x16x32_bf16 v[32:35],a[152:155],v[76:79],v[32:35]
ds_read_b128 v[100:103],v7 offset:1024
v_mfma_f32_16x16x32_bf16 v[36:39],a[156:159],v[76:79],v[36:39]
s_waitcnt lgkmcnt(9)
v_mfma_f32_16x16x32_bf16 v[32:35],a[160:163],v[80:83],v[32:35]
ds_read_b128 v[104:107],v7 offset:2048
v_mfma_f32_16x16x32_bf16 v[36:39],a[164:167],v[80:83],v[36:39]
s_waitcnt lgkmcnt(8)
s_waitcnt lgkmcnt(3)
v_add_f32 v56,v56,v58
v_mfma_f32_16x16x32_bf16 v[32:35],a[168:171],v[84:87],v[32:35]
ds_read_b128 v[108:111],v7 offset:3072
v_add_f32 v57,v57,v59
v_mfma_f32_16x16x32_bf16 v[36:39],a[172:175],v[84:87],v[36:39]
v_add_f32 v60,v60,v62
v_add_f32 v61,v61,v63
v_mfma_f32_16x16x32_bf16 v[32:35],a[176:179],v[88:91],v[32:35]
ds_read_b128 v[112:115],v7 offset:4096
v_add_f32 v56,v56,v60
v_mfma_f32_16x16x32_bf16 v[36:39],a[180:183],v[88:91],v[36:39]
v_add_f32 v57,v57,v61
v_mul_f32 v188,0xba800000,v56
v_mfma_f32_16x16x32_bf16 v[32:35],a[184:187],v[92:95],v[32:35]
ds_read_b128 v[116:119],v7 offset:5120
v_fma_f32 v58,v188,v188,-v210
v_mfma_f32_16x16x32_bf16 v[36:39],a[188:191],v[92:95],v[36:39]
s_waitcnt lgkmcnt(5)
v_fma_f32 v57,v57,v211,-v58
v_max_f32 v57,v210,v57
v_mfma_f32_16x16x32_bf16 v[32:35],a[192:195],v[96:99],v[32:35]
ds_read_b128 v[120:123],v7 offset:6144
v_mfma_f32_16x16x32_bf16 v[36:39],a[196:199],v[96:99],v[36:39]
s_waitcnt lgkmcnt(5)
v_rsq_f32 v58,v57
v_mfma_f32_16x16x32_bf16 v[32:35],a[200:203],v[100:103],v[32:35]
ds_read_b128 v[124:127],v7 offset:7168
v_mul_f32 v189,v57,v58
v_mfma_f32_16x16x32_bf16 v[36:39],a[204:207],v[100:103],v[36:39]
s_waitcnt lgkmcnt(5)
v_mul_f32 v190,v209,v58
v_mul_f32 v59,v58,v58
v_mfma_f32_16x16x32_bf16 v[32:35],a[208:211],v[104:107],v[32:35]
s_add_u32 s61,s61,32768
v_mul_f32 v191,v208,v58
v_mul_f32 v191,v191,v59
v_mfma_f32_16x16x32_bf16 v[36:39],a[212:215],v[104:107],v[36:39]
s_waitcnt lgkmcnt(4)
s_add_u32 s62,s62,32768
s_add_u32 s70,s70,32768
v_mfma_f32_16x16x32_bf16 v[32:35],a[216:219],v[108:111],v[32:35]
s_and_b32 s70,s70,0x1ffff
s_add_u32 s55,s55,32768
s_and_b32 s55,s55,0x1ffff
v_mfma_f32_16x16x32_bf16 v[36:39],a[220:223],v[108:111],v[36:39]
s_waitcnt lgkmcnt(3)
v_add_u32 v4,s55,v8
v_add_u32 v5,s55,v9
v_mfma_f32_16x16x32_bf16 v[32:35],a[224:227],v[112:115],v[32:35]
v_add_u32 v6,s55,v10
v_add_u32 v7,s55,v11
v_mfma_f32_16x16x32_bf16 v[36:39],a[228:231],v[112:115],v[36:39]
s_waitcnt lgkmcnt(2)
s_waitcnt vmcnt(9)
ds_read_b128 v[64:67],v4 offset:0
v_mfma_f32_16x16x32_bf16 v[32:35],a[232:235],v[116:119],v[32:35]
s_waitcnt vmcnt(8)
ds_read_b128 v[68:71],v4 offset:1024
v_mfma_f32_16x16x32_bf16 v[36:39],a[236:239],v[116:119],v[36:39]
s_waitcnt lgkmcnt(3)
s_waitcnt vmcnt(7)
ds_read_b128 v[72:75],v4 offset:2048
v_mfma_f32_16x16x32_bf16 v[32:35],a[240:243],v[120:123],v[32:35]
v_mfma_f32_16x16x32_bf16 v[36:39],a[244:247],v[120:123],v[36:39]
s_waitcnt lgkmcnt(3)
v_mfma_f32_16x16x32_bf16 v[40:43],a[248:251],v[124:127],v[32:35]
v_mfma_f32_16x16x32_bf16 v[44:47],a[252:255],v[124:127],v[36:39]
s_waitcnt vmcnt(2)
v_cmp_gt_u32 vcc,s53,v16
s_add_u32 s60,s60,1
s_cbranch_vccnz WN_316
.p2align 6
WR_315:
s_waitcnt lgkmcnt(2)
v_mfma_f32_16x16x32_bf16 v[32:35],a[0:3],v[64:67],0
s_waitcnt vmcnt(6)
s_add_u32 s71,s60,2
ds_read_b128 v[76:79],v4 offset:3072
v_mfma_f32_16x16x32_bf16 v[36:39],a[4:7],v[64:67],0
s_add_u32 s53,s60,3
s_mov_b32 s57,s63
v_mfma_f32_16x16x32_bf16 v[48:51],v[12:15],v[64:67],0
s_mov_b32 m0,s70
v_fma_f32 v40,v152,v188,v40
v_fma_f32 v41,v153,v188,v41
v_mul_f32 v168,v40,v40
v_mfma_f32_16x16x32_bf16 v[52:55],v[64:67],v[64:67],0
s_waitcnt lgkmcnt(2)
buffer_load_dwordx4 v3,s[20:23],s61 offen offset:0 lds
v_mul_f32 v169,v41,v41
v_fma_f32 v168,v168,v191,v190
v_mfma_f32_16x16x32_bf16 v[32:35],a[8:11],v[68:71],v[32:35]
s_waitcnt vmcnt(6)
ds_read_b128 v[80:83],v4 offset:4096
v_fma_f32 v169,v169,v191,v190
v_mul_f32 v168,v168,v40
v_mfma_f32_16x16x32_bf16 v[36:39],a[12:15],v[68:71],v[36:39]
v_exp_f32 v168,v168
v_mul_f32 v169,v169,v41
v_mfma_f32_16x16x32_bf16 v[48:51],v[12:15],v[68:71],v[48:51]
v_exp_f32 v169,v169
v_fma_f32 v168,v168,v189,v189
v_mfma_f32_16x16x32_bf16 v[52:55],v[68:71],v[68:71],v[52:55]
s_waitcnt lgkmcnt(2)
buffer_load_dwordx4 v3,s[20:23],s61 offen offset:1024 lds
v_rcp_f32 v168,v168
v_mfma_f32_16x16x32_bf16 v[32:35],a[16:19],v[72:75],v[32:35]
s_waitcnt vmcnt(6)
ds_read_b128 v[84:87],v4 offset:5120
v_fma_f32 v169,v169,v189,v189
v_mul_f32 v40,v168,v40
v_mfma_f32_16x16x32_bf16 v[36:39],a[20:23],v[72:75],v[36:39]
v_rcp_f32 v169,v169
v_fma_f32 v42,v154,v188,v42
v_mfma_f32_16x16x32_bf16 v[48:51],v[12:15],v[72:75],v[48:51]
v_mul_f32 v41,v169,v41
v_fma_f32 v43,v155,v188,v43
v_mul_f32 v170,v42,v42
v_mfma_f32_16x16x32_bf16 v[52:55],v[72:75],v[72:75],v[52:55]
s_waitcnt lgkmcnt(2)
buffer_load_dwordx4 v3,s[20:23],s61 offen offset:2048 lds
v_mul_f32 v171,v43,v43
v_fma_f32 v170,v170,v191,v190
v_mfma_f32_16x16x32_bf16 v[32:35],a[24:27],v[76:79],v[32:35]
s_waitcnt vmcnt(6)
ds_read_b128 v[88:91],v4 offset:6144
v_fma_f32 v171,v171,v191,v190
v_mfma_f32_16x16x32_bf16 v[36:39],a[28:31],v[76:79],v[36:39]
v_mul_f32 v170,v170,v42
v_mul_f32 v171,v171,v43
v_mfma_f32_16x16x32_bf16 v[48:51],v[12:15],v[76:79],v[48:51]
v_exp_f32 v170,v170
v_mfma_f32_16x16x32_bf16 v[52:55],v[76:79],v[76:79],v[52:55]
s_waitcnt lgkmcnt(2)
buffer_load_dwordx4 v3,s[20:23],s61 offen offset:3072 lds
v_fma_f32 v170,v170,v189,v189
v_mfma_f32_16x16x32_bf16 v[32:35],a[32:35],v[80:83],v[32:35]
s_waitcnt vmcnt(5)
ds_read_b128 v[92:95],v4 offset:7168
v_fma_f32 v44,v156,v188,v44
v_mfma_f32_16x16x32_bf16 v[36:39],a[36:39],v[80:83],v[36:39]
s_barrier
ds_read_b128 v[96:99],v5 offset:0
v_fma_f32 v45,v157,v188,v45
v_mfma_f32_16x16x32_bf16 v[48:51],v[12:15],v[80:83],v[48:51]
ds_read_b128 v[100:103],v5 offset:1024
v_mul_f32 v172,v44,v44
v_mfma_f32_16x16x32_bf16 v[52:55],v[80:83],v[80:83],v[52:55]
s_waitcnt lgkmcnt(4)
ds_read_b128 v[104:107],v5 offset:2048
v_mul_f32 v173,v45,v45
v_mfma_f32_16x16x32_bf16 v[32:35],a[40:43],v[84:87],v[32:35]
s_add_u32 m0,s70,4096
ds_read_b128 v[108:111],v5 offset:3072
v_fma_f32 v172,v172,v191,v190
v_mfma_f32_16x16x32_bf16 v[36:39],a[44:47],v[84:87],v[36:39]
buffer_load_dwordx4 v3,s[20:23],s62 offen offset:0 lds
v_fma_f32 v173,v173,v191,v190
v_mfma_f32_16x16x32_bf16 v[48:51],v[12:15],v[84:87],v[48:51]
s_waitcnt vmcnt(5)
v_mov_b32 v17,s57
buffer_store_dword v17,v26,s[20:23],s69 offen sc1
v_mfma_f32_16x16x32_bf16 v[52:55],v[84:87],v[84:87],v[52:55]
s_waitcnt lgkmcnt(5)
v_exp_f32 v171,v171
v_mfma_f32_16x16x32_bf16 v[32:35],a[48:51],v[88:91],v[32:35]
ds_read_b128 v[112:115],v5 offset:4096
v_fma_f32 v171,v171,v189,v189
v_mfma_f32_16x16x32_bf16 v[36:39],a[52:55],v[88:91],v[36:39]
buffer_load_dwordx4 v3,s[20:23],s62 offen offset:1024 lds
v_mul_f32 v172,v172,v44
v_mfma_f32_16x16x32_bf16 v[48:51],v[12:15],v[88:91],v[48:51]
v_rcp_f32 v170,v170
v_mfma_f32_16x16x32_bf16 v[52:55],v[88:91],v[88:91],v[52:55]
s_waitcnt lgkmcnt(5)
v_rcp_f32 v171,v171
v_mfma_f32_16x16x32_bf16 v[32:35],a[56:59],v[92:95],v[32:35]
ds_read_b128 v[116:119],v5 offset:5120
v_mul_f32 v42,v170,v42
v_mfma_f32_16x16x32_bf16 v[36:39],a[60:63],v[92:95],v[36:39]
buffer_load_dwordx4 v3,s[20:23],s62 offen offset:2048 lds
v_mul_f32 v43,v171,v43
v_mfma_f32_16x16x32_bf16 v[48:51],v[12:15],v[92:95],v[48:51]
buffer_load_dword v16,v2,s[20:23],s68 offen sc1
v_mul_f32 v173,v173,v45
v_mfma_f32_16x16x32_bf16 v[52:55],v[92:95],v[92:95],v[52:55]
s_waitcnt lgkmcnt(5)
v_exp_f32 v172,v172
v_mfma_f32_16x16x32_bf16 v[32:35],a[64:67],v[96:99],v[32:35]
ds_read_b128 v[120:123],v5 offset:6144
v_fma_f32 v172,v172,v189,v189
v_mfma_f32_16x16x32_bf16 v[36:39],a[68:71],v[96:99],v[36:39]
s_waitcnt lgkmcnt(5)
buffer_load_dwordx4 v3,s[20:23],s62 offen offset:3072 lds
v_fma_f32 v46,v158,v188,v46
v_mfma_f32_16x16x32_bf16 v[32:35],a[72:75],v[100:103],v[32:35]
ds_read_b128 v[124:127],v5 offset:7168
v_fma_f32 v47,v159,v188,v47
v_mfma_f32_16x16x32_bf16 v[36:39],a[76:79],v[100:103],v[36:39]
s_waitcnt lgkmcnt(5)
v_exp_f32 v173,v173
v_mfma_f32_16x16x32_bf16 v[32:35],a[80:83],v[104:107],v[32:35]
ds_read_b128 v[64:67],v6 offset:0
v_cndmask_b32 v49,v52,v53,s[74:75]
v_mfma_f32_16x16x32_bf16 v[36:39],a[84:87],v[104:107],v[36:39]
s_waitcnt lgkmcnt(5)
v_cndmask_b32 v49,v49,v54,s[76:77]
v_cndmask_b32 v49,v49,v55,s[78:79]
v_mfma_f32_16x16x32_bf16 v[32:35],a[88:91],v[108:111],v[32:35]
ds_read_b128 v[68:71],v6 offset:1024
v_fma_f32 v173,v173,v189,v189
v_mfma_f32_16x16x32_bf16 v[36:39],a[92:95],v[108:111],v[36:39]
s_waitcnt lgkmcnt(5)
ds_write_b64 v19,v[48:49]
v_mfma_f32_16x16x32_bf16 v[32:35],a[96:99],v[112:115],v[32:35]
ds_read_b128 v[72:75],v6 offset:2048
v_mul_f32 v174,v46,v46
v_mfma_f32_16x16x32_bf16 v[36:39],a[100:103],v[112:115],v[36:39]
s_waitcnt lgkmcnt(6)
v_rcp_f32 v172,v172
v_mfma_f32_16x16x32_bf16 v[32:35],a[104:107],v[116:119],v[32:35]
ds_read_b128 v[76:79],v6 offset:3072
v_mul_f32 v44,v172,v44
v_mfma_f32_16x16x32_bf16 v[36:39],a[108:111],v[116:119],v[36:39]
s_waitcnt lgkmcnt(6)
v_rcp_f32 v173,v173
v_mfma_f32_16x16x32_bf16 v[32:35],a[112:115],v[120:123],v[32:35]
s_waitcnt lgkmcnt(2)
s_barrier
ds_read_b128 v[80:83],v6 offset:4096
v_mfma_f32_16x16x32_bf16 v[36:39],a[116:119],v[120:123],v[36:39]
ds_read_b64 v[56:57],v20 offset:0
v_mul_f32 v45,v173,v45
v_mfma_f32_16x16x32_bf16 v[32:35],a[120:123],v[124:127],v[32:35]
ds_read_b128 v[84:87],v6 offset:5120
v_mul_f32 v175,v47,v47
v_mfma_f32_16x16x32_bf16 v[36:39],a[124:127],v[124:127],v[36:39]
ds_read_b64 v[58:59],v20 offset:512
v_fma_f32 v174,v174,v191,v190
v_mfma_f32_16x16x32_bf16 v[32:35],a[128:131],v[64:67],v[32:35]
ds_read_b128 v[88:91],v6 offset:6144
v_fma_f32 v175,v175,v191,v190
v_mfma_f32_16x16x32_bf16 v[36:39],a[132:135],v[64:67],v[36:39]
ds_read_b64 v[60:61],v20 offset:1024
v_mul_f32 v174,v174,v46
v_mfma_f32_16x16x32_bf16 v[32:35],a[136:139],v[68:71],v[32:35]
ds_read_b128 v[92:95],v6 offset:7168
v_mul_f32 v175,v175,v47
v_mfma_f32_16x16x32_bf16 v[36:39],a[140:143],v[68:71],v[36:39]
s_waitcnt lgkmcnt(8)
ds_read_b64 v[62:63],v20 offset:1536
v_cvt_pk_bf16_f32 v176,v40,v41
v_mfma_f32_16x16x32_bf16 v[32:35],a[144:147],v[72:75],v[32:35]
ds_read_b128 v[96:99],v7 offset:0
v_cvt_pk_bf16_f32 v177,v42,v43
v_mfma_f32_16x16x32_bf16 v[36:39],a[148:151],v[72:75],v[36:39]
s_waitcnt lgkmcnt(9)
v_exp_f32 v174,v174
v_mfma_f32_16x16x32_bf16 v[32:35],a[152:155],v[76:79],v[32:35]
ds_read_b128 v[100:103],v7 offset:1024
v_fma_f32 v174,v174,v189,v189
v_mfma_f32_16x16x32_bf16 v[36:39],a[156:159],v[76:79],v[36:39]
s_waitcnt lgkmcnt(9)
v_exp_f32 v175,v175
v_mfma_f32_16x16x32_bf16 v[32:35],a[160:163],v[80:83],v[32:35]
ds_read_b128 v[104:107],v7 offset:2048
v_fma_f32 v175,v175,v189,v189
v_mfma_f32_16x16x32_bf16 v[36:39],a[164:167],v[80:83],v[36:39]
s_waitcnt lgkmcnt(8)
s_waitcnt lgkmcnt(3)
v_rcp_f32 v174,v174
v_mfma_f32_16x16x32_bf16 v[32:35],a[168:171],v[84:87],v[32:35]
ds_read_b128 v[108:111],v7 offset:3072
v_mul_f32 v46,v174,v46
v_mfma_f32_16x16x32_bf16 v[36:39],a[172:175],v[84:87],v[36:39]
v_rcp_f32 v175,v175
v_mfma_f32_16x16x32_bf16 v[32:35],a[176:179],v[88:91],v[32:35]
ds_read_b128 v[112:115],v7 offset:4096
v_mul_f32 v47,v175,v47
v_mfma_f32_16x16x32_bf16 v[36:39],a[180:183],v[88:91],v[36:39]
v_cvt_pk_bf16_f32 v178,v44,v45
v_cvt_pk_bf16_f32 v179,v46,v47
v_mfma_f32_16x16x32_bf16 v[32:35],a[184:187],v[92:95],v[32:35]
ds_read_b128 v[116:119],v7 offset:5120
v_add_f32 v56,v56,v58
v_mfma_f32_16x16x32_bf16 v[36:39],a[188:191],v[92:95],v[36:39]
s_waitcnt lgkmcnt(5)
buffer_store_dwordx4 v[176:179],v0,s[20:23],s66 offen sc1
v_mfma_f32_16x16x32_bf16 v[32:35],a[192:195],v[96:99],v[32:35]
s_add_u32 s66,s66,32768
s_add_u32 s63,s63,1
ds_read_b128 v[120:123],v7 offset:6144
v_mfma_f32_16x16x32_bf16 v[36:39],a[196:199],v[96:99],v[36:39]
s_waitcnt lgkmcnt(5)
v_add_f32 v57,v57,v59
v_add_f32 v60,v60,v62
v_mfma_f32_16x16x32_bf16 v[32:35],a[200:203],v[100:103],v[32:35]
ds_read_b128 v[124:127],v7 offset:7168
v_add_f32 v61,v61,v63
v_mfma_f32_16x16x32_bf16 v[36:39],a[204:207],v[100:103],v[36:39]
s_waitcnt lgkmcnt(5)
v_add_f32 v56,v56,v60
v_add_f32 v57,v57,v61
v_mfma_f32_16x16x32_bf16 v[32:35],a[208:211],v[104:107],v[32:35]
s_add_u32 s61,s61,32768
v_mul_f32 v188,0xba800000,v56
v_fma_f32 v58,v188,v188,-v210
v_mfma_f32_16x16x32_bf16 v[36:39],a[212:215],v[104:107],v[36:39]
s_waitcnt lgkmcnt(4)
v_fma_f32 v57,v57,v211,-v58
v_max_f32 v57,v210,v57
v_mfma_f32_16x16x32_bf16 v[32:35],a[216:219],v[108:111],v[32:35]
s_add_u32 s62,s62,32768
v_rsq_f32 v58,v57
v_mfma_f32_16x16x32_bf16 v[36:39],a[220:223],v[108:111],v[36:39]
s_waitcnt lgkmcnt(3)
v_mul_f32 v189,v57,v58
v_mul_f32 v190,v209,v58
v_mfma_f32_16x16x32_bf16 v[32:35],a[224:227],v[112:115],v[32:35]
s_add_u32 s70,s70,32768
v_mul_f32 v59,v58,v58
v_mul_f32 v191,v208,v58
v_mfma_f32_16x16x32_bf16 v[36:39],a[228:231],v[112:115],v[36:39]
s_waitcnt lgkmcnt(2)
s_and_b32 s70,s70,0x1ffff
v_mul_f32 v191,v191,v59
v_mfma_f32_16x16x32_bf16 v[32:35],a[232:235],v[116:119],v[32:35]
s_add_u32 s55,s55,32768
s_and_b32 s55,s55,0x1ffff
v_add_u32 v4,s55,v8
v_mfma_f32_16x16x32_bf16 v[36:39],a[236:239],v[116:119],v[36:39]
s_waitcnt lgkmcnt(1)
v_add_u32 v5,s55,v9
v_add_u32 v6,s55,v10
v_mfma_f32_16x16x32_bf16 v[32:35],a[240:243],v[120:123],v[32:35]
v_add_u32 v7,s55,v11
v_mfma_f32_16x16x32_bf16 v[36:39],a[244:247],v[120:123],v[36:39]
s_waitcnt lgkmcnt(0)
s_waitcnt vmcnt(10)
ds_read_b128 v[64:67],v4 offset:0
v_mfma_f32_16x16x32_bf16 v[40:43],a[248:251],v[124:127],v[32:35]
s_waitcnt vmcnt(9)
ds_read_b128 v[68:71],v4 offset:1024
v_mfma_f32_16x16x32_bf16 v[44:47],a[252:255],v[124:127],v[36:39]
s_waitcnt vmcnt(2)
v_cmp_gt_u32 vcc,s53,v16
ds_read_b128 v[72:75],v4 offset:2048
s_add_u32 s60,s60,1
s_cbranch_vccz WR_315
WN_316:
s_waitcnt lgkmcnt(2)
v_mfma_f32_16x16x32_bf16 v[32:35],a[0:3],v[64:67],0
s_waitcnt vmcnt(6)
s_add_u32 s71,s60,2
ds_read_b128 v[76:79],v4 offset:3072
v_mfma_f32_16x16x32_bf16 v[36:39],a[4:7],v[64:67],0
s_add_u32 s53,s60,3
s_mov_b32 s57,s63
v_mfma_f32_16x16x32_bf16 v[48:51],v[12:15],v[64:67],0
v_fma_f32 v40,v152,v188,v40
v_fma_f32 v41,v153,v188,v41
v_mul_f32 v168,v40,v40
v_mfma_f32_16x16x32_bf16 v[52:55],v[64:67],v[64:67],0
s_waitcnt lgkmcnt(2)
v_mul_f32 v169,v41,v41
v_fma_f32 v168,v168,v191,v190
v_fma_f32 v169,v169,v191,v190
v_mfma_f32_16x16x32_bf16 v[32:35],a[8:11],v[68:71],v[32:35]
s_waitcnt vmcnt(5)
ds_read_b128 v[80:83],v4 offset:4096
v_mul_f32 v168,v168,v40
v_mul_f32 v169,v169,v41
v_mfma_f32_16x16x32_bf16 v[36:39],a[12:15],v[68:71],v[36:39]
v_exp_f32 v168,v168
v_fma_f32 v42,v154,v188,v42
v_mfma_f32_16x16x32_bf16 v[48:51],v[12:15],v[68:71],v[48:51]
v_exp_f32 v169,v169
v_fma_f32 v168,v168,v189,v189
v_mfma_f32_16x16x32_bf16 v[52:55],v[68:71],v[68:71],v[52:55]
s_waitcnt lgkmcnt(2)
v_rcp_f32 v168,v168
v_fma_f32 v169,v169,v189,v189
v_mfma_f32_16x16x32_bf16 v[32:35],a[16:19],v[72:75],v[32:35]
s_waitcnt vmcnt(4)
ds_read_b128 v[84:87],v4 offset:5120
v_rcp_f32 v169,v169
v_mfma_f32_16x16x32_bf16 v[36:39],a[20:23],v[72:75],v[36:39]
v_mul_f32 v40,v168,v40
v_mul_f32 v41,v169,v41
v_fma_f32 v43,v155,v188,v43
v_mfma_f32_16x16x32_bf16 v[48:51],v[12:15],v[72:75],v[48:51]
v_mul_f32 v170,v42,v42
v_mul_f32 v171,v43,v43
v_mfma_f32_16x16x32_bf16 v[52:55],v[72:75],v[72:75],v[52:55]
s_waitcnt lgkmcnt(2)
v_fma_f32 v170,v170,v191,v190
v_fma_f32 v171,v171,v191,v190
v_mfma_f32_16x16x32_bf16 v[32:35],a[24:27],v[76:79],v[32:35]
s_waitcnt vmcnt(3)
ds_read_b128 v[88:91],v4 offset:6144
v_mul_f32 v170,v170,v42
v_mfma_f32_16x16x32_bf16 v[36:39],a[28:31],v[76:79],v[36:39]
v_exp_f32 v170,v170
v_mfma_f32_16x16x32_bf16 v[48:51],v[12:15],v[76:79],v[48:51]
v_mul_f32 v171,v171,v43
v_fma_f32 v170,v170,v189,v189
v_mfma_f32_16x16x32_bf16 v[52:55],v[76:79],v[76:79],v[52:55]
s_waitcnt lgkmcnt(2)
v_exp_f32 v171,v171
v_mfma_f32_16x16x32_bf16 v[32:35],a[32:35],v[80:83],v[32:35]
s_waitcnt vmcnt(1)
ds_read_b128 v[92:95],v4 offset:7168
v_fma_f32 v171,v171,v189,v189
v_mfma_f32_16x16x32_bf16 v[36:39],a[36:39],v[80:83],v[36:39]
s_barrier
ds_read_b128 v[96:99],v5 offset:0
v_fma_f32 v44,v156,v188,v44
v_mfma_f32_16x16x32_bf16 v[48:51],v[12:15],v[80:83],v[48:51]
ds_read_b128 v[100:103],v5 offset:1024
v_fma_f32 v45,v157,v188,v45
v_mfma_f32_16x16x32_bf16 v[52:55],v[80:83],v[80:83],v[52:55]
s_waitcnt lgkmcnt(4)
ds_read_b128 v[104:107],v5 offset:2048
v_mul_f32 v172,v44,v44
v_mfma_f32_16x16x32_bf16 v[32:35],a[40:43],v[84:87],v[32:35]
ds_read_b128 v[108:111],v5 offset:3072
v_mul_f32 v173,v45,v45
v_mfma_f32_16x16x32_bf16 v[36:39],a[44:47],v[84:87],v[36:39]
s_waitcnt vmcnt(0)
v_mov_b32 v17,s57
buffer_store_dword v17,v26,s[20:23],s69 offen sc1
v_mfma_f32_16x16x32_bf16 v[48:51],v[12:15],v[84:87],v[48:51]
v_rcp_f32 v170,v170
v_mfma_f32_16x16x32_bf16 v[52:55],v[84:87],v[84:87],v[52:55]
s_waitcnt lgkmcnt(5)
v_rcp_f32 v171,v171
v_mfma_f32_16x16x32_bf16 v[32:35],a[48:51],v[88:91],v[32:35]
ds_read_b128 v[112:115],v5 offset:4096
v_mul_f32 v42,v170,v42
v_mfma_f32_16x16x32_bf16 v[36:39],a[52:55],v[88:91],v[36:39]
v_mul_f32 v43,v171,v43
v_fma_f32 v172,v172,v191,v190
v_mfma_f32_16x16x32_bf16 v[48:51],v[12:15],v[88:91],v[48:51]
v_fma_f32 v173,v173,v191,v190
v_mul_f32 v172,v172,v44
v_mfma_f32_16x16x32_bf16 v[52:55],v[88:91],v[88:91],v[52:55]
s_waitcnt lgkmcnt(5)
v_exp_f32 v172,v172
v_mfma_f32_16x16x32_bf16 v[32:35],a[56:59],v[92:95],v[32:35]
ds_read_b128 v[116:119],v5 offset:5120
v_mul_f32 v173,v173,v45
v_mfma_f32_16x16x32_bf16 v[36:39],a[60:63],v[92:95],v[36:39]
v_exp_f32 v173,v173
v_mfma_f32_16x16x32_bf16 v[48:51],v[12:15],v[92:95],v[48:51]
v_fma_f32 v172,v172,v189,v189
v_fma_f32 v173,v173,v189,v189
v_mfma_f32_16x16x32_bf16 v[52:55],v[92:95],v[92:95],v[52:55]
s_waitcnt lgkmcnt(5)
v_rcp_f32 v172,v172
v_mfma_f32_16x16x32_bf16 v[32:35],a[64:67],v[96:99],v[32:35]
ds_read_b128 v[120:123],v5 offset:6144
v_mul_f32 v44,v172,v44
v_mfma_f32_16x16x32_bf16 v[36:39],a[68:71],v[96:99],v[36:39]
s_waitcnt lgkmcnt(5)
v_rcp_f32 v173,v173
v_mfma_f32_16x16x32_bf16 v[32:35],a[72:75],v[100:103],v[32:35]
ds_read_b128 v[124:127],v5 offset:7168
v_mul_f32 v45,v173,v45
v_mfma_f32_16x16x32_bf16 v[36:39],a[76:79],v[100:103],v[36:39]
s_waitcnt lgkmcnt(5)
v_fma_f32 v46,v158,v188,v46
v_fma_f32 v47,v159,v188,v47
v_mfma_f32_16x16x32_bf16 v[32:35],a[80:83],v[104:107],v[32:35]
ds_read_b128 v[64:67],v6 offset:0
v_cndmask_b32 v49,v52,v53,s[74:75]
v_mfma_f32_16x16x32_bf16 v[36:39],a[84:87],v[104:107],v[36:39]
s_waitcnt lgkmcnt(5)
v_cndmask_b32 v49,v49,v54,s[76:77]
v_cndmask_b32 v49,v49,v55,s[78:79]
v_mfma_f32_16x16x32_bf16 v[32:35],a[88:91],v[108:111],v[32:35]
ds_read_b128 v[68:71],v6 offset:1024
v_mul_f32 v174,v46,v46
v_mfma_f32_16x16x32_bf16 v[36:39],a[92:95],v[108:111],v[36:39]
s_waitcnt lgkmcnt(5)
ds_write_b64 v19,v[48:49]
v_mfma_f32_16x16x32_bf16 v[32:35],a[96:99],v[112:115],v[32:35]
ds_read_b128 v[72:75],v6 offset:2048
v_mul_f32 v175,v47,v47
v_mfma_f32_16x16x32_bf16 v[36:39],a[100:103],v[112:115],v[36:39]
s_waitcnt lgkmcnt(6)
v_fma_f32 v174,v174,v191,v190
v_fma_f32 v175,v175,v191,v190
v_mfma_f32_16x16x32_bf16 v[32:35],a[104:107],v[116:119],v[32:35]
ds_read_b128 v[76:79],v6 offset:3072
v_mul_f32 v174,v174,v46
v_mfma_f32_16x16x32_bf16 v[36:39],a[108:111],v[116:119],v[36:39]
s_waitcnt lgkmcnt(6)
v_exp_f32 v174,v174
v_mfma_f32_16x16x32_bf16 v[32:35],a[112:115],v[120:123],v[32:35]
s_waitcnt lgkmcnt(2)
s_barrier
ds_read_b128 v[80:83],v6 offset:4096
v_mfma_f32_16x16x32_bf16 v[36:39],a[116:119],v[120:123],v[36:39]
ds_read_b64 v[56:57],v20 offset:0
v_mul_f32 v175,v175,v47
v_mfma_f32_16x16x32_bf16 v[32:35],a[120:123],v[124:127],v[32:35]
ds_read_b128 v[84:87],v6 offset:5120
v_fma_f32 v174,v174,v189,v189
v_mfma_f32_16x16x32_bf16 v[36:39],a[124:127],v[124:127],v[36:39]
ds_read_b64 v[58:59],v20 offset:512
v_cvt_pk_bf16_f32 v176,v40,v41
v_mfma_f32_16x16x32_bf16 v[32:35],a[128:131],v[64:67],v[32:35]
ds_read_b128 v[88:91],v6 offset:6144
v_cvt_pk_bf16_f32 v177,v42,v43
v_mfma_f32_16x16x32_bf16 v[36:39],a[132:135],v[64:67],v[36:39]
ds_read_b64 v[60:61],v20 offset:1024
v_cvt_pk_bf16_f32 v178,v44,v45
v_mfma_f32_16x16x32_bf16 v[32:35],a[136:139],v[68:71],v[32:35]
ds_read_b128 v[92:95],v6 offset:7168
v_mfma_f32_16x16x32_bf16 v[36:39],a[140:143],v[68:71],v[36:39]
s_waitcnt lgkmcnt(8)
ds_read_b64 v[62:63],v20 offset:1536
v_mfma_f32_16x16x32_bf16 v[32:35],a[144:147],v[72:75],v[32:35]
ds_read_b128 v[96:99],v7 offset:0
v_mfma_f32_16x16x32_bf16 v[36:39],a[148:151],v[72:75],v[36:39]
s_waitcnt lgkmcnt(9)
buffer_load_dword v16,v2,s[20:23],s68 offen sc1
v_mfma_f32_16x16x32_bf16 v[32:35],a[152:155],v[76:79],v[32:35]
ds_read_b128 v[100:103],v7 offset:1024
v_mfma_f32_16x16x32_bf16 v[36:39],a[156:159],v[76:79],v[36:39]
s_waitcnt lgkmcnt(9)
v_exp_f32 v175,v175
v_mfma_f32_16x16x32_bf16 v[32:35],a[160:163],v[80:83],v[32:35]
ds_read_b128 v[104:107],v7 offset:2048
v_fma_f32 v175,v175,v189,v189
v_mfma_f32_16x16x32_bf16 v[36:39],a[164:167],v[80:83],v[36:39]
s_waitcnt lgkmcnt(8)
s_waitcnt lgkmcnt(3)
v_rcp_f32 v174,v174
v_mfma_f32_16x16x32_bf16 v[32:35],a[168:171],v[84:87],v[32:35]
ds_read_b128 v[108:111],v7 offset:3072
v_mul_f32 v46,v174,v46
v_mfma_f32_16x16x32_bf16 v[36:39],a[172:175],v[84:87],v[36:39]
v_rcp_f32 v175,v175
v_mfma_f32_16x16x32_bf16 v[32:35],a[176:179],v[88:91],v[32:35]
ds_read_b128 v[112:115],v7 offset:4096
v_mul_f32 v47,v175,v47
v_mfma_f32_16x16x32_bf16 v[36:39],a[180:183],v[88:91],v[36:39]
v_cvt_pk_bf16_f32 v179,v46,v47
v_add_f32 v56,v56,v58
v_mfma_f32_16x16x32_bf16 v[32:35],a[184:187],v[92:95],v[32:35]
ds_read_b128 v[116:119],v7 offset:5120
v_add_f32 v57,v57,v59
v_mfma_f32_16x16x32_bf16 v[36:39],a[188:191],v[92:95],v[36:39]
s_waitcnt lgkmcnt(5)
buffer_store_dwordx4 v[176:179],v0,s[20:23],s66 offen sc1
v_mfma_f32_16x16x32_bf16 v[32:35],a[192:195],v[96:99],v[32:35]
s_add_u32 s66,s66,32768
s_add_u32 s63,s63,1
ds_read_b128 v[120:123],v7 offset:6144
v_mfma_f32_16x16x32_bf16 v[36:39],a[196:199],v[96:99],v[36:39]
s_waitcnt lgkmcnt(5)
v_add_f32 v60,v60,v62
v_add_f32 v61,v61,v63
v_mfma_f32_16x16x32_bf16 v[32:35],a[200:203],v[100:103],v[32:35]
ds_read_b128 v[124:127],v7 offset:7168
v_add_f32 v56,v56,v60
v_mfma_f32_16x16x32_bf16 v[36:39],a[204:207],v[100:103],v[36:39]
s_waitcnt lgkmcnt(5)
v_add_f32 v57,v57,v61
v_mul_f32 v188,0xba800000,v56
v_mfma_f32_16x16x32_bf16 v[32:35],a[208:211],v[104:107],v[32:35]
s_add_u32 s55,s55,32768
v_fma_f32 v58,v188,v188,-v210
v_fma_f32 v57,v57,v211,-v58
v_mfma_f32_16x16x32_bf16 v[36:39],a[212:215],v[104:107],v[36:39]
s_waitcnt lgkmcnt(4)
s_and_b32 s55,s55,0x1ffff
v_max_f32 v57,v210,v57
v_mfma_f32_16x16x32_bf16 v[32:35],a[216:219],v[108:111],v[32:35]
v_rsq_f32 v58,v57
v_mfma_f32_16x16x32_bf16 v[36:39],a[220:223],v[108:111],v[36:39]
s_waitcnt lgkmcnt(3)
v_mul_f32 v189,v57,v58
v_mul_f32 v190,v209,v58
v_mfma_f32_16x16x32_bf16 v[32:35],a[224:227],v[112:115],v[32:35]
v_mul_f32 v59,v58,v58
v_mul_f32 v191,v208,v58
v_mfma_f32_16x16x32_bf16 v[36:39],a[228:231],v[112:115],v[36:39]
s_waitcnt lgkmcnt(2)
v_mul_f32 v191,v191,v59
v_add_u32 v4,s55,v8
v_mfma_f32_16x16x32_bf16 v[32:35],a[232:235],v[116:119],v[32:35]
v_add_u32 v5,s55,v9
v_add_u32 v6,s55,v10
v_mfma_f32_16x16x32_bf16 v[36:39],a[236:239],v[116:119],v[36:39]
s_waitcnt lgkmcnt(1)
v_add_u32 v7,s55,v11
v_mfma_f32_16x16x32_bf16 v[32:35],a[240:243],v[120:123],v[32:35]
v_mfma_f32_16x16x32_bf16 v[36:39],a[244:247],v[120:123],v[36:39]
s_waitcnt lgkmcnt(0)
v_mfma_f32_16x16x32_bf16 v[40:43],a[248:251],v[124:127],v[32:35]
v_mfma_f32_16x16x32_bf16 v[44:47],a[252:255],v[124:127],v[36:39]
s_waitcnt vmcnt(1)
v_cmp_gt_u32 vcc,s71,v16
s_add_u32 s60,s60,1
s_branch endN_324
BN_318:
s_waitcnt vmcnt(9)
ds_read_b128 v[64:67],v4 offset:0
s_waitcnt vmcnt(8)
ds_read_b128 v[68:71],v4 offset:1024
s_waitcnt vmcnt(7)
ds_read_b128 v[72:75],v4 offset:2048
s_waitcnt vmcnt(6)
ds_read_b128 v[76:79],v4 offset:3072
s_waitcnt lgkmcnt(3)
v_mfma_f32_16x16x32_bf16 v[32:35],a[0:3],v[64:67],0
s_add_u32 s71,s60,2
s_add_u32 s53,s60,3
s_mov_b32 s57,s63
v_mfma_f32_16x16x32_bf16 v[36:39],a[4:7],v[64:67],0
v_mfma_f32_16x16x32_bf16 v[48:51],v[12:15],v[64:67],0
v_mfma_f32_16x16x32_bf16 v[52:55],v[64:67],v[64:67],0
s_waitcnt lgkmcnt(2)
s_waitcnt vmcnt(5)
ds_read_b128 v[80:83],v4 offset:4096
v_mfma_f32_16x16x32_bf16 v[32:35],a[8:11],v[68:71],v[32:35]
v_mfma_f32_16x16x32_bf16 v[36:39],a[12:15],v[68:71],v[36:39]
v_mfma_f32_16x16x32_bf16 v[48:51],v[12:15],v[68:71],v[48:51]
v_mfma_f32_16x16x32_bf16 v[52:55],v[68:71],v[68:71],v[52:55]
s_waitcnt lgkmcnt(2)
s_waitcnt vmcnt(4)
ds_read_b128 v[84:87],v4 offset:5120
v_mfma_f32_16x16x32_bf16 v[32:35],a[16:19],v[72:75],v[32:35]
v_mfma_f32_16x16x32_bf16 v[36:39],a[20:23],v[72:75],v[36:39]
v_mfma_f32_16x16x32_bf16 v[48:51],v[12:15],v[72:75],v[48:51]
v_mfma_f32_16x16x32_bf16 v[52:55],v[72:75],v[72:75],v[52:55]
s_waitcnt lgkmcnt(2)
s_waitcnt vmcnt(3)
ds_read_b128 v[88:91],v4 offset:6144
v_mfma_f32_16x16x32_bf16 v[32:35],a[24:27],v[76:79],v[32:35]
v_mfma_f32_16x16x32_bf16 v[36:39],a[28:31],v[76:79],v[36:39]
v_mfma_f32_16x16x32_bf16 v[48:51],v[12:15],v[76:79],v[48:51]
v_mfma_f32_16x16x32_bf16 v[52:55],v[76:79],v[76:79],v[52:55]
s_waitcnt lgkmcnt(2)
s_waitcnt vmcnt(2)
ds_read_b128 v[92:95],v4 offset:7168
v_mfma_f32_16x16x32_bf16 v[32:35],a[32:35],v[80:83],v[32:35]
v_mfma_f32_16x16x32_bf16 v[36:39],a[36:39],v[80:83],v[36:39]
v_mfma_f32_16x16x32_bf16 v[48:51],v[12:15],v[80:83],v[48:51]
v_mfma_f32_16x16x32_bf16 v[52:55],v[80:83],v[80:83],v[52:55]
s_waitcnt lgkmcnt(2)
s_barrier
ds_read_b128 v[96:99],v5 offset:0
v_mfma_f32_16x16x32_bf16 v[32:35],a[40:43],v[84:87],v[32:35]
ds_read_b128 v[100:103],v5 offset:1024
v_mfma_f32_16x16x32_bf16 v[36:39],a[44:47],v[84:87],v[36:39]
ds_read_b128 v[104:107],v5 offset:2048
v_mfma_f32_16x16x32_bf16 v[48:51],v[12:15],v[84:87],v[48:51]
ds_read_b128 v[108:111],v5 offset:3072
v_mfma_f32_16x16x32_bf16 v[52:55],v[84:87],v[84:87],v[52:55]
s_waitcnt lgkmcnt(5)
v_mfma_f32_16x16x32_bf16 v[32:35],a[48:51],v[88:91],v[32:35]
ds_read_b128 v[112:115],v5 offset:4096
v_mfma_f32_16x16x32_bf16 v[36:39],a[52:55],v[88:91],v[36:39]
v_mfma_f32_16x16x32_bf16 v[48:51],v[12:15],v[88:91],v[48:51]
v_mfma_f32_16x16x32_bf16 v[52:55],v[88:91],v[88:91],v[52:55]
s_waitcnt lgkmcnt(5)
v_mfma_f32_16x16x32_bf16 v[32:35],a[56:59],v[92:95],v[32:35]
ds_read_b128 v[116:119],v5 offset:5120
v_mfma_f32_16x16x32_bf16 v[36:39],a[60:63],v[92:95],v[36:39]
v_mfma_f32_16x16x32_bf16 v[48:51],v[12:15],v[92:95],v[48:51]
v_mfma_f32_16x16x32_bf16 v[52:55],v[92:95],v[92:95],v[52:55]
s_waitcnt lgkmcnt(5)
v_mfma_f32_16x16x32_bf16 v[32:35],a[64:67],v[96:99],v[32:35]
ds_read_b128 v[120:123],v5 offset:6144
v_mfma_f32_16x16x32_bf16 v[36:39],a[68:71],v[96:99],v[36:39]
s_waitcnt lgkmcnt(5)
v_mfma_f32_16x16x32_bf16 v[32:35],a[72:75],v[100:103],v[32:35]
ds_read_b128 v[124:127],v5 offset:7168
v_mfma_f32_16x16x32_bf16 v[36:39],a[76:79],v[100:103],v[36:39]
s_waitcnt lgkmcnt(5)
v_mfma_f32_16x16x32_bf16 v[32:35],a[80:83],v[104:107],v[32:35]
ds_read_b128 v[64:67],v6 offset:0
v_cndmask_b32 v49,v52,v53,s[74:75]
v_mfma_f32_16x16x32_bf16 v[36:39],a[84:87],v[104:107],v[36:39]
s_waitcnt lgkmcnt(5)
v_cndmask_b32 v49,v49,v54,s[76:77]
v_cndmask_b32 v49,v49,v55,s[78:79]
v_mfma_f32_16x16x32_bf16 v[32:35],a[88:91],v[108:111],v[32:35]
ds_read_b128 v[68:71],v6 offset:1024
v_mfma_f32_16x16x32_bf16 v[36:39],a[92:95],v[108:111],v[36:39]
s_waitcnt lgkmcnt(5)
ds_write_b64 v19,v[48:49]
v_mfma_f32_16x16x32_bf16 v[32:35],a[96:99],v[112:115],v[32:35]
ds_read_b128 v[72:75],v6 offset:2048
v_mfma_f32_16x16x32_bf16 v[36:39],a[100:103],v[112:115],v[36:39]
s_waitcnt lgkmcnt(6)
v_mfma_f32_16x16x32_bf16 v[32:35],a[104:107],v[116:119],v[32:35]
ds_read_b128 v[76:79],v6 offset:3072
v_mfma_f32_16x16x32_bf16 v[36:39],a[108:111],v[116:119],v[36:39]
s_waitcnt lgkmcnt(6)
v_mfma_f32_16x16x32_bf16 v[32:35],a[112:115],v[120:123],v[32:35]
s_waitcnt lgkmcnt(2)
s_barrier
ds_read_b128 v[80:83],v6 offset:4096
v_mfma_f32_16x16x32_bf16 v[36:39],a[116:119],v[120:123],v[36:39]
ds_read_b64 v[56:57],v20 offset:0
v_mfma_f32_16x16x32_bf16 v[32:35],a[120:123],v[124:127],v[32:35]
ds_read_b128 v[84:87],v6 offset:5120
v_mfma_f32_16x16x32_bf16 v[36:39],a[124:127],v[124:127],v[36:39]
ds_read_b64 v[58:59],v20 offset:512
v_mfma_f32_16x16x32_bf16 v[32:35],a[128:131],v[64:67],v[32:35]
ds_read_b128 v[88:91],v6 offset:6144
v_mfma_f32_16x16x32_bf16 v[36:39],a[132:135],v[64:67],v[36:39]
ds_read_b64 v[60:61],v20 offset:1024
v_mfma_f32_16x16x32_bf16 v[32:35],a[136:139],v[68:71],v[32:35]
ds_read_b128 v[92:95],v6 offset:7168
v_mfma_f32_16x16x32_bf16 v[36:39],a[140:143],v[68:71],v[36:39]
s_waitcnt lgkmcnt(8)
ds_read_b64 v[62:63],v20 offset:1536
v_mfma_f32_16x16x32_bf16 v[32:35],a[144:147],v[72:75],v[32:35]
ds_read_b128 v[96:99],v7 offset:0
v_mfma_f32_16x16x32_bf16 v[36:39],a[148:151],v[72:75],v[36:39]
s_waitcnt lgkmcnt(9)
buffer_load_dword v16,v2,s[20:23],s68 offen sc1
v_mfma_f32_16x16x32_bf16 v[32:35],a[152:155],v[76:79],v[32:35]
ds_read_b128 v[100:103],v7 offset:1024
v_mfma_f32_16x16x32_bf16 v[36:39],a[156:159],v[76:79],v[36:39]
s_waitcnt lgkmcnt(9)
s_waitcnt vmcnt(2)
v_mov_b32 v17,s57
buffer_store_dword v17,v26,s[20:23],s69 offen sc1
v_mfma_f32_16x16x32_bf16 v[32:35],a[160:163],v[80:83],v[32:35]
ds_read_b128 v[104:107],v7 offset:2048
v_mfma_f32_16x16x32_bf16 v[36:39],a[164:167],v[80:83],v[36:39]
s_waitcnt lgkmcnt(8)
s_waitcnt lgkmcnt(3)
v_add_f32 v56,v56,v58
v_mfma_f32_16x16x32_bf16 v[32:35],a[168:171],v[84:87],v[32:35]
ds_read_b128 v[108:111],v7 offset:3072
v_add_f32 v57,v57,v59
v_mfma_f32_16x16x32_bf16 v[36:39],a[172:175],v[84:87],v[36:39]
v_add_f32 v60,v60,v62
v_add_f32 v61,v61,v63
v_mfma_f32_16x16x32_bf16 v[32:35],a[176:179],v[88:91],v[32:35]
ds_read_b128 v[112:115],v7 offset:4096
v_add_f32 v56,v56,v60
v_mfma_f32_16x16x32_bf16 v[36:39],a[180:183],v[88:91],v[36:39]
v_add_f32 v57,v57,v61
v_mul_f32 v188,0xba800000,v56
v_mfma_f32_16x16x32_bf16 v[32:35],a[184:187],v[92:95],v[32:35]
ds_read_b128 v[116:119],v7 offset:5120
v_fma_f32 v58,v188,v188,-v210
v_mfma_f32_16x16x32_bf16 v[36:39],a[188:191],v[92:95],v[36:39]
s_waitcnt lgkmcnt(5)
v_fma_f32 v57,v57,v211,-v58
v_max_f32 v57,v210,v57
v_mfma_f32_16x16x32_bf16 v[32:35],a[192:195],v[96:99],v[32:35]
ds_read_b128 v[120:123],v7 offset:6144
v_mfma_f32_16x16x32_bf16 v[36:39],a[196:199],v[96:99],v[36:39]
s_waitcnt lgkmcnt(5)
v_rsq_f32 v58,v57
v_mfma_f32_16x16x32_bf16 v[32:35],a[200:203],v[100:103],v[32:35]
ds_read_b128 v[124:127],v7 offset:7168
v_mul_f32 v189,v57,v58
v_mfma_f32_16x16x32_bf16 v[36:39],a[204:207],v[100:103],v[36:39]
s_waitcnt lgkmcnt(5)
v_mul_f32 v190,v209,v58
v_mul_f32 v59,v58,v58
v_mfma_f32_16x16x32_bf16 v[32:35],a[208:211],v[104:107],v[32:35]
s_add_u32 s55,s55,32768
v_mul_f32 v191,v208,v58
v_mul_f32 v191,v191,v59
v_mfma_f32_16x16x32_bf16 v[36:39],a[212:215],v[104:107],v[36:39]
s_waitcnt lgkmcnt(4)
s_and_b32 s55,s55,0x1ffff
v_add_u32 v4,s55,v8
v_mfma_f32_16x16x32_bf16 v[32:35],a[216:219],v[108:111],v[32:35]
v_add_u32 v5,s55,v9
v_add_u32 v6,s55,v10
v_mfma_f32_16x16x32_bf16 v[36:39],a[220:223],v[108:111],v[36:39]
s_waitcnt lgkmcnt(3)
v_add_u32 v7,s55,v11
v_mfma_f32_16x16x32_bf16 v[32:35],a[224:227],v[112:115],v[32:35]
v_mfma_f32_16x16x32_bf16 v[36:39],a[228:231],v[112:115],v[36:39]
s_waitcnt lgkmcnt(2)
v_mfma_f32_16x16x32_bf16 v[32:35],a[232:235],v[116:119],v[32:35]
v_mfma_f32_16x16x32_bf16 v[36:39],a[236:239],v[116:119],v[36:39]
s_waitcnt lgkmcnt(1)
v_mfma_f32_16x16x32_bf16 v[32:35],a[240:243],v[120:123],v[32:35]
v_mfma_f32_16x16x32_bf16 v[36:39],a[244:247],v[120:123],v[36:39]
s_waitcnt lgkmcnt(0)
v_mfma_f32_16x16x32_bf16 v[40:43],a[248:251],v[124:127],v[32:35]
v_mfma_f32_16x16x32_bf16 v[44:47],a[252:255],v[124:127],v[36:39]
s_waitcnt vmcnt(1)
v_cmp_gt_u32 vcc,s71,v16
s_add_u32 s60,s60,1
endN_324:
s_cbranch_vccnz nb_321
s_mov_b32 m0,s70
s_nop 0
buffer_load_dwordx4 v3,s[20:23],s61 offen offset:0 lds
buffer_load_dwordx4 v3,s[20:23],s61 offen offset:1024 lds
buffer_load_dwordx4 v3,s[20:23],s61 offen offset:2048 lds
buffer_load_dwordx4 v3,s[20:23],s61 offen offset:3072 lds
s_add_u32 m0,s70,4096
s_nop 0
buffer_load_dwordx4 v3,s[20:23],s62 offen offset:0 lds
buffer_load_dwordx4 v3,s[20:23],s62 offen offset:1024 lds
buffer_load_dwordx4 v3,s[20:23],s62 offen offset:2048 lds
buffer_load_dwordx4 v3,s[20:23],s62 offen offset:3072 lds
s_add_u32 s61,s61,32768
s_add_u32 s62,s62,32768
s_add_u32 s70,s70,32768
s_and_b32 s70,s70,0x1ffff
s_mov_b32 s57,s63
v_pk_fma_f32 v[40:41],v[152:153],v[188:189],v[40:41] op_sel_hi:[1,0,1]
v_pk_fma_f32 v[42:43],v[154:155],v[188:189],v[42:43] op_sel_hi:[1,0,1]
v_pk_fma_f32 v[44:45],v[156:157],v[188:189],v[44:45] op_sel_hi:[1,0,1]
v_pk_fma_f32 v[46:47],v[158:159],v[188:189],v[46:47] op_sel_hi:[1,0,1]
v_pk_mul_f32 v[168:169],v[40:41],v[40:41]
v_pk_mul_f32 v[170:171],v[42:43],v[42:43]
v_pk_mul_f32 v[172:173],v[44:45],v[44:45]
v_pk_mul_f32 v[174:175],v[46:47],v[46:47]
v_pk_fma_f32 v[168:169],v[168:169],v[190:191],v[190:191] op_sel:[0,1,0] op_sel_hi:[1,1,0]
v_pk_fma_f32 v[170:171],v[170:171],v[190:191],v[190:191] op_sel:[0,1,0] op_sel_hi:[1,1,0]
v_pk_fma_f32 v[172:173],v[172:173],v[190:191],v[190:191] op_sel:[0,1,0] op_sel_hi:[1,1,0]
v_pk_fma_f32 v[174:175],v[174:175],v[190:191],v[190:191] op_sel:[0,1,0] op_sel_hi:[1,1,0]
v_pk_mul_f32 v[168:169],v[168:169],v[40:41]
v_pk_mul_f32 v[170:171],v[170:171],v[42:43]
v_pk_mul_f32 v[172:173],v[172:173],v[44:45]
v_pk_mul_f32 v[174:175],v[174:175],v[46:47]
v_exp_f32 v168,v168
v_exp_f32 v169,v169
v_exp_f32 v170,v170
v_exp_f32 v171,v171
v_exp_f32 v172,v172
v_exp_f32 v173,v173
v_exp_f32 v174,v174
v_exp_f32 v175,v175
v_pk_fma_f32 v[168:169],v[168:169],v[188:189],v[188:189] op_sel:[0,1,1] op_sel_hi:[1,1,1]
v_pk_fma_f32 v[170:171],v[170:171],v[188:189],v[188:189] op_sel:[0,1,1] op_sel_hi:[1,1,1]
v_pk_fma_f32 v[172:173],v[172:173],v[188:189],v[188:189] op_sel:[0,1,1] op_sel_hi:[1,1,1]
v_pk_fma_f32 v[174:175],v[174:175],v[188:189],v[188:189] op_sel:[0,1,1] op_sel_hi:[1,1,1]
v_rcp_f32 v168,v168
v_rcp_f32 v169,v169
v_rcp_f32 v170,v170
v_rcp_f32 v171,v171
v_rcp_f32 v172,v172
v_rcp_f32 v173,v173
v_rcp_f32 v174,v174
v_rcp_f32 v175,v175
v_pk_mul_f32 v[40:41],v[168:169],v[40:41]
v_pk_mul_f32 v[42:43],v[170:171],v[42:43]
v_pk_mul_f32 v[44:45],v[172:173],v[44:45]
v_pk_mul_f32 v[46:47],v[174:175],v[46:47]
v_cvt_pk_bf16_f32 v176,v40,v41
v_cvt_pk_bf16_f32 v177,v42,v43
v_cvt_pk_bf16_f32 v178,v44,v45
v_cvt_pk_bf16_f32 v179,v46,v47
buffer_store_dwordx4 v[176:179],v0,s[20:23],s66 offen sc1
s_add_u32 s66,s66,32768
s_add_u32 s63,s63,1
s_waitcnt vmcnt(9)
v_mov_b32 v17,s57
buffer_store_dword v17,v26,s[20:23],s69 offen sc1
s_branch dec_320
nb_321:
buffer_load_dword v16,v2,s[20:23],s68 offen sc1
s_nop 3
s_mov_b32 s57,s63
v_pk_fma_f32 v[40:41],v[152:153],v[188:189],v[40:41] op_sel_hi:[1,0,1]
v_pk_fma_f32 v[42:43],v[154:155],v[188:189],v[42:43] op_sel_hi:[1,0,1]
v_pk_fma_f32 v[44:45],v[156:157],v[188:189],v[44:45] op_sel_hi:[1,0,1]
v_pk_fma_f32 v[46:47],v[158:159],v[188:189],v[46:47] op_sel_hi:[1,0,1]
v_pk_mul_f32 v[168:169],v[40:41],v[40:41]
v_pk_mul_f32 v[170:171],v[42:43],v[42:43]
v_pk_mul_f32 v[172:173],v[44:45],v[44:45]
v_pk_mul_f32 v[174:175],v[46:47],v[46:47]
v_pk_fma_f32 v[168:169],v[168:169],v[190:191],v[190:191] op_sel:[0,1,0] op_sel_hi:[1,1,0]
v_pk_fma_f32 v[170:171],v[170:171],v[190:191],v[190:191] op_sel:[0,1,0] op_sel_hi:[1,1,0]
v_pk_fma_f32 v[172:173],v[172:173],v[190:191],v[190:191] op_sel:[0,1,0] op_sel_hi:[1,1,0]
v_pk_fma_f32 v[174:175],v[174:175],v[190:191],v[190:191] op_sel:[0,1,0] op_sel_hi:[1,1,0]
v_pk_mul_f32 v[168:169],v[168:169],v[40:41]
v_pk_mul_f32 v[170:171],v[170:171],v[42:43]
v_pk_mul_f32 v[172:173],v[172:173],v[44:45]
v_pk_mul_f32 v[174:175],v[174:175],v[46:47]
v_exp_f32 v168,v168
v_exp_f32 v169,v169
v_exp_f32 v170,v170
v_exp_f32 v171,v171
v_exp_f32 v172,v172
v_exp_f32 v173,v173
v_exp_f32 v174,v174
v_exp_f32 v175,v175
v_pk_fma_f32 v[168:169],v[168:169],v[188:189],v[188:189] op_sel:[0,1,1] op_sel_hi:[1,1,1]
v_pk_fma_f32 v[170:171],v[170:171],v[188:189],v[188:189] op_sel:[0,1,1] op_sel_hi:[1,1,1]
v_pk_fma_f32 v[172:173],v[172:173],v[188:189],v[188:189] op_sel:[0,1,1] op_sel_hi:[1,1,1]
v_pk_fma_f32 v[174:175],v[174:175],v[188:189],v[188:189] op_sel:[0,1,1] op_sel_hi:[1,1,1]
v_rcp_f32 v168,v168
v_rcp_f32 v169,v169
v_rcp_f32 v170,v170
v_rcp_f32 v171,v171
v_rcp_f32 v172,v172
v_rcp_f32 v173,v173
v_rcp_f32 v174,v174
v_rcp_f32 v175,v175
v_pk_mul_f32 v[40:41],v[168:169],v[40:41]
v_pk_mul_f32 v[42:43],v[170:171],v[42:43]
v_pk_mul_f32 v[44:45],v[172:173],v[44:45]
v_pk_mul_f32 v[46:47],v[174:175],v[46:47]
v_cvt_pk_bf16_f32 v176,v40,v41
v_cvt_pk_bf16_f32 v177,v42,v43
v_cvt_pk_bf16_f32 v178,v44,v45
v_cvt_pk_bf16_f32 v179,v46,v47
buffer_store_dwordx4 v[176:179],v0,s[20:23],s66 offen sc1
s_add_u32 s66,s66,32768
s_add_u32 s63,s63,1
s_waitcnt vmcnt(2)
v_mov_b32 v17,s57
buffer_store_dword v17,v26,s[20:23],s69 offen sc1
s_waitcnt vmcnt(2)
v_cmp_gt_u32 vcc,s71,v16
s_cbranch_vccz lag_319
s_waitcnt vmcnt(1)
v_mov_b32 v17,s63
buffer_store_dword v17,v26,s[20:23],s69 offen sc1
s_cmp_ge_u32 s60,128
s_cbranch_scc1 done_295
plp_325:
buffer_load_dword v16,v2,s[20:23],s68 offen sc1
s_waitcnt vmcnt(0)
v_cmp_gt_u32 vcc,s71,v16
s_cbranch_vccz pok_326
s_sleep 4
s_sub_u32 s90,s90,1
s_cmp_gt_i32 s90,0
s_cbranch_scc1 plp_325
pok_326:
s_branch lag_319
done_295:
s_endpgm
fl_w2:
v_and_b32 v21,15,v1
v_lshrrev_b32 v22,4,v1
v_lshrrev_b32 v23,2,v21
v_and_b32 v24,3,v21
s_lshl_b32 s61,s50,15
v_lshl_add_u32 v25,v22,3,v23
s_load_dwordx2 s[4:5],s[0:1],72
s_mov_b32 s52,0
s_mov_b32 s53,s59
s_mul_i32 s54,s52,2097152
s_lshl_b32 s64,s53,8
s_add_u32 s54,s54,s64
s_lshl_b32 s64,s50,6
s_add_u32 s54,s54,s64
s_waitcnt lgkmcnt(0)
s_mov_b32 s28,s4
s_and_b32 s29,s5,0xffff
s_mov_b32 s30,0x200000
s_mov_b32 s31,0x20000
v_lshrrev_b32 v26,2,v1
v_and_b32 v27,3,v1
v_mul_u32_u24 v16,2048,v26
v_lshl_add_u32 v16,v27,4,v16
v_lshlrev_b32 v17,6,v25
v_lshl_add_u32 v17,v24,4,v17
v_add_u32 v17,s61,v17
s_xor_b32 s62,s50,0
s_mul_i32 s62,s62,524288
s_add_u32 s62,s62,s54
s_add_u32 m0,s61,0
s_nop 0
buffer_load_dwordx4 v16,s[28:31],s62 offen lds
s_add_u32 s62,s62,32768
s_add_u32 m0,m0,1024
s_waitcnt vmcnt(2)
buffer_load_dwordx4 v16,s[28:31],s62 offen lds
s_add_u32 s62,s62,32768
s_add_u32 m0,m0,1024
s_waitcnt vmcnt(2)
buffer_load_dwordx4 v16,s[28:31],s62 offen lds
s_add_u32 s62,s62,32768
s_add_u32 m0,m0,1024
s_waitcnt vmcnt(2)
buffer_load_dwordx4 v16,s[28:31],s62 offen lds
s_add_u32 s62,s62,32768
s_add_u32 m0,m0,1024
s_waitcnt vmcnt(2)
buffer_load_dwordx4 v16,s[28:31],s62 offen lds
s_add_u32 s62,s62,32768
s_add_u32 m0,m0,1024
s_waitcnt vmcnt(2)
buffer_load_dwordx4 v16,s[28:31],s62 offen lds
s_add_u32 s62,s62,32768
s_add_u32 m0,m0,1024
s_waitcnt vmcnt(2)
buffer_load_dwordx4 v16,s[28:31],s62 offen lds
s_add_u32 s62,s62,32768
s_add_u32 m0,m0,1024
s_waitcnt vmcnt(2)
buffer_load_dwordx4 v16,s[28:31],s62 offen lds
s_add_u32 s62,s62,32768
s_add_u32 m0,m0,1024
s_waitcnt vmcnt(2)
buffer_load_dwordx4 v16,s[28:31],s62 offen lds
s_add_u32 s62,s62,32768
s_add_u32 m0,m0,1024
s_waitcnt vmcnt(2)
buffer_load_dwordx4 v16,s[28:31],s62 offen lds
s_add_u32 s62,s62,32768
s_add_u32 m0,m0,1024
s_waitcnt vmcnt(2)
buffer_load_dwordx4 v16,s[28:31],s62 offen lds
s_add_u32 s62,s62,32768
s_add_u32 m0,m0,1024
s_waitcnt vmcnt(2)
buffer_load_dwordx4 v16,s[28:31],s62 offen lds
s_add_u32 s62,s62,32768
s_add_u32 m0,m0,1024
s_waitcnt vmcnt(2)
buffer_load_dwordx4 v16,s[28:31],s62 offen lds
s_add_u32 s62,s62,32768
s_add_u32 m0,m0,1024
s_waitcnt vmcnt(2)
buffer_load_dwordx4 v16,s[28:31],s62 offen lds
s_add_u32 s62,s62,32768
s_add_u32 m0,m0,1024
s_waitcnt vmcnt(2)
buffer_load_dwordx4 v16,s[28:31],s62 offen lds
s_add_u32 s62,s62,32768
s_add_u32 m0,m0,1024
s_waitcnt vmcnt(2)
buffer_load_dwordx4 v16,s[28:31],s62 offen lds
s_waitcnt vmcnt(2)
s_xor_b32 s62,s50,1
s_mul_i32 s62,s62,524288
s_add_u32 s62,s62,s54
s_add_u32 m0,s61,16384
s_nop 0
buffer_load_dwordx4 v16,s[28:31],s62 offen lds
s_add_u32 s62,s62,32768
s_add_u32 m0,m0,1024
s_waitcnt vmcnt(2)
buffer_load_dwordx4 v16,s[28:31],s62 offen lds
s_add_u32 s62,s62,32768
s_add_u32 m0,m0,1024
s_waitcnt vmcnt(2)
buffer_load_dwordx4 v16,s[28:31],s62 offen lds
s_add_u32 s62,s62,32768
s_add_u32 m0,m0,1024
s_waitcnt vmcnt(2)
buffer_load_dwordx4 v16,s[28:31],s62 offen lds
s_add_u32 s62,s62,32768
s_add_u32 m0,m0,1024
s_waitcnt vmcnt(2)
buffer_load_dwordx4 v16,s[28:31],s62 offen lds
s_add_u32 s62,s62,32768
s_add_u32 m0,m0,1024
s_waitcnt vmcnt(2)
buffer_load_dwordx4 v16,s[28:31],s62 offen lds
s_add_u32 s62,s62,32768
s_add_u32 m0,m0,1024
s_waitcnt vmcnt(2)
buffer_load_dwordx4 v16,s[28:31],s62 offen lds
s_add_u32 s62,s62,32768
s_add_u32 m0,m0,1024
s_waitcnt vmcnt(2)
buffer_load_dwordx4 v16,s[28:31],s62 offen lds
s_add_u32 s62,s62,32768
s_add_u32 m0,m0,1024
s_waitcnt vmcnt(2)
buffer_load_dwordx4 v16,s[28:31],s62 offen lds
s_add_u32 s62,s62,32768
s_add_u32 m0,m0,1024
s_waitcnt vmcnt(2)
buffer_load_dwordx4 v16,s[28:31],s62 offen lds
s_add_u32 s62,s62,32768
s_add_u32 m0,m0,1024
s_waitcnt vmcnt(2)
buffer_load_dwordx4 v16,s[28:31],s62 offen lds
s_add_u32 s62,s62,32768
s_add_u32 m0,m0,1024
s_waitcnt vmcnt(2)
buffer_load_dwordx4 v16,s[28:31],s62 offen lds
s_add_u32 s62,s62,32768
s_add_u32 m0,m0,1024
s_waitcnt vmcnt(2)
buffer_load_dwordx4 v16,s[28:31],s62 offen lds
s_add_u32 s62,s62,32768
s_add_u32 m0,m0,1024
s_waitcnt vmcnt(2)
buffer_load_dwordx4 v16,s[28:31],s62 offen lds
s_add_u32 s62,s62,32768
s_add_u32 m0,m0,1024
s_waitcnt vmcnt(2)
buffer_load_dwordx4 v16,s[28:31],s62 offen lds
s_add_u32 s62,s62,32768
s_add_u32 m0,m0,1024
s_waitcnt vmcnt(2)
buffer_load_dwordx4 v16,s[28:31],s62 offen lds
s_waitcnt vmcnt(2)
s_waitcnt vmcnt(16)
ds_read_b64_tr_b16 a[0:1],v17 offset:0
ds_read_b64_tr_b16 a[2:3],v17 offset:256
ds_read_b64_tr_b16 a[4:5],v17 offset:8
ds_read_b64_tr_b16 a[6:7],v17 offset:264
ds_read_b64_tr_b16 a[8:9],v17 offset:2048
ds_read_b64_tr_b16 a[10:11],v17 offset:2304
ds_read_b64_tr_b16 a[12:13],v17 offset:2056
ds_read_b64_tr_b16 a[14:15],v17 offset:2312
ds_read_b64_tr_b16 a[16:17],v17 offset:4096
ds_read_b64_tr_b16 a[18:19],v17 offset:4352
ds_read_b64_tr_b16 a[20:21],v17 offset:4104
ds_read_b64_tr_b16 a[22:23],v17 offset:4360
s_waitcnt lgkmcnt(0)
ds_read_b64_tr_b16 a[24:25],v17 offset:6144
ds_read_b64_tr_b16 a[26:27],v17 offset:6400
ds_read_b64_tr_b16 a[28:29],v17 offset:6152
ds_read_b64_tr_b16 a[30:31],v17 offset:6408
ds_read_b64_tr_b16 a[32:33],v17 offset:8192
ds_read_b64_tr_b16 a[34:35],v17 offset:8448
ds_read_b64_tr_b16 a[36:37],v17 offset:8200
ds_read_b64_tr_b16 a[38:39],v17 offset:8456
ds_read_b64_tr_b16 a[40:41],v17 offset:10240
ds_read_b64_tr_b16 a[42:43],v17 offset:10496
ds_read_b64_tr_b16 a[44:45],v17 offset:10248
ds_read_b64_tr_b16 a[46:47],v17 offset:10504
s_waitcnt lgkmcnt(0)
ds_read_b64_tr_b16 a[48:49],v17 offset:12288
ds_read_b64_tr_b16 a[50:51],v17 offset:12544
ds_read_b64_tr_b16 a[52:53],v17 offset:12296
ds_read_b64_tr_b16 a[54:55],v17 offset:12552
ds_read_b64_tr_b16 a[56:57],v17 offset:14336
ds_read_b64_tr_b16 a[58:59],v17 offset:14592
ds_read_b64_tr_b16 a[60:61],v17 offset:14344
ds_read_b64_tr_b16 a[62:63],v17 offset:14600
s_waitcnt lgkmcnt(0)
s_xor_b32 s62,s50,2
s_mul_i32 s62,s62,524288
s_add_u32 s62,s62,s54
s_add_u32 m0,s61,0
s_nop 0
buffer_load_dwordx4 v16,s[28:31],s62 offen lds
s_add_u32 s62,s62,32768
s_add_u32 m0,m0,1024
s_waitcnt vmcnt(2)
buffer_load_dwordx4 v16,s[28:31],s62 offen lds
s_add_u32 s62,s62,32768
s_add_u32 m0,m0,1024
s_waitcnt vmcnt(2)
buffer_load_dwordx4 v16,s[28:31],s62 offen lds
s_add_u32 s62,s62,32768
s_add_u32 m0,m0,1024
s_waitcnt vmcnt(2)
buffer_load_dwordx4 v16,s[28:31],s62 offen lds
s_add_u32 s62,s62,32768
s_add_u32 m0,m0,1024
s_waitcnt vmcnt(2)
buffer_load_dwordx4 v16,s[28:31],s62 offen lds
s_add_u32 s62,s62,32768
s_add_u32 m0,m0,1024
s_waitcnt vmcnt(2)
buffer_load_dwordx4 v16,s[28:31],s62 offen lds
s_add_u32 s62,s62,32768
s_add_u32 m0,m0,1024
s_waitcnt vmcnt(2)
buffer_load_dwordx4 v16,s[28:31],s62 offen lds
s_add_u32 s62,s62,32768
s_add_u32 m0,m0,1024
s_waitcnt vmcnt(2)
buffer_load_dwordx4 v16,s[28:31],s62 offen lds
s_add_u32 s62,s62,32768
s_add_u32 m0,m0,1024
s_waitcnt vmcnt(2)
buffer_load_dwordx4 v16,s[28:31],s62 offen lds
s_add_u32 s62,s62,32768
s_add_u32 m0,m0,1024
s_waitcnt vmcnt(2)
buffer_load_dwordx4 v16,s[28:31],s62 offen lds
s_add_u32 s62,s62,32768
s_add_u32 m0,m0,1024
s_waitcnt vmcnt(2)
buffer_load_dwordx4 v16,s[28:31],s62 offen lds
s_add_u32 s62,s62,32768
s_add_u32 m0,m0,1024
s_waitcnt vmcnt(2)
buffer_load_dwordx4 v16,s[28:31],s62 offen lds
s_add_u32 s62,s62,32768
s_add_u32 m0,m0,1024
s_waitcnt vmcnt(2)
buffer_load_dwordx4 v16,s[28:31],s62 offen lds
s_add_u32 s62,s62,32768
s_add_u32 m0,m0,1024
s_waitcnt vmcnt(2)
buffer_load_dwordx4 v16,s[28:31],s62 offen lds
s_add_u32 s62,s62,32768
s_add_u32 m0,m0,1024
s_waitcnt vmcnt(2)
buffer_load_dwordx4 v16,s[28:31],s62 offen lds
s_add_u32 s62,s62,32768
s_add_u32 m0,m0,1024
s_waitcnt vmcnt(2)
buffer_load_dwordx4 v16,s[28:31],s62 offen lds
s_waitcnt vmcnt(2)
s_waitcnt vmcnt(16)
ds_read_b64_tr_b16 a[64:65],v17 offset:16384
ds_read_b64_tr_b16 a[66:67],v17 offset:16640
ds_read_b64_tr_b16 a[68:69],v17 offset:16392
ds_read_b64_tr_b16 a[70:71],v17 offset:16648
ds_read_b64_tr_b16 a[72:73],v17 offset:18432
ds_read_b64_tr_b16 a[74:75],v17 offset:18688
ds_read_b64_tr_b16 a[76:77],v17 offset:18440
ds_read_b64_tr_b16 a[78:79],v17 offset:18696
ds_read_b64_tr_b16 a[80:81],v17 offset:20480
ds_read_b64_tr_b16 a[82:83],v17 offset:20736
ds_read_b64_tr_b16 a[84:85],v17 offset:20488
ds_read_b64_tr_b16 a[86:87],v17 offset:20744
s_waitcnt lgkmcnt(0)
ds_read_b64_tr_b16 a[88:89],v17 offset:22528
ds_read_b64_tr_b16 a[90:91],v17 offset:22784
ds_read_b64_tr_b16 a[92:93],v17 offset:22536
ds_read_b64_tr_b16 a[94:95],v17 offset:22792
ds_read_b64_tr_b16 a[96:97],v17 offset:24576
ds_read_b64_tr_b16 a[98:99],v17 offset:24832
ds_read_b64_tr_b16 a[100:101],v17 offset:24584
ds_read_b64_tr_b16 a[102:103],v17 offset:24840
ds_read_b64_tr_b16 a[104:105],v17 offset:26624
ds_read_b64_tr_b16 a[106:107],v17 offset:26880
ds_read_b64_tr_b16 a[108:109],v17 offset:26632
ds_read_b64_tr_b16 a[110:111],v17 offset:26888
s_waitcnt lgkmcnt(0)
ds_read_b64_tr_b16 a[112:113],v17 offset:28672
ds_read_b64_tr_b16 a[114:115],v17 offset:28928
ds_read_b64_tr_b16 a[116:117],v17 offset:28680
ds_read_b64_tr_b16 a[118:119],v17 offset:28936
ds_read_b64_tr_b16 a[120:121],v17 offset:30720
ds_read_b64_tr_b16 a[122:123],v17 offset:30976
ds_read_b64_tr_b16 a[124:125],v17 offset:30728
ds_read_b64_tr_b16 a[126:127],v17 offset:30984
s_waitcnt lgkmcnt(0)
s_xor_b32 s62,s50,3
s_mul_i32 s62,s62,524288
s_add_u32 s62,s62,s54
s_add_u32 m0,s61,16384
s_nop 0
buffer_load_dwordx4 v16,s[28:31],s62 offen lds
s_add_u32 s62,s62,32768
s_add_u32 m0,m0,1024
s_waitcnt vmcnt(2)
buffer_load_dwordx4 v16,s[28:31],s62 offen lds
s_add_u32 s62,s62,32768
s_add_u32 m0,m0,1024
s_waitcnt vmcnt(2)
buffer_load_dwordx4 v16,s[28:31],s62 offen lds
s_add_u32 s62,s62,32768
s_add_u32 m0,m0,1024
s_waitcnt vmcnt(2)
buffer_load_dwordx4 v16,s[28:31],s62 offen lds
s_add_u32 s62,s62,32768
s_add_u32 m0,m0,1024
s_waitcnt vmcnt(2)
buffer_load_dwordx4 v16,s[28:31],s62 offen lds
s_add_u32 s62,s62,32768
s_add_u32 m0,m0,1024
s_waitcnt vmcnt(2)
buffer_load_dwordx4 v16,s[28:31],s62 offen lds
s_add_u32 s62,s62,32768
s_add_u32 m0,m0,1024
s_waitcnt vmcnt(2)
buffer_load_dwordx4 v16,s[28:31],s62 offen lds
s_add_u32 s62,s62,32768
s_add_u32 m0,m0,1024
s_waitcnt vmcnt(2)
buffer_load_dwordx4 v16,s[28:31],s62 offen lds
s_add_u32 s62,s62,32768
s_add_u32 m0,m0,1024
s_waitcnt vmcnt(2)
buffer_load_dwordx4 v16,s[28:31],s62 offen lds
s_add_u32 s62,s62,32768
s_add_u32 m0,m0,1024
s_waitcnt vmcnt(2)
buffer_load_dwordx4 v16,s[28:31],s62 offen lds
s_add_u32 s62,s62,32768
s_add_u32 m0,m0,1024
s_waitcnt vmcnt(2)
buffer_load_dwordx4 v16,s[28:31],s62 offen lds
s_add_u32 s62,s62,32768
s_add_u32 m0,m0,1024
s_waitcnt vmcnt(2)
buffer_load_dwordx4 v16,s[28:31],s62 offen lds
s_add_u32 s62,s62,32768
s_add_u32 m0,m0,1024
s_waitcnt vmcnt(2)
buffer_load_dwordx4 v16,s[28:31],s62 offen lds
s_add_u32 s62,s62,32768
s_add_u32 m0,m0,1024
s_waitcnt vmcnt(2)
buffer_load_dwordx4 v16,s[28:31],s62 offen lds
s_add_u32 s62,s62,32768
s_add_u32 m0,m0,1024
s_waitcnt vmcnt(2)
buffer_load_dwordx4 v16,s[28:31],s62 offen lds
s_add_u32 s62,s62,32768
s_add_u32 m0,m0,1024
s_waitcnt vmcnt(2)
buffer_load_dwordx4 v16,s[28:31],s62 offen lds
s_waitcnt vmcnt(2)
s_waitcnt vmcnt(16)
ds_read_b64_tr_b16 a[128:129],v17 offset:0
ds_read_b64_tr_b16 a[130:131],v17 offset:256
ds_read_b64_tr_b16 a[132:133],v17 offset:8
ds_read_b64_tr_b16 a[134:135],v17 offset:264
ds_read_b64_tr_b16 a[136:137],v17 offset:2048
ds_read_b64_tr_b16 a[138:139],v17 offset:2304
ds_read_b64_tr_b16 a[140:141],v17 offset:2056
ds_read_b64_tr_b16 a[142:143],v17 offset:2312
ds_read_b64_tr_b16 a[144:145],v17 offset:4096
ds_read_b64_tr_b16 a[146:147],v17 offset:4352
ds_read_b64_tr_b16 a[148:149],v17 offset:4104
ds_read_b64_tr_b16 a[150:151],v17 offset:4360
s_waitcnt lgkmcnt(0)
ds_read_b64_tr_b16 a[152:153],v17 offset:6144
ds_read_b64_tr_b16 a[154:155],v17 offset:6400
ds_read_b64_tr_b16 a[156:157],v17 offset:6152
ds_read_b64_tr_b16 a[158:159],v17 offset:6408
ds_read_b64_tr_b16 a[160:161],v17 offset:8192
ds_read_b64_tr_b16 a[162:163],v17 offset:8448
ds_read_b64_tr_b16 a[164:165],v17 offset:8200
ds_read_b64_tr_b16 a[166:167],v17 offset:8456
ds_read_b64_tr_b16 a[168:169],v17 offset:10240
ds_read_b64_tr_b16 a[170:171],v17 offset:10496
ds_read_b64_tr_b16 a[172:173],v17 offset:10248
ds_read_b64_tr_b16 a[174:175],v17 offset:10504
s_waitcnt lgkmcnt(0)
ds_read_b64_tr_b16 a[176:177],v17 offset:12288
ds_read_b64_tr_b16 a[178:179],v17 offset:12544
ds_read_b64_tr_b16 a[180:181],v17 offset:12296
ds_read_b64_tr_b16 a[182:183],v17 offset:12552
ds_read_b64_tr_b16 a[184:185],v17 offset:14336
ds_read_b64_tr_b16 a[186:187],v17 offset:14592
ds_read_b64_tr_b16 a[188:189],v17 offset:14344
ds_read_b64_tr_b16 a[190:191],v17 offset:14600
s_waitcnt lgkmcnt(0)
s_waitcnt vmcnt(0)
ds_read_b64_tr_b16 a[192:193],v17 offset:16384
ds_read_b64_tr_b16 a[194:195],v17 offset:16640
ds_read_b64_tr_b16 a[196:197],v17 offset:16392
ds_read_b64_tr_b16 a[198:199],v17 offset:16648
ds_read_b64_tr_b16 a[200:201],v17 offset:18432
ds_read_b64_tr_b16 a[202:203],v17 offset:18688
ds_read_b64_tr_b16 a[204:205],v17 offset:18440
ds_read_b64_tr_b16 a[206:207],v17 offset:18696
ds_read_b64_tr_b16 a[208:209],v17 offset:20480
ds_read_b64_tr_b16 a[210:211],v17 offset:20736
ds_read_b64_tr_b16 a[212:213],v17 offset:20488
ds_read_b64_tr_b16 a[214:215],v17 offset:20744
s_waitcnt lgkmcnt(0)
ds_read_b64_tr_b16 a[216:217],v17 offset:22528
ds_read_b64_tr_b16 a[218:219],v17 offset:22784
ds_read_b64_tr_b16 a[220:221],v17 offset:22536
ds_read_b64_tr_b16 a[222:223],v17 offset:22792
ds_read_b64_tr_b16 a[224:225],v17 offset:24576
ds_read_b64_tr_b16 a[226:227],v17 offset:24832
ds_read_b64_tr_b16 a[228:229],v17 offset:24584
ds_read_b64_tr_b16 a[230:231],v17 offset:24840
ds_read_b64_tr_b16 a[232:233],v17 offset:26624
ds_read_b64_tr_b16 a[234:235],v17 offset:26880
ds_read_b64_tr_b16 a[236:237],v17 offset:26632
ds_read_b64_tr_b16 a[238:239],v17 offset:26888
s_waitcnt lgkmcnt(0)
ds_read_b64_tr_b16 a[240:241],v17 offset:28672
ds_read_b64_tr_b16 a[242:243],v17 offset:28928
ds_read_b64_tr_b16 a[244:245],v17 offset:28680
ds_read_b64_tr_b16 a[246:247],v17 offset:28936
ds_read_b64_tr_b16 a[248:249],v17 offset:30720
ds_read_b64_tr_b16 a[250:251],v17 offset:30976
ds_read_b64_tr_b16 a[252:253],v17 offset:30728
ds_read_b64_tr_b16 a[254:255],v17 offset:30984
s_waitcnt lgkmcnt(0)
s_mov_b32 s92,s2
s_and_b32 s93,s3,0xffff
s_mov_b32 s94,0x100
s_mov_b32 s95,0x20000
v_mbcnt_lo_u32_b32 v16,-1,0
v_mbcnt_hi_u32_b32 v16,-1,v16
v_mov_b32 v18,0
v_cmp_eq_u32 vcc,22,v16
s_nop 1
v_cndmask_b32 v18,v18,63,vcc
v_cmp_eq_u32 vcc,17,v16
s_nop 1
v_cndmask_b32 v18,v18,63,vcc
v_cmp_eq_u32 vcc,18,v16
s_nop 1
v_cndmask_b32 v18,v18,1,vcc
v_and_b32 v19,1,v16
v_cmp_eq_u32 vcc,1,v19
v_mov_b32 v19,8192
s_nop 0
v_cndmask_b32 v19,-1,v19,vcc
v_min_u32 v16,31,v16
v_lshlrev_b32 v16,2,v16
s_sub_u32 s66,s88,64
s_cmp_lg_u32 s50,0
s_cbranch_scc1 vot_332
vpoll_328:
buffer_load_dword v17,v16,s[92:95],s66 offen sc1
s_waitcnt vmcnt(0)
s_cmp_lg_u32 s56,2
s_cbranch_scc1 vck_329
v_cmp_eq_u32 vcc,v17,v19
s_and_b32 s64,vcc_lo,0xffff
s_cmp_eq_u32 s64,65535
s_cbranch_scc1 vck_329
s_mov_b32 s65,0
v_readlane_b32 s64,v17,1
s_lshr_b32 s64,s64,8
s_add_u32 s65,s65,s64
v_readlane_b32 s64,v17,3
s_lshr_b32 s64,s64,8
s_add_u32 s65,s65,s64
v_readlane_b32 s64,v17,5
s_lshr_b32 s64,s64,8
s_add_u32 s65,s65,s64
v_readlane_b32 s64,v17,7
s_lshr_b32 s64,s64,8
s_add_u32 s65,s65,s64
v_readlane_b32 s64,v17,9
s_lshr_b32 s64,s64,8
s_add_u32 s65,s65,s64
v_readlane_b32 s64,v17,11
s_lshr_b32 s64,s64,8
s_add_u32 s65,s65,s64
v_readlane_b32 s64,v17,13
s_lshr_b32 s64,s64,8
s_add_u32 s65,s65,s64
v_readlane_b32 s64,v17,15
s_lshr_b32 s64,s64,8
s_add_u32 s65,s65,s64
s_cmp_ge_u32 s65,256
s_cbranch_scc1 vok_331
s_branch vrt_330
vck_329:
v_cmp_gt_u32 vcc,v18,v17
s_cbranch_vccz vok_331
vrt_330:
s_sleep 48
s_sub_u32 s90,s90,1
s_cmp_gt_i32 s90,0
s_cbranch_scc1 vpoll_328
vok_331:
v_add_u32 v18,160768,v16
ds_write_b32 v18,v17
s_waitcnt lgkmcnt(0)
vot_332:
s_barrier
v_add_u32 v18,160768,v16
ds_read_b32 v17,v18
s_waitcnt lgkmcnt(0)
s_cmp_lg_u32 s56,2
s_cbranch_scc1 vfin_333
v_cmp_eq_u32 vcc,v17,v19
s_and_b32 s64,vcc_lo,0xffff
s_cmp_eq_u32 s64,65535
s_cbranch_scc1 vfin_333
s_mov_b32 s65,0
v_readlane_b32 s64,v17,1
s_lshr_b32 s64,s64,8
s_add_u32 s65,s65,s64
v_readlane_b32 s64,v17,3
s_lshr_b32 s64,s64,8
s_add_u32 s65,s65,s64
v_readlane_b32 s64,v17,5
s_lshr_b32 s64,s64,8
s_add_u32 s65,s65,s64
v_readlane_b32 s64,v17,7
s_lshr_b32 s64,s64,8
s_add_u32 s65,s65,s64
v_readlane_b32 s64,v17,9
s_lshr_b32 s64,s64,8
s_add_u32 s65,s65,s64
v_readlane_b32 s64,v17,11
s_lshr_b32 s64,s64,8
s_add_u32 s65,s65,s64
v_readlane_b32 s64,v17,13
s_lshr_b32 s64,s64,8
s_add_u32 s65,s65,s64
v_readlane_b32 s64,v17,15
s_lshr_b32 s64,s64,8
s_add_u32 s65,s65,s64
s_cmp_ge_u32 s65,256
s_cbranch_scc1 fl_fb
vfin_333:
s_and_b32 s56,s56,1
s_mov_b32 s67,0
s_barrier
v_lshlrev_b32 v0,4,v1
s_mov_b32 s60,0
s_lshl_b32 s70,s50,13
s_mov_b32 s55,0
v_mov_b32 v3,v0
s_mov_b32 s73,0xffff0000
s_lshl_b32 s64,s52,2
s_add_u32 s64,s64,s50
s_mul_i32 s61,s64,8192
s_add_u32 s61,s61,209747968
s_lshl_b32 s68,s64,8
s_add_u32 s68,s68,138549248
s_lshl_b32 s83,s53,2
s_add_u32 s83,s83,s50
s_mov_b32 s63,0
s_xor_b32 s64,s50,0
s_lshl_b32 s64,s64,13
v_add_u32 v8,s64,v0
v_mov_b32 v4,v8
s_xor_b32 s64,s50,1
s_lshl_b32 s64,s64,13
v_add_u32 v9,s64,v0
v_mov_b32 v5,v9
s_xor_b32 s64,s50,2
s_lshl_b32 s64,s64,13
v_add_u32 v10,s64,v0
v_mov_b32 v6,v10
s_xor_b32 s64,s50,3
s_lshl_b32 s64,s64,13
v_add_u32 v11,s64,v0
v_mov_b32 v7,v11
v_min_u32 v2,7,v1
v_lshlrev_b32 v2,7,v2
s_mul_i32 s68,s50,1024
s_add_u32 s68,s68,138559488
s_lshr_b32 s64,s50,1
s_add_u32 s64,s64,1
s_sub_u32 s65,0,s64
s_bitcmp1_b32 s50,0
s_cselect_b32 s64,s64,s65
s_add_u32 s64,s64,16
v_add_u32 v26,s64,v21
v_lshrrev_b32 v27,4,v26
v_and_b32 v26,15,v26
v_lshl_add_u32 v26,v22,4,v26
v_lshlrev_b32 v26,4,v26
v_lshl_add_u32 v3,v27,15,v26
s_sub_u32 s61,s61,32768
s_and_b32 s64,s50,1
s_add_u32 s74,s64,1
s_add_u32 s75,s64,2
s_add_u32 s76,s64,3
s_add_u32 s62,s61,4096
s_lshl_b32 s66,s83,10
s_lshr_b32 s65,s83,3
s_lshl_b32 s65,s65,8
s_and_b32 s64,s83,7
s_lshl_b32 s64,s64,2
s_add_u32 s69,s64,s65
s_add_u32 s69,s69,138550272
s_add_u32 s82,s66,205520896
s_add_u32 s66,s66,214958080
v_cmp_eq_u32 vcc,0,v1
s_nop 1
v_cndmask_b32 v26,2.0,0,vcc
s_add_u32 s71,s60,s74
s_cmp_eq_u32 s60,127
s_cselect_b32 s71,128,s71
s_add_u32 s53,s60,s75
s_cmp_eq_u32 s60,126
s_cselect_b32 s53,128,s53
plp_341:
buffer_load_dword v16,v2,s[20:23],s68 offen sc1
s_waitcnt vmcnt(0)
v_cmp_gt_u32 vcc,s71,v16
s_cbranch_vccz pok_342
s_sleep 4
s_sub_u32 s90,s90,1
s_cmp_gt_i32 s90,0
s_cbranch_scc1 plp_341
pok_342:
lag_338:
s_mov_b32 m0,s70
s_nop 0
buffer_load_dwordx4 v3,s[20:23],s61 offen offset:0 lds
buffer_load_dwordx4 v3,s[20:23],s61 offen offset:1024 lds
buffer_load_dwordx4 v3,s[20:23],s61 offen offset:2048 lds
buffer_load_dwordx4 v3,s[20:23],s61 offen offset:3072 lds
s_add_u32 m0,s70,4096
s_nop 0
buffer_load_dwordx4 v3,s[20:23],s62 offen offset:0 lds
buffer_load_dwordx4 v3,s[20:23],s62 offen offset:1024 lds
buffer_load_dwordx4 v3,s[20:23],s62 offen offset:2048 lds
buffer_load_dwordx4 v3,s[20:23],s62 offen offset:3072 lds
s_add_u32 s61,s61,32768
s_add_u32 s62,s62,32768
s_add_u32 s70,s70,32768
s_and_b32 s70,s70,0x1ffff
buffer_load_dword v23,off,s[20:23],s66
buffer_load_dword v23,off,s[20:23],s66
dec_339:
v_cmp_gt_u32 vcc,s53,v16
s_cbranch_vccnz BN_337
BR_336:
s_waitcnt vmcnt(9)
ds_read_b128 v[64:67],v4 offset:0
s_waitcnt vmcnt(8)
ds_read_b128 v[68:71],v4 offset:1024
s_waitcnt vmcnt(7)
ds_read_b128 v[72:75],v4 offset:2048
s_waitcnt vmcnt(6)
ds_read_b128 v[76:79],v4 offset:3072
s_waitcnt lgkmcnt(3)
v_mfma_f32_16x16x32_bf16 v[32:35],a[0:3],v[64:67],0
s_add_u32 s71,s60,s75
s_cmp_eq_u32 s60,126
s_cselect_b32 s71,128,s71
buffer_load_dwordx4 v[160:163],v0,s[20:23],s82 offen
v_mfma_f32_16x16x32_bf16 v[36:39],a[4:7],v[64:67],0
s_waitcnt lgkmcnt(2)
s_waitcnt vmcnt(6)
s_mov_b32 m0,s70
s_add_u32 s82,s82,32768
ds_read_b128 v[80:83],v4 offset:4096
v_mfma_f32_16x16x32_bf16 v[32:35],a[8:11],v[68:71],v[32:35]
s_add_u32 s53,s60,s76
s_cmp_eq_u32 s60,125
s_cselect_b32 s53,128,s53
buffer_load_dwordx4 v3,s[20:23],s61 offen offset:0 lds
v_mfma_f32_16x16x32_bf16 v[36:39],a[12:15],v[68:71],v[36:39]
s_waitcnt lgkmcnt(2)
s_waitcnt vmcnt(6)
ds_read_b128 v[84:87],v4 offset:5120
v_mfma_f32_16x16x32_bf16 v[32:35],a[16:19],v[72:75],v[32:35]
s_mov_b32 s57,s63
buffer_load_dwordx4 v3,s[20:23],s61 offen offset:1024 lds
v_mfma_f32_16x16x32_bf16 v[36:39],a[20:23],v[72:75],v[36:39]
s_waitcnt lgkmcnt(2)
s_waitcnt vmcnt(6)
ds_read_b128 v[88:91],v4 offset:6144
v_mfma_f32_16x16x32_bf16 v[32:35],a[24:27],v[76:79],v[32:35]
buffer_load_dwordx4 v3,s[20:23],s61 offen offset:2048 lds
v_mfma_f32_16x16x32_bf16 v[36:39],a[28:31],v[76:79],v[36:39]
s_waitcnt lgkmcnt(2)
s_waitcnt vmcnt(6)
ds_read_b128 v[92:95],v4 offset:7168
v_mfma_f32_16x16x32_bf16 v[32:35],a[32:35],v[80:83],v[32:35]
buffer_load_dwordx4 v3,s[20:23],s61 offen offset:3072 lds
v_mfma_f32_16x16x32_bf16 v[36:39],a[36:39],v[80:83],v[36:39]
s_waitcnt lgkmcnt(2)
s_barrier
s_add_u32 m0,s70,4096
ds_read_b128 v[96:99],v5 offset:0
v_mfma_f32_16x16x32_bf16 v[32:35],a[40:43],v[84:87],v[32:35]
ds_read_b128 v[100:103],v5 offset:1024
buffer_load_dwordx4 v3,s[20:23],s62 offen offset:0 lds
v_mfma_f32_16x16x32_bf16 v[36:39],a[44:47],v[84:87],v[36:39]
s_waitcnt lgkmcnt(3)
ds_read_b128 v[104:107],v5 offset:2048
buffer_load_dwordx4 v3,s[20:23],s62 offen offset:1024 lds
v_mfma_f32_16x16x32_bf16 v[32:35],a[48:51],v[88:91],v[32:35]
ds_read_b128 v[108:111],v5 offset:3072
v_mfma_f32_16x16x32_bf16 v[36:39],a[52:55],v[88:91],v[36:39]
s_waitcnt lgkmcnt(4)
ds_read_b128 v[112:115],v5 offset:4096
buffer_load_dwordx4 v3,s[20:23],s62 offen offset:2048 lds
v_mfma_f32_16x16x32_bf16 v[32:35],a[56:59],v[92:95],v[32:35]
ds_read_b128 v[116:119],v5 offset:5120
v_mfma_f32_16x16x32_bf16 v[36:39],a[60:63],v[92:95],v[36:39]
s_waitcnt lgkmcnt(5)
buffer_load_dwordx4 v3,s[20:23],s62 offen offset:3072 lds
v_mfma_f32_16x16x32_bf16 v[32:35],a[64:67],v[96:99],v[32:35]
ds_read_b128 v[120:123],v5 offset:6144
v_mfma_f32_16x16x32_bf16 v[36:39],a[68:71],v[96:99],v[36:39]
s_waitcnt lgkmcnt(5)
v_mfma_f32_16x16x32_bf16 v[32:35],a[72:75],v[100:103],v[32:35]
ds_read_b128 v[124:127],v5 offset:7168
v_mfma_f32_16x16x32_bf16 v[36:39],a[76:79],v[100:103],v[36:39]
s_waitcnt lgkmcnt(5)
v_mfma_f32_16x16x32_bf16 v[32:35],a[80:83],v[104:107],v[32:35]
ds_read_b128 v[64:67],v6 offset:0
v_mfma_f32_16x16x32_bf16 v[36:39],a[84:87],v[104:107],v[36:39]
s_waitcnt lgkmcnt(5)
v_mfma_f32_16x16x32_bf16 v[32:35],a[88:91],v[108:111],v[32:35]
ds_read_b128 v[68:71],v6 offset:1024
v_mfma_f32_16x16x32_bf16 v[36:39],a[92:95],v[108:111],v[36:39]
s_waitcnt lgkmcnt(5)
v_mfma_f32_16x16x32_bf16 v[32:35],a[96:99],v[112:115],v[32:35]
ds_read_b128 v[72:75],v6 offset:2048
buffer_load_dword v16,v2,s[20:23],s68 offen sc1
v_mfma_f32_16x16x32_bf16 v[36:39],a[100:103],v[112:115],v[36:39]
s_waitcnt lgkmcnt(5)
v_mfma_f32_16x16x32_bf16 v[32:35],a[104:107],v[116:119],v[32:35]
ds_read_b128 v[76:79],v6 offset:3072
v_mfma_f32_16x16x32_bf16 v[36:39],a[108:111],v[116:119],v[36:39]
s_waitcnt lgkmcnt(5)
v_mfma_f32_16x16x32_bf16 v[32:35],a[112:115],v[120:123],v[32:35]
ds_read_b128 v[80:83],v6 offset:4096
v_mfma_f32_16x16x32_bf16 v[36:39],a[116:119],v[120:123],v[36:39]
s_waitcnt lgkmcnt(5)
v_mfma_f32_16x16x32_bf16 v[32:35],a[120:123],v[124:127],v[32:35]
ds_read_b128 v[84:87],v6 offset:5120
v_mfma_f32_16x16x32_bf16 v[36:39],a[124:127],v[124:127],v[36:39]
s_waitcnt lgkmcnt(5)
v_mfma_f32_16x16x32_bf16 v[32:35],a[128:131],v[64:67],v[32:35]
ds_read_b128 v[88:91],v6 offset:6144
v_mfma_f32_16x16x32_bf16 v[36:39],a[132:135],v[64:67],v[36:39]
s_waitcnt lgkmcnt(5)
v_mfma_f32_16x16x32_bf16 v[32:35],a[136:139],v[68:71],v[32:35]
ds_read_b128 v[92:95],v6 offset:7168
v_mfma_f32_16x16x32_bf16 v[36:39],a[140:143],v[68:71],v[36:39]
s_waitcnt lgkmcnt(5)
v_mfma_f32_16x16x32_bf16 v[32:35],a[144:147],v[72:75],v[32:35]
ds_read_b128 v[96:99],v7 offset:0
v_mfma_f32_16x16x32_bf16 v[36:39],a[148:151],v[72:75],v[36:39]
s_waitcnt lgkmcnt(5)
s_waitcnt vmcnt(11)
v_mov_b32 v17,s57
buffer_store_dword v17,v26,s[20:23],s69 offen sc1
v_mfma_f32_16x16x32_bf16 v[32:35],a[152:155],v[76:79],v[32:35]
ds_read_b128 v[100:103],v7 offset:1024
v_mfma_f32_16x16x32_bf16 v[36:39],a[156:159],v[76:79],v[36:39]
s_waitcnt lgkmcnt(5)
v_mfma_f32_16x16x32_bf16 v[32:35],a[160:163],v[80:83],v[32:35]
ds_read_b128 v[104:107],v7 offset:2048
v_mfma_f32_16x16x32_bf16 v[36:39],a[164:167],v[80:83],v[36:39]
s_waitcnt lgkmcnt(5)
v_mfma_f32_16x16x32_bf16 v[32:35],a[168:171],v[84:87],v[32:35]
ds_read_b128 v[108:111],v7 offset:3072
v_mfma_f32_16x16x32_bf16 v[36:39],a[172:175],v[84:87],v[36:39]
s_waitcnt lgkmcnt(5)
v_mfma_f32_16x16x32_bf16 v[32:35],a[176:179],v[88:91],v[32:35]
ds_read_b128 v[112:115],v7 offset:4096
v_mfma_f32_16x16x32_bf16 v[36:39],a[180:183],v[88:91],v[36:39]
s_waitcnt lgkmcnt(5)
v_mfma_f32_16x16x32_bf16 v[32:35],a[184:187],v[92:95],v[32:35]
ds_read_b128 v[116:119],v7 offset:5120
v_mfma_f32_16x16x32_bf16 v[36:39],a[188:191],v[92:95],v[36:39]
s_waitcnt lgkmcnt(5)
v_mfma_f32_16x16x32_bf16 v[32:35],a[192:195],v[96:99],v[32:35]
ds_read_b128 v[120:123],v7 offset:6144
v_mfma_f32_16x16x32_bf16 v[36:39],a[196:199],v[96:99],v[36:39]
s_waitcnt lgkmcnt(5)
v_mfma_f32_16x16x32_bf16 v[32:35],a[200:203],v[100:103],v[32:35]
s_waitcnt vmcnt(10)
ds_read_b128 v[124:127],v7 offset:7168
v_lshlrev_b32 v168,16,v160
v_mfma_f32_16x16x32_bf16 v[36:39],a[204:207],v[100:103],v[36:39]
s_waitcnt lgkmcnt(5)
v_and_b32 v169,s73,v160
v_lshlrev_b32 v170,16,v161
v_mfma_f32_16x16x32_bf16 v[32:35],a[208:211],v[104:107],v[32:35]
s_add_u32 s61,s61,32768
v_and_b32 v171,s73,v161
v_lshlrev_b32 v172,16,v162
v_mfma_f32_16x16x32_bf16 v[36:39],a[212:215],v[104:107],v[36:39]
s_waitcnt lgkmcnt(4)
v_and_b32 v173,s73,v162
v_lshlrev_b32 v174,16,v163
v_mfma_f32_16x16x32_bf16 v[32:35],a[216:219],v[108:111],v[32:35]
s_add_u32 s62,s62,32768
s_add_u32 s70,s70,32768
v_and_b32 v175,s73,v163
v_mfma_f32_16x16x32_bf16 v[36:39],a[220:223],v[108:111],v[36:39]
s_waitcnt lgkmcnt(3)
s_and_b32 s70,s70,0x1ffff
s_add_u32 s55,s55,32768
v_mfma_f32_16x16x32_bf16 v[32:35],a[224:227],v[112:115],v[32:35]
s_and_b32 s55,s55,0x1ffff
v_add_u32 v4,s55,v8
v_add_u32 v5,s55,v9
v_mfma_f32_16x16x32_bf16 v[36:39],a[228:231],v[112:115],v[36:39]
s_waitcnt lgkmcnt(2)
v_add_u32 v6,s55,v10
v_add_u32 v7,s55,v11
v_mfma_f32_16x16x32_bf16 v[32:35],a[232:235],v[116:119],v[32:35]
s_waitcnt vmcnt(9)
ds_read_b128 v[64:67],v4 offset:0
v_mfma_f32_16x16x32_bf16 v[36:39],a[236:239],v[116:119],v[36:39]
s_waitcnt lgkmcnt(2)
s_waitcnt vmcnt(8)
ds_read_b128 v[68:71],v4 offset:1024
v_mfma_f32_16x16x32_bf16 v[32:35],a[240:243],v[120:123],v[32:35]
s_waitcnt vmcnt(7)
ds_read_b128 v[72:75],v4 offset:2048
v_mfma_f32_16x16x32_bf16 v[36:39],a[244:247],v[120:123],v[36:39]
s_waitcnt lgkmcnt(3)
v_mfma_f32_16x16x32_bf16 v[40:43],a[248:251],v[124:127],v[32:35]
v_mfma_f32_16x16x32_bf16 v[44:47],a[252:255],v[124:127],v[36:39]
s_waitcnt vmcnt(1)
v_cmp_gt_u32 vcc,s53,v16
s_add_u32 s60,s60,1
s_cbranch_vccnz WN_335
.p2align 6
WR_334:
s_waitcnt lgkmcnt(2)
v_mfma_f32_16x16x32_bf16 v[32:35],a[0:3],v[64:67],0
s_waitcnt vmcnt(6)
s_mov_b32 m0,s70
ds_read_b128 v[76:79],v4 offset:3072
v_mfma_f32_16x16x32_bf16 v[36:39],a[4:7],v[64:67],0
s_waitcnt lgkmcnt(2)
s_add_u32 s71,s60,s75
s_cmp_eq_u32 s60,126
s_cselect_b32 s71,128,s71
buffer_load_dwordx4 v3,s[20:23],s61 offen offset:0 lds
v_mfma_f32_16x16x32_bf16 v[32:35],a[8:11],v[68:71],v[32:35]
s_waitcnt vmcnt(6)
ds_read_b128 v[80:83],v4 offset:4096
buffer_load_dwordx4 v[160:163],v0,s[20:23],s82 offen
v_add_f32 v40,v40,v168
v_mfma_f32_16x16x32_bf16 v[36:39],a[12:15],v[68:71],v[36:39]
s_waitcnt lgkmcnt(2)
s_add_u32 s82,s82,32768
buffer_load_dwordx4 v3,s[20:23],s61 offen offset:1024 lds
v_add_f32 v41,v41,v169
v_mfma_f32_16x16x32_bf16 v[32:35],a[16:19],v[72:75],v[32:35]
s_waitcnt vmcnt(7)
s_add_u32 s53,s60,s76
s_cmp_eq_u32 s60,125
s_cselect_b32 s53,128,s53
ds_read_b128 v[84:87],v4 offset:5120
v_mfma_f32_16x16x32_bf16 v[36:39],a[20:23],v[72:75],v[36:39]
s_waitcnt lgkmcnt(2)
s_mov_b32 s57,s63
buffer_load_dwordx4 v3,s[20:23],s61 offen offset:2048 lds
v_add_f32 v42,v42,v170
v_mfma_f32_16x16x32_bf16 v[32:35],a[24:27],v[76:79],v[32:35]
s_waitcnt vmcnt(7)
ds_read_b128 v[88:91],v4 offset:6144
v_add_f32 v43,v43,v171
v_add_f32 v44,v44,v172
v_mfma_f32_16x16x32_bf16 v[36:39],a[28:31],v[76:79],v[36:39]
s_waitcnt lgkmcnt(2)
buffer_load_dwordx4 v3,s[20:23],s61 offen offset:3072 lds
v_add_f32 v45,v45,v173
v_add_f32 v46,v46,v174
v_mfma_f32_16x16x32_bf16 v[32:35],a[32:35],v[80:83],v[32:35]
s_waitcnt vmcnt(7)
ds_read_b128 v[92:95],v4 offset:7168
v_add_f32 v47,v47,v175
v_cvt_pk_bf16_f32 v176,v40,v41
v_mfma_f32_16x16x32_bf16 v[36:39],a[36:39],v[80:83],v[36:39]
s_waitcnt lgkmcnt(2)
s_barrier
s_add_u32 m0,s70,4096
ds_read_b128 v[96:99],v5 offset:0
v_mfma_f32_16x16x32_bf16 v[32:35],a[40:43],v[84:87],v[32:35]
ds_read_b128 v[100:103],v5 offset:1024
buffer_load_dwordx4 v3,s[20:23],s62 offen offset:0 lds
v_cvt_pk_bf16_f32 v177,v42,v43
v_mfma_f32_16x16x32_bf16 v[36:39],a[44:47],v[84:87],v[36:39]
s_waitcnt lgkmcnt(3)
ds_read_b128 v[104:107],v5 offset:2048
buffer_load_dwordx4 v3,s[20:23],s62 offen offset:1024 lds
v_cvt_pk_bf16_f32 v178,v44,v45
v_mfma_f32_16x16x32_bf16 v[32:35],a[48:51],v[88:91],v[32:35]
ds_read_b128 v[108:111],v5 offset:3072
v_cvt_pk_bf16_f32 v179,v46,v47
v_mfma_f32_16x16x32_bf16 v[36:39],a[52:55],v[88:91],v[36:39]
s_waitcnt lgkmcnt(4)
ds_read_b128 v[112:115],v5 offset:4096
buffer_load_dwordx4 v3,s[20:23],s62 offen offset:2048 lds
v_mfma_f32_16x16x32_bf16 v[32:35],a[56:59],v[92:95],v[32:35]
ds_read_b128 v[116:119],v5 offset:5120
v_mfma_f32_16x16x32_bf16 v[36:39],a[60:63],v[92:95],v[36:39]
s_waitcnt lgkmcnt(5)
buffer_load_dwordx4 v3,s[20:23],s62 offen offset:3072 lds
v_mfma_f32_16x16x32_bf16 v[32:35],a[64:67],v[96:99],v[32:35]
ds_read_b128 v[120:123],v5 offset:6144
v_mfma_f32_16x16x32_bf16 v[36:39],a[68:71],v[96:99],v[36:39]
s_waitcnt lgkmcnt(5)
buffer_load_dword v16,v2,s[20:23],s68 offen sc1
v_mfma_f32_16x16x32_bf16 v[32:35],a[72:75],v[100:103],v[32:35]
ds_read_b128 v[124:127],v5 offset:7168
v_mfma_f32_16x16x32_bf16 v[36:39],a[76:79],v[100:103],v[36:39]
s_waitcnt lgkmcnt(5)
s_waitcnt vmcnt(10)
v_mov_b32 v17,s57
buffer_store_dword v17,v26,s[20:23],s69 offen sc1
v_mfma_f32_16x16x32_bf16 v[32:35],a[80:83],v[104:107],v[32:35]
ds_read_b128 v[64:67],v6 offset:0
v_mfma_f32_16x16x32_bf16 v[36:39],a[84:87],v[104:107],v[36:39]
s_waitcnt lgkmcnt(5)
buffer_store_dwordx4 v[176:179],v0,s[20:23],s66 offen sc1
v_mfma_f32_16x16x32_bf16 v[32:35],a[88:91],v[108:111],v[32:35]
s_add_u32 s66,s66,32768
s_add_u32 s63,s63,1
ds_read_b128 v[68:71],v6 offset:1024
v_mfma_f32_16x16x32_bf16 v[36:39],a[92:95],v[108:111],v[36:39]
s_waitcnt lgkmcnt(5)
v_mfma_f32_16x16x32_bf16 v[32:35],a[96:99],v[112:115],v[32:35]
ds_read_b128 v[72:75],v6 offset:2048
v_mfma_f32_16x16x32_bf16 v[36:39],a[100:103],v[112:115],v[36:39]
s_waitcnt lgkmcnt(5)
v_mfma_f32_16x16x32_bf16 v[32:35],a[104:107],v[116:119],v[32:35]
ds_read_b128 v[76:79],v6 offset:3072
v_mfma_f32_16x16x32_bf16 v[36:39],a[108:111],v[116:119],v[36:39]
s_waitcnt lgkmcnt(5)
v_mfma_f32_16x16x32_bf16 v[32:35],a[112:115],v[120:123],v[32:35]
ds_read_b128 v[80:83],v6 offset:4096
v_mfma_f32_16x16x32_bf16 v[36:39],a[116:119],v[120:123],v[36:39]
s_waitcnt lgkmcnt(5)
v_mfma_f32_16x16x32_bf16 v[32:35],a[120:123],v[124:127],v[32:35]
ds_read_b128 v[84:87],v6 offset:5120
v_mfma_f32_16x16x32_bf16 v[36:39],a[124:127],v[124:127],v[36:39]
s_waitcnt lgkmcnt(5)
v_mfma_f32_16x16x32_bf16 v[32:35],a[128:131],v[64:67],v[32:35]
ds_read_b128 v[88:91],v6 offset:6144
v_mfma_f32_16x16x32_bf16 v[36:39],a[132:135],v[64:67],v[36:39]
s_waitcnt lgkmcnt(5)
v_mfma_f32_16x16x32_bf16 v[32:35],a[136:139],v[68:71],v[32:35]
ds_read_b128 v[92:95],v6 offset:7168
v_mfma_f32_16x16x32_bf16 v[36:39],a[140:143],v[68:71],v[36:39]
s_waitcnt lgkmcnt(5)
v_mfma_f32_16x16x32_bf16 v[32:35],a[144:147],v[72:75],v[32:35]
ds_read_b128 v[96:99],v7 offset:0
v_mfma_f32_16x16x32_bf16 v[36:39],a[148:151],v[72:75],v[36:39]
s_waitcnt lgkmcnt(5)
v_mfma_f32_16x16x32_bf16 v[32:35],a[152:155],v[76:79],v[32:35]
ds_read_b128 v[100:103],v7 offset:1024
v_mfma_f32_16x16x32_bf16 v[36:39],a[156:159],v[76:79],v[36:39]
s_waitcnt lgkmcnt(5)
v_mfma_f32_16x16x32_bf16 v[32:35],a[160:163],v[80:83],v[32:35]
ds_read_b128 v[104:107],v7 offset:2048
v_mfma_f32_16x16x32_bf16 v[36:39],a[164:167],v[80:83],v[36:39]
s_waitcnt lgkmcnt(5)
v_mfma_f32_16x16x32_bf16 v[32:35],a[168:171],v[84:87],v[32:35]
ds_read_b128 v[108:111],v7 offset:3072
v_mfma_f32_16x16x32_bf16 v[36:39],a[172:175],v[84:87],v[36:39]
s_waitcnt lgkmcnt(5)
v_mfma_f32_16x16x32_bf16 v[32:35],a[176:179],v[88:91],v[32:35]
ds_read_b128 v[112:115],v7 offset:4096
v_mfma_f32_16x16x32_bf16 v[36:39],a[180:183],v[88:91],v[36:39]
s_waitcnt lgkmcnt(5)
v_mfma_f32_16x16x32_bf16 v[32:35],a[184:187],v[92:95],v[32:35]
ds_read_b128 v[116:119],v7 offset:5120
v_mfma_f32_16x16x32_bf16 v[36:39],a[188:191],v[92:95],v[36:39]
s_waitcnt lgkmcnt(5)
v_mfma_f32_16x16x32_bf16 v[32:35],a[192:195],v[96:99],v[32:35]
ds_read_b128 v[120:123],v7 offset:6144
v_mfma_f32_16x16x32_bf16 v[36:39],a[196:199],v[96:99],v[36:39]
s_waitcnt lgkmcnt(5)
v_mfma_f32_16x16x32_bf16 v[32:35],a[200:203],v[100:103],v[32:35]
s_waitcnt vmcnt(10)
ds_read_b128 v[124:127],v7 offset:7168
v_lshlrev_b32 v168,16,v160
v_mfma_f32_16x16x32_bf16 v[36:39],a[204:207],v[100:103],v[36:39]
s_waitcnt lgkmcnt(5)
v_and_b32 v169,s73,v160
v_lshlrev_b32 v170,16,v161
v_mfma_f32_16x16x32_bf16 v[32:35],a[208:211],v[104:107],v[32:35]
s_add_u32 s61,s61,32768
v_and_b32 v171,s73,v161
v_lshlrev_b32 v172,16,v162
v_mfma_f32_16x16x32_bf16 v[36:39],a[212:215],v[104:107],v[36:39]
s_waitcnt lgkmcnt(4)
v_and_b32 v173,s73,v162
v_lshlrev_b32 v174,16,v163
v_mfma_f32_16x16x32_bf16 v[32:35],a[216:219],v[108:111],v[32:35]
s_add_u32 s62,s62,32768
s_add_u32 s70,s70,32768
v_and_b32 v175,s73,v163
v_mfma_f32_16x16x32_bf16 v[36:39],a[220:223],v[108:111],v[36:39]
s_waitcnt lgkmcnt(3)
s_and_b32 s70,s70,0x1ffff
s_add_u32 s55,s55,32768
v_mfma_f32_16x16x32_bf16 v[32:35],a[224:227],v[112:115],v[32:35]
s_and_b32 s55,s55,0x1ffff
v_add_u32 v4,s55,v8
v_add_u32 v5,s55,v9
v_mfma_f32_16x16x32_bf16 v[36:39],a[228:231],v[112:115],v[36:39]
s_waitcnt lgkmcnt(2)
v_add_u32 v6,s55,v10
v_add_u32 v7,s55,v11
v_mfma_f32_16x16x32_bf16 v[32:35],a[232:235],v[116:119],v[32:35]
ds_read_b128 v[64:67],v4 offset:0
v_mfma_f32_16x16x32_bf16 v[36:39],a[236:239],v[116:119],v[36:39]
s_waitcnt lgkmcnt(2)
s_waitcnt vmcnt(9)
ds_read_b128 v[68:71],v4 offset:1024
v_mfma_f32_16x16x32_bf16 v[32:35],a[240:243],v[120:123],v[32:35]
s_waitcnt vmcnt(8)
ds_read_b128 v[72:75],v4 offset:2048
v_mfma_f32_16x16x32_bf16 v[36:39],a[244:247],v[120:123],v[36:39]
s_waitcnt lgkmcnt(3)
v_mfma_f32_16x16x32_bf16 v[40:43],a[248:251],v[124:127],v[32:35]
v_mfma_f32_16x16x32_bf16 v[44:47],a[252:255],v[124:127],v[36:39]
s_waitcnt vmcnt(2)
v_cmp_gt_u32 vcc,s53,v16
s_add_u32 s60,s60,1
s_cbranch_vccz WR_334
WN_335:
s_waitcnt lgkmcnt(2)
v_mfma_f32_16x16x32_bf16 v[32:35],a[0:3],v[64:67],0
s_waitcnt vmcnt(6)
ds_read_b128 v[76:79],v4 offset:3072
buffer_load_dwordx4 v[160:163],v0,s[20:23],s82 offen
v_mfma_f32_16x16x32_bf16 v[36:39],a[4:7],v[64:67],0
s_waitcnt lgkmcnt(2)
s_add_u32 s82,s82,32768
v_mfma_f32_16x16x32_bf16 v[32:35],a[8:11],v[68:71],v[32:35]
s_waitcnt vmcnt(6)
ds_read_b128 v[80:83],v4 offset:4096
v_add_f32 v40,v40,v168
v_add_f32 v41,v41,v169
v_mfma_f32_16x16x32_bf16 v[36:39],a[12:15],v[68:71],v[36:39]
s_waitcnt lgkmcnt(2)
s_add_u32 s71,s60,s75
s_cmp_eq_u32 s60,126
s_cselect_b32 s71,128,s71
v_mfma_f32_16x16x32_bf16 v[32:35],a[16:19],v[72:75],v[32:35]
s_waitcnt vmcnt(5)
ds_read_b128 v[84:87],v4 offset:5120
v_add_f32 v42,v42,v170
v_add_f32 v43,v43,v171
v_mfma_f32_16x16x32_bf16 v[36:39],a[20:23],v[72:75],v[36:39]
s_waitcnt lgkmcnt(2)
s_add_u32 s53,s60,s76
s_cmp_eq_u32 s60,125
s_cselect_b32 s53,128,s53
v_mfma_f32_16x16x32_bf16 v[32:35],a[24:27],v[76:79],v[32:35]
s_waitcnt vmcnt(4)
s_mov_b32 s57,s63
ds_read_b128 v[88:91],v4 offset:6144
v_add_f32 v44,v44,v172
v_mfma_f32_16x16x32_bf16 v[36:39],a[28:31],v[76:79],v[36:39]
s_waitcnt lgkmcnt(2)
v_add_f32 v45,v45,v173
v_add_f32 v46,v46,v174
v_mfma_f32_16x16x32_bf16 v[32:35],a[32:35],v[80:83],v[32:35]
s_waitcnt vmcnt(3)
ds_read_b128 v[92:95],v4 offset:7168
v_add_f32 v47,v47,v175
v_mfma_f32_16x16x32_bf16 v[36:39],a[36:39],v[80:83],v[36:39]
s_waitcnt lgkmcnt(2)
s_barrier
ds_read_b128 v[96:99],v5 offset:0
v_mfma_f32_16x16x32_bf16 v[32:35],a[40:43],v[84:87],v[32:35]
ds_read_b128 v[100:103],v5 offset:1024
v_cvt_pk_bf16_f32 v176,v40,v41
v_mfma_f32_16x16x32_bf16 v[36:39],a[44:47],v[84:87],v[36:39]
s_waitcnt lgkmcnt(3)
ds_read_b128 v[104:107],v5 offset:2048
v_cvt_pk_bf16_f32 v177,v42,v43
v_mfma_f32_16x16x32_bf16 v[32:35],a[48:51],v[88:91],v[32:35]
ds_read_b128 v[108:111],v5 offset:3072
v_cvt_pk_bf16_f32 v178,v44,v45
v_mfma_f32_16x16x32_bf16 v[36:39],a[52:55],v[88:91],v[36:39]
s_waitcnt lgkmcnt(4)
ds_read_b128 v[112:115],v5 offset:4096
v_cvt_pk_bf16_f32 v179,v46,v47
v_mfma_f32_16x16x32_bf16 v[32:35],a[56:59],v[92:95],v[32:35]
ds_read_b128 v[116:119],v5 offset:5120
v_mfma_f32_16x16x32_bf16 v[36:39],a[60:63],v[92:95],v[36:39]
s_waitcnt lgkmcnt(5)
v_mfma_f32_16x16x32_bf16 v[32:35],a[64:67],v[96:99],v[32:35]
ds_read_b128 v[120:123],v5 offset:6144
v_mfma_f32_16x16x32_bf16 v[36:39],a[68:71],v[96:99],v[36:39]
s_waitcnt lgkmcnt(5)
buffer_load_dword v16,v2,s[20:23],s68 offen sc1
v_mfma_f32_16x16x32_bf16 v[32:35],a[72:75],v[100:103],v[32:35]
ds_read_b128 v[124:127],v5 offset:7168
v_mfma_f32_16x16x32_bf16 v[36:39],a[76:79],v[100:103],v[36:39]
s_waitcnt lgkmcnt(5)
s_waitcnt vmcnt(2)
v_mov_b32 v17,s57
buffer_store_dword v17,v26,s[20:23],s69 offen sc1
v_mfma_f32_16x16x32_bf16 v[32:35],a[80:83],v[104:107],v[32:35]
ds_read_b128 v[64:67],v6 offset:0
v_mfma_f32_16x16x32_bf16 v[36:39],a[84:87],v[104:107],v[36:39]
s_waitcnt lgkmcnt(5)
buffer_store_dwordx4 v[176:179],v0,s[20:23],s66 offen sc1
v_mfma_f32_16x16x32_bf16 v[32:35],a[88:91],v[108:111],v[32:35]
s_add_u32 s66,s66,32768
s_add_u32 s63,s63,1
ds_read_b128 v[68:71],v6 offset:1024
v_mfma_f32_16x16x32_bf16 v[36:39],a[92:95],v[108:111],v[36:39]
s_waitcnt lgkmcnt(5)
v_mfma_f32_16x16x32_bf16 v[32:35],a[96:99],v[112:115],v[32:35]
ds_read_b128 v[72:75],v6 offset:2048
v_mfma_f32_16x16x32_bf16 v[36:39],a[100:103],v[112:115],v[36:39]
s_waitcnt lgkmcnt(5)
v_mfma_f32_16x16x32_bf16 v[32:35],a[104:107],v[116:119],v[32:35]
ds_read_b128 v[76:79],v6 offset:3072
v_mfma_f32_16x16x32_bf16 v[36:39],a[108:111],v[116:119],v[36:39]
s_waitcnt lgkmcnt(5)
v_mfma_f32_16x16x32_bf16 v[32:35],a[112:115],v[120:123],v[32:35]
ds_read_b128 v[80:83],v6 offset:4096
v_mfma_f32_16x16x32_bf16 v[36:39],a[116:119],v[120:123],v[36:39]
s_waitcnt lgkmcnt(5)
v_mfma_f32_16x16x32_bf16 v[32:35],a[120:123],v[124:127],v[32:35]
ds_read_b128 v[84:87],v6 offset:5120
v_mfma_f32_16x16x32_bf16 v[36:39],a[124:127],v[124:127],v[36:39]
s_waitcnt lgkmcnt(5)
v_mfma_f32_16x16x32_bf16 v[32:35],a[128:131],v[64:67],v[32:35]
ds_read_b128 v[88:91],v6 offset:6144
v_mfma_f32_16x16x32_bf16 v[36:39],a[132:135],v[64:67],v[36:39]
s_waitcnt lgkmcnt(5)
v_mfma_f32_16x16x32_bf16 v[32:35],a[136:139],v[68:71],v[32:35]
ds_read_b128 v[92:95],v6 offset:7168
v_mfma_f32_16x16x32_bf16 v[36:39],a[140:143],v[68:71],v[36:39]
s_waitcnt lgkmcnt(5)
v_mfma_f32_16x16x32_bf16 v[32:35],a[144:147],v[72:75],v[32:35]
ds_read_b128 v[96:99],v7 offset:0
v_mfma_f32_16x16x32_bf16 v[36:39],a[148:151],v[72:75],v[36:39]
s_waitcnt lgkmcnt(5)
v_mfma_f32_16x16x32_bf16 v[32:35],a[152:155],v[76:79],v[32:35]
ds_read_b128 v[100:103],v7 offset:1024
v_mfma_f32_16x16x32_bf16 v[36:39],a[156:159],v[76:79],v[36:39]
s_waitcnt lgkmcnt(5)
v_mfma_f32_16x16x32_bf16 v[32:35],a[160:163],v[80:83],v[32:35]
ds_read_b128 v[104:107],v7 offset:2048
v_mfma_f32_16x16x32_bf16 v[36:39],a[164:167],v[80:83],v[36:39]
s_waitcnt lgkmcnt(5)
v_mfma_f32_16x16x32_bf16 v[32:35],a[168:171],v[84:87],v[32:35]
ds_read_b128 v[108:111],v7 offset:3072
v_mfma_f32_16x16x32_bf16 v[36:39],a[172:175],v[84:87],v[36:39]
s_waitcnt lgkmcnt(5)
v_mfma_f32_16x16x32_bf16 v[32:35],a[176:179],v[88:91],v[32:35]
ds_read_b128 v[112:115],v7 offset:4096
v_mfma_f32_16x16x32_bf16 v[36:39],a[180:183],v[88:91],v[36:39]
s_waitcnt lgkmcnt(5)
v_mfma_f32_16x16x32_bf16 v[32:35],a[184:187],v[92:95],v[32:35]
ds_read_b128 v[116:119],v7 offset:5120
v_mfma_f32_16x16x32_bf16 v[36:39],a[188:191],v[92:95],v[36:39]
s_waitcnt lgkmcnt(5)
v_mfma_f32_16x16x32_bf16 v[32:35],a[192:195],v[96:99],v[32:35]
ds_read_b128 v[120:123],v7 offset:6144
v_mfma_f32_16x16x32_bf16 v[36:39],a[196:199],v[96:99],v[36:39]
s_waitcnt lgkmcnt(5)
v_mfma_f32_16x16x32_bf16 v[32:35],a[200:203],v[100:103],v[32:35]
s_waitcnt vmcnt(3)
ds_read_b128 v[124:127],v7 offset:7168
v_lshlrev_b32 v168,16,v160
v_mfma_f32_16x16x32_bf16 v[36:39],a[204:207],v[100:103],v[36:39]
s_waitcnt lgkmcnt(5)
v_and_b32 v169,s73,v160
v_lshlrev_b32 v170,16,v161
v_mfma_f32_16x16x32_bf16 v[32:35],a[208:211],v[104:107],v[32:35]
s_add_u32 s55,s55,32768
v_and_b32 v171,s73,v161
v_lshlrev_b32 v172,16,v162
v_mfma_f32_16x16x32_bf16 v[36:39],a[212:215],v[104:107],v[36:39]
s_waitcnt lgkmcnt(4)
v_and_b32 v173,s73,v162
v_lshlrev_b32 v174,16,v163
v_mfma_f32_16x16x32_bf16 v[32:35],a[216:219],v[108:111],v[32:35]
s_and_b32 s55,s55,0x1ffff
v_and_b32 v175,s73,v163
v_add_u32 v4,s55,v8
v_mfma_f32_16x16x32_bf16 v[36:39],a[220:223],v[108:111],v[36:39]
s_waitcnt lgkmcnt(3)
v_add_u32 v5,s55,v9
v_add_u32 v6,s55,v10
v_mfma_f32_16x16x32_bf16 v[32:35],a[224:227],v[112:115],v[32:35]
v_add_u32 v7,s55,v11
v_mfma_f32_16x16x32_bf16 v[36:39],a[228:231],v[112:115],v[36:39]
s_waitcnt lgkmcnt(2)
v_mfma_f32_16x16x32_bf16 v[32:35],a[232:235],v[116:119],v[32:35]
v_mfma_f32_16x16x32_bf16 v[36:39],a[236:239],v[116:119],v[36:39]
s_waitcnt lgkmcnt(1)
v_mfma_f32_16x16x32_bf16 v[32:35],a[240:243],v[120:123],v[32:35]
v_mfma_f32_16x16x32_bf16 v[36:39],a[244:247],v[120:123],v[36:39]
s_waitcnt lgkmcnt(0)
v_mfma_f32_16x16x32_bf16 v[40:43],a[248:251],v[124:127],v[32:35]
v_mfma_f32_16x16x32_bf16 v[44:47],a[252:255],v[124:127],v[36:39]
s_waitcnt vmcnt(2)
v_cmp_gt_u32 vcc,s71,v16
s_add_u32 s60,s60,1
s_branch endN_343
BN_337:
s_waitcnt vmcnt(9)
ds_read_b128 v[64:67],v4 offset:0
s_waitcnt vmcnt(8)
ds_read_b128 v[68:71],v4 offset:1024
s_waitcnt vmcnt(7)
ds_read_b128 v[72:75],v4 offset:2048
s_waitcnt vmcnt(6)
ds_read_b128 v[76:79],v4 offset:3072
s_waitcnt lgkmcnt(3)
v_mfma_f32_16x16x32_bf16 v[32:35],a[0:3],v[64:67],0
buffer_load_dwordx4 v[160:163],v0,s[20:23],s82 offen
v_mfma_f32_16x16x32_bf16 v[36:39],a[4:7],v[64:67],0
s_waitcnt lgkmcnt(2)
s_waitcnt vmcnt(6)
s_add_u32 s82,s82,32768
ds_read_b128 v[80:83],v4 offset:4096
v_mfma_f32_16x16x32_bf16 v[32:35],a[8:11],v[68:71],v[32:35]
s_add_u32 s71,s60,s75
s_cmp_eq_u32 s60,126
s_cselect_b32 s71,128,s71
v_mfma_f32_16x16x32_bf16 v[36:39],a[12:15],v[68:71],v[36:39]
s_waitcnt lgkmcnt(2)
s_waitcnt vmcnt(5)
ds_read_b128 v[84:87],v4 offset:5120
v_mfma_f32_16x16x32_bf16 v[32:35],a[16:19],v[72:75],v[32:35]
s_add_u32 s53,s60,s76
s_cmp_eq_u32 s60,125
s_cselect_b32 s53,128,s53
v_mfma_f32_16x16x32_bf16 v[36:39],a[20:23],v[72:75],v[36:39]
s_waitcnt lgkmcnt(2)
s_waitcnt vmcnt(4)
ds_read_b128 v[88:91],v4 offset:6144
v_mfma_f32_16x16x32_bf16 v[32:35],a[24:27],v[76:79],v[32:35]
s_mov_b32 s57,s63
v_mfma_f32_16x16x32_bf16 v[36:39],a[28:31],v[76:79],v[36:39]
s_waitcnt lgkmcnt(2)
s_waitcnt vmcnt(3)
ds_read_b128 v[92:95],v4 offset:7168
v_mfma_f32_16x16x32_bf16 v[32:35],a[32:35],v[80:83],v[32:35]
v_mfma_f32_16x16x32_bf16 v[36:39],a[36:39],v[80:83],v[36:39]
s_waitcnt lgkmcnt(2)
s_barrier
ds_read_b128 v[96:99],v5 offset:0
v_mfma_f32_16x16x32_bf16 v[32:35],a[40:43],v[84:87],v[32:35]
ds_read_b128 v[100:103],v5 offset:1024
v_mfma_f32_16x16x32_bf16 v[36:39],a[44:47],v[84:87],v[36:39]
s_waitcnt lgkmcnt(3)
ds_read_b128 v[104:107],v5 offset:2048
v_mfma_f32_16x16x32_bf16 v[32:35],a[48:51],v[88:91],v[32:35]
ds_read_b128 v[108:111],v5 offset:3072
v_mfma_f32_16x16x32_bf16 v[36:39],a[52:55],v[88:91],v[36:39]
s_waitcnt lgkmcnt(4)
ds_read_b128 v[112:115],v5 offset:4096
v_mfma_f32_16x16x32_bf16 v[32:35],a[56:59],v[92:95],v[32:35]
ds_read_b128 v[116:119],v5 offset:5120
v_mfma_f32_16x16x32_bf16 v[36:39],a[60:63],v[92:95],v[36:39]
s_waitcnt lgkmcnt(5)
v_mfma_f32_16x16x32_bf16 v[32:35],a[64:67],v[96:99],v[32:35]
ds_read_b128 v[120:123],v5 offset:6144
v_mfma_f32_16x16x32_bf16 v[36:39],a[68:71],v[96:99],v[36:39]
s_waitcnt lgkmcnt(5)
v_mfma_f32_16x16x32_bf16 v[32:35],a[72:75],v[100:103],v[32:35]
ds_read_b128 v[124:127],v5 offset:7168
v_mfma_f32_16x16x32_bf16 v[36:39],a[76:79],v[100:103],v[36:39]
s_waitcnt lgkmcnt(5)
v_mfma_f32_16x16x32_bf16 v[32:35],a[80:83],v[104:107],v[32:35]
ds_read_b128 v[64:67],v6 offset:0
v_mfma_f32_16x16x32_bf16 v[36:39],a[84:87],v[104:107],v[36:39]
s_waitcnt lgkmcnt(5)
v_mfma_f32_16x16x32_bf16 v[32:35],a[88:91],v[108:111],v[32:35]
ds_read_b128 v[68:71],v6 offset:1024
v_mfma_f32_16x16x32_bf16 v[36:39],a[92:95],v[108:111],v[36:39]
s_waitcnt lgkmcnt(5)
v_mfma_f32_16x16x32_bf16 v[32:35],a[96:99],v[112:115],v[32:35]
ds_read_b128 v[72:75],v6 offset:2048
v_mfma_f32_16x16x32_bf16 v[36:39],a[100:103],v[112:115],v[36:39]
s_waitcnt lgkmcnt(5)
v_mfma_f32_16x16x32_bf16 v[32:35],a[104:107],v[116:119],v[32:35]
ds_read_b128 v[76:79],v6 offset:3072
v_mfma_f32_16x16x32_bf16 v[36:39],a[108:111],v[116:119],v[36:39]
s_waitcnt lgkmcnt(5)
v_mfma_f32_16x16x32_bf16 v[32:35],a[112:115],v[120:123],v[32:35]
ds_read_b128 v[80:83],v6 offset:4096
v_mfma_f32_16x16x32_bf16 v[36:39],a[116:119],v[120:123],v[36:39]
s_waitcnt lgkmcnt(5)
v_mfma_f32_16x16x32_bf16 v[32:35],a[120:123],v[124:127],v[32:35]
ds_read_b128 v[84:87],v6 offset:5120
v_mfma_f32_16x16x32_bf16 v[36:39],a[124:127],v[124:127],v[36:39]
s_waitcnt lgkmcnt(5)
v_mfma_f32_16x16x32_bf16 v[32:35],a[128:131],v[64:67],v[32:35]
ds_read_b128 v[88:91],v6 offset:6144
v_mfma_f32_16x16x32_bf16 v[36:39],a[132:135],v[64:67],v[36:39]
s_waitcnt lgkmcnt(5)
v_mfma_f32_16x16x32_bf16 v[32:35],a[136:139],v[68:71],v[32:35]
ds_read_b128 v[92:95],v6 offset:7168
v_mfma_f32_16x16x32_bf16 v[36:39],a[140:143],v[68:71],v[36:39]
s_waitcnt lgkmcnt(5)
v_mfma_f32_16x16x32_bf16 v[32:35],a[144:147],v[72:75],v[32:35]
ds_read_b128 v[96:99],v7 offset:0
v_mfma_f32_16x16x32_bf16 v[36:39],a[148:151],v[72:75],v[36:39]
s_waitcnt lgkmcnt(5)
s_waitcnt vmcnt(2)
v_mov_b32 v17,s57
buffer_store_dword v17,v26,s[20:23],s69 offen sc1
v_mfma_f32_16x16x32_bf16 v[32:35],a[152:155],v[76:79],v[32:35]
ds_read_b128 v[100:103],v7 offset:1024
v_mfma_f32_16x16x32_bf16 v[36:39],a[156:159],v[76:79],v[36:39]
s_waitcnt lgkmcnt(5)
v_mfma_f32_16x16x32_bf16 v[32:35],a[160:163],v[80:83],v[32:35]
ds_read_b128 v[104:107],v7 offset:2048
buffer_load_dword v16,v2,s[20:23],s68 offen sc1
v_mfma_f32_16x16x32_bf16 v[36:39],a[164:167],v[80:83],v[36:39]
s_waitcnt lgkmcnt(5)
v_mfma_f32_16x16x32_bf16 v[32:35],a[168:171],v[84:87],v[32:35]
ds_read_b128 v[108:111],v7 offset:3072
v_mfma_f32_16x16x32_bf16 v[36:39],a[172:175],v[84:87],v[36:39]
s_waitcnt lgkmcnt(5)
v_mfma_f32_16x16x32_bf16 v[32:35],a[176:179],v[88:91],v[32:35]
ds_read_b128 v[112:115],v7 offset:4096
v_mfma_f32_16x16x32_bf16 v[36:39],a[180:183],v[88:91],v[36:39]
s_waitcnt lgkmcnt(5)
v_mfma_f32_16x16x32_bf16 v[32:35],a[184:187],v[92:95],v[32:35]
ds_read_b128 v[116:119],v7 offset:5120
v_mfma_f32_16x16x32_bf16 v[36:39],a[188:191],v[92:95],v[36:39]
s_waitcnt lgkmcnt(5)
v_mfma_f32_16x16x32_bf16 v[32:35],a[192:195],v[96:99],v[32:35]
ds_read_b128 v[120:123],v7 offset:6144
v_mfma_f32_16x16x32_bf16 v[36:39],a[196:199],v[96:99],v[36:39]
s_waitcnt lgkmcnt(5)
v_mfma_f32_16x16x32_bf16 v[32:35],a[200:203],v[100:103],v[32:35]
s_waitcnt vmcnt(2)
ds_read_b128 v[124:127],v7 offset:7168
v_lshlrev_b32 v168,16,v160
v_mfma_f32_16x16x32_bf16 v[36:39],a[204:207],v[100:103],v[36:39]
s_waitcnt lgkmcnt(5)
v_and_b32 v169,s73,v160
v_lshlrev_b32 v170,16,v161
v_mfma_f32_16x16x32_bf16 v[32:35],a[208:211],v[104:107],v[32:35]
s_add_u32 s55,s55,32768
v_and_b32 v171,s73,v161
v_lshlrev_b32 v172,16,v162
v_mfma_f32_16x16x32_bf16 v[36:39],a[212:215],v[104:107],v[36:39]
s_waitcnt lgkmcnt(4)
v_and_b32 v173,s73,v162
v_lshlrev_b32 v174,16,v163
v_mfma_f32_16x16x32_bf16 v[32:35],a[216:219],v[108:111],v[32:35]
s_and_b32 s55,s55,0x1ffff
v_and_b32 v175,s73,v163
v_add_u32 v4,s55,v8
v_mfma_f32_16x16x32_bf16 v[36:39],a[220:223],v[108:111],v[36:39]
s_waitcnt lgkmcnt(3)
v_add_u32 v5,s55,v9
v_add_u32 v6,s55,v10
v_mfma_f32_16x16x32_bf16 v[32:35],a[224:227],v[112:115],v[32:35]
v_add_u32 v7,s55,v11
v_mfma_f32_16x16x32_bf16 v[36:39],a[228:231],v[112:115],v[36:39]
s_waitcnt lgkmcnt(2)
v_mfma_f32_16x16x32_bf16 v[32:35],a[232:235],v[116:119],v[32:35]
v_mfma_f32_16x16x32_bf16 v[36:39],a[236:239],v[116:119],v[36:39]
s_waitcnt lgkmcnt(1)
v_mfma_f32_16x16x32_bf16 v[32:35],a[240:243],v[120:123],v[32:35]
v_mfma_f32_16x16x32_bf16 v[36:39],a[244:247],v[120:123],v[36:39]
s_waitcnt lgkmcnt(0)
v_mfma_f32_16x16x32_bf16 v[40:43],a[248:251],v[124:127],v[32:35]
v_mfma_f32_16x16x32_bf16 v[44:47],a[252:255],v[124:127],v[36:39]
s_waitcnt vmcnt(0)
v_cmp_gt_u32 vcc,s71,v16
s_add_u32 s60,s60,1
endN_343:
s_cbranch_vccnz nb_340
s_mov_b32 m0,s70
s_nop 0
buffer_load_dwordx4 v3,s[20:23],s61 offen offset:0 lds
buffer_load_dwordx4 v3,s[20:23],s61 offen offset:1024 lds
buffer_load_dwordx4 v3,s[20:23],s61 offen offset:2048 lds
buffer_load_dwordx4 v3,s[20:23],s61 offen offset:3072 lds
s_add_u32 m0,s70,4096
s_nop 0
buffer_load_dwordx4 v3,s[20:23],s62 offen offset:0 lds
buffer_load_dwordx4 v3,s[20:23],s62 offen offset:1024 lds
buffer_load_dwordx4 v3,s[20:23],s62 offen offset:2048 lds
buffer_load_dwordx4 v3,s[20:23],s62 offen offset:3072 lds
s_add_u32 s61,s61,32768
s_add_u32 s62,s62,32768
s_add_u32 s70,s70,32768
s_and_b32 s70,s70,0x1ffff
s_mov_b32 s57,s63
v_pk_add_f32 v[40:41],v[40:41],v[168:169]
v_pk_add_f32 v[42:43],v[42:43],v[170:171]
v_pk_add_f32 v[44:45],v[44:45],v[172:173]
v_pk_add_f32 v[46:47],v[46:47],v[174:175]
v_cvt_pk_bf16_f32 v176,v40,v41
v_cvt_pk_bf16_f32 v177,v42,v43
v_cvt_pk_bf16_f32 v178,v44,v45
v_cvt_pk_bf16_f32 v179,v46,v47
buffer_store_dwordx4 v[176:179],v0,s[20:23],s66 offen sc1
s_add_u32 s66,s66,32768
s_add_u32 s63,s63,1
s_waitcnt vmcnt(9)
v_mov_b32 v17,s57
buffer_store_dword v17,v26,s[20:23],s69 offen sc1
s_branch dec_339
nb_340:
buffer_load_dword v16,v2,s[20:23],s68 offen sc1
s_nop 3
s_mov_b32 s57,s63
v_pk_add_f32 v[40:41],v[40:41],v[168:169]
v_pk_add_f32 v[42:43],v[42:43],v[170:171]
v_pk_add_f32 v[44:45],v[44:45],v[172:173]
v_pk_add_f32 v[46:47],v[46:47],v[174:175]
v_cvt_pk_bf16_f32 v176,v40,v41
v_cvt_pk_bf16_f32 v177,v42,v43
v_cvt_pk_bf16_f32 v178,v44,v45
v_cvt_pk_bf16_f32 v179,v46,v47
buffer_store_dwordx4 v[176:179],v0,s[20:23],s66 offen sc1
s_add_u32 s66,s66,32768
s_add_u32 s63,s63,1
s_waitcnt vmcnt(2)
v_mov_b32 v17,s57
buffer_store_dword v17,v26,s[20:23],s69 offen sc1
s_waitcnt vmcnt(2)
v_cmp_gt_u32 vcc,s71,v16
s_cbranch_vccz lag_338
s_waitcnt vmcnt(1)
v_mov_b32 v17,s63
buffer_store_dword v17,v26,s[20:23],s69 offen sc1
s_cmp_ge_u32 s60,128
s_cbranch_scc1 done_327
plp_344:
buffer_load_dword v16,v2,s[20:23],s68 offen sc1
s_waitcnt vmcnt(0)
v_cmp_gt_u32 vcc,s71,v16
s_cbranch_vccz pok_345
s_sleep 4
s_sub_u32 s90,s90,1
s_cmp_gt_i32 s90,0
s_cbranch_scc1 plp_344
pok_345:
s_branch lag_338
done_327:
s_endpgm
fl_ln2:
s_mov_b32 s52,s59
s_mov_b32 s60,0
s_mov_b32 s73,0xffff0000
v_and_b32 v2,3,v1
v_lshrrev_b32 v3,2,v1
s_lshl_b32 s64,s52,2
v_add_u32 v4,s64,v2
s_lshl_b32 s65,s50,9
v_lshlrev_b32 v5,4,v3
v_add_u32 v5,s65,v5
v_lshl_add_u32 v8,v4,11,v5
v_lshlrev_b32 v9,1,v5
v_lshrrev_b32 v5,2,v3
v_and_b32 v3,3,v3
s_lshl_b32 s65,s50,13
v_lshlrev_b32 v5,10,v5
v_lshl_add_u32 v5,v3,8,v5
v_lshl_add_u32 v5,v4,4,v5
v_add_u32 v10,s65,v5
s_lshl_b32 s65,s50,9
v_lshlrev_b32 v5,3,v1
v_add_u32 v11,s65,v5
v_lshlrev_b32 v12,3,v2
v_and_b32 v13,7,v1
v_lshlrev_b32 v13,2,v13
s_mov_b32 s92,s2
s_and_b32 s93,s3,0xffff
s_mov_b32 s94,0x100
s_mov_b32 s95,0x20000
v_mbcnt_lo_u32_b32 v16,-1,0
v_mbcnt_hi_u32_b32 v16,-1,v16
v_mov_b32 v18,0
v_cmp_eq_u32 vcc,22,v16
s_nop 1
v_cndmask_b32 v18,v18,63,vcc
v_cmp_eq_u32 vcc,17,v16
s_nop 1
v_cndmask_b32 v18,v18,63,vcc
v_cmp_eq_u32 vcc,18,v16
s_nop 1
v_cndmask_b32 v18,v18,1,vcc
v_and_b32 v19,1,v16
v_cmp_eq_u32 vcc,1,v19
v_mov_b32 v19,8192
s_nop 0
v_cndmask_b32 v19,-1,v19,vcc
v_min_u32 v16,31,v16
v_lshlrev_b32 v16,2,v16
s_sub_u32 s66,s88,64
s_cmp_lg_u32 s50,0
s_cbranch_scc1 vot_351
vpoll_347:
buffer_load_dword v17,v16,s[92:95],s66 offen sc1
s_waitcnt vmcnt(0)
s_cmp_lg_u32 s56,2
s_cbranch_scc1 vck_348
v_cmp_eq_u32 vcc,v17,v19
s_and_b32 s64,vcc_lo,0xffff
s_cmp_eq_u32 s64,65535
s_cbranch_scc1 vck_348
s_mov_b32 s65,0
v_readlane_b32 s64,v17,1
s_lshr_b32 s64,s64,8
s_add_u32 s65,s65,s64
v_readlane_b32 s64,v17,3
s_lshr_b32 s64,s64,8
s_add_u32 s65,s65,s64
v_readlane_b32 s64,v17,5
s_lshr_b32 s64,s64,8
s_add_u32 s65,s65,s64
v_readlane_b32 s64,v17,7
s_lshr_b32 s64,s64,8
s_add_u32 s65,s65,s64
v_readlane_b32 s64,v17,9
s_lshr_b32 s64,s64,8
s_add_u32 s65,s65,s64
v_readlane_b32 s64,v17,11
s_lshr_b32 s64,s64,8
s_add_u32 s65,s65,s64
v_readlane_b32 s64,v17,13
s_lshr_b32 s64,s64,8
s_add_u32 s65,s65,s64
v_readlane_b32 s64,v17,15
s_lshr_b32 s64,s64,8
s_add_u32 s65,s65,s64
s_cmp_ge_u32 s65,256
s_cbranch_scc1 vok_350
s_branch vrt_349
vck_348:
v_cmp_gt_u32 vcc,v18,v17
s_cbranch_vccz vok_350
vrt_349:
s_sleep 48
s_sub_u32 s90,s90,1
s_cmp_gt_i32 s90,0
s_cbranch_scc1 vpoll_347
vok_350:
v_add_u32 v18,161024,v16
ds_write_b32 v18,v17
s_waitcnt lgkmcnt(0)
vot_351:
s_barrier
v_add_u32 v18,161024,v16
ds_read_b32 v17,v18
s_waitcnt lgkmcnt(0)
s_cmp_lg_u32 s56,2
s_cbranch_scc1 vfin_352
v_cmp_eq_u32 vcc,v17,v19
s_and_b32 s64,vcc_lo,0xffff
s_cmp_eq_u32 s64,65535
s_cbranch_scc1 vfin_352
s_mov_b32 s65,0
v_readlane_b32 s64,v17,1
s_lshr_b32 s64,s64,8
s_add_u32 s65,s65,s64
v_readlane_b32 s64,v17,3
s_lshr_b32 s64,s64,8
s_add_u32 s65,s65,s64
v_readlane_b32 s64,v17,5
s_lshr_b32 s64,s64,8
s_add_u32 s65,s65,s64
v_readlane_b32 s64,v17,7
s_lshr_b32 s64,s64,8
s_add_u32 s65,s65,s64
v_readlane_b32 s64,v17,9
s_lshr_b32 s64,s64,8
s_add_u32 s65,s65,s64
v_readlane_b32 s64,v17,11
s_lshr_b32 s64,s64,8
s_add_u32 s65,s65,s64
v_readlane_b32 s64,v17,13
s_lshr_b32 s64,s64,8
s_add_u32 s65,s65,s64
v_readlane_b32 s64,v17,15
s_lshr_b32 s64,s64,8
s_add_u32 s65,s65,s64
s_cmp_ge_u32 s65,256
s_cbranch_scc1 fl_fb
vfin_352:
s_and_b32 s56,s56,1
s_mov_b32 s67,0
s_mov_b32 s64,267403264
buffer_load_dwordx4 v[32:35],v9,s[20:23],s64 offen offset:0 sc1
buffer_load_dwordx4 v[36:39],v9,s[20:23],s64 offen offset:16 sc1
buffer_load_dwordx4 v[40:43],v9,s[20:23],s64 offen offset:512 sc1
buffer_load_dwordx4 v[44:47],v9,s[20:23],s64 offen offset:528 sc1
s_mov_b32 s64,267427840
buffer_load_dwordx4 v[64:67],v9,s[20:23],s64 offen offset:0 sc1
buffer_load_dwordx4 v[68:71],v9,s[20:23],s64 offen offset:16 sc1
buffer_load_dwordx4 v[72:75],v9,s[20:23],s64 offen offset:512 sc1
buffer_load_dwordx4 v[76:79],v9,s[20:23],s64 offen offset:528 sc1
s_mov_b32 s64,267452416
buffer_load_dwordx4 v[80:83],v9,s[20:23],s64 offen offset:0 sc1
buffer_load_dwordx4 v[84:87],v9,s[20:23],s64 offen offset:16 sc1
buffer_load_dwordx4 v[88:91],v9,s[20:23],s64 offen offset:512 sc1
buffer_load_dwordx4 v[92:95],v9,s[20:23],s64 offen offset:528 sc1
s_mov_b32 s64,267476992
buffer_load_dwordx4 v[96:99],v9,s[20:23],s64 offen offset:0 sc1
buffer_load_dwordx4 v[100:103],v9,s[20:23],s64 offen offset:16 sc1
buffer_load_dwordx4 v[104:107],v9,s[20:23],s64 offen offset:512 sc1
buffer_load_dwordx4 v[108:111],v9,s[20:23],s64 offen offset:528 sc1
s_waitcnt vmcnt(0)
v_pk_add_f32 v[32:33],v[32:33],v[64:65]
v_pk_add_f32 v[80:81],v[80:81],v[96:97]
v_pk_add_f32 v[34:35],v[34:35],v[66:67]
v_pk_add_f32 v[82:83],v[82:83],v[98:99]
v_pk_add_f32 v[36:37],v[36:37],v[68:69]
v_pk_add_f32 v[84:85],v[84:85],v[100:101]
v_pk_add_f32 v[38:39],v[38:39],v[70:71]
v_pk_add_f32 v[86:87],v[86:87],v[102:103]
v_pk_add_f32 v[40:41],v[40:41],v[72:73]
v_pk_add_f32 v[88:89],v[88:89],v[104:105]
v_pk_add_f32 v[42:43],v[42:43],v[74:75]
v_pk_add_f32 v[90:91],v[90:91],v[106:107]
v_pk_add_f32 v[44:45],v[44:45],v[76:77]
v_pk_add_f32 v[92:93],v[92:93],v[108:109]
v_pk_add_f32 v[46:47],v[46:47],v[78:79]
v_pk_add_f32 v[94:95],v[94:95],v[110:111]
v_pk_add_f32 v[32:33],v[32:33],v[80:81]
v_pk_add_f32 v[34:35],v[34:35],v[82:83]
v_pk_add_f32 v[36:37],v[36:37],v[84:85]
v_pk_add_f32 v[38:39],v[38:39],v[86:87]
v_pk_add_f32 v[40:41],v[40:41],v[88:89]
v_pk_add_f32 v[42:43],v[42:43],v[90:91]
v_pk_add_f32 v[44:45],v[44:45],v[92:93]
v_pk_add_f32 v[46:47],v[46:47],v[94:95]
v_cvt_pk_bf16_f32 v64,v32,v33
v_cvt_pk_bf16_f32 v65,v34,v35
v_cvt_pk_bf16_f32 v66,v36,v37
v_cvt_pk_bf16_f32 v67,v38,v39
v_cvt_pk_bf16_f32 v68,v40,v41
v_cvt_pk_bf16_f32 v69,v42,v43
v_cvt_pk_bf16_f32 v70,v44,v45
v_cvt_pk_bf16_f32 v71,v46,v47
v_lshlrev_b32 v32,16,v64
v_and_b32 v33,s73,v64
v_lshlrev_b32 v34,16,v65
v_and_b32 v35,s73,v65
v_lshlrev_b32 v36,16,v66
v_and_b32 v37,s73,v66
v_lshlrev_b32 v38,16,v67
v_and_b32 v39,s73,v67
v_lshlrev_b32 v40,16,v68
v_and_b32 v41,s73,v68
v_lshlrev_b32 v42,16,v69
v_and_b32 v43,s73,v69
v_lshlrev_b32 v44,16,v70
v_and_b32 v45,s73,v70
v_lshlrev_b32 v46,16,v71
v_and_b32 v47,s73,v71
v_add_f32 v32,1.0,v32
v_add_f32 v33,1.0,v33
v_add_f32 v34,1.0,v34
v_add_f32 v35,1.0,v35
v_add_f32 v36,1.0,v36
v_add_f32 v37,1.0,v37
v_add_f32 v38,1.0,v38
v_add_f32 v39,1.0,v39
v_add_f32 v40,1.0,v40
v_add_f32 v41,1.0,v41
v_add_f32 v42,1.0,v42
v_add_f32 v43,1.0,v43
v_add_f32 v44,1.0,v44
v_add_f32 v45,1.0,v45
v_add_f32 v46,1.0,v46
v_add_f32 v47,1.0,v47
s_mov_b32 s64,267399168
buffer_load_dwordx4 v[48:51],v9,s[20:23],s64 offen offset:0 sc1
buffer_load_dwordx4 v[52:55],v9,s[20:23],s64 offen offset:16 sc1
buffer_load_dwordx4 v[56:59],v9,s[20:23],s64 offen offset:512 sc1
buffer_load_dwordx4 v[60:63],v9,s[20:23],s64 offen offset:528 sc1
s_mov_b32 s64,267423744
buffer_load_dwordx4 v[64:67],v9,s[20:23],s64 offen offset:0 sc1
buffer_load_dwordx4 v[68:71],v9,s[20:23],s64 offen offset:16 sc1
buffer_load_dwordx4 v[72:75],v9,s[20:23],s64 offen offset:512 sc1
buffer_load_dwordx4 v[76:79],v9,s[20:23],s64 offen offset:528 sc1
s_mov_b32 s64,267448320
buffer_load_dwordx4 v[80:83],v9,s[20:23],s64 offen offset:0 sc1
buffer_load_dwordx4 v[84:87],v9,s[20:23],s64 offen offset:16 sc1
buffer_load_dwordx4 v[88:91],v9,s[20:23],s64 offen offset:512 sc1
buffer_load_dwordx4 v[92:95],v9,s[20:23],s64 offen offset:528 sc1
s_mov_b32 s64,267472896
buffer_load_dwordx4 v[96:99],v9,s[20:23],s64 offen offset:0 sc1
buffer_load_dwordx4 v[100:103],v9,s[20:23],s64 offen offset:16 sc1
buffer_load_dwordx4 v[104:107],v9,s[20:23],s64 offen offset:512 sc1
buffer_load_dwordx4 v[108:111],v9,s[20:23],s64 offen offset:528 sc1
s_waitcnt vmcnt(0)
v_pk_add_f32 v[48:49],v[48:49],v[64:65]
v_pk_add_f32 v[80:81],v[80:81],v[96:97]
v_pk_add_f32 v[50:51],v[50:51],v[66:67]
v_pk_add_f32 v[82:83],v[82:83],v[98:99]
v_pk_add_f32 v[52:53],v[52:53],v[68:69]
v_pk_add_f32 v[84:85],v[84:85],v[100:101]
v_pk_add_f32 v[54:55],v[54:55],v[70:71]
v_pk_add_f32 v[86:87],v[86:87],v[102:103]
v_pk_add_f32 v[56:57],v[56:57],v[72:73]
v_pk_add_f32 v[88:89],v[88:89],v[104:105]
v_pk_add_f32 v[58:59],v[58:59],v[74:75]
v_pk_add_f32 v[90:91],v[90:91],v[106:107]
v_pk_add_f32 v[60:61],v[60:61],v[76:77]
v_pk_add_f32 v[92:93],v[92:93],v[108:109]
v_pk_add_f32 v[62:63],v[62:63],v[78:79]
v_pk_add_f32 v[94:95],v[94:95],v[110:111]
v_pk_add_f32 v[48:49],v[48:49],v[80:81]
v_pk_add_f32 v[50:51],v[50:51],v[82:83]
v_pk_add_f32 v[52:53],v[52:53],v[84:85]
v_pk_add_f32 v[54:55],v[54:55],v[86:87]
v_pk_add_f32 v[56:57],v[56:57],v[88:89]
v_pk_add_f32 v[58:59],v[58:59],v[90:91]
v_pk_add_f32 v[60:61],v[60:61],v[92:93]
v_pk_add_f32 v[62:63],v[62:63],v[94:95]
v_cvt_pk_bf16_f32 v64,v48,v49
v_cvt_pk_bf16_f32 v65,v50,v51
v_cvt_pk_bf16_f32 v66,v52,v53
v_cvt_pk_bf16_f32 v67,v54,v55
v_cvt_pk_bf16_f32 v68,v56,v57
v_cvt_pk_bf16_f32 v69,v58,v59
v_cvt_pk_bf16_f32 v70,v60,v61
v_cvt_pk_bf16_f32 v71,v62,v63
v_lshlrev_b32 v48,16,v64
v_and_b32 v49,s73,v64
v_lshlrev_b32 v50,16,v65
v_and_b32 v51,s73,v65
v_lshlrev_b32 v52,16,v66
v_and_b32 v53,s73,v66
v_lshlrev_b32 v54,16,v67
v_and_b32 v55,s73,v67
v_lshlrev_b32 v56,16,v68
v_and_b32 v57,s73,v68
v_lshlrev_b32 v58,16,v69
v_and_b32 v59,s73,v69
v_lshlrev_b32 v60,16,v70
v_and_b32 v61,s73,v70
v_lshlrev_b32 v62,16,v71
v_and_b32 v63,s73,v71
s_mov_b32 s63,201326592
s_mov_b32 s66,205520896
s_lshl_b32 s64,s50,8
s_add_u32 s68,s64,138547200
s_lshl_b32 s65,s59,2
s_add_u32 s69,s64,s65
s_add_u32 s69,s69,138548224
s_lshl_b32 s64,s50,9
s_lshl_b32 s65,s59,7
s_add_u32 s69,s64,s65
s_add_u32 s69,s69,138567680
v_lshlrev_b32 v16,2,v1
v_cmp_gt_u32 vcc,32,v1
s_nop 1
v_cndmask_b32 v16,2.0,v16,vcc
s_cmp_eq_u32 s56,1
s_cbranch_scc1 lfar_353
s_add_u32 s64,s63,4096
buffer_load_dwordx4 v[64:67],v10,s[20:23],s63 offen sc1
buffer_load_dwordx4 v[68:71],v10,s[20:23],s64 offen sc1
buffer_load_dword v15,off,s[20:23],s68
buffer_load_dword v15,off,s[20:23],s68
top0_354:
s_waitcnt vmcnt(2)
v_max3_u32 v14,v64,v65,v66
v_max3_u32 v13,v67,v68,v69
v_max3_u32 v14,v14,v70,v71
v_max_u32 v14,v14,v13
v_cmp_eq_u32 vcc,-1,v14
s_cbranch_vccnz rt_356
go_357:
s_add_u32 s63,s63,32768
s_add_u32 s64,s63,4096
buffer_load_dwordx4 v[72:75],v10,s[20:23],s63 offen sc1
buffer_load_dwordx4 v[76:79],v10,s[20:23],s64 offen sc1
v_lshlrev_b32 v80,16,v64
v_and_b32 v81,s73,v64
v_lshlrev_b32 v82,16,v65
v_and_b32 v83,s73,v65
v_lshlrev_b32 v84,16,v66
v_and_b32 v85,s73,v66
v_lshlrev_b32 v86,16,v67
v_and_b32 v87,s73,v67
v_lshlrev_b32 v88,16,v68
v_and_b32 v89,s73,v68
v_lshlrev_b32 v90,16,v69
v_and_b32 v91,s73,v69
v_lshlrev_b32 v92,16,v70
v_and_b32 v93,s73,v70
v_lshlrev_b32 v94,16,v71
v_and_b32 v95,s73,v71
v_add_f32 v96,v80,v81
v_mul_f32 v97,v80,v80
v_add_f32 v98,v82,v83
v_mul_f32 v99,v81,v81
v_fmac_f32 v97,v82,v82
v_fmac_f32 v99,v83,v83
v_add_f32 v96,v96,v84
v_fmac_f32 v97,v84,v84
v_add_f32 v98,v98,v85
v_fmac_f32 v99,v85,v85
v_add_f32 v96,v96,v86
v_fmac_f32 v97,v86,v86
v_add_f32 v98,v98,v87
v_fmac_f32 v99,v87,v87
v_add_f32 v96,v96,v88
v_fmac_f32 v97,v88,v88
v_add_f32 v98,v98,v89
v_fmac_f32 v99,v89,v89
v_add_f32 v96,v96,v90
v_fmac_f32 v97,v90,v90
v_add_f32 v98,v98,v91
v_fmac_f32 v99,v91,v91
v_add_f32 v96,v96,v92
v_fmac_f32 v97,v92,v92
v_add_f32 v98,v98,v93
v_fmac_f32 v99,v93,v93
v_add_f32 v96,v96,v94
v_fmac_f32 v97,v94,v94
v_add_f32 v98,v98,v95
v_fmac_f32 v99,v95,v95
v_add_f32 v96,v96,v98
v_add_f32 v97,v97,v99
s_nop 0
v_add_f32_dpp v96,v96,v96 row_ror:4 row_mask:0xf bank_mask:0xf
v_add_f32_dpp v97,v97,v97 row_ror:4 row_mask:0xf bank_mask:0xf
s_nop 0
v_add_f32_dpp v96,v96,v96 row_ror:8 row_mask:0xf bank_mask:0xf
v_add_f32_dpp v97,v97,v97 row_ror:8 row_mask:0xf bank_mask:0xf
v_mov_b32 v98,v96
v_mov_b32 v99,v97
s_nop 0
v_permlane16_swap_b32 v98,v96
v_permlane16_swap_b32 v99,v97
v_add_f32 v96,v96,v98
v_add_f32 v97,v97,v99
v_mov_b32 v98,v96
v_mov_b32 v99,v97
s_nop 0
v_permlane32_swap_b32 v98,v96
v_permlane32_swap_b32 v99,v97
v_add_f32 v96,v96,v98
v_add_f32 v97,v97,v99
ds_write_b64 v11,v[96:97] offset:0
s_waitcnt lgkmcnt(0)
s_barrier
s_waitcnt vmcnt(2)
v_mov_b32 v15,s60
buffer_store_dword v15,v16,s[20:23],s69 offen
ds_read_b64 v[100:101],v12 offset:0
ds_read_b64 v[102:103],v12 offset:512
ds_read_b64 v[104:105],v12 offset:1024
ds_read_b64 v[106:107],v12 offset:1536
s_waitcnt lgkmcnt(0)
v_add_f32 v100,v100,v102
v_add_f32 v101,v101,v103
v_add_f32 v104,v104,v106
v_add_f32 v105,v105,v107
v_add_f32 v100,v100,v104
v_add_f32 v101,v101,v105
v_mul_f32 v96,0xba800000,v100
v_mul_f32 v102,v96,v96
v_mul_f32 v101,0x3a800000,v101
v_sub_f32 v101,v101,v102
v_max_f32 v101,0,v101
v_add_f32 v101,0x3727c5ac,v101
v_rsq_f32 v97,v101
s_nop 0
v_mul_f32 v96,v96,v97
v_fma_f32 v80,v80,v97,v96
v_fma_f32 v81,v81,v97,v96
v_fma_f32 v82,v82,v97,v96
v_fma_f32 v83,v83,v97,v96
v_fma_f32 v84,v84,v97,v96
v_fma_f32 v85,v85,v97,v96
v_fma_f32 v86,v86,v97,v96
v_fma_f32 v87,v87,v97,v96
v_fma_f32 v88,v88,v97,v96
v_fma_f32 v89,v89,v97,v96
v_fma_f32 v90,v90,v97,v96
v_fma_f32 v91,v91,v97,v96
v_fma_f32 v92,v92,v97,v96
v_fma_f32 v93,v93,v97,v96
v_fma_f32 v94,v94,v97,v96
v_fma_f32 v95,v95,v97,v96
v_fma_f32 v80,v80,v32,v48
v_fma_f32 v81,v81,v33,v49
v_fma_f32 v82,v82,v34,v50
v_fma_f32 v83,v83,v35,v51
v_fma_f32 v84,v84,v36,v52
v_fma_f32 v85,v85,v37,v53
v_fma_f32 v86,v86,v38,v54
v_fma_f32 v87,v87,v39,v55
v_fma_f32 v88,v88,v40,v56
v_fma_f32 v89,v89,v41,v57
v_fma_f32 v90,v90,v42,v58
v_fma_f32 v91,v91,v43,v59
v_fma_f32 v92,v92,v44,v60
v_fma_f32 v93,v93,v45,v61
v_fma_f32 v94,v94,v46,v62
v_fma_f32 v95,v95,v47,v63
v_cvt_pk_bf16_f32 v112,v80,v81
v_cvt_pk_bf16_f32 v113,v82,v83
v_cvt_pk_bf16_f32 v114,v84,v85
v_cvt_pk_bf16_f32 v115,v86,v87
v_cvt_pk_bf16_f32 v116,v88,v89
v_cvt_pk_bf16_f32 v117,v90,v91
v_cvt_pk_bf16_f32 v118,v92,v93
v_cvt_pk_bf16_f32 v119,v94,v95
s_add_u32 s64,s66,4096
buffer_store_dwordx4 v[112:115],v10,s[20:23],s66 offen sc1
buffer_store_dwordx4 v[116:119],v10,s[20:23],s64 offen sc1
s_add_u32 s66,s66,32768
s_add_u32 s60,s60,1
top1_355:
s_waitcnt vmcnt(2)
v_max3_u32 v14,v72,v73,v74
v_max3_u32 v13,v75,v76,v77
v_max3_u32 v14,v14,v78,v79
v_max_u32 v14,v14,v13
v_cmp_eq_u32 vcc,-1,v14
s_cbranch_vccnz rt_359
go_360:
s_add_u32 s63,s63,32768
s_add_u32 s64,s63,4096
buffer_load_dwordx4 v[64:67],v10,s[20:23],s63 offen sc1
buffer_load_dwordx4 v[68:71],v10,s[20:23],s64 offen sc1
v_lshlrev_b32 v80,16,v72
v_and_b32 v81,s73,v72
v_lshlrev_b32 v82,16,v73
v_and_b32 v83,s73,v73
v_lshlrev_b32 v84,16,v74
v_and_b32 v85,s73,v74
v_lshlrev_b32 v86,16,v75
v_and_b32 v87,s73,v75
v_lshlrev_b32 v88,16,v76
v_and_b32 v89,s73,v76
v_lshlrev_b32 v90,16,v77
v_and_b32 v91,s73,v77
v_lshlrev_b32 v92,16,v78
v_and_b32 v93,s73,v78
v_lshlrev_b32 v94,16,v79
v_and_b32 v95,s73,v79
v_add_f32 v96,v80,v81
v_mul_f32 v97,v80,v80
v_add_f32 v98,v82,v83
v_mul_f32 v99,v81,v81
v_fmac_f32 v97,v82,v82
v_fmac_f32 v99,v83,v83
v_add_f32 v96,v96,v84
v_fmac_f32 v97,v84,v84
v_add_f32 v98,v98,v85
v_fmac_f32 v99,v85,v85
v_add_f32 v96,v96,v86
v_fmac_f32 v97,v86,v86
v_add_f32 v98,v98,v87
v_fmac_f32 v99,v87,v87
v_add_f32 v96,v96,v88
v_fmac_f32 v97,v88,v88
v_add_f32 v98,v98,v89
v_fmac_f32 v99,v89,v89
v_add_f32 v96,v96,v90
v_fmac_f32 v97,v90,v90
v_add_f32 v98,v98,v91
v_fmac_f32 v99,v91,v91
v_add_f32 v96,v96,v92
v_fmac_f32 v97,v92,v92
v_add_f32 v98,v98,v93
v_fmac_f32 v99,v93,v93
v_add_f32 v96,v96,v94
v_fmac_f32 v97,v94,v94
v_add_f32 v98,v98,v95
v_fmac_f32 v99,v95,v95
v_add_f32 v96,v96,v98
v_add_f32 v97,v97,v99
s_nop 0
v_add_f32_dpp v96,v96,v96 row_ror:4 row_mask:0xf bank_mask:0xf
v_add_f32_dpp v97,v97,v97 row_ror:4 row_mask:0xf bank_mask:0xf
s_nop 0
v_add_f32_dpp v96,v96,v96 row_ror:8 row_mask:0xf bank_mask:0xf
v_add_f32_dpp v97,v97,v97 row_ror:8 row_mask:0xf bank_mask:0xf
v_mov_b32 v98,v96
v_mov_b32 v99,v97
s_nop 0
v_permlane16_swap_b32 v98,v96
v_permlane16_swap_b32 v99,v97
v_add_f32 v96,v96,v98
v_add_f32 v97,v97,v99
v_mov_b32 v98,v96
v_mov_b32 v99,v97
s_nop 0
v_permlane32_swap_b32 v98,v96
v_permlane32_swap_b32 v99,v97
v_add_f32 v96,v96,v98
v_add_f32 v97,v97,v99
ds_write_b64 v11,v[96:97] offset:2048
s_waitcnt lgkmcnt(0)
s_barrier
s_waitcnt vmcnt(2)
v_mov_b32 v15,s60
buffer_store_dword v15,v16,s[20:23],s69 offen
ds_read_b64 v[100:101],v12 offset:2048
ds_read_b64 v[102:103],v12 offset:2560
ds_read_b64 v[104:105],v12 offset:3072
ds_read_b64 v[106:107],v12 offset:3584
s_waitcnt lgkmcnt(0)
v_add_f32 v100,v100,v102
v_add_f32 v101,v101,v103
v_add_f32 v104,v104,v106
v_add_f32 v105,v105,v107
v_add_f32 v100,v100,v104
v_add_f32 v101,v101,v105
v_mul_f32 v96,0xba800000,v100
v_mul_f32 v102,v96,v96
v_mul_f32 v101,0x3a800000,v101
v_sub_f32 v101,v101,v102
v_max_f32 v101,0,v101
v_add_f32 v101,0x3727c5ac,v101
v_rsq_f32 v97,v101
s_nop 0
v_mul_f32 v96,v96,v97
v_fma_f32 v80,v80,v97,v96
v_fma_f32 v81,v81,v97,v96
v_fma_f32 v82,v82,v97,v96
v_fma_f32 v83,v83,v97,v96
v_fma_f32 v84,v84,v97,v96
v_fma_f32 v85,v85,v97,v96
v_fma_f32 v86,v86,v97,v96
v_fma_f32 v87,v87,v97,v96
v_fma_f32 v88,v88,v97,v96
v_fma_f32 v89,v89,v97,v96
v_fma_f32 v90,v90,v97,v96
v_fma_f32 v91,v91,v97,v96
v_fma_f32 v92,v92,v97,v96
v_fma_f32 v93,v93,v97,v96
v_fma_f32 v94,v94,v97,v96
v_fma_f32 v95,v95,v97,v96
v_fma_f32 v80,v80,v32,v48
v_fma_f32 v81,v81,v33,v49
v_fma_f32 v82,v82,v34,v50
v_fma_f32 v83,v83,v35,v51
v_fma_f32 v84,v84,v36,v52
v_fma_f32 v85,v85,v37,v53
v_fma_f32 v86,v86,v38,v54
v_fma_f32 v87,v87,v39,v55
v_fma_f32 v88,v88,v40,v56
v_fma_f32 v89,v89,v41,v57
v_fma_f32 v90,v90,v42,v58
v_fma_f32 v91,v91,v43,v59
v_fma_f32 v92,v92,v44,v60
v_fma_f32 v93,v93,v45,v61
v_fma_f32 v94,v94,v46,v62
v_fma_f32 v95,v95,v47,v63
v_cvt_pk_bf16_f32 v112,v80,v81
v_cvt_pk_bf16_f32 v113,v82,v83
v_cvt_pk_bf16_f32 v114,v84,v85
v_cvt_pk_bf16_f32 v115,v86,v87
v_cvt_pk_bf16_f32 v116,v88,v89
v_cvt_pk_bf16_f32 v117,v90,v91
v_cvt_pk_bf16_f32 v118,v92,v93
v_cvt_pk_bf16_f32 v119,v94,v95
s_add_u32 s64,s66,4096
buffer_store_dwordx4 v[112:115],v10,s[20:23],s66 offen sc1
buffer_store_dwordx4 v[116:119],v10,s[20:23],s64 offen sc1
s_add_u32 s66,s66,32768
s_add_u32 s60,s60,1
s_cmp_lt_u32 s60,128
s_cbranch_scc1 top0_354
s_waitcnt vmcnt(0)
v_mov_b32 v15,s60
buffer_store_dword v15,v16,s[20:23],s69 offen
s_branch done_346
rt_356:
s_add_u32 s64,s63,4096
buffer_load_dwordx4 v[64:67],v10,s[20:23],s63 offen sc1
buffer_load_dwordx4 v[68:71],v10,s[20:23],s64 offen sc1
s_waitcnt vmcnt(2)
v_mov_b32 v15,s60
buffer_store_dword v15,v16,s[20:23],s69 offen
s_waitcnt vmcnt(1)
v_max3_u32 v14,v64,v65,v66
v_max3_u32 v13,v67,v68,v69
v_max3_u32 v14,v14,v70,v71
v_max_u32 v14,v14,v13
v_cmp_eq_u32 vcc,-1,v14
s_cbranch_vccz go_357
lp_358:
s_sleep 1
s_add_u32 s64,s63,4096
buffer_load_dwordx4 v[64:67],v10,s[20:23],s63 offen sc1
buffer_load_dwordx4 v[68:71],v10,s[20:23],s64 offen sc1
s_waitcnt vmcnt(0)
v_max3_u32 v14,v64,v65,v66
v_max3_u32 v13,v67,v68,v69
v_max3_u32 v14,v14,v70,v71
v_max_u32 v14,v14,v13
v_cmp_eq_u32 vcc,-1,v14
s_cbranch_vccz go_357
s_sub_u32 s90,s90,1
s_cmp_gt_i32 s90,0
s_cbranch_scc1 lp_358
s_branch go_357
rt_359:
s_add_u32 s64,s63,4096
buffer_load_dwordx4 v[72:75],v10,s[20:23],s63 offen sc1
buffer_load_dwordx4 v[76:79],v10,s[20:23],s64 offen sc1
s_waitcnt vmcnt(2)
v_mov_b32 v15,s60
buffer_store_dword v15,v16,s[20:23],s69 offen
s_waitcnt vmcnt(1)
v_max3_u32 v14,v72,v73,v74
v_max3_u32 v13,v75,v76,v77
v_max3_u32 v14,v14,v78,v79
v_max_u32 v14,v14,v13
v_cmp_eq_u32 vcc,-1,v14
s_cbranch_vccz go_360
lp_361:
s_sleep 1
s_add_u32 s64,s63,4096
buffer_load_dwordx4 v[72:75],v10,s[20:23],s63 offen sc1
buffer_load_dwordx4 v[76:79],v10,s[20:23],s64 offen sc1
s_waitcnt vmcnt(0)
v_max3_u32 v14,v72,v73,v74
v_max3_u32 v13,v75,v76,v77
v_max3_u32 v14,v14,v78,v79
v_max_u32 v14,v14,v13
v_cmp_eq_u32 vcc,-1,v14
s_cbranch_vccz go_360
s_sub_u32 s90,s90,1
s_cmp_gt_i32 s90,0
s_cbranch_scc1 lp_361
s_branch go_360
lfar_353:
s_add_u32 s64,s63,4096
buffer_load_dwordx4 v[64:67],v10,s[20:23],s63 offen sc1
buffer_load_dwordx4 v[68:71],v10,s[20:23],s64 offen sc1
buffer_load_dword v15,off,s[20:23],s68
buffer_load_dword v15,off,s[20:23],s68
top0_362:
s_waitcnt vmcnt(2)
v_max3_u32 v14,v64,v65,v66
v_max3_u32 v13,v67,v68,v69
v_max3_u32 v14,v14,v70,v71
v_max_u32 v14,v14,v13
v_cmp_eq_u32 vcc,-1,v14
s_cbranch_vccnz rt_364
go_365:
s_add_u32 s63,s63,32768
s_add_u32 s64,s63,4096
buffer_load_dwordx4 v[72:75],v10,s[20:23],s63 offen sc1
buffer_load_dwordx4 v[76:79],v10,s[20:23],s64 offen sc1
v_lshlrev_b32 v80,16,v64
v_and_b32 v81,s73,v64
v_lshlrev_b32 v82,16,v65
v_and_b32 v83,s73,v65
v_lshlrev_b32 v84,16,v66
v_and_b32 v85,s73,v66
v_lshlrev_b32 v86,16,v67
v_and_b32 v87,s73,v67
v_lshlrev_b32 v88,16,v68
v_and_b32 v89,s73,v68
v_lshlrev_b32 v90,16,v69
v_and_b32 v91,s73,v69
v_lshlrev_b32 v92,16,v70
v_and_b32 v93,s73,v70
v_lshlrev_b32 v94,16,v71
v_and_b32 v95,s73,v71
v_add_f32 v96,v80,v81
v_mul_f32 v97,v80,v80
v_add_f32 v98,v82,v83
v_mul_f32 v99,v81,v81
v_fmac_f32 v97,v82,v82
v_fmac_f32 v99,v83,v83
v_add_f32 v96,v96,v84
v_fmac_f32 v97,v84,v84
v_add_f32 v98,v98,v85
v_fmac_f32 v99,v85,v85
v_add_f32 v96,v96,v86
v_fmac_f32 v97,v86,v86
v_add_f32 v98,v98,v87
v_fmac_f32 v99,v87,v87
v_add_f32 v96,v96,v88
v_fmac_f32 v97,v88,v88
v_add_f32 v98,v98,v89
v_fmac_f32 v99,v89,v89
v_add_f32 v96,v96,v90
v_fmac_f32 v97,v90,v90
v_add_f32 v98,v98,v91
v_fmac_f32 v99,v91,v91
v_add_f32 v96,v96,v92
v_fmac_f32 v97,v92,v92
v_add_f32 v98,v98,v93
v_fmac_f32 v99,v93,v93
v_add_f32 v96,v96,v94
v_fmac_f32 v97,v94,v94
v_add_f32 v98,v98,v95
v_fmac_f32 v99,v95,v95
v_add_f32 v96,v96,v98
v_add_f32 v97,v97,v99
s_nop 0
v_add_f32_dpp v96,v96,v96 row_ror:4 row_mask:0xf bank_mask:0xf
v_add_f32_dpp v97,v97,v97 row_ror:4 row_mask:0xf bank_mask:0xf
s_nop 0
v_add_f32_dpp v96,v96,v96 row_ror:8 row_mask:0xf bank_mask:0xf
v_add_f32_dpp v97,v97,v97 row_ror:8 row_mask:0xf bank_mask:0xf
v_mov_b32 v98,v96
v_mov_b32 v99,v97
s_nop 0
v_permlane16_swap_b32 v98,v96
v_permlane16_swap_b32 v99,v97
v_add_f32 v96,v96,v98
v_add_f32 v97,v97,v99
v_mov_b32 v98,v96
v_mov_b32 v99,v97
s_nop 0
v_permlane32_swap_b32 v98,v96
v_permlane32_swap_b32 v99,v97
v_add_f32 v96,v96,v98
v_add_f32 v97,v97,v99
ds_write_b64 v11,v[96:97] offset:0
s_waitcnt lgkmcnt(0)
s_barrier
s_waitcnt vmcnt(2)
v_mov_b32 v15,s60
buffer_store_dword v15,v16,s[20:23],s69 offen sc1
ds_read_b64 v[100:101],v12 offset:0
ds_read_b64 v[102:103],v12 offset:512
ds_read_b64 v[104:105],v12 offset:1024
ds_read_b64 v[106:107],v12 offset:1536
s_waitcnt lgkmcnt(0)
v_add_f32 v100,v100,v102
v_add_f32 v101,v101,v103
v_add_f32 v104,v104,v106
v_add_f32 v105,v105,v107
v_add_f32 v100,v100,v104
v_add_f32 v101,v101,v105
v_mul_f32 v96,0xba800000,v100
v_mul_f32 v102,v96,v96
v_mul_f32 v101,0x3a800000,v101
v_sub_f32 v101,v101,v102
v_max_f32 v101,0,v101
v_add_f32 v101,0x3727c5ac,v101
v_rsq_f32 v97,v101
s_nop 0
v_mul_f32 v96,v96,v97
v_fma_f32 v80,v80,v97,v96
v_fma_f32 v81,v81,v97,v96
v_fma_f32 v82,v82,v97,v96
v_fma_f32 v83,v83,v97,v96
v_fma_f32 v84,v84,v97,v96
v_fma_f32 v85,v85,v97,v96
v_fma_f32 v86,v86,v97,v96
v_fma_f32 v87,v87,v97,v96
v_fma_f32 v88,v88,v97,v96
v_fma_f32 v89,v89,v97,v96
v_fma_f32 v90,v90,v97,v96
v_fma_f32 v91,v91,v97,v96
v_fma_f32 v92,v92,v97,v96
v_fma_f32 v93,v93,v97,v96
v_fma_f32 v94,v94,v97,v96
v_fma_f32 v95,v95,v97,v96
v_fma_f32 v80,v80,v32,v48
v_fma_f32 v81,v81,v33,v49
v_fma_f32 v82,v82,v34,v50
v_fma_f32 v83,v83,v35,v51
v_fma_f32 v84,v84,v36,v52
v_fma_f32 v85,v85,v37,v53
v_fma_f32 v86,v86,v38,v54
v_fma_f32 v87,v87,v39,v55
v_fma_f32 v88,v88,v40,v56
v_fma_f32 v89,v89,v41,v57
v_fma_f32 v90,v90,v42,v58
v_fma_f32 v91,v91,v43,v59
v_fma_f32 v92,v92,v44,v60
v_fma_f32 v93,v93,v45,v61
v_fma_f32 v94,v94,v46,v62
v_fma_f32 v95,v95,v47,v63
v_cvt_pk_bf16_f32 v112,v80,v81
v_cvt_pk_bf16_f32 v113,v82,v83
v_cvt_pk_bf16_f32 v114,v84,v85
v_cvt_pk_bf16_f32 v115,v86,v87
v_cvt_pk_bf16_f32 v116,v88,v89
v_cvt_pk_bf16_f32 v117,v90,v91
v_cvt_pk_bf16_f32 v118,v92,v93
v_cvt_pk_bf16_f32 v119,v94,v95
s_add_u32 s64,s66,4096
buffer_store_dwordx4 v[112:115],v10,s[20:23],s66 offen sc1
buffer_store_dwordx4 v[116:119],v10,s[20:23],s64 offen sc1
s_add_u32 s66,s66,32768
s_add_u32 s60,s60,1
top1_363:
s_waitcnt vmcnt(2)
v_max3_u32 v14,v72,v73,v74
v_max3_u32 v13,v75,v76,v77
v_max3_u32 v14,v14,v78,v79
v_max_u32 v14,v14,v13
v_cmp_eq_u32 vcc,-1,v14
s_cbranch_vccnz rt_367
go_368:
s_add_u32 s63,s63,32768
s_add_u32 s64,s63,4096
buffer_load_dwordx4 v[64:67],v10,s[20:23],s63 offen sc1
buffer_load_dwordx4 v[68:71],v10,s[20:23],s64 offen sc1
v_lshlrev_b32 v80,16,v72
v_and_b32 v81,s73,v72
v_lshlrev_b32 v82,16,v73
v_and_b32 v83,s73,v73
v_lshlrev_b32 v84,16,v74
v_and_b32 v85,s73,v74
v_lshlrev_b32 v86,16,v75
v_and_b32 v87,s73,v75
v_lshlrev_b32 v88,16,v76
v_and_b32 v89,s73,v76
v_lshlrev_b32 v90,16,v77
v_and_b32 v91,s73,v77
v_lshlrev_b32 v92,16,v78
v_and_b32 v93,s73,v78
v_lshlrev_b32 v94,16,v79
v_and_b32 v95,s73,v79
v_add_f32 v96,v80,v81
v_mul_f32 v97,v80,v80
v_add_f32 v98,v82,v83
v_mul_f32 v99,v81,v81
v_fmac_f32 v97,v82,v82
v_fmac_f32 v99,v83,v83
v_add_f32 v96,v96,v84
v_fmac_f32 v97,v84,v84
v_add_f32 v98,v98,v85
v_fmac_f32 v99,v85,v85
v_add_f32 v96,v96,v86
v_fmac_f32 v97,v86,v86
v_add_f32 v98,v98,v87
v_fmac_f32 v99,v87,v87
v_add_f32 v96,v96,v88
v_fmac_f32 v97,v88,v88
v_add_f32 v98,v98,v89
v_fmac_f32 v99,v89,v89
v_add_f32 v96,v96,v90
v_fmac_f32 v97,v90,v90
v_add_f32 v98,v98,v91
v_fmac_f32 v99,v91,v91
v_add_f32 v96,v96,v92
v_fmac_f32 v97,v92,v92
v_add_f32 v98,v98,v93
v_fmac_f32 v99,v93,v93
v_add_f32 v96,v96,v94
v_fmac_f32 v97,v94,v94
v_add_f32 v98,v98,v95
v_fmac_f32 v99,v95,v95
v_add_f32 v96,v96,v98
v_add_f32 v97,v97,v99
s_nop 0
v_add_f32_dpp v96,v96,v96 row_ror:4 row_mask:0xf bank_mask:0xf
v_add_f32_dpp v97,v97,v97 row_ror:4 row_mask:0xf bank_mask:0xf
s_nop 0
v_add_f32_dpp v96,v96,v96 row_ror:8 row_mask:0xf bank_mask:0xf
v_add_f32_dpp v97,v97,v97 row_ror:8 row_mask:0xf bank_mask:0xf
v_mov_b32 v98,v96
v_mov_b32 v99,v97
s_nop 0
v_permlane16_swap_b32 v98,v96
v_permlane16_swap_b32 v99,v97
v_add_f32 v96,v96,v98
v_add_f32 v97,v97,v99
v_mov_b32 v98,v96
v_mov_b32 v99,v97
s_nop 0
v_permlane32_swap_b32 v98,v96
v_permlane32_swap_b32 v99,v97
v_add_f32 v96,v96,v98
v_add_f32 v97,v97,v99
ds_write_b64 v11,v[96:97] offset:2048
s_waitcnt lgkmcnt(0)
s_barrier
s_waitcnt vmcnt(2)
v_mov_b32 v15,s60
buffer_store_dword v15,v16,s[20:23],s69 offen sc1
ds_read_b64 v[100:101],v12 offset:2048
ds_read_b64 v[102:103],v12 offset:2560
ds_read_b64 v[104:105],v12 offset:3072
ds_read_b64 v[106:107],v12 offset:3584
s_waitcnt lgkmcnt(0)
v_add_f32 v100,v100,v102
v_add_f32 v101,v101,v103
v_add_f32 v104,v104,v106
v_add_f32 v105,v105,v107
v_add_f32 v100,v100,v104
v_add_f32 v101,v101,v105
v_mul_f32 v96,0xba800000,v100
v_mul_f32 v102,v96,v96
v_mul_f32 v101,0x3a800000,v101
v_sub_f32 v101,v101,v102
v_max_f32 v101,0,v101
v_add_f32 v101,0x3727c5ac,v101
v_rsq_f32 v97,v101
s_nop 0
v_mul_f32 v96,v96,v97
v_fma_f32 v80,v80,v97,v96
v_fma_f32 v81,v81,v97,v96
v_fma_f32 v82,v82,v97,v96
v_fma_f32 v83,v83,v97,v96
v_fma_f32 v84,v84,v97,v96
v_fma_f32 v85,v85,v97,v96
v_fma_f32 v86,v86,v97,v96
v_fma_f32 v87,v87,v97,v96
v_fma_f32 v88,v88,v97,v96
v_fma_f32 v89,v89,v97,v96
v_fma_f32 v90,v90,v97,v96
v_fma_f32 v91,v91,v97,v96
v_fma_f32 v92,v92,v97,v96
v_fma_f32 v93,v93,v97,v96
v_fma_f32 v94,v94,v97,v96
v_fma_f32 v95,v95,v97,v96
v_fma_f32 v80,v80,v32,v48
v_fma_f32 v81,v81,v33,v49
v_fma_f32 v82,v82,v34,v50
v_fma_f32 v83,v83,v35,v51
v_fma_f32 v84,v84,v36,v52
v_fma_f32 v85,v85,v37,v53
v_fma_f32 v86,v86,v38,v54
v_fma_f32 v87,v87,v39,v55
v_fma_f32 v88,v88,v40,v56
v_fma_f32 v89,v89,v41,v57
v_fma_f32 v90,v90,v42,v58
v_fma_f32 v91,v91,v43,v59
v_fma_f32 v92,v92,v44,v60
v_fma_f32 v93,v93,v45,v61
v_fma_f32 v94,v94,v46,v62
v_fma_f32 v95,v95,v47,v63
v_cvt_pk_bf16_f32 v112,v80,v81
v_cvt_pk_bf16_f32 v113,v82,v83
v_cvt_pk_bf16_f32 v114,v84,v85
v_cvt_pk_bf16_f32 v115,v86,v87
v_cvt_pk_bf16_f32 v116,v88,v89
v_cvt_pk_bf16_f32 v117,v90,v91
v_cvt_pk_bf16_f32 v118,v92,v93
v_cvt_pk_bf16_f32 v119,v94,v95
s_add_u32 s64,s66,4096
buffer_store_dwordx4 v[112:115],v10,s[20:23],s66 offen sc1
buffer_store_dwordx4 v[116:119],v10,s[20:23],s64 offen sc1
s_add_u32 s66,s66,32768
s_add_u32 s60,s60,1
s_cmp_lt_u32 s60,128
s_cbranch_scc1 top0_362
s_waitcnt vmcnt(0)
v_mov_b32 v15,s60
buffer_store_dword v15,v16,s[20:23],s69 offen sc1
s_branch done_346
rt_364:
s_add_u32 s64,s63,4096
buffer_load_dwordx4 v[64:67],v10,s[20:23],s63 offen sc1
buffer_load_dwordx4 v[68:71],v10,s[20:23],s64 offen sc1
s_waitcnt vmcnt(2)
v_mov_b32 v15,s60
buffer_store_dword v15,v16,s[20:23],s69 offen sc1
s_waitcnt vmcnt(1)
v_max3_u32 v14,v64,v65,v66
v_max3_u32 v13,v67,v68,v69
v_max3_u32 v14,v14,v70,v71
v_max_u32 v14,v14,v13
v_cmp_eq_u32 vcc,-1,v14
s_cbranch_vccz go_365
lp_366:
s_sleep 1
s_add_u32 s64,s63,4096
buffer_load_dwordx4 v[64:67],v10,s[20:23],s63 offen sc1
buffer_load_dwordx4 v[68:71],v10,s[20:23],s64 offen sc1
s_waitcnt vmcnt(0)
v_max3_u32 v14,v64,v65,v66
v_max3_u32 v13,v67,v68,v69
v_max3_u32 v14,v14,v70,v71
v_max_u32 v14,v14,v13
v_cmp_eq_u32 vcc,-1,v14
s_cbranch_vccz go_365
s_sub_u32 s90,s90,1
s_cmp_gt_i32 s90,0
s_cbranch_scc1 lp_366
s_branch go_365
rt_367:
s_add_u32 s64,s63,4096
buffer_load_dwordx4 v[72:75],v10,s[20:23],s63 offen sc1
buffer_load_dwordx4 v[76:79],v10,s[20:23],s64 offen sc1
s_waitcnt vmcnt(2)
v_mov_b32 v15,s60
buffer_store_dword v15,v16,s[20:23],s69 offen sc1
s_waitcnt vmcnt(1)
v_max3_u32 v14,v72,v73,v74
v_max3_u32 v13,v75,v76,v77
v_max3_u32 v14,v14,v78,v79
v_max_u32 v14,v14,v13
v_cmp_eq_u32 vcc,-1,v14
s_cbranch_vccz go_368
lp_369:
s_sleep 1
s_add_u32 s64,s63,4096
buffer_load_dwordx4 v[72:75],v10,s[20:23],s63 offen sc1
buffer_load_dwordx4 v[76:79],v10,s[20:23],s64 offen sc1
s_waitcnt vmcnt(0)
v_max3_u32 v14,v72,v73,v74
v_max3_u32 v13,v75,v76,v77
v_max3_u32 v14,v14,v78,v79
v_max_u32 v14,v14,v13
v_cmp_eq_u32 vcc,-1,v14
s_cbranch_vccz go_368
s_sub_u32 s90,s90,1
s_cmp_gt_i32 s90,0
s_cbranch_scc1 lp_369
s_branch go_368
done_346:
s_endpgm
fl_att:
s_mov_b32 s92,s2
s_and_b32 s93,s3,0xffff
s_mov_b32 s94,0x100
s_mov_b32 s95,0x20000
v_mbcnt_lo_u32_b32 v16,-1,0
v_mbcnt_hi_u32_b32 v16,-1,v16
v_mov_b32 v18,0
v_cmp_eq_u32 vcc,22,v16
s_nop 1
v_cndmask_b32 v18,v18,63,vcc
v_cmp_eq_u32 vcc,21,v16
s_nop 1
v_cndmask_b32 v18,v18,1,vcc
v_and_b32 v19,1,v16
v_cmp_eq_u32 vcc,1,v19
v_mov_b32 v19,8192
s_nop 0
v_cndmask_b32 v19,-1,v19,vcc
v_min_u32 v16,31,v16
v_lshlrev_b32 v16,2,v16
s_sub_u32 s66,s88,64
s_cmp_lg_u32 s50,0
s_cbranch_scc1 vot_374
vpoll_370:
buffer_load_dword v17,v16,s[92:95],s66 offen sc1
s_waitcnt vmcnt(0)
s_cmp_lg_u32 s56,2
s_cbranch_scc1 vck_371
v_cmp_eq_u32 vcc,v17,v19
s_and_b32 s64,vcc_lo,0xffff
s_cmp_eq_u32 s64,65535
s_cbranch_scc1 vck_371
s_mov_b32 s65,0
v_readlane_b32 s64,v17,1
s_lshr_b32 s64,s64,8
s_add_u32 s65,s65,s64
v_readlane_b32 s64,v17,3
s_lshr_b32 s64,s64,8
s_add_u32 s65,s65,s64
v_readlane_b32 s64,v17,5
s_lshr_b32 s64,s64,8
s_add_u32 s65,s65,s64
v_readlane_b32 s64,v17,7
s_lshr_b32 s64,s64,8
s_add_u32 s65,s65,s64
v_readlane_b32 s64,v17,9
s_lshr_b32 s64,s64,8
s_add_u32 s65,s65,s64
v_readlane_b32 s64,v17,11
s_lshr_b32 s64,s64,8
s_add_u32 s65,s65,s64
v_readlane_b32 s64,v17,13
s_lshr_b32 s64,s64,8
s_add_u32 s65,s65,s64
v_readlane_b32 s64,v17,15
s_lshr_b32 s64,s64,8
s_add_u32 s65,s65,s64
s_cmp_ge_u32 s65,256
s_cbranch_scc1 vok_373
s_branch vrt_372
vck_371:
v_cmp_gt_u32 vcc,v18,v17
s_cbranch_vccz vok_373
vrt_372:
s_sleep 8
s_sub_u32 s90,s90,1
s_cmp_gt_i32 s90,0
s_cbranch_scc1 vpoll_370
vok_373:
v_add_u32 v18,161280,v16
ds_write_b32 v18,v17
s_waitcnt lgkmcnt(0)
vot_374:
s_barrier
v_add_u32 v18,161280,v16
ds_read_b32 v17,v18
s_waitcnt lgkmcnt(0)
s_cmp_lg_u32 s56,2
s_cbranch_scc1 vfin_375
v_cmp_eq_u32 vcc,v17,v19
s_and_b32 s64,vcc_lo,0xffff
s_cmp_eq_u32 s64,65535
s_cbranch_scc1 vfin_375
s_mov_b32 s65,0
v_readlane_b32 s64,v17,1
s_lshr_b32 s64,s64,8
s_add_u32 s65,s65,s64
v_readlane_b32 s64,v17,3
s_lshr_b32 s64,s64,8
s_add_u32 s65,s65,s64
v_readlane_b32 s64,v17,5
s_lshr_b32 s64,s64,8
s_add_u32 s65,s65,s64
v_readlane_b32 s64,v17,7
s_lshr_b32 s64,s64,8
s_add_u32 s65,s65,s64
v_readlane_b32 s64,v17,9
s_lshr_b32 s64,s64,8
s_add_u32 s65,s65,s64
v_readlane_b32 s64,v17,11
s_lshr_b32 s64,s64,8
s_add_u32 s65,s65,s64
v_readlane_b32 s64,v17,13
s_lshr_b32 s64,s64,8
s_add_u32 s65,s65,s64
v_readlane_b32 s64,v17,15
s_lshr_b32 s64,s64,8
s_add_u32 s65,s65,s64
s_cmp_ge_u32 s65,256
s_cbranch_scc1 fl_fb
vfin_375:
s_and_b32 s56,s56,1
s_mov_b32 s67,0
v_readlane_b32 s65,v17,21
s_and_b32 s65,s65,2
s_lshl_b32 s67,s65,12
v_lshlrev_b32 v0,4,v1
v_and_b32 v21,15,v1
v_lshrrev_b32 v22,4,v1
v_and_b32 v23,7,v21
v_lshlrev_b32 v23,4,v23
v_lshl_add_u32 v3,v22,8,v23
v_and_b32 v23,31,v1
v_lshlrev_b32 v4,4,v23
v_and_b32 v23,3,v1
v_bfe_u32 v24,v1,2,1
v_lshlrev_b32 v23,14,v23
v_lshl_add_u32 v2,v24,7,v23
v_mov_b32 v7,0xff800000
s_and_b32 s54,s50,1
s_lshl_b32 s64,s54,4
v_lshlrev_b32 v23,2,v22
v_sub_u32 v23,v21,v23
v_add_u32 v23,s64,v23
v_cmp_le_i32 s[28:29],0,v23
v_cmp_le_i32 s[30:31],1,v23
v_cmp_le_i32 s[32:33],2,v23
v_cmp_le_i32 s[34:35],3,v23
v_cmp_le_i32 s[36:37],16,v23
v_cmp_le_i32 s[38:39],17,v23
v_cmp_le_i32 s[40:41],18,v23
v_cmp_le_i32 s[42:43],19,v23
s_mov_b32 s44,-1
s_mov_b32 s45,0
s_mov_b32 s80,0x3e0293ee
s_lshl_b32 s52,s59,1
s_lshr_b32 s64,s50,1
s_add_u32 s52,s52,s64
s_lshl_b32 s53,s52,15
s_lshl_b32 s68,s52,8
s_add_u32 s68,s68,s67
s_add_u32 s68,s68,138428416
s_lshl_b32 s69,s59,8
s_lshl_b32 s64,s64,2
s_add_u32 s69,s69,s64
s_lshl_b32 s64,s54,3
s_add_u32 s69,s69,s64
s_add_u32 s69,s69,138543104
s_lshl_b32 s66,s52,12
s_lshl_b32 s64,s54,17
s_add_u32 s66,s66,s64
s_add_u32 s66,s66,150994944
s_lshl_b32 s55,s54,10
s_xor_b32 s55,s55,0x2000
s_mov_b32 s60,0
s_add_u32 s64,s69,16
v_mov_b32 v6,124
s_mov_b64 exec,1
buffer_store_dword v6,off,s[20:23],s64 sc1
s_mov_b64 exec,-1
s_add_u32 s64,s69,32
v_mov_b32 v6,126
s_mov_b64 exec,1
buffer_store_dword v6,off,s[20:23],s64 sc1
s_mov_b64 exec,-1
s_mov_b32 s71,1
plp_376:
buffer_load_dword v5,v2,s[20:23],s68 offen sc1
s_waitcnt vmcnt(0)
v_cmp_gt_u32 vcc,s71,v5
s_cbranch_vccz pok_377
s_sleep 4
s_sub_u32 s90,s90,1
s_cmp_gt_i32 s90,0
s_cbranch_scc1 plp_376
pok_377:
s_add_u32 s64,s60,0
s_lshl_b32 s65,s64,11
s_and_b32 s65,s65,0x2000
s_xor_b32 s65,s65,s67
s_lshl_b32 s64,s64,19
s_add_u32 s64,s64,s65
s_add_u32 s92,s64,s53
s_add_u32 s93,s92,16384
s_add_u32 s94,s92,4096
s_add_u32 s95,s93,4096
s_xor_b32 s96,s92,s55
s_xor_b32 s97,s93,s55
buffer_load_dwordx4 a[0:3],v0,s[20:23],s96 offen offset:0
buffer_load_dwordx4 a[16:19],v0,s[20:23],s92 offen offset:0
buffer_load_dwordx4 a[32:35],v0,s[20:23],s92 offen offset:1024
buffer_load_dwordx4 a[4:7],v0,s[20:23],s96 offen offset:2048
buffer_load_dwordx4 a[20:23],v0,s[20:23],s92 offen offset:2048
buffer_load_dwordx4 a[36:39],v0,s[20:23],s92 offen offset:3072
buffer_load_dwordx4 a[8:11],v0,s[20:23],s97 offen offset:0
buffer_load_dwordx4 a[24:27],v0,s[20:23],s93 offen offset:0
buffer_load_dwordx4 a[40:43],v0,s[20:23],s93 offen offset:1024
buffer_load_dwordx4 a[12:15],v0,s[20:23],s97 offen offset:2048
buffer_load_dwordx4 a[28:31],v0,s[20:23],s93 offen offset:2048
buffer_load_dwordx4 a[44:47],v0,s[20:23],s93 offen offset:3072
buffer_load_dwordx4 a[48:51],v0,s[20:23],s94 offen offset:0
buffer_load_dwordx4 a[52:55],v0,s[20:23],s94 offen offset:1024
buffer_load_dwordx4 a[56:59],v0,s[20:23],s94 offen offset:2048
buffer_load_dwordx4 a[60:63],v0,s[20:23],s94 offen offset:3072
buffer_load_dwordx4 a[64:67],v0,s[20:23],s95 offen offset:0
buffer_load_dwordx4 a[68:71],v0,s[20:23],s95 offen offset:1024
buffer_load_dwordx4 a[72:75],v0,s[20:23],s95 offen offset:2048
buffer_load_dwordx4 a[76:79],v0,s[20:23],s95 offen offset:3072
s_waitcnt vmcnt(8)
top0_378:
v_mfma_f32_16x16x32_bf16 v[48:51],a[16:19],a[0:3],0
v_mfma_f32_16x16x32_bf16 v[52:55],a[32:35],a[0:3],0
v_mfma_f32_16x16x32_bf16 v[48:51],a[20:23],a[4:7],v[48:51]
v_mfma_f32_16x16x32_bf16 v[52:55],a[36:39],a[4:7],v[52:55]
v_mfma_f32_16x16x32_bf16 v[48:51],a[24:27],a[8:11],v[48:51]
v_mfma_f32_16x16x32_bf16 v[52:55],a[40:43],a[8:11],v[52:55]
v_mfma_f32_16x16x32_bf16 v[48:51],a[28:31],a[12:15],v[48:51]
v_mfma_f32_16x16x32_bf16 v[52:55],a[44:47],a[12:15],v[52:55]
s_nop 6
v_cndmask_b32 v48,v7,v48,s[28:29]
v_cndmask_b32 v49,v7,v49,s[30:31]
v_cndmask_b32 v50,v7,v50,s[32:33]
v_cndmask_b32 v51,v7,v51,s[34:35]
v_cndmask_b32 v52,v7,v52,s[36:37]
v_cndmask_b32 v53,v7,v53,s[38:39]
v_cndmask_b32 v54,v7,v54,s[40:41]
v_cndmask_b32 v55,v7,v55,s[42:43]
v_max3_f32 v72,v48,v49,v50
v_max3_f32 v72,v72,v51,v52
v_max3_f32 v72,v72,v53,v54
v_max_f32 v72,v72,v55
s_add_u32 s64,s60,0
s_lshl_b32 s65,s64,11
s_and_b32 s65,s65,0x2000
s_xor_b32 s65,s65,s67
s_lshl_b32 s64,s64,19
s_add_u32 s64,s64,s65
s_add_u32 s98,s64,s53
s_add_u32 s98,s98,67108864
s_add_u32 s99,s98,16384
s_lshr_b32 s71,s60,1
s_add_u32 s71,s71,1
s_waitcnt vmcnt(1)
v_cmp_gt_u32 vcc,s71,v5
s_cbranch_vccz ek_380
plp_383:
buffer_load_dword v5,v2,s[20:23],s68 offen sc1
s_waitcnt vmcnt(0)
v_cmp_gt_u32 vcc,s71,v5
s_cbranch_vccz pok_384
s_sleep 4
s_sub_u32 s90,s90,1
s_cmp_gt_i32 s90,0
s_cbranch_scc1 plp_383
pok_384:
ek_380:
buffer_load_dwordx4 v[16:19],v3,s[20:23],s98 offen offset:0
buffer_load_dwordx4 v[20:23],v3,s[20:23],s98 offen offset:128
buffer_load_dwordx4 v[24:27],v3,s[20:23],s99 offen offset:0
buffer_load_dwordx4 v[28:31],v3,s[20:23],s99 offen offset:128
buffer_load_dwordx4 v[32:35],v4,s[20:23],s98 offen offset:1024
buffer_load_dwordx4 v[36:39],v4,s[20:23],s98 offen offset:1536
buffer_load_dwordx4 v[40:43],v4,s[20:23],s99 offen offset:1024
buffer_load_dwordx4 v[44:47],v4,s[20:23],s99 offen offset:1536
s_barrier
s_add_u32 s64,s60,2
s_lshl_b32 s65,s64,11
s_and_b32 s65,s65,0x2000
s_xor_b32 s65,s65,s67
s_lshl_b32 s64,s64,19
s_add_u32 s64,s64,s65
s_add_u32 s92,s64,s53
s_add_u32 s93,s92,16384
s_add_u32 s94,s92,4096
s_add_u32 s95,s93,4096
s_xor_b32 s96,s92,s55
s_xor_b32 s97,s93,s55
buffer_load_dwordx4 a[80:83],v0,s[20:23],s96 offen offset:0
buffer_load_dwordx4 a[96:99],v0,s[20:23],s92 offen offset:0
buffer_load_dwordx4 a[112:115],v0,s[20:23],s92 offen offset:1024
buffer_load_dwordx4 a[84:87],v0,s[20:23],s96 offen offset:2048
buffer_load_dwordx4 a[100:103],v0,s[20:23],s92 offen offset:2048
buffer_load_dwordx4 a[116:119],v0,s[20:23],s92 offen offset:3072
buffer_load_dwordx4 a[88:91],v0,s[20:23],s97 offen offset:0
buffer_load_dwordx4 a[104:107],v0,s[20:23],s93 offen offset:0
buffer_load_dwordx4 a[120:123],v0,s[20:23],s93 offen offset:1024
buffer_load_dwordx4 a[92:95],v0,s[20:23],s97 offen offset:2048
buffer_load_dwordx4 a[108:111],v0,s[20:23],s93 offen offset:2048
buffer_load_dwordx4 a[124:127],v0,s[20:23],s93 offen offset:3072
s_waitcnt vmcnt(16)
v_mfma_f32_16x16x32_bf16 v[56:59],v[16:19],a[0:3],0
v_mfma_f32_16x16x32_bf16 v[56:59],v[20:23],a[4:7],v[56:59]
v_mfma_f32_16x16x32_bf16 v[56:59],v[24:27],a[8:11],v[56:59]
v_mfma_f32_16x16x32_bf16 v[56:59],v[28:31],a[12:15],v[56:59]
s_nop 7
v_cndmask_b32 v56,v7,v56,s[44:45]
v_cndmask_b32 v57,v7,v57,s[44:45]
v_cndmask_b32 v58,v7,v58,s[44:45]
v_cndmask_b32 v59,v7,v59,s[44:45]
v_max3_f32 v72,v72,v56,v57
v_max3_f32 v72,v72,v58,v59
v_mov_b32 v73,v72
s_nop 1
v_permlane16_swap_b32 v73,v72
v_max_f32 v72,v72,v73
v_mov_b32 v73,v72
s_nop 1
v_permlane32_swap_b32 v73,v72
v_max_f32 v72,v72,v73
v_mul_f32 v72,s80,v72
v_fma_f32 v48,v48,s80,-v72
v_fma_f32 v49,v49,s80,-v72
v_fma_f32 v50,v50,s80,-v72
v_fma_f32 v51,v51,s80,-v72
v_fma_f32 v52,v52,s80,-v72
v_fma_f32 v53,v53,s80,-v72
v_fma_f32 v54,v54,s80,-v72
v_fma_f32 v55,v55,s80,-v72
v_fma_f32 v56,v56,s80,-v72
v_fma_f32 v57,v57,s80,-v72
v_fma_f32 v58,v58,s80,-v72
v_fma_f32 v59,v59,s80,-v72
v_exp_f32 v48,v48
v_exp_f32 v49,v49
v_exp_f32 v50,v50
v_exp_f32 v51,v51
v_exp_f32 v52,v52
v_exp_f32 v53,v53
v_exp_f32 v54,v54
v_exp_f32 v55,v55
v_exp_f32 v56,v56
v_exp_f32 v57,v57
v_exp_f32 v58,v58
v_exp_f32 v59,v59
v_add_f32 v74,v48,v49
v_add_f32 v75,v50,v51
v_add_f32 v74,v74,v52
v_add_f32 v75,v75,v53
v_add_f32 v74,v74,v54
v_add_f32 v75,v75,v55
v_add_f32 v74,v74,v56
v_add_f32 v75,v75,v57
v_add_f32 v74,v74,v58
v_add_f32 v75,v75,v59
v_add_f32 v74,v74,v75
v_mov_b32 v73,v74
s_nop 1
v_permlane16_swap_b32 v73,v74
v_add_f32 v74,v74,v73
v_mov_b32 v73,v74
s_nop 1
v_permlane32_swap_b32 v73,v74
v_add_f32 v74,v74,v73
v_rcp_f32 v75,v74
s_nop 0
v_mul_f32 v48,v48,v75
v_mul_f32 v49,v49,v75
v_mul_f32 v50,v50,v75
v_mul_f32 v51,v51,v75
v_mul_f32 v52,v52,v75
v_mul_f32 v53,v53,v75
v_mul_f32 v54,v54,v75
v_mul_f32 v55,v55,v75
v_mul_f32 v56,v56,v75
v_mul_f32 v57,v57,v75
v_mul_f32 v58,v58,v75
v_mul_f32 v59,v59,v75
v_cvt_pk_bf16_f32 v64,v48,v49
v_cvt_pk_bf16_f32 v65,v50,v51
v_cvt_pk_bf16_f32 v66,v52,v53
v_cvt_pk_bf16_f32 v67,v54,v55
v_cvt_pk_bf16_f32 v68,v56,v57
v_cvt_pk_bf16_f32 v69,v58,v59
v_mfma_f32_16x16x32_bf16 v[80:83],a[48:51],v[64:67],0
v_mfma_f32_16x16x32_bf16 v[84:87],a[52:55],v[64:67],0
v_mfma_f32_16x16x32_bf16 v[88:91],a[56:59],v[64:67],0
v_mfma_f32_16x16x32_bf16 v[92:95],a[60:63],v[64:67],0
v_mfma_f32_16x16x32_bf16 v[96:99],a[64:67],v[64:67],0
v_mfma_f32_16x16x32_bf16 v[100:103],a[68:71],v[64:67],0
v_mfma_f32_16x16x32_bf16 v[104:107],a[72:75],v[64:67],0
v_mfma_f32_16x16x32_bf16 v[108:111],a[76:79],v[64:67],0
s_waitcnt vmcnt(12)
v_mfma_f32_16x16x16_bf16 v[80:83],v[32:33],v[68:69],v[80:83]
v_mfma_f32_16x16x16_bf16 v[84:87],v[34:35],v[68:69],v[84:87]
v_mfma_f32_16x16x16_bf16 v[88:91],v[36:37],v[68:69],v[88:91]
v_mfma_f32_16x16x16_bf16 v[92:95],v[38:39],v[68:69],v[92:95]
v_mfma_f32_16x16x16_bf16 v[96:99],v[40:41],v[68:69],v[96:99]
v_mfma_f32_16x16x16_bf16 v[100:103],v[42:43],v[68:69],v[100:103]
v_mfma_f32_16x16x16_bf16 v[104:107],v[44:45],v[68:69],v[104:107]
v_mfma_f32_16x16x16_bf16 v[108:111],v[46:47],v[68:69],v[108:111]
s_nop 0
v_cvt_pk_bf16_f32 v112,v80,v81
v_cvt_pk_bf16_f32 v113,v82,v83
v_cvt_pk_bf16_f32 v114,v84,v85
v_cvt_pk_bf16_f32 v115,v86,v87
buffer_store_dwordx4 v[112:115],v0,s[20:23],s66 offen offset:0 sc1
v_cvt_pk_bf16_f32 v116,v88,v89
v_cvt_pk_bf16_f32 v117,v90,v91
v_cvt_pk_bf16_f32 v118,v92,v93
v_cvt_pk_bf16_f32 v119,v94,v95
buffer_store_dwordx4 v[116:119],v0,s[20:23],s66 offen offset:1024 sc1
v_cvt_pk_bf16_f32 v112,v96,v97
v_cvt_pk_bf16_f32 v113,v98,v99
v_cvt_pk_bf16_f32 v114,v100,v101
v_cvt_pk_bf16_f32 v115,v102,v103
buffer_store_dwordx4 v[112:115],v0,s[20:23],s66 offen offset:2048 sc1
v_cvt_pk_bf16_f32 v116,v104,v105
v_cvt_pk_bf16_f32 v117,v106,v107
v_cvt_pk_bf16_f32 v118,v108,v109
v_cvt_pk_bf16_f32 v119,v110,v111
buffer_store_dwordx4 v[116:119],v0,s[20:23],s66 offen offset:3072 sc1
s_barrier
buffer_load_dwordx4 a[128:131],v0,s[20:23],s94 offen offset:0
buffer_load_dwordx4 a[132:135],v0,s[20:23],s94 offen offset:1024
buffer_load_dwordx4 a[136:139],v0,s[20:23],s94 offen offset:2048
buffer_load_dwordx4 a[140:143],v0,s[20:23],s94 offen offset:3072
buffer_load_dwordx4 a[144:147],v0,s[20:23],s95 offen offset:0
buffer_load_dwordx4 a[148:151],v0,s[20:23],s95 offen offset:1024
buffer_load_dwordx4 a[152:155],v0,s[20:23],s95 offen offset:2048
buffer_load_dwordx4 a[156:159],v0,s[20:23],s95 offen offset:3072
buffer_load_dword v5,v2,s[20:23],s68 offen sc1
s_add_u32 s66,s66,262144
s_add_u32 s60,s60,2
s_add_u32 s72,s60,s54
s_waitcnt vmcnt(9)
v_mov_b32 v6,s72
s_mov_b64 exec,1
buffer_store_dword v6,off,s[20:23],s69 sc1
s_mov_b64 exec,-1
top1_379:
v_mfma_f32_16x16x32_bf16 v[48:51],a[96:99],a[80:83],0
v_mfma_f32_16x16x32_bf16 v[52:55],a[112:115],a[80:83],0
v_mfma_f32_16x16x32_bf16 v[48:51],a[100:103],a[84:87],v[48:51]
v_mfma_f32_16x16x32_bf16 v[52:55],a[116:119],a[84:87],v[52:55]
v_mfma_f32_16x16x32_bf16 v[48:51],a[104:107],a[88:91],v[48:51]
v_mfma_f32_16x16x32_bf16 v[52:55],a[120:123],a[88:91],v[52:55]
v_mfma_f32_16x16x32_bf16 v[48:51],a[108:111],a[92:95],v[48:51]
v_mfma_f32_16x16x32_bf16 v[52:55],a[124:127],a[92:95],v[52:55]
s_nop 6
v_cndmask_b32 v48,v7,v48,s[28:29]
v_cndmask_b32 v49,v7,v49,s[30:31]
v_cndmask_b32 v50,v7,v50,s[32:33]
v_cndmask_b32 v51,v7,v51,s[34:35]
v_cndmask_b32 v52,v7,v52,s[36:37]
v_cndmask_b32 v53,v7,v53,s[38:39]
v_cndmask_b32 v54,v7,v54,s[40:41]
v_cndmask_b32 v55,v7,v55,s[42:43]
v_max3_f32 v72,v48,v49,v50
v_max3_f32 v72,v72,v51,v52
v_max3_f32 v72,v72,v53,v54
v_max_f32 v72,v72,v55
s_add_u32 s64,s60,0
s_lshl_b32 s65,s64,11
s_and_b32 s65,s65,0x2000
s_xor_b32 s65,s65,s67
s_lshl_b32 s64,s64,19
s_add_u32 s64,s64,s65
s_add_u32 s98,s64,s53
s_add_u32 s98,s98,67108864
s_add_u32 s99,s98,16384
s_lshr_b32 s71,s60,1
s_add_u32 s71,s71,1
s_waitcnt vmcnt(1)
v_cmp_gt_u32 vcc,s71,v5
s_cbranch_vccz ek_385
plp_388:
buffer_load_dword v5,v2,s[20:23],s68 offen sc1
s_waitcnt vmcnt(0)
v_cmp_gt_u32 vcc,s71,v5
s_cbranch_vccz pok_389
s_sleep 4
s_sub_u32 s90,s90,1
s_cmp_gt_i32 s90,0
s_cbranch_scc1 plp_388
pok_389:
ek_385:
buffer_load_dwordx4 v[16:19],v3,s[20:23],s98 offen offset:0
buffer_load_dwordx4 v[20:23],v3,s[20:23],s98 offen offset:128
buffer_load_dwordx4 v[24:27],v3,s[20:23],s99 offen offset:0
buffer_load_dwordx4 v[28:31],v3,s[20:23],s99 offen offset:128
buffer_load_dwordx4 v[32:35],v4,s[20:23],s98 offen offset:1024
buffer_load_dwordx4 v[36:39],v4,s[20:23],s98 offen offset:1536
buffer_load_dwordx4 v[40:43],v4,s[20:23],s99 offen offset:1024
buffer_load_dwordx4 v[44:47],v4,s[20:23],s99 offen offset:1536
s_barrier
s_cmp_lt_u32 s60,122
s_cbranch_scc1 pf_390
s_waitcnt vmcnt(0)
s_branch j1_391
pf_390:
s_add_u32 s64,s60,2
s_lshl_b32 s65,s64,11
s_and_b32 s65,s65,0x2000
s_xor_b32 s65,s65,s67
s_lshl_b32 s64,s64,19
s_add_u32 s64,s64,s65
s_add_u32 s92,s64,s53
s_add_u32 s93,s92,16384
s_add_u32 s94,s92,4096
s_add_u32 s95,s93,4096
s_xor_b32 s96,s92,s55
s_xor_b32 s97,s93,s55
buffer_load_dwordx4 a[0:3],v0,s[20:23],s96 offen offset:0
buffer_load_dwordx4 a[16:19],v0,s[20:23],s92 offen offset:0
buffer_load_dwordx4 a[32:35],v0,s[20:23],s92 offen offset:1024
buffer_load_dwordx4 a[4:7],v0,s[20:23],s96 offen offset:2048
buffer_load_dwordx4 a[20:23],v0,s[20:23],s92 offen offset:2048
buffer_load_dwordx4 a[36:39],v0,s[20:23],s92 offen offset:3072
buffer_load_dwordx4 a[8:11],v0,s[20:23],s97 offen offset:0
buffer_load_dwordx4 a[24:27],v0,s[20:23],s93 offen offset:0
buffer_load_dwordx4 a[40:43],v0,s[20:23],s93 offen offset:1024
buffer_load_dwordx4 a[12:15],v0,s[20:23],s97 offen offset:2048
buffer_load_dwordx4 a[28:31],v0,s[20:23],s93 offen offset:2048
buffer_load_dwordx4 a[44:47],v0,s[20:23],s93 offen offset:3072
j1_391:
s_waitcnt vmcnt(16)
v_mfma_f32_16x16x32_bf16 v[56:59],v[16:19],a[80:83],0
v_mfma_f32_16x16x32_bf16 v[56:59],v[20:23],a[84:87],v[56:59]
v_mfma_f32_16x16x32_bf16 v[56:59],v[24:27],a[88:91],v[56:59]
v_mfma_f32_16x16x32_bf16 v[56:59],v[28:31],a[92:95],v[56:59]
s_nop 7
v_cndmask_b32 v56,v7,v56,s[44:45]
v_cndmask_b32 v57,v7,v57,s[44:45]
v_cndmask_b32 v58,v7,v58,s[44:45]
v_cndmask_b32 v59,v7,v59,s[44:45]
v_max3_f32 v72,v72,v56,v57
v_max3_f32 v72,v72,v58,v59
v_mov_b32 v73,v72
s_nop 1
v_permlane16_swap_b32 v73,v72
v_max_f32 v72,v72,v73
v_mov_b32 v73,v72
s_nop 1
v_permlane32_swap_b32 v73,v72
v_max_f32 v72,v72,v73
v_mul_f32 v72,s80,v72
v_fma_f32 v48,v48,s80,-v72
v_fma_f32 v49,v49,s80,-v72
v_fma_f32 v50,v50,s80,-v72
v_fma_f32 v51,v51,s80,-v72
v_fma_f32 v52,v52,s80,-v72
v_fma_f32 v53,v53,s80,-v72
v_fma_f32 v54,v54,s80,-v72
v_fma_f32 v55,v55,s80,-v72
v_fma_f32 v56,v56,s80,-v72
v_fma_f32 v57,v57,s80,-v72
v_fma_f32 v58,v58,s80,-v72
v_fma_f32 v59,v59,s80,-v72
v_exp_f32 v48,v48
v_exp_f32 v49,v49
v_exp_f32 v50,v50
v_exp_f32 v51,v51
v_exp_f32 v52,v52
v_exp_f32 v53,v53
v_exp_f32 v54,v54
v_exp_f32 v55,v55
v_exp_f32 v56,v56
v_exp_f32 v57,v57
v_exp_f32 v58,v58
v_exp_f32 v59,v59
v_add_f32 v74,v48,v49
v_add_f32 v75,v50,v51
v_add_f32 v74,v74,v52
v_add_f32 v75,v75,v53
v_add_f32 v74,v74,v54
v_add_f32 v75,v75,v55
v_add_f32 v74,v74,v56
v_add_f32 v75,v75,v57
v_add_f32 v74,v74,v58
v_add_f32 v75,v75,v59
v_add_f32 v74,v74,v75
v_mov_b32 v73,v74
s_nop 1
v_permlane16_swap_b32 v73,v74
v_add_f32 v74,v74,v73
v_mov_b32 v73,v74
s_nop 1
v_permlane32_swap_b32 v73,v74
v_add_f32 v74,v74,v73
v_rcp_f32 v75,v74
s_nop 0
v_mul_f32 v48,v48,v75
v_mul_f32 v49,v49,v75
v_mul_f32 v50,v50,v75
v_mul_f32 v51,v51,v75
v_mul_f32 v52,v52,v75
v_mul_f32 v53,v53,v75
v_mul_f32 v54,v54,v75
v_mul_f32 v55,v55,v75
v_mul_f32 v56,v56,v75
v_mul_f32 v57,v57,v75
v_mul_f32 v58,v58,v75
v_mul_f32 v59,v59,v75
v_cvt_pk_bf16_f32 v64,v48,v49
v_cvt_pk_bf16_f32 v65,v50,v51
v_cvt_pk_bf16_f32 v66,v52,v53
v_cvt_pk_bf16_f32 v67,v54,v55
v_cvt_pk_bf16_f32 v68,v56,v57
v_cvt_pk_bf16_f32 v69,v58,v59
v_mfma_f32_16x16x32_bf16 v[80:83],a[128:131],v[64:67],0
v_mfma_f32_16x16x32_bf16 v[84:87],a[132:135],v[64:67],0
v_mfma_f32_16x16x32_bf16 v[88:91],a[136:139],v[64:67],0
v_mfma_f32_16x16x32_bf16 v[92:95],a[140:143],v[64:67],0
v_mfma_f32_16x16x32_bf16 v[96:99],a[144:147],v[64:67],0
v_mfma_f32_16x16x32_bf16 v[100:103],a[148:151],v[64:67],0
v_mfma_f32_16x16x32_bf16 v[104:107],a[152:155],v[64:67],0
v_mfma_f32_16x16x32_bf16 v[108:111],a[156:159],v[64:67],0
s_waitcnt vmcnt(12)
v_mfma_f32_16x16x16_bf16 v[80:83],v[32:33],v[68:69],v[80:83]
v_mfma_f32_16x16x16_bf16 v[84:87],v[34:35],v[68:69],v[84:87]
v_mfma_f32_16x16x16_bf16 v[88:91],v[36:37],v[68:69],v[88:91]
v_mfma_f32_16x16x16_bf16 v[92:95],v[38:39],v[68:69],v[92:95]
v_mfma_f32_16x16x16_bf16 v[96:99],v[40:41],v[68:69],v[96:99]
v_mfma_f32_16x16x16_bf16 v[100:103],v[42:43],v[68:69],v[100:103]
v_mfma_f32_16x16x16_bf16 v[104:107],v[44:45],v[68:69],v[104:107]
v_mfma_f32_16x16x16_bf16 v[108:111],v[46:47],v[68:69],v[108:111]
s_nop 0
v_cvt_pk_bf16_f32 v112,v80,v81
v_cvt_pk_bf16_f32 v113,v82,v83
v_cvt_pk_bf16_f32 v114,v84,v85
v_cvt_pk_bf16_f32 v115,v86,v87
buffer_store_dwordx4 v[112:115],v0,s[20:23],s66 offen offset:0 sc1
v_cvt_pk_bf16_f32 v116,v88,v89
v_cvt_pk_bf16_f32 v117,v90,v91
v_cvt_pk_bf16_f32 v118,v92,v93
v_cvt_pk_bf16_f32 v119,v94,v95
buffer_store_dwordx4 v[116:119],v0,s[20:23],s66 offen offset:1024 sc1
v_cvt_pk_bf16_f32 v112,v96,v97
v_cvt_pk_bf16_f32 v113,v98,v99
v_cvt_pk_bf16_f32 v114,v100,v101
v_cvt_pk_bf16_f32 v115,v102,v103
buffer_store_dwordx4 v[112:115],v0,s[20:23],s66 offen offset:2048 sc1
v_cvt_pk_bf16_f32 v116,v104,v105
v_cvt_pk_bf16_f32 v117,v106,v107
v_cvt_pk_bf16_f32 v118,v108,v109
v_cvt_pk_bf16_f32 v119,v110,v111
buffer_store_dwordx4 v[116:119],v0,s[20:23],s66 offen offset:3072 sc1
s_barrier
s_cmp_lt_u32 s60,122
s_cbranch_scc1 pf_392
s_waitcnt vmcnt(0)
s_branch j1_393
pf_392:
buffer_load_dwordx4 a[48:51],v0,s[20:23],s94 offen offset:0
buffer_load_dwordx4 a[52:55],v0,s[20:23],s94 offen offset:1024
buffer_load_dwordx4 a[56:59],v0,s[20:23],s94 offen offset:2048
buffer_load_dwordx4 a[60:63],v0,s[20:23],s94 offen offset:3072
buffer_load_dwordx4 a[64:67],v0,s[20:23],s95 offen offset:0
buffer_load_dwordx4 a[68:71],v0,s[20:23],s95 offen offset:1024
buffer_load_dwordx4 a[72:75],v0,s[20:23],s95 offen offset:2048
buffer_load_dwordx4 a[76:79],v0,s[20:23],s95 offen offset:3072
j1_393:
buffer_load_dword v5,v2,s[20:23],s68 offen sc1
s_add_u32 s66,s66,262144
s_add_u32 s60,s60,2
s_add_u32 s72,s60,s54
s_cmp_eq_u32 s60,124
s_cselect_b32 s72,128,s72
s_waitcnt vmcnt(9)
v_mov_b32 v6,s72
s_mov_b64 exec,1
buffer_store_dword v6,off,s[20:23],s69 sc1
s_mov_b64 exec,-1
s_cmp_lt_u32 s60,124
s_cbranch_scc1 top0_378
s_endpgm
fl_att2:
s_lshr_b32 s46,s59,4
s_and_b32 s59,s59,15
v_mbcnt_lo_u32_b32 v1,-1,0
v_mbcnt_hi_u32_b32 v1,-1,v1
v_lshlrev_b32 v0,4,v1
v_and_b32 v21,15,v1
v_lshrrev_b32 v22,4,v1
v_and_b32 v23,7,v21
v_lshlrev_b32 v23,4,v23
v_lshl_add_u32 v3,v22,8,v23
v_and_b32 v23,31,v1
v_lshlrev_b32 v4,4,v23
v_and_b32 v23,3,v1
v_bfe_u32 v24,v1,2,1
v_lshlrev_b32 v23,14,v23
v_lshl_add_u32 v2,v24,7,v23
v_mov_b32 v7,0xff800000
s_and_b32 s54,s50,1
s_lshl_b32 s64,s54,4
v_lshlrev_b32 v23,2,v22
v_sub_u32 v23,v21,v23
v_add_u32 v23,s64,v23
v_cmp_le_i32 s[28:29],0,v23
v_cmp_le_i32 s[30:31],1,v23
v_cmp_le_i32 s[32:33],2,v23
v_cmp_le_i32 s[34:35],3,v23
v_cmp_le_i32 s[36:37],16,v23
v_cmp_le_i32 s[38:39],17,v23
v_cmp_le_i32 s[40:41],18,v23
v_cmp_le_i32 s[42:43],19,v23
s_mov_b32 s44,-1
s_mov_b32 s45,0
s_mov_b32 s80,0x3e0293ee
s_lshl_b32 s52,s59,1
s_lshr_b32 s64,s50,1
s_add_u32 s52,s52,s64
s_lshl_b32 s53,s52,15
s_lshl_b32 s68,s52,8
s_add_u32 s68,s68,s67
s_add_u32 s68,s68,138428416
s_lshl_b32 s69,s59,8
s_lshl_b32 s64,s64,2
s_add_u32 s69,s69,s64
s_lshl_b32 s64,s54,3
s_add_u32 s69,s69,s64
s_add_u32 s69,s69,138543104
s_lshl_b32 s66,s52,12
s_lshl_b32 s64,s54,17
s_add_u32 s66,s66,s64
s_add_u32 s66,s66,150994944
s_lshl_b32 s55,s54,10
s_xor_b32 s55,s55,0x2000
s_mov_b32 s60,0
s_lshl_b32 s60,s46,1
s_add_u32 s60,s60,124
s_lshl_b32 s64,s60,17
s_add_u32 s66,s66,s64
s_lshl_b32 s47,s52,7
s_add_u32 s47,s47,s67
s_add_u32 s47,s47,138412032
v_and_b32 v23,1,v1
v_lshlrev_b32 v23,6,v23
s_mov_b32 s71,64
plp_394:
buffer_load_dword v5,v23,s[20:23],s47 offen sc1
s_waitcnt vmcnt(0)
v_cmp_gt_u32 vcc,s71,v5
s_cbranch_vccz pok_395
s_sleep 16
s_sub_u32 s90,s90,1
s_cmp_gt_i32 s90,0
s_cbranch_scc1 plp_394
pok_395:
s_add_u32 s64,s60,0
s_lshl_b32 s65,s64,11
s_and_b32 s65,s65,0x2000
s_xor_b32 s65,s65,s67
s_lshl_b32 s64,s64,19
s_add_u32 s64,s64,s65
s_add_u32 s92,s64,s53
s_add_u32 s93,s92,16384
s_add_u32 s94,s92,4096
s_add_u32 s95,s93,4096
s_xor_b32 s96,s92,s55
s_xor_b32 s97,s93,s55
buffer_load_dwordx4 a[0:3],v0,s[20:23],s96 offen offset:0
buffer_load_dwordx4 a[16:19],v0,s[20:23],s92 offen offset:0
buffer_load_dwordx4 a[32:35],v0,s[20:23],s92 offen offset:1024
buffer_load_dwordx4 a[4:7],v0,s[20:23],s96 offen offset:2048
buffer_load_dwordx4 a[20:23],v0,s[20:23],s92 offen offset:2048
buffer_load_dwordx4 a[36:39],v0,s[20:23],s92 offen offset:3072
buffer_load_dwordx4 a[8:11],v0,s[20:23],s97 offen offset:0
buffer_load_dwordx4 a[24:27],v0,s[20:23],s93 offen offset:0
buffer_load_dwordx4 a[40:43],v0,s[20:23],s93 offen offset:1024
buffer_load_dwordx4 a[12:15],v0,s[20:23],s97 offen offset:2048
buffer_load_dwordx4 a[28:31],v0,s[20:23],s93 offen offset:2048
buffer_load_dwordx4 a[44:47],v0,s[20:23],s93 offen offset:3072
buffer_load_dwordx4 a[48:51],v0,s[20:23],s94 offen offset:0
buffer_load_dwordx4 a[52:55],v0,s[20:23],s94 offen offset:1024
buffer_load_dwordx4 a[56:59],v0,s[20:23],s94 offen offset:2048
buffer_load_dwordx4 a[60:63],v0,s[20:23],s94 offen offset:3072
buffer_load_dwordx4 a[64:67],v0,s[20:23],s95 offen offset:0
buffer_load_dwordx4 a[68:71],v0,s[20:23],s95 offen offset:1024
buffer_load_dwordx4 a[72:75],v0,s[20:23],s95 offen offset:2048
buffer_load_dwordx4 a[76:79],v0,s[20:23],s95 offen offset:3072
s_waitcnt vmcnt(8)
top0_396:
v_mfma_f32_16x16x32_bf16 v[48:51],a[16:19],a[0:3],0
v_mfma_f32_16x16x32_bf16 v[52:55],a[32:35],a[0:3],0
v_mfma_f32_16x16x32_bf16 v[48:51],a[20:23],a[4:7],v[48:51]
v_mfma_f32_16x16x32_bf16 v[52:55],a[36:39],a[4:7],v[52:55]
v_mfma_f32_16x16x32_bf16 v[48:51],a[24:27],a[8:11],v[48:51]
v_mfma_f32_16x16x32_bf16 v[52:55],a[40:43],a[8:11],v[52:55]
v_mfma_f32_16x16x32_bf16 v[48:51],a[28:31],a[12:15],v[48:51]
v_mfma_f32_16x16x32_bf16 v[52:55],a[44:47],a[12:15],v[52:55]
s_nop 6
v_cndmask_b32 v48,v7,v48,s[28:29]
v_cndmask_b32 v49,v7,v49,s[30:31]
v_cndmask_b32 v50,v7,v50,s[32:33]
v_cndmask_b32 v51,v7,v51,s[34:35]
v_cndmask_b32 v52,v7,v52,s[36:37]
v_cndmask_b32 v53,v7,v53,s[38:39]
v_cndmask_b32 v54,v7,v54,s[40:41]
v_cndmask_b32 v55,v7,v55,s[42:43]
v_max3_f32 v72,v48,v49,v50
v_max3_f32 v72,v72,v51,v52
v_max3_f32 v72,v72,v53,v54
v_max_f32 v72,v72,v55
s_add_u32 s64,s60,0
s_lshl_b32 s65,s64,11
s_and_b32 s65,s65,0x2000
s_xor_b32 s65,s65,s67
s_lshl_b32 s64,s64,19
s_add_u32 s64,s64,s65
s_add_u32 s98,s64,s53
s_mov_b32 s71,118
plp_398:
buffer_load_dword v5,off,s[20:23],s69 sc1
s_waitcnt vmcnt(0)
v_cmp_gt_u32 vcc,s71,v5
s_cbranch_vccz pok_399
s_sleep 32
s_sub_u32 s90,s90,1
s_cmp_gt_i32 s90,0
s_cbranch_scc1 plp_398
pok_399:
s_lshl_b32 s64,s46,4
s_add_u32 s69,s69,s64
s_add_u32 s69,s69,16
s_add_u32 s98,s98,67108864
s_add_u32 s99,s98,16384
s_lshr_b32 s71,s60,1
s_add_u32 s71,s71,1
s_min_u32 s71,s71,63
plp_403:
buffer_load_dword v5,v2,s[20:23],s68 offen sc1
s_waitcnt vmcnt(0)
v_cmp_gt_u32 vcc,s71,v5
s_cbranch_vccz pok_404
s_sleep 4
s_sub_u32 s90,s90,1
s_cmp_gt_i32 s90,0
s_cbranch_scc1 plp_403
pok_404:
s_cmp_eq_u32 s60,126
s_cbranch_scc1 kd_401
ek_400:
buffer_load_dwordx4 v[16:19],v3,s[20:23],s98 offen offset:0
buffer_load_dwordx4 v[20:23],v3,s[20:23],s98 offen offset:128
buffer_load_dwordx4 v[24:27],v3,s[20:23],s99 offen offset:0
buffer_load_dwordx4 v[28:31],v3,s[20:23],s99 offen offset:128
buffer_load_dwordx4 v[32:35],v4,s[20:23],s98 offen offset:1024
buffer_load_dwordx4 v[36:39],v4,s[20:23],s98 offen offset:1536
buffer_load_dwordx4 v[40:43],v4,s[20:23],s99 offen offset:1024
buffer_load_dwordx4 v[44:47],v4,s[20:23],s99 offen offset:1536
s_branch kj_402
kd_401:
buffer_load_dwordx4 v[16:19],v3,s[20:23],s98 offen offset:0 sc1
buffer_load_dwordx4 v[20:23],v3,s[20:23],s98 offen offset:128 sc1
buffer_load_dwordx4 v[24:27],v3,s[20:23],s99 offen offset:0 sc1
buffer_load_dwordx4 v[28:31],v3,s[20:23],s99 offen offset:128 sc1
buffer_load_dwordx4 v[32:35],v4,s[20:23],s98 offen offset:1024 sc1
buffer_load_dwordx4 v[36:39],v4,s[20:23],s98 offen offset:1536 sc1
buffer_load_dwordx4 v[40:43],v4,s[20:23],s99 offen offset:1024 sc1
buffer_load_dwordx4 v[44:47],v4,s[20:23],s99 offen offset:1536 sc1
s_waitcnt vmcnt(4)
v_max3_u32 v5,v16,v17,v18
v_max3_u32 v6,v24,v25,v26
v_max3_u32 v5,v5,v19,v20
v_max3_u32 v6,v6,v21,v22
v_max3_u32 v5,v5,v27,v28
v_max3_u32 v6,v6,v29,v30
s_waitcnt vmcnt(0)
v_max3_u32 v5,v5,v32,v33
v_max3_u32 v6,v6,v34,v35
v_max3_u32 v5,v5,v36,v37
v_max3_u32 v6,v6,v38,v39
v_max3_u32 v5,v5,v40,v41
v_max3_u32 v6,v6,v42,v43
v_max3_u32 v5,v5,v44,v45
v_max3_u32 v6,v6,v46,v47
v_max3_u32 v5,v5,v23,v31
v_max_u32 v5,v5,v6
v_cmp_eq_u32 vcc,-1,v5
s_cbranch_vccz kj_402
s_sleep 1
s_sub_u32 s90,s90,1
s_cmp_gt_i32 s90,0
s_cbranch_scc1 kd_401
kj_402:
s_waitcnt vmcnt(4)
v_mfma_f32_16x16x32_bf16 v[56:59],v[16:19],a[0:3],0
v_mfma_f32_16x16x32_bf16 v[56:59],v[20:23],a[4:7],v[56:59]
v_mfma_f32_16x16x32_bf16 v[56:59],v[24:27],a[8:11],v[56:59]
v_mfma_f32_16x16x32_bf16 v[56:59],v[28:31],a[12:15],v[56:59]
s_nop 7
v_cndmask_b32 v56,v7,v56,s[44:45]
v_cndmask_b32 v57,v7,v57,s[44:45]
v_cndmask_b32 v58,v7,v58,s[44:45]
v_cndmask_b32 v59,v7,v59,s[44:45]
v_max3_f32 v72,v72,v56,v57
v_max3_f32 v72,v72,v58,v59
v_mov_b32 v73,v72
s_nop 1
v_permlane16_swap_b32 v73,v72
v_max_f32 v72,v72,v73
v_mov_b32 v73,v72
s_nop 1
v_permlane32_swap_b32 v73,v72
v_max_f32 v72,v72,v73
v_mul_f32 v72,s80,v72
v_fma_f32 v48,v48,s80,-v72
v_fma_f32 v49,v49,s80,-v72
v_fma_f32 v50,v50,s80,-v72
v_fma_f32 v51,v51,s80,-v72
v_fma_f32 v52,v52,s80,-v72
v_fma_f32 v53,v53,s80,-v72
v_fma_f32 v54,v54,s80,-v72
v_fma_f32 v55,v55,s80,-v72
v_fma_f32 v56,v56,s80,-v72
v_fma_f32 v57,v57,s80,-v72
v_fma_f32 v58,v58,s80,-v72
v_fma_f32 v59,v59,s80,-v72
v_exp_f32 v48,v48
v_exp_f32 v49,v49
v_exp_f32 v50,v50
v_exp_f32 v51,v51
v_exp_f32 v52,v52
v_exp_f32 v53,v53
v_exp_f32 v54,v54
v_exp_f32 v55,v55
v_exp_f32 v56,v56
v_exp_f32 v57,v57
v_exp_f32 v58,v58
v_exp_f32 v59,v59
v_add_f32 v74,v48,v49
v_add_f32 v75,v50,v51
v_add_f32 v74,v74,v52
v_add_f32 v75,v75,v53
v_add_f32 v74,v74,v54
v_add_f32 v75,v75,v55
v_add_f32 v74,v74,v56
v_add_f32 v75,v75,v57
v_add_f32 v74,v74,v58
v_add_f32 v75,v75,v59
v_add_f32 v74,v74,v75
v_mov_b32 v73,v74
s_nop 1
v_permlane16_swap_b32 v73,v74
v_add_f32 v74,v74,v73
v_mov_b32 v73,v74
s_nop 1
v_permlane32_swap_b32 v73,v74
v_add_f32 v74,v74,v73
v_rcp_f32 v75,v74
s_nop 0
v_mul_f32 v48,v48,v75
v_mul_f32 v49,v49,v75
v_mul_f32 v50,v50,v75
v_mul_f32 v51,v51,v75
v_mul_f32 v52,v52,v75
v_mul_f32 v53,v53,v75
v_mul_f32 v54,v54,v75
v_mul_f32 v55,v55,v75
v_mul_f32 v56,v56,v75
v_mul_f32 v57,v57,v75
v_mul_f32 v58,v58,v75
v_mul_f32 v59,v59,v75
v_cvt_pk_bf16_f32 v64,v48,v49
v_cvt_pk_bf16_f32 v65,v50,v51
v_cvt_pk_bf16_f32 v66,v52,v53
v_cvt_pk_bf16_f32 v67,v54,v55
v_cvt_pk_bf16_f32 v68,v56,v57
v_cvt_pk_bf16_f32 v69,v58,v59
v_mfma_f32_16x16x32_bf16 v[80:83],a[48:51],v[64:67],0
v_mfma_f32_16x16x32_bf16 v[84:87],a[52:55],v[64:67],0
v_mfma_f32_16x16x32_bf16 v[88:91],a[56:59],v[64:67],0
v_mfma_f32_16x16x32_bf16 v[92:95],a[60:63],v[64:67],0
v_mfma_f32_16x16x32_bf16 v[96:99],a[64:67],v[64:67],0
v_mfma_f32_16x16x32_bf16 v[100:103],a[68:71],v[64:67],0
v_mfma_f32_16x16x32_bf16 v[104:107],a[72:75],v[64:67],0
v_mfma_f32_16x16x32_bf16 v[108:111],a[76:79],v[64:67],0
s_waitcnt vmcnt(0)
v_mfma_f32_16x16x16_bf16 v[80:83],v[32:33],v[68:69],v[80:83]
v_mfma_f32_16x16x16_bf16 v[84:87],v[34:35],v[68:69],v[84:87]
v_mfma_f32_16x16x16_bf16 v[88:91],v[36:37],v[68:69],v[88:91]
v_mfma_f32_16x16x16_bf16 v[92:95],v[38:39],v[68:69],v[92:95]
v_mfma_f32_16x16x16_bf16 v[96:99],v[40:41],v[68:69],v[96:99]
v_mfma_f32_16x16x16_bf16 v[100:103],v[42:43],v[68:69],v[100:103]
v_mfma_f32_16x16x16_bf16 v[104:107],v[44:45],v[68:69],v[104:107]
v_mfma_f32_16x16x16_bf16 v[108:111],v[46:47],v[68:69],v[108:111]
s_nop 0
v_cvt_pk_bf16_f32 v112,v80,v81
v_cvt_pk_bf16_f32 v113,v82,v83
v_cvt_pk_bf16_f32 v114,v84,v85
v_cvt_pk_bf16_f32 v115,v86,v87
buffer_store_dwordx4 v[112:115],v0,s[20:23],s66 offen offset:0 sc1
v_cvt_pk_bf16_f32 v116,v88,v89
v_cvt_pk_bf16_f32 v117,v90,v91
v_cvt_pk_bf16_f32 v118,v92,v93
v_cvt_pk_bf16_f32 v119,v94,v95
buffer_store_dwordx4 v[116:119],v0,s[20:23],s66 offen offset:1024 sc1
v_cvt_pk_bf16_f32 v112,v96,v97
v_cvt_pk_bf16_f32 v113,v98,v99
v_cvt_pk_bf16_f32 v114,v100,v101
v_cvt_pk_bf16_f32 v115,v102,v103
buffer_store_dwordx4 v[112:115],v0,s[20:23],s66 offen offset:2048 sc1
v_cvt_pk_bf16_f32 v116,v104,v105
v_cvt_pk_bf16_f32 v117,v106,v107
v_cvt_pk_bf16_f32 v118,v108,v109
v_cvt_pk_bf16_f32 v119,v110,v111
buffer_store_dwordx4 v[116:119],v0,s[20:23],s66 offen offset:3072 sc1
s_waitcnt vmcnt(0)
v_mov_b32 v6,128
s_mov_b64 exec,1
buffer_store_dword v6,off,s[20:23],s69 sc1
s_mov_b64 exec,-1
s_endpgm
fl_rec:
s_load_dwordx8 s[4:11],s[0:1],8
s_load_dwordx2 s[12:13],s[0:1],40
s_mov_b32 s57,s58
v_mov_b32 v0,v1
s_waitcnt lgkmcnt(0)
s_mov_b32 s28,s6
s_and_b32 s29,s7,0xffff
s_mov_b32 s30,0x800000
s_mov_b32 s31,0x20000
s_mov_b32 s32,s8
s_and_b32 s33,s9,0xffff
s_mov_b32 s34,0x800000
s_mov_b32 s35,0x20000
s_mov_b32 s36,s10
s_and_b32 s37,s11,0xffff
s_mov_b32 s38,0x800000
s_mov_b32 s39,0x20000
s_mov_b32 s40,s12
s_and_b32 s41,s13,0xffff
s_mov_b32 s42,0x800000
s_mov_b32 s43,0x20000
s_mov_b32 s44,s4
s_and_b32 s45,s5,0xffff
s_mov_b32 s46,0x4000
s_mov_b32 s47,0x20000
s_lshr_b32 s58,s57,5
s_and_b32 s59,s57,31
v_and_b32 v20,63,v0
v_and_b32 v21,15,v20
v_lshrrev_b32 v22,4,v20
v_lshrrev_b32 v23,3,v20
v_and_b32 v24,7,v20
v_lshlrev_b32 v16,13,v23
v_lshl_add_u32 v16,v24,4,v16
v_lshrrev_b32 v23,2,v20
v_and_b32 v24,3,v20
v_lshlrev_b32 v17,11,v23
v_lshl_add_u32 v17,v24,4,v17
s_lshl_b32 s61,s50,15
s_add_u32 s61,s61,32768
s_lshl_b32 s62,s50,21
s_lshl_b32 s64,s57,7
s_add_u32 s62,s62,s64
s_lshl_b32 s63,s58,22
s_lshl_b32 s64,s50,20
s_add_u32 s63,s63,s64
s_lshl_b32 s64,s59,6
s_add_u32 s63,s63,s64
v_lshrrev_b32 v23,1,v22
v_lshlrev_b32 v25,4,v23
v_and_b32 v23,1,v22
v_lshl_add_u32 v25,v23,2,v25
v_lshrrev_b32 v23,3,v21
v_lshl_add_u32 v25,v23,3,v25
v_bfe_u32 v23,v21,2,1
v_add_u32 v25,v25,v23
v_lshlrev_b32 v28,4,v23
v_lshrrev_b32 v23,1,v22
v_lshl_add_u32 v28,v23,3,v28
v_lshrrev_b32 v23,3,v21
v_lshl_add_u32 v28,v23,2,v28
v_and_b32 v23,1,v22
v_lshl_add_u32 v28,v23,1,v28
v_and_b32 v24,3,v21
v_lshlrev_b32 v26,7,v28
v_add_u32 v26,s61,v26
v_lshl_add_u32 v18,v24,3,v26
v_lshl_add_u32 v19,v24,4,v26
v_lshlrev_b32 v26,6,v25
v_add_u32 v26,s61,v26
v_lshl_add_u32 v27,v24,3,v26
v_lshlrev_b32 v0,4,v20
v_add_u32 v7,s61,v0
s_and_b32 s64,s59,1
s_lshl_b32 s65,s64,18
s_add_u32 s70,s63,s65
s_sub_u32 s71,s63,s65
s_lshl_b32 s65,s64,13
s_add_u32 s72,s61,s65
s_sub_u32 s73,s61,s65
s_and_b32 s64,s57,7
s_lshl_b32 s65,s64,2
s_mov_b32 s66,0
s_lshl_b32 s65,s65,13
s_andn2_b32 s55,s57,7
s_lshl_b32 s55,s55,7
s_add_u32 s65,s65,s55
s_add_u32 s65,s65,384
v_and_b32 v29,3,v20
v_lshlrev_b32 v29,13,v29
v_add_u32 v29,s65,v29
v_and_b32 v15,4,v20
v_lshl_add_u32 v29,v15,4,v29
s_and_b32 s55,s57,31
s_add_u32 s66,s66,s55
s_lshl_b32 s66,s66,13
s_add_u32 s66,s66,8064
v_writelane_b32 v29,s66,8
s_add_u32 s66,s66,64
v_writelane_b32 v29,s66,9
s_cmp_eq_u32 s64,3
s_cselect_b32 s65,0,15
s_sub_u32 s66,s57,32
s_cmp_lt_u32 s66,31
s_cselect_b32 s66,256,0
s_or_b32 vcc_lo,s65,s66
s_mov_b32 vcc_hi,0
v_cndmask_b32 v29,-1,v29,vcc
s_lshl_b32 s68,s50,21
s_lshl_b32 s64,s58,22
s_lshl_b32 s65,s50,20
s_add_u32 s64,s64,s65
s_and_b32 s66,s59,15
s_lshl_b32 s65,s66,13
s_add_u32 s64,s64,s65
s_lshr_b32 s65,s59,4
s_lshl_b32 s65,s65,10
s_add_u32 s69,s64,s65
s_add_u32 s69,s69,384
s_lshr_b32 s66,s66,1
s_cmp_eq_u32 s66,3
s_cselect_b32 s65,0,4
v_and_b32 v30,3,v20
v_lshlrev_b32 v30,11,v30
v_and_b32 v31,4,v20
v_lshl_add_u32 v30,v31,4,v30
v_cmp_gt_u32 vcc,s65,v20
s_nop 1
v_cndmask_b32 v30,-1,v30,vcc
s_add_u32 s64,s68,262144
buffer_load_dword v31,v29,s[28:31],s64 offen
s_add_u32 s64,s68,524288
buffer_load_dword v31,v29,s[28:31],s64 offen
s_add_u32 s64,s68,786432
buffer_load_dword v31,v29,s[28:31],s64 offen
s_add_u32 s64,s62,0
s_add_u32 m0,s61,0
s_nop 0
buffer_load_dwordx4 v16,s[28:31],s64 offen lds
s_waitcnt vmcnt(10)
s_add_u32 s64,s62,65536
s_add_u32 m0,s61,1024
s_nop 0
buffer_load_dwordx4 v16,s[28:31],s64 offen lds
s_add_u32 s64,s68,1048576
buffer_load_dword v31,v29,s[28:31],s64 offen
s_waitcnt vmcnt(10)
s_add_u32 s64,s62,131072
s_add_u32 m0,s61,2048
s_nop 0
buffer_load_dwordx4 v16,s[28:31],s64 offen lds
s_waitcnt vmcnt(10)
s_add_u32 s64,s62,196608
s_add_u32 m0,s61,3072
s_nop 0
buffer_load_dwordx4 v16,s[28:31],s64 offen lds
s_waitcnt vmcnt(10)
s_add_u32 s64,s62,262144
s_add_u32 m0,s61,4096
s_nop 0
buffer_load_dwordx4 v16,s[28:31],s64 offen lds
s_waitcnt vmcnt(10)
s_add_u32 s64,s62,327680
s_add_u32 m0,s61,5120
s_nop 0
buffer_load_dwordx4 v16,s[28:31],s64 offen lds
s_add_u32 s64,s68,1310720
buffer_load_dword v31,v29,s[28:31],s64 offen
s_waitcnt vmcnt(10)
s_add_u32 s64,s62,393216
s_add_u32 m0,s61,6144
s_nop 0
buffer_load_dwordx4 v16,s[28:31],s64 offen lds
s_waitcnt vmcnt(10)
s_add_u32 s64,s62,458752
s_add_u32 m0,s61,7168
s_nop 0
buffer_load_dwordx4 v16,s[28:31],s64 offen lds
s_waitcnt vmcnt(10)
s_add_u32 s64,s62,524288
s_add_u32 m0,s61,8192
s_nop 0
buffer_load_dwordx4 v16,s[28:31],s64 offen lds
s_waitcnt vmcnt(10)
s_add_u32 s64,s62,589824
s_add_u32 m0,s61,9216
s_nop 0
buffer_load_dwordx4 v16,s[28:31],s64 offen lds
s_add_u32 s64,s68,1572864
buffer_load_dword v31,v29,s[28:31],s64 offen
s_waitcnt vmcnt(10)
s_add_u32 s64,s62,655360
s_add_u32 m0,s61,10240
s_nop 0
buffer_load_dwordx4 v16,s[28:31],s64 offen lds
s_waitcnt vmcnt(10)
s_add_u32 s64,s62,720896
s_add_u32 m0,s61,11264
s_nop 0
buffer_load_dwordx4 v16,s[28:31],s64 offen lds
s_waitcnt vmcnt(10)
s_add_u32 s64,s62,786432
s_add_u32 m0,s61,12288
s_nop 0
buffer_load_dwordx4 v16,s[28:31],s64 offen lds
s_waitcnt vmcnt(10)
s_add_u32 s64,s62,851968
s_add_u32 m0,s61,13312
s_nop 0
buffer_load_dwordx4 v16,s[28:31],s64 offen lds
s_add_u32 s64,s68,1835008
buffer_load_dword v31,v29,s[28:31],s64 offen
s_waitcnt vmcnt(10)
s_add_u32 s64,s62,917504
s_add_u32 m0,s61,14336
s_nop 0
buffer_load_dwordx4 v16,s[28:31],s64 offen lds
s_waitcnt vmcnt(10)
s_add_u32 s64,s62,983040
s_add_u32 m0,s61,15360
s_nop 0
buffer_load_dwordx4 v16,s[28:31],s64 offen lds
s_add_u32 s64,s62,1048576
s_add_u32 m0,s61,16384
s_nop 0
buffer_load_dwordx4 v16,s[28:31],s64 offen lds
s_waitcnt vmcnt(10)
s_add_u32 s64,s62,1114112
s_add_u32 m0,s61,17408
s_nop 0
buffer_load_dwordx4 v16,s[28:31],s64 offen lds
s_add_u32 s64,s68,0
buffer_load_dword v31,v29,s[32:35],s64 offen
s_waitcnt vmcnt(10)
s_add_u32 s64,s62,1179648
s_add_u32 m0,s61,18432
s_nop 0
buffer_load_dwordx4 v16,s[28:31],s64 offen lds
s_waitcnt vmcnt(10)
s_add_u32 s64,s62,1245184
s_add_u32 m0,s61,19456
s_nop 0
buffer_load_dwordx4 v16,s[28:31],s64 offen lds
s_waitcnt vmcnt(10)
s_add_u32 s64,s62,1310720
s_add_u32 m0,s61,20480
s_nop 0
buffer_load_dwordx4 v16,s[28:31],s64 offen lds
s_waitcnt vmcnt(10)
s_add_u32 s64,s62,1376256
s_add_u32 m0,s61,21504
s_nop 0
buffer_load_dwordx4 v16,s[28:31],s64 offen lds
s_add_u32 s64,s68,262144
buffer_load_dword v31,v29,s[32:35],s64 offen
s_waitcnt vmcnt(10)
s_add_u32 s64,s62,1441792
s_add_u32 m0,s61,22528
s_nop 0
buffer_load_dwordx4 v16,s[28:31],s64 offen lds
s_waitcnt vmcnt(10)
s_add_u32 s64,s62,1507328
s_add_u32 m0,s61,23552
s_nop 0
buffer_load_dwordx4 v16,s[28:31],s64 offen lds
s_waitcnt vmcnt(10)
s_add_u32 s64,s62,1572864
s_add_u32 m0,s61,24576
s_nop 0
buffer_load_dwordx4 v16,s[28:31],s64 offen lds
s_waitcnt vmcnt(10)
s_add_u32 s64,s62,1638400
s_add_u32 m0,s61,25600
s_nop 0
buffer_load_dwordx4 v16,s[28:31],s64 offen lds
s_add_u32 s64,s68,524288
buffer_load_dword v31,v29,s[32:35],s64 offen
s_waitcnt vmcnt(10)
s_add_u32 s64,s62,1703936
s_add_u32 m0,s61,26624
s_nop 0
buffer_load_dwordx4 v16,s[28:31],s64 offen lds
s_waitcnt vmcnt(10)
s_add_u32 s64,s62,1769472
s_add_u32 m0,s61,27648
s_nop 0
buffer_load_dwordx4 v16,s[28:31],s64 offen lds
s_waitcnt vmcnt(10)
s_add_u32 s64,s62,1835008
s_add_u32 m0,s61,28672
s_nop 0
buffer_load_dwordx4 v16,s[28:31],s64 offen lds
s_waitcnt vmcnt(10)
s_add_u32 s64,s62,1900544
s_add_u32 m0,s61,29696
s_nop 0
buffer_load_dwordx4 v16,s[28:31],s64 offen lds
s_add_u32 s64,s68,786432
buffer_load_dword v31,v29,s[32:35],s64 offen
s_waitcnt vmcnt(10)
s_add_u32 s64,s62,1966080
s_add_u32 m0,s61,30720
s_nop 0
buffer_load_dwordx4 v16,s[28:31],s64 offen lds
s_waitcnt vmcnt(10)
s_add_u32 s64,s62,2031616
s_add_u32 m0,s61,31744
s_nop 0
buffer_load_dwordx4 v16,s[28:31],s64 offen lds
s_waitcnt vmcnt(20)
ds_read_b64_tr_b16 a[0:1],v18 offset:0
ds_read_b64_tr_b16 a[2:3],v18 offset:128
ds_read_b64_tr_b16 a[4:5],v18 offset:4096
ds_read_b64_tr_b16 a[6:7],v18 offset:4224
ds_read_b64_tr_b16 a[8:9],v18 offset:32
ds_read_b64_tr_b16 a[10:11],v18 offset:160
ds_read_b64_tr_b16 a[12:13],v18 offset:4128
ds_read_b64_tr_b16 a[14:15],v18 offset:4256
ds_read_b64_tr_b16 a[16:17],v18 offset:64
ds_read_b64_tr_b16 a[18:19],v18 offset:192
ds_read_b64_tr_b16 a[20:21],v18 offset:4160
ds_read_b64_tr_b16 a[22:23],v18 offset:4288
ds_read_b64_tr_b16 a[24:25],v18 offset:96
ds_read_b64_tr_b16 a[26:27],v18 offset:224
ds_read_b64_tr_b16 a[28:29],v18 offset:4192
ds_read_b64_tr_b16 a[30:31],v18 offset:4320
s_waitcnt lgkmcnt(0)
ds_read_b64_tr_b16 a[64:65],v18 offset:8192
ds_read_b64_tr_b16 a[66:67],v18 offset:8320
ds_read_b64_tr_b16 a[68:69],v18 offset:12288
ds_read_b64_tr_b16 a[70:71],v18 offset:12416
ds_read_b64_tr_b16 a[72:73],v18 offset:8224
ds_read_b64_tr_b16 a[74:75],v18 offset:8352
ds_read_b64_tr_b16 a[76:77],v18 offset:12320
ds_read_b64_tr_b16 a[78:79],v18 offset:12448
ds_read_b64_tr_b16 a[80:81],v18 offset:8256
ds_read_b64_tr_b16 a[82:83],v18 offset:8384
ds_read_b64_tr_b16 a[84:85],v18 offset:12352
ds_read_b64_tr_b16 a[86:87],v18 offset:12480
ds_read_b64_tr_b16 a[88:89],v18 offset:8288
ds_read_b64_tr_b16 a[90:91],v18 offset:8416
ds_read_b64_tr_b16 a[92:93],v18 offset:12384
ds_read_b64_tr_b16 a[94:95],v18 offset:12512
s_waitcnt lgkmcnt(0)
s_add_u32 s64,s62,0
s_add_u32 m0,s61,0
s_nop 0
buffer_load_dwordx4 v16,s[32:35],s64 offen lds
s_waitcnt vmcnt(10)
s_add_u32 s64,s62,65536
s_add_u32 m0,s61,1024
s_nop 0
buffer_load_dwordx4 v16,s[32:35],s64 offen lds
s_add_u32 s64,s68,1048576
buffer_load_dword v31,v29,s[32:35],s64 offen
s_waitcnt vmcnt(10)
s_add_u32 s64,s62,131072
s_add_u32 m0,s61,2048
s_nop 0
buffer_load_dwordx4 v16,s[32:35],s64 offen lds
s_waitcnt vmcnt(10)
s_add_u32 s64,s62,196608
s_add_u32 m0,s61,3072
s_nop 0
buffer_load_dwordx4 v16,s[32:35],s64 offen lds
s_waitcnt vmcnt(10)
s_add_u32 s64,s62,262144
s_add_u32 m0,s61,4096
s_nop 0
buffer_load_dwordx4 v16,s[32:35],s64 offen lds
s_waitcnt vmcnt(10)
s_add_u32 s64,s62,327680
s_add_u32 m0,s61,5120
s_nop 0
buffer_load_dwordx4 v16,s[32:35],s64 offen lds
s_add_u32 s64,s68,1310720
buffer_load_dword v31,v29,s[32:35],s64 offen
s_waitcnt vmcnt(10)
s_add_u32 s64,s62,393216
s_add_u32 m0,s61,6144
s_nop 0
buffer_load_dwordx4 v16,s[32:35],s64 offen lds
s_waitcnt vmcnt(10)
s_add_u32 s64,s62,458752
s_add_u32 m0,s61,7168
s_nop 0
buffer_load_dwordx4 v16,s[32:35],s64 offen lds
s_waitcnt vmcnt(10)
s_add_u32 s64,s62,524288
s_add_u32 m0,s61,8192
s_nop 0
buffer_load_dwordx4 v16,s[32:35],s64 offen lds
s_waitcnt vmcnt(10)
s_add_u32 s64,s62,589824
s_add_u32 m0,s61,9216
s_nop 0
buffer_load_dwordx4 v16,s[32:35],s64 offen lds
s_add_u32 s64,s68,1572864
buffer_load_dword v31,v29,s[32:35],s64 offen
s_waitcnt vmcnt(10)
s_add_u32 s64,s62,655360
s_add_u32 m0,s61,10240
s_nop 0
buffer_load_dwordx4 v16,s[32:35],s64 offen lds
s_waitcnt vmcnt(10)
s_add_u32 s64,s62,720896
s_add_u32 m0,s61,11264
s_nop 0
buffer_load_dwordx4 v16,s[32:35],s64 offen lds
s_waitcnt vmcnt(10)
s_add_u32 s64,s62,786432
s_add_u32 m0,s61,12288
s_nop 0
buffer_load_dwordx4 v16,s[32:35],s64 offen lds
s_waitcnt vmcnt(10)
s_add_u32 s64,s62,851968
s_add_u32 m0,s61,13312
s_nop 0
buffer_load_dwordx4 v16,s[32:35],s64 offen lds
s_add_u32 s64,s68,1835008
buffer_load_dword v31,v29,s[32:35],s64 offen
s_waitcnt vmcnt(10)
s_add_u32 s64,s62,917504
s_add_u32 m0,s61,14336
s_nop 0
buffer_load_dwordx4 v16,s[32:35],s64 offen lds
s_waitcnt vmcnt(10)
s_add_u32 s64,s62,983040
s_add_u32 m0,s61,15360
s_nop 0
buffer_load_dwordx4 v16,s[32:35],s64 offen lds
s_waitcnt vmcnt(20)
ds_read_b64_tr_b16 a[128:129],v18 offset:16384
ds_read_b64_tr_b16 a[130:131],v18 offset:16512
ds_read_b64_tr_b16 a[132:133],v18 offset:20480
ds_read_b64_tr_b16 a[134:135],v18 offset:20608
ds_read_b64_tr_b16 a[136:137],v18 offset:16416
ds_read_b64_tr_b16 a[138:139],v18 offset:16544
ds_read_b64_tr_b16 a[140:141],v18 offset:20512
ds_read_b64_tr_b16 a[142:143],v18 offset:20640
ds_read_b64_tr_b16 a[144:145],v18 offset:16448
ds_read_b64_tr_b16 a[146:147],v18 offset:16576
ds_read_b64_tr_b16 a[148:149],v18 offset:20544
ds_read_b64_tr_b16 a[150:151],v18 offset:20672
ds_read_b64_tr_b16 a[152:153],v18 offset:16480
ds_read_b64_tr_b16 a[154:155],v18 offset:16608
ds_read_b64_tr_b16 a[156:157],v18 offset:20576
ds_read_b64_tr_b16 a[158:159],v18 offset:20704
s_waitcnt lgkmcnt(0)
ds_read_b64_tr_b16 a[192:193],v18 offset:24576
ds_read_b64_tr_b16 a[194:195],v18 offset:24704
ds_read_b64_tr_b16 a[196:197],v18 offset:28672
ds_read_b64_tr_b16 a[198:199],v18 offset:28800
ds_read_b64_tr_b16 a[200:201],v18 offset:24608
ds_read_b64_tr_b16 a[202:203],v18 offset:24736
ds_read_b64_tr_b16 a[204:205],v18 offset:28704
ds_read_b64_tr_b16 a[206:207],v18 offset:28832
ds_read_b64_tr_b16 a[208:209],v18 offset:24640
ds_read_b64_tr_b16 a[210:211],v18 offset:24768
ds_read_b64_tr_b16 a[212:213],v18 offset:28736
ds_read_b64_tr_b16 a[214:215],v18 offset:28864
ds_read_b64_tr_b16 a[216:217],v18 offset:24672
ds_read_b64_tr_b16 a[218:219],v18 offset:24800
ds_read_b64_tr_b16 a[220:221],v18 offset:28768
ds_read_b64_tr_b16 a[222:223],v18 offset:28896
s_waitcnt lgkmcnt(0)
s_add_u32 s64,s62,1048576
s_add_u32 m0,s61,16384
s_nop 0
buffer_load_dwordx4 v16,s[32:35],s64 offen lds
s_waitcnt vmcnt(10)
s_add_u32 s64,s62,1114112
s_add_u32 m0,s61,17408
s_nop 0
buffer_load_dwordx4 v16,s[32:35],s64 offen lds
s_add_u32 s64,s69,0
buffer_load_dword v31,v30,s[40:43],s64 offen
s_waitcnt vmcnt(10)
s_add_u32 s64,s62,1179648
s_add_u32 m0,s61,18432
s_nop 0
buffer_load_dwordx4 v16,s[32:35],s64 offen lds
s_waitcnt vmcnt(10)
s_add_u32 s64,s62,1245184
s_add_u32 m0,s61,19456
s_nop 0
buffer_load_dwordx4 v16,s[32:35],s64 offen lds
s_waitcnt vmcnt(10)
s_add_u32 s64,s62,1310720
s_add_u32 m0,s61,20480
s_nop 0
buffer_load_dwordx4 v16,s[32:35],s64 offen lds
s_waitcnt vmcnt(10)
s_add_u32 s64,s62,1376256
s_add_u32 m0,s61,21504
s_nop 0
buffer_load_dwordx4 v16,s[32:35],s64 offen lds
s_add_u32 s64,s69,131072
buffer_load_dword v31,v30,s[40:43],s64 offen
s_waitcnt vmcnt(10)
s_add_u32 s64,s62,1441792
s_add_u32 m0,s61,22528
s_nop 0
buffer_load_dwordx4 v16,s[32:35],s64 offen lds
s_waitcnt vmcnt(10)
s_add_u32 s64,s62,1507328
s_add_u32 m0,s61,23552
s_nop 0
buffer_load_dwordx4 v16,s[32:35],s64 offen lds
s_waitcnt vmcnt(10)
s_add_u32 s64,s62,1572864
s_add_u32 m0,s61,24576
s_nop 0
buffer_load_dwordx4 v16,s[32:35],s64 offen lds
s_waitcnt vmcnt(10)
s_add_u32 s64,s62,1638400
s_add_u32 m0,s61,25600
s_nop 0
buffer_load_dwordx4 v16,s[32:35],s64 offen lds
s_add_u32 s64,s69,262144
buffer_load_dword v31,v30,s[40:43],s64 offen
s_waitcnt vmcnt(10)
s_add_u32 s64,s62,1703936
s_add_u32 m0,s61,26624
s_nop 0
buffer_load_dwordx4 v16,s[32:35],s64 offen lds
s_waitcnt vmcnt(10)
s_add_u32 s64,s62,1769472
s_add_u32 m0,s61,27648
s_nop 0
buffer_load_dwordx4 v16,s[32:35],s64 offen lds
s_waitcnt vmcnt(10)
s_add_u32 s64,s62,1835008
s_add_u32 m0,s61,28672
s_nop 0
buffer_load_dwordx4 v16,s[32:35],s64 offen lds
s_waitcnt vmcnt(10)
s_add_u32 s64,s62,1900544
s_add_u32 m0,s61,29696
s_nop 0
buffer_load_dwordx4 v16,s[32:35],s64 offen lds
s_add_u32 s64,s69,393216
buffer_load_dword v31,v30,s[40:43],s64 offen
s_waitcnt vmcnt(10)
s_add_u32 s64,s62,1966080
s_add_u32 m0,s61,30720
s_nop 0
buffer_load_dwordx4 v16,s[32:35],s64 offen lds
s_waitcnt vmcnt(10)
s_add_u32 s64,s62,2031616
s_add_u32 m0,s61,31744
s_nop 0
buffer_load_dwordx4 v16,s[32:35],s64 offen lds
s_waitcnt vmcnt(20)
ds_read_b64_tr_b16 a[32:33],v18 offset:0
ds_read_b64_tr_b16 a[34:35],v18 offset:128
ds_read_b64_tr_b16 a[36:37],v18 offset:4096
ds_read_b64_tr_b16 a[38:39],v18 offset:4224
ds_read_b64_tr_b16 a[40:41],v18 offset:32
ds_read_b64_tr_b16 a[42:43],v18 offset:160
ds_read_b64_tr_b16 a[44:45],v18 offset:4128
ds_read_b64_tr_b16 a[46:47],v18 offset:4256
ds_read_b64_tr_b16 a[48:49],v18 offset:64
ds_read_b64_tr_b16 a[50:51],v18 offset:192
ds_read_b64_tr_b16 a[52:53],v18 offset:4160
ds_read_b64_tr_b16 a[54:55],v18 offset:4288
ds_read_b64_tr_b16 a[56:57],v18 offset:96
ds_read_b64_tr_b16 a[58:59],v18 offset:224
ds_read_b64_tr_b16 a[60:61],v18 offset:4192
ds_read_b64_tr_b16 a[62:63],v18 offset:4320
s_waitcnt lgkmcnt(0)
ds_read_b64_tr_b16 a[96:97],v18 offset:8192
ds_read_b64_tr_b16 a[98:99],v18 offset:8320
ds_read_b64_tr_b16 a[100:101],v18 offset:12288
ds_read_b64_tr_b16 a[102:103],v18 offset:12416
ds_read_b64_tr_b16 a[104:105],v18 offset:8224
ds_read_b64_tr_b16 a[106:107],v18 offset:8352
ds_read_b64_tr_b16 a[108:109],v18 offset:12320
ds_read_b64_tr_b16 a[110:111],v18 offset:12448
ds_read_b64_tr_b16 a[112:113],v18 offset:8256
ds_read_b64_tr_b16 a[114:115],v18 offset:8384
ds_read_b64_tr_b16 a[116:117],v18 offset:12352
ds_read_b64_tr_b16 a[118:119],v18 offset:12480
ds_read_b64_tr_b16 a[120:121],v18 offset:8288
ds_read_b64_tr_b16 a[122:123],v18 offset:8416
ds_read_b64_tr_b16 a[124:125],v18 offset:12384
ds_read_b64_tr_b16 a[126:127],v18 offset:12512
s_waitcnt lgkmcnt(0)
s_add_u32 s64,s70,0
s_add_u32 m0,s72,0
s_nop 0
buffer_load_dwordx4 v17,s[40:43],s64 offen lds
s_waitcnt vmcnt(10)
s_add_u32 s64,s70,32768
s_add_u32 m0,s72,1024
s_nop 0
buffer_load_dwordx4 v17,s[40:43],s64 offen lds
s_add_u32 s64,s69,524288
buffer_load_dword v31,v30,s[40:43],s64 offen
s_waitcnt vmcnt(10)
s_add_u32 s64,s70,65536
s_add_u32 m0,s72,2048
s_nop 0
buffer_load_dwordx4 v17,s[40:43],s64 offen lds
s_waitcnt vmcnt(10)
s_add_u32 s64,s70,98304
s_add_u32 m0,s72,3072
s_nop 0
buffer_load_dwordx4 v17,s[40:43],s64 offen lds
s_waitcnt vmcnt(10)
s_add_u32 s64,s70,131072
s_add_u32 m0,s72,4096
s_nop 0
buffer_load_dwordx4 v17,s[40:43],s64 offen lds
s_waitcnt vmcnt(10)
s_add_u32 s64,s70,163840
s_add_u32 m0,s72,5120
s_nop 0
buffer_load_dwordx4 v17,s[40:43],s64 offen lds
s_add_u32 s64,s69,655360
buffer_load_dword v31,v30,s[40:43],s64 offen
s_waitcnt vmcnt(10)
s_add_u32 s64,s70,196608
s_add_u32 m0,s72,6144
s_nop 0
buffer_load_dwordx4 v17,s[40:43],s64 offen lds
s_waitcnt vmcnt(10)
s_add_u32 s64,s70,229376
s_add_u32 m0,s72,7168
s_nop 0
buffer_load_dwordx4 v17,s[40:43],s64 offen lds
s_waitcnt vmcnt(10)
s_add_u32 s64,s71,262144
s_add_u32 m0,s73,8192
s_nop 0
buffer_load_dwordx4 v17,s[40:43],s64 offen lds
s_waitcnt vmcnt(10)
s_add_u32 s64,s71,294912
s_add_u32 m0,s73,9216
s_nop 0
buffer_load_dwordx4 v17,s[40:43],s64 offen lds
s_add_u32 s64,s69,786432
buffer_load_dword v31,v30,s[40:43],s64 offen
s_waitcnt vmcnt(10)
s_add_u32 s64,s71,327680
s_add_u32 m0,s73,10240
s_nop 0
buffer_load_dwordx4 v17,s[40:43],s64 offen lds
s_waitcnt vmcnt(10)
s_add_u32 s64,s71,360448
s_add_u32 m0,s73,11264
s_nop 0
buffer_load_dwordx4 v17,s[40:43],s64 offen lds
s_waitcnt vmcnt(10)
s_add_u32 s64,s71,393216
s_add_u32 m0,s73,12288
s_nop 0
buffer_load_dwordx4 v17,s[40:43],s64 offen lds
s_waitcnt vmcnt(10)
s_add_u32 s64,s71,425984
s_add_u32 m0,s73,13312
s_nop 0
buffer_load_dwordx4 v17,s[40:43],s64 offen lds
s_add_u32 s64,s69,917504
buffer_load_dword v31,v30,s[40:43],s64 offen
s_waitcnt vmcnt(10)
s_add_u32 s64,s71,458752
s_add_u32 m0,s73,14336
s_nop 0
buffer_load_dwordx4 v17,s[40:43],s64 offen lds
s_waitcnt vmcnt(10)
s_add_u32 s64,s71,491520
s_add_u32 m0,s73,15360
s_nop 0
buffer_load_dwordx4 v17,s[40:43],s64 offen lds
s_waitcnt vmcnt(20)
ds_read_b64_tr_b16 a[160:161],v18 offset:16384
ds_read_b64_tr_b16 a[162:163],v18 offset:16512
ds_read_b64_tr_b16 a[164:165],v18 offset:20480
ds_read_b64_tr_b16 a[166:167],v18 offset:20608
ds_read_b64_tr_b16 a[168:169],v18 offset:16416
ds_read_b64_tr_b16 a[170:171],v18 offset:16544
ds_read_b64_tr_b16 a[172:173],v18 offset:20512
ds_read_b64_tr_b16 a[174:175],v18 offset:20640
ds_read_b64_tr_b16 a[176:177],v18 offset:16448
ds_read_b64_tr_b16 a[178:179],v18 offset:16576
ds_read_b64_tr_b16 a[180:181],v18 offset:20544
ds_read_b64_tr_b16 a[182:183],v18 offset:20672
ds_read_b64_tr_b16 a[184:185],v18 offset:16480
ds_read_b64_tr_b16 a[186:187],v18 offset:16608
ds_read_b64_tr_b16 a[188:189],v18 offset:20576
ds_read_b64_tr_b16 a[190:191],v18 offset:20704
s_waitcnt lgkmcnt(0)
ds_read_b64_tr_b16 a[224:225],v18 offset:24576
ds_read_b64_tr_b16 a[226:227],v18 offset:24704
ds_read_b64_tr_b16 a[228:229],v18 offset:28672
ds_read_b64_tr_b16 a[230:231],v18 offset:28800
ds_read_b64_tr_b16 a[232:233],v18 offset:24608
ds_read_b64_tr_b16 a[234:235],v18 offset:24736
ds_read_b64_tr_b16 a[236:237],v18 offset:28704
ds_read_b64_tr_b16 a[238:239],v18 offset:28832
ds_read_b64_tr_b16 a[240:241],v18 offset:24640
ds_read_b64_tr_b16 a[242:243],v18 offset:24768
ds_read_b64_tr_b16 a[244:245],v18 offset:28736
ds_read_b64_tr_b16 a[246:247],v18 offset:28864
ds_read_b64_tr_b16 a[248:249],v18 offset:24672
ds_read_b64_tr_b16 a[250:251],v18 offset:24800
ds_read_b64_tr_b16 a[252:253],v18 offset:28768
ds_read_b64_tr_b16 a[254:255],v18 offset:28896
s_waitcnt lgkmcnt(0)
s_add_u32 s64,s70,524288
s_add_u32 m0,s72,16384
s_nop 0
buffer_load_dwordx4 v17,s[40:43],s64 offen lds
s_waitcnt vmcnt(10)
s_add_u32 s64,s70,557056
s_add_u32 m0,s72,17408
s_nop 0
buffer_load_dwordx4 v17,s[40:43],s64 offen lds
s_add_u32 s64,s68,0
buffer_load_dword v31,v29,s[36:39],s64 offen
s_waitcnt vmcnt(10)
s_add_u32 s64,s70,589824
s_add_u32 m0,s72,18432
s_nop 0
buffer_load_dwordx4 v17,s[40:43],s64 offen lds
s_waitcnt vmcnt(10)
s_add_u32 s64,s70,622592
s_add_u32 m0,s72,19456
s_nop 0
buffer_load_dwordx4 v17,s[40:43],s64 offen lds
s_waitcnt vmcnt(10)
s_add_u32 s64,s70,655360
s_add_u32 m0,s72,20480
s_nop 0
buffer_load_dwordx4 v17,s[40:43],s64 offen lds
s_waitcnt vmcnt(10)
s_add_u32 s64,s70,688128
s_add_u32 m0,s72,21504
s_nop 0
buffer_load_dwordx4 v17,s[40:43],s64 offen lds
s_add_u32 s64,s68,262144
buffer_load_dword v31,v29,s[36:39],s64 offen
s_waitcnt vmcnt(10)
s_add_u32 s64,s70,720896
s_add_u32 m0,s72,22528
s_nop 0
buffer_load_dwordx4 v17,s[40:43],s64 offen lds
s_waitcnt vmcnt(10)
s_add_u32 s64,s70,753664
s_add_u32 m0,s72,23552
s_nop 0
buffer_load_dwordx4 v17,s[40:43],s64 offen lds
s_waitcnt vmcnt(10)
s_add_u32 s64,s71,786432
s_add_u32 m0,s73,24576
s_nop 0
buffer_load_dwordx4 v17,s[40:43],s64 offen lds
s_waitcnt vmcnt(10)
s_add_u32 s64,s71,819200
s_add_u32 m0,s73,25600
s_nop 0
buffer_load_dwordx4 v17,s[40:43],s64 offen lds
s_add_u32 s64,s68,524288
buffer_load_dword v31,v29,s[36:39],s64 offen
s_waitcnt vmcnt(10)
s_add_u32 s64,s71,851968
s_add_u32 m0,s73,26624
s_nop 0
buffer_load_dwordx4 v17,s[40:43],s64 offen lds
s_waitcnt vmcnt(10)
s_add_u32 s64,s71,884736
s_add_u32 m0,s73,27648
s_nop 0
buffer_load_dwordx4 v17,s[40:43],s64 offen lds
s_waitcnt vmcnt(10)
s_add_u32 s64,s71,917504
s_add_u32 m0,s73,28672
s_nop 0
buffer_load_dwordx4 v17,s[40:43],s64 offen lds
s_waitcnt vmcnt(10)
s_add_u32 s64,s71,950272
s_add_u32 m0,s73,29696
s_nop 0
buffer_load_dwordx4 v17,s[40:43],s64 offen lds
s_add_u32 s64,s68,786432
buffer_load_dword v31,v29,s[36:39],s64 offen
s_waitcnt vmcnt(10)
s_add_u32 s64,s71,983040
s_add_u32 m0,s73,30720
s_nop 0
buffer_load_dwordx4 v17,s[40:43],s64 offen lds
s_waitcnt vmcnt(10)
s_add_u32 s64,s71,1015808
s_add_u32 m0,s73,31744
s_nop 0
buffer_load_dwordx4 v17,s[40:43],s64 offen lds
s_waitcnt vmcnt(20)
ds_read_b64_tr_b16 v[48:49],v27 offset:0
ds_read_b64_tr_b16 v[50:51],v27 offset:128
ds_read_b64_tr_b16 v[52:53],v27 offset:2048
ds_read_b64_tr_b16 v[54:55],v27 offset:2176
ds_read_b64_tr_b16 v[56:57],v27 offset:32
ds_read_b64_tr_b16 v[58:59],v27 offset:160
ds_read_b64_tr_b16 v[60:61],v27 offset:2080
ds_read_b64_tr_b16 v[62:63],v27 offset:2208
ds_read_b64_tr_b16 v[64:65],v27 offset:4096
ds_read_b64_tr_b16 v[66:67],v27 offset:4224
ds_read_b64_tr_b16 v[68:69],v27 offset:6144
ds_read_b64_tr_b16 v[70:71],v27 offset:6272
ds_read_b64_tr_b16 v[72:73],v27 offset:4128
ds_read_b64_tr_b16 v[74:75],v27 offset:4256
ds_read_b64_tr_b16 v[76:77],v27 offset:6176
ds_read_b64_tr_b16 v[78:79],v27 offset:6304
s_waitcnt lgkmcnt(0)
ds_read_b64_tr_b16 v[80:81],v27 offset:8192
ds_read_b64_tr_b16 v[82:83],v27 offset:8320
ds_read_b64_tr_b16 v[84:85],v27 offset:10240
ds_read_b64_tr_b16 v[86:87],v27 offset:10368
ds_read_b64_tr_b16 v[88:89],v27 offset:8224
ds_read_b64_tr_b16 v[90:91],v27 offset:8352
ds_read_b64_tr_b16 v[92:93],v27 offset:10272
ds_read_b64_tr_b16 v[94:95],v27 offset:10400
ds_read_b64_tr_b16 v[128:129],v27 offset:12288
ds_read_b64_tr_b16 v[130:131],v27 offset:12416
ds_read_b64_tr_b16 v[132:133],v27 offset:14336
ds_read_b64_tr_b16 v[134:135],v27 offset:14464
ds_read_b64_tr_b16 v[136:137],v27 offset:12320
ds_read_b64_tr_b16 v[138:139],v27 offset:12448
ds_read_b64_tr_b16 v[140:141],v27 offset:14368
ds_read_b64_tr_b16 v[142:143],v27 offset:14496
s_waitcnt lgkmcnt(0)
s_add_u32 s64,s62,0
s_add_u32 m0,s61,0
s_nop 0
buffer_load_dwordx4 v16,s[36:39],s64 offen lds
s_waitcnt vmcnt(10)
s_add_u32 s64,s62,65536
s_add_u32 m0,s61,1024
s_nop 0
buffer_load_dwordx4 v16,s[36:39],s64 offen lds
s_add_u32 s64,s68,1048576
buffer_load_dword v31,v29,s[36:39],s64 offen
s_waitcnt vmcnt(10)
s_add_u32 s64,s62,131072
s_add_u32 m0,s61,2048
s_nop 0
buffer_load_dwordx4 v16,s[36:39],s64 offen lds
s_waitcnt vmcnt(10)
s_add_u32 s64,s62,196608
s_add_u32 m0,s61,3072
s_nop 0
buffer_load_dwordx4 v16,s[36:39],s64 offen lds
s_waitcnt vmcnt(10)
s_add_u32 s64,s62,262144
s_add_u32 m0,s61,4096
s_nop 0
buffer_load_dwordx4 v16,s[36:39],s64 offen lds
s_waitcnt vmcnt(10)
s_add_u32 s64,s62,327680
s_add_u32 m0,s61,5120
s_nop 0
buffer_load_dwordx4 v16,s[36:39],s64 offen lds
s_add_u32 s64,s68,1310720
buffer_load_dword v31,v29,s[36:39],s64 offen
s_waitcnt vmcnt(10)
s_add_u32 s64,s62,393216
s_add_u32 m0,s61,6144
s_nop 0
buffer_load_dwordx4 v16,s[36:39],s64 offen lds
s_waitcnt vmcnt(10)
s_add_u32 s64,s62,458752
s_add_u32 m0,s61,7168
s_nop 0
buffer_load_dwordx4 v16,s[36:39],s64 offen lds
s_waitcnt vmcnt(10)
s_add_u32 s64,s62,524288
s_add_u32 m0,s61,8192
s_nop 0
buffer_load_dwordx4 v16,s[36:39],s64 offen lds
s_waitcnt vmcnt(10)
s_add_u32 s64,s62,589824
s_add_u32 m0,s61,9216
s_nop 0
buffer_load_dwordx4 v16,s[36:39],s64 offen lds
s_add_u32 s64,s68,1572864
buffer_load_dword v31,v29,s[36:39],s64 offen
s_waitcnt vmcnt(10)
s_add_u32 s64,s62,655360
s_add_u32 m0,s61,10240
s_nop 0
buffer_load_dwordx4 v16,s[36:39],s64 offen lds
s_waitcnt vmcnt(10)
s_add_u32 s64,s62,720896
s_add_u32 m0,s61,11264
s_nop 0
buffer_load_dwordx4 v16,s[36:39],s64 offen lds
s_waitcnt vmcnt(10)
s_add_u32 s64,s62,786432
s_add_u32 m0,s61,12288
s_nop 0
buffer_load_dwordx4 v16,s[36:39],s64 offen lds
s_waitcnt vmcnt(10)
s_add_u32 s64,s62,851968
s_add_u32 m0,s61,13312
s_nop 0
buffer_load_dwordx4 v16,s[36:39],s64 offen lds
s_add_u32 s64,s68,1835008
buffer_load_dword v31,v29,s[36:39],s64 offen
s_waitcnt vmcnt(10)
s_add_u32 s64,s62,917504
s_add_u32 m0,s61,14336
s_nop 0
buffer_load_dwordx4 v16,s[36:39],s64 offen lds
s_waitcnt vmcnt(10)
s_add_u32 s64,s62,983040
s_add_u32 m0,s61,15360
s_nop 0
buffer_load_dwordx4 v16,s[36:39],s64 offen lds
s_waitcnt vmcnt(20)
ds_read_b64_tr_b16 v[144:145],v27 offset:16384
ds_read_b64_tr_b16 v[146:147],v27 offset:16512
ds_read_b64_tr_b16 v[148:149],v27 offset:18432
ds_read_b64_tr_b16 v[150:151],v27 offset:18560
ds_read_b64_tr_b16 v[152:153],v27 offset:16416
ds_read_b64_tr_b16 v[154:155],v27 offset:16544
ds_read_b64_tr_b16 v[156:157],v27 offset:18464
ds_read_b64_tr_b16 v[158:159],v27 offset:18592
ds_read_b64_tr_b16 v[160:161],v27 offset:20480
ds_read_b64_tr_b16 v[162:163],v27 offset:20608
ds_read_b64_tr_b16 v[164:165],v27 offset:22528
ds_read_b64_tr_b16 v[166:167],v27 offset:22656
ds_read_b64_tr_b16 v[168:169],v27 offset:20512
ds_read_b64_tr_b16 v[170:171],v27 offset:20640
ds_read_b64_tr_b16 v[172:173],v27 offset:22560
ds_read_b64_tr_b16 v[174:175],v27 offset:22688
s_waitcnt lgkmcnt(0)
ds_read_b64_tr_b16 v[176:177],v27 offset:24576
ds_read_b64_tr_b16 v[178:179],v27 offset:24704
ds_read_b64_tr_b16 v[180:181],v27 offset:26624
ds_read_b64_tr_b16 v[182:183],v27 offset:26752
ds_read_b64_tr_b16 v[184:185],v27 offset:24608
ds_read_b64_tr_b16 v[186:187],v27 offset:24736
ds_read_b64_tr_b16 v[188:189],v27 offset:26656
ds_read_b64_tr_b16 v[190:191],v27 offset:26784
ds_read_b64_tr_b16 v[192:193],v27 offset:28672
ds_read_b64_tr_b16 v[194:195],v27 offset:28800
ds_read_b64_tr_b16 v[196:197],v27 offset:30720
ds_read_b64_tr_b16 v[198:199],v27 offset:30848
ds_read_b64_tr_b16 v[200:201],v27 offset:28704
ds_read_b64_tr_b16 v[202:203],v27 offset:28832
ds_read_b64_tr_b16 v[204:205],v27 offset:30752
ds_read_b64_tr_b16 v[206:207],v27 offset:30880
s_waitcnt lgkmcnt(0)
s_add_u32 s64,s62,1048576
s_add_u32 m0,s61,16384
s_nop 0
buffer_load_dwordx4 v16,s[36:39],s64 offen lds
s_waitcnt vmcnt(10)
s_add_u32 s64,s62,1114112
s_add_u32 m0,s61,17408
s_nop 0
buffer_load_dwordx4 v16,s[36:39],s64 offen lds
s_waitcnt vmcnt(10)
s_add_u32 s64,s62,1179648
s_add_u32 m0,s61,18432
s_nop 0
buffer_load_dwordx4 v16,s[36:39],s64 offen lds
s_waitcnt vmcnt(10)
s_add_u32 s64,s62,1245184
s_add_u32 m0,s61,19456
s_nop 0
buffer_load_dwordx4 v16,s[36:39],s64 offen lds
s_waitcnt vmcnt(10)
s_add_u32 s64,s62,1310720
s_add_u32 m0,s61,20480
s_nop 0
buffer_load_dwordx4 v16,s[36:39],s64 offen lds
s_waitcnt vmcnt(10)
s_add_u32 s64,s62,1376256
s_add_u32 m0,s61,21504
s_nop 0
buffer_load_dwordx4 v16,s[36:39],s64 offen lds
s_waitcnt vmcnt(10)
s_add_u32 s64,s62,1441792
s_add_u32 m0,s61,22528
s_nop 0
buffer_load_dwordx4 v16,s[36:39],s64 offen lds
s_waitcnt vmcnt(10)
s_add_u32 s64,s62,1507328
s_add_u32 m0,s61,23552
s_nop 0
buffer_load_dwordx4 v16,s[36:39],s64 offen lds
s_waitcnt vmcnt(10)
s_add_u32 s64,s62,1572864
s_add_u32 m0,s61,24576
s_nop 0
buffer_load_dwordx4 v16,s[36:39],s64 offen lds
s_waitcnt vmcnt(10)
s_add_u32 s64,s62,1638400
s_add_u32 m0,s61,25600
s_nop 0
buffer_load_dwordx4 v16,s[36:39],s64 offen lds
s_waitcnt vmcnt(10)
s_add_u32 s64,s62,1703936
s_add_u32 m0,s61,26624
s_nop 0
buffer_load_dwordx4 v16,s[36:39],s64 offen lds
s_waitcnt vmcnt(10)
s_add_u32 s64,s62,1769472
s_add_u32 m0,s61,27648
s_nop 0
buffer_load_dwordx4 v16,s[36:39],s64 offen lds
s_waitcnt vmcnt(10)
s_add_u32 s64,s62,1835008
s_add_u32 m0,s61,28672
s_nop 0
buffer_load_dwordx4 v16,s[36:39],s64 offen lds
s_waitcnt vmcnt(10)
s_add_u32 s64,s62,1900544
s_add_u32 m0,s61,29696
s_nop 0
buffer_load_dwordx4 v16,s[36:39],s64 offen lds
s_waitcnt vmcnt(10)
s_add_u32 s64,s62,1966080
s_add_u32 m0,s61,30720
s_nop 0
buffer_load_dwordx4 v16,s[36:39],s64 offen lds
s_waitcnt vmcnt(10)
s_add_u32 s64,s62,2031616
s_add_u32 m0,s61,31744
s_nop 0
buffer_load_dwordx4 v16,s[36:39],s64 offen lds
s_waitcnt vmcnt(16)
ds_read_b64_tr_b16 v[208:209],v19 offset:0
ds_read_b64_tr_b16 v[210:211],v19 offset:128
ds_read_b64_tr_b16 v[212:213],v19 offset:4096
ds_read_b64_tr_b16 v[214:215],v19 offset:4224
ds_read_b64_tr_b16 v[216:217],v19 offset:8
ds_read_b64_tr_b16 v[218:219],v19 offset:136
ds_read_b64_tr_b16 v[220:221],v19 offset:4104
ds_read_b64_tr_b16 v[222:223],v19 offset:4232
ds_read_b64_tr_b16 v[224:225],v19 offset:64
ds_read_b64_tr_b16 v[226:227],v19 offset:192
ds_read_b64_tr_b16 v[228:229],v19 offset:4160
ds_read_b64_tr_b16 v[230:231],v19 offset:4288
ds_read_b64_tr_b16 v[232:233],v19 offset:72
ds_read_b64_tr_b16 v[234:235],v19 offset:200
ds_read_b64_tr_b16 v[236:237],v19 offset:4168
ds_read_b64_tr_b16 v[238:239],v19 offset:4296
s_waitcnt lgkmcnt(0)
ds_read_b64_tr_b16 v[240:241],v19 offset:8192
ds_read_b64_tr_b16 v[242:243],v19 offset:8320
ds_read_b64_tr_b16 v[244:245],v19 offset:12288
ds_read_b64_tr_b16 v[246:247],v19 offset:12416
ds_read_b64_tr_b16 v[248:249],v19 offset:8200
ds_read_b64_tr_b16 v[250:251],v19 offset:8328
ds_read_b64_tr_b16 v[252:253],v19 offset:12296
ds_read_b64_tr_b16 v[254:255],v19 offset:12424
ds_read_b64_tr_b16 v[96:97],v19 offset:8256
ds_read_b64_tr_b16 v[98:99],v19 offset:8384
ds_read_b64_tr_b16 v[100:101],v19 offset:12352
ds_read_b64_tr_b16 v[102:103],v19 offset:12480
ds_read_b64_tr_b16 v[104:105],v19 offset:8264
ds_read_b64_tr_b16 v[106:107],v19 offset:8392
ds_read_b64_tr_b16 v[108:109],v19 offset:12360
ds_read_b64_tr_b16 v[110:111],v19 offset:12488
s_waitcnt lgkmcnt(0)
s_waitcnt vmcnt(0)
ds_write_b128 v7,v[96:99] offset:0
ds_write_b128 v7,v[100:103] offset:1024
ds_write_b128 v7,v[104:107] offset:2048
ds_write_b128 v7,v[108:111] offset:3072
s_waitcnt lgkmcnt(0)
ds_read_b64_tr_b16 v[96:97],v19 offset:16384
ds_read_b64_tr_b16 v[98:99],v19 offset:16512
ds_read_b64_tr_b16 v[100:101],v19 offset:20480
ds_read_b64_tr_b16 v[102:103],v19 offset:20608
ds_read_b64_tr_b16 v[104:105],v19 offset:16392
ds_read_b64_tr_b16 v[106:107],v19 offset:16520
ds_read_b64_tr_b16 v[108:109],v19 offset:20488
ds_read_b64_tr_b16 v[110:111],v19 offset:20616
s_waitcnt lgkmcnt(0)
ds_write_b128 v7,v[96:99] offset:4096
ds_write_b128 v7,v[100:103] offset:5120
ds_write_b128 v7,v[104:107] offset:6144
ds_write_b128 v7,v[108:111] offset:7168
s_waitcnt lgkmcnt(0)
ds_read_b64_tr_b16 v[96:97],v19 offset:16448
ds_read_b64_tr_b16 v[98:99],v19 offset:16576
ds_read_b64_tr_b16 v[100:101],v19 offset:20544
ds_read_b64_tr_b16 v[102:103],v19 offset:20672
ds_read_b64_tr_b16 v[104:105],v19 offset:16456
ds_read_b64_tr_b16 v[106:107],v19 offset:16584
ds_read_b64_tr_b16 v[108:109],v19 offset:20552
ds_read_b64_tr_b16 v[110:111],v19 offset:20680
s_waitcnt lgkmcnt(0)
ds_write_b128 v7,v[96:99] offset:8192
ds_write_b128 v7,v[100:103] offset:9216
ds_write_b128 v7,v[104:107] offset:10240
ds_write_b128 v7,v[108:111] offset:11264
s_waitcnt lgkmcnt(0)
ds_read_b64_tr_b16 v[96:97],v19 offset:24576
ds_read_b64_tr_b16 v[98:99],v19 offset:24704
ds_read_b64_tr_b16 v[100:101],v19 offset:28672
ds_read_b64_tr_b16 v[102:103],v19 offset:28800
ds_read_b64_tr_b16 v[104:105],v19 offset:24584
ds_read_b64_tr_b16 v[106:107],v19 offset:24712
ds_read_b64_tr_b16 v[108:109],v19 offset:28680
ds_read_b64_tr_b16 v[110:111],v19 offset:28808
s_waitcnt lgkmcnt(0)
ds_write_b128 v7,v[96:99] offset:12288
ds_write_b128 v7,v[100:103] offset:13312
ds_write_b128 v7,v[104:107] offset:14336
ds_write_b128 v7,v[108:111] offset:15360
s_waitcnt lgkmcnt(0)
ds_read_b64_tr_b16 v[112:113],v19 offset:24640
ds_read_b64_tr_b16 v[114:115],v19 offset:24768
ds_read_b64_tr_b16 v[116:117],v19 offset:28736
ds_read_b64_tr_b16 v[118:119],v19 offset:28864
ds_read_b64_tr_b16 v[120:121],v19 offset:24648
ds_read_b64_tr_b16 v[122:123],v19 offset:24776
ds_read_b64_tr_b16 v[124:125],v19 offset:28744
ds_read_b64_tr_b16 v[126:127],v19 offset:28872
s_waitcnt lgkmcnt(0)
ds_write_b128 v7,v[112:115] offset:16384
ds_write_b128 v7,v[116:119] offset:17408
ds_write_b128 v7,v[120:123] offset:18432
ds_write_b128 v7,v[124:127] offset:19456
ds_write_b128 v7,v[48:51] offset:20480
ds_write_b128 v7,v[52:55] offset:21504
ds_write_b128 v7,v[56:59] offset:22528
ds_write_b128 v7,v[60:63] offset:23552
ds_write_b128 v7,v[64:67] offset:24576
ds_write_b128 v7,v[68:71] offset:25600
ds_write_b128 v7,v[72:75] offset:26624
ds_write_b128 v7,v[76:79] offset:27648
ds_write_b128 v7,v[80:83] offset:28672
ds_write_b128 v7,v[84:87] offset:29696
ds_write_b128 v7,v[88:91] offset:30720
ds_write_b128 v7,v[92:95] offset:31744
s_waitcnt lgkmcnt(0)
v_and_b32 v23,1,v21
v_mov_b32 v1,0x4444
v_mov_b32 v24,0xeeee
v_cmp_eq_u32 vcc,1,v23
s_nop 1
v_cndmask_b32 v1,v1,v24,vcc
v_lshlrev_b32 v23,1,v22
v_sub_u32 v23,v21,v23
v_mov_b32 v5,0
v_mov_b32 v24,0x3f80
v_cmp_eq_u32 vcc,0,v23
s_nop 1
v_cndmask_b32 v5,v5,v24,vcc
v_mov_b32 v24,0x3f800000
v_cmp_eq_u32 vcc,1,v23
s_nop 1
v_cndmask_b32 v5,v5,v24,vcc
s_and_b32 s64,s50,1
s_lshl_b32 s64,s64,11
v_lshl_add_u32 v127,v20,2,s64
v_and_b32 v23,7,v21
v_lshrrev_b32 v24,3,v21
v_lshlrev_b32 v25,8,v24
v_lshl_add_u32 v25,v22,6,v25
v_lshl_add_u32 v4,v23,2,v25
v_lshrrev_b32 v25,1,v22
v_lshl_add_u32 v25,v25,3,v23
v_lshlrev_b32 v25,5,v25
v_and_b32 v26,1,v22
v_lshl_add_u32 v6,v26,4,v25
v_lshl_add_u32 v27,v22,3,v23
v_lshlrev_b32 v27,4,v27
s_mov_b32 s80,0x3e0293ee
s_mov_b32 s81,0xfffffffe
s_mov_b32 s84,0x00ff00ff
s_mov_b32 s85,0x00ff00ff
s_mov_b32 s86,-1
s_mov_b32 s87,0
s_cmp_gt_u32 s50,1
s_cselect_b32 s82,0xff00ff00,-1
s_cselect_b32 s83,0xff00ff00,0
s_lshl_b32 m0,s50,8
s_cmp_gt_u32 s50,1
s_cbranch_scc1 w23_100405
v_lshl_add_u32 v2,v24,9,v27
v_lshrrev_b32 v25,1,v22
v_lshl_add_u32 v25,v25,3,v23
v_lshlrev_b32 v25,4,v25
v_lshl_add_u32 v26,v26,1,v24
v_lshl_add_u32 v3,v26,2,v25
v_add_u32 v3,1024 + 256,v3
v_cndmask_b32 v6,2.0,v6,s[84:85]
v_mov_b32 v8,0x3f803f80
v_mov_b32 v9,0x3f803f80
v_mov_b32 v10,0x3f803f80
v_mov_b32 v11,0x3f803f80
v_mov_b32 v12,0x3f803f80
v_mov_b32 v13,0
v_mov_b32 v14,0
v_mov_b32 v15,0
s_branch jn_100406
w23_100405:
s_sub_u32 s64,s50,2
s_mul_i32 s64,s64,4160
v_lshrrev_b32 v25,1,v22
v_mul_u32_u24 v25,2080,v25
v_and_b32 v28,1,v23
v_mul_u32_u24 v28,1040,v28
v_add_u32 v25,v25,v28
v_lshrrev_b32 v28,1,v23
v_lshl_add_u32 v25,v28,6,v25
v_lshl_add_u32 v25,v26,5,v25
v_mul_u32_u24 v28,8448,v24
v_add3_u32 v2,v25,v28,s64
v_cndmask_b32 v3,2.0,v27,s[84:85]
v_mov_b32 v8,-1
v_mov_b32 v9,-1
v_mov_b32 v10,-1
v_mov_b32 v11,-1
jn_100406:
s_mov_b32 s92,s2
s_and_b32 s93,s3,0xffff
s_mov_b32 s94,0x100
s_mov_b32 s95,0x20000
v_mbcnt_lo_u32_b32 v16,-1,0
v_mbcnt_hi_u32_b32 v16,-1,v16
v_mov_b32 v18,0
v_cmp_eq_u32 vcc,22,v16
s_nop 1
v_cndmask_b32 v18,v18,63,vcc
v_cmp_eq_u32 vcc,21,v16
s_nop 1
v_cndmask_b32 v18,v18,1,vcc
v_and_b32 v19,1,v16
v_cmp_eq_u32 vcc,1,v19
v_mov_b32 v19,8192
s_nop 0
v_cndmask_b32 v19,-1,v19,vcc
v_min_u32 v16,31,v16
v_lshlrev_b32 v16,2,v16
s_sub_u32 s66,s88,64
s_cmp_lg_u32 s50,0
s_cbranch_scc1 vot_100413
vpoll_100409:
buffer_load_dword v17,v16,s[92:95],s66 offen sc1
s_waitcnt vmcnt(0)
s_cmp_lg_u32 s56,2
s_cbranch_scc1 vck_100410
v_cmp_eq_u32 vcc,v17,v19
s_and_b32 s64,vcc_lo,0xffff
s_cmp_eq_u32 s64,65535
s_cbranch_scc1 vck_100410
s_mov_b32 s65,0
v_readlane_b32 s64,v17,1
s_lshr_b32 s64,s64,8
s_add_u32 s65,s65,s64
v_readlane_b32 s64,v17,3
s_lshr_b32 s64,s64,8
s_add_u32 s65,s65,s64
v_readlane_b32 s64,v17,5
s_lshr_b32 s64,s64,8
s_add_u32 s65,s65,s64
v_readlane_b32 s64,v17,7
s_lshr_b32 s64,s64,8
s_add_u32 s65,s65,s64
v_readlane_b32 s64,v17,9
s_lshr_b32 s64,s64,8
s_add_u32 s65,s65,s64
v_readlane_b32 s64,v17,11
s_lshr_b32 s64,s64,8
s_add_u32 s65,s65,s64
v_readlane_b32 s64,v17,13
s_lshr_b32 s64,s64,8
s_add_u32 s65,s65,s64
v_readlane_b32 s64,v17,15
s_lshr_b32 s64,s64,8
s_add_u32 s65,s65,s64
s_cmp_ge_u32 s65,256
s_cbranch_scc1 vok_100412
s_branch vrt_100411
vck_100410:
v_cmp_gt_u32 vcc,v18,v17
s_cbranch_vccz vok_100412
vrt_100411:
s_sleep 8
s_sub_u32 s90,s90,1
s_cmp_gt_i32 s90,0
s_cbranch_scc1 vpoll_100409
vok_100412:
ds_write_b32 v16,v17 offset:1792
s_waitcnt lgkmcnt(0)
vot_100413:
s_barrier
v_add_u32 v18,1792,v16
ds_read_b32 v17,v18
s_waitcnt lgkmcnt(0)
s_cmp_lg_u32 s56,2
s_cbranch_scc1 vfin_100414
v_cmp_eq_u32 vcc,v17,v19
s_and_b32 s64,vcc_lo,0xffff
s_cmp_eq_u32 s64,65535
s_cbranch_scc1 vfin_100414
s_mov_b32 s65,0
v_readlane_b32 s64,v17,1
s_lshr_b32 s64,s64,8
s_add_u32 s65,s65,s64
v_readlane_b32 s64,v17,3
s_lshr_b32 s64,s64,8
s_add_u32 s65,s65,s64
v_readlane_b32 s64,v17,5
s_lshr_b32 s64,s64,8
s_add_u32 s65,s65,s64
v_readlane_b32 s64,v17,7
s_lshr_b32 s64,s64,8
s_add_u32 s65,s65,s64
v_readlane_b32 s64,v17,9
s_lshr_b32 s64,s64,8
s_add_u32 s65,s65,s64
v_readlane_b32 s64,v17,11
s_lshr_b32 s64,s64,8
s_add_u32 s65,s65,s64
v_readlane_b32 s64,v17,13
s_lshr_b32 s64,s64,8
s_add_u32 s65,s65,s64
v_readlane_b32 s64,v17,15
s_lshr_b32 s64,s64,8
s_add_u32 s65,s65,s64
s_cmp_ge_u32 s65,256
s_cbranch_scc1 fl_fb
vfin_100414:
s_and_b32 s56,s56,1
s_mov_b32 s67,0
v_readlane_b32 s65,v17,21
s_and_b32 s65,s65,2
s_lshl_b32 s67,s65,12
s_lshl_b32 s64,s58,14
s_lshl_b32 s65,s50,12
s_add_u32 s70,s64,s65
s_add_u32 s70,s70,134217728
s_lshl_b32 s65,s59,9
s_add_u32 s71,s64,s65
s_add_u32 s71,s71,134217728
s_xor_b32 s64,s58,1
s_lshl_b32 s64,s64,15
s_lshr_b32 s65,s50,1
s_lshl_b32 s65,s65,14
s_add_u32 s64,s64,s65
s_and_b32 s65,s50,1
s_lshl_b32 s65,s65,12
s_add_u32 s64,s64,s65
s_add_u32 s72,s64,s67
s_add_u32 s72,s72,142606336
s_lshl_b32 s64,s58,15
s_lshr_b32 s65,s59,4
s_lshl_b32 s65,s65,14
s_add_u32 s64,s64,s65
s_and_b32 s65,s59,15
s_lshl_b32 s65,s65,9
s_add_u32 s64,s64,s65
s_add_u32 s73,s64,s67
s_add_u32 s73,s73,142606336
s_cmp_eq_u32 s50,1
s_cselect_b32 s54,2048 - 256,0
s_sub_u32 s71,s71,s54
s_lshl_b32 s64,s58,15
s_lshl_b32 s65,s50,13
s_add_u32 s74,s64,s65
s_add_u32 s74,s74,134250496
s_lshl_b32 s64,s57,10
s_and_b32 s65,s50,1
s_lshl_b32 s65,s65,9
s_cmp_gt_u32 s50,1
s_cselect_b32 s65,0,s65
s_add_u32 s75,s64,s65
s_add_u32 s75,s75,134250496
s_lshl_b32 s64,s57,12
s_and_b32 s65,s64,0xffffe000
s_cmp_eq_u32 s50,3
s_cselect_b32 s66,1536,0
s_add_u32 s64,s64,s66
s_cmp_gt_u32 s50,1
s_cselect_b32 s76,s64,s65
s_add_u32 s76,s76,134479872
s_lshl_b32 s64,s57,14
s_and_b32 s65,s50,1
s_lshl_b32 s66,s65,11
s_add_u32 s77,s64,s66
s_cmp_gt_u32 s50,1
s_cselect_b32 s66,0,4096
s_add_u32 s77,s77,s66
s_add_u32 s77,s77,0
s_lshl_b32 s66,s65,9
s_add_u32 s66,s66,1024 + 128
s_lshl_b32 s65,s65,7
s_cmp_gt_u32 s50,1
s_cselect_b32 s65,s65,s66
s_add_u32 s78,s64,s65
s_add_u32 s78,s78,67108736
s_lshl_b32 s64,s57,6
s_add_u32 s68,s64,s67
s_add_u32 s69,s68,s64
s_add_u32 s69,s69,138428416
s_lshl_b32 s64,s50,14
s_add_u32 s69,s69,s64
s_and_b32 s64,s50,1
s_lshl_b32 s64,s64,11
s_sub_u32 s69,s69,s64
s_add_u32 s68,s68,138412032
s_mov_b32 s79,0
s_mov_b32 s91,0
s_mov_b32 s90,100000
s_barrier
s_cmp_eq_u32 s56,1
s_cbranch_scc1 recslow_100407
v_lshrrev_b32 v124,4,v0
s_lshl_b32 s64,s58,14
s_lshl_b32 s65,s59,9
s_add_u32 s64,s64,s65
s_add_u32 s64,s64,134217728
s_lshl_b32 s65,s57,10
s_add_u32 s65,s65,134249984
s_lshl_b32 s66,s57,12
s_add_u32 s66,s66,134478336
v_mov_b32 v16,s66
v_mov_b32 v17,s65
v_cmp_gt_u32 vcc,12,v124
s_nop 1
v_cndmask_b32 v16,v16,v17,vcc
v_mov_b32 v17,s64
v_cmp_gt_u32 vcc,4,v124
s_nop 1
v_cndmask_b32 v16,v16,v17,vcc
v_lshl_add_u32 v16,v124,7,v16
v_cmp_gt_u32 vcc,36,v124
s_nop 1
v_cndmask_b32 v16,2.0,v16,vcc
s_lshl_b32 s64,s50,19
buffer_load_dword v17,v16,s[20:23],s64 offen
s_mov_b32 s55,0
s_cmp_lg_u32 s50,0
s_cbranch_scc1 np0_100417
v_mov_b32 v120,0
v_mov_b32 v121,0
s_cmp_lg_u32 s58,0
s_cbranch_scc1 z1_100418
v_lshrrev_b32 v124,6,v127
v_lshlrev_b32 v124,12,v124
v_bfe_u32 v125,v127,1,5
v_add_u32 v124,v124,v125
s_lshl_b32 s64,s59,6
buffer_load_ushort v120,v124,s[44:47],s64 offen
buffer_load_ushort v122,v124,s[44:47],s64 offen offset:32
buffer_load_ushort v121,v124,s[44:47],s64 offen offset:2048
buffer_load_ushort v123,v124,s[44:47],s64 offen offset:2080
s_waitcnt vmcnt(0)
v_lshl_or_b32 v120,v122,16,v120
v_lshl_or_b32 v121,v123,16,v121
v_min_u32 v120,s81,v120
v_min_u32 v121,s81,v121
z1_100418:
s_waitcnt vmcnt(0)
buffer_store_dword v120,v4,s[20:23],s71 offen
buffer_store_dword v121,v4,s[20:23],s71 offen offset:32
buffer_store_dword v120,v4,s[20:23],s73 offen sc1
buffer_store_dword v121,v4,s[20:23],s73 offen offset:32 sc1
np0_100417:
v_lshrrev_b32 v124,2,v0
v_bfe_u32 v125,v124,5,1
v_mul_u32_u24 v125,2048,v125
s_and_b32 s64,s50,1
s_lshl_b32 s64,s64,5
v_add3_u32 v4,v124,v125,s64
s_mov_b32 s61,1
buffer_load_dword v119,off,s[20:23],s68 sc1
s_waitcnt vmcnt(0)
s_mov_b32 s92,s70
s_mov_b32 s93,s72
s_mov_b32 s94,s76
s_add_u32 s95,s94,4096
s_mov_b32 s96,s74
s_add_u32 s97,s96,4096
s_mov_b32 s98,s75
s_barrier
v_mov_b32 v96,v104
v_mov_b32 v97,v105
v_mov_b32 v98,v106
v_mov_b32 v99,v107
v_mov_b32 v100,v108
v_mov_b32 v101,v109
v_mov_b32 v102,v110
v_mov_b32 v103,v111
v_mov_b32 v48,0
v_mov_b32 v49,0
v_mov_b32 v50,0
v_mov_b32 v51,0
v_mov_b32 v52,0
v_mov_b32 v53,0
v_mov_b32 v54,0
v_mov_b32 v55,0
v_mov_b32 v56,0
v_mov_b32 v57,0
v_mov_b32 v58,0
v_mov_b32 v59,0
v_mov_b32 v60,0
v_mov_b32 v61,0
v_mov_b32 v62,0
v_mov_b32 v63,0
v_mov_b32 v64,0
v_mov_b32 v65,0
v_mov_b32 v66,0
v_mov_b32 v67,0
v_mov_b32 v68,0
v_mov_b32 v69,0
v_mov_b32 v70,0
v_mov_b32 v71,0
v_mov_b32 v72,0
v_mov_b32 v73,0
v_mov_b32 v74,0
v_mov_b32 v75,0
v_mov_b32 v76,0
v_mov_b32 v77,0
v_mov_b32 v78,0
v_mov_b32 v79,0
v_mov_b32 v80,0
v_mov_b32 v81,0
v_mov_b32 v82,0
v_mov_b32 v83,0
v_mov_b32 v84,0
v_mov_b32 v85,0
v_mov_b32 v86,0
v_mov_b32 v87,0
v_mov_b32 v88,0
v_mov_b32 v89,0
v_mov_b32 v90,0
v_mov_b32 v91,0
v_mov_b32 v92,0
v_mov_b32 v93,0
v_mov_b32 v94,0
v_mov_b32 v95,0
s_cmp_gt_u32 s50,1
s_cbranch_scc0 loop0_100419x
.p2align 6
s_nop 0
s_nop 0
s_nop 0
s_nop 0
s_nop 0
s_nop 0
s_nop 0
loop_100415:
v_mov_b32 v125,0
s_nop 1
v_mfma_f32_16x16x1_4b_f32 v[48:63],v125,v125,0
v_mfma_f32_16x16x1_4b_f32 v[64:79],v125,v125,0
v_mfma_f32_16x16x1_4b_f32 v[80:95],v125,v125,0
s_max_u32 s66,s79,1
s_sub_u32 s66,s66,1
v_cndmask_b32 v126,2.0,v0,s[82:83]
s_add_u32 s64,s66,0
s_lshl_b32 s65,s64,12
s_and_b32 s65,s65,0x2000
s_xor_b32 s65,s65,s67
s_lshl_b32 s64,s64,20
s_add_u32 s65,s65,s64
s_add_u32 s101,s65,s78
buffer_store_dwordx4 v[112:115],v126,s[20:23],s101 offen sc1
s_nop 15
s_nop 15
s_nop 15
s_nop 7
buffer_load_dwordx4 v[16:19],v0,s[20:23],s92 offen offset:0 sc1
s_nop 7
buffer_load_dwordx4 v[20:23],v0,s[20:23],s92 offen offset:1024 sc1
s_nop 7
buffer_load_dwordx4 v[24:27],v0,s[20:23],s92 offen offset:2048 sc1
s_nop 7
buffer_load_dwordx4 v[28:31],v0,s[20:23],s92 offen offset:3072 sc1
v_mov_b32 v96,v104
v_mov_b32 v97,v105
v_mov_b32 v98,v106
v_mov_b32 v99,v107
v_mov_b32 v100,v108
v_mov_b32 v101,v109
v_mov_b32 v102,v110
v_mov_b32 v103,v111
s_branch ja_100420
loop0_100419x:
v_mov_b32 v125,0
s_nop 1
v_mfma_f32_16x16x1_4b_f32 v[48:63],v125,v125,0
v_mfma_f32_16x16x1_4b_f32 v[64:79],v125,v125,0
v_mfma_f32_16x16x1_4b_f32 v[80:95],v125,v125,0
s_max_u32 s66,s79,1
s_sub_u32 s66,s66,1
v_cndmask_b32 v126,2.0,v0,s[82:83]
s_add_u32 s64,s66,0
s_lshl_b32 s65,s64,12
s_and_b32 s65,s65,0x2000
s_xor_b32 s65,s65,s67
s_lshl_b32 s64,s64,20
s_add_u32 s65,s65,s64
s_add_u32 s101,s65,s78
buffer_store_dwordx4 v[112:115],v126,s[20:23],s101 offen sc1
s_nop 15
s_nop 3
buffer_load_dwordx4 v[16:19],v0,s[20:23],s92 offen offset:0 sc1
s_nop 7
buffer_load_dwordx4 v[20:23],v0,s[20:23],s92 offen offset:1024 sc1
s_nop 7
buffer_load_dwordx4 v[24:27],v0,s[20:23],s92 offen offset:2048 sc1
s_nop 7
buffer_load_dwordx4 v[28:31],v0,s[20:23],s92 offen offset:3072 sc1
ja_100420:
.p2align 5
s_nop 0
s_nop 0
s_cmp_lg_u32 s61,0
s_cbranch_scc1 pe_100421
pb_100422:
v_mov_b32 v126,s79
s_cmp_eq_u32 s79,63
s_cbranch_scc1 last_100416
s_add_u32 s64,s79,1
s_lshl_b32 s65,s64,12
s_and_b32 s65,s65,0x2000
s_xor_b32 s65,s65,s67
s_lshl_b32 s64,s64,20
s_add_u32 s65,s65,s64
s_add_u32 s99,s65,s77
s_waitcnt vmcnt(3)
v_max3_u32 v124,v16,v17,v18
v_max_u32 v124,v124,v19
v_cmp_eq_u32 vcc,-1,v124
v_cndmask_b32 v121,2.0,v127,s[86:87]
v_readfirstlane_b32 s91,v119
s_add_u32 s64,s79,1
s_cmp_gt_u32 s91,s64
s_cselect_b32 s99,s99,2.0
s_cselect_b32 s63,0,1
s_cbranch_vccnz flb_100451
seg_100427:
segb_100435:
v_smfmac_f32_16x16x64_bf16 v[48:51],v[16:19],a[0:7],v1
buffer_load_dword v125,off,s[20:23],s92 sc1
v_smfmac_f32_16x16x64_bf16 v[52:55],v[16:19],a[8:15],v1
buffer_load_dwordx4 v[32:35],v0,s[20:23],s93 offen offset:0 sc1
v_smfmac_f32_16x16x64_bf16 v[56:59],v[16:19],a[16:23],v1
s_waitcnt vmcnt(4)
v_max3_u32 v124,v20,v21,v22
v_smfmac_f32_16x16x64_bf16 v[60:63],v[16:19],a[24:31],v1
v_max_u32 v124,v124,v23
v_smfmac_f32_16x16x64_bf16 v[64:67],v[16:19],a[32:39],v1
v_cmp_eq_u32 vcc,-1,v124
v_smfmac_f32_16x16x64_bf16 v[68:71],v[16:19],a[40:47],v1
v_smfmac_f32_16x16x64_bf16 v[72:75],v[16:19],a[48:55],v1
s_cbranch_vccnz fl_100444
seg_100428:
v_smfmac_f32_16x16x64_bf16 v[76:79],v[16:19],a[56:63],v1
segb_100436:
v_smfmac_f32_16x16x64_bf16 v[48:51],v[20:23],a[64:71],v1
buffer_load_dword v125,off,s[20:23],s92 sc1
v_smfmac_f32_16x16x64_bf16 v[52:55],v[20:23],a[72:79],v1
buffer_load_dwordx4 v[36:39],v0,s[20:23],s93 offen offset:1024 sc1
v_smfmac_f32_16x16x64_bf16 v[56:59],v[20:23],a[80:87],v1
s_waitcnt vmcnt(5)
v_max3_u32 v124,v24,v25,v26
v_smfmac_f32_16x16x64_bf16 v[60:63],v[20:23],a[88:95],v1
v_max_u32 v124,v124,v27
v_smfmac_f32_16x16x64_bf16 v[64:67],v[20:23],a[96:103],v1
v_cmp_eq_u32 vcc,-1,v124
v_smfmac_f32_16x16x64_bf16 v[68:71],v[20:23],a[104:111],v1
v_smfmac_f32_16x16x64_bf16 v[72:75],v[20:23],a[112:119],v1
s_cbranch_vccnz fl_100445
seg_100429:
v_smfmac_f32_16x16x64_bf16 v[76:79],v[20:23],a[120:127],v1
segb_100437:
v_smfmac_f32_16x16x64_bf16 v[48:51],v[24:27],a[128:135],v1
buffer_load_dword v125,off,s[20:23],s92 sc1
v_smfmac_f32_16x16x64_bf16 v[52:55],v[24:27],a[136:143],v1
buffer_load_dwordx4 v[40:43],v0,s[20:23],s93 offen offset:2048 sc1
v_smfmac_f32_16x16x64_bf16 v[56:59],v[24:27],a[144:151],v1
buffer_load_dwordx4 v[44:47],v0,s[20:23],s93 offen offset:3072 sc1
s_waitcnt vmcnt(7)
v_max3_u32 v124,v28,v29,v30
v_smfmac_f32_16x16x64_bf16 v[60:63],v[24:27],a[152:159],v1
v_max_u32 v124,v124,v31
v_smfmac_f32_16x16x64_bf16 v[64:67],v[24:27],a[160:167],v1
v_cmp_eq_u32 vcc,-1,v124
v_smfmac_f32_16x16x64_bf16 v[68:71],v[24:27],a[168:175],v1
v_smfmac_f32_16x16x64_bf16 v[72:75],v[24:27],a[176:183],v1
s_cbranch_vccnz fl_100446
seg_100430:
v_smfmac_f32_16x16x64_bf16 v[76:79],v[24:27],a[184:191],v1
segb_100438:
v_smfmac_f32_16x16x64_bf16 v[48:51],v[28:31],a[192:199],v1
buffer_load_dword v125,off,s[20:23],s92 sc1
v_smfmac_f32_16x16x64_bf16 v[52:55],v[28:31],a[200:207],v1
buffer_store_dword v126,v121,s[20:23],s69 offen sc1
v_smfmac_f32_16x16x64_bf16 v[56:59],v[28:31],a[208:215],v1
s_waitcnt vmcnt(7)
v_max3_u32 v124,v32,v33,v34
v_smfmac_f32_16x16x64_bf16 v[60:63],v[28:31],a[216:223],v1
v_max_u32 v124,v124,v35
v_smfmac_f32_16x16x64_bf16 v[64:67],v[28:31],a[224:231],v1
v_cmp_eq_u32 vcc,-1,v124
v_smfmac_f32_16x16x64_bf16 v[68:71],v[28:31],a[232:239],v1
v_smfmac_f32_16x16x64_bf16 v[72:75],v[28:31],a[240:247],v1
s_cbranch_vccnz fl_100447
seg_100431:
v_smfmac_f32_16x16x64_bf16 v[76:79],v[28:31],a[248:255],v1
segb_100439:
v_smfmac_f32_16x16x64_bf16 v[48:51],v[32:35],a[0:7],v1
buffer_load_dword v125,off,s[20:23],s92 sc1
v_smfmac_f32_16x16x64_bf16 v[52:55],v[32:35],a[8:15],v1
v_smfmac_f32_16x16x64_bf16 v[56:59],v[32:35],a[16:23],v1
s_waitcnt vmcnt(6)
v_max3_u32 v124,v36,v37,v38
v_smfmac_f32_16x16x64_bf16 v[60:63],v[32:35],a[24:31],v1
v_max_u32 v124,v124,v39
v_smfmac_f32_16x16x64_bf16 v[64:67],v[32:35],a[32:39],v1
v_cmp_eq_u32 vcc,-1,v124
v_smfmac_f32_16x16x64_bf16 v[68:71],v[32:35],a[40:47],v1
v_smfmac_f32_16x16x64_bf16 v[72:75],v[32:35],a[48:55],v1
s_cbranch_vccnz fl_100448
seg_100432:
v_smfmac_f32_16x16x64_bf16 v[76:79],v[32:35],a[56:63],v1
segb_100440:
v_smfmac_f32_16x16x64_bf16 v[48:51],v[36:39],a[64:71],v1
buffer_load_dword v125,off,s[20:23],s92 sc1
s_waitcnt vmcnt(4)
v_max3_u32 v124,v40,v41,v42
v_smfmac_f32_16x16x64_bf16 v[52:55],v[36:39],a[72:79],v1
v_max3_u32 v124,v124,v43,v44
v_smfmac_f32_16x16x64_bf16 v[56:59],v[36:39],a[80:87],v1
v_max3_u32 v124,v124,v45,v46
v_smfmac_f32_16x16x64_bf16 v[60:63],v[36:39],a[88:95],v1
v_max_u32 v124,v124,v47
v_smfmac_f32_16x16x64_bf16 v[64:67],v[36:39],a[96:103],v1
v_cmp_eq_u32 vcc,-1,v124
v_smfmac_f32_16x16x64_bf16 v[68:71],v[36:39],a[104:111],v1
v_smfmac_f32_16x16x64_bf16 v[72:75],v[36:39],a[112:119],v1
s_cbranch_vccnz fl_100449
seg_100433:
v_smfmac_f32_16x16x64_bf16 v[76:79],v[36:39],a[120:127],v1
segb_100441:
v_smfmac_f32_16x16x64_bf16 v[48:51],v[40:43],a[128:135],v1
s_cmp_lg_u32 s61,0
s_cbranch_scc1 pq_100423
pk_100424:
buffer_load_dwordx4 v[104:107],v0,s[20:23],s99 offen
v_smfmac_f32_16x16x64_bf16 v[52:55],v[40:43],a[136:143],v1
buffer_load_dwordx4 v[108:111],v0,s[20:23],s99 offen offset:1024
s_add_u32 s64,s79,2
v_smfmac_f32_16x16x64_bf16 v[48:51],v[44:47],a[192:199],v1
s_and_b32 s64,s64,3
s_lshl_b32 s100,s64,19
v_smfmac_f32_16x16x64_bf16 v[52:55],v[44:47],a[200:207],v1
s_mov_b32 s61,s63
s_nop 1
v_add_f32 v48,v48,v49
v_smfmac_f32_16x16x64_bf16 v[56:59],v[40:43],a[144:151],v1
ds_write_addtid_b32 v48 offset:0
v_add_f32 v50,v50,v51
v_smfmac_f32_16x16x64_bf16 v[60:63],v[40:43],a[152:159],v1
ds_write_addtid_b32 v50 offset:1040
v_add_f32 v52,v52,v53
v_smfmac_f32_16x16x64_bf16 v[56:59],v[44:47],a[208:215],v1
ds_write_addtid_b32 v52 offset:2080
v_add_f32 v54,v54,v55
v_smfmac_f32_16x16x64_bf16 v[60:63],v[44:47],a[216:223],v1
ds_write_addtid_b32 v54 offset:3120
s_nop 1
v_add_f32 v56,v56,v57
v_smfmac_f32_16x16x64_bf16 v[64:67],v[40:43],a[160:167],v1
ds_write_addtid_b32 v56 offset:4160
v_add_f32 v58,v58,v59
v_smfmac_f32_16x16x64_bf16 v[68:71],v[40:43],a[168:175],v1
ds_write_addtid_b32 v58 offset:5200
v_add_f32 v60,v60,v61
v_smfmac_f32_16x16x64_bf16 v[64:67],v[44:47],a[224:231],v1
ds_write_addtid_b32 v60 offset:6240
v_add_f32 v62,v62,v63
v_smfmac_f32_16x16x64_bf16 v[68:71],v[44:47],a[232:239],v1
ds_write_addtid_b32 v62 offset:7280
s_nop 1
v_add_f32 v64,v64,v65
v_smfmac_f32_16x16x64_bf16 v[72:75],v[40:43],a[176:183],v1
ds_write_addtid_b32 v64 offset:8448
v_add_f32 v66,v66,v67
v_smfmac_f32_16x16x64_bf16 v[76:79],v[40:43],a[184:191],v1
ds_write_addtid_b32 v66 offset:9488
v_add_f32 v68,v68,v69
v_smfmac_f32_16x16x64_bf16 v[72:75],v[44:47],a[240:247],v1
ds_write_addtid_b32 v68 offset:10528
v_add_f32 v70,v70,v71
v_smfmac_f32_16x16x64_bf16 v[76:79],v[44:47],a[248:255],v1
ds_write_addtid_b32 v70 offset:11568
s_nop 1
v_add_f32 v72,v72,v73
v_smfmac_f32_16x16x64_bf16 v[80:83],v[16:19],v[208:215],v1
ds_write_addtid_b32 v72 offset:12608
v_add_f32 v74,v74,v75
v_smfmac_f32_16x16x64_bf16 v[80:83],v[32:35],v[208:215],v1
ds_write_addtid_b32 v74 offset:13648
v_add_f32 v76,v76,v77
ds_write_addtid_b32 v76 offset:14688
v_add_f32 v78,v78,v79
ds_write_addtid_b32 v78 offset:15728
doneA_100460:
s_waitcnt lgkmcnt(0)
s_barrier
s_cmp_gt_u32 s50,1
s_cbranch_scc1 w23_100461
v_smfmac_f32_16x16x64_bf16 v[84:87],v[16:19],v[216:223],v1
v_smfmac_f32_16x16x64_bf16 v[84:87],v[32:35],v[216:223],v1
v_smfmac_f32_16x16x64_bf16 v[88:91],v[16:19],v[224:231],v1
v_smfmac_f32_16x16x64_bf16 v[88:91],v[32:35],v[224:231],v1
v_smfmac_f32_16x16x64_bf16 v[92:95],v[16:19],v[232:239],v1
ds_read_b128 v[48:51],v7 offset:0
ds_read_b128 v[52:55],v7 offset:1024
v_smfmac_f32_16x16x64_bf16 v[92:95],v[32:35],v[232:239],v1
ds_read_b128 v[56:59],v7 offset:2048
ds_read_b128 v[60:63],v7 offset:3072
v_smfmac_f32_16x16x64_bf16 v[80:83],v[20:23],v[240:247],v1
ds_read_b128 v[64:67],v7 offset:4096
ds_read_b128 v[68:71],v7 offset:5120
v_smfmac_f32_16x16x64_bf16 v[80:83],v[36:39],v[240:247],v1
ds_read_b128 v[72:75],v7 offset:6144
ds_read_b128 v[76:79],v7 offset:7168
v_smfmac_f32_16x16x64_bf16 v[84:87],v[20:23],v[248:255],v1
v_smfmac_f32_16x16x64_bf16 v[84:87],v[36:39],v[248:255],v1
s_waitcnt lgkmcnt(6)
v_smfmac_f32_16x16x64_bf16 v[88:91],v[20:23],v[48:55],v1
v_smfmac_f32_16x16x64_bf16 v[88:91],v[36:39],v[48:55],v1
ds_read_b128 v[48:51],v7 offset:8192
ds_read_b128 v[52:55],v7 offset:9216
s_waitcnt lgkmcnt(6)
v_smfmac_f32_16x16x64_bf16 v[92:95],v[20:23],v[56:63],v1
v_smfmac_f32_16x16x64_bf16 v[92:95],v[36:39],v[56:63],v1
ds_read_b128 v[56:59],v7 offset:10240
ds_read_b128 v[60:63],v7 offset:11264
s_waitcnt lgkmcnt(6)
v_smfmac_f32_16x16x64_bf16 v[80:83],v[24:27],v[64:71],v1
v_smfmac_f32_16x16x64_bf16 v[80:83],v[40:43],v[64:71],v1
ds_read_b128 v[64:67],v7 offset:12288
ds_read_b128 v[68:71],v7 offset:13312
s_waitcnt lgkmcnt(6)
v_smfmac_f32_16x16x64_bf16 v[84:87],v[24:27],v[72:79],v1
v_smfmac_f32_16x16x64_bf16 v[84:87],v[40:43],v[72:79],v1
ds_read_b128 v[72:75],v7 offset:14336
ds_read_b128 v[76:79],v7 offset:15360
s_waitcnt lgkmcnt(6)
v_smfmac_f32_16x16x64_bf16 v[88:91],v[24:27],v[48:55],v1
v_smfmac_f32_16x16x64_bf16 v[88:91],v[40:43],v[48:55],v1
ds_read_b128 v[48:51],v7 offset:16384
ds_read_b128 v[52:55],v7 offset:17408
s_waitcnt lgkmcnt(6)
v_smfmac_f32_16x16x64_bf16 v[92:95],v[24:27],v[56:63],v1
v_smfmac_f32_16x16x64_bf16 v[92:95],v[40:43],v[56:63],v1
ds_read_b128 v[56:59],v7 offset:18432
ds_read_b128 v[60:63],v7 offset:19456
s_waitcnt lgkmcnt(6)
v_smfmac_f32_16x16x64_bf16 v[80:83],v[28:31],v[64:71],v1
v_smfmac_f32_16x16x64_bf16 v[80:83],v[44:47],v[64:71],v1
s_waitcnt lgkmcnt(4)
v_smfmac_f32_16x16x64_bf16 v[84:87],v[28:31],v[72:79],v1
v_smfmac_f32_16x16x64_bf16 v[84:87],v[44:47],v[72:79],v1
s_waitcnt lgkmcnt(2)
v_smfmac_f32_16x16x64_bf16 v[88:91],v[28:31],v[48:55],v1
v_add_f32 v80,v80,v81
v_smfmac_f32_16x16x64_bf16 v[88:91],v[44:47],v[48:55],v1
v_add_f32 v82,v82,v83
s_waitcnt lgkmcnt(0)
v_smfmac_f32_16x16x64_bf16 v[92:95],v[28:31],v[56:63],v1
v_cvt_pk_bf16_f32 v80,v80,v82
v_smfmac_f32_16x16x64_bf16 v[92:95],v[44:47],v[56:63],v1
buffer_load_dwordx4 v[16:19],v2,s[20:23],s94 offen offset:0 sc1
ds_write_addtid_b32 v80 offset:16896
v_add_f32 v84,v84,v85
buffer_load_dwordx4 v[32:35],v2,s[20:23],s94 offen offset:1536 sc1
buffer_load_dwordx4 v[20:23],v2,s[20:23],s95 offen offset:0 sc1
buffer_load_dwordx4 v[36:39],v2,s[20:23],s95 offen offset:1536 sc1
buffer_load_dword v120,v3,s[20:23],s94 offen offset:0 sc1
buffer_load_dword v121,v3,s[20:23],s94 offen offset:1536 sc1
buffer_load_dword v122,v3,s[20:23],s95 offen offset:0 sc1
buffer_load_dword v123,v3,s[20:23],s95 offen offset:1536 sc1
v_add_f32 v86,v86,v87
v_cvt_pk_bf16_f32 v84,v84,v86
v_add_f32 v88,v88,v89
v_add_f32 v90,v90,v91
v_cvt_pk_bf16_f32 v88,v88,v90
v_add_f32 v92,v92,v93
v_add_f32 v94,v94,v95
v_cvt_pk_bf16_f32 v92,v92,v94
ds_write_addtid_b32 v84 offset:17920
ds_write_addtid_b32 v88 offset:18944
ds_write_addtid_b32 v92 offset:19968
.p2align 5
s_nop 0
s_nop 0
s_nop 0
s_nop 0
s_nop 0
sp_100465:
s_waitcnt vmcnt(6)
v_pk_add_f32 v[16:17],v[16:17],v[32:33]
v_pk_add_f32 v[18:19],v[18:19],v[34:35]
s_waitcnt vmcnt(4)
v_pk_add_f32 v[20:21],v[20:21],v[36:37]
v_pk_add_f32 v[22:23],v[22:23],v[38:39]
v_pk_add_f32 v[16:17],v[16:17],v[20:21]
v_pk_add_f32 v[18:19],v[18:19],v[22:23]
v_max3_f32 v124,v16,v17,v18
v_pk_add_f32 v[20:21],v[16:17],v[18:19]
s_waitcnt vmcnt(0)
v_pk_add_f32 v[120:121],v[120:121],v[122:123]
v_add_f32 v120,v120,v121
v_max3_f32 v124,v124,v19,v120
v_add_f32 v20,v20,v120
v_cmp_u_f32 vcc,v20,v21
v_max_f32_dpp v124,v124,v124 row_ror:8 row_mask:0xf bank_mask:0xf
v_mov_b32 v125,v124
s_cbranch_vccnz srt_100467
sok_100466:
s_nop 0
v_permlane16_swap_b32 v125,v124
v_max_f32 v124,v124,v125
v_mov_b32 v125,v124
s_nop 1
v_permlane32_swap_b32 v125,v124
v_max_f32 v124,v124,v125
v_mul_f32 v124,s80,v124
v_fma_f32 v16,v16,s80,-v124
v_fma_f32 v17,v17,s80,-v124
v_fma_f32 v18,v18,s80,-v124
v_fma_f32 v19,v19,s80,-v124
v_fma_f32 v120,v120,s80,-v124
s_waitcnt lgkmcnt(0)
s_barrier
ds_read2st64_b32 v[112:113],v127 offset0:66 offset1:67
ds_read2st64_b32 v[114:115],v127 offset0:68 offset1:69
ds_read2st64_b32 v[116:117],v127 offset0:70 offset1:71
ds_read2st64_b32 v[118:119],v127 offset0:72 offset1:73
v_exp_f32 v16,v16
v_exp_f32 v17,v17
v_exp_f32 v18,v18
v_exp_f32 v19,v19
v_cvt_pk_bf16_f32 v48,v16,v17
v_cvt_pk_bf16_f32 v49,v18,v19
v_exp_f32 v120,v120
v_mov_b32_dpp v50,v48 row_ror:8 row_mask:0xf bank_mask:0xf
v_mov_b32_dpp v51,v49 row_ror:8 row_mask:0xf bank_mask:0xf
v_mov_b32_dpp v121,v120 row_ror:8 row_mask:0xf bank_mask:0xf
v_cvt_pk_bf16_f32 v52,v120,v121
v_mfma_f32_16x16x32_bf16 v[64:67],v[8:11],v[48:51],0
v_mov_b32 v53,v52
v_mfma_f32_16x16x32_bf16 v[56:59],v[96:99],v[48:51],0
v_mov_b32 v54,v52
v_mov_b32 v55,v52
v_mfma_f32_16x16x32_bf16 v[60:63],v[100:103],v[48:51],0
v_mfma_f32_16x16x32_bf16 v[64:67],v[12:15],v[52:55],v[64:67]
s_waitcnt lgkmcnt(0)
v_mfma_f32_16x16x32_bf16 v[56:59],v[112:115],v[52:55],v[56:59]
v_mfma_f32_16x16x32_bf16 v[60:63],v[116:119],v[52:55],v[60:63]
s_nop 0
v_rcp_f32 v66,v64
s_nop 2
v_pk_mul_f32 v[56:57],v[56:57],v[66:67] op_sel_hi:[1,0]
v_pk_mul_f32 v[58:59],v[58:59],v[66:67] op_sel_hi:[1,0]
s_nop 0
v_pk_mul_f32 v[60:61],v[60:61],v[66:67] op_sel_hi:[1,0]
v_pk_mul_f32 v[62:63],v[62:63],v[66:67] op_sel_hi:[1,0]
v_cvt_pk_bf16_f32 v120,v56,v57
v_cvt_pk_bf16_f32 v121,v58,v59
v_cvt_pk_bf16_f32 v122,v60,v61
v_cvt_pk_bf16_f32 v123,v62,v63
buffer_store_dwordx4 v[120:123],v6,s[20:23],s98 offen
s_barrier
ds_read_b128 v[48:51],v7 offset:20480
ds_read_b128 v[52:55],v7 offset:21504
ds_read_b128 v[56:59],v7 offset:22528
ds_read_b128 v[60:63],v7 offset:23552
ds_read_b128 v[64:67],v7 offset:24576
ds_read_b128 v[68:71],v7 offset:25600
ds_read_b128 v[72:75],v7 offset:26624
ds_read_b128 v[76:79],v7 offset:27648
ds_read_b128 v[80:83],v7 offset:28672
ds_read_b128 v[84:87],v7 offset:29696
ds_read_b128 v[88:91],v7 offset:30720
ds_read_b128 v[92:95],v7 offset:31744
v_mov_b32 v96,0
v_mov_b32 v97,0
v_mov_b32 v98,0
v_mov_b32 v99,0
v_mov_b32 v100,0
v_mov_b32 v101,0
v_mov_b32 v102,0
v_mov_b32 v103,0
s_nop 11
buffer_load_dwordx4 v[16:19],v0,s[20:23],s96 offen offset:0 sc1
v_mov_b32 v120,v5
v_mov_b32 v121,v5
v_mov_b32 v122,v5
v_mov_b32 v123,v5
s_nop 1
v_mfma_f32_16x16x32_bf16 v[112:115],v[120:123],v[112:115],0
buffer_load_dwordx4 v[20:23],v0,s[20:23],s96 offen offset:1024 sc1
v_mfma_f32_16x16x32_bf16 v[116:119],v[120:123],v[116:119],0
s_add_u32 s79,s79,1
s_and_b32 s64,s79,3
s_lshl_b32 s64,s64,19
s_lshl_b32 s65,s79,8
buffer_load_dwordx4 v[24:27],v0,s[20:23],s96 offen offset:2048 sc1
s_and_b32 s65,s65,0x2000
s_lshl_b32 s66,s79,16
s_xor_b32 s88,s73,s65
s_add_u32 s88,s88,s66
s_sub_u32 s88,s88,s54
s_add_u32 s89,s71,s64
s_add_u32 s92,s70,s64
s_xor_b32 s93,s72,s65
buffer_load_dwordx4 v[28:31],v0,s[20:23],s96 offen offset:3072 sc1
s_add_u32 s93,s93,s66
s_add_u32 s94,s76,s64
s_add_u32 s95,s94,4096
s_add_u32 s98,s75,s64
s_add_u32 s60,s74,s64
v_cvt_pk_bf16_f32 v112,v112,v113
v_cvt_pk_bf16_f32 v113,v114,v115
v_cvt_pk_bf16_f32 v114,v116,v117
buffer_load_dwordx4 v[32:35],v0,s[20:23],s97 offen offset:0 sc1
v_cvt_pk_bf16_f32 v115,v118,v119
s_nop 6
buffer_load_dwordx4 v[36:39],v0,s[20:23],s97 offen offset:1024 sc1
s_nop 7
buffer_load_dwordx4 v[40:43],v0,s[20:23],s97 offen offset:2048 sc1
s_nop 7
buffer_load_dwordx4 v[44:47],v0,s[20:23],s97 offen offset:3072 sc1
s_branch ogo_100462
.p2align 5
s_nop 0
s_nop 0
s_nop 0
s_nop 0
w23_100461:
ds_read_b128 v[48:51],v2 offset:0
ds_read_b128 v[52:55],v2 offset:256
ds_read_b128 v[56:59],v2 offset:512
ds_read_b128 v[60:63],v2 offset:768
ds_read_b128 v[64:67],v2 offset:16
ds_read_b128 v[68:71],v2 offset:272
ds_read_b128 v[72:75],v2 offset:528
ds_read_b128 v[76:79],v2 offset:784
s_waitcnt lgkmcnt(6)
v_pk_add_f32 v[48:49],v[48:49],v[52:53]
v_pk_add_f32 v[50:51],v[50:51],v[54:55]
s_waitcnt lgkmcnt(4)
v_pk_add_f32 v[56:57],v[56:57],v[60:61]
v_pk_add_f32 v[58:59],v[58:59],v[62:63]
v_pk_add_f32 v[48:49],v[48:49],v[56:57]
v_pk_add_f32 v[50:51],v[50:51],v[58:59]
v_cvt_pk_bf16_f32 v112,v48,v49
v_cvt_pk_bf16_f32 v113,v50,v51
s_waitcnt lgkmcnt(2)
v_pk_add_f32 v[64:65],v[64:65],v[68:69]
v_pk_add_f32 v[66:67],v[66:67],v[70:71]
s_waitcnt lgkmcnt(0)
v_pk_add_f32 v[72:73],v[72:73],v[76:77]
v_pk_add_f32 v[74:75],v[74:75],v[78:79]
v_pk_add_f32 v[64:65],v[64:65],v[72:73]
v_pk_add_f32 v[66:67],v[66:67],v[74:75]
v_cvt_pk_bf16_f32 v114,v64,v65
v_cvt_pk_bf16_f32 v115,v66,v67
s_nop 1
v_mfma_f32_16x16x32_bf16 v[116:119],v[96:99],v[112:115],0
v_mfma_f32_16x16x32_bf16 v[120:123],v[100:103],v[112:115],0
v_mfma_f32_16x16x32_bf16 v[12:15],v[112:115],v[112:115],0
ds_read_b128 v[48:51],v7 offset:0
ds_read_b128 v[52:55],v7 offset:1024
ds_read_b128 v[56:59],v7 offset:2048
ds_read_b128 v[60:63],v7 offset:3072
ds_read_b128 v[64:67],v7 offset:4096
buffer_store_dwordx4 v[116:119],v3,s[20:23],s94 offen
buffer_store_dwordx4 v[120:123],v3,s[20:23],s94 offen offset:512
s_nop 0
buffer_store_dwordx4 v[12:15],v3,s[20:23],s94 offen offset:1024
ds_read_b128 v[68:71],v7 offset:5120
ds_read_b128 v[72:75],v7 offset:6144
ds_read_b128 v[76:79],v7 offset:7168
v_smfmac_f32_16x16x64_bf16 v[84:87],v[16:19],v[216:223],v1
v_smfmac_f32_16x16x64_bf16 v[84:87],v[32:35],v[216:223],v1
v_smfmac_f32_16x16x64_bf16 v[88:91],v[16:19],v[224:231],v1
v_smfmac_f32_16x16x64_bf16 v[88:91],v[32:35],v[224:231],v1
v_smfmac_f32_16x16x64_bf16 v[92:95],v[16:19],v[232:239],v1
v_smfmac_f32_16x16x64_bf16 v[92:95],v[32:35],v[232:239],v1
v_smfmac_f32_16x16x64_bf16 v[80:83],v[20:23],v[240:247],v1
v_smfmac_f32_16x16x64_bf16 v[80:83],v[36:39],v[240:247],v1
v_smfmac_f32_16x16x64_bf16 v[84:87],v[20:23],v[248:255],v1
v_smfmac_f32_16x16x64_bf16 v[84:87],v[36:39],v[248:255],v1
s_waitcnt lgkmcnt(6)
v_smfmac_f32_16x16x64_bf16 v[88:91],v[20:23],v[48:55],v1
v_smfmac_f32_16x16x64_bf16 v[88:91],v[36:39],v[48:55],v1
ds_read_b128 v[48:51],v7 offset:8192
ds_read_b128 v[52:55],v7 offset:9216
s_waitcnt lgkmcnt(6)
v_smfmac_f32_16x16x64_bf16 v[92:95],v[20:23],v[56:63],v1
v_smfmac_f32_16x16x64_bf16 v[92:95],v[36:39],v[56:63],v1
ds_read_b128 v[56:59],v7 offset:10240
ds_read_b128 v[60:63],v7 offset:11264
s_waitcnt lgkmcnt(6)
v_smfmac_f32_16x16x64_bf16 v[80:83],v[24:27],v[64:71],v1
v_smfmac_f32_16x16x64_bf16 v[80:83],v[40:43],v[64:71],v1
ds_read_b128 v[64:67],v7 offset:12288
ds_read_b128 v[68:71],v7 offset:13312
s_waitcnt lgkmcnt(6)
v_smfmac_f32_16x16x64_bf16 v[84:87],v[24:27],v[72:79],v1
v_smfmac_f32_16x16x64_bf16 v[84:87],v[40:43],v[72:79],v1
ds_read_b128 v[72:75],v7 offset:14336
ds_read_b128 v[76:79],v7 offset:15360
s_waitcnt lgkmcnt(6)
v_smfmac_f32_16x16x64_bf16 v[88:91],v[24:27],v[48:55],v1
v_smfmac_f32_16x16x64_bf16 v[88:91],v[40:43],v[48:55],v1
ds_read_b128 v[48:51],v7 offset:16384
ds_read_b128 v[52:55],v7 offset:17408
s_waitcnt lgkmcnt(6)
v_smfmac_f32_16x16x64_bf16 v[92:95],v[24:27],v[56:63],v1
v_smfmac_f32_16x16x64_bf16 v[92:95],v[40:43],v[56:63],v1
ds_read_b128 v[56:59],v7 offset:18432
ds_read_b128 v[60:63],v7 offset:19456
s_waitcnt lgkmcnt(6)
v_smfmac_f32_16x16x64_bf16 v[80:83],v[28:31],v[64:71],v1
v_smfmac_f32_16x16x64_bf16 v[80:83],v[44:47],v[64:71],v1
s_waitcnt lgkmcnt(4)
v_smfmac_f32_16x16x64_bf16 v[84:87],v[28:31],v[72:79],v1
v_smfmac_f32_16x16x64_bf16 v[84:87],v[44:47],v[72:79],v1
s_waitcnt lgkmcnt(2)
v_smfmac_f32_16x16x64_bf16 v[88:91],v[28:31],v[48:55],v1
v_add_f32 v80,v80,v81
v_smfmac_f32_16x16x64_bf16 v[88:91],v[44:47],v[48:55],v1
v_add_f32 v82,v82,v83
s_waitcnt lgkmcnt(0)
v_smfmac_f32_16x16x64_bf16 v[92:95],v[28:31],v[56:63],v1
v_cvt_pk_bf16_f32 v80,v80,v82
v_smfmac_f32_16x16x64_bf16 v[92:95],v[44:47],v[56:63],v1
ds_write_addtid_b32 v80 offset:16896
v_add_f32 v84,v84,v85
v_add_f32 v86,v86,v87
v_cvt_pk_bf16_f32 v84,v84,v86
v_add_f32 v88,v88,v89
v_add_f32 v90,v90,v91
v_cvt_pk_bf16_f32 v88,v88,v90
s_nop 0
v_add_f32 v92,v92,v93
v_add_f32 v94,v94,v95
v_cvt_pk_bf16_f32 v92,v92,v94
ds_write_addtid_b32 v84 offset:17920
ds_write_addtid_b32 v88 offset:18944
ds_write_addtid_b32 v92 offset:19968
s_waitcnt lgkmcnt(0)
s_barrier
ds_read_b128 v[48:51],v7 offset:20480
ds_read_b128 v[52:55],v7 offset:21504
ds_read_b128 v[56:59],v7 offset:22528
ds_read_b128 v[60:63],v7 offset:23552
ds_read_b128 v[64:67],v7 offset:24576
ds_read_b128 v[68:71],v7 offset:25600
ds_read_b128 v[72:75],v7 offset:26624
ds_read_b128 v[76:79],v7 offset:27648
ds_read_b128 v[80:83],v7 offset:28672
ds_read_b128 v[84:87],v7 offset:29696
ds_read_b128 v[88:91],v7 offset:30720
ds_read_b128 v[92:95],v7 offset:31744
s_add_u32 s65,s76,s100
s_add_u32 s66,s75,s100
s_add_u32 s64,s71,s100
s_cmp_eq_u32 s50,2
s_cselect_b32 s66,s66,s64
buffer_store_dwordx4 v[8:11],v0,s[20:23],s65 offen
s_cmp_eq_u32 s50,2
s_cselect_b32 exec_hi,-1,0
buffer_store_dwordx4 v[8:11],v0,s[20:23],s66 offen
s_mov_b32 exec_hi,0
buffer_store_dwordx4 v[8:11],v0,s[20:23],s65 offen offset:1024
s_mov_b64 exec,-1
v_mov_b32 v96,0
v_mov_b32 v97,0
v_mov_b32 v98,0
v_mov_b32 v99,0
v_mov_b32 v100,0
v_mov_b32 v101,0
v_mov_b32 v102,0
v_mov_b32 v103,0
s_barrier
s_nop 15
s_nop 15
s_nop 7
buffer_load_dwordx4 v[16:19],v0,s[20:23],s96 offen offset:0 sc1
s_add_u32 s79,s79,1
s_and_b32 s64,s79,3
s_lshl_b32 s64,s64,19
s_lshl_b32 s65,s79,8
s_and_b32 s65,s65,0x2000
s_lshl_b32 s66,s79,16
s_xor_b32 s88,s73,s65
s_add_u32 s88,s88,s66
buffer_load_dwordx4 v[20:23],v0,s[20:23],s96 offen offset:1024 sc1
s_sub_u32 s88,s88,s54
s_add_u32 s89,s71,s64
s_add_u32 s92,s70,s64
s_xor_b32 s93,s72,s65
s_add_u32 s93,s93,s66
s_add_u32 s94,s76,s64
s_add_u32 s95,s94,4096
s_add_u32 s98,s75,s64
buffer_load_dwordx4 v[24:27],v0,s[20:23],s96 offen offset:2048 sc1
s_add_u32 s60,s74,s64
s_nop 6
buffer_load_dwordx4 v[28:31],v0,s[20:23],s96 offen offset:3072 sc1
s_nop 7
buffer_load_dwordx4 v[32:35],v0,s[20:23],s97 offen offset:0 sc1
s_nop 7
buffer_load_dwordx4 v[36:39],v0,s[20:23],s97 offen offset:1024 sc1
s_nop 7
buffer_load_dwordx4 v[40:43],v0,s[20:23],s97 offen offset:2048 sc1
s_nop 7
buffer_load_dwordx4 v[44:47],v0,s[20:23],s97 offen offset:3072 sc1
.p2align 5
s_nop 0
s_nop 0
s_nop 0
s_nop 0
ogo_100462:
s_waitcnt lgkmcnt(0)
s_waitcnt vmcnt(6)
v_max3_u32 v124,v16,v17,v18
v_max3_u32 v124,v124,v19,v20
v_max3_u32 v124,v124,v21,v22
v_max_u32 v124,v124,v23
v_cmp_eq_u32 vcc,-1,v124
s_cbranch_vccnz of_100468
v_smfmac_f32_16x16x64_bf16 v[96:99],v[16:19],v[48:55],v1
v_smfmac_f32_16x16x64_bf16 v[100:103],v[16:19],v[56:63],v1
v_smfmac_f32_16x16x64_bf16 v[96:99],v[20:23],v[64:71],v1
v_smfmac_f32_16x16x64_bf16 v[100:103],v[20:23],v[72:79],v1
s_waitcnt vmcnt(4)
v_max3_u32 v124,v24,v25,v26
v_max3_u32 v124,v124,v27,v28
v_max3_u32 v124,v124,v29,v30
v_max_u32 v124,v124,v31
v_cmp_eq_u32 vcc,-1,v124
s_cbranch_vccnz of_100469
v_smfmac_f32_16x16x64_bf16 v[96:99],v[24:27],v[80:87],v1
v_smfmac_f32_16x16x64_bf16 v[100:103],v[24:27],v[88:95],v1
v_smfmac_f32_16x16x64_bf16 v[96:99],v[28:31],v[128:135],v1
v_smfmac_f32_16x16x64_bf16 v[100:103],v[28:31],v[136:143],v1
s_waitcnt vmcnt(2)
v_max3_u32 v124,v32,v33,v34
v_max3_u32 v124,v124,v35,v36
v_max3_u32 v124,v124,v37,v38
v_max_u32 v124,v124,v39
v_cmp_eq_u32 vcc,-1,v124
s_cbranch_vccnz of_100470
v_smfmac_f32_16x16x64_bf16 v[96:99],v[32:35],v[144:151],v1
v_smfmac_f32_16x16x64_bf16 v[100:103],v[32:35],v[152:159],v1
v_smfmac_f32_16x16x64_bf16 v[96:99],v[36:39],v[160:167],v1
v_smfmac_f32_16x16x64_bf16 v[100:103],v[36:39],v[168:175],v1
s_waitcnt vmcnt(1)
v_max3_u32 v124,v40,v41,v42
v_max_u32 v124,v124,v43
v_cmp_eq_u32 vcc,-1,v124
s_cbranch_vccnz of_100471
v_smfmac_f32_16x16x64_bf16 v[96:99],v[40:43],v[176:183],v1
v_smfmac_f32_16x16x64_bf16 v[100:103],v[40:43],v[184:191],v1
s_waitcnt vmcnt(0)
v_max3_u32 v124,v44,v45,v46
v_max_u32 v124,v124,v47
v_cmp_eq_u32 vcc,-1,v124
s_cbranch_vccnz of_100472
v_smfmac_f32_16x16x64_bf16 v[96:99],v[44:47],v[192:199],v1
v_smfmac_f32_16x16x64_bf16 v[100:103],v[44:47],v[200:207],v1
oback_100479:
buffer_load_dword v119,off,s[20:23],s68 sc1
s_nop 3
v_add_f32 v96,v96,v97
v_add_f32 v98,v98,v99
s_nop 0
v_add_f32 v100,v100,v101
v_add_f32 v102,v102,v103
ds_write_addtid_b32 v96 offset:20992
ds_write_addtid_b32 v98 offset:23072
ds_write_addtid_b32 v100 offset:22016
ds_write_addtid_b32 v102 offset:24096
s_mov_b32 s96,s60
s_add_u32 s97,s60,4096
s_cmp_gt_u32 s50,1
s_waitcnt lgkmcnt(0)
s_barrier
s_cbranch_scc1 loop_100415
ds_read2st64_b32 v[48:49],v4 offset0:82 offset1:86
ds_read2st64_b32 v[50:51],v4 offset0:83 offset1:87
ds_read2st64_b32 v[52:53],v4 offset0:84 offset1:88
ds_read2st64_b32 v[54:55],v4 offset0:85 offset1:89
v_mov_b32 v96,v104
v_mov_b32 v97,v105
v_mov_b32 v98,v106
v_mov_b32 v99,v107
v_mov_b32 v100,v108
v_mov_b32 v101,v109
v_mov_b32 v102,v110
v_mov_b32 v103,v111
s_waitcnt lgkmcnt(2)
v_pk_add_f32 v[48:49],v[48:49],v[50:51]
s_waitcnt lgkmcnt(0)
v_pk_add_f32 v[52:53],v[52:53],v[54:55]
v_pk_add_f32 v[48:49],v[48:49],v[52:53]
v_cvt_pk_bf16_f32 v124,v48,v49
buffer_store_dword v124,v127,s[20:23],s89 offen
s_nop 7
buffer_store_dword v124,v127,s[20:23],s88 offen sc1
s_branch loop0_100419x
last_100416:
s_waitcnt vmcnt(3)
v_max3_u32 v124,v16,v17,v18
v_max_u32 v124,v124,v19
v_cmp_eq_u32 vcc,-1,v124
v_cndmask_b32 v121,2.0,v127,s[86:87]
s_cbranch_vccnz flb_100504
seg_100480:
segb_100488:
v_smfmac_f32_16x16x64_bf16 v[64:67],v[16:19],a[32:39],v1
buffer_load_dword v125,off,s[20:23],s92 sc1
buffer_load_dwordx4 v[32:35],v0,s[20:23],s93 offen offset:0 sc1
s_waitcnt vmcnt(4)
v_max3_u32 v124,v20,v21,v22
v_smfmac_f32_16x16x64_bf16 v[68:71],v[16:19],a[40:47],v1
v_max_u32 v124,v124,v23
v_cmp_eq_u32 vcc,-1,v124
v_smfmac_f32_16x16x64_bf16 v[72:75],v[16:19],a[48:55],v1
v_smfmac_f32_16x16x64_bf16 v[76:79],v[16:19],a[56:63],v1
s_cbranch_vccnz fl_100497
seg_100481:
segb_100489:
v_smfmac_f32_16x16x64_bf16 v[64:67],v[20:23],a[96:103],v1
buffer_load_dword v125,off,s[20:23],s92 sc1
buffer_load_dwordx4 v[36:39],v0,s[20:23],s93 offen offset:1024 sc1
s_waitcnt vmcnt(5)
v_max3_u32 v124,v24,v25,v26
v_smfmac_f32_16x16x64_bf16 v[68:71],v[20:23],a[104:111],v1
v_max_u32 v124,v124,v27
v_cmp_eq_u32 vcc,-1,v124
v_smfmac_f32_16x16x64_bf16 v[72:75],v[20:23],a[112:119],v1
v_smfmac_f32_16x16x64_bf16 v[76:79],v[20:23],a[120:127],v1
s_cbranch_vccnz fl_100498
seg_100482:
segb_100490:
v_smfmac_f32_16x16x64_bf16 v[64:67],v[24:27],a[160:167],v1
buffer_load_dword v125,off,s[20:23],s92 sc1
buffer_load_dwordx4 v[40:43],v0,s[20:23],s93 offen offset:2048 sc1
buffer_load_dwordx4 v[44:47],v0,s[20:23],s93 offen offset:3072 sc1
s_waitcnt vmcnt(7)
v_max3_u32 v124,v28,v29,v30
v_smfmac_f32_16x16x64_bf16 v[68:71],v[24:27],a[168:175],v1
v_max_u32 v124,v124,v31
v_cmp_eq_u32 vcc,-1,v124
v_smfmac_f32_16x16x64_bf16 v[72:75],v[24:27],a[176:183],v1
v_smfmac_f32_16x16x64_bf16 v[76:79],v[24:27],a[184:191],v1
s_cbranch_vccnz fl_100499
seg_100483:
segb_100491:
v_smfmac_f32_16x16x64_bf16 v[64:67],v[28:31],a[224:231],v1
buffer_load_dword v125,off,s[20:23],s92 sc1
buffer_store_dword v126,v121,s[20:23],s69 offen sc1
s_waitcnt vmcnt(7)
v_max3_u32 v124,v32,v33,v34
v_smfmac_f32_16x16x64_bf16 v[68:71],v[28:31],a[232:239],v1
v_max_u32 v124,v124,v35
v_cmp_eq_u32 vcc,-1,v124
v_smfmac_f32_16x16x64_bf16 v[72:75],v[28:31],a[240:247],v1
v_smfmac_f32_16x16x64_bf16 v[76:79],v[28:31],a[248:255],v1
s_cbranch_vccnz fl_100500
seg_100484:
segb_100492:
v_smfmac_f32_16x16x64_bf16 v[64:67],v[32:35],a[32:39],v1
buffer_load_dword v125,off,s[20:23],s92 sc1
s_waitcnt vmcnt(6)
v_max3_u32 v124,v36,v37,v38
v_smfmac_f32_16x16x64_bf16 v[68:71],v[32:35],a[40:47],v1
v_max_u32 v124,v124,v39
v_cmp_eq_u32 vcc,-1,v124
v_smfmac_f32_16x16x64_bf16 v[72:75],v[32:35],a[48:55],v1
v_smfmac_f32_16x16x64_bf16 v[76:79],v[32:35],a[56:63],v1
s_cbranch_vccnz fl_100501
seg_100485:
segb_100493:
v_smfmac_f32_16x16x64_bf16 v[64:67],v[36:39],a[96:103],v1
buffer_load_dword v125,off,s[20:23],s92 sc1
s_waitcnt vmcnt(4)
v_max3_u32 v124,v40,v41,v42
v_smfmac_f32_16x16x64_bf16 v[68:71],v[36:39],a[104:111],v1
v_max3_u32 v124,v124,v43,v44
v_max3_u32 v124,v124,v45,v46
v_max_u32 v124,v124,v47
v_cmp_eq_u32 vcc,-1,v124
v_smfmac_f32_16x16x64_bf16 v[72:75],v[36:39],a[112:119],v1
v_smfmac_f32_16x16x64_bf16 v[76:79],v[36:39],a[120:127],v1
s_cbranch_vccnz fl_100502
seg_100486:
segb_100494:
v_smfmac_f32_16x16x64_bf16 v[64:67],v[40:43],a[160:167],v1
v_smfmac_f32_16x16x64_bf16 v[68:71],v[40:43],a[168:175],v1
v_smfmac_f32_16x16x64_bf16 v[64:67],v[44:47],a[224:231],v1
v_smfmac_f32_16x16x64_bf16 v[68:71],v[44:47],a[232:239],v1
v_smfmac_f32_16x16x64_bf16 v[72:75],v[40:43],a[176:183],v1
s_nop 1
v_add_f32 v64,v64,v65
v_smfmac_f32_16x16x64_bf16 v[76:79],v[40:43],a[184:191],v1
ds_write_addtid_b32 v64 offset:8448
v_add_f32 v66,v66,v67
v_smfmac_f32_16x16x64_bf16 v[72:75],v[44:47],a[240:247],v1
ds_write_addtid_b32 v66 offset:9488
v_add_f32 v68,v68,v69
v_smfmac_f32_16x16x64_bf16 v[76:79],v[44:47],a[248:255],v1
ds_write_addtid_b32 v68 offset:10528
v_add_f32 v70,v70,v71
v_smfmac_f32_16x16x64_bf16 v[80:83],v[16:19],v[208:215],v1
ds_write_addtid_b32 v70 offset:11568
v_add_f32 v72,v72,v73
v_smfmac_f32_16x16x64_bf16 v[80:83],v[32:35],v[208:215],v1
ds_write_addtid_b32 v72 offset:12608
v_add_f32 v74,v74,v75
v_smfmac_f32_16x16x64_bf16 v[84:87],v[16:19],v[216:223],v1
ds_write_addtid_b32 v74 offset:13648
v_add_f32 v76,v76,v77
v_smfmac_f32_16x16x64_bf16 v[84:87],v[32:35],v[216:223],v1
ds_write_addtid_b32 v76 offset:14688
v_add_f32 v78,v78,v79
v_smfmac_f32_16x16x64_bf16 v[88:91],v[16:19],v[224:231],v1
ds_write_addtid_b32 v78 offset:15728
v_smfmac_f32_16x16x64_bf16 v[88:91],v[32:35],v[224:231],v1
v_smfmac_f32_16x16x64_bf16 v[92:95],v[16:19],v[232:239],v1
v_smfmac_f32_16x16x64_bf16 v[92:95],v[32:35],v[232:239],v1
doneA_100513:
s_waitcnt vmcnt(0) lgkmcnt(0)
s_add_u32 s64,s79,0
s_lshl_b32 s65,s64,12
s_and_b32 s65,s65,0x2000
s_xor_b32 s65,s65,s67
s_lshl_b32 s64,s64,20
s_add_u32 s65,s65,s64
s_add_u32 s101,s65,s78
v_smfmac_f32_16x16x64_bf16 v[80:83],v[20:23],v[240:247],v1
ds_read_b128 v[48:51],v7 offset:0
ds_read_b128 v[52:55],v7 offset:1024
v_smfmac_f32_16x16x64_bf16 v[80:83],v[36:39],v[240:247],v1
ds_read_b128 v[56:59],v7 offset:2048
ds_read_b128 v[60:63],v7 offset:3072
v_smfmac_f32_16x16x64_bf16 v[84:87],v[20:23],v[248:255],v1
ds_read_b128 v[64:67],v7 offset:4096
ds_read_b128 v[68:71],v7 offset:5120
v_smfmac_f32_16x16x64_bf16 v[84:87],v[36:39],v[248:255],v1
ds_read_b128 v[72:75],v7 offset:6144
ds_read_b128 v[76:79],v7 offset:7168
s_waitcnt lgkmcnt(6)
v_smfmac_f32_16x16x64_bf16 v[88:91],v[20:23],v[48:55],v1
v_smfmac_f32_16x16x64_bf16 v[88:91],v[36:39],v[48:55],v1
ds_read_b128 v[48:51],v7 offset:8192
ds_read_b128 v[52:55],v7 offset:9216
s_waitcnt lgkmcnt(6)
v_smfmac_f32_16x16x64_bf16 v[92:95],v[20:23],v[56:63],v1
v_smfmac_f32_16x16x64_bf16 v[92:95],v[36:39],v[56:63],v1
ds_read_b128 v[56:59],v7 offset:10240
ds_read_b128 v[60:63],v7 offset:11264
s_waitcnt lgkmcnt(6)
v_smfmac_f32_16x16x64_bf16 v[80:83],v[24:27],v[64:71],v1
v_smfmac_f32_16x16x64_bf16 v[80:83],v[40:43],v[64:71],v1
ds_read_b128 v[64:67],v7 offset:12288
ds_read_b128 v[68:71],v7 offset:13312
s_waitcnt lgkmcnt(6)
v_smfmac_f32_16x16x64_bf16 v[84:87],v[24:27],v[72:79],v1
v_smfmac_f32_16x16x64_bf16 v[84:87],v[40:43],v[72:79],v1
ds_read_b128 v[72:75],v7 offset:14336
ds_read_b128 v[76:79],v7 offset:15360
s_waitcnt lgkmcnt(6)
v_smfmac_f32_16x16x64_bf16 v[88:91],v[24:27],v[48:55],v1
v_smfmac_f32_16x16x64_bf16 v[88:91],v[40:43],v[48:55],v1
ds_read_b128 v[48:51],v7 offset:16384
ds_read_b128 v[52:55],v7 offset:17408
s_waitcnt lgkmcnt(6)
v_smfmac_f32_16x16x64_bf16 v[92:95],v[24:27],v[56:63],v1
v_smfmac_f32_16x16x64_bf16 v[92:95],v[40:43],v[56:63],v1
ds_read_b128 v[56:59],v7 offset:18432
ds_read_b128 v[60:63],v7 offset:19456
s_waitcnt lgkmcnt(6)
v_smfmac_f32_16x16x64_bf16 v[80:83],v[28:31],v[64:71],v1
v_smfmac_f32_16x16x64_bf16 v[80:83],v[44:47],v[64:71],v1
s_waitcnt lgkmcnt(4)
v_smfmac_f32_16x16x64_bf16 v[84:87],v[28:31],v[72:79],v1
v_smfmac_f32_16x16x64_bf16 v[84:87],v[44:47],v[72:79],v1
s_waitcnt lgkmcnt(2)
v_smfmac_f32_16x16x64_bf16 v[88:91],v[28:31],v[48:55],v1
v_add_f32 v80,v80,v81
v_smfmac_f32_16x16x64_bf16 v[88:91],v[44:47],v[48:55],v1
v_add_f32 v82,v82,v83
s_waitcnt lgkmcnt(0)
v_smfmac_f32_16x16x64_bf16 v[92:95],v[28:31],v[56:63],v1
v_cvt_pk_bf16_f32 v80,v80,v82
v_smfmac_f32_16x16x64_bf16 v[92:95],v[44:47],v[56:63],v1
ds_write_addtid_b32 v80 offset:16896
v_add_f32 v84,v84,v85
v_add_f32 v86,v86,v87
v_cvt_pk_bf16_f32 v84,v84,v86
v_add_f32 v88,v88,v89
v_add_f32 v90,v90,v91
v_cvt_pk_bf16_f32 v88,v88,v90
s_nop 0
v_add_f32 v92,v92,v93
v_add_f32 v94,v94,v95
v_cvt_pk_bf16_f32 v92,v92,v94
ds_write_addtid_b32 v84 offset:17920
ds_write_addtid_b32 v88 offset:18944
ds_write_addtid_b32 v92 offset:19968
s_waitcnt lgkmcnt(0)
s_barrier
s_cmp_gt_u32 s50,1
s_cbranch_scc1 l23_100514
ds_read2st64_b32 v[112:113],v127 offset0:66 offset1:67
ds_read2st64_b32 v[114:115],v127 offset0:68 offset1:69
ds_read2st64_b32 v[116:117],v127 offset0:70 offset1:71
ds_read2st64_b32 v[118:119],v127 offset0:72 offset1:73
s_waitcnt lgkmcnt(0)
v_mov_b32 v120,v5
v_mov_b32 v121,v5
v_mov_b32 v122,v5
v_mov_b32 v123,v5
s_nop 1
v_mfma_f32_16x16x32_bf16 v[112:115],v[120:123],v[112:115],0
v_mfma_f32_16x16x32_bf16 v[116:119],v[120:123],v[116:119],0
s_nop 4
v_cvt_pk_bf16_f32 v112,v112,v113
v_cvt_pk_bf16_f32 v113,v114,v115
s_nop 0
v_cvt_pk_bf16_f32 v114,v116,v117
v_cvt_pk_bf16_f32 v115,v118,v119
s_branch lj_100515
l23_100514:
ds_read_b128 v[48:51],v2 offset:0
ds_read_b128 v[52:55],v2 offset:256
ds_read_b128 v[56:59],v2 offset:512
ds_read_b128 v[60:63],v2 offset:768
ds_read_b128 v[64:67],v2 offset:16
ds_read_b128 v[68:71],v2 offset:272
ds_read_b128 v[72:75],v2 offset:528
ds_read_b128 v[76:79],v2 offset:784
s_waitcnt lgkmcnt(6)
v_pk_add_f32 v[48:49],v[48:49],v[52:53]
v_pk_add_f32 v[50:51],v[50:51],v[54:55]
s_waitcnt lgkmcnt(4)
v_pk_add_f32 v[56:57],v[56:57],v[60:61]
v_pk_add_f32 v[58:59],v[58:59],v[62:63]
v_pk_add_f32 v[48:49],v[48:49],v[56:57]
v_pk_add_f32 v[50:51],v[50:51],v[58:59]
v_cvt_pk_bf16_f32 v112,v48,v49
v_cvt_pk_bf16_f32 v113,v50,v51
s_waitcnt lgkmcnt(2)
v_pk_add_f32 v[64:65],v[64:65],v[68:69]
v_pk_add_f32 v[66:67],v[66:67],v[70:71]
s_waitcnt lgkmcnt(0)
v_pk_add_f32 v[72:73],v[72:73],v[76:77]
v_pk_add_f32 v[74:75],v[74:75],v[78:79]
v_pk_add_f32 v[64:65],v[64:65],v[72:73]
v_pk_add_f32 v[66:67],v[66:67],v[74:75]
v_cvt_pk_bf16_f32 v114,v64,v65
v_cvt_pk_bf16_f32 v115,v66,v67
lj_100515:
v_cndmask_b32 v120,2.0,v0,s[82:83]
v_cndmask_b32 v121,2.0,v127,s[86:87]
buffer_store_dwordx4 v[112:115],v120,s[20:23],s101 offen sc1
s_waitcnt vmcnt(0)
s_barrier
v_mov_b32 v126,64
buffer_store_dword v126,v121,s[20:23],s69 offen sc1
s_branch recfin_100408
pe_100421:
s_waitcnt vmcnt(5)
v_readfirstlane_b32 s91,v119
s_cmp_gt_u32 s91,s79
s_cbranch_scc0 pb_100422
s_add_u32 s64,s79,0
s_lshl_b32 s65,s64,12
s_and_b32 s65,s65,0x2000
s_xor_b32 s65,s65,s67
s_lshl_b32 s64,s64,20
s_add_u32 s65,s65,s64
s_add_u32 s62,s65,s77
buffer_load_dwordx4 v[96:99],v0,s[20:23],s62 offen
buffer_load_dwordx4 v[100:103],v0,s[20:23],s62 offen offset:1024
s_mov_b32 s61,0
s_branch pb_100422
pq_100423:
s_cmp_gt_u32 s91,s79
s_cbranch_scc1 pg_100426
pl_100425:
buffer_load_dword v124,off,s[20:23],s68 sc1
s_waitcnt vmcnt(0)
v_readfirstlane_b32 s91,v124
s_cmp_gt_u32 s91,s79
s_cbranch_scc1 pg_100426
s_sleep 2
s_sub_u32 s90,s90,1
s_cmp_gt_i32 s90,0
s_cbranch_scc1 pl_100425
pg_100426:
s_add_u32 s64,s79,0
s_lshl_b32 s65,s64,12
s_and_b32 s65,s65,0x2000
s_xor_b32 s65,s65,s67
s_lshl_b32 s64,s64,20
s_add_u32 s65,s65,s64
s_add_u32 s62,s65,s77
buffer_load_dwordx4 v[96:99],v0,s[20:23],s62 offen
buffer_load_dwordx4 v[100:103],v0,s[20:23],s62 offen offset:1024
s_waitcnt vmcnt(0)
s_branch pk_100424
fl_100443:
flb_100451:
buffer_load_dwordx4 v[16:19],v0,s[20:23],s92 offen offset:0 sc1
s_mov_b32 s55,1
buffer_load_dwordx4 v[32:35],v0,s[20:23],s93 offen offset:0 sc1
s_waitcnt vmcnt(4)
v_max3_u32 v124,v20,v21,v22
v_max_u32 v124,v124,v23
v_cmp_eq_u32 vcc,-1,v124
s_cbranch_vccnz dfl_100516
v_smfmac_f32_16x16x64_bf16 v[48:51],v[20:23],a[64:71],v1
buffer_load_dword v125,off,s[20:23],s92 sc1
v_smfmac_f32_16x16x64_bf16 v[52:55],v[20:23],a[72:79],v1
buffer_load_dwordx4 v[36:39],v0,s[20:23],s93 offen offset:1024 sc1
v_smfmac_f32_16x16x64_bf16 v[56:59],v[20:23],a[80:87],v1
s_waitcnt vmcnt(5)
v_max3_u32 v124,v24,v25,v26
v_smfmac_f32_16x16x64_bf16 v[60:63],v[20:23],a[88:95],v1
v_max_u32 v124,v124,v27
v_smfmac_f32_16x16x64_bf16 v[64:67],v[20:23],a[96:103],v1
v_cmp_eq_u32 vcc,-1,v124
v_smfmac_f32_16x16x64_bf16 v[68:71],v[20:23],a[104:111],v1
v_smfmac_f32_16x16x64_bf16 v[72:75],v[20:23],a[112:119],v1
v_smfmac_f32_16x16x64_bf16 v[76:79],v[20:23],a[120:127],v1
s_cbranch_vccnz dfl_100517
v_smfmac_f32_16x16x64_bf16 v[48:51],v[24:27],a[128:135],v1
buffer_load_dword v125,off,s[20:23],s92 sc1
v_smfmac_f32_16x16x64_bf16 v[52:55],v[24:27],a[136:143],v1
buffer_load_dwordx4 v[40:43],v0,s[20:23],s93 offen offset:2048 sc1
v_smfmac_f32_16x16x64_bf16 v[56:59],v[24:27],a[144:151],v1
buffer_load_dwordx4 v[44:47],v0,s[20:23],s93 offen offset:3072 sc1
s_waitcnt vmcnt(7)
v_max3_u32 v124,v28,v29,v30
v_smfmac_f32_16x16x64_bf16 v[60:63],v[24:27],a[152:159],v1
v_max_u32 v124,v124,v31
v_smfmac_f32_16x16x64_bf16 v[64:67],v[24:27],a[160:167],v1
v_cmp_eq_u32 vcc,-1,v124
v_smfmac_f32_16x16x64_bf16 v[68:71],v[24:27],a[168:175],v1
v_smfmac_f32_16x16x64_bf16 v[72:75],v[24:27],a[176:183],v1
v_smfmac_f32_16x16x64_bf16 v[76:79],v[24:27],a[184:191],v1
s_cbranch_vccnz dfl_100518
v_smfmac_f32_16x16x64_bf16 v[48:51],v[28:31],a[192:199],v1
buffer_load_dword v125,off,s[20:23],s92 sc1
v_smfmac_f32_16x16x64_bf16 v[52:55],v[28:31],a[200:207],v1
buffer_store_dword v126,v121,s[20:23],s69 offen sc1
v_smfmac_f32_16x16x64_bf16 v[56:59],v[28:31],a[208:215],v1
s_waitcnt vmcnt(8)
v_max3_u32 v124,v16,v17,v18
v_smfmac_f32_16x16x64_bf16 v[60:63],v[28:31],a[216:223],v1
v_max_u32 v124,v124,v19
v_smfmac_f32_16x16x64_bf16 v[64:67],v[28:31],a[224:231],v1
v_cmp_eq_u32 vcc,-1,v124
v_smfmac_f32_16x16x64_bf16 v[68:71],v[28:31],a[232:239],v1
v_smfmac_f32_16x16x64_bf16 v[72:75],v[28:31],a[240:247],v1
v_smfmac_f32_16x16x64_bf16 v[76:79],v[28:31],a[248:255],v1
s_cbranch_vccnz lfb_100523
s_mov_b32 s55,0
v_smfmac_f32_16x16x64_bf16 v[48:51],v[16:19],a[0:7],v1
v_smfmac_f32_16x16x64_bf16 v[52:55],v[16:19],a[8:15],v1
v_smfmac_f32_16x16x64_bf16 v[56:59],v[16:19],a[16:23],v1
s_waitcnt vmcnt(7)
v_max3_u32 v124,v32,v33,v34
v_max_u32 v124,v124,v35
v_cmp_eq_u32 vcc,-1,v124
v_smfmac_f32_16x16x64_bf16 v[60:63],v[16:19],a[24:31],v1
v_smfmac_f32_16x16x64_bf16 v[64:67],v[16:19],a[32:39],v1
v_smfmac_f32_16x16x64_bf16 v[68:71],v[16:19],a[40:47],v1
v_smfmac_f32_16x16x64_bf16 v[72:75],v[16:19],a[48:55],v1
v_smfmac_f32_16x16x64_bf16 v[76:79],v[16:19],a[56:63],v1
s_cbranch_vccnz flb_100455
s_branch segb_100439
fl_100444:
v_smfmac_f32_16x16x64_bf16 v[76:79],v[16:19],a[56:63],v1
flb_100452:
buffer_load_dwordx4 v[20:23],v0,s[20:23],s92 offen offset:1024 sc1
s_mov_b32 s55,2
buffer_load_dwordx4 v[36:39],v0,s[20:23],s93 offen offset:1024 sc1
s_waitcnt vmcnt(5)
v_max3_u32 v124,v24,v25,v26
v_max_u32 v124,v124,v27
v_cmp_eq_u32 vcc,-1,v124
s_cbranch_vccnz dfl_100517
v_smfmac_f32_16x16x64_bf16 v[48:51],v[24:27],a[128:135],v1
buffer_load_dword v125,off,s[20:23],s92 sc1
v_smfmac_f32_16x16x64_bf16 v[52:55],v[24:27],a[136:143],v1
buffer_load_dwordx4 v[40:43],v0,s[20:23],s93 offen offset:2048 sc1
v_smfmac_f32_16x16x64_bf16 v[56:59],v[24:27],a[144:151],v1
buffer_load_dwordx4 v[44:47],v0,s[20:23],s93 offen offset:3072 sc1
s_waitcnt vmcnt(7)
v_max3_u32 v124,v28,v29,v30
v_smfmac_f32_16x16x64_bf16 v[60:63],v[24:27],a[152:159],v1
v_max_u32 v124,v124,v31
v_smfmac_f32_16x16x64_bf16 v[64:67],v[24:27],a[160:167],v1
v_cmp_eq_u32 vcc,-1,v124
v_smfmac_f32_16x16x64_bf16 v[68:71],v[24:27],a[168:175],v1
v_smfmac_f32_16x16x64_bf16 v[72:75],v[24:27],a[176:183],v1
v_smfmac_f32_16x16x64_bf16 v[76:79],v[24:27],a[184:191],v1
s_cbranch_vccnz dfl_100518
v_smfmac_f32_16x16x64_bf16 v[48:51],v[28:31],a[192:199],v1
buffer_load_dword v125,off,s[20:23],s92 sc1
v_smfmac_f32_16x16x64_bf16 v[52:55],v[28:31],a[200:207],v1
buffer_store_dword v126,v121,s[20:23],s69 offen sc1
v_smfmac_f32_16x16x64_bf16 v[56:59],v[28:31],a[208:215],v1
s_waitcnt vmcnt(6)
v_max3_u32 v124,v20,v21,v22
v_smfmac_f32_16x16x64_bf16 v[60:63],v[28:31],a[216:223],v1
v_max_u32 v124,v124,v23
v_smfmac_f32_16x16x64_bf16 v[64:67],v[28:31],a[224:231],v1
v_cmp_eq_u32 vcc,-1,v124
v_smfmac_f32_16x16x64_bf16 v[68:71],v[28:31],a[232:239],v1
v_smfmac_f32_16x16x64_bf16 v[72:75],v[28:31],a[240:247],v1
v_smfmac_f32_16x16x64_bf16 v[76:79],v[28:31],a[248:255],v1
s_cbranch_vccnz lfb_100523
s_mov_b32 s55,0
v_smfmac_f32_16x16x64_bf16 v[48:51],v[20:23],a[64:71],v1
v_smfmac_f32_16x16x64_bf16 v[52:55],v[20:23],a[72:79],v1
v_smfmac_f32_16x16x64_bf16 v[56:59],v[20:23],a[80:87],v1
s_waitcnt vmcnt(7)
v_max3_u32 v124,v32,v33,v34
v_max_u32 v124,v124,v35
v_cmp_eq_u32 vcc,-1,v124
v_smfmac_f32_16x16x64_bf16 v[60:63],v[20:23],a[88:95],v1
v_smfmac_f32_16x16x64_bf16 v[64:67],v[20:23],a[96:103],v1
v_smfmac_f32_16x16x64_bf16 v[68:71],v[20:23],a[104:111],v1
v_smfmac_f32_16x16x64_bf16 v[72:75],v[20:23],a[112:119],v1
v_smfmac_f32_16x16x64_bf16 v[76:79],v[20:23],a[120:127],v1
s_cbranch_vccnz flb_100455
s_branch segb_100439
fl_100445:
v_smfmac_f32_16x16x64_bf16 v[76:79],v[20:23],a[120:127],v1
flb_100453:
buffer_load_dwordx4 v[24:27],v0,s[20:23],s92 offen offset:2048 sc1
s_mov_b32 s55,4
buffer_load_dwordx4 v[40:43],v0,s[20:23],s93 offen offset:2048 sc1
buffer_load_dwordx4 v[44:47],v0,s[20:23],s93 offen offset:3072 sc1
s_waitcnt vmcnt(7)
v_max3_u32 v124,v28,v29,v30
v_max_u32 v124,v124,v31
v_cmp_eq_u32 vcc,-1,v124
s_cbranch_vccnz dfl_100518
v_smfmac_f32_16x16x64_bf16 v[48:51],v[28:31],a[192:199],v1
buffer_load_dword v125,off,s[20:23],s92 sc1
v_smfmac_f32_16x16x64_bf16 v[52:55],v[28:31],a[200:207],v1
buffer_store_dword v126,v121,s[20:23],s69 offen sc1
v_smfmac_f32_16x16x64_bf16 v[56:59],v[28:31],a[208:215],v1
s_waitcnt vmcnt(4)
v_max3_u32 v124,v24,v25,v26
v_smfmac_f32_16x16x64_bf16 v[60:63],v[28:31],a[216:223],v1
v_max_u32 v124,v124,v27
v_smfmac_f32_16x16x64_bf16 v[64:67],v[28:31],a[224:231],v1
v_cmp_eq_u32 vcc,-1,v124
v_smfmac_f32_16x16x64_bf16 v[68:71],v[28:31],a[232:239],v1
v_smfmac_f32_16x16x64_bf16 v[72:75],v[28:31],a[240:247],v1
v_smfmac_f32_16x16x64_bf16 v[76:79],v[28:31],a[248:255],v1
s_cbranch_vccnz lfb_100523
s_mov_b32 s55,0
v_smfmac_f32_16x16x64_bf16 v[48:51],v[24:27],a[128:135],v1
v_smfmac_f32_16x16x64_bf16 v[52:55],v[24:27],a[136:143],v1
v_smfmac_f32_16x16x64_bf16 v[56:59],v[24:27],a[144:151],v1
s_waitcnt vmcnt(7)
v_max3_u32 v124,v32,v33,v34
v_max_u32 v124,v124,v35
v_cmp_eq_u32 vcc,-1,v124
v_smfmac_f32_16x16x64_bf16 v[60:63],v[24:27],a[152:159],v1
v_smfmac_f32_16x16x64_bf16 v[64:67],v[24:27],a[160:167],v1
v_smfmac_f32_16x16x64_bf16 v[68:71],v[24:27],a[168:175],v1
v_smfmac_f32_16x16x64_bf16 v[72:75],v[24:27],a[176:183],v1
v_smfmac_f32_16x16x64_bf16 v[76:79],v[24:27],a[184:191],v1
s_cbranch_vccnz flb_100455
s_branch segb_100439
fl_100446:
v_smfmac_f32_16x16x64_bf16 v[76:79],v[24:27],a[184:191],v1
flb_100454:
buffer_load_dwordx4 v[28:31],v0,s[20:23],s92 offen offset:3072 sc1
s_mov_b32 s55,8
buffer_store_dword v126,v121,s[20:23],s69 offen sc1
s_waitcnt vmcnt(1)
v_max3_u32 v124,v28,v29,v30
v_max_u32 v124,v124,v31
v_cmp_eq_u32 vcc,-1,v124
s_cbranch_vccnz lfb_100523
s_mov_b32 s55,0
v_smfmac_f32_16x16x64_bf16 v[48:51],v[28:31],a[192:199],v1
v_smfmac_f32_16x16x64_bf16 v[52:55],v[28:31],a[200:207],v1
v_smfmac_f32_16x16x64_bf16 v[56:59],v[28:31],a[208:215],v1
s_waitcnt vmcnt(7)
v_max3_u32 v124,v32,v33,v34
v_max_u32 v124,v124,v35
v_cmp_eq_u32 vcc,-1,v124
v_smfmac_f32_16x16x64_bf16 v[60:63],v[28:31],a[216:223],v1
v_smfmac_f32_16x16x64_bf16 v[64:67],v[28:31],a[224:231],v1
v_smfmac_f32_16x16x64_bf16 v[68:71],v[28:31],a[232:239],v1
v_smfmac_f32_16x16x64_bf16 v[72:75],v[28:31],a[240:247],v1
v_smfmac_f32_16x16x64_bf16 v[76:79],v[28:31],a[248:255],v1
s_cbranch_vccnz flb_100455
s_branch segb_100439
fl_100447:
v_smfmac_f32_16x16x64_bf16 v[76:79],v[28:31],a[248:255],v1
flb_100455:
buffer_load_dwordx4 v[32:35],v0,s[20:23],s93 offen offset:0 sc1
s_mov_b32 s55,240
s_bitcmp1_b32 s55,5
s_cbranch_scc0 rdn_100526
s_waitcnt vmcnt(6)
v_max3_u32 v124,v36,v37,v38
v_max_u32 v124,v124,v39
v_cmp_eq_u32 vcc,-1,v124
s_cbranch_vccnz rfa_100527
buffer_load_dword v125,off,s[20:23],s92 sc1
s_bitset0_b32 s55,5
v_smfmac_f32_16x16x64_bf16 v[48:51],v[36:39],a[64:71],v1
v_smfmac_f32_16x16x64_bf16 v[52:55],v[36:39],a[72:79],v1
v_smfmac_f32_16x16x64_bf16 v[56:59],v[36:39],a[80:87],v1
v_smfmac_f32_16x16x64_bf16 v[60:63],v[36:39],a[88:95],v1
v_smfmac_f32_16x16x64_bf16 v[64:67],v[36:39],a[96:103],v1
v_smfmac_f32_16x16x64_bf16 v[68:71],v[36:39],a[104:111],v1
v_smfmac_f32_16x16x64_bf16 v[72:75],v[36:39],a[112:119],v1
v_smfmac_f32_16x16x64_bf16 v[76:79],v[36:39],a[120:127],v1
s_cmp_eq_u32 s55,0
s_cbranch_scc1 segb_100441
s_branch rnx_100528
rdn_100526:
buffer_load_dword v125,off,s[20:23],s92 sc1
s_branch rnx_100528
rfa_100527:
buffer_load_dwordx4 v[36:39],v0,s[20:23],s93 offen offset:1024 sc1
rnx_100528:
s_bitcmp1_b32 s55,6
s_cbranch_scc0 rdn_100529
s_waitcnt vmcnt(5)
v_max3_u32 v124,v40,v41,v42
v_max_u32 v124,v124,v43
v_cmp_eq_u32 vcc,-1,v124
s_cbranch_vccnz rfa_100530
buffer_load_dword v125,off,s[20:23],s92 sc1
s_bitset0_b32 s55,6
s_cmp_eq_u32 s55,0
s_cbranch_scc1 segb_100441
s_branch rnx_100531
rdn_100529:
buffer_load_dword v125,off,s[20:23],s92 sc1
s_branch rnx_100531
rfa_100530:
buffer_load_dwordx4 v[40:43],v0,s[20:23],s93 offen offset:2048 sc1
rnx_100531:
s_bitcmp1_b32 s55,7
s_cbranch_scc0 rdn_100532
s_waitcnt vmcnt(5)
v_max3_u32 v124,v44,v45,v46
v_max_u32 v124,v124,v47
v_cmp_eq_u32 vcc,-1,v124
s_cbranch_vccnz rfa_100533
buffer_load_dword v125,off,s[20:23],s92 sc1
s_bitset0_b32 s55,7
s_cmp_eq_u32 s55,0
s_cbranch_scc1 segb_100441
s_branch rnx_100534
rdn_100532:
buffer_load_dword v125,off,s[20:23],s92 sc1
s_branch rnx_100534
rfa_100533:
buffer_load_dwordx4 v[44:47],v0,s[20:23],s93 offen offset:3072 sc1
rnx_100534:
rot_100525:
s_bitcmp1_b32 s55,4
s_cbranch_scc0 rdn_100535
s_waitcnt vmcnt(3)
v_max3_u32 v124,v32,v33,v34
v_max_u32 v124,v124,v35
v_cmp_eq_u32 vcc,-1,v124
s_cbranch_vccnz rfa_100536
buffer_load_dword v125,off,s[20:23],s92 sc1
s_bitset0_b32 s55,4
v_smfmac_f32_16x16x64_bf16 v[48:51],v[32:35],a[0:7],v1
v_smfmac_f32_16x16x64_bf16 v[52:55],v[32:35],a[8:15],v1
v_smfmac_f32_16x16x64_bf16 v[56:59],v[32:35],a[16:23],v1
v_smfmac_f32_16x16x64_bf16 v[60:63],v[32:35],a[24:31],v1
v_smfmac_f32_16x16x64_bf16 v[64:67],v[32:35],a[32:39],v1
v_smfmac_f32_16x16x64_bf16 v[68:71],v[32:35],a[40:47],v1
v_smfmac_f32_16x16x64_bf16 v[72:75],v[32:35],a[48:55],v1
v_smfmac_f32_16x16x64_bf16 v[76:79],v[32:35],a[56:63],v1
s_cmp_eq_u32 s55,0
s_cbranch_scc1 segb_100441
s_branch rnx_100537
rdn_100535:
buffer_load_dword v125,off,s[20:23],s92 sc1
s_branch rnx_100537
rfa_100536:
buffer_load_dwordx4 v[32:35],v0,s[20:23],s93 offen offset:0 sc1
rnx_100537:
s_bitcmp1_b32 s55,5
s_cbranch_scc0 rdn_100538
s_waitcnt vmcnt(3)
v_max3_u32 v124,v36,v37,v38
v_max_u32 v124,v124,v39
v_cmp_eq_u32 vcc,-1,v124
s_cbranch_vccnz rfa_100539
buffer_load_dword v125,off,s[20:23],s92 sc1
s_bitset0_b32 s55,5
v_smfmac_f32_16x16x64_bf16 v[48:51],v[36:39],a[64:71],v1
v_smfmac_f32_16x16x64_bf16 v[52:55],v[36:39],a[72:79],v1
v_smfmac_f32_16x16x64_bf16 v[56:59],v[36:39],a[80:87],v1
v_smfmac_f32_16x16x64_bf16 v[60:63],v[36:39],a[88:95],v1
v_smfmac_f32_16x16x64_bf16 v[64:67],v[36:39],a[96:103],v1
v_smfmac_f32_16x16x64_bf16 v[68:71],v[36:39],a[104:111],v1
v_smfmac_f32_16x16x64_bf16 v[72:75],v[36:39],a[112:119],v1
v_smfmac_f32_16x16x64_bf16 v[76:79],v[36:39],a[120:127],v1
s_cmp_eq_u32 s55,0
s_cbranch_scc1 segb_100441
s_branch rnx_100540
rdn_100538:
buffer_load_dword v125,off,s[20:23],s92 sc1
s_branch rnx_100540
rfa_100539:
buffer_load_dwordx4 v[36:39],v0,s[20:23],s93 offen offset:1024 sc1
rnx_100540:
s_bitcmp1_b32 s55,6
s_cbranch_scc0 rdn_100541
s_waitcnt vmcnt(3)
v_max3_u32 v124,v40,v41,v42
v_max_u32 v124,v124,v43
v_cmp_eq_u32 vcc,-1,v124
s_cbranch_vccnz rfa_100542
buffer_load_dword v125,off,s[20:23],s92 sc1
s_bitset0_b32 s55,6
s_cmp_eq_u32 s55,0
s_cbranch_scc1 segb_100441
s_branch rnx_100543
rdn_100541:
buffer_load_dword v125,off,s[20:23],s92 sc1
s_branch rnx_100543
rfa_100542:
buffer_load_dwordx4 v[40:43],v0,s[20:23],s93 offen offset:2048 sc1
rnx_100543:
s_bitcmp1_b32 s55,7
s_cbranch_scc0 rdn_100544
s_waitcnt vmcnt(3)
v_max3_u32 v124,v44,v45,v46
v_max_u32 v124,v124,v47
v_cmp_eq_u32 vcc,-1,v124
s_cbranch_vccnz rfa_100545
buffer_load_dword v125,off,s[20:23],s92 sc1
s_bitset0_b32 s55,7
s_cmp_eq_u32 s55,0
s_cbranch_scc1 segb_100441
s_branch rnx_100546
rdn_100544:
buffer_load_dword v125,off,s[20:23],s92 sc1
s_branch rnx_100546
rfa_100545:
buffer_load_dwordx4 v[44:47],v0,s[20:23],s93 offen offset:3072 sc1
rnx_100546:
s_sub_u32 s90,s90,1
s_cmp_gt_i32 s90,0
s_cbranch_scc1 rot_100525
s_mov_b32 s55,0
s_branch segb_100441
fl_100448:
v_smfmac_f32_16x16x64_bf16 v[76:79],v[32:35],a[56:63],v1
flb_100456:
buffer_load_dwordx4 v[36:39],v0,s[20:23],s93 offen offset:1024 sc1
s_mov_b32 s55,224
s_bitcmp1_b32 s55,6
s_cbranch_scc0 rdn_100548
s_waitcnt vmcnt(5)
v_max3_u32 v124,v40,v41,v42
v_max_u32 v124,v124,v43
v_cmp_eq_u32 vcc,-1,v124
s_cbranch_vccnz rfa_100549
buffer_load_dword v125,off,s[20:23],s92 sc1
s_bitset0_b32 s55,6
s_cmp_eq_u32 s55,0
s_cbranch_scc1 segb_100441
s_branch rnx_100550
rdn_100548:
buffer_load_dword v125,off,s[20:23],s92 sc1
s_branch rnx_100550
rfa_100549:
buffer_load_dwordx4 v[40:43],v0,s[20:23],s93 offen offset:2048 sc1
rnx_100550:
s_bitcmp1_b32 s55,7
s_cbranch_scc0 rdn_100551
s_waitcnt vmcnt(5)
v_max3_u32 v124,v44,v45,v46
v_max_u32 v124,v124,v47
v_cmp_eq_u32 vcc,-1,v124
s_cbranch_vccnz rfa_100552
buffer_load_dword v125,off,s[20:23],s92 sc1
s_bitset0_b32 s55,7
s_cmp_eq_u32 s55,0
s_cbranch_scc1 segb_100441
s_branch rnx_100553
rdn_100551:
buffer_load_dword v125,off,s[20:23],s92 sc1
s_branch rnx_100553
rfa_100552:
buffer_load_dwordx4 v[44:47],v0,s[20:23],s93 offen offset:3072 sc1
rnx_100553:
rot_100547:
s_bitcmp1_b32 s55,5
s_cbranch_scc0 rdn_100554
s_waitcnt vmcnt(2)
v_max3_u32 v124,v36,v37,v38
v_max_u32 v124,v124,v39
v_cmp_eq_u32 vcc,-1,v124
s_cbranch_vccnz rfa_100555
buffer_load_dword v125,off,s[20:23],s92 sc1
s_bitset0_b32 s55,5
v_smfmac_f32_16x16x64_bf16 v[48:51],v[36:39],a[64:71],v1
v_smfmac_f32_16x16x64_bf16 v[52:55],v[36:39],a[72:79],v1
v_smfmac_f32_16x16x64_bf16 v[56:59],v[36:39],a[80:87],v1
v_smfmac_f32_16x16x64_bf16 v[60:63],v[36:39],a[88:95],v1
v_smfmac_f32_16x16x64_bf16 v[64:67],v[36:39],a[96:103],v1
v_smfmac_f32_16x16x64_bf16 v[68:71],v[36:39],a[104:111],v1
v_smfmac_f32_16x16x64_bf16 v[72:75],v[36:39],a[112:119],v1
v_smfmac_f32_16x16x64_bf16 v[76:79],v[36:39],a[120:127],v1
s_cmp_eq_u32 s55,0
s_cbranch_scc1 segb_100441
s_branch rnx_100556
rdn_100554:
buffer_load_dword v125,off,s[20:23],s92 sc1
s_branch rnx_100556
rfa_100555:
buffer_load_dwordx4 v[36:39],v0,s[20:23],s93 offen offset:1024 sc1
rnx_100556:
s_bitcmp1_b32 s55,6
s_cbranch_scc0 rdn_100557
s_waitcnt vmcnt(2)
v_max3_u32 v124,v40,v41,v42
v_max_u32 v124,v124,v43
v_cmp_eq_u32 vcc,-1,v124
s_cbranch_vccnz rfa_100558
buffer_load_dword v125,off,s[20:23],s92 sc1
s_bitset0_b32 s55,6
s_cmp_eq_u32 s55,0
s_cbranch_scc1 segb_100441
s_branch rnx_100559
rdn_100557:
buffer_load_dword v125,off,s[20:23],s92 sc1
s_branch rnx_100559
rfa_100558:
buffer_load_dwordx4 v[40:43],v0,s[20:23],s93 offen offset:2048 sc1
rnx_100559:
s_bitcmp1_b32 s55,7
s_cbranch_scc0 rdn_100560
s_waitcnt vmcnt(2)
v_max3_u32 v124,v44,v45,v46
v_max_u32 v124,v124,v47
v_cmp_eq_u32 vcc,-1,v124
s_cbranch_vccnz rfa_100561
buffer_load_dword v125,off,s[20:23],s92 sc1
s_bitset0_b32 s55,7
s_cmp_eq_u32 s55,0
s_cbranch_scc1 segb_100441
s_branch rnx_100562
rdn_100560:
buffer_load_dword v125,off,s[20:23],s92 sc1
s_branch rnx_100562
rfa_100561:
buffer_load_dwordx4 v[44:47],v0,s[20:23],s93 offen offset:3072 sc1
rnx_100562:
s_sub_u32 s90,s90,1
s_cmp_gt_i32 s90,0
s_cbranch_scc1 rot_100547
s_mov_b32 s55,0
s_branch segb_100441
fl_100449:
v_smfmac_f32_16x16x64_bf16 v[76:79],v[36:39],a[120:127],v1
flb_100457:
s_mov_b32 s55,192
s_bitcmp1_b32 s55,6
s_cbranch_scc0 rdn_100564
s_waitcnt vmcnt(5)
v_max3_u32 v124,v40,v41,v42
v_max_u32 v124,v124,v43
v_cmp_eq_u32 vcc,-1,v124
s_cbranch_vccnz rfa_100565
buffer_load_dword v125,off,s[20:23],s92 sc1
s_bitset0_b32 s55,6
s_cmp_eq_u32 s55,0
s_cbranch_scc1 segb_100441
s_branch rnx_100566
rdn_100564:
buffer_load_dword v125,off,s[20:23],s92 sc1
s_branch rnx_100566
rfa_100565:
buffer_load_dwordx4 v[40:43],v0,s[20:23],s93 offen offset:2048 sc1
rnx_100566:
s_bitcmp1_b32 s55,7
s_cbranch_scc0 rdn_100567
s_waitcnt vmcnt(5)
v_max3_u32 v124,v44,v45,v46
v_max_u32 v124,v124,v47
v_cmp_eq_u32 vcc,-1,v124
s_cbranch_vccnz rfa_100568
buffer_load_dword v125,off,s[20:23],s92 sc1
s_bitset0_b32 s55,7
s_cmp_eq_u32 s55,0
s_cbranch_scc1 segb_100441
s_branch rnx_100569
rdn_100567:
buffer_load_dword v125,off,s[20:23],s92 sc1
s_branch rnx_100569
rfa_100568:
buffer_load_dwordx4 v[44:47],v0,s[20:23],s93 offen offset:3072 sc1
rnx_100569:
rot_100563:
s_bitcmp1_b32 s55,6
s_cbranch_scc0 rdn_100570
s_waitcnt vmcnt(1)
v_max3_u32 v124,v40,v41,v42
v_max_u32 v124,v124,v43
v_cmp_eq_u32 vcc,-1,v124
s_cbranch_vccnz rfa_100571
buffer_load_dword v125,off,s[20:23],s92 sc1
s_bitset0_b32 s55,6
s_cmp_eq_u32 s55,0
s_cbranch_scc1 segb_100441
s_branch rnx_100572
rdn_100570:
buffer_load_dword v125,off,s[20:23],s92 sc1
s_branch rnx_100572
rfa_100571:
buffer_load_dwordx4 v[40:43],v0,s[20:23],s93 offen offset:2048 sc1
rnx_100572:
s_bitcmp1_b32 s55,7
s_cbranch_scc0 rdn_100573
s_waitcnt vmcnt(1)
v_max3_u32 v124,v44,v45,v46
v_max_u32 v124,v124,v47
v_cmp_eq_u32 vcc,-1,v124
s_cbranch_vccnz rfa_100574
buffer_load_dword v125,off,s[20:23],s92 sc1
s_bitset0_b32 s55,7
s_cmp_eq_u32 s55,0
s_cbranch_scc1 segb_100441
s_branch rnx_100575
rdn_100573:
buffer_load_dword v125,off,s[20:23],s92 sc1
s_branch rnx_100575
rfa_100574:
buffer_load_dwordx4 v[44:47],v0,s[20:23],s93 offen offset:3072 sc1
rnx_100575:
s_sub_u32 s90,s90,1
s_cmp_gt_i32 s90,0
s_cbranch_scc1 rot_100563
s_mov_b32 s55,0
s_branch segb_100441
dfl_100516:
buffer_load_dwordx4 v[20:23],v0,s[20:23],s92 offen offset:1024 sc1
s_bitset1_b32 s55,1
buffer_load_dwordx4 v[36:39],v0,s[20:23],s93 offen offset:1024 sc1
s_waitcnt vmcnt(5)
v_max3_u32 v124,v24,v25,v26
v_max_u32 v124,v124,v27
v_cmp_eq_u32 vcc,-1,v124
s_cbranch_vccnz dfl_100517
s_branch dseg_100520
dfl_100517:
buffer_load_dwordx4 v[24:27],v0,s[20:23],s92 offen offset:2048 sc1
s_bitset1_b32 s55,2
buffer_load_dwordx4 v[40:43],v0,s[20:23],s93 offen offset:2048 sc1
buffer_load_dwordx4 v[44:47],v0,s[20:23],s93 offen offset:3072 sc1
s_waitcnt vmcnt(7)
v_max3_u32 v124,v28,v29,v30
v_max_u32 v124,v124,v31
v_cmp_eq_u32 vcc,-1,v124
s_cbranch_vccnz dfl_100518
s_branch dseg_100521
dfl_100518:
buffer_load_dwordx4 v[28:31],v0,s[20:23],s92 offen offset:3072 sc1
s_bitset1_b32 s55,3
buffer_store_dword v126,v121,s[20:23],s69 offen sc1
s_branch lap2_100522
dseg_100520:
v_smfmac_f32_16x16x64_bf16 v[48:51],v[24:27],a[128:135],v1
buffer_load_dword v125,off,s[20:23],s92 sc1
v_smfmac_f32_16x16x64_bf16 v[52:55],v[24:27],a[136:143],v1
buffer_load_dwordx4 v[40:43],v0,s[20:23],s93 offen offset:2048 sc1
v_smfmac_f32_16x16x64_bf16 v[56:59],v[24:27],a[144:151],v1
buffer_load_dwordx4 v[44:47],v0,s[20:23],s93 offen offset:3072 sc1
s_waitcnt vmcnt(7)
v_max3_u32 v124,v28,v29,v30
v_smfmac_f32_16x16x64_bf16 v[60:63],v[24:27],a[152:159],v1
v_max_u32 v124,v124,v31
v_smfmac_f32_16x16x64_bf16 v[64:67],v[24:27],a[160:167],v1
v_cmp_eq_u32 vcc,-1,v124
v_smfmac_f32_16x16x64_bf16 v[68:71],v[24:27],a[168:175],v1
v_smfmac_f32_16x16x64_bf16 v[72:75],v[24:27],a[176:183],v1
v_smfmac_f32_16x16x64_bf16 v[76:79],v[24:27],a[184:191],v1
s_cbranch_vccnz dfl_100518
dseg_100521:
v_smfmac_f32_16x16x64_bf16 v[48:51],v[28:31],a[192:199],v1
buffer_load_dword v125,off,s[20:23],s92 sc1
v_smfmac_f32_16x16x64_bf16 v[52:55],v[28:31],a[200:207],v1
buffer_store_dword v126,v121,s[20:23],s69 offen sc1
v_smfmac_f32_16x16x64_bf16 v[56:59],v[28:31],a[208:215],v1
v_smfmac_f32_16x16x64_bf16 v[60:63],v[28:31],a[216:223],v1
v_smfmac_f32_16x16x64_bf16 v[64:67],v[28:31],a[224:231],v1
v_smfmac_f32_16x16x64_bf16 v[68:71],v[28:31],a[232:239],v1
v_smfmac_f32_16x16x64_bf16 v[72:75],v[28:31],a[240:247],v1
v_smfmac_f32_16x16x64_bf16 v[76:79],v[28:31],a[248:255],v1
lap2_100522:
s_bitcmp1_b32 s55,0
s_cbranch_scc0 l2s_100576
s_waitcnt vmcnt(8)
v_max3_u32 v124,v16,v17,v18
v_max_u32 v124,v124,v19
v_cmp_eq_u32 vcc,-1,v124
s_cbranch_vccnz l2s_100576
s_bitset0_b32 s55,0
v_smfmac_f32_16x16x64_bf16 v[48:51],v[16:19],a[0:7],v1
v_smfmac_f32_16x16x64_bf16 v[52:55],v[16:19],a[8:15],v1
v_smfmac_f32_16x16x64_bf16 v[56:59],v[16:19],a[16:23],v1
v_smfmac_f32_16x16x64_bf16 v[60:63],v[16:19],a[24:31],v1
v_smfmac_f32_16x16x64_bf16 v[64:67],v[16:19],a[32:39],v1
v_smfmac_f32_16x16x64_bf16 v[68:71],v[16:19],a[40:47],v1
v_smfmac_f32_16x16x64_bf16 v[72:75],v[16:19],a[48:55],v1
v_smfmac_f32_16x16x64_bf16 v[76:79],v[16:19],a[56:63],v1
l2s_100576:
s_bitcmp1_b32 s55,1
s_cbranch_scc0 l2s_100578
s_waitcnt vmcnt(6)
v_max3_u32 v124,v20,v21,v22
v_max_u32 v124,v124,v23
v_cmp_eq_u32 vcc,-1,v124
s_cbranch_vccnz l2s_100578
s_bitset0_b32 s55,1
v_smfmac_f32_16x16x64_bf16 v[48:51],v[20:23],a[64:71],v1
v_smfmac_f32_16x16x64_bf16 v[52:55],v[20:23],a[72:79],v1
v_smfmac_f32_16x16x64_bf16 v[56:59],v[20:23],a[80:87],v1
v_smfmac_f32_16x16x64_bf16 v[60:63],v[20:23],a[88:95],v1
v_smfmac_f32_16x16x64_bf16 v[64:67],v[20:23],a[96:103],v1
v_smfmac_f32_16x16x64_bf16 v[68:71],v[20:23],a[104:111],v1
v_smfmac_f32_16x16x64_bf16 v[72:75],v[20:23],a[112:119],v1
v_smfmac_f32_16x16x64_bf16 v[76:79],v[20:23],a[120:127],v1
l2s_100578:
s_bitcmp1_b32 s55,2
s_cbranch_scc0 l2s_100580
s_waitcnt vmcnt(4)
v_max3_u32 v124,v24,v25,v26
v_max_u32 v124,v124,v27
v_cmp_eq_u32 vcc,-1,v124
s_cbranch_vccnz l2s_100580
s_bitset0_b32 s55,2
v_smfmac_f32_16x16x64_bf16 v[48:51],v[24:27],a[128:135],v1
v_smfmac_f32_16x16x64_bf16 v[52:55],v[24:27],a[136:143],v1
v_smfmac_f32_16x16x64_bf16 v[56:59],v[24:27],a[144:151],v1
v_smfmac_f32_16x16x64_bf16 v[60:63],v[24:27],a[152:159],v1
v_smfmac_f32_16x16x64_bf16 v[64:67],v[24:27],a[160:167],v1
v_smfmac_f32_16x16x64_bf16 v[68:71],v[24:27],a[168:175],v1
v_smfmac_f32_16x16x64_bf16 v[72:75],v[24:27],a[176:183],v1
v_smfmac_f32_16x16x64_bf16 v[76:79],v[24:27],a[184:191],v1
l2s_100580:
s_bitcmp1_b32 s55,3
s_cbranch_scc0 l2s_100582
s_waitcnt vmcnt(1)
v_max3_u32 v124,v28,v29,v30
v_max_u32 v124,v124,v31
v_cmp_eq_u32 vcc,-1,v124
s_cbranch_vccnz l2s_100582
s_bitset0_b32 s55,3
v_smfmac_f32_16x16x64_bf16 v[48:51],v[28:31],a[192:199],v1
v_smfmac_f32_16x16x64_bf16 v[52:55],v[28:31],a[200:207],v1
v_smfmac_f32_16x16x64_bf16 v[56:59],v[28:31],a[208:215],v1
v_smfmac_f32_16x16x64_bf16 v[60:63],v[28:31],a[216:223],v1
v_smfmac_f32_16x16x64_bf16 v[64:67],v[28:31],a[224:231],v1
v_smfmac_f32_16x16x64_bf16 v[68:71],v[28:31],a[232:239],v1
v_smfmac_f32_16x16x64_bf16 v[72:75],v[28:31],a[240:247],v1
v_smfmac_f32_16x16x64_bf16 v[76:79],v[28:31],a[248:255],v1
l2s_100582:
s_cmp_eq_u32 s55,0
s_cbranch_scc0 lfb_100523
Ldone_100524:
s_waitcnt vmcnt(7)
v_max3_u32 v124,v32,v33,v34
v_max_u32 v124,v124,v35
v_cmp_eq_u32 vcc,-1,v124
s_cbranch_vccnz flb_100455
s_branch segb_100439
lfb_100523:
s_bitcmp1_b32 s55,0
s_cbranch_scc0 dsk_100584
buffer_load_dwordx4 v[16:19],v0,s[20:23],s92 offen offset:0 sc1
dsk_100584:
s_bitcmp1_b32 s55,1
s_cbranch_scc0 dsk_100585
buffer_load_dwordx4 v[20:23],v0,s[20:23],s92 offen offset:1024 sc1
dsk_100585:
s_bitcmp1_b32 s55,2
s_cbranch_scc0 dsk_100586
buffer_load_dwordx4 v[24:27],v0,s[20:23],s92 offen offset:2048 sc1
dsk_100586:
s_bitcmp1_b32 s55,3
s_cbranch_scc0 dsk_100587
buffer_load_dwordx4 v[28:31],v0,s[20:23],s92 offen offset:3072 sc1
dsk_100587:
s_bitcmp1_b32 s55,0
s_cbranch_scc0 dsk_100588
s_waitcnt vmcnt(2)
v_max3_u32 v124,v16,v17,v18
v_max_u32 v124,v124,v19
v_cmp_eq_u32 vcc,-1,v124
s_cbranch_vccz dgo_100589
s_nop 15
buffer_load_dwordx4 v[104:107],v0,s[20:23],s92 offen offset:0 sc1
s_nop 15
buffer_load_dwordx4 v[108:111],v0,s[20:23],s92 offen offset:0 sc1
dlp_100590:
s_waitcnt vmcnt(2)
v_max3_u32 v124,v16,v17,v18
v_max_u32 v124,v124,v19
v_cmp_eq_u32 vcc,-1,v124
s_cbranch_vccz dgo_100589
buffer_load_dwordx4 v[16:19],v0,s[20:23],s92 offen offset:0 sc1
s_waitcnt vmcnt(2)
v_max3_u32 v124,v104,v105,v106
v_max_u32 v124,v124,v107
v_cmp_eq_u32 vcc,-1,v124
s_cbranch_vccz dcp_100592
buffer_load_dwordx4 v[104:107],v0,s[20:23],s92 offen offset:0 sc1
s_waitcnt vmcnt(2)
v_max3_u32 v124,v108,v109,v110
v_max_u32 v124,v124,v111
v_cmp_eq_u32 vcc,-1,v124
s_cbranch_vccz dcp_100593
buffer_load_dwordx4 v[108:111],v0,s[20:23],s92 offen offset:0 sc1
s_sub_u32 s90,s90,1
s_cmp_gt_i32 s90,0
s_cbranch_scc1 dlp_100590
s_branch dgo_100589
dcp_100592:
v_mov_b32 v16,v104
v_mov_b32 v17,v105
v_mov_b32 v18,v106
v_mov_b32 v19,v107
s_nop 1
s_branch dgo_100589
dcp_100593:
v_mov_b32 v16,v108
v_mov_b32 v17,v109
v_mov_b32 v18,v110
v_mov_b32 v19,v111
s_nop 1
dgo_100589:
v_smfmac_f32_16x16x64_bf16 v[48:51],v[16:19],a[0:7],v1
v_smfmac_f32_16x16x64_bf16 v[52:55],v[16:19],a[8:15],v1
v_smfmac_f32_16x16x64_bf16 v[56:59],v[16:19],a[16:23],v1
v_smfmac_f32_16x16x64_bf16 v[60:63],v[16:19],a[24:31],v1
v_smfmac_f32_16x16x64_bf16 v[64:67],v[16:19],a[32:39],v1
v_smfmac_f32_16x16x64_bf16 v[68:71],v[16:19],a[40:47],v1
v_smfmac_f32_16x16x64_bf16 v[72:75],v[16:19],a[48:55],v1
v_smfmac_f32_16x16x64_bf16 v[76:79],v[16:19],a[56:63],v1
dsk_100588:
s_bitcmp1_b32 s55,1
s_cbranch_scc0 dsk_100594
s_waitcnt vmcnt(2)
v_max3_u32 v124,v20,v21,v22
v_max_u32 v124,v124,v23
v_cmp_eq_u32 vcc,-1,v124
s_cbranch_vccz dgo_100595
s_nop 15
buffer_load_dwordx4 v[104:107],v0,s[20:23],s92 offen offset:1024 sc1
s_nop 15
buffer_load_dwordx4 v[108:111],v0,s[20:23],s92 offen offset:1024 sc1
dlp_100596:
s_waitcnt vmcnt(2)
v_max3_u32 v124,v20,v21,v22
v_max_u32 v124,v124,v23
v_cmp_eq_u32 vcc,-1,v124
s_cbranch_vccz dgo_100595
buffer_load_dwordx4 v[20:23],v0,s[20:23],s92 offen offset:1024 sc1
s_waitcnt vmcnt(2)
v_max3_u32 v124,v104,v105,v106
v_max_u32 v124,v124,v107
v_cmp_eq_u32 vcc,-1,v124
s_cbranch_vccz dcp_100598
buffer_load_dwordx4 v[104:107],v0,s[20:23],s92 offen offset:1024 sc1
s_waitcnt vmcnt(2)
v_max3_u32 v124,v108,v109,v110
v_max_u32 v124,v124,v111
v_cmp_eq_u32 vcc,-1,v124
s_cbranch_vccz dcp_100599
buffer_load_dwordx4 v[108:111],v0,s[20:23],s92 offen offset:1024 sc1
s_sub_u32 s90,s90,1
s_cmp_gt_i32 s90,0
s_cbranch_scc1 dlp_100596
s_branch dgo_100595
dcp_100598:
v_mov_b32 v20,v104
v_mov_b32 v21,v105
v_mov_b32 v22,v106
v_mov_b32 v23,v107
s_nop 1
s_branch dgo_100595
dcp_100599:
v_mov_b32 v20,v108
v_mov_b32 v21,v109
v_mov_b32 v22,v110
v_mov_b32 v23,v111
s_nop 1
dgo_100595:
v_smfmac_f32_16x16x64_bf16 v[48:51],v[20:23],a[64:71],v1
v_smfmac_f32_16x16x64_bf16 v[52:55],v[20:23],a[72:79],v1
v_smfmac_f32_16x16x64_bf16 v[56:59],v[20:23],a[80:87],v1
v_smfmac_f32_16x16x64_bf16 v[60:63],v[20:23],a[88:95],v1
v_smfmac_f32_16x16x64_bf16 v[64:67],v[20:23],a[96:103],v1
v_smfmac_f32_16x16x64_bf16 v[68:71],v[20:23],a[104:111],v1
v_smfmac_f32_16x16x64_bf16 v[72:75],v[20:23],a[112:119],v1
v_smfmac_f32_16x16x64_bf16 v[76:79],v[20:23],a[120:127],v1
dsk_100594:
s_bitcmp1_b32 s55,2
s_cbranch_scc0 dsk_100600
s_waitcnt vmcnt(2)
v_max3_u32 v124,v24,v25,v26
v_max_u32 v124,v124,v27
v_cmp_eq_u32 vcc,-1,v124
s_cbranch_vccz dgo_100601
s_nop 15
buffer_load_dwordx4 v[104:107],v0,s[20:23],s92 offen offset:2048 sc1
s_nop 15
buffer_load_dwordx4 v[108:111],v0,s[20:23],s92 offen offset:2048 sc1
dlp_100602:
s_waitcnt vmcnt(2)
v_max3_u32 v124,v24,v25,v26
v_max_u32 v124,v124,v27
v_cmp_eq_u32 vcc,-1,v124
s_cbranch_vccz dgo_100601
buffer_load_dwordx4 v[24:27],v0,s[20:23],s92 offen offset:2048 sc1
s_waitcnt vmcnt(2)
v_max3_u32 v124,v104,v105,v106
v_max_u32 v124,v124,v107
v_cmp_eq_u32 vcc,-1,v124
s_cbranch_vccz dcp_100604
buffer_load_dwordx4 v[104:107],v0,s[20:23],s92 offen offset:2048 sc1
s_waitcnt vmcnt(2)
v_max3_u32 v124,v108,v109,v110
v_max_u32 v124,v124,v111
v_cmp_eq_u32 vcc,-1,v124
s_cbranch_vccz dcp_100605
buffer_load_dwordx4 v[108:111],v0,s[20:23],s92 offen offset:2048 sc1
s_sub_u32 s90,s90,1
s_cmp_gt_i32 s90,0
s_cbranch_scc1 dlp_100602
s_branch dgo_100601
dcp_100604:
v_mov_b32 v24,v104
v_mov_b32 v25,v105
v_mov_b32 v26,v106
v_mov_b32 v27,v107
s_nop 1
s_branch dgo_100601
dcp_100605:
v_mov_b32 v24,v108
v_mov_b32 v25,v109
v_mov_b32 v26,v110
v_mov_b32 v27,v111
s_nop 1
dgo_100601:
v_smfmac_f32_16x16x64_bf16 v[48:51],v[24:27],a[128:135],v1
v_smfmac_f32_16x16x64_bf16 v[52:55],v[24:27],a[136:143],v1
v_smfmac_f32_16x16x64_bf16 v[56:59],v[24:27],a[144:151],v1
v_smfmac_f32_16x16x64_bf16 v[60:63],v[24:27],a[152:159],v1
v_smfmac_f32_16x16x64_bf16 v[64:67],v[24:27],a[160:167],v1
v_smfmac_f32_16x16x64_bf16 v[68:71],v[24:27],a[168:175],v1
v_smfmac_f32_16x16x64_bf16 v[72:75],v[24:27],a[176:183],v1
v_smfmac_f32_16x16x64_bf16 v[76:79],v[24:27],a[184:191],v1
dsk_100600:
s_bitcmp1_b32 s55,3
s_cbranch_scc0 dsk_100606
s_waitcnt vmcnt(2)
v_max3_u32 v124,v28,v29,v30
v_max_u32 v124,v124,v31
v_cmp_eq_u32 vcc,-1,v124
s_cbranch_vccz dgo_100607
s_nop 15
buffer_load_dwordx4 v[104:107],v0,s[20:23],s92 offen offset:3072 sc1
s_nop 15
buffer_load_dwordx4 v[108:111],v0,s[20:23],s92 offen offset:3072 sc1
dlp_100608:
s_waitcnt vmcnt(2)
v_max3_u32 v124,v28,v29,v30
v_max_u32 v124,v124,v31
v_cmp_eq_u32 vcc,-1,v124
s_cbranch_vccz dgo_100607
buffer_load_dwordx4 v[28:31],v0,s[20:23],s92 offen offset:3072 sc1
s_waitcnt vmcnt(2)
v_max3_u32 v124,v104,v105,v106
v_max_u32 v124,v124,v107
v_cmp_eq_u32 vcc,-1,v124
s_cbranch_vccz dcp_100610
buffer_load_dwordx4 v[104:107],v0,s[20:23],s92 offen offset:3072 sc1
s_waitcnt vmcnt(2)
v_max3_u32 v124,v108,v109,v110
v_max_u32 v124,v124,v111
v_cmp_eq_u32 vcc,-1,v124
s_cbranch_vccz dcp_100611
buffer_load_dwordx4 v[108:111],v0,s[20:23],s92 offen offset:3072 sc1
s_sub_u32 s90,s90,1
s_cmp_gt_i32 s90,0
s_cbranch_scc1 dlp_100608
s_branch dgo_100607
dcp_100610:
v_mov_b32 v28,v104
v_mov_b32 v29,v105
v_mov_b32 v30,v106
v_mov_b32 v31,v107
s_nop 1
s_branch dgo_100607
dcp_100611:
v_mov_b32 v28,v108
v_mov_b32 v29,v109
v_mov_b32 v30,v110
v_mov_b32 v31,v111
s_nop 1
dgo_100607:
v_smfmac_f32_16x16x64_bf16 v[48:51],v[28:31],a[192:199],v1
v_smfmac_f32_16x16x64_bf16 v[52:55],v[28:31],a[200:207],v1
v_smfmac_f32_16x16x64_bf16 v[56:59],v[28:31],a[208:215],v1
v_smfmac_f32_16x16x64_bf16 v[60:63],v[28:31],a[216:223],v1
v_smfmac_f32_16x16x64_bf16 v[64:67],v[28:31],a[224:231],v1
v_smfmac_f32_16x16x64_bf16 v[68:71],v[28:31],a[232:239],v1
v_smfmac_f32_16x16x64_bf16 v[72:75],v[28:31],a[240:247],v1
v_smfmac_f32_16x16x64_bf16 v[76:79],v[28:31],a[248:255],v1
dsk_100606:
s_mov_b32 s55,0
s_branch Ldone_100524
slowA_100459:
buffer_load_dwordx4 v[44:47],v0,s[20:23],s93 offen offset:3072 sc1
dsk_100612:
s_bitcmp1_b32 s55,7
s_cbranch_scc0 dsk_100613
s_waitcnt vmcnt(2)
v_max3_u32 v124,v44,v45,v46
v_max_u32 v124,v124,v47
v_cmp_eq_u32 vcc,-1,v124
s_cbranch_vccz dgo_100614
s_nop 15
s_nop 3
buffer_load_dwordx4 v[104:107],v0,s[20:23],s93 offen offset:3072 sc1
s_nop 15
s_nop 3
buffer_load_dwordx4 v[108:111],v0,s[20:23],s93 offen offset:3072 sc1
dlp_100615:
s_waitcnt vmcnt(2)
v_max3_u32 v124,v44,v45,v46
v_max_u32 v124,v124,v47
v_cmp_eq_u32 vcc,-1,v124
s_cbranch_vccz dgo_100614
buffer_load_dwordx4 v[44:47],v0,s[20:23],s93 offen offset:3072 sc1
s_waitcnt vmcnt(2)
v_max3_u32 v124,v104,v105,v106
v_max_u32 v124,v124,v107
v_cmp_eq_u32 vcc,-1,v124
s_cbranch_vccz dcp_100617
buffer_load_dwordx4 v[104:107],v0,s[20:23],s93 offen offset:3072 sc1
s_waitcnt vmcnt(2)
v_max3_u32 v124,v108,v109,v110
v_max_u32 v124,v124,v111
v_cmp_eq_u32 vcc,-1,v124
s_cbranch_vccz dcp_100618
buffer_load_dwordx4 v[108:111],v0,s[20:23],s93 offen offset:3072 sc1
s_sub_u32 s90,s90,1
s_cmp_gt_i32 s90,0
s_cbranch_scc1 dlp_100615
s_branch dgo_100614
dcp_100617:
v_mov_b32 v44,v104
v_mov_b32 v45,v105
v_mov_b32 v46,v106
v_mov_b32 v47,v107
s_nop 1
s_branch dgo_100614
dcp_100618:
v_mov_b32 v44,v108
v_mov_b32 v45,v109
v_mov_b32 v46,v110
v_mov_b32 v47,v111
s_nop 1
dgo_100614:
dsk_100613:
s_mov_b32 s55,0
s_branch segb_100441
srt_100467:
s_sub_u32 s90,s90,1
s_cmp_gt_i32 s90,0
s_cbranch_scc0 sok_100466
buffer_load_dwordx4 v[16:19],v2,s[20:23],s94 offen offset:0 sc1
buffer_load_dwordx4 v[32:35],v2,s[20:23],s94 offen offset:1536 sc1
buffer_load_dwordx4 v[20:23],v2,s[20:23],s95 offen offset:0 sc1
buffer_load_dwordx4 v[36:39],v2,s[20:23],s95 offen offset:1536 sc1
buffer_load_dword v120,v3,s[20:23],s94 offen offset:0 sc1
buffer_load_dword v121,v3,s[20:23],s94 offen offset:1536 sc1
buffer_load_dword v122,v3,s[20:23],s95 offen offset:0 sc1
buffer_load_dword v123,v3,s[20:23],s95 offen offset:1536 sc1
s_branch sp_100465
of_100468:
s_mov_b32 s55,3
buffer_load_dwordx4 v[16:19],v0,s[20:23],s96 offen offset:0 sc1
buffer_load_dwordx4 v[20:23],v0,s[20:23],s96 offen offset:1024 sc1
s_waitcnt vmcnt(6)
v_max3_u32 v124,v24,v25,v26
v_max3_u32 v124,v124,v27,v28
v_max3_u32 v124,v124,v29,v30
v_max_u32 v124,v124,v31
v_cmp_eq_u32 vcc,-1,v124
s_cbranch_vccnz ost_100620
v_smfmac_f32_16x16x64_bf16 v[96:99],v[24:27],v[80:87],v1
buffer_load_dword v120,off,s[20:23],s96 sc1
v_smfmac_f32_16x16x64_bf16 v[100:103],v[24:27],v[88:95],v1
buffer_load_dword v120,off,s[20:23],s96 sc1
v_smfmac_f32_16x16x64_bf16 v[96:99],v[28:31],v[128:135],v1
v_smfmac_f32_16x16x64_bf16 v[100:103],v[28:31],v[136:143],v1
ort_100621:
s_waitcnt vmcnt(6)
v_max3_u32 v124,v32,v33,v34
v_max3_u32 v124,v124,v35,v36
v_max3_u32 v124,v124,v37,v38
v_max_u32 v124,v124,v39
v_cmp_eq_u32 vcc,-1,v124
s_cbranch_vccnz ost_100622
v_smfmac_f32_16x16x64_bf16 v[96:99],v[32:35],v[144:151],v1
buffer_load_dword v120,off,s[20:23],s96 sc1
v_smfmac_f32_16x16x64_bf16 v[100:103],v[32:35],v[152:159],v1
buffer_load_dword v120,off,s[20:23],s96 sc1
v_smfmac_f32_16x16x64_bf16 v[96:99],v[36:39],v[160:167],v1
v_smfmac_f32_16x16x64_bf16 v[100:103],v[36:39],v[168:175],v1
ort_100623:
s_waitcnt vmcnt(7)
v_max3_u32 v124,v40,v41,v42
v_max_u32 v124,v124,v43
v_cmp_eq_u32 vcc,-1,v124
s_cbranch_vccnz ost_100624
v_smfmac_f32_16x16x64_bf16 v[96:99],v[40:43],v[176:183],v1
buffer_load_dword v120,off,s[20:23],s96 sc1
v_smfmac_f32_16x16x64_bf16 v[100:103],v[40:43],v[184:191],v1
ort_100625:
s_waitcnt vmcnt(7)
v_max3_u32 v124,v44,v45,v46
v_max_u32 v124,v124,v47
v_cmp_eq_u32 vcc,-1,v124
s_cbranch_vccnz ost_100626
v_smfmac_f32_16x16x64_bf16 v[96:99],v[44:47],v[192:199],v1
buffer_load_dword v120,off,s[20:23],s96 sc1
v_smfmac_f32_16x16x64_bf16 v[100:103],v[44:47],v[200:207],v1
ort_100627:
s_waitcnt vmcnt(6)
v_max3_u32 v124,v16,v17,v18
v_max3_u32 v124,v124,v19,v20
v_max3_u32 v124,v124,v21,v22
v_max_u32 v124,v124,v23
v_cmp_eq_u32 vcc,-1,v124
s_cbranch_vccnz olap2_100619
s_andn2_b32 s55,s55,3
v_smfmac_f32_16x16x64_bf16 v[96:99],v[16:19],v[48:55],v1
v_smfmac_f32_16x16x64_bf16 v[100:103],v[16:19],v[56:63],v1
v_smfmac_f32_16x16x64_bf16 v[96:99],v[20:23],v[64:71],v1
v_smfmac_f32_16x16x64_bf16 v[100:103],v[20:23],v[72:79],v1
s_cbranch_scc0 oback_100479
s_branch olap2_100619
ost_100620:
buffer_load_dwordx4 v[24:27],v0,s[20:23],s96 offen offset:2048 sc1
buffer_load_dwordx4 v[28:31],v0,s[20:23],s96 offen offset:3072 sc1
s_or_b32 s55,s55,12
s_branch ort_100621
ost_100622:
buffer_load_dwordx4 v[32:35],v0,s[20:23],s97 offen offset:0 sc1
buffer_load_dwordx4 v[36:39],v0,s[20:23],s97 offen offset:1024 sc1
s_or_b32 s55,s55,48
s_branch ort_100623
ost_100624:
buffer_load_dwordx4 v[40:43],v0,s[20:23],s97 offen offset:2048 sc1
s_or_b32 s55,s55,64
s_branch ort_100625
ost_100626:
buffer_load_dwordx4 v[44:47],v0,s[20:23],s97 offen offset:3072 sc1
s_or_b32 s55,s55,128
s_branch ort_100627
of_100469:
s_mov_b32 s55,12
buffer_load_dwordx4 v[24:27],v0,s[20:23],s96 offen offset:2048 sc1
buffer_load_dwordx4 v[28:31],v0,s[20:23],s96 offen offset:3072 sc1
s_waitcnt vmcnt(4)
v_max3_u32 v124,v32,v33,v34
v_max3_u32 v124,v124,v35,v36
v_max3_u32 v124,v124,v37,v38
v_max_u32 v124,v124,v39
v_cmp_eq_u32 vcc,-1,v124
s_cbranch_vccnz ost_100629
v_smfmac_f32_16x16x64_bf16 v[96:99],v[32:35],v[144:151],v1
buffer_load_dword v120,off,s[20:23],s96 sc1
v_smfmac_f32_16x16x64_bf16 v[100:103],v[32:35],v[152:159],v1
buffer_load_dword v120,off,s[20:23],s96 sc1
v_smfmac_f32_16x16x64_bf16 v[96:99],v[36:39],v[160:167],v1
v_smfmac_f32_16x16x64_bf16 v[100:103],v[36:39],v[168:175],v1
ort_100630:
s_waitcnt vmcnt(5)
v_max3_u32 v124,v40,v41,v42
v_max_u32 v124,v124,v43
v_cmp_eq_u32 vcc,-1,v124
s_cbranch_vccnz ost_100631
v_smfmac_f32_16x16x64_bf16 v[96:99],v[40:43],v[176:183],v1
buffer_load_dword v120,off,s[20:23],s96 sc1
v_smfmac_f32_16x16x64_bf16 v[100:103],v[40:43],v[184:191],v1
ort_100632:
s_waitcnt vmcnt(5)
v_max3_u32 v124,v44,v45,v46
v_max_u32 v124,v124,v47
v_cmp_eq_u32 vcc,-1,v124
s_cbranch_vccnz ost_100633
v_smfmac_f32_16x16x64_bf16 v[96:99],v[44:47],v[192:199],v1
buffer_load_dword v120,off,s[20:23],s96 sc1
v_smfmac_f32_16x16x64_bf16 v[100:103],v[44:47],v[200:207],v1
ort_100634:
s_waitcnt vmcnt(4)
v_max3_u32 v124,v24,v25,v26
v_max3_u32 v124,v124,v27,v28
v_max3_u32 v124,v124,v29,v30
v_max_u32 v124,v124,v31
v_cmp_eq_u32 vcc,-1,v124
s_cbranch_vccnz olap2_100619
s_andn2_b32 s55,s55,12
v_smfmac_f32_16x16x64_bf16 v[96:99],v[24:27],v[80:87],v1
v_smfmac_f32_16x16x64_bf16 v[100:103],v[24:27],v[88:95],v1
v_smfmac_f32_16x16x64_bf16 v[96:99],v[28:31],v[128:135],v1
v_smfmac_f32_16x16x64_bf16 v[100:103],v[28:31],v[136:143],v1
s_cbranch_scc0 oback_100479
s_branch olap2_100619
ost_100629:
buffer_load_dwordx4 v[32:35],v0,s[20:23],s97 offen offset:0 sc1
buffer_load_dwordx4 v[36:39],v0,s[20:23],s97 offen offset:1024 sc1
s_or_b32 s55,s55,48
s_branch ort_100630
ost_100631:
buffer_load_dwordx4 v[40:43],v0,s[20:23],s97 offen offset:2048 sc1
s_or_b32 s55,s55,64
s_branch ort_100632
ost_100633:
buffer_load_dwordx4 v[44:47],v0,s[20:23],s97 offen offset:3072 sc1
s_or_b32 s55,s55,128
s_branch ort_100634
of_100470:
s_mov_b32 s55,48
buffer_load_dwordx4 v[32:35],v0,s[20:23],s97 offen offset:0 sc1
buffer_load_dwordx4 v[36:39],v0,s[20:23],s97 offen offset:1024 sc1
s_waitcnt vmcnt(3)
v_max3_u32 v124,v40,v41,v42
v_max_u32 v124,v124,v43
v_cmp_eq_u32 vcc,-1,v124
s_cbranch_vccnz ost_100636
v_smfmac_f32_16x16x64_bf16 v[96:99],v[40:43],v[176:183],v1
buffer_load_dword v120,off,s[20:23],s96 sc1
v_smfmac_f32_16x16x64_bf16 v[100:103],v[40:43],v[184:191],v1
ort_100637:
s_waitcnt vmcnt(3)
v_max3_u32 v124,v44,v45,v46
v_max_u32 v124,v124,v47
v_cmp_eq_u32 vcc,-1,v124
s_cbranch_vccnz ost_100638
v_smfmac_f32_16x16x64_bf16 v[96:99],v[44:47],v[192:199],v1
buffer_load_dword v120,off,s[20:23],s96 sc1
v_smfmac_f32_16x16x64_bf16 v[100:103],v[44:47],v[200:207],v1
ort_100639:
s_waitcnt vmcnt(2)
v_max3_u32 v124,v32,v33,v34
v_max3_u32 v124,v124,v35,v36
v_max3_u32 v124,v124,v37,v38
v_max_u32 v124,v124,v39
v_cmp_eq_u32 vcc,-1,v124
s_cbranch_vccnz olap2_100619
s_andn2_b32 s55,s55,48
v_smfmac_f32_16x16x64_bf16 v[96:99],v[32:35],v[144:151],v1
v_smfmac_f32_16x16x64_bf16 v[100:103],v[32:35],v[152:159],v1
v_smfmac_f32_16x16x64_bf16 v[96:99],v[36:39],v[160:167],v1
v_smfmac_f32_16x16x64_bf16 v[100:103],v[36:39],v[168:175],v1
s_cbranch_scc0 oback_100479
s_branch olap2_100619
ost_100636:
buffer_load_dwordx4 v[40:43],v0,s[20:23],s97 offen offset:2048 sc1
s_or_b32 s55,s55,64
s_branch ort_100637
ost_100638:
buffer_load_dwordx4 v[44:47],v0,s[20:23],s97 offen offset:3072 sc1
s_or_b32 s55,s55,128
s_branch ort_100639
of_100471:
s_mov_b32 s55,64
buffer_load_dwordx4 v[40:43],v0,s[20:23],s97 offen offset:2048 sc1
s_waitcnt vmcnt(1)
v_max3_u32 v124,v44,v45,v46
v_max_u32 v124,v124,v47
v_cmp_eq_u32 vcc,-1,v124
s_cbranch_vccnz ost_100641
v_smfmac_f32_16x16x64_bf16 v[96:99],v[44:47],v[192:199],v1
buffer_load_dword v120,off,s[20:23],s96 sc1
v_smfmac_f32_16x16x64_bf16 v[100:103],v[44:47],v[200:207],v1
ort_100642:
s_waitcnt vmcnt(1)
v_max3_u32 v124,v40,v41,v42
v_max_u32 v124,v124,v43
v_cmp_eq_u32 vcc,-1,v124
s_cbranch_vccnz olap2_100619
s_andn2_b32 s55,s55,64
v_smfmac_f32_16x16x64_bf16 v[96:99],v[40:43],v[176:183],v1
v_smfmac_f32_16x16x64_bf16 v[100:103],v[40:43],v[184:191],v1
s_cbranch_scc0 oback_100479
s_branch olap2_100619
ost_100641:
buffer_load_dwordx4 v[44:47],v0,s[20:23],s97 offen offset:3072 sc1
s_or_b32 s55,s55,128
s_branch ort_100642
of_100472:
s_mov_b32 s55,128
s_branch oslow_100478
olap2_100619:
s_bitcmp1_b32 s55,0
s_cbranch_scc0 l2s_100644
s_waitcnt vmcnt(6)
v_max3_u32 v124,v16,v17,v18
v_max3_u32 v124,v124,v19,v20
v_max3_u32 v124,v124,v21,v22
v_max_u32 v124,v124,v23
v_cmp_eq_u32 vcc,-1,v124
s_cbranch_vccnz l2s_100644
s_andn2_b32 s55,s55,3
v_smfmac_f32_16x16x64_bf16 v[96:99],v[16:19],v[48:55],v1
v_smfmac_f32_16x16x64_bf16 v[100:103],v[16:19],v[56:63],v1
v_smfmac_f32_16x16x64_bf16 v[96:99],v[20:23],v[64:71],v1
v_smfmac_f32_16x16x64_bf16 v[100:103],v[20:23],v[72:79],v1
l2s_100644:
s_bitcmp1_b32 s55,2
s_cbranch_scc0 l2s_100645
s_waitcnt vmcnt(4)
v_max3_u32 v124,v24,v25,v26
v_max3_u32 v124,v124,v27,v28
v_max3_u32 v124,v124,v29,v30
v_max_u32 v124,v124,v31
v_cmp_eq_u32 vcc,-1,v124
s_cbranch_vccnz l2s_100645
s_andn2_b32 s55,s55,12
v_smfmac_f32_16x16x64_bf16 v[96:99],v[24:27],v[80:87],v1
v_smfmac_f32_16x16x64_bf16 v[100:103],v[24:27],v[88:95],v1
v_smfmac_f32_16x16x64_bf16 v[96:99],v[28:31],v[128:135],v1
v_smfmac_f32_16x16x64_bf16 v[100:103],v[28:31],v[136:143],v1
l2s_100645:
s_bitcmp1_b32 s55,4
s_cbranch_scc0 l2s_100646
s_waitcnt vmcnt(2)
v_max3_u32 v124,v32,v33,v34
v_max3_u32 v124,v124,v35,v36
v_max3_u32 v124,v124,v37,v38
v_max_u32 v124,v124,v39
v_cmp_eq_u32 vcc,-1,v124
s_cbranch_vccnz l2s_100646
s_andn2_b32 s55,s55,48
v_smfmac_f32_16x16x64_bf16 v[96:99],v[32:35],v[144:151],v1
v_smfmac_f32_16x16x64_bf16 v[100:103],v[32:35],v[152:159],v1
v_smfmac_f32_16x16x64_bf16 v[96:99],v[36:39],v[160:167],v1
v_smfmac_f32_16x16x64_bf16 v[100:103],v[36:39],v[168:175],v1
l2s_100646:
s_bitcmp1_b32 s55,6
s_cbranch_scc0 l2s_100647
s_waitcnt vmcnt(1)
v_max3_u32 v124,v40,v41,v42
v_max_u32 v124,v124,v43
v_cmp_eq_u32 vcc,-1,v124
s_cbranch_vccnz l2s_100647
s_andn2_b32 s55,s55,64
v_smfmac_f32_16x16x64_bf16 v[96:99],v[40:43],v[176:183],v1
v_smfmac_f32_16x16x64_bf16 v[100:103],v[40:43],v[184:191],v1
l2s_100647:
s_bitcmp1_b32 s55,7
s_cbranch_scc0 l2s_100648
s_waitcnt vmcnt(0)
v_max3_u32 v124,v44,v45,v46
v_max_u32 v124,v124,v47
v_cmp_eq_u32 vcc,-1,v124
s_cbranch_vccnz l2s_100648
s_andn2_b32 s55,s55,128
v_smfmac_f32_16x16x64_bf16 v[96:99],v[44:47],v[192:199],v1
v_smfmac_f32_16x16x64_bf16 v[100:103],v[44:47],v[200:207],v1
l2s_100648:
s_cmp_eq_u32 s55,0
s_cbranch_scc1 oback_100479
oslow_100478:
s_bitcmp1_b32 s55,0
s_cbranch_scc0 dsk_100649
buffer_load_dwordx4 v[16:19],v0,s[20:23],s96 offen offset:0 sc1
dsk_100649:
s_bitcmp1_b32 s55,1
s_cbranch_scc0 dsk_100650
buffer_load_dwordx4 v[20:23],v0,s[20:23],s96 offen offset:1024 sc1
dsk_100650:
s_bitcmp1_b32 s55,2
s_cbranch_scc0 dsk_100651
buffer_load_dwordx4 v[24:27],v0,s[20:23],s96 offen offset:2048 sc1
dsk_100651:
s_bitcmp1_b32 s55,3
s_cbranch_scc0 dsk_100652
buffer_load_dwordx4 v[28:31],v0,s[20:23],s96 offen offset:3072 sc1
dsk_100652:
s_bitcmp1_b32 s55,4
s_cbranch_scc0 dsk_100653
buffer_load_dwordx4 v[32:35],v0,s[20:23],s97 offen offset:0 sc1
dsk_100653:
s_bitcmp1_b32 s55,5
s_cbranch_scc0 dsk_100654
buffer_load_dwordx4 v[36:39],v0,s[20:23],s97 offen offset:1024 sc1
dsk_100654:
s_bitcmp1_b32 s55,6
s_cbranch_scc0 dsk_100655
buffer_load_dwordx4 v[40:43],v0,s[20:23],s97 offen offset:2048 sc1
dsk_100655:
s_bitcmp1_b32 s55,7
s_cbranch_scc0 dsk_100656
buffer_load_dwordx4 v[44:47],v0,s[20:23],s97 offen offset:3072 sc1
dsk_100656:
s_bitcmp1_b32 s55,0
s_cbranch_scc0 dsk_100657
s_waitcnt vmcnt(2)
v_max3_u32 v124,v16,v17,v18
v_max_u32 v124,v124,v19
v_cmp_eq_u32 vcc,-1,v124
s_cbranch_vccz dgo_100658
s_nop 15
buffer_load_dwordx4 v[116:119],v0,s[20:23],s96 offen offset:0 sc1
s_nop 15
buffer_load_dwordx4 v[120:123],v0,s[20:23],s96 offen offset:0 sc1
dlp_100659:
s_waitcnt vmcnt(2)
v_max3_u32 v124,v16,v17,v18
v_max_u32 v124,v124,v19
v_cmp_eq_u32 vcc,-1,v124
s_cbranch_vccz dgo_100658
buffer_load_dwordx4 v[16:19],v0,s[20:23],s96 offen offset:0 sc1
s_waitcnt vmcnt(2)
v_max3_u32 v124,v116,v117,v118
v_max_u32 v124,v124,v119
v_cmp_eq_u32 vcc,-1,v124
s_cbranch_vccz dcp_100661
buffer_load_dwordx4 v[116:119],v0,s[20:23],s96 offen offset:0 sc1
s_waitcnt vmcnt(2)
v_max3_u32 v124,v120,v121,v122
v_max_u32 v124,v124,v123
v_cmp_eq_u32 vcc,-1,v124
s_cbranch_vccz dcp_100662
buffer_load_dwordx4 v[120:123],v0,s[20:23],s96 offen offset:0 sc1
s_sub_u32 s90,s90,1
s_cmp_gt_i32 s90,0
s_cbranch_scc1 dlp_100659
s_branch dgo_100658
dcp_100661:
v_mov_b32 v16,v116
v_mov_b32 v17,v117
v_mov_b32 v18,v118
v_mov_b32 v19,v119
s_nop 1
s_branch dgo_100658
dcp_100662:
v_mov_b32 v16,v120
v_mov_b32 v17,v121
v_mov_b32 v18,v122
v_mov_b32 v19,v123
s_nop 1
dgo_100658:
v_smfmac_f32_16x16x64_bf16 v[96:99],v[16:19],v[48:55],v1
v_smfmac_f32_16x16x64_bf16 v[100:103],v[16:19],v[56:63],v1
dsk_100657:
s_bitcmp1_b32 s55,1
s_cbranch_scc0 dsk_100663
s_waitcnt vmcnt(2)
v_max3_u32 v124,v20,v21,v22
v_max_u32 v124,v124,v23
v_cmp_eq_u32 vcc,-1,v124
s_cbranch_vccz dgo_100664
s_nop 15
buffer_load_dwordx4 v[116:119],v0,s[20:23],s96 offen offset:1024 sc1
s_nop 15
buffer_load_dwordx4 v[120:123],v0,s[20:23],s96 offen offset:1024 sc1
dlp_100665:
s_waitcnt vmcnt(2)
v_max3_u32 v124,v20,v21,v22
v_max_u32 v124,v124,v23
v_cmp_eq_u32 vcc,-1,v124
s_cbranch_vccz dgo_100664
buffer_load_dwordx4 v[20:23],v0,s[20:23],s96 offen offset:1024 sc1
s_waitcnt vmcnt(2)
v_max3_u32 v124,v116,v117,v118
v_max_u32 v124,v124,v119
v_cmp_eq_u32 vcc,-1,v124
s_cbranch_vccz dcp_100667
buffer_load_dwordx4 v[116:119],v0,s[20:23],s96 offen offset:1024 sc1
s_waitcnt vmcnt(2)
v_max3_u32 v124,v120,v121,v122
v_max_u32 v124,v124,v123
v_cmp_eq_u32 vcc,-1,v124
s_cbranch_vccz dcp_100668
buffer_load_dwordx4 v[120:123],v0,s[20:23],s96 offen offset:1024 sc1
s_sub_u32 s90,s90,1
s_cmp_gt_i32 s90,0
s_cbranch_scc1 dlp_100665
s_branch dgo_100664
dcp_100667:
v_mov_b32 v20,v116
v_mov_b32 v21,v117
v_mov_b32 v22,v118
v_mov_b32 v23,v119
s_nop 1
s_branch dgo_100664
dcp_100668:
v_mov_b32 v20,v120
v_mov_b32 v21,v121
v_mov_b32 v22,v122
v_mov_b32 v23,v123
s_nop 1
dgo_100664:
v_smfmac_f32_16x16x64_bf16 v[96:99],v[20:23],v[64:71],v1
v_smfmac_f32_16x16x64_bf16 v[100:103],v[20:23],v[72:79],v1
dsk_100663:
s_bitcmp1_b32 s55,2
s_cbranch_scc0 dsk_100669
s_waitcnt vmcnt(2)
v_max3_u32 v124,v24,v25,v26
v_max_u32 v124,v124,v27
v_cmp_eq_u32 vcc,-1,v124
s_cbranch_vccz dgo_100670
s_nop 15
buffer_load_dwordx4 v[116:119],v0,s[20:23],s96 offen offset:2048 sc1
s_nop 15
buffer_load_dwordx4 v[120:123],v0,s[20:23],s96 offen offset:2048 sc1
dlp_100671:
s_waitcnt vmcnt(2)
v_max3_u32 v124,v24,v25,v26
v_max_u32 v124,v124,v27
v_cmp_eq_u32 vcc,-1,v124
s_cbranch_vccz dgo_100670
buffer_load_dwordx4 v[24:27],v0,s[20:23],s96 offen offset:2048 sc1
s_waitcnt vmcnt(2)
v_max3_u32 v124,v116,v117,v118
v_max_u32 v124,v124,v119
v_cmp_eq_u32 vcc,-1,v124
s_cbranch_vccz dcp_100673
buffer_load_dwordx4 v[116:119],v0,s[20:23],s96 offen offset:2048 sc1
s_waitcnt vmcnt(2)
v_max3_u32 v124,v120,v121,v122
v_max_u32 v124,v124,v123
v_cmp_eq_u32 vcc,-1,v124
s_cbranch_vccz dcp_100674
buffer_load_dwordx4 v[120:123],v0,s[20:23],s96 offen offset:2048 sc1
s_sub_u32 s90,s90,1
s_cmp_gt_i32 s90,0
s_cbranch_scc1 dlp_100671
s_branch dgo_100670
dcp_100673:
v_mov_b32 v24,v116
v_mov_b32 v25,v117
v_mov_b32 v26,v118
v_mov_b32 v27,v119
s_nop 1
s_branch dgo_100670
dcp_100674:
v_mov_b32 v24,v120
v_mov_b32 v25,v121
v_mov_b32 v26,v122
v_mov_b32 v27,v123
s_nop 1
dgo_100670:
v_smfmac_f32_16x16x64_bf16 v[96:99],v[24:27],v[80:87],v1
v_smfmac_f32_16x16x64_bf16 v[100:103],v[24:27],v[88:95],v1
dsk_100669:
s_bitcmp1_b32 s55,3
s_cbranch_scc0 dsk_100675
s_waitcnt vmcnt(2)
v_max3_u32 v124,v28,v29,v30
v_max_u32 v124,v124,v31
v_cmp_eq_u32 vcc,-1,v124
s_cbranch_vccz dgo_100676
s_nop 15
buffer_load_dwordx4 v[116:119],v0,s[20:23],s96 offen offset:3072 sc1
s_nop 15
buffer_load_dwordx4 v[120:123],v0,s[20:23],s96 offen offset:3072 sc1
dlp_100677:
s_waitcnt vmcnt(2)
v_max3_u32 v124,v28,v29,v30
v_max_u32 v124,v124,v31
v_cmp_eq_u32 vcc,-1,v124
s_cbranch_vccz dgo_100676
buffer_load_dwordx4 v[28:31],v0,s[20:23],s96 offen offset:3072 sc1
s_waitcnt vmcnt(2)
v_max3_u32 v124,v116,v117,v118
v_max_u32 v124,v124,v119
v_cmp_eq_u32 vcc,-1,v124
s_cbranch_vccz dcp_100679
buffer_load_dwordx4 v[116:119],v0,s[20:23],s96 offen offset:3072 sc1
s_waitcnt vmcnt(2)
v_max3_u32 v124,v120,v121,v122
v_max_u32 v124,v124,v123
v_cmp_eq_u32 vcc,-1,v124
s_cbranch_vccz dcp_100680
buffer_load_dwordx4 v[120:123],v0,s[20:23],s96 offen offset:3072 sc1
s_sub_u32 s90,s90,1
s_cmp_gt_i32 s90,0
s_cbranch_scc1 dlp_100677
s_branch dgo_100676
dcp_100679:
v_mov_b32 v28,v116
v_mov_b32 v29,v117
v_mov_b32 v30,v118
v_mov_b32 v31,v119
s_nop 1
s_branch dgo_100676
dcp_100680:
v_mov_b32 v28,v120
v_mov_b32 v29,v121
v_mov_b32 v30,v122
v_mov_b32 v31,v123
s_nop 1
dgo_100676:
v_smfmac_f32_16x16x64_bf16 v[96:99],v[28:31],v[128:135],v1
v_smfmac_f32_16x16x64_bf16 v[100:103],v[28:31],v[136:143],v1
dsk_100675:
s_bitcmp1_b32 s55,4
s_cbranch_scc0 dsk_100681
s_waitcnt vmcnt(2)
v_max3_u32 v124,v32,v33,v34
v_max_u32 v124,v124,v35
v_cmp_eq_u32 vcc,-1,v124
s_cbranch_vccz dgo_100682
s_nop 15
buffer_load_dwordx4 v[116:119],v0,s[20:23],s97 offen offset:0 sc1
s_nop 15
buffer_load_dwordx4 v[120:123],v0,s[20:23],s97 offen offset:0 sc1
dlp_100683:
s_waitcnt vmcnt(2)
v_max3_u32 v124,v32,v33,v34
v_max_u32 v124,v124,v35
v_cmp_eq_u32 vcc,-1,v124
s_cbranch_vccz dgo_100682
buffer_load_dwordx4 v[32:35],v0,s[20:23],s97 offen offset:0 sc1
s_waitcnt vmcnt(2)
v_max3_u32 v124,v116,v117,v118
v_max_u32 v124,v124,v119
v_cmp_eq_u32 vcc,-1,v124
s_cbranch_vccz dcp_100685
buffer_load_dwordx4 v[116:119],v0,s[20:23],s97 offen offset:0 sc1
s_waitcnt vmcnt(2)
v_max3_u32 v124,v120,v121,v122
v_max_u32 v124,v124,v123
v_cmp_eq_u32 vcc,-1,v124
s_cbranch_vccz dcp_100686
buffer_load_dwordx4 v[120:123],v0,s[20:23],s97 offen offset:0 sc1
s_sub_u32 s90,s90,1
s_cmp_gt_i32 s90,0
s_cbranch_scc1 dlp_100683
s_branch dgo_100682
dcp_100685:
v_mov_b32 v32,v116
v_mov_b32 v33,v117
v_mov_b32 v34,v118
v_mov_b32 v35,v119
s_nop 1
s_branch dgo_100682
dcp_100686:
v_mov_b32 v32,v120
v_mov_b32 v33,v121
v_mov_b32 v34,v122
v_mov_b32 v35,v123
s_nop 1
dgo_100682:
v_smfmac_f32_16x16x64_bf16 v[96:99],v[32:35],v[144:151],v1
v_smfmac_f32_16x16x64_bf16 v[100:103],v[32:35],v[152:159],v1
dsk_100681:
s_bitcmp1_b32 s55,5
s_cbranch_scc0 dsk_100687
s_waitcnt vmcnt(2)
v_max3_u32 v124,v36,v37,v38
v_max_u32 v124,v124,v39
v_cmp_eq_u32 vcc,-1,v124
s_cbranch_vccz dgo_100688
s_nop 15
buffer_load_dwordx4 v[116:119],v0,s[20:23],s97 offen offset:1024 sc1
s_nop 15
buffer_load_dwordx4 v[120:123],v0,s[20:23],s97 offen offset:1024 sc1
dlp_100689:
s_waitcnt vmcnt(2)
v_max3_u32 v124,v36,v37,v38
v_max_u32 v124,v124,v39
v_cmp_eq_u32 vcc,-1,v124
s_cbranch_vccz dgo_100688
buffer_load_dwordx4 v[36:39],v0,s[20:23],s97 offen offset:1024 sc1
s_waitcnt vmcnt(2)
v_max3_u32 v124,v116,v117,v118
v_max_u32 v124,v124,v119
v_cmp_eq_u32 vcc,-1,v124
s_cbranch_vccz dcp_100691
buffer_load_dwordx4 v[116:119],v0,s[20:23],s97 offen offset:1024 sc1
s_waitcnt vmcnt(2)
v_max3_u32 v124,v120,v121,v122
v_max_u32 v124,v124,v123
v_cmp_eq_u32 vcc,-1,v124
s_cbranch_vccz dcp_100692
buffer_load_dwordx4 v[120:123],v0,s[20:23],s97 offen offset:1024 sc1
s_sub_u32 s90,s90,1
s_cmp_gt_i32 s90,0
s_cbranch_scc1 dlp_100689
s_branch dgo_100688
dcp_100691:
v_mov_b32 v36,v116
v_mov_b32 v37,v117
v_mov_b32 v38,v118
v_mov_b32 v39,v119
s_nop 1
s_branch dgo_100688
dcp_100692:
v_mov_b32 v36,v120
v_mov_b32 v37,v121
v_mov_b32 v38,v122
v_mov_b32 v39,v123
s_nop 1
dgo_100688:
v_smfmac_f32_16x16x64_bf16 v[96:99],v[36:39],v[160:167],v1
v_smfmac_f32_16x16x64_bf16 v[100:103],v[36:39],v[168:175],v1
dsk_100687:
s_bitcmp1_b32 s55,6
s_cbranch_scc0 dsk_100693
s_waitcnt vmcnt(2)
v_max3_u32 v124,v40,v41,v42
v_max_u32 v124,v124,v43
v_cmp_eq_u32 vcc,-1,v124
s_cbranch_vccz dgo_100694
s_nop 15
buffer_load_dwordx4 v[116:119],v0,s[20:23],s97 offen offset:2048 sc1
s_nop 15
buffer_load_dwordx4 v[120:123],v0,s[20:23],s97 offen offset:2048 sc1
dlp_100695:
s_waitcnt vmcnt(2)
v_max3_u32 v124,v40,v41,v42
v_max_u32 v124,v124,v43
v_cmp_eq_u32 vcc,-1,v124
s_cbranch_vccz dgo_100694
buffer_load_dwordx4 v[40:43],v0,s[20:23],s97 offen offset:2048 sc1
s_waitcnt vmcnt(2)
v_max3_u32 v124,v116,v117,v118
v_max_u32 v124,v124,v119
v_cmp_eq_u32 vcc,-1,v124
s_cbranch_vccz dcp_100697
buffer_load_dwordx4 v[116:119],v0,s[20:23],s97 offen offset:2048 sc1
s_waitcnt vmcnt(2)
v_max3_u32 v124,v120,v121,v122
v_max_u32 v124,v124,v123
v_cmp_eq_u32 vcc,-1,v124
s_cbranch_vccz dcp_100698
buffer_load_dwordx4 v[120:123],v0,s[20:23],s97 offen offset:2048 sc1
s_sub_u32 s90,s90,1
s_cmp_gt_i32 s90,0
s_cbranch_scc1 dlp_100695
s_branch dgo_100694
dcp_100697:
v_mov_b32 v40,v116
v_mov_b32 v41,v117
v_mov_b32 v42,v118
v_mov_b32 v43,v119
s_nop 1
s_branch dgo_100694
dcp_100698:
v_mov_b32 v40,v120
v_mov_b32 v41,v121
v_mov_b32 v42,v122
v_mov_b32 v43,v123
s_nop 1
dgo_100694:
v_smfmac_f32_16x16x64_bf16 v[96:99],v[40:43],v[176:183],v1
v_smfmac_f32_16x16x64_bf16 v[100:103],v[40:43],v[184:191],v1
dsk_100693:
s_bitcmp1_b32 s55,7
s_cbranch_scc0 dsk_100699
s_waitcnt vmcnt(2)
v_max3_u32 v124,v44,v45,v46
v_max_u32 v124,v124,v47
v_cmp_eq_u32 vcc,-1,v124
s_cbranch_vccz dgo_100700
s_nop 15
buffer_load_dwordx4 v[116:119],v0,s[20:23],s97 offen offset:3072 sc1
s_nop 15
buffer_load_dwordx4 v[120:123],v0,s[20:23],s97 offen offset:3072 sc1
dlp_100701:
s_waitcnt vmcnt(2)
v_max3_u32 v124,v44,v45,v46
v_max_u32 v124,v124,v47
v_cmp_eq_u32 vcc,-1,v124
s_cbranch_vccz dgo_100700
buffer_load_dwordx4 v[44:47],v0,s[20:23],s97 offen offset:3072 sc1
s_waitcnt vmcnt(2)
v_max3_u32 v124,v116,v117,v118
v_max_u32 v124,v124,v119
v_cmp_eq_u32 vcc,-1,v124
s_cbranch_vccz dcp_100703
buffer_load_dwordx4 v[116:119],v0,s[20:23],s97 offen offset:3072 sc1
s_waitcnt vmcnt(2)
v_max3_u32 v124,v120,v121,v122
v_max_u32 v124,v124,v123
v_cmp_eq_u32 vcc,-1,v124
s_cbranch_vccz dcp_100704
buffer_load_dwordx4 v[120:123],v0,s[20:23],s97 offen offset:3072 sc1
s_sub_u32 s90,s90,1
s_cmp_gt_i32 s90,0
s_cbranch_scc1 dlp_100701
s_branch dgo_100700
dcp_100703:
v_mov_b32 v44,v116
v_mov_b32 v45,v117
v_mov_b32 v46,v118
v_mov_b32 v47,v119
s_nop 1
s_branch dgo_100700
dcp_100704:
v_mov_b32 v44,v120
v_mov_b32 v45,v121
v_mov_b32 v46,v122
v_mov_b32 v47,v123
s_nop 1
dgo_100700:
v_smfmac_f32_16x16x64_bf16 v[96:99],v[44:47],v[192:199],v1
v_smfmac_f32_16x16x64_bf16 v[100:103],v[44:47],v[200:207],v1
dsk_100699:
s_mov_b32 s55,0
s_branch oback_100479
fl_100496:
flb_100504:
buffer_load_dwordx4 v[16:19],v0,s[20:23],s92 offen offset:0 sc1
s_mov_b32 s55,1
buffer_load_dwordx4 v[32:35],v0,s[20:23],s93 offen offset:0 sc1
s_waitcnt vmcnt(4)
v_max3_u32 v124,v20,v21,v22
v_max_u32 v124,v124,v23
v_cmp_eq_u32 vcc,-1,v124
s_cbranch_vccnz dfl_100705
v_smfmac_f32_16x16x64_bf16 v[64:67],v[20:23],a[96:103],v1
buffer_load_dword v125,off,s[20:23],s92 sc1
buffer_load_dwordx4 v[36:39],v0,s[20:23],s93 offen offset:1024 sc1
s_waitcnt vmcnt(5)
v_max3_u32 v124,v24,v25,v26
v_smfmac_f32_16x16x64_bf16 v[68:71],v[20:23],a[104:111],v1
v_max_u32 v124,v124,v27
v_cmp_eq_u32 vcc,-1,v124
v_smfmac_f32_16x16x64_bf16 v[72:75],v[20:23],a[112:119],v1
v_smfmac_f32_16x16x64_bf16 v[76:79],v[20:23],a[120:127],v1
s_cbranch_vccnz dfl_100706
v_smfmac_f32_16x16x64_bf16 v[64:67],v[24:27],a[160:167],v1
buffer_load_dword v125,off,s[20:23],s92 sc1
buffer_load_dwordx4 v[40:43],v0,s[20:23],s93 offen offset:2048 sc1
buffer_load_dwordx4 v[44:47],v0,s[20:23],s93 offen offset:3072 sc1
s_waitcnt vmcnt(7)
v_max3_u32 v124,v28,v29,v30
v_smfmac_f32_16x16x64_bf16 v[68:71],v[24:27],a[168:175],v1
v_max_u32 v124,v124,v31
v_cmp_eq_u32 vcc,-1,v124
v_smfmac_f32_16x16x64_bf16 v[72:75],v[24:27],a[176:183],v1
v_smfmac_f32_16x16x64_bf16 v[76:79],v[24:27],a[184:191],v1
s_cbranch_vccnz dfl_100707
v_smfmac_f32_16x16x64_bf16 v[64:67],v[28:31],a[224:231],v1
buffer_load_dword v125,off,s[20:23],s92 sc1
buffer_store_dword v126,v121,s[20:23],s69 offen sc1
s_waitcnt vmcnt(8)
v_max3_u32 v124,v16,v17,v18
v_smfmac_f32_16x16x64_bf16 v[68:71],v[28:31],a[232:239],v1
v_max_u32 v124,v124,v19
v_cmp_eq_u32 vcc,-1,v124
v_smfmac_f32_16x16x64_bf16 v[72:75],v[28:31],a[240:247],v1
v_smfmac_f32_16x16x64_bf16 v[76:79],v[28:31],a[248:255],v1
s_cbranch_vccnz lfb_100712
s_mov_b32 s55,0
v_smfmac_f32_16x16x64_bf16 v[64:67],v[16:19],a[32:39],v1
s_waitcnt vmcnt(7)
v_max3_u32 v124,v32,v33,v34
v_max_u32 v124,v124,v35
v_cmp_eq_u32 vcc,-1,v124
v_smfmac_f32_16x16x64_bf16 v[68:71],v[16:19],a[40:47],v1
v_smfmac_f32_16x16x64_bf16 v[72:75],v[16:19],a[48:55],v1
v_smfmac_f32_16x16x64_bf16 v[76:79],v[16:19],a[56:63],v1
s_cbranch_vccnz flb_100508
s_branch segb_100492
fl_100497:
flb_100505:
buffer_load_dwordx4 v[20:23],v0,s[20:23],s92 offen offset:1024 sc1
s_mov_b32 s55,2
buffer_load_dwordx4 v[36:39],v0,s[20:23],s93 offen offset:1024 sc1
s_waitcnt vmcnt(5)
v_max3_u32 v124,v24,v25,v26
v_max_u32 v124,v124,v27
v_cmp_eq_u32 vcc,-1,v124
s_cbranch_vccnz dfl_100706
v_smfmac_f32_16x16x64_bf16 v[64:67],v[24:27],a[160:167],v1
buffer_load_dword v125,off,s[20:23],s92 sc1
buffer_load_dwordx4 v[40:43],v0,s[20:23],s93 offen offset:2048 sc1
buffer_load_dwordx4 v[44:47],v0,s[20:23],s93 offen offset:3072 sc1
s_waitcnt vmcnt(7)
v_max3_u32 v124,v28,v29,v30
v_smfmac_f32_16x16x64_bf16 v[68:71],v[24:27],a[168:175],v1
v_max_u32 v124,v124,v31
v_cmp_eq_u32 vcc,-1,v124
v_smfmac_f32_16x16x64_bf16 v[72:75],v[24:27],a[176:183],v1
v_smfmac_f32_16x16x64_bf16 v[76:79],v[24:27],a[184:191],v1
s_cbranch_vccnz dfl_100707
v_smfmac_f32_16x16x64_bf16 v[64:67],v[28:31],a[224:231],v1
buffer_load_dword v125,off,s[20:23],s92 sc1
buffer_store_dword v126,v121,s[20:23],s69 offen sc1
s_waitcnt vmcnt(6)
v_max3_u32 v124,v20,v21,v22
v_smfmac_f32_16x16x64_bf16 v[68:71],v[28:31],a[232:239],v1
v_max_u32 v124,v124,v23
v_cmp_eq_u32 vcc,-1,v124
v_smfmac_f32_16x16x64_bf16 v[72:75],v[28:31],a[240:247],v1
v_smfmac_f32_16x16x64_bf16 v[76:79],v[28:31],a[248:255],v1
s_cbranch_vccnz lfb_100712
s_mov_b32 s55,0
v_smfmac_f32_16x16x64_bf16 v[64:67],v[20:23],a[96:103],v1
s_waitcnt vmcnt(7)
v_max3_u32 v124,v32,v33,v34
v_max_u32 v124,v124,v35
v_cmp_eq_u32 vcc,-1,v124
v_smfmac_f32_16x16x64_bf16 v[68:71],v[20:23],a[104:111],v1
v_smfmac_f32_16x16x64_bf16 v[72:75],v[20:23],a[112:119],v1
v_smfmac_f32_16x16x64_bf16 v[76:79],v[20:23],a[120:127],v1
s_cbranch_vccnz flb_100508
s_branch segb_100492
fl_100498:
flb_100506:
buffer_load_dwordx4 v[24:27],v0,s[20:23],s92 offen offset:2048 sc1
s_mov_b32 s55,4
buffer_load_dwordx4 v[40:43],v0,s[20:23],s93 offen offset:2048 sc1
buffer_load_dwordx4 v[44:47],v0,s[20:23],s93 offen offset:3072 sc1
s_waitcnt vmcnt(7)
v_max3_u32 v124,v28,v29,v30
v_max_u32 v124,v124,v31
v_cmp_eq_u32 vcc,-1,v124
s_cbranch_vccnz dfl_100707
v_smfmac_f32_16x16x64_bf16 v[64:67],v[28:31],a[224:231],v1
buffer_load_dword v125,off,s[20:23],s92 sc1
buffer_store_dword v126,v121,s[20:23],s69 offen sc1
s_waitcnt vmcnt(4)
v_max3_u32 v124,v24,v25,v26
v_smfmac_f32_16x16x64_bf16 v[68:71],v[28:31],a[232:239],v1
v_max_u32 v124,v124,v27
v_cmp_eq_u32 vcc,-1,v124
v_smfmac_f32_16x16x64_bf16 v[72:75],v[28:31],a[240:247],v1
v_smfmac_f32_16x16x64_bf16 v[76:79],v[28:31],a[248:255],v1
s_cbranch_vccnz lfb_100712
s_mov_b32 s55,0
v_smfmac_f32_16x16x64_bf16 v[64:67],v[24:27],a[160:167],v1
s_waitcnt vmcnt(7)
v_max3_u32 v124,v32,v33,v34
v_max_u32 v124,v124,v35
v_cmp_eq_u32 vcc,-1,v124
v_smfmac_f32_16x16x64_bf16 v[68:71],v[24:27],a[168:175],v1
v_smfmac_f32_16x16x64_bf16 v[72:75],v[24:27],a[176:183],v1
v_smfmac_f32_16x16x64_bf16 v[76:79],v[24:27],a[184:191],v1
s_cbranch_vccnz flb_100508
s_branch segb_100492
fl_100499:
flb_100507:
buffer_load_dwordx4 v[28:31],v0,s[20:23],s92 offen offset:3072 sc1
s_mov_b32 s55,8
buffer_store_dword v126,v121,s[20:23],s69 offen sc1
s_waitcnt vmcnt(1)
v_max3_u32 v124,v28,v29,v30
v_max_u32 v124,v124,v31
v_cmp_eq_u32 vcc,-1,v124
s_cbranch_vccnz lfb_100712
s_mov_b32 s55,0
v_smfmac_f32_16x16x64_bf16 v[64:67],v[28:31],a[224:231],v1
s_waitcnt vmcnt(7)
v_max3_u32 v124,v32,v33,v34
v_max_u32 v124,v124,v35
v_cmp_eq_u32 vcc,-1,v124
v_smfmac_f32_16x16x64_bf16 v[68:71],v[28:31],a[232:239],v1
v_smfmac_f32_16x16x64_bf16 v[72:75],v[28:31],a[240:247],v1
v_smfmac_f32_16x16x64_bf16 v[76:79],v[28:31],a[248:255],v1
s_cbranch_vccnz flb_100508
s_branch segb_100492
fl_100500:
flb_100508:
buffer_load_dwordx4 v[32:35],v0,s[20:23],s93 offen offset:0 sc1
s_mov_b32 s55,240
s_bitcmp1_b32 s55,5
s_cbranch_scc0 rdn_100715
s_waitcnt vmcnt(6)
v_max3_u32 v124,v36,v37,v38
v_max_u32 v124,v124,v39
v_cmp_eq_u32 vcc,-1,v124
s_cbranch_vccnz rfa_100716
buffer_load_dword v125,off,s[20:23],s92 sc1
s_bitset0_b32 s55,5
v_smfmac_f32_16x16x64_bf16 v[64:67],v[36:39],a[96:103],v1
v_smfmac_f32_16x16x64_bf16 v[68:71],v[36:39],a[104:111],v1
v_smfmac_f32_16x16x64_bf16 v[72:75],v[36:39],a[112:119],v1
v_smfmac_f32_16x16x64_bf16 v[76:79],v[36:39],a[120:127],v1
s_cmp_eq_u32 s55,0
s_cbranch_scc1 segb_100494
s_branch rnx_100717
rdn_100715:
buffer_load_dword v125,off,s[20:23],s92 sc1
s_branch rnx_100717
rfa_100716:
buffer_load_dwordx4 v[36:39],v0,s[20:23],s93 offen offset:1024 sc1
rnx_100717:
s_bitcmp1_b32 s55,6
s_cbranch_scc0 rdn_100718
s_waitcnt vmcnt(5)
v_max3_u32 v124,v40,v41,v42
v_max_u32 v124,v124,v43
v_cmp_eq_u32 vcc,-1,v124
s_cbranch_vccnz rfa_100719
buffer_load_dword v125,off,s[20:23],s92 sc1
s_bitset0_b32 s55,6
s_cmp_eq_u32 s55,0
s_cbranch_scc1 segb_100494
s_branch rnx_100720
rdn_100718:
buffer_load_dword v125,off,s[20:23],s92 sc1
s_branch rnx_100720
rfa_100719:
buffer_load_dwordx4 v[40:43],v0,s[20:23],s93 offen offset:2048 sc1
rnx_100720:
s_bitcmp1_b32 s55,7
s_cbranch_scc0 rdn_100721
s_waitcnt vmcnt(5)
v_max3_u32 v124,v44,v45,v46
v_max_u32 v124,v124,v47
v_cmp_eq_u32 vcc,-1,v124
s_cbranch_vccnz rfa_100722
buffer_load_dword v125,off,s[20:23],s92 sc1
s_bitset0_b32 s55,7
s_cmp_eq_u32 s55,0
s_cbranch_scc1 segb_100494
s_branch rnx_100723
rdn_100721:
buffer_load_dword v125,off,s[20:23],s92 sc1
s_branch rnx_100723
rfa_100722:
buffer_load_dwordx4 v[44:47],v0,s[20:23],s93 offen offset:3072 sc1
rnx_100723:
rot_100714:
s_bitcmp1_b32 s55,4
s_cbranch_scc0 rdn_100724
s_waitcnt vmcnt(3)
v_max3_u32 v124,v32,v33,v34
v_max_u32 v124,v124,v35
v_cmp_eq_u32 vcc,-1,v124
s_cbranch_vccnz rfa_100725
buffer_load_dword v125,off,s[20:23],s92 sc1
s_bitset0_b32 s55,4
v_smfmac_f32_16x16x64_bf16 v[64:67],v[32:35],a[32:39],v1
v_smfmac_f32_16x16x64_bf16 v[68:71],v[32:35],a[40:47],v1
v_smfmac_f32_16x16x64_bf16 v[72:75],v[32:35],a[48:55],v1
v_smfmac_f32_16x16x64_bf16 v[76:79],v[32:35],a[56:63],v1
s_cmp_eq_u32 s55,0
s_cbranch_scc1 segb_100494
s_branch rnx_100726
rdn_100724:
buffer_load_dword v125,off,s[20:23],s92 sc1
s_branch rnx_100726
rfa_100725:
buffer_load_dwordx4 v[32:35],v0,s[20:23],s93 offen offset:0 sc1
rnx_100726:
s_bitcmp1_b32 s55,5
s_cbranch_scc0 rdn_100727
s_waitcnt vmcnt(3)
v_max3_u32 v124,v36,v37,v38
v_max_u32 v124,v124,v39
v_cmp_eq_u32 vcc,-1,v124
s_cbranch_vccnz rfa_100728
buffer_load_dword v125,off,s[20:23],s92 sc1
s_bitset0_b32 s55,5
v_smfmac_f32_16x16x64_bf16 v[64:67],v[36:39],a[96:103],v1
v_smfmac_f32_16x16x64_bf16 v[68:71],v[36:39],a[104:111],v1
v_smfmac_f32_16x16x64_bf16 v[72:75],v[36:39],a[112:119],v1
v_smfmac_f32_16x16x64_bf16 v[76:79],v[36:39],a[120:127],v1
s_cmp_eq_u32 s55,0
s_cbranch_scc1 segb_100494
s_branch rnx_100729
rdn_100727:
buffer_load_dword v125,off,s[20:23],s92 sc1
s_branch rnx_100729
rfa_100728:
buffer_load_dwordx4 v[36:39],v0,s[20:23],s93 offen offset:1024 sc1
rnx_100729:
s_bitcmp1_b32 s55,6
s_cbranch_scc0 rdn_100730
s_waitcnt vmcnt(3)
v_max3_u32 v124,v40,v41,v42
v_max_u32 v124,v124,v43
v_cmp_eq_u32 vcc,-1,v124
s_cbranch_vccnz rfa_100731
buffer_load_dword v125,off,s[20:23],s92 sc1
s_bitset0_b32 s55,6
s_cmp_eq_u32 s55,0
s_cbranch_scc1 segb_100494
s_branch rnx_100732
rdn_100730:
buffer_load_dword v125,off,s[20:23],s92 sc1
s_branch rnx_100732
rfa_100731:
buffer_load_dwordx4 v[40:43],v0,s[20:23],s93 offen offset:2048 sc1
rnx_100732:
s_bitcmp1_b32 s55,7
s_cbranch_scc0 rdn_100733
s_waitcnt vmcnt(3)
v_max3_u32 v124,v44,v45,v46
v_max_u32 v124,v124,v47
v_cmp_eq_u32 vcc,-1,v124
s_cbranch_vccnz rfa_100734
buffer_load_dword v125,off,s[20:23],s92 sc1
s_bitset0_b32 s55,7
s_cmp_eq_u32 s55,0
s_cbranch_scc1 segb_100494
s_branch rnx_100735
rdn_100733:
buffer_load_dword v125,off,s[20:23],s92 sc1
s_branch rnx_100735
rfa_100734:
buffer_load_dwordx4 v[44:47],v0,s[20:23],s93 offen offset:3072 sc1
rnx_100735:
s_sub_u32 s90,s90,1
s_cmp_gt_i32 s90,0
s_cbranch_scc1 rot_100714
s_mov_b32 s55,0
s_branch segb_100494
fl_100501:
flb_100509:
buffer_load_dwordx4 v[36:39],v0,s[20:23],s93 offen offset:1024 sc1
s_mov_b32 s55,224
s_bitcmp1_b32 s55,6
s_cbranch_scc0 rdn_100737
s_waitcnt vmcnt(5)
v_max3_u32 v124,v40,v41,v42
v_max_u32 v124,v124,v43
v_cmp_eq_u32 vcc,-1,v124
s_cbranch_vccnz rfa_100738
buffer_load_dword v125,off,s[20:23],s92 sc1
s_bitset0_b32 s55,6
s_cmp_eq_u32 s55,0
s_cbranch_scc1 segb_100494
s_branch rnx_100739
rdn_100737:
buffer_load_dword v125,off,s[20:23],s92 sc1
s_branch rnx_100739
rfa_100738:
buffer_load_dwordx4 v[40:43],v0,s[20:23],s93 offen offset:2048 sc1
rnx_100739:
s_bitcmp1_b32 s55,7
s_cbranch_scc0 rdn_100740
s_waitcnt vmcnt(5)
v_max3_u32 v124,v44,v45,v46
v_max_u32 v124,v124,v47
v_cmp_eq_u32 vcc,-1,v124
s_cbranch_vccnz rfa_100741
buffer_load_dword v125,off,s[20:23],s92 sc1
s_bitset0_b32 s55,7
s_cmp_eq_u32 s55,0
s_cbranch_scc1 segb_100494
s_branch rnx_100742
rdn_100740:
buffer_load_dword v125,off,s[20:23],s92 sc1
s_branch rnx_100742
rfa_100741:
buffer_load_dwordx4 v[44:47],v0,s[20:23],s93 offen offset:3072 sc1
rnx_100742:
rot_100736:
s_bitcmp1_b32 s55,5
s_cbranch_scc0 rdn_100743
s_waitcnt vmcnt(2)
v_max3_u32 v124,v36,v37,v38
v_max_u32 v124,v124,v39
v_cmp_eq_u32 vcc,-1,v124
s_cbranch_vccnz rfa_100744
buffer_load_dword v125,off,s[20:23],s92 sc1
s_bitset0_b32 s55,5
v_smfmac_f32_16x16x64_bf16 v[64:67],v[36:39],a[96:103],v1
v_smfmac_f32_16x16x64_bf16 v[68:71],v[36:39],a[104:111],v1
v_smfmac_f32_16x16x64_bf16 v[72:75],v[36:39],a[112:119],v1
v_smfmac_f32_16x16x64_bf16 v[76:79],v[36:39],a[120:127],v1
s_cmp_eq_u32 s55,0
s_cbranch_scc1 segb_100494
s_branch rnx_100745
rdn_100743:
buffer_load_dword v125,off,s[20:23],s92 sc1
s_branch rnx_100745
rfa_100744:
buffer_load_dwordx4 v[36:39],v0,s[20:23],s93 offen offset:1024 sc1
rnx_100745:
s_bitcmp1_b32 s55,6
s_cbranch_scc0 rdn_100746
s_waitcnt vmcnt(2)
v_max3_u32 v124,v40,v41,v42
v_max_u32 v124,v124,v43
v_cmp_eq_u32 vcc,-1,v124
s_cbranch_vccnz rfa_100747
buffer_load_dword v125,off,s[20:23],s92 sc1
s_bitset0_b32 s55,6
s_cmp_eq_u32 s55,0
s_cbranch_scc1 segb_100494
s_branch rnx_100748
rdn_100746:
buffer_load_dword v125,off,s[20:23],s92 sc1
s_branch rnx_100748
rfa_100747:
buffer_load_dwordx4 v[40:43],v0,s[20:23],s93 offen offset:2048 sc1
rnx_100748:
s_bitcmp1_b32 s55,7
s_cbranch_scc0 rdn_100749
s_waitcnt vmcnt(2)
v_max3_u32 v124,v44,v45,v46
v_max_u32 v124,v124,v47
v_cmp_eq_u32 vcc,-1,v124
s_cbranch_vccnz rfa_100750
buffer_load_dword v125,off,s[20:23],s92 sc1
s_bitset0_b32 s55,7
s_cmp_eq_u32 s55,0
s_cbranch_scc1 segb_100494
s_branch rnx_100751
rdn_100749:
buffer_load_dword v125,off,s[20:23],s92 sc1
s_branch rnx_100751
rfa_100750:
buffer_load_dwordx4 v[44:47],v0,s[20:23],s93 offen offset:3072 sc1
rnx_100751:
s_sub_u32 s90,s90,1
s_cmp_gt_i32 s90,0
s_cbranch_scc1 rot_100736
s_mov_b32 s55,0
s_branch segb_100494
fl_100502:
flb_100510:
s_mov_b32 s55,192
s_bitcmp1_b32 s55,6
s_cbranch_scc0 rdn_100753
s_waitcnt vmcnt(5)
v_max3_u32 v124,v40,v41,v42
v_max_u32 v124,v124,v43
v_cmp_eq_u32 vcc,-1,v124
s_cbranch_vccnz rfa_100754
buffer_load_dword v125,off,s[20:23],s92 sc1
s_bitset0_b32 s55,6
s_cmp_eq_u32 s55,0
s_cbranch_scc1 segb_100494
s_branch rnx_100755
rdn_100753:
buffer_load_dword v125,off,s[20:23],s92 sc1
s_branch rnx_100755
rfa_100754:
buffer_load_dwordx4 v[40:43],v0,s[20:23],s93 offen offset:2048 sc1
rnx_100755:
s_bitcmp1_b32 s55,7
s_cbranch_scc0 rdn_100756
s_waitcnt vmcnt(5)
v_max3_u32 v124,v44,v45,v46
v_max_u32 v124,v124,v47
v_cmp_eq_u32 vcc,-1,v124
s_cbranch_vccnz rfa_100757
buffer_load_dword v125,off,s[20:23],s92 sc1
s_bitset0_b32 s55,7
s_cmp_eq_u32 s55,0
s_cbranch_scc1 segb_100494
s_branch rnx_100758
rdn_100756:
buffer_load_dword v125,off,s[20:23],s92 sc1
s_branch rnx_100758
rfa_100757:
buffer_load_dwordx4 v[44:47],v0,s[20:23],s93 offen offset:3072 sc1
rnx_100758:
rot_100752:
s_bitcmp1_b32 s55,6
s_cbranch_scc0 rdn_100759
s_waitcnt vmcnt(1)
v_max3_u32 v124,v40,v41,v42
v_max_u32 v124,v124,v43
v_cmp_eq_u32 vcc,-1,v124
s_cbranch_vccnz rfa_100760
buffer_load_dword v125,off,s[20:23],s92 sc1
s_bitset0_b32 s55,6
s_cmp_eq_u32 s55,0
s_cbranch_scc1 segb_100494
s_branch rnx_100761
rdn_100759:
buffer_load_dword v125,off,s[20:23],s92 sc1
s_branch rnx_100761
rfa_100760:
buffer_load_dwordx4 v[40:43],v0,s[20:23],s93 offen offset:2048 sc1
rnx_100761:
s_bitcmp1_b32 s55,7
s_cbranch_scc0 rdn_100762
s_waitcnt vmcnt(1)
v_max3_u32 v124,v44,v45,v46
v_max_u32 v124,v124,v47
v_cmp_eq_u32 vcc,-1,v124
s_cbranch_vccnz rfa_100763
buffer_load_dword v125,off,s[20:23],s92 sc1
s_bitset0_b32 s55,7
s_cmp_eq_u32 s55,0
s_cbranch_scc1 segb_100494
s_branch rnx_100764
rdn_100762:
buffer_load_dword v125,off,s[20:23],s92 sc1
s_branch rnx_100764
rfa_100763:
buffer_load_dwordx4 v[44:47],v0,s[20:23],s93 offen offset:3072 sc1
rnx_100764:
s_sub_u32 s90,s90,1
s_cmp_gt_i32 s90,0
s_cbranch_scc1 rot_100752
s_mov_b32 s55,0
s_branch segb_100494
dfl_100705:
buffer_load_dwordx4 v[20:23],v0,s[20:23],s92 offen offset:1024 sc1
s_bitset1_b32 s55,1
buffer_load_dwordx4 v[36:39],v0,s[20:23],s93 offen offset:1024 sc1
s_waitcnt vmcnt(5)
v_max3_u32 v124,v24,v25,v26
v_max_u32 v124,v124,v27
v_cmp_eq_u32 vcc,-1,v124
s_cbranch_vccnz dfl_100706
s_branch dseg_100709
dfl_100706:
buffer_load_dwordx4 v[24:27],v0,s[20:23],s92 offen offset:2048 sc1
s_bitset1_b32 s55,2
buffer_load_dwordx4 v[40:43],v0,s[20:23],s93 offen offset:2048 sc1
buffer_load_dwordx4 v[44:47],v0,s[20:23],s93 offen offset:3072 sc1
s_waitcnt vmcnt(7)
v_max3_u32 v124,v28,v29,v30
v_max_u32 v124,v124,v31
v_cmp_eq_u32 vcc,-1,v124
s_cbranch_vccnz dfl_100707
s_branch dseg_100710
dfl_100707:
buffer_load_dwordx4 v[28:31],v0,s[20:23],s92 offen offset:3072 sc1
s_bitset1_b32 s55,3
buffer_store_dword v126,v121,s[20:23],s69 offen sc1
s_branch lap2_100711
dseg_100709:
v_smfmac_f32_16x16x64_bf16 v[64:67],v[24:27],a[160:167],v1
buffer_load_dword v125,off,s[20:23],s92 sc1
buffer_load_dwordx4 v[40:43],v0,s[20:23],s93 offen offset:2048 sc1
buffer_load_dwordx4 v[44:47],v0,s[20:23],s93 offen offset:3072 sc1
s_waitcnt vmcnt(7)
v_max3_u32 v124,v28,v29,v30
v_smfmac_f32_16x16x64_bf16 v[68:71],v[24:27],a[168:175],v1
v_max_u32 v124,v124,v31
v_cmp_eq_u32 vcc,-1,v124
v_smfmac_f32_16x16x64_bf16 v[72:75],v[24:27],a[176:183],v1
v_smfmac_f32_16x16x64_bf16 v[76:79],v[24:27],a[184:191],v1
s_cbranch_vccnz dfl_100707
dseg_100710:
v_smfmac_f32_16x16x64_bf16 v[64:67],v[28:31],a[224:231],v1
buffer_load_dword v125,off,s[20:23],s92 sc1
v_smfmac_f32_16x16x64_bf16 v[68:71],v[28:31],a[232:239],v1
buffer_store_dword v126,v121,s[20:23],s69 offen sc1
v_smfmac_f32_16x16x64_bf16 v[72:75],v[28:31],a[240:247],v1
v_smfmac_f32_16x16x64_bf16 v[76:79],v[28:31],a[248:255],v1
lap2_100711:
s_bitcmp1_b32 s55,0
s_cbranch_scc0 l2s_100765
s_waitcnt vmcnt(8)
v_max3_u32 v124,v16,v17,v18
v_max_u32 v124,v124,v19
v_cmp_eq_u32 vcc,-1,v124
s_cbranch_vccnz l2s_100765
s_bitset0_b32 s55,0
v_smfmac_f32_16x16x64_bf16 v[64:67],v[16:19],a[32:39],v1
v_smfmac_f32_16x16x64_bf16 v[68:71],v[16:19],a[40:47],v1
v_smfmac_f32_16x16x64_bf16 v[72:75],v[16:19],a[48:55],v1
v_smfmac_f32_16x16x64_bf16 v[76:79],v[16:19],a[56:63],v1
l2s_100765:
s_bitcmp1_b32 s55,1
s_cbranch_scc0 l2s_100767
s_waitcnt vmcnt(6)
v_max3_u32 v124,v20,v21,v22
v_max_u32 v124,v124,v23
v_cmp_eq_u32 vcc,-1,v124
s_cbranch_vccnz l2s_100767
s_bitset0_b32 s55,1
v_smfmac_f32_16x16x64_bf16 v[64:67],v[20:23],a[96:103],v1
v_smfmac_f32_16x16x64_bf16 v[68:71],v[20:23],a[104:111],v1
v_smfmac_f32_16x16x64_bf16 v[72:75],v[20:23],a[112:119],v1
v_smfmac_f32_16x16x64_bf16 v[76:79],v[20:23],a[120:127],v1
l2s_100767:
s_bitcmp1_b32 s55,2
s_cbranch_scc0 l2s_100769
s_waitcnt vmcnt(4)
v_max3_u32 v124,v24,v25,v26
v_max_u32 v124,v124,v27
v_cmp_eq_u32 vcc,-1,v124
s_cbranch_vccnz l2s_100769
s_bitset0_b32 s55,2
v_smfmac_f32_16x16x64_bf16 v[64:67],v[24:27],a[160:167],v1
v_smfmac_f32_16x16x64_bf16 v[68:71],v[24:27],a[168:175],v1
v_smfmac_f32_16x16x64_bf16 v[72:75],v[24:27],a[176:183],v1
v_smfmac_f32_16x16x64_bf16 v[76:79],v[24:27],a[184:191],v1
l2s_100769:
s_bitcmp1_b32 s55,3
s_cbranch_scc0 l2s_100771
s_waitcnt vmcnt(1)
v_max3_u32 v124,v28,v29,v30
v_max_u32 v124,v124,v31
v_cmp_eq_u32 vcc,-1,v124
s_cbranch_vccnz l2s_100771
s_bitset0_b32 s55,3
v_smfmac_f32_16x16x64_bf16 v[64:67],v[28:31],a[224:231],v1
v_smfmac_f32_16x16x64_bf16 v[68:71],v[28:31],a[232:239],v1
v_smfmac_f32_16x16x64_bf16 v[72:75],v[28:31],a[240:247],v1
v_smfmac_f32_16x16x64_bf16 v[76:79],v[28:31],a[248:255],v1
l2s_100771:
s_cmp_eq_u32 s55,0
s_cbranch_scc0 lfb_100712
Ldone_100713:
s_waitcnt vmcnt(7)
v_max3_u32 v124,v32,v33,v34
v_max_u32 v124,v124,v35
v_cmp_eq_u32 vcc,-1,v124
s_cbranch_vccnz flb_100508
s_branch segb_100492
lfb_100712:
s_bitcmp1_b32 s55,0
s_cbranch_scc0 dsk_100773
buffer_load_dwordx4 v[16:19],v0,s[20:23],s92 offen offset:0 sc1
dsk_100773:
s_bitcmp1_b32 s55,1
s_cbranch_scc0 dsk_100774
buffer_load_dwordx4 v[20:23],v0,s[20:23],s92 offen offset:1024 sc1
dsk_100774:
s_bitcmp1_b32 s55,2
s_cbranch_scc0 dsk_100775
buffer_load_dwordx4 v[24:27],v0,s[20:23],s92 offen offset:2048 sc1
dsk_100775:
s_bitcmp1_b32 s55,3
s_cbranch_scc0 dsk_100776
buffer_load_dwordx4 v[28:31],v0,s[20:23],s92 offen offset:3072 sc1
dsk_100776:
s_bitcmp1_b32 s55,0
s_cbranch_scc0 dsk_100777
s_waitcnt vmcnt(2)
v_max3_u32 v124,v16,v17,v18
v_max_u32 v124,v124,v19
v_cmp_eq_u32 vcc,-1,v124
s_cbranch_vccz dgo_100778
s_nop 15
buffer_load_dwordx4 v[104:107],v0,s[20:23],s92 offen offset:0 sc1
s_nop 15
buffer_load_dwordx4 v[108:111],v0,s[20:23],s92 offen offset:0 sc1
dlp_100779:
s_waitcnt vmcnt(2)
v_max3_u32 v124,v16,v17,v18
v_max_u32 v124,v124,v19
v_cmp_eq_u32 vcc,-1,v124
s_cbranch_vccz dgo_100778
buffer_load_dwordx4 v[16:19],v0,s[20:23],s92 offen offset:0 sc1
s_waitcnt vmcnt(2)
v_max3_u32 v124,v104,v105,v106
v_max_u32 v124,v124,v107
v_cmp_eq_u32 vcc,-1,v124
s_cbranch_vccz dcp_100781
buffer_load_dwordx4 v[104:107],v0,s[20:23],s92 offen offset:0 sc1
s_waitcnt vmcnt(2)
v_max3_u32 v124,v108,v109,v110
v_max_u32 v124,v124,v111
v_cmp_eq_u32 vcc,-1,v124
s_cbranch_vccz dcp_100782
buffer_load_dwordx4 v[108:111],v0,s[20:23],s92 offen offset:0 sc1
s_sub_u32 s90,s90,1
s_cmp_gt_i32 s90,0
s_cbranch_scc1 dlp_100779
s_branch dgo_100778
dcp_100781:
v_mov_b32 v16,v104
v_mov_b32 v17,v105
v_mov_b32 v18,v106
v_mov_b32 v19,v107
s_nop 1
s_branch dgo_100778
dcp_100782:
v_mov_b32 v16,v108
v_mov_b32 v17,v109
v_mov_b32 v18,v110
v_mov_b32 v19,v111
s_nop 1
dgo_100778:
v_smfmac_f32_16x16x64_bf16 v[64:67],v[16:19],a[32:39],v1
v_smfmac_f32_16x16x64_bf16 v[68:71],v[16:19],a[40:47],v1
v_smfmac_f32_16x16x64_bf16 v[72:75],v[16:19],a[48:55],v1
v_smfmac_f32_16x16x64_bf16 v[76:79],v[16:19],a[56:63],v1
dsk_100777:
s_bitcmp1_b32 s55,1
s_cbranch_scc0 dsk_100783
s_waitcnt vmcnt(2)
v_max3_u32 v124,v20,v21,v22
v_max_u32 v124,v124,v23
v_cmp_eq_u32 vcc,-1,v124
s_cbranch_vccz dgo_100784
s_nop 15
buffer_load_dwordx4 v[104:107],v0,s[20:23],s92 offen offset:1024 sc1
s_nop 15
buffer_load_dwordx4 v[108:111],v0,s[20:23],s92 offen offset:1024 sc1
dlp_100785:
s_waitcnt vmcnt(2)
v_max3_u32 v124,v20,v21,v22
v_max_u32 v124,v124,v23
v_cmp_eq_u32 vcc,-1,v124
s_cbranch_vccz dgo_100784
buffer_load_dwordx4 v[20:23],v0,s[20:23],s92 offen offset:1024 sc1
s_waitcnt vmcnt(2)
v_max3_u32 v124,v104,v105,v106
v_max_u32 v124,v124,v107
v_cmp_eq_u32 vcc,-1,v124
s_cbranch_vccz dcp_100787
buffer_load_dwordx4 v[104:107],v0,s[20:23],s92 offen offset:1024 sc1
s_waitcnt vmcnt(2)
v_max3_u32 v124,v108,v109,v110
v_max_u32 v124,v124,v111
v_cmp_eq_u32 vcc,-1,v124
s_cbranch_vccz dcp_100788
buffer_load_dwordx4 v[108:111],v0,s[20:23],s92 offen offset:1024 sc1
s_sub_u32 s90,s90,1
s_cmp_gt_i32 s90,0
s_cbranch_scc1 dlp_100785
s_branch dgo_100784
dcp_100787:
v_mov_b32 v20,v104
v_mov_b32 v21,v105
v_mov_b32 v22,v106
v_mov_b32 v23,v107
s_nop 1
s_branch dgo_100784
dcp_100788:
v_mov_b32 v20,v108
v_mov_b32 v21,v109
v_mov_b32 v22,v110
v_mov_b32 v23,v111
s_nop 1
dgo_100784:
v_smfmac_f32_16x16x64_bf16 v[64:67],v[20:23],a[96:103],v1
v_smfmac_f32_16x16x64_bf16 v[68:71],v[20:23],a[104:111],v1
v_smfmac_f32_16x16x64_bf16 v[72:75],v[20:23],a[112:119],v1
v_smfmac_f32_16x16x64_bf16 v[76:79],v[20:23],a[120:127],v1
dsk_100783:
s_bitcmp1_b32 s55,2
s_cbranch_scc0 dsk_100789
s_waitcnt vmcnt(2)
v_max3_u32 v124,v24,v25,v26
v_max_u32 v124,v124,v27
v_cmp_eq_u32 vcc,-1,v124
s_cbranch_vccz dgo_100790
s_nop 15
buffer_load_dwordx4 v[104:107],v0,s[20:23],s92 offen offset:2048 sc1
s_nop 15
buffer_load_dwordx4 v[108:111],v0,s[20:23],s92 offen offset:2048 sc1
dlp_100791:
s_waitcnt vmcnt(2)
v_max3_u32 v124,v24,v25,v26
v_max_u32 v124,v124,v27
v_cmp_eq_u32 vcc,-1,v124
s_cbranch_vccz dgo_100790
buffer_load_dwordx4 v[24:27],v0,s[20:23],s92 offen offset:2048 sc1
s_waitcnt vmcnt(2)
v_max3_u32 v124,v104,v105,v106
v_max_u32 v124,v124,v107
v_cmp_eq_u32 vcc,-1,v124
s_cbranch_vccz dcp_100793
buffer_load_dwordx4 v[104:107],v0,s[20:23],s92 offen offset:2048 sc1
s_waitcnt vmcnt(2)
v_max3_u32 v124,v108,v109,v110
v_max_u32 v124,v124,v111
v_cmp_eq_u32 vcc,-1,v124
s_cbranch_vccz dcp_100794
buffer_load_dwordx4 v[108:111],v0,s[20:23],s92 offen offset:2048 sc1
s_sub_u32 s90,s90,1
s_cmp_gt_i32 s90,0
s_cbranch_scc1 dlp_100791
s_branch dgo_100790
dcp_100793:
v_mov_b32 v24,v104
v_mov_b32 v25,v105
v_mov_b32 v26,v106
v_mov_b32 v27,v107
s_nop 1
s_branch dgo_100790
dcp_100794:
v_mov_b32 v24,v108
v_mov_b32 v25,v109
v_mov_b32 v26,v110
v_mov_b32 v27,v111
s_nop 1
dgo_100790:
v_smfmac_f32_16x16x64_bf16 v[64:67],v[24:27],a[160:167],v1
v_smfmac_f32_16x16x64_bf16 v[68:71],v[24:27],a[168:175],v1
v_smfmac_f32_16x16x64_bf16 v[72:75],v[24:27],a[176:183],v1
v_smfmac_f32_16x16x64_bf16 v[76:79],v[24:27],a[184:191],v1
dsk_100789:
s_bitcmp1_b32 s55,3
s_cbranch_scc0 dsk_100795
s_waitcnt vmcnt(2)
v_max3_u32 v124,v28,v29,v30
v_max_u32 v124,v124,v31
v_cmp_eq_u32 vcc,-1,v124
s_cbranch_vccz dgo_100796
s_nop 15
buffer_load_dwordx4 v[104:107],v0,s[20:23],s92 offen offset:3072 sc1
s_nop 15
buffer_load_dwordx4 v[108:111],v0,s[20:23],s92 offen offset:3072 sc1
dlp_100797:
s_waitcnt vmcnt(2)
v_max3_u32 v124,v28,v29,v30
v_max_u32 v124,v124,v31
v_cmp_eq_u32 vcc,-1,v124
s_cbranch_vccz dgo_100796
buffer_load_dwordx4 v[28:31],v0,s[20:23],s92 offen offset:3072 sc1
s_waitcnt vmcnt(2)
v_max3_u32 v124,v104,v105,v106
v_max_u32 v124,v124,v107
v_cmp_eq_u32 vcc,-1,v124
s_cbranch_vccz dcp_100799
buffer_load_dwordx4 v[104:107],v0,s[20:23],s92 offen offset:3072 sc1
s_waitcnt vmcnt(2)
v_max3_u32 v124,v108,v109,v110
v_max_u32 v124,v124,v111
v_cmp_eq_u32 vcc,-1,v124
s_cbranch_vccz dcp_100800
buffer_load_dwordx4 v[108:111],v0,s[20:23],s92 offen offset:3072 sc1
s_sub_u32 s90,s90,1
s_cmp_gt_i32 s90,0
s_cbranch_scc1 dlp_100797
s_branch dgo_100796
dcp_100799:
v_mov_b32 v28,v104
v_mov_b32 v29,v105
v_mov_b32 v30,v106
v_mov_b32 v31,v107
s_nop 1
s_branch dgo_100796
dcp_100800:
v_mov_b32 v28,v108
v_mov_b32 v29,v109
v_mov_b32 v30,v110
v_mov_b32 v31,v111
s_nop 1
dgo_100796:
v_smfmac_f32_16x16x64_bf16 v[64:67],v[28:31],a[224:231],v1
v_smfmac_f32_16x16x64_bf16 v[68:71],v[28:31],a[232:239],v1
v_smfmac_f32_16x16x64_bf16 v[72:75],v[28:31],a[240:247],v1
v_smfmac_f32_16x16x64_bf16 v[76:79],v[28:31],a[248:255],v1
dsk_100795:
s_mov_b32 s55,0
s_branch Ldone_100713
slowA_100512:
buffer_load_dwordx4 v[44:47],v0,s[20:23],s93 offen offset:3072 sc1
dsk_100801:
s_bitcmp1_b32 s55,7
s_cbranch_scc0 dsk_100802
s_waitcnt vmcnt(2)
v_max3_u32 v124,v44,v45,v46
v_max_u32 v124,v124,v47
v_cmp_eq_u32 vcc,-1,v124
s_cbranch_vccz dgo_100803
s_nop 15
s_nop 3
buffer_load_dwordx4 v[104:107],v0,s[20:23],s93 offen offset:3072 sc1
s_nop 15
s_nop 3
buffer_load_dwordx4 v[108:111],v0,s[20:23],s93 offen offset:3072 sc1
dlp_100804:
s_waitcnt vmcnt(2)
v_max3_u32 v124,v44,v45,v46
v_max_u32 v124,v124,v47
v_cmp_eq_u32 vcc,-1,v124
s_cbranch_vccz dgo_100803
buffer_load_dwordx4 v[44:47],v0,s[20:23],s93 offen offset:3072 sc1
s_waitcnt vmcnt(2)
v_max3_u32 v124,v104,v105,v106
v_max_u32 v124,v124,v107
v_cmp_eq_u32 vcc,-1,v124
s_cbranch_vccz dcp_100806
buffer_load_dwordx4 v[104:107],v0,s[20:23],s93 offen offset:3072 sc1
s_waitcnt vmcnt(2)
v_max3_u32 v124,v108,v109,v110
v_max_u32 v124,v124,v111
v_cmp_eq_u32 vcc,-1,v124
s_cbranch_vccz dcp_100807
buffer_load_dwordx4 v[108:111],v0,s[20:23],s93 offen offset:3072 sc1
s_sub_u32 s90,s90,1
s_cmp_gt_i32 s90,0
s_cbranch_scc1 dlp_100804
s_branch dgo_100803
dcp_100806:
v_mov_b32 v44,v104
v_mov_b32 v45,v105
v_mov_b32 v46,v106
v_mov_b32 v47,v107
s_nop 1
s_branch dgo_100803
dcp_100807:
v_mov_b32 v44,v108
v_mov_b32 v45,v109
v_mov_b32 v46,v110
v_mov_b32 v47,v111
s_nop 1
dgo_100803:
dsk_100802:
s_mov_b32 s55,0
s_branch segb_100494
recslow_100407:
s_mov_b32 s55,0
s_cmp_lg_u32 s50,0
s_cbranch_scc1 np0_100810
v_mov_b32 v120,0
v_mov_b32 v121,0
s_cmp_lg_u32 s58,0
s_cbranch_scc1 z1_100811
v_lshrrev_b32 v124,6,v127
v_lshlrev_b32 v124,12,v124
v_bfe_u32 v125,v127,1,5
v_add_u32 v124,v124,v125
s_lshl_b32 s64,s59,6
buffer_load_ushort v120,v124,s[44:47],s64 offen
buffer_load_ushort v122,v124,s[44:47],s64 offen offset:32
buffer_load_ushort v121,v124,s[44:47],s64 offen offset:2048
buffer_load_ushort v123,v124,s[44:47],s64 offen offset:2080
s_waitcnt vmcnt(0)
v_lshl_or_b32 v120,v122,16,v120
v_lshl_or_b32 v121,v123,16,v121
v_min_u32 v120,s81,v120
v_min_u32 v121,s81,v121
z1_100811:
s_waitcnt vmcnt(0)
buffer_store_dword v120,v4,s[20:23],s71 offen sc1
buffer_store_dword v121,v4,s[20:23],s71 offen offset:32 sc1
buffer_store_dword v120,v4,s[20:23],s73 offen sc1
buffer_store_dword v121,v4,s[20:23],s73 offen offset:32 sc1
np0_100810:
v_lshrrev_b32 v124,2,v0
v_bfe_u32 v125,v124,5,1
v_mul_u32_u24 v125,2048,v125
s_and_b32 s64,s50,1
s_lshl_b32 s64,s64,5
v_add3_u32 v4,v124,v125,s64
s_mov_b32 s61,1
buffer_load_dword v119,off,s[20:23],s68 sc1
s_waitcnt vmcnt(0)
s_mov_b32 s92,s70
s_mov_b32 s93,s72
s_mov_b32 s94,s76
s_add_u32 s95,s94,4096
s_mov_b32 s96,s74
s_add_u32 s97,s96,4096
s_mov_b32 s98,s75
s_barrier
v_mov_b32 v96,v104
v_mov_b32 v97,v105
v_mov_b32 v98,v106
v_mov_b32 v99,v107
v_mov_b32 v100,v108
v_mov_b32 v101,v109
v_mov_b32 v102,v110
v_mov_b32 v103,v111
v_mov_b32 v48,0
v_mov_b32 v49,0
v_mov_b32 v50,0
v_mov_b32 v51,0
v_mov_b32 v52,0
v_mov_b32 v53,0
v_mov_b32 v54,0
v_mov_b32 v55,0
v_mov_b32 v56,0
v_mov_b32 v57,0
v_mov_b32 v58,0
v_mov_b32 v59,0
v_mov_b32 v60,0
v_mov_b32 v61,0
v_mov_b32 v62,0
v_mov_b32 v63,0
v_mov_b32 v64,0
v_mov_b32 v65,0
v_mov_b32 v66,0
v_mov_b32 v67,0
v_mov_b32 v68,0
v_mov_b32 v69,0
v_mov_b32 v70,0
v_mov_b32 v71,0
v_mov_b32 v72,0
v_mov_b32 v73,0
v_mov_b32 v74,0
v_mov_b32 v75,0
v_mov_b32 v76,0
v_mov_b32 v77,0
v_mov_b32 v78,0
v_mov_b32 v79,0
v_mov_b32 v80,0
v_mov_b32 v81,0
v_mov_b32 v82,0
v_mov_b32 v83,0
v_mov_b32 v84,0
v_mov_b32 v85,0
v_mov_b32 v86,0
v_mov_b32 v87,0
v_mov_b32 v88,0
v_mov_b32 v89,0
v_mov_b32 v90,0
v_mov_b32 v91,0
v_mov_b32 v92,0
v_mov_b32 v93,0
v_mov_b32 v94,0
v_mov_b32 v95,0
s_cmp_gt_u32 s50,1
s_cbranch_scc0 loop0_100812x
.p2align 6
s_nop 0
s_nop 0
s_nop 0
s_nop 0
s_nop 0
s_nop 0
s_nop 0
loop_100808:
v_mov_b32 v125,0
s_nop 1
v_mfma_f32_16x16x1_4b_f32 v[48:63],v125,v125,0
v_mfma_f32_16x16x1_4b_f32 v[64:79],v125,v125,0
v_mfma_f32_16x16x1_4b_f32 v[80:95],v125,v125,0
s_max_u32 s66,s79,1
s_sub_u32 s66,s66,1
v_cndmask_b32 v126,2.0,v0,s[82:83]
s_add_u32 s64,s66,0
s_lshl_b32 s65,s64,12
s_and_b32 s65,s65,0x2000
s_xor_b32 s65,s65,s67
s_lshl_b32 s64,s64,20
s_add_u32 s65,s65,s64
s_add_u32 s101,s65,s78
buffer_store_dwordx4 v[112:115],v126,s[20:23],s101 offen sc1
s_nop 15
s_nop 15
s_nop 15
s_nop 7
buffer_load_dwordx4 v[16:19],v0,s[20:23],s92 offen offset:0 sc1
s_nop 7
buffer_load_dwordx4 v[20:23],v0,s[20:23],s92 offen offset:1024 sc1
s_nop 7
buffer_load_dwordx4 v[24:27],v0,s[20:23],s92 offen offset:2048 sc1
s_nop 7
buffer_load_dwordx4 v[28:31],v0,s[20:23],s92 offen offset:3072 sc1
v_mov_b32 v96,v104
v_mov_b32 v97,v105
v_mov_b32 v98,v106
v_mov_b32 v99,v107
v_mov_b32 v100,v108
v_mov_b32 v101,v109
v_mov_b32 v102,v110
v_mov_b32 v103,v111
s_branch ja_100813
loop0_100812x:
v_mov_b32 v125,0
s_nop 1
v_mfma_f32_16x16x1_4b_f32 v[48:63],v125,v125,0
v_mfma_f32_16x16x1_4b_f32 v[64:79],v125,v125,0
v_mfma_f32_16x16x1_4b_f32 v[80:95],v125,v125,0
s_max_u32 s66,s79,1
s_sub_u32 s66,s66,1
v_cndmask_b32 v126,2.0,v0,s[82:83]
s_add_u32 s64,s66,0
s_lshl_b32 s65,s64,12
s_and_b32 s65,s65,0x2000
s_xor_b32 s65,s65,s67
s_lshl_b32 s64,s64,20
s_add_u32 s65,s65,s64
s_add_u32 s101,s65,s78
buffer_store_dwordx4 v[112:115],v126,s[20:23],s101 offen sc1
s_nop 15
s_nop 3
buffer_load_dwordx4 v[16:19],v0,s[20:23],s92 offen offset:0 sc1
s_nop 7
buffer_load_dwordx4 v[20:23],v0,s[20:23],s92 offen offset:1024 sc1
s_nop 7
buffer_load_dwordx4 v[24:27],v0,s[20:23],s92 offen offset:2048 sc1
s_nop 7
buffer_load_dwordx4 v[28:31],v0,s[20:23],s92 offen offset:3072 sc1
ja_100813:
.p2align 5
s_nop 0
s_nop 0
s_cmp_lg_u32 s61,0
s_cbranch_scc1 pe_100814
pb_100815:
v_mov_b32 v126,s79
s_cmp_eq_u32 s79,63
s_cbranch_scc1 last_100809
s_add_u32 s64,s79,1
s_lshl_b32 s65,s64,12
s_and_b32 s65,s65,0x2000
s_xor_b32 s65,s65,s67
s_lshl_b32 s64,s64,20
s_add_u32 s65,s65,s64
s_add_u32 s99,s65,s77
s_waitcnt vmcnt(3)
v_max3_u32 v124,v16,v17,v18
v_max_u32 v124,v124,v19
v_cmp_eq_u32 vcc,-1,v124
v_cndmask_b32 v121,2.0,v127,s[86:87]
v_readfirstlane_b32 s91,v119
s_add_u32 s64,s79,1
s_cmp_gt_u32 s91,s64
s_cselect_b32 s99,s99,2.0
s_cselect_b32 s63,0,1
s_cbranch_vccnz flb_100844
seg_100820:
segb_100828:
v_smfmac_f32_16x16x64_bf16 v[48:51],v[16:19],a[0:7],v1
buffer_load_dword v125,off,s[20:23],s92 sc1
v_smfmac_f32_16x16x64_bf16 v[52:55],v[16:19],a[8:15],v1
buffer_load_dwordx4 v[32:35],v0,s[20:23],s93 offen offset:0 sc1
v_smfmac_f32_16x16x64_bf16 v[56:59],v[16:19],a[16:23],v1
s_waitcnt vmcnt(4)
v_max3_u32 v124,v20,v21,v22
v_smfmac_f32_16x16x64_bf16 v[60:63],v[16:19],a[24:31],v1
v_max_u32 v124,v124,v23
v_smfmac_f32_16x16x64_bf16 v[64:67],v[16:19],a[32:39],v1
v_cmp_eq_u32 vcc,-1,v124
v_smfmac_f32_16x16x64_bf16 v[68:71],v[16:19],a[40:47],v1
v_smfmac_f32_16x16x64_bf16 v[72:75],v[16:19],a[48:55],v1
s_cbranch_vccnz fl_100837
seg_100821:
v_smfmac_f32_16x16x64_bf16 v[76:79],v[16:19],a[56:63],v1
segb_100829:
v_smfmac_f32_16x16x64_bf16 v[48:51],v[20:23],a[64:71],v1
buffer_load_dword v125,off,s[20:23],s92 sc1
v_smfmac_f32_16x16x64_bf16 v[52:55],v[20:23],a[72:79],v1
buffer_load_dwordx4 v[36:39],v0,s[20:23],s93 offen offset:1024 sc1
v_smfmac_f32_16x16x64_bf16 v[56:59],v[20:23],a[80:87],v1
s_waitcnt vmcnt(5)
v_max3_u32 v124,v24,v25,v26
v_smfmac_f32_16x16x64_bf16 v[60:63],v[20:23],a[88:95],v1
v_max_u32 v124,v124,v27
v_smfmac_f32_16x16x64_bf16 v[64:67],v[20:23],a[96:103],v1
v_cmp_eq_u32 vcc,-1,v124
v_smfmac_f32_16x16x64_bf16 v[68:71],v[20:23],a[104:111],v1
v_smfmac_f32_16x16x64_bf16 v[72:75],v[20:23],a[112:119],v1
s_cbranch_vccnz fl_100838
seg_100822:
v_smfmac_f32_16x16x64_bf16 v[76:79],v[20:23],a[120:127],v1
segb_100830:
v_smfmac_f32_16x16x64_bf16 v[48:51],v[24:27],a[128:135],v1
buffer_load_dword v125,off,s[20:23],s92 sc1
v_smfmac_f32_16x16x64_bf16 v[52:55],v[24:27],a[136:143],v1
buffer_load_dwordx4 v[40:43],v0,s[20:23],s93 offen offset:2048 sc1
v_smfmac_f32_16x16x64_bf16 v[56:59],v[24:27],a[144:151],v1
buffer_load_dwordx4 v[44:47],v0,s[20:23],s93 offen offset:3072 sc1
s_waitcnt vmcnt(7)
v_max3_u32 v124,v28,v29,v30
v_smfmac_f32_16x16x64_bf16 v[60:63],v[24:27],a[152:159],v1
v_max_u32 v124,v124,v31
v_smfmac_f32_16x16x64_bf16 v[64:67],v[24:27],a[160:167],v1
v_cmp_eq_u32 vcc,-1,v124
v_smfmac_f32_16x16x64_bf16 v[68:71],v[24:27],a[168:175],v1
v_smfmac_f32_16x16x64_bf16 v[72:75],v[24:27],a[176:183],v1
s_cbranch_vccnz fl_100839
seg_100823:
v_smfmac_f32_16x16x64_bf16 v[76:79],v[24:27],a[184:191],v1
segb_100831:
v_smfmac_f32_16x16x64_bf16 v[48:51],v[28:31],a[192:199],v1
buffer_load_dword v125,off,s[20:23],s92 sc1
v_smfmac_f32_16x16x64_bf16 v[52:55],v[28:31],a[200:207],v1
buffer_store_dword v126,v121,s[20:23],s69 offen sc1
v_smfmac_f32_16x16x64_bf16 v[56:59],v[28:31],a[208:215],v1
s_waitcnt vmcnt(7)
v_max3_u32 v124,v32,v33,v34
v_smfmac_f32_16x16x64_bf16 v[60:63],v[28:31],a[216:223],v1
v_max_u32 v124,v124,v35
v_smfmac_f32_16x16x64_bf16 v[64:67],v[28:31],a[224:231],v1
v_cmp_eq_u32 vcc,-1,v124
v_smfmac_f32_16x16x64_bf16 v[68:71],v[28:31],a[232:239],v1
v_smfmac_f32_16x16x64_bf16 v[72:75],v[28:31],a[240:247],v1
s_cbranch_vccnz fl_100840
seg_100824:
v_smfmac_f32_16x16x64_bf16 v[76:79],v[28:31],a[248:255],v1
segb_100832:
v_smfmac_f32_16x16x64_bf16 v[48:51],v[32:35],a[0:7],v1
buffer_load_dword v125,off,s[20:23],s92 sc1
v_smfmac_f32_16x16x64_bf16 v[52:55],v[32:35],a[8:15],v1
v_smfmac_f32_16x16x64_bf16 v[56:59],v[32:35],a[16:23],v1
s_waitcnt vmcnt(6)
v_max3_u32 v124,v36,v37,v38
v_smfmac_f32_16x16x64_bf16 v[60:63],v[32:35],a[24:31],v1
v_max_u32 v124,v124,v39
v_smfmac_f32_16x16x64_bf16 v[64:67],v[32:35],a[32:39],v1
v_cmp_eq_u32 vcc,-1,v124
v_smfmac_f32_16x16x64_bf16 v[68:71],v[32:35],a[40:47],v1
v_smfmac_f32_16x16x64_bf16 v[72:75],v[32:35],a[48:55],v1
s_cbranch_vccnz fl_100841
seg_100825:
v_smfmac_f32_16x16x64_bf16 v[76:79],v[32:35],a[56:63],v1
segb_100833:
v_smfmac_f32_16x16x64_bf16 v[48:51],v[36:39],a[64:71],v1
buffer_load_dword v125,off,s[20:23],s92 sc1
s_waitcnt vmcnt(4)
v_max3_u32 v124,v40,v41,v42
v_smfmac_f32_16x16x64_bf16 v[52:55],v[36:39],a[72:79],v1
v_max3_u32 v124,v124,v43,v44
v_smfmac_f32_16x16x64_bf16 v[56:59],v[36:39],a[80:87],v1
v_max3_u32 v124,v124,v45,v46
v_smfmac_f32_16x16x64_bf16 v[60:63],v[36:39],a[88:95],v1
v_max_u32 v124,v124,v47
v_smfmac_f32_16x16x64_bf16 v[64:67],v[36:39],a[96:103],v1
v_cmp_eq_u32 vcc,-1,v124
v_smfmac_f32_16x16x64_bf16 v[68:71],v[36:39],a[104:111],v1
v_smfmac_f32_16x16x64_bf16 v[72:75],v[36:39],a[112:119],v1
s_cbranch_vccnz fl_100842
seg_100826:
v_smfmac_f32_16x16x64_bf16 v[76:79],v[36:39],a[120:127],v1
segb_100834:
v_smfmac_f32_16x16x64_bf16 v[48:51],v[40:43],a[128:135],v1
s_cmp_lg_u32 s61,0
s_cbranch_scc1 pq_100816
pk_100817:
buffer_load_dwordx4 v[104:107],v0,s[20:23],s99 offen
v_smfmac_f32_16x16x64_bf16 v[52:55],v[40:43],a[136:143],v1
buffer_load_dwordx4 v[108:111],v0,s[20:23],s99 offen offset:1024
s_add_u32 s64,s79,2
v_smfmac_f32_16x16x64_bf16 v[48:51],v[44:47],a[192:199],v1
s_and_b32 s64,s64,3
s_lshl_b32 s100,s64,19
v_smfmac_f32_16x16x64_bf16 v[52:55],v[44:47],a[200:207],v1
s_mov_b32 s61,s63
s_nop 1
v_add_f32 v48,v48,v49
v_smfmac_f32_16x16x64_bf16 v[56:59],v[40:43],a[144:151],v1
ds_write_addtid_b32 v48 offset:0
v_add_f32 v50,v50,v51
v_smfmac_f32_16x16x64_bf16 v[60:63],v[40:43],a[152:159],v1
ds_write_addtid_b32 v50 offset:1040
v_add_f32 v52,v52,v53
v_smfmac_f32_16x16x64_bf16 v[56:59],v[44:47],a[208:215],v1
ds_write_addtid_b32 v52 offset:2080
v_add_f32 v54,v54,v55
v_smfmac_f32_16x16x64_bf16 v[60:63],v[44:47],a[216:223],v1
ds_write_addtid_b32 v54 offset:3120
s_nop 1
v_add_f32 v56,v56,v57
v_smfmac_f32_16x16x64_bf16 v[64:67],v[40:43],a[160:167],v1
ds_write_addtid_b32 v56 offset:4160
v_add_f32 v58,v58,v59
v_smfmac_f32_16x16x64_bf16 v[68:71],v[40:43],a[168:175],v1
ds_write_addtid_b32 v58 offset:5200
v_add_f32 v60,v60,v61
v_smfmac_f32_16x16x64_bf16 v[64:67],v[44:47],a[224:231],v1
ds_write_addtid_b32 v60 offset:6240
v_add_f32 v62,v62,v63
v_smfmac_f32_16x16x64_bf16 v[68:71],v[44:47],a[232:239],v1
ds_write_addtid_b32 v62 offset:7280
s_nop 1
v_add_f32 v64,v64,v65
v_smfmac_f32_16x16x64_bf16 v[72:75],v[40:43],a[176:183],v1
ds_write_addtid_b32 v64 offset:8448
v_add_f32 v66,v66,v67
v_smfmac_f32_16x16x64_bf16 v[76:79],v[40:43],a[184:191],v1
ds_write_addtid_b32 v66 offset:9488
v_add_f32 v68,v68,v69
v_smfmac_f32_16x16x64_bf16 v[72:75],v[44:47],a[240:247],v1
ds_write_addtid_b32 v68 offset:10528
v_add_f32 v70,v70,v71
v_smfmac_f32_16x16x64_bf16 v[76:79],v[44:47],a[248:255],v1
ds_write_addtid_b32 v70 offset:11568
s_nop 1
v_add_f32 v72,v72,v73
v_smfmac_f32_16x16x64_bf16 v[80:83],v[16:19],v[208:215],v1
ds_write_addtid_b32 v72 offset:12608
v_add_f32 v74,v74,v75
v_smfmac_f32_16x16x64_bf16 v[80:83],v[32:35],v[208:215],v1
ds_write_addtid_b32 v74 offset:13648
v_add_f32 v76,v76,v77
ds_write_addtid_b32 v76 offset:14688
v_add_f32 v78,v78,v79
ds_write_addtid_b32 v78 offset:15728
doneA_100853:
s_waitcnt lgkmcnt(0)
s_barrier
s_cmp_gt_u32 s50,1
s_cbranch_scc1 w23_100854
v_smfmac_f32_16x16x64_bf16 v[84:87],v[16:19],v[216:223],v1
v_smfmac_f32_16x16x64_bf16 v[84:87],v[32:35],v[216:223],v1
v_smfmac_f32_16x16x64_bf16 v[88:91],v[16:19],v[224:231],v1
v_smfmac_f32_16x16x64_bf16 v[88:91],v[32:35],v[224:231],v1
v_smfmac_f32_16x16x64_bf16 v[92:95],v[16:19],v[232:239],v1
ds_read_b128 v[48:51],v7 offset:0
ds_read_b128 v[52:55],v7 offset:1024
v_smfmac_f32_16x16x64_bf16 v[92:95],v[32:35],v[232:239],v1
ds_read_b128 v[56:59],v7 offset:2048
ds_read_b128 v[60:63],v7 offset:3072
v_smfmac_f32_16x16x64_bf16 v[80:83],v[20:23],v[240:247],v1
ds_read_b128 v[64:67],v7 offset:4096
ds_read_b128 v[68:71],v7 offset:5120
v_smfmac_f32_16x16x64_bf16 v[80:83],v[36:39],v[240:247],v1
ds_read_b128 v[72:75],v7 offset:6144
ds_read_b128 v[76:79],v7 offset:7168
v_smfmac_f32_16x16x64_bf16 v[84:87],v[20:23],v[248:255],v1
v_smfmac_f32_16x16x64_bf16 v[84:87],v[36:39],v[248:255],v1
s_waitcnt lgkmcnt(6)
v_smfmac_f32_16x16x64_bf16 v[88:91],v[20:23],v[48:55],v1
v_smfmac_f32_16x16x64_bf16 v[88:91],v[36:39],v[48:55],v1
ds_read_b128 v[48:51],v7 offset:8192
ds_read_b128 v[52:55],v7 offset:9216
s_waitcnt lgkmcnt(6)
v_smfmac_f32_16x16x64_bf16 v[92:95],v[20:23],v[56:63],v1
v_smfmac_f32_16x16x64_bf16 v[92:95],v[36:39],v[56:63],v1
ds_read_b128 v[56:59],v7 offset:10240
ds_read_b128 v[60:63],v7 offset:11264
s_waitcnt lgkmcnt(6)
v_smfmac_f32_16x16x64_bf16 v[80:83],v[24:27],v[64:71],v1
v_smfmac_f32_16x16x64_bf16 v[80:83],v[40:43],v[64:71],v1
ds_read_b128 v[64:67],v7 offset:12288
ds_read_b128 v[68:71],v7 offset:13312
s_waitcnt lgkmcnt(6)
v_smfmac_f32_16x16x64_bf16 v[84:87],v[24:27],v[72:79],v1
v_smfmac_f32_16x16x64_bf16 v[84:87],v[40:43],v[72:79],v1
ds_read_b128 v[72:75],v7 offset:14336
ds_read_b128 v[76:79],v7 offset:15360
s_waitcnt lgkmcnt(6)
v_smfmac_f32_16x16x64_bf16 v[88:91],v[24:27],v[48:55],v1
v_smfmac_f32_16x16x64_bf16 v[88:91],v[40:43],v[48:55],v1
ds_read_b128 v[48:51],v7 offset:16384
ds_read_b128 v[52:55],v7 offset:17408
s_waitcnt lgkmcnt(6)
v_smfmac_f32_16x16x64_bf16 v[92:95],v[24:27],v[56:63],v1
v_smfmac_f32_16x16x64_bf16 v[92:95],v[40:43],v[56:63],v1
ds_read_b128 v[56:59],v7 offset:18432
ds_read_b128 v[60:63],v7 offset:19456
s_waitcnt lgkmcnt(6)
v_smfmac_f32_16x16x64_bf16 v[80:83],v[28:31],v[64:71],v1
v_smfmac_f32_16x16x64_bf16 v[80:83],v[44:47],v[64:71],v1
s_waitcnt lgkmcnt(4)
v_smfmac_f32_16x16x64_bf16 v[84:87],v[28:31],v[72:79],v1
v_smfmac_f32_16x16x64_bf16 v[84:87],v[44:47],v[72:79],v1
s_waitcnt lgkmcnt(2)
v_smfmac_f32_16x16x64_bf16 v[88:91],v[28:31],v[48:55],v1
v_add_f32 v80,v80,v81
v_smfmac_f32_16x16x64_bf16 v[88:91],v[44:47],v[48:55],v1
v_add_f32 v82,v82,v83
s_waitcnt lgkmcnt(0)
v_smfmac_f32_16x16x64_bf16 v[92:95],v[28:31],v[56:63],v1
v_cvt_pk_bf16_f32 v80,v80,v82
v_smfmac_f32_16x16x64_bf16 v[92:95],v[44:47],v[56:63],v1
buffer_load_dwordx4 v[16:19],v2,s[20:23],s94 offen offset:0 sc1
ds_write_addtid_b32 v80 offset:16896
v_add_f32 v84,v84,v85
buffer_load_dwordx4 v[32:35],v2,s[20:23],s94 offen offset:1536 sc1
buffer_load_dwordx4 v[20:23],v2,s[20:23],s95 offen offset:0 sc1
buffer_load_dwordx4 v[36:39],v2,s[20:23],s95 offen offset:1536 sc1
buffer_load_dword v120,v3,s[20:23],s94 offen offset:0 sc1
buffer_load_dword v121,v3,s[20:23],s94 offen offset:1536 sc1
buffer_load_dword v122,v3,s[20:23],s95 offen offset:0 sc1
buffer_load_dword v123,v3,s[20:23],s95 offen offset:1536 sc1
v_add_f32 v86,v86,v87
v_cvt_pk_bf16_f32 v84,v84,v86
v_add_f32 v88,v88,v89
v_add_f32 v90,v90,v91
v_cvt_pk_bf16_f32 v88,v88,v90
v_add_f32 v92,v92,v93
v_add_f32 v94,v94,v95
v_cvt_pk_bf16_f32 v92,v92,v94
ds_write_addtid_b32 v84 offset:17920
ds_write_addtid_b32 v88 offset:18944
ds_write_addtid_b32 v92 offset:19968
.p2align 5
s_nop 0
s_nop 0
s_nop 0
s_nop 0
s_nop 0
sp_100858:
s_waitcnt vmcnt(6)
v_pk_add_f32 v[16:17],v[16:17],v[32:33]
v_pk_add_f32 v[18:19],v[18:19],v[34:35]
s_waitcnt vmcnt(4)
v_pk_add_f32 v[20:21],v[20:21],v[36:37]
v_pk_add_f32 v[22:23],v[22:23],v[38:39]
v_pk_add_f32 v[16:17],v[16:17],v[20:21]
v_pk_add_f32 v[18:19],v[18:19],v[22:23]
v_max3_f32 v124,v16,v17,v18
v_pk_add_f32 v[20:21],v[16:17],v[18:19]
s_waitcnt vmcnt(0)
v_pk_add_f32 v[120:121],v[120:121],v[122:123]
v_add_f32 v120,v120,v121
v_max3_f32 v124,v124,v19,v120
v_add_f32 v20,v20,v120
v_cmp_u_f32 vcc,v20,v21
v_max_f32_dpp v124,v124,v124 row_ror:8 row_mask:0xf bank_mask:0xf
v_mov_b32 v125,v124
s_cbranch_vccnz srt_100860
sok_100859:
s_nop 0
v_permlane16_swap_b32 v125,v124
v_max_f32 v124,v124,v125
v_mov_b32 v125,v124
s_nop 1
v_permlane32_swap_b32 v125,v124
v_max_f32 v124,v124,v125
v_mul_f32 v124,s80,v124
v_fma_f32 v16,v16,s80,-v124
v_fma_f32 v17,v17,s80,-v124
v_fma_f32 v18,v18,s80,-v124
v_fma_f32 v19,v19,s80,-v124
v_fma_f32 v120,v120,s80,-v124
s_waitcnt lgkmcnt(0)
s_barrier
ds_read2st64_b32 v[112:113],v127 offset0:66 offset1:67
ds_read2st64_b32 v[114:115],v127 offset0:68 offset1:69
ds_read2st64_b32 v[116:117],v127 offset0:70 offset1:71
ds_read2st64_b32 v[118:119],v127 offset0:72 offset1:73
v_exp_f32 v16,v16
v_exp_f32 v17,v17
v_exp_f32 v18,v18
v_exp_f32 v19,v19
v_cvt_pk_bf16_f32 v48,v16,v17
v_cvt_pk_bf16_f32 v49,v18,v19
v_exp_f32 v120,v120
v_mov_b32_dpp v50,v48 row_ror:8 row_mask:0xf bank_mask:0xf
v_mov_b32_dpp v51,v49 row_ror:8 row_mask:0xf bank_mask:0xf
v_mov_b32_dpp v121,v120 row_ror:8 row_mask:0xf bank_mask:0xf
v_cvt_pk_bf16_f32 v52,v120,v121
v_mfma_f32_16x16x32_bf16 v[64:67],v[8:11],v[48:51],0
v_mov_b32 v53,v52
v_mfma_f32_16x16x32_bf16 v[56:59],v[96:99],v[48:51],0
v_mov_b32 v54,v52
v_mov_b32 v55,v52
v_mfma_f32_16x16x32_bf16 v[60:63],v[100:103],v[48:51],0
v_mfma_f32_16x16x32_bf16 v[64:67],v[12:15],v[52:55],v[64:67]
s_waitcnt lgkmcnt(0)
v_mfma_f32_16x16x32_bf16 v[56:59],v[112:115],v[52:55],v[56:59]
v_mfma_f32_16x16x32_bf16 v[60:63],v[116:119],v[52:55],v[60:63]
s_nop 0
v_rcp_f32 v66,v64
s_nop 2
v_pk_mul_f32 v[56:57],v[56:57],v[66:67] op_sel_hi:[1,0]
v_pk_mul_f32 v[58:59],v[58:59],v[66:67] op_sel_hi:[1,0]
s_nop 0
v_pk_mul_f32 v[60:61],v[60:61],v[66:67] op_sel_hi:[1,0]
v_pk_mul_f32 v[62:63],v[62:63],v[66:67] op_sel_hi:[1,0]
v_cvt_pk_bf16_f32 v120,v56,v57
v_cvt_pk_bf16_f32 v121,v58,v59
v_cvt_pk_bf16_f32 v122,v60,v61
v_cvt_pk_bf16_f32 v123,v62,v63
buffer_store_dwordx4 v[120:123],v6,s[20:23],s98 offen sc1
s_barrier
ds_read_b128 v[48:51],v7 offset:20480
ds_read_b128 v[52:55],v7 offset:21504
ds_read_b128 v[56:59],v7 offset:22528
ds_read_b128 v[60:63],v7 offset:23552
ds_read_b128 v[64:67],v7 offset:24576
ds_read_b128 v[68:71],v7 offset:25600
ds_read_b128 v[72:75],v7 offset:26624
ds_read_b128 v[76:79],v7 offset:27648
ds_read_b128 v[80:83],v7 offset:28672
ds_read_b128 v[84:87],v7 offset:29696
ds_read_b128 v[88:91],v7 offset:30720
ds_read_b128 v[92:95],v7 offset:31744
v_mov_b32 v96,0
v_mov_b32 v97,0
v_mov_b32 v98,0
v_mov_b32 v99,0
v_mov_b32 v100,0
v_mov_b32 v101,0
v_mov_b32 v102,0
v_mov_b32 v103,0
s_nop 11
buffer_load_dwordx4 v[16:19],v0,s[20:23],s96 offen offset:0 sc1
v_mov_b32 v120,v5
v_mov_b32 v121,v5
v_mov_b32 v122,v5
v_mov_b32 v123,v5
s_nop 1
v_mfma_f32_16x16x32_bf16 v[112:115],v[120:123],v[112:115],0
buffer_load_dwordx4 v[20:23],v0,s[20:23],s96 offen offset:1024 sc1
v_mfma_f32_16x16x32_bf16 v[116:119],v[120:123],v[116:119],0
s_add_u32 s79,s79,1
s_and_b32 s64,s79,3
s_lshl_b32 s64,s64,19
s_lshl_b32 s65,s79,8
buffer_load_dwordx4 v[24:27],v0,s[20:23],s96 offen offset:2048 sc1
s_and_b32 s65,s65,0x2000
s_lshl_b32 s66,s79,16
s_xor_b32 s88,s73,s65
s_add_u32 s88,s88,s66
s_sub_u32 s88,s88,s54
s_add_u32 s89,s71,s64
s_add_u32 s92,s70,s64
s_xor_b32 s93,s72,s65
buffer_load_dwordx4 v[28:31],v0,s[20:23],s96 offen offset:3072 sc1
s_add_u32 s93,s93,s66
s_add_u32 s94,s76,s64
s_add_u32 s95,s94,4096
s_add_u32 s98,s75,s64
s_add_u32 s60,s74,s64
v_cvt_pk_bf16_f32 v112,v112,v113
v_cvt_pk_bf16_f32 v113,v114,v115
v_cvt_pk_bf16_f32 v114,v116,v117
buffer_load_dwordx4 v[32:35],v0,s[20:23],s97 offen offset:0 sc1
v_cvt_pk_bf16_f32 v115,v118,v119
s_nop 6
buffer_load_dwordx4 v[36:39],v0,s[20:23],s97 offen offset:1024 sc1
s_nop 7
buffer_load_dwordx4 v[40:43],v0,s[20:23],s97 offen offset:2048 sc1
s_nop 7
buffer_load_dwordx4 v[44:47],v0,s[20:23],s97 offen offset:3072 sc1
s_branch ogo_100855
.p2align 5
s_nop 0
s_nop 0
s_nop 0
s_nop 0
w23_100854:
ds_read_b128 v[48:51],v2 offset:0
ds_read_b128 v[52:55],v2 offset:256
ds_read_b128 v[56:59],v2 offset:512
ds_read_b128 v[60:63],v2 offset:768
ds_read_b128 v[64:67],v2 offset:16
ds_read_b128 v[68:71],v2 offset:272
ds_read_b128 v[72:75],v2 offset:528
ds_read_b128 v[76:79],v2 offset:784
s_waitcnt lgkmcnt(6)
v_pk_add_f32 v[48:49],v[48:49],v[52:53]
v_pk_add_f32 v[50:51],v[50:51],v[54:55]
s_waitcnt lgkmcnt(4)
v_pk_add_f32 v[56:57],v[56:57],v[60:61]
v_pk_add_f32 v[58:59],v[58:59],v[62:63]
v_pk_add_f32 v[48:49],v[48:49],v[56:57]
v_pk_add_f32 v[50:51],v[50:51],v[58:59]
v_cvt_pk_bf16_f32 v112,v48,v49
v_cvt_pk_bf16_f32 v113,v50,v51
s_waitcnt lgkmcnt(2)
v_pk_add_f32 v[64:65],v[64:65],v[68:69]
v_pk_add_f32 v[66:67],v[66:67],v[70:71]
s_waitcnt lgkmcnt(0)
v_pk_add_f32 v[72:73],v[72:73],v[76:77]
v_pk_add_f32 v[74:75],v[74:75],v[78:79]
v_pk_add_f32 v[64:65],v[64:65],v[72:73]
v_pk_add_f32 v[66:67],v[66:67],v[74:75]
v_cvt_pk_bf16_f32 v114,v64,v65
v_cvt_pk_bf16_f32 v115,v66,v67
s_nop 1
v_mfma_f32_16x16x32_bf16 v[116:119],v[96:99],v[112:115],0
v_mfma_f32_16x16x32_bf16 v[120:123],v[100:103],v[112:115],0
v_mfma_f32_16x16x32_bf16 v[12:15],v[112:115],v[112:115],0
ds_read_b128 v[48:51],v7 offset:0
ds_read_b128 v[52:55],v7 offset:1024
ds_read_b128 v[56:59],v7 offset:2048
ds_read_b128 v[60:63],v7 offset:3072
ds_read_b128 v[64:67],v7 offset:4096
buffer_store_dwordx4 v[116:119],v3,s[20:23],s94 offen sc1
buffer_store_dwordx4 v[120:123],v3,s[20:23],s94 offen offset:512 sc1
s_nop 0
buffer_store_dwordx4 v[12:15],v3,s[20:23],s94 offen offset:1024 sc1
ds_read_b128 v[68:71],v7 offset:5120
ds_read_b128 v[72:75],v7 offset:6144
ds_read_b128 v[76:79],v7 offset:7168
v_smfmac_f32_16x16x64_bf16 v[84:87],v[16:19],v[216:223],v1
v_smfmac_f32_16x16x64_bf16 v[84:87],v[32:35],v[216:223],v1
v_smfmac_f32_16x16x64_bf16 v[88:91],v[16:19],v[224:231],v1
v_smfmac_f32_16x16x64_bf16 v[88:91],v[32:35],v[224:231],v1
v_smfmac_f32_16x16x64_bf16 v[92:95],v[16:19],v[232:239],v1
v_smfmac_f32_16x16x64_bf16 v[92:95],v[32:35],v[232:239],v1
v_smfmac_f32_16x16x64_bf16 v[80:83],v[20:23],v[240:247],v1
v_smfmac_f32_16x16x64_bf16 v[80:83],v[36:39],v[240:247],v1
v_smfmac_f32_16x16x64_bf16 v[84:87],v[20:23],v[248:255],v1
v_smfmac_f32_16x16x64_bf16 v[84:87],v[36:39],v[248:255],v1
s_waitcnt lgkmcnt(6)
v_smfmac_f32_16x16x64_bf16 v[88:91],v[20:23],v[48:55],v1
v_smfmac_f32_16x16x64_bf16 v[88:91],v[36:39],v[48:55],v1
ds_read_b128 v[48:51],v7 offset:8192
ds_read_b128 v[52:55],v7 offset:9216
s_waitcnt lgkmcnt(6)
v_smfmac_f32_16x16x64_bf16 v[92:95],v[20:23],v[56:63],v1
v_smfmac_f32_16x16x64_bf16 v[92:95],v[36:39],v[56:63],v1
ds_read_b128 v[56:59],v7 offset:10240
ds_read_b128 v[60:63],v7 offset:11264
s_waitcnt lgkmcnt(6)
v_smfmac_f32_16x16x64_bf16 v[80:83],v[24:27],v[64:71],v1
v_smfmac_f32_16x16x64_bf16 v[80:83],v[40:43],v[64:71],v1
ds_read_b128 v[64:67],v7 offset:12288
ds_read_b128 v[68:71],v7 offset:13312
s_waitcnt lgkmcnt(6)
v_smfmac_f32_16x16x64_bf16 v[84:87],v[24:27],v[72:79],v1
v_smfmac_f32_16x16x64_bf16 v[84:87],v[40:43],v[72:79],v1
ds_read_b128 v[72:75],v7 offset:14336
ds_read_b128 v[76:79],v7 offset:15360
s_waitcnt lgkmcnt(6)
v_smfmac_f32_16x16x64_bf16 v[88:91],v[24:27],v[48:55],v1
v_smfmac_f32_16x16x64_bf16 v[88:91],v[40:43],v[48:55],v1
ds_read_b128 v[48:51],v7 offset:16384
ds_read_b128 v[52:55],v7 offset:17408
s_waitcnt lgkmcnt(6)
v_smfmac_f32_16x16x64_bf16 v[92:95],v[24:27],v[56:63],v1
v_smfmac_f32_16x16x64_bf16 v[92:95],v[40:43],v[56:63],v1
ds_read_b128 v[56:59],v7 offset:18432
ds_read_b128 v[60:63],v7 offset:19456
s_waitcnt lgkmcnt(6)
v_smfmac_f32_16x16x64_bf16 v[80:83],v[28:31],v[64:71],v1
v_smfmac_f32_16x16x64_bf16 v[80:83],v[44:47],v[64:71],v1
s_waitcnt lgkmcnt(4)
v_smfmac_f32_16x16x64_bf16 v[84:87],v[28:31],v[72:79],v1
v_smfmac_f32_16x16x64_bf16 v[84:87],v[44:47],v[72:79],v1
s_waitcnt lgkmcnt(2)
v_smfmac_f32_16x16x64_bf16 v[88:91],v[28:31],v[48:55],v1
v_add_f32 v80,v80,v81
v_smfmac_f32_16x16x64_bf16 v[88:91],v[44:47],v[48:55],v1
v_add_f32 v82,v82,v83
s_waitcnt lgkmcnt(0)
v_smfmac_f32_16x16x64_bf16 v[92:95],v[28:31],v[56:63],v1
v_cvt_pk_bf16_f32 v80,v80,v82
v_smfmac_f32_16x16x64_bf16 v[92:95],v[44:47],v[56:63],v1
ds_write_addtid_b32 v80 offset:16896
v_add_f32 v84,v84,v85
v_add_f32 v86,v86,v87
v_cvt_pk_bf16_f32 v84,v84,v86
v_add_f32 v88,v88,v89
v_add_f32 v90,v90,v91
v_cvt_pk_bf16_f32 v88,v88,v90
s_nop 0
v_add_f32 v92,v92,v93
v_add_f32 v94,v94,v95
v_cvt_pk_bf16_f32 v92,v92,v94
ds_write_addtid_b32 v84 offset:17920
ds_write_addtid_b32 v88 offset:18944
ds_write_addtid_b32 v92 offset:19968
s_waitcnt lgkmcnt(0)
s_barrier
ds_read_b128 v[48:51],v7 offset:20480
ds_read_b128 v[52:55],v7 offset:21504
ds_read_b128 v[56:59],v7 offset:22528
ds_read_b128 v[60:63],v7 offset:23552
ds_read_b128 v[64:67],v7 offset:24576
ds_read_b128 v[68:71],v7 offset:25600
ds_read_b128 v[72:75],v7 offset:26624
ds_read_b128 v[76:79],v7 offset:27648
ds_read_b128 v[80:83],v7 offset:28672
ds_read_b128 v[84:87],v7 offset:29696
ds_read_b128 v[88:91],v7 offset:30720
ds_read_b128 v[92:95],v7 offset:31744
s_add_u32 s65,s76,s100
s_add_u32 s66,s75,s100
s_add_u32 s64,s71,s100
s_cmp_eq_u32 s50,2
s_cselect_b32 s66,s66,s64
buffer_store_dwordx4 v[8:11],v0,s[20:23],s65 offen sc1
s_cmp_eq_u32 s50,2
s_cselect_b32 exec_hi,-1,0
buffer_store_dwordx4 v[8:11],v0,s[20:23],s66 offen sc1
s_mov_b32 exec_hi,0
buffer_store_dwordx4 v[8:11],v0,s[20:23],s65 offen offset:1024 sc1
s_mov_b64 exec,-1
v_mov_b32 v96,0
v_mov_b32 v97,0
v_mov_b32 v98,0
v_mov_b32 v99,0
v_mov_b32 v100,0
v_mov_b32 v101,0
v_mov_b32 v102,0
v_mov_b32 v103,0
s_barrier
s_nop 15
s_nop 15
s_nop 7
buffer_load_dwordx4 v[16:19],v0,s[20:23],s96 offen offset:0 sc1
s_add_u32 s79,s79,1
s_and_b32 s64,s79,3
s_lshl_b32 s64,s64,19
s_lshl_b32 s65,s79,8
s_and_b32 s65,s65,0x2000
s_lshl_b32 s66,s79,16
s_xor_b32 s88,s73,s65
s_add_u32 s88,s88,s66
buffer_load_dwordx4 v[20:23],v0,s[20:23],s96 offen offset:1024 sc1
s_sub_u32 s88,s88,s54
s_add_u32 s89,s71,s64
s_add_u32 s92,s70,s64
s_xor_b32 s93,s72,s65
s_add_u32 s93,s93,s66
s_add_u32 s94,s76,s64
s_add_u32 s95,s94,4096
s_add_u32 s98,s75,s64
buffer_load_dwordx4 v[24:27],v0,s[20:23],s96 offen offset:2048 sc1
s_add_u32 s60,s74,s64
s_nop 6
buffer_load_dwordx4 v[28:31],v0,s[20:23],s96 offen offset:3072 sc1
s_nop 7
buffer_load_dwordx4 v[32:35],v0,s[20:23],s97 offen offset:0 sc1
s_nop 7
buffer_load_dwordx4 v[36:39],v0,s[20:23],s97 offen offset:1024 sc1
s_nop 7
buffer_load_dwordx4 v[40:43],v0,s[20:23],s97 offen offset:2048 sc1
s_nop 7
buffer_load_dwordx4 v[44:47],v0,s[20:23],s97 offen offset:3072 sc1
.p2align 5
s_nop 0
s_nop 0
s_nop 0
s_nop 0
ogo_100855:
s_waitcnt lgkmcnt(0)
s_waitcnt vmcnt(6)
v_max3_u32 v124,v16,v17,v18
v_max3_u32 v124,v124,v19,v20
v_max3_u32 v124,v124,v21,v22
v_max_u32 v124,v124,v23
v_cmp_eq_u32 vcc,-1,v124
s_cbranch_vccnz of_100861
v_smfmac_f32_16x16x64_bf16 v[96:99],v[16:19],v[48:55],v1
v_smfmac_f32_16x16x64_bf16 v[100:103],v[16:19],v[56:63],v1
v_smfmac_f32_16x16x64_bf16 v[96:99],v[20:23],v[64:71],v1
v_smfmac_f32_16x16x64_bf16 v[100:103],v[20:23],v[72:79],v1
s_waitcnt vmcnt(4)
v_max3_u32 v124,v24,v25,v26
v_max3_u32 v124,v124,v27,v28
v_max3_u32 v124,v124,v29,v30
v_max_u32 v124,v124,v31
v_cmp_eq_u32 vcc,-1,v124
s_cbranch_vccnz of_100862
v_smfmac_f32_16x16x64_bf16 v[96:99],v[24:27],v[80:87],v1
v_smfmac_f32_16x16x64_bf16 v[100:103],v[24:27],v[88:95],v1
v_smfmac_f32_16x16x64_bf16 v[96:99],v[28:31],v[128:135],v1
v_smfmac_f32_16x16x64_bf16 v[100:103],v[28:31],v[136:143],v1
s_waitcnt vmcnt(2)
v_max3_u32 v124,v32,v33,v34
v_max3_u32 v124,v124,v35,v36
v_max3_u32 v124,v124,v37,v38
v_max_u32 v124,v124,v39
v_cmp_eq_u32 vcc,-1,v124
s_cbranch_vccnz of_100863
v_smfmac_f32_16x16x64_bf16 v[96:99],v[32:35],v[144:151],v1
v_smfmac_f32_16x16x64_bf16 v[100:103],v[32:35],v[152:159],v1
v_smfmac_f32_16x16x64_bf16 v[96:99],v[36:39],v[160:167],v1
v_smfmac_f32_16x16x64_bf16 v[100:103],v[36:39],v[168:175],v1
s_waitcnt vmcnt(1)
v_max3_u32 v124,v40,v41,v42
v_max_u32 v124,v124,v43
v_cmp_eq_u32 vcc,-1,v124
s_cbranch_vccnz of_100864
v_smfmac_f32_16x16x64_bf16 v[96:99],v[40:43],v[176:183],v1
v_smfmac_f32_16x16x64_bf16 v[100:103],v[40:43],v[184:191],v1
s_waitcnt vmcnt(0)
v_max3_u32 v124,v44,v45,v46
v_max_u32 v124,v124,v47
v_cmp_eq_u32 vcc,-1,v124
s_cbranch_vccnz of_100865
v_smfmac_f32_16x16x64_bf16 v[96:99],v[44:47],v[192:199],v1
v_smfmac_f32_16x16x64_bf16 v[100:103],v[44:47],v[200:207],v1
oback_100872:
buffer_load_dword v119,off,s[20:23],s68 sc1
s_nop 3
v_add_f32 v96,v96,v97
v_add_f32 v98,v98,v99
s_nop 0
v_add_f32 v100,v100,v101
v_add_f32 v102,v102,v103
ds_write_addtid_b32 v96 offset:20992
ds_write_addtid_b32 v98 offset:23072
ds_write_addtid_b32 v100 offset:22016
ds_write_addtid_b32 v102 offset:24096
s_mov_b32 s96,s60
s_add_u32 s97,s60,4096
s_cmp_gt_u32 s50,1
s_waitcnt lgkmcnt(0)
s_barrier
s_cbranch_scc1 loop_100808
ds_read2st64_b32 v[48:49],v4 offset0:82 offset1:86
ds_read2st64_b32 v[50:51],v4 offset0:83 offset1:87
ds_read2st64_b32 v[52:53],v4 offset0:84 offset1:88
ds_read2st64_b32 v[54:55],v4 offset0:85 offset1:89
v_mov_b32 v96,v104
v_mov_b32 v97,v105
v_mov_b32 v98,v106
v_mov_b32 v99,v107
v_mov_b32 v100,v108
v_mov_b32 v101,v109
v_mov_b32 v102,v110
v_mov_b32 v103,v111
s_waitcnt lgkmcnt(2)
v_pk_add_f32 v[48:49],v[48:49],v[50:51]
s_waitcnt lgkmcnt(0)
v_pk_add_f32 v[52:53],v[52:53],v[54:55]
v_pk_add_f32 v[48:49],v[48:49],v[52:53]
v_cvt_pk_bf16_f32 v124,v48,v49
buffer_store_dword v124,v127,s[20:23],s89 offen sc1
s_nop 7
buffer_store_dword v124,v127,s[20:23],s88 offen sc1
s_branch loop0_100812x
last_100809:
s_waitcnt vmcnt(3)
v_max3_u32 v124,v16,v17,v18
v_max_u32 v124,v124,v19
v_cmp_eq_u32 vcc,-1,v124
v_cndmask_b32 v121,2.0,v127,s[86:87]
s_cbranch_vccnz flb_100897
seg_100873:
segb_100881:
v_smfmac_f32_16x16x64_bf16 v[64:67],v[16:19],a[32:39],v1
buffer_load_dword v125,off,s[20:23],s92 sc1
buffer_load_dwordx4 v[32:35],v0,s[20:23],s93 offen offset:0 sc1
s_waitcnt vmcnt(4)
v_max3_u32 v124,v20,v21,v22
v_smfmac_f32_16x16x64_bf16 v[68:71],v[16:19],a[40:47],v1
v_max_u32 v124,v124,v23
v_cmp_eq_u32 vcc,-1,v124
v_smfmac_f32_16x16x64_bf16 v[72:75],v[16:19],a[48:55],v1
v_smfmac_f32_16x16x64_bf16 v[76:79],v[16:19],a[56:63],v1
s_cbranch_vccnz fl_100890
seg_100874:
segb_100882:
v_smfmac_f32_16x16x64_bf16 v[64:67],v[20:23],a[96:103],v1
buffer_load_dword v125,off,s[20:23],s92 sc1
buffer_load_dwordx4 v[36:39],v0,s[20:23],s93 offen offset:1024 sc1
s_waitcnt vmcnt(5)
v_max3_u32 v124,v24,v25,v26
v_smfmac_f32_16x16x64_bf16 v[68:71],v[20:23],a[104:111],v1
v_max_u32 v124,v124,v27
v_cmp_eq_u32 vcc,-1,v124
v_smfmac_f32_16x16x64_bf16 v[72:75],v[20:23],a[112:119],v1
v_smfmac_f32_16x16x64_bf16 v[76:79],v[20:23],a[120:127],v1
s_cbranch_vccnz fl_100891
seg_100875:
segb_100883:
v_smfmac_f32_16x16x64_bf16 v[64:67],v[24:27],a[160:167],v1
buffer_load_dword v125,off,s[20:23],s92 sc1
buffer_load_dwordx4 v[40:43],v0,s[20:23],s93 offen offset:2048 sc1
buffer_load_dwordx4 v[44:47],v0,s[20:23],s93 offen offset:3072 sc1
s_waitcnt vmcnt(7)
v_max3_u32 v124,v28,v29,v30
v_smfmac_f32_16x16x64_bf16 v[68:71],v[24:27],a[168:175],v1
v_max_u32 v124,v124,v31
v_cmp_eq_u32 vcc,-1,v124
v_smfmac_f32_16x16x64_bf16 v[72:75],v[24:27],a[176:183],v1
v_smfmac_f32_16x16x64_bf16 v[76:79],v[24:27],a[184:191],v1
s_cbranch_vccnz fl_100892
seg_100876:
segb_100884:
v_smfmac_f32_16x16x64_bf16 v[64:67],v[28:31],a[224:231],v1
buffer_load_dword v125,off,s[20:23],s92 sc1
buffer_store_dword v126,v121,s[20:23],s69 offen sc1
s_waitcnt vmcnt(7)
v_max3_u32 v124,v32,v33,v34
v_smfmac_f32_16x16x64_bf16 v[68:71],v[28:31],a[232:239],v1
v_max_u32 v124,v124,v35
v_cmp_eq_u32 vcc,-1,v124
v_smfmac_f32_16x16x64_bf16 v[72:75],v[28:31],a[240:247],v1
v_smfmac_f32_16x16x64_bf16 v[76:79],v[28:31],a[248:255],v1
s_cbranch_vccnz fl_100893
seg_100877:
segb_100885:
v_smfmac_f32_16x16x64_bf16 v[64:67],v[32:35],a[32:39],v1
buffer_load_dword v125,off,s[20:23],s92 sc1
s_waitcnt vmcnt(6)
v_max3_u32 v124,v36,v37,v38
v_smfmac_f32_16x16x64_bf16 v[68:71],v[32:35],a[40:47],v1
v_max_u32 v124,v124,v39
v_cmp_eq_u32 vcc,-1,v124
v_smfmac_f32_16x16x64_bf16 v[72:75],v[32:35],a[48:55],v1
v_smfmac_f32_16x16x64_bf16 v[76:79],v[32:35],a[56:63],v1
s_cbranch_vccnz fl_100894
seg_100878:
segb_100886:
v_smfmac_f32_16x16x64_bf16 v[64:67],v[36:39],a[96:103],v1
buffer_load_dword v125,off,s[20:23],s92 sc1
s_waitcnt vmcnt(4)
v_max3_u32 v124,v40,v41,v42
v_smfmac_f32_16x16x64_bf16 v[68:71],v[36:39],a[104:111],v1
v_max3_u32 v124,v124,v43,v44
v_max3_u32 v124,v124,v45,v46
v_max_u32 v124,v124,v47
v_cmp_eq_u32 vcc,-1,v124
v_smfmac_f32_16x16x64_bf16 v[72:75],v[36:39],a[112:119],v1
v_smfmac_f32_16x16x64_bf16 v[76:79],v[36:39],a[120:127],v1
s_cbranch_vccnz fl_100895
seg_100879:
segb_100887:
v_smfmac_f32_16x16x64_bf16 v[64:67],v[40:43],a[160:167],v1
v_smfmac_f32_16x16x64_bf16 v[68:71],v[40:43],a[168:175],v1
v_smfmac_f32_16x16x64_bf16 v[64:67],v[44:47],a[224:231],v1
v_smfmac_f32_16x16x64_bf16 v[68:71],v[44:47],a[232:239],v1
v_smfmac_f32_16x16x64_bf16 v[72:75],v[40:43],a[176:183],v1
s_nop 1
v_add_f32 v64,v64,v65
v_smfmac_f32_16x16x64_bf16 v[76:79],v[40:43],a[184:191],v1
ds_write_addtid_b32 v64 offset:8448
v_add_f32 v66,v66,v67
v_smfmac_f32_16x16x64_bf16 v[72:75],v[44:47],a[240:247],v1
ds_write_addtid_b32 v66 offset:9488
v_add_f32 v68,v68,v69
v_smfmac_f32_16x16x64_bf16 v[76:79],v[44:47],a[248:255],v1
ds_write_addtid_b32 v68 offset:10528
v_add_f32 v70,v70,v71
v_smfmac_f32_16x16x64_bf16 v[80:83],v[16:19],v[208:215],v1
ds_write_addtid_b32 v70 offset:11568
v_add_f32 v72,v72,v73
v_smfmac_f32_16x16x64_bf16 v[80:83],v[32:35],v[208:215],v1
ds_write_addtid_b32 v72 offset:12608
v_add_f32 v74,v74,v75
v_smfmac_f32_16x16x64_bf16 v[84:87],v[16:19],v[216:223],v1
ds_write_addtid_b32 v74 offset:13648
v_add_f32 v76,v76,v77
v_smfmac_f32_16x16x64_bf16 v[84:87],v[32:35],v[216:223],v1
ds_write_addtid_b32 v76 offset:14688
v_add_f32 v78,v78,v79
v_smfmac_f32_16x16x64_bf16 v[88:91],v[16:19],v[224:231],v1
ds_write_addtid_b32 v78 offset:15728
v_smfmac_f32_16x16x64_bf16 v[88:91],v[32:35],v[224:231],v1
v_smfmac_f32_16x16x64_bf16 v[92:95],v[16:19],v[232:239],v1
v_smfmac_f32_16x16x64_bf16 v[92:95],v[32:35],v[232:239],v1
doneA_100906:
s_waitcnt vmcnt(0) lgkmcnt(0)
s_add_u32 s64,s79,0
s_lshl_b32 s65,s64,12
s_and_b32 s65,s65,0x2000
s_xor_b32 s65,s65,s67
s_lshl_b32 s64,s64,20
s_add_u32 s65,s65,s64
s_add_u32 s101,s65,s78
v_smfmac_f32_16x16x64_bf16 v[80:83],v[20:23],v[240:247],v1
ds_read_b128 v[48:51],v7 offset:0
ds_read_b128 v[52:55],v7 offset:1024
v_smfmac_f32_16x16x64_bf16 v[80:83],v[36:39],v[240:247],v1
ds_read_b128 v[56:59],v7 offset:2048
ds_read_b128 v[60:63],v7 offset:3072
v_smfmac_f32_16x16x64_bf16 v[84:87],v[20:23],v[248:255],v1
ds_read_b128 v[64:67],v7 offset:4096
ds_read_b128 v[68:71],v7 offset:5120
v_smfmac_f32_16x16x64_bf16 v[84:87],v[36:39],v[248:255],v1
ds_read_b128 v[72:75],v7 offset:6144
ds_read_b128 v[76:79],v7 offset:7168
s_waitcnt lgkmcnt(6)
v_smfmac_f32_16x16x64_bf16 v[88:91],v[20:23],v[48:55],v1
v_smfmac_f32_16x16x64_bf16 v[88:91],v[36:39],v[48:55],v1
ds_read_b128 v[48:51],v7 offset:8192
ds_read_b128 v[52:55],v7 offset:9216
s_waitcnt lgkmcnt(6)
v_smfmac_f32_16x16x64_bf16 v[92:95],v[20:23],v[56:63],v1
v_smfmac_f32_16x16x64_bf16 v[92:95],v[36:39],v[56:63],v1
ds_read_b128 v[56:59],v7 offset:10240
ds_read_b128 v[60:63],v7 offset:11264
s_waitcnt lgkmcnt(6)
v_smfmac_f32_16x16x64_bf16 v[80:83],v[24:27],v[64:71],v1
v_smfmac_f32_16x16x64_bf16 v[80:83],v[40:43],v[64:71],v1
ds_read_b128 v[64:67],v7 offset:12288
ds_read_b128 v[68:71],v7 offset:13312
s_waitcnt lgkmcnt(6)
v_smfmac_f32_16x16x64_bf16 v[84:87],v[24:27],v[72:79],v1
v_smfmac_f32_16x16x64_bf16 v[84:87],v[40:43],v[72:79],v1
ds_read_b128 v[72:75],v7 offset:14336
ds_read_b128 v[76:79],v7 offset:15360
s_waitcnt lgkmcnt(6)
v_smfmac_f32_16x16x64_bf16 v[88:91],v[24:27],v[48:55],v1
v_smfmac_f32_16x16x64_bf16 v[88:91],v[40:43],v[48:55],v1
ds_read_b128 v[48:51],v7 offset:16384
ds_read_b128 v[52:55],v7 offset:17408
s_waitcnt lgkmcnt(6)
v_smfmac_f32_16x16x64_bf16 v[92:95],v[24:27],v[56:63],v1
v_smfmac_f32_16x16x64_bf16 v[92:95],v[40:43],v[56:63],v1
ds_read_b128 v[56:59],v7 offset:18432
ds_read_b128 v[60:63],v7 offset:19456
s_waitcnt lgkmcnt(6)
v_smfmac_f32_16x16x64_bf16 v[80:83],v[28:31],v[64:71],v1
v_smfmac_f32_16x16x64_bf16 v[80:83],v[44:47],v[64:71],v1
s_waitcnt lgkmcnt(4)
v_smfmac_f32_16x16x64_bf16 v[84:87],v[28:31],v[72:79],v1
v_smfmac_f32_16x16x64_bf16 v[84:87],v[44:47],v[72:79],v1
s_waitcnt lgkmcnt(2)
v_smfmac_f32_16x16x64_bf16 v[88:91],v[28:31],v[48:55],v1
v_add_f32 v80,v80,v81
v_smfmac_f32_16x16x64_bf16 v[88:91],v[44:47],v[48:55],v1
v_add_f32 v82,v82,v83
s_waitcnt lgkmcnt(0)
v_smfmac_f32_16x16x64_bf16 v[92:95],v[28:31],v[56:63],v1
v_cvt_pk_bf16_f32 v80,v80,v82
v_smfmac_f32_16x16x64_bf16 v[92:95],v[44:47],v[56:63],v1
ds_write_addtid_b32 v80 offset:16896
v_add_f32 v84,v84,v85
v_add_f32 v86,v86,v87
v_cvt_pk_bf16_f32 v84,v84,v86
v_add_f32 v88,v88,v89
v_add_f32 v90,v90,v91
v_cvt_pk_bf16_f32 v88,v88,v90
s_nop 0
v_add_f32 v92,v92,v93
v_add_f32 v94,v94,v95
v_cvt_pk_bf16_f32 v92,v92,v94
ds_write_addtid_b32 v84 offset:17920
ds_write_addtid_b32 v88 offset:18944
ds_write_addtid_b32 v92 offset:19968
s_waitcnt lgkmcnt(0)
s_barrier
s_cmp_gt_u32 s50,1
s_cbranch_scc1 l23_100907
ds_read2st64_b32 v[112:113],v127 offset0:66 offset1:67
ds_read2st64_b32 v[114:115],v127 offset0:68 offset1:69
ds_read2st64_b32 v[116:117],v127 offset0:70 offset1:71
ds_read2st64_b32 v[118:119],v127 offset0:72 offset1:73
s_waitcnt lgkmcnt(0)
v_mov_b32 v120,v5
v_mov_b32 v121,v5
v_mov_b32 v122,v5
v_mov_b32 v123,v5
s_nop 1
v_mfma_f32_16x16x32_bf16 v[112:115],v[120:123],v[112:115],0
v_mfma_f32_16x16x32_bf16 v[116:119],v[120:123],v[116:119],0
s_nop 4
v_cvt_pk_bf16_f32 v112,v112,v113
v_cvt_pk_bf16_f32 v113,v114,v115
s_nop 0
v_cvt_pk_bf16_f32 v114,v116,v117
v_cvt_pk_bf16_f32 v115,v118,v119
s_branch lj_100908
l23_100907:
ds_read_b128 v[48:51],v2 offset:0
ds_read_b128 v[52:55],v2 offset:256
ds_read_b128 v[56:59],v2 offset:512
ds_read_b128 v[60:63],v2 offset:768
ds_read_b128 v[64:67],v2 offset:16
ds_read_b128 v[68:71],v2 offset:272
ds_read_b128 v[72:75],v2 offset:528
ds_read_b128 v[76:79],v2 offset:784
s_waitcnt lgkmcnt(6)
v_pk_add_f32 v[48:49],v[48:49],v[52:53]
v_pk_add_f32 v[50:51],v[50:51],v[54:55]
s_waitcnt lgkmcnt(4)
v_pk_add_f32 v[56:57],v[56:57],v[60:61]
v_pk_add_f32 v[58:59],v[58:59],v[62:63]
v_pk_add_f32 v[48:49],v[48:49],v[56:57]
v_pk_add_f32 v[50:51],v[50:51],v[58:59]
v_cvt_pk_bf16_f32 v112,v48,v49
v_cvt_pk_bf16_f32 v113,v50,v51
s_waitcnt lgkmcnt(2)
v_pk_add_f32 v[64:65],v[64:65],v[68:69]
v_pk_add_f32 v[66:67],v[66:67],v[70:71]
s_waitcnt lgkmcnt(0)
v_pk_add_f32 v[72:73],v[72:73],v[76:77]
v_pk_add_f32 v[74:75],v[74:75],v[78:79]
v_pk_add_f32 v[64:65],v[64:65],v[72:73]
v_pk_add_f32 v[66:67],v[66:67],v[74:75]
v_cvt_pk_bf16_f32 v114,v64,v65
v_cvt_pk_bf16_f32 v115,v66,v67
lj_100908:
v_cndmask_b32 v120,2.0,v0,s[82:83]
v_cndmask_b32 v121,2.0,v127,s[86:87]
buffer_store_dwordx4 v[112:115],v120,s[20:23],s101 offen sc1
s_waitcnt vmcnt(0)
s_barrier
v_mov_b32 v126,64
buffer_store_dword v126,v121,s[20:23],s69 offen sc1
s_branch recfin_100408
pe_100814:
s_waitcnt vmcnt(5)
v_readfirstlane_b32 s91,v119
s_cmp_gt_u32 s91,s79
s_cbranch_scc0 pb_100815
s_add_u32 s64,s79,0
s_lshl_b32 s65,s64,12
s_and_b32 s65,s65,0x2000
s_xor_b32 s65,s65,s67
s_lshl_b32 s64,s64,20
s_add_u32 s65,s65,s64
s_add_u32 s62,s65,s77
buffer_load_dwordx4 v[96:99],v0,s[20:23],s62 offen
buffer_load_dwordx4 v[100:103],v0,s[20:23],s62 offen offset:1024
s_mov_b32 s61,0
s_branch pb_100815
pq_100816:
s_cmp_gt_u32 s91,s79
s_cbranch_scc1 pg_100819
pl_100818:
buffer_load_dword v124,off,s[20:23],s68 sc1
s_waitcnt vmcnt(0)
v_readfirstlane_b32 s91,v124
s_cmp_gt_u32 s91,s79
s_cbranch_scc1 pg_100819
s_sleep 2
s_sub_u32 s90,s90,1
s_cmp_gt_i32 s90,0
s_cbranch_scc1 pl_100818
pg_100819:
s_add_u32 s64,s79,0
s_lshl_b32 s65,s64,12
s_and_b32 s65,s65,0x2000
s_xor_b32 s65,s65,s67
s_lshl_b32 s64,s64,20
s_add_u32 s65,s65,s64
s_add_u32 s62,s65,s77
buffer_load_dwordx4 v[96:99],v0,s[20:23],s62 offen
buffer_load_dwordx4 v[100:103],v0,s[20:23],s62 offen offset:1024
s_waitcnt vmcnt(0)
s_branch pk_100817
fl_100836:
flb_100844:
buffer_load_dwordx4 v[16:19],v0,s[20:23],s92 offen offset:0 sc1
s_mov_b32 s55,1
buffer_load_dwordx4 v[32:35],v0,s[20:23],s93 offen offset:0 sc1
s_waitcnt vmcnt(4)
v_max3_u32 v124,v20,v21,v22
v_max_u32 v124,v124,v23
v_cmp_eq_u32 vcc,-1,v124
s_cbranch_vccnz dfl_100909
v_smfmac_f32_16x16x64_bf16 v[48:51],v[20:23],a[64:71],v1
buffer_load_dword v125,off,s[20:23],s92 sc1
v_smfmac_f32_16x16x64_bf16 v[52:55],v[20:23],a[72:79],v1
buffer_load_dwordx4 v[36:39],v0,s[20:23],s93 offen offset:1024 sc1
v_smfmac_f32_16x16x64_bf16 v[56:59],v[20:23],a[80:87],v1
s_waitcnt vmcnt(5)
v_max3_u32 v124,v24,v25,v26
v_smfmac_f32_16x16x64_bf16 v[60:63],v[20:23],a[88:95],v1
v_max_u32 v124,v124,v27
v_smfmac_f32_16x16x64_bf16 v[64:67],v[20:23],a[96:103],v1
v_cmp_eq_u32 vcc,-1,v124
v_smfmac_f32_16x16x64_bf16 v[68:71],v[20:23],a[104:111],v1
v_smfmac_f32_16x16x64_bf16 v[72:75],v[20:23],a[112:119],v1
v_smfmac_f32_16x16x64_bf16 v[76:79],v[20:23],a[120:127],v1
s_cbranch_vccnz dfl_100910
v_smfmac_f32_16x16x64_bf16 v[48:51],v[24:27],a[128:135],v1
buffer_load_dword v125,off,s[20:23],s92 sc1
v_smfmac_f32_16x16x64_bf16 v[52:55],v[24:27],a[136:143],v1
buffer_load_dwordx4 v[40:43],v0,s[20:23],s93 offen offset:2048 sc1
v_smfmac_f32_16x16x64_bf16 v[56:59],v[24:27],a[144:151],v1
buffer_load_dwordx4 v[44:47],v0,s[20:23],s93 offen offset:3072 sc1
s_waitcnt vmcnt(7)
v_max3_u32 v124,v28,v29,v30
v_smfmac_f32_16x16x64_bf16 v[60:63],v[24:27],a[152:159],v1
v_max_u32 v124,v124,v31
v_smfmac_f32_16x16x64_bf16 v[64:67],v[24:27],a[160:167],v1
v_cmp_eq_u32 vcc,-1,v124
v_smfmac_f32_16x16x64_bf16 v[68:71],v[24:27],a[168:175],v1
v_smfmac_f32_16x16x64_bf16 v[72:75],v[24:27],a[176:183],v1
v_smfmac_f32_16x16x64_bf16 v[76:79],v[24:27],a[184:191],v1
s_cbranch_vccnz dfl_100911
v_smfmac_f32_16x16x64_bf16 v[48:51],v[28:31],a[192:199],v1
buffer_load_dword v125,off,s[20:23],s92 sc1
v_smfmac_f32_16x16x64_bf16 v[52:55],v[28:31],a[200:207],v1
buffer_store_dword v126,v121,s[20:23],s69 offen sc1
v_smfmac_f32_16x16x64_bf16 v[56:59],v[28:31],a[208:215],v1
s_waitcnt vmcnt(8)
v_max3_u32 v124,v16,v17,v18
v_smfmac_f32_16x16x64_bf16 v[60:63],v[28:31],a[216:223],v1
v_max_u32 v124,v124,v19
v_smfmac_f32_16x16x64_bf16 v[64:67],v[28:31],a[224:231],v1
v_cmp_eq_u32 vcc,-1,v124
v_smfmac_f32_16x16x64_bf16 v[68:71],v[28:31],a[232:239],v1
v_smfmac_f32_16x16x64_bf16 v[72:75],v[28:31],a[240:247],v1
v_smfmac_f32_16x16x64_bf16 v[76:79],v[28:31],a[248:255],v1
s_cbranch_vccnz lfb_100916
s_mov_b32 s55,0
v_smfmac_f32_16x16x64_bf16 v[48:51],v[16:19],a[0:7],v1
v_smfmac_f32_16x16x64_bf16 v[52:55],v[16:19],a[8:15],v1
v_smfmac_f32_16x16x64_bf16 v[56:59],v[16:19],a[16:23],v1
s_waitcnt vmcnt(7)
v_max3_u32 v124,v32,v33,v34
v_max_u32 v124,v124,v35
v_cmp_eq_u32 vcc,-1,v124
v_smfmac_f32_16x16x64_bf16 v[60:63],v[16:19],a[24:31],v1
v_smfmac_f32_16x16x64_bf16 v[64:67],v[16:19],a[32:39],v1
v_smfmac_f32_16x16x64_bf16 v[68:71],v[16:19],a[40:47],v1
v_smfmac_f32_16x16x64_bf16 v[72:75],v[16:19],a[48:55],v1
v_smfmac_f32_16x16x64_bf16 v[76:79],v[16:19],a[56:63],v1
s_cbranch_vccnz flb_100848
s_branch segb_100832
fl_100837:
v_smfmac_f32_16x16x64_bf16 v[76:79],v[16:19],a[56:63],v1
flb_100845:
buffer_load_dwordx4 v[20:23],v0,s[20:23],s92 offen offset:1024 sc1
s_mov_b32 s55,2
buffer_load_dwordx4 v[36:39],v0,s[20:23],s93 offen offset:1024 sc1
s_waitcnt vmcnt(5)
v_max3_u32 v124,v24,v25,v26
v_max_u32 v124,v124,v27
v_cmp_eq_u32 vcc,-1,v124
s_cbranch_vccnz dfl_100910
v_smfmac_f32_16x16x64_bf16 v[48:51],v[24:27],a[128:135],v1
buffer_load_dword v125,off,s[20:23],s92 sc1
v_smfmac_f32_16x16x64_bf16 v[52:55],v[24:27],a[136:143],v1
buffer_load_dwordx4 v[40:43],v0,s[20:23],s93 offen offset:2048 sc1
v_smfmac_f32_16x16x64_bf16 v[56:59],v[24:27],a[144:151],v1
buffer_load_dwordx4 v[44:47],v0,s[20:23],s93 offen offset:3072 sc1
s_waitcnt vmcnt(7)
v_max3_u32 v124,v28,v29,v30
v_smfmac_f32_16x16x64_bf16 v[60:63],v[24:27],a[152:159],v1
v_max_u32 v124,v124,v31
v_smfmac_f32_16x16x64_bf16 v[64:67],v[24:27],a[160:167],v1
v_cmp_eq_u32 vcc,-1,v124
v_smfmac_f32_16x16x64_bf16 v[68:71],v[24:27],a[168:175],v1
v_smfmac_f32_16x16x64_bf16 v[72:75],v[24:27],a[176:183],v1
v_smfmac_f32_16x16x64_bf16 v[76:79],v[24:27],a[184:191],v1
s_cbranch_vccnz dfl_100911
v_smfmac_f32_16x16x64_bf16 v[48:51],v[28:31],a[192:199],v1
buffer_load_dword v125,off,s[20:23],s92 sc1
v_smfmac_f32_16x16x64_bf16 v[52:55],v[28:31],a[200:207],v1
buffer_store_dword v126,v121,s[20:23],s69 offen sc1
v_smfmac_f32_16x16x64_bf16 v[56:59],v[28:31],a[208:215],v1
s_waitcnt vmcnt(6)
v_max3_u32 v124,v20,v21,v22
v_smfmac_f32_16x16x64_bf16 v[60:63],v[28:31],a[216:223],v1
v_max_u32 v124,v124,v23
v_smfmac_f32_16x16x64_bf16 v[64:67],v[28:31],a[224:231],v1
v_cmp_eq_u32 vcc,-1,v124
v_smfmac_f32_16x16x64_bf16 v[68:71],v[28:31],a[232:239],v1
v_smfmac_f32_16x16x64_bf16 v[72:75],v[28:31],a[240:247],v1
v_smfmac_f32_16x16x64_bf16 v[76:79],v[28:31],a[248:255],v1
s_cbranch_vccnz lfb_100916
s_mov_b32 s55,0
v_smfmac_f32_16x16x64_bf16 v[48:51],v[20:23],a[64:71],v1
v_smfmac_f32_16x16x64_bf16 v[52:55],v[20:23],a[72:79],v1
v_smfmac_f32_16x16x64_bf16 v[56:59],v[20:23],a[80:87],v1
s_waitcnt vmcnt(7)
v_max3_u32 v124,v32,v33,v34
v_max_u32 v124,v124,v35
v_cmp_eq_u32 vcc,-1,v124
v_smfmac_f32_16x16x64_bf16 v[60:63],v[20:23],a[88:95],v1
v_smfmac_f32_16x16x64_bf16 v[64:67],v[20:23],a[96:103],v1
v_smfmac_f32_16x16x64_bf16 v[68:71],v[20:23],a[104:111],v1
v_smfmac_f32_16x16x64_bf16 v[72:75],v[20:23],a[112:119],v1
v_smfmac_f32_16x16x64_bf16 v[76:79],v[20:23],a[120:127],v1
s_cbranch_vccnz flb_100848
s_branch segb_100832
fl_100838:
v_smfmac_f32_16x16x64_bf16 v[76:79],v[20:23],a[120:127],v1
flb_100846:
buffer_load_dwordx4 v[24:27],v0,s[20:23],s92 offen offset:2048 sc1
s_mov_b32 s55,4
buffer_load_dwordx4 v[40:43],v0,s[20:23],s93 offen offset:2048 sc1
buffer_load_dwordx4 v[44:47],v0,s[20:23],s93 offen offset:3072 sc1
s_waitcnt vmcnt(7)
v_max3_u32 v124,v28,v29,v30
v_max_u32 v124,v124,v31
v_cmp_eq_u32 vcc,-1,v124
s_cbranch_vccnz dfl_100911
v_smfmac_f32_16x16x64_bf16 v[48:51],v[28:31],a[192:199],v1
buffer_load_dword v125,off,s[20:23],s92 sc1
v_smfmac_f32_16x16x64_bf16 v[52:55],v[28:31],a[200:207],v1
buffer_store_dword v126,v121,s[20:23],s69 offen sc1
v_smfmac_f32_16x16x64_bf16 v[56:59],v[28:31],a[208:215],v1
s_waitcnt vmcnt(4)
v_max3_u32 v124,v24,v25,v26
v_smfmac_f32_16x16x64_bf16 v[60:63],v[28:31],a[216:223],v1
v_max_u32 v124,v124,v27
v_smfmac_f32_16x16x64_bf16 v[64:67],v[28:31],a[224:231],v1
v_cmp_eq_u32 vcc,-1,v124
v_smfmac_f32_16x16x64_bf16 v[68:71],v[28:31],a[232:239],v1
v_smfmac_f32_16x16x64_bf16 v[72:75],v[28:31],a[240:247],v1
v_smfmac_f32_16x16x64_bf16 v[76:79],v[28:31],a[248:255],v1
s_cbranch_vccnz lfb_100916
s_mov_b32 s55,0
v_smfmac_f32_16x16x64_bf16 v[48:51],v[24:27],a[128:135],v1
v_smfmac_f32_16x16x64_bf16 v[52:55],v[24:27],a[136:143],v1
v_smfmac_f32_16x16x64_bf16 v[56:59],v[24:27],a[144:151],v1
s_waitcnt vmcnt(7)
v_max3_u32 v124,v32,v33,v34
v_max_u32 v124,v124,v35
v_cmp_eq_u32 vcc,-1,v124
v_smfmac_f32_16x16x64_bf16 v[60:63],v[24:27],a[152:159],v1
v_smfmac_f32_16x16x64_bf16 v[64:67],v[24:27],a[160:167],v1
v_smfmac_f32_16x16x64_bf16 v[68:71],v[24:27],a[168:175],v1
v_smfmac_f32_16x16x64_bf16 v[72:75],v[24:27],a[176:183],v1
v_smfmac_f32_16x16x64_bf16 v[76:79],v[24:27],a[184:191],v1
s_cbranch_vccnz flb_100848
s_branch segb_100832
fl_100839:
v_smfmac_f32_16x16x64_bf16 v[76:79],v[24:27],a[184:191],v1
flb_100847:
buffer_load_dwordx4 v[28:31],v0,s[20:23],s92 offen offset:3072 sc1
s_mov_b32 s55,8
buffer_store_dword v126,v121,s[20:23],s69 offen sc1
s_waitcnt vmcnt(1)
v_max3_u32 v124,v28,v29,v30
v_max_u32 v124,v124,v31
v_cmp_eq_u32 vcc,-1,v124
s_cbranch_vccnz lfb_100916
s_mov_b32 s55,0
v_smfmac_f32_16x16x64_bf16 v[48:51],v[28:31],a[192:199],v1
v_smfmac_f32_16x16x64_bf16 v[52:55],v[28:31],a[200:207],v1
v_smfmac_f32_16x16x64_bf16 v[56:59],v[28:31],a[208:215],v1
s_waitcnt vmcnt(7)
v_max3_u32 v124,v32,v33,v34
v_max_u32 v124,v124,v35
v_cmp_eq_u32 vcc,-1,v124
v_smfmac_f32_16x16x64_bf16 v[60:63],v[28:31],a[216:223],v1
v_smfmac_f32_16x16x64_bf16 v[64:67],v[28:31],a[224:231],v1
v_smfmac_f32_16x16x64_bf16 v[68:71],v[28:31],a[232:239],v1
v_smfmac_f32_16x16x64_bf16 v[72:75],v[28:31],a[240:247],v1
v_smfmac_f32_16x16x64_bf16 v[76:79],v[28:31],a[248:255],v1
s_cbranch_vccnz flb_100848
s_branch segb_100832
fl_100840:
v_smfmac_f32_16x16x64_bf16 v[76:79],v[28:31],a[248:255],v1
flb_100848:
buffer_load_dwordx4 v[32:35],v0,s[20:23],s93 offen offset:0 sc1
s_mov_b32 s55,240
s_bitcmp1_b32 s55,5
s_cbranch_scc0 rdn_100919
s_waitcnt vmcnt(6)
v_max3_u32 v124,v36,v37,v38
v_max_u32 v124,v124,v39
v_cmp_eq_u32 vcc,-1,v124
s_cbranch_vccnz rfa_100920
buffer_load_dword v125,off,s[20:23],s92 sc1
s_bitset0_b32 s55,5
v_smfmac_f32_16x16x64_bf16 v[48:51],v[36:39],a[64:71],v1
v_smfmac_f32_16x16x64_bf16 v[52:55],v[36:39],a[72:79],v1
v_smfmac_f32_16x16x64_bf16 v[56:59],v[36:39],a[80:87],v1
v_smfmac_f32_16x16x64_bf16 v[60:63],v[36:39],a[88:95],v1
v_smfmac_f32_16x16x64_bf16 v[64:67],v[36:39],a[96:103],v1
v_smfmac_f32_16x16x64_bf16 v[68:71],v[36:39],a[104:111],v1
v_smfmac_f32_16x16x64_bf16 v[72:75],v[36:39],a[112:119],v1
v_smfmac_f32_16x16x64_bf16 v[76:79],v[36:39],a[120:127],v1
s_cmp_eq_u32 s55,0
s_cbranch_scc1 segb_100834
s_branch rnx_100921
rdn_100919:
buffer_load_dword v125,off,s[20:23],s92 sc1
s_branch rnx_100921
rfa_100920:
buffer_load_dwordx4 v[36:39],v0,s[20:23],s93 offen offset:1024 sc1
rnx_100921:
s_bitcmp1_b32 s55,6
s_cbranch_scc0 rdn_100922
s_waitcnt vmcnt(5)
v_max3_u32 v124,v40,v41,v42
v_max_u32 v124,v124,v43
v_cmp_eq_u32 vcc,-1,v124
s_cbranch_vccnz rfa_100923
buffer_load_dword v125,off,s[20:23],s92 sc1
s_bitset0_b32 s55,6
s_cmp_eq_u32 s55,0
s_cbranch_scc1 segb_100834
s_branch rnx_100924
rdn_100922:
buffer_load_dword v125,off,s[20:23],s92 sc1
s_branch rnx_100924
rfa_100923:
buffer_load_dwordx4 v[40:43],v0,s[20:23],s93 offen offset:2048 sc1
rnx_100924:
s_bitcmp1_b32 s55,7
s_cbranch_scc0 rdn_100925
s_waitcnt vmcnt(5)
v_max3_u32 v124,v44,v45,v46
v_max_u32 v124,v124,v47
v_cmp_eq_u32 vcc,-1,v124
s_cbranch_vccnz rfa_100926
buffer_load_dword v125,off,s[20:23],s92 sc1
s_bitset0_b32 s55,7
s_cmp_eq_u32 s55,0
s_cbranch_scc1 segb_100834
s_branch rnx_100927
rdn_100925:
buffer_load_dword v125,off,s[20:23],s92 sc1
s_branch rnx_100927
rfa_100926:
buffer_load_dwordx4 v[44:47],v0,s[20:23],s93 offen offset:3072 sc1
rnx_100927:
rot_100918:
s_bitcmp1_b32 s55,4
s_cbranch_scc0 rdn_100928
s_waitcnt vmcnt(3)
v_max3_u32 v124,v32,v33,v34
v_max_u32 v124,v124,v35
v_cmp_eq_u32 vcc,-1,v124
s_cbranch_vccnz rfa_100929
buffer_load_dword v125,off,s[20:23],s92 sc1
s_bitset0_b32 s55,4
v_smfmac_f32_16x16x64_bf16 v[48:51],v[32:35],a[0:7],v1
v_smfmac_f32_16x16x64_bf16 v[52:55],v[32:35],a[8:15],v1
v_smfmac_f32_16x16x64_bf16 v[56:59],v[32:35],a[16:23],v1
v_smfmac_f32_16x16x64_bf16 v[60:63],v[32:35],a[24:31],v1
v_smfmac_f32_16x16x64_bf16 v[64:67],v[32:35],a[32:39],v1
v_smfmac_f32_16x16x64_bf16 v[68:71],v[32:35],a[40:47],v1
v_smfmac_f32_16x16x64_bf16 v[72:75],v[32:35],a[48:55],v1
v_smfmac_f32_16x16x64_bf16 v[76:79],v[32:35],a[56:63],v1
s_cmp_eq_u32 s55,0
s_cbranch_scc1 segb_100834
s_branch rnx_100930
rdn_100928:
buffer_load_dword v125,off,s[20:23],s92 sc1
s_branch rnx_100930
rfa_100929:
buffer_load_dwordx4 v[32:35],v0,s[20:23],s93 offen offset:0 sc1
rnx_100930:
s_bitcmp1_b32 s55,5
s_cbranch_scc0 rdn_100931
s_waitcnt vmcnt(3)
v_max3_u32 v124,v36,v37,v38
v_max_u32 v124,v124,v39
v_cmp_eq_u32 vcc,-1,v124
s_cbranch_vccnz rfa_100932
buffer_load_dword v125,off,s[20:23],s92 sc1
s_bitset0_b32 s55,5
v_smfmac_f32_16x16x64_bf16 v[48:51],v[36:39],a[64:71],v1
v_smfmac_f32_16x16x64_bf16 v[52:55],v[36:39],a[72:79],v1
v_smfmac_f32_16x16x64_bf16 v[56:59],v[36:39],a[80:87],v1
v_smfmac_f32_16x16x64_bf16 v[60:63],v[36:39],a[88:95],v1
v_smfmac_f32_16x16x64_bf16 v[64:67],v[36:39],a[96:103],v1
v_smfmac_f32_16x16x64_bf16 v[68:71],v[36:39],a[104:111],v1
v_smfmac_f32_16x16x64_bf16 v[72:75],v[36:39],a[112:119],v1
v_smfmac_f32_16x16x64_bf16 v[76:79],v[36:39],a[120:127],v1
s_cmp_eq_u32 s55,0
s_cbranch_scc1 segb_100834
s_branch rnx_100933
rdn_100931:
buffer_load_dword v125,off,s[20:23],s92 sc1
s_branch rnx_100933
rfa_100932:
buffer_load_dwordx4 v[36:39],v0,s[20:23],s93 offen offset:1024 sc1
rnx_100933:
s_bitcmp1_b32 s55,6
s_cbranch_scc0 rdn_100934
s_waitcnt vmcnt(3)
v_max3_u32 v124,v40,v41,v42
v_max_u32 v124,v124,v43
v_cmp_eq_u32 vcc,-1,v124
s_cbranch_vccnz rfa_100935
buffer_load_dword v125,off,s[20:23],s92 sc1
s_bitset0_b32 s55,6
s_cmp_eq_u32 s55,0
s_cbranch_scc1 segb_100834
s_branch rnx_100936
rdn_100934:
buffer_load_dword v125,off,s[20:23],s92 sc1
s_branch rnx_100936
rfa_100935:
buffer_load_dwordx4 v[40:43],v0,s[20:23],s93 offen offset:2048 sc1
rnx_100936:
s_bitcmp1_b32 s55,7
s_cbranch_scc0 rdn_100937
s_waitcnt vmcnt(3)
v_max3_u32 v124,v44,v45,v46
v_max_u32 v124,v124,v47
v_cmp_eq_u32 vcc,-1,v124
s_cbranch_vccnz rfa_100938
buffer_load_dword v125,off,s[20:23],s92 sc1
s_bitset0_b32 s55,7
s_cmp_eq_u32 s55,0
s_cbranch_scc1 segb_100834
s_branch rnx_100939
rdn_100937:
buffer_load_dword v125,off,s[20:23],s92 sc1
s_branch rnx_100939
rfa_100938:
buffer_load_dwordx4 v[44:47],v0,s[20:23],s93 offen offset:3072 sc1
rnx_100939:
s_sub_u32 s90,s90,1
s_cmp_gt_i32 s90,0
s_cbranch_scc1 rot_100918
s_mov_b32 s55,0
s_branch segb_100834
fl_100841:
v_smfmac_f32_16x16x64_bf16 v[76:79],v[32:35],a[56:63],v1
flb_100849:
buffer_load_dwordx4 v[36:39],v0,s[20:23],s93 offen offset:1024 sc1
s_mov_b32 s55,224
s_bitcmp1_b32 s55,6
s_cbranch_scc0 rdn_100941
s_waitcnt vmcnt(5)
v_max3_u32 v124,v40,v41,v42
v_max_u32 v124,v124,v43
v_cmp_eq_u32 vcc,-1,v124
s_cbranch_vccnz rfa_100942
buffer_load_dword v125,off,s[20:23],s92 sc1
s_bitset0_b32 s55,6
s_cmp_eq_u32 s55,0
s_cbranch_scc1 segb_100834
s_branch rnx_100943
rdn_100941:
buffer_load_dword v125,off,s[20:23],s92 sc1
s_branch rnx_100943
rfa_100942:
buffer_load_dwordx4 v[40:43],v0,s[20:23],s93 offen offset:2048 sc1
rnx_100943:
s_bitcmp1_b32 s55,7
s_cbranch_scc0 rdn_100944
s_waitcnt vmcnt(5)
v_max3_u32 v124,v44,v45,v46
v_max_u32 v124,v124,v47
v_cmp_eq_u32 vcc,-1,v124
s_cbranch_vccnz rfa_100945
buffer_load_dword v125,off,s[20:23],s92 sc1
s_bitset0_b32 s55,7
s_cmp_eq_u32 s55,0
s_cbranch_scc1 segb_100834
s_branch rnx_100946
rdn_100944:
buffer_load_dword v125,off,s[20:23],s92 sc1
s_branch rnx_100946
rfa_100945:
buffer_load_dwordx4 v[44:47],v0,s[20:23],s93 offen offset:3072 sc1
rnx_100946:
rot_100940:
s_bitcmp1_b32 s55,5
s_cbranch_scc0 rdn_100947
s_waitcnt vmcnt(2)
v_max3_u32 v124,v36,v37,v38
v_max_u32 v124,v124,v39
v_cmp_eq_u32 vcc,-1,v124
s_cbranch_vccnz rfa_100948
buffer_load_dword v125,off,s[20:23],s92 sc1
s_bitset0_b32 s55,5
v_smfmac_f32_16x16x64_bf16 v[48:51],v[36:39],a[64:71],v1
v_smfmac_f32_16x16x64_bf16 v[52:55],v[36:39],a[72:79],v1
v_smfmac_f32_16x16x64_bf16 v[56:59],v[36:39],a[80:87],v1
v_smfmac_f32_16x16x64_bf16 v[60:63],v[36:39],a[88:95],v1
v_smfmac_f32_16x16x64_bf16 v[64:67],v[36:39],a[96:103],v1
v_smfmac_f32_16x16x64_bf16 v[68:71],v[36:39],a[104:111],v1
v_smfmac_f32_16x16x64_bf16 v[72:75],v[36:39],a[112:119],v1
v_smfmac_f32_16x16x64_bf16 v[76:79],v[36:39],a[120:127],v1
s_cmp_eq_u32 s55,0
s_cbranch_scc1 segb_100834
s_branch rnx_100949
rdn_100947:
buffer_load_dword v125,off,s[20:23],s92 sc1
s_branch rnx_100949
rfa_100948:
buffer_load_dwordx4 v[36:39],v0,s[20:23],s93 offen offset:1024 sc1
rnx_100949:
s_bitcmp1_b32 s55,6
s_cbranch_scc0 rdn_100950
s_waitcnt vmcnt(2)
v_max3_u32 v124,v40,v41,v42
v_max_u32 v124,v124,v43
v_cmp_eq_u32 vcc,-1,v124
s_cbranch_vccnz rfa_100951
buffer_load_dword v125,off,s[20:23],s92 sc1
s_bitset0_b32 s55,6
s_cmp_eq_u32 s55,0
s_cbranch_scc1 segb_100834
s_branch rnx_100952
rdn_100950:
buffer_load_dword v125,off,s[20:23],s92 sc1
s_branch rnx_100952
rfa_100951:
buffer_load_dwordx4 v[40:43],v0,s[20:23],s93 offen offset:2048 sc1
rnx_100952:
s_bitcmp1_b32 s55,7
s_cbranch_scc0 rdn_100953
s_waitcnt vmcnt(2)
v_max3_u32 v124,v44,v45,v46
v_max_u32 v124,v124,v47
v_cmp_eq_u32 vcc,-1,v124
s_cbranch_vccnz rfa_100954
buffer_load_dword v125,off,s[20:23],s92 sc1
s_bitset0_b32 s55,7
s_cmp_eq_u32 s55,0
s_cbranch_scc1 segb_100834
s_branch rnx_100955
rdn_100953:
buffer_load_dword v125,off,s[20:23],s92 sc1
s_branch rnx_100955
rfa_100954:
buffer_load_dwordx4 v[44:47],v0,s[20:23],s93 offen offset:3072 sc1
rnx_100955:
s_sub_u32 s90,s90,1
s_cmp_gt_i32 s90,0
s_cbranch_scc1 rot_100940
s_mov_b32 s55,0
s_branch segb_100834
fl_100842:
v_smfmac_f32_16x16x64_bf16 v[76:79],v[36:39],a[120:127],v1
flb_100850:
s_mov_b32 s55,192
s_bitcmp1_b32 s55,6
s_cbranch_scc0 rdn_100957
s_waitcnt vmcnt(5)
v_max3_u32 v124,v40,v41,v42
v_max_u32 v124,v124,v43
v_cmp_eq_u32 vcc,-1,v124
s_cbranch_vccnz rfa_100958
buffer_load_dword v125,off,s[20:23],s92 sc1
s_bitset0_b32 s55,6
s_cmp_eq_u32 s55,0
s_cbranch_scc1 segb_100834
s_branch rnx_100959
rdn_100957:
buffer_load_dword v125,off,s[20:23],s92 sc1
s_branch rnx_100959
rfa_100958:
buffer_load_dwordx4 v[40:43],v0,s[20:23],s93 offen offset:2048 sc1
rnx_100959:
s_bitcmp1_b32 s55,7
s_cbranch_scc0 rdn_100960
s_waitcnt vmcnt(5)
v_max3_u32 v124,v44,v45,v46
v_max_u32 v124,v124,v47
v_cmp_eq_u32 vcc,-1,v124
s_cbranch_vccnz rfa_100961
buffer_load_dword v125,off,s[20:23],s92 sc1
s_bitset0_b32 s55,7
s_cmp_eq_u32 s55,0
s_cbranch_scc1 segb_100834
s_branch rnx_100962
rdn_100960:
buffer_load_dword v125,off,s[20:23],s92 sc1
s_branch rnx_100962
rfa_100961:
buffer_load_dwordx4 v[44:47],v0,s[20:23],s93 offen offset:3072 sc1
rnx_100962:
rot_100956:
s_bitcmp1_b32 s55,6
s_cbranch_scc0 rdn_100963
s_waitcnt vmcnt(1)
v_max3_u32 v124,v40,v41,v42
v_max_u32 v124,v124,v43
v_cmp_eq_u32 vcc,-1,v124
s_cbranch_vccnz rfa_100964
buffer_load_dword v125,off,s[20:23],s92 sc1
s_bitset0_b32 s55,6
s_cmp_eq_u32 s55,0
s_cbranch_scc1 segb_100834
s_branch rnx_100965
rdn_100963:
buffer_load_dword v125,off,s[20:23],s92 sc1
s_branch rnx_100965
rfa_100964:
buffer_load_dwordx4 v[40:43],v0,s[20:23],s93 offen offset:2048 sc1
rnx_100965:
s_bitcmp1_b32 s55,7
s_cbranch_scc0 rdn_100966
s_waitcnt vmcnt(1)
v_max3_u32 v124,v44,v45,v46
v_max_u32 v124,v124,v47
v_cmp_eq_u32 vcc,-1,v124
s_cbranch_vccnz rfa_100967
buffer_load_dword v125,off,s[20:23],s92 sc1
s_bitset0_b32 s55,7
s_cmp_eq_u32 s55,0
s_cbranch_scc1 segb_100834
s_branch rnx_100968
rdn_100966:
buffer_load_dword v125,off,s[20:23],s92 sc1
s_branch rnx_100968
rfa_100967:
buffer_load_dwordx4 v[44:47],v0,s[20:23],s93 offen offset:3072 sc1
rnx_100968:
s_sub_u32 s90,s90,1
s_cmp_gt_i32 s90,0
s_cbranch_scc1 rot_100956
s_mov_b32 s55,0
s_branch segb_100834
dfl_100909:
buffer_load_dwordx4 v[20:23],v0,s[20:23],s92 offen offset:1024 sc1
s_bitset1_b32 s55,1
buffer_load_dwordx4 v[36:39],v0,s[20:23],s93 offen offset:1024 sc1
s_waitcnt vmcnt(5)
v_max3_u32 v124,v24,v25,v26
v_max_u32 v124,v124,v27
v_cmp_eq_u32 vcc,-1,v124
s_cbranch_vccnz dfl_100910
s_branch dseg_100913
dfl_100910:
buffer_load_dwordx4 v[24:27],v0,s[20:23],s92 offen offset:2048 sc1
s_bitset1_b32 s55,2
buffer_load_dwordx4 v[40:43],v0,s[20:23],s93 offen offset:2048 sc1
buffer_load_dwordx4 v[44:47],v0,s[20:23],s93 offen offset:3072 sc1
s_waitcnt vmcnt(7)
v_max3_u32 v124,v28,v29,v30
v_max_u32 v124,v124,v31
v_cmp_eq_u32 vcc,-1,v124
s_cbranch_vccnz dfl_100911
s_branch dseg_100914
dfl_100911:
buffer_load_dwordx4 v[28:31],v0,s[20:23],s92 offen offset:3072 sc1
s_bitset1_b32 s55,3
buffer_store_dword v126,v121,s[20:23],s69 offen sc1
s_branch lap2_100915
dseg_100913:
v_smfmac_f32_16x16x64_bf16 v[48:51],v[24:27],a[128:135],v1
buffer_load_dword v125,off,s[20:23],s92 sc1
v_smfmac_f32_16x16x64_bf16 v[52:55],v[24:27],a[136:143],v1
buffer_load_dwordx4 v[40:43],v0,s[20:23],s93 offen offset:2048 sc1
v_smfmac_f32_16x16x64_bf16 v[56:59],v[24:27],a[144:151],v1
buffer_load_dwordx4 v[44:47],v0,s[20:23],s93 offen offset:3072 sc1
s_waitcnt vmcnt(7)
v_max3_u32 v124,v28,v29,v30
v_smfmac_f32_16x16x64_bf16 v[60:63],v[24:27],a[152:159],v1
v_max_u32 v124,v124,v31
v_smfmac_f32_16x16x64_bf16 v[64:67],v[24:27],a[160:167],v1
v_cmp_eq_u32 vcc,-1,v124
v_smfmac_f32_16x16x64_bf16 v[68:71],v[24:27],a[168:175],v1
v_smfmac_f32_16x16x64_bf16 v[72:75],v[24:27],a[176:183],v1
v_smfmac_f32_16x16x64_bf16 v[76:79],v[24:27],a[184:191],v1
s_cbranch_vccnz dfl_100911
dseg_100914:
v_smfmac_f32_16x16x64_bf16 v[48:51],v[28:31],a[192:199],v1
buffer_load_dword v125,off,s[20:23],s92 sc1
v_smfmac_f32_16x16x64_bf16 v[52:55],v[28:31],a[200:207],v1
buffer_store_dword v126,v121,s[20:23],s69 offen sc1
v_smfmac_f32_16x16x64_bf16 v[56:59],v[28:31],a[208:215],v1
v_smfmac_f32_16x16x64_bf16 v[60:63],v[28:31],a[216:223],v1
v_smfmac_f32_16x16x64_bf16 v[64:67],v[28:31],a[224:231],v1
v_smfmac_f32_16x16x64_bf16 v[68:71],v[28:31],a[232:239],v1
v_smfmac_f32_16x16x64_bf16 v[72:75],v[28:31],a[240:247],v1
v_smfmac_f32_16x16x64_bf16 v[76:79],v[28:31],a[248:255],v1
lap2_100915:
s_bitcmp1_b32 s55,0
s_cbranch_scc0 l2s_100969
s_waitcnt vmcnt(8)
v_max3_u32 v124,v16,v17,v18
v_max_u32 v124,v124,v19
v_cmp_eq_u32 vcc,-1,v124
s_cbranch_vccnz l2s_100969
s_bitset0_b32 s55,0
v_smfmac_f32_16x16x64_bf16 v[48:51],v[16:19],a[0:7],v1
v_smfmac_f32_16x16x64_bf16 v[52:55],v[16:19],a[8:15],v1
v_smfmac_f32_16x16x64_bf16 v[56:59],v[16:19],a[16:23],v1
v_smfmac_f32_16x16x64_bf16 v[60:63],v[16:19],a[24:31],v1
v_smfmac_f32_16x16x64_bf16 v[64:67],v[16:19],a[32:39],v1
v_smfmac_f32_16x16x64_bf16 v[68:71],v[16:19],a[40:47],v1
v_smfmac_f32_16x16x64_bf16 v[72:75],v[16:19],a[48:55],v1
v_smfmac_f32_16x16x64_bf16 v[76:79],v[16:19],a[56:63],v1
l2s_100969:
s_bitcmp1_b32 s55,1
s_cbranch_scc0 l2s_100971
s_waitcnt vmcnt(6)
v_max3_u32 v124,v20,v21,v22
v_max_u32 v124,v124,v23
v_cmp_eq_u32 vcc,-1,v124
s_cbranch_vccnz l2s_100971
s_bitset0_b32 s55,1
v_smfmac_f32_16x16x64_bf16 v[48:51],v[20:23],a[64:71],v1
v_smfmac_f32_16x16x64_bf16 v[52:55],v[20:23],a[72:79],v1
v_smfmac_f32_16x16x64_bf16 v[56:59],v[20:23],a[80:87],v1
v_smfmac_f32_16x16x64_bf16 v[60:63],v[20:23],a[88:95],v1
v_smfmac_f32_16x16x64_bf16 v[64:67],v[20:23],a[96:103],v1
v_smfmac_f32_16x16x64_bf16 v[68:71],v[20:23],a[104:111],v1
v_smfmac_f32_16x16x64_bf16 v[72:75],v[20:23],a[112:119],v1
v_smfmac_f32_16x16x64_bf16 v[76:79],v[20:23],a[120:127],v1
l2s_100971:
s_bitcmp1_b32 s55,2
s_cbranch_scc0 l2s_100973
s_waitcnt vmcnt(4)
v_max3_u32 v124,v24,v25,v26
v_max_u32 v124,v124,v27
v_cmp_eq_u32 vcc,-1,v124
s_cbranch_vccnz l2s_100973
s_bitset0_b32 s55,2
v_smfmac_f32_16x16x64_bf16 v[48:51],v[24:27],a[128:135],v1
v_smfmac_f32_16x16x64_bf16 v[52:55],v[24:27],a[136:143],v1
v_smfmac_f32_16x16x64_bf16 v[56:59],v[24:27],a[144:151],v1
v_smfmac_f32_16x16x64_bf16 v[60:63],v[24:27],a[152:159],v1
v_smfmac_f32_16x16x64_bf16 v[64:67],v[24:27],a[160:167],v1
v_smfmac_f32_16x16x64_bf16 v[68:71],v[24:27],a[168:175],v1
v_smfmac_f32_16x16x64_bf16 v[72:75],v[24:27],a[176:183],v1
v_smfmac_f32_16x16x64_bf16 v[76:79],v[24:27],a[184:191],v1
l2s_100973:
s_bitcmp1_b32 s55,3
s_cbranch_scc0 l2s_100975
s_waitcnt vmcnt(1)
v_max3_u32 v124,v28,v29,v30
v_max_u32 v124,v124,v31
v_cmp_eq_u32 vcc,-1,v124
s_cbranch_vccnz l2s_100975
s_bitset0_b32 s55,3
v_smfmac_f32_16x16x64_bf16 v[48:51],v[28:31],a[192:199],v1
v_smfmac_f32_16x16x64_bf16 v[52:55],v[28:31],a[200:207],v1
v_smfmac_f32_16x16x64_bf16 v[56:59],v[28:31],a[208:215],v1
v_smfmac_f32_16x16x64_bf16 v[60:63],v[28:31],a[216:223],v1
v_smfmac_f32_16x16x64_bf16 v[64:67],v[28:31],a[224:231],v1
v_smfmac_f32_16x16x64_bf16 v[68:71],v[28:31],a[232:239],v1
v_smfmac_f32_16x16x64_bf16 v[72:75],v[28:31],a[240:247],v1
v_smfmac_f32_16x16x64_bf16 v[76:79],v[28:31],a[248:255],v1
l2s_100975:
s_cmp_eq_u32 s55,0
s_cbranch_scc0 lfb_100916
Ldone_100917:
s_waitcnt vmcnt(7)
v_max3_u32 v124,v32,v33,v34
v_max_u32 v124,v124,v35
v_cmp_eq_u32 vcc,-1,v124
s_cbranch_vccnz flb_100848
s_branch segb_100832
lfb_100916:
s_bitcmp1_b32 s55,0
s_cbranch_scc0 dsk_100977
buffer_load_dwordx4 v[16:19],v0,s[20:23],s92 offen offset:0 sc1
dsk_100977:
s_bitcmp1_b32 s55,1
s_cbranch_scc0 dsk_100978
buffer_load_dwordx4 v[20:23],v0,s[20:23],s92 offen offset:1024 sc1
dsk_100978:
s_bitcmp1_b32 s55,2
s_cbranch_scc0 dsk_100979
buffer_load_dwordx4 v[24:27],v0,s[20:23],s92 offen offset:2048 sc1
dsk_100979:
s_bitcmp1_b32 s55,3
s_cbranch_scc0 dsk_100980
buffer_load_dwordx4 v[28:31],v0,s[20:23],s92 offen offset:3072 sc1
dsk_100980:
s_bitcmp1_b32 s55,0
s_cbranch_scc0 dsk_100981
s_waitcnt vmcnt(2)
v_max3_u32 v124,v16,v17,v18
v_max_u32 v124,v124,v19
v_cmp_eq_u32 vcc,-1,v124
s_cbranch_vccz dgo_100982
s_nop 15
buffer_load_dwordx4 v[104:107],v0,s[20:23],s92 offen offset:0 sc1
s_nop 15
buffer_load_dwordx4 v[108:111],v0,s[20:23],s92 offen offset:0 sc1
dlp_100983:
s_waitcnt vmcnt(2)
v_max3_u32 v124,v16,v17,v18
v_max_u32 v124,v124,v19
v_cmp_eq_u32 vcc,-1,v124
s_cbranch_vccz dgo_100982
buffer_load_dwordx4 v[16:19],v0,s[20:23],s92 offen offset:0 sc1
s_waitcnt vmcnt(2)
v_max3_u32 v124,v104,v105,v106
v_max_u32 v124,v124,v107
v_cmp_eq_u32 vcc,-1,v124
s_cbranch_vccz dcp_100985
buffer_load_dwordx4 v[104:107],v0,s[20:23],s92 offen offset:0 sc1
s_waitcnt vmcnt(2)
v_max3_u32 v124,v108,v109,v110
v_max_u32 v124,v124,v111
v_cmp_eq_u32 vcc,-1,v124
s_cbranch_vccz dcp_100986
buffer_load_dwordx4 v[108:111],v0,s[20:23],s92 offen offset:0 sc1
s_sub_u32 s90,s90,1
s_cmp_gt_i32 s90,0
s_cbranch_scc1 dlp_100983
s_branch dgo_100982
dcp_100985:
v_mov_b32 v16,v104
v_mov_b32 v17,v105
v_mov_b32 v18,v106
v_mov_b32 v19,v107
s_nop 1
s_branch dgo_100982
dcp_100986:
v_mov_b32 v16,v108
v_mov_b32 v17,v109
v_mov_b32 v18,v110
v_mov_b32 v19,v111
s_nop 1
dgo_100982:
v_smfmac_f32_16x16x64_bf16 v[48:51],v[16:19],a[0:7],v1
v_smfmac_f32_16x16x64_bf16 v[52:55],v[16:19],a[8:15],v1
v_smfmac_f32_16x16x64_bf16 v[56:59],v[16:19],a[16:23],v1
v_smfmac_f32_16x16x64_bf16 v[60:63],v[16:19],a[24:31],v1
v_smfmac_f32_16x16x64_bf16 v[64:67],v[16:19],a[32:39],v1
v_smfmac_f32_16x16x64_bf16 v[68:71],v[16:19],a[40:47],v1
v_smfmac_f32_16x16x64_bf16 v[72:75],v[16:19],a[48:55],v1
v_smfmac_f32_16x16x64_bf16 v[76:79],v[16:19],a[56:63],v1
dsk_100981:
s_bitcmp1_b32 s55,1
s_cbranch_scc0 dsk_100987
s_waitcnt vmcnt(2)
v_max3_u32 v124,v20,v21,v22
v_max_u32 v124,v124,v23
v_cmp_eq_u32 vcc,-1,v124
s_cbranch_vccz dgo_100988
s_nop 15
buffer_load_dwordx4 v[104:107],v0,s[20:23],s92 offen offset:1024 sc1
s_nop 15
buffer_load_dwordx4 v[108:111],v0,s[20:23],s92 offen offset:1024 sc1
dlp_100989:
s_waitcnt vmcnt(2)
v_max3_u32 v124,v20,v21,v22
v_max_u32 v124,v124,v23
v_cmp_eq_u32 vcc,-1,v124
s_cbranch_vccz dgo_100988
buffer_load_dwordx4 v[20:23],v0,s[20:23],s92 offen offset:1024 sc1
s_waitcnt vmcnt(2)
v_max3_u32 v124,v104,v105,v106
v_max_u32 v124,v124,v107
v_cmp_eq_u32 vcc,-1,v124
s_cbranch_vccz dcp_100991
buffer_load_dwordx4 v[104:107],v0,s[20:23],s92 offen offset:1024 sc1
s_waitcnt vmcnt(2)
v_max3_u32 v124,v108,v109,v110
v_max_u32 v124,v124,v111
v_cmp_eq_u32 vcc,-1,v124
s_cbranch_vccz dcp_100992
buffer_load_dwordx4 v[108:111],v0,s[20:23],s92 offen offset:1024 sc1
s_sub_u32 s90,s90,1
s_cmp_gt_i32 s90,0
s_cbranch_scc1 dlp_100989
s_branch dgo_100988
dcp_100991:
v_mov_b32 v20,v104
v_mov_b32 v21,v105
v_mov_b32 v22,v106
v_mov_b32 v23,v107
s_nop 1
s_branch dgo_100988
dcp_100992:
v_mov_b32 v20,v108
v_mov_b32 v21,v109
v_mov_b32 v22,v110
v_mov_b32 v23,v111
s_nop 1
dgo_100988:
v_smfmac_f32_16x16x64_bf16 v[48:51],v[20:23],a[64:71],v1
v_smfmac_f32_16x16x64_bf16 v[52:55],v[20:23],a[72:79],v1
v_smfmac_f32_16x16x64_bf16 v[56:59],v[20:23],a[80:87],v1
v_smfmac_f32_16x16x64_bf16 v[60:63],v[20:23],a[88:95],v1
v_smfmac_f32_16x16x64_bf16 v[64:67],v[20:23],a[96:103],v1
v_smfmac_f32_16x16x64_bf16 v[68:71],v[20:23],a[104:111],v1
v_smfmac_f32_16x16x64_bf16 v[72:75],v[20:23],a[112:119],v1
v_smfmac_f32_16x16x64_bf16 v[76:79],v[20:23],a[120:127],v1
dsk_100987:
s_bitcmp1_b32 s55,2
s_cbranch_scc0 dsk_100993
s_waitcnt vmcnt(2)
v_max3_u32 v124,v24,v25,v26
v_max_u32 v124,v124,v27
v_cmp_eq_u32 vcc,-1,v124
s_cbranch_vccz dgo_100994
s_nop 15
buffer_load_dwordx4 v[104:107],v0,s[20:23],s92 offen offset:2048 sc1
s_nop 15
buffer_load_dwordx4 v[108:111],v0,s[20:23],s92 offen offset:2048 sc1
dlp_100995:
s_waitcnt vmcnt(2)
v_max3_u32 v124,v24,v25,v26
v_max_u32 v124,v124,v27
v_cmp_eq_u32 vcc,-1,v124
s_cbranch_vccz dgo_100994
buffer_load_dwordx4 v[24:27],v0,s[20:23],s92 offen offset:2048 sc1
s_waitcnt vmcnt(2)
v_max3_u32 v124,v104,v105,v106
v_max_u32 v124,v124,v107
v_cmp_eq_u32 vcc,-1,v124
s_cbranch_vccz dcp_100997
buffer_load_dwordx4 v[104:107],v0,s[20:23],s92 offen offset:2048 sc1
s_waitcnt vmcnt(2)
v_max3_u32 v124,v108,v109,v110
v_max_u32 v124,v124,v111
v_cmp_eq_u32 vcc,-1,v124
s_cbranch_vccz dcp_100998
buffer_load_dwordx4 v[108:111],v0,s[20:23],s92 offen offset:2048 sc1
s_sub_u32 s90,s90,1
s_cmp_gt_i32 s90,0
s_cbranch_scc1 dlp_100995
s_branch dgo_100994
dcp_100997:
v_mov_b32 v24,v104
v_mov_b32 v25,v105
v_mov_b32 v26,v106
v_mov_b32 v27,v107
s_nop 1
s_branch dgo_100994
dcp_100998:
v_mov_b32 v24,v108
v_mov_b32 v25,v109
v_mov_b32 v26,v110
v_mov_b32 v27,v111
s_nop 1
dgo_100994:
v_smfmac_f32_16x16x64_bf16 v[48:51],v[24:27],a[128:135],v1
v_smfmac_f32_16x16x64_bf16 v[52:55],v[24:27],a[136:143],v1
v_smfmac_f32_16x16x64_bf16 v[56:59],v[24:27],a[144:151],v1
v_smfmac_f32_16x16x64_bf16 v[60:63],v[24:27],a[152:159],v1
v_smfmac_f32_16x16x64_bf16 v[64:67],v[24:27],a[160:167],v1
v_smfmac_f32_16x16x64_bf16 v[68:71],v[24:27],a[168:175],v1
v_smfmac_f32_16x16x64_bf16 v[72:75],v[24:27],a[176:183],v1
v_smfmac_f32_16x16x64_bf16 v[76:79],v[24:27],a[184:191],v1
dsk_100993:
s_bitcmp1_b32 s55,3
s_cbranch_scc0 dsk_100999
s_waitcnt vmcnt(2)
v_max3_u32 v124,v28,v29,v30
v_max_u32 v124,v124,v31
v_cmp_eq_u32 vcc,-1,v124
s_cbranch_vccz dgo_101000
s_nop 15
buffer_load_dwordx4 v[104:107],v0,s[20:23],s92 offen offset:3072 sc1
s_nop 15
buffer_load_dwordx4 v[108:111],v0,s[20:23],s92 offen offset:3072 sc1
dlp_101001:
s_waitcnt vmcnt(2)
v_max3_u32 v124,v28,v29,v30
v_max_u32 v124,v124,v31
v_cmp_eq_u32 vcc,-1,v124
s_cbranch_vccz dgo_101000
buffer_load_dwordx4 v[28:31],v0,s[20:23],s92 offen offset:3072 sc1
s_waitcnt vmcnt(2)
v_max3_u32 v124,v104,v105,v106
v_max_u32 v124,v124,v107
v_cmp_eq_u32 vcc,-1,v124
s_cbranch_vccz dcp_101003
buffer_load_dwordx4 v[104:107],v0,s[20:23],s92 offen offset:3072 sc1
s_waitcnt vmcnt(2)
v_max3_u32 v124,v108,v109,v110
v_max_u32 v124,v124,v111
v_cmp_eq_u32 vcc,-1,v124
s_cbranch_vccz dcp_101004
buffer_load_dwordx4 v[108:111],v0,s[20:23],s92 offen offset:3072 sc1
s_sub_u32 s90,s90,1
s_cmp_gt_i32 s90,0
s_cbranch_scc1 dlp_101001
s_branch dgo_101000
dcp_101003:
v_mov_b32 v28,v104
v_mov_b32 v29,v105
v_mov_b32 v30,v106
v_mov_b32 v31,v107
s_nop 1
s_branch dgo_101000
dcp_101004:
v_mov_b32 v28,v108
v_mov_b32 v29,v109
v_mov_b32 v30,v110
v_mov_b32 v31,v111
s_nop 1
dgo_101000:
v_smfmac_f32_16x16x64_bf16 v[48:51],v[28:31],a[192:199],v1
v_smfmac_f32_16x16x64_bf16 v[52:55],v[28:31],a[200:207],v1
v_smfmac_f32_16x16x64_bf16 v[56:59],v[28:31],a[208:215],v1
v_smfmac_f32_16x16x64_bf16 v[60:63],v[28:31],a[216:223],v1
v_smfmac_f32_16x16x64_bf16 v[64:67],v[28:31],a[224:231],v1
v_smfmac_f32_16x16x64_bf16 v[68:71],v[28:31],a[232:239],v1
v_smfmac_f32_16x16x64_bf16 v[72:75],v[28:31],a[240:247],v1
v_smfmac_f32_16x16x64_bf16 v[76:79],v[28:31],a[248:255],v1
dsk_100999:
s_mov_b32 s55,0
s_branch Ldone_100917
slowA_100852:
buffer_load_dwordx4 v[44:47],v0,s[20:23],s93 offen offset:3072 sc1
dsk_101005:
s_bitcmp1_b32 s55,7
s_cbranch_scc0 dsk_101006
s_waitcnt vmcnt(2)
v_max3_u32 v124,v44,v45,v46
v_max_u32 v124,v124,v47
v_cmp_eq_u32 vcc,-1,v124
s_cbranch_vccz dgo_101007
s_nop 15
s_nop 3
buffer_load_dwordx4 v[104:107],v0,s[20:23],s93 offen offset:3072 sc1
s_nop 15
s_nop 3
buffer_load_dwordx4 v[108:111],v0,s[20:23],s93 offen offset:3072 sc1
dlp_101008:
s_waitcnt vmcnt(2)
v_max3_u32 v124,v44,v45,v46
v_max_u32 v124,v124,v47
v_cmp_eq_u32 vcc,-1,v124
s_cbranch_vccz dgo_101007
buffer_load_dwordx4 v[44:47],v0,s[20:23],s93 offen offset:3072 sc1
s_waitcnt vmcnt(2)
v_max3_u32 v124,v104,v105,v106
v_max_u32 v124,v124,v107
v_cmp_eq_u32 vcc,-1,v124
s_cbranch_vccz dcp_101010
buffer_load_dwordx4 v[104:107],v0,s[20:23],s93 offen offset:3072 sc1
s_waitcnt vmcnt(2)
v_max3_u32 v124,v108,v109,v110
v_max_u32 v124,v124,v111
v_cmp_eq_u32 vcc,-1,v124
s_cbranch_vccz dcp_101011
buffer_load_dwordx4 v[108:111],v0,s[20:23],s93 offen offset:3072 sc1
s_sub_u32 s90,s90,1
s_cmp_gt_i32 s90,0
s_cbranch_scc1 dlp_101008
s_branch dgo_101007
dcp_101010:
v_mov_b32 v44,v104
v_mov_b32 v45,v105
v_mov_b32 v46,v106
v_mov_b32 v47,v107
s_nop 1
s_branch dgo_101007
dcp_101011:
v_mov_b32 v44,v108
v_mov_b32 v45,v109
v_mov_b32 v46,v110
v_mov_b32 v47,v111
s_nop 1
dgo_101007:
dsk_101006:
s_mov_b32 s55,0
s_branch segb_100834
srt_100860:
s_sub_u32 s90,s90,1
s_cmp_gt_i32 s90,0
s_cbranch_scc0 sok_100859
buffer_load_dwordx4 v[16:19],v2,s[20:23],s94 offen offset:0 sc1
buffer_load_dwordx4 v[32:35],v2,s[20:23],s94 offen offset:1536 sc1
buffer_load_dwordx4 v[20:23],v2,s[20:23],s95 offen offset:0 sc1
buffer_load_dwordx4 v[36:39],v2,s[20:23],s95 offen offset:1536 sc1
buffer_load_dword v120,v3,s[20:23],s94 offen offset:0 sc1
buffer_load_dword v121,v3,s[20:23],s94 offen offset:1536 sc1
buffer_load_dword v122,v3,s[20:23],s95 offen offset:0 sc1
buffer_load_dword v123,v3,s[20:23],s95 offen offset:1536 sc1
s_branch sp_100858
of_100861:
s_mov_b32 s55,3
buffer_load_dwordx4 v[16:19],v0,s[20:23],s96 offen offset:0 sc1
buffer_load_dwordx4 v[20:23],v0,s[20:23],s96 offen offset:1024 sc1
s_waitcnt vmcnt(6)
v_max3_u32 v124,v24,v25,v26
v_max3_u32 v124,v124,v27,v28
v_max3_u32 v124,v124,v29,v30
v_max_u32 v124,v124,v31
v_cmp_eq_u32 vcc,-1,v124
s_cbranch_vccnz ost_101013
v_smfmac_f32_16x16x64_bf16 v[96:99],v[24:27],v[80:87],v1
buffer_load_dword v120,off,s[20:23],s96 sc1
v_smfmac_f32_16x16x64_bf16 v[100:103],v[24:27],v[88:95],v1
buffer_load_dword v120,off,s[20:23],s96 sc1
v_smfmac_f32_16x16x64_bf16 v[96:99],v[28:31],v[128:135],v1
v_smfmac_f32_16x16x64_bf16 v[100:103],v[28:31],v[136:143],v1
ort_101014:
s_waitcnt vmcnt(6)
v_max3_u32 v124,v32,v33,v34
v_max3_u32 v124,v124,v35,v36
v_max3_u32 v124,v124,v37,v38
v_max_u32 v124,v124,v39
v_cmp_eq_u32 vcc,-1,v124
s_cbranch_vccnz ost_101015
v_smfmac_f32_16x16x64_bf16 v[96:99],v[32:35],v[144:151],v1
buffer_load_dword v120,off,s[20:23],s96 sc1
v_smfmac_f32_16x16x64_bf16 v[100:103],v[32:35],v[152:159],v1
buffer_load_dword v120,off,s[20:23],s96 sc1
v_smfmac_f32_16x16x64_bf16 v[96:99],v[36:39],v[160:167],v1
v_smfmac_f32_16x16x64_bf16 v[100:103],v[36:39],v[168:175],v1
ort_101016:
s_waitcnt vmcnt(7)
v_max3_u32 v124,v40,v41,v42
v_max_u32 v124,v124,v43
v_cmp_eq_u32 vcc,-1,v124
s_cbranch_vccnz ost_101017
v_smfmac_f32_16x16x64_bf16 v[96:99],v[40:43],v[176:183],v1
buffer_load_dword v120,off,s[20:23],s96 sc1
v_smfmac_f32_16x16x64_bf16 v[100:103],v[40:43],v[184:191],v1
ort_101018:
s_waitcnt vmcnt(7)
v_max3_u32 v124,v44,v45,v46
v_max_u32 v124,v124,v47
v_cmp_eq_u32 vcc,-1,v124
s_cbranch_vccnz ost_101019
v_smfmac_f32_16x16x64_bf16 v[96:99],v[44:47],v[192:199],v1
buffer_load_dword v120,off,s[20:23],s96 sc1
v_smfmac_f32_16x16x64_bf16 v[100:103],v[44:47],v[200:207],v1
ort_101020:
s_waitcnt vmcnt(6)
v_max3_u32 v124,v16,v17,v18
v_max3_u32 v124,v124,v19,v20
v_max3_u32 v124,v124,v21,v22
v_max_u32 v124,v124,v23
v_cmp_eq_u32 vcc,-1,v124
s_cbranch_vccnz olap2_101012
s_andn2_b32 s55,s55,3
v_smfmac_f32_16x16x64_bf16 v[96:99],v[16:19],v[48:55],v1
v_smfmac_f32_16x16x64_bf16 v[100:103],v[16:19],v[56:63],v1
v_smfmac_f32_16x16x64_bf16 v[96:99],v[20:23],v[64:71],v1
v_smfmac_f32_16x16x64_bf16 v[100:103],v[20:23],v[72:79],v1
s_cbranch_scc0 oback_100872
s_branch olap2_101012
ost_101013:
buffer_load_dwordx4 v[24:27],v0,s[20:23],s96 offen offset:2048 sc1
buffer_load_dwordx4 v[28:31],v0,s[20:23],s96 offen offset:3072 sc1
s_or_b32 s55,s55,12
s_branch ort_101014
ost_101015:
buffer_load_dwordx4 v[32:35],v0,s[20:23],s97 offen offset:0 sc1
buffer_load_dwordx4 v[36:39],v0,s[20:23],s97 offen offset:1024 sc1
s_or_b32 s55,s55,48
s_branch ort_101016
ost_101017:
buffer_load_dwordx4 v[40:43],v0,s[20:23],s97 offen offset:2048 sc1
s_or_b32 s55,s55,64
s_branch ort_101018
ost_101019:
buffer_load_dwordx4 v[44:47],v0,s[20:23],s97 offen offset:3072 sc1
s_or_b32 s55,s55,128
s_branch ort_101020
of_100862:
s_mov_b32 s55,12
buffer_load_dwordx4 v[24:27],v0,s[20:23],s96 offen offset:2048 sc1
buffer_load_dwordx4 v[28:31],v0,s[20:23],s96 offen offset:3072 sc1
s_waitcnt vmcnt(4)
v_max3_u32 v124,v32,v33,v34
v_max3_u32 v124,v124,v35,v36
v_max3_u32 v124,v124,v37,v38
v_max_u32 v124,v124,v39
v_cmp_eq_u32 vcc,-1,v124
s_cbranch_vccnz ost_101022
v_smfmac_f32_16x16x64_bf16 v[96:99],v[32:35],v[144:151],v1
buffer_load_dword v120,off,s[20:23],s96 sc1
v_smfmac_f32_16x16x64_bf16 v[100:103],v[32:35],v[152:159],v1
buffer_load_dword v120,off,s[20:23],s96 sc1
v_smfmac_f32_16x16x64_bf16 v[96:99],v[36:39],v[160:167],v1
v_smfmac_f32_16x16x64_bf16 v[100:103],v[36:39],v[168:175],v1
ort_101023:
s_waitcnt vmcnt(5)
v_max3_u32 v124,v40,v41,v42
v_max_u32 v124,v124,v43
v_cmp_eq_u32 vcc,-1,v124
s_cbranch_vccnz ost_101024
v_smfmac_f32_16x16x64_bf16 v[96:99],v[40:43],v[176:183],v1
buffer_load_dword v120,off,s[20:23],s96 sc1
v_smfmac_f32_16x16x64_bf16 v[100:103],v[40:43],v[184:191],v1
ort_101025:
s_waitcnt vmcnt(5)
v_max3_u32 v124,v44,v45,v46
v_max_u32 v124,v124,v47
v_cmp_eq_u32 vcc,-1,v124
s_cbranch_vccnz ost_101026
v_smfmac_f32_16x16x64_bf16 v[96:99],v[44:47],v[192:199],v1
buffer_load_dword v120,off,s[20:23],s96 sc1
v_smfmac_f32_16x16x64_bf16 v[100:103],v[44:47],v[200:207],v1
ort_101027:
s_waitcnt vmcnt(4)
v_max3_u32 v124,v24,v25,v26
v_max3_u32 v124,v124,v27,v28
v_max3_u32 v124,v124,v29,v30
v_max_u32 v124,v124,v31
v_cmp_eq_u32 vcc,-1,v124
s_cbranch_vccnz olap2_101012
s_andn2_b32 s55,s55,12
v_smfmac_f32_16x16x64_bf16 v[96:99],v[24:27],v[80:87],v1
v_smfmac_f32_16x16x64_bf16 v[100:103],v[24:27],v[88:95],v1
v_smfmac_f32_16x16x64_bf16 v[96:99],v[28:31],v[128:135],v1
v_smfmac_f32_16x16x64_bf16 v[100:103],v[28:31],v[136:143],v1
s_cbranch_scc0 oback_100872
s_branch olap2_101012
ost_101022:
buffer_load_dwordx4 v[32:35],v0,s[20:23],s97 offen offset:0 sc1
buffer_load_dwordx4 v[36:39],v0,s[20:23],s97 offen offset:1024 sc1
s_or_b32 s55,s55,48
s_branch ort_101023
ost_101024:
buffer_load_dwordx4 v[40:43],v0,s[20:23],s97 offen offset:2048 sc1
s_or_b32 s55,s55,64
s_branch ort_101025
ost_101026:
buffer_load_dwordx4 v[44:47],v0,s[20:23],s97 offen offset:3072 sc1
s_or_b32 s55,s55,128
s_branch ort_101027
of_100863:
s_mov_b32 s55,48
buffer_load_dwordx4 v[32:35],v0,s[20:23],s97 offen offset:0 sc1
buffer_load_dwordx4 v[36:39],v0,s[20:23],s97 offen offset:1024 sc1
s_waitcnt vmcnt(3)
v_max3_u32 v124,v40,v41,v42
v_max_u32 v124,v124,v43
v_cmp_eq_u32 vcc,-1,v124
s_cbranch_vccnz ost_101029
v_smfmac_f32_16x16x64_bf16 v[96:99],v[40:43],v[176:183],v1
buffer_load_dword v120,off,s[20:23],s96 sc1
v_smfmac_f32_16x16x64_bf16 v[100:103],v[40:43],v[184:191],v1
ort_101030:
s_waitcnt vmcnt(3)
v_max3_u32 v124,v44,v45,v46
v_max_u32 v124,v124,v47
v_cmp_eq_u32 vcc,-1,v124
s_cbranch_vccnz ost_101031
v_smfmac_f32_16x16x64_bf16 v[96:99],v[44:47],v[192:199],v1
buffer_load_dword v120,off,s[20:23],s96 sc1
v_smfmac_f32_16x16x64_bf16 v[100:103],v[44:47],v[200:207],v1
ort_101032:
s_waitcnt vmcnt(2)
v_max3_u32 v124,v32,v33,v34
v_max3_u32 v124,v124,v35,v36
v_max3_u32 v124,v124,v37,v38
v_max_u32 v124,v124,v39
v_cmp_eq_u32 vcc,-1,v124
s_cbranch_vccnz olap2_101012
s_andn2_b32 s55,s55,48
v_smfmac_f32_16x16x64_bf16 v[96:99],v[32:35],v[144:151],v1
v_smfmac_f32_16x16x64_bf16 v[100:103],v[32:35],v[152:159],v1
v_smfmac_f32_16x16x64_bf16 v[96:99],v[36:39],v[160:167],v1
v_smfmac_f32_16x16x64_bf16 v[100:103],v[36:39],v[168:175],v1
s_cbranch_scc0 oback_100872
s_branch olap2_101012
ost_101029:
buffer_load_dwordx4 v[40:43],v0,s[20:23],s97 offen offset:2048 sc1
s_or_b32 s55,s55,64
s_branch ort_101030
ost_101031:
buffer_load_dwordx4 v[44:47],v0,s[20:23],s97 offen offset:3072 sc1
s_or_b32 s55,s55,128
s_branch ort_101032
of_100864:
s_mov_b32 s55,64
buffer_load_dwordx4 v[40:43],v0,s[20:23],s97 offen offset:2048 sc1
s_waitcnt vmcnt(1)
v_max3_u32 v124,v44,v45,v46
v_max_u32 v124,v124,v47
v_cmp_eq_u32 vcc,-1,v124
s_cbranch_vccnz ost_101034
v_smfmac_f32_16x16x64_bf16 v[96:99],v[44:47],v[192:199],v1
buffer_load_dword v120,off,s[20:23],s96 sc1
v_smfmac_f32_16x16x64_bf16 v[100:103],v[44:47],v[200:207],v1
ort_101035:
s_waitcnt vmcnt(1)
v_max3_u32 v124,v40,v41,v42
v_max_u32 v124,v124,v43
v_cmp_eq_u32 vcc,-1,v124
s_cbranch_vccnz olap2_101012
s_andn2_b32 s55,s55,64
v_smfmac_f32_16x16x64_bf16 v[96:99],v[40:43],v[176:183],v1
v_smfmac_f32_16x16x64_bf16 v[100:103],v[40:43],v[184:191],v1
s_cbranch_scc0 oback_100872
s_branch olap2_101012
ost_101034:
buffer_load_dwordx4 v[44:47],v0,s[20:23],s97 offen offset:3072 sc1
s_or_b32 s55,s55,128
s_branch ort_101035
of_100865:
s_mov_b32 s55,128
s_branch oslow_100871
olap2_101012:
s_bitcmp1_b32 s55,0
s_cbranch_scc0 l2s_101037
s_waitcnt vmcnt(6)
v_max3_u32 v124,v16,v17,v18
v_max3_u32 v124,v124,v19,v20
v_max3_u32 v124,v124,v21,v22
v_max_u32 v124,v124,v23
v_cmp_eq_u32 vcc,-1,v124
s_cbranch_vccnz l2s_101037
s_andn2_b32 s55,s55,3
v_smfmac_f32_16x16x64_bf16 v[96:99],v[16:19],v[48:55],v1
v_smfmac_f32_16x16x64_bf16 v[100:103],v[16:19],v[56:63],v1
v_smfmac_f32_16x16x64_bf16 v[96:99],v[20:23],v[64:71],v1
v_smfmac_f32_16x16x64_bf16 v[100:103],v[20:23],v[72:79],v1
l2s_101037:
s_bitcmp1_b32 s55,2
s_cbranch_scc0 l2s_101038
s_waitcnt vmcnt(4)
v_max3_u32 v124,v24,v25,v26
v_max3_u32 v124,v124,v27,v28
v_max3_u32 v124,v124,v29,v30
v_max_u32 v124,v124,v31
v_cmp_eq_u32 vcc,-1,v124
s_cbranch_vccnz l2s_101038
s_andn2_b32 s55,s55,12
v_smfmac_f32_16x16x64_bf16 v[96:99],v[24:27],v[80:87],v1
v_smfmac_f32_16x16x64_bf16 v[100:103],v[24:27],v[88:95],v1
v_smfmac_f32_16x16x64_bf16 v[96:99],v[28:31],v[128:135],v1
v_smfmac_f32_16x16x64_bf16 v[100:103],v[28:31],v[136:143],v1
l2s_101038:
s_bitcmp1_b32 s55,4
s_cbranch_scc0 l2s_101039
s_waitcnt vmcnt(2)
v_max3_u32 v124,v32,v33,v34
v_max3_u32 v124,v124,v35,v36
v_max3_u32 v124,v124,v37,v38
v_max_u32 v124,v124,v39
v_cmp_eq_u32 vcc,-1,v124
s_cbranch_vccnz l2s_101039
s_andn2_b32 s55,s55,48
v_smfmac_f32_16x16x64_bf16 v[96:99],v[32:35],v[144:151],v1
v_smfmac_f32_16x16x64_bf16 v[100:103],v[32:35],v[152:159],v1
v_smfmac_f32_16x16x64_bf16 v[96:99],v[36:39],v[160:167],v1
v_smfmac_f32_16x16x64_bf16 v[100:103],v[36:39],v[168:175],v1
l2s_101039:
s_bitcmp1_b32 s55,6
s_cbranch_scc0 l2s_101040
s_waitcnt vmcnt(1)
v_max3_u32 v124,v40,v41,v42
v_max_u32 v124,v124,v43
v_cmp_eq_u32 vcc,-1,v124
s_cbranch_vccnz l2s_101040
s_andn2_b32 s55,s55,64
v_smfmac_f32_16x16x64_bf16 v[96:99],v[40:43],v[176:183],v1
v_smfmac_f32_16x16x64_bf16 v[100:103],v[40:43],v[184:191],v1
l2s_101040:
s_bitcmp1_b32 s55,7
s_cbranch_scc0 l2s_101041
s_waitcnt vmcnt(0)
v_max3_u32 v124,v44,v45,v46
v_max_u32 v124,v124,v47
v_cmp_eq_u32 vcc,-1,v124
s_cbranch_vccnz l2s_101041
s_andn2_b32 s55,s55,128
v_smfmac_f32_16x16x64_bf16 v[96:99],v[44:47],v[192:199],v1
v_smfmac_f32_16x16x64_bf16 v[100:103],v[44:47],v[200:207],v1
l2s_101041:
s_cmp_eq_u32 s55,0
s_cbranch_scc1 oback_100872
oslow_100871:
s_bitcmp1_b32 s55,0
s_cbranch_scc0 dsk_101042
buffer_load_dwordx4 v[16:19],v0,s[20:23],s96 offen offset:0 sc1
dsk_101042:
s_bitcmp1_b32 s55,1
s_cbranch_scc0 dsk_101043
buffer_load_dwordx4 v[20:23],v0,s[20:23],s96 offen offset:1024 sc1
dsk_101043:
s_bitcmp1_b32 s55,2
s_cbranch_scc0 dsk_101044
buffer_load_dwordx4 v[24:27],v0,s[20:23],s96 offen offset:2048 sc1
dsk_101044:
s_bitcmp1_b32 s55,3
s_cbranch_scc0 dsk_101045
buffer_load_dwordx4 v[28:31],v0,s[20:23],s96 offen offset:3072 sc1
dsk_101045:
s_bitcmp1_b32 s55,4
s_cbranch_scc0 dsk_101046
buffer_load_dwordx4 v[32:35],v0,s[20:23],s97 offen offset:0 sc1
dsk_101046:
s_bitcmp1_b32 s55,5
s_cbranch_scc0 dsk_101047
buffer_load_dwordx4 v[36:39],v0,s[20:23],s97 offen offset:1024 sc1
dsk_101047:
s_bitcmp1_b32 s55,6
s_cbranch_scc0 dsk_101048
buffer_load_dwordx4 v[40:43],v0,s[20:23],s97 offen offset:2048 sc1
dsk_101048:
s_bitcmp1_b32 s55,7
s_cbranch_scc0 dsk_101049
buffer_load_dwordx4 v[44:47],v0,s[20:23],s97 offen offset:3072 sc1
dsk_101049:
s_bitcmp1_b32 s55,0
s_cbranch_scc0 dsk_101050
s_waitcnt vmcnt(2)
v_max3_u32 v124,v16,v17,v18
v_max_u32 v124,v124,v19
v_cmp_eq_u32 vcc,-1,v124
s_cbranch_vccz dgo_101051
s_nop 15
buffer_load_dwordx4 v[116:119],v0,s[20:23],s96 offen offset:0 sc1
s_nop 15
buffer_load_dwordx4 v[120:123],v0,s[20:23],s96 offen offset:0 sc1
dlp_101052:
s_waitcnt vmcnt(2)
v_max3_u32 v124,v16,v17,v18
v_max_u32 v124,v124,v19
v_cmp_eq_u32 vcc,-1,v124
s_cbranch_vccz dgo_101051
buffer_load_dwordx4 v[16:19],v0,s[20:23],s96 offen offset:0 sc1
s_waitcnt vmcnt(2)
v_max3_u32 v124,v116,v117,v118
v_max_u32 v124,v124,v119
v_cmp_eq_u32 vcc,-1,v124
s_cbranch_vccz dcp_101054
buffer_load_dwordx4 v[116:119],v0,s[20:23],s96 offen offset:0 sc1
s_waitcnt vmcnt(2)
v_max3_u32 v124,v120,v121,v122
v_max_u32 v124,v124,v123
v_cmp_eq_u32 vcc,-1,v124
s_cbranch_vccz dcp_101055
buffer_load_dwordx4 v[120:123],v0,s[20:23],s96 offen offset:0 sc1
s_sub_u32 s90,s90,1
s_cmp_gt_i32 s90,0
s_cbranch_scc1 dlp_101052
s_branch dgo_101051
dcp_101054:
v_mov_b32 v16,v116
v_mov_b32 v17,v117
v_mov_b32 v18,v118
v_mov_b32 v19,v119
s_nop 1
s_branch dgo_101051
dcp_101055:
v_mov_b32 v16,v120
v_mov_b32 v17,v121
v_mov_b32 v18,v122
v_mov_b32 v19,v123
s_nop 1
dgo_101051:
v_smfmac_f32_16x16x64_bf16 v[96:99],v[16:19],v[48:55],v1
v_smfmac_f32_16x16x64_bf16 v[100:103],v[16:19],v[56:63],v1
dsk_101050:
s_bitcmp1_b32 s55,1
s_cbranch_scc0 dsk_101056
s_waitcnt vmcnt(2)
v_max3_u32 v124,v20,v21,v22
v_max_u32 v124,v124,v23
v_cmp_eq_u32 vcc,-1,v124
s_cbranch_vccz dgo_101057
s_nop 15
buffer_load_dwordx4 v[116:119],v0,s[20:23],s96 offen offset:1024 sc1
s_nop 15
buffer_load_dwordx4 v[120:123],v0,s[20:23],s96 offen offset:1024 sc1
dlp_101058:
s_waitcnt vmcnt(2)
v_max3_u32 v124,v20,v21,v22
v_max_u32 v124,v124,v23
v_cmp_eq_u32 vcc,-1,v124
s_cbranch_vccz dgo_101057
buffer_load_dwordx4 v[20:23],v0,s[20:23],s96 offen offset:1024 sc1
s_waitcnt vmcnt(2)
v_max3_u32 v124,v116,v117,v118
v_max_u32 v124,v124,v119
v_cmp_eq_u32 vcc,-1,v124
s_cbranch_vccz dcp_101060
buffer_load_dwordx4 v[116:119],v0,s[20:23],s96 offen offset:1024 sc1
s_waitcnt vmcnt(2)
v_max3_u32 v124,v120,v121,v122
v_max_u32 v124,v124,v123
v_cmp_eq_u32 vcc,-1,v124
s_cbranch_vccz dcp_101061
buffer_load_dwordx4 v[120:123],v0,s[20:23],s96 offen offset:1024 sc1
s_sub_u32 s90,s90,1
s_cmp_gt_i32 s90,0
s_cbranch_scc1 dlp_101058
s_branch dgo_101057
dcp_101060:
v_mov_b32 v20,v116
v_mov_b32 v21,v117
v_mov_b32 v22,v118
v_mov_b32 v23,v119
s_nop 1
s_branch dgo_101057
dcp_101061:
v_mov_b32 v20,v120
v_mov_b32 v21,v121
v_mov_b32 v22,v122
v_mov_b32 v23,v123
s_nop 1
dgo_101057:
v_smfmac_f32_16x16x64_bf16 v[96:99],v[20:23],v[64:71],v1
v_smfmac_f32_16x16x64_bf16 v[100:103],v[20:23],v[72:79],v1
dsk_101056:
s_bitcmp1_b32 s55,2
s_cbranch_scc0 dsk_101062
s_waitcnt vmcnt(2)
v_max3_u32 v124,v24,v25,v26
v_max_u32 v124,v124,v27
v_cmp_eq_u32 vcc,-1,v124
s_cbranch_vccz dgo_101063
s_nop 15
buffer_load_dwordx4 v[116:119],v0,s[20:23],s96 offen offset:2048 sc1
s_nop 15
buffer_load_dwordx4 v[120:123],v0,s[20:23],s96 offen offset:2048 sc1
dlp_101064:
s_waitcnt vmcnt(2)
v_max3_u32 v124,v24,v25,v26
v_max_u32 v124,v124,v27
v_cmp_eq_u32 vcc,-1,v124
s_cbranch_vccz dgo_101063
buffer_load_dwordx4 v[24:27],v0,s[20:23],s96 offen offset:2048 sc1
s_waitcnt vmcnt(2)
v_max3_u32 v124,v116,v117,v118
v_max_u32 v124,v124,v119
v_cmp_eq_u32 vcc,-1,v124
s_cbranch_vccz dcp_101066
buffer_load_dwordx4 v[116:119],v0,s[20:23],s96 offen offset:2048 sc1
s_waitcnt vmcnt(2)
v_max3_u32 v124,v120,v121,v122
v_max_u32 v124,v124,v123
v_cmp_eq_u32 vcc,-1,v124
s_cbranch_vccz dcp_101067
buffer_load_dwordx4 v[120:123],v0,s[20:23],s96 offen offset:2048 sc1
s_sub_u32 s90,s90,1
s_cmp_gt_i32 s90,0
s_cbranch_scc1 dlp_101064
s_branch dgo_101063
dcp_101066:
v_mov_b32 v24,v116
v_mov_b32 v25,v117
v_mov_b32 v26,v118
v_mov_b32 v27,v119
s_nop 1
s_branch dgo_101063
dcp_101067:
v_mov_b32 v24,v120
v_mov_b32 v25,v121
v_mov_b32 v26,v122
v_mov_b32 v27,v123
s_nop 1
dgo_101063:
v_smfmac_f32_16x16x64_bf16 v[96:99],v[24:27],v[80:87],v1
v_smfmac_f32_16x16x64_bf16 v[100:103],v[24:27],v[88:95],v1
dsk_101062:
s_bitcmp1_b32 s55,3
s_cbranch_scc0 dsk_101068
s_waitcnt vmcnt(2)
v_max3_u32 v124,v28,v29,v30
v_max_u32 v124,v124,v31
v_cmp_eq_u32 vcc,-1,v124
s_cbranch_vccz dgo_101069
s_nop 15
buffer_load_dwordx4 v[116:119],v0,s[20:23],s96 offen offset:3072 sc1
s_nop 15
buffer_load_dwordx4 v[120:123],v0,s[20:23],s96 offen offset:3072 sc1
dlp_101070:
s_waitcnt vmcnt(2)
v_max3_u32 v124,v28,v29,v30
v_max_u32 v124,v124,v31
v_cmp_eq_u32 vcc,-1,v124
s_cbranch_vccz dgo_101069
buffer_load_dwordx4 v[28:31],v0,s[20:23],s96 offen offset:3072 sc1
s_waitcnt vmcnt(2)
v_max3_u32 v124,v116,v117,v118
v_max_u32 v124,v124,v119
v_cmp_eq_u32 vcc,-1,v124
s_cbranch_vccz dcp_101072
buffer_load_dwordx4 v[116:119],v0,s[20:23],s96 offen offset:3072 sc1
s_waitcnt vmcnt(2)
v_max3_u32 v124,v120,v121,v122
v_max_u32 v124,v124,v123
v_cmp_eq_u32 vcc,-1,v124
s_cbranch_vccz dcp_101073
buffer_load_dwordx4 v[120:123],v0,s[20:23],s96 offen offset:3072 sc1
s_sub_u32 s90,s90,1
s_cmp_gt_i32 s90,0
s_cbranch_scc1 dlp_101070
s_branch dgo_101069
dcp_101072:
v_mov_b32 v28,v116
v_mov_b32 v29,v117
v_mov_b32 v30,v118
v_mov_b32 v31,v119
s_nop 1
s_branch dgo_101069
dcp_101073:
v_mov_b32 v28,v120
v_mov_b32 v29,v121
v_mov_b32 v30,v122
v_mov_b32 v31,v123
s_nop 1
dgo_101069:
v_smfmac_f32_16x16x64_bf16 v[96:99],v[28:31],v[128:135],v1
v_smfmac_f32_16x16x64_bf16 v[100:103],v[28:31],v[136:143],v1
dsk_101068:
s_bitcmp1_b32 s55,4
s_cbranch_scc0 dsk_101074
s_waitcnt vmcnt(2)
v_max3_u32 v124,v32,v33,v34
v_max_u32 v124,v124,v35
v_cmp_eq_u32 vcc,-1,v124
s_cbranch_vccz dgo_101075
s_nop 15
buffer_load_dwordx4 v[116:119],v0,s[20:23],s97 offen offset:0 sc1
s_nop 15
buffer_load_dwordx4 v[120:123],v0,s[20:23],s97 offen offset:0 sc1
dlp_101076:
s_waitcnt vmcnt(2)
v_max3_u32 v124,v32,v33,v34
v_max_u32 v124,v124,v35
v_cmp_eq_u32 vcc,-1,v124
s_cbranch_vccz dgo_101075
buffer_load_dwordx4 v[32:35],v0,s[20:23],s97 offen offset:0 sc1
s_waitcnt vmcnt(2)
v_max3_u32 v124,v116,v117,v118
v_max_u32 v124,v124,v119
v_cmp_eq_u32 vcc,-1,v124
s_cbranch_vccz dcp_101078
buffer_load_dwordx4 v[116:119],v0,s[20:23],s97 offen offset:0 sc1
s_waitcnt vmcnt(2)
v_max3_u32 v124,v120,v121,v122
v_max_u32 v124,v124,v123
v_cmp_eq_u32 vcc,-1,v124
s_cbranch_vccz dcp_101079
buffer_load_dwordx4 v[120:123],v0,s[20:23],s97 offen offset:0 sc1
s_sub_u32 s90,s90,1
s_cmp_gt_i32 s90,0
s_cbranch_scc1 dlp_101076
s_branch dgo_101075
dcp_101078:
v_mov_b32 v32,v116
v_mov_b32 v33,v117
v_mov_b32 v34,v118
v_mov_b32 v35,v119
s_nop 1
s_branch dgo_101075
dcp_101079:
v_mov_b32 v32,v120
v_mov_b32 v33,v121
v_mov_b32 v34,v122
v_mov_b32 v35,v123
s_nop 1
dgo_101075:
v_smfmac_f32_16x16x64_bf16 v[96:99],v[32:35],v[144:151],v1
v_smfmac_f32_16x16x64_bf16 v[100:103],v[32:35],v[152:159],v1
dsk_101074:
s_bitcmp1_b32 s55,5
s_cbranch_scc0 dsk_101080
s_waitcnt vmcnt(2)
v_max3_u32 v124,v36,v37,v38
v_max_u32 v124,v124,v39
v_cmp_eq_u32 vcc,-1,v124
s_cbranch_vccz dgo_101081
s_nop 15
buffer_load_dwordx4 v[116:119],v0,s[20:23],s97 offen offset:1024 sc1
s_nop 15
buffer_load_dwordx4 v[120:123],v0,s[20:23],s97 offen offset:1024 sc1
dlp_101082:
s_waitcnt vmcnt(2)
v_max3_u32 v124,v36,v37,v38
v_max_u32 v124,v124,v39
v_cmp_eq_u32 vcc,-1,v124
s_cbranch_vccz dgo_101081
buffer_load_dwordx4 v[36:39],v0,s[20:23],s97 offen offset:1024 sc1
s_waitcnt vmcnt(2)
v_max3_u32 v124,v116,v117,v118
v_max_u32 v124,v124,v119
v_cmp_eq_u32 vcc,-1,v124
s_cbranch_vccz dcp_101084
buffer_load_dwordx4 v[116:119],v0,s[20:23],s97 offen offset:1024 sc1
s_waitcnt vmcnt(2)
v_max3_u32 v124,v120,v121,v122
v_max_u32 v124,v124,v123
v_cmp_eq_u32 vcc,-1,v124
s_cbranch_vccz dcp_101085
buffer_load_dwordx4 v[120:123],v0,s[20:23],s97 offen offset:1024 sc1
s_sub_u32 s90,s90,1
s_cmp_gt_i32 s90,0
s_cbranch_scc1 dlp_101082
s_branch dgo_101081
dcp_101084:
v_mov_b32 v36,v116
v_mov_b32 v37,v117
v_mov_b32 v38,v118
v_mov_b32 v39,v119
s_nop 1
s_branch dgo_101081
dcp_101085:
v_mov_b32 v36,v120
v_mov_b32 v37,v121
v_mov_b32 v38,v122
v_mov_b32 v39,v123
s_nop 1
dgo_101081:
v_smfmac_f32_16x16x64_bf16 v[96:99],v[36:39],v[160:167],v1
v_smfmac_f32_16x16x64_bf16 v[100:103],v[36:39],v[168:175],v1
dsk_101080:
s_bitcmp1_b32 s55,6
s_cbranch_scc0 dsk_101086
s_waitcnt vmcnt(2)
v_max3_u32 v124,v40,v41,v42
v_max_u32 v124,v124,v43
v_cmp_eq_u32 vcc,-1,v124
s_cbranch_vccz dgo_101087
s_nop 15
buffer_load_dwordx4 v[116:119],v0,s[20:23],s97 offen offset:2048 sc1
s_nop 15
buffer_load_dwordx4 v[120:123],v0,s[20:23],s97 offen offset:2048 sc1
dlp_101088:
s_waitcnt vmcnt(2)
v_max3_u32 v124,v40,v41,v42
v_max_u32 v124,v124,v43
v_cmp_eq_u32 vcc,-1,v124
s_cbranch_vccz dgo_101087
buffer_load_dwordx4 v[40:43],v0,s[20:23],s97 offen offset:2048 sc1
s_waitcnt vmcnt(2)
v_max3_u32 v124,v116,v117,v118
v_max_u32 v124,v124,v119
v_cmp_eq_u32 vcc,-1,v124
s_cbranch_vccz dcp_101090
buffer_load_dwordx4 v[116:119],v0,s[20:23],s97 offen offset:2048 sc1
s_waitcnt vmcnt(2)
v_max3_u32 v124,v120,v121,v122
v_max_u32 v124,v124,v123
v_cmp_eq_u32 vcc,-1,v124
s_cbranch_vccz dcp_101091
buffer_load_dwordx4 v[120:123],v0,s[20:23],s97 offen offset:2048 sc1
s_sub_u32 s90,s90,1
s_cmp_gt_i32 s90,0
s_cbranch_scc1 dlp_101088
s_branch dgo_101087
dcp_101090:
v_mov_b32 v40,v116
v_mov_b32 v41,v117
v_mov_b32 v42,v118
v_mov_b32 v43,v119
s_nop 1
s_branch dgo_101087
dcp_101091:
v_mov_b32 v40,v120
v_mov_b32 v41,v121
v_mov_b32 v42,v122
v_mov_b32 v43,v123
s_nop 1
dgo_101087:
v_smfmac_f32_16x16x64_bf16 v[96:99],v[40:43],v[176:183],v1
v_smfmac_f32_16x16x64_bf16 v[100:103],v[40:43],v[184:191],v1
dsk_101086:
s_bitcmp1_b32 s55,7
s_cbranch_scc0 dsk_101092
s_waitcnt vmcnt(2)
v_max3_u32 v124,v44,v45,v46
v_max_u32 v124,v124,v47
v_cmp_eq_u32 vcc,-1,v124
s_cbranch_vccz dgo_101093
s_nop 15
buffer_load_dwordx4 v[116:119],v0,s[20:23],s97 offen offset:3072 sc1
s_nop 15
buffer_load_dwordx4 v[120:123],v0,s[20:23],s97 offen offset:3072 sc1
dlp_101094:
s_waitcnt vmcnt(2)
v_max3_u32 v124,v44,v45,v46
v_max_u32 v124,v124,v47
v_cmp_eq_u32 vcc,-1,v124
s_cbranch_vccz dgo_101093
buffer_load_dwordx4 v[44:47],v0,s[20:23],s97 offen offset:3072 sc1
s_waitcnt vmcnt(2)
v_max3_u32 v124,v116,v117,v118
v_max_u32 v124,v124,v119
v_cmp_eq_u32 vcc,-1,v124
s_cbranch_vccz dcp_101096
buffer_load_dwordx4 v[116:119],v0,s[20:23],s97 offen offset:3072 sc1
s_waitcnt vmcnt(2)
v_max3_u32 v124,v120,v121,v122
v_max_u32 v124,v124,v123
v_cmp_eq_u32 vcc,-1,v124
s_cbranch_vccz dcp_101097
buffer_load_dwordx4 v[120:123],v0,s[20:23],s97 offen offset:3072 sc1
s_sub_u32 s90,s90,1
s_cmp_gt_i32 s90,0
s_cbranch_scc1 dlp_101094
s_branch dgo_101093
dcp_101096:
v_mov_b32 v44,v116
v_mov_b32 v45,v117
v_mov_b32 v46,v118
v_mov_b32 v47,v119
s_nop 1
s_branch dgo_101093
dcp_101097:
v_mov_b32 v44,v120
v_mov_b32 v45,v121
v_mov_b32 v46,v122
v_mov_b32 v47,v123
s_nop 1
dgo_101093:
v_smfmac_f32_16x16x64_bf16 v[96:99],v[44:47],v[192:199],v1
v_smfmac_f32_16x16x64_bf16 v[100:103],v[44:47],v[200:207],v1
dsk_101092:
s_mov_b32 s55,0
s_branch oback_100872
fl_100889:
flb_100897:
buffer_load_dwordx4 v[16:19],v0,s[20:23],s92 offen offset:0 sc1
s_mov_b32 s55,1
buffer_load_dwordx4 v[32:35],v0,s[20:23],s93 offen offset:0 sc1
s_waitcnt vmcnt(4)
v_max3_u32 v124,v20,v21,v22
v_max_u32 v124,v124,v23
v_cmp_eq_u32 vcc,-1,v124
s_cbranch_vccnz dfl_101098
v_smfmac_f32_16x16x64_bf16 v[64:67],v[20:23],a[96:103],v1
buffer_load_dword v125,off,s[20:23],s92 sc1
buffer_load_dwordx4 v[36:39],v0,s[20:23],s93 offen offset:1024 sc1
s_waitcnt vmcnt(5)
v_max3_u32 v124,v24,v25,v26
v_smfmac_f32_16x16x64_bf16 v[68:71],v[20:23],a[104:111],v1
v_max_u32 v124,v124,v27
v_cmp_eq_u32 vcc,-1,v124
v_smfmac_f32_16x16x64_bf16 v[72:75],v[20:23],a[112:119],v1
v_smfmac_f32_16x16x64_bf16 v[76:79],v[20:23],a[120:127],v1
s_cbranch_vccnz dfl_101099
v_smfmac_f32_16x16x64_bf16 v[64:67],v[24:27],a[160:167],v1
buffer_load_dword v125,off,s[20:23],s92 sc1
buffer_load_dwordx4 v[40:43],v0,s[20:23],s93 offen offset:2048 sc1
buffer_load_dwordx4 v[44:47],v0,s[20:23],s93 offen offset:3072 sc1
s_waitcnt vmcnt(7)
v_max3_u32 v124,v28,v29,v30
v_smfmac_f32_16x16x64_bf16 v[68:71],v[24:27],a[168:175],v1
v_max_u32 v124,v124,v31
v_cmp_eq_u32 vcc,-1,v124
v_smfmac_f32_16x16x64_bf16 v[72:75],v[24:27],a[176:183],v1
v_smfmac_f32_16x16x64_bf16 v[76:79],v[24:27],a[184:191],v1
s_cbranch_vccnz dfl_101100
v_smfmac_f32_16x16x64_bf16 v[64:67],v[28:31],a[224:231],v1
buffer_load_dword v125,off,s[20:23],s92 sc1
buffer_store_dword v126,v121,s[20:23],s69 offen sc1
s_waitcnt vmcnt(8)
v_max3_u32 v124,v16,v17,v18
v_smfmac_f32_16x16x64_bf16 v[68:71],v[28:31],a[232:239],v1
v_max_u32 v124,v124,v19
v_cmp_eq_u32 vcc,-1,v124
v_smfmac_f32_16x16x64_bf16 v[72:75],v[28:31],a[240:247],v1
v_smfmac_f32_16x16x64_bf16 v[76:79],v[28:31],a[248:255],v1
s_cbranch_vccnz lfb_101105
s_mov_b32 s55,0
v_smfmac_f32_16x16x64_bf16 v[64:67],v[16:19],a[32:39],v1
s_waitcnt vmcnt(7)
v_max3_u32 v124,v32,v33,v34
v_max_u32 v124,v124,v35
v_cmp_eq_u32 vcc,-1,v124
v_smfmac_f32_16x16x64_bf16 v[68:71],v[16:19],a[40:47],v1
v_smfmac_f32_16x16x64_bf16 v[72:75],v[16:19],a[48:55],v1
v_smfmac_f32_16x16x64_bf16 v[76:79],v[16:19],a[56:63],v1
s_cbranch_vccnz flb_100901
s_branch segb_100885
fl_100890:
flb_100898:
buffer_load_dwordx4 v[20:23],v0,s[20:23],s92 offen offset:1024 sc1
s_mov_b32 s55,2
buffer_load_dwordx4 v[36:39],v0,s[20:23],s93 offen offset:1024 sc1
s_waitcnt vmcnt(5)
v_max3_u32 v124,v24,v25,v26
v_max_u32 v124,v124,v27
v_cmp_eq_u32 vcc,-1,v124
s_cbranch_vccnz dfl_101099
v_smfmac_f32_16x16x64_bf16 v[64:67],v[24:27],a[160:167],v1
buffer_load_dword v125,off,s[20:23],s92 sc1
buffer_load_dwordx4 v[40:43],v0,s[20:23],s93 offen offset:2048 sc1
buffer_load_dwordx4 v[44:47],v0,s[20:23],s93 offen offset:3072 sc1
s_waitcnt vmcnt(7)
v_max3_u32 v124,v28,v29,v30
v_smfmac_f32_16x16x64_bf16 v[68:71],v[24:27],a[168:175],v1
v_max_u32 v124,v124,v31
v_cmp_eq_u32 vcc,-1,v124
v_smfmac_f32_16x16x64_bf16 v[72:75],v[24:27],a[176:183],v1
v_smfmac_f32_16x16x64_bf16 v[76:79],v[24:27],a[184:191],v1
s_cbranch_vccnz dfl_101100
v_smfmac_f32_16x16x64_bf16 v[64:67],v[28:31],a[224:231],v1
buffer_load_dword v125,off,s[20:23],s92 sc1
buffer_store_dword v126,v121,s[20:23],s69 offen sc1
s_waitcnt vmcnt(6)
v_max3_u32 v124,v20,v21,v22
v_smfmac_f32_16x16x64_bf16 v[68:71],v[28:31],a[232:239],v1
v_max_u32 v124,v124,v23
v_cmp_eq_u32 vcc,-1,v124
v_smfmac_f32_16x16x64_bf16 v[72:75],v[28:31],a[240:247],v1
v_smfmac_f32_16x16x64_bf16 v[76:79],v[28:31],a[248:255],v1
s_cbranch_vccnz lfb_101105
s_mov_b32 s55,0
v_smfmac_f32_16x16x64_bf16 v[64:67],v[20:23],a[96:103],v1
s_waitcnt vmcnt(7)
v_max3_u32 v124,v32,v33,v34
v_max_u32 v124,v124,v35
v_cmp_eq_u32 vcc,-1,v124
v_smfmac_f32_16x16x64_bf16 v[68:71],v[20:23],a[104:111],v1
v_smfmac_f32_16x16x64_bf16 v[72:75],v[20:23],a[112:119],v1
v_smfmac_f32_16x16x64_bf16 v[76:79],v[20:23],a[120:127],v1
s_cbranch_vccnz flb_100901
s_branch segb_100885
fl_100891:
flb_100899:
buffer_load_dwordx4 v[24:27],v0,s[20:23],s92 offen offset:2048 sc1
s_mov_b32 s55,4
buffer_load_dwordx4 v[40:43],v0,s[20:23],s93 offen offset:2048 sc1
buffer_load_dwordx4 v[44:47],v0,s[20:23],s93 offen offset:3072 sc1
s_waitcnt vmcnt(7)
v_max3_u32 v124,v28,v29,v30
v_max_u32 v124,v124,v31
v_cmp_eq_u32 vcc,-1,v124
s_cbranch_vccnz dfl_101100
v_smfmac_f32_16x16x64_bf16 v[64:67],v[28:31],a[224:231],v1
buffer_load_dword v125,off,s[20:23],s92 sc1
buffer_store_dword v126,v121,s[20:23],s69 offen sc1
s_waitcnt vmcnt(4)
v_max3_u32 v124,v24,v25,v26
v_smfmac_f32_16x16x64_bf16 v[68:71],v[28:31],a[232:239],v1
v_max_u32 v124,v124,v27
v_cmp_eq_u32 vcc,-1,v124
v_smfmac_f32_16x16x64_bf16 v[72:75],v[28:31],a[240:247],v1
v_smfmac_f32_16x16x64_bf16 v[76:79],v[28:31],a[248:255],v1
s_cbranch_vccnz lfb_101105
s_mov_b32 s55,0
v_smfmac_f32_16x16x64_bf16 v[64:67],v[24:27],a[160:167],v1
s_waitcnt vmcnt(7)
v_max3_u32 v124,v32,v33,v34
v_max_u32 v124,v124,v35
v_cmp_eq_u32 vcc,-1,v124
v_smfmac_f32_16x16x64_bf16 v[68:71],v[24:27],a[168:175],v1
v_smfmac_f32_16x16x64_bf16 v[72:75],v[24:27],a[176:183],v1
v_smfmac_f32_16x16x64_bf16 v[76:79],v[24:27],a[184:191],v1
s_cbranch_vccnz flb_100901
s_branch segb_100885
fl_100892:
flb_100900:
buffer_load_dwordx4 v[28:31],v0,s[20:23],s92 offen offset:3072 sc1
s_mov_b32 s55,8
buffer_store_dword v126,v121,s[20:23],s69 offen sc1
s_waitcnt vmcnt(1)
v_max3_u32 v124,v28,v29,v30
v_max_u32 v124,v124,v31
v_cmp_eq_u32 vcc,-1,v124
s_cbranch_vccnz lfb_101105
s_mov_b32 s55,0
v_smfmac_f32_16x16x64_bf16 v[64:67],v[28:31],a[224:231],v1
s_waitcnt vmcnt(7)
v_max3_u32 v124,v32,v33,v34
v_max_u32 v124,v124,v35
v_cmp_eq_u32 vcc,-1,v124
v_smfmac_f32_16x16x64_bf16 v[68:71],v[28:31],a[232:239],v1
v_smfmac_f32_16x16x64_bf16 v[72:75],v[28:31],a[240:247],v1
v_smfmac_f32_16x16x64_bf16 v[76:79],v[28:31],a[248:255],v1
s_cbranch_vccnz flb_100901
s_branch segb_100885
fl_100893:
flb_100901:
buffer_load_dwordx4 v[32:35],v0,s[20:23],s93 offen offset:0 sc1
s_mov_b32 s55,240
s_bitcmp1_b32 s55,5
s_cbranch_scc0 rdn_101108
s_waitcnt vmcnt(6)
v_max3_u32 v124,v36,v37,v38
v_max_u32 v124,v124,v39
v_cmp_eq_u32 vcc,-1,v124
s_cbranch_vccnz rfa_101109
buffer_load_dword v125,off,s[20:23],s92 sc1
s_bitset0_b32 s55,5
v_smfmac_f32_16x16x64_bf16 v[64:67],v[36:39],a[96:103],v1
v_smfmac_f32_16x16x64_bf16 v[68:71],v[36:39],a[104:111],v1
v_smfmac_f32_16x16x64_bf16 v[72:75],v[36:39],a[112:119],v1
v_smfmac_f32_16x16x64_bf16 v[76:79],v[36:39],a[120:127],v1
s_cmp_eq_u32 s55,0
s_cbranch_scc1 segb_100887
s_branch rnx_101110
rdn_101108:
buffer_load_dword v125,off,s[20:23],s92 sc1
s_branch rnx_101110
rfa_101109:
buffer_load_dwordx4 v[36:39],v0,s[20:23],s93 offen offset:1024 sc1
rnx_101110:
s_bitcmp1_b32 s55,6
s_cbranch_scc0 rdn_101111
s_waitcnt vmcnt(5)
v_max3_u32 v124,v40,v41,v42
v_max_u32 v124,v124,v43
v_cmp_eq_u32 vcc,-1,v124
s_cbranch_vccnz rfa_101112
buffer_load_dword v125,off,s[20:23],s92 sc1
s_bitset0_b32 s55,6
s_cmp_eq_u32 s55,0
s_cbranch_scc1 segb_100887
s_branch rnx_101113
rdn_101111:
buffer_load_dword v125,off,s[20:23],s92 sc1
s_branch rnx_101113
rfa_101112:
buffer_load_dwordx4 v[40:43],v0,s[20:23],s93 offen offset:2048 sc1
rnx_101113:
s_bitcmp1_b32 s55,7
s_cbranch_scc0 rdn_101114
s_waitcnt vmcnt(5)
v_max3_u32 v124,v44,v45,v46
v_max_u32 v124,v124,v47
v_cmp_eq_u32 vcc,-1,v124
s_cbranch_vccnz rfa_101115
buffer_load_dword v125,off,s[20:23],s92 sc1
s_bitset0_b32 s55,7
s_cmp_eq_u32 s55,0
s_cbranch_scc1 segb_100887
s_branch rnx_101116
rdn_101114:
buffer_load_dword v125,off,s[20:23],s92 sc1
s_branch rnx_101116
rfa_101115:
buffer_load_dwordx4 v[44:47],v0,s[20:23],s93 offen offset:3072 sc1
rnx_101116:
rot_101107:
s_bitcmp1_b32 s55,4
s_cbranch_scc0 rdn_101117
s_waitcnt vmcnt(3)
v_max3_u32 v124,v32,v33,v34
v_max_u32 v124,v124,v35
v_cmp_eq_u32 vcc,-1,v124
s_cbranch_vccnz rfa_101118
buffer_load_dword v125,off,s[20:23],s92 sc1
s_bitset0_b32 s55,4
v_smfmac_f32_16x16x64_bf16 v[64:67],v[32:35],a[32:39],v1
v_smfmac_f32_16x16x64_bf16 v[68:71],v[32:35],a[40:47],v1
v_smfmac_f32_16x16x64_bf16 v[72:75],v[32:35],a[48:55],v1
v_smfmac_f32_16x16x64_bf16 v[76:79],v[32:35],a[56:63],v1
s_cmp_eq_u32 s55,0
s_cbranch_scc1 segb_100887
s_branch rnx_101119
rdn_101117:
buffer_load_dword v125,off,s[20:23],s92 sc1
s_branch rnx_101119
rfa_101118:
buffer_load_dwordx4 v[32:35],v0,s[20:23],s93 offen offset:0 sc1
rnx_101119:
s_bitcmp1_b32 s55,5
s_cbranch_scc0 rdn_101120
s_waitcnt vmcnt(3)
v_max3_u32 v124,v36,v37,v38
v_max_u32 v124,v124,v39
v_cmp_eq_u32 vcc,-1,v124
s_cbranch_vccnz rfa_101121
buffer_load_dword v125,off,s[20:23],s92 sc1
s_bitset0_b32 s55,5
v_smfmac_f32_16x16x64_bf16 v[64:67],v[36:39],a[96:103],v1
v_smfmac_f32_16x16x64_bf16 v[68:71],v[36:39],a[104:111],v1
v_smfmac_f32_16x16x64_bf16 v[72:75],v[36:39],a[112:119],v1
v_smfmac_f32_16x16x64_bf16 v[76:79],v[36:39],a[120:127],v1
s_cmp_eq_u32 s55,0
s_cbranch_scc1 segb_100887
s_branch rnx_101122
rdn_101120:
buffer_load_dword v125,off,s[20:23],s92 sc1
s_branch rnx_101122
rfa_101121:
buffer_load_dwordx4 v[36:39],v0,s[20:23],s93 offen offset:1024 sc1
rnx_101122:
s_bitcmp1_b32 s55,6
s_cbranch_scc0 rdn_101123
s_waitcnt vmcnt(3)
v_max3_u32 v124,v40,v41,v42
v_max_u32 v124,v124,v43
v_cmp_eq_u32 vcc,-1,v124
s_cbranch_vccnz rfa_101124
buffer_load_dword v125,off,s[20:23],s92 sc1
s_bitset0_b32 s55,6
s_cmp_eq_u32 s55,0
s_cbranch_scc1 segb_100887
s_branch rnx_101125
rdn_101123:
buffer_load_dword v125,off,s[20:23],s92 sc1
s_branch rnx_101125
rfa_101124:
buffer_load_dwordx4 v[40:43],v0,s[20:23],s93 offen offset:2048 sc1
rnx_101125:
s_bitcmp1_b32 s55,7
s_cbranch_scc0 rdn_101126
s_waitcnt vmcnt(3)
v_max3_u32 v124,v44,v45,v46
v_max_u32 v124,v124,v47
v_cmp_eq_u32 vcc,-1,v124
s_cbranch_vccnz rfa_101127
buffer_load_dword v125,off,s[20:23],s92 sc1
s_bitset0_b32 s55,7
s_cmp_eq_u32 s55,0
s_cbranch_scc1 segb_100887
s_branch rnx_101128
rdn_101126:
buffer_load_dword v125,off,s[20:23],s92 sc1
s_branch rnx_101128
rfa_101127:
buffer_load_dwordx4 v[44:47],v0,s[20:23],s93 offen offset:3072 sc1
rnx_101128:
s_sub_u32 s90,s90,1
s_cmp_gt_i32 s90,0
s_cbranch_scc1 rot_101107
s_mov_b32 s55,0
s_branch segb_100887
fl_100894:
flb_100902:
buffer_load_dwordx4 v[36:39],v0,s[20:23],s93 offen offset:1024 sc1
s_mov_b32 s55,224
s_bitcmp1_b32 s55,6
s_cbranch_scc0 rdn_101130
s_waitcnt vmcnt(5)
v_max3_u32 v124,v40,v41,v42
v_max_u32 v124,v124,v43
v_cmp_eq_u32 vcc,-1,v124
s_cbranch_vccnz rfa_101131
buffer_load_dword v125,off,s[20:23],s92 sc1
s_bitset0_b32 s55,6
s_cmp_eq_u32 s55,0
s_cbranch_scc1 segb_100887
s_branch rnx_101132
rdn_101130:
buffer_load_dword v125,off,s[20:23],s92 sc1
s_branch rnx_101132
rfa_101131:
buffer_load_dwordx4 v[40:43],v0,s[20:23],s93 offen offset:2048 sc1
rnx_101132:
s_bitcmp1_b32 s55,7
s_cbranch_scc0 rdn_101133
s_waitcnt vmcnt(5)
v_max3_u32 v124,v44,v45,v46
v_max_u32 v124,v124,v47
v_cmp_eq_u32 vcc,-1,v124
s_cbranch_vccnz rfa_101134
buffer_load_dword v125,off,s[20:23],s92 sc1
s_bitset0_b32 s55,7
s_cmp_eq_u32 s55,0
s_cbranch_scc1 segb_100887
s_branch rnx_101135
rdn_101133:
buffer_load_dword v125,off,s[20:23],s92 sc1
s_branch rnx_101135
rfa_101134:
buffer_load_dwordx4 v[44:47],v0,s[20:23],s93 offen offset:3072 sc1
rnx_101135:
rot_101129:
s_bitcmp1_b32 s55,5
s_cbranch_scc0 rdn_101136
s_waitcnt vmcnt(2)
v_max3_u32 v124,v36,v37,v38
v_max_u32 v124,v124,v39
v_cmp_eq_u32 vcc,-1,v124
s_cbranch_vccnz rfa_101137
buffer_load_dword v125,off,s[20:23],s92 sc1
s_bitset0_b32 s55,5
v_smfmac_f32_16x16x64_bf16 v[64:67],v[36:39],a[96:103],v1
v_smfmac_f32_16x16x64_bf16 v[68:71],v[36:39],a[104:111],v1
v_smfmac_f32_16x16x64_bf16 v[72:75],v[36:39],a[112:119],v1
v_smfmac_f32_16x16x64_bf16 v[76:79],v[36:39],a[120:127],v1
s_cmp_eq_u32 s55,0
s_cbranch_scc1 segb_100887
s_branch rnx_101138
rdn_101136:
buffer_load_dword v125,off,s[20:23],s92 sc1
s_branch rnx_101138
rfa_101137:
buffer_load_dwordx4 v[36:39],v0,s[20:23],s93 offen offset:1024 sc1
rnx_101138:
s_bitcmp1_b32 s55,6
s_cbranch_scc0 rdn_101139
s_waitcnt vmcnt(2)
v_max3_u32 v124,v40,v41,v42
v_max_u32 v124,v124,v43
v_cmp_eq_u32 vcc,-1,v124
s_cbranch_vccnz rfa_101140
buffer_load_dword v125,off,s[20:23],s92 sc1
s_bitset0_b32 s55,6
s_cmp_eq_u32 s55,0
s_cbranch_scc1 segb_100887
s_branch rnx_101141
rdn_101139:
buffer_load_dword v125,off,s[20:23],s92 sc1
s_branch rnx_101141
rfa_101140:
buffer_load_dwordx4 v[40:43],v0,s[20:23],s93 offen offset:2048 sc1
rnx_101141:
s_bitcmp1_b32 s55,7
s_cbranch_scc0 rdn_101142
s_waitcnt vmcnt(2)
v_max3_u32 v124,v44,v45,v46
v_max_u32 v124,v124,v47
v_cmp_eq_u32 vcc,-1,v124
s_cbranch_vccnz rfa_101143
buffer_load_dword v125,off,s[20:23],s92 sc1
s_bitset0_b32 s55,7
s_cmp_eq_u32 s55,0
s_cbranch_scc1 segb_100887
s_branch rnx_101144
rdn_101142:
buffer_load_dword v125,off,s[20:23],s92 sc1
s_branch rnx_101144
rfa_101143:
buffer_load_dwordx4 v[44:47],v0,s[20:23],s93 offen offset:3072 sc1
rnx_101144:
s_sub_u32 s90,s90,1
s_cmp_gt_i32 s90,0
s_cbranch_scc1 rot_101129
s_mov_b32 s55,0
s_branch segb_100887
fl_100895:
flb_100903:
s_mov_b32 s55,192
s_bitcmp1_b32 s55,6
s_cbranch_scc0 rdn_101146
s_waitcnt vmcnt(5)
v_max3_u32 v124,v40,v41,v42
v_max_u32 v124,v124,v43
v_cmp_eq_u32 vcc,-1,v124
s_cbranch_vccnz rfa_101147
buffer_load_dword v125,off,s[20:23],s92 sc1
s_bitset0_b32 s55,6
s_cmp_eq_u32 s55,0
s_cbranch_scc1 segb_100887
s_branch rnx_101148
rdn_101146:
buffer_load_dword v125,off,s[20:23],s92 sc1
s_branch rnx_101148
rfa_101147:
buffer_load_dwordx4 v[40:43],v0,s[20:23],s93 offen offset:2048 sc1
rnx_101148:
s_bitcmp1_b32 s55,7
s_cbranch_scc0 rdn_101149
s_waitcnt vmcnt(5)
v_max3_u32 v124,v44,v45,v46
v_max_u32 v124,v124,v47
v_cmp_eq_u32 vcc,-1,v124
s_cbranch_vccnz rfa_101150
buffer_load_dword v125,off,s[20:23],s92 sc1
s_bitset0_b32 s55,7
s_cmp_eq_u32 s55,0
s_cbranch_scc1 segb_100887
s_branch rnx_101151
rdn_101149:
buffer_load_dword v125,off,s[20:23],s92 sc1
s_branch rnx_101151
rfa_101150:
buffer_load_dwordx4 v[44:47],v0,s[20:23],s93 offen offset:3072 sc1
rnx_101151:
rot_101145:
s_bitcmp1_b32 s55,6
s_cbranch_scc0 rdn_101152
s_waitcnt vmcnt(1)
v_max3_u32 v124,v40,v41,v42
v_max_u32 v124,v124,v43
v_cmp_eq_u32 vcc,-1,v124
s_cbranch_vccnz rfa_101153
buffer_load_dword v125,off,s[20:23],s92 sc1
s_bitset0_b32 s55,6
s_cmp_eq_u32 s55,0
s_cbranch_scc1 segb_100887
s_branch rnx_101154
rdn_101152:
buffer_load_dword v125,off,s[20:23],s92 sc1
s_branch rnx_101154
rfa_101153:
buffer_load_dwordx4 v[40:43],v0,s[20:23],s93 offen offset:2048 sc1
rnx_101154:
s_bitcmp1_b32 s55,7
s_cbranch_scc0 rdn_101155
s_waitcnt vmcnt(1)
v_max3_u32 v124,v44,v45,v46
v_max_u32 v124,v124,v47
v_cmp_eq_u32 vcc,-1,v124
s_cbranch_vccnz rfa_101156
buffer_load_dword v125,off,s[20:23],s92 sc1
s_bitset0_b32 s55,7
s_cmp_eq_u32 s55,0
s_cbranch_scc1 segb_100887
s_branch rnx_101157
rdn_101155:
buffer_load_dword v125,off,s[20:23],s92 sc1
s_branch rnx_101157
rfa_101156:
buffer_load_dwordx4 v[44:47],v0,s[20:23],s93 offen offset:3072 sc1
rnx_101157:
s_sub_u32 s90,s90,1
s_cmp_gt_i32 s90,0
s_cbranch_scc1 rot_101145
s_mov_b32 s55,0
s_branch segb_100887
dfl_101098:
buffer_load_dwordx4 v[20:23],v0,s[20:23],s92 offen offset:1024 sc1
s_bitset1_b32 s55,1
buffer_load_dwordx4 v[36:39],v0,s[20:23],s93 offen offset:1024 sc1
s_waitcnt vmcnt(5)
v_max3_u32 v124,v24,v25,v26
v_max_u32 v124,v124,v27
v_cmp_eq_u32 vcc,-1,v124
s_cbranch_vccnz dfl_101099
s_branch dseg_101102
dfl_101099:
buffer_load_dwordx4 v[24:27],v0,s[20:23],s92 offen offset:2048 sc1
s_bitset1_b32 s55,2
buffer_load_dwordx4 v[40:43],v0,s[20:23],s93 offen offset:2048 sc1
buffer_load_dwordx4 v[44:47],v0,s[20:23],s93 offen offset:3072 sc1
s_waitcnt vmcnt(7)
v_max3_u32 v124,v28,v29,v30
v_max_u32 v124,v124,v31
v_cmp_eq_u32 vcc,-1,v124
s_cbranch_vccnz dfl_101100
s_branch dseg_101103
dfl_101100:
buffer_load_dwordx4 v[28:31],v0,s[20:23],s92 offen offset:3072 sc1
s_bitset1_b32 s55,3
buffer_store_dword v126,v121,s[20:23],s69 offen sc1
s_branch lap2_101104
dseg_101102:
v_smfmac_f32_16x16x64_bf16 v[64:67],v[24:27],a[160:167],v1
buffer_load_dword v125,off,s[20:23],s92 sc1
buffer_load_dwordx4 v[40:43],v0,s[20:23],s93 offen offset:2048 sc1
buffer_load_dwordx4 v[44:47],v0,s[20:23],s93 offen offset:3072 sc1
s_waitcnt vmcnt(7)
v_max3_u32 v124,v28,v29,v30
v_smfmac_f32_16x16x64_bf16 v[68:71],v[24:27],a[168:175],v1
v_max_u32 v124,v124,v31
v_cmp_eq_u32 vcc,-1,v124
v_smfmac_f32_16x16x64_bf16 v[72:75],v[24:27],a[176:183],v1
v_smfmac_f32_16x16x64_bf16 v[76:79],v[24:27],a[184:191],v1
s_cbranch_vccnz dfl_101100
dseg_101103:
v_smfmac_f32_16x16x64_bf16 v[64:67],v[28:31],a[224:231],v1
buffer_load_dword v125,off,s[20:23],s92 sc1
v_smfmac_f32_16x16x64_bf16 v[68:71],v[28:31],a[232:239],v1
buffer_store_dword v126,v121,s[20:23],s69 offen sc1
v_smfmac_f32_16x16x64_bf16 v[72:75],v[28:31],a[240:247],v1
v_smfmac_f32_16x16x64_bf16 v[76:79],v[28:31],a[248:255],v1
lap2_101104:
s_bitcmp1_b32 s55,0
s_cbranch_scc0 l2s_101158
s_waitcnt vmcnt(8)
v_max3_u32 v124,v16,v17,v18
v_max_u32 v124,v124,v19
v_cmp_eq_u32 vcc,-1,v124
s_cbranch_vccnz l2s_101158
s_bitset0_b32 s55,0
v_smfmac_f32_16x16x64_bf16 v[64:67],v[16:19],a[32:39],v1
v_smfmac_f32_16x16x64_bf16 v[68:71],v[16:19],a[40:47],v1
v_smfmac_f32_16x16x64_bf16 v[72:75],v[16:19],a[48:55],v1
v_smfmac_f32_16x16x64_bf16 v[76:79],v[16:19],a[56:63],v1
l2s_101158:
s_bitcmp1_b32 s55,1
s_cbranch_scc0 l2s_101160
s_waitcnt vmcnt(6)
v_max3_u32 v124,v20,v21,v22
v_max_u32 v124,v124,v23
v_cmp_eq_u32 vcc,-1,v124
s_cbranch_vccnz l2s_101160
s_bitset0_b32 s55,1
v_smfmac_f32_16x16x64_bf16 v[64:67],v[20:23],a[96:103],v1
v_smfmac_f32_16x16x64_bf16 v[68:71],v[20:23],a[104:111],v1
v_smfmac_f32_16x16x64_bf16 v[72:75],v[20:23],a[112:119],v1
v_smfmac_f32_16x16x64_bf16 v[76:79],v[20:23],a[120:127],v1
l2s_101160:
s_bitcmp1_b32 s55,2
s_cbranch_scc0 l2s_101162
s_waitcnt vmcnt(4)
v_max3_u32 v124,v24,v25,v26
v_max_u32 v124,v124,v27
v_cmp_eq_u32 vcc,-1,v124
s_cbranch_vccnz l2s_101162
s_bitset0_b32 s55,2
v_smfmac_f32_16x16x64_bf16 v[64:67],v[24:27],a[160:167],v1
v_smfmac_f32_16x16x64_bf16 v[68:71],v[24:27],a[168:175],v1
v_smfmac_f32_16x16x64_bf16 v[72:75],v[24:27],a[176:183],v1
v_smfmac_f32_16x16x64_bf16 v[76:79],v[24:27],a[184:191],v1
l2s_101162:
s_bitcmp1_b32 s55,3
s_cbranch_scc0 l2s_101164
s_waitcnt vmcnt(1)
v_max3_u32 v124,v28,v29,v30
v_max_u32 v124,v124,v31
v_cmp_eq_u32 vcc,-1,v124
s_cbranch_vccnz l2s_101164
s_bitset0_b32 s55,3
v_smfmac_f32_16x16x64_bf16 v[64:67],v[28:31],a[224:231],v1
v_smfmac_f32_16x16x64_bf16 v[68:71],v[28:31],a[232:239],v1
v_smfmac_f32_16x16x64_bf16 v[72:75],v[28:31],a[240:247],v1
v_smfmac_f32_16x16x64_bf16 v[76:79],v[28:31],a[248:255],v1
l2s_101164:
s_cmp_eq_u32 s55,0
s_cbranch_scc0 lfb_101105
Ldone_101106:
s_waitcnt vmcnt(7)
v_max3_u32 v124,v32,v33,v34
v_max_u32 v124,v124,v35
v_cmp_eq_u32 vcc,-1,v124
s_cbranch_vccnz flb_100901
s_branch segb_100885
lfb_101105:
s_bitcmp1_b32 s55,0
s_cbranch_scc0 dsk_101166
buffer_load_dwordx4 v[16:19],v0,s[20:23],s92 offen offset:0 sc1
dsk_101166:
s_bitcmp1_b32 s55,1
s_cbranch_scc0 dsk_101167
buffer_load_dwordx4 v[20:23],v0,s[20:23],s92 offen offset:1024 sc1
dsk_101167:
s_bitcmp1_b32 s55,2
s_cbranch_scc0 dsk_101168
buffer_load_dwordx4 v[24:27],v0,s[20:23],s92 offen offset:2048 sc1
dsk_101168:
s_bitcmp1_b32 s55,3
s_cbranch_scc0 dsk_101169
buffer_load_dwordx4 v[28:31],v0,s[20:23],s92 offen offset:3072 sc1
dsk_101169:
s_bitcmp1_b32 s55,0
s_cbranch_scc0 dsk_101170
s_waitcnt vmcnt(2)
v_max3_u32 v124,v16,v17,v18
v_max_u32 v124,v124,v19
v_cmp_eq_u32 vcc,-1,v124
s_cbranch_vccz dgo_101171
s_nop 15
buffer_load_dwordx4 v[104:107],v0,s[20:23],s92 offen offset:0 sc1
s_nop 15
buffer_load_dwordx4 v[108:111],v0,s[20:23],s92 offen offset:0 sc1
dlp_101172:
s_waitcnt vmcnt(2)
v_max3_u32 v124,v16,v17,v18
v_max_u32 v124,v124,v19
v_cmp_eq_u32 vcc,-1,v124
s_cbranch_vccz dgo_101171
buffer_load_dwordx4 v[16:19],v0,s[20:23],s92 offen offset:0 sc1
s_waitcnt vmcnt(2)
v_max3_u32 v124,v104,v105,v106
v_max_u32 v124,v124,v107
v_cmp_eq_u32 vcc,-1,v124
s_cbranch_vccz dcp_101174
buffer_load_dwordx4 v[104:107],v0,s[20:23],s92 offen offset:0 sc1
s_waitcnt vmcnt(2)
v_max3_u32 v124,v108,v109,v110
v_max_u32 v124,v124,v111
v_cmp_eq_u32 vcc,-1,v124
s_cbranch_vccz dcp_101175
buffer_load_dwordx4 v[108:111],v0,s[20:23],s92 offen offset:0 sc1
s_sub_u32 s90,s90,1
s_cmp_gt_i32 s90,0
s_cbranch_scc1 dlp_101172
s_branch dgo_101171
dcp_101174:
v_mov_b32 v16,v104
v_mov_b32 v17,v105
v_mov_b32 v18,v106
v_mov_b32 v19,v107
s_nop 1
s_branch dgo_101171
dcp_101175:
v_mov_b32 v16,v108
v_mov_b32 v17,v109
v_mov_b32 v18,v110
v_mov_b32 v19,v111
s_nop 1
dgo_101171:
v_smfmac_f32_16x16x64_bf16 v[64:67],v[16:19],a[32:39],v1
v_smfmac_f32_16x16x64_bf16 v[68:71],v[16:19],a[40:47],v1
v_smfmac_f32_16x16x64_bf16 v[72:75],v[16:19],a[48:55],v1
v_smfmac_f32_16x16x64_bf16 v[76:79],v[16:19],a[56:63],v1
dsk_101170:
s_bitcmp1_b32 s55,1
s_cbranch_scc0 dsk_101176
s_waitcnt vmcnt(2)
v_max3_u32 v124,v20,v21,v22
v_max_u32 v124,v124,v23
v_cmp_eq_u32 vcc,-1,v124
s_cbranch_vccz dgo_101177
s_nop 15
buffer_load_dwordx4 v[104:107],v0,s[20:23],s92 offen offset:1024 sc1
s_nop 15
buffer_load_dwordx4 v[108:111],v0,s[20:23],s92 offen offset:1024 sc1
dlp_101178:
s_waitcnt vmcnt(2)
v_max3_u32 v124,v20,v21,v22
v_max_u32 v124,v124,v23
v_cmp_eq_u32 vcc,-1,v124
s_cbranch_vccz dgo_101177
buffer_load_dwordx4 v[20:23],v0,s[20:23],s92 offen offset:1024 sc1
s_waitcnt vmcnt(2)
v_max3_u32 v124,v104,v105,v106
v_max_u32 v124,v124,v107
v_cmp_eq_u32 vcc,-1,v124
s_cbranch_vccz dcp_101180
buffer_load_dwordx4 v[104:107],v0,s[20:23],s92 offen offset:1024 sc1
s_waitcnt vmcnt(2)
v_max3_u32 v124,v108,v109,v110
v_max_u32 v124,v124,v111
v_cmp_eq_u32 vcc,-1,v124
s_cbranch_vccz dcp_101181
buffer_load_dwordx4 v[108:111],v0,s[20:23],s92 offen offset:1024 sc1
s_sub_u32 s90,s90,1
s_cmp_gt_i32 s90,0
s_cbranch_scc1 dlp_101178
s_branch dgo_101177
dcp_101180:
v_mov_b32 v20,v104
v_mov_b32 v21,v105
v_mov_b32 v22,v106
v_mov_b32 v23,v107
s_nop 1
s_branch dgo_101177
dcp_101181:
v_mov_b32 v20,v108
v_mov_b32 v21,v109
v_mov_b32 v22,v110
v_mov_b32 v23,v111
s_nop 1
dgo_101177:
v_smfmac_f32_16x16x64_bf16 v[64:67],v[20:23],a[96:103],v1
v_smfmac_f32_16x16x64_bf16 v[68:71],v[20:23],a[104:111],v1
v_smfmac_f32_16x16x64_bf16 v[72:75],v[20:23],a[112:119],v1
v_smfmac_f32_16x16x64_bf16 v[76:79],v[20:23],a[120:127],v1
dsk_101176:
s_bitcmp1_b32 s55,2
s_cbranch_scc0 dsk_101182
s_waitcnt vmcnt(2)
v_max3_u32 v124,v24,v25,v26
v_max_u32 v124,v124,v27
v_cmp_eq_u32 vcc,-1,v124
s_cbranch_vccz dgo_101183
s_nop 15
buffer_load_dwordx4 v[104:107],v0,s[20:23],s92 offen offset:2048 sc1
s_nop 15
buffer_load_dwordx4 v[108:111],v0,s[20:23],s92 offen offset:2048 sc1
dlp_101184:
s_waitcnt vmcnt(2)
v_max3_u32 v124,v24,v25,v26
v_max_u32 v124,v124,v27
v_cmp_eq_u32 vcc,-1,v124
s_cbranch_vccz dgo_101183
buffer_load_dwordx4 v[24:27],v0,s[20:23],s92 offen offset:2048 sc1
s_waitcnt vmcnt(2)
v_max3_u32 v124,v104,v105,v106
v_max_u32 v124,v124,v107
v_cmp_eq_u32 vcc,-1,v124
s_cbranch_vccz dcp_101186
buffer_load_dwordx4 v[104:107],v0,s[20:23],s92 offen offset:2048 sc1
s_waitcnt vmcnt(2)
v_max3_u32 v124,v108,v109,v110
v_max_u32 v124,v124,v111
v_cmp_eq_u32 vcc,-1,v124
s_cbranch_vccz dcp_101187
buffer_load_dwordx4 v[108:111],v0,s[20:23],s92 offen offset:2048 sc1
s_sub_u32 s90,s90,1
s_cmp_gt_i32 s90,0
s_cbranch_scc1 dlp_101184
s_branch dgo_101183
dcp_101186:
v_mov_b32 v24,v104
v_mov_b32 v25,v105
v_mov_b32 v26,v106
v_mov_b32 v27,v107
s_nop 1
s_branch dgo_101183
dcp_101187:
v_mov_b32 v24,v108
v_mov_b32 v25,v109
v_mov_b32 v26,v110
v_mov_b32 v27,v111
s_nop 1
dgo_101183:
v_smfmac_f32_16x16x64_bf16 v[64:67],v[24:27],a[160:167],v1
v_smfmac_f32_16x16x64_bf16 v[68:71],v[24:27],a[168:175],v1
v_smfmac_f32_16x16x64_bf16 v[72:75],v[24:27],a[176:183],v1
v_smfmac_f32_16x16x64_bf16 v[76:79],v[24:27],a[184:191],v1
dsk_101182:
s_bitcmp1_b32 s55,3
s_cbranch_scc0 dsk_101188
s_waitcnt vmcnt(2)
v_max3_u32 v124,v28,v29,v30
v_max_u32 v124,v124,v31
v_cmp_eq_u32 vcc,-1,v124
s_cbranch_vccz dgo_101189
s_nop 15
buffer_load_dwordx4 v[104:107],v0,s[20:23],s92 offen offset:3072 sc1
s_nop 15
buffer_load_dwordx4 v[108:111],v0,s[20:23],s92 offen offset:3072 sc1
dlp_101190:
s_waitcnt vmcnt(2)
v_max3_u32 v124,v28,v29,v30
v_max_u32 v124,v124,v31
v_cmp_eq_u32 vcc,-1,v124
s_cbranch_vccz dgo_101189
buffer_load_dwordx4 v[28:31],v0,s[20:23],s92 offen offset:3072 sc1
s_waitcnt vmcnt(2)
v_max3_u32 v124,v104,v105,v106
v_max_u32 v124,v124,v107
v_cmp_eq_u32 vcc,-1,v124
s_cbranch_vccz dcp_101192
buffer_load_dwordx4 v[104:107],v0,s[20:23],s92 offen offset:3072 sc1
s_waitcnt vmcnt(2)
v_max3_u32 v124,v108,v109,v110
v_max_u32 v124,v124,v111
v_cmp_eq_u32 vcc,-1,v124
s_cbranch_vccz dcp_101193
buffer_load_dwordx4 v[108:111],v0,s[20:23],s92 offen offset:3072 sc1
s_sub_u32 s90,s90,1
s_cmp_gt_i32 s90,0
s_cbranch_scc1 dlp_101190
s_branch dgo_101189
dcp_101192:
v_mov_b32 v28,v104
v_mov_b32 v29,v105
v_mov_b32 v30,v106
v_mov_b32 v31,v107
s_nop 1
s_branch dgo_101189
dcp_101193:
v_mov_b32 v28,v108
v_mov_b32 v29,v109
v_mov_b32 v30,v110
v_mov_b32 v31,v111
s_nop 1
dgo_101189:
v_smfmac_f32_16x16x64_bf16 v[64:67],v[28:31],a[224:231],v1
v_smfmac_f32_16x16x64_bf16 v[68:71],v[28:31],a[232:239],v1
v_smfmac_f32_16x16x64_bf16 v[72:75],v[28:31],a[240:247],v1
v_smfmac_f32_16x16x64_bf16 v[76:79],v[28:31],a[248:255],v1
dsk_101188:
s_mov_b32 s55,0
s_branch Ldone_101106
slowA_100905:
buffer_load_dwordx4 v[44:47],v0,s[20:23],s93 offen offset:3072 sc1
dsk_101194:
s_bitcmp1_b32 s55,7
s_cbranch_scc0 dsk_101195
s_waitcnt vmcnt(2)
v_max3_u32 v124,v44,v45,v46
v_max_u32 v124,v124,v47
v_cmp_eq_u32 vcc,-1,v124
s_cbranch_vccz dgo_101196
s_nop 15
s_nop 3
buffer_load_dwordx4 v[104:107],v0,s[20:23],s93 offen offset:3072 sc1
s_nop 15
s_nop 3
buffer_load_dwordx4 v[108:111],v0,s[20:23],s93 offen offset:3072 sc1
dlp_101197:
s_waitcnt vmcnt(2)
v_max3_u32 v124,v44,v45,v46
v_max_u32 v124,v124,v47
v_cmp_eq_u32 vcc,-1,v124
s_cbranch_vccz dgo_101196
buffer_load_dwordx4 v[44:47],v0,s[20:23],s93 offen offset:3072 sc1
s_waitcnt vmcnt(2)
v_max3_u32 v124,v104,v105,v106
v_max_u32 v124,v124,v107
v_cmp_eq_u32 vcc,-1,v124
s_cbranch_vccz dcp_101199
buffer_load_dwordx4 v[104:107],v0,s[20:23],s93 offen offset:3072 sc1
s_waitcnt vmcnt(2)
v_max3_u32 v124,v108,v109,v110
v_max_u32 v124,v124,v111
v_cmp_eq_u32 vcc,-1,v124
s_cbranch_vccz dcp_101200
buffer_load_dwordx4 v[108:111],v0,s[20:23],s93 offen offset:3072 sc1
s_sub_u32 s90,s90,1
s_cmp_gt_i32 s90,0
s_cbranch_scc1 dlp_101197
s_branch dgo_101196
dcp_101199:
v_mov_b32 v44,v104
v_mov_b32 v45,v105
v_mov_b32 v46,v106
v_mov_b32 v47,v107
s_nop 1
s_branch dgo_101196
dcp_101200:
v_mov_b32 v44,v108
v_mov_b32 v45,v109
v_mov_b32 v46,v110
v_mov_b32 v47,v111
s_nop 1
dgo_101196:
dsk_101195:
s_mov_b32 s55,0
s_branch segb_100887
recfin_100408:
s_endpgm
.section .rodata,"a"
.p2align 6
.amdhsa_kernel flow_kernel
  .amdhsa_next_free_vgpr 512
  .amdhsa_next_free_sgpr 102
  .amdhsa_accum_offset 256
  .amdhsa_group_segment_fixed_size 0
  .amdhsa_kernarg_size 136
  .amdhsa_user_sgpr_count 2
  .amdhsa_user_sgpr_kernarg_segment_ptr 1
  .amdhsa_system_sgpr_workgroup_id_x 1
.end_amdhsa_kernel
```

```asm
; @launch kernel=flow_kernel grid=(256,1,1) block=(256,1,1) lds=163840
.amdgcn_target "amdgcn-amd-amdhsa--gfx950"
.text
.globl flow_kernel
.p2align 8
.type flow_kernel,@function
flow_kernel:
s_cmp_ge_u32 s2,256
s_cbranch_scc1 done_1
s_lshr_b32 s49,s2,3
s_load_dwordx2 s[18:19],s[0:1],128
s_load_dwordx2 s[2:3],s[0:1],120
s_load_dwordx2 s[4:5],s[0:1],0
s_getreg_b32 s51,hwreg(HW_REG_XCC_ID)
v_lshrrev_b32 v2,6,v0
v_and_b32 v1,63,v0
s_and_b32 s51,s51,7
v_readfirstlane_b32 s50,v2
s_mov_b32 s90,40000
s_mov_b32 s56,2
s_mov_b32 s88,64
s_lshl_b32 s64,s51,2
s_lshr_b32 s64,0x76325410,s64
s_and_b32 s64,s64,7
s_lshl_b32 s58,s64,5
s_add_u32 s58,s58,s49
s_waitcnt lgkmcnt(0)
s_mov_b32 s20,s18
s_and_b32 s21,s19,0xffff
s_mov_b32 s22,0x10000000
s_mov_b32 s23,0x20000
s_cmp_lg_u32 s50,0
s_cbranch_scc1 fl_disp0
s_mov_b32 s92,s2
s_and_b32 s93,s3,0xffff
s_mov_b32 s94,0x100
s_mov_b32 s95,0x20000
s_lshl_b32 s64,1,s49
v_mov_b32 v2,s64
v_mov_b32 v3,0x100
s_lshl_b32 s64,s51,3
s_mov_b64 exec,1
buffer_atomic_add_x2 v[2:3],off,s[92:95],s64 sc1
s_mov_b64 exec,-1
fl_disp0:
v_mbcnt_lo_u32_b32 v1,-1,0
v_mbcnt_hi_u32_b32 v1,-1,v1
s_sub_u32 s59,s58,64
s_cbranch_scc0 nx_3
s_branch fl_rec
nx_3:
s_cmp_lt_u32 s58,128
s_cbranch_scc0 nx_4
s_branch fl_qkv
nx_4:
s_cmp_ge_u32 s58,192
s_cbranch_scc1 fl_dutb
s_load_dwordx4 s[4:7],s[0:1],96
s_load_dwordx2 s[8:9],s[0:1],0
s_sub_u32 s59,s58,128
s_and_b32 s52,s59,15
s_lshr_b32 s53,s59,4
s_lshl_b32 s64,s50,6
v_add_u32 v14,s64,v1
v_lshrrev_b32 v2,4,v14
v_and_b32 v3,15,v14
v_mul_u32_u24 v13,196608,v2
v_lshl_add_u32 v13,v3,4,v13
s_mul_i32 s54,s53,3145728
s_lshl_b32 s64,s52,8
s_add_u32 s54,s54,s64
s_add_u32 s54,s54,0
v_lshlrev_b32 v15,1,v14
s_lshl_b32 s55,s53,9
s_mov_b32 s60,0
s_mov_b32 s73,0xffff0000
s_sub_u32 s61,s58,128
s_lshl_b32 s61,s61,15
v_lshlrev_b32 v25,6,v2
v_lshlrev_b32 v24,4,v1
v_and_b32 v2,3,v1
v_lshrrev_b32 v3,2,v1
s_lshl_b32 s64,s60,2
v_add_u32 v4,s64,v2
s_lshl_b32 s65,s50,9
v_lshlrev_b32 v5,4,v3
v_add_u32 v5,s65,v5
v_lshl_add_u32 v8,v4,11,v5
v_lshlrev_b32 v9,1,v5
v_lshrrev_b32 v5,2,v3
v_and_b32 v3,3,v3
s_lshl_b32 s65,s50,13
v_lshlrev_b32 v5,10,v5
v_lshl_add_u32 v5,v3,8,v5
v_lshl_add_u32 v5,v4,4,v5
v_add_u32 v10,s65,v5
s_lshl_b32 s65,s50,9
v_lshlrev_b32 v5,3,v1
v_add_u32 v11,s65,v5
v_lshlrev_b32 v12,3,v2
s_waitcnt lgkmcnt(0)
s_mov_b32 s24,s4
s_and_b32 s25,s5,0xffff
s_mov_b32 s26,0x800
s_mov_b32 s27,0x20000
s_mov_b32 s28,s6
s_and_b32 s29,s7,0xffff
s_mov_b32 s30,0xc00000
s_mov_b32 s31,0x20000
s_mov_b32 s32,s8
s_and_b32 s33,s9,0xffff
s_mov_b32 s34,0x400000
s_mov_b32 s35,0x20000
v_mov_b32 v28,-1
v_mov_b32 v20,0
v_mov_b32 v29,-1
v_mov_b32 v21,0
v_mov_b32 v30,-1
v_mov_b32 v22,0
v_mov_b32 v31,-1
v_mov_b32 v23,0
buffer_load_ushort v16,v15,s[24:27],s55 offen
buffer_load_dwordx4 v[96:99],v13,s[28:31],s54 offen offset:0
s_add_u32 s54,s54,12288
buffer_load_dwordx4 v[100:103],v13,s[28:31],s54 offen offset:0
s_add_u32 s54,s54,12288
buffer_load_dwordx4 v[104:107],v13,s[28:31],s54 offen offset:0
s_add_u32 s54,s54,12288
buffer_load_dwordx4 v[108:111],v13,s[28:31],s54 offen offset:0
s_add_u32 s54,s54,12288
buffer_load_dwordx4 v[112:115],v13,s[28:31],s54 offen offset:0
s_add_u32 s54,s54,12288
buffer_load_dwordx4 v[116:119],v13,s[28:31],s54 offen offset:0
s_add_u32 s54,s54,12288
buffer_load_dwordx4 v[120:123],v13,s[28:31],s54 offen offset:0
s_add_u32 s54,s54,12288
buffer_load_dwordx4 v[124:127],v13,s[28:31],s54 offen offset:0
s_add_u32 s54,s54,12288
buffer_load_dwordx4 v[128:131],v13,s[28:31],s54 offen offset:0
s_add_u32 s54,s54,12288
buffer_load_dwordx4 v[132:135],v13,s[28:31],s54 offen offset:0
s_add_u32 s54,s54,12288
buffer_load_dwordx4 v[136:139],v13,s[28:31],s54 offen offset:0
s_add_u32 s54,s54,12288
buffer_load_dwordx4 v[140:143],v13,s[28:31],s54 offen offset:0
s_add_u32 s54,s54,12288
buffer_load_dwordx4 v[144:147],v13,s[28:31],s54 offen offset:0
s_add_u32 s54,s54,12288
buffer_load_dwordx4 v[148:151],v13,s[28:31],s54 offen offset:0
s_add_u32 s54,s54,12288
buffer_load_dwordx4 v[152:155],v13,s[28:31],s54 offen offset:0
s_add_u32 s54,s54,12288
buffer_load_dwordx4 v[156:159],v13,s[28:31],s54 offen offset:0
s_add_u32 s64,s61,0
buffer_load_dwordx4 v[48:51],v8,s[32:35],s64 offen offset:0
buffer_load_dwordx4 v[52:55],v8,s[32:35],s64 offen offset:256
s_add_u32 s64,s61,8192
buffer_load_dwordx4 v[56:59],v8,s[32:35],s64 offen offset:0
buffer_load_dwordx4 v[60:63],v8,s[32:35],s64 offen offset:256
s_add_u32 s64,s61,16384
buffer_load_dwordx4 v[64:67],v8,s[32:35],s64 offen offset:0
buffer_load_dwordx4 v[68:71],v8,s[32:35],s64 offen offset:256
s_add_u32 s64,s61,24576
buffer_load_dwordx4 v[72:75],v8,s[32:35],s64 offen offset:0
buffer_load_dwordx4 v[76:79],v8,s[32:35],s64 offen offset:256
s_waitcnt vmcnt(24)
v_lshlrev_b32 v16,16,v16
v_mul_f32 v17,0xbfb8aa3b,v16
v_exp_f32 v17,v17
s_nop 0
v_add_f32 v17,1.0,v17
v_rcp_f32 v17,v17
s_nop 0
v_mul_f32 v17,v17,v16
v_cvt_pk_bf16_f32 v17,v17,v17
v_and_b32 v17,s73,v17
v_lshlrev_b32 v18,2,v14
ds_write_b32 v18,v17 offset:8192
s_waitcnt lgkmcnt(0)
s_barrier
ds_read_b128 v[32:35],v25 offset:8192
ds_read_b128 v[36:39],v25 offset:8208
ds_read_b128 v[40:43],v25 offset:8224
ds_read_b128 v[44:47],v25 offset:8240
v_mov_b32 v80,0
v_mov_b32 v81,0
v_mov_b32 v82,0
v_mov_b32 v83,0
v_mov_b32 v84,0
v_mov_b32 v85,0
v_mov_b32 v86,0
v_mov_b32 v87,0
s_waitcnt lgkmcnt(0)
s_waitcnt vmcnt(23)
v_lshlrev_b32 v16,16,v96
v_and_b32 v17,s73,v96
v_pk_fma_f32 v[80:81],v[16:17],v[32:33],v[80:81] op_sel:[0,0,0] op_sel_hi:[1,0,1]
v_lshlrev_b32 v18,16,v97
v_and_b32 v19,s73,v97
v_pk_fma_f32 v[82:83],v[18:19],v[32:33],v[82:83] op_sel:[0,0,0] op_sel_hi:[1,0,1]
v_lshlrev_b32 v16,16,v98
v_and_b32 v17,s73,v98
v_pk_fma_f32 v[84:85],v[16:17],v[32:33],v[84:85] op_sel:[0,0,0] op_sel_hi:[1,0,1]
v_lshlrev_b32 v18,16,v99
v_and_b32 v19,s73,v99
v_pk_fma_f32 v[86:87],v[18:19],v[32:33],v[86:87] op_sel:[0,0,0] op_sel_hi:[1,0,1]
s_waitcnt vmcnt(22)
v_lshlrev_b32 v16,16,v100
v_and_b32 v17,s73,v100
v_pk_fma_f32 v[80:81],v[16:17],v[32:33],v[80:81] op_sel:[0,1,0] op_sel_hi:[1,1,1]
v_lshlrev_b32 v18,16,v101
v_and_b32 v19,s73,v101
v_pk_fma_f32 v[82:83],v[18:19],v[32:33],v[82:83] op_sel:[0,1,0] op_sel_hi:[1,1,1]
v_lshlrev_b32 v16,16,v102
v_and_b32 v17,s73,v102
v_pk_fma_f32 v[84:85],v[16:17],v[32:33],v[84:85] op_sel:[0,1,0] op_sel_hi:[1,1,1]
v_lshlrev_b32 v18,16,v103
v_and_b32 v19,s73,v103
v_pk_fma_f32 v[86:87],v[18:19],v[32:33],v[86:87] op_sel:[0,1,0] op_sel_hi:[1,1,1]
s_waitcnt vmcnt(21)
v_lshlrev_b32 v16,16,v104
v_and_b32 v17,s73,v104
v_pk_fma_f32 v[80:81],v[16:17],v[34:35],v[80:81] op_sel:[0,0,0] op_sel_hi:[1,0,1]
v_lshlrev_b32 v18,16,v105
v_and_b32 v19,s73,v105
v_pk_fma_f32 v[82:83],v[18:19],v[34:35],v[82:83] op_sel:[0,0,0] op_sel_hi:[1,0,1]
v_lshlrev_b32 v16,16,v106
v_and_b32 v17,s73,v106
v_pk_fma_f32 v[84:85],v[16:17],v[34:35],v[84:85] op_sel:[0,0,0] op_sel_hi:[1,0,1]
v_lshlrev_b32 v18,16,v107
v_and_b32 v19,s73,v107
v_pk_fma_f32 v[86:87],v[18:19],v[34:35],v[86:87] op_sel:[0,0,0] op_sel_hi:[1,0,1]
s_waitcnt vmcnt(20)
v_lshlrev_b32 v16,16,v108
v_and_b32 v17,s73,v108
v_pk_fma_f32 v[80:81],v[16:17],v[34:35],v[80:81] op_sel:[0,1,0] op_sel_hi:[1,1,1]
v_lshlrev_b32 v18,16,v109
v_and_b32 v19,s73,v109
v_pk_fma_f32 v[82:83],v[18:19],v[34:35],v[82:83] op_sel:[0,1,0] op_sel_hi:[1,1,1]
v_lshlrev_b32 v16,16,v110
v_and_b32 v17,s73,v110
v_pk_fma_f32 v[84:85],v[16:17],v[34:35],v[84:85] op_sel:[0,1,0] op_sel_hi:[1,1,1]
v_lshlrev_b32 v18,16,v111
v_and_b32 v19,s73,v111
v_pk_fma_f32 v[86:87],v[18:19],v[34:35],v[86:87] op_sel:[0,1,0] op_sel_hi:[1,1,1]
s_waitcnt vmcnt(19)
v_lshlrev_b32 v16,16,v112
v_and_b32 v17,s73,v112
v_pk_fma_f32 v[80:81],v[16:17],v[36:37],v[80:81] op_sel:[0,0,0] op_sel_hi:[1,0,1]
v_lshlrev_b32 v18,16,v113
v_and_b32 v19,s73,v113
v_pk_fma_f32 v[82:83],v[18:19],v[36:37],v[82:83] op_sel:[0,0,0] op_sel_hi:[1,0,1]
v_lshlrev_b32 v16,16,v114
v_and_b32 v17,s73,v114
v_pk_fma_f32 v[84:85],v[16:17],v[36:37],v[84:85] op_sel:[0,0,0] op_sel_hi:[1,0,1]
v_lshlrev_b32 v18,16,v115
v_and_b32 v19,s73,v115
v_pk_fma_f32 v[86:87],v[18:19],v[36:37],v[86:87] op_sel:[0,0,0] op_sel_hi:[1,0,1]
s_waitcnt vmcnt(18)
v_lshlrev_b32 v16,16,v116
v_and_b32 v17,s73,v116
v_pk_fma_f32 v[80:81],v[16:17],v[36:37],v[80:81] op_sel:[0,1,0] op_sel_hi:[1,1,1]
v_lshlrev_b32 v18,16,v117
v_and_b32 v19,s73,v117
v_pk_fma_f32 v[82:83],v[18:19],v[36:37],v[82:83] op_sel:[0,1,0] op_sel_hi:[1,1,1]
v_lshlrev_b32 v16,16,v118
v_and_b32 v17,s73,v118
v_pk_fma_f32 v[84:85],v[16:17],v[36:37],v[84:85] op_sel:[0,1,0] op_sel_hi:[1,1,1]
v_lshlrev_b32 v18,16,v119
v_and_b32 v19,s73,v119
v_pk_fma_f32 v[86:87],v[18:19],v[36:37],v[86:87] op_sel:[0,1,0] op_sel_hi:[1,1,1]
s_waitcnt vmcnt(17)
v_lshlrev_b32 v16,16,v120
v_and_b32 v17,s73,v120
v_pk_fma_f32 v[80:81],v[16:17],v[38:39],v[80:81] op_sel:[0,0,0] op_sel_hi:[1,0,1]
v_lshlrev_b32 v18,16,v121
v_and_b32 v19,s73,v121
v_pk_fma_f32 v[82:83],v[18:19],v[38:39],v[82:83] op_sel:[0,0,0] op_sel_hi:[1,0,1]
v_lshlrev_b32 v16,16,v122
v_and_b32 v17,s73,v122
v_pk_fma_f32 v[84:85],v[16:17],v[38:39],v[84:85] op_sel:[0,0,0] op_sel_hi:[1,0,1]
v_lshlrev_b32 v18,16,v123
v_and_b32 v19,s73,v123
v_pk_fma_f32 v[86:87],v[18:19],v[38:39],v[86:87] op_sel:[0,0,0] op_sel_hi:[1,0,1]
s_waitcnt vmcnt(16)
v_lshlrev_b32 v16,16,v124
v_and_b32 v17,s73,v124
v_pk_fma_f32 v[80:81],v[16:17],v[38:39],v[80:81] op_sel:[0,1,0] op_sel_hi:[1,1,1]
v_lshlrev_b32 v18,16,v125
v_and_b32 v19,s73,v125
v_pk_fma_f32 v[82:83],v[18:19],v[38:39],v[82:83] op_sel:[0,1,0] op_sel_hi:[1,1,1]
v_lshlrev_b32 v16,16,v126
v_and_b32 v17,s73,v126
v_pk_fma_f32 v[84:85],v[16:17],v[38:39],v[84:85] op_sel:[0,1,0] op_sel_hi:[1,1,1]
v_lshlrev_b32 v18,16,v127
v_and_b32 v19,s73,v127
v_pk_fma_f32 v[86:87],v[18:19],v[38:39],v[86:87] op_sel:[0,1,0] op_sel_hi:[1,1,1]
s_waitcnt vmcnt(15)
v_lshlrev_b32 v16,16,v128
v_and_b32 v17,s73,v128
v_pk_fma_f32 v[80:81],v[16:17],v[40:41],v[80:81] op_sel:[0,0,0] op_sel_hi:[1,0,1]
v_lshlrev_b32 v18,16,v129
v_and_b32 v19,s73,v129
v_pk_fma_f32 v[82:83],v[18:19],v[40:41],v[82:83] op_sel:[0,0,0] op_sel_hi:[1,0,1]
v_lshlrev_b32 v16,16,v130
v_and_b32 v17,s73,v130
v_pk_fma_f32 v[84:85],v[16:17],v[40:41],v[84:85] op_sel:[0,0,0] op_sel_hi:[1,0,1]
v_lshlrev_b32 v18,16,v131
v_and_b32 v19,s73,v131
v_pk_fma_f32 v[86:87],v[18:19],v[40:41],v[86:87] op_sel:[0,0,0] op_sel_hi:[1,0,1]
s_waitcnt vmcnt(14)
v_lshlrev_b32 v16,16,v132
v_and_b32 v17,s73,v132
v_pk_fma_f32 v[80:81],v[16:17],v[40:41],v[80:81] op_sel:[0,1,0] op_sel_hi:[1,1,1]
v_lshlrev_b32 v18,16,v133
v_and_b32 v19,s73,v133
v_pk_fma_f32 v[82:83],v[18:19],v[40:41],v[82:83] op_sel:[0,1,0] op_sel_hi:[1,1,1]
v_lshlrev_b32 v16,16,v134
v_and_b32 v17,s73,v134
v_pk_fma_f32 v[84:85],v[16:17],v[40:41],v[84:85] op_sel:[0,1,0] op_sel_hi:[1,1,1]
v_lshlrev_b32 v18,16,v135
v_and_b32 v19,s73,v135
v_pk_fma_f32 v[86:87],v[18:19],v[40:41],v[86:87] op_sel:[0,1,0] op_sel_hi:[1,1,1]
s_waitcnt vmcnt(13)
v_lshlrev_b32 v16,16,v136
v_and_b32 v17,s73,v136
v_pk_fma_f32 v[80:81],v[16:17],v[42:43],v[80:81] op_sel:[0,0,0] op_sel_hi:[1,0,1]
v_lshlrev_b32 v18,16,v137
v_and_b32 v19,s73,v137
v_pk_fma_f32 v[82:83],v[18:19],v[42:43],v[82:83] op_sel:[0,0,0] op_sel_hi:[1,0,1]
v_lshlrev_b32 v16,16,v138
v_and_b32 v17,s73,v138
v_pk_fma_f32 v[84:85],v[16:17],v[42:43],v[84:85] op_sel:[0,0,0] op_sel_hi:[1,0,1]
v_lshlrev_b32 v18,16,v139
v_and_b32 v19,s73,v139
v_pk_fma_f32 v[86:87],v[18:19],v[42:43],v[86:87] op_sel:[0,0,0] op_sel_hi:[1,0,1]
s_waitcnt vmcnt(12)
v_lshlrev_b32 v16,16,v140
v_and_b32 v17,s73,v140
v_pk_fma_f32 v[80:81],v[16:17],v[42:43],v[80:81] op_sel:[0,1,0] op_sel_hi:[1,1,1]
v_lshlrev_b32 v18,16,v141
v_and_b32 v19,s73,v141
v_pk_fma_f32 v[82:83],v[18:19],v[42:43],v[82:83] op_sel:[0,1,0] op_sel_hi:[1,1,1]
v_lshlrev_b32 v16,16,v142
v_and_b32 v17,s73,v142
v_pk_fma_f32 v[84:85],v[16:17],v[42:43],v[84:85] op_sel:[0,1,0] op_sel_hi:[1,1,1]
v_lshlrev_b32 v18,16,v143
v_and_b32 v19,s73,v143
v_pk_fma_f32 v[86:87],v[18:19],v[42:43],v[86:87] op_sel:[0,1,0] op_sel_hi:[1,1,1]
s_waitcnt vmcnt(11)
v_lshlrev_b32 v16,16,v144
v_and_b32 v17,s73,v144
v_pk_fma_f32 v[80:81],v[16:17],v[44:45],v[80:81] op_sel:[0,0,0] op_sel_hi:[1,0,1]
v_lshlrev_b32 v18,16,v145
v_and_b32 v19,s73,v145
v_pk_fma_f32 v[82:83],v[18:19],v[44:45],v[82:83] op_sel:[0,0,0] op_sel_hi:[1,0,1]
v_lshlrev_b32 v16,16,v146
v_and_b32 v17,s73,v146
v_pk_fma_f32 v[84:85],v[16:17],v[44:45],v[84:85] op_sel:[0,0,0] op_sel_hi:[1,0,1]
v_lshlrev_b32 v18,16,v147
v_and_b32 v19,s73,v147
v_pk_fma_f32 v[86:87],v[18:19],v[44:45],v[86:87] op_sel:[0,0,0] op_sel_hi:[1,0,1]
s_waitcnt vmcnt(10)
v_lshlrev_b32 v16,16,v148
v_and_b32 v17,s73,v148
v_pk_fma_f32 v[80:81],v[16:17],v[44:45],v[80:81] op_sel:[0,1,0] op_sel_hi:[1,1,1]
v_lshlrev_b32 v18,16,v149
v_and_b32 v19,s73,v149
v_pk_fma_f32 v[82:83],v[18:19],v[44:45],v[82:83] op_sel:[0,1,0] op_sel_hi:[1,1,1]
v_lshlrev_b32 v16,16,v150
v_and_b32 v17,s73,v150
v_pk_fma_f32 v[84:85],v[16:17],v[44:45],v[84:85] op_sel:[0,1,0] op_sel_hi:[1,1,1]
v_lshlrev_b32 v18,16,v151
v_and_b32 v19,s73,v151
v_pk_fma_f32 v[86:87],v[18:19],v[44:45],v[86:87] op_sel:[0,1,0] op_sel_hi:[1,1,1]
s_waitcnt vmcnt(9)
v_lshlrev_b32 v16,16,v152
v_and_b32 v17,s73,v152
v_pk_fma_f32 v[80:81],v[16:17],v[46:47],v[80:81] op_sel:[0,0,0] op_sel_hi:[1,0,1]
v_lshlrev_b32 v18,16,v153
v_and_b32 v19,s73,v153
v_pk_fma_f32 v[82:83],v[18:19],v[46:47],v[82:83] op_sel:[0,0,0] op_sel_hi:[1,0,1]
v_lshlrev_b32 v16,16,v154
v_and_b32 v17,s73,v154
v_pk_fma_f32 v[84:85],v[16:17],v[46:47],v[84:85] op_sel:[0,0,0] op_sel_hi:[1,0,1]
v_lshlrev_b32 v18,16,v155
v_and_b32 v19,s73,v155
v_pk_fma_f32 v[86:87],v[18:19],v[46:47],v[86:87] op_sel:[0,0,0] op_sel_hi:[1,0,1]
s_waitcnt vmcnt(8)
v_lshlrev_b32 v16,16,v156
v_and_b32 v17,s73,v156
v_pk_fma_f32 v[80:81],v[16:17],v[46:47],v[80:81] op_sel:[0,1,0] op_sel_hi:[1,1,1]
v_lshlrev_b32 v18,16,v157
v_and_b32 v19,s73,v157
v_pk_fma_f32 v[82:83],v[18:19],v[46:47],v[82:83] op_sel:[0,1,0] op_sel_hi:[1,1,1]
v_lshlrev_b32 v16,16,v158
v_and_b32 v17,s73,v158
v_pk_fma_f32 v[84:85],v[16:17],v[46:47],v[84:85] op_sel:[0,1,0] op_sel_hi:[1,1,1]
v_lshlrev_b32 v18,16,v159
v_and_b32 v19,s73,v159
v_pk_fma_f32 v[86:87],v[18:19],v[46:47],v[86:87] op_sel:[0,1,0] op_sel_hi:[1,1,1]
v_lshlrev_b32 v18,5,v14
ds_write_b128 v18,v[80:83] offset:16384
ds_write_b128 v18,v[84:87] offset:16400
v_and_b32 v18,127,v14
v_lshlrev_b32 v18,2,v18
v_lshrrev_b32 v19,7,v14
v_mov_b32 v19,v18
s_waitcnt lgkmcnt(0)
s_barrier
ds_read_b32 v32,v19 offset:16384
ds_read_b32 v33,v19 offset:16896
ds_read_b32 v34,v19 offset:17408
ds_read_b32 v35,v19 offset:17920
ds_read_b32 v36,v19 offset:18432
ds_read_b32 v37,v19 offset:18944
ds_read_b32 v38,v19 offset:19456
ds_read_b32 v39,v19 offset:19968
ds_read_b32 v40,v19 offset:20480
ds_read_b32 v41,v19 offset:20992
ds_read_b32 v42,v19 offset:21504
ds_read_b32 v43,v19 offset:22016
s_waitcnt lgkmcnt(4)
ds_read_b32 v44,v19 offset:22528
ds_read_b32 v45,v19 offset:23040
ds_read_b32 v46,v19 offset:23552
ds_read_b32 v47,v19 offset:24064
s_waitcnt lgkmcnt(0)
v_pk_add_f32 v[32:33],v[32:33],v[40:41]
v_pk_add_f32 v[34:35],v[34:35],v[42:43]
v_pk_add_f32 v[36:37],v[36:37],v[44:45]
v_pk_add_f32 v[38:39],v[38:39],v[46:47]
v_pk_add_f32 v[32:33],v[32:33],v[36:37]
v_pk_add_f32 v[34:35],v[34:35],v[38:39]
v_pk_add_f32 v[32:33],v[32:33],v[34:35]
v_add_f32 v32,v32,v33
s_mul_i32 s64,s53,24576
s_lshl_b32 s65,s52,9
s_add_u32 s64,s64,s65
s_add_u32 s64,s64,267386880
buffer_store_dword v32,v18,s[20:23],s64 offen sc1
s_waitcnt vmcnt(0)
s_barrier
s_cmp_lg_u32 s50,0
s_cbranch_scc1 sig_5
s_mov_b32 s92,s2
s_and_b32 s93,s3,0xffff
s_mov_b32 s94,0x100
s_mov_b32 s95,0x20000
s_add_u32 s64,s88,0
v_mov_b32 v16,1
s_mov_b64 exec,1
buffer_atomic_add v16,off,s[92:95],s64 sc1
s_mov_b64 exec,-1
sig_5:
v_lshlrev_b32 v128,16,v48
v_and_b32 v129,s73,v48
v_lshlrev_b32 v130,16,v49
v_and_b32 v131,s73,v49
v_lshlrev_b32 v132,16,v50
v_and_b32 v133,s73,v50
v_lshlrev_b32 v134,16,v51
v_and_b32 v135,s73,v51
v_lshlrev_b32 v136,16,v52
v_and_b32 v137,s73,v52
v_lshlrev_b32 v138,16,v53
v_and_b32 v139,s73,v53
v_lshlrev_b32 v140,16,v54
v_and_b32 v141,s73,v54
v_lshlrev_b32 v142,16,v55
v_and_b32 v143,s73,v55
v_lshlrev_b32 v144,16,v56
v_and_b32 v145,s73,v56
v_lshlrev_b32 v146,16,v57
v_and_b32 v147,s73,v57
v_lshlrev_b32 v148,16,v58
v_and_b32 v149,s73,v58
v_lshlrev_b32 v150,16,v59
v_and_b32 v151,s73,v59
v_lshlrev_b32 v152,16,v60
v_and_b32 v153,s73,v60
v_lshlrev_b32 v154,16,v61
v_and_b32 v155,s73,v61
v_lshlrev_b32 v156,16,v62
v_and_b32 v157,s73,v62
v_lshlrev_b32 v158,16,v63
v_and_b32 v159,s73,v63
v_lshlrev_b32 v160,16,v64
v_and_b32 v161,s73,v64
v_lshlrev_b32 v162,16,v65
v_and_b32 v163,s73,v65
v_lshlrev_b32 v164,16,v66
v_and_b32 v165,s73,v66
v_lshlrev_b32 v166,16,v67
v_and_b32 v167,s73,v67
v_lshlrev_b32 v168,16,v68
v_and_b32 v169,s73,v68
v_lshlrev_b32 v170,16,v69
v_and_b32 v171,s73,v69
v_lshlrev_b32 v172,16,v70
v_and_b32 v173,s73,v70
v_lshlrev_b32 v174,16,v71
v_and_b32 v175,s73,v71
v_lshlrev_b32 v176,16,v72
v_and_b32 v177,s73,v72
v_lshlrev_b32 v178,16,v73
v_and_b32 v179,s73,v73
v_lshlrev_b32 v180,16,v74
v_and_b32 v181,s73,v74
v_lshlrev_b32 v182,16,v75
v_and_b32 v183,s73,v75
v_lshlrev_b32 v184,16,v76
v_and_b32 v185,s73,v76
v_lshlrev_b32 v186,16,v77
v_and_b32 v187,s73,v77
v_lshlrev_b32 v188,16,v78
v_and_b32 v189,s73,v78
v_lshlrev_b32 v190,16,v79
v_and_b32 v191,s73,v79
v_add_f32 v208,v128,v129
v_mul_f32 v209,v128,v128
v_add_f32 v210,v130,v131
v_mul_f32 v211,v129,v129
v_fmac_f32 v209,v130,v130
v_fmac_f32 v211,v131,v131
v_add_f32 v208,v208,v132
v_fmac_f32 v209,v132,v132
v_add_f32 v210,v210,v133
v_fmac_f32 v211,v133,v133
v_add_f32 v208,v208,v134
v_fmac_f32 v209,v134,v134
v_add_f32 v210,v210,v135
v_fmac_f32 v211,v135,v135
v_add_f32 v208,v208,v136
v_fmac_f32 v209,v136,v136
v_add_f32 v210,v210,v137
v_fmac_f32 v211,v137,v137
v_add_f32 v208,v208,v138
v_fmac_f32 v209,v138,v138
v_add_f32 v210,v210,v139
v_fmac_f32 v211,v139,v139
v_add_f32 v208,v208,v140
v_fmac_f32 v209,v140,v140
v_add_f32 v210,v210,v141
v_fmac_f32 v211,v141,v141
v_add_f32 v208,v208,v142
v_fmac_f32 v209,v142,v142
v_add_f32 v210,v210,v143
v_fmac_f32 v211,v143,v143
v_add_f32 v208,v208,v210
v_add_f32 v209,v209,v211
v_add_f32 v212,v144,v145
v_mul_f32 v213,v144,v144
v_add_f32 v214,v146,v147
v_mul_f32 v215,v145,v145
v_fmac_f32 v213,v146,v146
v_fmac_f32 v215,v147,v147
v_add_f32 v212,v212,v148
v_fmac_f32 v213,v148,v148
v_add_f32 v214,v214,v149
v_fmac_f32 v215,v149,v149
v_add_f32 v212,v212,v150
v_fmac_f32 v213,v150,v150
v_add_f32 v214,v214,v151
v_fmac_f32 v215,v151,v151
v_add_f32 v212,v212,v152
v_fmac_f32 v213,v152,v152
v_add_f32 v214,v214,v153
v_fmac_f32 v215,v153,v153
v_add_f32 v212,v212,v154
v_fmac_f32 v213,v154,v154
v_add_f32 v214,v214,v155
v_fmac_f32 v215,v155,v155
v_add_f32 v212,v212,v156
v_fmac_f32 v213,v156,v156
v_add_f32 v214,v214,v157
v_fmac_f32 v215,v157,v157
v_add_f32 v212,v212,v158
v_fmac_f32 v213,v158,v158
v_add_f32 v214,v214,v159
v_fmac_f32 v215,v159,v159
v_add_f32 v212,v212,v214
v_add_f32 v213,v213,v215
v_add_f32 v216,v160,v161
v_mul_f32 v217,v160,v160
v_add_f32 v218,v162,v163
v_mul_f32 v219,v161,v161
v_fmac_f32 v217,v162,v162
v_fmac_f32 v219,v163,v163
v_add_f32 v216,v216,v164
v_fmac_f32 v217,v164,v164
v_add_f32 v218,v218,v165
v_fmac_f32 v219,v165,v165
v_add_f32 v216,v216,v166
v_fmac_f32 v217,v166,v166
v_add_f32 v218,v218,v167
v_fmac_f32 v219,v167,v167
v_add_f32 v216,v216,v168
v_fmac_f32 v217,v168,v168
v_add_f32 v218,v218,v169
v_fmac_f32 v219,v169,v169
v_add_f32 v216,v216,v170
v_fmac_f32 v217,v170,v170
v_add_f32 v218,v218,v171
v_fmac_f32 v219,v171,v171
v_add_f32 v216,v216,v172
v_fmac_f32 v217,v172,v172
v_add_f32 v218,v218,v173
v_fmac_f32 v219,v173,v173
v_add_f32 v216,v216,v174
v_fmac_f32 v217,v174,v174
v_add_f32 v218,v218,v175
v_fmac_f32 v219,v175,v175
v_add_f32 v216,v216,v218
v_add_f32 v217,v217,v219
v_add_f32 v220,v176,v177
v_mul_f32 v221,v176,v176
v_add_f32 v222,v178,v179
v_mul_f32 v223,v177,v177
v_fmac_f32 v221,v178,v178
v_fmac_f32 v223,v179,v179
v_add_f32 v220,v220,v180
v_fmac_f32 v221,v180,v180
v_add_f32 v222,v222,v181
v_fmac_f32 v223,v181,v181
v_add_f32 v220,v220,v182
v_fmac_f32 v221,v182,v182
v_add_f32 v222,v222,v183
v_fmac_f32 v223,v183,v183
v_add_f32 v220,v220,v184
v_fmac_f32 v221,v184,v184
v_add_f32 v222,v222,v185
v_fmac_f32 v223,v185,v185
v_add_f32 v220,v220,v186
v_fmac_f32 v221,v186,v186
v_add_f32 v222,v222,v187
v_fmac_f32 v223,v187,v187
v_add_f32 v220,v220,v188
v_fmac_f32 v221,v188,v188
v_add_f32 v222,v222,v189
v_fmac_f32 v223,v189,v189
v_add_f32 v220,v220,v190
v_fmac_f32 v221,v190,v190
v_add_f32 v222,v222,v191
v_fmac_f32 v223,v191,v191
v_add_f32 v220,v220,v222
v_add_f32 v221,v221,v223
v_add_f32_dpp v208,v208,v208 row_ror:4 row_mask:0xf bank_mask:0xf
v_add_f32_dpp v209,v209,v209 row_ror:4 row_mask:0xf bank_mask:0xf
v_add_f32_dpp v212,v212,v212 row_ror:4 row_mask:0xf bank_mask:0xf
v_add_f32_dpp v213,v213,v213 row_ror:4 row_mask:0xf bank_mask:0xf
v_add_f32_dpp v216,v216,v216 row_ror:4 row_mask:0xf bank_mask:0xf
v_add_f32_dpp v217,v217,v217 row_ror:4 row_mask:0xf bank_mask:0xf
v_add_f32_dpp v220,v220,v220 row_ror:4 row_mask:0xf bank_mask:0xf
v_add_f32_dpp v221,v221,v221 row_ror:4 row_mask:0xf bank_mask:0xf
v_add_f32_dpp v208,v208,v208 row_ror:8 row_mask:0xf bank_mask:0xf
v_add_f32_dpp v209,v209,v209 row_ror:8 row_mask:0xf bank_mask:0xf
v_add_f32_dpp v212,v212,v212 row_ror:8 row_mask:0xf bank_mask:0xf
v_add_f32_dpp v213,v213,v213 row_ror:8 row_mask:0xf bank_mask:0xf
v_add_f32_dpp v216,v216,v216 row_ror:8 row_mask:0xf bank_mask:0xf
v_add_f32_dpp v217,v217,v217 row_ror:8 row_mask:0xf bank_mask:0xf
v_add_f32_dpp v220,v220,v220 row_ror:8 row_mask:0xf bank_mask:0xf
v_add_f32_dpp v221,v221,v221 row_ror:8 row_mask:0xf bank_mask:0xf
v_mov_b32 v210,v208
v_mov_b32 v211,v209
s_nop 0
v_permlane16_swap_b32 v210,v208
v_permlane16_swap_b32 v211,v209
v_add_f32 v208,v208,v210
v_add_f32 v209,v209,v211
v_mov_b32 v214,v212
v_mov_b32 v215,v213
s_nop 0
v_permlane16_swap_b32 v214,v212
v_permlane16_swap_b32 v215,v213
v_add_f32 v212,v212,v214
v_add_f32 v213,v213,v215
v_mov_b32 v218,v216
v_mov_b32 v219,v217
s_nop 0
v_permlane16_swap_b32 v218,v216
v_permlane16_swap_b32 v219,v217
v_add_f32 v216,v216,v218
v_add_f32 v217,v217,v219
v_mov_b32 v222,v220
v_mov_b32 v223,v221
s_nop 0
v_permlane16_swap_b32 v222,v220
v_permlane16_swap_b32 v223,v221
v_add_f32 v220,v220,v222
v_add_f32 v221,v221,v223
v_mov_b32 v210,v208
v_mov_b32 v211,v209
s_nop 0
v_permlane32_swap_b32 v210,v208
v_permlane32_swap_b32 v211,v209
v_add_f32 v208,v208,v210
v_add_f32 v209,v209,v211
v_mov_b32 v214,v212
v_mov_b32 v215,v213
s_nop 0
v_permlane32_swap_b32 v214,v212
v_permlane32_swap_b32 v215,v213
v_add_f32 v212,v212,v214
v_add_f32 v213,v213,v215
v_mov_b32 v218,v216
v_mov_b32 v219,v217
s_nop 0
v_permlane32_swap_b32 v218,v216
v_permlane32_swap_b32 v219,v217
v_add_f32 v216,v216,v218
v_add_f32 v217,v217,v219
v_mov_b32 v222,v220
v_mov_b32 v223,v221
s_nop 0
v_permlane32_swap_b32 v222,v220
v_permlane32_swap_b32 v223,v221
v_add_f32 v220,v220,v222
v_add_f32 v221,v221,v223
ds_write_b64 v11,v[208:209] offset:32768
ds_write_b64 v11,v[212:213] offset:34816
ds_write_b64 v11,v[216:217] offset:36864
ds_write_b64 v11,v[220:221] offset:38912
s_waitcnt lgkmcnt(0)
s_barrier
ds_read_b64 v[32:33],v12 offset:32768
ds_read_b64 v[34:35],v12 offset:33280
ds_read_b64 v[36:37],v12 offset:33792
ds_read_b64 v[38:39],v12 offset:34304
s_waitcnt lgkmcnt(0)
v_add_f32 v32,v32,v34
v_add_f32 v33,v33,v35
v_add_f32 v36,v36,v38
v_add_f32 v37,v37,v39
v_add_f32 v32,v32,v36
v_add_f32 v33,v33,v37
v_mul_f32 v208,0xba800000,v32
v_mul_f32 v34,v208,v208
v_mul_f32 v33,0x3a800000,v33
v_sub_f32 v33,v33,v34
v_max_f32 v33,0,v33
v_add_f32 v33,0x3727c5ac,v33
v_rsq_f32 v209,v33
s_nop 0
v_mul_f32 v208,v208,v209
v_fma_f32 v128,v128,v209,v208
v_fma_f32 v129,v129,v209,v208
v_fma_f32 v130,v130,v209,v208
v_fma_f32 v131,v131,v209,v208
v_fma_f32 v132,v132,v209,v208
v_fma_f32 v133,v133,v209,v208
v_fma_f32 v134,v134,v209,v208
v_fma_f32 v135,v135,v209,v208
v_fma_f32 v136,v136,v209,v208
v_fma_f32 v137,v137,v209,v208
v_fma_f32 v138,v138,v209,v208
v_fma_f32 v139,v139,v209,v208
v_fma_f32 v140,v140,v209,v208
v_fma_f32 v141,v141,v209,v208
v_fma_f32 v142,v142,v209,v208
v_fma_f32 v143,v143,v209,v208
ds_read_b64 v[32:33],v12 offset:34816
ds_read_b64 v[34:35],v12 offset:35328
ds_read_b64 v[36:37],v12 offset:35840
ds_read_b64 v[38:39],v12 offset:36352
s_waitcnt lgkmcnt(0)
v_add_f32 v32,v32,v34
v_add_f32 v33,v33,v35
v_add_f32 v36,v36,v38
v_add_f32 v37,v37,v39
v_add_f32 v32,v32,v36
v_add_f32 v33,v33,v37
v_mul_f32 v208,0xba800000,v32
v_mul_f32 v34,v208,v208
v_mul_f32 v33,0x3a800000,v33
v_sub_f32 v33,v33,v34
v_max_f32 v33,0,v33
v_add_f32 v33,0x3727c5ac,v33
v_rsq_f32 v209,v33
s_nop 0
v_mul_f32 v208,v208,v209
v_fma_f32 v144,v144,v209,v208
v_fma_f32 v145,v145,v209,v208
v_fma_f32 v146,v146,v209,v208
v_fma_f32 v147,v147,v209,v208
v_fma_f32 v148,v148,v209,v208
v_fma_f32 v149,v149,v209,v208
v_fma_f32 v150,v150,v209,v208
v_fma_f32 v151,v151,v209,v208
v_fma_f32 v152,v152,v209,v208
v_fma_f32 v153,v153,v209,v208
v_fma_f32 v154,v154,v209,v208
v_fma_f32 v155,v155,v209,v208
v_fma_f32 v156,v156,v209,v208
v_fma_f32 v157,v157,v209,v208
v_fma_f32 v158,v158,v209,v208
v_fma_f32 v159,v159,v209,v208
ds_read_b64 v[32:33],v12 offset:36864
ds_read_b64 v[34:35],v12 offset:37376
ds_read_b64 v[36:37],v12 offset:37888
ds_read_b64 v[38:39],v12 offset:38400
s_waitcnt lgkmcnt(0)
v_add_f32 v32,v32,v34
v_add_f32 v33,v33,v35
v_add_f32 v36,v36,v38
v_add_f32 v37,v37,v39
v_add_f32 v32,v32,v36
v_add_f32 v33,v33,v37
v_mul_f32 v208,0xba800000,v32
v_mul_f32 v34,v208,v208
v_mul_f32 v33,0x3a800000,v33
v_sub_f32 v33,v33,v34
v_max_f32 v33,0,v33
v_add_f32 v33,0x3727c5ac,v33
v_rsq_f32 v209,v33
s_nop 0
v_mul_f32 v208,v208,v209
v_fma_f32 v160,v160,v209,v208
v_fma_f32 v161,v161,v209,v208
v_fma_f32 v162,v162,v209,v208
v_fma_f32 v163,v163,v209,v208
v_fma_f32 v164,v164,v209,v208
v_fma_f32 v165,v165,v209,v208
v_fma_f32 v166,v166,v209,v208
v_fma_f32 v167,v167,v209,v208
v_fma_f32 v168,v168,v209,v208
v_fma_f32 v169,v169,v209,v208
v_fma_f32 v170,v170,v209,v208
v_fma_f32 v171,v171,v209,v208
v_fma_f32 v172,v172,v209,v208
v_fma_f32 v173,v173,v209,v208
v_fma_f32 v174,v174,v209,v208
v_fma_f32 v175,v175,v209,v208
ds_read_b64 v[32:33],v12 offset:38912
ds_read_b64 v[34:35],v12 offset:39424
ds_read_b64 v[36:37],v12 offset:39936
ds_read_b64 v[38:39],v12 offset:40448
s_waitcnt lgkmcnt(0)
v_add_f32 v32,v32,v34
v_add_f32 v33,v33,v35
v_add_f32 v36,v36,v38
v_add_f32 v37,v37,v39
v_add_f32 v32,v32,v36
v_add_f32 v33,v33,v37
v_mul_f32 v208,0xba800000,v32
v_mul_f32 v34,v208,v208
v_mul_f32 v33,0x3a800000,v33
v_sub_f32 v33,v33,v34
v_max_f32 v33,0,v33
v_add_f32 v33,0x3727c5ac,v33
v_rsq_f32 v209,v33
s_nop 0
v_mul_f32 v208,v208,v209
v_fma_f32 v176,v176,v209,v208
v_fma_f32 v177,v177,v209,v208
v_fma_f32 v178,v178,v209,v208
v_fma_f32 v179,v179,v209,v208
v_fma_f32 v180,v180,v209,v208
v_fma_f32 v181,v181,v209,v208
v_fma_f32 v182,v182,v209,v208
v_fma_f32 v183,v183,v209,v208
v_fma_f32 v184,v184,v209,v208
v_fma_f32 v185,v185,v209,v208
v_fma_f32 v186,v186,v209,v208
v_fma_f32 v187,v187,v209,v208
v_fma_f32 v188,v188,v209,v208
v_fma_f32 v189,v189,v209,v208
v_fma_f32 v190,v190,v209,v208
v_fma_f32 v191,v191,v209,v208
s_mov_b32 s92,s2
s_and_b32 s93,s3,0xffff
s_mov_b32 s94,0x100
s_mov_b32 s95,0x20000
v_mbcnt_lo_u32_b32 v16,-1,0
v_mbcnt_hi_u32_b32 v16,-1,v16
v_mov_b32 v18,0
v_cmp_eq_u32 vcc,16,v16
s_nop 1
v_cndmask_b32 v18,v18,64,vcc
v_and_b32 v19,1,v16
v_cmp_eq_u32 vcc,1,v19
v_mov_b32 v19,8192
s_nop 0
v_cndmask_b32 v19,-1,v19,vcc
v_min_u32 v16,31,v16
v_lshlrev_b32 v16,2,v16
s_sub_u32 s66,s88,64
s_cmp_lg_u32 s50,0
s_cbranch_scc1 vot_10
vpoll_6:
buffer_load_dword v17,v16,s[92:95],s66 offen sc1
s_waitcnt vmcnt(0)
s_cmp_lg_u32 s56,2
s_cbranch_scc1 vck_7
v_cmp_eq_u32 vcc,v17,v19
s_and_b32 s64,vcc_lo,0xffff
s_cmp_eq_u32 s64,65535
s_cbranch_scc1 vck_7
s_mov_b32 s65,0
v_readlane_b32 s64,v17,1
s_lshr_b32 s64,s64,8
s_add_u32 s65,s65,s64
v_readlane_b32 s64,v17,3
s_lshr_b32 s64,s64,8
s_add_u32 s65,s65,s64
v_readlane_b32 s64,v17,5
s_lshr_b32 s64,s64,8
s_add_u32 s65,s65,s64
v_readlane_b32 s64,v17,7
s_lshr_b32 s64,s64,8
s_add_u32 s65,s65,s64
v_readlane_b32 s64,v17,9
s_lshr_b32 s64,s64,8
s_add_u32 s65,s65,s64
v_readlane_b32 s64,v17,11
s_lshr_b32 s64,s64,8
s_add_u32 s65,s65,s64
v_readlane_b32 s64,v17,13
s_lshr_b32 s64,s64,8
s_add_u32 s65,s65,s64
v_readlane_b32 s64,v17,15
s_lshr_b32 s64,s64,8
s_add_u32 s65,s65,s64
s_cmp_ge_u32 s65,256
s_cbranch_scc1 vok_9
s_branch vrt_8
vck_7:
v_cmp_gt_u32 vcc,v18,v17
s_cbranch_vccz vok_9
vrt_8:
s_sleep 8
s_sub_u32 s90,s90,1
s_cmp_gt_i32 s90,0
s_cbranch_scc1 vpoll_6
vok_9:
v_add_u32 v18,160000,v16
ds_write_b32 v18,v17
s_waitcnt lgkmcnt(0)
vot_10:
s_barrier
v_add_u32 v18,160000,v16
ds_read_b32 v17,v18
s_waitcnt lgkmcnt(0)
s_cmp_lg_u32 s56,2
s_cbranch_scc1 vfin_11
v_cmp_eq_u32 vcc,v17,v19
s_and_b32 s64,vcc_lo,0xffff
s_cmp_eq_u32 s64,65535
s_cbranch_scc1 vfin_11
s_mov_b32 s65,0
v_readlane_b32 s64,v17,1
s_lshr_b32 s64,s64,8
s_add_u32 s65,s65,s64
v_readlane_b32 s64,v17,3
s_lshr_b32 s64,s64,8
s_add_u32 s65,s65,s64
v_readlane_b32 s64,v17,5
s_lshr_b32 s64,s64,8
s_add_u32 s65,s65,s64
v_readlane_b32 s64,v17,7
s_lshr_b32 s64,s64,8
s_add_u32 s65,s65,s64
v_readlane_b32 s64,v17,9
s_lshr_b32 s64,s64,8
s_add_u32 s65,s65,s64
v_readlane_b32 s64,v17,11
s_lshr_b32 s64,s64,8
s_add_u32 s65,s65,s64
v_readlane_b32 s64,v17,13
s_lshr_b32 s64,s64,8
s_add_u32 s65,s65,s64
v_readlane_b32 s64,v17,15
s_lshr_b32 s64,s64,8
s_add_u32 s65,s65,s64
s_cmp_ge_u32 s65,256
s_cbranch_scc1 fl_fb
vfin_11:
s_and_b32 s56,s56,1
v_lshlrev_b32 v18,5,v14
s_mov_b32 s64,267386880
buffer_load_dwordx4 v[32:35],v18,s[20:23],s64 offen offset:0 sc1
buffer_load_dwordx4 v[36:39],v18,s[20:23],s64 offen offset:16 sc1
s_mov_b32 s64,267411456
buffer_load_dwordx4 v[40:43],v18,s[20:23],s64 offen offset:0 sc1
buffer_load_dwordx4 v[44:47],v18,s[20:23],s64 offen offset:16 sc1
s_mov_b32 s64,267436032
buffer_load_dwordx4 v[48:51],v18,s[20:23],s64 offen offset:0 sc1
buffer_load_dwordx4 v[52:55],v18,s[20:23],s64 offen offset:16 sc1
s_mov_b32 s64,267460608
buffer_load_dwordx4 v[56:59],v18,s[20:23],s64 offen offset:0 sc1
buffer_load_dwordx4 v[60:63],v18,s[20:23],s64 offen offset:16 sc1
s_cmp_gt_u32 s50,1
s_cselect_b32 s64,1.0,0
s_waitcnt vmcnt(0)
v_pk_add_f32 v[32:33],v[32:33],v[40:41]
v_pk_add_f32 v[48:49],v[48:49],v[56:57]
v_pk_add_f32 v[34:35],v[34:35],v[42:43]
v_pk_add_f32 v[50:51],v[50:51],v[58:59]
v_pk_add_f32 v[36:37],v[36:37],v[44:45]
v_pk_add_f32 v[52:53],v[52:53],v[60:61]
v_pk_add_f32 v[38:39],v[38:39],v[46:47]
v_pk_add_f32 v[54:55],v[54:55],v[62:63]
v_pk_add_f32 v[32:33],v[32:33],v[48:49]
v_pk_add_f32 v[34:35],v[34:35],v[50:51]
v_pk_add_f32 v[36:37],v[36:37],v[52:53]
v_pk_add_f32 v[38:39],v[38:39],v[54:55]
v_cvt_pk_bf16_f32 v40,v32,v33
v_cvt_pk_bf16_f32 v41,v34,v35
v_cvt_pk_bf16_f32 v42,v36,v37
v_cvt_pk_bf16_f32 v43,v38,v39
v_lshlrev_b32 v32,16,v40
v_and_b32 v33,s73,v40
v_lshlrev_b32 v34,16,v41
v_and_b32 v35,s73,v41
v_lshlrev_b32 v36,16,v42
v_and_b32 v37,s73,v42
v_lshlrev_b32 v38,16,v43
v_and_b32 v39,s73,v43
v_add_f32 v32,s64,v32
v_add_f32 v33,s64,v33
v_add_f32 v34,s64,v34
v_add_f32 v35,s64,v35
v_add_f32 v36,s64,v36
v_add_f32 v37,s64,v37
v_add_f32 v38,s64,v38
v_add_f32 v39,s64,v39
ds_write_b128 v18,v[32:35] offset:0
ds_write_b128 v18,v[36:39] offset:16
s_waitcnt lgkmcnt(0)
s_barrier
ds_read_b128 v[112:115],v9 offset:0
ds_read_b128 v[116:119],v9 offset:16
ds_read_b128 v[120:123],v9 offset:512
ds_read_b128 v[124:127],v9 offset:528
ds_read_b128 v[96:99],v9 offset:4096
ds_read_b128 v[100:103],v9 offset:4112
ds_read_b128 v[104:107],v9 offset:4608
ds_read_b128 v[108:111],v9 offset:4624
s_add_u32 s61,s61,146800640
s_add_u32 s62,s61,4096
s_waitcnt lgkmcnt(0)
v_fma_f32 v128,v128,v96,v112
v_fma_f32 v129,v129,v97,v113
v_fma_f32 v130,v130,v98,v114
v_fma_f32 v131,v131,v99,v115
v_fma_f32 v132,v132,v100,v116
v_fma_f32 v133,v133,v101,v117
v_fma_f32 v134,v134,v102,v118
v_fma_f32 v135,v135,v103,v119
v_fma_f32 v136,v136,v104,v120
v_fma_f32 v137,v137,v105,v121
v_fma_f32 v138,v138,v106,v122
v_fma_f32 v139,v139,v107,v123
v_fma_f32 v140,v140,v108,v124
v_fma_f32 v141,v141,v109,v125
v_fma_f32 v142,v142,v110,v126
v_fma_f32 v143,v143,v111,v127
v_cvt_pk_bf16_f32 v48,v128,v129
v_cvt_pk_bf16_f32 v49,v130,v131
v_cvt_pk_bf16_f32 v50,v132,v133
v_cvt_pk_bf16_f32 v51,v134,v135
v_cvt_pk_bf16_f32 v52,v136,v137
v_cvt_pk_bf16_f32 v53,v138,v139
v_cvt_pk_bf16_f32 v54,v140,v141
v_cvt_pk_bf16_f32 v55,v142,v143
buffer_store_dwordx4 v[48:51],v10,s[20:23],s61 offen offset:0 sc1
buffer_store_dwordx4 v[52:55],v10,s[20:23],s62 offen offset:0 sc1
v_fma_f32 v144,v144,v96,v112
v_fma_f32 v145,v145,v97,v113
v_fma_f32 v146,v146,v98,v114
v_fma_f32 v147,v147,v99,v115
v_fma_f32 v148,v148,v100,v116
v_fma_f32 v149,v149,v101,v117
v_fma_f32 v150,v150,v102,v118
v_fma_f32 v151,v151,v103,v119
v_fma_f32 v152,v152,v104,v120
v_fma_f32 v153,v153,v105,v121
v_fma_f32 v154,v154,v106,v122
v_fma_f32 v155,v155,v107,v123
v_fma_f32 v156,v156,v108,v124
v_fma_f32 v157,v157,v109,v125
v_fma_f32 v158,v158,v110,v126
v_fma_f32 v159,v159,v111,v127
v_cvt_pk_bf16_f32 v56,v144,v145
v_cvt_pk_bf16_f32 v57,v146,v147
v_cvt_pk_bf16_f32 v58,v148,v149
v_cvt_pk_bf16_f32 v59,v150,v151
v_cvt_pk_bf16_f32 v60,v152,v153
v_cvt_pk_bf16_f32 v61,v154,v155
v_cvt_pk_bf16_f32 v62,v156,v157
v_cvt_pk_bf16_f32 v63,v158,v159
buffer_store_dwordx4 v[56:59],v10,s[20:23],s61 offen offset:64 sc1
buffer_store_dwordx4 v[60:63],v10,s[20:23],s62 offen offset:64 sc1
v_fma_f32 v160,v160,v96,v112
v_fma_f32 v161,v161,v97,v113
v_fma_f32 v162,v162,v98,v114
v_fma_f32 v163,v163,v99,v115
v_fma_f32 v164,v164,v100,v116
v_fma_f32 v165,v165,v101,v117
v_fma_f32 v166,v166,v102,v118
v_fma_f32 v167,v167,v103,v119
v_fma_f32 v168,v168,v104,v120
v_fma_f32 v169,v169,v105,v121
v_fma_f32 v170,v170,v106,v122
v_fma_f32 v171,v171,v107,v123
v_fma_f32 v172,v172,v108,v124
v_fma_f32 v173,v173,v109,v125
v_fma_f32 v174,v174,v110,v126
v_fma_f32 v175,v175,v111,v127
v_cvt_pk_bf16_f32 v64,v160,v161
v_cvt_pk_bf16_f32 v65,v162,v163
v_cvt_pk_bf16_f32 v66,v164,v165
v_cvt_pk_bf16_f32 v67,v166,v167
v_cvt_pk_bf16_f32 v68,v168,v169
v_cvt_pk_bf16_f32 v69,v170,v171
v_cvt_pk_bf16_f32 v70,v172,v173
v_cvt_pk_bf16_f32 v71,v174,v175
buffer_store_dwordx4 v[64:67],v10,s[20:23],s61 offen offset:128 sc1
buffer_store_dwordx4 v[68:71],v10,s[20:23],s62 offen offset:128 sc1
v_fma_f32 v176,v176,v96,v112
v_fma_f32 v177,v177,v97,v113
v_fma_f32 v178,v178,v98,v114
v_fma_f32 v179,v179,v99,v115
v_fma_f32 v180,v180,v100,v116
v_fma_f32 v181,v181,v101,v117
v_fma_f32 v182,v182,v102,v118
v_fma_f32 v183,v183,v103,v119
v_fma_f32 v184,v184,v104,v120
v_fma_f32 v185,v185,v105,v121
v_fma_f32 v186,v186,v106,v122
v_fma_f32 v187,v187,v107,v123
v_fma_f32 v188,v188,v108,v124
v_fma_f32 v189,v189,v109,v125
v_fma_f32 v190,v190,v110,v126
v_fma_f32 v191,v191,v111,v127
v_cvt_pk_bf16_f32 v72,v176,v177
v_cvt_pk_bf16_f32 v73,v178,v179
v_cvt_pk_bf16_f32 v74,v180,v181
v_cvt_pk_bf16_f32 v75,v182,v183
v_cvt_pk_bf16_f32 v76,v184,v185
v_cvt_pk_bf16_f32 v77,v186,v187
v_cvt_pk_bf16_f32 v78,v188,v189
v_cvt_pk_bf16_f32 v79,v190,v191
buffer_store_dwordx4 v[72:75],v10,s[20:23],s61 offen offset:192 sc1
buffer_store_dwordx4 v[76:79],v10,s[20:23],s62 offen offset:192 sc1
s_waitcnt vmcnt(0)
s_barrier
s_cmp_lg_u32 s50,0
s_cbranch_scc1 sig_12
s_mov_b32 s92,s2
s_and_b32 s93,s3,0xffff
s_mov_b32 s94,0x100
s_mov_b32 s95,0x20000
s_add_u32 s64,s88,12
v_mov_b32 v16,1
s_mov_b64 exec,1
buffer_atomic_add v16,off,s[92:95],s64 sc1
s_mov_b64 exec,-1
sig_12:
s_branch fl_disp
fl_dutb:
s_load_dwordx4 s[4:7],s[0:1],96
s_load_dwordx2 s[8:9],s[0:1],0
s_cmp_lg_u32 s58,220
s_cbranch_scc1 nomeas_13
s_cmp_lg_u32 s50,0
s_cbranch_scc1 nomeas_13
s_mov_b64 exec,1
s_mov_b32 s65,1
s_cmp_eq_u32 s56,1
s_cbranch_scc1 pub_14
s_mov_b32 s66,138526720
s_mov_b32 s67,138534912
s_mov_b32 s70,0x7fffffff
s_mov_b32 s71,0x7fffffff
s_mov_b32 s72,8
mlp_15:
s_memtime s[94:95]
s_waitcnt lgkmcnt(0)
buffer_store_dword v16,off,s[20:23],s66 sc1
s_waitcnt vmcnt(0)
s_memtime s[96:97]
s_waitcnt lgkmcnt(0)
s_sub_u32 s96,s96,s94
s_min_u32 s70,s70,s96
s_memtime s[94:95]
s_waitcnt lgkmcnt(0)
buffer_store_dword v16,off,s[20:23],s67 sc1
s_waitcnt vmcnt(0)
s_memtime s[96:97]
s_waitcnt lgkmcnt(0)
s_sub_u32 s96,s96,s94
s_min_u32 s71,s71,s96
s_sub_u32 s72,s72,1
s_cmp_gt_u32 s72,0
s_cbranch_scc1 mlp_15
s_cmp_gt_u32 s71,s70
s_cselect_b32 s65,2,1
pub_14:
s_mov_b32 s92,s2
s_and_b32 s93,s3,0xffff
s_mov_b32 s94,0x100
s_mov_b32 s95,0x20000
v_mov_b32 v16,s65
s_add_u32 s64,s88,20
buffer_store_dword v16,off,s[92:95],s64 sc1
s_mov_b64 exec,-1
nomeas_13:
s_barrier
s_sub_u32 s59,s58,192
s_and_b32 s52,s59,15
s_lshr_b32 s53,s59,4
s_lshl_b32 s64,s50,6
v_add_u32 v14,s64,v1
v_lshrrev_b32 v2,4,v14
v_and_b32 v3,15,v14
v_mul_u32_u24 v13,196608,v2
v_lshl_add_u32 v13,v3,4,v13
s_mul_i32 s54,s53,3145728
s_lshl_b32 s64,s52,9
s_add_u32 s54,s54,s64
s_add_u32 s54,s54,4096
v_lshlrev_b32 v15,1,v14
s_lshl_b32 s55,s53,9
s_mov_b32 s60,0
s_mov_b32 s73,0xffff0000
s_sub_u32 s61,s58,128
s_lshl_b32 s61,s61,15
v_lshlrev_b32 v25,6,v2
v_lshlrev_b32 v24,4,v1
v_and_b32 v2,3,v1
v_lshrrev_b32 v3,2,v1
s_lshl_b32 s64,s60,2
v_add_u32 v4,s64,v2
s_lshl_b32 s65,s50,9
v_lshlrev_b32 v5,4,v3
v_add_u32 v5,s65,v5
v_lshl_add_u32 v8,v4,11,v5
v_lshlrev_b32 v9,1,v5
v_lshrrev_b32 v5,2,v3
v_and_b32 v3,3,v3
s_lshl_b32 s65,s50,13
v_lshlrev_b32 v5,10,v5
v_lshl_add_u32 v5,v3,8,v5
v_lshl_add_u32 v5,v4,4,v5
v_add_u32 v10,s65,v5
s_lshl_b32 s65,s50,9
v_lshlrev_b32 v5,3,v1
v_add_u32 v11,s65,v5
v_lshlrev_b32 v12,3,v2
s_waitcnt lgkmcnt(0)
s_mov_b32 s24,s4
s_and_b32 s25,s5,0xffff
s_mov_b32 s26,0x800
s_mov_b32 s27,0x20000
s_mov_b32 s28,s6
s_and_b32 s29,s7,0xffff
s_mov_b32 s30,0xc00000
s_mov_b32 s31,0x20000
s_mov_b32 s32,s8
s_and_b32 s33,s9,0xffff
s_mov_b32 s34,0x400000
s_mov_b32 s35,0x20000
v_mov_b32 v28,-1
v_mov_b32 v20,0
v_mov_b32 v29,-1
v_mov_b32 v21,0
v_mov_b32 v30,-1
v_mov_b32 v22,0
v_mov_b32 v31,-1
v_mov_b32 v23,0
s_load_dwordx8 s[36:43],s[0:1],16
s_cmp_eq_u32 s58,220
s_cbranch_scc1 npf_16
s_lshl_b32 s64,s59,2
s_add_u32 s64,s64,s50
v_lshlrev_b32 v16,10,v1
v_lshlrev_b32 v17,7,v1
s_waitcnt lgkmcnt(0)
s_mov_b32 s68,s36
s_and_b32 s69,s37,0xffff
s_mov_b32 s70,0x800000
s_mov_b32 s71,0x20000
s_mov_b32 s72,s38
s_and_b32 s73,s39,0xffff
s_mov_b32 s74,0x800000
s_mov_b32 s75,0x20000
s_mov_b32 s76,s40
s_and_b32 s77,s41,0xffff
s_mov_b32 s78,0x800000
s_mov_b32 s79,0x20000
s_mov_b32 s92,s42
s_and_b32 s93,s43,0xffff
s_mov_b32 s94,0x800000
s_mov_b32 s95,0x20000
s_and_b32 s65,s64,127
s_lshl_b32 s65,s65,16
s_add_u32 s65,s65,384
s_cmp_ge_u32 s64,128
s_cselect_b64 s[44:45],s[72:73],s[68:69]
s_cselect_b64 s[46:47],s[74:75],s[70:71]
buffer_load_dword v26,v16,s[44:47],s65 offen
s_cselect_b64 s[44:45],s[92:93],s[76:77]
buffer_load_dword v26,v16,s[44:47],s65 offen
v_lshlrev_b32 v19,13,v1
s_and_b32 s65,s64,15
s_lshl_b32 s65,s65,19
s_add_u32 s65,s65,8064
s_cmp_ge_u32 s64,16
s_cselect_b64 s[44:45],s[72:73],s[68:69]
s_cmp_ge_u32 s64,32
s_cselect_b64 s[44:45],s[76:77],s[44:45]
s_cmp_ge_u32 s64,48
s_cselect_b32 s65,2.0,s65
buffer_load_dword v26,v19,s[44:47],s65 offen
s_lshl_b32 s65,s64,13
npf_16:
s_mov_b32 s73,0xffff0000
s_cmp_eq_u32 s58,220
s_cbranch_scc1 fl2_18
s_mov_b32 s62,s59
fl1_17:
s_lshl_b32 s64,s62,2
s_add_u32 s64,s64,s50
s_mul_i32 s64,s64,2048
s_add_u32 s64,s64,142606336
buffer_store_dwordx4 v[28:31],v24,s[20:23],s64 offen offset:0 sc1
buffer_store_dwordx4 v[28:31],v24,s[20:23],s64 offen offset:1024 sc1
s_lshl_b32 s64,s62,2
s_add_u32 s64,s64,s50
s_lshr_b32 s65,s64,6
s_lshl_b32 s65,s65,19
s_and_b32 s64,s64,63
s_mul_i32 s64,s64,2048
s_add_u32 s64,s64,134217728
s_add_u32 s64,s64,s65
buffer_store_dwordx4 v[28:31],v24,s[20:23],s64 offen offset:0 sc1
buffer_store_dwordx4 v[28:31],v24,s[20:23],s64 offen offset:1024 sc1
s_lshl_b32 s64,s62,2
s_add_u32 s64,s64,s50
s_lshr_b32 s65,s64,6
s_lshl_b32 s65,s65,19
s_and_b32 s64,s64,63
s_mul_i32 s64,s64,4096
s_add_u32 s64,s64,134479872
s_add_u32 s64,s64,s65
buffer_store_dwordx4 v[28:31],v24,s[20:23],s64 offen offset:0 sc1
buffer_store_dwordx4 v[28:31],v24,s[20:23],s64 offen offset:1024 sc1
buffer_store_dwordx4 v[28:31],v24,s[20:23],s64 offen offset:2048 sc1
buffer_store_dwordx4 v[28:31],v24,s[20:23],s64 offen offset:3072 sc1
s_lshl_b32 s64,s62,2
s_add_u32 s64,s64,s50
s_mul_i32 s64,s64,1024
s_add_u32 s64,s64,138412032
buffer_store_dwordx4 v[20:23],v24,s[20:23],s64 offen offset:0 sc1
s_cmp_eq_u32 s62,29
s_mov_b32 s62,28
s_cbranch_scc1 fl1_17
fl2_18:
s_waitcnt vmcnt(0)
s_barrier
s_cmp_lg_u32 s50,0
s_cbranch_scc1 sig_19
s_mov_b32 s92,s2
s_and_b32 s93,s3,0xffff
s_mov_b32 s94,0x100
s_mov_b32 s95,0x20000
s_add_u32 s64,s88,24
s_add_u32 s65,s88,32
s_cmp_eq_u32 s58,220
s_cselect_b32 s64,s65,s64
v_mov_b32 v16,1
s_mov_b64 exec,1
buffer_atomic_add v16,off,s[92:95],s64 sc1
s_mov_b64 exec,-1
sig_19:
s_mov_b32 s92,s2
s_and_b32 s93,s3,0xffff
s_mov_b32 s94,0x100
s_mov_b32 s95,0x20000
v_mbcnt_lo_u32_b32 v16,-1,0
v_mbcnt_hi_u32_b32 v16,-1,v16
v_mov_b32 v18,0
v_and_b32 v19,1,v16
v_cmp_eq_u32 vcc,1,v19
v_mov_b32 v19,8192
s_nop 0
v_cndmask_b32 v19,-1,v19,vcc
v_min_u32 v16,31,v16
v_lshlrev_b32 v16,2,v16
s_sub_u32 s66,s88,64
s_cmp_lg_u32 s50,0
s_cbranch_scc1 vot_24
s_mov_b32 s64,13
pre_26:
s_sleep 32
s_sub_u32 s64,s64,1
s_cmp_gt_i32 s64,0
s_cbranch_scc1 pre_26
vpoll_20:
buffer_load_dword v17,v16,s[92:95],s66 offen sc1
s_waitcnt vmcnt(0)
s_cmp_lg_u32 s56,2
s_cbranch_scc1 vck_21
v_cmp_eq_u32 vcc,v17,v19
s_and_b32 s64,vcc_lo,0xffff
s_cmp_eq_u32 s64,65535
s_cbranch_scc1 vck_21
s_mov_b32 s65,0
v_readlane_b32 s64,v17,1
s_lshr_b32 s64,s64,8
s_add_u32 s65,s65,s64
v_readlane_b32 s64,v17,3
s_lshr_b32 s64,s64,8
s_add_u32 s65,s65,s64
v_readlane_b32 s64,v17,5
s_lshr_b32 s64,s64,8
s_add_u32 s65,s65,s64
v_readlane_b32 s64,v17,7
s_lshr_b32 s64,s64,8
s_add_u32 s65,s65,s64
v_readlane_b32 s64,v17,9
s_lshr_b32 s64,s64,8
s_add_u32 s65,s65,s64
v_readlane_b32 s64,v17,11
s_lshr_b32 s64,s64,8
s_add_u32 s65,s65,s64
v_readlane_b32 s64,v17,13
s_lshr_b32 s64,s64,8
s_add_u32 s65,s65,s64
v_readlane_b32 s64,v17,15
s_lshr_b32 s64,s64,8
s_add_u32 s65,s65,s64
s_cmp_ge_u32 s65,256
s_cbranch_scc1 vok_23
s_branch vrt_22
vck_21:
v_cmp_gt_u32 vcc,v18,v17
s_cbranch_vccz vok_23
vrt_22:
s_sleep 48
s_sub_u32 s90,s90,1
s_cmp_gt_i32 s90,0
s_cbranch_scc1 vpoll_20
vok_23:
v_add_u32 v18,160256,v16
ds_write_b32 v18,v17
s_waitcnt lgkmcnt(0)
vot_24:
s_barrier
v_add_u32 v18,160256,v16
ds_read_b32 v17,v18
s_waitcnt lgkmcnt(0)
s_cmp_lg_u32 s56,2
s_cbranch_scc1 vfin_25
v_cmp_eq_u32 vcc,v17,v19
s_and_b32 s64,vcc_lo,0xffff
s_cmp_eq_u32 s64,65535
s_cbranch_scc1 vfin_25
s_mov_b32 s65,0
v_readlane_b32 s64,v17,1
s_lshr_b32 s64,s64,8
s_add_u32 s65,s65,s64
v_readlane_b32 s64,v17,3
s_lshr_b32 s64,s64,8
s_add_u32 s65,s65,s64
v_readlane_b32 s64,v17,5
s_lshr_b32 s64,s64,8
s_add_u32 s65,s65,s64
v_readlane_b32 s64,v17,7
s_lshr_b32 s64,s64,8
s_add_u32 s65,s65,s64
v_readlane_b32 s64,v17,9
s_lshr_b32 s64,s64,8
s_add_u32 s65,s65,s64
v_readlane_b32 s64,v17,11
s_lshr_b32 s64,s64,8
s_add_u32 s65,s65,s64
v_readlane_b32 s64,v17,13
s_lshr_b32 s64,s64,8
s_add_u32 s65,s65,s64
v_readlane_b32 s64,v17,15
s_lshr_b32 s64,s64,8
s_add_u32 s65,s65,s64
s_cmp_ge_u32 s65,256
s_cbranch_scc1 fl_fb
vfin_25:
s_and_b32 s56,s56,1
buffer_load_ushort v16,v15,s[24:27],s55 offen
buffer_load_dwordx4 v[96:99],v13,s[28:31],s54 offen offset:0
buffer_load_dwordx4 v[160:163],v13,s[28:31],s54 offen offset:256
s_add_u32 s54,s54,12288
s_waitcnt vmcnt(2)
buffer_load_dwordx4 v[100:103],v13,s[28:31],s54 offen offset:0
buffer_load_dwordx4 v[164:167],v13,s[28:31],s54 offen offset:256
s_add_u32 s54,s54,12288
s_waitcnt vmcnt(2)
buffer_load_dwordx4 v[104:107],v13,s[28:31],s54 offen offset:0
buffer_load_dwordx4 v[168:171],v13,s[28:31],s54 offen offset:256
s_add_u32 s54,s54,12288
s_waitcnt vmcnt(2)
buffer_load_dwordx4 v[108:111],v13,s[28:31],s54 offen offset:0
buffer_load_dwordx4 v[172:175],v13,s[28:31],s54 offen offset:256
s_add_u32 s54,s54,12288
s_waitcnt vmcnt(2)
buffer_load_dwordx4 v[112:115],v13,s[28:31],s54 offen offset:0
buffer_load_dwordx4 v[176:179],v13,s[28:31],s54 offen offset:256
s_add_u32 s54,s54,12288
s_waitcnt vmcnt(2)
buffer_load_dwordx4 v[116:119],v13,s[28:31],s54 offen offset:0
buffer_load_dwordx4 v[180:183],v13,s[28:31],s54 offen offset:256
s_add_u32 s54,s54,12288
s_waitcnt vmcnt(2)
buffer_load_dwordx4 v[120:123],v13,s[28:31],s54 offen offset:0
buffer_load_dwordx4 v[184:187],v13,s[28:31],s54 offen offset:256
s_add_u32 s54,s54,12288
s_waitcnt vmcnt(2)
buffer_load_dwordx4 v[124:127],v13,s[28:31],s54 offen offset:0
buffer_load_dwordx4 v[188:191],v13,s[28:31],s54 offen offset:256
s_add_u32 s54,s54,12288
s_waitcnt vmcnt(2)
buffer_load_dwordx4 v[128:131],v13,s[28:31],s54 offen offset:0
buffer_load_dwordx4 v[192:195],v13,s[28:31],s54 offen offset:256
s_add_u32 s54,s54,12288
s_waitcnt vmcnt(2)
buffer_load_dwordx4 v[132:135],v13,s[28:31],s54 offen offset:0
buffer_load_dwordx4 v[196:199],v13,s[28:31],s54 offen offset:256
s_add_u32 s54,s54,12288
s_waitcnt vmcnt(2)
buffer_load_dwordx4 v[136:139],v13,s[28:31],s54 offen offset:0
buffer_load_dwordx4 v[200:203],v13,s[28:31],s54 offen offset:256
s_add_u32 s54,s54,12288
s_waitcnt vmcnt(2)
buffer_load_dwordx4 v[140:143],v13,s[28:31],s54 offen offset:0
buffer_load_dwordx4 v[204:207],v13,s[28:31],s54 offen offset:256
s_add_u32 s54,s54,12288
s_waitcnt vmcnt(2)
buffer_load_dwordx4 v[144:147],v13,s[28:31],s54 offen offset:0
buffer_load_dwordx4 v[208:211],v13,s[28:31],s54 offen offset:256
s_add_u32 s54,s54,12288
s_waitcnt vmcnt(2)
buffer_load_dwordx4 v[148:151],v13,s[28:31],s54 offen offset:0
buffer_load_dwordx4 v[212:215],v13,s[28:31],s54 offen offset:256
s_add_u32 s54,s54,12288
s_waitcnt vmcnt(2)
buffer_load_dwordx4 v[152:155],v13,s[28:31],s54 offen offset:0
buffer_load_dwordx4 v[216:219],v13,s[28:31],s54 offen offset:256
s_add_u32 s54,s54,12288
s_waitcnt vmcnt(2)
buffer_load_dwordx4 v[156:159],v13,s[28:31],s54 offen offset:0
buffer_load_dwordx4 v[220:223],v13,s[28:31],s54 offen offset:256
s_waitcnt vmcnt(2)
s_add_u32 s64,s61,0
buffer_load_dwordx4 v[48:51],v8,s[32:35],s64 offen offset:0
buffer_load_dwordx4 v[52:55],v8,s[32:35],s64 offen offset:256
s_add_u32 s64,s61,8192
buffer_load_dwordx4 v[56:59],v8,s[32:35],s64 offen offset:0
buffer_load_dwordx4 v[60:63],v8,s[32:35],s64 offen offset:256
s_add_u32 s64,s61,16384
buffer_load_dwordx4 v[64:67],v8,s[32:35],s64 offen offset:0
buffer_load_dwordx4 v[68:71],v8,s[32:35],s64 offen offset:256
s_add_u32 s64,s61,24576
buffer_load_dwordx4 v[72:75],v8,s[32:35],s64 offen offset:0
buffer_load_dwordx4 v[76:79],v8,s[32:35],s64 offen offset:256
s_waitcnt vmcnt(40)
v_lshlrev_b32 v16,16,v16
v_mul_f32 v17,0xbfb8aa3b,v16
v_exp_f32 v17,v17
s_nop 0
v_add_f32 v17,1.0,v17
v_rcp_f32 v17,v17
s_nop 0
v_mul_f32 v17,v17,v16
v_cvt_pk_bf16_f32 v17,v17,v17
v_and_b32 v17,s73,v17
v_lshlrev_b32 v18,2,v14
ds_write_b32 v18,v17 offset:8192
s_waitcnt lgkmcnt(0)
s_barrier
ds_read_b128 v[32:35],v25 offset:8192
ds_read_b128 v[36:39],v25 offset:8208
ds_read_b128 v[40:43],v25 offset:8224
ds_read_b128 v[44:47],v25 offset:8240
v_mov_b32 v80,0
v_mov_b32 v81,0
v_mov_b32 v82,0
v_mov_b32 v83,0
v_mov_b32 v84,0
v_mov_b32 v85,0
v_mov_b32 v86,0
v_mov_b32 v87,0
v_mov_b32 v88,0
v_mov_b32 v89,0
v_mov_b32 v90,0
v_mov_b32 v91,0
v_mov_b32 v92,0
v_mov_b32 v93,0
v_mov_b32 v94,0
v_mov_b32 v95,0
s_waitcnt lgkmcnt(0)
s_waitcnt vmcnt(39)
v_lshlrev_b32 v16,16,v96
v_and_b32 v17,s73,v96
v_pk_fma_f32 v[80:81],v[16:17],v[32:33],v[80:81] op_sel:[0,0,0] op_sel_hi:[1,0,1]
v_lshlrev_b32 v18,16,v97
v_and_b32 v19,s73,v97
v_pk_fma_f32 v[82:83],v[18:19],v[32:33],v[82:83] op_sel:[0,0,0] op_sel_hi:[1,0,1]
v_lshlrev_b32 v16,16,v98
v_and_b32 v17,s73,v98
v_pk_fma_f32 v[84:85],v[16:17],v[32:33],v[84:85] op_sel:[0,0,0] op_sel_hi:[1,0,1]
v_lshlrev_b32 v18,16,v99
v_and_b32 v19,s73,v99
v_pk_fma_f32 v[86:87],v[18:19],v[32:33],v[86:87] op_sel:[0,0,0] op_sel_hi:[1,0,1]
s_waitcnt vmcnt(38)
v_lshlrev_b32 v16,16,v160
v_and_b32 v17,s73,v160
v_pk_fma_f32 v[88:89],v[16:17],v[32:33],v[88:89] op_sel:[0,0,0] op_sel_hi:[1,0,1]
v_lshlrev_b32 v18,16,v161
v_and_b32 v19,s73,v161
v_pk_fma_f32 v[90:91],v[18:19],v[32:33],v[90:91] op_sel:[0,0,0] op_sel_hi:[1,0,1]
v_lshlrev_b32 v16,16,v162
v_and_b32 v17,s73,v162
v_pk_fma_f32 v[92:93],v[16:17],v[32:33],v[92:93] op_sel:[0,0,0] op_sel_hi:[1,0,1]
v_lshlrev_b32 v18,16,v163
v_and_b32 v19,s73,v163
v_pk_fma_f32 v[94:95],v[18:19],v[32:33],v[94:95] op_sel:[0,0,0] op_sel_hi:[1,0,1]
s_waitcnt vmcnt(37)
v_lshlrev_b32 v16,16,v100
v_and_b32 v17,s73,v100
v_pk_fma_f32 v[80:81],v[16:17],v[32:33],v[80:81] op_sel:[0,1,0] op_sel_hi:[1,1,1]
v_lshlrev_b32 v18,16,v101
v_and_b32 v19,s73,v101
v_pk_fma_f32 v[82:83],v[18:19],v[32:33],v[82:83] op_sel:[0,1,0] op_sel_hi:[1,1,1]
v_lshlrev_b32 v16,16,v102
v_and_b32 v17,s73,v102
v_pk_fma_f32 v[84:85],v[16:17],v[32:33],v[84:85] op_sel:[0,1,0] op_sel_hi:[1,1,1]
v_lshlrev_b32 v18,16,v103
v_and_b32 v19,s73,v103
v_pk_fma_f32 v[86:87],v[18:19],v[32:33],v[86:87] op_sel:[0,1,0] op_sel_hi:[1,1,1]
s_waitcnt vmcnt(36)
v_lshlrev_b32 v16,16,v164
v_and_b32 v17,s73,v164
v_pk_fma_f32 v[88:89],v[16:17],v[32:33],v[88:89] op_sel:[0,1,0] op_sel_hi:[1,1,1]
v_lshlrev_b32 v18,16,v165
v_and_b32 v19,s73,v165
v_pk_fma_f32 v[90:91],v[18:19],v[32:33],v[90:91] op_sel:[0,1,0] op_sel_hi:[1,1,1]
v_lshlrev_b32 v16,16,v166
v_and_b32 v17,s73,v166
v_pk_fma_f32 v[92:93],v[16:17],v[32:33],v[92:93] op_sel:[0,1,0] op_sel_hi:[1,1,1]
v_lshlrev_b32 v18,16,v167
v_and_b32 v19,s73,v167
v_pk_fma_f32 v[94:95],v[18:19],v[32:33],v[94:95] op_sel:[0,1,0] op_sel_hi:[1,1,1]
s_waitcnt vmcnt(35)
v_lshlrev_b32 v16,16,v104
v_and_b32 v17,s73,v104
v_pk_fma_f32 v[80:81],v[16:17],v[34:35],v[80:81] op_sel:[0,0,0] op_sel_hi:[1,0,1]
v_lshlrev_b32 v18,16,v105
v_and_b32 v19,s73,v105
v_pk_fma_f32 v[82:83],v[18:19],v[34:35],v[82:83] op_sel:[0,0,0] op_sel_hi:[1,0,1]
v_lshlrev_b32 v16,16,v106
v_and_b32 v17,s73,v106
v_pk_fma_f32 v[84:85],v[16:17],v[34:35],v[84:85] op_sel:[0,0,0] op_sel_hi:[1,0,1]
v_lshlrev_b32 v18,16,v107
v_and_b32 v19,s73,v107
v_pk_fma_f32 v[86:87],v[18:19],v[34:35],v[86:87] op_sel:[0,0,0] op_sel_hi:[1,0,1]
s_waitcnt vmcnt(34)
v_lshlrev_b32 v16,16,v168
v_and_b32 v17,s73,v168
v_pk_fma_f32 v[88:89],v[16:17],v[34:35],v[88:89] op_sel:[0,0,0] op_sel_hi:[1,0,1]
v_lshlrev_b32 v18,16,v169
v_and_b32 v19,s73,v169
v_pk_fma_f32 v[90:91],v[18:19],v[34:35],v[90:91] op_sel:[0,0,0] op_sel_hi:[1,0,1]
v_lshlrev_b32 v16,16,v170
v_and_b32 v17,s73,v170
v_pk_fma_f32 v[92:93],v[16:17],v[34:35],v[92:93] op_sel:[0,0,0] op_sel_hi:[1,0,1]
v_lshlrev_b32 v18,16,v171
v_and_b32 v19,s73,v171
v_pk_fma_f32 v[94:95],v[18:19],v[34:35],v[94:95] op_sel:[0,0,0] op_sel_hi:[1,0,1]
s_waitcnt vmcnt(33)
v_lshlrev_b32 v16,16,v108
v_and_b32 v17,s73,v108
v_pk_fma_f32 v[80:81],v[16:17],v[34:35],v[80:81] op_sel:[0,1,0] op_sel_hi:[1,1,1]
v_lshlrev_b32 v18,16,v109
v_and_b32 v19,s73,v109
v_pk_fma_f32 v[82:83],v[18:19],v[34:35],v[82:83] op_sel:[0,1,0] op_sel_hi:[1,1,1]
v_lshlrev_b32 v16,16,v110
v_and_b32 v17,s73,v110
v_pk_fma_f32 v[84:85],v[16:17],v[34:35],v[84:85] op_sel:[0,1,0] op_sel_hi:[1,1,1]
v_lshlrev_b32 v18,16,v111
v_and_b32 v19,s73,v111
v_pk_fma_f32 v[86:87],v[18:19],v[34:35],v[86:87] op_sel:[0,1,0] op_sel_hi:[1,1,1]
s_waitcnt vmcnt(32)
v_lshlrev_b32 v16,16,v172
v_and_b32 v17,s73,v172
v_pk_fma_f32 v[88:89],v[16:17],v[34:35],v[88:89] op_sel:[0,1,0] op_sel_hi:[1,1,1]
v_lshlrev_b32 v18,16,v173
v_and_b32 v19,s73,v173
v_pk_fma_f32 v[90:91],v[18:19],v[34:35],v[90:91] op_sel:[0,1,0] op_sel_hi:[1,1,1]
v_lshlrev_b32 v16,16,v174
v_and_b32 v17,s73,v174
v_pk_fma_f32 v[92:93],v[16:17],v[34:35],v[92:93] op_sel:[0,1,0] op_sel_hi:[1,1,1]
v_lshlrev_b32 v18,16,v175
v_and_b32 v19,s73,v175
v_pk_fma_f32 v[94:95],v[18:19],v[34:35],v[94:95] op_sel:[0,1,0] op_sel_hi:[1,1,1]
s_waitcnt vmcnt(31)
v_lshlrev_b32 v16,16,v112
v_and_b32 v17,s73,v112
v_pk_fma_f32 v[80:81],v[16:17],v[36:37],v[80:81] op_sel:[0,0,0] op_sel_hi:[1,0,1]
v_lshlrev_b32 v18,16,v113
v_and_b32 v19,s73,v113
v_pk_fma_f32 v[82:83],v[18:19],v[36:37],v[82:83] op_sel:[0,0,0] op_sel_hi:[1,0,1]
v_lshlrev_b32 v16,16,v114
v_and_b32 v17,s73,v114
v_pk_fma_f32 v[84:85],v[16:17],v[36:37],v[84:85] op_sel:[0,0,0] op_sel_hi:[1,0,1]
v_lshlrev_b32 v18,16,v115
v_and_b32 v19,s73,v115
v_pk_fma_f32 v[86:87],v[18:19],v[36:37],v[86:87] op_sel:[0,0,0] op_sel_hi:[1,0,1]
s_waitcnt vmcnt(30)
v_lshlrev_b32 v16,16,v176
v_and_b32 v17,s73,v176
v_pk_fma_f32 v[88:89],v[16:17],v[36:37],v[88:89] op_sel:[0,0,0] op_sel_hi:[1,0,1]
v_lshlrev_b32 v18,16,v177
v_and_b32 v19,s73,v177
v_pk_fma_f32 v[90:91],v[18:19],v[36:37],v[90:91] op_sel:[0,0,0] op_sel_hi:[1,0,1]
v_lshlrev_b32 v16,16,v178
v_and_b32 v17,s73,v178
v_pk_fma_f32 v[92:93],v[16:17],v[36:37],v[92:93] op_sel:[0,0,0] op_sel_hi:[1,0,1]
v_lshlrev_b32 v18,16,v179
v_and_b32 v19,s73,v179
v_pk_fma_f32 v[94:95],v[18:19],v[36:37],v[94:95] op_sel:[0,0,0] op_sel_hi:[1,0,1]
s_waitcnt vmcnt(29)
v_lshlrev_b32 v16,16,v116
v_and_b32 v17,s73,v116
v_pk_fma_f32 v[80:81],v[16:17],v[36:37],v[80:81] op_sel:[0,1,0] op_sel_hi:[1,1,1]
v_lshlrev_b32 v18,16,v117
v_and_b32 v19,s73,v117
v_pk_fma_f32 v[82:83],v[18:19],v[36:37],v[82:83] op_sel:[0,1,0] op_sel_hi:[1,1,1]
v_lshlrev_b32 v16,16,v118
v_and_b32 v17,s73,v118
v_pk_fma_f32 v[84:85],v[16:17],v[36:37],v[84:85] op_sel:[0,1,0] op_sel_hi:[1,1,1]
v_lshlrev_b32 v18,16,v119
v_and_b32 v19,s73,v119
v_pk_fma_f32 v[86:87],v[18:19],v[36:37],v[86:87] op_sel:[0,1,0] op_sel_hi:[1,1,1]
s_waitcnt vmcnt(28)
v_lshlrev_b32 v16,16,v180
v_and_b32 v17,s73,v180
v_pk_fma_f32 v[88:89],v[16:17],v[36:37],v[88:89] op_sel:[0,1,0] op_sel_hi:[1,1,1]
v_lshlrev_b32 v18,16,v181
v_and_b32 v19,s73,v181
v_pk_fma_f32 v[90:91],v[18:19],v[36:37],v[90:91] op_sel:[0,1,0] op_sel_hi:[1,1,1]
v_lshlrev_b32 v16,16,v182
v_and_b32 v17,s73,v182
v_pk_fma_f32 v[92:93],v[16:17],v[36:37],v[92:93] op_sel:[0,1,0] op_sel_hi:[1,1,1]
v_lshlrev_b32 v18,16,v183
v_and_b32 v19,s73,v183
v_pk_fma_f32 v[94:95],v[18:19],v[36:37],v[94:95] op_sel:[0,1,0] op_sel_hi:[1,1,1]
s_waitcnt vmcnt(27)
v_lshlrev_b32 v16,16,v120
v_and_b32 v17,s73,v120
v_pk_fma_f32 v[80:81],v[16:17],v[38:39],v[80:81] op_sel:[0,0,0] op_sel_hi:[1,0,1]
v_lshlrev_b32 v18,16,v121
v_and_b32 v19,s73,v121
v_pk_fma_f32 v[82:83],v[18:19],v[38:39],v[82:83] op_sel:[0,0,0] op_sel_hi:[1,0,1]
v_lshlrev_b32 v16,16,v122
v_and_b32 v17,s73,v122
v_pk_fma_f32 v[84:85],v[16:17],v[38:39],v[84:85] op_sel:[0,0,0] op_sel_hi:[1,0,1]
v_lshlrev_b32 v18,16,v123
v_and_b32 v19,s73,v123
v_pk_fma_f32 v[86:87],v[18:19],v[38:39],v[86:87] op_sel:[0,0,0] op_sel_hi:[1,0,1]
s_waitcnt vmcnt(26)
v_lshlrev_b32 v16,16,v184
v_and_b32 v17,s73,v184
v_pk_fma_f32 v[88:89],v[16:17],v[38:39],v[88:89] op_sel:[0,0,0] op_sel_hi:[1,0,1]
v_lshlrev_b32 v18,16,v185
v_and_b32 v19,s73,v185
v_pk_fma_f32 v[90:91],v[18:19],v[38:39],v[90:91] op_sel:[0,0,0] op_sel_hi:[1,0,1]
v_lshlrev_b32 v16,16,v186
v_and_b32 v17,s73,v186
v_pk_fma_f32 v[92:93],v[16:17],v[38:39],v[92:93] op_sel:[0,0,0] op_sel_hi:[1,0,1]
v_lshlrev_b32 v18,16,v187
v_and_b32 v19,s73,v187
v_pk_fma_f32 v[94:95],v[18:19],v[38:39],v[94:95] op_sel:[0,0,0] op_sel_hi:[1,0,1]
s_waitcnt vmcnt(25)
v_lshlrev_b32 v16,16,v124
v_and_b32 v17,s73,v124
v_pk_fma_f32 v[80:81],v[16:17],v[38:39],v[80:81] op_sel:[0,1,0] op_sel_hi:[1,1,1]
v_lshlrev_b32 v18,16,v125
v_and_b32 v19,s73,v125
v_pk_fma_f32 v[82:83],v[18:19],v[38:39],v[82:83] op_sel:[0,1,0] op_sel_hi:[1,1,1]
v_lshlrev_b32 v16,16,v126
v_and_b32 v17,s73,v126
v_pk_fma_f32 v[84:85],v[16:17],v[38:39],v[84:85] op_sel:[0,1,0] op_sel_hi:[1,1,1]
v_lshlrev_b32 v18,16,v127
v_and_b32 v19,s73,v127
v_pk_fma_f32 v[86:87],v[18:19],v[38:39],v[86:87] op_sel:[0,1,0] op_sel_hi:[1,1,1]
s_waitcnt vmcnt(24)
v_lshlrev_b32 v16,16,v188
v_and_b32 v17,s73,v188
v_pk_fma_f32 v[88:89],v[16:17],v[38:39],v[88:89] op_sel:[0,1,0] op_sel_hi:[1,1,1]
v_lshlrev_b32 v18,16,v189
v_and_b32 v19,s73,v189
v_pk_fma_f32 v[90:91],v[18:19],v[38:39],v[90:91] op_sel:[0,1,0] op_sel_hi:[1,1,1]
v_lshlrev_b32 v16,16,v190
v_and_b32 v17,s73,v190
v_pk_fma_f32 v[92:93],v[16:17],v[38:39],v[92:93] op_sel:[0,1,0] op_sel_hi:[1,1,1]
v_lshlrev_b32 v18,16,v191
v_and_b32 v19,s73,v191
v_pk_fma_f32 v[94:95],v[18:19],v[38:39],v[94:95] op_sel:[0,1,0] op_sel_hi:[1,1,1]
s_waitcnt vmcnt(23)
v_lshlrev_b32 v16,16,v128
v_and_b32 v17,s73,v128
v_pk_fma_f32 v[80:81],v[16:17],v[40:41],v[80:81] op_sel:[0,0,0] op_sel_hi:[1,0,1]
v_lshlrev_b32 v18,16,v129
v_and_b32 v19,s73,v129
v_pk_fma_f32 v[82:83],v[18:19],v[40:41],v[82:83] op_sel:[0,0,0] op_sel_hi:[1,0,1]
v_lshlrev_b32 v16,16,v130
v_and_b32 v17,s73,v130
v_pk_fma_f32 v[84:85],v[16:17],v[40:41],v[84:85] op_sel:[0,0,0] op_sel_hi:[1,0,1]
v_lshlrev_b32 v18,16,v131
v_and_b32 v19,s73,v131
v_pk_fma_f32 v[86:87],v[18:19],v[40:41],v[86:87] op_sel:[0,0,0] op_sel_hi:[1,0,1]
s_waitcnt vmcnt(22)
v_lshlrev_b32 v16,16,v192
v_and_b32 v17,s73,v192
v_pk_fma_f32 v[88:89],v[16:17],v[40:41],v[88:89] op_sel:[0,0,0] op_sel_hi:[1,0,1]
v_lshlrev_b32 v18,16,v193
v_and_b32 v19,s73,v193
v_pk_fma_f32 v[90:91],v[18:19],v[40:41],v[90:91] op_sel:[0,0,0] op_sel_hi:[1,0,1]
v_lshlrev_b32 v16,16,v194
v_and_b32 v17,s73,v194
v_pk_fma_f32 v[92:93],v[16:17],v[40:41],v[92:93] op_sel:[0,0,0] op_sel_hi:[1,0,1]
v_lshlrev_b32 v18,16,v195
v_and_b32 v19,s73,v195
v_pk_fma_f32 v[94:95],v[18:19],v[40:41],v[94:95] op_sel:[0,0,0] op_sel_hi:[1,0,1]
s_waitcnt vmcnt(21)
v_lshlrev_b32 v16,16,v132
v_and_b32 v17,s73,v132
v_pk_fma_f32 v[80:81],v[16:17],v[40:41],v[80:81] op_sel:[0,1,0] op_sel_hi:[1,1,1]
v_lshlrev_b32 v18,16,v133
v_and_b32 v19,s73,v133
v_pk_fma_f32 v[82:83],v[18:19],v[40:41],v[82:83] op_sel:[0,1,0] op_sel_hi:[1,1,1]
v_lshlrev_b32 v16,16,v134
v_and_b32 v17,s73,v134
v_pk_fma_f32 v[84:85],v[16:17],v[40:41],v[84:85] op_sel:[0,1,0] op_sel_hi:[1,1,1]
v_lshlrev_b32 v18,16,v135
v_and_b32 v19,s73,v135
v_pk_fma_f32 v[86:87],v[18:19],v[40:41],v[86:87] op_sel:[0,1,0] op_sel_hi:[1,1,1]
s_waitcnt vmcnt(20)
v_lshlrev_b32 v16,16,v196
v_and_b32 v17,s73,v196
v_pk_fma_f32 v[88:89],v[16:17],v[40:41],v[88:89] op_sel:[0,1,0] op_sel_hi:[1,1,1]
v_lshlrev_b32 v18,16,v197
v_and_b32 v19,s73,v197
v_pk_fma_f32 v[90:91],v[18:19],v[40:41],v[90:91] op_sel:[0,1,0] op_sel_hi:[1,1,1]
v_lshlrev_b32 v16,16,v198
v_and_b32 v17,s73,v198
v_pk_fma_f32 v[92:93],v[16:17],v[40:41],v[92:93] op_sel:[0,1,0] op_sel_hi:[1,1,1]
v_lshlrev_b32 v18,16,v199
v_and_b32 v19,s73,v199
v_pk_fma_f32 v[94:95],v[18:19],v[40:41],v[94:95] op_sel:[0,1,0] op_sel_hi:[1,1,1]
s_waitcnt vmcnt(19)
v_lshlrev_b32 v16,16,v136
v_and_b32 v17,s73,v136
v_pk_fma_f32 v[80:81],v[16:17],v[42:43],v[80:81] op_sel:[0,0,0] op_sel_hi:[1,0,1]
v_lshlrev_b32 v18,16,v137
v_and_b32 v19,s73,v137
v_pk_fma_f32 v[82:83],v[18:19],v[42:43],v[82:83] op_sel:[0,0,0] op_sel_hi:[1,0,1]
v_lshlrev_b32 v16,16,v138
v_and_b32 v17,s73,v138
v_pk_fma_f32 v[84:85],v[16:17],v[42:43],v[84:85] op_sel:[0,0,0] op_sel_hi:[1,0,1]
v_lshlrev_b32 v18,16,v139
v_and_b32 v19,s73,v139
v_pk_fma_f32 v[86:87],v[18:19],v[42:43],v[86:87] op_sel:[0,0,0] op_sel_hi:[1,0,1]
s_waitcnt vmcnt(18)
v_lshlrev_b32 v16,16,v200
v_and_b32 v17,s73,v200
v_pk_fma_f32 v[88:89],v[16:17],v[42:43],v[88:89] op_sel:[0,0,0] op_sel_hi:[1,0,1]
v_lshlrev_b32 v18,16,v201
v_and_b32 v19,s73,v201
v_pk_fma_f32 v[90:91],v[18:19],v[42:43],v[90:91] op_sel:[0,0,0] op_sel_hi:[1,0,1]
v_lshlrev_b32 v16,16,v202
v_and_b32 v17,s73,v202
v_pk_fma_f32 v[92:93],v[16:17],v[42:43],v[92:93] op_sel:[0,0,0] op_sel_hi:[1,0,1]
v_lshlrev_b32 v18,16,v203
v_and_b32 v19,s73,v203
v_pk_fma_f32 v[94:95],v[18:19],v[42:43],v[94:95] op_sel:[0,0,0] op_sel_hi:[1,0,1]
s_waitcnt vmcnt(17)
v_lshlrev_b32 v16,16,v140
v_and_b32 v17,s73,v140
v_pk_fma_f32 v[80:81],v[16:17],v[42:43],v[80:81] op_sel:[0,1,0] op_sel_hi:[1,1,1]
v_lshlrev_b32 v18,16,v141
v_and_b32 v19,s73,v141
v_pk_fma_f32 v[82:83],v[18:19],v[42:43],v[82:83] op_sel:[0,1,0] op_sel_hi:[1,1,1]
v_lshlrev_b32 v16,16,v142
v_and_b32 v17,s73,v142
v_pk_fma_f32 v[84:85],v[16:17],v[42:43],v[84:85] op_sel:[0,1,0] op_sel_hi:[1,1,1]
v_lshlrev_b32 v18,16,v143
v_and_b32 v19,s73,v143
v_pk_fma_f32 v[86:87],v[18:19],v[42:43],v[86:87] op_sel:[0,1,0] op_sel_hi:[1,1,1]
s_waitcnt vmcnt(16)
v_lshlrev_b32 v16,16,v204
v_and_b32 v17,s73,v204
v_pk_fma_f32 v[88:89],v[16:17],v[42:43],v[88:89] op_sel:[0,1,0] op_sel_hi:[1,1,1]
v_lshlrev_b32 v18,16,v205
v_and_b32 v19,s73,v205
v_pk_fma_f32 v[90:91],v[18:19],v[42:43],v[90:91] op_sel:[0,1,0] op_sel_hi:[1,1,1]
v_lshlrev_b32 v16,16,v206
v_and_b32 v17,s73,v206
v_pk_fma_f32 v[92:93],v[16:17],v[42:43],v[92:93] op_sel:[0,1,0] op_sel_hi:[1,1,1]
v_lshlrev_b32 v18,16,v207
v_and_b32 v19,s73,v207
v_pk_fma_f32 v[94:95],v[18:19],v[42:43],v[94:95] op_sel:[0,1,0] op_sel_hi:[1,1,1]
s_waitcnt vmcnt(15)
v_lshlrev_b32 v16,16,v144
v_and_b32 v17,s73,v144
v_pk_fma_f32 v[80:81],v[16:17],v[44:45],v[80:81] op_sel:[0,0,0] op_sel_hi:[1,0,1]
v_lshlrev_b32 v18,16,v145
v_and_b32 v19,s73,v145
v_pk_fma_f32 v[82:83],v[18:19],v[44:45],v[82:83] op_sel:[0,0,0] op_sel_hi:[1,0,1]
v_lshlrev_b32 v16,16,v146
v_and_b32 v17,s73,v146
v_pk_fma_f32 v[84:85],v[16:17],v[44:45],v[84:85] op_sel:[0,0,0] op_sel_hi:[1,0,1]
v_lshlrev_b32 v18,16,v147
v_and_b32 v19,s73,v147
v_pk_fma_f32 v[86:87],v[18:19],v[44:45],v[86:87] op_sel:[0,0,0] op_sel_hi:[1,0,1]
s_waitcnt vmcnt(14)
v_lshlrev_b32 v16,16,v208
v_and_b32 v17,s73,v208
v_pk_fma_f32 v[88:89],v[16:17],v[44:45],v[88:89] op_sel:[0,0,0] op_sel_hi:[1,0,1]
v_lshlrev_b32 v18,16,v209
v_and_b32 v19,s73,v209
v_pk_fma_f32 v[90:91],v[18:19],v[44:45],v[90:91] op_sel:[0,0,0] op_sel_hi:[1,0,1]
v_lshlrev_b32 v16,16,v210
v_and_b32 v17,s73,v210
v_pk_fma_f32 v[92:93],v[16:17],v[44:45],v[92:93] op_sel:[0,0,0] op_sel_hi:[1,0,1]
v_lshlrev_b32 v18,16,v211
v_and_b32 v19,s73,v211
v_pk_fma_f32 v[94:95],v[18:19],v[44:45],v[94:95] op_sel:[0,0,0] op_sel_hi:[1,0,1]
s_waitcnt vmcnt(13)
v_lshlrev_b32 v16,16,v148
v_and_b32 v17,s73,v148
v_pk_fma_f32 v[80:81],v[16:17],v[44:45],v[80:81] op_sel:[0,1,0] op_sel_hi:[1,1,1]
v_lshlrev_b32 v18,16,v149
v_and_b32 v19,s73,v149
v_pk_fma_f32 v[82:83],v[18:19],v[44:45],v[82:83] op_sel:[0,1,0] op_sel_hi:[1,1,1]
v_lshlrev_b32 v16,16,v150
v_and_b32 v17,s73,v150
v_pk_fma_f32 v[84:85],v[16:17],v[44:45],v[84:85] op_sel:[0,1,0] op_sel_hi:[1,1,1]
v_lshlrev_b32 v18,16,v151
v_and_b32 v19,s73,v151
v_pk_fma_f32 v[86:87],v[18:19],v[44:45],v[86:87] op_sel:[0,1,0] op_sel_hi:[1,1,1]
s_waitcnt vmcnt(12)
v_lshlrev_b32 v16,16,v212
v_and_b32 v17,s73,v212
v_pk_fma_f32 v[88:89],v[16:17],v[44:45],v[88:89] op_sel:[0,1,0] op_sel_hi:[1,1,1]
v_lshlrev_b32 v18,16,v213
v_and_b32 v19,s73,v213
v_pk_fma_f32 v[90:91],v[18:19],v[44:45],v[90:91] op_sel:[0,1,0] op_sel_hi:[1,1,1]
v_lshlrev_b32 v16,16,v214
v_and_b32 v17,s73,v214
v_pk_fma_f32 v[92:93],v[16:17],v[44:45],v[92:93] op_sel:[0,1,0] op_sel_hi:[1,1,1]
v_lshlrev_b32 v18,16,v215
v_and_b32 v19,s73,v215
v_pk_fma_f32 v[94:95],v[18:19],v[44:45],v[94:95] op_sel:[0,1,0] op_sel_hi:[1,1,1]
s_waitcnt vmcnt(11)
v_lshlrev_b32 v16,16,v152
v_and_b32 v17,s73,v152
v_pk_fma_f32 v[80:81],v[16:17],v[46:47],v[80:81] op_sel:[0,0,0] op_sel_hi:[1,0,1]
v_lshlrev_b32 v18,16,v153
v_and_b32 v19,s73,v153
v_pk_fma_f32 v[82:83],v[18:19],v[46:47],v[82:83] op_sel:[0,0,0] op_sel_hi:[1,0,1]
v_lshlrev_b32 v16,16,v154
v_and_b32 v17,s73,v154
v_pk_fma_f32 v[84:85],v[16:17],v[46:47],v[84:85] op_sel:[0,0,0] op_sel_hi:[1,0,1]
v_lshlrev_b32 v18,16,v155
v_and_b32 v19,s73,v155
v_pk_fma_f32 v[86:87],v[18:19],v[46:47],v[86:87] op_sel:[0,0,0] op_sel_hi:[1,0,1]
s_waitcnt vmcnt(10)
v_lshlrev_b32 v16,16,v216
v_and_b32 v17,s73,v216
v_pk_fma_f32 v[88:89],v[16:17],v[46:47],v[88:89] op_sel:[0,0,0] op_sel_hi:[1,0,1]
v_lshlrev_b32 v18,16,v217
v_and_b32 v19,s73,v217
v_pk_fma_f32 v[90:91],v[18:19],v[46:47],v[90:91] op_sel:[0,0,0] op_sel_hi:[1,0,1]
v_lshlrev_b32 v16,16,v218
v_and_b32 v17,s73,v218
v_pk_fma_f32 v[92:93],v[16:17],v[46:47],v[92:93] op_sel:[0,0,0] op_sel_hi:[1,0,1]
v_lshlrev_b32 v18,16,v219
v_and_b32 v19,s73,v219
v_pk_fma_f32 v[94:95],v[18:19],v[46:47],v[94:95] op_sel:[0,0,0] op_sel_hi:[1,0,1]
s_waitcnt vmcnt(9)
v_lshlrev_b32 v16,16,v156
v_and_b32 v17,s73,v156
v_pk_fma_f32 v[80:81],v[16:17],v[46:47],v[80:81] op_sel:[0,1,0] op_sel_hi:[1,1,1]
v_lshlrev_b32 v18,16,v157
v_and_b32 v19,s73,v157
v_pk_fma_f32 v[82:83],v[18:19],v[46:47],v[82:83] op_sel:[0,1,0] op_sel_hi:[1,1,1]
v_lshlrev_b32 v16,16,v158
v_and_b32 v17,s73,v158
v_pk_fma_f32 v[84:85],v[16:17],v[46:47],v[84:85] op_sel:[0,1,0] op_sel_hi:[1,1,1]
v_lshlrev_b32 v18,16,v159
v_and_b32 v19,s73,v159
v_pk_fma_f32 v[86:87],v[18:19],v[46:47],v[86:87] op_sel:[0,1,0] op_sel_hi:[1,1,1]
s_waitcnt vmcnt(8)
v_lshlrev_b32 v16,16,v220
v_and_b32 v17,s73,v220
v_pk_fma_f32 v[88:89],v[16:17],v[46:47],v[88:89] op_sel:[0,1,0] op_sel_hi:[1,1,1]
v_lshlrev_b32 v18,16,v221
v_and_b32 v19,s73,v221
v_pk_fma_f32 v[90:91],v[18:19],v[46:47],v[90:91] op_sel:[0,1,0] op_sel_hi:[1,1,1]
v_lshlrev_b32 v16,16,v222
v_and_b32 v17,s73,v222
v_pk_fma_f32 v[92:93],v[16:17],v[46:47],v[92:93] op_sel:[0,1,0] op_sel_hi:[1,1,1]
v_lshlrev_b32 v18,16,v223
v_and_b32 v19,s73,v223
v_pk_fma_f32 v[94:95],v[18:19],v[46:47],v[94:95] op_sel:[0,1,0] op_sel_hi:[1,1,1]
v_lshlrev_b32 v18,5,v14
ds_write_b128 v18,v[80:83] offset:16384
ds_write_b128 v18,v[84:87] offset:16400
ds_write_b128 v18,v[88:91] offset:24576
ds_write_b128 v18,v[92:95] offset:24592
v_and_b32 v18,127,v14
v_lshlrev_b32 v18,2,v18
v_lshrrev_b32 v19,7,v14
v_lshl_add_u32 v19,v19,13,v18
s_waitcnt lgkmcnt(0)
s_barrier
ds_read_b32 v32,v19 offset:16384
ds_read_b32 v33,v19 offset:16896
ds_read_b32 v34,v19 offset:17408
ds_read_b32 v35,v19 offset:17920
ds_read_b32 v36,v19 offset:18432
ds_read_b32 v37,v19 offset:18944
ds_read_b32 v38,v19 offset:19456
ds_read_b32 v39,v19 offset:19968
ds_read_b32 v40,v19 offset:20480
ds_read_b32 v41,v19 offset:20992
ds_read_b32 v42,v19 offset:21504
ds_read_b32 v43,v19 offset:22016
s_waitcnt lgkmcnt(4)
ds_read_b32 v44,v19 offset:22528
ds_read_b32 v45,v19 offset:23040
ds_read_b32 v46,v19 offset:23552
ds_read_b32 v47,v19 offset:24064
s_waitcnt lgkmcnt(0)
v_pk_add_f32 v[32:33],v[32:33],v[40:41]
v_pk_add_f32 v[34:35],v[34:35],v[42:43]
v_pk_add_f32 v[36:37],v[36:37],v[44:45]
v_pk_add_f32 v[38:39],v[38:39],v[46:47]
v_pk_add_f32 v[32:33],v[32:33],v[36:37]
v_pk_add_f32 v[34:35],v[34:35],v[38:39]
v_pk_add_f32 v[32:33],v[32:33],v[34:35]
v_add_f32 v32,v32,v33
s_mul_i32 s64,s53,24576
s_lshl_b32 s65,s52,10
s_add_u32 s64,s64,s65
s_add_u32 s64,s64,267395072
v_lshlrev_b32 v18,2,v14
buffer_store_dword v32,v18,s[20:23],s64 offen sc1
s_cmp_eq_u32 s58,220
s_cbranch_scc1 fl2_28
s_mov_b32 s62,s59
fl1_27:
s_lshl_b32 s64,s62,2
s_add_u32 s64,s64,s50
s_mul_i32 s64,s64,14336
s_add_u32 s64,s64,143130624
buffer_store_dwordx4 v[28:31],v24,s[20:23],s64 offen offset:0 sc1
s_waitcnt vmcnt(2)
buffer_store_dwordx4 v[28:31],v24,s[20:23],s64 offen offset:1024 sc1
s_waitcnt vmcnt(2)
buffer_store_dwordx4 v[28:31],v24,s[20:23],s64 offen offset:2048 sc1
s_waitcnt vmcnt(2)
buffer_store_dwordx4 v[28:31],v24,s[20:23],s64 offen offset:3072 sc1
s_waitcnt vmcnt(2)
s_add_u32 s64,s64,4096
buffer_store_dwordx4 v[28:31],v24,s[20:23],s64 offen offset:0 sc1
s_waitcnt vmcnt(2)
buffer_store_dwordx4 v[28:31],v24,s[20:23],s64 offen offset:1024 sc1
s_waitcnt vmcnt(2)
buffer_store_dwordx4 v[28:31],v24,s[20:23],s64 offen offset:2048 sc1
s_waitcnt vmcnt(2)
buffer_store_dwordx4 v[28:31],v24,s[20:23],s64 offen offset:3072 sc1
s_waitcnt vmcnt(2)
s_add_u32 s64,s64,4096
buffer_store_dwordx4 v[28:31],v24,s[20:23],s64 offen offset:0 sc1
s_waitcnt vmcnt(2)
buffer_store_dwordx4 v[28:31],v24,s[20:23],s64 offen offset:1024 sc1
s_waitcnt vmcnt(2)
buffer_store_dwordx4 v[28:31],v24,s[20:23],s64 offen offset:2048 sc1
s_waitcnt vmcnt(2)
buffer_store_dwordx4 v[28:31],v24,s[20:23],s64 offen offset:3072 sc1
s_waitcnt vmcnt(2)
s_add_u32 s64,s64,4096
buffer_store_dwordx4 v[28:31],v24,s[20:23],s64 offen offset:0 sc1
s_waitcnt vmcnt(2)
buffer_store_dwordx4 v[28:31],v24,s[20:23],s64 offen offset:1024 sc1
s_waitcnt vmcnt(2)
s_lshl_b32 s64,s62,2
s_add_u32 s64,s64,s50
s_mul_i32 s64,s64,6144
s_add_u32 s64,s64,167772160
buffer_store_dwordx4 v[28:31],v24,s[20:23],s64 offen offset:0 sc1
s_waitcnt vmcnt(2)
buffer_store_dwordx4 v[28:31],v24,s[20:23],s64 offen offset:1024 sc1
s_waitcnt vmcnt(2)
buffer_store_dwordx4 v[28:31],v24,s[20:23],s64 offen offset:2048 sc1
s_waitcnt vmcnt(2)
buffer_store_dwordx4 v[28:31],v24,s[20:23],s64 offen offset:3072 sc1
s_waitcnt vmcnt(2)
s_add_u32 s64,s64,4096
buffer_store_dwordx4 v[28:31],v24,s[20:23],s64 offen offset:0 sc1
s_waitcnt vmcnt(2)
buffer_store_dwordx4 v[28:31],v24,s[20:23],s64 offen offset:1024 sc1
s_waitcnt vmcnt(2)
s_and_b32 s64,s62,31
s_lshl_b32 s64,s64,10
s_add_u32 s64,s64,209715200
s_bitcmp1_b32 s62,5
s_cselect_b32 s65,4227072,0
s_add_u32 s64,s64,s65
buffer_store_dwordx4 v[20:23],v24,s[20:23],s64 offen sc1
s_lshl_b32 s64,s62,10
s_add_u32 s64,s64,201326592
buffer_store_dwordx4 v[28:31],v24,s[20:23],s64 offen sc1
s_lshl_b32 s64,s62,14
s_lshl_b32 s65,s50,12
s_and_b32 s65,s65,0x2000
s_add_u32 s64,s64,s65
s_and_b32 s65,s50,1
s_lshl_b32 s65,s65,10
s_add_u32 s64,s64,s65
s_add_u32 s64,s64,133169152
buffer_store_dwordx4 v[28:31],v24,s[20:23],s64 offen sc1
s_cmp_eq_u32 s62,29
s_mov_b32 s62,28
s_cbranch_scc1 fl1_27
fl2_28:
s_waitcnt vmcnt(0)
s_barrier
s_cmp_lg_u32 s50,0
s_cbranch_scc1 sig_29
s_mov_b32 s92,s2
s_and_b32 s93,s3,0xffff
s_mov_b32 s94,0x100
s_mov_b32 s95,0x20000
s_add_u32 s64,s88,4
s_add_u32 s65,s88,8
s_cmp_eq_u32 s58,220
s_cselect_b32 s64,s65,s64
v_mov_b32 v16,1
s_mov_b64 exec,1
buffer_atomic_add v16,off,s[92:95],s64 sc1
s_mov_b64 exec,-1
sig_29:
v_lshlrev_b32 v128,16,v48
v_and_b32 v129,s73,v48
v_lshlrev_b32 v130,16,v49
v_and_b32 v131,s73,v49
v_lshlrev_b32 v132,16,v50
v_and_b32 v133,s73,v50
v_lshlrev_b32 v134,16,v51
v_and_b32 v135,s73,v51
v_lshlrev_b32 v136,16,v52
v_and_b32 v137,s73,v52
v_lshlrev_b32 v138,16,v53
v_and_b32 v139,s73,v53
v_lshlrev_b32 v140,16,v54
v_and_b32 v141,s73,v54
v_lshlrev_b32 v142,16,v55
v_and_b32 v143,s73,v55
v_lshlrev_b32 v144,16,v56
v_and_b32 v145,s73,v56
v_lshlrev_b32 v146,16,v57
v_and_b32 v147,s73,v57
v_lshlrev_b32 v148,16,v58
v_and_b32 v149,s73,v58
v_lshlrev_b32 v150,16,v59
v_and_b32 v151,s73,v59
v_lshlrev_b32 v152,16,v60
v_and_b32 v153,s73,v60
v_lshlrev_b32 v154,16,v61
v_and_b32 v155,s73,v61
v_lshlrev_b32 v156,16,v62
v_and_b32 v157,s73,v62
v_lshlrev_b32 v158,16,v63
v_and_b32 v159,s73,v63
v_lshlrev_b32 v160,16,v64
v_and_b32 v161,s73,v64
v_lshlrev_b32 v162,16,v65
v_and_b32 v163,s73,v65
v_lshlrev_b32 v164,16,v66
v_and_b32 v165,s73,v66
v_lshlrev_b32 v166,16,v67
v_and_b32 v167,s73,v67
v_lshlrev_b32 v168,16,v68
v_and_b32 v169,s73,v68
v_lshlrev_b32 v170,16,v69
v_and_b32 v171,s73,v69
v_lshlrev_b32 v172,16,v70
v_and_b32 v173,s73,v70
v_lshlrev_b32 v174,16,v71
v_and_b32 v175,s73,v71
v_lshlrev_b32 v176,16,v72
v_and_b32 v177,s73,v72
v_lshlrev_b32 v178,16,v73
v_and_b32 v179,s73,v73
v_lshlrev_b32 v180,16,v74
v_and_b32 v181,s73,v74
v_lshlrev_b32 v182,16,v75
v_and_b32 v183,s73,v75
v_lshlrev_b32 v184,16,v76
v_and_b32 v185,s73,v76
v_lshlrev_b32 v186,16,v77
v_and_b32 v187,s73,v77
v_lshlrev_b32 v188,16,v78
v_and_b32 v189,s73,v78
v_lshlrev_b32 v190,16,v79
v_and_b32 v191,s73,v79
v_add_f32 v208,v128,v129
v_mul_f32 v209,v128,v128
v_add_f32 v210,v130,v131
v_mul_f32 v211,v129,v129
v_fmac_f32 v209,v130,v130
v_fmac_f32 v211,v131,v131
v_add_f32 v208,v208,v132
v_fmac_f32 v209,v132,v132
v_add_f32 v210,v210,v133
v_fmac_f32 v211,v133,v133
v_add_f32 v208,v208,v134
v_fmac_f32 v209,v134,v134
v_add_f32 v210,v210,v135
v_fmac_f32 v211,v135,v135
v_add_f32 v208,v208,v136
v_fmac_f32 v209,v136,v136
v_add_f32 v210,v210,v137
v_fmac_f32 v211,v137,v137
v_add_f32 v208,v208,v138
v_fmac_f32 v209,v138,v138
v_add_f32 v210,v210,v139
v_fmac_f32 v211,v139,v139
v_add_f32 v208,v208,v140
v_fmac_f32 v209,v140,v140
v_add_f32 v210,v210,v141
v_fmac_f32 v211,v141,v141
v_add_f32 v208,v208,v142
v_fmac_f32 v209,v142,v142
v_add_f32 v210,v210,v143
v_fmac_f32 v211,v143,v143
v_add_f32 v208,v208,v210
v_add_f32 v209,v209,v211
v_add_f32 v212,v144,v145
v_mul_f32 v213,v144,v144
v_add_f32 v214,v146,v147
v_mul_f32 v215,v145,v145
v_fmac_f32 v213,v146,v146
v_fmac_f32 v215,v147,v147
v_add_f32 v212,v212,v148
v_fmac_f32 v213,v148,v148
v_add_f32 v214,v214,v149
v_fmac_f32 v215,v149,v149
v_add_f32 v212,v212,v150
v_fmac_f32 v213,v150,v150
v_add_f32 v214,v214,v151
v_fmac_f32 v215,v151,v151
v_add_f32 v212,v212,v152
v_fmac_f32 v213,v152,v152
v_add_f32 v214,v214,v153
v_fmac_f32 v215,v153,v153
v_add_f32 v212,v212,v154
v_fmac_f32 v213,v154,v154
v_add_f32 v214,v214,v155
v_fmac_f32 v215,v155,v155
v_add_f32 v212,v212,v156
v_fmac_f32 v213,v156,v156
v_add_f32 v214,v214,v157
v_fmac_f32 v215,v157,v157
v_add_f32 v212,v212,v158
v_fmac_f32 v213,v158,v158
v_add_f32 v214,v214,v159
v_fmac_f32 v215,v159,v159
v_add_f32 v212,v212,v214
v_add_f32 v213,v213,v215
v_add_f32 v216,v160,v161
v_mul_f32 v217,v160,v160
v_add_f32 v218,v162,v163
v_mul_f32 v219,v161,v161
v_fmac_f32 v217,v162,v162
v_fmac_f32 v219,v163,v163
v_add_f32 v216,v216,v164
v_fmac_f32 v217,v164,v164
v_add_f32 v218,v218,v165
v_fmac_f32 v219,v165,v165
v_add_f32 v216,v216,v166
v_fmac_f32 v217,v166,v166
v_add_f32 v218,v218,v167
v_fmac_f32 v219,v167,v167
v_add_f32 v216,v216,v168
v_fmac_f32 v217,v168,v168
v_add_f32 v218,v218,v169
v_fmac_f32 v219,v169,v169
v_add_f32 v216,v216,v170
v_fmac_f32 v217,v170,v170
v_add_f32 v218,v218,v171
v_fmac_f32 v219,v171,v171
v_add_f32 v216,v216,v172
v_fmac_f32 v217,v172,v172
v_add_f32 v218,v218,v173
v_fmac_f32 v219,v173,v173
v_add_f32 v216,v216,v174
v_fmac_f32 v217,v174,v174
v_add_f32 v218,v218,v175
v_fmac_f32 v219,v175,v175
v_add_f32 v216,v216,v218
v_add_f32 v217,v217,v219
v_add_f32 v220,v176,v177
v_mul_f32 v221,v176,v176
v_add_f32 v222,v178,v179
v_mul_f32 v223,v177,v177
v_fmac_f32 v221,v178,v178
v_fmac_f32 v223,v179,v179
v_add_f32 v220,v220,v180
v_fmac_f32 v221,v180,v180
v_add_f32 v222,v222,v181
v_fmac_f32 v223,v181,v181
v_add_f32 v220,v220,v182
v_fmac_f32 v221,v182,v182
v_add_f32 v222,v222,v183
v_fmac_f32 v223,v183,v183
v_add_f32 v220,v220,v184
v_fmac_f32 v221,v184,v184
v_add_f32 v222,v222,v185
v_fmac_f32 v223,v185,v185
v_add_f32 v220,v220,v186
v_fmac_f32 v221,v186,v186
v_add_f32 v222,v222,v187
v_fmac_f32 v223,v187,v187
v_add_f32 v220,v220,v188
v_fmac_f32 v221,v188,v188
v_add_f32 v222,v222,v189
v_fmac_f32 v223,v189,v189
v_add_f32 v220,v220,v190
v_fmac_f32 v221,v190,v190
v_add_f32 v222,v222,v191
v_fmac_f32 v223,v191,v191
v_add_f32 v220,v220,v222
v_add_f32 v221,v221,v223
v_add_f32_dpp v208,v208,v208 row_ror:4 row_mask:0xf bank_mask:0xf
v_add_f32_dpp v209,v209,v209 row_ror:4 row_mask:0xf bank_mask:0xf
v_add_f32_dpp v212,v212,v212 row_ror:4 row_mask:0xf bank_mask:0xf
v_add_f32_dpp v213,v213,v213 row_ror:4 row_mask:0xf bank_mask:0xf
v_add_f32_dpp v216,v216,v216 row_ror:4 row_mask:0xf bank_mask:0xf
v_add_f32_dpp v217,v217,v217 row_ror:4 row_mask:0xf bank_mask:0xf
v_add_f32_dpp v220,v220,v220 row_ror:4 row_mask:0xf bank_mask:0xf
v_add_f32_dpp v221,v221,v221 row_ror:4 row_mask:0xf bank_mask:0xf
v_add_f32_dpp v208,v208,v208 row_ror:8 row_mask:0xf bank_mask:0xf
v_add_f32_dpp v209,v209,v209 row_ror:8 row_mask:0xf bank_mask:0xf
v_add_f32_dpp v212,v212,v212 row_ror:8 row_mask:0xf bank_mask:0xf
v_add_f32_dpp v213,v213,v213 row_ror:8 row_mask:0xf bank_mask:0xf
v_add_f32_dpp v216,v216,v216 row_ror:8 row_mask:0xf bank_mask:0xf
v_add_f32_dpp v217,v217,v217 row_ror:8 row_mask:0xf bank_mask:0xf
v_add_f32_dpp v220,v220,v220 row_ror:8 row_mask:0xf bank_mask:0xf
v_add_f32_dpp v221,v221,v221 row_ror:8 row_mask:0xf bank_mask:0xf
v_mov_b32 v210,v208
v_mov_b32 v211,v209
s_nop 0
v_permlane16_swap_b32 v210,v208
v_permlane16_swap_b32 v211,v209
v_add_f32 v208,v208,v210
v_add_f32 v209,v209,v211
v_mov_b32 v214,v212
v_mov_b32 v215,v213
s_nop 0
v_permlane16_swap_b32 v214,v212
v_permlane16_swap_b32 v215,v213
v_add_f32 v212,v212,v214
v_add_f32 v213,v213,v215
v_mov_b32 v218,v216
v_mov_b32 v219,v217
s_nop 0
v_permlane16_swap_b32 v218,v216
v_permlane16_swap_b32 v219,v217
v_add_f32 v216,v216,v218
v_add_f32 v217,v217,v219
v_mov_b32 v222,v220
v_mov_b32 v223,v221
s_nop 0
v_permlane16_swap_b32 v222,v220
v_permlane16_swap_b32 v223,v221
v_add_f32 v220,v220,v222
v_add_f32 v221,v221,v223
v_mov_b32 v210,v208
v_mov_b32 v211,v209
s_nop 0
v_permlane32_swap_b32 v210,v208
v_permlane32_swap_b32 v211,v209
v_add_f32 v208,v208,v210
v_add_f32 v209,v209,v211
v_mov_b32 v214,v212
v_mov_b32 v215,v213
s_nop 0
v_permlane32_swap_b32 v214,v212
v_permlane32_swap_b32 v215,v213
v_add_f32 v212,v212,v214
v_add_f32 v213,v213,v215
v_mov_b32 v218,v216
v_mov_b32 v219,v217
s_nop 0
v_permlane32_swap_b32 v218,v216
v_permlane32_swap_b32 v219,v217
v_add_f32 v216,v216,v218
v_add_f32 v217,v217,v219
v_mov_b32 v222,v220
v_mov_b32 v223,v221
s_nop 0
v_permlane32_swap_b32 v222,v220
v_permlane32_swap_b32 v223,v221
v_add_f32 v220,v220,v222
v_add_f32 v221,v221,v223
ds_write_b64 v11,v[208:209] offset:32768
ds_write_b64 v11,v[212:213] offset:34816
ds_write_b64 v11,v[216:217] offset:36864
ds_write_b64 v11,v[220:221] offset:38912
s_waitcnt lgkmcnt(0)
s_barrier
ds_read_b64 v[32:33],v12 offset:32768
ds_read_b64 v[34:35],v12 offset:33280
ds_read_b64 v[36:37],v12 offset:33792
ds_read_b64 v[38:39],v12 offset:34304
s_waitcnt lgkmcnt(0)
v_add_f32 v32,v32,v34
v_add_f32 v33,v33,v35
v_add_f32 v36,v36,v38
v_add_f32 v37,v37,v39
v_add_f32 v32,v32,v36
v_add_f32 v33,v33,v37
v_mul_f32 v208,0xba800000,v32
v_mul_f32 v34,v208,v208
v_mul_f32 v33,0x3a800000,v33
v_sub_f32 v33,v33,v34
v_max_f32 v33,0,v33
v_add_f32 v33,0x3727c5ac,v33
v_rsq_f32 v209,v33
s_nop 0
v_mul_f32 v208,v208,v209
v_fma_f32 v128,v128,v209,v208
v_fma_f32 v129,v129,v209,v208
v_fma_f32 v130,v130,v209,v208
v_fma_f32 v131,v131,v209,v208
v_fma_f32 v132,v132,v209,v208
v_fma_f32 v133,v133,v209,v208
v_fma_f32 v134,v134,v209,v208
v_fma_f32 v135,v135,v209,v208
v_fma_f32 v136,v136,v209,v208
v_fma_f32 v137,v137,v209,v208
v_fma_f32 v138,v138,v209,v208
v_fma_f32 v139,v139,v209,v208
v_fma_f32 v140,v140,v209,v208
v_fma_f32 v141,v141,v209,v208
v_fma_f32 v142,v142,v209,v208
v_fma_f32 v143,v143,v209,v208
ds_read_b64 v[32:33],v12 offset:34816
ds_read_b64 v[34:35],v12 offset:35328
ds_read_b64 v[36:37],v12 offset:35840
ds_read_b64 v[38:39],v12 offset:36352
s_waitcnt lgkmcnt(0)
v_add_f32 v32,v32,v34
v_add_f32 v33,v33,v35
v_add_f32 v36,v36,v38
v_add_f32 v37,v37,v39
v_add_f32 v32,v32,v36
v_add_f32 v33,v33,v37
v_mul_f32 v208,0xba800000,v32
v_mul_f32 v34,v208,v208
v_mul_f32 v33,0x3a800000,v33
v_sub_f32 v33,v33,v34
v_max_f32 v33,0,v33
v_add_f32 v33,0x3727c5ac,v33
v_rsq_f32 v209,v33
s_nop 0
v_mul_f32 v208,v208,v209
v_fma_f32 v144,v144,v209,v208
v_fma_f32 v145,v145,v209,v208
v_fma_f32 v146,v146,v209,v208
v_fma_f32 v147,v147,v209,v208
v_fma_f32 v148,v148,v209,v208
v_fma_f32 v149,v149,v209,v208
v_fma_f32 v150,v150,v209,v208
v_fma_f32 v151,v151,v209,v208
v_fma_f32 v152,v152,v209,v208
v_fma_f32 v153,v153,v209,v208
v_fma_f32 v154,v154,v209,v208
v_fma_f32 v155,v155,v209,v208
v_fma_f32 v156,v156,v209,v208
v_fma_f32 v157,v157,v209,v208
v_fma_f32 v158,v158,v209,v208
v_fma_f32 v159,v159,v209,v208
ds_read_b64 v[32:33],v12 offset:36864
ds_read_b64 v[34:35],v12 offset:37376
ds_read_b64 v[36:37],v12 offset:37888
ds_read_b64 v[38:39],v12 offset:38400
s_waitcnt lgkmcnt(0)
v_add_f32 v32,v32,v34
v_add_f32 v33,v33,v35
v_add_f32 v36,v36,v38
v_add_f32 v37,v37,v39
v_add_f32 v32,v32,v36
v_add_f32 v33,v33,v37
v_mul_f32 v208,0xba800000,v32
v_mul_f32 v34,v208,v208
v_mul_f32 v33,0x3a800000,v33
v_sub_f32 v33,v33,v34
v_max_f32 v33,0,v33
v_add_f32 v33,0x3727c5ac,v33
v_rsq_f32 v209,v33
s_nop 0
v_mul_f32 v208,v208,v209
v_fma_f32 v160,v160,v209,v208
v_fma_f32 v161,v161,v209,v208
v_fma_f32 v162,v162,v209,v208
v_fma_f32 v163,v163,v209,v208
v_fma_f32 v164,v164,v209,v208
v_fma_f32 v165,v165,v209,v208
v_fma_f32 v166,v166,v209,v208
v_fma_f32 v167,v167,v209,v208
v_fma_f32 v168,v168,v209,v208
v_fma_f32 v169,v169,v209,v208
v_fma_f32 v170,v170,v209,v208
v_fma_f32 v171,v171,v209,v208
v_fma_f32 v172,v172,v209,v208
v_fma_f32 v173,v173,v209,v208
v_fma_f32 v174,v174,v209,v208
v_fma_f32 v175,v175,v209,v208
ds_read_b64 v[32:33],v12 offset:38912
ds_read_b64 v[34:35],v12 offset:39424
ds_read_b64 v[36:37],v12 offset:39936
ds_read_b64 v[38:39],v12 offset:40448
s_waitcnt lgkmcnt(0)
v_add_f32 v32,v32,v34
v_add_f32 v33,v33,v35
v_add_f32 v36,v36,v38
v_add_f32 v37,v37,v39
v_add_f32 v32,v32,v36
v_add_f32 v33,v33,v37
v_mul_f32 v208,0xba800000,v32
v_mul_f32 v34,v208,v208
v_mul_f32 v33,0x3a800000,v33
v_sub_f32 v33,v33,v34
v_max_f32 v33,0,v33
v_add_f32 v33,0x3727c5ac,v33
v_rsq_f32 v209,v33
s_nop 0
v_mul_f32 v208,v208,v209
v_fma_f32 v176,v176,v209,v208
v_fma_f32 v177,v177,v209,v208
v_fma_f32 v178,v178,v209,v208
v_fma_f32 v179,v179,v209,v208
v_fma_f32 v180,v180,v209,v208
v_fma_f32 v181,v181,v209,v208
v_fma_f32 v182,v182,v209,v208
v_fma_f32 v183,v183,v209,v208
v_fma_f32 v184,v184,v209,v208
v_fma_f32 v185,v185,v209,v208
v_fma_f32 v186,v186,v209,v208
v_fma_f32 v187,v187,v209,v208
v_fma_f32 v188,v188,v209,v208
v_fma_f32 v189,v189,v209,v208
v_fma_f32 v190,v190,v209,v208
v_fma_f32 v191,v191,v209,v208
s_mov_b32 s92,s2
s_and_b32 s93,s3,0xffff
s_mov_b32 s94,0x100
s_mov_b32 s95,0x20000
v_mbcnt_lo_u32_b32 v16,-1,0
v_mbcnt_hi_u32_b32 v16,-1,v16
v_mov_b32 v18,0
v_cmp_eq_u32 vcc,16,v16
s_nop 1
v_cndmask_b32 v18,v18,64,vcc
v_and_b32 v19,1,v16
v_cmp_eq_u32 vcc,1,v19
v_mov_b32 v19,8192
s_nop 0
v_cndmask_b32 v19,-1,v19,vcc
v_min_u32 v16,31,v16
v_lshlrev_b32 v16,2,v16
s_sub_u32 s66,s88,64
s_cmp_lg_u32 s50,0
s_cbranch_scc1 vot_34
vpoll_30:
buffer_load_dword v17,v16,s[92:95],s66 offen sc1
s_waitcnt vmcnt(0)
s_cmp_lg_u32 s56,2
s_cbranch_scc1 vck_31
v_cmp_eq_u32 vcc,v17,v19
s_and_b32 s64,vcc_lo,0xffff
s_cmp_eq_u32 s64,65535
s_cbranch_scc1 vck_31
s_mov_b32 s65,0
v_readlane_b32 s64,v17,1
s_lshr_b32 s64,s64,8
s_add_u32 s65,s65,s64
v_readlane_b32 s64,v17,3
s_lshr_b32 s64,s64,8
s_add_u32 s65,s65,s64
v_readlane_b32 s64,v17,5
s_lshr_b32 s64,s64,8
s_add_u32 s65,s65,s64
v_readlane_b32 s64,v17,7
s_lshr_b32 s64,s64,8
s_add_u32 s65,s65,s64
v_readlane_b32 s64,v17,9
s_lshr_b32 s64,s64,8
s_add_u32 s65,s65,s64
v_readlane_b32 s64,v17,11
s_lshr_b32 s64,s64,8
s_add_u32 s65,s65,s64
v_readlane_b32 s64,v17,13
s_lshr_b32 s64,s64,8
s_add_u32 s65,s65,s64
v_readlane_b32 s64,v17,15
s_lshr_b32 s64,s64,8
s_add_u32 s65,s65,s64
s_cmp_ge_u32 s65,256
s_cbranch_scc1 vok_33
s_branch vrt_32
vck_31:
v_cmp_gt_u32 vcc,v18,v17
s_cbranch_vccz vok_33
vrt_32:
s_sleep 8
s_sub_u32 s90,s90,1
s_cmp_gt_i32 s90,0
s_cbranch_scc1 vpoll_30
vok_33:
v_add_u32 v18,160512,v16
ds_write_b32 v18,v17
s_waitcnt lgkmcnt(0)
vot_34:
s_barrier
v_add_u32 v18,160512,v16
ds_read_b32 v17,v18
s_waitcnt lgkmcnt(0)
s_cmp_lg_u32 s56,2
s_cbranch_scc1 vfin_35
v_cmp_eq_u32 vcc,v17,v19
s_and_b32 s64,vcc_lo,0xffff
s_cmp_eq_u32 s64,65535
s_cbranch_scc1 vfin_35
s_mov_b32 s65,0
v_readlane_b32 s64,v17,1
s_lshr_b32 s64,s64,8
s_add_u32 s65,s65,s64
v_readlane_b32 s64,v17,3
s_lshr_b32 s64,s64,8
s_add_u32 s65,s65,s64
v_readlane_b32 s64,v17,5
s_lshr_b32 s64,s64,8
s_add_u32 s65,s65,s64
v_readlane_b32 s64,v17,7
s_lshr_b32 s64,s64,8
s_add_u32 s65,s65,s64
v_readlane_b32 s64,v17,9
s_lshr_b32 s64,s64,8
s_add_u32 s65,s65,s64
v_readlane_b32 s64,v17,11
s_lshr_b32 s64,s64,8
s_add_u32 s65,s65,s64
v_readlane_b32 s64,v17,13
s_lshr_b32 s64,s64,8
s_add_u32 s65,s65,s64
v_readlane_b32 s64,v17,15
s_lshr_b32 s64,s64,8
s_add_u32 s65,s65,s64
s_cmp_ge_u32 s65,256
s_cbranch_scc1 fl_fb
vfin_35:
s_and_b32 s56,s56,1
v_lshlrev_b32 v18,5,v14
s_mov_b32 s64,267386880
buffer_load_dwordx4 v[32:35],v18,s[20:23],s64 offen offset:0 sc1
buffer_load_dwordx4 v[36:39],v18,s[20:23],s64 offen offset:16 sc1
s_mov_b32 s64,267411456
buffer_load_dwordx4 v[40:43],v18,s[20:23],s64 offen offset:0 sc1
buffer_load_dwordx4 v[44:47],v18,s[20:23],s64 offen offset:16 sc1
s_mov_b32 s64,267436032
buffer_load_dwordx4 v[48:51],v18,s[20:23],s64 offen offset:0 sc1
buffer_load_dwordx4 v[52:55],v18,s[20:23],s64 offen offset:16 sc1
s_mov_b32 s64,267460608
buffer_load_dwordx4 v[56:59],v18,s[20:23],s64 offen offset:0 sc1
buffer_load_dwordx4 v[60:63],v18,s[20:23],s64 offen offset:16 sc1
s_cmp_gt_u32 s50,1
s_cselect_b32 s64,1.0,0
s_waitcnt vmcnt(0)
v_pk_add_f32 v[32:33],v[32:33],v[40:41]
v_pk_add_f32 v[48:49],v[48:49],v[56:57]
v_pk_add_f32 v[34:35],v[34:35],v[42:43]
v_pk_add_f32 v[50:51],v[50:51],v[58:59]
v_pk_add_f32 v[36:37],v[36:37],v[44:45]
v_pk_add_f32 v[52:53],v[52:53],v[60:61]
v_pk_add_f32 v[38:39],v[38:39],v[46:47]
v_pk_add_f32 v[54:55],v[54:55],v[62:63]
v_pk_add_f32 v[32:33],v[32:33],v[48:49]
v_pk_add_f32 v[34:35],v[34:35],v[50:51]
v_pk_add_f32 v[36:37],v[36:37],v[52:53]
v_pk_add_f32 v[38:39],v[38:39],v[54:55]
v_cvt_pk_bf16_f32 v40,v32,v33
v_cvt_pk_bf16_f32 v41,v34,v35
v_cvt_pk_bf16_f32 v42,v36,v37
v_cvt_pk_bf16_f32 v43,v38,v39
v_lshlrev_b32 v32,16,v40
v_and_b32 v33,s73,v40
v_lshlrev_b32 v34,16,v41
v_and_b32 v35,s73,v41
v_lshlrev_b32 v36,16,v42
v_and_b32 v37,s73,v42
v_lshlrev_b32 v38,16,v43
v_and_b32 v39,s73,v43
v_add_f32 v32,s64,v32
v_add_f32 v33,s64,v33
v_add_f32 v34,s64,v34
v_add_f32 v35,s64,v35
v_add_f32 v36,s64,v36
v_add_f32 v37,s64,v37
v_add_f32 v38,s64,v38
v_add_f32 v39,s64,v39
ds_write_b128 v18,v[32:35] offset:0
ds_write_b128 v18,v[36:39] offset:16
s_waitcnt lgkmcnt(0)
s_barrier
ds_read_b128 v[112:115],v9 offset:0
ds_read_b128 v[116:119],v9 offset:16
ds_read_b128 v[120:123],v9 offset:512
ds_read_b128 v[124:127],v9 offset:528
ds_read_b128 v[96:99],v9 offset:4096
ds_read_b128 v[100:103],v9 offset:4112
ds_read_b128 v[104:107],v9 offset:4608
ds_read_b128 v[108:111],v9 offset:4624
s_add_u32 s61,s61,146800640
s_add_u32 s62,s61,4096
s_waitcnt lgkmcnt(0)
v_fma_f32 v128,v128,v96,v112
v_fma_f32 v129,v129,v97,v113
v_fma_f32 v130,v130,v98,v114
v_fma_f32 v131,v131,v99,v115
v_fma_f32 v132,v132,v100,v116
v_fma_f32 v133,v133,v101,v117
v_fma_f32 v134,v134,v102,v118
v_fma_f32 v135,v135,v103,v119
v_fma_f32 v136,v136,v104,v120
v_fma_f32 v137,v137,v105,v121
v_fma_f32 v138,v138,v106,v122
v_fma_f32 v139,v139,v107,v123
v_fma_f32 v140,v140,v108,v124
v_fma_f32 v141,v141,v109,v125
v_fma_f32 v142,v142,v110,v126
v_fma_f32 v143,v143,v111,v127
v_cvt_pk_bf16_f32 v48,v128,v129
v_cvt_pk_bf16_f32 v49,v130,v131
v_cvt_pk_bf16_f32 v50,v132,v133
v_cvt_pk_bf16_f32 v51,v134,v135
v_cvt_pk_bf16_f32 v52,v136,v137
v_cvt_pk_bf16_f32 v53,v138,v139
v_cvt_pk_bf16_f32 v54,v140,v141
v_cvt_pk_bf16_f32 v55,v142,v143
buffer_store_dwordx4 v[48:51],v10,s[20:23],s61 offen offset:0 sc1
buffer_store_dwordx4 v[52:55],v10,s[20:23],s62 offen offset:0 sc1
v_fma_f32 v144,v144,v96,v112
v_fma_f32 v145,v145,v97,v113
v_fma_f32 v146,v146,v98,v114
v_fma_f32 v147,v147,v99,v115
v_fma_f32 v148,v148,v100,v116
v_fma_f32 v149,v149,v101,v117
v_fma_f32 v150,v150,v102,v118
v_fma_f32 v151,v151,v103,v119
v_fma_f32 v152,v152,v104,v120
v_fma_f32 v153,v153,v105,v121
v_fma_f32 v154,v154,v106,v122
v_fma_f32 v155,v155,v107,v123
v_fma_f32 v156,v156,v108,v124
v_fma_f32 v157,v157,v109,v125
v_fma_f32 v158,v158,v110,v126
v_fma_f32 v159,v159,v111,v127
v_cvt_pk_bf16_f32 v56,v144,v145
v_cvt_pk_bf16_f32 v57,v146,v147
v_cvt_pk_bf16_f32 v58,v148,v149
v_cvt_pk_bf16_f32 v59,v150,v151
v_cvt_pk_bf16_f32 v60,v152,v153
v_cvt_pk_bf16_f32 v61,v154,v155
v_cvt_pk_bf16_f32 v62,v156,v157
v_cvt_pk_bf16_f32 v63,v158,v159
buffer_store_dwordx4 v[56:59],v10,s[20:23],s61 offen offset:64 sc1
buffer_store_dwordx4 v[60:63],v10,s[20:23],s62 offen offset:64 sc1
v_fma_f32 v160,v160,v96,v112
v_fma_f32 v161,v161,v97,v113
v_fma_f32 v162,v162,v98,v114
v_fma_f32 v163,v163,v99,v115
v_fma_f32 v164,v164,v100,v116
v_fma_f32 v165,v165,v101,v117
v_fma_f32 v166,v166,v102,v118
v_fma_f32 v167,v167,v103,v119
v_fma_f32 v168,v168,v104,v120
v_fma_f32 v169,v169,v105,v121
v_fma_f32 v170,v170,v106,v122
v_fma_f32 v171,v171,v107,v123
v_fma_f32 v172,v172,v108,v124
v_fma_f32 v173,v173,v109,v125
v_fma_f32 v174,v174,v110,v126
v_fma_f32 v175,v175,v111,v127
v_cvt_pk_bf16_f32 v64,v160,v161
v_cvt_pk_bf16_f32 v65,v162,v163
v_cvt_pk_bf16_f32 v66,v164,v165
v_cvt_pk_bf16_f32 v67,v166,v167
v_cvt_pk_bf16_f32 v68,v168,v169
v_cvt_pk_bf16_f32 v69,v170,v171
v_cvt_pk_bf16_f32 v70,v172,v173
v_cvt_pk_bf16_f32 v71,v174,v175
buffer_store_dwordx4 v[64:67],v10,s[20:23],s61 offen offset:128 sc1
buffer_store_dwordx4 v[68:71],v10,s[20:23],s62 offen offset:128 sc1
v_fma_f32 v176,v176,v96,v112
v_fma_f32 v177,v177,v97,v113
v_fma_f32 v178,v178,v98,v114
v_fma_f32 v179,v179,v99,v115
v_fma_f32 v180,v180,v100,v116
v_fma_f32 v181,v181,v101,v117
v_fma_f32 v182,v182,v102,v118
v_fma_f32 v183,v183,v103,v119
v_fma_f32 v184,v184,v104,v120
v_fma_f32 v185,v185,v105,v121
v_fma_f32 v186,v186,v106,v122
v_fma_f32 v187,v187,v107,v123
v_fma_f32 v188,v188,v108,v124
v_fma_f32 v189,v189,v109,v125
v_fma_f32 v190,v190,v110,v126
v_fma_f32 v191,v191,v111,v127
v_cvt_pk_bf16_f32 v72,v176,v177
v_cvt_pk_bf16_f32 v73,v178,v179
v_cvt_pk_bf16_f32 v74,v180,v181
v_cvt_pk_bf16_f32 v75,v182,v183
v_cvt_pk_bf16_f32 v76,v184,v185
v_cvt_pk_bf16_f32 v77,v186,v187
v_cvt_pk_bf16_f32 v78,v188,v189
v_cvt_pk_bf16_f32 v79,v190,v191
buffer_store_dwordx4 v[72:75],v10,s[20:23],s61 offen offset:192 sc1
buffer_store_dwordx4 v[76:79],v10,s[20:23],s62 offen offset:192 sc1
s_waitcnt vmcnt(0)
s_barrier
s_cmp_lg_u32 s50,0
s_cbranch_scc1 sig_36
s_mov_b32 s92,s2
s_and_b32 s93,s3,0xffff
s_mov_b32 s94,0x100
s_mov_b32 s95,0x20000
s_add_u32 s64,s88,16
v_mov_b32 v16,1
s_mov_b64 exec,1
buffer_atomic_add v16,off,s[92:95],s64 sc1
s_mov_b64 exec,-1
sig_36:
fl_disp:
s_lshr_b32 s64,s58,2
s_sub_u32 s64,s64,55
s_andn2_b32 s64,s64,4
s_cmp_eq_u32 s64,0
s_cselect_b32 s64,48,0
s_xor_b32 s58,s58,s64
s_sub_u32 s59,s58,248
s_cbranch_scc1 nx_37
s_branch fl_w2
nx_37:
s_sub_u32 s59,s58,240
s_cbranch_scc1 nx_38
s_branch fl_w1
nx_38:
s_sub_u32 s59,s58,224
s_cbranch_scc1 nx_39
s_branch fl_att
nx_39:
s_sub_u32 s59,s58,220
s_cbranch_scc1 nx_40
s_branch fl_ln2
nx_40:
s_sub_u32 s59,s58,192
s_cbranch_scc1 nx_41
s_branch fl_w3
nx_41:
s_sub_u32 s59,s58,160
s_cbranch_scc1 nx_42
s_branch fl_w4
nx_42:
s_sub_u32 s59,s58,128
s_branch fl_wo
fl_fb:
s_mov_b32 s92,s2
s_and_b32 s93,s3,0xffff
s_mov_b32 s94,0x100
s_mov_b32 s95,0x20000
s_waitcnt vmcnt(0) lgkmcnt(0)
s_barrier
v_mov_b32 v4,0
s_cmp_lg_u32 s50,0
s_cbranch_scc1 norole_2
s_mov_b64 exec,1
v_mov_b32 v3,1
s_lshl_b32 s52,s51,2
s_add_u32 s52,s52,128
buffer_atomic_add v3,off,s[92:95],s52 sc0 sc1
s_waitcnt vmcnt(0)
ds_write_b32 v4,v3
s_waitcnt lgkmcnt(0)
s_mov_b64 exec,-1
norole_2:
s_barrier
ds_read_b32 v3,v4
v_mbcnt_lo_u32_b32 v16,-1,0
v_and_b32 v16,7,v16
v_lshlrev_b32 v16,2,v16
s_waitcnt lgkmcnt(0)
v_readfirstlane_b32 s49,v3
s_barrier
tp_43:
buffer_load_dword v17,v16,s[92:95],0 offen offset:128 sc1
s_waitcnt vmcnt(0)
v_readlane_b32 s72,v17,0
v_readlane_b32 s73,v17,1
v_readlane_b32 s74,v17,2
v_readlane_b32 s75,v17,3
v_readlane_b32 s76,v17,4
v_readlane_b32 s77,v17,5
v_readlane_b32 s78,v17,6
v_readlane_b32 s79,v17,7
s_add_u32 s65,s72,s73
s_add_u32 s65,s65,s74
s_add_u32 s65,s65,s75
s_add_u32 s65,s65,s76
s_add_u32 s65,s65,s77
s_add_u32 s65,s65,s78
s_add_u32 s65,s65,s79
s_cmp_ge_u32 s65,256
s_cbranch_scc1 tg_44
s_sleep 4
s_sub_u32 s90,s90,1
s_cmp_gt_i32 s90,0
s_cbranch_scc1 tp_43
tg_44:
s_min_u32 s65,s72,s73
s_min_u32 s65,s65,s74
s_min_u32 s65,s65,s75
s_min_u32 s65,s65,s76
s_min_u32 s65,s65,s77
s_min_u32 s65,s65,s78
s_min_u32 s65,s65,s79
s_mov_b32 s88,192
s_cmp_lt_u32 s65,32
s_cbranch_scc1 tsl_45
s_lshl_b32 s64,s51,2
s_lshr_b32 s64,0x76325410,s64
s_and_b32 s64,s64,7
s_lshl_b32 s58,s64,5
s_add_u32 s58,s58,s49
s_mov_b32 s56,0
s_branch fl_disp0
tsl_45:
s_mov_b32 s58,s49
s_cmp_gt_u32 s51,0
s_cselect_b32 s65,s72,0
s_add_u32 s58,s58,s65
s_cmp_gt_u32 s51,1
s_cselect_b32 s65,s73,0
s_add_u32 s58,s58,s65
s_cmp_gt_u32 s51,2
s_cselect_b32 s65,s74,0
s_add_u32 s58,s58,s65
s_cmp_gt_u32 s51,3
s_cselect_b32 s65,s75,0
s_add_u32 s58,s58,s65
s_cmp_gt_u32 s51,4
s_cselect_b32 s65,s76,0
s_add_u32 s58,s58,s65
s_cmp_gt_u32 s51,5
s_cselect_b32 s65,s77,0
s_add_u32 s58,s58,s65
s_cmp_gt_u32 s51,6
s_cselect_b32 s65,s78,0
s_add_u32 s58,s58,s65
s_mov_b32 s56,1
s_cmp_lt_u32 s58,256
s_cbranch_scc1 fl_disp0
done_1:
s_endpgm
fl_qkv:
v_and_b32 v21,15,v1
v_lshrrev_b32 v22,4,v1
v_lshrrev_b32 v23,2,v21
v_and_b32 v24,3,v21
s_lshl_b32 s61,s50,15
v_lshl_add_u32 v25,v22,3,v23
s_load_dwordx4 s[4:7],s[0:1],16
s_load_dwordx2 s[8:9],s[0:1],32
s_lshl_b32 s52,s59,7
s_and_b32 s64,s50,1
s_lshl_b32 s65,s64,6
s_add_u32 s53,s52,s65
s_lshr_b32 s65,s50,1
s_lshl_b32 s65,s65,6
s_add_u32 s52,s52,s65
s_lshl_b32 s54,s64,3
s_waitcnt lgkmcnt(0)
s_cmp_gt_u32 s50,1
s_cselect_b64 s[10:11],s[4:5],s[6:7]
s_mov_b32 s28,s10
s_and_b32 s29,s11,0xffff
s_mov_b32 s30,0x800000
s_mov_b32 s31,0x20000
s_mov_b32 s32,s8
s_and_b32 s33,s9,0xffff
s_mov_b32 s34,0x800000
s_mov_b32 s35,0x20000
s_and_b32 s64,s59,7
s_lshl_b32 s65,s64,3
s_and_b32 s66,s50,1
s_lshl_b32 s55,s66,2
s_add_u32 s65,s65,s55
s_lshl_b32 s66,s66,5
s_lshl_b32 s65,s65,13
s_andn2_b32 s55,s59,7
s_lshl_b32 s55,s55,7
s_add_u32 s65,s65,s55
s_add_u32 s65,s65,384
v_and_b32 v28,3,v1
v_lshlrev_b32 v28,13,v28
v_add_u32 v28,s65,v28
v_and_b32 v15,4,v1
v_lshl_add_u32 v28,v15,4,v28
s_and_b32 s55,s59,31
s_add_u32 s66,s66,s55
s_lshl_b32 s66,s66,13
s_add_u32 s66,s66,8064
v_writelane_b32 v28,s66,8
s_add_u32 s66,s66,64
v_writelane_b32 v28,s66,9
s_cmp_eq_u32 s64,3
s_cselect_b32 s65,0,15
s_sub_u32 s66,s59,32
s_cmp_lt_u32 s66,31
s_cselect_b32 s66,256,0
s_or_b32 vcc_lo,s65,s66
s_mov_b32 vcc_hi,0
v_cndmask_b32 v28,-1,v28,vcc
s_and_b32 s64,s59,7
s_lshl_b32 s65,s64,4
s_lshl_b32 s55,s50,2
s_add_u32 s65,s65,s55
s_lshl_b32 s66,s50,5
s_lshl_b32 s65,s65,13
s_andn2_b32 s55,s59,7
s_lshl_b32 s55,s55,7
s_add_u32 s65,s65,s55
s_add_u32 s65,s65,384
v_and_b32 v31,3,v1
v_lshlrev_b32 v31,13,v31
v_add_u32 v31,s65,v31
v_and_b32 v15,4,v1
v_lshl_add_u32 v31,v15,4,v31
s_and_b32 s55,s59,31
s_add_u32 s66,s66,s55
s_lshl_b32 s66,s66,13
s_add_u32 s66,s66,8064
v_writelane_b32 v31,s66,8
s_add_u32 s66,s66,64
v_writelane_b32 v31,s66,9
s_cmp_eq_u32 s64,3
s_cselect_b32 s65,0,15
s_sub_u32 s66,s59,32
s_cmp_lt_u32 s66,31
s_cselect_b32 s66,256,0
s_or_b32 vcc_lo,s65,s66
s_mov_b32 vcc_hi,0
v_cndmask_b32 v31,-1,v31,vcc
s_and_b32 s60,s50,1
s_lshl_b32 s60,s60,1
v_lshrrev_b32 v26,2,v1
v_and_b32 v27,3,v1
v_mul_u32_u24 v16,8192,v26
v_lshl_add_u32 v16,v27,4,v16
v_lshlrev_b32 v17,6,v25
v_lshl_add_u32 v17,v24,4,v17
v_add_u32 v17,s61,v17
s_mov_b32 s64,1048576
buffer_load_dword v29,v28,s[28:31],s64 offen
s_mov_b32 s64,1572864
buffer_load_dword v29,v28,s[28:31],s64 offen
s_add_u32 s62,s53,0
s_add_u32 m0,s61,0
s_nop 0
buffer_load_dwordx4 v16,s[28:31],s62 offen lds
s_add_u32 s62,s62,131072
s_add_u32 m0,m0,1024
s_waitcnt vmcnt(10)
buffer_load_dwordx4 v16,s[28:31],s62 offen lds
s_add_u32 s62,s62,131072
s_add_u32 m0,m0,1024
s_mov_b32 s64,0
buffer_load_dword v29,v31,s[32:35],s64 offen
s_waitcnt vmcnt(10)
buffer_load_dwordx4 v16,s[28:31],s62 offen lds
s_add_u32 s62,s62,131072
s_add_u32 m0,m0,1024
s_waitcnt vmcnt(10)
buffer_load_dwordx4 v16,s[28:31],s62 offen lds
s_add_u32 s62,s62,131072
s_add_u32 m0,m0,1024
s_waitcnt vmcnt(10)
buffer_load_dwordx4 v16,s[28:31],s62 offen lds
s_add_u32 s62,s62,131072
s_add_u32 m0,m0,1024
s_waitcnt vmcnt(10)
buffer_load_dwordx4 v16,s[28:31],s62 offen lds
s_add_u32 s62,s62,131072
s_add_u32 m0,m0,1024
s_waitcnt vmcnt(10)
buffer_load_dwordx4 v16,s[28:31],s62 offen lds
s_add_u32 s62,s62,131072
s_add_u32 m0,m0,1024
s_waitcnt vmcnt(10)
buffer_load_dwordx4 v16,s[28:31],s62 offen lds
s_add_u32 s62,s62,131072
s_add_u32 m0,m0,1024
s_waitcnt vmcnt(10)
buffer_load_dwordx4 v16,s[28:31],s62 offen lds
s_add_u32 s62,s62,131072
s_add_u32 m0,m0,1024
s_waitcnt vmcnt(10)
buffer_load_dwordx4 v16,s[28:31],s62 offen lds
s_add_u32 s62,s62,131072
s_add_u32 m0,m0,1024
s_mov_b32 s64,1048576
buffer_load_dword v29,v31,s[32:35],s64 offen
s_waitcnt vmcnt(10)
buffer_load_dwordx4 v16,s[28:31],s62 offen lds
s_add_u32 s62,s62,131072
s_add_u32 m0,m0,1024
s_waitcnt vmcnt(10)
buffer_load_dwordx4 v16,s[28:31],s62 offen lds
s_add_u32 s62,s62,131072
s_add_u32 m0,m0,1024
s_waitcnt vmcnt(10)
buffer_load_dwordx4 v16,s[28:31],s62 offen lds
s_add_u32 s62,s62,131072
s_add_u32 m0,m0,1024
s_waitcnt vmcnt(10)
buffer_load_dwordx4 v16,s[28:31],s62 offen lds
s_add_u32 s62,s62,131072
s_add_u32 m0,m0,1024
s_waitcnt vmcnt(10)
buffer_load_dwordx4 v16,s[28:31],s62 offen lds
s_add_u32 s62,s62,131072
s_add_u32 m0,m0,1024
s_waitcnt vmcnt(10)
buffer_load_dwordx4 v16,s[28:31],s62 offen lds
s_waitcnt vmcnt(10)
s_add_u32 s62,s52,0
s_add_u32 m0,s61,16384
s_nop 0
buffer_load_dwordx4 v16,s[32:35],s62 offen lds
s_add_u32 s62,s62,131072
s_add_u32 m0,m0,1024
s_waitcnt vmcnt(10)
buffer_load_dwordx4 v16,s[32:35],s62 offen lds
s_add_u32 s62,s62,131072
s_add_u32 m0,m0,1024
s_mov_b32 s64,2097152
buffer_load_dword v29,v28,s[28:31],s64 offen
s_waitcnt vmcnt(10)
buffer_load_dwordx4 v16,s[32:35],s62 offen lds
s_add_u32 s62,s62,131072
s_add_u32 m0,m0,1024
s_waitcnt vmcnt(10)
buffer_load_dwordx4 v16,s[32:35],s62 offen lds
s_add_u32 s62,s62,131072
s_add_u32 m0,m0,1024
s_waitcnt vmcnt(10)
buffer_load_dwordx4 v16,s[32:35],s62 offen lds
s_add_u32 s62,s62,131072
s_add_u32 m0,m0,1024
s_waitcnt vmcnt(10)
buffer_load_dwordx4 v16,s[32:35],s62 offen lds
s_add_u32 s62,s62,131072
s_add_u32 m0,m0,1024
s_mov_b32 s64,2621440
buffer_load_dword v29,v28,s[28:31],s64 offen
s_waitcnt vmcnt(10)
buffer_load_dwordx4 v16,s[32:35],s62 offen lds
s_add_u32 s62,s62,131072
s_add_u32 m0,m0,1024
s_waitcnt vmcnt(10)
buffer_load_dwordx4 v16,s[32:35],s62 offen lds
s_add_u32 s62,s62,131072
s_add_u32 m0,m0,1024
s_waitcnt vmcnt(10)
buffer_load_dwordx4 v16,s[32:35],s62 offen lds
s_add_u32 s62,s62,131072
s_add_u32 m0,m0,1024
s_waitcnt vmcnt(10)
buffer_load_dwordx4 v16,s[32:35],s62 offen lds
s_add_u32 s62,s62,131072
s_add_u32 m0,m0,1024
s_mov_b32 s64,3145728
buffer_load_dword v29,v28,s[28:31],s64 offen
s_waitcnt vmcnt(10)
buffer_load_dwordx4 v16,s[32:35],s62 offen lds
s_add_u32 s62,s62,131072
s_add_u32 m0,m0,1024
s_waitcnt vmcnt(10)
buffer_load_dwordx4 v16,s[32:35],s62 offen lds
s_add_u32 s62,s62,131072
s_add_u32 m0,m0,1024
s_waitcnt vmcnt(10)
buffer_load_dwordx4 v16,s[32:35],s62 offen lds
s_add_u32 s62,s62,131072
s_add_u32 m0,m0,1024
s_waitcnt vmcnt(10)
buffer_load_dwordx4 v16,s[32:35],s62 offen lds
s_add_u32 s62,s62,131072
s_add_u32 m0,m0,1024
s_mov_b32 s64,3670016
buffer_load_dword v29,v28,s[28:31],s64 offen
s_waitcnt vmcnt(10)
buffer_load_dwordx4 v16,s[32:35],s62 offen lds
s_add_u32 s62,s62,131072
s_add_u32 m0,m0,1024
s_waitcnt vmcnt(10)
buffer_load_dwordx4 v16,s[32:35],s62 offen lds
s_waitcnt vmcnt(10)
s_waitcnt vmcnt(20)
ds_read_b64_tr_b16 a[0:1],v17 offset:0
ds_read_b64_tr_b16 a[2:3],v17 offset:256
ds_read_b64_tr_b16 a[4:5],v17 offset:8
ds_read_b64_tr_b16 a[6:7],v17 offset:264
ds_read_b64_tr_b16 a[12:13],v17 offset:2048
ds_read_b64_tr_b16 a[14:15],v17 offset:2304
ds_read_b64_tr_b16 a[16:17],v17 offset:2056
ds_read_b64_tr_b16 a[18:19],v17 offset:2312
ds_read_b64_tr_b16 a[24:25],v17 offset:4096
ds_read_b64_tr_b16 a[26:27],v17 offset:4352
ds_read_b64_tr_b16 a[28:29],v17 offset:4104
ds_read_b64_tr_b16 a[30:31],v17 offset:4360
s_waitcnt lgkmcnt(0)
ds_read_b64_tr_b16 a[36:37],v17 offset:6144
ds_read_b64_tr_b16 a[38:39],v17 offset:6400
ds_read_b64_tr_b16 a[40:41],v17 offset:6152
ds_read_b64_tr_b16 a[42:43],v17 offset:6408
ds_read_b64_tr_b16 a[48:49],v17 offset:8192
ds_read_b64_tr_b16 a[50:51],v17 offset:8448
ds_read_b64_tr_b16 a[52:53],v17 offset:8200
ds_read_b64_tr_b16 a[54:55],v17 offset:8456
ds_read_b64_tr_b16 a[60:61],v17 offset:10240
ds_read_b64_tr_b16 a[62:63],v17 offset:10496
ds_read_b64_tr_b16 a[64:65],v17 offset:10248
ds_read_b64_tr_b16 a[66:67],v17 offset:10504
s_waitcnt lgkmcnt(0)
ds_read_b64_tr_b16 a[72:73],v17 offset:12288
ds_read_b64_tr_b16 a[74:75],v17 offset:12544
ds_read_b64_tr_b16 a[76:77],v17 offset:12296
ds_read_b64_tr_b16 a[78:79],v17 offset:12552
ds_read_b64_tr_b16 a[84:85],v17 offset:14336
ds_read_b64_tr_b16 a[86:87],v17 offset:14592
ds_read_b64_tr_b16 a[88:89],v17 offset:14344
ds_read_b64_tr_b16 a[90:91],v17 offset:14600
s_waitcnt lgkmcnt(0)
s_add_u32 s62,s53,2097152
s_add_u32 m0,s61,0
s_nop 0
buffer_load_dwordx4 v16,s[28:31],s62 offen lds
s_add_u32 s62,s62,131072
s_add_u32 m0,m0,1024
s_waitcnt vmcnt(10)
buffer_load_dwordx4 v16,s[28:31],s62 offen lds
s_add_u32 s62,s62,131072
s_add_u32 m0,m0,1024
s_mov_b32 s64,2097152
buffer_load_dword v29,v31,s[32:35],s64 offen
s_waitcnt vmcnt(10)
buffer_load_dwordx4 v16,s[28:31],s62 offen lds
s_add_u32 s62,s62,131072
s_add_u32 m0,m0,1024
s_waitcnt vmcnt(10)
buffer_load_dwordx4 v16,s[28:31],s62 offen lds
s_add_u32 s62,s62,131072
s_add_u32 m0,m0,1024
s_waitcnt vmcnt(10)
buffer_load_dwordx4 v16,s[28:31],s62 offen lds
s_add_u32 s62,s62,131072
s_add_u32 m0,m0,1024
s_waitcnt vmcnt(10)
buffer_load_dwordx4 v16,s[28:31],s62 offen lds
s_add_u32 s62,s62,131072
s_add_u32 m0,m0,1024
s_waitcnt vmcnt(10)
buffer_load_dwordx4 v16,s[28:31],s62 offen lds
s_add_u32 s62,s62,131072
s_add_u32 m0,m0,1024
s_waitcnt vmcnt(10)
buffer_load_dwordx4 v16,s[28:31],s62 offen lds
s_add_u32 s62,s62,131072
s_add_u32 m0,m0,1024
s_waitcnt vmcnt(10)
buffer_load_dwordx4 v16,s[28:31],s62 offen lds
s_add_u32 s62,s62,131072
s_add_u32 m0,m0,1024
s_waitcnt vmcnt(10)
buffer_load_dwordx4 v16,s[28:31],s62 offen lds
s_add_u32 s62,s62,131072
s_add_u32 m0,m0,1024
s_mov_b32 s64,3145728
buffer_load_dword v29,v31,s[32:35],s64 offen
s_waitcnt vmcnt(10)
buffer_load_dwordx4 v16,s[28:31],s62 offen lds
s_add_u32 s62,s62,131072
s_add_u32 m0,m0,1024
s_waitcnt vmcnt(10)
buffer_load_dwordx4 v16,s[28:31],s62 offen lds
s_add_u32 s62,s62,131072
s_add_u32 m0,m0,1024
s_waitcnt vmcnt(10)
buffer_load_dwordx4 v16,s[28:31],s62 offen lds
s_add_u32 s62,s62,131072
s_add_u32 m0,m0,1024
s_waitcnt vmcnt(10)
buffer_load_dwordx4 v16,s[28:31],s62 offen lds
s_add_u32 s62,s62,131072
s_add_u32 m0,m0,1024
s_waitcnt vmcnt(10)
buffer_load_dwordx4 v16,s[28:31],s62 offen lds
s_add_u32 s62,s62,131072
s_add_u32 m0,m0,1024
s_waitcnt vmcnt(10)
buffer_load_dwordx4 v16,s[28:31],s62 offen lds
s_waitcnt vmcnt(10)
s_waitcnt vmcnt(18)
v_add_u32 v18,s54,v17
ds_read_b64_tr_b16 a[8:9],v18 offset:16384
ds_read_b64_tr_b16 a[10:11],v18 offset:16640
ds_read_b64_tr_b16 a[20:21],v18 offset:18432
ds_read_b64_tr_b16 a[22:23],v18 offset:18688
ds_read_b64_tr_b16 a[32:33],v18 offset:20480
ds_read_b64_tr_b16 a[34:35],v18 offset:20736
ds_read_b64_tr_b16 a[44:45],v18 offset:22528
ds_read_b64_tr_b16 a[46:47],v18 offset:22784
ds_read_b64_tr_b16 a[56:57],v18 offset:24576
ds_read_b64_tr_b16 a[58:59],v18 offset:24832
ds_read_b64_tr_b16 a[68:69],v18 offset:26624
ds_read_b64_tr_b16 a[70:71],v18 offset:26880
s_waitcnt lgkmcnt(0)
ds_read_b64_tr_b16 a[80:81],v18 offset:28672
ds_read_b64_tr_b16 a[82:83],v18 offset:28928
ds_read_b64_tr_b16 a[92:93],v18 offset:30720
ds_read_b64_tr_b16 a[94:95],v18 offset:30976
s_waitcnt lgkmcnt(0)
s_add_u32 s62,s52,2097152
s_add_u32 m0,s61,16384
s_nop 0
buffer_load_dwordx4 v16,s[32:35],s62 offen lds
s_add_u32 s62,s62,131072
s_add_u32 m0,m0,1024
s_waitcnt vmcnt(10)
buffer_load_dwordx4 v16,s[32:35],s62 offen lds
s_add_u32 s62,s62,131072
s_add_u32 m0,m0,1024
s_mov_b32 s64,4194304
buffer_load_dword v29,v28,s[28:31],s64 offen
s_waitcnt vmcnt(10)
buffer_load_dwordx4 v16,s[32:35],s62 offen lds
s_add_u32 s62,s62,131072
s_add_u32 m0,m0,1024
s_waitcnt vmcnt(10)
buffer_load_dwordx4 v16,s[32:35],s62 offen lds
s_add_u32 s62,s62,131072
s_add_u32 m0,m0,1024
s_waitcnt vmcnt(10)
buffer_load_dwordx4 v16,s[32:35],s62 offen lds
s_add_u32 s62,s62,131072
s_add_u32 m0,m0,1024
s_waitcnt vmcnt(10)
buffer_load_dwordx4 v16,s[32:35],s62 offen lds
s_add_u32 s62,s62,131072
s_add_u32 m0,m0,1024
s_mov_b32 s64,4718592
buffer_load_dword v29,v28,s[28:31],s64 offen
s_waitcnt vmcnt(10)
buffer_load_dwordx4 v16,s[32:35],s62 offen lds
s_add_u32 s62,s62,131072
s_add_u32 m0,m0,1024
s_waitcnt vmcnt(10)
buffer_load_dwordx4 v16,s[32:35],s62 offen lds
s_add_u32 s62,s62,131072
s_add_u32 m0,m0,1024
s_waitcnt vmcnt(10)
buffer_load_dwordx4 v16,s[32:35],s62 offen lds
s_add_u32 s62,s62,131072
s_add_u32 m0,m0,1024
s_waitcnt vmcnt(10)
buffer_load_dwordx4 v16,s[32:35],s62 offen lds
s_add_u32 s62,s62,131072
s_add_u32 m0,m0,1024
s_mov_b32 s64,5242880
buffer_load_dword v29,v28,s[28:31],s64 offen
s_waitcnt vmcnt(10)
buffer_load_dwordx4 v16,s[32:35],s62 offen lds
s_add_u32 s62,s62,131072
s_add_u32 m0,m0,1024
s_waitcnt vmcnt(10)
buffer_load_dwordx4 v16,s[32:35],s62 offen lds
s_add_u32 s62,s62,131072
s_add_u32 m0,m0,1024
s_waitcnt vmcnt(10)
buffer_load_dwordx4 v16,s[32:35],s62 offen lds
s_add_u32 s62,s62,131072
s_add_u32 m0,m0,1024
s_waitcnt vmcnt(10)
buffer_load_dwordx4 v16,s[32:35],s62 offen lds
s_add_u32 s62,s62,131072
s_add_u32 m0,m0,1024
s_mov_b32 s64,5767168
buffer_load_dword v29,v28,s[28:31],s64 offen
s_waitcnt vmcnt(10)
buffer_load_dwordx4 v16,s[32:35],s62 offen lds
s_add_u32 s62,s62,131072
s_add_u32 m0,m0,1024
s_waitcnt vmcnt(10)
buffer_load_dwordx4 v16,s[32:35],s62 offen lds
s_waitcnt vmcnt(10)
s_waitcnt vmcnt(20)
ds_read_b64_tr_b16 a[96:97],v17 offset:0
ds_read_b64_tr_b16 a[98:99],v17 offset:256
ds_read_b64_tr_b16 a[100:101],v17 offset:8
ds_read_b64_tr_b16 a[102:103],v17 offset:264
ds_read_b64_tr_b16 a[108:109],v17 offset:2048
ds_read_b64_tr_b16 a[110:111],v17 offset:2304
ds_read_b64_tr_b16 a[112:113],v17 offset:2056
ds_read_b64_tr_b16 a[114:115],v17 offset:2312
ds_read_b64_tr_b16 a[120:121],v17 offset:4096
ds_read_b64_tr_b16 a[122:123],v17 offset:4352
ds_read_b64_tr_b16 a[124:125],v17 offset:4104
ds_read_b64_tr_b16 a[126:127],v17 offset:4360
s_waitcnt lgkmcnt(0)
ds_read_b64_tr_b16 a[132:133],v17 offset:6144
ds_read_b64_tr_b16 a[134:135],v17 offset:6400
ds_read_b64_tr_b16 a[136:137],v17 offset:6152
ds_read_b64_tr_b16 a[138:139],v17 offset:6408
ds_read_b64_tr_b16 a[144:145],v17 offset:8192
ds_read_b64_tr_b16 a[146:147],v17 offset:8448
ds_read_b64_tr_b16 a[148:149],v17 offset:8200
ds_read_b64_tr_b16 a[150:151],v17 offset:8456
ds_read_b64_tr_b16 a[156:157],v17 offset:10240
ds_read_b64_tr_b16 a[158:159],v17 offset:10496
ds_read_b64_tr_b16 a[160:161],v17 offset:10248
ds_read_b64_tr_b16 a[162:163],v17 offset:10504
s_waitcnt lgkmcnt(0)
ds_read_b64_tr_b16 a[168:169],v17 offset:12288
ds_read_b64_tr_b16 a[170:171],v17 offset:12544
ds_read_b64_tr_b16 a[172:173],v17 offset:12296
ds_read_b64_tr_b16 a[174:175],v17 offset:12552
ds_read_b64_tr_b16 a[180:181],v17 offset:14336
ds_read_b64_tr_b16 a[182:183],v17 offset:14592
ds_read_b64_tr_b16 a[184:185],v17 offset:14344
ds_read_b64_tr_b16 a[186:187],v17 offset:14600
s_waitcnt lgkmcnt(0)
s_add_u32 s62,s53,4194304
s_add_u32 m0,s61,0
s_nop 0
buffer_load_dwordx4 v16,s[28:31],s62 offen lds
s_add_u32 s62,s62,131072
s_add_u32 m0,m0,1024
s_waitcnt vmcnt(10)
buffer_load_dwordx4 v16,s[28:31],s62 offen lds
s_add_u32 s62,s62,131072
s_add_u32 m0,m0,1024
s_mov_b32 s64,4194304
buffer_load_dword v29,v31,s[32:35],s64 offen
s_waitcnt vmcnt(10)
buffer_load_dwordx4 v16,s[28:31],s62 offen lds
s_add_u32 s62,s62,131072
s_add_u32 m0,m0,1024
s_waitcnt vmcnt(10)
buffer_load_dwordx4 v16,s[28:31],s62 offen lds
s_add_u32 s62,s62,131072
s_add_u32 m0,m0,1024
s_waitcnt vmcnt(10)
buffer_load_dwordx4 v16,s[28:31],s62 offen lds
s_add_u32 s62,s62,131072
s_add_u32 m0,m0,1024
s_waitcnt vmcnt(10)
buffer_load_dwordx4 v16,s[28:31],s62 offen lds
s_add_u32 s62,s62,131072
s_add_u32 m0,m0,1024
s_waitcnt vmcnt(10)
buffer_load_dwordx4 v16,s[28:31],s62 offen lds
s_add_u32 s62,s62,131072
s_add_u32 m0,m0,1024
s_waitcnt vmcnt(10)
buffer_load_dwordx4 v16,s[28:31],s62 offen lds
s_add_u32 s62,s62,131072
s_add_u32 m0,m0,1024
s_waitcnt vmcnt(10)
buffer_load_dwordx4 v16,s[28:31],s62 offen lds
s_add_u32 s62,s62,131072
s_add_u32 m0,m0,1024
s_waitcnt vmcnt(10)
buffer_load_dwordx4 v16,s[28:31],s62 offen lds
s_add_u32 s62,s62,131072
s_add_u32 m0,m0,1024
s_mov_b32 s64,5242880
buffer_load_dword v29,v31,s[32:35],s64 offen
s_waitcnt vmcnt(10)
buffer_load_dwordx4 v16,s[28:31],s62 offen lds
s_add_u32 s62,s62,131072
s_add_u32 m0,m0,1024
s_waitcnt vmcnt(10)
buffer_load_dwordx4 v16,s[28:31],s62 offen lds
s_add_u32 s62,s62,131072
s_add_u32 m0,m0,1024
s_waitcnt vmcnt(10)
buffer_load_dwordx4 v16,s[28:31],s62 offen lds
s_add_u32 s62,s62,131072
s_add_u32 m0,m0,1024
s_waitcnt vmcnt(10)
buffer_load_dwordx4 v16,s[28:31],s62 offen lds
s_add_u32 s62,s62,131072
s_add_u32 m0,m0,1024
s_waitcnt vmcnt(10)
buffer_load_dwordx4 v16,s[28:31],s62 offen lds
s_add_u32 s62,s62,131072
s_add_u32 m0,m0,1024
s_waitcnt vmcnt(10)
buffer_load_dwordx4 v16,s[28:31],s62 offen lds
s_waitcnt vmcnt(10)
s_waitcnt vmcnt(18)
ds_read_b64_tr_b16 a[104:105],v18 offset:16384
ds_read_b64_tr_b16 a[106:107],v18 offset:16640
ds_read_b64_tr_b16 a[116:117],v18 offset:18432
ds_read_b64_tr_b16 a[118:119],v18 offset:18688
ds_read_b64_tr_b16 a[128:129],v18 offset:20480
ds_read_b64_tr_b16 a[130:131],v18 offset:20736
ds_read_b64_tr_b16 a[140:141],v18 offset:22528
ds_read_b64_tr_b16 a[142:143],v18 offset:22784
ds_read_b64_tr_b16 a[152:153],v18 offset:24576
ds_read_b64_tr_b16 a[154:155],v18 offset:24832
ds_read_b64_tr_b16 a[164:165],v18 offset:26624
ds_read_b64_tr_b16 a[166:167],v18 offset:26880
s_waitcnt lgkmcnt(0)
ds_read_b64_tr_b16 a[176:177],v18 offset:28672
ds_read_b64_tr_b16 a[178:179],v18 offset:28928
ds_read_b64_tr_b16 a[188:189],v18 offset:30720
ds_read_b64_tr_b16 a[190:191],v18 offset:30976
s_waitcnt lgkmcnt(0)
s_add_u32 s62,s52,4194304
s_add_u32 m0,s61,16384
s_nop 0
buffer_load_dwordx4 v16,s[32:35],s62 offen lds
s_add_u32 s62,s62,131072
s_add_u32 m0,m0,1024
s_waitcnt vmcnt(10)
buffer_load_dwordx4 v16,s[32:35],s62 offen lds
s_add_u32 s62,s62,131072
s_add_u32 m0,m0,1024
s_mov_b32 s64,6291456
buffer_load_dword v29,v28,s[28:31],s64 offen
s_waitcnt vmcnt(10)
buffer_load_dwordx4 v16,s[32:35],s62 offen lds
s_add_u32 s62,s62,131072
s_add_u32 m0,m0,1024
s_waitcnt vmcnt(10)
buffer_load_dwordx4 v16,s[32:35],s62 offen lds
s_add_u32 s62,s62,131072
s_add_u32 m0,m0,1024
s_waitcnt vmcnt(10)
buffer_load_dwordx4 v16,s[32:35],s62 offen lds
s_add_u32 s62,s62,131072
s_add_u32 m0,m0,1024
s_waitcnt vmcnt(10)
buffer_load_dwordx4 v16,s[32:35],s62 offen lds
s_add_u32 s62,s62,131072
s_add_u32 m0,m0,1024
s_mov_b32 s64,6815744
buffer_load_dword v29,v28,s[28:31],s64 offen
s_waitcnt vmcnt(10)
buffer_load_dwordx4 v16,s[32:35],s62 offen lds
s_add_u32 s62,s62,131072
s_add_u32 m0,m0,1024
s_waitcnt vmcnt(10)
buffer_load_dwordx4 v16,s[32:35],s62 offen lds
s_add_u32 s62,s62,131072
s_add_u32 m0,m0,1024
s_waitcnt vmcnt(10)
buffer_load_dwordx4 v16,s[32:35],s62 offen lds
s_add_u32 s62,s62,131072
s_add_u32 m0,m0,1024
s_waitcnt vmcnt(10)
buffer_load_dwordx4 v16,s[32:35],s62 offen lds
s_add_u32 s62,s62,131072
s_add_u32 m0,m0,1024
s_mov_b32 s64,7340032
buffer_load_dword v29,v28,s[28:31],s64 offen
s_waitcnt vmcnt(10)
buffer_load_dwordx4 v16,s[32:35],s62 offen lds
s_add_u32 s62,s62,131072
s_add_u32 m0,m0,1024
s_waitcnt vmcnt(10)
buffer_load_dwordx4 v16,s[32:35],s62 offen lds
s_add_u32 s62,s62,131072
s_add_u32 m0,m0,1024
s_waitcnt vmcnt(10)
buffer_load_dwordx4 v16,s[32:35],s62 offen lds
s_add_u32 s62,s62,131072
s_add_u32 m0,m0,1024
s_waitcnt vmcnt(10)
buffer_load_dwordx4 v16,s[32:35],s62 offen lds
s_add_u32 s62,s62,131072
s_add_u32 m0,m0,1024
s_mov_b32 s64,7864320
buffer_load_dword v29,v28,s[28:31],s64 offen
s_waitcnt vmcnt(10)
buffer_load_dwordx4 v16,s[32:35],s62 offen lds
s_add_u32 s62,s62,131072
s_add_u32 m0,m0,1024
s_waitcnt vmcnt(10)
buffer_load_dwordx4 v16,s[32:35],s62 offen lds
s_waitcnt vmcnt(10)
s_waitcnt vmcnt(20)
ds_read_b64_tr_b16 a[192:193],v17 offset:0
ds_read_b64_tr_b16 a[194:195],v17 offset:256
ds_read_b64_tr_b16 a[196:197],v17 offset:8
ds_read_b64_tr_b16 a[198:199],v17 offset:264
ds_read_b64_tr_b16 a[204:205],v17 offset:2048
ds_read_b64_tr_b16 a[206:207],v17 offset:2304
ds_read_b64_tr_b16 a[208:209],v17 offset:2056
ds_read_b64_tr_b16 a[210:211],v17 offset:2312
ds_read_b64_tr_b16 a[216:217],v17 offset:4096
ds_read_b64_tr_b16 a[218:219],v17 offset:4352
ds_read_b64_tr_b16 a[220:221],v17 offset:4104
ds_read_b64_tr_b16 a[222:223],v17 offset:4360
s_waitcnt lgkmcnt(0)
ds_read_b64_tr_b16 a[228:229],v17 offset:6144
ds_read_b64_tr_b16 a[230:231],v17 offset:6400
ds_read_b64_tr_b16 a[232:233],v17 offset:6152
ds_read_b64_tr_b16 a[234:235],v17 offset:6408
ds_read_b64_tr_b16 a[240:241],v17 offset:8192
ds_read_b64_tr_b16 a[242:243],v17 offset:8448
ds_read_b64_tr_b16 a[244:245],v17 offset:8200
ds_read_b64_tr_b16 a[246:247],v17 offset:8456
ds_read_b64_tr_b16 a[252:253],v17 offset:10240
ds_read_b64_tr_b16 a[254:255],v17 offset:10496
ds_read_b64_tr_b16 v[128:129],v17 offset:10248
ds_read_b64_tr_b16 v[130:131],v17 offset:10504
s_waitcnt lgkmcnt(0)
ds_read_b64_tr_b16 v[136:137],v17 offset:12288
ds_read_b64_tr_b16 v[138:139],v17 offset:12544
ds_read_b64_tr_b16 v[140:141],v17 offset:12296
ds_read_b64_tr_b16 v[142:143],v17 offset:12552
ds_read_b64_tr_b16 v[148:149],v17 offset:14336
ds_read_b64_tr_b16 v[150:151],v17 offset:14592
ds_read_b64_tr_b16 v[152:153],v17 offset:14344
ds_read_b64_tr_b16 v[154:155],v17 offset:14600
s_waitcnt lgkmcnt(0)
s_add_u32 s62,s53,6291456
s_add_u32 m0,s61,0
s_nop 0
buffer_load_dwordx4 v16,s[28:31],s62 offen lds
s_add_u32 s62,s62,131072
s_add_u32 m0,m0,1024
s_waitcnt vmcnt(10)
buffer_load_dwordx4 v16,s[28:31],s62 offen lds
s_add_u32 s62,s62,131072
s_add_u32 m0,m0,1024
s_mov_b32 s64,6291456
buffer_load_dword v29,v31,s[32:35],s64 offen
s_waitcnt vmcnt(10)
buffer_load_dwordx4 v16,s[28:31],s62 offen lds
s_add_u32 s62,s62,131072
s_add_u32 m0,m0,1024
s_waitcnt vmcnt(10)
buffer_load_dwordx4 v16,s[28:31],s62 offen lds
s_add_u32 s62,s62,131072
s_add_u32 m0,m0,1024
s_waitcnt vmcnt(10)
buffer_load_dwordx4 v16,s[28:31],s62 offen lds
s_add_u32 s62,s62,131072
s_add_u32 m0,m0,1024
s_waitcnt vmcnt(10)
buffer_load_dwordx4 v16,s[28:31],s62 offen lds
s_add_u32 s62,s62,131072
s_add_u32 m0,m0,1024
s_waitcnt vmcnt(10)
buffer_load_dwordx4 v16,s[28:31],s62 offen lds
s_add_u32 s62,s62,131072
s_add_u32 m0,m0,1024
s_waitcnt vmcnt(10)
buffer_load_dwordx4 v16,s[28:31],s62 offen lds
s_add_u32 s62,s62,131072
s_add_u32 m0,m0,1024
s_waitcnt vmcnt(10)
buffer_load_dwordx4 v16,s[28:31],s62 offen lds
s_add_u32 s62,s62,131072
s_add_u32 m0,m0,1024
s_waitcnt vmcnt(10)
buffer_load_dwordx4 v16,s[28:31],s62 offen lds
s_add_u32 s62,s62,131072
s_add_u32 m0,m0,1024
s_mov_b32 s64,7340032
buffer_load_dword v29,v31,s[32:35],s64 offen
s_waitcnt vmcnt(10)
buffer_load_dwordx4 v16,s[28:31],s62 offen lds
s_add_u32 s62,s62,131072
s_add_u32 m0,m0,1024
s_waitcnt vmcnt(10)
buffer_load_dwordx4 v16,s[28:31],s62 offen lds
s_add_u32 s62,s62,131072
s_add_u32 m0,m0,1024
s_waitcnt vmcnt(10)
buffer_load_dwordx4 v16,s[28:31],s62 offen lds
s_add_u32 s62,s62,131072
s_add_u32 m0,m0,1024
s_waitcnt vmcnt(10)
buffer_load_dwordx4 v16,s[28:31],s62 offen lds
s_add_u32 s62,s62,131072
s_add_u32 m0,m0,1024
s_waitcnt vmcnt(10)
buffer_load_dwordx4 v16,s[28:31],s62 offen lds
s_add_u32 s62,s62,131072
s_add_u32 m0,m0,1024
s_waitcnt vmcnt(10)
buffer_load_dwordx4 v16,s[28:31],s62 offen lds
s_waitcnt vmcnt(10)
s_waitcnt vmcnt(18)
ds_read_b64_tr_b16 a[200:201],v18 offset:16384
ds_read_b64_tr_b16 a[202:203],v18 offset:16640
ds_read_b64_tr_b16 a[212:213],v18 offset:18432
ds_read_b64_tr_b16 a[214:215],v18 offset:18688
ds_read_b64_tr_b16 a[224:225],v18 offset:20480
ds_read_b64_tr_b16 a[226:227],v18 offset:20736
ds_read_b64_tr_b16 a[236:237],v18 offset:22528
ds_read_b64_tr_b16 a[238:239],v18 offset:22784
ds_read_b64_tr_b16 a[248:249],v18 offset:24576
ds_read_b64_tr_b16 a[250:251],v18 offset:24832
ds_read_b64_tr_b16 v[132:133],v18 offset:26624
ds_read_b64_tr_b16 v[134:135],v18 offset:26880
s_waitcnt lgkmcnt(0)
ds_read_b64_tr_b16 v[144:145],v18 offset:28672
ds_read_b64_tr_b16 v[146:147],v18 offset:28928
ds_read_b64_tr_b16 v[156:157],v18 offset:30720
ds_read_b64_tr_b16 v[158:159],v18 offset:30976
s_waitcnt lgkmcnt(0)
s_mov_b32 s92,s2
s_and_b32 s93,s3,0xffff
s_mov_b32 s94,0x100
s_mov_b32 s95,0x20000
v_min_u32 v9,31,v1
v_lshlrev_b32 v9,2,v9
s_sub_u32 s64,s88,64
buffer_load_dword v9,v9,s[92:95],s64 offen sc1
s_add_u32 s62,s52,6291456
s_add_u32 m0,s61,16384
s_nop 0
buffer_load_dwordx4 v16,s[32:35],s62 offen lds
s_add_u32 s62,s62,131072
s_add_u32 m0,m0,1024
s_waitcnt vmcnt(10)
buffer_load_dwordx4 v16,s[32:35],s62 offen lds
s_add_u32 s62,s62,131072
s_add_u32 m0,m0,1024
s_waitcnt vmcnt(10)
buffer_load_dwordx4 v16,s[32:35],s62 offen lds
s_add_u32 s62,s62,131072
s_add_u32 m0,m0,1024
s_waitcnt vmcnt(10)
buffer_load_dwordx4 v16,s[32:35],s62 offen lds
s_add_u32 s62,s62,131072
s_add_u32 m0,m0,1024
s_waitcnt vmcnt(10)
buffer_load_dwordx4 v16,s[32:35],s62 offen lds
s_add_u32 s62,s62,131072
s_add_u32 m0,m0,1024
s_waitcnt vmcnt(10)
buffer_load_dwordx4 v16,s[32:35],s62 offen lds
s_add_u32 s62,s62,131072
s_add_u32 m0,m0,1024
s_waitcnt vmcnt(10)
buffer_load_dwordx4 v16,s[32:35],s62 offen lds
s_add_u32 s62,s62,131072
s_add_u32 m0,m0,1024
s_waitcnt vmcnt(10)
buffer_load_dwordx4 v16,s[32:35],s62 offen lds
s_add_u32 s62,s62,131072
s_add_u32 m0,m0,1024
s_waitcnt vmcnt(10)
buffer_load_dwordx4 v16,s[32:35],s62 offen lds
s_add_u32 s62,s62,131072
s_add_u32 m0,m0,1024
s_waitcnt vmcnt(10)
buffer_load_dwordx4 v16,s[32:35],s62 offen lds
s_add_u32 s62,s62,131072
s_add_u32 m0,m0,1024
s_waitcnt vmcnt(10)
buffer_load_dwordx4 v16,s[32:35],s62 offen lds
s_add_u32 s62,s62,131072
s_add_u32 m0,m0,1024
s_waitcnt vmcnt(10)
buffer_load_dwordx4 v16,s[32:35],s62 offen lds
s_add_u32 s62,s62,131072
s_add_u32 m0,m0,1024
s_waitcnt vmcnt(10)
buffer_load_dwordx4 v16,s[32:35],s62 offen lds
s_add_u32 s62,s62,131072
s_add_u32 m0,m0,1024
s_waitcnt vmcnt(10)
buffer_load_dwordx4 v16,s[32:35],s62 offen lds
s_add_u32 s62,s62,131072
s_add_u32 m0,m0,1024
s_waitcnt vmcnt(10)
buffer_load_dwordx4 v16,s[32:35],s62 offen lds
s_add_u32 s62,s62,131072
s_add_u32 m0,m0,1024
s_waitcnt vmcnt(10)
buffer_load_dwordx4 v16,s[32:35],s62 offen lds
s_waitcnt vmcnt(10)
s_waitcnt vmcnt(17)
ds_read_b64_tr_b16 v[160:161],v17 offset:0
ds_read_b64_tr_b16 v[162:163],v17 offset:256
ds_read_b64_tr_b16 v[164:165],v17 offset:8
ds_read_b64_tr_b16 v[166:167],v17 offset:264
ds_read_b64_tr_b16 v[172:173],v17 offset:2048
ds_read_b64_tr_b16 v[174:175],v17 offset:2304
ds_read_b64_tr_b16 v[176:177],v17 offset:2056
ds_read_b64_tr_b16 v[178:179],v17 offset:2312
ds_read_b64_tr_b16 v[184:185],v17 offset:4096
ds_read_b64_tr_b16 v[186:187],v17 offset:4352
ds_read_b64_tr_b16 v[188:189],v17 offset:4104
ds_read_b64_tr_b16 v[190:191],v17 offset:4360
s_waitcnt lgkmcnt(0)
ds_read_b64_tr_b16 v[196:197],v17 offset:6144
ds_read_b64_tr_b16 v[198:199],v17 offset:6400
ds_read_b64_tr_b16 v[200:201],v17 offset:6152
ds_read_b64_tr_b16 v[202:203],v17 offset:6408
ds_read_b64_tr_b16 v[208:209],v17 offset:8192
ds_read_b64_tr_b16 v[210:211],v17 offset:8448
ds_read_b64_tr_b16 v[212:213],v17 offset:8200
ds_read_b64_tr_b16 v[214:215],v17 offset:8456
ds_read_b64_tr_b16 v[220:221],v17 offset:10240
ds_read_b64_tr_b16 v[222:223],v17 offset:10496
ds_read_b64_tr_b16 v[224:225],v17 offset:10248
ds_read_b64_tr_b16 v[226:227],v17 offset:10504
s_waitcnt lgkmcnt(0)
ds_read_b64_tr_b16 v[232:233],v17 offset:12288
ds_read_b64_tr_b16 v[234:235],v17 offset:12544
ds_read_b64_tr_b16 v[236:237],v17 offset:12296
ds_read_b64_tr_b16 v[238:239],v17 offset:12552
ds_read_b64_tr_b16 v[244:245],v17 offset:14336
ds_read_b64_tr_b16 v[246:247],v17 offset:14592
ds_read_b64_tr_b16 v[248:249],v17 offset:14344
ds_read_b64_tr_b16 v[250:251],v17 offset:14600
s_waitcnt lgkmcnt(0)
s_waitcnt vmcnt(16)
v_and_b32 v10,1,v1
v_cmp_eq_u32 vcc,1,v10
v_mov_b32 v10,8192
s_nop 0
v_cndmask_b32 v10,-1,v10,vcc
v_cmp_eq_u32 vcc,v9,v10
s_and_b32 s64,vcc_lo,0xffff
v_readlane_b32 s65,v9,21
s_cmp_eq_u32 s64,65535
s_cselect_b32 s65,s65,0
s_cmp_eq_u32 s56,2
s_cselect_b32 s65,s65,0
v_readlane_b32 s64,v9,22
s_cmp_ge_u32 s64,63
s_cselect_b32 s65,s65,0
v_readlane_b32 s64,v9,19
s_cmp_ge_u32 s64,64
s_cselect_b32 s65,s65,0
s_and_b32 s64,s65,2
s_lshl_b32 s64,s64,12
s_or_b32 s64,s64,1
s_cmp_eq_u32 s65,0
s_cselect_b32 s65,0,s64
v_mov_b32 v10,131072
s_cmp_lg_u32 s50,0
s_cbranch_scc1 avs_49
v_and_b32 v9,3,v1
v_mad_u32_u24 v10,v9,64,0
v_lshlrev_b32 v10,7,v10
v_add_u32 v10,131072,v10
v_mov_b32 v9,s65
ds_write_b32 v10,v9
s_waitcnt lgkmcnt(0)
avs_49:
s_mul_i32 s64,s50,8192
s_add_u32 s64,s64,131072
v_mov_b32 v10,s64
s_barrier
ds_read_b32 v9,v10
s_waitcnt lgkmcnt(0)
v_readfirstlane_b32 s89,v9
s_cmp_eq_u32 s89,0
s_cbranch_scc1 qe_47
s_lshl_b32 s64,s50,13
s_add_u32 m0,s64,131072
s_add_u32 s64,s64,146800640
s_add_u32 s65,s64,4096
v_lshlrev_b32 v0,4,v1
buffer_load_dwordx4 v0,s[20:23],s64 offen offset:0 lds
buffer_load_dwordx4 v0,s[20:23],s64 offen offset:1024 lds
buffer_load_dwordx4 v0,s[20:23],s64 offen offset:2048 lds
buffer_load_dwordx4 v0,s[20:23],s64 offen offset:3072 lds
s_add_u32 m0,m0,4096
s_nop 0
buffer_load_dwordx4 v0,s[20:23],s65 offen offset:0 lds
buffer_load_dwordx4 v0,s[20:23],s65 offen offset:1024 lds
buffer_load_dwordx4 v0,s[20:23],s65 offen offset:2048 lds
buffer_load_dwordx4 v0,s[20:23],s65 offen offset:3072 lds
s_waitcnt vmcnt(8)
s_branch qj_48
qe_47:
s_waitcnt vmcnt(0)
qj_48:
ds_read_b64_tr_b16 v[168:169],v18 offset:16384
ds_read_b64_tr_b16 v[170:171],v18 offset:16640
ds_read_b64_tr_b16 v[180:181],v18 offset:18432
ds_read_b64_tr_b16 v[182:183],v18 offset:18688
ds_read_b64_tr_b16 v[192:193],v18 offset:20480
ds_read_b64_tr_b16 v[194:195],v18 offset:20736
ds_read_b64_tr_b16 v[204:205],v18 offset:22528
ds_read_b64_tr_b16 v[206:207],v18 offset:22784
ds_read_b64_tr_b16 v[216:217],v18 offset:24576
ds_read_b64_tr_b16 v[218:219],v18 offset:24832
ds_read_b64_tr_b16 v[228:229],v18 offset:26624
ds_read_b64_tr_b16 v[230:231],v18 offset:26880
s_waitcnt lgkmcnt(0)
ds_read_b64_tr_b16 v[240:241],v18 offset:28672
ds_read_b64_tr_b16 v[242:243],v18 offset:28928
ds_read_b64_tr_b16 v[252:253],v18 offset:30720
ds_read_b64_tr_b16 v[254:255],v18 offset:30976
s_waitcnt lgkmcnt(0)
s_cmp_eq_u32 s89,0
s_cbranch_scc1 avn_50
s_mov_b32 s56,0
s_and_b32 s67,s89,0x2000
s_branch avj_51
avn_50:
s_mov_b32 s92,s2
s_and_b32 s93,s3,0xffff
s_mov_b32 s94,0x100
s_mov_b32 s95,0x20000
v_mbcnt_lo_u32_b32 v16,-1,0
v_mbcnt_hi_u32_b32 v16,-1,v16
v_mov_b32 v18,0
v_cmp_eq_u32 vcc,22,v16
s_nop 1
v_cndmask_b32 v18,v18,63,vcc
v_cmp_eq_u32 vcc,19,v16
s_nop 1
v_cndmask_b32 v18,v18,64,vcc
v_cmp_eq_u32 vcc,21,v16
s_nop 1
v_cndmask_b32 v18,v18,1,vcc
v_and_b32 v19,1,v16
v_cmp_eq_u32 vcc,1,v19
v_mov_b32 v19,8192
s_nop 0
v_cndmask_b32 v19,-1,v19,vcc
v_min_u32 v16,31,v16
v_lshlrev_b32 v16,2,v16
s_sub_u32 s66,s88,64
s_cmp_lg_u32 s50,0
s_cbranch_scc1 vot_56
vpoll_52:
buffer_load_dword v17,v16,s[92:95],s66 offen sc1
s_waitcnt vmcnt(0)
s_cmp_lg_u32 s56,2
s_cbranch_scc1 vck_53
v_cmp_eq_u32 vcc,v17,v19
s_and_b32 s64,vcc_lo,0xffff
s_cmp_eq_u32 s64,65535
s_cbranch_scc1 vck_53
s_mov_b32 s65,0
v_readlane_b32 s64,v17,1
s_lshr_b32 s64,s64,8
s_add_u32 s65,s65,s64
v_readlane_b32 s64,v17,3
s_lshr_b32 s64,s64,8
s_add_u32 s65,s65,s64
v_readlane_b32 s64,v17,5
s_lshr_b32 s64,s64,8
s_add_u32 s65,s65,s64
v_readlane_b32 s64,v17,7
s_lshr_b32 s64,s64,8
s_add_u32 s65,s65,s64
v_readlane_b32 s64,v17,9
s_lshr_b32 s64,s64,8
s_add_u32 s65,s65,s64
v_readlane_b32 s64,v17,11
s_lshr_b32 s64,s64,8
s_add_u32 s65,s65,s64
v_readlane_b32 s64,v17,13
s_lshr_b32 s64,s64,8
s_add_u32 s65,s65,s64
v_readlane_b32 s64,v17,15
s_lshr_b32 s64,s64,8
s_add_u32 s65,s65,s64
s_cmp_ge_u32 s65,256
s_cbranch_scc1 vok_55
s_branch vrt_54
vck_53:
v_cmp_gt_u32 vcc,v18,v17
s_cbranch_vccz vok_55
vrt_54:
s_sleep 8
s_sub_u32 s90,s90,1
s_cmp_gt_i32 s90,0
s_cbranch_scc1 vpoll_52
vok_55:
v_add_u32 v18,160768,v16
ds_write_b32 v18,v17
s_waitcnt lgkmcnt(0)
vot_56:
s_barrier
v_add_u32 v18,160768,v16
ds_read_b32 v17,v18
s_waitcnt lgkmcnt(0)
s_cmp_lg_u32 s56,2
s_cbranch_scc1 vfin_57
v_cmp_eq_u32 vcc,v17,v19
s_and_b32 s64,vcc_lo,0xffff
s_cmp_eq_u32 s64,65535
s_cbranch_scc1 vfin_57
s_mov_b32 s65,0
v_readlane_b32 s64,v17,1
s_lshr_b32 s64,s64,8
s_add_u32 s65,s65,s64
v_readlane_b32 s64,v17,3
s_lshr_b32 s64,s64,8
s_add_u32 s65,s65,s64
v_readlane_b32 s64,v17,5
s_lshr_b32 s64,s64,8
s_add_u32 s65,s65,s64
v_readlane_b32 s64,v17,7
s_lshr_b32 s64,s64,8
s_add_u32 s65,s65,s64
v_readlane_b32 s64,v17,9
s_lshr_b32 s64,s64,8
s_add_u32 s65,s65,s64
v_readlane_b32 s64,v17,11
s_lshr_b32 s64,s64,8
s_add_u32 s65,s65,s64
v_readlane_b32 s64,v17,13
s_lshr_b32 s64,s64,8
s_add_u32 s65,s65,s64
v_readlane_b32 s64,v17,15
s_lshr_b32 s64,s64,8
s_add_u32 s65,s65,s64
s_cmp_ge_u32 s65,256
s_cbranch_scc1 fl_fb
vfin_57:
s_and_b32 s56,s56,1
s_mov_b32 s67,0
v_readlane_b32 s65,v17,21
s_and_b32 s65,s65,2
s_lshl_b32 s67,s65,12
s_barrier
s_lshl_b32 s64,s50,13
s_add_u32 m0,s64,131072
s_add_u32 s64,s64,146800640
s_add_u32 s65,s64,4096
v_lshlrev_b32 v0,4,v1
buffer_load_dwordx4 v0,s[20:23],s64 offen offset:0 lds
buffer_load_dwordx4 v0,s[20:23],s64 offen offset:1024 lds
buffer_load_dwordx4 v0,s[20:23],s64 offen offset:2048 lds
buffer_load_dwordx4 v0,s[20:23],s64 offen offset:3072 lds
s_add_u32 m0,m0,4096
s_nop 0
buffer_load_dwordx4 v0,s[20:23],s65 offen offset:0 lds
buffer_load_dwordx4 v0,s[20:23],s65 offen offset:1024 lds
buffer_load_dwordx4 v0,s[20:23],s65 offen offset:2048 lds
buffer_load_dwordx4 v0,s[20:23],s65 offen offset:3072 lds
avj_51:
s_barrier
v_lshlrev_b32 v0,4,v1
s_mov_b32 s60,0
s_lshl_b32 s63,s50,13
s_add_u32 s61,s63,146800640
s_mov_b32 s70,0
s_lshl_b32 s52,s59,14
s_and_b32 s64,s50,1
s_lshl_b32 s64,s64,11
s_add_u32 s53,s52,s64
s_lshl_b32 s64,s50,10
s_add_u32 s52,s52,s64
s_add_u32 s52,s52,4096
s_cmp_gt_u32 s50,1
s_cselect_b32 s54,0x2000,0
s_lshl_b32 s69,s59,6
s_add_u32 s69,s69,s67
s_add_u32 s69,s69,138412032
v_mov_b32 v4,v0
v_add_u32 v5,32768,v0
s_add_u32 s61,s61,32768
v_add_u32 v4,131072,v0
v_mov_b32 v5,v0
s_add_u32 m0,s70,s63
s_add_u32 s62,s61,4096
buffer_load_dwordx4 v0,s[20:23],s61 offen offset:0 lds
buffer_load_dwordx4 v0,s[20:23],s61 offen offset:1024 lds
buffer_load_dwordx4 v0,s[20:23],s61 offen offset:2048 lds
buffer_load_dwordx4 v0,s[20:23],s61 offen offset:3072 lds
s_add_u32 m0,m0,4096
s_nop 0
buffer_load_dwordx4 v0,s[20:23],s62 offen offset:0 lds
buffer_load_dwordx4 v0,s[20:23],s62 offen offset:1024 lds
buffer_load_dwordx4 v0,s[20:23],s62 offen offset:2048 lds
buffer_load_dwordx4 v0,s[20:23],s62 offen offset:3072 lds
s_add_u32 s61,s61,32768
s_add_u32 s70,s70,32768
s_and_b32 s70,s70,0x1ffff
s_waitcnt vmcnt(8)
s_barrier
ds_read_b128 v[64:67],v4 offset:0
ds_read_b128 v[68:71],v4 offset:1024
ds_read_b128 v[72:75],v4 offset:2048
ds_read_b128 v[76:79],v4 offset:3072
ds_read_b128 v[80:83],v4 offset:4096
top_58:
s_waitcnt lgkmcnt(4)
v_mfma_f32_16x16x32_bf16 v[32:35],a[0:3],v[64:67],0
ds_read_b128 v[84:87],v4 offset:5120
v_mfma_f32_16x16x32_bf16 v[36:39],a[4:7],v[64:67],0
v_mfma_f32_16x16x32_bf16 v[40:43],v[64:67],a[8:11],0
s_waitcnt lgkmcnt(4)
v_mfma_f32_16x16x32_bf16 v[32:35],a[12:15],v[68:71],v[32:35]
ds_read_b128 v[88:91],v4 offset:6144
s_sub_u32 s66,s60,1
s_lshr_b32 s64,s66,1
v_mfma_f32_16x16x32_bf16 v[36:39],a[16:19],v[68:71],v[36:39]
s_lshl_b32 s65,s64,12
s_and_b32 s65,s65,0x2000
v_mfma_f32_16x16x32_bf16 v[40:43],v[68:71],a[20:23],v[40:43]
s_xor_b32 s65,s65,s67
s_lshl_b32 s64,s64,20
s_waitcnt lgkmcnt(4)
v_mfma_f32_16x16x32_bf16 v[32:35],a[24:27],v[72:75],v[32:35]
ds_read_b128 v[92:95],v4 offset:7168
s_add_u32 s64,s64,s65
s_add_u32 s65,s64,s52
v_mfma_f32_16x16x32_bf16 v[36:39],a[28:31],v[72:75],v[36:39]
s_xor_b32 s64,s64,s54
s_add_u32 s66,s64,s53
v_mfma_f32_16x16x32_bf16 v[40:43],v[72:75],a[32:35],v[40:43]
s_cmp_eq_u32 s60,0
s_cselect_b32 s65,138608640,s65
s_waitcnt lgkmcnt(4)
v_mfma_f32_16x16x32_bf16 v[32:35],a[36:39],v[76:79],v[32:35]
ds_read_b128 v[96:99],v4 offset:8192
s_cselect_b32 s66,138608640,s66
v_mfma_f32_16x16x32_bf16 v[36:39],a[40:43],v[76:79],v[36:39]
v_cvt_pk_bf16_f32 v60,v44,v45
v_mfma_f32_16x16x32_bf16 v[40:43],v[76:79],a[44:47],v[40:43]
v_cvt_pk_bf16_f32 v61,v46,v47
s_waitcnt lgkmcnt(4)
v_mfma_f32_16x16x32_bf16 v[32:35],a[48:51],v[80:83],v[32:35]
ds_read_b128 v[100:103],v4 offset:9216
v_cvt_pk_bf16_f32 v62,v48,v49
v_mfma_f32_16x16x32_bf16 v[36:39],a[52:55],v[80:83],v[36:39]
v_cvt_pk_bf16_f32 v63,v50,v51
v_mfma_f32_16x16x32_bf16 v[40:43],v[80:83],a[56:59],v[40:43]
v_cvt_pk_bf16_f32 v58,v52,v53
s_waitcnt lgkmcnt(4)
v_mfma_f32_16x16x32_bf16 v[32:35],a[60:63],v[84:87],v[32:35]
ds_read_b128 v[104:107],v4 offset:10240
v_cvt_pk_bf16_f32 v59,v54,v55
v_mfma_f32_16x16x32_bf16 v[36:39],a[64:67],v[84:87],v[36:39]
buffer_store_dwordx4 v[60:63],v0,s[20:23],s66 offen offset:1024 sc1
v_mfma_f32_16x16x32_bf16 v[40:43],v[84:87],a[68:71],v[40:43]
buffer_store_dwordx4 v[56:59],v0,s[20:23],s65 offen sc1
s_waitcnt lgkmcnt(4)
v_mfma_f32_16x16x32_bf16 v[32:35],a[72:75],v[88:91],v[32:35]
ds_read_b128 v[108:111],v4 offset:11264
v_mfma_f32_16x16x32_bf16 v[36:39],a[76:79],v[88:91],v[36:39]
v_mfma_f32_16x16x32_bf16 v[40:43],v[88:91],a[80:83],v[40:43]
s_waitcnt lgkmcnt(4)
v_mfma_f32_16x16x32_bf16 v[32:35],a[84:87],v[92:95],v[32:35]
ds_read_b128 v[112:115],v4 offset:12288
v_mfma_f32_16x16x32_bf16 v[36:39],a[88:91],v[92:95],v[36:39]
v_mfma_f32_16x16x32_bf16 v[40:43],v[92:95],a[92:95],v[40:43]
s_waitcnt lgkmcnt(4)
v_mfma_f32_16x16x32_bf16 v[32:35],a[96:99],v[96:99],v[32:35]
ds_read_b128 v[116:119],v4 offset:13312
v_mfma_f32_16x16x32_bf16 v[36:39],a[100:103],v[96:99],v[36:39]
v_mfma_f32_16x16x32_bf16 v[40:43],v[96:99],a[104:107],v[40:43]
s_waitcnt lgkmcnt(4)
v_mfma_f32_16x16x32_bf16 v[32:35],a[108:111],v[100:103],v[32:35]
ds_read_b128 v[120:123],v4 offset:14336
v_mfma_f32_16x16x32_bf16 v[36:39],a[112:115],v[100:103],v[36:39]
v_mfma_f32_16x16x32_bf16 v[40:43],v[100:103],a[116:119],v[40:43]
s_waitcnt lgkmcnt(4)
v_mfma_f32_16x16x32_bf16 v[32:35],a[120:123],v[104:107],v[32:35]
ds_read_b128 v[124:127],v4 offset:15360
v_mfma_f32_16x16x32_bf16 v[36:39],a[124:127],v[104:107],v[36:39]
v_mfma_f32_16x16x32_bf16 v[40:43],v[104:107],a[128:131],v[40:43]
s_waitcnt lgkmcnt(4)
v_mfma_f32_16x16x32_bf16 v[32:35],a[132:135],v[108:111],v[32:35]
ds_read_b128 v[64:67],v4 offset:16384
v_mfma_f32_16x16x32_bf16 v[36:39],a[136:139],v[108:111],v[36:39]
v_mfma_f32_16x16x32_bf16 v[40:43],v[108:111],a[140:143],v[40:43]
s_waitcnt lgkmcnt(4)
v_mfma_f32_16x16x32_bf16 v[32:35],a[144:147],v[112:115],v[32:35]
ds_read_b128 v[68:71],v4 offset:17408
v_mfma_f32_16x16x32_bf16 v[36:39],a[148:151],v[112:115],v[36:39]
v_mfma_f32_16x16x32_bf16 v[40:43],v[112:115],a[152:155],v[40:43]
s_waitcnt lgkmcnt(4)
v_mfma_f32_16x16x32_bf16 v[32:35],a[156:159],v[116:119],v[32:35]
ds_read_b128 v[72:75],v4 offset:18432
v_mfma_f32_16x16x32_bf16 v[36:39],a[160:163],v[116:119],v[36:39]
v_mfma_f32_16x16x32_bf16 v[40:43],v[116:119],a[164:167],v[40:43]
s_waitcnt lgkmcnt(4)
v_mfma_f32_16x16x32_bf16 v[32:35],a[168:171],v[120:123],v[32:35]
ds_read_b128 v[76:79],v4 offset:19456
v_mfma_f32_16x16x32_bf16 v[36:39],a[172:175],v[120:123],v[36:39]
v_mfma_f32_16x16x32_bf16 v[40:43],v[120:123],a[176:179],v[40:43]
s_waitcnt lgkmcnt(4)
v_mfma_f32_16x16x32_bf16 v[32:35],a[180:183],v[124:127],v[32:35]
ds_read_b128 v[80:83],v4 offset:20480
v_mfma_f32_16x16x32_bf16 v[36:39],a[184:187],v[124:127],v[36:39]
s_waitcnt vmcnt(2)
s_cmp_eq_u32 s60,60
s_cbranch_scc1 hb_61
s_cmp_eq_u32 s60,16
s_cbranch_scc1 hc_63
hb2_62:
s_sub_u32 s64,s60,2
s_cmp_gt_u32 s64,128
s_cbranch_scc1 sk_60
s_waitcnt vmcnt(0)
sk_60:
s_cselect_b32 s64,1,s50
s_barrier
s_cmp_ge_u32 s60,126
s_cselect_b32 s61,146800640,s61
s_cmp_lg_u32 s64,0
s_cbranch_scc1 nf_59
s_lshr_b32 s64,s60,1
v_mov_b32 v6,s64
s_mov_b64 exec,1
buffer_store_dword v6,off,s[20:23],s69 sc1
s_mov_b64 exec,-1
nf_59:
v_mfma_f32_16x16x32_bf16 v[40:43],v[124:127],a[188:191],v[40:43]
s_waitcnt lgkmcnt(4)
v_mfma_f32_16x16x32_bf16 v[32:35],a[192:195],v[64:67],v[32:35]
ds_read_b128 v[84:87],v4 offset:21504
s_add_u32 m0,s70,s63
v_mfma_f32_16x16x32_bf16 v[36:39],a[196:199],v[64:67],v[36:39]
v_mfma_f32_16x16x32_bf16 v[40:43],v[64:67],a[200:203],v[40:43]
s_add_u32 s62,s61,4096
s_waitcnt lgkmcnt(4)
v_mfma_f32_16x16x32_bf16 v[32:35],a[204:207],v[68:71],v[32:35]
ds_read_b128 v[88:91],v4 offset:22528
v_mfma_f32_16x16x32_bf16 v[36:39],a[208:211],v[68:71],v[36:39]
buffer_load_dwordx4 v0,s[20:23],s61 offen offset:0 lds
v_mfma_f32_16x16x32_bf16 v[40:43],v[68:71],a[212:215],v[40:43]
s_waitcnt lgkmcnt(4)
v_mfma_f32_16x16x32_bf16 v[32:35],a[216:219],v[72:75],v[32:35]
ds_read_b128 v[92:95],v4 offset:23552
buffer_load_dwordx4 v0,s[20:23],s61 offen offset:1024 lds
v_mfma_f32_16x16x32_bf16 v[36:39],a[220:223],v[72:75],v[36:39]
v_mfma_f32_16x16x32_bf16 v[40:43],v[72:75],a[224:227],v[40:43]
buffer_load_dwordx4 v0,s[20:23],s61 offen offset:2048 lds
s_waitcnt lgkmcnt(4)
v_mfma_f32_16x16x32_bf16 v[32:35],a[228:231],v[76:79],v[32:35]
ds_read_b128 v[96:99],v4 offset:24576
v_mfma_f32_16x16x32_bf16 v[36:39],a[232:235],v[76:79],v[36:39]
buffer_load_dwordx4 v0,s[20:23],s61 offen offset:3072 lds
v_mfma_f32_16x16x32_bf16 v[40:43],v[76:79],a[236:239],v[40:43]
s_waitcnt lgkmcnt(4)
v_mfma_f32_16x16x32_bf16 v[32:35],a[240:243],v[80:83],v[32:35]
ds_read_b128 v[100:103],v4 offset:25600
s_add_u32 m0,m0,4096
v_mfma_f32_16x16x32_bf16 v[36:39],a[244:247],v[80:83],v[36:39]
v_mfma_f32_16x16x32_bf16 v[40:43],v[80:83],a[248:251],v[40:43]
buffer_load_dwordx4 v0,s[20:23],s62 offen offset:0 lds
s_waitcnt lgkmcnt(4)
v_mfma_f32_16x16x32_bf16 v[32:35],a[252:255],v[84:87],v[32:35]
ds_read_b128 v[104:107],v4 offset:26624
v_mfma_f32_16x16x32_bf16 v[36:39],v[128:131],v[84:87],v[36:39]
buffer_load_dwordx4 v0,s[20:23],s62 offen offset:1024 lds
v_mfma_f32_16x16x32_bf16 v[40:43],v[84:87],v[132:135],v[40:43]
s_waitcnt lgkmcnt(4)
v_mfma_f32_16x16x32_bf16 v[32:35],v[136:139],v[88:91],v[32:35]
ds_read_b128 v[108:111],v4 offset:27648
buffer_load_dwordx4 v0,s[20:23],s62 offen offset:2048 lds
v_mfma_f32_16x16x32_bf16 v[36:39],v[140:143],v[88:91],v[36:39]
v_mfma_f32_16x16x32_bf16 v[40:43],v[88:91],v[144:147],v[40:43]
buffer_load_dwordx4 v0,s[20:23],s62 offen offset:3072 lds
s_waitcnt lgkmcnt(4)
v_mfma_f32_16x16x32_bf16 v[32:35],v[148:151],v[92:95],v[32:35]
ds_read_b128 v[112:115],v4 offset:28672
v_mfma_f32_16x16x32_bf16 v[36:39],v[152:155],v[92:95],v[36:39]
s_add_u32 s61,s61,32768
v_mfma_f32_16x16x32_bf16 v[40:43],v[92:95],v[156:159],v[40:43]
s_waitcnt lgkmcnt(4)
v_mfma_f32_16x16x32_bf16 v[32:35],v[160:163],v[96:99],v[32:35]
ds_read_b128 v[116:119],v4 offset:29696
s_add_u32 s70,s70,32768
v_mfma_f32_16x16x32_bf16 v[36:39],v[164:167],v[96:99],v[36:39]
v_mfma_f32_16x16x32_bf16 v[40:43],v[96:99],v[168:171],v[40:43]
s_and_b32 s70,s70,0x1ffff
s_waitcnt lgkmcnt(4)
v_mfma_f32_16x16x32_bf16 v[32:35],v[172:175],v[100:103],v[32:35]
ds_read_b128 v[120:123],v4 offset:30720
v_mfma_f32_16x16x32_bf16 v[36:39],v[176:179],v[100:103],v[36:39]
v_mfma_f32_16x16x32_bf16 v[40:43],v[100:103],v[180:183],v[40:43]
s_waitcnt lgkmcnt(4)
v_mfma_f32_16x16x32_bf16 v[32:35],v[184:187],v[104:107],v[32:35]
ds_read_b128 v[124:127],v4 offset:31744
v_mfma_f32_16x16x32_bf16 v[36:39],v[188:191],v[104:107],v[36:39]
v_mfma_f32_16x16x32_bf16 v[40:43],v[104:107],v[192:195],v[40:43]
s_waitcnt lgkmcnt(4)
v_mfma_f32_16x16x32_bf16 v[32:35],v[196:199],v[108:111],v[32:35]
ds_read_b128 v[64:67],v5 offset:0
v_mfma_f32_16x16x32_bf16 v[36:39],v[200:203],v[108:111],v[36:39]
v_mfma_f32_16x16x32_bf16 v[40:43],v[108:111],v[204:207],v[40:43]
s_waitcnt lgkmcnt(4)
v_mfma_f32_16x16x32_bf16 v[32:35],v[208:211],v[112:115],v[32:35]
ds_read_b128 v[68:71],v5 offset:1024
v_mfma_f32_16x16x32_bf16 v[36:39],v[212:215],v[112:115],v[36:39]
v_mfma_f32_16x16x32_bf16 v[40:43],v[112:115],v[216:219],v[40:43]
s_waitcnt lgkmcnt(4)
v_mfma_f32_16x16x32_bf16 v[32:35],v[220:223],v[116:119],v[32:35]
ds_read_b128 v[72:75],v5 offset:2048
v_mfma_f32_16x16x32_bf16 v[36:39],v[224:227],v[116:119],v[36:39]
v_mfma_f32_16x16x32_bf16 v[40:43],v[116:119],v[228:231],v[40:43]
s_waitcnt lgkmcnt(4)
v_mfma_f32_16x16x32_bf16 v[32:35],v[232:235],v[120:123],v[32:35]
ds_read_b128 v[76:79],v5 offset:3072
v_mfma_f32_16x16x32_bf16 v[36:39],v[236:239],v[120:123],v[36:39]
v_mfma_f32_16x16x32_bf16 v[40:43],v[120:123],v[240:243],v[40:43]
s_waitcnt lgkmcnt(4)
v_mfma_f32_16x16x32_bf16 v[32:35],v[244:247],v[124:127],v[32:35]
ds_read_b128 v[80:83],v5 offset:4096
v_mfma_f32_16x16x32_bf16 v[36:39],v[248:251],v[124:127],v[36:39]
v_mfma_f32_16x16x32_bf16 v[40:43],v[124:127],v[252:255],v[40:43]
v_mov_b32 v4,v5
v_add_u32 v5,32768,v5
v_and_b32 v5,0x1ffff,v5
s_add_u32 s60,s60,1
s_waitcnt lgkmcnt(4)
v_mfma_f32_16x16x32_bf16 v[44:47],a[0:3],v[64:67],0
ds_read_b128 v[84:87],v4 offset:5120
v_mfma_f32_16x16x32_bf16 v[48:51],a[4:7],v[64:67],0
v_mfma_f32_16x16x32_bf16 v[52:55],v[64:67],a[8:11],0
s_waitcnt lgkmcnt(4)
v_mfma_f32_16x16x32_bf16 v[44:47],a[12:15],v[68:71],v[44:47]
ds_read_b128 v[88:91],v4 offset:6144
s_sub_u32 s66,s60,1
s_lshr_b32 s64,s66,1
v_mfma_f32_16x16x32_bf16 v[48:51],a[16:19],v[68:71],v[48:51]
s_lshl_b32 s65,s64,12
s_and_b32 s65,s65,0x2000
v_mfma_f32_16x16x32_bf16 v[52:55],v[68:71],a[20:23],v[52:55]
s_xor_b32 s65,s65,s67
s_lshl_b32 s64,s64,20
s_waitcnt lgkmcnt(4)
v_mfma_f32_16x16x32_bf16 v[44:47],a[24:27],v[72:75],v[44:47]
ds_read_b128 v[92:95],v4 offset:7168
s_add_u32 s64,s64,s65
s_add_u32 s65,s64,s52
v_mfma_f32_16x16x32_bf16 v[48:51],a[28:31],v[72:75],v[48:51]
s_xor_b32 s64,s64,s54
s_add_u32 s66,s64,s53
v_mfma_f32_16x16x32_bf16 v[52:55],v[72:75],a[32:35],v[52:55]
v_cvt_pk_bf16_f32 v60,v32,v33
v_cvt_pk_bf16_f32 v61,v34,v35
s_waitcnt lgkmcnt(4)
v_mfma_f32_16x16x32_bf16 v[44:47],a[36:39],v[76:79],v[44:47]
ds_read_b128 v[96:99],v4 offset:8192
v_cvt_pk_bf16_f32 v62,v36,v37
v_mfma_f32_16x16x32_bf16 v[48:51],a[40:43],v[76:79],v[48:51]
v_cvt_pk_bf16_f32 v63,v38,v39
v_mfma_f32_16x16x32_bf16 v[52:55],v[76:79],a[44:47],v[52:55]
v_cvt_pk_bf16_f32 v56,v40,v41
s_waitcnt lgkmcnt(4)
v_mfma_f32_16x16x32_bf16 v[44:47],a[48:51],v[80:83],v[44:47]
ds_read_b128 v[100:103],v4 offset:9216
v_cvt_pk_bf16_f32 v57,v42,v43
v_mfma_f32_16x16x32_bf16 v[48:51],a[52:55],v[80:83],v[48:51]
buffer_store_dwordx4 v[60:63],v0,s[20:23],s66 offen offset:0 sc1
v_mfma_f32_16x16x32_bf16 v[52:55],v[80:83],a[56:59],v[52:55]
s_waitcnt lgkmcnt(4)
v_mfma_f32_16x16x32_bf16 v[44:47],a[60:63],v[84:87],v[44:47]
ds_read_b128 v[104:107],v4 offset:10240
v_mfma_f32_16x16x32_bf16 v[48:51],a[64:67],v[84:87],v[48:51]
v_mfma_f32_16x16x32_bf16 v[52:55],v[84:87],a[68:71],v[52:55]
s_waitcnt lgkmcnt(4)
v_mfma_f32_16x16x32_bf16 v[44:47],a[72:75],v[88:91],v[44:47]
ds_read_b128 v[108:111],v4 offset:11264
v_mfma_f32_16x16x32_bf16 v[48:51],a[76:79],v[88:91],v[48:51]
v_mfma_f32_16x16x32_bf16 v[52:55],v[88:91],a[80:83],v[52:55]
s_waitcnt lgkmcnt(4)
v_mfma_f32_16x16x32_bf16 v[44:47],a[84:87],v[92:95],v[44:47]
ds_read_b128 v[112:115],v4 offset:12288
v_mfma_f32_16x16x32_bf16 v[48:51],a[88:91],v[92:95],v[48:51]
v_mfma_f32_16x16x32_bf16 v[52:55],v[92:95],a[92:95],v[52:55]
s_waitcnt lgkmcnt(4)
v_mfma_f32_16x16x32_bf16 v[44:47],a[96:99],v[96:99],v[44:47]
ds_read_b128 v[116:119],v4 offset:13312
v_mfma_f32_16x16x32_bf16 v[48:51],a[100:103],v[96:99],v[48:51]
v_mfma_f32_16x16x32_bf16 v[52:55],v[96:99],a[104:107],v[52:55]
s_waitcnt lgkmcnt(4)
v_mfma_f32_16x16x32_bf16 v[44:47],a[108:111],v[100:103],v[44:47]
ds_read_b128 v[120:123],v4 offset:14336
v_mfma_f32_16x16x32_bf16 v[48:51],a[112:115],v[100:103],v[48:51]
v_mfma_f32_16x16x32_bf16 v[52:55],v[100:103],a[116:119],v[52:55]
s_waitcnt lgkmcnt(4)
v_mfma_f32_16x16x32_bf16 v[44:47],a[120:123],v[104:107],v[44:47]
ds_read_b128 v[124:127],v4 offset:15360
v_mfma_f32_16x16x32_bf16 v[48:51],a[124:127],v[104:107],v[48:51]
v_mfma_f32_16x16x32_bf16 v[52:55],v[104:107],a[128:131],v[52:55]
s_waitcnt lgkmcnt(4)
v_mfma_f32_16x16x32_bf16 v[44:47],a[132:135],v[108:111],v[44:47]
ds_read_b128 v[64:67],v4 offset:16384
v_mfma_f32_16x16x32_bf16 v[48:51],a[136:139],v[108:111],v[48:51]
v_mfma_f32_16x16x32_bf16 v[52:55],v[108:111],a[140:143],v[52:55]
s_waitcnt lgkmcnt(4)
v_mfma_f32_16x16x32_bf16 v[44:47],a[144:147],v[112:115],v[44:47]
ds_read_b128 v[68:71],v4 offset:17408
v_mfma_f32_16x16x32_bf16 v[48:51],a[148:151],v[112:115],v[48:51]
v_mfma_f32_16x16x32_bf16 v[52:55],v[112:115],a[152:155],v[52:55]
s_waitcnt lgkmcnt(4)
v_mfma_f32_16x16x32_bf16 v[44:47],a[156:159],v[116:119],v[44:47]
ds_read_b128 v[72:75],v4 offset:18432
v_mfma_f32_16x16x32_bf16 v[48:51],a[160:163],v[116:119],v[48:51]
v_mfma_f32_16x16x32_bf16 v[52:55],v[116:119],a[164:167],v[52:55]
s_waitcnt lgkmcnt(4)
v_mfma_f32_16x16x32_bf16 v[44:47],a[168:171],v[120:123],v[44:47]
ds_read_b128 v[76:79],v4 offset:19456
v_mfma_f32_16x16x32_bf16 v[48:51],a[172:175],v[120:123],v[48:51]
v_mfma_f32_16x16x32_bf16 v[52:55],v[120:123],a[176:179],v[52:55]
s_waitcnt lgkmcnt(4)
v_mfma_f32_16x16x32_bf16 v[44:47],a[180:183],v[124:127],v[44:47]
ds_read_b128 v[80:83],v4 offset:20480
v_mfma_f32_16x16x32_bf16 v[48:51],a[184:187],v[124:127],v[48:51]
s_waitcnt vmcnt(1)
s_mov_b32 s64,s50
s_barrier
s_cmp_ge_u32 s60,126
s_cselect_b32 s61,146800640,s61
s_cmp_lg_u32 s64,0
s_cbranch_scc1 nf_64
s_lshr_b32 s64,s60,1
v_mov_b32 v6,s64
s_mov_b64 exec,1
buffer_store_dword v6,off,s[20:23],s69 sc1
s_mov_b64 exec,-1
nf_64:
v_mfma_f32_16x16x32_bf16 v[52:55],v[124:127],a[188:191],v[52:55]
s_waitcnt lgkmcnt(4)
v_mfma_f32_16x16x32_bf16 v[44:47],a[192:195],v[64:67],v[44:47]
ds_read_b128 v[84:87],v4 offset:21504
s_add_u32 m0,s70,s63
v_mfma_f32_16x16x32_bf16 v[48:51],a[196:199],v[64:67],v[48:51]
v_mfma_f32_16x16x32_bf16 v[52:55],v[64:67],a[200:203],v[52:55]
s_add_u32 s62,s61,4096
s_waitcnt lgkmcnt(4)
v_mfma_f32_16x16x32_bf16 v[44:47],a[204:207],v[68:71],v[44:47]
ds_read_b128 v[88:91],v4 offset:22528
v_mfma_f32_16x16x32_bf16 v[48:51],a[208:211],v[68:71],v[48:51]
buffer_load_dwordx4 v0,s[20:23],s61 offen offset:0 lds
v_mfma_f32_16x16x32_bf16 v[52:55],v[68:71],a[212:215],v[52:55]
s_waitcnt lgkmcnt(4)
v_mfma_f32_16x16x32_bf16 v[44:47],a[216:219],v[72:75],v[44:47]
ds_read_b128 v[92:95],v4 offset:23552
buffer_load_dwordx4 v0,s[20:23],s61 offen offset:1024 lds
v_mfma_f32_16x16x32_bf16 v[48:51],a[220:223],v[72:75],v[48:51]
v_mfma_f32_16x16x32_bf16 v[52:55],v[72:75],a[224:227],v[52:55]
buffer_load_dwordx4 v0,s[20:23],s61 offen offset:2048 lds
s_waitcnt lgkmcnt(4)
v_mfma_f32_16x16x32_bf16 v[44:47],a[228:231],v[76:79],v[44:47]
ds_read_b128 v[96:99],v4 offset:24576
v_mfma_f32_16x16x32_bf16 v[48:51],a[232:235],v[76:79],v[48:51]
buffer_load_dwordx4 v0,s[20:23],s61 offen offset:3072 lds
v_mfma_f32_16x16x32_bf16 v[52:55],v[76:79],a[236:239],v[52:55]
s_waitcnt lgkmcnt(4)
v_mfma_f32_16x16x32_bf16 v[44:47],a[240:243],v[80:83],v[44:47]
ds_read_b128 v[100:103],v4 offset:25600
s_add_u32 m0,m0,4096
v_mfma_f32_16x16x32_bf16 v[48:51],a[244:247],v[80:83],v[48:51]
v_mfma_f32_16x16x32_bf16 v[52:55],v[80:83],a[248:251],v[52:55]
buffer_load_dwordx4 v0,s[20:23],s62 offen offset:0 lds
s_waitcnt lgkmcnt(4)
v_mfma_f32_16x16x32_bf16 v[44:47],a[252:255],v[84:87],v[44:47]
ds_read_b128 v[104:107],v4 offset:26624
v_mfma_f32_16x16x32_bf16 v[48:51],v[128:131],v[84:87],v[48:51]
buffer_load_dwordx4 v0,s[20:23],s62 offen offset:1024 lds
v_mfma_f32_16x16x32_bf16 v[52:55],v[84:87],v[132:135],v[52:55]
s_waitcnt lgkmcnt(4)
v_mfma_f32_16x16x32_bf16 v[44:47],v[136:139],v[88:91],v[44:47]
ds_read_b128 v[108:111],v4 offset:27648
buffer_load_dwordx4 v0,s[20:23],s62 offen offset:2048 lds
v_mfma_f32_16x16x32_bf16 v[48:51],v[140:143],v[88:91],v[48:51]
v_mfma_f32_16x16x32_bf16 v[52:55],v[88:91],v[144:147],v[52:55]
buffer_load_dwordx4 v0,s[20:23],s62 offen offset:3072 lds
s_waitcnt lgkmcnt(4)
v_mfma_f32_16x16x32_bf16 v[44:47],v[148:151],v[92:95],v[44:47]
ds_read_b128 v[112:115],v4 offset:28672
v_mfma_f32_16x16x32_bf16 v[48:51],v[152:155],v[92:95],v[48:51]
s_add_u32 s61,s61,32768
v_mfma_f32_16x16x32_bf16 v[52:55],v[92:95],v[156:159],v[52:55]
s_waitcnt lgkmcnt(4)
v_mfma_f32_16x16x32_bf16 v[44:47],v[160:163],v[96:99],v[44:47]
ds_read_b128 v[116:119],v4 offset:29696
s_add_u32 s70,s70,32768
v_mfma_f32_16x16x32_bf16 v[48:51],v[164:167],v[96:99],v[48:51]
v_mfma_f32_16x16x32_bf16 v[52:55],v[96:99],v[168:171],v[52:55]
s_and_b32 s70,s70,0x1ffff
s_waitcnt lgkmcnt(4)
v_mfma_f32_16x16x32_bf16 v[44:47],v[172:175],v[100:103],v[44:47]
ds_read_b128 v[120:123],v4 offset:30720
v_mfma_f32_16x16x32_bf16 v[48:51],v[176:179],v[100:103],v[48:51]
v_mfma_f32_16x16x32_bf16 v[52:55],v[100:103],v[180:183],v[52:55]
s_waitcnt lgkmcnt(4)
v_mfma_f32_16x16x32_bf16 v[44:47],v[184:187],v[104:107],v[44:47]
ds_read_b128 v[124:127],v4 offset:31744
v_mfma_f32_16x16x32_bf16 v[48:51],v[188:191],v[104:107],v[48:51]
v_mfma_f32_16x16x32_bf16 v[52:55],v[104:107],v[192:195],v[52:55]
s_waitcnt lgkmcnt(4)
v_mfma_f32_16x16x32_bf16 v[44:47],v[196:199],v[108:111],v[44:47]
ds_read_b128 v[64:67],v5 offset:0
v_mfma_f32_16x16x32_bf16 v[48:51],v[200:203],v[108:111],v[48:51]
v_mfma_f32_16x16x32_bf16 v[52:55],v[108:111],v[204:207],v[52:55]
s_waitcnt lgkmcnt(4)
v_mfma_f32_16x16x32_bf16 v[44:47],v[208:211],v[112:115],v[44:47]
ds_read_b128 v[68:71],v5 offset:1024
v_mfma_f32_16x16x32_bf16 v[48:51],v[212:215],v[112:115],v[48:51]
v_mfma_f32_16x16x32_bf16 v[52:55],v[112:115],v[216:219],v[52:55]
s_waitcnt lgkmcnt(4)
v_mfma_f32_16x16x32_bf16 v[44:47],v[220:223],v[116:119],v[44:47]
ds_read_b128 v[72:75],v5 offset:2048
v_mfma_f32_16x16x32_bf16 v[48:51],v[224:227],v[116:119],v[48:51]
v_mfma_f32_16x16x32_bf16 v[52:55],v[116:119],v[228:231],v[52:55]
s_waitcnt lgkmcnt(4)
v_mfma_f32_16x16x32_bf16 v[44:47],v[232:235],v[120:123],v[44:47]
ds_read_b128 v[76:79],v5 offset:3072
v_mfma_f32_16x16x32_bf16 v[48:51],v[236:239],v[120:123],v[48:51]
v_mfma_f32_16x16x32_bf16 v[52:55],v[120:123],v[240:243],v[52:55]
s_waitcnt lgkmcnt(4)
v_mfma_f32_16x16x32_bf16 v[44:47],v[244:247],v[124:127],v[44:47]
ds_read_b128 v[80:83],v5 offset:4096
v_mfma_f32_16x16x32_bf16 v[48:51],v[248:251],v[124:127],v[48:51]
v_mfma_f32_16x16x32_bf16 v[52:55],v[124:127],v[252:255],v[52:55]
v_mov_b32 v4,v5
v_add_u32 v5,32768,v5
v_and_b32 v5,0x1ffff,v5
s_add_u32 s60,s60,1
s_cmp_lt_u32 s60,128
s_cbranch_scc1 top_58
s_sub_u32 s66,s60,1
s_lshr_b32 s64,s66,1
s_lshl_b32 s65,s64,12
s_and_b32 s65,s65,0x2000
s_xor_b32 s65,s65,s67
s_lshl_b32 s64,s64,20
s_add_u32 s64,s64,s65
s_add_u32 s65,s64,s52
s_xor_b32 s64,s64,s54
s_add_u32 s66,s64,s53
s_cmp_eq_u32 s60,0
s_cselect_b32 s65,138608640,s65
s_cselect_b32 s66,138608640,s66
v_cvt_pk_bf16_f32 v60,v44,v45
v_cvt_pk_bf16_f32 v61,v46,v47
v_cvt_pk_bf16_f32 v62,v48,v49
v_cvt_pk_bf16_f32 v63,v50,v51
v_cvt_pk_bf16_f32 v58,v52,v53
v_cvt_pk_bf16_f32 v59,v54,v55
buffer_store_dwordx4 v[60:63],v0,s[20:23],s66 offen offset:1024 sc1
buffer_store_dwordx4 v[56:59],v0,s[20:23],s65 offen sc1
s_waitcnt vmcnt(0) lgkmcnt(0)
s_barrier
s_cmp_lg_u32 s50,0
s_cbranch_scc1 done_46
v_mov_b32 v6,64
s_mov_b64 exec,1
buffer_store_dword v6,off,s[20:23],s69 sc1
s_mov_b64 exec,-1
done_46:
s_cmp_lt_u32 s59,32
s_cbranch_scc1 fl_att2
s_endpgm
hb_61:
s_mov_b32 s28,s2
s_and_b32 s29,s3,0xffff
s_mov_b32 s30,0x100
s_mov_b32 s31,0x20000
v_mbcnt_lo_u32_b32 v12,-1,0
v_mbcnt_hi_u32_b32 v12,-1,v12
v_mov_b32 v14,0
v_cmp_eq_u32 vcc,20,v12
s_nop 1
v_cndmask_b32 v14,v14,64,vcc
v_and_b32 v15,1,v12
v_cmp_eq_u32 vcc,1,v15
v_mov_b32 v15,8192
s_nop 0
v_cndmask_b32 v15,-1,v15,vcc
v_min_u32 v12,31,v12
v_lshlrev_b32 v12,2,v12
s_sub_u32 s66,s88,64
vpoll_65:
buffer_load_dword v13,v12,s[28:31],s66 offen sc1
s_waitcnt vmcnt(0)
vck_66:
v_cmp_gt_u32 vcc,v14,v13
s_cbranch_vccz vok_68
vrt_67:
s_sleep 8
s_sub_u32 s90,s90,1
s_cmp_gt_i32 s90,0
s_cbranch_scc1 vpoll_65
vok_68:
s_branch hb2_62
hc_63:
s_mov_b32 s28,s2
s_and_b32 s29,s3,0xffff
s_mov_b32 s30,0x100
s_mov_b32 s31,0x20000
v_mbcnt_lo_u32_b32 v12,-1,0
v_mbcnt_hi_u32_b32 v12,-1,v12
v_mov_b32 v14,0
v_cmp_eq_u32 vcc,17,v12
s_nop 1
v_cndmask_b32 v14,v14,63,vcc
v_and_b32 v15,1,v12
v_cmp_eq_u32 vcc,1,v15
v_mov_b32 v15,8192
s_nop 0
v_cndmask_b32 v15,-1,v15,vcc
v_min_u32 v12,31,v12
v_lshlrev_b32 v12,2,v12
s_sub_u32 s66,s88,64
vpoll_71:
buffer_load_dword v13,v12,s[28:31],s66 offen sc1
s_waitcnt vmcnt(0)
vck_72:
v_cmp_gt_u32 vcc,v14,v13
s_cbranch_vccz vok_74
vrt_73:
s_sleep 8
s_sub_u32 s90,s90,1
s_cmp_gt_i32 s90,0
s_cbranch_scc1 vpoll_71
vok_74:
s_branch hb2_62
fl_wo:
v_and_b32 v21,15,v1
v_lshrrev_b32 v22,4,v1
v_lshrrev_b32 v23,2,v21
v_and_b32 v24,3,v21
s_lshl_b32 s61,s50,15
v_lshl_add_u32 v25,v22,3,v23
s_load_dwordx2 s[4:5],s[0:1],40
s_load_dwordx2 s[6:7],s[0:1],0
s_lshr_b32 s52,s59,3
s_and_b32 s53,s59,7
s_mul_i32 s54,s52,2097152
s_lshl_b32 s64,s53,8
s_add_u32 s54,s54,s64
s_lshl_b32 s64,s50,6
s_add_u32 s54,s54,s64
s_waitcnt lgkmcnt(0)
s_mov_b32 s28,s4
s_and_b32 s29,s5,0xffff
s_mov_b32 s30,0x800000
s_mov_b32 s31,0x20000
s_mov_b32 s24,s6
s_and_b32 s25,s7,0xffff
s_mov_b32 s26,0x400000
s_mov_b32 s27,0x20000
v_lshrrev_b32 v26,2,v1
v_and_b32 v27,3,v1
v_mul_u32_u24 v16,2048,v26
v_lshl_add_u32 v16,v27,4,v16
v_lshlrev_b32 v17,6,v25
v_lshl_add_u32 v17,v24,4,v17
v_add_u32 v17,s61,v17
s_xor_b32 s62,s50,0
s_mul_i32 s62,s62,524288
s_add_u32 s62,s62,s54
s_add_u32 m0,s61,0
s_nop 0
buffer_load_dwordx4 v16,s[28:31],s62 offen lds
s_add_u32 s62,s62,32768
s_add_u32 m0,m0,1024
s_waitcnt vmcnt(2)
buffer_load_dwordx4 v16,s[28:31],s62 offen lds
s_add_u32 s62,s62,32768
s_add_u32 m0,m0,1024
s_waitcnt vmcnt(2)
buffer_load_dwordx4 v16,s[28:31],s62 offen lds
s_add_u32 s62,s62,32768
s_add_u32 m0,m0,1024
s_waitcnt vmcnt(2)
buffer_load_dwordx4 v16,s[28:31],s62 offen lds
s_add_u32 s62,s62,32768
s_add_u32 m0,m0,1024
s_waitcnt vmcnt(2)
buffer_load_dwordx4 v16,s[28:31],s62 offen lds
s_add_u32 s62,s62,32768
s_add_u32 m0,m0,1024
s_waitcnt vmcnt(2)
buffer_load_dwordx4 v16,s[28:31],s62 offen lds
s_add_u32 s62,s62,32768
s_add_u32 m0,m0,1024
s_waitcnt vmcnt(2)
buffer_load_dwordx4 v16,s[28:31],s62 offen lds
s_add_u32 s62,s62,32768
s_add_u32 m0,m0,1024
s_waitcnt vmcnt(2)
buffer_load_dwordx4 v16,s[28:31],s62 offen lds
s_add_u32 s62,s62,32768
s_add_u32 m0,m0,1024
s_waitcnt vmcnt(2)
buffer_load_dwordx4 v16,s[28:31],s62 offen lds
s_add_u32 s62,s62,32768
s_add_u32 m0,m0,1024
s_waitcnt vmcnt(2)
buffer_load_dwordx4 v16,s[28:31],s62 offen lds
s_add_u32 s62,s62,32768
s_add_u32 m0,m0,1024
s_waitcnt vmcnt(2)
buffer_load_dwordx4 v16,s[28:31],s62 offen lds
s_add_u32 s62,s62,32768
s_add_u32 m0,m0,1024
s_waitcnt vmcnt(2)
buffer_load_dwordx4 v16,s[28:31],s62 offen lds
s_add_u32 s62,s62,32768
s_add_u32 m0,m0,1024
s_waitcnt vmcnt(2)
buffer_load_dwordx4 v16,s[28:31],s62 offen lds
s_add_u32 s62,s62,32768
s_add_u32 m0,m0,1024
s_waitcnt vmcnt(2)
buffer_load_dwordx4 v16,s[28:31],s62 offen lds
s_add_u32 s62,s62,32768
s_add_u32 m0,m0,1024
s_waitcnt vmcnt(2)
buffer_load_dwordx4 v16,s[28:31],s62 offen lds
s_add_u32 s62,s62,32768
s_add_u32 m0,m0,1024
s_waitcnt vmcnt(2)
buffer_load_dwordx4 v16,s[28:31],s62 offen lds
s_waitcnt vmcnt(2)
s_xor_b32 s62,s50,1
s_mul_i32 s62,s62,524288
s_add_u32 s62,s62,s54
s_add_u32 m0,s61,16384
s_nop 0
buffer_load_dwordx4 v16,s[28:31],s62 offen lds
s_add_u32 s62,s62,32768
s_add_u32 m0,m0,1024
s_waitcnt vmcnt(2)
buffer_load_dwordx4 v16,s[28:31],s62 offen lds
s_add_u32 s62,s62,32768
s_add_u32 m0,m0,1024
s_waitcnt vmcnt(2)
buffer_load_dwordx4 v16,s[28:31],s62 offen lds
s_add_u32 s62,s62,32768
s_add_u32 m0,m0,1024
s_waitcnt vmcnt(2)
buffer_load_dwordx4 v16,s[28:31],s62 offen lds
s_add_u32 s62,s62,32768
s_add_u32 m0,m0,1024
s_waitcnt vmcnt(2)
buffer_load_dwordx4 v16,s[28:31],s62 offen lds
s_add_u32 s62,s62,32768
s_add_u32 m0,m0,1024
s_waitcnt vmcnt(2)
buffer_load_dwordx4 v16,s[28:31],s62 offen lds
s_add_u32 s62,s62,32768
s_add_u32 m0,m0,1024
s_waitcnt vmcnt(2)
buffer_load_dwordx4 v16,s[28:31],s62 offen lds
s_add_u32 s62,s62,32768
s_add_u32 m0,m0,1024
s_waitcnt vmcnt(2)
buffer_load_dwordx4 v16,s[28:31],s62 offen lds
s_add_u32 s62,s62,32768
s_add_u32 m0,m0,1024
s_waitcnt vmcnt(2)
buffer_load_dwordx4 v16,s[28:31],s62 offen lds
s_add_u32 s62,s62,32768
s_add_u32 m0,m0,1024
s_waitcnt vmcnt(2)
buffer_load_dwordx4 v16,s[28:31],s62 offen lds
s_add_u32 s62,s62,32768
s_add_u32 m0,m0,1024
s_waitcnt vmcnt(2)
buffer_load_dwordx4 v16,s[28:31],s62 offen lds
s_add_u32 s62,s62,32768
s_add_u32 m0,m0,1024
s_waitcnt vmcnt(2)
buffer_load_dwordx4 v16,s[28:31],s62 offen lds
s_add_u32 s62,s62,32768
s_add_u32 m0,m0,1024
s_waitcnt vmcnt(2)
buffer_load_dwordx4 v16,s[28:31],s62 offen lds
s_add_u32 s62,s62,32768
s_add_u32 m0,m0,1024
s_waitcnt vmcnt(2)
buffer_load_dwordx4 v16,s[28:31],s62 offen lds
s_add_u32 s62,s62,32768
s_add_u32 m0,m0,1024
s_waitcnt vmcnt(2)
buffer_load_dwordx4 v16,s[28:31],s62 offen lds
s_add_u32 s62,s62,32768
s_add_u32 m0,m0,1024
s_waitcnt vmcnt(2)
buffer_load_dwordx4 v16,s[28:31],s62 offen lds
s_waitcnt vmcnt(2)
s_waitcnt vmcnt(16)
ds_read_b64_tr_b16 a[0:1],v17 offset:0
ds_read_b64_tr_b16 a[2:3],v17 offset:256
ds_read_b64_tr_b16 a[4:5],v17 offset:8
ds_read_b64_tr_b16 a[6:7],v17 offset:264
ds_read_b64_tr_b16 a[8:9],v17 offset:2048
ds_read_b64_tr_b16 a[10:11],v17 offset:2304
ds_read_b64_tr_b16 a[12:13],v17 offset:2056
ds_read_b64_tr_b16 a[14:15],v17 offset:2312
ds_read_b64_tr_b16 a[16:17],v17 offset:4096
ds_read_b64_tr_b16 a[18:19],v17 offset:4352
ds_read_b64_tr_b16 a[20:21],v17 offset:4104
ds_read_b64_tr_b16 a[22:23],v17 offset:4360
s_waitcnt lgkmcnt(0)
ds_read_b64_tr_b16 a[24:25],v17 offset:6144
ds_read_b64_tr_b16 a[26:27],v17 offset:6400
ds_read_b64_tr_b16 a[28:29],v17 offset:6152
ds_read_b64_tr_b16 a[30:31],v17 offset:6408
ds_read_b64_tr_b16 a[32:33],v17 offset:8192
ds_read_b64_tr_b16 a[34:35],v17 offset:8448
ds_read_b64_tr_b16 a[36:37],v17 offset:8200
ds_read_b64_tr_b16 a[38:39],v17 offset:8456
ds_read_b64_tr_b16 a[40:41],v17 offset:10240
ds_read_b64_tr_b16 a[42:43],v17 offset:10496
ds_read_b64_tr_b16 a[44:45],v17 offset:10248
ds_read_b64_tr_b16 a[46:47],v17 offset:10504
s_waitcnt lgkmcnt(0)
ds_read_b64_tr_b16 a[48:49],v17 offset:12288
ds_read_b64_tr_b16 a[50:51],v17 offset:12544
ds_read_b64_tr_b16 a[52:53],v17 offset:12296
ds_read_b64_tr_b16 a[54:55],v17 offset:12552
ds_read_b64_tr_b16 a[56:57],v17 offset:14336
ds_read_b64_tr_b16 a[58:59],v17 offset:14592
ds_read_b64_tr_b16 a[60:61],v17 offset:14344
ds_read_b64_tr_b16 a[62:63],v17 offset:14600
s_waitcnt lgkmcnt(0)
s_xor_b32 s62,s50,2
s_mul_i32 s62,s62,524288
s_add_u32 s62,s62,s54
s_add_u32 m0,s61,0
s_nop 0
buffer_load_dwordx4 v16,s[28:31],s62 offen lds
s_add_u32 s62,s62,32768
s_add_u32 m0,m0,1024
s_waitcnt vmcnt(2)
buffer_load_dwordx4 v16,s[28:31],s62 offen lds
s_add_u32 s62,s62,32768
s_add_u32 m0,m0,1024
s_waitcnt vmcnt(2)
buffer_load_dwordx4 v16,s[28:31],s62 offen lds
s_add_u32 s62,s62,32768
s_add_u32 m0,m0,1024
s_waitcnt vmcnt(2)
buffer_load_dwordx4 v16,s[28:31],s62 offen lds
s_add_u32 s62,s62,32768
s_add_u32 m0,m0,1024
s_waitcnt vmcnt(2)
buffer_load_dwordx4 v16,s[28:31],s62 offen lds
s_add_u32 s62,s62,32768
s_add_u32 m0,m0,1024
s_waitcnt vmcnt(2)
buffer_load_dwordx4 v16,s[28:31],s62 offen lds
s_add_u32 s62,s62,32768
s_add_u32 m0,m0,1024
s_waitcnt vmcnt(2)
buffer_load_dwordx4 v16,s[28:31],s62 offen lds
s_add_u32 s62,s62,32768
s_add_u32 m0,m0,1024
s_waitcnt vmcnt(2)
buffer_load_dwordx4 v16,s[28:31],s62 offen lds
s_add_u32 s62,s62,32768
s_add_u32 m0,m0,1024
s_waitcnt vmcnt(2)
buffer_load_dwordx4 v16,s[28:31],s62 offen lds
s_add_u32 s62,s62,32768
s_add_u32 m0,m0,1024
s_waitcnt vmcnt(2)
buffer_load_dwordx4 v16,s[28:31],s62 offen lds
s_add_u32 s62,s62,32768
s_add_u32 m0,m0,1024
s_waitcnt vmcnt(2)
buffer_load_dwordx4 v16,s[28:31],s62 offen lds
s_add_u32 s62,s62,32768
s_add_u32 m0,m0,1024
s_waitcnt vmcnt(2)
buffer_load_dwordx4 v16,s[28:31],s62 offen lds
s_add_u32 s62,s62,32768
s_add_u32 m0,m0,1024
s_waitcnt vmcnt(2)
buffer_load_dwordx4 v16,s[28:31],s62 offen lds
s_add_u32 s62,s62,32768
s_add_u32 m0,m0,1024
s_waitcnt vmcnt(2)
buffer_load_dwordx4 v16,s[28:31],s62 offen lds
s_add_u32 s62,s62,32768
s_add_u32 m0,m0,1024
s_waitcnt vmcnt(2)
buffer_load_dwordx4 v16,s[28:31],s62 offen lds
s_add_u32 s62,s62,32768
s_add_u32 m0,m0,1024
s_waitcnt vmcnt(2)
buffer_load_dwordx4 v16,s[28:31],s62 offen lds
s_waitcnt vmcnt(2)
s_waitcnt vmcnt(16)
ds_read_b64_tr_b16 a[64:65],v17 offset:16384
ds_read_b64_tr_b16 a[66:67],v17 offset:16640
ds_read_b64_tr_b16 a[68:69],v17 offset:16392
ds_read_b64_tr_b16 a[70:71],v17 offset:16648
ds_read_b64_tr_b16 a[72:73],v17 offset:18432
ds_read_b64_tr_b16 a[74:75],v17 offset:18688
ds_read_b64_tr_b16 a[76:77],v17 offset:18440
ds_read_b64_tr_b16 a[78:79],v17 offset:18696
ds_read_b64_tr_b16 a[80:81],v17 offset:20480
ds_read_b64_tr_b16 a[82:83],v17 offset:20736
ds_read_b64_tr_b16 a[84:85],v17 offset:20488
ds_read_b64_tr_b16 a[86:87],v17 offset:20744
s_waitcnt lgkmcnt(0)
ds_read_b64_tr_b16 a[88:89],v17 offset:22528
ds_read_b64_tr_b16 a[90:91],v17 offset:22784
ds_read_b64_tr_b16 a[92:93],v17 offset:22536
ds_read_b64_tr_b16 a[94:95],v17 offset:22792
ds_read_b64_tr_b16 a[96:97],v17 offset:24576
ds_read_b64_tr_b16 a[98:99],v17 offset:24832
ds_read_b64_tr_b16 a[100:101],v17 offset:24584
ds_read_b64_tr_b16 a[102:103],v17 offset:24840
ds_read_b64_tr_b16 a[104:105],v17 offset:26624
ds_read_b64_tr_b16 a[106:107],v17 offset:26880
ds_read_b64_tr_b16 a[108:109],v17 offset:26632
ds_read_b64_tr_b16 a[110:111],v17 offset:26888
s_waitcnt lgkmcnt(0)
ds_read_b64_tr_b16 a[112:113],v17 offset:28672
ds_read_b64_tr_b16 a[114:115],v17 offset:28928
ds_read_b64_tr_b16 a[116:117],v17 offset:28680
ds_read_b64_tr_b16 a[118:119],v17 offset:28936
ds_read_b64_tr_b16 a[120:121],v17 offset:30720
ds_read_b64_tr_b16 a[122:123],v17 offset:30976
ds_read_b64_tr_b16 a[124:125],v17 offset:30728
ds_read_b64_tr_b16 a[126:127],v17 offset:30984
s_waitcnt lgkmcnt(0)
s_xor_b32 s62,s50,3
s_mul_i32 s62,s62,524288
s_add_u32 s62,s62,s54
s_add_u32 m0,s61,16384
s_nop 0
buffer_load_dwordx4 v16,s[28:31],s62 offen lds
s_add_u32 s62,s62,32768
s_add_u32 m0,m0,1024
s_waitcnt vmcnt(2)
buffer_load_dwordx4 v16,s[28:31],s62 offen lds
s_add_u32 s62,s62,32768
s_add_u32 m0,m0,1024
s_waitcnt vmcnt(2)
buffer_load_dwordx4 v16,s[28:31],s62 offen lds
s_add_u32 s62,s62,32768
s_add_u32 m0,m0,1024
s_waitcnt vmcnt(2)
buffer_load_dwordx4 v16,s[28:31],s62 offen lds
s_add_u32 s62,s62,32768
s_add_u32 m0,m0,1024
s_waitcnt vmcnt(2)
buffer_load_dwordx4 v16,s[28:31],s62 offen lds
s_add_u32 s62,s62,32768
s_add_u32 m0,m0,1024
s_waitcnt vmcnt(2)
buffer_load_dwordx4 v16,s[28:31],s62 offen lds
s_add_u32 s62,s62,32768
s_add_u32 m0,m0,1024
s_waitcnt vmcnt(2)
buffer_load_dwordx4 v16,s[28:31],s62 offen lds
s_add_u32 s62,s62,32768
s_add_u32 m0,m0,1024
s_waitcnt vmcnt(2)
buffer_load_dwordx4 v16,s[28:31],s62 offen lds
s_add_u32 s62,s62,32768
s_add_u32 m0,m0,1024
s_waitcnt vmcnt(2)
buffer_load_dwordx4 v16,s[28:31],s62 offen lds
s_add_u32 s62,s62,32768
s_add_u32 m0,m0,1024
s_waitcnt vmcnt(2)
buffer_load_dwordx4 v16,s[28:31],s62 offen lds
s_add_u32 s62,s62,32768
s_add_u32 m0,m0,1024
s_waitcnt vmcnt(2)
buffer_load_dwordx4 v16,s[28:31],s62 offen lds
s_add_u32 s62,s62,32768
s_add_u32 m0,m0,1024
s_waitcnt vmcnt(2)
buffer_load_dwordx4 v16,s[28:31],s62 offen lds
s_add_u32 s62,s62,32768
s_add_u32 m0,m0,1024
s_waitcnt vmcnt(2)
buffer_load_dwordx4 v16,s[28:31],s62 offen lds
s_add_u32 s62,s62,32768
s_add_u32 m0,m0,1024
s_waitcnt vmcnt(2)
buffer_load_dwordx4 v16,s[28:31],s62 offen lds
s_add_u32 s62,s62,32768
s_add_u32 m0,m0,1024
s_waitcnt vmcnt(2)
buffer_load_dwordx4 v16,s[28:31],s62 offen lds
s_add_u32 s62,s62,32768
s_add_u32 m0,m0,1024
s_waitcnt vmcnt(2)
buffer_load_dwordx4 v16,s[28:31],s62 offen lds
s_waitcnt vmcnt(2)
s_waitcnt vmcnt(16)
ds_read_b64_tr_b16 a[128:129],v17 offset:0
ds_read_b64_tr_b16 a[130:131],v17 offset:256
ds_read_b64_tr_b16 a[132:133],v17 offset:8
ds_read_b64_tr_b16 a[134:135],v17 offset:264
ds_read_b64_tr_b16 a[136:137],v17 offset:2048
ds_read_b64_tr_b16 a[138:139],v17 offset:2304
ds_read_b64_tr_b16 a[140:141],v17 offset:2056
ds_read_b64_tr_b16 a[142:143],v17 offset:2312
ds_read_b64_tr_b16 a[144:145],v17 offset:4096
ds_read_b64_tr_b16 a[146:147],v17 offset:4352
ds_read_b64_tr_b16 a[148:149],v17 offset:4104
ds_read_b64_tr_b16 a[150:151],v17 offset:4360
s_waitcnt lgkmcnt(0)
ds_read_b64_tr_b16 a[152:153],v17 offset:6144
ds_read_b64_tr_b16 a[154:155],v17 offset:6400
ds_read_b64_tr_b16 a[156:157],v17 offset:6152
ds_read_b64_tr_b16 a[158:159],v17 offset:6408
ds_read_b64_tr_b16 a[160:161],v17 offset:8192
ds_read_b64_tr_b16 a[162:163],v17 offset:8448
ds_read_b64_tr_b16 a[164:165],v17 offset:8200
ds_read_b64_tr_b16 a[166:167],v17 offset:8456
ds_read_b64_tr_b16 a[168:169],v17 offset:10240
ds_read_b64_tr_b16 a[170:171],v17 offset:10496
ds_read_b64_tr_b16 a[172:173],v17 offset:10248
ds_read_b64_tr_b16 a[174:175],v17 offset:10504
s_waitcnt lgkmcnt(0)
ds_read_b64_tr_b16 a[176:177],v17 offset:12288
ds_read_b64_tr_b16 a[178:179],v17 offset:12544
ds_read_b64_tr_b16 a[180:181],v17 offset:12296
ds_read_b64_tr_b16 a[182:183],v17 offset:12552
ds_read_b64_tr_b16 a[184:185],v17 offset:14336
ds_read_b64_tr_b16 a[186:187],v17 offset:14592
ds_read_b64_tr_b16 a[188:189],v17 offset:14344
ds_read_b64_tr_b16 a[190:191],v17 offset:14600
s_waitcnt lgkmcnt(0)
s_waitcnt vmcnt(0)
ds_read_b64_tr_b16 a[192:193],v17 offset:16384
ds_read_b64_tr_b16 a[194:195],v17 offset:16640
ds_read_b64_tr_b16 a[196:197],v17 offset:16392
ds_read_b64_tr_b16 a[198:199],v17 offset:16648
ds_read_b64_tr_b16 a[200:201],v17 offset:18432
ds_read_b64_tr_b16 a[202:203],v17 offset:18688
ds_read_b64_tr_b16 a[204:205],v17 offset:18440
ds_read_b64_tr_b16 a[206:207],v17 offset:18696
ds_read_b64_tr_b16 a[208:209],v17 offset:20480
ds_read_b64_tr_b16 a[210:211],v17 offset:20736
ds_read_b64_tr_b16 a[212:213],v17 offset:20488
ds_read_b64_tr_b16 a[214:215],v17 offset:20744
s_waitcnt lgkmcnt(0)
ds_read_b64_tr_b16 a[216:217],v17 offset:22528
ds_read_b64_tr_b16 a[218:219],v17 offset:22784
ds_read_b64_tr_b16 a[220:221],v17 offset:22536
ds_read_b64_tr_b16 a[222:223],v17 offset:22792
ds_read_b64_tr_b16 a[224:225],v17 offset:24576
ds_read_b64_tr_b16 a[226:227],v17 offset:24832
ds_read_b64_tr_b16 a[228:229],v17 offset:24584
ds_read_b64_tr_b16 a[230:231],v17 offset:24840
ds_read_b64_tr_b16 a[232:233],v17 offset:26624
ds_read_b64_tr_b16 a[234:235],v17 offset:26880
ds_read_b64_tr_b16 a[236:237],v17 offset:26632
ds_read_b64_tr_b16 a[238:239],v17 offset:26888
s_waitcnt lgkmcnt(0)
ds_read_b64_tr_b16 a[240:241],v17 offset:28672
ds_read_b64_tr_b16 a[242:243],v17 offset:28928
ds_read_b64_tr_b16 a[244:245],v17 offset:28680
ds_read_b64_tr_b16 a[246:247],v17 offset:28936
ds_read_b64_tr_b16 a[248:249],v17 offset:30720
ds_read_b64_tr_b16 a[250:251],v17 offset:30976
ds_read_b64_tr_b16 a[252:253],v17 offset:30728
ds_read_b64_tr_b16 a[254:255],v17 offset:30984
s_waitcnt lgkmcnt(0)
s_mov_b32 s92,s2
s_and_b32 s93,s3,0xffff
s_mov_b32 s94,0x100
s_mov_b32 s95,0x20000
v_mbcnt_lo_u32_b32 v16,-1,0
v_mbcnt_hi_u32_b32 v16,-1,v16
v_mov_b32 v18,0
v_cmp_eq_u32 vcc,22,v16
s_nop 1
v_cndmask_b32 v18,v18,63,vcc
v_cmp_eq_u32 vcc,17,v16
s_nop 1
v_cndmask_b32 v18,v18,63,vcc
v_cmp_eq_u32 vcc,18,v16
s_nop 1
v_cndmask_b32 v18,v18,1,vcc
v_and_b32 v19,1,v16
v_cmp_eq_u32 vcc,1,v19
v_mov_b32 v19,8192
s_nop 0
v_cndmask_b32 v19,-1,v19,vcc
v_min_u32 v16,31,v16
v_lshlrev_b32 v16,2,v16
s_sub_u32 s66,s88,64
s_cmp_lg_u32 s50,0
s_cbranch_scc1 vot_82
vpoll_78:
buffer_load_dword v17,v16,s[92:95],s66 offen sc1
s_waitcnt vmcnt(0)
s_cmp_lg_u32 s56,2
s_cbranch_scc1 vck_79
v_cmp_eq_u32 vcc,v17,v19
s_and_b32 s64,vcc_lo,0xffff
s_cmp_eq_u32 s64,65535
s_cbranch_scc1 vck_79
s_mov_b32 s65,0
v_readlane_b32 s64,v17,1
s_lshr_b32 s64,s64,8
s_add_u32 s65,s65,s64
v_readlane_b32 s64,v17,3
s_lshr_b32 s64,s64,8
s_add_u32 s65,s65,s64
v_readlane_b32 s64,v17,5
s_lshr_b32 s64,s64,8
s_add_u32 s65,s65,s64
v_readlane_b32 s64,v17,7
s_lshr_b32 s64,s64,8
s_add_u32 s65,s65,s64
v_readlane_b32 s64,v17,9
s_lshr_b32 s64,s64,8
s_add_u32 s65,s65,s64
v_readlane_b32 s64,v17,11
s_lshr_b32 s64,s64,8
s_add_u32 s65,s65,s64
v_readlane_b32 s64,v17,13
s_lshr_b32 s64,s64,8
s_add_u32 s65,s65,s64
v_readlane_b32 s64,v17,15
s_lshr_b32 s64,s64,8
s_add_u32 s65,s65,s64
s_cmp_ge_u32 s65,256
s_cbranch_scc1 vok_81
s_branch vrt_80
vck_79:
v_cmp_gt_u32 vcc,v18,v17
s_cbranch_vccz vok_81
vrt_80:
s_sleep 48
s_sub_u32 s90,s90,1
s_cmp_gt_i32 s90,0
s_cbranch_scc1 vpoll_78
vok_81:
v_add_u32 v18,161536,v16
ds_write_b32 v18,v17
s_waitcnt lgkmcnt(0)
vot_82:
s_barrier
v_add_u32 v18,161536,v16
ds_read_b32 v17,v18
s_waitcnt lgkmcnt(0)
s_cmp_lg_u32 s56,2
s_cbranch_scc1 vfin_83
v_cmp_eq_u32 vcc,v17,v19
s_and_b32 s64,vcc_lo,0xffff
s_cmp_eq_u32 s64,65535
s_cbranch_scc1 vfin_83
s_mov_b32 s65,0
v_readlane_b32 s64,v17,1
s_lshr_b32 s64,s64,8
s_add_u32 s65,s65,s64
v_readlane_b32 s64,v17,3
s_lshr_b32 s64,s64,8
s_add_u32 s65,s65,s64
v_readlane_b32 s64,v17,5
s_lshr_b32 s64,s64,8
s_add_u32 s65,s65,s64
v_readlane_b32 s64,v17,7
s_lshr_b32 s64,s64,8
s_add_u32 s65,s65,s64
v_readlane_b32 s64,v17,9
s_lshr_b32 s64,s64,8
s_add_u32 s65,s65,s64
v_readlane_b32 s64,v17,11
s_lshr_b32 s64,s64,8
s_add_u32 s65,s65,s64
v_readlane_b32 s64,v17,13
s_lshr_b32 s64,s64,8
s_add_u32 s65,s65,s64
v_readlane_b32 s64,v17,15
s_lshr_b32 s64,s64,8
s_add_u32 s65,s65,s64
s_cmp_ge_u32 s65,256
s_cbranch_scc1 fl_fb
vfin_83:
s_and_b32 s56,s56,1
s_mov_b32 s67,0
s_barrier
v_lshlrev_b32 v0,4,v1
s_mov_b32 s60,0
s_lshl_b32 s70,s50,13
s_mov_b32 s55,0
v_mov_b32 v3,v0
s_mov_b32 s73,0xffff0000
s_lshl_b32 s64,s52,2
s_add_u32 s64,s64,s50
s_mul_i32 s61,s64,8192
s_add_u32 s61,s61,150994944
s_lshl_b32 s68,s64,8
s_add_u32 s68,s68,138543104
s_lshl_b32 s83,s53,2
s_add_u32 s83,s83,s50
s_mov_b32 s63,0
s_xor_b32 s64,s50,0
s_lshl_b32 s64,s64,13
v_add_u32 v8,s64,v0
v_mov_b32 v4,v8
s_xor_b32 s64,s50,1
s_lshl_b32 s64,s64,13
v_add_u32 v9,s64,v0
v_mov_b32 v5,v9
s_xor_b32 s64,s50,2
s_lshl_b32 s64,s64,13
v_add_u32 v10,s64,v0
v_mov_b32 v6,v10
s_xor_b32 s64,s50,3
s_lshl_b32 s64,s64,13
v_add_u32 v11,s64,v0
v_mov_b32 v7,v11
v_min_u32 v2,11,v1
v_lshlrev_b32 v2,2,v2
s_add_u32 s62,s61,4096
s_lshl_b32 s66,s83,10
s_lshr_b32 s65,s83,3
s_lshl_b32 s65,s65,8
s_and_b32 s64,s83,7
s_lshl_b32 s64,s64,2
s_add_u32 s69,s64,s65
s_add_u32 s69,s69,138547200
s_mov_b32 s82,0
s_lshl_b32 s64,s53,2
s_add_u32 s64,s64,s50
s_mul_i32 s74,s64,24576
s_xor_b32 s64,s50,s52
s_sub_u32 s64,s64,1
s_max_i32 s64,s64,0
s_lshl_b32 s64,s64,11
s_add_u32 s74,s74,s64
s_add_u32 s74,s74,167772160
s_mov_b32 s75,0
s_mov_b32 s77,0
v_lshlrev_b32 v26,11,v21
v_lshl_add_u32 v26,v22,4,v26
s_lshl_b32 s64,s83,6
v_add_u32 v18,s64,v26
v_lshlrev_b32 v26,5,v22
s_lshl_b32 s64,s83,7
s_add_u32 s64,s64,267395072
buffer_load_dwordx4 v[152:155],v26,s[20:23],s64 offen offset:0 sc1
buffer_load_dwordx4 v[156:159],v26,s[20:23],s64 offen offset:16 sc1
s_add_u32 s64,s64,24576
buffer_load_dwordx4 v[128:131],v26,s[20:23],s64 offen offset:0 sc1
buffer_load_dwordx4 v[132:135],v26,s[20:23],s64 offen offset:16 sc1
s_add_u32 s64,s64,24576
buffer_load_dwordx4 v[136:139],v26,s[20:23],s64 offen offset:0 sc1
buffer_load_dwordx4 v[140:143],v26,s[20:23],s64 offen offset:16 sc1
s_add_u32 s64,s64,24576
buffer_load_dwordx4 v[144:147],v26,s[20:23],s64 offen offset:0 sc1
buffer_load_dwordx4 v[148:151],v26,s[20:23],s64 offen offset:16 sc1
s_add_u32 s64,s64,24576
s_waitcnt vmcnt(0)
v_pk_add_f32 v[152:153],v[152:153],v[128:129]
v_pk_add_f32 v[136:137],v[136:137],v[144:145]
v_pk_add_f32 v[154:155],v[154:155],v[130:131]
v_pk_add_f32 v[138:139],v[138:139],v[146:147]
v_pk_add_f32 v[156:157],v[156:157],v[132:133]
v_pk_add_f32 v[140:141],v[140:141],v[148:149]
v_pk_add_f32 v[158:159],v[158:159],v[134:135]
v_pk_add_f32 v[142:143],v[142:143],v[150:151]
v_pk_add_f32 v[152:153],v[152:153],v[136:137]
v_pk_add_f32 v[154:155],v[154:155],v[138:139]
v_pk_add_f32 v[156:157],v[156:157],v[140:141]
v_pk_add_f32 v[158:159],v[158:159],v[142:143]
v_cvt_pk_bf16_f32 v128,v152,v153
v_cvt_pk_bf16_f32 v129,v154,v155
v_cvt_pk_bf16_f32 v130,v156,v157
v_cvt_pk_bf16_f32 v131,v158,v159
v_lshlrev_b32 v152,16,v128
v_and_b32 v153,s73,v128
v_lshlrev_b32 v154,16,v129
v_and_b32 v155,s73,v129
v_lshlrev_b32 v156,16,v130
v_and_b32 v157,s73,v130
v_lshlrev_b32 v158,16,v131
v_and_b32 v159,s73,v131
v_mov_b32 v204,-1
v_mov_b32 v205,-1
v_mov_b32 v206,-1
v_mov_b32 v207,-1
v_cmp_eq_u32 vcc,0,v1
s_nop 1
v_cndmask_b32 v26,2.0,0,vcc
s_cmp_eq_u32 s50,s52
s_cbranch_scc1 lfin_84
s_add_u32 s71,s60,1
s_add_u32 s53,s60,2
plp_94:
buffer_load_dword v16,v2,s[20:23],s68 offen sc1
s_waitcnt vmcnt(0)
v_cmp_gt_u32 vcc,s71,v16
s_cbranch_vccz pok_95
s_sleep 4
s_sub_u32 s90,s90,1
s_cmp_gt_i32 s90,0
s_cbranch_scc1 plp_94
pok_95:
lag_91:
s_mov_b32 m0,s70
s_nop 0
buffer_load_dwordx4 v3,s[20:23],s61 offen offset:0 lds
buffer_load_dwordx4 v3,s[20:23],s61 offen offset:1024 lds
buffer_load_dwordx4 v3,s[20:23],s61 offen offset:2048 lds
buffer_load_dwordx4 v3,s[20:23],s61 offen offset:3072 lds
s_add_u32 m0,s70,4096
s_nop 0
buffer_load_dwordx4 v3,s[20:23],s62 offen offset:0 lds
buffer_load_dwordx4 v3,s[20:23],s62 offen offset:1024 lds
buffer_load_dwordx4 v3,s[20:23],s62 offen offset:2048 lds
buffer_load_dwordx4 v3,s[20:23],s62 offen offset:3072 lds
s_add_u32 s61,s61,131072
s_add_u32 s62,s62,131072
s_add_u32 s70,s70,32768
s_and_b32 s70,s70,0x1ffff
buffer_load_dword v23,off,s[20:23],s66
buffer_load_dword v23,off,s[20:23],s66
dec_92:
v_cmp_gt_u32 vcc,s53,v16
s_cbranch_vccnz BN_90
BR_89:
s_waitcnt vmcnt(9)
ds_read_b128 v[64:67],v4 offset:0
s_waitcnt vmcnt(8)
ds_read_b128 v[68:71],v4 offset:1024
s_waitcnt vmcnt(7)
ds_read_b128 v[72:75],v4 offset:2048
s_waitcnt vmcnt(6)
ds_read_b128 v[76:79],v4 offset:3072
s_waitcnt lgkmcnt(3)
v_mfma_f32_16x16x32_bf16 v[32:35],a[0:3],v[64:67],0
s_add_u32 s71,s60,2
s_add_u32 s53,s60,3
v_mfma_f32_16x16x32_bf16 v[36:39],a[4:7],v[64:67],0
s_waitcnt lgkmcnt(2)
s_waitcnt vmcnt(5)
ds_read_b128 v[80:83],v4 offset:4096
v_mfma_f32_16x16x32_bf16 v[32:35],a[8:11],v[68:71],v[32:35]
v_mfma_f32_16x16x32_bf16 v[36:39],a[12:15],v[68:71],v[36:39]
s_waitcnt lgkmcnt(2)
s_waitcnt vmcnt(4)
s_mov_b32 m0,s70
ds_read_b128 v[84:87],v4 offset:5120
v_mfma_f32_16x16x32_bf16 v[32:35],a[16:19],v[72:75],v[32:35]
buffer_load_dwordx4 v3,s[20:23],s61 offen offset:0 lds
v_mfma_f32_16x16x32_bf16 v[36:39],a[20:23],v[72:75],v[36:39]
s_waitcnt lgkmcnt(2)
s_waitcnt vmcnt(4)
ds_read_b128 v[88:91],v4 offset:6144
v_mfma_f32_16x16x32_bf16 v[32:35],a[24:27],v[76:79],v[32:35]
buffer_load_dwordx4 v3,s[20:23],s61 offen offset:1024 lds
v_mfma_f32_16x16x32_bf16 v[36:39],a[28:31],v[76:79],v[36:39]
s_waitcnt lgkmcnt(2)
s_waitcnt vmcnt(4)
ds_read_b128 v[92:95],v4 offset:7168
v_mfma_f32_16x16x32_bf16 v[32:35],a[32:35],v[80:83],v[32:35]
v_mfma_f32_16x16x32_bf16 v[36:39],a[36:39],v[80:83],v[36:39]
s_waitcnt lgkmcnt(2)
s_barrier
ds_read_b128 v[96:99],v5 offset:0
v_mfma_f32_16x16x32_bf16 v[32:35],a[40:43],v[84:87],v[32:35]
ds_read_b128 v[100:103],v5 offset:1024
buffer_load_dwordx4 v3,s[20:23],s61 offen offset:2048 lds
v_mfma_f32_16x16x32_bf16 v[36:39],a[44:47],v[84:87],v[36:39]
s_waitcnt lgkmcnt(3)
ds_read_b128 v[104:107],v5 offset:2048
v_mfma_f32_16x16x32_bf16 v[32:35],a[48:51],v[88:91],v[32:35]
ds_read_b128 v[108:111],v5 offset:3072
v_mfma_f32_16x16x32_bf16 v[36:39],a[52:55],v[88:91],v[36:39]
s_waitcnt lgkmcnt(4)
ds_read_b128 v[112:115],v5 offset:4096
buffer_load_dwordx4 v3,s[20:23],s61 offen offset:3072 lds
v_mfma_f32_16x16x32_bf16 v[32:35],a[56:59],v[92:95],v[32:35]
ds_read_b128 v[116:119],v5 offset:5120
v_mfma_f32_16x16x32_bf16 v[36:39],a[60:63],v[92:95],v[36:39]
s_waitcnt lgkmcnt(5)
s_add_u32 m0,s70,4096
v_mfma_f32_16x16x32_bf16 v[32:35],a[64:67],v[96:99],v[32:35]
ds_read_b128 v[120:123],v5 offset:6144
buffer_load_dwordx4 v3,s[20:23],s62 offen offset:0 lds
v_mfma_f32_16x16x32_bf16 v[36:39],a[68:71],v[96:99],v[36:39]
s_waitcnt lgkmcnt(5)
v_mfma_f32_16x16x32_bf16 v[32:35],a[72:75],v[100:103],v[32:35]
ds_read_b128 v[124:127],v5 offset:7168
v_mfma_f32_16x16x32_bf16 v[36:39],a[76:79],v[100:103],v[36:39]
s_waitcnt lgkmcnt(5)
buffer_load_dwordx4 v3,s[20:23],s62 offen offset:1024 lds
v_mfma_f32_16x16x32_bf16 v[32:35],a[80:83],v[104:107],v[32:35]
ds_read_b128 v[64:67],v6 offset:0
v_mfma_f32_16x16x32_bf16 v[36:39],a[84:87],v[104:107],v[36:39]
s_waitcnt lgkmcnt(5)
v_mfma_f32_16x16x32_bf16 v[32:35],a[88:91],v[108:111],v[32:35]
ds_read_b128 v[68:71],v6 offset:1024
v_mfma_f32_16x16x32_bf16 v[36:39],a[92:95],v[108:111],v[36:39]
s_waitcnt lgkmcnt(5)
buffer_load_dwordx4 v3,s[20:23],s62 offen offset:2048 lds
v_mfma_f32_16x16x32_bf16 v[32:35],a[96:99],v[112:115],v[32:35]
ds_read_b128 v[72:75],v6 offset:2048
buffer_load_dword v16,v2,s[20:23],s68 offen sc1
v_mfma_f32_16x16x32_bf16 v[36:39],a[100:103],v[112:115],v[36:39]
s_waitcnt lgkmcnt(5)
v_mfma_f32_16x16x32_bf16 v[32:35],a[104:107],v[116:119],v[32:35]
ds_read_b128 v[76:79],v6 offset:3072
buffer_load_dwordx4 v3,s[20:23],s62 offen offset:3072 lds
v_mfma_f32_16x16x32_bf16 v[36:39],a[108:111],v[116:119],v[36:39]
s_waitcnt lgkmcnt(5)
v_mfma_f32_16x16x32_bf16 v[32:35],a[112:115],v[120:123],v[32:35]
ds_read_b128 v[80:83],v6 offset:4096
v_mfma_f32_16x16x32_bf16 v[36:39],a[116:119],v[120:123],v[36:39]
s_waitcnt lgkmcnt(5)
v_mfma_f32_16x16x32_bf16 v[32:35],a[120:123],v[124:127],v[32:35]
ds_read_b128 v[84:87],v6 offset:5120
v_mfma_f32_16x16x32_bf16 v[36:39],a[124:127],v[124:127],v[36:39]
s_waitcnt lgkmcnt(5)
v_mfma_f32_16x16x32_bf16 v[32:35],a[128:131],v[64:67],v[32:35]
ds_read_b128 v[88:91],v6 offset:6144
v_mfma_f32_16x16x32_bf16 v[36:39],a[132:135],v[64:67],v[36:39]
s_waitcnt lgkmcnt(5)
v_mfma_f32_16x16x32_bf16 v[32:35],a[136:139],v[68:71],v[32:35]
ds_read_b128 v[92:95],v6 offset:7168
v_mfma_f32_16x16x32_bf16 v[36:39],a[140:143],v[68:71],v[36:39]
s_waitcnt lgkmcnt(5)
v_mfma_f32_16x16x32_bf16 v[32:35],a[144:147],v[72:75],v[32:35]
ds_read_b128 v[96:99],v7 offset:0
v_mfma_f32_16x16x32_bf16 v[36:39],a[148:151],v[72:75],v[36:39]
s_waitcnt lgkmcnt(5)
v_mfma_f32_16x16x32_bf16 v[32:35],a[152:155],v[76:79],v[32:35]
ds_read_b128 v[100:103],v7 offset:1024
v_mfma_f32_16x16x32_bf16 v[36:39],a[156:159],v[76:79],v[36:39]
s_waitcnt lgkmcnt(5)
v_mfma_f32_16x16x32_bf16 v[32:35],a[160:163],v[80:83],v[32:35]
ds_read_b128 v[104:107],v7 offset:2048
v_mfma_f32_16x16x32_bf16 v[36:39],a[164:167],v[80:83],v[36:39]
s_waitcnt lgkmcnt(5)
v_mfma_f32_16x16x32_bf16 v[32:35],a[168:171],v[84:87],v[32:35]
ds_read_b128 v[108:111],v7 offset:3072
v_mfma_f32_16x16x32_bf16 v[36:39],a[172:175],v[84:87],v[36:39]
s_waitcnt lgkmcnt(5)
v_mfma_f32_16x16x32_bf16 v[32:35],a[176:179],v[88:91],v[32:35]
ds_read_b128 v[112:115],v7 offset:4096
v_mfma_f32_16x16x32_bf16 v[36:39],a[180:183],v[88:91],v[36:39]
s_waitcnt lgkmcnt(5)
v_mfma_f32_16x16x32_bf16 v[32:35],a[184:187],v[92:95],v[32:35]
ds_read_b128 v[116:119],v7 offset:5120
v_mfma_f32_16x16x32_bf16 v[36:39],a[188:191],v[92:95],v[36:39]
s_waitcnt lgkmcnt(5)
v_mfma_f32_16x16x32_bf16 v[32:35],a[192:195],v[96:99],v[32:35]
ds_read_b128 v[120:123],v7 offset:6144
v_mfma_f32_16x16x32_bf16 v[36:39],a[196:199],v[96:99],v[36:39]
s_waitcnt lgkmcnt(5)
v_mfma_f32_16x16x32_bf16 v[32:35],a[200:203],v[100:103],v[32:35]
ds_read_b128 v[124:127],v7 offset:7168
v_mfma_f32_16x16x32_bf16 v[36:39],a[204:207],v[100:103],v[36:39]
s_waitcnt lgkmcnt(5)
s_add_u32 s61,s61,131072
s_add_u32 s62,s62,131072
v_mfma_f32_16x16x32_bf16 v[32:35],a[208:211],v[104:107],v[32:35]
s_add_u32 s70,s70,32768
s_and_b32 s70,s70,0x1ffff
s_add_u32 s55,s55,32768
v_mfma_f32_16x16x32_bf16 v[36:39],a[212:215],v[104:107],v[36:39]
s_waitcnt lgkmcnt(4)
s_and_b32 s55,s55,0x1ffff
v_add_u32 v4,s55,v8
v_mfma_f32_16x16x32_bf16 v[32:35],a[216:219],v[108:111],v[32:35]
v_add_u32 v5,s55,v9
v_add_u32 v6,s55,v10
v_mfma_f32_16x16x32_bf16 v[36:39],a[220:223],v[108:111],v[36:39]
s_waitcnt lgkmcnt(3)
v_add_u32 v7,s55,v11
v_mfma_f32_16x16x32_bf16 v[32:35],a[224:227],v[112:115],v[32:35]
s_waitcnt vmcnt(8)
ds_read_b128 v[64:67],v4 offset:0
v_mfma_f32_16x16x32_bf16 v[36:39],a[228:231],v[112:115],v[36:39]
s_waitcnt lgkmcnt(3)
s_waitcnt vmcnt(7)
ds_read_b128 v[68:71],v4 offset:1024
v_mfma_f32_16x16x32_bf16 v[32:35],a[232:235],v[116:119],v[32:35]
s_waitcnt vmcnt(6)
ds_read_b128 v[72:75],v4 offset:2048
v_mfma_f32_16x16x32_bf16 v[36:39],a[236:239],v[116:119],v[36:39]
s_waitcnt lgkmcnt(4)
v_mfma_f32_16x16x32_bf16 v[32:35],a[240:243],v[120:123],v[32:35]
v_mfma_f32_16x16x32_bf16 v[36:39],a[244:247],v[120:123],v[36:39]
s_waitcnt lgkmcnt(3)
v_mfma_f32_16x16x32_bf16 v[40:43],a[248:251],v[124:127],v[32:35]
v_mfma_f32_16x16x32_bf16 v[44:47],a[252:255],v[124:127],v[36:39]
s_waitcnt vmcnt(1)
v_cmp_gt_u32 vcc,s53,v16
s_add_u32 s60,s60,1
s_cbranch_vccnz WN_88
.p2align 6
WR_87:
s_waitcnt lgkmcnt(2)
v_mfma_f32_16x16x32_bf16 v[32:35],a[0:3],v[64:67],0
s_waitcnt vmcnt(5)
s_add_u32 s71,s60,2
ds_read_b128 v[76:79],v4 offset:3072
v_mfma_f32_16x16x32_bf16 v[36:39],a[4:7],v[64:67],0
s_waitcnt lgkmcnt(2)
s_add_u32 s53,s60,3
v_mfma_f32_16x16x32_bf16 v[32:35],a[8:11],v[68:71],v[32:35]
s_waitcnt vmcnt(4)
s_mov_b32 m0,s70
ds_read_b128 v[80:83],v4 offset:4096
v_mfma_f32_16x16x32_bf16 v[36:39],a[12:15],v[68:71],v[36:39]
s_waitcnt lgkmcnt(2)
buffer_load_dwordx4 v3,s[20:23],s61 offen offset:0 lds
s_add_u32 s64,s74,s75
s_cmp_eq_u32 s56,1
s_cbranch_scc1 b1_96
buffer_store_dwordx4 v[40:43],v0,s[20:23],s64 offen offset:0
buffer_store_dwordx4 v[44:47],v0,s[20:23],s64 offen offset:1024
b2_97:
v_mfma_f32_16x16x32_bf16 v[32:35],a[16:19],v[72:75],v[32:35]
s_waitcnt vmcnt(6)
s_add_u32 s75,s75,6144
ds_read_b128 v[84:87],v4 offset:5120
v_mfma_f32_16x16x32_bf16 v[36:39],a[20:23],v[72:75],v[36:39]
s_waitcnt lgkmcnt(2)
s_cmp_eq_u32 s75,24576
s_cselect_b32 s75,0,s75
v_mfma_f32_16x16x32_bf16 v[32:35],a[24:27],v[76:79],v[32:35]
s_waitcnt vmcnt(5)
ds_read_b128 v[88:91],v4 offset:6144
buffer_load_dwordx4 v3,s[20:23],s61 offen offset:1024 lds
v_mfma_f32_16x16x32_bf16 v[36:39],a[28:31],v[76:79],v[36:39]
s_waitcnt lgkmcnt(2)
v_mfma_f32_16x16x32_bf16 v[32:35],a[32:35],v[80:83],v[32:35]
s_waitcnt vmcnt(4)
ds_read_b128 v[92:95],v4 offset:7168
v_mfma_f32_16x16x32_bf16 v[36:39],a[36:39],v[80:83],v[36:39]
s_waitcnt lgkmcnt(2)
s_barrier
ds_read_b128 v[96:99],v5 offset:0
v_mfma_f32_16x16x32_bf16 v[32:35],a[40:43],v[84:87],v[32:35]
ds_read_b128 v[100:103],v5 offset:1024
buffer_load_dwordx4 v3,s[20:23],s61 offen offset:2048 lds
v_mfma_f32_16x16x32_bf16 v[36:39],a[44:47],v[84:87],v[36:39]
s_waitcnt lgkmcnt(3)
ds_read_b128 v[104:107],v5 offset:2048
v_mfma_f32_16x16x32_bf16 v[32:35],a[48:51],v[88:91],v[32:35]
ds_read_b128 v[108:111],v5 offset:3072
v_mfma_f32_16x16x32_bf16 v[36:39],a[52:55],v[88:91],v[36:39]
s_waitcnt lgkmcnt(4)
ds_read_b128 v[112:115],v5 offset:4096
buffer_load_dwordx4 v3,s[20:23],s61 offen offset:3072 lds
v_mfma_f32_16x16x32_bf16 v[32:35],a[56:59],v[92:95],v[32:35]
ds_read_b128 v[116:119],v5 offset:5120
v_mfma_f32_16x16x32_bf16 v[36:39],a[60:63],v[92:95],v[36:39]
s_waitcnt lgkmcnt(5)
s_add_u32 m0,s70,4096
v_mfma_f32_16x16x32_bf16 v[32:35],a[64:67],v[96:99],v[32:35]
ds_read_b128 v[120:123],v5 offset:6144
buffer_load_dwordx4 v3,s[20:23],s62 offen offset:0 lds
v_mfma_f32_16x16x32_bf16 v[36:39],a[68:71],v[96:99],v[36:39]
s_waitcnt lgkmcnt(5)
v_mfma_f32_16x16x32_bf16 v[32:35],a[72:75],v[100:103],v[32:35]
ds_read_b128 v[124:127],v5 offset:7168
v_mfma_f32_16x16x32_bf16 v[36:39],a[76:79],v[100:103],v[36:39]
s_waitcnt lgkmcnt(5)
buffer_load_dwordx4 v3,s[20:23],s62 offen offset:1024 lds
v_mfma_f32_16x16x32_bf16 v[32:35],a[80:83],v[104:107],v[32:35]
ds_read_b128 v[64:67],v6 offset:0
v_mfma_f32_16x16x32_bf16 v[36:39],a[84:87],v[104:107],v[36:39]
s_waitcnt lgkmcnt(5)
v_mfma_f32_16x16x32_bf16 v[32:35],a[88:91],v[108:111],v[32:35]
ds_read_b128 v[68:71],v6 offset:1024
v_mfma_f32_16x16x32_bf16 v[36:39],a[92:95],v[108:111],v[36:39]
s_waitcnt lgkmcnt(5)
buffer_load_dwordx4 v3,s[20:23],s62 offen offset:2048 lds
v_mfma_f32_16x16x32_bf16 v[32:35],a[96:99],v[112:115],v[32:35]
ds_read_b128 v[72:75],v6 offset:2048
buffer_load_dword v16,v2,s[20:23],s68 offen sc1
v_mfma_f32_16x16x32_bf16 v[36:39],a[100:103],v[112:115],v[36:39]
s_waitcnt lgkmcnt(5)
v_mfma_f32_16x16x32_bf16 v[32:35],a[104:107],v[116:119],v[32:35]
ds_read_b128 v[76:79],v6 offset:3072
buffer_load_dwordx4 v3,s[20:23],s62 offen offset:3072 lds
v_mfma_f32_16x16x32_bf16 v[36:39],a[108:111],v[116:119],v[36:39]
s_waitcnt lgkmcnt(5)
v_mfma_f32_16x16x32_bf16 v[32:35],a[112:115],v[120:123],v[32:35]
ds_read_b128 v[80:83],v6 offset:4096
v_mfma_f32_16x16x32_bf16 v[36:39],a[116:119],v[120:123],v[36:39]
s_waitcnt lgkmcnt(5)
v_mfma_f32_16x16x32_bf16 v[32:35],a[120:123],v[124:127],v[32:35]
ds_read_b128 v[84:87],v6 offset:5120
v_mfma_f32_16x16x32_bf16 v[36:39],a[124:127],v[124:127],v[36:39]
s_waitcnt lgkmcnt(5)
v_mfma_f32_16x16x32_bf16 v[32:35],a[128:131],v[64:67],v[32:35]
ds_read_b128 v[88:91],v6 offset:6144
v_mfma_f32_16x16x32_bf16 v[36:39],a[132:135],v[64:67],v[36:39]
s_waitcnt lgkmcnt(5)
v_mfma_f32_16x16x32_bf16 v[32:35],a[136:139],v[68:71],v[32:35]
ds_read_b128 v[92:95],v6 offset:7168
v_mfma_f32_16x16x32_bf16 v[36:39],a[140:143],v[68:71],v[36:39]
s_waitcnt lgkmcnt(5)
v_mfma_f32_16x16x32_bf16 v[32:35],a[144:147],v[72:75],v[32:35]
ds_read_b128 v[96:99],v7 offset:0
v_mfma_f32_16x16x32_bf16 v[36:39],a[148:151],v[72:75],v[36:39]
s_waitcnt lgkmcnt(5)
v_mfma_f32_16x16x32_bf16 v[32:35],a[152:155],v[76:79],v[32:35]
ds_read_b128 v[100:103],v7 offset:1024
v_mfma_f32_16x16x32_bf16 v[36:39],a[156:159],v[76:79],v[36:39]
s_waitcnt lgkmcnt(5)
v_mfma_f32_16x16x32_bf16 v[32:35],a[160:163],v[80:83],v[32:35]
ds_read_b128 v[104:107],v7 offset:2048
v_mfma_f32_16x16x32_bf16 v[36:39],a[164:167],v[80:83],v[36:39]
s_waitcnt lgkmcnt(5)
v_mfma_f32_16x16x32_bf16 v[32:35],a[168:171],v[84:87],v[32:35]
ds_read_b128 v[108:111],v7 offset:3072
v_mfma_f32_16x16x32_bf16 v[36:39],a[172:175],v[84:87],v[36:39]
s_waitcnt lgkmcnt(5)
v_mfma_f32_16x16x32_bf16 v[32:35],a[176:179],v[88:91],v[32:35]
ds_read_b128 v[112:115],v7 offset:4096
v_mfma_f32_16x16x32_bf16 v[36:39],a[180:183],v[88:91],v[36:39]
s_waitcnt lgkmcnt(5)
v_mfma_f32_16x16x32_bf16 v[32:35],a[184:187],v[92:95],v[32:35]
ds_read_b128 v[116:119],v7 offset:5120
v_mfma_f32_16x16x32_bf16 v[36:39],a[188:191],v[92:95],v[36:39]
s_waitcnt lgkmcnt(5)
v_mfma_f32_16x16x32_bf16 v[32:35],a[192:195],v[96:99],v[32:35]
ds_read_b128 v[120:123],v7 offset:6144
v_mfma_f32_16x16x32_bf16 v[36:39],a[196:199],v[96:99],v[36:39]
s_waitcnt lgkmcnt(5)
v_mfma_f32_16x16x32_bf16 v[32:35],a[200:203],v[100:103],v[32:35]
ds_read_b128 v[124:127],v7 offset:7168
v_mfma_f32_16x16x32_bf16 v[36:39],a[204:207],v[100:103],v[36:39]
s_waitcnt lgkmcnt(5)
s_add_u32 s61,s61,131072
s_add_u32 s62,s62,131072
v_mfma_f32_16x16x32_bf16 v[32:35],a[208:211],v[104:107],v[32:35]
s_add_u32 s70,s70,32768
s_and_b32 s70,s70,0x1ffff
s_add_u32 s55,s55,32768
v_mfma_f32_16x16x32_bf16 v[36:39],a[212:215],v[104:107],v[36:39]
s_waitcnt lgkmcnt(4)
s_and_b32 s55,s55,0x1ffff
v_add_u32 v4,s55,v8
v_mfma_f32_16x16x32_bf16 v[32:35],a[216:219],v[108:111],v[32:35]
v_add_u32 v5,s55,v9
v_add_u32 v6,s55,v10
v_mfma_f32_16x16x32_bf16 v[36:39],a[220:223],v[108:111],v[36:39]
s_waitcnt lgkmcnt(3)
v_add_u32 v7,s55,v11
v_mfma_f32_16x16x32_bf16 v[32:35],a[224:227],v[112:115],v[32:35]
s_waitcnt vmcnt(10)
ds_read_b128 v[64:67],v4 offset:0
v_mfma_f32_16x16x32_bf16 v[36:39],a[228:231],v[112:115],v[36:39]
s_waitcnt lgkmcnt(3)
s_waitcnt vmcnt(7)
ds_read_b128 v[68:71],v4 offset:1024
v_mfma_f32_16x16x32_bf16 v[32:35],a[232:235],v[116:119],v[32:35]
s_waitcnt vmcnt(6)
ds_read_b128 v[72:75],v4 offset:2048
v_mfma_f32_16x16x32_bf16 v[36:39],a[236:239],v[116:119],v[36:39]
s_waitcnt lgkmcnt(4)
v_mfma_f32_16x16x32_bf16 v[32:35],a[240:243],v[120:123],v[32:35]
v_mfma_f32_16x16x32_bf16 v[36:39],a[244:247],v[120:123],v[36:39]
s_waitcnt lgkmcnt(3)
v_mfma_f32_16x16x32_bf16 v[40:43],a[248:251],v[124:127],v[32:35]
v_mfma_f32_16x16x32_bf16 v[44:47],a[252:255],v[124:127],v[36:39]
s_waitcnt vmcnt(1)
v_cmp_gt_u32 vcc,s53,v16
s_add_u32 s60,s60,1
s_cbranch_vccz WR_87
WN_88:
s_waitcnt lgkmcnt(2)
v_mfma_f32_16x16x32_bf16 v[32:35],a[0:3],v[64:67],0
s_waitcnt vmcnt(5)
s_add_u32 s71,s60,2
ds_read_b128 v[76:79],v4 offset:3072
v_mfma_f32_16x16x32_bf16 v[36:39],a[4:7],v[64:67],0
s_waitcnt lgkmcnt(2)
s_add_u32 s53,s60,3
v_mfma_f32_16x16x32_bf16 v[32:35],a[8:11],v[68:71],v[32:35]
s_waitcnt vmcnt(4)
ds_read_b128 v[80:83],v4 offset:4096
v_mfma_f32_16x16x32_bf16 v[36:39],a[12:15],v[68:71],v[36:39]
s_waitcnt lgkmcnt(2)
s_add_u32 s64,s74,s75
s_cmp_eq_u32 s56,1
s_cbranch_scc1 b1_99
buffer_store_dwordx4 v[40:43],v0,s[20:23],s64 offen offset:0
buffer_store_dwordx4 v[44:47],v0,s[20:23],s64 offen offset:1024
b2_100:
v_mfma_f32_16x16x32_bf16 v[32:35],a[16:19],v[72:75],v[32:35]
s_waitcnt vmcnt(5)
s_add_u32 s75,s75,6144
ds_read_b128 v[84:87],v4 offset:5120
v_mfma_f32_16x16x32_bf16 v[36:39],a[20:23],v[72:75],v[36:39]
s_waitcnt lgkmcnt(2)
s_cmp_eq_u32 s75,24576
s_cselect_b32 s75,0,s75
v_mfma_f32_16x16x32_bf16 v[32:35],a[24:27],v[76:79],v[32:35]
s_waitcnt vmcnt(4)
ds_read_b128 v[88:91],v4 offset:6144
v_mfma_f32_16x16x32_bf16 v[36:39],a[28:31],v[76:79],v[36:39]
s_waitcnt lgkmcnt(2)
v_mfma_f32_16x16x32_bf16 v[32:35],a[32:35],v[80:83],v[32:35]
s_waitcnt vmcnt(2)
ds_read_b128 v[92:95],v4 offset:7168
v_mfma_f32_16x16x32_bf16 v[36:39],a[36:39],v[80:83],v[36:39]
s_waitcnt lgkmcnt(2)
s_barrier
ds_read_b128 v[96:99],v5 offset:0
v_mfma_f32_16x16x32_bf16 v[32:35],a[40:43],v[84:87],v[32:35]
ds_read_b128 v[100:103],v5 offset:1024
v_mfma_f32_16x16x32_bf16 v[36:39],a[44:47],v[84:87],v[36:39]
s_waitcnt lgkmcnt(3)
ds_read_b128 v[104:107],v5 offset:2048
v_mfma_f32_16x16x32_bf16 v[32:35],a[48:51],v[88:91],v[32:35]
ds_read_b128 v[108:111],v5 offset:3072
v_mfma_f32_16x16x32_bf16 v[36:39],a[52:55],v[88:91],v[36:39]
s_waitcnt lgkmcnt(4)
ds_read_b128 v[112:115],v5 offset:4096
v_mfma_f32_16x16x32_bf16 v[32:35],a[56:59],v[92:95],v[32:35]
ds_read_b128 v[116:119],v5 offset:5120
v_mfma_f32_16x16x32_bf16 v[36:39],a[60:63],v[92:95],v[36:39]
s_waitcnt lgkmcnt(5)
v_mfma_f32_16x16x32_bf16 v[32:35],a[64:67],v[96:99],v[32:35]
ds_read_b128 v[120:123],v5 offset:6144
v_mfma_f32_16x16x32_bf16 v[36:39],a[68:71],v[96:99],v[36:39]
s_waitcnt lgkmcnt(5)
v_mfma_f32_16x16x32_bf16 v[32:35],a[72:75],v[100:103],v[32:35]
ds_read_b128 v[124:127],v5 offset:7168
v_mfma_f32_16x16x32_bf16 v[36:39],a[76:79],v[100:103],v[36:39]
s_waitcnt lgkmcnt(5)
v_mfma_f32_16x16x32_bf16 v[32:35],a[80:83],v[104:107],v[32:35]
ds_read_b128 v[64:67],v6 offset:0
v_mfma_f32_16x16x32_bf16 v[36:39],a[84:87],v[104:107],v[36:39]
s_waitcnt lgkmcnt(5)
v_mfma_f32_16x16x32_bf16 v[32:35],a[88:91],v[108:111],v[32:35]
ds_read_b128 v[68:71],v6 offset:1024
v_mfma_f32_16x16x32_bf16 v[36:39],a[92:95],v[108:111],v[36:39]
s_waitcnt lgkmcnt(5)
v_mfma_f32_16x16x32_bf16 v[32:35],a[96:99],v[112:115],v[32:35]
ds_read_b128 v[72:75],v6 offset:2048
v_mfma_f32_16x16x32_bf16 v[36:39],a[100:103],v[112:115],v[36:39]
s_waitcnt lgkmcnt(5)
v_mfma_f32_16x16x32_bf16 v[32:35],a[104:107],v[116:119],v[32:35]
ds_read_b128 v[76:79],v6 offset:3072
v_mfma_f32_16x16x32_bf16 v[36:39],a[108:111],v[116:119],v[36:39]
s_waitcnt lgkmcnt(5)
v_mfma_f32_16x16x32_bf16 v[32:35],a[112:115],v[120:123],v[32:35]
ds_read_b128 v[80:83],v6 offset:4096
v_mfma_f32_16x16x32_bf16 v[36:39],a[116:119],v[120:123],v[36:39]
s_waitcnt lgkmcnt(5)
v_mfma_f32_16x16x32_bf16 v[32:35],a[120:123],v[124:127],v[32:35]
ds_read_b128 v[84:87],v6 offset:5120
v_mfma_f32_16x16x32_bf16 v[36:39],a[124:127],v[124:127],v[36:39]
s_waitcnt lgkmcnt(5)
v_mfma_f32_16x16x32_bf16 v[32:35],a[128:131],v[64:67],v[32:35]
ds_read_b128 v[88:91],v6 offset:6144
v_mfma_f32_16x16x32_bf16 v[36:39],a[132:135],v[64:67],v[36:39]
s_waitcnt lgkmcnt(5)
v_mfma_f32_16x16x32_bf16 v[32:35],a[136:139],v[68:71],v[32:35]
ds_read_b128 v[92:95],v6 offset:7168
v_mfma_f32_16x16x32_bf16 v[36:39],a[140:143],v[68:71],v[36:39]
s_waitcnt lgkmcnt(5)
v_mfma_f32_16x16x32_bf16 v[32:35],a[144:147],v[72:75],v[32:35]
ds_read_b128 v[96:99],v7 offset:0
v_mfma_f32_16x16x32_bf16 v[36:39],a[148:151],v[72:75],v[36:39]
s_waitcnt lgkmcnt(5)
v_mfma_f32_16x16x32_bf16 v[32:35],a[152:155],v[76:79],v[32:35]
ds_read_b128 v[100:103],v7 offset:1024
v_mfma_f32_16x16x32_bf16 v[36:39],a[156:159],v[76:79],v[36:39]
s_waitcnt lgkmcnt(5)
v_mfma_f32_16x16x32_bf16 v[32:35],a[160:163],v[80:83],v[32:35]
ds_read_b128 v[104:107],v7 offset:2048
buffer_load_dword v16,v2,s[20:23],s68 offen sc1
v_mfma_f32_16x16x32_bf16 v[36:39],a[164:167],v[80:83],v[36:39]
s_waitcnt lgkmcnt(5)
v_mfma_f32_16x16x32_bf16 v[32:35],a[168:171],v[84:87],v[32:35]
ds_read_b128 v[108:111],v7 offset:3072
v_mfma_f32_16x16x32_bf16 v[36:39],a[172:175],v[84:87],v[36:39]
s_waitcnt lgkmcnt(5)
v_mfma_f32_16x16x32_bf16 v[32:35],a[176:179],v[88:91],v[32:35]
ds_read_b128 v[112:115],v7 offset:4096
v_mfma_f32_16x16x32_bf16 v[36:39],a[180:183],v[88:91],v[36:39]
s_waitcnt lgkmcnt(5)
v_mfma_f32_16x16x32_bf16 v[32:35],a[184:187],v[92:95],v[32:35]
ds_read_b128 v[116:119],v7 offset:5120
v_mfma_f32_16x16x32_bf16 v[36:39],a[188:191],v[92:95],v[36:39]
s_waitcnt lgkmcnt(5)
v_mfma_f32_16x16x32_bf16 v[32:35],a[192:195],v[96:99],v[32:35]
ds_read_b128 v[120:123],v7 offset:6144
v_mfma_f32_16x16x32_bf16 v[36:39],a[196:199],v[96:99],v[36:39]
s_waitcnt lgkmcnt(5)
v_mfma_f32_16x16x32_bf16 v[32:35],a[200:203],v[100:103],v[32:35]
ds_read_b128 v[124:127],v7 offset:7168
v_mfma_f32_16x16x32_bf16 v[36:39],a[204:207],v[100:103],v[36:39]
s_waitcnt lgkmcnt(5)
s_add_u32 s55,s55,32768
s_and_b32 s55,s55,0x1ffff
v_mfma_f32_16x16x32_bf16 v[32:35],a[208:211],v[104:107],v[32:35]
v_add_u32 v4,s55,v8
v_add_u32 v5,s55,v9
v_mfma_f32_16x16x32_bf16 v[36:39],a[212:215],v[104:107],v[36:39]
s_waitcnt lgkmcnt(4)
v_add_u32 v6,s55,v10
v_add_u32 v7,s55,v11
v_mfma_f32_16x16x32_bf16 v[32:35],a[216:219],v[108:111],v[32:35]
v_mfma_f32_16x16x32_bf16 v[36:39],a[220:223],v[108:111],v[36:39]
s_waitcnt lgkmcnt(3)
v_mfma_f32_16x16x32_bf16 v[32:35],a[224:227],v[112:115],v[32:35]
v_mfma_f32_16x16x32_bf16 v[36:39],a[228:231],v[112:115],v[36:39]
s_waitcnt lgkmcnt(2)
v_mfma_f32_16x16x32_bf16 v[32:35],a[232:235],v[116:119],v[32:35]
v_mfma_f32_16x16x32_bf16 v[36:39],a[236:239],v[116:119],v[36:39]
s_waitcnt lgkmcnt(1)
v_mfma_f32_16x16x32_bf16 v[32:35],a[240:243],v[120:123],v[32:35]
v_mfma_f32_16x16x32_bf16 v[36:39],a[244:247],v[120:123],v[36:39]
s_waitcnt lgkmcnt(0)
v_mfma_f32_16x16x32_bf16 v[40:43],a[248:251],v[124:127],v[32:35]
v_mfma_f32_16x16x32_bf16 v[44:47],a[252:255],v[124:127],v[36:39]
s_waitcnt vmcnt(0)
v_cmp_gt_u32 vcc,s71,v16
s_add_u32 s60,s60,1
s_branch endN_98
BN_90:
s_waitcnt vmcnt(9)
ds_read_b128 v[64:67],v4 offset:0
s_waitcnt vmcnt(8)
ds_read_b128 v[68:71],v4 offset:1024
s_waitcnt vmcnt(7)
ds_read_b128 v[72:75],v4 offset:2048
s_waitcnt vmcnt(6)
ds_read_b128 v[76:79],v4 offset:3072
s_waitcnt lgkmcnt(3)
v_mfma_f32_16x16x32_bf16 v[32:35],a[0:3],v[64:67],0
s_add_u32 s71,s60,2
s_add_u32 s53,s60,3
v_mfma_f32_16x16x32_bf16 v[36:39],a[4:7],v[64:67],0
s_waitcnt lgkmcnt(2)
s_waitcnt vmcnt(5)
ds_read_b128 v[80:83],v4 offset:4096
v_mfma_f32_16x16x32_bf16 v[32:35],a[8:11],v[68:71],v[32:35]
v_mfma_f32_16x16x32_bf16 v[36:39],a[12:15],v[68:71],v[36:39]
s_waitcnt lgkmcnt(2)
s_waitcnt vmcnt(4)
ds_read_b128 v[84:87],v4 offset:5120
v_mfma_f32_16x16x32_bf16 v[32:35],a[16:19],v[72:75],v[32:35]
v_mfma_f32_16x16x32_bf16 v[36:39],a[20:23],v[72:75],v[36:39]
s_waitcnt lgkmcnt(2)
s_waitcnt vmcnt(3)
ds_read_b128 v[88:91],v4 offset:6144
v_mfma_f32_16x16x32_bf16 v[32:35],a[24:27],v[76:79],v[32:35]
v_mfma_f32_16x16x32_bf16 v[36:39],a[28:31],v[76:79],v[36:39]
s_waitcnt lgkmcnt(2)
s_waitcnt vmcnt(2)
ds_read_b128 v[92:95],v4 offset:7168
v_mfma_f32_16x16x32_bf16 v[32:35],a[32:35],v[80:83],v[32:35]
v_mfma_f32_16x16x32_bf16 v[36:39],a[36:39],v[80:83],v[36:39]
s_waitcnt lgkmcnt(2)
s_barrier
ds_read_b128 v[96:99],v5 offset:0
v_mfma_f32_16x16x32_bf16 v[32:35],a[40:43],v[84:87],v[32:35]
ds_read_b128 v[100:103],v5 offset:1024
v_mfma_f32_16x16x32_bf16 v[36:39],a[44:47],v[84:87],v[36:39]
s_waitcnt lgkmcnt(3)
ds_read_b128 v[104:107],v5 offset:2048
v_mfma_f32_16x16x32_bf16 v[32:35],a[48:51],v[88:91],v[32:35]
ds_read_b128 v[108:111],v5 offset:3072
v_mfma_f32_16x16x32_bf16 v[36:39],a[52:55],v[88:91],v[36:39]
s_waitcnt lgkmcnt(4)
ds_read_b128 v[112:115],v5 offset:4096
v_mfma_f32_16x16x32_bf16 v[32:35],a[56:59],v[92:95],v[32:35]
ds_read_b128 v[116:119],v5 offset:5120
v_mfma_f32_16x16x32_bf16 v[36:39],a[60:63],v[92:95],v[36:39]
s_waitcnt lgkmcnt(5)
v_mfma_f32_16x16x32_bf16 v[32:35],a[64:67],v[96:99],v[32:35]
ds_read_b128 v[120:123],v5 offset:6144
v_mfma_f32_16x16x32_bf16 v[36:39],a[68:71],v[96:99],v[36:39]
s_waitcnt lgkmcnt(5)
v_mfma_f32_16x16x32_bf16 v[32:35],a[72:75],v[100:103],v[32:35]
ds_read_b128 v[124:127],v5 offset:7168
v_mfma_f32_16x16x32_bf16 v[36:39],a[76:79],v[100:103],v[36:39]
s_waitcnt lgkmcnt(5)
v_mfma_f32_16x16x32_bf16 v[32:35],a[80:83],v[104:107],v[32:35]
ds_read_b128 v[64:67],v6 offset:0
v_mfma_f32_16x16x32_bf16 v[36:39],a[84:87],v[104:107],v[36:39]
s_waitcnt lgkmcnt(5)
v_mfma_f32_16x16x32_bf16 v[32:35],a[88:91],v[108:111],v[32:35]
ds_read_b128 v[68:71],v6 offset:1024
v_mfma_f32_16x16x32_bf16 v[36:39],a[92:95],v[108:111],v[36:39]
s_waitcnt lgkmcnt(5)
v_mfma_f32_16x16x32_bf16 v[32:35],a[96:99],v[112:115],v[32:35]
ds_read_b128 v[72:75],v6 offset:2048
v_mfma_f32_16x16x32_bf16 v[36:39],a[100:103],v[112:115],v[36:39]
s_waitcnt lgkmcnt(5)
v_mfma_f32_16x16x32_bf16 v[32:35],a[104:107],v[116:119],v[32:35]
ds_read_b128 v[76:79],v6 offset:3072
v_mfma_f32_16x16x32_bf16 v[36:39],a[108:111],v[116:119],v[36:39]
s_waitcnt lgkmcnt(5)
v_mfma_f32_16x16x32_bf16 v[32:35],a[112:115],v[120:123],v[32:35]
ds_read_b128 v[80:83],v6 offset:4096
v_mfma_f32_16x16x32_bf16 v[36:39],a[116:119],v[120:123],v[36:39]
s_waitcnt lgkmcnt(5)
v_mfma_f32_16x16x32_bf16 v[32:35],a[120:123],v[124:127],v[32:35]
ds_read_b128 v[84:87],v6 offset:5120
v_mfma_f32_16x16x32_bf16 v[36:39],a[124:127],v[124:127],v[36:39]
s_waitcnt lgkmcnt(5)
v_mfma_f32_16x16x32_bf16 v[32:35],a[128:131],v[64:67],v[32:35]
ds_read_b128 v[88:91],v6 offset:6144
v_mfma_f32_16x16x32_bf16 v[36:39],a[132:135],v[64:67],v[36:39]
s_waitcnt lgkmcnt(5)
v_mfma_f32_16x16x32_bf16 v[32:35],a[136:139],v[68:71],v[32:35]
ds_read_b128 v[92:95],v6 offset:7168
v_mfma_f32_16x16x32_bf16 v[36:39],a[140:143],v[68:71],v[36:39]
s_waitcnt lgkmcnt(5)
v_mfma_f32_16x16x32_bf16 v[32:35],a[144:147],v[72:75],v[32:35]
ds_read_b128 v[96:99],v7 offset:0
v_mfma_f32_16x16x32_bf16 v[36:39],a[148:151],v[72:75],v[36:39]
s_waitcnt lgkmcnt(5)
v_mfma_f32_16x16x32_bf16 v[32:35],a[152:155],v[76:79],v[32:35]
ds_read_b128 v[100:103],v7 offset:1024
v_mfma_f32_16x16x32_bf16 v[36:39],a[156:159],v[76:79],v[36:39]
s_waitcnt lgkmcnt(5)
v_mfma_f32_16x16x32_bf16 v[32:35],a[160:163],v[80:83],v[32:35]
ds_read_b128 v[104:107],v7 offset:2048
buffer_load_dword v16,v2,s[20:23],s68 offen sc1
v_mfma_f32_16x16x32_bf16 v[36:39],a[164:167],v[80:83],v[36:39]
s_waitcnt lgkmcnt(5)
v_mfma_f32_16x16x32_bf16 v[32:35],a[168:171],v[84:87],v[32:35]
ds_read_b128 v[108:111],v7 offset:3072
v_mfma_f32_16x16x32_bf16 v[36:39],a[172:175],v[84:87],v[36:39]
s_waitcnt lgkmcnt(5)
v_mfma_f32_16x16x32_bf16 v[32:35],a[176:179],v[88:91],v[32:35]
ds_read_b128 v[112:115],v7 offset:4096
v_mfma_f32_16x16x32_bf16 v[36:39],a[180:183],v[88:91],v[36:39]
s_waitcnt lgkmcnt(5)
v_mfma_f32_16x16x32_bf16 v[32:35],a[184:187],v[92:95],v[32:35]
ds_read_b128 v[116:119],v7 offset:5120
v_mfma_f32_16x16x32_bf16 v[36:39],a[188:191],v[92:95],v[36:39]
s_waitcnt lgkmcnt(5)
v_mfma_f32_16x16x32_bf16 v[32:35],a[192:195],v[96:99],v[32:35]
ds_read_b128 v[120:123],v7 offset:6144
v_mfma_f32_16x16x32_bf16 v[36:39],a[196:199],v[96:99],v[36:39]
s_waitcnt lgkmcnt(5)
v_mfma_f32_16x16x32_bf16 v[32:35],a[200:203],v[100:103],v[32:35]
ds_read_b128 v[124:127],v7 offset:7168
v_mfma_f32_16x16x32_bf16 v[36:39],a[204:207],v[100:103],v[36:39]
s_waitcnt lgkmcnt(5)
s_add_u32 s55,s55,32768
s_and_b32 s55,s55,0x1ffff
v_mfma_f32_16x16x32_bf16 v[32:35],a[208:211],v[104:107],v[32:35]
v_add_u32 v4,s55,v8
v_add_u32 v5,s55,v9
v_mfma_f32_16x16x32_bf16 v[36:39],a[212:215],v[104:107],v[36:39]
s_waitcnt lgkmcnt(4)
v_add_u32 v6,s55,v10
v_add_u32 v7,s55,v11
v_mfma_f32_16x16x32_bf16 v[32:35],a[216:219],v[108:111],v[32:35]
v_mfma_f32_16x16x32_bf16 v[36:39],a[220:223],v[108:111],v[36:39]
s_waitcnt lgkmcnt(3)
v_mfma_f32_16x16x32_bf16 v[32:35],a[224:227],v[112:115],v[32:35]
v_mfma_f32_16x16x32_bf16 v[36:39],a[228:231],v[112:115],v[36:39]
s_waitcnt lgkmcnt(2)
v_mfma_f32_16x16x32_bf16 v[32:35],a[232:235],v[116:119],v[32:35]
v_mfma_f32_16x16x32_bf16 v[36:39],a[236:239],v[116:119],v[36:39]
s_waitcnt lgkmcnt(1)
v_mfma_f32_16x16x32_bf16 v[32:35],a[240:243],v[120:123],v[32:35]
v_mfma_f32_16x16x32_bf16 v[36:39],a[244:247],v[120:123],v[36:39]
s_waitcnt lgkmcnt(0)
v_mfma_f32_16x16x32_bf16 v[40:43],a[248:251],v[124:127],v[32:35]
v_mfma_f32_16x16x32_bf16 v[44:47],a[252:255],v[124:127],v[36:39]
s_waitcnt vmcnt(0)
v_cmp_gt_u32 vcc,s71,v16
s_add_u32 s60,s60,1
endN_98:
s_cbranch_vccnz nb_93
s_mov_b32 m0,s70
s_nop 0
buffer_load_dwordx4 v3,s[20:23],s61 offen offset:0 lds
buffer_load_dwordx4 v3,s[20:23],s61 offen offset:1024 lds
buffer_load_dwordx4 v3,s[20:23],s61 offen offset:2048 lds
buffer_load_dwordx4 v3,s[20:23],s61 offen offset:3072 lds
s_add_u32 m0,s70,4096
s_nop 0
buffer_load_dwordx4 v3,s[20:23],s62 offen offset:0 lds
buffer_load_dwordx4 v3,s[20:23],s62 offen offset:1024 lds
buffer_load_dwordx4 v3,s[20:23],s62 offen offset:2048 lds
buffer_load_dwordx4 v3,s[20:23],s62 offen offset:3072 lds
s_add_u32 s61,s61,131072
s_add_u32 s62,s62,131072
s_add_u32 s70,s70,32768
s_and_b32 s70,s70,0x1ffff
s_add_u32 s64,s74,s75
s_cmp_eq_u32 s56,1
s_cbranch_scc1 b1_101
buffer_store_dwordx4 v[40:43],v0,s[20:23],s64 offen offset:0
buffer_store_dwordx4 v[44:47],v0,s[20:23],s64 offen offset:1024
b2_102:
s_add_u32 s75,s75,6144
s_cmp_eq_u32 s75,24576
s_cselect_b32 s75,0,s75
s_branch dec_92
nb_93:
buffer_load_dword v16,v2,s[20:23],s68 offen sc1
s_nop 3
s_add_u32 s64,s74,s75
s_cmp_eq_u32 s56,1
s_cbranch_scc1 b1_103
buffer_store_dwordx4 v[40:43],v0,s[20:23],s64 offen offset:0
buffer_store_dwordx4 v[44:47],v0,s[20:23],s64 offen offset:1024
b2_104:
s_add_u32 s75,s75,6144
s_cmp_eq_u32 s75,24576
s_cselect_b32 s75,0,s75
s_waitcnt vmcnt(2)
v_cmp_gt_u32 vcc,s71,v16
s_cbranch_vccz lag_91
s_cmp_ge_u32 s60,128
s_cbranch_scc1 done_77
plp_107:
buffer_load_dword v16,v2,s[20:23],s68 offen sc1
s_waitcnt vmcnt(0)
v_cmp_gt_u32 vcc,s71,v16
s_cbranch_vccz pok_108
s_sleep 4
s_sub_u32 s90,s90,1
s_cmp_gt_i32 s90,0
s_cbranch_scc1 plp_107
pok_108:
s_branch lag_91
lfin_84:
s_add_u32 s71,s60,1
s_add_u32 s53,s60,2
plp_128:
buffer_load_dword v16,v2,s[20:23],s68 offen sc1
s_waitcnt vmcnt(0)
v_cmp_gt_u32 vcc,s71,v16
s_cbranch_vccz pok_129
s_sleep 4
s_sub_u32 s90,s90,1
s_cmp_gt_i32 s90,0
s_cbranch_scc1 plp_128
pok_129:
lag_125:
s_mov_b32 m0,s70
s_nop 0
buffer_load_dwordx4 v3,s[20:23],s61 offen offset:0 lds
buffer_load_dwordx4 v3,s[20:23],s61 offen offset:1024 lds
buffer_load_dwordx4 v3,s[20:23],s61 offen offset:2048 lds
buffer_load_dwordx4 v3,s[20:23],s61 offen offset:3072 lds
s_add_u32 m0,s70,4096
s_nop 0
buffer_load_dwordx4 v3,s[20:23],s62 offen offset:0 lds
buffer_load_dwordx4 v3,s[20:23],s62 offen offset:1024 lds
buffer_load_dwordx4 v3,s[20:23],s62 offen offset:2048 lds
buffer_load_dwordx4 v3,s[20:23],s62 offen offset:3072 lds
s_add_u32 s61,s61,131072
s_add_u32 s62,s62,131072
s_add_u32 s70,s70,32768
s_and_b32 s70,s70,0x1ffff
dec_126:
v_cmp_gt_u32 vcc,s53,v16
s_cbranch_vccnz BN_124
BR_123:
s_waitcnt vmcnt(7)
ds_read_b128 v[64:67],v4 offset:0
s_waitcnt vmcnt(6)
ds_read_b128 v[68:71],v4 offset:1024
s_waitcnt vmcnt(5)
ds_read_b128 v[72:75],v4 offset:2048
s_waitcnt vmcnt(4)
ds_read_b128 v[76:79],v4 offset:3072
s_waitcnt lgkmcnt(3)
v_mfma_f32_16x16x32_bf16 v[32:35],a[0:3],v[64:67],0
s_add_u32 s71,s60,2
s_add_u32 s53,s60,3
v_mfma_f32_16x16x32_bf16 v[36:39],a[4:7],v[64:67],0
s_waitcnt lgkmcnt(2)
s_waitcnt vmcnt(3)
ds_read_b128 v[80:83],v4 offset:4096
v_mfma_f32_16x16x32_bf16 v[32:35],a[8:11],v[68:71],v[32:35]
v_mfma_f32_16x16x32_bf16 v[36:39],a[12:15],v[68:71],v[36:39]
s_waitcnt lgkmcnt(2)
s_waitcnt vmcnt(2)
s_mov_b32 m0,s70
ds_read_b128 v[84:87],v4 offset:5120
v_mfma_f32_16x16x32_bf16 v[32:35],a[16:19],v[72:75],v[32:35]
buffer_load_dwordx4 v3,s[20:23],s61 offen offset:0 lds
v_mfma_f32_16x16x32_bf16 v[36:39],a[20:23],v[72:75],v[36:39]
s_waitcnt lgkmcnt(2)
s_waitcnt vmcnt(2)
ds_read_b128 v[88:91],v4 offset:6144
v_mfma_f32_16x16x32_bf16 v[32:35],a[24:27],v[76:79],v[32:35]
buffer_load_dwordx4 v3,s[20:23],s61 offen offset:1024 lds
v_mfma_f32_16x16x32_bf16 v[36:39],a[28:31],v[76:79],v[36:39]
s_waitcnt lgkmcnt(2)
s_waitcnt vmcnt(2)
ds_read_b128 v[92:95],v4 offset:7168
v_mfma_f32_16x16x32_bf16 v[32:35],a[32:35],v[80:83],v[32:35]
v_mfma_f32_16x16x32_bf16 v[36:39],a[36:39],v[80:83],v[36:39]
s_waitcnt lgkmcnt(2)
s_barrier
ds_read_b128 v[96:99],v5 offset:0
v_mfma_f32_16x16x32_bf16 v[32:35],a[40:43],v[84:87],v[32:35]
ds_read_b128 v[100:103],v5 offset:1024
buffer_load_dwordx4 v3,s[20:23],s61 offen offset:2048 lds
v_mfma_f32_16x16x32_bf16 v[36:39],a[44:47],v[84:87],v[36:39]
s_waitcnt lgkmcnt(3)
ds_read_b128 v[104:107],v5 offset:2048
v_mfma_f32_16x16x32_bf16 v[32:35],a[48:51],v[88:91],v[32:35]
ds_read_b128 v[108:111],v5 offset:3072
v_mfma_f32_16x16x32_bf16 v[36:39],a[52:55],v[88:91],v[36:39]
s_waitcnt lgkmcnt(4)
ds_read_b128 v[112:115],v5 offset:4096
buffer_load_dwordx4 v3,s[20:23],s61 offen offset:3072 lds
v_mfma_f32_16x16x32_bf16 v[32:35],a[56:59],v[92:95],v[32:35]
s_cmp_eq_u32 s77,0
s_cselect_b32 s57,2.0,0
ds_read_b128 v[116:119],v5 offset:5120
v_mfma_f32_16x16x32_bf16 v[36:39],a[60:63],v[92:95],v[36:39]
s_waitcnt lgkmcnt(5)
s_add_u32 m0,s70,4096
v_or_b32 v21,s57,v0
v_mfma_f32_16x16x32_bf16 v[32:35],a[64:67],v[96:99],v[32:35]
ds_read_b128 v[120:123],v5 offset:6144
buffer_load_dwordx4 v3,s[20:23],s62 offen offset:0 lds
v_mfma_f32_16x16x32_bf16 v[36:39],a[68:71],v[96:99],v[36:39]
s_waitcnt lgkmcnt(5)
v_lshlrev_b32 v168,16,v160
v_and_b32 v169,s73,v160
v_mfma_f32_16x16x32_bf16 v[32:35],a[72:75],v[100:103],v[32:35]
ds_read_b128 v[124:127],v5 offset:7168
v_lshlrev_b32 v170,16,v161
v_mfma_f32_16x16x32_bf16 v[36:39],a[76:79],v[100:103],v[36:39]
s_waitcnt lgkmcnt(5)
buffer_load_dwordx4 v3,s[20:23],s62 offen offset:1024 lds
v_and_b32 v171,s73,v161
v_mfma_f32_16x16x32_bf16 v[32:35],a[80:83],v[104:107],v[32:35]
ds_read_b128 v[64:67],v6 offset:0
v_lshlrev_b32 v172,16,v162
v_mfma_f32_16x16x32_bf16 v[36:39],a[84:87],v[104:107],v[36:39]
s_waitcnt lgkmcnt(5)
v_and_b32 v173,s73,v162
v_lshlrev_b32 v174,16,v163
v_mfma_f32_16x16x32_bf16 v[32:35],a[88:91],v[108:111],v[32:35]
ds_read_b128 v[68:71],v6 offset:1024
v_and_b32 v175,s73,v163
v_mfma_f32_16x16x32_bf16 v[36:39],a[92:95],v[108:111],v[36:39]
s_waitcnt lgkmcnt(5)
buffer_load_dwordx4 v3,s[20:23],s62 offen offset:2048 lds
v_fma_f32 v168,v212,v152,v168
v_mfma_f32_16x16x32_bf16 v[32:35],a[96:99],v[112:115],v[32:35]
ds_read_b128 v[72:75],v6 offset:2048
buffer_load_dword v16,v2,s[20:23],s68 offen sc1
v_mfma_f32_16x16x32_bf16 v[36:39],a[100:103],v[112:115],v[36:39]
s_waitcnt lgkmcnt(5)
v_fma_f32 v169,v213,v153,v169
v_fma_f32 v170,v214,v154,v170
v_mfma_f32_16x16x32_bf16 v[32:35],a[104:107],v[116:119],v[32:35]
ds_read_b128 v[76:79],v6 offset:3072
buffer_load_dwordx4 v3,s[20:23],s62 offen offset:3072 lds
v_mfma_f32_16x16x32_bf16 v[36:39],a[108:111],v[116:119],v[36:39]
s_waitcnt lgkmcnt(5)
v_fma_f32 v171,v215,v155,v171
v_fma_f32 v172,v216,v156,v172
v_mfma_f32_16x16x32_bf16 v[32:35],a[112:115],v[120:123],v[32:35]
s_add_u32 s84,s74,s75
s_add_u32 s85,s84,4096
ds_read_b128 v[80:83],v6 offset:4096
v_mfma_f32_16x16x32_bf16 v[36:39],a[116:119],v[120:123],v[36:39]
s_waitcnt lgkmcnt(5)
buffer_load_dwordx4 v[128:131],v0,s[20:23],s84 offen offset:0 sc1
v_fma_f32 v173,v217,v157,v173
v_mfma_f32_16x16x32_bf16 v[32:35],a[120:123],v[124:127],v[32:35]
ds_read_b128 v[84:87],v6 offset:5120
v_fma_f32 v174,v218,v158,v174
v_mfma_f32_16x16x32_bf16 v[36:39],a[124:127],v[124:127],v[36:39]
s_waitcnt lgkmcnt(5)
buffer_load_dwordx4 v[132:135],v0,s[20:23],s84 offen offset:1024 sc1
v_fma_f32 v175,v219,v159,v175
v_mfma_f32_16x16x32_bf16 v[32:35],a[128:131],v[64:67],v[32:35]
ds_read_b128 v[88:91],v6 offset:6144
buffer_load_dwordx4 v[160:163],v18,s[24:27],s82 offen
v_mfma_f32_16x16x32_bf16 v[36:39],a[132:135],v[64:67],v[36:39]
s_waitcnt lgkmcnt(5)
s_add_u32 s82,s82,32768
buffer_load_dwordx4 v[136:139],v0,s[20:23],s84 offen offset:2048 sc1
v_mfma_f32_16x16x32_bf16 v[32:35],a[136:139],v[68:71],v[32:35]
ds_read_b128 v[92:95],v6 offset:7168
v_mfma_f32_16x16x32_bf16 v[36:39],a[140:143],v[68:71],v[36:39]
s_waitcnt lgkmcnt(5)
buffer_load_dwordx4 v[140:143],v0,s[20:23],s84 offen offset:3072 sc1
v_mfma_f32_16x16x32_bf16 v[32:35],a[144:147],v[72:75],v[32:35]
ds_read_b128 v[96:99],v7 offset:0
v_mfma_f32_16x16x32_bf16 v[36:39],a[148:151],v[72:75],v[36:39]
s_waitcnt lgkmcnt(5)
buffer_load_dwordx4 v[144:147],v0,s[20:23],s85 offen offset:0 sc1
v_mfma_f32_16x16x32_bf16 v[32:35],a[152:155],v[76:79],v[32:35]
ds_read_b128 v[100:103],v7 offset:1024
v_mfma_f32_16x16x32_bf16 v[36:39],a[156:159],v[76:79],v[36:39]
s_waitcnt lgkmcnt(5)
buffer_load_dwordx4 v[148:151],v0,s[20:23],s85 offen offset:1024 sc1
v_mfma_f32_16x16x32_bf16 v[32:35],a[160:163],v[80:83],v[32:35]
ds_read_b128 v[104:107],v7 offset:2048
v_mfma_f32_16x16x32_bf16 v[36:39],a[164:167],v[80:83],v[36:39]
s_waitcnt lgkmcnt(5)
v_mfma_f32_16x16x32_bf16 v[32:35],a[168:171],v[84:87],v[32:35]
ds_read_b128 v[108:111],v7 offset:3072
v_mfma_f32_16x16x32_bf16 v[36:39],a[172:175],v[84:87],v[36:39]
s_waitcnt lgkmcnt(5)
v_mfma_f32_16x16x32_bf16 v[32:35],a[176:179],v[88:91],v[32:35]
ds_read_b128 v[112:115],v7 offset:4096
v_mfma_f32_16x16x32_bf16 v[36:39],a[180:183],v[88:91],v[36:39]
s_waitcnt lgkmcnt(5)
v_mfma_f32_16x16x32_bf16 v[32:35],a[184:187],v[92:95],v[32:35]
ds_read_b128 v[116:119],v7 offset:5120
v_mfma_f32_16x16x32_bf16 v[36:39],a[188:191],v[92:95],v[36:39]
s_waitcnt lgkmcnt(5)
v_mfma_f32_16x16x32_bf16 v[32:35],a[192:195],v[96:99],v[32:35]
ds_read_b128 v[120:123],v7 offset:6144
v_mfma_f32_16x16x32_bf16 v[36:39],a[196:199],v[96:99],v[36:39]
s_waitcnt lgkmcnt(5)
v_mfma_f32_16x16x32_bf16 v[32:35],a[200:203],v[100:103],v[32:35]
ds_read_b128 v[124:127],v7 offset:7168
v_mfma_f32_16x16x32_bf16 v[36:39],a[204:207],v[100:103],v[36:39]
s_waitcnt lgkmcnt(5)
s_add_u32 s61,s61,131072
s_add_u32 s62,s62,131072
v_mfma_f32_16x16x32_bf16 v[32:35],a[208:211],v[104:107],v[32:35]
s_add_u32 s70,s70,32768
s_and_b32 s70,s70,0x1ffff
s_add_u32 s55,s55,32768
v_mfma_f32_16x16x32_bf16 v[36:39],a[212:215],v[104:107],v[36:39]
s_waitcnt lgkmcnt(4)
s_and_b32 s55,s55,0x1ffff
v_add_u32 v4,s55,v8
v_mfma_f32_16x16x32_bf16 v[32:35],a[216:219],v[108:111],v[32:35]
v_add_u32 v5,s55,v9
v_add_u32 v6,s55,v10
v_mfma_f32_16x16x32_bf16 v[36:39],a[220:223],v[108:111],v[36:39]
s_waitcnt lgkmcnt(3)
v_add_u32 v7,s55,v11
v_mfma_f32_16x16x32_bf16 v[32:35],a[224:227],v[112:115],v[32:35]
s_waitcnt vmcnt(15)
ds_read_b128 v[64:67],v4 offset:0
v_mfma_f32_16x16x32_bf16 v[36:39],a[228:231],v[112:115],v[36:39]
s_waitcnt lgkmcnt(3)
s_waitcnt vmcnt(14)
ds_read_b128 v[68:71],v4 offset:1024
v_mfma_f32_16x16x32_bf16 v[32:35],a[232:235],v[116:119],v[32:35]
s_waitcnt vmcnt(0)
s_cmp_eq_u32 s77,0
s_cbranch_scc1 go_138
ck_136:
v_max3_u32 v184,v128,v129,v130
v_max3_u32 v185,v140,v141,v142
v_max3_u32 v184,v184,v131,v132
v_max3_u32 v185,v185,v143,v144
v_max3_u32 v184,v184,v133,v134
v_max3_u32 v185,v185,v145,v146
v_max3_u32 v184,v184,v135,v136
v_max3_u32 v185,v185,v147,v148
v_max3_u32 v184,v184,v137,v138
v_max3_u32 v185,v185,v149,v150
v_max3_u32 v184,v184,v139,v151
v_max_u32 v184,v184,v185
v_cmp_eq_u32 vcc,-1,v184
s_cbranch_vccnz rt_137
go_138:
v_mfma_f32_16x16x32_bf16 v[36:39],a[236:239],v[116:119],v[36:39]
s_waitcnt lgkmcnt(3)
ds_read_b128 v[72:75],v4 offset:2048
v_add_f32 v128,v128,v136
v_mfma_f32_16x16x32_bf16 v[32:35],a[240:243],v[120:123],v[32:35]
v_add_f32 v129,v129,v137
v_add_f32 v130,v130,v138
v_add_f32 v131,v131,v139
v_mfma_f32_16x16x32_bf16 v[36:39],a[244:247],v[120:123],v[36:39]
s_waitcnt lgkmcnt(3)
v_add_f32 v132,v132,v140
v_add_f32 v133,v133,v141
v_add_f32 v134,v134,v142
v_mfma_f32_16x16x32_bf16 v[40:43],a[248:251],v[124:127],v[32:35]
v_add_f32 v135,v135,v143
v_add_f32 v128,v128,v144
v_add_f32 v129,v129,v145
v_mfma_f32_16x16x32_bf16 v[44:47],a[252:255],v[124:127],v[36:39]
v_add_f32 v130,v130,v146
v_add_f32 v131,v131,v147
v_add_f32 v132,v132,v148
v_add_f32 v133,v133,v149
v_add_f32 v134,v134,v150
v_add_f32 v135,v135,v151
v_fma_f32 v168,v128,v152,v168
v_fma_f32 v169,v129,v153,v169
v_fma_f32 v170,v130,v154,v170
v_fma_f32 v171,v131,v155,v171
v_fma_f32 v172,v132,v156,v172
v_fma_f32 v173,v133,v157,v173
v_fma_f32 v174,v134,v158,v174
v_fma_f32 v175,v135,v159,v175
v_cvt_pk_bf16_f32 v176,v168,v169
v_cvt_pk_bf16_f32 v177,v170,v171
v_cvt_pk_bf16_f32 v178,v172,v173
v_cvt_pk_bf16_f32 v179,v174,v175
s_add_u32 s64,s66,201326592
buffer_store_dwordx4 v[176:179],v21,s[20:23],s64 offen sc1
s_add_u32 s79,s66,201392128
s_cmp_ge_u32 s63,126
s_cselect_b32 s79,138641408,s79
buffer_store_dwordx4 v[204:207],v21,s[20:23],s79 offen sc1
s_cmp_eq_u32 s56,1
s_cbranch_scc1 b1_130
buffer_store_dwordx4 v[204:207],v21,s[20:23],s84 offen offset:0
buffer_store_dwordx4 v[204:207],v21,s[20:23],s84 offen offset:1024
b2_131:
s_cmp_eq_u32 s56,1
s_cbranch_scc1 b1_132
buffer_store_dwordx4 v[204:207],v21,s[20:23],s84 offen offset:2048
buffer_store_dwordx4 v[204:207],v21,s[20:23],s84 offen offset:3072
b2_133:
s_cmp_eq_u32 s56,1
s_cbranch_scc1 b1_134
buffer_store_dwordx4 v[204:207],v21,s[20:23],s85 offen offset:0
buffer_store_dwordx4 v[204:207],v21,s[20:23],s85 offen offset:1024
b2_135:
s_mul_i32 s64,s77,32768
s_add_u32 s66,s66,s64
s_mul_i32 s64,s77,6144
s_add_u32 s75,s75,s64
s_cmp_eq_u32 s75,24576
s_cselect_b32 s75,0,s75
s_add_u32 s63,s63,s77
s_mov_b32 s77,0
v_cmp_gt_u32 vcc,s53,v16
s_add_u32 s60,s60,1
s_cbranch_vccnz WN_122
.p2align 6
WR_121:
s_waitcnt lgkmcnt(2)
v_mfma_f32_16x16x32_bf16 v[32:35],a[0:3],v[64:67],0
s_waitcnt vmcnt(20)
s_add_u32 s71,s60,2
ds_read_b128 v[76:79],v4 offset:3072
v_mfma_f32_16x16x32_bf16 v[36:39],a[4:7],v[64:67],0
s_waitcnt lgkmcnt(2)
s_add_u32 s53,s60,3
v_mfma_f32_16x16x32_bf16 v[32:35],a[8:11],v[68:71],v[32:35]
s_waitcnt vmcnt(19)
s_mov_b32 m0,s70
ds_read_b128 v[80:83],v4 offset:4096
v_mfma_f32_16x16x32_bf16 v[36:39],a[12:15],v[68:71],v[36:39]
s_waitcnt lgkmcnt(2)
buffer_load_dwordx4 v3,s[20:23],s61 offen offset:0 lds
v_mov_b32 v212,v40
v_mfma_f32_16x16x32_bf16 v[32:35],a[16:19],v[72:75],v[32:35]
s_waitcnt vmcnt(19)
ds_read_b128 v[84:87],v4 offset:5120
v_mov_b32 v213,v41
v_mfma_f32_16x16x32_bf16 v[36:39],a[20:23],v[72:75],v[36:39]
s_waitcnt lgkmcnt(2)
v_mov_b32 v214,v42
v_mov_b32 v215,v43
v_mfma_f32_16x16x32_bf16 v[32:35],a[24:27],v[76:79],v[32:35]
s_waitcnt vmcnt(18)
ds_read_b128 v[88:91],v4 offset:6144
buffer_load_dwordx4 v3,s[20:23],s61 offen offset:1024 lds
v_mfma_f32_16x16x32_bf16 v[36:39],a[28:31],v[76:79],v[36:39]
s_waitcnt lgkmcnt(2)
v_mov_b32 v216,v44
v_mov_b32 v217,v45
v_mfma_f32_16x16x32_bf16 v[32:35],a[32:35],v[80:83],v[32:35]
s_waitcnt vmcnt(17)
ds_read_b128 v[92:95],v4 offset:7168
v_mov_b32 v218,v46
v_mfma_f32_16x16x32_bf16 v[36:39],a[36:39],v[80:83],v[36:39]
s_waitcnt lgkmcnt(2)
s_barrier
ds_read_b128 v[96:99],v5 offset:0
v_mfma_f32_16x16x32_bf16 v[32:35],a[40:43],v[84:87],v[32:35]
ds_read_b128 v[100:103],v5 offset:1024
buffer_load_dwordx4 v3,s[20:23],s61 offen offset:2048 lds
v_mfma_f32_16x16x32_bf16 v[36:39],a[44:47],v[84:87],v[36:39]
s_waitcnt lgkmcnt(3)
ds_read_b128 v[104:107],v5 offset:2048
v_mov_b32 v219,v47
v_mfma_f32_16x16x32_bf16 v[32:35],a[48:51],v[88:91],v[32:35]
s_mov_b32 s77,1
ds_read_b128 v[108:111],v5 offset:3072
v_mfma_f32_16x16x32_bf16 v[36:39],a[52:55],v[88:91],v[36:39]
s_waitcnt lgkmcnt(4)
ds_read_b128 v[112:115],v5 offset:4096
buffer_load_dwordx4 v3,s[20:23],s61 offen offset:3072 lds
v_mfma_f32_16x16x32_bf16 v[32:35],a[56:59],v[92:95],v[32:35]
s_waitcnt vmcnt(16)
s_cmp_eq_u32 s77,0
s_cselect_b32 s57,2.0,0
ds_read_b128 v[116:119],v5 offset:5120
v_mfma_f32_16x16x32_bf16 v[36:39],a[60:63],v[92:95],v[36:39]
s_waitcnt lgkmcnt(5)
s_add_u32 m0,s70,4096
v_or_b32 v21,s57,v0
v_mfma_f32_16x16x32_bf16 v[32:35],a[64:67],v[96:99],v[32:35]
ds_read_b128 v[120:123],v5 offset:6144
buffer_load_dwordx4 v3,s[20:23],s62 offen offset:0 lds
v_mfma_f32_16x16x32_bf16 v[36:39],a[68:71],v[96:99],v[36:39]
s_waitcnt lgkmcnt(5)
v_lshlrev_b32 v168,16,v160
v_and_b32 v169,s73,v160
v_mfma_f32_16x16x32_bf16 v[32:35],a[72:75],v[100:103],v[32:35]
ds_read_b128 v[124:127],v5 offset:7168
v_lshlrev_b32 v170,16,v161
v_mfma_f32_16x16x32_bf16 v[36:39],a[76:79],v[100:103],v[36:39]
s_waitcnt lgkmcnt(5)
buffer_load_dwordx4 v3,s[20:23],s62 offen offset:1024 lds
v_and_b32 v171,s73,v161
v_mfma_f32_16x16x32_bf16 v[32:35],a[80:83],v[104:107],v[32:35]
ds_read_b128 v[64:67],v6 offset:0
v_lshlrev_b32 v172,16,v162
v_mfma_f32_16x16x32_bf16 v[36:39],a[84:87],v[104:107],v[36:39]
s_waitcnt lgkmcnt(5)
v_and_b32 v173,s73,v162
v_lshlrev_b32 v174,16,v163
v_mfma_f32_16x16x32_bf16 v[32:35],a[88:91],v[108:111],v[32:35]
ds_read_b128 v[68:71],v6 offset:1024
v_and_b32 v175,s73,v163
v_mfma_f32_16x16x32_bf16 v[36:39],a[92:95],v[108:111],v[36:39]
s_waitcnt lgkmcnt(5)
buffer_load_dwordx4 v3,s[20:23],s62 offen offset:2048 lds
v_fma_f32 v168,v212,v152,v168
v_mfma_f32_16x16x32_bf16 v[32:35],a[96:99],v[112:115],v[32:35]
ds_read_b128 v[72:75],v6 offset:2048
buffer_load_dword v16,v2,s[20:23],s68 offen sc1
v_mfma_f32_16x16x32_bf16 v[36:39],a[100:103],v[112:115],v[36:39]
s_waitcnt lgkmcnt(5)
v_fma_f32 v169,v213,v153,v169
v_fma_f32 v170,v214,v154,v170
v_mfma_f32_16x16x32_bf16 v[32:35],a[104:107],v[116:119],v[32:35]
ds_read_b128 v[76:79],v6 offset:3072
buffer_load_dwordx4 v3,s[20:23],s62 offen offset:3072 lds
v_mfma_f32_16x16x32_bf16 v[36:39],a[108:111],v[116:119],v[36:39]
s_waitcnt lgkmcnt(5)
v_fma_f32 v171,v215,v155,v171
v_fma_f32 v172,v216,v156,v172
v_mfma_f32_16x16x32_bf16 v[32:35],a[112:115],v[120:123],v[32:35]
s_add_u32 s84,s74,s75
s_add_u32 s85,s84,4096
ds_read_b128 v[80:83],v6 offset:4096
v_mfma_f32_16x16x32_bf16 v[36:39],a[116:119],v[120:123],v[36:39]
s_waitcnt lgkmcnt(5)
buffer_load_dwordx4 v[128:131],v0,s[20:23],s84 offen offset:0 sc1
v_fma_f32 v173,v217,v157,v173
v_mfma_f32_16x16x32_bf16 v[32:35],a[120:123],v[124:127],v[32:35]
ds_read_b128 v[84:87],v6 offset:5120
v_fma_f32 v174,v218,v158,v174
v_mfma_f32_16x16x32_bf16 v[36:39],a[124:127],v[124:127],v[36:39]
s_waitcnt lgkmcnt(5)
buffer_load_dwordx4 v[132:135],v0,s[20:23],s84 offen offset:1024 sc1
v_fma_f32 v175,v219,v159,v175
v_mfma_f32_16x16x32_bf16 v[32:35],a[128:131],v[64:67],v[32:35]
ds_read_b128 v[88:91],v6 offset:6144
buffer_load_dwordx4 v[160:163],v18,s[24:27],s82 offen
v_mfma_f32_16x16x32_bf16 v[36:39],a[132:135],v[64:67],v[36:39]
s_waitcnt lgkmcnt(5)
s_add_u32 s82,s82,32768
buffer_load_dwordx4 v[136:139],v0,s[20:23],s84 offen offset:2048 sc1
v_mfma_f32_16x16x32_bf16 v[32:35],a[136:139],v[68:71],v[32:35]
ds_read_b128 v[92:95],v6 offset:7168
v_mfma_f32_16x16x32_bf16 v[36:39],a[140:143],v[68:71],v[36:39]
s_waitcnt lgkmcnt(5)
buffer_load_dwordx4 v[140:143],v0,s[20:23],s84 offen offset:3072 sc1
v_mfma_f32_16x16x32_bf16 v[32:35],a[144:147],v[72:75],v[32:35]
ds_read_b128 v[96:99],v7 offset:0
v_mfma_f32_16x16x32_bf16 v[36:39],a[148:151],v[72:75],v[36:39]
s_waitcnt lgkmcnt(5)
buffer_load_dwordx4 v[144:147],v0,s[20:23],s85 offen offset:0 sc1
v_mfma_f32_16x16x32_bf16 v[32:35],a[152:155],v[76:79],v[32:35]
ds_read_b128 v[100:103],v7 offset:1024
v_mfma_f32_16x16x32_bf16 v[36:39],a[156:159],v[76:79],v[36:39]
s_waitcnt lgkmcnt(5)
buffer_load_dwordx4 v[148:151],v0,s[20:23],s85 offen offset:1024 sc1
v_mfma_f32_16x16x32_bf16 v[32:35],a[160:163],v[80:83],v[32:35]
ds_read_b128 v[104:107],v7 offset:2048
v_mfma_f32_16x16x32_bf16 v[36:39],a[164:167],v[80:83],v[36:39]
s_waitcnt lgkmcnt(5)
v_mfma_f32_16x16x32_bf16 v[32:35],a[168:171],v[84:87],v[32:35]
ds_read_b128 v[108:111],v7 offset:3072
v_mfma_f32_16x16x32_bf16 v[36:39],a[172:175],v[84:87],v[36:39]
s_waitcnt lgkmcnt(5)
v_mfma_f32_16x16x32_bf16 v[32:35],a[176:179],v[88:91],v[32:35]
ds_read_b128 v[112:115],v7 offset:4096
v_mfma_f32_16x16x32_bf16 v[36:39],a[180:183],v[88:91],v[36:39]
s_waitcnt lgkmcnt(5)
v_mfma_f32_16x16x32_bf16 v[32:35],a[184:187],v[92:95],v[32:35]
ds_read_b128 v[116:119],v7 offset:5120
v_mfma_f32_16x16x32_bf16 v[36:39],a[188:191],v[92:95],v[36:39]
s_waitcnt lgkmcnt(5)
v_mfma_f32_16x16x32_bf16 v[32:35],a[192:195],v[96:99],v[32:35]
ds_read_b128 v[120:123],v7 offset:6144
v_mfma_f32_16x16x32_bf16 v[36:39],a[196:199],v[96:99],v[36:39]
s_waitcnt lgkmcnt(5)
v_mfma_f32_16x16x32_bf16 v[32:35],a[200:203],v[100:103],v[32:35]
ds_read_b128 v[124:127],v7 offset:7168
v_mfma_f32_16x16x32_bf16 v[36:39],a[204:207],v[100:103],v[36:39]
s_waitcnt lgkmcnt(5)
s_add_u32 s61,s61,131072
s_add_u32 s62,s62,131072
v_mfma_f32_16x16x32_bf16 v[32:35],a[208:211],v[104:107],v[32:35]
s_add_u32 s70,s70,32768
s_and_b32 s70,s70,0x1ffff
s_add_u32 s55,s55,32768
v_mfma_f32_16x16x32_bf16 v[36:39],a[212:215],v[104:107],v[36:39]
s_waitcnt lgkmcnt(4)
s_and_b32 s55,s55,0x1ffff
v_add_u32 v4,s55,v8
v_mfma_f32_16x16x32_bf16 v[32:35],a[216:219],v[108:111],v[32:35]
v_add_u32 v5,s55,v9
v_add_u32 v6,s55,v10
v_mfma_f32_16x16x32_bf16 v[36:39],a[220:223],v[108:111],v[36:39]
s_waitcnt lgkmcnt(3)
v_add_u32 v7,s55,v11
v_mfma_f32_16x16x32_bf16 v[32:35],a[224:227],v[112:115],v[32:35]
s_waitcnt vmcnt(15)
ds_read_b128 v[64:67],v4 offset:0
v_mfma_f32_16x16x32_bf16 v[36:39],a[228:231],v[112:115],v[36:39]
s_waitcnt lgkmcnt(3)
s_waitcnt vmcnt(14)
ds_read_b128 v[68:71],v4 offset:1024
v_mfma_f32_16x16x32_bf16 v[32:35],a[232:235],v[116:119],v[32:35]
s_waitcnt vmcnt(0)
s_cmp_eq_u32 s77,0
s_cbranch_scc1 go_147
ck_145:
v_max3_u32 v184,v128,v129,v130
v_max3_u32 v185,v140,v141,v142
v_max3_u32 v184,v184,v131,v132
v_max3_u32 v185,v185,v143,v144
v_max3_u32 v184,v184,v133,v134
v_max3_u32 v185,v185,v145,v146
v_max3_u32 v184,v184,v135,v136
v_max3_u32 v185,v185,v147,v148
v_max3_u32 v184,v184,v137,v138
v_max3_u32 v185,v185,v149,v150
v_max3_u32 v184,v184,v139,v151
v_max_u32 v184,v184,v185
v_cmp_eq_u32 vcc,-1,v184
s_cbranch_vccnz rt_146
go_147:
v_mfma_f32_16x16x32_bf16 v[36:39],a[236:239],v[116:119],v[36:39]
s_waitcnt lgkmcnt(3)
ds_read_b128 v[72:75],v4 offset:2048
v_add_f32 v128,v128,v136
v_mfma_f32_16x16x32_bf16 v[32:35],a[240:243],v[120:123],v[32:35]
v_add_f32 v129,v129,v137
v_add_f32 v130,v130,v138
v_add_f32 v131,v131,v139
v_mfma_f32_16x16x32_bf16 v[36:39],a[244:247],v[120:123],v[36:39]
s_waitcnt lgkmcnt(3)
v_add_f32 v132,v132,v140
v_add_f32 v133,v133,v141
v_add_f32 v134,v134,v142
v_mfma_f32_16x16x32_bf16 v[40:43],a[248:251],v[124:127],v[32:35]
v_add_f32 v135,v135,v143
v_add_f32 v128,v128,v144
v_add_f32 v129,v129,v145
v_mfma_f32_16x16x32_bf16 v[44:47],a[252:255],v[124:127],v[36:39]
v_add_f32 v130,v130,v146
v_add_f32 v131,v131,v147
v_add_f32 v132,v132,v148
v_add_f32 v133,v133,v149
v_add_f32 v134,v134,v150
v_add_f32 v135,v135,v151
v_fma_f32 v168,v128,v152,v168
v_fma_f32 v169,v129,v153,v169
v_fma_f32 v170,v130,v154,v170
v_fma_f32 v171,v131,v155,v171
v_fma_f32 v172,v132,v156,v172
v_fma_f32 v173,v133,v157,v173
v_fma_f32 v174,v134,v158,v174
v_fma_f32 v175,v135,v159,v175
v_cvt_pk_bf16_f32 v176,v168,v169
v_cvt_pk_bf16_f32 v177,v170,v171
v_cvt_pk_bf16_f32 v178,v172,v173
v_cvt_pk_bf16_f32 v179,v174,v175
s_add_u32 s64,s66,201326592
buffer_store_dwordx4 v[176:179],v21,s[20:23],s64 offen sc1
s_add_u32 s79,s66,201392128
s_cmp_ge_u32 s63,126
s_cselect_b32 s79,138641408,s79
buffer_store_dwordx4 v[204:207],v21,s[20:23],s79 offen sc1
s_cmp_eq_u32 s56,1
s_cbranch_scc1 b1_139
buffer_store_dwordx4 v[204:207],v21,s[20:23],s84 offen offset:0
buffer_store_dwordx4 v[204:207],v21,s[20:23],s84 offen offset:1024
b2_140:
s_cmp_eq_u32 s56,1
s_cbranch_scc1 b1_141
buffer_store_dwordx4 v[204:207],v21,s[20:23],s84 offen offset:2048
buffer_store_dwordx4 v[204:207],v21,s[20:23],s84 offen offset:3072
b2_142:
s_cmp_eq_u32 s56,1
s_cbranch_scc1 b1_143
buffer_store_dwordx4 v[204:207],v21,s[20:23],s85 offen offset:0
buffer_store_dwordx4 v[204:207],v21,s[20:23],s85 offen offset:1024
b2_144:
s_mul_i32 s64,s77,32768
s_add_u32 s66,s66,s64
s_mul_i32 s64,s77,6144
s_add_u32 s75,s75,s64
s_cmp_eq_u32 s75,24576
s_cselect_b32 s75,0,s75
s_add_u32 s63,s63,s77
s_mov_b32 s77,0
v_cmp_gt_u32 vcc,s53,v16
s_add_u32 s60,s60,1
s_cbranch_vccz WR_121
WN_122:
s_waitcnt lgkmcnt(2)
v_mfma_f32_16x16x32_bf16 v[32:35],a[0:3],v[64:67],0
s_waitcnt vmcnt(20)
s_add_u32 s71,s60,2
ds_read_b128 v[76:79],v4 offset:3072
v_mfma_f32_16x16x32_bf16 v[36:39],a[4:7],v[64:67],0
s_waitcnt lgkmcnt(2)
s_add_u32 s53,s60,3
v_mfma_f32_16x16x32_bf16 v[32:35],a[8:11],v[68:71],v[32:35]
s_waitcnt vmcnt(19)
ds_read_b128 v[80:83],v4 offset:4096
v_mov_b32 v212,v40
v_mfma_f32_16x16x32_bf16 v[36:39],a[12:15],v[68:71],v[36:39]
s_waitcnt lgkmcnt(2)
v_mov_b32 v213,v41
v_mov_b32 v214,v42
v_mfma_f32_16x16x32_bf16 v[32:35],a[16:19],v[72:75],v[32:35]
s_waitcnt vmcnt(18)
ds_read_b128 v[84:87],v4 offset:5120
v_mov_b32 v215,v43
v_mfma_f32_16x16x32_bf16 v[36:39],a[20:23],v[72:75],v[36:39]
s_waitcnt lgkmcnt(2)
v_mov_b32 v216,v44
v_mov_b32 v217,v45
v_mfma_f32_16x16x32_bf16 v[32:35],a[24:27],v[76:79],v[32:35]
s_waitcnt vmcnt(17)
ds_read_b128 v[88:91],v4 offset:6144
v_mov_b32 v218,v46
v_mfma_f32_16x16x32_bf16 v[36:39],a[28:31],v[76:79],v[36:39]
s_waitcnt lgkmcnt(2)
v_mov_b32 v219,v47
v_mfma_f32_16x16x32_bf16 v[32:35],a[32:35],v[80:83],v[32:35]
s_waitcnt vmcnt(15)
s_mov_b32 s77,1
ds_read_b128 v[92:95],v4 offset:7168
v_mfma_f32_16x16x32_bf16 v[36:39],a[36:39],v[80:83],v[36:39]
s_waitcnt lgkmcnt(2)
s_barrier
ds_read_b128 v[96:99],v5 offset:0
v_mfma_f32_16x16x32_bf16 v[32:35],a[40:43],v[84:87],v[32:35]
ds_read_b128 v[100:103],v5 offset:1024
v_mfma_f32_16x16x32_bf16 v[36:39],a[44:47],v[84:87],v[36:39]
s_waitcnt lgkmcnt(3)
ds_read_b128 v[104:107],v5 offset:2048
v_mfma_f32_16x16x32_bf16 v[32:35],a[48:51],v[88:91],v[32:35]
ds_read_b128 v[108:111],v5 offset:3072
v_mfma_f32_16x16x32_bf16 v[36:39],a[52:55],v[88:91],v[36:39]
s_waitcnt lgkmcnt(4)
ds_read_b128 v[112:115],v5 offset:4096
v_mfma_f32_16x16x32_bf16 v[32:35],a[56:59],v[92:95],v[32:35]
s_waitcnt vmcnt(12)
s_cmp_eq_u32 s77,0
s_cselect_b32 s57,2.0,0
ds_read_b128 v[116:119],v5 offset:5120
v_mfma_f32_16x16x32_bf16 v[36:39],a[60:63],v[92:95],v[36:39]
s_waitcnt lgkmcnt(5)
v_or_b32 v21,s57,v0
v_lshlrev_b32 v168,16,v160
v_mfma_f32_16x16x32_bf16 v[32:35],a[64:67],v[96:99],v[32:35]
ds_read_b128 v[120:123],v5 offset:6144
v_and_b32 v169,s73,v160
v_mfma_f32_16x16x32_bf16 v[36:39],a[68:71],v[96:99],v[36:39]
s_waitcnt lgkmcnt(5)
v_lshlrev_b32 v170,16,v161
v_and_b32 v171,s73,v161
v_mfma_f32_16x16x32_bf16 v[32:35],a[72:75],v[100:103],v[32:35]
ds_read_b128 v[124:127],v5 offset:7168
v_lshlrev_b32 v172,16,v162
v_mfma_f32_16x16x32_bf16 v[36:39],a[76:79],v[100:103],v[36:39]
s_waitcnt lgkmcnt(5)
v_and_b32 v173,s73,v162
v_lshlrev_b32 v174,16,v163
v_mfma_f32_16x16x32_bf16 v[32:35],a[80:83],v[104:107],v[32:35]
ds_read_b128 v[64:67],v6 offset:0
v_and_b32 v175,s73,v163
v_mfma_f32_16x16x32_bf16 v[36:39],a[84:87],v[104:107],v[36:39]
s_waitcnt lgkmcnt(5)
v_fma_f32 v168,v212,v152,v168
v_fma_f32 v169,v213,v153,v169
v_mfma_f32_16x16x32_bf16 v[32:35],a[88:91],v[108:111],v[32:35]
ds_read_b128 v[68:71],v6 offset:1024
v_fma_f32 v170,v214,v154,v170
v_mfma_f32_16x16x32_bf16 v[36:39],a[92:95],v[108:111],v[36:39]
s_waitcnt lgkmcnt(5)
v_fma_f32 v171,v215,v155,v171
v_fma_f32 v172,v216,v156,v172
v_mfma_f32_16x16x32_bf16 v[32:35],a[96:99],v[112:115],v[32:35]
ds_read_b128 v[72:75],v6 offset:2048
v_fma_f32 v173,v217,v157,v173
v_mfma_f32_16x16x32_bf16 v[36:39],a[100:103],v[112:115],v[36:39]
s_waitcnt lgkmcnt(5)
v_fma_f32 v174,v218,v158,v174
v_fma_f32 v175,v219,v159,v175
v_mfma_f32_16x16x32_bf16 v[32:35],a[104:107],v[116:119],v[32:35]
ds_read_b128 v[76:79],v6 offset:3072
v_mfma_f32_16x16x32_bf16 v[36:39],a[108:111],v[116:119],v[36:39]
s_waitcnt lgkmcnt(5)
buffer_load_dwordx4 v[160:163],v18,s[24:27],s82 offen
v_mfma_f32_16x16x32_bf16 v[32:35],a[112:115],v[120:123],v[32:35]
s_add_u32 s84,s74,s75
s_add_u32 s85,s84,4096
ds_read_b128 v[80:83],v6 offset:4096
v_mfma_f32_16x16x32_bf16 v[36:39],a[116:119],v[120:123],v[36:39]
s_waitcnt lgkmcnt(5)
s_add_u32 s82,s82,32768
buffer_load_dwordx4 v[128:131],v0,s[20:23],s84 offen offset:0 sc1
v_mfma_f32_16x16x32_bf16 v[32:35],a[120:123],v[124:127],v[32:35]
ds_read_b128 v[84:87],v6 offset:5120
v_mfma_f32_16x16x32_bf16 v[36:39],a[124:127],v[124:127],v[36:39]
s_waitcnt lgkmcnt(5)
buffer_load_dwordx4 v[132:135],v0,s[20:23],s84 offen offset:1024 sc1
v_mfma_f32_16x16x32_bf16 v[32:35],a[128:131],v[64:67],v[32:35]
ds_read_b128 v[88:91],v6 offset:6144
v_mfma_f32_16x16x32_bf16 v[36:39],a[132:135],v[64:67],v[36:39]
s_waitcnt lgkmcnt(5)
buffer_load_dwordx4 v[136:139],v0,s[20:23],s84 offen offset:2048 sc1
v_mfma_f32_16x16x32_bf16 v[32:35],a[136:139],v[68:71],v[32:35]
ds_read_b128 v[92:95],v6 offset:7168
v_mfma_f32_16x16x32_bf16 v[36:39],a[140:143],v[68:71],v[36:39]
s_waitcnt lgkmcnt(5)
buffer_load_dwordx4 v[140:143],v0,s[20:23],s84 offen offset:3072 sc1
v_mfma_f32_16x16x32_bf16 v[32:35],a[144:147],v[72:75],v[32:35]
ds_read_b128 v[96:99],v7 offset:0
v_mfma_f32_16x16x32_bf16 v[36:39],a[148:151],v[72:75],v[36:39]
s_waitcnt lgkmcnt(5)
buffer_load_dwordx4 v[144:147],v0,s[20:23],s85 offen offset:0 sc1
v_mfma_f32_16x16x32_bf16 v[32:35],a[152:155],v[76:79],v[32:35]
ds_read_b128 v[100:103],v7 offset:1024
v_mfma_f32_16x16x32_bf16 v[36:39],a[156:159],v[76:79],v[36:39]
s_waitcnt lgkmcnt(5)
buffer_load_dwordx4 v[148:151],v0,s[20:23],s85 offen offset:1024 sc1
v_mfma_f32_16x16x32_bf16 v[32:35],a[160:163],v[80:83],v[32:35]
ds_read_b128 v[104:107],v7 offset:2048
buffer_load_dword v16,v2,s[20:23],s68 offen sc1
v_mfma_f32_16x16x32_bf16 v[36:39],a[164:167],v[80:83],v[36:39]
s_waitcnt lgkmcnt(5)
v_mfma_f32_16x16x32_bf16 v[32:35],a[168:171],v[84:87],v[32:35]
ds_read_b128 v[108:111],v7 offset:3072
v_mfma_f32_16x16x32_bf16 v[36:39],a[172:175],v[84:87],v[36:39]
s_waitcnt lgkmcnt(5)
v_mfma_f32_16x16x32_bf16 v[32:35],a[176:179],v[88:91],v[32:35]
ds_read_b128 v[112:115],v7 offset:4096
v_mfma_f32_16x16x32_bf16 v[36:39],a[180:183],v[88:91],v[36:39]
s_waitcnt lgkmcnt(5)
v_mfma_f32_16x16x32_bf16 v[32:35],a[184:187],v[92:95],v[32:35]
ds_read_b128 v[116:119],v7 offset:5120
v_mfma_f32_16x16x32_bf16 v[36:39],a[188:191],v[92:95],v[36:39]
s_waitcnt lgkmcnt(5)
v_mfma_f32_16x16x32_bf16 v[32:35],a[192:195],v[96:99],v[32:35]
ds_read_b128 v[120:123],v7 offset:6144
v_mfma_f32_16x16x32_bf16 v[36:39],a[196:199],v[96:99],v[36:39]
s_waitcnt lgkmcnt(5)
v_mfma_f32_16x16x32_bf16 v[32:35],a[200:203],v[100:103],v[32:35]
s_waitcnt vmcnt(1)
ds_read_b128 v[124:127],v7 offset:7168
s_cmp_eq_u32 s77,0
s_cbranch_scc1 go_157
ck_155:
v_max3_u32 v184,v128,v129,v130
v_max3_u32 v185,v140,v141,v142
v_max3_u32 v184,v184,v131,v132
v_max3_u32 v185,v185,v143,v144
v_max3_u32 v184,v184,v133,v134
v_max3_u32 v185,v185,v145,v146
v_max3_u32 v184,v184,v135,v136
v_max3_u32 v185,v185,v147,v148
v_max3_u32 v184,v184,v137,v138
v_max3_u32 v185,v185,v149,v150
v_max3_u32 v184,v184,v139,v151
v_max_u32 v184,v184,v185
v_cmp_eq_u32 vcc,-1,v184
s_cbranch_vccnz rt_156
go_157:
v_mfma_f32_16x16x32_bf16 v[36:39],a[204:207],v[100:103],v[36:39]
s_waitcnt lgkmcnt(5)
s_add_u32 s55,s55,32768
s_and_b32 s55,s55,0x1ffff
v_add_f32 v128,v128,v136
v_mfma_f32_16x16x32_bf16 v[32:35],a[208:211],v[104:107],v[32:35]
v_add_u32 v4,s55,v8
v_add_u32 v5,s55,v9
v_add_f32 v129,v129,v137
v_mfma_f32_16x16x32_bf16 v[36:39],a[212:215],v[104:107],v[36:39]
s_waitcnt lgkmcnt(4)
v_add_u32 v6,s55,v10
v_add_u32 v7,s55,v11
v_add_f32 v130,v130,v138
v_mfma_f32_16x16x32_bf16 v[32:35],a[216:219],v[108:111],v[32:35]
v_add_f32 v131,v131,v139
v_add_f32 v132,v132,v140
v_add_f32 v133,v133,v141
v_mfma_f32_16x16x32_bf16 v[36:39],a[220:223],v[108:111],v[36:39]
s_waitcnt lgkmcnt(3)
v_add_f32 v134,v134,v142
v_add_f32 v135,v135,v143
v_add_f32 v128,v128,v144
v_mfma_f32_16x16x32_bf16 v[32:35],a[224:227],v[112:115],v[32:35]
v_add_f32 v129,v129,v145
v_add_f32 v130,v130,v146
v_add_f32 v131,v131,v147
v_mfma_f32_16x16x32_bf16 v[36:39],a[228:231],v[112:115],v[36:39]
s_waitcnt lgkmcnt(2)
v_add_f32 v132,v132,v148
v_add_f32 v133,v133,v149
v_add_f32 v134,v134,v150
v_mfma_f32_16x16x32_bf16 v[32:35],a[232:235],v[116:119],v[32:35]
v_add_f32 v135,v135,v151
v_fma_f32 v168,v128,v152,v168
v_fma_f32 v169,v129,v153,v169
v_mfma_f32_16x16x32_bf16 v[36:39],a[236:239],v[116:119],v[36:39]
s_waitcnt lgkmcnt(1)
v_fma_f32 v170,v130,v154,v170
v_fma_f32 v171,v131,v155,v171
v_fma_f32 v172,v132,v156,v172
v_mfma_f32_16x16x32_bf16 v[32:35],a[240:243],v[120:123],v[32:35]
v_fma_f32 v173,v133,v157,v173
v_fma_f32 v174,v134,v158,v174
v_fma_f32 v175,v135,v159,v175
v_mfma_f32_16x16x32_bf16 v[36:39],a[244:247],v[120:123],v[36:39]
s_waitcnt lgkmcnt(0)
v_cvt_pk_bf16_f32 v176,v168,v169
v_cvt_pk_bf16_f32 v177,v170,v171
v_cvt_pk_bf16_f32 v178,v172,v173
v_mfma_f32_16x16x32_bf16 v[40:43],a[248:251],v[124:127],v[32:35]
v_cvt_pk_bf16_f32 v179,v174,v175
v_mfma_f32_16x16x32_bf16 v[44:47],a[252:255],v[124:127],v[36:39]
s_waitcnt vmcnt(0)
s_add_u32 s64,s66,201326592
buffer_store_dwordx4 v[176:179],v21,s[20:23],s64 offen sc1
s_add_u32 s79,s66,201392128
s_cmp_ge_u32 s63,126
s_cselect_b32 s79,138641408,s79
buffer_store_dwordx4 v[204:207],v21,s[20:23],s79 offen sc1
s_cmp_eq_u32 s56,1
s_cbranch_scc1 b1_149
buffer_store_dwordx4 v[204:207],v21,s[20:23],s84 offen offset:0
buffer_store_dwordx4 v[204:207],v21,s[20:23],s84 offen offset:1024
b2_150:
s_cmp_eq_u32 s56,1
s_cbranch_scc1 b1_151
buffer_store_dwordx4 v[204:207],v21,s[20:23],s84 offen offset:2048
buffer_store_dwordx4 v[204:207],v21,s[20:23],s84 offen offset:3072
b2_152:
s_cmp_eq_u32 s56,1
s_cbranch_scc1 b1_153
buffer_store_dwordx4 v[204:207],v21,s[20:23],s85 offen offset:0
buffer_store_dwordx4 v[204:207],v21,s[20:23],s85 offen offset:1024
b2_154:
s_mul_i32 s64,s77,32768
s_add_u32 s66,s66,s64
s_mul_i32 s64,s77,6144
s_add_u32 s75,s75,s64
s_cmp_eq_u32 s75,24576
s_cselect_b32 s75,0,s75
s_add_u32 s63,s63,s77
s_mov_b32 s77,0
v_cmp_gt_u32 vcc,s71,v16
s_add_u32 s60,s60,1
s_branch endN_148
BN_124:
s_waitcnt vmcnt(7)
ds_read_b128 v[64:67],v4 offset:0
s_waitcnt vmcnt(6)
ds_read_b128 v[68:71],v4 offset:1024
s_waitcnt vmcnt(5)
ds_read_b128 v[72:75],v4 offset:2048
s_waitcnt vmcnt(4)
ds_read_b128 v[76:79],v4 offset:3072
s_waitcnt lgkmcnt(3)
v_mfma_f32_16x16x32_bf16 v[32:35],a[0:3],v[64:67],0
s_add_u32 s71,s60,2
s_add_u32 s53,s60,3
v_mfma_f32_16x16x32_bf16 v[36:39],a[4:7],v[64:67],0
s_waitcnt lgkmcnt(2)
s_waitcnt vmcnt(3)
ds_read_b128 v[80:83],v4 offset:4096
v_mfma_f32_16x16x32_bf16 v[32:35],a[8:11],v[68:71],v[32:35]
v_mfma_f32_16x16x32_bf16 v[36:39],a[12:15],v[68:71],v[36:39]
s_waitcnt lgkmcnt(2)
s_waitcnt vmcnt(2)
ds_read_b128 v[84:87],v4 offset:5120
v_mfma_f32_16x16x32_bf16 v[32:35],a[16:19],v[72:75],v[32:35]
v_mfma_f32_16x16x32_bf16 v[36:39],a[20:23],v[72:75],v[36:39]
s_waitcnt lgkmcnt(2)
s_waitcnt vmcnt(1)
ds_read_b128 v[88:91],v4 offset:6144
v_mfma_f32_16x16x32_bf16 v[32:35],a[24:27],v[76:79],v[32:35]
v_mfma_f32_16x16x32_bf16 v[36:39],a[28:31],v[76:79],v[36:39]
s_waitcnt lgkmcnt(2)
s_waitcnt vmcnt(0)
ds_read_b128 v[92:95],v4 offset:7168
v_mfma_f32_16x16x32_bf16 v[32:35],a[32:35],v[80:83],v[32:35]
v_mfma_f32_16x16x32_bf16 v[36:39],a[36:39],v[80:83],v[36:39]
s_waitcnt lgkmcnt(2)
s_barrier
ds_read_b128 v[96:99],v5 offset:0
v_mfma_f32_16x16x32_bf16 v[32:35],a[40:43],v[84:87],v[32:35]
ds_read_b128 v[100:103],v5 offset:1024
v_mfma_f32_16x16x32_bf16 v[36:39],a[44:47],v[84:87],v[36:39]
s_waitcnt lgkmcnt(3)
ds_read_b128 v[104:107],v5 offset:2048
v_mfma_f32_16x16x32_bf16 v[32:35],a[48:51],v[88:91],v[32:35]
ds_read_b128 v[108:111],v5 offset:3072
v_mfma_f32_16x16x32_bf16 v[36:39],a[52:55],v[88:91],v[36:39]
s_waitcnt lgkmcnt(4)
ds_read_b128 v[112:115],v5 offset:4096
v_mfma_f32_16x16x32_bf16 v[32:35],a[56:59],v[92:95],v[32:35]
s_cmp_eq_u32 s77,0
s_cselect_b32 s57,2.0,0
ds_read_b128 v[116:119],v5 offset:5120
v_mfma_f32_16x16x32_bf16 v[36:39],a[60:63],v[92:95],v[36:39]
s_waitcnt lgkmcnt(5)
v_or_b32 v21,s57,v0
v_lshlrev_b32 v168,16,v160
v_mfma_f32_16x16x32_bf16 v[32:35],a[64:67],v[96:99],v[32:35]
ds_read_b128 v[120:123],v5 offset:6144
v_and_b32 v169,s73,v160
v_mfma_f32_16x16x32_bf16 v[36:39],a[68:71],v[96:99],v[36:39]
s_waitcnt lgkmcnt(5)
v_lshlrev_b32 v170,16,v161
v_and_b32 v171,s73,v161
v_mfma_f32_16x16x32_bf16 v[32:35],a[72:75],v[100:103],v[32:35]
ds_read_b128 v[124:127],v5 offset:7168
v_lshlrev_b32 v172,16,v162
v_mfma_f32_16x16x32_bf16 v[36:39],a[76:79],v[100:103],v[36:39]
s_waitcnt lgkmcnt(5)
v_and_b32 v173,s73,v162
v_lshlrev_b32 v174,16,v163
v_mfma_f32_16x16x32_bf16 v[32:35],a[80:83],v[104:107],v[32:35]
ds_read_b128 v[64:67],v6 offset:0
v_and_b32 v175,s73,v163
v_mfma_f32_16x16x32_bf16 v[36:39],a[84:87],v[104:107],v[36:39]
s_waitcnt lgkmcnt(5)
v_fma_f32 v168,v212,v152,v168
v_fma_f32 v169,v213,v153,v169
v_mfma_f32_16x16x32_bf16 v[32:35],a[88:91],v[108:111],v[32:35]
ds_read_b128 v[68:71],v6 offset:1024
v_fma_f32 v170,v214,v154,v170
v_mfma_f32_16x16x32_bf16 v[36:39],a[92:95],v[108:111],v[36:39]
s_waitcnt lgkmcnt(5)
v_fma_f32 v171,v215,v155,v171
v_fma_f32 v172,v216,v156,v172
v_mfma_f32_16x16x32_bf16 v[32:35],a[96:99],v[112:115],v[32:35]
ds_read_b128 v[72:75],v6 offset:2048
v_fma_f32 v173,v217,v157,v173
v_mfma_f32_16x16x32_bf16 v[36:39],a[100:103],v[112:115],v[36:39]
s_waitcnt lgkmcnt(5)
v_fma_f32 v174,v218,v158,v174
v_fma_f32 v175,v219,v159,v175
v_mfma_f32_16x16x32_bf16 v[32:35],a[104:107],v[116:119],v[32:35]
ds_read_b128 v[76:79],v6 offset:3072
v_mfma_f32_16x16x32_bf16 v[36:39],a[108:111],v[116:119],v[36:39]
s_waitcnt lgkmcnt(5)
buffer_load_dwordx4 v[160:163],v18,s[24:27],s82 offen
v_mfma_f32_16x16x32_bf16 v[32:35],a[112:115],v[120:123],v[32:35]
s_add_u32 s84,s74,s75
s_add_u32 s85,s84,4096
ds_read_b128 v[80:83],v6 offset:4096
v_mfma_f32_16x16x32_bf16 v[36:39],a[116:119],v[120:123],v[36:39]
s_waitcnt lgkmcnt(5)
s_add_u32 s82,s82,32768
buffer_load_dwordx4 v[128:131],v0,s[20:23],s84 offen offset:0 sc1
v_mfma_f32_16x16x32_bf16 v[32:35],a[120:123],v[124:127],v[32:35]
ds_read_b128 v[84:87],v6 offset:5120
v_mfma_f32_16x16x32_bf16 v[36:39],a[124:127],v[124:127],v[36:39]
s_waitcnt lgkmcnt(5)
buffer_load_dwordx4 v[132:135],v0,s[20:23],s84 offen offset:1024 sc1
v_mfma_f32_16x16x32_bf16 v[32:35],a[128:131],v[64:67],v[32:35]
ds_read_b128 v[88:91],v6 offset:6144
v_mfma_f32_16x16x32_bf16 v[36:39],a[132:135],v[64:67],v[36:39]
s_waitcnt lgkmcnt(5)
buffer_load_dwordx4 v[136:139],v0,s[20:23],s84 offen offset:2048 sc1
v_mfma_f32_16x16x32_bf16 v[32:35],a[136:139],v[68:71],v[32:35]
ds_read_b128 v[92:95],v6 offset:7168
v_mfma_f32_16x16x32_bf16 v[36:39],a[140:143],v[68:71],v[36:39]
s_waitcnt lgkmcnt(5)
buffer_load_dwordx4 v[140:143],v0,s[20:23],s84 offen offset:3072 sc1
v_mfma_f32_16x16x32_bf16 v[32:35],a[144:147],v[72:75],v[32:35]
ds_read_b128 v[96:99],v7 offset:0
v_mfma_f32_16x16x32_bf16 v[36:39],a[148:151],v[72:75],v[36:39]
s_waitcnt lgkmcnt(5)
buffer_load_dwordx4 v[144:147],v0,s[20:23],s85 offen offset:0 sc1
v_mfma_f32_16x16x32_bf16 v[32:35],a[152:155],v[76:79],v[32:35]
ds_read_b128 v[100:103],v7 offset:1024
v_mfma_f32_16x16x32_bf16 v[36:39],a[156:159],v[76:79],v[36:39]
s_waitcnt lgkmcnt(5)
buffer_load_dwordx4 v[148:151],v0,s[20:23],s85 offen offset:1024 sc1
v_mfma_f32_16x16x32_bf16 v[32:35],a[160:163],v[80:83],v[32:35]
ds_read_b128 v[104:107],v7 offset:2048
buffer_load_dword v16,v2,s[20:23],s68 offen sc1
v_mfma_f32_16x16x32_bf16 v[36:39],a[164:167],v[80:83],v[36:39]
s_waitcnt lgkmcnt(5)
v_mfma_f32_16x16x32_bf16 v[32:35],a[168:171],v[84:87],v[32:35]
ds_read_b128 v[108:111],v7 offset:3072
v_mfma_f32_16x16x32_bf16 v[36:39],a[172:175],v[84:87],v[36:39]
s_waitcnt lgkmcnt(5)
v_mfma_f32_16x16x32_bf16 v[32:35],a[176:179],v[88:91],v[32:35]
ds_read_b128 v[112:115],v7 offset:4096
v_mfma_f32_16x16x32_bf16 v[36:39],a[180:183],v[88:91],v[36:39]
s_waitcnt lgkmcnt(5)
v_mfma_f32_16x16x32_bf16 v[32:35],a[184:187],v[92:95],v[32:35]
ds_read_b128 v[116:119],v7 offset:5120
v_mfma_f32_16x16x32_bf16 v[36:39],a[188:191],v[92:95],v[36:39]
s_waitcnt lgkmcnt(5)
v_mfma_f32_16x16x32_bf16 v[32:35],a[192:195],v[96:99],v[32:35]
ds_read_b128 v[120:123],v7 offset:6144
v_mfma_f32_16x16x32_bf16 v[36:39],a[196:199],v[96:99],v[36:39]
s_waitcnt lgkmcnt(5)
v_mfma_f32_16x16x32_bf16 v[32:35],a[200:203],v[100:103],v[32:35]
s_waitcnt vmcnt(1)
ds_read_b128 v[124:127],v7 offset:7168
s_cmp_eq_u32 s77,0
s_cbranch_scc1 go_166
ck_164:
v_max3_u32 v184,v128,v129,v130
v_max3_u32 v185,v140,v141,v142
v_max3_u32 v184,v184,v131,v132
v_max3_u32 v185,v185,v143,v144
v_max3_u32 v184,v184,v133,v134
v_max3_u32 v185,v185,v145,v146
v_max3_u32 v184,v184,v135,v136
v_max3_u32 v185,v185,v147,v148
v_max3_u32 v184,v184,v137,v138
v_max3_u32 v185,v185,v149,v150
v_max3_u32 v184,v184,v139,v151
v_max_u32 v184,v184,v185
v_cmp_eq_u32 vcc,-1,v184
s_cbranch_vccnz rt_165
go_166:
v_mfma_f32_16x16x32_bf16 v[36:39],a[204:207],v[100:103],v[36:39]
s_waitcnt lgkmcnt(5)
s_add_u32 s55,s55,32768
s_and_b32 s55,s55,0x1ffff
v_add_f32 v128,v128,v136
v_mfma_f32_16x16x32_bf16 v[32:35],a[208:211],v[104:107],v[32:35]
v_add_u32 v4,s55,v8
v_add_u32 v5,s55,v9
v_add_f32 v129,v129,v137
v_mfma_f32_16x16x32_bf16 v[36:39],a[212:215],v[104:107],v[36:39]
s_waitcnt lgkmcnt(4)
v_add_u32 v6,s55,v10
v_add_u32 v7,s55,v11
v_add_f32 v130,v130,v138
v_mfma_f32_16x16x32_bf16 v[32:35],a[216:219],v[108:111],v[32:35]
v_add_f32 v131,v131,v139
v_add_f32 v132,v132,v140
v_add_f32 v133,v133,v141
v_mfma_f32_16x16x32_bf16 v[36:39],a[220:223],v[108:111],v[36:39]
s_waitcnt lgkmcnt(3)
v_add_f32 v134,v134,v142
v_add_f32 v135,v135,v143
v_add_f32 v128,v128,v144
v_mfma_f32_16x16x32_bf16 v[32:35],a[224:227],v[112:115],v[32:35]
v_add_f32 v129,v129,v145
v_add_f32 v130,v130,v146
v_add_f32 v131,v131,v147
v_mfma_f32_16x16x32_bf16 v[36:39],a[228:231],v[112:115],v[36:39]
s_waitcnt lgkmcnt(2)
v_add_f32 v132,v132,v148
v_add_f32 v133,v133,v149
v_add_f32 v134,v134,v150
v_mfma_f32_16x16x32_bf16 v[32:35],a[232:235],v[116:119],v[32:35]
v_add_f32 v135,v135,v151
v_fma_f32 v168,v128,v152,v168
v_fma_f32 v169,v129,v153,v169
v_mfma_f32_16x16x32_bf16 v[36:39],a[236:239],v[116:119],v[36:39]
s_waitcnt lgkmcnt(1)
v_fma_f32 v170,v130,v154,v170
v_fma_f32 v171,v131,v155,v171
v_fma_f32 v172,v132,v156,v172
v_mfma_f32_16x16x32_bf16 v[32:35],a[240:243],v[120:123],v[32:35]
v_fma_f32 v173,v133,v157,v173
v_fma_f32 v174,v134,v158,v174
v_fma_f32 v175,v135,v159,v175
v_mfma_f32_16x16x32_bf16 v[36:39],a[244:247],v[120:123],v[36:39]
s_waitcnt lgkmcnt(0)
v_cvt_pk_bf16_f32 v176,v168,v169
v_cvt_pk_bf16_f32 v177,v170,v171
v_cvt_pk_bf16_f32 v178,v172,v173
v_mfma_f32_16x16x32_bf16 v[40:43],a[248:251],v[124:127],v[32:35]
v_cvt_pk_bf16_f32 v179,v174,v175
v_mfma_f32_16x16x32_bf16 v[44:47],a[252:255],v[124:127],v[36:39]
s_waitcnt vmcnt(0)
s_add_u32 s64,s66,201326592
buffer_store_dwordx4 v[176:179],v21,s[20:23],s64 offen sc1
s_add_u32 s79,s66,201392128
s_cmp_ge_u32 s63,126
s_cselect_b32 s79,138641408,s79
buffer_store_dwordx4 v[204:207],v21,s[20:23],s79 offen sc1
s_cmp_eq_u32 s56,1
s_cbranch_scc1 b1_158
buffer_store_dwordx4 v[204:207],v21,s[20:23],s84 offen offset:0
buffer_store_dwordx4 v[204:207],v21,s[20:23],s84 offen offset:1024
b2_159:
s_cmp_eq_u32 s56,1
s_cbranch_scc1 b1_160
buffer_store_dwordx4 v[204:207],v21,s[20:23],s84 offen offset:2048
buffer_store_dwordx4 v[204:207],v21,s[20:23],s84 offen offset:3072
b2_161:
s_cmp_eq_u32 s56,1
s_cbranch_scc1 b1_162
buffer_store_dwordx4 v[204:207],v21,s[20:23],s85 offen offset:0
buffer_store_dwordx4 v[204:207],v21,s[20:23],s85 offen offset:1024
b2_163:
s_mul_i32 s64,s77,32768
s_add_u32 s66,s66,s64
s_mul_i32 s64,s77,6144
s_add_u32 s75,s75,s64
s_cmp_eq_u32 s75,24576
s_cselect_b32 s75,0,s75
s_add_u32 s63,s63,s77
s_mov_b32 s77,0
v_cmp_gt_u32 vcc,s71,v16
s_add_u32 s60,s60,1
endN_148:
s_cbranch_vccnz nb_127
s_mov_b32 m0,s70
s_nop 0
buffer_load_dwordx4 v3,s[20:23],s61 offen offset:0 lds
buffer_load_dwordx4 v3,s[20:23],s61 offen offset:1024 lds
buffer_load_dwordx4 v3,s[20:23],s61 offen offset:2048 lds
buffer_load_dwordx4 v3,s[20:23],s61 offen offset:3072 lds
s_add_u32 m0,s70,4096
s_nop 0
buffer_load_dwordx4 v3,s[20:23],s62 offen offset:0 lds
buffer_load_dwordx4 v3,s[20:23],s62 offen offset:1024 lds
buffer_load_dwordx4 v3,s[20:23],s62 offen offset:2048 lds
buffer_load_dwordx4 v3,s[20:23],s62 offen offset:3072 lds
s_add_u32 s61,s61,131072
s_add_u32 s62,s62,131072
s_add_u32 s70,s70,32768
s_and_b32 s70,s70,0x1ffff
v_mov_b32 v212,v40
v_mov_b32 v213,v41
v_mov_b32 v214,v42
v_mov_b32 v215,v43
v_mov_b32 v216,v44
v_mov_b32 v217,v45
v_mov_b32 v218,v46
v_mov_b32 v219,v47
s_mov_b32 s77,1
s_branch dec_126
nb_127:
s_nop 3
s_mov_b32 s77,1
s_add_u32 s84,s74,s75
s_add_u32 s85,s84,4096
buffer_load_dwordx4 v[128:131],v0,s[20:23],s84 offen offset:0 sc1
buffer_load_dwordx4 v[132:135],v0,s[20:23],s84 offen offset:1024 sc1
buffer_load_dwordx4 v[136:139],v0,s[20:23],s84 offen offset:2048 sc1
buffer_load_dwordx4 v[140:143],v0,s[20:23],s84 offen offset:3072 sc1
buffer_load_dwordx4 v[144:147],v0,s[20:23],s85 offen offset:0 sc1
buffer_load_dwordx4 v[148:151],v0,s[20:23],s85 offen offset:1024 sc1
s_cmp_eq_u32 s77,0
s_cselect_b32 s57,2.0,0
v_or_b32 v21,s57,v0
v_lshlrev_b32 v168,16,v160
v_and_b32 v169,s73,v160
v_lshlrev_b32 v170,16,v161
v_and_b32 v171,s73,v161
v_lshlrev_b32 v172,16,v162
v_and_b32 v173,s73,v162
v_lshlrev_b32 v174,16,v163
v_and_b32 v175,s73,v163
v_pk_fma_f32 v[168:169],v[40:41],v[152:153],v[168:169]
v_pk_fma_f32 v[170:171],v[42:43],v[154:155],v[170:171]
v_pk_fma_f32 v[172:173],v[44:45],v[156:157],v[172:173]
v_pk_fma_f32 v[174:175],v[46:47],v[158:159],v[174:175]
s_waitcnt vmcnt(0)
s_cmp_eq_u32 s77,0
s_cbranch_scc1 go_175
ck_173:
v_max3_u32 v184,v128,v129,v130
v_max3_u32 v185,v140,v141,v142
v_max3_u32 v184,v184,v131,v132
v_max3_u32 v185,v185,v143,v144
v_max3_u32 v184,v184,v133,v134
v_max3_u32 v185,v185,v145,v146
v_max3_u32 v184,v184,v135,v136
v_max3_u32 v185,v185,v147,v148
v_max3_u32 v184,v184,v137,v138
v_max3_u32 v185,v185,v149,v150
v_max3_u32 v184,v184,v139,v151
v_max_u32 v184,v184,v185
v_cmp_eq_u32 vcc,-1,v184
s_cbranch_vccnz rt_174
go_175:
buffer_load_dword v16,v2,s[20:23],s68 offen sc1
v_pk_add_f32 v[128:129],v[128:129],v[136:137]
v_pk_add_f32 v[130:131],v[130:131],v[138:139]
v_pk_add_f32 v[132:133],v[132:133],v[140:141]
v_pk_add_f32 v[134:135],v[134:135],v[142:143]
v_pk_add_f32 v[128:129],v[128:129],v[144:145]
v_pk_add_f32 v[130:131],v[130:131],v[146:147]
v_pk_add_f32 v[132:133],v[132:133],v[148:149]
v_pk_add_f32 v[134:135],v[134:135],v[150:151]
v_pk_fma_f32 v[168:169],v[128:129],v[152:153],v[168:169]
v_pk_fma_f32 v[170:171],v[130:131],v[154:155],v[170:171]
v_pk_fma_f32 v[172:173],v[132:133],v[156:157],v[172:173]
v_pk_fma_f32 v[174:175],v[134:135],v[158:159],v[174:175]
v_cvt_pk_bf16_f32 v176,v168,v169
v_cvt_pk_bf16_f32 v177,v170,v171
v_cvt_pk_bf16_f32 v178,v172,v173
v_cvt_pk_bf16_f32 v179,v174,v175
s_add_u32 s64,s66,201326592
buffer_store_dwordx4 v[176:179],v21,s[20:23],s64 offen sc1
s_add_u32 s79,s66,201392128
s_cmp_ge_u32 s63,126
s_cselect_b32 s79,138641408,s79
buffer_store_dwordx4 v[204:207],v21,s[20:23],s79 offen sc1
s_cmp_eq_u32 s56,1
s_cbranch_scc1 b1_167
buffer_store_dwordx4 v[204:207],v21,s[20:23],s84 offen offset:0
buffer_store_dwordx4 v[204:207],v21,s[20:23],s84 offen offset:1024
b2_168:
s_cmp_eq_u32 s56,1
s_cbranch_scc1 b1_169
buffer_store_dwordx4 v[204:207],v21,s[20:23],s84 offen offset:2048
buffer_store_dwordx4 v[204:207],v21,s[20:23],s84 offen offset:3072
b2_170:
s_cmp_eq_u32 s56,1
s_cbranch_scc1 b1_171
buffer_store_dwordx4 v[204:207],v21,s[20:23],s85 offen offset:0
buffer_store_dwordx4 v[204:207],v21,s[20:23],s85 offen offset:1024
b2_172:
s_mul_i32 s64,s77,32768
s_add_u32 s66,s66,s64
s_mul_i32 s64,s77,6144
s_add_u32 s75,s75,s64
s_cmp_eq_u32 s75,24576
s_cselect_b32 s75,0,s75
s_add_u32 s63,s63,s77
s_mov_b32 s77,0
s_waitcnt vmcnt(8)
v_cmp_gt_u32 vcc,s71,v16
s_cbranch_vccz lag_125
s_cmp_ge_u32 s60,128
s_cbranch_scc1 done_77
plp_178:
buffer_load_dword v16,v2,s[20:23],s68 offen sc1
s_waitcnt vmcnt(0)
v_cmp_gt_u32 vcc,s71,v16
s_cbranch_vccz pok_179
s_sleep 4
s_sub_u32 s90,s90,1
s_cmp_gt_i32 s90,0
s_cbranch_scc1 plp_178
pok_179:
s_branch lag_125
b1_96:
s_nop 7
buffer_store_dwordx4 v[40:43],v0,s[20:23],s64 offen offset:0 sc1
buffer_store_dwordx4 v[44:47],v0,s[20:23],s64 offen offset:1024 sc1
s_branch b2_97
b1_99:
s_nop 7
buffer_store_dwordx4 v[40:43],v0,s[20:23],s64 offen offset:0 sc1
buffer_store_dwordx4 v[44:47],v0,s[20:23],s64 offen offset:1024 sc1
s_branch b2_100
b1_101:
s_nop 7
buffer_store_dwordx4 v[40:43],v0,s[20:23],s64 offen offset:0 sc1
buffer_store_dwordx4 v[44:47],v0,s[20:23],s64 offen offset:1024 sc1
s_branch b2_102
b1_103:
s_nop 7
buffer_store_dwordx4 v[40:43],v0,s[20:23],s64 offen offset:0 sc1
buffer_store_dwordx4 v[44:47],v0,s[20:23],s64 offen offset:1024 sc1
s_branch b2_104
b1_130:
s_nop 7
buffer_store_dwordx4 v[204:207],v21,s[20:23],s84 offen offset:0 sc1
buffer_store_dwordx4 v[204:207],v21,s[20:23],s84 offen offset:1024 sc1
s_branch b2_131
b1_132:
s_nop 7
buffer_store_dwordx4 v[204:207],v21,s[20:23],s84 offen offset:2048 sc1
buffer_store_dwordx4 v[204:207],v21,s[20:23],s84 offen offset:3072 sc1
s_branch b2_133
b1_134:
s_nop 7
buffer_store_dwordx4 v[204:207],v21,s[20:23],s85 offen offset:0 sc1
buffer_store_dwordx4 v[204:207],v21,s[20:23],s85 offen offset:1024 sc1
s_branch b2_135
rt_137:
s_sub_u32 s90,s90,1
s_cmp_gt_i32 s90,0
s_cbranch_scc0 go_138
s_add_u32 s84,s74,s75
s_add_u32 s85,s84,4096
buffer_load_dwordx4 v[128:131],v0,s[20:23],s84 offen offset:0 sc1
buffer_load_dwordx4 v[132:135],v0,s[20:23],s84 offen offset:1024 sc1
buffer_load_dwordx4 v[136:139],v0,s[20:23],s84 offen offset:2048 sc1
buffer_load_dwordx4 v[140:143],v0,s[20:23],s84 offen offset:3072 sc1
buffer_load_dwordx4 v[144:147],v0,s[20:23],s85 offen offset:0 sc1
buffer_load_dwordx4 v[148:151],v0,s[20:23],s85 offen offset:1024 sc1
s_waitcnt vmcnt(0)
s_branch ck_136
b1_139:
s_nop 7
buffer_store_dwordx4 v[204:207],v21,s[20:23],s84 offen offset:0 sc1
buffer_store_dwordx4 v[204:207],v21,s[20:23],s84 offen offset:1024 sc1
s_branch b2_140
b1_141:
s_nop 7
buffer_store_dwordx4 v[204:207],v21,s[20:23],s84 offen offset:2048 sc1
buffer_store_dwordx4 v[204:207],v21,s[20:23],s84 offen offset:3072 sc1
s_branch b2_142
b1_143:
s_nop 7
buffer_store_dwordx4 v[204:207],v21,s[20:23],s85 offen offset:0 sc1
buffer_store_dwordx4 v[204:207],v21,s[20:23],s85 offen offset:1024 sc1
s_branch b2_144
rt_146:
s_sub_u32 s90,s90,1
s_cmp_gt_i32 s90,0
s_cbranch_scc0 go_147
s_add_u32 s84,s74,s75
s_add_u32 s85,s84,4096
buffer_load_dwordx4 v[128:131],v0,s[20:23],s84 offen offset:0 sc1
buffer_load_dwordx4 v[132:135],v0,s[20:23],s84 offen offset:1024 sc1
buffer_load_dwordx4 v[136:139],v0,s[20:23],s84 offen offset:2048 sc1
buffer_load_dwordx4 v[140:143],v0,s[20:23],s84 offen offset:3072 sc1
buffer_load_dwordx4 v[144:147],v0,s[20:23],s85 offen offset:0 sc1
buffer_load_dwordx4 v[148:151],v0,s[20:23],s85 offen offset:1024 sc1
s_waitcnt vmcnt(0)
s_branch ck_145
b1_149:
s_nop 7
buffer_store_dwordx4 v[204:207],v21,s[20:23],s84 offen offset:0 sc1
buffer_store_dwordx4 v[204:207],v21,s[20:23],s84 offen offset:1024 sc1
s_branch b2_150
b1_151:
s_nop 7
buffer_store_dwordx4 v[204:207],v21,s[20:23],s84 offen offset:2048 sc1
buffer_store_dwordx4 v[204:207],v21,s[20:23],s84 offen offset:3072 sc1
s_branch b2_152
b1_153:
s_nop 7
buffer_store_dwordx4 v[204:207],v21,s[20:23],s85 offen offset:0 sc1
buffer_store_dwordx4 v[204:207],v21,s[20:23],s85 offen offset:1024 sc1
s_branch b2_154
rt_156:
s_sub_u32 s90,s90,1
s_cmp_gt_i32 s90,0
s_cbranch_scc0 go_157
s_add_u32 s84,s74,s75
s_add_u32 s85,s84,4096
buffer_load_dwordx4 v[128:131],v0,s[20:23],s84 offen offset:0 sc1
buffer_load_dwordx4 v[132:135],v0,s[20:23],s84 offen offset:1024 sc1
buffer_load_dwordx4 v[136:139],v0,s[20:23],s84 offen offset:2048 sc1
buffer_load_dwordx4 v[140:143],v0,s[20:23],s84 offen offset:3072 sc1
buffer_load_dwordx4 v[144:147],v0,s[20:23],s85 offen offset:0 sc1
buffer_load_dwordx4 v[148:151],v0,s[20:23],s85 offen offset:1024 sc1
s_waitcnt vmcnt(0)
s_branch ck_155
b1_158:
s_nop 7
buffer_store_dwordx4 v[204:207],v21,s[20:23],s84 offen offset:0 sc1
buffer_store_dwordx4 v[204:207],v21,s[20:23],s84 offen offset:1024 sc1
s_branch b2_159
b1_160:
s_nop 7
buffer_store_dwordx4 v[204:207],v21,s[20:23],s84 offen offset:2048 sc1
buffer_store_dwordx4 v[204:207],v21,s[20:23],s84 offen offset:3072 sc1
s_branch b2_161
b1_162:
s_nop 7
buffer_store_dwordx4 v[204:207],v21,s[20:23],s85 offen offset:0 sc1
buffer_store_dwordx4 v[204:207],v21,s[20:23],s85 offen offset:1024 sc1
s_branch b2_163
rt_165:
s_sub_u32 s90,s90,1
s_cmp_gt_i32 s90,0
s_cbranch_scc0 go_166
s_add_u32 s84,s74,s75
s_add_u32 s85,s84,4096
buffer_load_dwordx4 v[128:131],v0,s[20:23],s84 offen offset:0 sc1
buffer_load_dwordx4 v[132:135],v0,s[20:23],s84 offen offset:1024 sc1
buffer_load_dwordx4 v[136:139],v0,s[20:23],s84 offen offset:2048 sc1
buffer_load_dwordx4 v[140:143],v0,s[20:23],s84 offen offset:3072 sc1
buffer_load_dwordx4 v[144:147],v0,s[20:23],s85 offen offset:0 sc1
buffer_load_dwordx4 v[148:151],v0,s[20:23],s85 offen offset:1024 sc1
s_waitcnt vmcnt(0)
s_branch ck_164
b1_167:
s_nop 7
buffer_store_dwordx4 v[204:207],v21,s[20:23],s84 offen offset:0 sc1
buffer_store_dwordx4 v[204:207],v21,s[20:23],s84 offen offset:1024 sc1
s_branch b2_168
b1_169:
s_nop 7
buffer_store_dwordx4 v[204:207],v21,s[20:23],s84 offen offset:2048 sc1
buffer_store_dwordx4 v[204:207],v21,s[20:23],s84 offen offset:3072 sc1
s_branch b2_170
b1_171:
s_nop 7
buffer_store_dwordx4 v[204:207],v21,s[20:23],s85 offen offset:0 sc1
buffer_store_dwordx4 v[204:207],v21,s[20:23],s85 offen offset:1024 sc1
s_branch b2_172
rt_174:
s_sub_u32 s90,s90,1
s_cmp_gt_i32 s90,0
s_cbranch_scc0 go_175
s_add_u32 s84,s74,s75
s_add_u32 s85,s84,4096
buffer_load_dwordx4 v[128:131],v0,s[20:23],s84 offen offset:0 sc1
buffer_load_dwordx4 v[132:135],v0,s[20:23],s84 offen offset:1024 sc1
buffer_load_dwordx4 v[136:139],v0,s[20:23],s84 offen offset:2048 sc1
buffer_load_dwordx4 v[140:143],v0,s[20:23],s84 offen offset:3072 sc1
buffer_load_dwordx4 v[144:147],v0,s[20:23],s85 offen offset:0 sc1
buffer_load_dwordx4 v[148:151],v0,s[20:23],s85 offen offset:1024 sc1
s_waitcnt vmcnt(0)
s_branch ck_173
done_77:
s_endpgm
fl_w4:
v_and_b32 v21,15,v1
v_lshrrev_b32 v22,4,v1
v_lshrrev_b32 v23,2,v21
v_and_b32 v24,3,v21
s_lshl_b32 s61,s50,15
v_lshl_add_u32 v25,v22,3,v23
s_load_dwordx2 s[4:5],s[0:1],88
s_load_dwordx2 s[6:7],s[0:1],112
s_lshr_b32 s52,s59,3
s_and_b32 s53,s59,7
s_mul_i32 s54,s52,1835008
s_lshl_b32 s64,s53,8
s_add_u32 s54,s54,s64
s_lshl_b32 s64,s50,6
s_add_u32 s54,s54,s64
s_waitcnt lgkmcnt(0)
s_mov_b32 s28,s4
s_and_b32 s29,s5,0xffff
s_mov_b32 s30,0x700000
s_mov_b32 s31,0x20000
s_mov_b32 s24,s6
s_and_b32 s25,s7,0xffff
s_mov_b32 s26,0x400000
s_mov_b32 s27,0x20000
s_mov_b32 s92,s2
s_and_b32 s93,s3,0xffff
s_mov_b32 s94,0x100
s_mov_b32 s95,0x20000
v_mbcnt_lo_u32_b32 v16,-1,0
v_mbcnt_hi_u32_b32 v16,-1,v16
v_mov_b32 v18,0
v_cmp_eq_u32 vcc,17,v16
s_nop 1
v_cndmask_b32 v18,v18,63,vcc
v_and_b32 v19,1,v16
v_cmp_eq_u32 vcc,1,v19
v_mov_b32 v19,8192
s_nop 0
v_cndmask_b32 v19,-1,v19,vcc
v_min_u32 v16,31,v16
v_lshlrev_b32 v16,2,v16
s_sub_u32 s66,s88,64
s_cmp_lg_u32 s50,0
s_cbranch_scc1 vot_185
vpoll_181:
buffer_load_dword v17,v16,s[92:95],s66 offen sc1
s_waitcnt vmcnt(0)
s_cmp_lg_u32 s56,2
s_cbranch_scc1 vck_182
v_cmp_eq_u32 vcc,v17,v19
s_and_b32 s64,vcc_lo,0xffff
s_cmp_eq_u32 s64,65535
s_cbranch_scc1 vck_182
s_mov_b32 s65,0
v_readlane_b32 s64,v17,1
s_lshr_b32 s64,s64,8
s_add_u32 s65,s65,s64
v_readlane_b32 s64,v17,3
s_lshr_b32 s64,s64,8
s_add_u32 s65,s65,s64
v_readlane_b32 s64,v17,5
s_lshr_b32 s64,s64,8
s_add_u32 s65,s65,s64
v_readlane_b32 s64,v17,7
s_lshr_b32 s64,s64,8
s_add_u32 s65,s65,s64
v_readlane_b32 s64,v17,9
s_lshr_b32 s64,s64,8
s_add_u32 s65,s65,s64
v_readlane_b32 s64,v17,11
s_lshr_b32 s64,s64,8
s_add_u32 s65,s65,s64
v_readlane_b32 s64,v17,13
s_lshr_b32 s64,s64,8
s_add_u32 s65,s65,s64
v_readlane_b32 s64,v17,15
s_lshr_b32 s64,s64,8
s_add_u32 s65,s65,s64
s_cmp_ge_u32 s65,256
s_cbranch_scc1 vok_184
s_branch vrt_183
vck_182:
v_cmp_gt_u32 vcc,v18,v17
s_cbranch_vccz vok_184
vrt_183:
s_sleep 48
s_sub_u32 s90,s90,1
s_cmp_gt_i32 s90,0
s_cbranch_scc1 vpoll_181
vok_184:
v_add_u32 v18,159744,v16
ds_write_b32 v18,v17
s_waitcnt lgkmcnt(0)
vot_185:
s_barrier
v_add_u32 v18,159744,v16
ds_read_b32 v17,v18
s_waitcnt lgkmcnt(0)
s_cmp_lg_u32 s56,2
s_cbranch_scc1 vfin_186
v_cmp_eq_u32 vcc,v17,v19
s_and_b32 s64,vcc_lo,0xffff
s_cmp_eq_u32 s64,65535
s_cbranch_scc1 vfin_186
s_mov_b32 s65,0
v_readlane_b32 s64,v17,1
s_lshr_b32 s64,s64,8
s_add_u32 s65,s65,s64
v_readlane_b32 s64,v17,3
s_lshr_b32 s64,s64,8
s_add_u32 s65,s65,s64
v_readlane_b32 s64,v17,5
s_lshr_b32 s64,s64,8
s_add_u32 s65,s65,s64
v_readlane_b32 s64,v17,7
s_lshr_b32 s64,s64,8
s_add_u32 s65,s65,s64
v_readlane_b32 s64,v17,9
s_lshr_b32 s64,s64,8
s_add_u32 s65,s65,s64
v_readlane_b32 s64,v17,11
s_lshr_b32 s64,s64,8
s_add_u32 s65,s65,s64
v_readlane_b32 s64,v17,13
s_lshr_b32 s64,s64,8
s_add_u32 s65,s65,s64
v_readlane_b32 s64,v17,15
s_lshr_b32 s64,s64,8
s_add_u32 s65,s65,s64
s_cmp_ge_u32 s65,256
s_cbranch_scc1 fl_fb
vfin_186:
s_and_b32 s56,s56,1
v_lshrrev_b32 v26,2,v1
v_and_b32 v27,3,v1
v_mul_u32_u24 v16,2048,v26
v_lshl_add_u32 v16,v27,4,v16
v_lshlrev_b32 v17,6,v25
v_lshl_add_u32 v17,v24,4,v17
v_add_u32 v17,s61,v17
s_xor_b32 s62,s50,0
s_mul_i32 s62,s62,458752
s_add_u32 s62,s62,s54
s_add_u32 m0,s61,0
s_nop 0
buffer_load_dwordx4 v16,s[28:31],s62 offen lds
s_add_u32 s62,s62,32768
s_add_u32 m0,m0,1024
s_waitcnt vmcnt(2)
buffer_load_dwordx4 v16,s[28:31],s62 offen lds
s_add_u32 s62,s62,32768
s_add_u32 m0,m0,1024
s_waitcnt vmcnt(2)
buffer_load_dwordx4 v16,s[28:31],s62 offen lds
s_add_u32 s62,s62,32768
s_add_u32 m0,m0,1024
s_waitcnt vmcnt(2)
buffer_load_dwordx4 v16,s[28:31],s62 offen lds
s_add_u32 s62,s62,32768
s_add_u32 m0,m0,1024
s_waitcnt vmcnt(2)
buffer_load_dwordx4 v16,s[28:31],s62 offen lds
s_add_u32 s62,s62,32768
s_add_u32 m0,m0,1024
s_waitcnt vmcnt(2)
buffer_load_dwordx4 v16,s[28:31],s62 offen lds
s_add_u32 s62,s62,32768
s_add_u32 m0,m0,1024
s_waitcnt vmcnt(2)
buffer_load_dwordx4 v16,s[28:31],s62 offen lds
s_add_u32 s62,s62,32768
s_add_u32 m0,m0,1024
s_waitcnt vmcnt(2)
buffer_load_dwordx4 v16,s[28:31],s62 offen lds
s_add_u32 s62,s62,32768
s_add_u32 m0,m0,1024
s_waitcnt vmcnt(2)
buffer_load_dwordx4 v16,s[28:31],s62 offen lds
s_add_u32 s62,s62,32768
s_add_u32 m0,m0,1024
s_waitcnt vmcnt(2)
buffer_load_dwordx4 v16,s[28:31],s62 offen lds
s_add_u32 s62,s62,32768
s_add_u32 m0,m0,1024
s_waitcnt vmcnt(2)
buffer_load_dwordx4 v16,s[28:31],s62 offen lds
s_add_u32 s62,s62,32768
s_add_u32 m0,m0,1024
s_waitcnt vmcnt(2)
buffer_load_dwordx4 v16,s[28:31],s62 offen lds
s_add_u32 s62,s62,32768
s_add_u32 m0,m0,1024
s_waitcnt vmcnt(2)
buffer_load_dwordx4 v16,s[28:31],s62 offen lds
s_add_u32 s62,s62,32768
s_add_u32 m0,m0,1024
s_waitcnt vmcnt(2)
buffer_load_dwordx4 v16,s[28:31],s62 offen lds
s_waitcnt vmcnt(2)
s_xor_b32 s62,s50,1
s_mul_i32 s62,s62,458752
s_add_u32 s62,s62,s54
s_add_u32 m0,s61,16384
s_nop 0
buffer_load_dwordx4 v16,s[28:31],s62 offen lds
s_add_u32 s62,s62,32768
s_add_u32 m0,m0,1024
s_waitcnt vmcnt(2)
buffer_load_dwordx4 v16,s[28:31],s62 offen lds
s_add_u32 s62,s62,32768
s_add_u32 m0,m0,1024
s_waitcnt vmcnt(2)
buffer_load_dwordx4 v16,s[28:31],s62 offen lds
s_add_u32 s62,s62,32768
s_add_u32 m0,m0,1024
s_waitcnt vmcnt(2)
buffer_load_dwordx4 v16,s[28:31],s62 offen lds
s_add_u32 s62,s62,32768
s_add_u32 m0,m0,1024
s_waitcnt vmcnt(2)
buffer_load_dwordx4 v16,s[28:31],s62 offen lds
s_add_u32 s62,s62,32768
s_add_u32 m0,m0,1024
s_waitcnt vmcnt(2)
buffer_load_dwordx4 v16,s[28:31],s62 offen lds
s_add_u32 s62,s62,32768
s_add_u32 m0,m0,1024
s_waitcnt vmcnt(2)
buffer_load_dwordx4 v16,s[28:31],s62 offen lds
s_add_u32 s62,s62,32768
s_add_u32 m0,m0,1024
s_waitcnt vmcnt(2)
buffer_load_dwordx4 v16,s[28:31],s62 offen lds
s_add_u32 s62,s62,32768
s_add_u32 m0,m0,1024
s_waitcnt vmcnt(2)
buffer_load_dwordx4 v16,s[28:31],s62 offen lds
s_add_u32 s62,s62,32768
s_add_u32 m0,m0,1024
s_waitcnt vmcnt(2)
buffer_load_dwordx4 v16,s[28:31],s62 offen lds
s_add_u32 s62,s62,32768
s_add_u32 m0,m0,1024
s_waitcnt vmcnt(2)
buffer_load_dwordx4 v16,s[28:31],s62 offen lds
s_add_u32 s62,s62,32768
s_add_u32 m0,m0,1024
s_waitcnt vmcnt(2)
buffer_load_dwordx4 v16,s[28:31],s62 offen lds
s_add_u32 s62,s62,32768
s_add_u32 m0,m0,1024
s_waitcnt vmcnt(2)
buffer_load_dwordx4 v16,s[28:31],s62 offen lds
s_add_u32 s62,s62,32768
s_add_u32 m0,m0,1024
s_waitcnt vmcnt(2)
buffer_load_dwordx4 v16,s[28:31],s62 offen lds
s_waitcnt vmcnt(2)
s_waitcnt vmcnt(14)
ds_read_b64_tr_b16 a[0:1],v17 offset:0
ds_read_b64_tr_b16 a[2:3],v17 offset:256
ds_read_b64_tr_b16 a[4:5],v17 offset:8
ds_read_b64_tr_b16 a[6:7],v17 offset:264
ds_read_b64_tr_b16 a[8:9],v17 offset:2048
ds_read_b64_tr_b16 a[10:11],v17 offset:2304
ds_read_b64_tr_b16 a[12:13],v17 offset:2056
ds_read_b64_tr_b16 a[14:15],v17 offset:2312
ds_read_b64_tr_b16 a[16:17],v17 offset:4096
ds_read_b64_tr_b16 a[18:19],v17 offset:4352
ds_read_b64_tr_b16 a[20:21],v17 offset:4104
ds_read_b64_tr_b16 a[22:23],v17 offset:4360
s_waitcnt lgkmcnt(0)
ds_read_b64_tr_b16 a[24:25],v17 offset:6144
ds_read_b64_tr_b16 a[26:27],v17 offset:6400
ds_read_b64_tr_b16 a[28:29],v17 offset:6152
ds_read_b64_tr_b16 a[30:31],v17 offset:6408
ds_read_b64_tr_b16 a[32:33],v17 offset:8192
ds_read_b64_tr_b16 a[34:35],v17 offset:8448
ds_read_b64_tr_b16 a[36:37],v17 offset:8200
ds_read_b64_tr_b16 a[38:39],v17 offset:8456
ds_read_b64_tr_b16 a[40:41],v17 offset:10240
ds_read_b64_tr_b16 a[42:43],v17 offset:10496
ds_read_b64_tr_b16 a[44:45],v17 offset:10248
ds_read_b64_tr_b16 a[46:47],v17 offset:10504
s_waitcnt lgkmcnt(0)
ds_read_b64_tr_b16 a[48:49],v17 offset:12288
ds_read_b64_tr_b16 a[50:51],v17 offset:12544
ds_read_b64_tr_b16 a[52:53],v17 offset:12296
ds_read_b64_tr_b16 a[54:55],v17 offset:12552
s_waitcnt lgkmcnt(0)
s_xor_b32 s62,s50,2
s_mul_i32 s62,s62,458752
s_add_u32 s62,s62,s54
s_add_u32 m0,s61,0
s_nop 0
buffer_load_dwordx4 v16,s[28:31],s62 offen lds
s_add_u32 s62,s62,32768
s_add_u32 m0,m0,1024
s_waitcnt vmcnt(2)
buffer_load_dwordx4 v16,s[28:31],s62 offen lds
s_add_u32 s62,s62,32768
s_add_u32 m0,m0,1024
s_waitcnt vmcnt(2)
buffer_load_dwordx4 v16,s[28:31],s62 offen lds
s_add_u32 s62,s62,32768
s_add_u32 m0,m0,1024
s_waitcnt vmcnt(2)
buffer_load_dwordx4 v16,s[28:31],s62 offen lds
s_add_u32 s62,s62,32768
s_add_u32 m0,m0,1024
s_waitcnt vmcnt(2)
buffer_load_dwordx4 v16,s[28:31],s62 offen lds
s_add_u32 s62,s62,32768
s_add_u32 m0,m0,1024
s_waitcnt vmcnt(2)
buffer_load_dwordx4 v16,s[28:31],s62 offen lds
s_add_u32 s62,s62,32768
s_add_u32 m0,m0,1024
s_waitcnt vmcnt(2)
buffer_load_dwordx4 v16,s[28:31],s62 offen lds
s_add_u32 s62,s62,32768
s_add_u32 m0,m0,1024
s_waitcnt vmcnt(2)
buffer_load_dwordx4 v16,s[28:31],s62 offen lds
s_add_u32 s62,s62,32768
s_add_u32 m0,m0,1024
s_waitcnt vmcnt(2)
buffer_load_dwordx4 v16,s[28:31],s62 offen lds
s_add_u32 s62,s62,32768
s_add_u32 m0,m0,1024
s_waitcnt vmcnt(2)
buffer_load_dwordx4 v16,s[28:31],s62 offen lds
s_add_u32 s62,s62,32768
s_add_u32 m0,m0,1024
s_waitcnt vmcnt(2)
buffer_load_dwordx4 v16,s[28:31],s62 offen lds
s_add_u32 s62,s62,32768
s_add_u32 m0,m0,1024
s_waitcnt vmcnt(2)
buffer_load_dwordx4 v16,s[28:31],s62 offen lds
s_add_u32 s62,s62,32768
s_add_u32 m0,m0,1024
s_waitcnt vmcnt(2)
buffer_load_dwordx4 v16,s[28:31],s62 offen lds
s_add_u32 s62,s62,32768
s_add_u32 m0,m0,1024
s_waitcnt vmcnt(2)
buffer_load_dwordx4 v16,s[28:31],s62 offen lds
s_waitcnt vmcnt(2)
s_waitcnt vmcnt(14)
ds_read_b64_tr_b16 a[56:57],v17 offset:16384
ds_read_b64_tr_b16 a[58:59],v17 offset:16640
ds_read_b64_tr_b16 a[60:61],v17 offset:16392
ds_read_b64_tr_b16 a[62:63],v17 offset:16648
ds_read_b64_tr_b16 a[64:65],v17 offset:18432
ds_read_b64_tr_b16 a[66:67],v17 offset:18688
ds_read_b64_tr_b16 a[68:69],v17 offset:18440
ds_read_b64_tr_b16 a[70:71],v17 offset:18696
ds_read_b64_tr_b16 a[72:73],v17 offset:20480
ds_read_b64_tr_b16 a[74:75],v17 offset:20736
ds_read_b64_tr_b16 a[76:77],v17 offset:20488
ds_read_b64_tr_b16 a[78:79],v17 offset:20744
s_waitcnt lgkmcnt(0)
ds_read_b64_tr_b16 a[80:81],v17 offset:22528
ds_read_b64_tr_b16 a[82:83],v17 offset:22784
ds_read_b64_tr_b16 a[84:85],v17 offset:22536
ds_read_b64_tr_b16 a[86:87],v17 offset:22792
ds_read_b64_tr_b16 a[88:89],v17 offset:24576
ds_read_b64_tr_b16 a[90:91],v17 offset:24832
ds_read_b64_tr_b16 a[92:93],v17 offset:24584
ds_read_b64_tr_b16 a[94:95],v17 offset:24840
ds_read_b64_tr_b16 a[96:97],v17 offset:26624
ds_read_b64_tr_b16 a[98:99],v17 offset:26880
ds_read_b64_tr_b16 a[100:101],v17 offset:26632
ds_read_b64_tr_b16 a[102:103],v17 offset:26888
s_waitcnt lgkmcnt(0)
ds_read_b64_tr_b16 a[104:105],v17 offset:28672
ds_read_b64_tr_b16 a[106:107],v17 offset:28928
ds_read_b64_tr_b16 a[108:109],v17 offset:28680
ds_read_b64_tr_b16 a[110:111],v17 offset:28936
s_waitcnt lgkmcnt(0)
s_xor_b32 s62,s50,3
s_mul_i32 s62,s62,458752
s_add_u32 s62,s62,s54
s_add_u32 m0,s61,16384
s_nop 0
buffer_load_dwordx4 v16,s[28:31],s62 offen lds
s_add_u32 s62,s62,32768
s_add_u32 m0,m0,1024
s_waitcnt vmcnt(2)
buffer_load_dwordx4 v16,s[28:31],s62 offen lds
s_add_u32 s62,s62,32768
s_add_u32 m0,m0,1024
s_waitcnt vmcnt(2)
buffer_load_dwordx4 v16,s[28:31],s62 offen lds
s_add_u32 s62,s62,32768
s_add_u32 m0,m0,1024
s_waitcnt vmcnt(2)
buffer_load_dwordx4 v16,s[28:31],s62 offen lds
s_add_u32 s62,s62,32768
s_add_u32 m0,m0,1024
s_waitcnt vmcnt(2)
buffer_load_dwordx4 v16,s[28:31],s62 offen lds
s_add_u32 s62,s62,32768
s_add_u32 m0,m0,1024
s_waitcnt vmcnt(2)
buffer_load_dwordx4 v16,s[28:31],s62 offen lds
s_add_u32 s62,s62,32768
s_add_u32 m0,m0,1024
s_waitcnt vmcnt(2)
buffer_load_dwordx4 v16,s[28:31],s62 offen lds
s_add_u32 s62,s62,32768
s_add_u32 m0,m0,1024
s_waitcnt vmcnt(2)
buffer_load_dwordx4 v16,s[28:31],s62 offen lds
s_add_u32 s62,s62,32768
s_add_u32 m0,m0,1024
s_waitcnt vmcnt(2)
buffer_load_dwordx4 v16,s[28:31],s62 offen lds
s_add_u32 s62,s62,32768
s_add_u32 m0,m0,1024
s_waitcnt vmcnt(2)
buffer_load_dwordx4 v16,s[28:31],s62 offen lds
s_add_u32 s62,s62,32768
s_add_u32 m0,m0,1024
s_waitcnt vmcnt(2)
buffer_load_dwordx4 v16,s[28:31],s62 offen lds
s_add_u32 s62,s62,32768
s_add_u32 m0,m0,1024
s_waitcnt vmcnt(2)
buffer_load_dwordx4 v16,s[28:31],s62 offen lds
s_add_u32 s62,s62,32768
s_add_u32 m0,m0,1024
s_waitcnt vmcnt(2)
buffer_load_dwordx4 v16,s[28:31],s62 offen lds
s_add_u32 s62,s62,32768
s_add_u32 m0,m0,1024
s_waitcnt vmcnt(2)
buffer_load_dwordx4 v16,s[28:31],s62 offen lds
s_waitcnt vmcnt(2)
s_waitcnt vmcnt(14)
ds_read_b64_tr_b16 a[112:113],v17 offset:0
ds_read_b64_tr_b16 a[114:115],v17 offset:256
ds_read_b64_tr_b16 a[116:117],v17 offset:8
ds_read_b64_tr_b16 a[118:119],v17 offset:264
ds_read_b64_tr_b16 a[120:121],v17 offset:2048
ds_read_b64_tr_b16 a[122:123],v17 offset:2304
ds_read_b64_tr_b16 a[124:125],v17 offset:2056
ds_read_b64_tr_b16 a[126:127],v17 offset:2312
ds_read_b64_tr_b16 a[128:129],v17 offset:4096
ds_read_b64_tr_b16 a[130:131],v17 offset:4352
ds_read_b64_tr_b16 a[132:133],v17 offset:4104
ds_read_b64_tr_b16 a[134:135],v17 offset:4360
s_waitcnt lgkmcnt(0)
ds_read_b64_tr_b16 a[136:137],v17 offset:6144
ds_read_b64_tr_b16 a[138:139],v17 offset:6400
ds_read_b64_tr_b16 a[140:141],v17 offset:6152
ds_read_b64_tr_b16 a[142:143],v17 offset:6408
ds_read_b64_tr_b16 a[144:145],v17 offset:8192
ds_read_b64_tr_b16 a[146:147],v17 offset:8448
ds_read_b64_tr_b16 a[148:149],v17 offset:8200
ds_read_b64_tr_b16 a[150:151],v17 offset:8456
ds_read_b64_tr_b16 a[152:153],v17 offset:10240
ds_read_b64_tr_b16 a[154:155],v17 offset:10496
ds_read_b64_tr_b16 a[156:157],v17 offset:10248
ds_read_b64_tr_b16 a[158:159],v17 offset:10504
s_waitcnt lgkmcnt(0)
ds_read_b64_tr_b16 a[160:161],v17 offset:12288
ds_read_b64_tr_b16 a[162:163],v17 offset:12544
ds_read_b64_tr_b16 a[164:165],v17 offset:12296
ds_read_b64_tr_b16 a[166:167],v17 offset:12552
s_waitcnt lgkmcnt(0)
s_waitcnt vmcnt(0)
ds_read_b64_tr_b16 a[168:169],v17 offset:16384
ds_read_b64_tr_b16 a[170:171],v17 offset:16640
ds_read_b64_tr_b16 a[172:173],v17 offset:16392
ds_read_b64_tr_b16 a[174:175],v17 offset:16648
ds_read_b64_tr_b16 a[176:177],v17 offset:18432
ds_read_b64_tr_b16 a[178:179],v17 offset:18688
ds_read_b64_tr_b16 a[180:181],v17 offset:18440
ds_read_b64_tr_b16 a[182:183],v17 offset:18696
ds_read_b64_tr_b16 a[184:185],v17 offset:20480
ds_read_b64_tr_b16 a[186:187],v17 offset:20736
ds_read_b64_tr_b16 a[188:189],v17 offset:20488
ds_read_b64_tr_b16 a[190:191],v17 offset:20744
s_waitcnt lgkmcnt(0)
ds_read_b64_tr_b16 a[192:193],v17 offset:22528
ds_read_b64_tr_b16 a[194:195],v17 offset:22784
ds_read_b64_tr_b16 a[196:197],v17 offset:22536
ds_read_b64_tr_b16 a[198:199],v17 offset:22792
ds_read_b64_tr_b16 a[200:201],v17 offset:24576
ds_read_b64_tr_b16 a[202:203],v17 offset:24832
ds_read_b64_tr_b16 a[204:205],v17 offset:24584
ds_read_b64_tr_b16 a[206:207],v17 offset:24840
ds_read_b64_tr_b16 a[208:209],v17 offset:26624
ds_read_b64_tr_b16 a[210:211],v17 offset:26880
ds_read_b64_tr_b16 a[212:213],v17 offset:26632
ds_read_b64_tr_b16 a[214:215],v17 offset:26888
s_waitcnt lgkmcnt(0)
ds_read_b64_tr_b16 a[216:217],v17 offset:28672
ds_read_b64_tr_b16 a[218:219],v17 offset:28928
ds_read_b64_tr_b16 a[220:221],v17 offset:28680
ds_read_b64_tr_b16 a[222:223],v17 offset:28936
s_waitcnt lgkmcnt(0)
s_mov_b32 s92,s2
s_and_b32 s93,s3,0xffff
s_mov_b32 s94,0x100
s_mov_b32 s95,0x20000
v_mbcnt_lo_u32_b32 v16,-1,0
v_mbcnt_hi_u32_b32 v16,-1,v16
v_mov_b32 v18,0
v_cmp_eq_u32 vcc,22,v16
s_nop 1
v_cndmask_b32 v18,v18,63,vcc
v_cmp_eq_u32 vcc,17,v16
s_nop 1
v_cndmask_b32 v18,v18,63,vcc
v_cmp_eq_u32 vcc,18,v16
s_nop 1
v_cndmask_b32 v18,v18,1,vcc
v_and_b32 v19,1,v16
v_cmp_eq_u32 vcc,1,v19
v_mov_b32 v19,8192
s_nop 0
v_cndmask_b32 v19,-1,v19,vcc
v_min_u32 v16,31,v16
v_lshlrev_b32 v16,2,v16
s_sub_u32 s66,s88,64
s_cmp_lg_u32 s50,0
s_cbranch_scc1 vot_191
vpoll_187:
buffer_load_dword v17,v16,s[92:95],s66 offen sc1
s_waitcnt vmcnt(0)
s_cmp_lg_u32 s56,2
s_cbranch_scc1 vck_188
v_cmp_eq_u32 vcc,v17,v19
s_and_b32 s64,vcc_lo,0xffff
s_cmp_eq_u32 s64,65535
s_cbranch_scc1 vck_188
s_mov_b32 s65,0
v_readlane_b32 s64,v17,1
s_lshr_b32 s64,s64,8
s_add_u32 s65,s65,s64
v_readlane_b32 s64,v17,3
s_lshr_b32 s64,s64,8
s_add_u32 s65,s65,s64
v_readlane_b32 s64,v17,5
s_lshr_b32 s64,s64,8
s_add_u32 s65,s65,s64
v_readlane_b32 s64,v17,7
s_lshr_b32 s64,s64,8
s_add_u32 s65,s65,s64
v_readlane_b32 s64,v17,9
s_lshr_b32 s64,s64,8
s_add_u32 s65,s65,s64
v_readlane_b32 s64,v17,11
s_lshr_b32 s64,s64,8
s_add_u32 s65,s65,s64
v_readlane_b32 s64,v17,13
s_lshr_b32 s64,s64,8
s_add_u32 s65,s65,s64
v_readlane_b32 s64,v17,15
s_lshr_b32 s64,s64,8
s_add_u32 s65,s65,s64
s_cmp_ge_u32 s65,256
s_cbranch_scc1 vok_190
s_branch vrt_189
vck_188:
v_cmp_gt_u32 vcc,v18,v17
s_cbranch_vccz vok_190
vrt_189:
s_sleep 48
s_sub_u32 s90,s90,1
s_cmp_gt_i32 s90,0
s_cbranch_scc1 vpoll_187
vok_190:
v_add_u32 v18,160000,v16
ds_write_b32 v18,v17
s_waitcnt lgkmcnt(0)
vot_191:
s_barrier
v_add_u32 v18,160000,v16
ds_read_b32 v17,v18
s_waitcnt lgkmcnt(0)
s_cmp_lg_u32 s56,2
s_cbranch_scc1 vfin_192
v_cmp_eq_u32 vcc,v17,v19
s_and_b32 s64,vcc_lo,0xffff
s_cmp_eq_u32 s64,65535
s_cbranch_scc1 vfin_192
s_mov_b32 s65,0
v_readlane_b32 s64,v17,1
s_lshr_b32 s64,s64,8
s_add_u32 s65,s65,s64
v_readlane_b32 s64,v17,3
s_lshr_b32 s64,s64,8
s_add_u32 s65,s65,s64
v_readlane_b32 s64,v17,5
s_lshr_b32 s64,s64,8
s_add_u32 s65,s65,s64
v_readlane_b32 s64,v17,7
s_lshr_b32 s64,s64,8
s_add_u32 s65,s65,s64
v_readlane_b32 s64,v17,9
s_lshr_b32 s64,s64,8
s_add_u32 s65,s65,s64
v_readlane_b32 s64,v17,11
s_lshr_b32 s64,s64,8
s_add_u32 s65,s65,s64
v_readlane_b32 s64,v17,13
s_lshr_b32 s64,s64,8
s_add_u32 s65,s65,s64
v_readlane_b32 s64,v17,15
s_lshr_b32 s64,s64,8
s_add_u32 s65,s65,s64
s_cmp_ge_u32 s65,256
s_cbranch_scc1 fl_fb
vfin_192:
s_and_b32 s56,s56,1
s_mov_b32 s67,0
s_barrier
v_lshlrev_b32 v0,4,v1
s_mov_b32 s60,0
s_lshl_b32 s70,s50,13
s_mov_b32 s55,0
v_mov_b32 v3,v0
s_mov_b32 s73,0xffff0000
s_lshl_b32 s64,s52,2
s_add_u32 s64,s64,s50
s_mul_i32 s61,s64,7168
s_add_u32 s61,s61,219152384
s_lshl_b32 s68,s64,8
s_add_u32 s68,s68,138551296
s_lshl_b32 s83,s53,2
s_add_u32 s83,s83,s50
s_mov_b32 s63,0
s_xor_b32 s64,s50,0
s_lshl_b32 s64,s64,13
v_add_u32 v8,s64,v0
v_mov_b32 v4,v8
s_xor_b32 s64,s50,1
s_lshl_b32 s64,s64,13
v_add_u32 v9,s64,v0
v_mov_b32 v5,v9
s_xor_b32 s64,s50,2
s_lshl_b32 s64,s64,13
v_add_u32 v10,s64,v0
v_mov_b32 v6,v10
s_xor_b32 s64,s50,3
s_lshl_b32 s64,s64,13
v_add_u32 v11,s64,v0
v_mov_b32 v7,v11
v_min_u32 v2,6,v1
v_lshlrev_b32 v2,2,v2
s_add_u32 s62,s61,4096
s_lshl_b32 s66,s83,10
s_lshr_b32 s65,s83,3
s_lshl_b32 s65,s65,8
s_and_b32 s64,s83,7
s_lshl_b32 s64,s64,2
s_add_u32 s69,s64,s65
s_add_u32 s69,s69,138555392
s_add_u32 s82,s66,201326592
s_lshl_b32 s64,s53,2
s_add_u32 s64,s64,s50
s_mul_i32 s74,s64,24576
s_xor_b32 s64,s50,s52
s_sub_u32 s64,s64,1
s_max_i32 s64,s64,0
s_lshl_b32 s64,s64,11
s_add_u32 s74,s74,s64
s_add_u32 s74,s74,168558592
s_mov_b32 s75,0
s_mov_b32 s77,0
v_lshlrev_b32 v26,11,v21
v_lshl_add_u32 v26,v22,4,v26
s_lshl_b32 s64,s83,6
v_add_u32 v18,s64,v26
v_lshlrev_b32 v26,5,v22
s_lshl_b32 s64,s83,7
s_add_u32 s64,s64,267407360
buffer_load_dwordx4 v[152:155],v26,s[20:23],s64 offen offset:0 sc1
buffer_load_dwordx4 v[156:159],v26,s[20:23],s64 offen offset:16 sc1
s_add_u32 s64,s64,24576
buffer_load_dwordx4 v[128:131],v26,s[20:23],s64 offen offset:0 sc1
buffer_load_dwordx4 v[132:135],v26,s[20:23],s64 offen offset:16 sc1
s_add_u32 s64,s64,24576
buffer_load_dwordx4 v[136:139],v26,s[20:23],s64 offen offset:0 sc1
buffer_load_dwordx4 v[140:143],v26,s[20:23],s64 offen offset:16 sc1
s_add_u32 s64,s64,24576
buffer_load_dwordx4 v[144:147],v26,s[20:23],s64 offen offset:0 sc1
buffer_load_dwordx4 v[148:151],v26,s[20:23],s64 offen offset:16 sc1
s_add_u32 s64,s64,24576
s_waitcnt vmcnt(0)
v_pk_add_f32 v[152:153],v[152:153],v[128:129]
v_pk_add_f32 v[136:137],v[136:137],v[144:145]
v_pk_add_f32 v[154:155],v[154:155],v[130:131]
v_pk_add_f32 v[138:139],v[138:139],v[146:147]
v_pk_add_f32 v[156:157],v[156:157],v[132:133]
v_pk_add_f32 v[140:141],v[140:141],v[148:149]
v_pk_add_f32 v[158:159],v[158:159],v[134:135]
v_pk_add_f32 v[142:143],v[142:143],v[150:151]
v_pk_add_f32 v[152:153],v[152:153],v[136:137]
v_pk_add_f32 v[154:155],v[154:155],v[138:139]
v_pk_add_f32 v[156:157],v[156:157],v[140:141]
v_pk_add_f32 v[158:159],v[158:159],v[142:143]
v_cvt_pk_bf16_f32 v128,v152,v153
v_cvt_pk_bf16_f32 v129,v154,v155
v_cvt_pk_bf16_f32 v130,v156,v157
v_cvt_pk_bf16_f32 v131,v158,v159
v_lshlrev_b32 v152,16,v128
v_and_b32 v153,s73,v128
v_lshlrev_b32 v154,16,v129
v_and_b32 v155,s73,v129
v_lshlrev_b32 v156,16,v130
v_and_b32 v157,s73,v130
v_lshlrev_b32 v158,16,v131
v_and_b32 v159,s73,v131
v_mov_b32 v204,-1
v_mov_b32 v205,-1
v_mov_b32 v206,-1
v_mov_b32 v207,-1
v_cmp_eq_u32 vcc,0,v1
s_nop 1
v_cndmask_b32 v26,2.0,0,vcc
s_cmp_eq_u32 s50,s52
s_cbranch_scc1 lfin_193
s_add_u32 s71,s60,1
s_add_u32 s53,s60,2
plp_203:
buffer_load_dword v16,v2,s[20:23],s68 offen sc1
s_waitcnt vmcnt(0)
v_cmp_gt_u32 vcc,s71,v16
s_cbranch_vccz pok_204
s_sleep 4
s_sub_u32 s90,s90,1
s_cmp_gt_i32 s90,0
s_cbranch_scc1 plp_203
pok_204:
lag_200:
s_mov_b32 m0,s70
s_nop 0
buffer_load_dwordx4 v3,s[20:23],s61 offen offset:0 lds
buffer_load_dwordx4 v3,s[20:23],s61 offen offset:1024 lds
buffer_load_dwordx4 v3,s[20:23],s61 offen offset:2048 lds
buffer_load_dwordx4 v3,s[20:23],s61 offen offset:3072 lds
s_add_u32 m0,s70,4096
s_nop 0
buffer_load_dwordx4 v3,s[20:23],s62 offen offset:0 lds
buffer_load_dwordx4 v3,s[20:23],s62 offen offset:1024 lds
buffer_load_dwordx4 v3,s[20:23],s62 offen offset:2048 lds
s_add_u32 s61,s61,114688
s_add_u32 s62,s62,114688
s_add_u32 s70,s70,32768
s_and_b32 s70,s70,0x1ffff
buffer_load_dword v23,off,s[20:23],s66
buffer_load_dword v23,off,s[20:23],s66
dec_201:
v_cmp_gt_u32 vcc,s53,v16
s_cbranch_vccnz BN_199
BR_198:
s_waitcnt vmcnt(8)
ds_read_b128 v[64:67],v4 offset:0
s_waitcnt vmcnt(7)
ds_read_b128 v[68:71],v4 offset:1024
s_waitcnt vmcnt(6)
ds_read_b128 v[72:75],v4 offset:2048
s_waitcnt vmcnt(5)
ds_read_b128 v[76:79],v4 offset:3072
s_waitcnt lgkmcnt(3)
v_mfma_f32_16x16x32_bf16 v[32:35],a[0:3],v[64:67],0
s_add_u32 s71,s60,2
s_add_u32 s53,s60,3
v_mfma_f32_16x16x32_bf16 v[36:39],a[4:7],v[64:67],0
s_waitcnt lgkmcnt(2)
s_waitcnt vmcnt(4)
ds_read_b128 v[80:83],v4 offset:4096
v_mfma_f32_16x16x32_bf16 v[32:35],a[8:11],v[68:71],v[32:35]
v_mfma_f32_16x16x32_bf16 v[36:39],a[12:15],v[68:71],v[36:39]
s_waitcnt lgkmcnt(2)
s_waitcnt vmcnt(3)
s_mov_b32 m0,s70
ds_read_b128 v[84:87],v4 offset:5120
v_mfma_f32_16x16x32_bf16 v[32:35],a[16:19],v[72:75],v[32:35]
buffer_load_dwordx4 v3,s[20:23],s61 offen offset:0 lds
v_mfma_f32_16x16x32_bf16 v[36:39],a[20:23],v[72:75],v[36:39]
s_waitcnt lgkmcnt(2)
s_waitcnt vmcnt(3)
ds_read_b128 v[88:91],v4 offset:6144
v_mfma_f32_16x16x32_bf16 v[32:35],a[24:27],v[76:79],v[32:35]
buffer_load_dwordx4 v3,s[20:23],s61 offen offset:1024 lds
v_mfma_f32_16x16x32_bf16 v[36:39],a[28:31],v[76:79],v[36:39]
s_waitcnt lgkmcnt(2)
s_barrier
ds_read_b128 v[92:95],v5 offset:0
v_mfma_f32_16x16x32_bf16 v[32:35],a[32:35],v[80:83],v[32:35]
ds_read_b128 v[96:99],v5 offset:1024
v_mfma_f32_16x16x32_bf16 v[36:39],a[36:39],v[80:83],v[36:39]
s_waitcnt lgkmcnt(3)
ds_read_b128 v[100:103],v5 offset:2048
buffer_load_dwordx4 v3,s[20:23],s61 offen offset:2048 lds
v_mfma_f32_16x16x32_bf16 v[32:35],a[40:43],v[84:87],v[32:35]
ds_read_b128 v[104:107],v5 offset:3072
v_mfma_f32_16x16x32_bf16 v[36:39],a[44:47],v[84:87],v[36:39]
s_waitcnt lgkmcnt(4)
ds_read_b128 v[108:111],v5 offset:4096
v_mfma_f32_16x16x32_bf16 v[32:35],a[48:51],v[88:91],v[32:35]
ds_read_b128 v[112:115],v5 offset:5120
buffer_load_dwordx4 v3,s[20:23],s61 offen offset:3072 lds
v_mfma_f32_16x16x32_bf16 v[36:39],a[52:55],v[88:91],v[36:39]
s_waitcnt lgkmcnt(5)
v_mfma_f32_16x16x32_bf16 v[32:35],a[56:59],v[92:95],v[32:35]
ds_read_b128 v[116:119],v5 offset:6144
v_mfma_f32_16x16x32_bf16 v[36:39],a[60:63],v[92:95],v[36:39]
s_waitcnt lgkmcnt(5)
s_add_u32 m0,s70,4096
v_mfma_f32_16x16x32_bf16 v[32:35],a[64:67],v[96:99],v[32:35]
ds_read_b128 v[120:123],v6 offset:0
buffer_load_dwordx4 v3,s[20:23],s62 offen offset:0 lds
v_mfma_f32_16x16x32_bf16 v[36:39],a[68:71],v[96:99],v[36:39]
s_waitcnt lgkmcnt(5)
v_mfma_f32_16x16x32_bf16 v[32:35],a[72:75],v[100:103],v[32:35]
ds_read_b128 v[124:127],v6 offset:1024
v_mfma_f32_16x16x32_bf16 v[36:39],a[76:79],v[100:103],v[36:39]
s_waitcnt lgkmcnt(5)
buffer_load_dwordx4 v3,s[20:23],s62 offen offset:1024 lds
v_mfma_f32_16x16x32_bf16 v[32:35],a[80:83],v[104:107],v[32:35]
ds_read_b128 v[64:67],v6 offset:2048
v_mfma_f32_16x16x32_bf16 v[36:39],a[84:87],v[104:107],v[36:39]
s_waitcnt lgkmcnt(5)
buffer_load_dword v16,v2,s[20:23],s68 offen sc1
v_mfma_f32_16x16x32_bf16 v[32:35],a[88:91],v[108:111],v[32:35]
ds_read_b128 v[68:71],v6 offset:3072
buffer_load_dwordx4 v3,s[20:23],s62 offen offset:2048 lds
v_mfma_f32_16x16x32_bf16 v[36:39],a[92:95],v[108:111],v[36:39]
s_waitcnt lgkmcnt(5)
v_mfma_f32_16x16x32_bf16 v[32:35],a[96:99],v[112:115],v[32:35]
ds_read_b128 v[72:75],v6 offset:4096
v_mfma_f32_16x16x32_bf16 v[36:39],a[100:103],v[112:115],v[36:39]
s_waitcnt lgkmcnt(5)
v_mfma_f32_16x16x32_bf16 v[32:35],a[104:107],v[116:119],v[32:35]
ds_read_b128 v[76:79],v6 offset:5120
v_mfma_f32_16x16x32_bf16 v[36:39],a[108:111],v[116:119],v[36:39]
s_waitcnt lgkmcnt(5)
v_mfma_f32_16x16x32_bf16 v[32:35],a[112:115],v[120:123],v[32:35]
ds_read_b128 v[80:83],v6 offset:6144
v_mfma_f32_16x16x32_bf16 v[36:39],a[116:119],v[120:123],v[36:39]
s_waitcnt lgkmcnt(5)
v_mfma_f32_16x16x32_bf16 v[32:35],a[120:123],v[124:127],v[32:35]
ds_read_b128 v[84:87],v7 offset:0
v_mfma_f32_16x16x32_bf16 v[36:39],a[124:127],v[124:127],v[36:39]
s_waitcnt lgkmcnt(5)
v_mfma_f32_16x16x32_bf16 v[32:35],a[128:131],v[64:67],v[32:35]
ds_read_b128 v[88:91],v7 offset:1024
v_mfma_f32_16x16x32_bf16 v[36:39],a[132:135],v[64:67],v[36:39]
s_waitcnt lgkmcnt(5)
v_mfma_f32_16x16x32_bf16 v[32:35],a[136:139],v[68:71],v[32:35]
ds_read_b128 v[92:95],v7 offset:2048
v_mfma_f32_16x16x32_bf16 v[36:39],a[140:143],v[68:71],v[36:39]
s_waitcnt lgkmcnt(5)
v_mfma_f32_16x16x32_bf16 v[32:35],a[144:147],v[72:75],v[32:35]
ds_read_b128 v[96:99],v7 offset:3072
v_mfma_f32_16x16x32_bf16 v[36:39],a[148:151],v[72:75],v[36:39]
s_waitcnt lgkmcnt(5)
v_mfma_f32_16x16x32_bf16 v[32:35],a[152:155],v[76:79],v[32:35]
ds_read_b128 v[100:103],v7 offset:4096
v_mfma_f32_16x16x32_bf16 v[36:39],a[156:159],v[76:79],v[36:39]
s_waitcnt lgkmcnt(5)
v_mfma_f32_16x16x32_bf16 v[32:35],a[160:163],v[80:83],v[32:35]
ds_read_b128 v[104:107],v7 offset:5120
v_mfma_f32_16x16x32_bf16 v[36:39],a[164:167],v[80:83],v[36:39]
s_waitcnt lgkmcnt(5)
v_mfma_f32_16x16x32_bf16 v[32:35],a[168:171],v[84:87],v[32:35]
ds_read_b128 v[108:111],v7 offset:6144
v_mfma_f32_16x16x32_bf16 v[36:39],a[172:175],v[84:87],v[36:39]
s_waitcnt lgkmcnt(5)
s_add_u32 s61,s61,114688
s_add_u32 s62,s62,114688
v_mfma_f32_16x16x32_bf16 v[32:35],a[176:179],v[88:91],v[32:35]
s_add_u32 s70,s70,32768
s_and_b32 s70,s70,0x1ffff
s_add_u32 s55,s55,32768
v_mfma_f32_16x16x32_bf16 v[36:39],a[180:183],v[88:91],v[36:39]
s_waitcnt lgkmcnt(4)
s_and_b32 s55,s55,0x1ffff
v_add_u32 v4,s55,v8
v_mfma_f32_16x16x32_bf16 v[32:35],a[184:187],v[92:95],v[32:35]
v_add_u32 v5,s55,v9
v_add_u32 v6,s55,v10
v_mfma_f32_16x16x32_bf16 v[36:39],a[188:191],v[92:95],v[36:39]
s_waitcnt lgkmcnt(3)
v_add_u32 v7,s55,v11
v_mfma_f32_16x16x32_bf16 v[32:35],a[192:195],v[96:99],v[32:35]
s_waitcnt vmcnt(7)
ds_read_b128 v[64:67],v4 offset:0
v_mfma_f32_16x16x32_bf16 v[36:39],a[196:199],v[96:99],v[36:39]
s_waitcnt lgkmcnt(3)
s_waitcnt vmcnt(6)
ds_read_b128 v[68:71],v4 offset:1024
v_mfma_f32_16x16x32_bf16 v[32:35],a[200:203],v[100:103],v[32:35]
s_waitcnt vmcnt(5)
ds_read_b128 v[72:75],v4 offset:2048
v_mfma_f32_16x16x32_bf16 v[36:39],a[204:207],v[100:103],v[36:39]
s_waitcnt lgkmcnt(4)
v_mfma_f32_16x16x32_bf16 v[32:35],a[208:211],v[104:107],v[32:35]
v_mfma_f32_16x16x32_bf16 v[36:39],a[212:215],v[104:107],v[36:39]
s_waitcnt lgkmcnt(3)
v_mfma_f32_16x16x32_bf16 v[40:43],a[216:219],v[108:111],v[32:35]
v_mfma_f32_16x16x32_bf16 v[44:47],a[220:223],v[108:111],v[36:39]
s_waitcnt vmcnt(1)
v_cmp_gt_u32 vcc,s53,v16
s_add_u32 s60,s60,1
s_cbranch_vccnz WN_197
.p2align 6
WR_196:
s_waitcnt lgkmcnt(2)
v_mfma_f32_16x16x32_bf16 v[32:35],a[0:3],v[64:67],0
s_waitcnt vmcnt(4)
s_add_u32 s71,s60,2
ds_read_b128 v[76:79],v4 offset:3072
v_mfma_f32_16x16x32_bf16 v[36:39],a[4:7],v[64:67],0
s_waitcnt lgkmcnt(2)
s_add_u32 s53,s60,3
v_mfma_f32_16x16x32_bf16 v[32:35],a[8:11],v[68:71],v[32:35]
s_waitcnt vmcnt(3)
s_mov_b32 m0,s70
ds_read_b128 v[80:83],v4 offset:4096
v_mfma_f32_16x16x32_bf16 v[36:39],a[12:15],v[68:71],v[36:39]
s_waitcnt lgkmcnt(2)
buffer_load_dwordx4 v3,s[20:23],s61 offen offset:0 lds
s_add_u32 s64,s74,s75
s_cmp_eq_u32 s56,1
s_cbranch_scc1 b1_205
buffer_store_dwordx4 v[40:43],v0,s[20:23],s64 offen offset:0
buffer_store_dwordx4 v[44:47],v0,s[20:23],s64 offen offset:1024
b2_206:
v_mfma_f32_16x16x32_bf16 v[32:35],a[16:19],v[72:75],v[32:35]
s_waitcnt vmcnt(5)
s_add_u32 s75,s75,6144
ds_read_b128 v[84:87],v4 offset:5120
v_mfma_f32_16x16x32_bf16 v[36:39],a[20:23],v[72:75],v[36:39]
s_waitcnt lgkmcnt(2)
s_cmp_eq_u32 s75,24576
s_cselect_b32 s75,0,s75
v_mfma_f32_16x16x32_bf16 v[32:35],a[24:27],v[76:79],v[32:35]
s_waitcnt vmcnt(3)
ds_read_b128 v[88:91],v4 offset:6144
buffer_load_dwordx4 v3,s[20:23],s61 offen offset:1024 lds
v_mfma_f32_16x16x32_bf16 v[36:39],a[28:31],v[76:79],v[36:39]
s_waitcnt lgkmcnt(2)
s_barrier
ds_read_b128 v[92:95],v5 offset:0
v_mfma_f32_16x16x32_bf16 v[32:35],a[32:35],v[80:83],v[32:35]
ds_read_b128 v[96:99],v5 offset:1024
v_mfma_f32_16x16x32_bf16 v[36:39],a[36:39],v[80:83],v[36:39]
s_waitcnt lgkmcnt(3)
ds_read_b128 v[100:103],v5 offset:2048
buffer_load_dwordx4 v3,s[20:23],s61 offen offset:2048 lds
v_mfma_f32_16x16x32_bf16 v[32:35],a[40:43],v[84:87],v[32:35]
ds_read_b128 v[104:107],v5 offset:3072
v_mfma_f32_16x16x32_bf16 v[36:39],a[44:47],v[84:87],v[36:39]
s_waitcnt lgkmcnt(4)
ds_read_b128 v[108:111],v5 offset:4096
v_mfma_f32_16x16x32_bf16 v[32:35],a[48:51],v[88:91],v[32:35]
ds_read_b128 v[112:115],v5 offset:5120
buffer_load_dwordx4 v3,s[20:23],s61 offen offset:3072 lds
v_mfma_f32_16x16x32_bf16 v[36:39],a[52:55],v[88:91],v[36:39]
s_waitcnt lgkmcnt(5)
v_mfma_f32_16x16x32_bf16 v[32:35],a[56:59],v[92:95],v[32:35]
ds_read_b128 v[116:119],v5 offset:6144
v_mfma_f32_16x16x32_bf16 v[36:39],a[60:63],v[92:95],v[36:39]
s_waitcnt lgkmcnt(5)
s_add_u32 m0,s70,4096
v_mfma_f32_16x16x32_bf16 v[32:35],a[64:67],v[96:99],v[32:35]
ds_read_b128 v[120:123],v6 offset:0
buffer_load_dwordx4 v3,s[20:23],s62 offen offset:0 lds
v_mfma_f32_16x16x32_bf16 v[36:39],a[68:71],v[96:99],v[36:39]
s_waitcnt lgkmcnt(5)
v_mfma_f32_16x16x32_bf16 v[32:35],a[72:75],v[100:103],v[32:35]
ds_read_b128 v[124:127],v6 offset:1024
v_mfma_f32_16x16x32_bf16 v[36:39],a[76:79],v[100:103],v[36:39]
s_waitcnt lgkmcnt(5)
buffer_load_dwordx4 v3,s[20:23],s62 offen offset:1024 lds
v_mfma_f32_16x16x32_bf16 v[32:35],a[80:83],v[104:107],v[32:35]
ds_read_b128 v[64:67],v6 offset:2048
v_mfma_f32_16x16x32_bf16 v[36:39],a[84:87],v[104:107],v[36:39]
s_waitcnt lgkmcnt(5)
buffer_load_dword v16,v2,s[20:23],s68 offen sc1
v_mfma_f32_16x16x32_bf16 v[32:35],a[88:91],v[108:111],v[32:35]
ds_read_b128 v[68:71],v6 offset:3072
buffer_load_dwordx4 v3,s[20:23],s62 offen offset:2048 lds
v_mfma_f32_16x16x32_bf16 v[36:39],a[92:95],v[108:111],v[36:39]
s_waitcnt lgkmcnt(5)
v_mfma_f32_16x16x32_bf16 v[32:35],a[96:99],v[112:115],v[32:35]
ds_read_b128 v[72:75],v6 offset:4096
v_mfma_f32_16x16x32_bf16 v[36:39],a[100:103],v[112:115],v[36:39]
s_waitcnt lgkmcnt(5)
v_mfma_f32_16x16x32_bf16 v[32:35],a[104:107],v[116:119],v[32:35]
ds_read_b128 v[76:79],v6 offset:5120
v_mfma_f32_16x16x32_bf16 v[36:39],a[108:111],v[116:119],v[36:39]
s_waitcnt lgkmcnt(5)
v_mfma_f32_16x16x32_bf16 v[32:35],a[112:115],v[120:123],v[32:35]
ds_read_b128 v[80:83],v6 offset:6144
v_mfma_f32_16x16x32_bf16 v[36:39],a[116:119],v[120:123],v[36:39]
s_waitcnt lgkmcnt(5)
v_mfma_f32_16x16x32_bf16 v[32:35],a[120:123],v[124:127],v[32:35]
ds_read_b128 v[84:87],v7 offset:0
v_mfma_f32_16x16x32_bf16 v[36:39],a[124:127],v[124:127],v[36:39]
s_waitcnt lgkmcnt(5)
v_mfma_f32_16x16x32_bf16 v[32:35],a[128:131],v[64:67],v[32:35]
ds_read_b128 v[88:91],v7 offset:1024
v_mfma_f32_16x16x32_bf16 v[36:39],a[132:135],v[64:67],v[36:39]
s_waitcnt lgkmcnt(5)
v_mfma_f32_16x16x32_bf16 v[32:35],a[136:139],v[68:71],v[32:35]
ds_read_b128 v[92:95],v7 offset:2048
v_mfma_f32_16x16x32_bf16 v[36:39],a[140:143],v[68:71],v[36:39]
s_waitcnt lgkmcnt(5)
v_mfma_f32_16x16x32_bf16 v[32:35],a[144:147],v[72:75],v[32:35]
ds_read_b128 v[96:99],v7 offset:3072
v_mfma_f32_16x16x32_bf16 v[36:39],a[148:151],v[72:75],v[36:39]
s_waitcnt lgkmcnt(5)
v_mfma_f32_16x16x32_bf16 v[32:35],a[152:155],v[76:79],v[32:35]
ds_read_b128 v[100:103],v7 offset:4096
v_mfma_f32_16x16x32_bf16 v[36:39],a[156:159],v[76:79],v[36:39]
s_waitcnt lgkmcnt(5)
v_mfma_f32_16x16x32_bf16 v[32:35],a[160:163],v[80:83],v[32:35]
ds_read_b128 v[104:107],v7 offset:5120
v_mfma_f32_16x16x32_bf16 v[36:39],a[164:167],v[80:83],v[36:39]
s_waitcnt lgkmcnt(5)
v_mfma_f32_16x16x32_bf16 v[32:35],a[168:171],v[84:87],v[32:35]
ds_read_b128 v[108:111],v7 offset:6144
v_mfma_f32_16x16x32_bf16 v[36:39],a[172:175],v[84:87],v[36:39]
s_waitcnt lgkmcnt(5)
s_add_u32 s61,s61,114688
s_add_u32 s62,s62,114688
v_mfma_f32_16x16x32_bf16 v[32:35],a[176:179],v[88:91],v[32:35]
s_add_u32 s70,s70,32768
s_and_b32 s70,s70,0x1ffff
s_add_u32 s55,s55,32768
v_mfma_f32_16x16x32_bf16 v[36:39],a[180:183],v[88:91],v[36:39]
s_waitcnt lgkmcnt(4)
s_and_b32 s55,s55,0x1ffff
v_add_u32 v4,s55,v8
v_mfma_f32_16x16x32_bf16 v[32:35],a[184:187],v[92:95],v[32:35]
v_add_u32 v5,s55,v9
v_add_u32 v6,s55,v10
v_mfma_f32_16x16x32_bf16 v[36:39],a[188:191],v[92:95],v[36:39]
s_waitcnt lgkmcnt(3)
v_add_u32 v7,s55,v11
v_mfma_f32_16x16x32_bf16 v[32:35],a[192:195],v[96:99],v[32:35]
s_waitcnt vmcnt(9)
ds_read_b128 v[64:67],v4 offset:0
v_mfma_f32_16x16x32_bf16 v[36:39],a[196:199],v[96:99],v[36:39]
s_waitcnt lgkmcnt(3)
s_waitcnt vmcnt(6)
ds_read_b128 v[68:71],v4 offset:1024
v_mfma_f32_16x16x32_bf16 v[32:35],a[200:203],v[100:103],v[32:35]
s_waitcnt vmcnt(5)
ds_read_b128 v[72:75],v4 offset:2048
v_mfma_f32_16x16x32_bf16 v[36:39],a[204:207],v[100:103],v[36:39]
s_waitcnt lgkmcnt(4)
v_mfma_f32_16x16x32_bf16 v[32:35],a[208:211],v[104:107],v[32:35]
v_mfma_f32_16x16x32_bf16 v[36:39],a[212:215],v[104:107],v[36:39]
s_waitcnt lgkmcnt(3)
v_mfma_f32_16x16x32_bf16 v[40:43],a[216:219],v[108:111],v[32:35]
v_mfma_f32_16x16x32_bf16 v[44:47],a[220:223],v[108:111],v[36:39]
s_waitcnt vmcnt(1)
v_cmp_gt_u32 vcc,s53,v16
s_add_u32 s60,s60,1
s_cbranch_vccz WR_196
WN_197:
s_waitcnt lgkmcnt(2)
v_mfma_f32_16x16x32_bf16 v[32:35],a[0:3],v[64:67],0
s_waitcnt vmcnt(4)
s_add_u32 s71,s60,2
ds_read_b128 v[76:79],v4 offset:3072
v_mfma_f32_16x16x32_bf16 v[36:39],a[4:7],v[64:67],0
s_waitcnt lgkmcnt(2)
s_add_u32 s53,s60,3
v_mfma_f32_16x16x32_bf16 v[32:35],a[8:11],v[68:71],v[32:35]
s_waitcnt vmcnt(3)
ds_read_b128 v[80:83],v4 offset:4096
v_mfma_f32_16x16x32_bf16 v[36:39],a[12:15],v[68:71],v[36:39]
s_waitcnt lgkmcnt(2)
s_add_u32 s64,s74,s75
s_cmp_eq_u32 s56,1
s_cbranch_scc1 b1_208
buffer_store_dwordx4 v[40:43],v0,s[20:23],s64 offen offset:0
buffer_store_dwordx4 v[44:47],v0,s[20:23],s64 offen offset:1024
b2_209:
v_mfma_f32_16x16x32_bf16 v[32:35],a[16:19],v[72:75],v[32:35]
s_waitcnt vmcnt(4)
s_add_u32 s75,s75,6144
ds_read_b128 v[84:87],v4 offset:5120
v_mfma_f32_16x16x32_bf16 v[36:39],a[20:23],v[72:75],v[36:39]
s_waitcnt lgkmcnt(2)
s_cmp_eq_u32 s75,24576
s_cselect_b32 s75,0,s75
v_mfma_f32_16x16x32_bf16 v[32:35],a[24:27],v[76:79],v[32:35]
s_waitcnt vmcnt(2)
ds_read_b128 v[88:91],v4 offset:6144
v_mfma_f32_16x16x32_bf16 v[36:39],a[28:31],v[76:79],v[36:39]
s_waitcnt lgkmcnt(2)
s_barrier
ds_read_b128 v[92:95],v5 offset:0
v_mfma_f32_16x16x32_bf16 v[32:35],a[32:35],v[80:83],v[32:35]
ds_read_b128 v[96:99],v5 offset:1024
v_mfma_f32_16x16x32_bf16 v[36:39],a[36:39],v[80:83],v[36:39]
s_waitcnt lgkmcnt(3)
ds_read_b128 v[100:103],v5 offset:2048
v_mfma_f32_16x16x32_bf16 v[32:35],a[40:43],v[84:87],v[32:35]
ds_read_b128 v[104:107],v5 offset:3072
v_mfma_f32_16x16x32_bf16 v[36:39],a[44:47],v[84:87],v[36:39]
s_waitcnt lgkmcnt(4)
ds_read_b128 v[108:111],v5 offset:4096
v_mfma_f32_16x16x32_bf16 v[32:35],a[48:51],v[88:91],v[32:35]
ds_read_b128 v[112:115],v5 offset:5120
v_mfma_f32_16x16x32_bf16 v[36:39],a[52:55],v[88:91],v[36:39]
s_waitcnt lgkmcnt(5)
v_mfma_f32_16x16x32_bf16 v[32:35],a[56:59],v[92:95],v[32:35]
ds_read_b128 v[116:119],v5 offset:6144
v_mfma_f32_16x16x32_bf16 v[36:39],a[60:63],v[92:95],v[36:39]
s_waitcnt lgkmcnt(5)
v_mfma_f32_16x16x32_bf16 v[32:35],a[64:67],v[96:99],v[32:35]
ds_read_b128 v[120:123],v6 offset:0
v_mfma_f32_16x16x32_bf16 v[36:39],a[68:71],v[96:99],v[36:39]
s_waitcnt lgkmcnt(5)
v_mfma_f32_16x16x32_bf16 v[32:35],a[72:75],v[100:103],v[32:35]
ds_read_b128 v[124:127],v6 offset:1024
v_mfma_f32_16x16x32_bf16 v[36:39],a[76:79],v[100:103],v[36:39]
s_waitcnt lgkmcnt(5)
v_mfma_f32_16x16x32_bf16 v[32:35],a[80:83],v[104:107],v[32:35]
ds_read_b128 v[64:67],v6 offset:2048
v_mfma_f32_16x16x32_bf16 v[36:39],a[84:87],v[104:107],v[36:39]
s_waitcnt lgkmcnt(5)
v_mfma_f32_16x16x32_bf16 v[32:35],a[88:91],v[108:111],v[32:35]
ds_read_b128 v[68:71],v6 offset:3072
v_mfma_f32_16x16x32_bf16 v[36:39],a[92:95],v[108:111],v[36:39]
s_waitcnt lgkmcnt(5)
v_mfma_f32_16x16x32_bf16 v[32:35],a[96:99],v[112:115],v[32:35]
ds_read_b128 v[72:75],v6 offset:4096
v_mfma_f32_16x16x32_bf16 v[36:39],a[100:103],v[112:115],v[36:39]
s_waitcnt lgkmcnt(5)
v_mfma_f32_16x16x32_bf16 v[32:35],a[104:107],v[116:119],v[32:35]
ds_read_b128 v[76:79],v6 offset:5120
v_mfma_f32_16x16x32_bf16 v[36:39],a[108:111],v[116:119],v[36:39]
s_waitcnt lgkmcnt(5)
v_mfma_f32_16x16x32_bf16 v[32:35],a[112:115],v[120:123],v[32:35]
ds_read_b128 v[80:83],v6 offset:6144
v_mfma_f32_16x16x32_bf16 v[36:39],a[116:119],v[120:123],v[36:39]
s_waitcnt lgkmcnt(5)
v_mfma_f32_16x16x32_bf16 v[32:35],a[120:123],v[124:127],v[32:35]
ds_read_b128 v[84:87],v7 offset:0
v_mfma_f32_16x16x32_bf16 v[36:39],a[124:127],v[124:127],v[36:39]
s_waitcnt lgkmcnt(5)
v_mfma_f32_16x16x32_bf16 v[32:35],a[128:131],v[64:67],v[32:35]
ds_read_b128 v[88:91],v7 offset:1024
v_mfma_f32_16x16x32_bf16 v[36:39],a[132:135],v[64:67],v[36:39]
s_waitcnt lgkmcnt(5)
v_mfma_f32_16x16x32_bf16 v[32:35],a[136:139],v[68:71],v[32:35]
ds_read_b128 v[92:95],v7 offset:2048
v_mfma_f32_16x16x32_bf16 v[36:39],a[140:143],v[68:71],v[36:39]
s_waitcnt lgkmcnt(5)
buffer_load_dword v16,v2,s[20:23],s68 offen sc1
v_mfma_f32_16x16x32_bf16 v[32:35],a[144:147],v[72:75],v[32:35]
ds_read_b128 v[96:99],v7 offset:3072
v_mfma_f32_16x16x32_bf16 v[36:39],a[148:151],v[72:75],v[36:39]
s_waitcnt lgkmcnt(5)
v_mfma_f32_16x16x32_bf16 v[32:35],a[152:155],v[76:79],v[32:35]
ds_read_b128 v[100:103],v7 offset:4096
v_mfma_f32_16x16x32_bf16 v[36:39],a[156:159],v[76:79],v[36:39]
s_waitcnt lgkmcnt(5)
v_mfma_f32_16x16x32_bf16 v[32:35],a[160:163],v[80:83],v[32:35]
ds_read_b128 v[104:107],v7 offset:5120
v_mfma_f32_16x16x32_bf16 v[36:39],a[164:167],v[80:83],v[36:39]
s_waitcnt lgkmcnt(5)
v_mfma_f32_16x16x32_bf16 v[32:35],a[168:171],v[84:87],v[32:35]
ds_read_b128 v[108:111],v7 offset:6144
v_mfma_f32_16x16x32_bf16 v[36:39],a[172:175],v[84:87],v[36:39]
s_waitcnt lgkmcnt(5)
s_add_u32 s55,s55,32768
s_and_b32 s55,s55,0x1ffff
v_mfma_f32_16x16x32_bf16 v[32:35],a[176:179],v[88:91],v[32:35]
v_add_u32 v4,s55,v8
v_add_u32 v5,s55,v9
v_mfma_f32_16x16x32_bf16 v[36:39],a[180:183],v[88:91],v[36:39]
s_waitcnt lgkmcnt(4)
v_add_u32 v6,s55,v10
v_add_u32 v7,s55,v11
v_mfma_f32_16x16x32_bf16 v[32:35],a[184:187],v[92:95],v[32:35]
v_mfma_f32_16x16x32_bf16 v[36:39],a[188:191],v[92:95],v[36:39]
s_waitcnt lgkmcnt(3)
v_mfma_f32_16x16x32_bf16 v[32:35],a[192:195],v[96:99],v[32:35]
v_mfma_f32_16x16x32_bf16 v[36:39],a[196:199],v[96:99],v[36:39]
s_waitcnt lgkmcnt(2)
v_mfma_f32_16x16x32_bf16 v[32:35],a[200:203],v[100:103],v[32:35]
v_mfma_f32_16x16x32_bf16 v[36:39],a[204:207],v[100:103],v[36:39]
s_waitcnt lgkmcnt(1)
v_mfma_f32_16x16x32_bf16 v[32:35],a[208:211],v[104:107],v[32:35]
v_mfma_f32_16x16x32_bf16 v[36:39],a[212:215],v[104:107],v[36:39]
s_waitcnt lgkmcnt(0)
v_mfma_f32_16x16x32_bf16 v[40:43],a[216:219],v[108:111],v[32:35]
v_mfma_f32_16x16x32_bf16 v[44:47],a[220:223],v[108:111],v[36:39]
s_waitcnt vmcnt(0)
v_cmp_gt_u32 vcc,s71,v16
s_add_u32 s60,s60,1
s_branch endN_207
BN_199:
s_waitcnt vmcnt(8)
ds_read_b128 v[64:67],v4 offset:0
s_waitcnt vmcnt(7)
ds_read_b128 v[68:71],v4 offset:1024
s_waitcnt vmcnt(6)
ds_read_b128 v[72:75],v4 offset:2048
s_waitcnt vmcnt(5)
ds_read_b128 v[76:79],v4 offset:3072
s_waitcnt lgkmcnt(3)
v_mfma_f32_16x16x32_bf16 v[32:35],a[0:3],v[64:67],0
s_add_u32 s71,s60,2
s_add_u32 s53,s60,3
v_mfma_f32_16x16x32_bf16 v[36:39],a[4:7],v[64:67],0
s_waitcnt lgkmcnt(2)
s_waitcnt vmcnt(4)
ds_read_b128 v[80:83],v4 offset:4096
v_mfma_f32_16x16x32_bf16 v[32:35],a[8:11],v[68:71],v[32:35]
v_mfma_f32_16x16x32_bf16 v[36:39],a[12:15],v[68:71],v[36:39]
s_waitcnt lgkmcnt(2)
s_waitcnt vmcnt(3)
ds_read_b128 v[84:87],v4 offset:5120
v_mfma_f32_16x16x32_bf16 v[32:35],a[16:19],v[72:75],v[32:35]
v_mfma_f32_16x16x32_bf16 v[36:39],a[20:23],v[72:75],v[36:39]
s_waitcnt lgkmcnt(2)
s_waitcnt vmcnt(2)
ds_read_b128 v[88:91],v4 offset:6144
v_mfma_f32_16x16x32_bf16 v[32:35],a[24:27],v[76:79],v[32:35]
v_mfma_f32_16x16x32_bf16 v[36:39],a[28:31],v[76:79],v[36:39]
s_waitcnt lgkmcnt(2)
s_barrier
ds_read_b128 v[92:95],v5 offset:0
v_mfma_f32_16x16x32_bf16 v[32:35],a[32:35],v[80:83],v[32:35]
ds_read_b128 v[96:99],v5 offset:1024
v_mfma_f32_16x16x32_bf16 v[36:39],a[36:39],v[80:83],v[36:39]
s_waitcnt lgkmcnt(3)
ds_read_b128 v[100:103],v5 offset:2048
v_mfma_f32_16x16x32_bf16 v[32:35],a[40:43],v[84:87],v[32:35]
ds_read_b128 v[104:107],v5 offset:3072
v_mfma_f32_16x16x32_bf16 v[36:39],a[44:47],v[84:87],v[36:39]
s_waitcnt lgkmcnt(4)
ds_read_b128 v[108:111],v5 offset:4096
v_mfma_f32_16x16x32_bf16 v[32:35],a[48:51],v[88:91],v[32:35]
ds_read_b128 v[112:115],v5 offset:5120
v_mfma_f32_16x16x32_bf16 v[36:39],a[52:55],v[88:91],v[36:39]
s_waitcnt lgkmcnt(5)
v_mfma_f32_16x16x32_bf16 v[32:35],a[56:59],v[92:95],v[32:35]
ds_read_b128 v[116:119],v5 offset:6144
v_mfma_f32_16x16x32_bf16 v[36:39],a[60:63],v[92:95],v[36:39]
s_waitcnt lgkmcnt(5)
v_mfma_f32_16x16x32_bf16 v[32:35],a[64:67],v[96:99],v[32:35]
ds_read_b128 v[120:123],v6 offset:0
v_mfma_f32_16x16x32_bf16 v[36:39],a[68:71],v[96:99],v[36:39]
s_waitcnt lgkmcnt(5)
v_mfma_f32_16x16x32_bf16 v[32:35],a[72:75],v[100:103],v[32:35]
ds_read_b128 v[124:127],v6 offset:1024
v_mfma_f32_16x16x32_bf16 v[36:39],a[76:79],v[100:103],v[36:39]
s_waitcnt lgkmcnt(5)
v_mfma_f32_16x16x32_bf16 v[32:35],a[80:83],v[104:107],v[32:35]
ds_read_b128 v[64:67],v6 offset:2048
v_mfma_f32_16x16x32_bf16 v[36:39],a[84:87],v[104:107],v[36:39]
s_waitcnt lgkmcnt(5)
v_mfma_f32_16x16x32_bf16 v[32:35],a[88:91],v[108:111],v[32:35]
ds_read_b128 v[68:71],v6 offset:3072
v_mfma_f32_16x16x32_bf16 v[36:39],a[92:95],v[108:111],v[36:39]
s_waitcnt lgkmcnt(5)
v_mfma_f32_16x16x32_bf16 v[32:35],a[96:99],v[112:115],v[32:35]
ds_read_b128 v[72:75],v6 offset:4096
v_mfma_f32_16x16x32_bf16 v[36:39],a[100:103],v[112:115],v[36:39]
s_waitcnt lgkmcnt(5)
v_mfma_f32_16x16x32_bf16 v[32:35],a[104:107],v[116:119],v[32:35]
ds_read_b128 v[76:79],v6 offset:5120
v_mfma_f32_16x16x32_bf16 v[36:39],a[108:111],v[116:119],v[36:39]
s_waitcnt lgkmcnt(5)
v_mfma_f32_16x16x32_bf16 v[32:35],a[112:115],v[120:123],v[32:35]
ds_read_b128 v[80:83],v6 offset:6144
v_mfma_f32_16x16x32_bf16 v[36:39],a[116:119],v[120:123],v[36:39]
s_waitcnt lgkmcnt(5)
v_mfma_f32_16x16x32_bf16 v[32:35],a[120:123],v[124:127],v[32:35]
ds_read_b128 v[84:87],v7 offset:0
v_mfma_f32_16x16x32_bf16 v[36:39],a[124:127],v[124:127],v[36:39]
s_waitcnt lgkmcnt(5)
v_mfma_f32_16x16x32_bf16 v[32:35],a[128:131],v[64:67],v[32:35]
ds_read_b128 v[88:91],v7 offset:1024
v_mfma_f32_16x16x32_bf16 v[36:39],a[132:135],v[64:67],v[36:39]
s_waitcnt lgkmcnt(5)
v_mfma_f32_16x16x32_bf16 v[32:35],a[136:139],v[68:71],v[32:35]
ds_read_b128 v[92:95],v7 offset:2048
v_mfma_f32_16x16x32_bf16 v[36:39],a[140:143],v[68:71],v[36:39]
s_waitcnt lgkmcnt(5)
buffer_load_dword v16,v2,s[20:23],s68 offen sc1
v_mfma_f32_16x16x32_bf16 v[32:35],a[144:147],v[72:75],v[32:35]
ds_read_b128 v[96:99],v7 offset:3072
v_mfma_f32_16x16x32_bf16 v[36:39],a[148:151],v[72:75],v[36:39]
s_waitcnt lgkmcnt(5)
v_mfma_f32_16x16x32_bf16 v[32:35],a[152:155],v[76:79],v[32:35]
ds_read_b128 v[100:103],v7 offset:4096
v_mfma_f32_16x16x32_bf16 v[36:39],a[156:159],v[76:79],v[36:39]
s_waitcnt lgkmcnt(5)
v_mfma_f32_16x16x32_bf16 v[32:35],a[160:163],v[80:83],v[32:35]
ds_read_b128 v[104:107],v7 offset:5120
v_mfma_f32_16x16x32_bf16 v[36:39],a[164:167],v[80:83],v[36:39]
s_waitcnt lgkmcnt(5)
v_mfma_f32_16x16x32_bf16 v[32:35],a[168:171],v[84:87],v[32:35]
ds_read_b128 v[108:111],v7 offset:6144
v_mfma_f32_16x16x32_bf16 v[36:39],a[172:175],v[84:87],v[36:39]
s_waitcnt lgkmcnt(5)
s_add_u32 s55,s55,32768
s_and_b32 s55,s55,0x1ffff
v_mfma_f32_16x16x32_bf16 v[32:35],a[176:179],v[88:91],v[32:35]
v_add_u32 v4,s55,v8
v_add_u32 v5,s55,v9
v_mfma_f32_16x16x32_bf16 v[36:39],a[180:183],v[88:91],v[36:39]
s_waitcnt lgkmcnt(4)
v_add_u32 v6,s55,v10
v_add_u32 v7,s55,v11
v_mfma_f32_16x16x32_bf16 v[32:35],a[184:187],v[92:95],v[32:35]
v_mfma_f32_16x16x32_bf16 v[36:39],a[188:191],v[92:95],v[36:39]
s_waitcnt lgkmcnt(3)
v_mfma_f32_16x16x32_bf16 v[32:35],a[192:195],v[96:99],v[32:35]
v_mfma_f32_16x16x32_bf16 v[36:39],a[196:199],v[96:99],v[36:39]
s_waitcnt lgkmcnt(2)
v_mfma_f32_16x16x32_bf16 v[32:35],a[200:203],v[100:103],v[32:35]
v_mfma_f32_16x16x32_bf16 v[36:39],a[204:207],v[100:103],v[36:39]
s_waitcnt lgkmcnt(1)
v_mfma_f32_16x16x32_bf16 v[32:35],a[208:211],v[104:107],v[32:35]
v_mfma_f32_16x16x32_bf16 v[36:39],a[212:215],v[104:107],v[36:39]
s_waitcnt lgkmcnt(0)
v_mfma_f32_16x16x32_bf16 v[40:43],a[216:219],v[108:111],v[32:35]
v_mfma_f32_16x16x32_bf16 v[44:47],a[220:223],v[108:111],v[36:39]
s_waitcnt vmcnt(0)
v_cmp_gt_u32 vcc,s71,v16
s_add_u32 s60,s60,1
endN_207:
s_cbranch_vccnz nb_202
s_mov_b32 m0,s70
s_nop 0
buffer_load_dwordx4 v3,s[20:23],s61 offen offset:0 lds
buffer_load_dwordx4 v3,s[20:23],s61 offen offset:1024 lds
buffer_load_dwordx4 v3,s[20:23],s61 offen offset:2048 lds
buffer_load_dwordx4 v3,s[20:23],s61 offen offset:3072 lds
s_add_u32 m0,s70,4096
s_nop 0
buffer_load_dwordx4 v3,s[20:23],s62 offen offset:0 lds
buffer_load_dwordx4 v3,s[20:23],s62 offen offset:1024 lds
buffer_load_dwordx4 v3,s[20:23],s62 offen offset:2048 lds
s_add_u32 s61,s61,114688
s_add_u32 s62,s62,114688
s_add_u32 s70,s70,32768
s_and_b32 s70,s70,0x1ffff
s_add_u32 s64,s74,s75
s_cmp_eq_u32 s56,1
s_cbranch_scc1 b1_210
buffer_store_dwordx4 v[40:43],v0,s[20:23],s64 offen offset:0
buffer_store_dwordx4 v[44:47],v0,s[20:23],s64 offen offset:1024
b2_211:
s_add_u32 s75,s75,6144
s_cmp_eq_u32 s75,24576
s_cselect_b32 s75,0,s75
s_branch dec_201
nb_202:
buffer_load_dword v16,v2,s[20:23],s68 offen sc1
s_nop 3
s_add_u32 s64,s74,s75
s_cmp_eq_u32 s56,1
s_cbranch_scc1 b1_212
buffer_store_dwordx4 v[40:43],v0,s[20:23],s64 offen offset:0
buffer_store_dwordx4 v[44:47],v0,s[20:23],s64 offen offset:1024
b2_213:
s_add_u32 s75,s75,6144
s_cmp_eq_u32 s75,24576
s_cselect_b32 s75,0,s75
s_waitcnt vmcnt(2)
v_cmp_gt_u32 vcc,s71,v16
s_cbranch_vccz lag_200
s_cmp_ge_u32 s60,128
s_cbranch_scc1 done_180
plp_216:
buffer_load_dword v16,v2,s[20:23],s68 offen sc1
s_waitcnt vmcnt(0)
v_cmp_gt_u32 vcc,s71,v16
s_cbranch_vccz pok_217
s_sleep 4
s_sub_u32 s90,s90,1
s_cmp_gt_i32 s90,0
s_cbranch_scc1 plp_216
pok_217:
s_branch lag_200
lfin_193:
s_add_u32 s71,s60,1
s_add_u32 s53,s60,2
plp_237:
buffer_load_dword v16,v2,s[20:23],s68 offen sc1
s_waitcnt vmcnt(0)
v_cmp_gt_u32 vcc,s71,v16
s_cbranch_vccz pok_238
s_sleep 4
s_sub_u32 s90,s90,1
s_cmp_gt_i32 s90,0
s_cbranch_scc1 plp_237
pok_238:
lag_234:
s_mov_b32 m0,s70
s_nop 0
buffer_load_dwordx4 v3,s[20:23],s61 offen offset:0 lds
buffer_load_dwordx4 v3,s[20:23],s61 offen offset:1024 lds
buffer_load_dwordx4 v3,s[20:23],s61 offen offset:2048 lds
buffer_load_dwordx4 v3,s[20:23],s61 offen offset:3072 lds
s_add_u32 m0,s70,4096
s_nop 0
buffer_load_dwordx4 v3,s[20:23],s62 offen offset:0 lds
buffer_load_dwordx4 v3,s[20:23],s62 offen offset:1024 lds
buffer_load_dwordx4 v3,s[20:23],s62 offen offset:2048 lds
s_add_u32 s61,s61,114688
s_add_u32 s62,s62,114688
s_add_u32 s70,s70,32768
s_and_b32 s70,s70,0x1ffff
dec_235:
v_cmp_gt_u32 vcc,s53,v16
s_cbranch_vccnz BN_233
BR_232:
s_waitcnt vmcnt(6)
ds_read_b128 v[64:67],v4 offset:0
s_waitcnt vmcnt(5)
ds_read_b128 v[68:71],v4 offset:1024
s_waitcnt vmcnt(4)
ds_read_b128 v[72:75],v4 offset:2048
s_waitcnt vmcnt(3)
ds_read_b128 v[76:79],v4 offset:3072
s_waitcnt lgkmcnt(3)
v_mfma_f32_16x16x32_bf16 v[32:35],a[0:3],v[64:67],0
s_add_u32 s71,s60,2
s_add_u32 s53,s60,3
v_mfma_f32_16x16x32_bf16 v[36:39],a[4:7],v[64:67],0
s_waitcnt lgkmcnt(2)
s_waitcnt vmcnt(2)
ds_read_b128 v[80:83],v4 offset:4096
v_mfma_f32_16x16x32_bf16 v[32:35],a[8:11],v[68:71],v[32:35]
v_mfma_f32_16x16x32_bf16 v[36:39],a[12:15],v[68:71],v[36:39]
s_waitcnt lgkmcnt(2)
s_waitcnt vmcnt(1)
s_mov_b32 m0,s70
ds_read_b128 v[84:87],v4 offset:5120
v_mfma_f32_16x16x32_bf16 v[32:35],a[16:19],v[72:75],v[32:35]
buffer_load_dwordx4 v3,s[20:23],s61 offen offset:0 lds
v_mfma_f32_16x16x32_bf16 v[36:39],a[20:23],v[72:75],v[36:39]
s_waitcnt lgkmcnt(2)
s_waitcnt vmcnt(1)
ds_read_b128 v[88:91],v4 offset:6144
v_mfma_f32_16x16x32_bf16 v[32:35],a[24:27],v[76:79],v[32:35]
buffer_load_dwordx4 v3,s[20:23],s61 offen offset:1024 lds
v_mfma_f32_16x16x32_bf16 v[36:39],a[28:31],v[76:79],v[36:39]
s_waitcnt lgkmcnt(2)
s_barrier
ds_read_b128 v[92:95],v5 offset:0
v_mfma_f32_16x16x32_bf16 v[32:35],a[32:35],v[80:83],v[32:35]
ds_read_b128 v[96:99],v5 offset:1024
v_mfma_f32_16x16x32_bf16 v[36:39],a[36:39],v[80:83],v[36:39]
s_waitcnt lgkmcnt(3)
ds_read_b128 v[100:103],v5 offset:2048
buffer_load_dwordx4 v3,s[20:23],s61 offen offset:2048 lds
v_mfma_f32_16x16x32_bf16 v[32:35],a[40:43],v[84:87],v[32:35]
ds_read_b128 v[104:107],v5 offset:3072
v_mfma_f32_16x16x32_bf16 v[36:39],a[44:47],v[84:87],v[36:39]
s_waitcnt lgkmcnt(4)
ds_read_b128 v[108:111],v5 offset:4096
v_mfma_f32_16x16x32_bf16 v[32:35],a[48:51],v[88:91],v[32:35]
ds_read_b128 v[112:115],v5 offset:5120
buffer_load_dwordx4 v3,s[20:23],s61 offen offset:3072 lds
v_mfma_f32_16x16x32_bf16 v[36:39],a[52:55],v[88:91],v[36:39]
s_waitcnt lgkmcnt(5)
v_mfma_f32_16x16x32_bf16 v[32:35],a[56:59],v[92:95],v[32:35]
s_cmp_eq_u32 s77,0
s_cselect_b32 s57,2.0,0
ds_read_b128 v[116:119],v5 offset:6144
v_mfma_f32_16x16x32_bf16 v[36:39],a[60:63],v[92:95],v[36:39]
s_waitcnt lgkmcnt(5)
s_add_u32 m0,s70,4096
v_or_b32 v21,s57,v0
v_mfma_f32_16x16x32_bf16 v[32:35],a[64:67],v[96:99],v[32:35]
ds_read_b128 v[120:123],v6 offset:0
buffer_load_dwordx4 v3,s[20:23],s62 offen offset:0 lds
v_mfma_f32_16x16x32_bf16 v[36:39],a[68:71],v[96:99],v[36:39]
s_waitcnt lgkmcnt(5)
v_or_b32 v22,s57,v18
v_lshlrev_b32 v168,16,v160
v_mfma_f32_16x16x32_bf16 v[32:35],a[72:75],v[100:103],v[32:35]
ds_read_b128 v[124:127],v6 offset:1024
v_and_b32 v169,s73,v160
v_mfma_f32_16x16x32_bf16 v[36:39],a[76:79],v[100:103],v[36:39]
s_waitcnt lgkmcnt(5)
buffer_load_dwordx4 v3,s[20:23],s62 offen offset:1024 lds
v_lshlrev_b32 v170,16,v161
v_mfma_f32_16x16x32_bf16 v[32:35],a[80:83],v[104:107],v[32:35]
ds_read_b128 v[64:67],v6 offset:2048
v_and_b32 v171,s73,v161
v_mfma_f32_16x16x32_bf16 v[36:39],a[84:87],v[104:107],v[36:39]
s_waitcnt lgkmcnt(5)
buffer_load_dword v16,v2,s[20:23],s68 offen sc1
v_lshlrev_b32 v172,16,v162
v_mfma_f32_16x16x32_bf16 v[32:35],a[88:91],v[108:111],v[32:35]
ds_read_b128 v[68:71],v6 offset:3072
buffer_load_dwordx4 v3,s[20:23],s62 offen offset:2048 lds
v_mfma_f32_16x16x32_bf16 v[36:39],a[92:95],v[108:111],v[36:39]
s_waitcnt lgkmcnt(5)
v_and_b32 v173,s73,v162
v_lshlrev_b32 v174,16,v163
v_mfma_f32_16x16x32_bf16 v[32:35],a[96:99],v[112:115],v[32:35]
s_add_u32 s84,s74,s75
s_add_u32 s85,s84,4096
ds_read_b128 v[72:75],v6 offset:4096
v_mfma_f32_16x16x32_bf16 v[36:39],a[100:103],v[112:115],v[36:39]
s_waitcnt lgkmcnt(5)
buffer_load_dwordx4 v[128:131],v0,s[20:23],s84 offen offset:0 sc1
v_and_b32 v175,s73,v163
v_mfma_f32_16x16x32_bf16 v[32:35],a[104:107],v[116:119],v[32:35]
ds_read_b128 v[76:79],v6 offset:5120
v_lshlrev_b32 v176,16,v164
v_mfma_f32_16x16x32_bf16 v[36:39],a[108:111],v[116:119],v[36:39]
s_waitcnt lgkmcnt(5)
buffer_load_dwordx4 v[132:135],v0,s[20:23],s84 offen offset:1024 sc1
v_and_b32 v177,s73,v164
v_mfma_f32_16x16x32_bf16 v[32:35],a[112:115],v[120:123],v[32:35]
ds_read_b128 v[80:83],v6 offset:6144
v_lshlrev_b32 v178,16,v165
v_mfma_f32_16x16x32_bf16 v[36:39],a[116:119],v[120:123],v[36:39]
s_waitcnt lgkmcnt(5)
buffer_load_dwordx4 v[136:139],v0,s[20:23],s84 offen offset:2048 sc1
v_and_b32 v179,s73,v165
v_mfma_f32_16x16x32_bf16 v[32:35],a[120:123],v[124:127],v[32:35]
ds_read_b128 v[84:87],v7 offset:0
v_lshlrev_b32 v180,16,v166
v_mfma_f32_16x16x32_bf16 v[36:39],a[124:127],v[124:127],v[36:39]
s_waitcnt lgkmcnt(5)
buffer_load_dwordx4 v[140:143],v0,s[20:23],s84 offen offset:3072 sc1
v_and_b32 v181,s73,v166
v_mfma_f32_16x16x32_bf16 v[32:35],a[128:131],v[64:67],v[32:35]
ds_read_b128 v[88:91],v7 offset:1024
v_lshlrev_b32 v182,16,v167
v_mfma_f32_16x16x32_bf16 v[36:39],a[132:135],v[64:67],v[36:39]
s_waitcnt lgkmcnt(5)
buffer_load_dwordx4 v[144:147],v0,s[20:23],s85 offen offset:0 sc1
v_and_b32 v183,s73,v167
v_mfma_f32_16x16x32_bf16 v[32:35],a[136:139],v[68:71],v[32:35]
ds_read_b128 v[92:95],v7 offset:2048
v_add_f32 v212,v212,v176
v_mfma_f32_16x16x32_bf16 v[36:39],a[140:143],v[68:71],v[36:39]
s_waitcnt lgkmcnt(5)
buffer_load_dwordx4 v[148:151],v0,s[20:23],s85 offen offset:1024 sc1
v_add_f32 v213,v213,v177
v_mfma_f32_16x16x32_bf16 v[32:35],a[144:147],v[72:75],v[32:35]
ds_read_b128 v[96:99],v7 offset:3072
v_add_f32 v214,v214,v178
v_mfma_f32_16x16x32_bf16 v[36:39],a[148:151],v[72:75],v[36:39]
s_waitcnt lgkmcnt(5)
v_add_f32 v215,v215,v179
v_add_f32 v216,v216,v180
v_mfma_f32_16x16x32_bf16 v[32:35],a[152:155],v[76:79],v[32:35]
ds_read_b128 v[100:103],v7 offset:4096
v_add_f32 v217,v217,v181
v_mfma_f32_16x16x32_bf16 v[36:39],a[156:159],v[76:79],v[36:39]
s_waitcnt lgkmcnt(5)
v_add_f32 v218,v218,v182
v_add_f32 v219,v219,v183
v_mfma_f32_16x16x32_bf16 v[32:35],a[160:163],v[80:83],v[32:35]
ds_read_b128 v[104:107],v7 offset:5120
v_fma_f32 v168,v212,v152,v168
v_mfma_f32_16x16x32_bf16 v[36:39],a[164:167],v[80:83],v[36:39]
s_waitcnt lgkmcnt(5)
v_fma_f32 v169,v213,v153,v169
v_fma_f32 v170,v214,v154,v170
v_mfma_f32_16x16x32_bf16 v[32:35],a[168:171],v[84:87],v[32:35]
ds_read_b128 v[108:111],v7 offset:6144
v_fma_f32 v171,v215,v155,v171
v_mfma_f32_16x16x32_bf16 v[36:39],a[172:175],v[84:87],v[36:39]
s_waitcnt lgkmcnt(5)
v_fma_f32 v172,v216,v156,v172
v_fma_f32 v173,v217,v157,v173
v_mfma_f32_16x16x32_bf16 v[32:35],a[176:179],v[88:91],v[32:35]
s_add_u32 s61,s61,114688
v_fma_f32 v174,v218,v158,v174
v_fma_f32 v175,v219,v159,v175
v_mfma_f32_16x16x32_bf16 v[36:39],a[180:183],v[88:91],v[36:39]
s_waitcnt lgkmcnt(4)
s_add_u32 s62,s62,114688
buffer_load_dwordx4 v[160:163],v0,s[20:23],s82 offen
v_mfma_f32_16x16x32_bf16 v[32:35],a[184:187],v[92:95],v[32:35]
s_add_u32 s70,s70,32768
s_add_u32 s64,s82,13631488
buffer_load_dwordx4 v[164:167],v0,s[20:23],s64 offen
v_mfma_f32_16x16x32_bf16 v[36:39],a[188:191],v[92:95],v[36:39]
s_waitcnt lgkmcnt(3)
s_add_u32 s82,s82,32768
s_and_b32 s70,s70,0x1ffff
v_mfma_f32_16x16x32_bf16 v[32:35],a[192:195],v[96:99],v[32:35]
s_add_u32 s55,s55,32768
s_and_b32 s55,s55,0x1ffff
v_add_u32 v4,s55,v8
v_mfma_f32_16x16x32_bf16 v[36:39],a[196:199],v[96:99],v[36:39]
s_waitcnt lgkmcnt(2)
v_add_u32 v5,s55,v9
v_add_u32 v6,s55,v10
v_mfma_f32_16x16x32_bf16 v[32:35],a[200:203],v[100:103],v[32:35]
s_waitcnt vmcnt(2)
s_cmp_eq_u32 s77,0
s_cbranch_scc1 go_247
ck_245:
v_max3_u32 v184,v128,v129,v130
v_max3_u32 v185,v140,v141,v142
v_max3_u32 v184,v184,v131,v132
v_max3_u32 v185,v185,v143,v144
v_max3_u32 v184,v184,v133,v134
v_max3_u32 v185,v185,v145,v146
v_max3_u32 v184,v184,v135,v136
v_max3_u32 v185,v185,v147,v148
v_max3_u32 v184,v184,v137,v138
v_max3_u32 v185,v185,v149,v150
v_max3_u32 v184,v184,v139,v151
v_max_u32 v184,v184,v185
v_cmp_eq_u32 vcc,-1,v184
s_cbranch_vccnz rt_246
go_247:
v_mfma_f32_16x16x32_bf16 v[36:39],a[204:207],v[100:103],v[36:39]
s_waitcnt lgkmcnt(1)
v_add_u32 v7,s55,v11
v_add_f32 v128,v128,v136
v_add_f32 v129,v129,v137
v_mfma_f32_16x16x32_bf16 v[32:35],a[208:211],v[104:107],v[32:35]
ds_read_b128 v[64:67],v4 offset:0
v_add_f32 v130,v130,v138
v_add_f32 v131,v131,v139
v_mfma_f32_16x16x32_bf16 v[36:39],a[212:215],v[104:107],v[36:39]
s_waitcnt lgkmcnt(1)
ds_read_b128 v[68:71],v4 offset:1024
v_add_f32 v132,v132,v140
v_mfma_f32_16x16x32_bf16 v[40:43],a[216:219],v[108:111],v[32:35]
ds_read_b128 v[72:75],v4 offset:2048
v_add_f32 v133,v133,v141
v_add_f32 v134,v134,v142
v_mfma_f32_16x16x32_bf16 v[44:47],a[220:223],v[108:111],v[36:39]
v_add_f32 v135,v135,v143
v_add_f32 v128,v128,v144
v_add_f32 v129,v129,v145
v_add_f32 v130,v130,v146
v_add_f32 v131,v131,v147
v_add_f32 v132,v132,v148
v_add_f32 v133,v133,v149
v_add_f32 v134,v134,v150
v_add_f32 v135,v135,v151
v_fma_f32 v168,v128,v152,v168
v_fma_f32 v169,v129,v153,v169
v_fma_f32 v170,v130,v154,v170
v_fma_f32 v171,v131,v155,v171
v_fma_f32 v172,v132,v156,v172
v_fma_f32 v173,v133,v157,v173
v_fma_f32 v174,v134,v158,v174
v_fma_f32 v175,v135,v159,v175
v_cvt_pk_bf16_f32 v176,v168,v169
v_cvt_pk_bf16_f32 v177,v170,v171
v_cvt_pk_bf16_f32 v178,v172,v173
v_cvt_pk_bf16_f32 v179,v174,v175
s_and_b32 s64,s66,0xffff8000
buffer_store_dwordx4 v[176:179],v22,s[24:27],s64 offen
s_cmp_eq_u32 s56,1
s_cbranch_scc1 b1_239
buffer_store_dwordx4 v[204:207],v21,s[20:23],s84 offen offset:0
buffer_store_dwordx4 v[204:207],v21,s[20:23],s84 offen offset:1024
b2_240:
s_cmp_eq_u32 s56,1
s_cbranch_scc1 b1_241
buffer_store_dwordx4 v[204:207],v21,s[20:23],s84 offen offset:2048
buffer_store_dwordx4 v[204:207],v21,s[20:23],s84 offen offset:3072
b2_242:
s_cmp_eq_u32 s56,1
s_cbranch_scc1 b1_243
buffer_store_dwordx4 v[204:207],v21,s[20:23],s85 offen offset:0
buffer_store_dwordx4 v[204:207],v21,s[20:23],s85 offen offset:1024
b2_244:
s_mul_i32 s64,s77,32768
s_add_u32 s66,s66,s64
s_mul_i32 s64,s77,6144
s_add_u32 s75,s75,s64
s_cmp_eq_u32 s75,24576
s_cselect_b32 s75,0,s75
s_add_u32 s63,s63,s77
s_mov_b32 s77,0
v_cmp_gt_u32 vcc,s53,v16
s_add_u32 s60,s60,1
s_cbranch_vccnz WN_231
.p2align 6
WR_230:
s_waitcnt lgkmcnt(2)
v_mfma_f32_16x16x32_bf16 v[32:35],a[0:3],v[64:67],0
s_waitcnt vmcnt(19)
s_add_u32 s71,s60,2
ds_read_b128 v[76:79],v4 offset:3072
v_mfma_f32_16x16x32_bf16 v[36:39],a[4:7],v[64:67],0
s_waitcnt lgkmcnt(2)
s_add_u32 s53,s60,3
v_mfma_f32_16x16x32_bf16 v[32:35],a[8:11],v[68:71],v[32:35]
s_waitcnt vmcnt(18)
s_mov_b32 m0,s70
ds_read_b128 v[80:83],v4 offset:4096
v_mfma_f32_16x16x32_bf16 v[36:39],a[12:15],v[68:71],v[36:39]
s_waitcnt lgkmcnt(2)
buffer_load_dwordx4 v3,s[20:23],s61 offen offset:0 lds
v_mov_b32 v212,v40
v_mfma_f32_16x16x32_bf16 v[32:35],a[16:19],v[72:75],v[32:35]
s_waitcnt vmcnt(18)
ds_read_b128 v[84:87],v4 offset:5120
v_mov_b32 v213,v41
v_mfma_f32_16x16x32_bf16 v[36:39],a[20:23],v[72:75],v[36:39]
s_waitcnt lgkmcnt(2)
v_mov_b32 v214,v42
v_mov_b32 v215,v43
v_mfma_f32_16x16x32_bf16 v[32:35],a[24:27],v[76:79],v[32:35]
s_waitcnt vmcnt(16)
ds_read_b128 v[88:91],v4 offset:6144
buffer_load_dwordx4 v3,s[20:23],s61 offen offset:1024 lds
v_mfma_f32_16x16x32_bf16 v[36:39],a[28:31],v[76:79],v[36:39]
s_waitcnt lgkmcnt(2)
s_barrier
ds_read_b128 v[92:95],v5 offset:0
v_mfma_f32_16x16x32_bf16 v[32:35],a[32:35],v[80:83],v[32:35]
ds_read_b128 v[96:99],v5 offset:1024
v_mov_b32 v216,v44
v_mfma_f32_16x16x32_bf16 v[36:39],a[36:39],v[80:83],v[36:39]
s_waitcnt lgkmcnt(3)
ds_read_b128 v[100:103],v5 offset:2048
buffer_load_dwordx4 v3,s[20:23],s61 offen offset:2048 lds
v_mfma_f32_16x16x32_bf16 v[32:35],a[40:43],v[84:87],v[32:35]
ds_read_b128 v[104:107],v5 offset:3072
v_mov_b32 v217,v45
v_mfma_f32_16x16x32_bf16 v[36:39],a[44:47],v[84:87],v[36:39]
s_waitcnt lgkmcnt(4)
ds_read_b128 v[108:111],v5 offset:4096
v_mov_b32 v218,v46
v_mfma_f32_16x16x32_bf16 v[32:35],a[48:51],v[88:91],v[32:35]
ds_read_b128 v[112:115],v5 offset:5120
buffer_load_dwordx4 v3,s[20:23],s61 offen offset:3072 lds
v_mfma_f32_16x16x32_bf16 v[36:39],a[52:55],v[88:91],v[36:39]
s_waitcnt lgkmcnt(5)
v_mov_b32 v219,v47
v_mfma_f32_16x16x32_bf16 v[32:35],a[56:59],v[92:95],v[32:35]
s_mov_b32 s77,1
s_waitcnt vmcnt(11)
s_cmp_eq_u32 s77,0
s_cselect_b32 s57,2.0,0
ds_read_b128 v[116:119],v5 offset:6144
v_mfma_f32_16x16x32_bf16 v[36:39],a[60:63],v[92:95],v[36:39]
s_waitcnt lgkmcnt(5)
s_add_u32 m0,s70,4096
v_or_b32 v21,s57,v0
v_mfma_f32_16x16x32_bf16 v[32:35],a[64:67],v[96:99],v[32:35]
ds_read_b128 v[120:123],v6 offset:0
buffer_load_dwordx4 v3,s[20:23],s62 offen offset:0 lds
v_mfma_f32_16x16x32_bf16 v[36:39],a[68:71],v[96:99],v[36:39]
s_waitcnt lgkmcnt(5)
v_or_b32 v22,s57,v18
v_lshlrev_b32 v168,16,v160
v_mfma_f32_16x16x32_bf16 v[32:35],a[72:75],v[100:103],v[32:35]
ds_read_b128 v[124:127],v6 offset:1024
v_and_b32 v169,s73,v160
v_mfma_f32_16x16x32_bf16 v[36:39],a[76:79],v[100:103],v[36:39]
s_waitcnt lgkmcnt(5)
buffer_load_dwordx4 v3,s[20:23],s62 offen offset:1024 lds
v_lshlrev_b32 v170,16,v161
v_mfma_f32_16x16x32_bf16 v[32:35],a[80:83],v[104:107],v[32:35]
ds_read_b128 v[64:67],v6 offset:2048
v_and_b32 v171,s73,v161
v_mfma_f32_16x16x32_bf16 v[36:39],a[84:87],v[104:107],v[36:39]
s_waitcnt lgkmcnt(5)
buffer_load_dword v16,v2,s[20:23],s68 offen sc1
v_lshlrev_b32 v172,16,v162
v_mfma_f32_16x16x32_bf16 v[32:35],a[88:91],v[108:111],v[32:35]
ds_read_b128 v[68:71],v6 offset:3072
buffer_load_dwordx4 v3,s[20:23],s62 offen offset:2048 lds
v_mfma_f32_16x16x32_bf16 v[36:39],a[92:95],v[108:111],v[36:39]
s_waitcnt lgkmcnt(5)
v_and_b32 v173,s73,v162
v_lshlrev_b32 v174,16,v163
v_mfma_f32_16x16x32_bf16 v[32:35],a[96:99],v[112:115],v[32:35]
s_add_u32 s84,s74,s75
s_add_u32 s85,s84,4096
ds_read_b128 v[72:75],v6 offset:4096
v_mfma_f32_16x16x32_bf16 v[36:39],a[100:103],v[112:115],v[36:39]
s_waitcnt lgkmcnt(5)
buffer_load_dwordx4 v[128:131],v0,s[20:23],s84 offen offset:0 sc1
v_and_b32 v175,s73,v163
v_mfma_f32_16x16x32_bf16 v[32:35],a[104:107],v[116:119],v[32:35]
ds_read_b128 v[76:79],v6 offset:5120
v_lshlrev_b32 v176,16,v164
v_mfma_f32_16x16x32_bf16 v[36:39],a[108:111],v[116:119],v[36:39]
s_waitcnt lgkmcnt(5)
buffer_load_dwordx4 v[132:135],v0,s[20:23],s84 offen offset:1024 sc1
v_and_b32 v177,s73,v164
v_mfma_f32_16x16x32_bf16 v[32:35],a[112:115],v[120:123],v[32:35]
ds_read_b128 v[80:83],v6 offset:6144
v_lshlrev_b32 v178,16,v165
v_mfma_f32_16x16x32_bf16 v[36:39],a[116:119],v[120:123],v[36:39]
s_waitcnt lgkmcnt(5)
buffer_load_dwordx4 v[136:139],v0,s[20:23],s84 offen offset:2048 sc1
v_and_b32 v179,s73,v165
v_mfma_f32_16x16x32_bf16 v[32:35],a[120:123],v[124:127],v[32:35]
ds_read_b128 v[84:87],v7 offset:0
v_lshlrev_b32 v180,16,v166
v_mfma_f32_16x16x32_bf16 v[36:39],a[124:127],v[124:127],v[36:39]
s_waitcnt lgkmcnt(5)
buffer_load_dwordx4 v[140:143],v0,s[20:23],s84 offen offset:3072 sc1
v_and_b32 v181,s73,v166
v_mfma_f32_16x16x32_bf16 v[32:35],a[128:131],v[64:67],v[32:35]
ds_read_b128 v[88:91],v7 offset:1024
v_lshlrev_b32 v182,16,v167
v_mfma_f32_16x16x32_bf16 v[36:39],a[132:135],v[64:67],v[36:39]
s_waitcnt lgkmcnt(5)
buffer_load_dwordx4 v[144:147],v0,s[20:23],s85 offen offset:0 sc1
v_and_b32 v183,s73,v167
v_mfma_f32_16x16x32_bf16 v[32:35],a[136:139],v[68:71],v[32:35]
ds_read_b128 v[92:95],v7 offset:2048
v_add_f32 v212,v212,v176
v_mfma_f32_16x16x32_bf16 v[36:39],a[140:143],v[68:71],v[36:39]
s_waitcnt lgkmcnt(5)
buffer_load_dwordx4 v[148:151],v0,s[20:23],s85 offen offset:1024 sc1
v_add_f32 v213,v213,v177
v_mfma_f32_16x16x32_bf16 v[32:35],a[144:147],v[72:75],v[32:35]
ds_read_b128 v[96:99],v7 offset:3072
v_add_f32 v214,v214,v178
v_mfma_f32_16x16x32_bf16 v[36:39],a[148:151],v[72:75],v[36:39]
s_waitcnt lgkmcnt(5)
v_add_f32 v215,v215,v179
v_add_f32 v216,v216,v180
v_mfma_f32_16x16x32_bf16 v[32:35],a[152:155],v[76:79],v[32:35]
ds_read_b128 v[100:103],v7 offset:4096
v_add_f32 v217,v217,v181
v_mfma_f32_16x16x32_bf16 v[36:39],a[156:159],v[76:79],v[36:39]
s_waitcnt lgkmcnt(5)
v_add_f32 v218,v218,v182
v_add_f32 v219,v219,v183
v_mfma_f32_16x16x32_bf16 v[32:35],a[160:163],v[80:83],v[32:35]
ds_read_b128 v[104:107],v7 offset:5120
v_fma_f32 v168,v212,v152,v168
v_mfma_f32_16x16x32_bf16 v[36:39],a[164:167],v[80:83],v[36:39]
s_waitcnt lgkmcnt(5)
v_fma_f32 v169,v213,v153,v169
v_fma_f32 v170,v214,v154,v170
v_mfma_f32_16x16x32_bf16 v[32:35],a[168:171],v[84:87],v[32:35]
ds_read_b128 v[108:111],v7 offset:6144
v_fma_f32 v171,v215,v155,v171
v_mfma_f32_16x16x32_bf16 v[36:39],a[172:175],v[84:87],v[36:39]
s_waitcnt lgkmcnt(5)
v_fma_f32 v172,v216,v156,v172
v_fma_f32 v173,v217,v157,v173
v_mfma_f32_16x16x32_bf16 v[32:35],a[176:179],v[88:91],v[32:35]
s_add_u32 s61,s61,114688
v_fma_f32 v174,v218,v158,v174
v_fma_f32 v175,v219,v159,v175
v_mfma_f32_16x16x32_bf16 v[36:39],a[180:183],v[88:91],v[36:39]
s_waitcnt lgkmcnt(4)
s_add_u32 s62,s62,114688
buffer_load_dwordx4 v[160:163],v0,s[20:23],s82 offen
v_mfma_f32_16x16x32_bf16 v[32:35],a[184:187],v[92:95],v[32:35]
s_add_u32 s70,s70,32768
s_add_u32 s64,s82,13631488
buffer_load_dwordx4 v[164:167],v0,s[20:23],s64 offen
v_mfma_f32_16x16x32_bf16 v[36:39],a[188:191],v[92:95],v[36:39]
s_waitcnt lgkmcnt(3)
s_add_u32 s82,s82,32768
s_and_b32 s70,s70,0x1ffff
v_mfma_f32_16x16x32_bf16 v[32:35],a[192:195],v[96:99],v[32:35]
s_add_u32 s55,s55,32768
s_and_b32 s55,s55,0x1ffff
v_add_u32 v4,s55,v8
v_mfma_f32_16x16x32_bf16 v[36:39],a[196:199],v[96:99],v[36:39]
s_waitcnt lgkmcnt(2)
v_add_u32 v5,s55,v9
v_add_u32 v6,s55,v10
v_mfma_f32_16x16x32_bf16 v[32:35],a[200:203],v[100:103],v[32:35]
s_waitcnt vmcnt(2)
s_cmp_eq_u32 s77,0
s_cbranch_scc1 go_256
ck_254:
v_max3_u32 v184,v128,v129,v130
v_max3_u32 v185,v140,v141,v142
v_max3_u32 v184,v184,v131,v132
v_max3_u32 v185,v185,v143,v144
v_max3_u32 v184,v184,v133,v134
v_max3_u32 v185,v185,v145,v146
v_max3_u32 v184,v184,v135,v136
v_max3_u32 v185,v185,v147,v148
v_max3_u32 v184,v184,v137,v138
v_max3_u32 v185,v185,v149,v150
v_max3_u32 v184,v184,v139,v151
v_max_u32 v184,v184,v185
v_cmp_eq_u32 vcc,-1,v184
s_cbranch_vccnz rt_255
go_256:
v_mfma_f32_16x16x32_bf16 v[36:39],a[204:207],v[100:103],v[36:39]
s_waitcnt lgkmcnt(1)
v_add_u32 v7,s55,v11
v_add_f32 v128,v128,v136
v_add_f32 v129,v129,v137
v_mfma_f32_16x16x32_bf16 v[32:35],a[208:211],v[104:107],v[32:35]
ds_read_b128 v[64:67],v4 offset:0
v_add_f32 v130,v130,v138
v_add_f32 v131,v131,v139
v_mfma_f32_16x16x32_bf16 v[36:39],a[212:215],v[104:107],v[36:39]
s_waitcnt lgkmcnt(1)
ds_read_b128 v[68:71],v4 offset:1024
v_add_f32 v132,v132,v140
v_mfma_f32_16x16x32_bf16 v[40:43],a[216:219],v[108:111],v[32:35]
ds_read_b128 v[72:75],v4 offset:2048
v_add_f32 v133,v133,v141
v_add_f32 v134,v134,v142
v_mfma_f32_16x16x32_bf16 v[44:47],a[220:223],v[108:111],v[36:39]
v_add_f32 v135,v135,v143
v_add_f32 v128,v128,v144
v_add_f32 v129,v129,v145
v_add_f32 v130,v130,v146
v_add_f32 v131,v131,v147
v_add_f32 v132,v132,v148
v_add_f32 v133,v133,v149
v_add_f32 v134,v134,v150
v_add_f32 v135,v135,v151
v_fma_f32 v168,v128,v152,v168
v_fma_f32 v169,v129,v153,v169
v_fma_f32 v170,v130,v154,v170
v_fma_f32 v171,v131,v155,v171
v_fma_f32 v172,v132,v156,v172
v_fma_f32 v173,v133,v157,v173
v_fma_f32 v174,v134,v158,v174
v_fma_f32 v175,v135,v159,v175
v_cvt_pk_bf16_f32 v176,v168,v169
v_cvt_pk_bf16_f32 v177,v170,v171
v_cvt_pk_bf16_f32 v178,v172,v173
v_cvt_pk_bf16_f32 v179,v174,v175
s_and_b32 s64,s66,0xffff8000
buffer_store_dwordx4 v[176:179],v22,s[24:27],s64 offen
s_cmp_eq_u32 s56,1
s_cbranch_scc1 b1_248
buffer_store_dwordx4 v[204:207],v21,s[20:23],s84 offen offset:0
buffer_store_dwordx4 v[204:207],v21,s[20:23],s84 offen offset:1024
b2_249:
s_cmp_eq_u32 s56,1
s_cbranch_scc1 b1_250
buffer_store_dwordx4 v[204:207],v21,s[20:23],s84 offen offset:2048
buffer_store_dwordx4 v[204:207],v21,s[20:23],s84 offen offset:3072
b2_251:
s_cmp_eq_u32 s56,1
s_cbranch_scc1 b1_252
buffer_store_dwordx4 v[204:207],v21,s[20:23],s85 offen offset:0
buffer_store_dwordx4 v[204:207],v21,s[20:23],s85 offen offset:1024
b2_253:
s_mul_i32 s64,s77,32768
s_add_u32 s66,s66,s64
s_mul_i32 s64,s77,6144
s_add_u32 s75,s75,s64
s_cmp_eq_u32 s75,24576
s_cselect_b32 s75,0,s75
s_add_u32 s63,s63,s77
s_mov_b32 s77,0
v_cmp_gt_u32 vcc,s53,v16
s_add_u32 s60,s60,1
s_cbranch_vccz WR_230
WN_231:
s_waitcnt lgkmcnt(2)
v_mfma_f32_16x16x32_bf16 v[32:35],a[0:3],v[64:67],0
s_waitcnt vmcnt(19)
s_add_u32 s71,s60,2
ds_read_b128 v[76:79],v4 offset:3072
v_mfma_f32_16x16x32_bf16 v[36:39],a[4:7],v[64:67],0
s_waitcnt lgkmcnt(2)
s_add_u32 s53,s60,3
v_mfma_f32_16x16x32_bf16 v[32:35],a[8:11],v[68:71],v[32:35]
s_waitcnt vmcnt(18)
ds_read_b128 v[80:83],v4 offset:4096
v_mov_b32 v212,v40
v_mfma_f32_16x16x32_bf16 v[36:39],a[12:15],v[68:71],v[36:39]
s_waitcnt lgkmcnt(2)
v_mov_b32 v213,v41
v_mov_b32 v214,v42
v_mfma_f32_16x16x32_bf16 v[32:35],a[16:19],v[72:75],v[32:35]
s_waitcnt vmcnt(17)
ds_read_b128 v[84:87],v4 offset:5120
v_mov_b32 v215,v43
v_mfma_f32_16x16x32_bf16 v[36:39],a[20:23],v[72:75],v[36:39]
s_waitcnt lgkmcnt(2)
v_mov_b32 v216,v44
v_mov_b32 v217,v45
v_mfma_f32_16x16x32_bf16 v[32:35],a[24:27],v[76:79],v[32:35]
s_waitcnt vmcnt(15)
ds_read_b128 v[88:91],v4 offset:6144
v_mov_b32 v218,v46
v_mfma_f32_16x16x32_bf16 v[36:39],a[28:31],v[76:79],v[36:39]
s_waitcnt lgkmcnt(2)
s_barrier
ds_read_b128 v[92:95],v5 offset:0
v_mfma_f32_16x16x32_bf16 v[32:35],a[32:35],v[80:83],v[32:35]
ds_read_b128 v[96:99],v5 offset:1024
v_mov_b32 v219,v47
v_mfma_f32_16x16x32_bf16 v[36:39],a[36:39],v[80:83],v[36:39]
s_waitcnt lgkmcnt(3)
s_mov_b32 s77,1
ds_read_b128 v[100:103],v5 offset:2048
v_mfma_f32_16x16x32_bf16 v[32:35],a[40:43],v[84:87],v[32:35]
ds_read_b128 v[104:107],v5 offset:3072
v_mfma_f32_16x16x32_bf16 v[36:39],a[44:47],v[84:87],v[36:39]
s_waitcnt lgkmcnt(4)
ds_read_b128 v[108:111],v5 offset:4096
v_mfma_f32_16x16x32_bf16 v[32:35],a[48:51],v[88:91],v[32:35]
ds_read_b128 v[112:115],v5 offset:5120
v_mfma_f32_16x16x32_bf16 v[36:39],a[52:55],v[88:91],v[36:39]
s_waitcnt lgkmcnt(5)
v_mfma_f32_16x16x32_bf16 v[32:35],a[56:59],v[92:95],v[32:35]
s_waitcnt vmcnt(7)
s_cmp_eq_u32 s77,0
s_cselect_b32 s57,2.0,0
ds_read_b128 v[116:119],v5 offset:6144
v_mfma_f32_16x16x32_bf16 v[36:39],a[60:63],v[92:95],v[36:39]
s_waitcnt lgkmcnt(5)
v_or_b32 v21,s57,v0
v_or_b32 v22,s57,v18
v_mfma_f32_16x16x32_bf16 v[32:35],a[64:67],v[96:99],v[32:35]
ds_read_b128 v[120:123],v6 offset:0
v_lshlrev_b32 v168,16,v160
v_mfma_f32_16x16x32_bf16 v[36:39],a[68:71],v[96:99],v[36:39]
s_waitcnt lgkmcnt(5)
v_and_b32 v169,s73,v160
v_lshlrev_b32 v170,16,v161
v_mfma_f32_16x16x32_bf16 v[32:35],a[72:75],v[100:103],v[32:35]
ds_read_b128 v[124:127],v6 offset:1024
v_and_b32 v171,s73,v161
v_mfma_f32_16x16x32_bf16 v[36:39],a[76:79],v[100:103],v[36:39]
s_waitcnt lgkmcnt(5)
v_lshlrev_b32 v172,16,v162
v_and_b32 v173,s73,v162
v_mfma_f32_16x16x32_bf16 v[32:35],a[80:83],v[104:107],v[32:35]
ds_read_b128 v[64:67],v6 offset:2048
v_lshlrev_b32 v174,16,v163
v_mfma_f32_16x16x32_bf16 v[36:39],a[84:87],v[104:107],v[36:39]
s_waitcnt lgkmcnt(5)
v_and_b32 v175,s73,v163
v_lshlrev_b32 v176,16,v164
v_mfma_f32_16x16x32_bf16 v[32:35],a[88:91],v[108:111],v[32:35]
ds_read_b128 v[68:71],v6 offset:3072
v_and_b32 v177,s73,v164
v_mfma_f32_16x16x32_bf16 v[36:39],a[92:95],v[108:111],v[36:39]
s_waitcnt lgkmcnt(5)
v_lshlrev_b32 v178,16,v165
v_and_b32 v179,s73,v165
v_mfma_f32_16x16x32_bf16 v[32:35],a[96:99],v[112:115],v[32:35]
s_add_u32 s84,s74,s75
s_add_u32 s85,s84,4096
ds_read_b128 v[72:75],v6 offset:4096
buffer_load_dwordx4 v[128:131],v0,s[20:23],s84 offen offset:0 sc1
buffer_load_dwordx4 v[132:135],v0,s[20:23],s84 offen offset:1024 sc1
v_mfma_f32_16x16x32_bf16 v[36:39],a[100:103],v[112:115],v[36:39]
s_waitcnt lgkmcnt(5)
buffer_load_dwordx4 v[136:139],v0,s[20:23],s84 offen offset:2048 sc1
v_lshlrev_b32 v180,16,v166
v_mfma_f32_16x16x32_bf16 v[32:35],a[104:107],v[116:119],v[32:35]
ds_read_b128 v[76:79],v6 offset:5120
v_and_b32 v181,s73,v166
v_mfma_f32_16x16x32_bf16 v[36:39],a[108:111],v[116:119],v[36:39]
s_waitcnt lgkmcnt(5)
buffer_load_dwordx4 v[140:143],v0,s[20:23],s84 offen offset:3072 sc1
v_lshlrev_b32 v182,16,v167
v_mfma_f32_16x16x32_bf16 v[32:35],a[112:115],v[120:123],v[32:35]
ds_read_b128 v[80:83],v6 offset:6144
v_and_b32 v183,s73,v167
v_mfma_f32_16x16x32_bf16 v[36:39],a[116:119],v[120:123],v[36:39]
s_waitcnt lgkmcnt(5)
buffer_load_dwordx4 v[144:147],v0,s[20:23],s85 offen offset:0 sc1
v_add_f32 v212,v212,v176
v_mfma_f32_16x16x32_bf16 v[32:35],a[120:123],v[124:127],v[32:35]
ds_read_b128 v[84:87],v7 offset:0
v_add_f32 v213,v213,v177
v_mfma_f32_16x16x32_bf16 v[36:39],a[124:127],v[124:127],v[36:39]
s_waitcnt lgkmcnt(5)
buffer_load_dwordx4 v[148:151],v0,s[20:23],s85 offen offset:1024 sc1
v_add_f32 v214,v214,v178
v_mfma_f32_16x16x32_bf16 v[32:35],a[128:131],v[64:67],v[32:35]
ds_read_b128 v[88:91],v7 offset:1024
v_add_f32 v215,v215,v179
v_mfma_f32_16x16x32_bf16 v[36:39],a[132:135],v[64:67],v[36:39]
s_waitcnt lgkmcnt(5)
v_add_f32 v216,v216,v180
v_add_f32 v217,v217,v181
v_mfma_f32_16x16x32_bf16 v[32:35],a[136:139],v[68:71],v[32:35]
ds_read_b128 v[92:95],v7 offset:2048
v_add_f32 v218,v218,v182
v_mfma_f32_16x16x32_bf16 v[36:39],a[140:143],v[68:71],v[36:39]
s_waitcnt lgkmcnt(5)
buffer_load_dword v16,v2,s[20:23],s68 offen sc1
v_add_f32 v219,v219,v183
v_mfma_f32_16x16x32_bf16 v[32:35],a[144:147],v[72:75],v[32:35]
ds_read_b128 v[96:99],v7 offset:3072
v_fma_f32 v168,v212,v152,v168
v_mfma_f32_16x16x32_bf16 v[36:39],a[148:151],v[72:75],v[36:39]
s_waitcnt lgkmcnt(5)
v_fma_f32 v169,v213,v153,v169
v_fma_f32 v170,v214,v154,v170
v_mfma_f32_16x16x32_bf16 v[32:35],a[152:155],v[76:79],v[32:35]
ds_read_b128 v[100:103],v7 offset:4096
v_fma_f32 v171,v215,v155,v171
v_mfma_f32_16x16x32_bf16 v[36:39],a[156:159],v[76:79],v[36:39]
s_waitcnt lgkmcnt(5)
v_fma_f32 v172,v216,v156,v172
v_fma_f32 v173,v217,v157,v173
v_mfma_f32_16x16x32_bf16 v[32:35],a[160:163],v[80:83],v[32:35]
ds_read_b128 v[104:107],v7 offset:5120
v_fma_f32 v174,v218,v158,v174
v_mfma_f32_16x16x32_bf16 v[36:39],a[164:167],v[80:83],v[36:39]
s_waitcnt lgkmcnt(5)
v_fma_f32 v175,v219,v159,v175
v_mfma_f32_16x16x32_bf16 v[32:35],a[168:171],v[84:87],v[32:35]
ds_read_b128 v[108:111],v7 offset:6144
v_mfma_f32_16x16x32_bf16 v[36:39],a[172:175],v[84:87],v[36:39]
s_waitcnt lgkmcnt(5)
s_add_u32 s55,s55,32768
buffer_load_dwordx4 v[160:163],v0,s[20:23],s82 offen
v_mfma_f32_16x16x32_bf16 v[32:35],a[176:179],v[88:91],v[32:35]
s_and_b32 s55,s55,0x1ffff
s_add_u32 s64,s82,13631488
buffer_load_dwordx4 v[164:167],v0,s[20:23],s64 offen
v_mfma_f32_16x16x32_bf16 v[36:39],a[180:183],v[88:91],v[36:39]
s_waitcnt lgkmcnt(4)
s_add_u32 s82,s82,32768
v_add_u32 v4,s55,v8
v_mfma_f32_16x16x32_bf16 v[32:35],a[184:187],v[92:95],v[32:35]
s_waitcnt vmcnt(3)
s_cmp_eq_u32 s77,0
s_cbranch_scc1 go_266
ck_264:
v_max3_u32 v184,v128,v129,v130
v_max3_u32 v185,v140,v141,v142
v_max3_u32 v184,v184,v131,v132
v_max3_u32 v185,v185,v143,v144
v_max3_u32 v184,v184,v133,v134
v_max3_u32 v185,v185,v145,v146
v_max3_u32 v184,v184,v135,v136
v_max3_u32 v185,v185,v147,v148
v_max3_u32 v184,v184,v137,v138
v_max3_u32 v185,v185,v149,v150
v_max3_u32 v184,v184,v139,v151
v_max_u32 v184,v184,v185
v_cmp_eq_u32 vcc,-1,v184
s_cbranch_vccnz rt_265
go_266:
v_mfma_f32_16x16x32_bf16 v[36:39],a[188:191],v[92:95],v[36:39]
s_waitcnt lgkmcnt(3)
v_add_u32 v5,s55,v9
v_add_u32 v6,s55,v10
v_add_f32 v128,v128,v136
v_mfma_f32_16x16x32_bf16 v[32:35],a[192:195],v[96:99],v[32:35]
v_add_u32 v7,s55,v11
v_add_f32 v129,v129,v137
v_add_f32 v130,v130,v138
v_mfma_f32_16x16x32_bf16 v[36:39],a[196:199],v[96:99],v[36:39]
s_waitcnt lgkmcnt(2)
v_add_f32 v131,v131,v139
v_add_f32 v132,v132,v140
v_add_f32 v133,v133,v141
v_mfma_f32_16x16x32_bf16 v[32:35],a[200:203],v[100:103],v[32:35]
v_add_f32 v134,v134,v142
v_add_f32 v135,v135,v143
v_add_f32 v128,v128,v144
v_mfma_f32_16x16x32_bf16 v[36:39],a[204:207],v[100:103],v[36:39]
s_waitcnt lgkmcnt(1)
v_add_f32 v129,v129,v145
v_add_f32 v130,v130,v146
v_add_f32 v131,v131,v147
v_mfma_f32_16x16x32_bf16 v[32:35],a[208:211],v[104:107],v[32:35]
v_add_f32 v132,v132,v148
v_add_f32 v133,v133,v149
v_add_f32 v134,v134,v150
v_mfma_f32_16x16x32_bf16 v[36:39],a[212:215],v[104:107],v[36:39]
s_waitcnt lgkmcnt(0)
v_add_f32 v135,v135,v151
v_fma_f32 v168,v128,v152,v168
v_fma_f32 v169,v129,v153,v169
v_mfma_f32_16x16x32_bf16 v[40:43],a[216:219],v[108:111],v[32:35]
v_fma_f32 v170,v130,v154,v170
v_fma_f32 v171,v131,v155,v171
v_fma_f32 v172,v132,v156,v172
v_mfma_f32_16x16x32_bf16 v[44:47],a[220:223],v[108:111],v[36:39]
s_waitcnt vmcnt(2)
v_fma_f32 v173,v133,v157,v173
v_fma_f32 v174,v134,v158,v174
v_fma_f32 v175,v135,v159,v175
v_cvt_pk_bf16_f32 v176,v168,v169
v_cvt_pk_bf16_f32 v177,v170,v171
v_cvt_pk_bf16_f32 v178,v172,v173
v_cvt_pk_bf16_f32 v179,v174,v175
s_and_b32 s64,s66,0xffff8000
buffer_store_dwordx4 v[176:179],v22,s[24:27],s64 offen
s_cmp_eq_u32 s56,1
s_cbranch_scc1 b1_258
buffer_store_dwordx4 v[204:207],v21,s[20:23],s84 offen offset:0
buffer_store_dwordx4 v[204:207],v21,s[20:23],s84 offen offset:1024
b2_259:
s_cmp_eq_u32 s56,1
s_cbranch_scc1 b1_260
buffer_store_dwordx4 v[204:207],v21,s[20:23],s84 offen offset:2048
buffer_store_dwordx4 v[204:207],v21,s[20:23],s84 offen offset:3072
b2_261:
s_cmp_eq_u32 s56,1
s_cbranch_scc1 b1_262
buffer_store_dwordx4 v[204:207],v21,s[20:23],s85 offen offset:0
buffer_store_dwordx4 v[204:207],v21,s[20:23],s85 offen offset:1024
b2_263:
s_mul_i32 s64,s77,32768
s_add_u32 s66,s66,s64
s_mul_i32 s64,s77,6144
s_add_u32 s75,s75,s64
s_cmp_eq_u32 s75,24576
s_cselect_b32 s75,0,s75
s_add_u32 s63,s63,s77
s_mov_b32 s77,0
v_cmp_gt_u32 vcc,s71,v16
s_add_u32 s60,s60,1
s_branch endN_257
BN_233:
s_waitcnt vmcnt(6)
ds_read_b128 v[64:67],v4 offset:0
s_waitcnt vmcnt(5)
ds_read_b128 v[68:71],v4 offset:1024
s_waitcnt vmcnt(4)
ds_read_b128 v[72:75],v4 offset:2048
s_waitcnt vmcnt(3)
ds_read_b128 v[76:79],v4 offset:3072
s_waitcnt lgkmcnt(3)
v_mfma_f32_16x16x32_bf16 v[32:35],a[0:3],v[64:67],0
s_add_u32 s71,s60,2
s_add_u32 s53,s60,3
v_mfma_f32_16x16x32_bf16 v[36:39],a[4:7],v[64:67],0
s_waitcnt lgkmcnt(2)
s_waitcnt vmcnt(2)
ds_read_b128 v[80:83],v4 offset:4096
v_mfma_f32_16x16x32_bf16 v[32:35],a[8:11],v[68:71],v[32:35]
v_mfma_f32_16x16x32_bf16 v[36:39],a[12:15],v[68:71],v[36:39]
s_waitcnt lgkmcnt(2)
s_waitcnt vmcnt(1)
ds_read_b128 v[84:87],v4 offset:5120
v_mfma_f32_16x16x32_bf16 v[32:35],a[16:19],v[72:75],v[32:35]
v_mfma_f32_16x16x32_bf16 v[36:39],a[20:23],v[72:75],v[36:39]
s_waitcnt lgkmcnt(2)
s_waitcnt vmcnt(0)
ds_read_b128 v[88:91],v4 offset:6144
v_mfma_f32_16x16x32_bf16 v[32:35],a[24:27],v[76:79],v[32:35]
v_mfma_f32_16x16x32_bf16 v[36:39],a[28:31],v[76:79],v[36:39]
s_waitcnt lgkmcnt(2)
s_barrier
ds_read_b128 v[92:95],v5 offset:0
v_mfma_f32_16x16x32_bf16 v[32:35],a[32:35],v[80:83],v[32:35]
ds_read_b128 v[96:99],v5 offset:1024
v_mfma_f32_16x16x32_bf16 v[36:39],a[36:39],v[80:83],v[36:39]
s_waitcnt lgkmcnt(3)
ds_read_b128 v[100:103],v5 offset:2048
v_mfma_f32_16x16x32_bf16 v[32:35],a[40:43],v[84:87],v[32:35]
ds_read_b128 v[104:107],v5 offset:3072
v_mfma_f32_16x16x32_bf16 v[36:39],a[44:47],v[84:87],v[36:39]
s_waitcnt lgkmcnt(4)
ds_read_b128 v[108:111],v5 offset:4096
v_mfma_f32_16x16x32_bf16 v[32:35],a[48:51],v[88:91],v[32:35]
ds_read_b128 v[112:115],v5 offset:5120
v_mfma_f32_16x16x32_bf16 v[36:39],a[52:55],v[88:91],v[36:39]
s_waitcnt lgkmcnt(5)
v_mfma_f32_16x16x32_bf16 v[32:35],a[56:59],v[92:95],v[32:35]
s_cmp_eq_u32 s77,0
s_cselect_b32 s57,2.0,0
ds_read_b128 v[116:119],v5 offset:6144
v_mfma_f32_16x16x32_bf16 v[36:39],a[60:63],v[92:95],v[36:39]
s_waitcnt lgkmcnt(5)
v_or_b32 v21,s57,v0
v_or_b32 v22,s57,v18
v_mfma_f32_16x16x32_bf16 v[32:35],a[64:67],v[96:99],v[32:35]
ds_read_b128 v[120:123],v6 offset:0
v_lshlrev_b32 v168,16,v160
v_mfma_f32_16x16x32_bf16 v[36:39],a[68:71],v[96:99],v[36:39]
s_waitcnt lgkmcnt(5)
v_and_b32 v169,s73,v160
v_lshlrev_b32 v170,16,v161
v_mfma_f32_16x16x32_bf16 v[32:35],a[72:75],v[100:103],v[32:35]
ds_read_b128 v[124:127],v6 offset:1024
v_and_b32 v171,s73,v161
v_mfma_f32_16x16x32_bf16 v[36:39],a[76:79],v[100:103],v[36:39]
s_waitcnt lgkmcnt(5)
v_lshlrev_b32 v172,16,v162
v_and_b32 v173,s73,v162
v_mfma_f32_16x16x32_bf16 v[32:35],a[80:83],v[104:107],v[32:35]
ds_read_b128 v[64:67],v6 offset:2048
v_lshlrev_b32 v174,16,v163
v_mfma_f32_16x16x32_bf16 v[36:39],a[84:87],v[104:107],v[36:39]
s_waitcnt lgkmcnt(5)
v_and_b32 v175,s73,v163
v_lshlrev_b32 v176,16,v164
v_mfma_f32_16x16x32_bf16 v[32:35],a[88:91],v[108:111],v[32:35]
ds_read_b128 v[68:71],v6 offset:3072
v_and_b32 v177,s73,v164
v_mfma_f32_16x16x32_bf16 v[36:39],a[92:95],v[108:111],v[36:39]
s_waitcnt lgkmcnt(5)
v_lshlrev_b32 v178,16,v165
v_and_b32 v179,s73,v165
v_mfma_f32_16x16x32_bf16 v[32:35],a[96:99],v[112:115],v[32:35]
s_add_u32 s84,s74,s75
s_add_u32 s85,s84,4096
ds_read_b128 v[72:75],v6 offset:4096
buffer_load_dwordx4 v[128:131],v0,s[20:23],s84 offen offset:0 sc1
buffer_load_dwordx4 v[132:135],v0,s[20:23],s84 offen offset:1024 sc1
v_mfma_f32_16x16x32_bf16 v[36:39],a[100:103],v[112:115],v[36:39]
s_waitcnt lgkmcnt(5)
buffer_load_dwordx4 v[136:139],v0,s[20:23],s84 offen offset:2048 sc1
v_lshlrev_b32 v180,16,v166
v_mfma_f32_16x16x32_bf16 v[32:35],a[104:107],v[116:119],v[32:35]
ds_read_b128 v[76:79],v6 offset:5120
v_and_b32 v181,s73,v166
v_mfma_f32_16x16x32_bf16 v[36:39],a[108:111],v[116:119],v[36:39]
s_waitcnt lgkmcnt(5)
buffer_load_dwordx4 v[140:143],v0,s[20:23],s84 offen offset:3072 sc1
v_lshlrev_b32 v182,16,v167
v_mfma_f32_16x16x32_bf16 v[32:35],a[112:115],v[120:123],v[32:35]
ds_read_b128 v[80:83],v6 offset:6144
v_and_b32 v183,s73,v167
v_mfma_f32_16x16x32_bf16 v[36:39],a[116:119],v[120:123],v[36:39]
s_waitcnt lgkmcnt(5)
buffer_load_dwordx4 v[144:147],v0,s[20:23],s85 offen offset:0 sc1
v_add_f32 v212,v212,v176
v_mfma_f32_16x16x32_bf16 v[32:35],a[120:123],v[124:127],v[32:35]
ds_read_b128 v[84:87],v7 offset:0
v_add_f32 v213,v213,v177
v_mfma_f32_16x16x32_bf16 v[36:39],a[124:127],v[124:127],v[36:39]
s_waitcnt lgkmcnt(5)
buffer_load_dwordx4 v[148:151],v0,s[20:23],s85 offen offset:1024 sc1
v_add_f32 v214,v214,v178
v_mfma_f32_16x16x32_bf16 v[32:35],a[128:131],v[64:67],v[32:35]
ds_read_b128 v[88:91],v7 offset:1024
v_add_f32 v215,v215,v179
v_mfma_f32_16x16x32_bf16 v[36:39],a[132:135],v[64:67],v[36:39]
s_waitcnt lgkmcnt(5)
v_add_f32 v216,v216,v180
v_add_f32 v217,v217,v181
v_mfma_f32_16x16x32_bf16 v[32:35],a[136:139],v[68:71],v[32:35]
ds_read_b128 v[92:95],v7 offset:2048
v_add_f32 v218,v218,v182
v_mfma_f32_16x16x32_bf16 v[36:39],a[140:143],v[68:71],v[36:39]
s_waitcnt lgkmcnt(5)
buffer_load_dword v16,v2,s[20:23],s68 offen sc1
v_add_f32 v219,v219,v183
v_mfma_f32_16x16x32_bf16 v[32:35],a[144:147],v[72:75],v[32:35]
ds_read_b128 v[96:99],v7 offset:3072
v_fma_f32 v168,v212,v152,v168
v_mfma_f32_16x16x32_bf16 v[36:39],a[148:151],v[72:75],v[36:39]
s_waitcnt lgkmcnt(5)
v_fma_f32 v169,v213,v153,v169
v_fma_f32 v170,v214,v154,v170
v_mfma_f32_16x16x32_bf16 v[32:35],a[152:155],v[76:79],v[32:35]
ds_read_b128 v[100:103],v7 offset:4096
v_fma_f32 v171,v215,v155,v171
v_mfma_f32_16x16x32_bf16 v[36:39],a[156:159],v[76:79],v[36:39]
s_waitcnt lgkmcnt(5)
v_fma_f32 v172,v216,v156,v172
v_fma_f32 v173,v217,v157,v173
v_mfma_f32_16x16x32_bf16 v[32:35],a[160:163],v[80:83],v[32:35]
ds_read_b128 v[104:107],v7 offset:5120
v_fma_f32 v174,v218,v158,v174
v_mfma_f32_16x16x32_bf16 v[36:39],a[164:167],v[80:83],v[36:39]
s_waitcnt lgkmcnt(5)
v_fma_f32 v175,v219,v159,v175
v_mfma_f32_16x16x32_bf16 v[32:35],a[168:171],v[84:87],v[32:35]
ds_read_b128 v[108:111],v7 offset:6144
v_mfma_f32_16x16x32_bf16 v[36:39],a[172:175],v[84:87],v[36:39]
s_waitcnt lgkmcnt(5)
s_add_u32 s55,s55,32768
buffer_load_dwordx4 v[160:163],v0,s[20:23],s82 offen
v_mfma_f32_16x16x32_bf16 v[32:35],a[176:179],v[88:91],v[32:35]
s_and_b32 s55,s55,0x1ffff
s_add_u32 s64,s82,13631488
buffer_load_dwordx4 v[164:167],v0,s[20:23],s64 offen
v_mfma_f32_16x16x32_bf16 v[36:39],a[180:183],v[88:91],v[36:39]
s_waitcnt lgkmcnt(4)
s_add_u32 s82,s82,32768
v_add_u32 v4,s55,v8
v_mfma_f32_16x16x32_bf16 v[32:35],a[184:187],v[92:95],v[32:35]
s_waitcnt vmcnt(3)
s_cmp_eq_u32 s77,0
s_cbranch_scc1 go_275
ck_273:
v_max3_u32 v184,v128,v129,v130
v_max3_u32 v185,v140,v141,v142
v_max3_u32 v184,v184,v131,v132
v_max3_u32 v185,v185,v143,v144
v_max3_u32 v184,v184,v133,v134
v_max3_u32 v185,v185,v145,v146
v_max3_u32 v184,v184,v135,v136
v_max3_u32 v185,v185,v147,v148
v_max3_u32 v184,v184,v137,v138
v_max3_u32 v185,v185,v149,v150
v_max3_u32 v184,v184,v139,v151
v_max_u32 v184,v184,v185
v_cmp_eq_u32 vcc,-1,v184
s_cbranch_vccnz rt_274
go_275:
v_mfma_f32_16x16x32_bf16 v[36:39],a[188:191],v[92:95],v[36:39]
s_waitcnt lgkmcnt(3)
v_add_u32 v5,s55,v9
v_add_u32 v6,s55,v10
v_add_f32 v128,v128,v136
v_mfma_f32_16x16x32_bf16 v[32:35],a[192:195],v[96:99],v[32:35]
v_add_u32 v7,s55,v11
v_add_f32 v129,v129,v137
v_add_f32 v130,v130,v138
v_mfma_f32_16x16x32_bf16 v[36:39],a[196:199],v[96:99],v[36:39]
s_waitcnt lgkmcnt(2)
v_add_f32 v131,v131,v139
v_add_f32 v132,v132,v140
v_add_f32 v133,v133,v141
v_mfma_f32_16x16x32_bf16 v[32:35],a[200:203],v[100:103],v[32:35]
v_add_f32 v134,v134,v142
v_add_f32 v135,v135,v143
v_add_f32 v128,v128,v144
v_mfma_f32_16x16x32_bf16 v[36:39],a[204:207],v[100:103],v[36:39]
s_waitcnt lgkmcnt(1)
v_add_f32 v129,v129,v145
v_add_f32 v130,v130,v146
v_add_f32 v131,v131,v147
v_mfma_f32_16x16x32_bf16 v[32:35],a[208:211],v[104:107],v[32:35]
v_add_f32 v132,v132,v148
v_add_f32 v133,v133,v149
v_add_f32 v134,v134,v150
v_mfma_f32_16x16x32_bf16 v[36:39],a[212:215],v[104:107],v[36:39]
s_waitcnt lgkmcnt(0)
v_add_f32 v135,v135,v151
v_fma_f32 v168,v128,v152,v168
v_fma_f32 v169,v129,v153,v169
v_mfma_f32_16x16x32_bf16 v[40:43],a[216:219],v[108:111],v[32:35]
v_fma_f32 v170,v130,v154,v170
v_fma_f32 v171,v131,v155,v171
v_fma_f32 v172,v132,v156,v172
v_mfma_f32_16x16x32_bf16 v[44:47],a[220:223],v[108:111],v[36:39]
s_waitcnt vmcnt(2)
v_fma_f32 v173,v133,v157,v173
v_fma_f32 v174,v134,v158,v174
v_fma_f32 v175,v135,v159,v175
v_cvt_pk_bf16_f32 v176,v168,v169
v_cvt_pk_bf16_f32 v177,v170,v171
v_cvt_pk_bf16_f32 v178,v172,v173
v_cvt_pk_bf16_f32 v179,v174,v175
s_and_b32 s64,s66,0xffff8000
buffer_store_dwordx4 v[176:179],v22,s[24:27],s64 offen
s_cmp_eq_u32 s56,1
s_cbranch_scc1 b1_267
buffer_store_dwordx4 v[204:207],v21,s[20:23],s84 offen offset:0
buffer_store_dwordx4 v[204:207],v21,s[20:23],s84 offen offset:1024
b2_268:
s_cmp_eq_u32 s56,1
s_cbranch_scc1 b1_269
buffer_store_dwordx4 v[204:207],v21,s[20:23],s84 offen offset:2048
buffer_store_dwordx4 v[204:207],v21,s[20:23],s84 offen offset:3072
b2_270:
s_cmp_eq_u32 s56,1
s_cbranch_scc1 b1_271
buffer_store_dwordx4 v[204:207],v21,s[20:23],s85 offen offset:0
buffer_store_dwordx4 v[204:207],v21,s[20:23],s85 offen offset:1024
b2_272:
s_mul_i32 s64,s77,32768
s_add_u32 s66,s66,s64
s_mul_i32 s64,s77,6144
s_add_u32 s75,s75,s64
s_cmp_eq_u32 s75,24576
s_cselect_b32 s75,0,s75
s_add_u32 s63,s63,s77
s_mov_b32 s77,0
v_cmp_gt_u32 vcc,s71,v16
s_add_u32 s60,s60,1
endN_257:
s_cbranch_vccnz nb_236
s_mov_b32 m0,s70
s_nop 0
buffer_load_dwordx4 v3,s[20:23],s61 offen offset:0 lds
buffer_load_dwordx4 v3,s[20:23],s61 offen offset:1024 lds
buffer_load_dwordx4 v3,s[20:23],s61 offen offset:2048 lds
buffer_load_dwordx4 v3,s[20:23],s61 offen offset:3072 lds
s_add_u32 m0,s70,4096
s_nop 0
buffer_load_dwordx4 v3,s[20:23],s62 offen offset:0 lds
buffer_load_dwordx4 v3,s[20:23],s62 offen offset:1024 lds
buffer_load_dwordx4 v3,s[20:23],s62 offen offset:2048 lds
s_add_u32 s61,s61,114688
s_add_u32 s62,s62,114688
s_add_u32 s70,s70,32768
s_and_b32 s70,s70,0x1ffff
v_mov_b32 v212,v40
v_mov_b32 v213,v41
v_mov_b32 v214,v42
v_mov_b32 v215,v43
v_mov_b32 v216,v44
v_mov_b32 v217,v45
v_mov_b32 v218,v46
v_mov_b32 v219,v47
s_mov_b32 s77,1
s_branch dec_235
nb_236:
s_nop 3
s_mov_b32 s77,1
s_add_u32 s84,s74,s75
s_add_u32 s85,s84,4096
buffer_load_dwordx4 v[128:131],v0,s[20:23],s84 offen offset:0 sc1
buffer_load_dwordx4 v[132:135],v0,s[20:23],s84 offen offset:1024 sc1
buffer_load_dwordx4 v[136:139],v0,s[20:23],s84 offen offset:2048 sc1
buffer_load_dwordx4 v[140:143],v0,s[20:23],s84 offen offset:3072 sc1
buffer_load_dwordx4 v[144:147],v0,s[20:23],s85 offen offset:0 sc1
buffer_load_dwordx4 v[148:151],v0,s[20:23],s85 offen offset:1024 sc1
s_waitcnt vmcnt(13)
s_cmp_eq_u32 s77,0
s_cselect_b32 s57,2.0,0
v_or_b32 v21,s57,v0
v_or_b32 v22,s57,v18
v_lshlrev_b32 v168,16,v160
v_and_b32 v169,s73,v160
v_lshlrev_b32 v170,16,v161
v_and_b32 v171,s73,v161
v_lshlrev_b32 v172,16,v162
v_and_b32 v173,s73,v162
v_lshlrev_b32 v174,16,v163
v_and_b32 v175,s73,v163
v_lshlrev_b32 v176,16,v164
v_and_b32 v177,s73,v164
v_lshlrev_b32 v178,16,v165
v_and_b32 v179,s73,v165
v_lshlrev_b32 v180,16,v166
v_and_b32 v181,s73,v166
v_lshlrev_b32 v182,16,v167
v_and_b32 v183,s73,v167
v_pk_add_f32 v[40:41],v[40:41],v[176:177]
v_pk_add_f32 v[42:43],v[42:43],v[178:179]
v_pk_add_f32 v[44:45],v[44:45],v[180:181]
v_pk_add_f32 v[46:47],v[46:47],v[182:183]
v_pk_fma_f32 v[168:169],v[40:41],v[152:153],v[168:169]
v_pk_fma_f32 v[170:171],v[42:43],v[154:155],v[170:171]
v_pk_fma_f32 v[172:173],v[44:45],v[156:157],v[172:173]
v_pk_fma_f32 v[174:175],v[46:47],v[158:159],v[174:175]
s_waitcnt vmcnt(0)
s_cmp_eq_u32 s77,0
s_cbranch_scc1 go_284
ck_282:
v_max3_u32 v184,v128,v129,v130
v_max3_u32 v185,v140,v141,v142
v_max3_u32 v184,v184,v131,v132
v_max3_u32 v185,v185,v143,v144
v_max3_u32 v184,v184,v133,v134
v_max3_u32 v185,v185,v145,v146
v_max3_u32 v184,v184,v135,v136
v_max3_u32 v185,v185,v147,v148
v_max3_u32 v184,v184,v137,v138
v_max3_u32 v185,v185,v149,v150
v_max3_u32 v184,v184,v139,v151
v_max_u32 v184,v184,v185
v_cmp_eq_u32 vcc,-1,v184
s_cbranch_vccnz rt_283
go_284:
buffer_load_dword v16,v2,s[20:23],s68 offen sc1
v_pk_add_f32 v[128:129],v[128:129],v[136:137]
v_pk_add_f32 v[130:131],v[130:131],v[138:139]
v_pk_add_f32 v[132:133],v[132:133],v[140:141]
v_pk_add_f32 v[134:135],v[134:135],v[142:143]
v_pk_add_f32 v[128:129],v[128:129],v[144:145]
v_pk_add_f32 v[130:131],v[130:131],v[146:147]
v_pk_add_f32 v[132:133],v[132:133],v[148:149]
v_pk_add_f32 v[134:135],v[134:135],v[150:151]
v_pk_fma_f32 v[168:169],v[128:129],v[152:153],v[168:169]
v_pk_fma_f32 v[170:171],v[130:131],v[154:155],v[170:171]
v_pk_fma_f32 v[172:173],v[132:133],v[156:157],v[172:173]
v_pk_fma_f32 v[174:175],v[134:135],v[158:159],v[174:175]
v_cvt_pk_bf16_f32 v176,v168,v169
v_cvt_pk_bf16_f32 v177,v170,v171
v_cvt_pk_bf16_f32 v178,v172,v173
v_cvt_pk_bf16_f32 v179,v174,v175
s_and_b32 s64,s66,0xffff8000
buffer_store_dwordx4 v[176:179],v22,s[24:27],s64 offen
s_cmp_eq_u32 s56,1
s_cbranch_scc1 b1_276
buffer_store_dwordx4 v[204:207],v21,s[20:23],s84 offen offset:0
buffer_store_dwordx4 v[204:207],v21,s[20:23],s84 offen offset:1024
b2_277:
s_cmp_eq_u32 s56,1
s_cbranch_scc1 b1_278
buffer_store_dwordx4 v[204:207],v21,s[20:23],s84 offen offset:2048
buffer_store_dwordx4 v[204:207],v21,s[20:23],s84 offen offset:3072
b2_279:
s_cmp_eq_u32 s56,1
s_cbranch_scc1 b1_280
buffer_store_dwordx4 v[204:207],v21,s[20:23],s85 offen offset:0
buffer_store_dwordx4 v[204:207],v21,s[20:23],s85 offen offset:1024
b2_281:
s_mul_i32 s64,s77,32768
s_add_u32 s66,s66,s64
s_mul_i32 s64,s77,6144
s_add_u32 s75,s75,s64
s_cmp_eq_u32 s75,24576
s_cselect_b32 s75,0,s75
s_add_u32 s63,s63,s77
s_mov_b32 s77,0
s_waitcnt vmcnt(7)
v_cmp_gt_u32 vcc,s71,v16
s_cbranch_vccz lag_234
s_cmp_ge_u32 s60,128
s_cbranch_scc1 done_180
plp_287:
buffer_load_dword v16,v2,s[20:23],s68 offen sc1
s_waitcnt vmcnt(0)
v_cmp_gt_u32 vcc,s71,v16
s_cbranch_vccz pok_288
s_sleep 4
s_sub_u32 s90,s90,1
s_cmp_gt_i32 s90,0
s_cbranch_scc1 plp_287
pok_288:
s_branch lag_234
b1_205:
s_nop 7
buffer_store_dwordx4 v[40:43],v0,s[20:23],s64 offen offset:0 sc1
buffer_store_dwordx4 v[44:47],v0,s[20:23],s64 offen offset:1024 sc1
s_branch b2_206
b1_208:
s_nop 7
buffer_store_dwordx4 v[40:43],v0,s[20:23],s64 offen offset:0 sc1
buffer_store_dwordx4 v[44:47],v0,s[20:23],s64 offen offset:1024 sc1
s_branch b2_209
b1_210:
s_nop 7
buffer_store_dwordx4 v[40:43],v0,s[20:23],s64 offen offset:0 sc1
buffer_store_dwordx4 v[44:47],v0,s[20:23],s64 offen offset:1024 sc1
s_branch b2_211
b1_212:
s_nop 7
buffer_store_dwordx4 v[40:43],v0,s[20:23],s64 offen offset:0 sc1
buffer_store_dwordx4 v[44:47],v0,s[20:23],s64 offen offset:1024 sc1
s_branch b2_213
b1_239:
s_nop 7
buffer_store_dwordx4 v[204:207],v21,s[20:23],s84 offen offset:0 sc1
buffer_store_dwordx4 v[204:207],v21,s[20:23],s84 offen offset:1024 sc1
s_branch b2_240
b1_241:
s_nop 7
buffer_store_dwordx4 v[204:207],v21,s[20:23],s84 offen offset:2048 sc1
buffer_store_dwordx4 v[204:207],v21,s[20:23],s84 offen offset:3072 sc1
s_branch b2_242
b1_243:
s_nop 7
buffer_store_dwordx4 v[204:207],v21,s[20:23],s85 offen offset:0 sc1
buffer_store_dwordx4 v[204:207],v21,s[20:23],s85 offen offset:1024 sc1
s_branch b2_244
rt_246:
s_sub_u32 s90,s90,1
s_cmp_gt_i32 s90,0
s_cbranch_scc0 go_247
s_add_u32 s84,s74,s75
s_add_u32 s85,s84,4096
buffer_load_dwordx4 v[128:131],v0,s[20:23],s84 offen offset:0 sc1
buffer_load_dwordx4 v[132:135],v0,s[20:23],s84 offen offset:1024 sc1
buffer_load_dwordx4 v[136:139],v0,s[20:23],s84 offen offset:2048 sc1
buffer_load_dwordx4 v[140:143],v0,s[20:23],s84 offen offset:3072 sc1
buffer_load_dwordx4 v[144:147],v0,s[20:23],s85 offen offset:0 sc1
buffer_load_dwordx4 v[148:151],v0,s[20:23],s85 offen offset:1024 sc1
s_waitcnt vmcnt(0)
s_branch ck_245
b1_248:
s_nop 7
buffer_store_dwordx4 v[204:207],v21,s[20:23],s84 offen offset:0 sc1
buffer_store_dwordx4 v[204:207],v21,s[20:23],s84 offen offset:1024 sc1
s_branch b2_249
b1_250:
s_nop 7
buffer_store_dwordx4 v[204:207],v21,s[20:23],s84 offen offset:2048 sc1
buffer_store_dwordx4 v[204:207],v21,s[20:23],s84 offen offset:3072 sc1
s_branch b2_251
b1_252:
s_nop 7
buffer_store_dwordx4 v[204:207],v21,s[20:23],s85 offen offset:0 sc1
buffer_store_dwordx4 v[204:207],v21,s[20:23],s85 offen offset:1024 sc1
s_branch b2_253
rt_255:
s_sub_u32 s90,s90,1
s_cmp_gt_i32 s90,0
s_cbranch_scc0 go_256
s_add_u32 s84,s74,s75
s_add_u32 s85,s84,4096
buffer_load_dwordx4 v[128:131],v0,s[20:23],s84 offen offset:0 sc1
buffer_load_dwordx4 v[132:135],v0,s[20:23],s84 offen offset:1024 sc1
buffer_load_dwordx4 v[136:139],v0,s[20:23],s84 offen offset:2048 sc1
buffer_load_dwordx4 v[140:143],v0,s[20:23],s84 offen offset:3072 sc1
buffer_load_dwordx4 v[144:147],v0,s[20:23],s85 offen offset:0 sc1
buffer_load_dwordx4 v[148:151],v0,s[20:23],s85 offen offset:1024 sc1
s_waitcnt vmcnt(0)
s_branch ck_254
b1_258:
s_nop 7
buffer_store_dwordx4 v[204:207],v21,s[20:23],s84 offen offset:0 sc1
buffer_store_dwordx4 v[204:207],v21,s[20:23],s84 offen offset:1024 sc1
s_branch b2_259
b1_260:
s_nop 7
buffer_store_dwordx4 v[204:207],v21,s[20:23],s84 offen offset:2048 sc1
buffer_store_dwordx4 v[204:207],v21,s[20:23],s84 offen offset:3072 sc1
s_branch b2_261
b1_262:
s_nop 7
buffer_store_dwordx4 v[204:207],v21,s[20:23],s85 offen offset:0 sc1
buffer_store_dwordx4 v[204:207],v21,s[20:23],s85 offen offset:1024 sc1
s_branch b2_263
rt_265:
s_sub_u32 s90,s90,1
s_cmp_gt_i32 s90,0
s_cbranch_scc0 go_266
s_add_u32 s84,s74,s75
s_add_u32 s85,s84,4096
buffer_load_dwordx4 v[128:131],v0,s[20:23],s84 offen offset:0 sc1
buffer_load_dwordx4 v[132:135],v0,s[20:23],s84 offen offset:1024 sc1
buffer_load_dwordx4 v[136:139],v0,s[20:23],s84 offen offset:2048 sc1
buffer_load_dwordx4 v[140:143],v0,s[20:23],s84 offen offset:3072 sc1
buffer_load_dwordx4 v[144:147],v0,s[20:23],s85 offen offset:0 sc1
buffer_load_dwordx4 v[148:151],v0,s[20:23],s85 offen offset:1024 sc1
s_waitcnt vmcnt(0)
s_branch ck_264
b1_267:
s_nop 7
buffer_store_dwordx4 v[204:207],v21,s[20:23],s84 offen offset:0 sc1
buffer_store_dwordx4 v[204:207],v21,s[20:23],s84 offen offset:1024 sc1
s_branch b2_268
b1_269:
s_nop 7
buffer_store_dwordx4 v[204:207],v21,s[20:23],s84 offen offset:2048 sc1
buffer_store_dwordx4 v[204:207],v21,s[20:23],s84 offen offset:3072 sc1
s_branch b2_270
b1_271:
s_nop 7
buffer_store_dwordx4 v[204:207],v21,s[20:23],s85 offen offset:0 sc1
buffer_store_dwordx4 v[204:207],v21,s[20:23],s85 offen offset:1024 sc1
s_branch b2_272
rt_274:
s_sub_u32 s90,s90,1
s_cmp_gt_i32 s90,0
s_cbranch_scc0 go_275
s_add_u32 s84,s74,s75
s_add_u32 s85,s84,4096
buffer_load_dwordx4 v[128:131],v0,s[20:23],s84 offen offset:0 sc1
buffer_load_dwordx4 v[132:135],v0,s[20:23],s84 offen offset:1024 sc1
buffer_load_dwordx4 v[136:139],v0,s[20:23],s84 offen offset:2048 sc1
buffer_load_dwordx4 v[140:143],v0,s[20:23],s84 offen offset:3072 sc1
buffer_load_dwordx4 v[144:147],v0,s[20:23],s85 offen offset:0 sc1
buffer_load_dwordx4 v[148:151],v0,s[20:23],s85 offen offset:1024 sc1
s_waitcnt vmcnt(0)
s_branch ck_273
b1_276:
s_nop 7
buffer_store_dwordx4 v[204:207],v21,s[20:23],s84 offen offset:0 sc1
buffer_store_dwordx4 v[204:207],v21,s[20:23],s84 offen offset:1024 sc1
s_branch b2_277
b1_278:
s_nop 7
buffer_store_dwordx4 v[204:207],v21,s[20:23],s84 offen offset:2048 sc1
buffer_store_dwordx4 v[204:207],v21,s[20:23],s84 offen offset:3072 sc1
s_branch b2_279
b1_280:
s_nop 7
buffer_store_dwordx4 v[204:207],v21,s[20:23],s85 offen offset:0 sc1
buffer_store_dwordx4 v[204:207],v21,s[20:23],s85 offen offset:1024 sc1
s_branch b2_281
rt_283:
s_sub_u32 s90,s90,1
s_cmp_gt_i32 s90,0
s_cbranch_scc0 go_284
s_add_u32 s84,s74,s75
s_add_u32 s85,s84,4096
buffer_load_dwordx4 v[128:131],v0,s[20:23],s84 offen offset:0 sc1
buffer_load_dwordx4 v[132:135],v0,s[20:23],s84 offen offset:1024 sc1
buffer_load_dwordx4 v[136:139],v0,s[20:23],s84 offen offset:2048 sc1
buffer_load_dwordx4 v[140:143],v0,s[20:23],s84 offen offset:3072 sc1
buffer_load_dwordx4 v[144:147],v0,s[20:23],s85 offen offset:0 sc1
buffer_load_dwordx4 v[148:151],v0,s[20:23],s85 offen offset:1024 sc1
s_waitcnt vmcnt(0)
s_branch ck_282
done_180:
s_endpgm
fl_w3:
v_and_b32 v21,15,v1
v_lshrrev_b32 v22,4,v1
v_lshrrev_b32 v23,2,v21
v_and_b32 v24,3,v21
s_lshl_b32 s61,s50,15
v_lshl_add_u32 v25,v22,3,v23
s_load_dwordx2 s[4:5],s[0:1],80
s_mov_b32 s52,0
s_mov_b32 s53,s59
s_mul_i32 s54,s52,7340032
s_lshl_b32 s64,s53,8
s_add_u32 s54,s54,s64
s_lshl_b32 s64,s50,6
s_add_u32 s54,s54,s64
s_waitcnt lgkmcnt(0)
s_mov_b32 s28,s4
s_and_b32 s29,s5,0xffff
s_mov_b32 s30,0x700000
s_mov_b32 s31,0x20000
v_lshrrev_b32 v26,2,v1
v_and_b32 v27,3,v1
v_mul_u32_u24 v16,7168,v26
v_lshl_add_u32 v16,v27,4,v16
v_lshlrev_b32 v17,6,v25
v_lshl_add_u32 v17,v24,4,v17
v_add_u32 v17,s61,v17
s_xor_b32 s62,s50,0
s_mul_i32 s62,s62,1835008
s_add_u32 s62,s62,s54
s_add_u32 m0,s61,0
s_nop 0
buffer_load_dwordx4 v16,s[28:31],s62 offen lds
s_add_u32 s62,s62,114688
s_add_u32 m0,m0,1024
s_waitcnt vmcnt(2)
buffer_load_dwordx4 v16,s[28:31],s62 offen lds
s_add_u32 s62,s62,114688
s_add_u32 m0,m0,1024
s_waitcnt vmcnt(2)
buffer_load_dwordx4 v16,s[28:31],s62 offen lds
s_add_u32 s62,s62,114688
s_add_u32 m0,m0,1024
s_waitcnt vmcnt(2)
buffer_load_dwordx4 v16,s[28:31],s62 offen lds
s_add_u32 s62,s62,114688
s_add_u32 m0,m0,1024
s_waitcnt vmcnt(2)
buffer_load_dwordx4 v16,s[28:31],s62 offen lds
s_add_u32 s62,s62,114688
s_add_u32 m0,m0,1024
s_waitcnt vmcnt(2)
buffer_load_dwordx4 v16,s[28:31],s62 offen lds
s_add_u32 s62,s62,114688
s_add_u32 m0,m0,1024
s_waitcnt vmcnt(2)
buffer_load_dwordx4 v16,s[28:31],s62 offen lds
s_add_u32 s62,s62,114688
s_add_u32 m0,m0,1024
s_waitcnt vmcnt(2)
buffer_load_dwordx4 v16,s[28:31],s62 offen lds
s_add_u32 s62,s62,114688
s_add_u32 m0,m0,1024
s_waitcnt vmcnt(2)
buffer_load_dwordx4 v16,s[28:31],s62 offen lds
s_add_u32 s62,s62,114688
s_add_u32 m0,m0,1024
s_waitcnt vmcnt(2)
buffer_load_dwordx4 v16,s[28:31],s62 offen lds
s_add_u32 s62,s62,114688
s_add_u32 m0,m0,1024
s_waitcnt vmcnt(2)
buffer_load_dwordx4 v16,s[28:31],s62 offen lds
s_add_u32 s62,s62,114688
s_add_u32 m0,m0,1024
s_waitcnt vmcnt(2)
buffer_load_dwordx4 v16,s[28:31],s62 offen lds
s_add_u32 s62,s62,114688
s_add_u32 m0,m0,1024
s_waitcnt vmcnt(2)
buffer_load_dwordx4 v16,s[28:31],s62 offen lds
s_add_u32 s62,s62,114688
s_add_u32 m0,m0,1024
s_waitcnt vmcnt(2)
buffer_load_dwordx4 v16,s[28:31],s62 offen lds
s_add_u32 s62,s62,114688
s_add_u32 m0,m0,1024
s_waitcnt vmcnt(2)
buffer_load_dwordx4 v16,s[28:31],s62 offen lds
s_add_u32 s62,s62,114688
s_add_u32 m0,m0,1024
s_waitcnt vmcnt(2)
buffer_load_dwordx4 v16,s[28:31],s62 offen lds
s_waitcnt vmcnt(2)
s_xor_b32 s62,s50,1
s_mul_i32 s62,s62,1835008
s_add_u32 s62,s62,s54
s_add_u32 m0,s61,16384
s_nop 0
buffer_load_dwordx4 v16,s[28:31],s62 offen lds
s_add_u32 s62,s62,114688
s_add_u32 m0,m0,1024
s_waitcnt vmcnt(2)
buffer_load_dwordx4 v16,s[28:31],s62 offen lds
s_add_u32 s62,s62,114688
s_add_u32 m0,m0,1024
s_waitcnt vmcnt(2)
buffer_load_dwordx4 v16,s[28:31],s62 offen lds
s_add_u32 s62,s62,114688
s_add_u32 m0,m0,1024
s_waitcnt vmcnt(2)
buffer_load_dwordx4 v16,s[28:31],s62 offen lds
s_add_u32 s62,s62,114688
s_add_u32 m0,m0,1024
s_waitcnt vmcnt(2)
buffer_load_dwordx4 v16,s[28:31],s62 offen lds
s_add_u32 s62,s62,114688
s_add_u32 m0,m0,1024
s_waitcnt vmcnt(2)
buffer_load_dwordx4 v16,s[28:31],s62 offen lds
s_add_u32 s62,s62,114688
s_add_u32 m0,m0,1024
s_waitcnt vmcnt(2)
buffer_load_dwordx4 v16,s[28:31],s62 offen lds
s_add_u32 s62,s62,114688
s_add_u32 m0,m0,1024
s_waitcnt vmcnt(2)
buffer_load_dwordx4 v16,s[28:31],s62 offen lds
s_add_u32 s62,s62,114688
s_add_u32 m0,m0,1024
s_waitcnt vmcnt(2)
buffer_load_dwordx4 v16,s[28:31],s62 offen lds
s_add_u32 s62,s62,114688
s_add_u32 m0,m0,1024
s_waitcnt vmcnt(2)
buffer_load_dwordx4 v16,s[28:31],s62 offen lds
s_add_u32 s62,s62,114688
s_add_u32 m0,m0,1024
s_waitcnt vmcnt(2)
buffer_load_dwordx4 v16,s[28:31],s62 offen lds
s_add_u32 s62,s62,114688
s_add_u32 m0,m0,1024
s_waitcnt vmcnt(2)
buffer_load_dwordx4 v16,s[28:31],s62 offen lds
s_add_u32 s62,s62,114688
s_add_u32 m0,m0,1024
s_waitcnt vmcnt(2)
buffer_load_dwordx4 v16,s[28:31],s62 offen lds
s_add_u32 s62,s62,114688
s_add_u32 m0,m0,1024
s_waitcnt vmcnt(2)
buffer_load_dwordx4 v16,s[28:31],s62 offen lds
s_add_u32 s62,s62,114688
s_add_u32 m0,m0,1024
s_waitcnt vmcnt(2)
buffer_load_dwordx4 v16,s[28:31],s62 offen lds
s_add_u32 s62,s62,114688
s_add_u32 m0,m0,1024
s_waitcnt vmcnt(2)
buffer_load_dwordx4 v16,s[28:31],s62 offen lds
s_waitcnt vmcnt(2)
s_waitcnt vmcnt(16)
ds_read_b64_tr_b16 a[0:1],v17 offset:0
ds_read_b64_tr_b16 a[2:3],v17 offset:256
ds_read_b64_tr_b16 a[4:5],v17 offset:8
ds_read_b64_tr_b16 a[6:7],v17 offset:264
ds_read_b64_tr_b16 a[8:9],v17 offset:2048
ds_read_b64_tr_b16 a[10:11],v17 offset:2304
ds_read_b64_tr_b16 a[12:13],v17 offset:2056
ds_read_b64_tr_b16 a[14:15],v17 offset:2312
ds_read_b64_tr_b16 a[16:17],v17 offset:4096
ds_read_b64_tr_b16 a[18:19],v17 offset:4352
ds_read_b64_tr_b16 a[20:21],v17 offset:4104
ds_read_b64_tr_b16 a[22:23],v17 offset:4360
s_waitcnt lgkmcnt(0)
ds_read_b64_tr_b16 a[24:25],v17 offset:6144
ds_read_b64_tr_b16 a[26:27],v17 offset:6400
ds_read_b64_tr_b16 a[28:29],v17 offset:6152
ds_read_b64_tr_b16 a[30:31],v17 offset:6408
ds_read_b64_tr_b16 a[32:33],v17 offset:8192
ds_read_b64_tr_b16 a[34:35],v17 offset:8448
ds_read_b64_tr_b16 a[36:37],v17 offset:8200
ds_read_b64_tr_b16 a[38:39],v17 offset:8456
ds_read_b64_tr_b16 a[40:41],v17 offset:10240
ds_read_b64_tr_b16 a[42:43],v17 offset:10496
ds_read_b64_tr_b16 a[44:45],v17 offset:10248
ds_read_b64_tr_b16 a[46:47],v17 offset:10504
s_waitcnt lgkmcnt(0)
ds_read_b64_tr_b16 a[48:49],v17 offset:12288
ds_read_b64_tr_b16 a[50:51],v17 offset:12544
ds_read_b64_tr_b16 a[52:53],v17 offset:12296
ds_read_b64_tr_b16 a[54:55],v17 offset:12552
ds_read_b64_tr_b16 a[56:57],v17 offset:14336
ds_read_b64_tr_b16 a[58:59],v17 offset:14592
ds_read_b64_tr_b16 a[60:61],v17 offset:14344
ds_read_b64_tr_b16 a[62:63],v17 offset:14600
s_waitcnt lgkmcnt(0)
s_xor_b32 s62,s50,2
s_mul_i32 s62,s62,1835008
s_add_u32 s62,s62,s54
s_add_u32 m0,s61,0
s_nop 0
buffer_load_dwordx4 v16,s[28:31],s62 offen lds
s_add_u32 s62,s62,114688
s_add_u32 m0,m0,1024
s_waitcnt vmcnt(2)
buffer_load_dwordx4 v16,s[28:31],s62 offen lds
s_add_u32 s62,s62,114688
s_add_u32 m0,m0,1024
s_waitcnt vmcnt(2)
buffer_load_dwordx4 v16,s[28:31],s62 offen lds
s_add_u32 s62,s62,114688
s_add_u32 m0,m0,1024
s_waitcnt vmcnt(2)
buffer_load_dwordx4 v16,s[28:31],s62 offen lds
s_add_u32 s62,s62,114688
s_add_u32 m0,m0,1024
s_waitcnt vmcnt(2)
buffer_load_dwordx4 v16,s[28:31],s62 offen lds
s_add_u32 s62,s62,114688
s_add_u32 m0,m0,1024
s_waitcnt vmcnt(2)
buffer_load_dwordx4 v16,s[28:31],s62 offen lds
s_add_u32 s62,s62,114688
s_add_u32 m0,m0,1024
s_waitcnt vmcnt(2)
buffer_load_dwordx4 v16,s[28:31],s62 offen lds
s_add_u32 s62,s62,114688
s_add_u32 m0,m0,1024
s_waitcnt vmcnt(2)
buffer_load_dwordx4 v16,s[28:31],s62 offen lds
s_add_u32 s62,s62,114688
s_add_u32 m0,m0,1024
s_waitcnt vmcnt(2)
buffer_load_dwordx4 v16,s[28:31],s62 offen lds
s_add_u32 s62,s62,114688
s_add_u32 m0,m0,1024
s_waitcnt vmcnt(2)
buffer_load_dwordx4 v16,s[28:31],s62 offen lds
s_add_u32 s62,s62,114688
s_add_u32 m0,m0,1024
s_waitcnt vmcnt(2)
buffer_load_dwordx4 v16,s[28:31],s62 offen lds
s_add_u32 s62,s62,114688
s_add_u32 m0,m0,1024
s_waitcnt vmcnt(2)
buffer_load_dwordx4 v16,s[28:31],s62 offen lds
s_add_u32 s62,s62,114688
s_add_u32 m0,m0,1024
s_waitcnt vmcnt(2)
buffer_load_dwordx4 v16,s[28:31],s62 offen lds
s_add_u32 s62,s62,114688
s_add_u32 m0,m0,1024
s_waitcnt vmcnt(2)
buffer_load_dwordx4 v16,s[28:31],s62 offen lds
s_add_u32 s62,s62,114688
s_add_u32 m0,m0,1024
s_waitcnt vmcnt(2)
buffer_load_dwordx4 v16,s[28:31],s62 offen lds
s_add_u32 s62,s62,114688
s_add_u32 m0,m0,1024
s_waitcnt vmcnt(2)
buffer_load_dwordx4 v16,s[28:31],s62 offen lds
s_waitcnt vmcnt(2)
s_waitcnt vmcnt(16)
ds_read_b64_tr_b16 a[64:65],v17 offset:16384
ds_read_b64_tr_b16 a[66:67],v17 offset:16640
ds_read_b64_tr_b16 a[68:69],v17 offset:16392
ds_read_b64_tr_b16 a[70:71],v17 offset:16648
ds_read_b64_tr_b16 a[72:73],v17 offset:18432
ds_read_b64_tr_b16 a[74:75],v17 offset:18688
ds_read_b64_tr_b16 a[76:77],v17 offset:18440
ds_read_b64_tr_b16 a[78:79],v17 offset:18696
ds_read_b64_tr_b16 a[80:81],v17 offset:20480
ds_read_b64_tr_b16 a[82:83],v17 offset:20736
ds_read_b64_tr_b16 a[84:85],v17 offset:20488
ds_read_b64_tr_b16 a[86:87],v17 offset:20744
s_waitcnt lgkmcnt(0)
ds_read_b64_tr_b16 a[88:89],v17 offset:22528
ds_read_b64_tr_b16 a[90:91],v17 offset:22784
ds_read_b64_tr_b16 a[92:93],v17 offset:22536
ds_read_b64_tr_b16 a[94:95],v17 offset:22792
ds_read_b64_tr_b16 a[96:97],v17 offset:24576
ds_read_b64_tr_b16 a[98:99],v17 offset:24832
ds_read_b64_tr_b16 a[100:101],v17 offset:24584
ds_read_b64_tr_b16 a[102:103],v17 offset:24840
ds_read_b64_tr_b16 a[104:105],v17 offset:26624
ds_read_b64_tr_b16 a[106:107],v17 offset:26880
ds_read_b64_tr_b16 a[108:109],v17 offset:26632
ds_read_b64_tr_b16 a[110:111],v17 offset:26888
s_waitcnt lgkmcnt(0)
ds_read_b64_tr_b16 a[112:113],v17 offset:28672
ds_read_b64_tr_b16 a[114:115],v17 offset:28928
ds_read_b64_tr_b16 a[116:117],v17 offset:28680
ds_read_b64_tr_b16 a[118:119],v17 offset:28936
ds_read_b64_tr_b16 a[120:121],v17 offset:30720
ds_read_b64_tr_b16 a[122:123],v17 offset:30976
ds_read_b64_tr_b16 a[124:125],v17 offset:30728
ds_read_b64_tr_b16 a[126:127],v17 offset:30984
s_waitcnt lgkmcnt(0)
s_xor_b32 s62,s50,3
s_mul_i32 s62,s62,1835008
s_add_u32 s62,s62,s54
s_add_u32 m0,s61,16384
s_nop 0
buffer_load_dwordx4 v16,s[28:31],s62 offen lds
s_add_u32 s62,s62,114688
s_add_u32 m0,m0,1024
s_waitcnt vmcnt(2)
buffer_load_dwordx4 v16,s[28:31],s62 offen lds
s_add_u32 s62,s62,114688
s_add_u32 m0,m0,1024
s_waitcnt vmcnt(2)
buffer_load_dwordx4 v16,s[28:31],s62 offen lds
s_add_u32 s62,s62,114688
s_add_u32 m0,m0,1024
s_waitcnt vmcnt(2)
buffer_load_dwordx4 v16,s[28:31],s62 offen lds
s_add_u32 s62,s62,114688
s_add_u32 m0,m0,1024
s_waitcnt vmcnt(2)
buffer_load_dwordx4 v16,s[28:31],s62 offen lds
s_add_u32 s62,s62,114688
s_add_u32 m0,m0,1024
s_waitcnt vmcnt(2)
buffer_load_dwordx4 v16,s[28:31],s62 offen lds
s_add_u32 s62,s62,114688
s_add_u32 m0,m0,1024
s_waitcnt vmcnt(2)
buffer_load_dwordx4 v16,s[28:31],s62 offen lds
s_add_u32 s62,s62,114688
s_add_u32 m0,m0,1024
s_waitcnt vmcnt(2)
buffer_load_dwordx4 v16,s[28:31],s62 offen lds
s_add_u32 s62,s62,114688
s_add_u32 m0,m0,1024
s_waitcnt vmcnt(2)
buffer_load_dwordx4 v16,s[28:31],s62 offen lds
s_add_u32 s62,s62,114688
s_add_u32 m0,m0,1024
s_waitcnt vmcnt(2)
buffer_load_dwordx4 v16,s[28:31],s62 offen lds
s_add_u32 s62,s62,114688
s_add_u32 m0,m0,1024
s_waitcnt vmcnt(2)
buffer_load_dwordx4 v16,s[28:31],s62 offen lds
s_add_u32 s62,s62,114688
s_add_u32 m0,m0,1024
s_waitcnt vmcnt(2)
buffer_load_dwordx4 v16,s[28:31],s62 offen lds
s_add_u32 s62,s62,114688
s_add_u32 m0,m0,1024
s_waitcnt vmcnt(2)
buffer_load_dwordx4 v16,s[28:31],s62 offen lds
s_add_u32 s62,s62,114688
s_add_u32 m0,m0,1024
s_waitcnt vmcnt(2)
buffer_load_dwordx4 v16,s[28:31],s62 offen lds
s_add_u32 s62,s62,114688
s_add_u32 m0,m0,1024
s_waitcnt vmcnt(2)
buffer_load_dwordx4 v16,s[28:31],s62 offen lds
s_add_u32 s62,s62,114688
s_add_u32 m0,m0,1024
s_waitcnt vmcnt(2)
buffer_load_dwordx4 v16,s[28:31],s62 offen lds
s_waitcnt vmcnt(2)
s_waitcnt vmcnt(16)
ds_read_b64_tr_b16 a[128:129],v17 offset:0
ds_read_b64_tr_b16 a[130:131],v17 offset:256
ds_read_b64_tr_b16 a[132:133],v17 offset:8
ds_read_b64_tr_b16 a[134:135],v17 offset:264
ds_read_b64_tr_b16 a[136:137],v17 offset:2048
ds_read_b64_tr_b16 a[138:139],v17 offset:2304
ds_read_b64_tr_b16 a[140:141],v17 offset:2056
ds_read_b64_tr_b16 a[142:143],v17 offset:2312
ds_read_b64_tr_b16 a[144:145],v17 offset:4096
ds_read_b64_tr_b16 a[146:147],v17 offset:4352
ds_read_b64_tr_b16 a[148:149],v17 offset:4104
ds_read_b64_tr_b16 a[150:151],v17 offset:4360
s_waitcnt lgkmcnt(0)
ds_read_b64_tr_b16 a[152:153],v17 offset:6144
ds_read_b64_tr_b16 a[154:155],v17 offset:6400
ds_read_b64_tr_b16 a[156:157],v17 offset:6152
ds_read_b64_tr_b16 a[158:159],v17 offset:6408
ds_read_b64_tr_b16 a[160:161],v17 offset:8192
ds_read_b64_tr_b16 a[162:163],v17 offset:8448
ds_read_b64_tr_b16 a[164:165],v17 offset:8200
ds_read_b64_tr_b16 a[166:167],v17 offset:8456
ds_read_b64_tr_b16 a[168:169],v17 offset:10240
ds_read_b64_tr_b16 a[170:171],v17 offset:10496
ds_read_b64_tr_b16 a[172:173],v17 offset:10248
ds_read_b64_tr_b16 a[174:175],v17 offset:10504
s_waitcnt lgkmcnt(0)
ds_read_b64_tr_b16 a[176:177],v17 offset:12288
ds_read_b64_tr_b16 a[178:179],v17 offset:12544
ds_read_b64_tr_b16 a[180:181],v17 offset:12296
ds_read_b64_tr_b16 a[182:183],v17 offset:12552
ds_read_b64_tr_b16 a[184:185],v17 offset:14336
ds_read_b64_tr_b16 a[186:187],v17 offset:14592
ds_read_b64_tr_b16 a[188:189],v17 offset:14344
ds_read_b64_tr_b16 a[190:191],v17 offset:14600
s_waitcnt lgkmcnt(0)
s_waitcnt vmcnt(0)
ds_read_b64_tr_b16 a[192:193],v17 offset:16384
ds_read_b64_tr_b16 a[194:195],v17 offset:16640
ds_read_b64_tr_b16 a[196:197],v17 offset:16392
ds_read_b64_tr_b16 a[198:199],v17 offset:16648
ds_read_b64_tr_b16 a[200:201],v17 offset:18432
ds_read_b64_tr_b16 a[202:203],v17 offset:18688
ds_read_b64_tr_b16 a[204:205],v17 offset:18440
ds_read_b64_tr_b16 a[206:207],v17 offset:18696
ds_read_b64_tr_b16 a[208:209],v17 offset:20480
ds_read_b64_tr_b16 a[210:211],v17 offset:20736
ds_read_b64_tr_b16 a[212:213],v17 offset:20488
ds_read_b64_tr_b16 a[214:215],v17 offset:20744
s_waitcnt lgkmcnt(0)
ds_read_b64_tr_b16 a[216:217],v17 offset:22528
ds_read_b64_tr_b16 a[218:219],v17 offset:22784
ds_read_b64_tr_b16 a[220:221],v17 offset:22536
ds_read_b64_tr_b16 a[222:223],v17 offset:22792
ds_read_b64_tr_b16 a[224:225],v17 offset:24576
ds_read_b64_tr_b16 a[226:227],v17 offset:24832
ds_read_b64_tr_b16 a[228:229],v17 offset:24584
ds_read_b64_tr_b16 a[230:231],v17 offset:24840
ds_read_b64_tr_b16 a[232:233],v17 offset:26624
ds_read_b64_tr_b16 a[234:235],v17 offset:26880
ds_read_b64_tr_b16 a[236:237],v17 offset:26632
ds_read_b64_tr_b16 a[238:239],v17 offset:26888
s_waitcnt lgkmcnt(0)
ds_read_b64_tr_b16 a[240:241],v17 offset:28672
ds_read_b64_tr_b16 a[242:243],v17 offset:28928
ds_read_b64_tr_b16 a[244:245],v17 offset:28680
ds_read_b64_tr_b16 a[246:247],v17 offset:28936
ds_read_b64_tr_b16 a[248:249],v17 offset:30720
ds_read_b64_tr_b16 a[250:251],v17 offset:30976
ds_read_b64_tr_b16 a[252:253],v17 offset:30728
ds_read_b64_tr_b16 a[254:255],v17 offset:30984
s_waitcnt lgkmcnt(0)
s_mov_b32 s92,s2
s_and_b32 s93,s3,0xffff
s_mov_b32 s94,0x100
s_mov_b32 s95,0x20000
v_mbcnt_lo_u32_b32 v16,-1,0
v_mbcnt_hi_u32_b32 v16,-1,v16
v_mov_b32 v18,0
v_cmp_eq_u32 vcc,22,v16
s_nop 1
v_cndmask_b32 v18,v18,63,vcc
v_cmp_eq_u32 vcc,17,v16
s_nop 1
v_cndmask_b32 v18,v18,63,vcc
v_cmp_eq_u32 vcc,18,v16
s_nop 1
v_cndmask_b32 v18,v18,1,vcc
v_and_b32 v19,1,v16
v_cmp_eq_u32 vcc,1,v19
v_mov_b32 v19,8192
s_nop 0
v_cndmask_b32 v19,-1,v19,vcc
v_min_u32 v16,31,v16
v_lshlrev_b32 v16,2,v16
s_sub_u32 s66,s88,64
s_cmp_lg_u32 s50,0
s_cbranch_scc1 vot_294
vpoll_290:
buffer_load_dword v17,v16,s[92:95],s66 offen sc1
s_waitcnt vmcnt(0)
s_cmp_lg_u32 s56,2
s_cbranch_scc1 vck_291
v_cmp_eq_u32 vcc,v17,v19
s_and_b32 s64,vcc_lo,0xffff
s_cmp_eq_u32 s64,65535
s_cbranch_scc1 vck_291
s_mov_b32 s65,0
v_readlane_b32 s64,v17,1
s_lshr_b32 s64,s64,8
s_add_u32 s65,s65,s64
v_readlane_b32 s64,v17,3
s_lshr_b32 s64,s64,8
s_add_u32 s65,s65,s64
v_readlane_b32 s64,v17,5
s_lshr_b32 s64,s64,8
s_add_u32 s65,s65,s64
v_readlane_b32 s64,v17,7
s_lshr_b32 s64,s64,8
s_add_u32 s65,s65,s64
v_readlane_b32 s64,v17,9
s_lshr_b32 s64,s64,8
s_add_u32 s65,s65,s64
v_readlane_b32 s64,v17,11
s_lshr_b32 s64,s64,8
s_add_u32 s65,s65,s64
v_readlane_b32 s64,v17,13
s_lshr_b32 s64,s64,8
s_add_u32 s65,s65,s64
v_readlane_b32 s64,v17,15
s_lshr_b32 s64,s64,8
s_add_u32 s65,s65,s64
s_cmp_ge_u32 s65,256
s_cbranch_scc1 vok_293
s_branch vrt_292
vck_291:
v_cmp_gt_u32 vcc,v18,v17
s_cbranch_vccz vok_293
vrt_292:
s_sleep 48
s_sub_u32 s90,s90,1
s_cmp_gt_i32 s90,0
s_cbranch_scc1 vpoll_290
vok_293:
v_add_u32 v18,160256,v16
ds_write_b32 v18,v17
s_waitcnt lgkmcnt(0)
vot_294:
s_barrier
v_add_u32 v18,160256,v16
ds_read_b32 v17,v18
s_waitcnt lgkmcnt(0)
s_cmp_lg_u32 s56,2
s_cbranch_scc1 vfin_295
v_cmp_eq_u32 vcc,v17,v19
s_and_b32 s64,vcc_lo,0xffff
s_cmp_eq_u32 s64,65535
s_cbranch_scc1 vfin_295
s_mov_b32 s65,0
v_readlane_b32 s64,v17,1
s_lshr_b32 s64,s64,8
s_add_u32 s65,s65,s64
v_readlane_b32 s64,v17,3
s_lshr_b32 s64,s64,8
s_add_u32 s65,s65,s64
v_readlane_b32 s64,v17,5
s_lshr_b32 s64,s64,8
s_add_u32 s65,s65,s64
v_readlane_b32 s64,v17,7
s_lshr_b32 s64,s64,8
s_add_u32 s65,s65,s64
v_readlane_b32 s64,v17,9
s_lshr_b32 s64,s64,8
s_add_u32 s65,s65,s64
v_readlane_b32 s64,v17,11
s_lshr_b32 s64,s64,8
s_add_u32 s65,s65,s64
v_readlane_b32 s64,v17,13
s_lshr_b32 s64,s64,8
s_add_u32 s65,s65,s64
v_readlane_b32 s64,v17,15
s_lshr_b32 s64,s64,8
s_add_u32 s65,s65,s64
s_cmp_ge_u32 s65,256
s_cbranch_scc1 fl_fb
vfin_295:
s_and_b32 s56,s56,1
s_mov_b32 s67,0
s_barrier
v_lshlrev_b32 v0,4,v1
s_mov_b32 s60,0
s_lshl_b32 s70,s50,13
s_mov_b32 s55,0
v_mov_b32 v3,v0
s_mov_b32 s73,0xffff0000
s_lshl_b32 s64,s52,2
s_add_u32 s64,s64,s50
s_mul_i32 s61,s64,8192
s_add_u32 s61,s61,214958080
s_lshl_b32 s68,s64,8
s_add_u32 s68,s68,138550272
s_lshl_b32 s83,s53,2
s_add_u32 s83,s83,s50
s_mov_b32 s63,0
s_xor_b32 s64,s50,0
s_lshl_b32 s64,s64,13
v_add_u32 v8,s64,v0
v_mov_b32 v4,v8
s_xor_b32 s64,s50,1
s_lshl_b32 s64,s64,13
v_add_u32 v9,s64,v0
v_mov_b32 v5,v9
s_xor_b32 s64,s50,2
s_lshl_b32 s64,s64,13
v_add_u32 v10,s64,v0
v_mov_b32 v6,v10
s_xor_b32 s64,s50,3
s_lshl_b32 s64,s64,13
v_add_u32 v11,s64,v0
v_mov_b32 v7,v11
v_min_u32 v2,7,v1
v_lshlrev_b32 v2,2,v2
s_add_u32 s62,s61,4096
s_lshl_b32 s66,s83,10
s_mul_i32 s65,s83,147
s_lshr_b32 s65,s65,10
s_mul_i32 s69,s65,228
s_lshl_b32 s64,s83,2
s_add_u32 s69,s69,s64
s_add_u32 s69,s69,138551296
s_add_u32 s82,s66,201326592
s_add_u32 s66,s66,219152384
s_lshl_b32 s64,s50,9
s_add_u32 s64,s64,131072
v_lshlrev_b32 v26,3,v1
v_add_u32 v19,s64,v26
v_lshl_add_u32 v26,v23,4,v21
v_lshlrev_b32 v26,3,v26
v_add_u32 v20,131072,v26
s_mov_b32 s74,0x22222222
s_mov_b32 s75,0x22222222
s_mov_b32 s76,0x44444444
s_mov_b32 s77,0x44444444
s_mov_b32 s78,0x88888888
s_mov_b32 s79,0x88888888
v_mov_b32 v208,0xbdd2d3e8
v_mov_b32 v209,0xc0135761
v_mov_b32 v210,0x3727c5ac
v_mov_b32 v211,0x3a800000
v_mov_b32 v12,0x3f803f80
v_mov_b32 v13,0x3f803f80
v_mov_b32 v14,0x3f803f80
v_mov_b32 v15,0x3f803f80
s_nop 1
v_mfma_f32_16x16x32_bf16 v[152:155],a[0:3],v[12:15],0
v_mfma_f32_16x16x32_bf16 v[156:159],a[4:7],v[12:15],0
v_mfma_f32_16x16x32_bf16 v[152:155],a[8:11],v[12:15],v[152:155]
v_mfma_f32_16x16x32_bf16 v[156:159],a[12:15],v[12:15],v[156:159]
v_mfma_f32_16x16x32_bf16 v[152:155],a[16:19],v[12:15],v[152:155]
v_mfma_f32_16x16x32_bf16 v[156:159],a[20:23],v[12:15],v[156:159]
v_mfma_f32_16x16x32_bf16 v[152:155],a[24:27],v[12:15],v[152:155]
v_mfma_f32_16x16x32_bf16 v[156:159],a[28:31],v[12:15],v[156:159]
v_mfma_f32_16x16x32_bf16 v[152:155],a[32:35],v[12:15],v[152:155]
v_mfma_f32_16x16x32_bf16 v[156:159],a[36:39],v[12:15],v[156:159]
v_mfma_f32_16x16x32_bf16 v[152:155],a[40:43],v[12:15],v[152:155]
v_mfma_f32_16x16x32_bf16 v[156:159],a[44:47],v[12:15],v[156:159]
v_mfma_f32_16x16x32_bf16 v[152:155],a[48:51],v[12:15],v[152:155]
v_mfma_f32_16x16x32_bf16 v[156:159],a[52:55],v[12:15],v[156:159]
v_mfma_f32_16x16x32_bf16 v[152:155],a[56:59],v[12:15],v[152:155]
v_mfma_f32_16x16x32_bf16 v[156:159],a[60:63],v[12:15],v[156:159]
v_mfma_f32_16x16x32_bf16 v[152:155],a[64:67],v[12:15],v[152:155]
v_mfma_f32_16x16x32_bf16 v[156:159],a[68:71],v[12:15],v[156:159]
v_mfma_f32_16x16x32_bf16 v[152:155],a[72:75],v[12:15],v[152:155]
v_mfma_f32_16x16x32_bf16 v[156:159],a[76:79],v[12:15],v[156:159]
v_mfma_f32_16x16x32_bf16 v[152:155],a[80:83],v[12:15],v[152:155]
v_mfma_f32_16x16x32_bf16 v[156:159],a[84:87],v[12:15],v[156:159]
v_mfma_f32_16x16x32_bf16 v[152:155],a[88:91],v[12:15],v[152:155]
v_mfma_f32_16x16x32_bf16 v[156:159],a[92:95],v[12:15],v[156:159]
v_mfma_f32_16x16x32_bf16 v[152:155],a[96:99],v[12:15],v[152:155]
v_mfma_f32_16x16x32_bf16 v[156:159],a[100:103],v[12:15],v[156:159]
v_mfma_f32_16x16x32_bf16 v[152:155],a[104:107],v[12:15],v[152:155]
v_mfma_f32_16x16x32_bf16 v[156:159],a[108:111],v[12:15],v[156:159]
v_mfma_f32_16x16x32_bf16 v[152:155],a[112:115],v[12:15],v[152:155]
v_mfma_f32_16x16x32_bf16 v[156:159],a[116:119],v[12:15],v[156:159]
v_mfma_f32_16x16x32_bf16 v[152:155],a[120:123],v[12:15],v[152:155]
v_mfma_f32_16x16x32_bf16 v[156:159],a[124:127],v[12:15],v[156:159]
v_mfma_f32_16x16x32_bf16 v[152:155],a[128:131],v[12:15],v[152:155]
v_mfma_f32_16x16x32_bf16 v[156:159],a[132:135],v[12:15],v[156:159]
v_mfma_f32_16x16x32_bf16 v[152:155],a[136:139],v[12:15],v[152:155]
v_mfma_f32_16x16x32_bf16 v[156:159],a[140:143],v[12:15],v[156:159]
v_mfma_f32_16x16x32_bf16 v[152:155],a[144:147],v[12:15],v[152:155]
v_mfma_f32_16x16x32_bf16 v[156:159],a[148:151],v[12:15],v[156:159]
v_mfma_f32_16x16x32_bf16 v[152:155],a[152:155],v[12:15],v[152:155]
v_mfma_f32_16x16x32_bf16 v[156:159],a[156:159],v[12:15],v[156:159]
v_mfma_f32_16x16x32_bf16 v[152:155],a[160:163],v[12:15],v[152:155]
v_mfma_f32_16x16x32_bf16 v[156:159],a[164:167],v[12:15],v[156:159]
v_mfma_f32_16x16x32_bf16 v[152:155],a[168:171],v[12:15],v[152:155]
v_mfma_f32_16x16x32_bf16 v[156:159],a[172:175],v[12:15],v[156:159]
v_mfma_f32_16x16x32_bf16 v[152:155],a[176:179],v[12:15],v[152:155]
v_mfma_f32_16x16x32_bf16 v[156:159],a[180:183],v[12:15],v[156:159]
v_mfma_f32_16x16x32_bf16 v[152:155],a[184:187],v[12:15],v[152:155]
v_mfma_f32_16x16x32_bf16 v[156:159],a[188:191],v[12:15],v[156:159]
v_mfma_f32_16x16x32_bf16 v[152:155],a[192:195],v[12:15],v[152:155]
v_mfma_f32_16x16x32_bf16 v[156:159],a[196:199],v[12:15],v[156:159]
v_mfma_f32_16x16x32_bf16 v[152:155],a[200:203],v[12:15],v[152:155]
v_mfma_f32_16x16x32_bf16 v[156:159],a[204:207],v[12:15],v[156:159]
v_mfma_f32_16x16x32_bf16 v[152:155],a[208:211],v[12:15],v[152:155]
v_mfma_f32_16x16x32_bf16 v[156:159],a[212:215],v[12:15],v[156:159]
v_mfma_f32_16x16x32_bf16 v[152:155],a[216:219],v[12:15],v[152:155]
v_mfma_f32_16x16x32_bf16 v[156:159],a[220:223],v[12:15],v[156:159]
v_mfma_f32_16x16x32_bf16 v[152:155],a[224:227],v[12:15],v[152:155]
v_mfma_f32_16x16x32_bf16 v[156:159],a[228:231],v[12:15],v[156:159]
v_mfma_f32_16x16x32_bf16 v[152:155],a[232:235],v[12:15],v[152:155]
v_mfma_f32_16x16x32_bf16 v[156:159],a[236:239],v[12:15],v[156:159]
v_mfma_f32_16x16x32_bf16 v[152:155],a[240:243],v[12:15],v[152:155]
v_mfma_f32_16x16x32_bf16 v[156:159],a[244:247],v[12:15],v[156:159]
v_mfma_f32_16x16x32_bf16 v[152:155],a[248:251],v[12:15],v[152:155]
v_mfma_f32_16x16x32_bf16 v[156:159],a[252:255],v[12:15],v[156:159]
v_cmp_eq_u32 vcc,0,v1
s_nop 1
v_cndmask_b32 v26,2.0,0,vcc
s_add_u32 s71,s60,1
s_add_u32 s53,s60,2
plp_303:
buffer_load_dword v16,v2,s[20:23],s68 offen sc1
s_waitcnt vmcnt(0)
v_cmp_gt_u32 vcc,s71,v16
s_cbranch_vccz pok_304
s_sleep 4
s_sub_u32 s90,s90,1
s_cmp_gt_i32 s90,0
s_cbranch_scc1 plp_303
pok_304:
lag_300:
s_mov_b32 m0,s70
s_nop 0
buffer_load_dwordx4 v3,s[20:23],s61 offen offset:0 lds
buffer_load_dwordx4 v3,s[20:23],s61 offen offset:1024 lds
buffer_load_dwordx4 v3,s[20:23],s61 offen offset:2048 lds
buffer_load_dwordx4 v3,s[20:23],s61 offen offset:3072 lds
s_add_u32 m0,s70,4096
s_nop 0
buffer_load_dwordx4 v3,s[20:23],s62 offen offset:0 lds
buffer_load_dwordx4 v3,s[20:23],s62 offen offset:1024 lds
buffer_load_dwordx4 v3,s[20:23],s62 offen offset:2048 lds
buffer_load_dwordx4 v3,s[20:23],s62 offen offset:3072 lds
s_add_u32 s61,s61,32768
s_add_u32 s62,s62,32768
s_add_u32 s70,s70,32768
s_and_b32 s70,s70,0x1ffff
buffer_load_dword v23,off,s[20:23],s66
buffer_load_dword v23,off,s[20:23],s66
dec_301:
v_cmp_gt_u32 vcc,s53,v16
s_cbranch_vccnz BN_299
BR_298:
s_waitcnt vmcnt(9)
ds_read_b128 v[64:67],v4 offset:0
s_waitcnt vmcnt(8)
ds_read_b128 v[68:71],v4 offset:1024
s_waitcnt vmcnt(7)
ds_read_b128 v[72:75],v4 offset:2048
s_waitcnt vmcnt(6)
ds_read_b128 v[76:79],v4 offset:3072
s_waitcnt lgkmcnt(3)
v_mfma_f32_16x16x32_bf16 v[32:35],a[0:3],v[64:67],0
s_add_u32 s71,s60,2
s_add_u32 s53,s60,3
s_mov_b32 s57,s63
v_mfma_f32_16x16x32_bf16 v[36:39],a[4:7],v[64:67],0
v_mfma_f32_16x16x32_bf16 v[48:51],v[12:15],v[64:67],0
v_mfma_f32_16x16x32_bf16 v[52:55],v[64:67],v[64:67],0
s_waitcnt lgkmcnt(2)
s_waitcnt vmcnt(5)
s_mov_b32 m0,s70
ds_read_b128 v[80:83],v4 offset:4096
v_mfma_f32_16x16x32_bf16 v[32:35],a[8:11],v[68:71],v[32:35]
buffer_load_dwordx4 v3,s[20:23],s61 offen offset:0 lds
v_mfma_f32_16x16x32_bf16 v[36:39],a[12:15],v[68:71],v[36:39]
v_mfma_f32_16x16x32_bf16 v[48:51],v[12:15],v[68:71],v[48:51]
v_mfma_f32_16x16x32_bf16 v[52:55],v[68:71],v[68:71],v[52:55]
s_waitcnt lgkmcnt(2)
s_waitcnt vmcnt(5)
ds_read_b128 v[84:87],v4 offset:5120
v_mfma_f32_16x16x32_bf16 v[32:35],a[16:19],v[72:75],v[32:35]
buffer_load_dwordx4 v3,s[20:23],s61 offen offset:1024 lds
v_mfma_f32_16x16x32_bf16 v[36:39],a[20:23],v[72:75],v[36:39]
v_mfma_f32_16x16x32_bf16 v[48:51],v[12:15],v[72:75],v[48:51]
v_mfma_f32_16x16x32_bf16 v[52:55],v[72:75],v[72:75],v[52:55]
s_waitcnt lgkmcnt(2)
s_waitcnt vmcnt(5)
ds_read_b128 v[88:91],v4 offset:6144
v_mfma_f32_16x16x32_bf16 v[32:35],a[24:27],v[76:79],v[32:35]
buffer_load_dwordx4 v3,s[20:23],s61 offen offset:2048 lds
v_mfma_f32_16x16x32_bf16 v[36:39],a[28:31],v[76:79],v[36:39]
v_mfma_f32_16x16x32_bf16 v[48:51],v[12:15],v[76:79],v[48:51]
v_mfma_f32_16x16x32_bf16 v[52:55],v[76:79],v[76:79],v[52:55]
s_waitcnt lgkmcnt(2)
s_waitcnt vmcnt(5)
ds_read_b128 v[92:95],v4 offset:7168
v_mfma_f32_16x16x32_bf16 v[32:35],a[32:35],v[80:83],v[32:35]
buffer_load_dwordx4 v3,s[20:23],s61 offen offset:3072 lds
v_mfma_f32_16x16x32_bf16 v[36:39],a[36:39],v[80:83],v[36:39]
v_mfma_f32_16x16x32_bf16 v[48:51],v[12:15],v[80:83],v[48:51]
v_mfma_f32_16x16x32_bf16 v[52:55],v[80:83],v[80:83],v[52:55]
s_waitcnt lgkmcnt(2)
s_barrier
ds_read_b128 v[96:99],v5 offset:0
v_mfma_f32_16x16x32_bf16 v[32:35],a[40:43],v[84:87],v[32:35]
ds_read_b128 v[100:103],v5 offset:1024
v_mfma_f32_16x16x32_bf16 v[36:39],a[44:47],v[84:87],v[36:39]
ds_read_b128 v[104:107],v5 offset:2048
v_mfma_f32_16x16x32_bf16 v[48:51],v[12:15],v[84:87],v[48:51]
s_add_u32 m0,s70,4096
ds_read_b128 v[108:111],v5 offset:3072
v_mfma_f32_16x16x32_bf16 v[52:55],v[84:87],v[84:87],v[52:55]
s_waitcnt lgkmcnt(5)
buffer_load_dwordx4 v3,s[20:23],s62 offen offset:0 lds
v_mfma_f32_16x16x32_bf16 v[32:35],a[48:51],v[88:91],v[32:35]
ds_read_b128 v[112:115],v5 offset:4096
v_mfma_f32_16x16x32_bf16 v[36:39],a[52:55],v[88:91],v[36:39]
buffer_load_dwordx4 v3,s[20:23],s62 offen offset:1024 lds
v_mfma_f32_16x16x32_bf16 v[48:51],v[12:15],v[88:91],v[48:51]
v_mfma_f32_16x16x32_bf16 v[52:55],v[88:91],v[88:91],v[52:55]
s_waitcnt lgkmcnt(5)
v_mfma_f32_16x16x32_bf16 v[32:35],a[56:59],v[92:95],v[32:35]
ds_read_b128 v[116:119],v5 offset:5120
v_mfma_f32_16x16x32_bf16 v[36:39],a[60:63],v[92:95],v[36:39]
buffer_load_dwordx4 v3,s[20:23],s62 offen offset:2048 lds
v_mfma_f32_16x16x32_bf16 v[48:51],v[12:15],v[92:95],v[48:51]
buffer_load_dword v16,v2,s[20:23],s68 offen sc1
v_mfma_f32_16x16x32_bf16 v[52:55],v[92:95],v[92:95],v[52:55]
s_waitcnt lgkmcnt(5)
v_mfma_f32_16x16x32_bf16 v[32:35],a[64:67],v[96:99],v[32:35]
ds_read_b128 v[120:123],v5 offset:6144
v_mfma_f32_16x16x32_bf16 v[36:39],a[68:71],v[96:99],v[36:39]
s_waitcnt lgkmcnt(5)
buffer_load_dwordx4 v3,s[20:23],s62 offen offset:3072 lds
v_mfma_f32_16x16x32_bf16 v[32:35],a[72:75],v[100:103],v[32:35]
ds_read_b128 v[124:127],v5 offset:7168
v_mfma_f32_16x16x32_bf16 v[36:39],a[76:79],v[100:103],v[36:39]
s_waitcnt lgkmcnt(5)
v_mfma_f32_16x16x32_bf16 v[32:35],a[80:83],v[104:107],v[32:35]
ds_read_b128 v[64:67],v6 offset:0
v_cndmask_b32 v49,v52,v53,s[74:75]
v_mfma_f32_16x16x32_bf16 v[36:39],a[84:87],v[104:107],v[36:39]
s_waitcnt lgkmcnt(5)
v_cndmask_b32 v49,v49,v54,s[76:77]
v_cndmask_b32 v49,v49,v55,s[78:79]
v_mfma_f32_16x16x32_bf16 v[32:35],a[88:91],v[108:111],v[32:35]
ds_read_b128 v[68:71],v6 offset:1024
v_mfma_f32_16x16x32_bf16 v[36:39],a[92:95],v[108:111],v[36:39]
s_waitcnt lgkmcnt(5)
ds_write_b64 v19,v[48:49]
v_mfma_f32_16x16x32_bf16 v[32:35],a[96:99],v[112:115],v[32:35]
ds_read_b128 v[72:75],v6 offset:2048
v_mfma_f32_16x16x32_bf16 v[36:39],a[100:103],v[112:115],v[36:39]
s_waitcnt lgkmcnt(6)
v_mfma_f32_16x16x32_bf16 v[32:35],a[104:107],v[116:119],v[32:35]
ds_read_b128 v[76:79],v6 offset:3072
v_mfma_f32_16x16x32_bf16 v[36:39],a[108:111],v[116:119],v[36:39]
s_waitcnt lgkmcnt(6)
v_mfma_f32_16x16x32_bf16 v[32:35],a[112:115],v[120:123],v[32:35]
s_waitcnt lgkmcnt(2)
s_barrier
ds_read_b128 v[80:83],v6 offset:4096
v_mfma_f32_16x16x32_bf16 v[36:39],a[116:119],v[120:123],v[36:39]
ds_read_b64 v[56:57],v20 offset:0
v_mfma_f32_16x16x32_bf16 v[32:35],a[120:123],v[124:127],v[32:35]
ds_read_b128 v[84:87],v6 offset:5120
v_mfma_f32_16x16x32_bf16 v[36:39],a[124:127],v[124:127],v[36:39]
ds_read_b64 v[58:59],v20 offset:512
v_mfma_f32_16x16x32_bf16 v[32:35],a[128:131],v[64:67],v[32:35]
ds_read_b128 v[88:91],v6 offset:6144
v_mfma_f32_16x16x32_bf16 v[36:39],a[132:135],v[64:67],v[36:39]
ds_read_b64 v[60:61],v20 offset:1024
v_mfma_f32_16x16x32_bf16 v[32:35],a[136:139],v[68:71],v[32:35]
ds_read_b128 v[92:95],v6 offset:7168
v_mfma_f32_16x16x32_bf16 v[36:39],a[140:143],v[68:71],v[36:39]
s_waitcnt lgkmcnt(8)
ds_read_b64 v[62:63],v20 offset:1536
v_mfma_f32_16x16x32_bf16 v[32:35],a[144:147],v[72:75],v[32:35]
ds_read_b128 v[96:99],v7 offset:0
v_mfma_f32_16x16x32_bf16 v[36:39],a[148:151],v[72:75],v[36:39]
s_waitcnt lgkmcnt(9)
s_waitcnt vmcnt(10)
v_mov_b32 v17,s57
buffer_store_dword v17,v26,s[20:23],s69 offen sc1
v_mfma_f32_16x16x32_bf16 v[32:35],a[152:155],v[76:79],v[32:35]
ds_read_b128 v[100:103],v7 offset:1024
v_mfma_f32_16x16x32_bf16 v[36:39],a[156:159],v[76:79],v[36:39]
s_waitcnt lgkmcnt(9)
v_mfma_f32_16x16x32_bf16 v[32:35],a[160:163],v[80:83],v[32:35]
ds_read_b128 v[104:107],v7 offset:2048
v_mfma_f32_16x16x32_bf16 v[36:39],a[164:167],v[80:83],v[36:39]
s_waitcnt lgkmcnt(8)
s_waitcnt lgkmcnt(3)
v_add_f32 v56,v56,v58
v_mfma_f32_16x16x32_bf16 v[32:35],a[168:171],v[84:87],v[32:35]
ds_read_b128 v[108:111],v7 offset:3072
v_add_f32 v57,v57,v59
v_mfma_f32_16x16x32_bf16 v[36:39],a[172:175],v[84:87],v[36:39]
v_add_f32 v60,v60,v62
v_add_f32 v61,v61,v63
v_mfma_f32_16x16x32_bf16 v[32:35],a[176:179],v[88:91],v[32:35]
ds_read_b128 v[112:115],v7 offset:4096
v_add_f32 v56,v56,v60
v_mfma_f32_16x16x32_bf16 v[36:39],a[180:183],v[88:91],v[36:39]
v_add_f32 v57,v57,v61
v_mul_f32 v188,0xba800000,v56
v_mfma_f32_16x16x32_bf16 v[32:35],a[184:187],v[92:95],v[32:35]
ds_read_b128 v[116:119],v7 offset:5120
v_fma_f32 v58,v188,v188,-v210
v_mfma_f32_16x16x32_bf16 v[36:39],a[188:191],v[92:95],v[36:39]
s_waitcnt lgkmcnt(5)
v_fma_f32 v57,v57,v211,-v58
v_max_f32 v57,v210,v57
v_mfma_f32_16x16x32_bf16 v[32:35],a[192:195],v[96:99],v[32:35]
ds_read_b128 v[120:123],v7 offset:6144
v_mfma_f32_16x16x32_bf16 v[36:39],a[196:199],v[96:99],v[36:39]
s_waitcnt lgkmcnt(5)
v_rsq_f32 v58,v57
v_mfma_f32_16x16x32_bf16 v[32:35],a[200:203],v[100:103],v[32:35]
ds_read_b128 v[124:127],v7 offset:7168
v_mul_f32 v189,v57,v58
v_mfma_f32_16x16x32_bf16 v[36:39],a[204:207],v[100:103],v[36:39]
s_waitcnt lgkmcnt(5)
v_mul_f32 v190,v209,v58
v_mul_f32 v59,v58,v58
v_mfma_f32_16x16x32_bf16 v[32:35],a[208:211],v[104:107],v[32:35]
s_add_u32 s61,s61,32768
v_mul_f32 v191,v208,v58
v_mul_f32 v191,v191,v59
v_mfma_f32_16x16x32_bf16 v[36:39],a[212:215],v[104:107],v[36:39]
s_waitcnt lgkmcnt(4)
s_add_u32 s62,s62,32768
s_add_u32 s70,s70,32768
v_mfma_f32_16x16x32_bf16 v[32:35],a[216:219],v[108:111],v[32:35]
s_and_b32 s70,s70,0x1ffff
s_add_u32 s55,s55,32768
s_and_b32 s55,s55,0x1ffff
v_mfma_f32_16x16x32_bf16 v[36:39],a[220:223],v[108:111],v[36:39]
s_waitcnt lgkmcnt(3)
v_add_u32 v4,s55,v8
v_add_u32 v5,s55,v9
v_mfma_f32_16x16x32_bf16 v[32:35],a[224:227],v[112:115],v[32:35]
v_add_u32 v6,s55,v10
v_add_u32 v7,s55,v11
v_mfma_f32_16x16x32_bf16 v[36:39],a[228:231],v[112:115],v[36:39]
s_waitcnt lgkmcnt(2)
s_waitcnt vmcnt(9)
ds_read_b128 v[64:67],v4 offset:0
v_mfma_f32_16x16x32_bf16 v[32:35],a[232:235],v[116:119],v[32:35]
s_waitcnt vmcnt(8)
ds_read_b128 v[68:71],v4 offset:1024
v_mfma_f32_16x16x32_bf16 v[36:39],a[236:239],v[116:119],v[36:39]
s_waitcnt lgkmcnt(3)
s_waitcnt vmcnt(7)
ds_read_b128 v[72:75],v4 offset:2048
v_mfma_f32_16x16x32_bf16 v[32:35],a[240:243],v[120:123],v[32:35]
v_mfma_f32_16x16x32_bf16 v[36:39],a[244:247],v[120:123],v[36:39]
s_waitcnt lgkmcnt(3)
v_mfma_f32_16x16x32_bf16 v[40:43],a[248:251],v[124:127],v[32:35]
v_mfma_f32_16x16x32_bf16 v[44:47],a[252:255],v[124:127],v[36:39]
s_waitcnt vmcnt(2)
v_cmp_gt_u32 vcc,s53,v16
s_add_u32 s60,s60,1
s_cbranch_vccnz WN_297
.p2align 6
WR_296:
s_waitcnt lgkmcnt(2)
v_mfma_f32_16x16x32_bf16 v[32:35],a[0:3],v[64:67],0
s_waitcnt vmcnt(6)
s_add_u32 s71,s60,2
ds_read_b128 v[76:79],v4 offset:3072
v_mfma_f32_16x16x32_bf16 v[36:39],a[4:7],v[64:67],0
s_add_u32 s53,s60,3
s_mov_b32 s57,s63
v_mfma_f32_16x16x32_bf16 v[48:51],v[12:15],v[64:67],0
s_mov_b32 m0,s70
v_fma_f32 v40,v152,v188,v40
v_fma_f32 v41,v153,v188,v41
v_mul_f32 v168,v40,v40
v_mfma_f32_16x16x32_bf16 v[52:55],v[64:67],v[64:67],0
s_waitcnt lgkmcnt(2)
buffer_load_dwordx4 v3,s[20:23],s61 offen offset:0 lds
v_mul_f32 v169,v41,v41
v_fma_f32 v168,v168,v191,v190
v_mfma_f32_16x16x32_bf16 v[32:35],a[8:11],v[68:71],v[32:35]
s_waitcnt vmcnt(6)
ds_read_b128 v[80:83],v4 offset:4096
v_fma_f32 v169,v169,v191,v190
v_mul_f32 v168,v168,v40
v_mfma_f32_16x16x32_bf16 v[36:39],a[12:15],v[68:71],v[36:39]
v_exp_f32 v168,v168
v_mul_f32 v169,v169,v41
v_mfma_f32_16x16x32_bf16 v[48:51],v[12:15],v[68:71],v[48:51]
v_exp_f32 v169,v169
v_fma_f32 v168,v168,v189,v189
v_mfma_f32_16x16x32_bf16 v[52:55],v[68:71],v[68:71],v[52:55]
s_waitcnt lgkmcnt(2)
buffer_load_dwordx4 v3,s[20:23],s61 offen offset:1024 lds
v_rcp_f32 v168,v168
v_mfma_f32_16x16x32_bf16 v[32:35],a[16:19],v[72:75],v[32:35]
s_waitcnt vmcnt(6)
ds_read_b128 v[84:87],v4 offset:5120
v_fma_f32 v169,v169,v189,v189
v_mul_f32 v40,v168,v40
v_mfma_f32_16x16x32_bf16 v[36:39],a[20:23],v[72:75],v[36:39]
v_rcp_f32 v169,v169
v_fma_f32 v42,v154,v188,v42
v_mfma_f32_16x16x32_bf16 v[48:51],v[12:15],v[72:75],v[48:51]
v_mul_f32 v41,v169,v41
v_fma_f32 v43,v155,v188,v43
v_mul_f32 v170,v42,v42
v_mfma_f32_16x16x32_bf16 v[52:55],v[72:75],v[72:75],v[52:55]
s_waitcnt lgkmcnt(2)
buffer_load_dwordx4 v3,s[20:23],s61 offen offset:2048 lds
v_mul_f32 v171,v43,v43
v_fma_f32 v170,v170,v191,v190
v_mfma_f32_16x16x32_bf16 v[32:35],a[24:27],v[76:79],v[32:35]
s_waitcnt vmcnt(6)
ds_read_b128 v[88:91],v4 offset:6144
v_fma_f32 v171,v171,v191,v190
v_mfma_f32_16x16x32_bf16 v[36:39],a[28:31],v[76:79],v[36:39]
v_mul_f32 v170,v170,v42
v_mul_f32 v171,v171,v43
v_mfma_f32_16x16x32_bf16 v[48:51],v[12:15],v[76:79],v[48:51]
v_exp_f32 v170,v170
v_mfma_f32_16x16x32_bf16 v[52:55],v[76:79],v[76:79],v[52:55]
s_waitcnt lgkmcnt(2)
buffer_load_dwordx4 v3,s[20:23],s61 offen offset:3072 lds
v_fma_f32 v170,v170,v189,v189
v_mfma_f32_16x16x32_bf16 v[32:35],a[32:35],v[80:83],v[32:35]
s_waitcnt vmcnt(5)
ds_read_b128 v[92:95],v4 offset:7168
v_fma_f32 v44,v156,v188,v44
v_mfma_f32_16x16x32_bf16 v[36:39],a[36:39],v[80:83],v[36:39]
s_barrier
ds_read_b128 v[96:99],v5 offset:0
v_fma_f32 v45,v157,v188,v45
v_mfma_f32_16x16x32_bf16 v[48:51],v[12:15],v[80:83],v[48:51]
ds_read_b128 v[100:103],v5 offset:1024
v_mul_f32 v172,v44,v44
v_mfma_f32_16x16x32_bf16 v[52:55],v[80:83],v[80:83],v[52:55]
s_waitcnt lgkmcnt(4)
ds_read_b128 v[104:107],v5 offset:2048
v_mul_f32 v173,v45,v45
v_mfma_f32_16x16x32_bf16 v[32:35],a[40:43],v[84:87],v[32:35]
s_add_u32 m0,s70,4096
ds_read_b128 v[108:111],v5 offset:3072
v_fma_f32 v172,v172,v191,v190
v_mfma_f32_16x16x32_bf16 v[36:39],a[44:47],v[84:87],v[36:39]
buffer_load_dwordx4 v3,s[20:23],s62 offen offset:0 lds
v_fma_f32 v173,v173,v191,v190
v_mfma_f32_16x16x32_bf16 v[48:51],v[12:15],v[84:87],v[48:51]
s_waitcnt vmcnt(5)
v_mov_b32 v17,s57
buffer_store_dword v17,v26,s[20:23],s69 offen sc1
v_mfma_f32_16x16x32_bf16 v[52:55],v[84:87],v[84:87],v[52:55]
s_waitcnt lgkmcnt(5)
v_exp_f32 v171,v171
v_mfma_f32_16x16x32_bf16 v[32:35],a[48:51],v[88:91],v[32:35]
ds_read_b128 v[112:115],v5 offset:4096
v_fma_f32 v171,v171,v189,v189
v_mfma_f32_16x16x32_bf16 v[36:39],a[52:55],v[88:91],v[36:39]
buffer_load_dwordx4 v3,s[20:23],s62 offen offset:1024 lds
v_mul_f32 v172,v172,v44
v_mfma_f32_16x16x32_bf16 v[48:51],v[12:15],v[88:91],v[48:51]
v_rcp_f32 v170,v170
v_mfma_f32_16x16x32_bf16 v[52:55],v[88:91],v[88:91],v[52:55]
s_waitcnt lgkmcnt(5)
v_rcp_f32 v171,v171
v_mfma_f32_16x16x32_bf16 v[32:35],a[56:59],v[92:95],v[32:35]
ds_read_b128 v[116:119],v5 offset:5120
v_mul_f32 v42,v170,v42
v_mfma_f32_16x16x32_bf16 v[36:39],a[60:63],v[92:95],v[36:39]
buffer_load_dwordx4 v3,s[20:23],s62 offen offset:2048 lds
v_mul_f32 v43,v171,v43
v_mfma_f32_16x16x32_bf16 v[48:51],v[12:15],v[92:95],v[48:51]
buffer_load_dword v16,v2,s[20:23],s68 offen sc1
v_mul_f32 v173,v173,v45
v_mfma_f32_16x16x32_bf16 v[52:55],v[92:95],v[92:95],v[52:55]
s_waitcnt lgkmcnt(5)
v_exp_f32 v172,v172
v_mfma_f32_16x16x32_bf16 v[32:35],a[64:67],v[96:99],v[32:35]
ds_read_b128 v[120:123],v5 offset:6144
v_fma_f32 v172,v172,v189,v189
v_mfma_f32_16x16x32_bf16 v[36:39],a[68:71],v[96:99],v[36:39]
s_waitcnt lgkmcnt(5)
buffer_load_dwordx4 v3,s[20:23],s62 offen offset:3072 lds
v_fma_f32 v46,v158,v188,v46
v_mfma_f32_16x16x32_bf16 v[32:35],a[72:75],v[100:103],v[32:35]
ds_read_b128 v[124:127],v5 offset:7168
v_fma_f32 v47,v159,v188,v47
v_mfma_f32_16x16x32_bf16 v[36:39],a[76:79],v[100:103],v[36:39]
s_waitcnt lgkmcnt(5)
v_exp_f32 v173,v173
v_mfma_f32_16x16x32_bf16 v[32:35],a[80:83],v[104:107],v[32:35]
ds_read_b128 v[64:67],v6 offset:0
v_cndmask_b32 v49,v52,v53,s[74:75]
v_mfma_f32_16x16x32_bf16 v[36:39],a[84:87],v[104:107],v[36:39]
s_waitcnt lgkmcnt(5)
v_cndmask_b32 v49,v49,v54,s[76:77]
v_cndmask_b32 v49,v49,v55,s[78:79]
v_mfma_f32_16x16x32_bf16 v[32:35],a[88:91],v[108:111],v[32:35]
ds_read_b128 v[68:71],v6 offset:1024
v_fma_f32 v173,v173,v189,v189
v_mfma_f32_16x16x32_bf16 v[36:39],a[92:95],v[108:111],v[36:39]
s_waitcnt lgkmcnt(5)
ds_write_b64 v19,v[48:49]
v_mfma_f32_16x16x32_bf16 v[32:35],a[96:99],v[112:115],v[32:35]
ds_read_b128 v[72:75],v6 offset:2048
v_mul_f32 v174,v46,v46
v_mfma_f32_16x16x32_bf16 v[36:39],a[100:103],v[112:115],v[36:39]
s_waitcnt lgkmcnt(6)
v_rcp_f32 v172,v172
v_mfma_f32_16x16x32_bf16 v[32:35],a[104:107],v[116:119],v[32:35]
ds_read_b128 v[76:79],v6 offset:3072
v_mul_f32 v44,v172,v44
v_mfma_f32_16x16x32_bf16 v[36:39],a[108:111],v[116:119],v[36:39]
s_waitcnt lgkmcnt(6)
v_rcp_f32 v173,v173
v_mfma_f32_16x16x32_bf16 v[32:35],a[112:115],v[120:123],v[32:35]
s_waitcnt lgkmcnt(2)
s_barrier
ds_read_b128 v[80:83],v6 offset:4096
v_mfma_f32_16x16x32_bf16 v[36:39],a[116:119],v[120:123],v[36:39]
ds_read_b64 v[56:57],v20 offset:0
v_mul_f32 v45,v173,v45
v_mfma_f32_16x16x32_bf16 v[32:35],a[120:123],v[124:127],v[32:35]
ds_read_b128 v[84:87],v6 offset:5120
v_mul_f32 v175,v47,v47
v_mfma_f32_16x16x32_bf16 v[36:39],a[124:127],v[124:127],v[36:39]
ds_read_b64 v[58:59],v20 offset:512
v_fma_f32 v174,v174,v191,v190
v_mfma_f32_16x16x32_bf16 v[32:35],a[128:131],v[64:67],v[32:35]
ds_read_b128 v[88:91],v6 offset:6144
v_fma_f32 v175,v175,v191,v190
v_mfma_f32_16x16x32_bf16 v[36:39],a[132:135],v[64:67],v[36:39]
ds_read_b64 v[60:61],v20 offset:1024
v_mul_f32 v174,v174,v46
v_mfma_f32_16x16x32_bf16 v[32:35],a[136:139],v[68:71],v[32:35]
ds_read_b128 v[92:95],v6 offset:7168
v_mul_f32 v175,v175,v47
v_mfma_f32_16x16x32_bf16 v[36:39],a[140:143],v[68:71],v[36:39]
s_waitcnt lgkmcnt(8)
ds_read_b64 v[62:63],v20 offset:1536
v_cvt_pk_bf16_f32 v176,v40,v41
v_mfma_f32_16x16x32_bf16 v[32:35],a[144:147],v[72:75],v[32:35]
ds_read_b128 v[96:99],v7 offset:0
v_cvt_pk_bf16_f32 v177,v42,v43
v_mfma_f32_16x16x32_bf16 v[36:39],a[148:151],v[72:75],v[36:39]
s_waitcnt lgkmcnt(9)
v_exp_f32 v174,v174
v_mfma_f32_16x16x32_bf16 v[32:35],a[152:155],v[76:79],v[32:35]
ds_read_b128 v[100:103],v7 offset:1024
v_fma_f32 v174,v174,v189,v189
v_mfma_f32_16x16x32_bf16 v[36:39],a[156:159],v[76:79],v[36:39]
s_waitcnt lgkmcnt(9)
v_exp_f32 v175,v175
v_mfma_f32_16x16x32_bf16 v[32:35],a[160:163],v[80:83],v[32:35]
ds_read_b128 v[104:107],v7 offset:2048
v_fma_f32 v175,v175,v189,v189
v_mfma_f32_16x16x32_bf16 v[36:39],a[164:167],v[80:83],v[36:39]
s_waitcnt lgkmcnt(8)
s_waitcnt lgkmcnt(3)
v_rcp_f32 v174,v174
v_mfma_f32_16x16x32_bf16 v[32:35],a[168:171],v[84:87],v[32:35]
ds_read_b128 v[108:111],v7 offset:3072
v_mul_f32 v46,v174,v46
v_mfma_f32_16x16x32_bf16 v[36:39],a[172:175],v[84:87],v[36:39]
v_rcp_f32 v175,v175
v_mfma_f32_16x16x32_bf16 v[32:35],a[176:179],v[88:91],v[32:35]
ds_read_b128 v[112:115],v7 offset:4096
v_mul_f32 v47,v175,v47
v_mfma_f32_16x16x32_bf16 v[36:39],a[180:183],v[88:91],v[36:39]
v_cvt_pk_bf16_f32 v178,v44,v45
v_cvt_pk_bf16_f32 v179,v46,v47
v_mfma_f32_16x16x32_bf16 v[32:35],a[184:187],v[92:95],v[32:35]
ds_read_b128 v[116:119],v7 offset:5120
v_add_f32 v56,v56,v58
v_mfma_f32_16x16x32_bf16 v[36:39],a[188:191],v[92:95],v[36:39]
s_waitcnt lgkmcnt(5)
buffer_store_dwordx4 v[176:179],v0,s[20:23],s66 offen sc1
v_mfma_f32_16x16x32_bf16 v[32:35],a[192:195],v[96:99],v[32:35]
s_add_u32 s66,s66,114688
s_add_u32 s63,s63,1
ds_read_b128 v[120:123],v7 offset:6144
v_mfma_f32_16x16x32_bf16 v[36:39],a[196:199],v[96:99],v[36:39]
s_waitcnt lgkmcnt(5)
v_add_f32 v57,v57,v59
v_add_f32 v60,v60,v62
v_mfma_f32_16x16x32_bf16 v[32:35],a[200:203],v[100:103],v[32:35]
ds_read_b128 v[124:127],v7 offset:7168
v_add_f32 v61,v61,v63
v_mfma_f32_16x16x32_bf16 v[36:39],a[204:207],v[100:103],v[36:39]
s_waitcnt lgkmcnt(5)
v_add_f32 v56,v56,v60
v_add_f32 v57,v57,v61
v_mfma_f32_16x16x32_bf16 v[32:35],a[208:211],v[104:107],v[32:35]
s_add_u32 s61,s61,32768
v_mul_f32 v188,0xba800000,v56
v_fma_f32 v58,v188,v188,-v210
v_mfma_f32_16x16x32_bf16 v[36:39],a[212:215],v[104:107],v[36:39]
s_waitcnt lgkmcnt(4)
v_fma_f32 v57,v57,v211,-v58
v_max_f32 v57,v210,v57
v_mfma_f32_16x16x32_bf16 v[32:35],a[216:219],v[108:111],v[32:35]
s_add_u32 s62,s62,32768
v_rsq_f32 v58,v57
v_mfma_f32_16x16x32_bf16 v[36:39],a[220:223],v[108:111],v[36:39]
s_waitcnt lgkmcnt(3)
v_mul_f32 v189,v57,v58
v_mul_f32 v190,v209,v58
v_mfma_f32_16x16x32_bf16 v[32:35],a[224:227],v[112:115],v[32:35]
s_add_u32 s70,s70,32768
v_mul_f32 v59,v58,v58
v_mul_f32 v191,v208,v58
v_mfma_f32_16x16x32_bf16 v[36:39],a[228:231],v[112:115],v[36:39]
s_waitcnt lgkmcnt(2)
s_and_b32 s70,s70,0x1ffff
v_mul_f32 v191,v191,v59
v_mfma_f32_16x16x32_bf16 v[32:35],a[232:235],v[116:119],v[32:35]
s_add_u32 s55,s55,32768
s_and_b32 s55,s55,0x1ffff
v_add_u32 v4,s55,v8
v_mfma_f32_16x16x32_bf16 v[36:39],a[236:239],v[116:119],v[36:39]
s_waitcnt lgkmcnt(1)
v_add_u32 v5,s55,v9
v_add_u32 v6,s55,v10
v_mfma_f32_16x16x32_bf16 v[32:35],a[240:243],v[120:123],v[32:35]
v_add_u32 v7,s55,v11
v_mfma_f32_16x16x32_bf16 v[36:39],a[244:247],v[120:123],v[36:39]
s_waitcnt lgkmcnt(0)
s_waitcnt vmcnt(10)
ds_read_b128 v[64:67],v4 offset:0
v_mfma_f32_16x16x32_bf16 v[40:43],a[248:251],v[124:127],v[32:35]
s_waitcnt vmcnt(9)
ds_read_b128 v[68:71],v4 offset:1024
v_mfma_f32_16x16x32_bf16 v[44:47],a[252:255],v[124:127],v[36:39]
s_waitcnt vmcnt(2)
v_cmp_gt_u32 vcc,s53,v16
ds_read_b128 v[72:75],v4 offset:2048
s_add_u32 s60,s60,1
s_cbranch_vccz WR_296
WN_297:
s_waitcnt lgkmcnt(2)
v_mfma_f32_16x16x32_bf16 v[32:35],a[0:3],v[64:67],0
s_waitcnt vmcnt(6)
s_add_u32 s71,s60,2
ds_read_b128 v[76:79],v4 offset:3072
v_mfma_f32_16x16x32_bf16 v[36:39],a[4:7],v[64:67],0
s_add_u32 s53,s60,3
s_mov_b32 s57,s63
v_mfma_f32_16x16x32_bf16 v[48:51],v[12:15],v[64:67],0
v_fma_f32 v40,v152,v188,v40
v_fma_f32 v41,v153,v188,v41
v_mul_f32 v168,v40,v40
v_mfma_f32_16x16x32_bf16 v[52:55],v[64:67],v[64:67],0
s_waitcnt lgkmcnt(2)
v_mul_f32 v169,v41,v41
v_fma_f32 v168,v168,v191,v190
v_fma_f32 v169,v169,v191,v190
v_mfma_f32_16x16x32_bf16 v[32:35],a[8:11],v[68:71],v[32:35]
s_waitcnt vmcnt(5)
ds_read_b128 v[80:83],v4 offset:4096
v_mul_f32 v168,v168,v40
v_mul_f32 v169,v169,v41
v_mfma_f32_16x16x32_bf16 v[36:39],a[12:15],v[68:71],v[36:39]
v_exp_f32 v168,v168
v_fma_f32 v42,v154,v188,v42
v_mfma_f32_16x16x32_bf16 v[48:51],v[12:15],v[68:71],v[48:51]
v_exp_f32 v169,v169
v_fma_f32 v168,v168,v189,v189
v_mfma_f32_16x16x32_bf16 v[52:55],v[68:71],v[68:71],v[52:55]
s_waitcnt lgkmcnt(2)
v_rcp_f32 v168,v168
v_fma_f32 v169,v169,v189,v189
v_mfma_f32_16x16x32_bf16 v[32:35],a[16:19],v[72:75],v[32:35]
s_waitcnt vmcnt(4)
ds_read_b128 v[84:87],v4 offset:5120
v_rcp_f32 v169,v169
v_mfma_f32_16x16x32_bf16 v[36:39],a[20:23],v[72:75],v[36:39]
v_mul_f32 v40,v168,v40
v_mul_f32 v41,v169,v41
v_fma_f32 v43,v155,v188,v43
v_mfma_f32_16x16x32_bf16 v[48:51],v[12:15],v[72:75],v[48:51]
v_mul_f32 v170,v42,v42
v_mul_f32 v171,v43,v43
v_mfma_f32_16x16x32_bf16 v[52:55],v[72:75],v[72:75],v[52:55]
s_waitcnt lgkmcnt(2)
v_fma_f32 v170,v170,v191,v190
v_fma_f32 v171,v171,v191,v190
v_mfma_f32_16x16x32_bf16 v[32:35],a[24:27],v[76:79],v[32:35]
s_waitcnt vmcnt(3)
ds_read_b128 v[88:91],v4 offset:6144
v_mul_f32 v170,v170,v42
v_mfma_f32_16x16x32_bf16 v[36:39],a[28:31],v[76:79],v[36:39]
v_exp_f32 v170,v170
v_mfma_f32_16x16x32_bf16 v[48:51],v[12:15],v[76:79],v[48:51]
v_mul_f32 v171,v171,v43
v_fma_f32 v170,v170,v189,v189
v_mfma_f32_16x16x32_bf16 v[52:55],v[76:79],v[76:79],v[52:55]
s_waitcnt lgkmcnt(2)
v_exp_f32 v171,v171
v_mfma_f32_16x16x32_bf16 v[32:35],a[32:35],v[80:83],v[32:35]
s_waitcnt vmcnt(1)
ds_read_b128 v[92:95],v4 offset:7168
v_fma_f32 v171,v171,v189,v189
v_mfma_f32_16x16x32_bf16 v[36:39],a[36:39],v[80:83],v[36:39]
s_barrier
ds_read_b128 v[96:99],v5 offset:0
v_fma_f32 v44,v156,v188,v44
v_mfma_f32_16x16x32_bf16 v[48:51],v[12:15],v[80:83],v[48:51]
ds_read_b128 v[100:103],v5 offset:1024
v_fma_f32 v45,v157,v188,v45
v_mfma_f32_16x16x32_bf16 v[52:55],v[80:83],v[80:83],v[52:55]
s_waitcnt lgkmcnt(4)
ds_read_b128 v[104:107],v5 offset:2048
v_mul_f32 v172,v44,v44
v_mfma_f32_16x16x32_bf16 v[32:35],a[40:43],v[84:87],v[32:35]
ds_read_b128 v[108:111],v5 offset:3072
v_mul_f32 v173,v45,v45
v_mfma_f32_16x16x32_bf16 v[36:39],a[44:47],v[84:87],v[36:39]
s_waitcnt vmcnt(0)
v_mov_b32 v17,s57
buffer_store_dword v17,v26,s[20:23],s69 offen sc1
v_mfma_f32_16x16x32_bf16 v[48:51],v[12:15],v[84:87],v[48:51]
v_rcp_f32 v170,v170
v_mfma_f32_16x16x32_bf16 v[52:55],v[84:87],v[84:87],v[52:55]
s_waitcnt lgkmcnt(5)
v_rcp_f32 v171,v171
v_mfma_f32_16x16x32_bf16 v[32:35],a[48:51],v[88:91],v[32:35]
ds_read_b128 v[112:115],v5 offset:4096
v_mul_f32 v42,v170,v42
v_mfma_f32_16x16x32_bf16 v[36:39],a[52:55],v[88:91],v[36:39]
v_mul_f32 v43,v171,v43
v_fma_f32 v172,v172,v191,v190
v_mfma_f32_16x16x32_bf16 v[48:51],v[12:15],v[88:91],v[48:51]
v_fma_f32 v173,v173,v191,v190
v_mul_f32 v172,v172,v44
v_mfma_f32_16x16x32_bf16 v[52:55],v[88:91],v[88:91],v[52:55]
s_waitcnt lgkmcnt(5)
v_exp_f32 v172,v172
v_mfma_f32_16x16x32_bf16 v[32:35],a[56:59],v[92:95],v[32:35]
ds_read_b128 v[116:119],v5 offset:5120
v_mul_f32 v173,v173,v45
v_mfma_f32_16x16x32_bf16 v[36:39],a[60:63],v[92:95],v[36:39]
v_exp_f32 v173,v173
v_mfma_f32_16x16x32_bf16 v[48:51],v[12:15],v[92:95],v[48:51]
v_fma_f32 v172,v172,v189,v189
v_fma_f32 v173,v173,v189,v189
v_mfma_f32_16x16x32_bf16 v[52:55],v[92:95],v[92:95],v[52:55]
s_waitcnt lgkmcnt(5)
v_rcp_f32 v172,v172
v_mfma_f32_16x16x32_bf16 v[32:35],a[64:67],v[96:99],v[32:35]
ds_read_b128 v[120:123],v5 offset:6144
v_mul_f32 v44,v172,v44
v_mfma_f32_16x16x32_bf16 v[36:39],a[68:71],v[96:99],v[36:39]
s_waitcnt lgkmcnt(5)
v_rcp_f32 v173,v173
v_mfma_f32_16x16x32_bf16 v[32:35],a[72:75],v[100:103],v[32:35]
ds_read_b128 v[124:127],v5 offset:7168
v_mul_f32 v45,v173,v45
v_mfma_f32_16x16x32_bf16 v[36:39],a[76:79],v[100:103],v[36:39]
s_waitcnt lgkmcnt(5)
v_fma_f32 v46,v158,v188,v46
v_fma_f32 v47,v159,v188,v47
v_mfma_f32_16x16x32_bf16 v[32:35],a[80:83],v[104:107],v[32:35]
ds_read_b128 v[64:67],v6 offset:0
v_cndmask_b32 v49,v52,v53,s[74:75]
v_mfma_f32_16x16x32_bf16 v[36:39],a[84:87],v[104:107],v[36:39]
s_waitcnt lgkmcnt(5)
v_cndmask_b32 v49,v49,v54,s[76:77]
v_cndmask_b32 v49,v49,v55,s[78:79]
v_mfma_f32_16x16x32_bf16 v[32:35],a[88:91],v[108:111],v[32:35]
ds_read_b128 v[68:71],v6 offset:1024
v_mul_f32 v174,v46,v46
v_mfma_f32_16x16x32_bf16 v[36:39],a[92:95],v[108:111],v[36:39]
s_waitcnt lgkmcnt(5)
ds_write_b64 v19,v[48:49]
v_mfma_f32_16x16x32_bf16 v[32:35],a[96:99],v[112:115],v[32:35]
ds_read_b128 v[72:75],v6 offset:2048
v_mul_f32 v175,v47,v47
v_mfma_f32_16x16x32_bf16 v[36:39],a[100:103],v[112:115],v[36:39]
s_waitcnt lgkmcnt(6)
v_fma_f32 v174,v174,v191,v190
v_fma_f32 v175,v175,v191,v190
v_mfma_f32_16x16x32_bf16 v[32:35],a[104:107],v[116:119],v[32:35]
ds_read_b128 v[76:79],v6 offset:3072
v_mul_f32 v174,v174,v46
v_mfma_f32_16x16x32_bf16 v[36:39],a[108:111],v[116:119],v[36:39]
s_waitcnt lgkmcnt(6)
v_exp_f32 v174,v174
v_mfma_f32_16x16x32_bf16 v[32:35],a[112:115],v[120:123],v[32:35]
s_waitcnt lgkmcnt(2)
s_barrier
ds_read_b128 v[80:83],v6 offset:4096
v_mfma_f32_16x16x32_bf16 v[36:39],a[116:119],v[120:123],v[36:39]
ds_read_b64 v[56:57],v20 offset:0
v_mul_f32 v175,v175,v47
v_mfma_f32_16x16x32_bf16 v[32:35],a[120:123],v[124:127],v[32:35]
ds_read_b128 v[84:87],v6 offset:5120
v_fma_f32 v174,v174,v189,v189
v_mfma_f32_16x16x32_bf16 v[36:39],a[124:127],v[124:127],v[36:39]
ds_read_b64 v[58:59],v20 offset:512
v_cvt_pk_bf16_f32 v176,v40,v41
v_mfma_f32_16x16x32_bf16 v[32:35],a[128:131],v[64:67],v[32:35]
ds_read_b128 v[88:91],v6 offset:6144
v_cvt_pk_bf16_f32 v177,v42,v43
v_mfma_f32_16x16x32_bf16 v[36:39],a[132:135],v[64:67],v[36:39]
ds_read_b64 v[60:61],v20 offset:1024
v_cvt_pk_bf16_f32 v178,v44,v45
v_mfma_f32_16x16x32_bf16 v[32:35],a[136:139],v[68:71],v[32:35]
ds_read_b128 v[92:95],v6 offset:7168
v_mfma_f32_16x16x32_bf16 v[36:39],a[140:143],v[68:71],v[36:39]
s_waitcnt lgkmcnt(8)
ds_read_b64 v[62:63],v20 offset:1536
v_mfma_f32_16x16x32_bf16 v[32:35],a[144:147],v[72:75],v[32:35]
ds_read_b128 v[96:99],v7 offset:0
v_mfma_f32_16x16x32_bf16 v[36:39],a[148:151],v[72:75],v[36:39]
s_waitcnt lgkmcnt(9)
buffer_load_dword v16,v2,s[20:23],s68 offen sc1
v_mfma_f32_16x16x32_bf16 v[32:35],a[152:155],v[76:79],v[32:35]
ds_read_b128 v[100:103],v7 offset:1024
v_mfma_f32_16x16x32_bf16 v[36:39],a[156:159],v[76:79],v[36:39]
s_waitcnt lgkmcnt(9)
v_exp_f32 v175,v175
v_mfma_f32_16x16x32_bf16 v[32:35],a[160:163],v[80:83],v[32:35]
ds_read_b128 v[104:107],v7 offset:2048
v_fma_f32 v175,v175,v189,v189
v_mfma_f32_16x16x32_bf16 v[36:39],a[164:167],v[80:83],v[36:39]
s_waitcnt lgkmcnt(8)
s_waitcnt lgkmcnt(3)
v_rcp_f32 v174,v174
v_mfma_f32_16x16x32_bf16 v[32:35],a[168:171],v[84:87],v[32:35]
ds_read_b128 v[108:111],v7 offset:3072
v_mul_f32 v46,v174,v46
v_mfma_f32_16x16x32_bf16 v[36:39],a[172:175],v[84:87],v[36:39]
v_rcp_f32 v175,v175
v_mfma_f32_16x16x32_bf16 v[32:35],a[176:179],v[88:91],v[32:35]
ds_read_b128 v[112:115],v7 offset:4096
v_mul_f32 v47,v175,v47
v_mfma_f32_16x16x32_bf16 v[36:39],a[180:183],v[88:91],v[36:39]
v_cvt_pk_bf16_f32 v179,v46,v47
v_add_f32 v56,v56,v58
v_mfma_f32_16x16x32_bf16 v[32:35],a[184:187],v[92:95],v[32:35]
ds_read_b128 v[116:119],v7 offset:5120
v_add_f32 v57,v57,v59
v_mfma_f32_16x16x32_bf16 v[36:39],a[188:191],v[92:95],v[36:39]
s_waitcnt lgkmcnt(5)
buffer_store_dwordx4 v[176:179],v0,s[20:23],s66 offen sc1
v_mfma_f32_16x16x32_bf16 v[32:35],a[192:195],v[96:99],v[32:35]
s_add_u32 s66,s66,114688
s_add_u32 s63,s63,1
ds_read_b128 v[120:123],v7 offset:6144
v_mfma_f32_16x16x32_bf16 v[36:39],a[196:199],v[96:99],v[36:39]
s_waitcnt lgkmcnt(5)
v_add_f32 v60,v60,v62
v_add_f32 v61,v61,v63
v_mfma_f32_16x16x32_bf16 v[32:35],a[200:203],v[100:103],v[32:35]
ds_read_b128 v[124:127],v7 offset:7168
v_add_f32 v56,v56,v60
v_mfma_f32_16x16x32_bf16 v[36:39],a[204:207],v[100:103],v[36:39]
s_waitcnt lgkmcnt(5)
v_add_f32 v57,v57,v61
v_mul_f32 v188,0xba800000,v56
v_mfma_f32_16x16x32_bf16 v[32:35],a[208:211],v[104:107],v[32:35]
s_add_u32 s55,s55,32768
v_fma_f32 v58,v188,v188,-v210
v_fma_f32 v57,v57,v211,-v58
v_mfma_f32_16x16x32_bf16 v[36:39],a[212:215],v[104:107],v[36:39]
s_waitcnt lgkmcnt(4)
s_and_b32 s55,s55,0x1ffff
v_max_f32 v57,v210,v57
v_mfma_f32_16x16x32_bf16 v[32:35],a[216:219],v[108:111],v[32:35]
v_rsq_f32 v58,v57
v_mfma_f32_16x16x32_bf16 v[36:39],a[220:223],v[108:111],v[36:39]
s_waitcnt lgkmcnt(3)
v_mul_f32 v189,v57,v58
v_mul_f32 v190,v209,v58
v_mfma_f32_16x16x32_bf16 v[32:35],a[224:227],v[112:115],v[32:35]
v_mul_f32 v59,v58,v58
v_mul_f32 v191,v208,v58
v_mfma_f32_16x16x32_bf16 v[36:39],a[228:231],v[112:115],v[36:39]
s_waitcnt lgkmcnt(2)
v_mul_f32 v191,v191,v59
v_add_u32 v4,s55,v8
v_mfma_f32_16x16x32_bf16 v[32:35],a[232:235],v[116:119],v[32:35]
v_add_u32 v5,s55,v9
v_add_u32 v6,s55,v10
v_mfma_f32_16x16x32_bf16 v[36:39],a[236:239],v[116:119],v[36:39]
s_waitcnt lgkmcnt(1)
v_add_u32 v7,s55,v11
v_mfma_f32_16x16x32_bf16 v[32:35],a[240:243],v[120:123],v[32:35]
v_mfma_f32_16x16x32_bf16 v[36:39],a[244:247],v[120:123],v[36:39]
s_waitcnt lgkmcnt(0)
v_mfma_f32_16x16x32_bf16 v[40:43],a[248:251],v[124:127],v[32:35]
v_mfma_f32_16x16x32_bf16 v[44:47],a[252:255],v[124:127],v[36:39]
s_waitcnt vmcnt(1)
v_cmp_gt_u32 vcc,s71,v16
s_add_u32 s60,s60,1
s_branch endN_305
BN_299:
s_waitcnt vmcnt(9)
ds_read_b128 v[64:67],v4 offset:0
s_waitcnt vmcnt(8)
ds_read_b128 v[68:71],v4 offset:1024
s_waitcnt vmcnt(7)
ds_read_b128 v[72:75],v4 offset:2048
s_waitcnt vmcnt(6)
ds_read_b128 v[76:79],v4 offset:3072
s_waitcnt lgkmcnt(3)
v_mfma_f32_16x16x32_bf16 v[32:35],a[0:3],v[64:67],0
s_add_u32 s71,s60,2
s_add_u32 s53,s60,3
s_mov_b32 s57,s63
v_mfma_f32_16x16x32_bf16 v[36:39],a[4:7],v[64:67],0
v_mfma_f32_16x16x32_bf16 v[48:51],v[12:15],v[64:67],0
v_mfma_f32_16x16x32_bf16 v[52:55],v[64:67],v[64:67],0
s_waitcnt lgkmcnt(2)
s_waitcnt vmcnt(5)
ds_read_b128 v[80:83],v4 offset:4096
v_mfma_f32_16x16x32_bf16 v[32:35],a[8:11],v[68:71],v[32:35]
v_mfma_f32_16x16x32_bf16 v[36:39],a[12:15],v[68:71],v[36:39]
v_mfma_f32_16x16x32_bf16 v[48:51],v[12:15],v[68:71],v[48:51]
v_mfma_f32_16x16x32_bf16 v[52:55],v[68:71],v[68:71],v[52:55]
s_waitcnt lgkmcnt(2)
s_waitcnt vmcnt(4)
ds_read_b128 v[84:87],v4 offset:5120
v_mfma_f32_16x16x32_bf16 v[32:35],a[16:19],v[72:75],v[32:35]
v_mfma_f32_16x16x32_bf16 v[36:39],a[20:23],v[72:75],v[36:39]
v_mfma_f32_16x16x32_bf16 v[48:51],v[12:15],v[72:75],v[48:51]
v_mfma_f32_16x16x32_bf16 v[52:55],v[72:75],v[72:75],v[52:55]
s_waitcnt lgkmcnt(2)
s_waitcnt vmcnt(3)
ds_read_b128 v[88:91],v4 offset:6144
v_mfma_f32_16x16x32_bf16 v[32:35],a[24:27],v[76:79],v[32:35]
v_mfma_f32_16x16x32_bf16 v[36:39],a[28:31],v[76:79],v[36:39]
v_mfma_f32_16x16x32_bf16 v[48:51],v[12:15],v[76:79],v[48:51]
v_mfma_f32_16x16x32_bf16 v[52:55],v[76:79],v[76:79],v[52:55]
s_waitcnt lgkmcnt(2)
s_waitcnt vmcnt(2)
ds_read_b128 v[92:95],v4 offset:7168
v_mfma_f32_16x16x32_bf16 v[32:35],a[32:35],v[80:83],v[32:35]
v_mfma_f32_16x16x32_bf16 v[36:39],a[36:39],v[80:83],v[36:39]
v_mfma_f32_16x16x32_bf16 v[48:51],v[12:15],v[80:83],v[48:51]
v_mfma_f32_16x16x32_bf16 v[52:55],v[80:83],v[80:83],v[52:55]
s_waitcnt lgkmcnt(2)
s_barrier
ds_read_b128 v[96:99],v5 offset:0
v_mfma_f32_16x16x32_bf16 v[32:35],a[40:43],v[84:87],v[32:35]
ds_read_b128 v[100:103],v5 offset:1024
v_mfma_f32_16x16x32_bf16 v[36:39],a[44:47],v[84:87],v[36:39]
ds_read_b128 v[104:107],v5 offset:2048
v_mfma_f32_16x16x32_bf16 v[48:51],v[12:15],v[84:87],v[48:51]
ds_read_b128 v[108:111],v5 offset:3072
v_mfma_f32_16x16x32_bf16 v[52:55],v[84:87],v[84:87],v[52:55]
s_waitcnt lgkmcnt(5)
v_mfma_f32_16x16x32_bf16 v[32:35],a[48:51],v[88:91],v[32:35]
ds_read_b128 v[112:115],v5 offset:4096
v_mfma_f32_16x16x32_bf16 v[36:39],a[52:55],v[88:91],v[36:39]
v_mfma_f32_16x16x32_bf16 v[48:51],v[12:15],v[88:91],v[48:51]
v_mfma_f32_16x16x32_bf16 v[52:55],v[88:91],v[88:91],v[52:55]
s_waitcnt lgkmcnt(5)
v_mfma_f32_16x16x32_bf16 v[32:35],a[56:59],v[92:95],v[32:35]
ds_read_b128 v[116:119],v5 offset:5120
v_mfma_f32_16x16x32_bf16 v[36:39],a[60:63],v[92:95],v[36:39]
v_mfma_f32_16x16x32_bf16 v[48:51],v[12:15],v[92:95],v[48:51]
v_mfma_f32_16x16x32_bf16 v[52:55],v[92:95],v[92:95],v[52:55]
s_waitcnt lgkmcnt(5)
v_mfma_f32_16x16x32_bf16 v[32:35],a[64:67],v[96:99],v[32:35]
ds_read_b128 v[120:123],v5 offset:6144
v_mfma_f32_16x16x32_bf16 v[36:39],a[68:71],v[96:99],v[36:39]
s_waitcnt lgkmcnt(5)
v_mfma_f32_16x16x32_bf16 v[32:35],a[72:75],v[100:103],v[32:35]
ds_read_b128 v[124:127],v5 offset:7168
v_mfma_f32_16x16x32_bf16 v[36:39],a[76:79],v[100:103],v[36:39]
s_waitcnt lgkmcnt(5)
v_mfma_f32_16x16x32_bf16 v[32:35],a[80:83],v[104:107],v[32:35]
ds_read_b128 v[64:67],v6 offset:0
v_cndmask_b32 v49,v52,v53,s[74:75]
v_mfma_f32_16x16x32_bf16 v[36:39],a[84:87],v[104:107],v[36:39]
s_waitcnt lgkmcnt(5)
v_cndmask_b32 v49,v49,v54,s[76:77]
v_cndmask_b32 v49,v49,v55,s[78:79]
v_mfma_f32_16x16x32_bf16 v[32:35],a[88:91],v[108:111],v[32:35]
ds_read_b128 v[68:71],v6 offset:1024
v_mfma_f32_16x16x32_bf16 v[36:39],a[92:95],v[108:111],v[36:39]
s_waitcnt lgkmcnt(5)
ds_write_b64 v19,v[48:49]
v_mfma_f32_16x16x32_bf16 v[32:35],a[96:99],v[112:115],v[32:35]
ds_read_b128 v[72:75],v6 offset:2048
v_mfma_f32_16x16x32_bf16 v[36:39],a[100:103],v[112:115],v[36:39]
s_waitcnt lgkmcnt(6)
v_mfma_f32_16x16x32_bf16 v[32:35],a[104:107],v[116:119],v[32:35]
ds_read_b128 v[76:79],v6 offset:3072
v_mfma_f32_16x16x32_bf16 v[36:39],a[108:111],v[116:119],v[36:39]
s_waitcnt lgkmcnt(6)
v_mfma_f32_16x16x32_bf16 v[32:35],a[112:115],v[120:123],v[32:35]
s_waitcnt lgkmcnt(2)
s_barrier
ds_read_b128 v[80:83],v6 offset:4096
v_mfma_f32_16x16x32_bf16 v[36:39],a[116:119],v[120:123],v[36:39]
ds_read_b64 v[56:57],v20 offset:0
v_mfma_f32_16x16x32_bf16 v[32:35],a[120:123],v[124:127],v[32:35]
ds_read_b128 v[84:87],v6 offset:5120
v_mfma_f32_16x16x32_bf16 v[36:39],a[124:127],v[124:127],v[36:39]
ds_read_b64 v[58:59],v20 offset:512
v_mfma_f32_16x16x32_bf16 v[32:35],a[128:131],v[64:67],v[32:35]
ds_read_b128 v[88:91],v6 offset:6144
v_mfma_f32_16x16x32_bf16 v[36:39],a[132:135],v[64:67],v[36:39]
ds_read_b64 v[60:61],v20 offset:1024
v_mfma_f32_16x16x32_bf16 v[32:35],a[136:139],v[68:71],v[32:35]
ds_read_b128 v[92:95],v6 offset:7168
v_mfma_f32_16x16x32_bf16 v[36:39],a[140:143],v[68:71],v[36:39]
s_waitcnt lgkmcnt(8)
ds_read_b64 v[62:63],v20 offset:1536
v_mfma_f32_16x16x32_bf16 v[32:35],a[144:147],v[72:75],v[32:35]
ds_read_b128 v[96:99],v7 offset:0
v_mfma_f32_16x16x32_bf16 v[36:39],a[148:151],v[72:75],v[36:39]
s_waitcnt lgkmcnt(9)
buffer_load_dword v16,v2,s[20:23],s68 offen sc1
v_mfma_f32_16x16x32_bf16 v[32:35],a[152:155],v[76:79],v[32:35]
ds_read_b128 v[100:103],v7 offset:1024
v_mfma_f32_16x16x32_bf16 v[36:39],a[156:159],v[76:79],v[36:39]
s_waitcnt lgkmcnt(9)
s_waitcnt vmcnt(2)
v_mov_b32 v17,s57
buffer_store_dword v17,v26,s[20:23],s69 offen sc1
v_mfma_f32_16x16x32_bf16 v[32:35],a[160:163],v[80:83],v[32:35]
ds_read_b128 v[104:107],v7 offset:2048
v_mfma_f32_16x16x32_bf16 v[36:39],a[164:167],v[80:83],v[36:39]
s_waitcnt lgkmcnt(8)
s_waitcnt lgkmcnt(3)
v_add_f32 v56,v56,v58
v_mfma_f32_16x16x32_bf16 v[32:35],a[168:171],v[84:87],v[32:35]
ds_read_b128 v[108:111],v7 offset:3072
v_add_f32 v57,v57,v59
v_mfma_f32_16x16x32_bf16 v[36:39],a[172:175],v[84:87],v[36:39]
v_add_f32 v60,v60,v62
v_add_f32 v61,v61,v63
v_mfma_f32_16x16x32_bf16 v[32:35],a[176:179],v[88:91],v[32:35]
ds_read_b128 v[112:115],v7 offset:4096
v_add_f32 v56,v56,v60
v_mfma_f32_16x16x32_bf16 v[36:39],a[180:183],v[88:91],v[36:39]
v_add_f32 v57,v57,v61
v_mul_f32 v188,0xba800000,v56
v_mfma_f32_16x16x32_bf16 v[32:35],a[184:187],v[92:95],v[32:35]
ds_read_b128 v[116:119],v7 offset:5120
v_fma_f32 v58,v188,v188,-v210
v_mfma_f32_16x16x32_bf16 v[36:39],a[188:191],v[92:95],v[36:39]
s_waitcnt lgkmcnt(5)
v_fma_f32 v57,v57,v211,-v58
v_max_f32 v57,v210,v57
v_mfma_f32_16x16x32_bf16 v[32:35],a[192:195],v[96:99],v[32:35]
ds_read_b128 v[120:123],v7 offset:6144
v_mfma_f32_16x16x32_bf16 v[36:39],a[196:199],v[96:99],v[36:39]
s_waitcnt lgkmcnt(5)
v_rsq_f32 v58,v57
v_mfma_f32_16x16x32_bf16 v[32:35],a[200:203],v[100:103],v[32:35]
ds_read_b128 v[124:127],v7 offset:7168
v_mul_f32 v189,v57,v58
v_mfma_f32_16x16x32_bf16 v[36:39],a[204:207],v[100:103],v[36:39]
s_waitcnt lgkmcnt(5)
v_mul_f32 v190,v209,v58
v_mul_f32 v59,v58,v58
v_mfma_f32_16x16x32_bf16 v[32:35],a[208:211],v[104:107],v[32:35]
s_add_u32 s55,s55,32768
v_mul_f32 v191,v208,v58
v_mul_f32 v191,v191,v59
v_mfma_f32_16x16x32_bf16 v[36:39],a[212:215],v[104:107],v[36:39]
s_waitcnt lgkmcnt(4)
s_and_b32 s55,s55,0x1ffff
v_add_u32 v4,s55,v8
v_mfma_f32_16x16x32_bf16 v[32:35],a[216:219],v[108:111],v[32:35]
v_add_u32 v5,s55,v9
v_add_u32 v6,s55,v10
v_mfma_f32_16x16x32_bf16 v[36:39],a[220:223],v[108:111],v[36:39]
s_waitcnt lgkmcnt(3)
v_add_u32 v7,s55,v11
v_mfma_f32_16x16x32_bf16 v[32:35],a[224:227],v[112:115],v[32:35]
v_mfma_f32_16x16x32_bf16 v[36:39],a[228:231],v[112:115],v[36:39]
s_waitcnt lgkmcnt(2)
v_mfma_f32_16x16x32_bf16 v[32:35],a[232:235],v[116:119],v[32:35]
v_mfma_f32_16x16x32_bf16 v[36:39],a[236:239],v[116:119],v[36:39]
s_waitcnt lgkmcnt(1)
v_mfma_f32_16x16x32_bf16 v[32:35],a[240:243],v[120:123],v[32:35]
v_mfma_f32_16x16x32_bf16 v[36:39],a[244:247],v[120:123],v[36:39]
s_waitcnt lgkmcnt(0)
v_mfma_f32_16x16x32_bf16 v[40:43],a[248:251],v[124:127],v[32:35]
v_mfma_f32_16x16x32_bf16 v[44:47],a[252:255],v[124:127],v[36:39]
s_waitcnt vmcnt(1)
v_cmp_gt_u32 vcc,s71,v16
s_add_u32 s60,s60,1
endN_305:
s_cbranch_vccnz nb_302
s_mov_b32 m0,s70
s_nop 0
buffer_load_dwordx4 v3,s[20:23],s61 offen offset:0 lds
buffer_load_dwordx4 v3,s[20:23],s61 offen offset:1024 lds
buffer_load_dwordx4 v3,s[20:23],s61 offen offset:2048 lds
buffer_load_dwordx4 v3,s[20:23],s61 offen offset:3072 lds
s_add_u32 m0,s70,4096
s_nop 0
buffer_load_dwordx4 v3,s[20:23],s62 offen offset:0 lds
buffer_load_dwordx4 v3,s[20:23],s62 offen offset:1024 lds
buffer_load_dwordx4 v3,s[20:23],s62 offen offset:2048 lds
buffer_load_dwordx4 v3,s[20:23],s62 offen offset:3072 lds
s_add_u32 s61,s61,32768
s_add_u32 s62,s62,32768
s_add_u32 s70,s70,32768
s_and_b32 s70,s70,0x1ffff
s_mov_b32 s57,s63
v_pk_fma_f32 v[40:41],v[152:153],v[188:189],v[40:41] op_sel_hi:[1,0,1]
v_pk_fma_f32 v[42:43],v[154:155],v[188:189],v[42:43] op_sel_hi:[1,0,1]
v_pk_fma_f32 v[44:45],v[156:157],v[188:189],v[44:45] op_sel_hi:[1,0,1]
v_pk_fma_f32 v[46:47],v[158:159],v[188:189],v[46:47] op_sel_hi:[1,0,1]
v_pk_mul_f32 v[168:169],v[40:41],v[40:41]
v_pk_mul_f32 v[170:171],v[42:43],v[42:43]
v_pk_mul_f32 v[172:173],v[44:45],v[44:45]
v_pk_mul_f32 v[174:175],v[46:47],v[46:47]
v_pk_fma_f32 v[168:169],v[168:169],v[190:191],v[190:191] op_sel:[0,1,0] op_sel_hi:[1,1,0]
v_pk_fma_f32 v[170:171],v[170:171],v[190:191],v[190:191] op_sel:[0,1,0] op_sel_hi:[1,1,0]
v_pk_fma_f32 v[172:173],v[172:173],v[190:191],v[190:191] op_sel:[0,1,0] op_sel_hi:[1,1,0]
v_pk_fma_f32 v[174:175],v[174:175],v[190:191],v[190:191] op_sel:[0,1,0] op_sel_hi:[1,1,0]
v_pk_mul_f32 v[168:169],v[168:169],v[40:41]
v_pk_mul_f32 v[170:171],v[170:171],v[42:43]
v_pk_mul_f32 v[172:173],v[172:173],v[44:45]
v_pk_mul_f32 v[174:175],v[174:175],v[46:47]
v_exp_f32 v168,v168
v_exp_f32 v169,v169
v_exp_f32 v170,v170
v_exp_f32 v171,v171
v_exp_f32 v172,v172
v_exp_f32 v173,v173
v_exp_f32 v174,v174
v_exp_f32 v175,v175
v_pk_fma_f32 v[168:169],v[168:169],v[188:189],v[188:189] op_sel:[0,1,1] op_sel_hi:[1,1,1]
v_pk_fma_f32 v[170:171],v[170:171],v[188:189],v[188:189] op_sel:[0,1,1] op_sel_hi:[1,1,1]
v_pk_fma_f32 v[172:173],v[172:173],v[188:189],v[188:189] op_sel:[0,1,1] op_sel_hi:[1,1,1]
v_pk_fma_f32 v[174:175],v[174:175],v[188:189],v[188:189] op_sel:[0,1,1] op_sel_hi:[1,1,1]
v_rcp_f32 v168,v168
v_rcp_f32 v169,v169
v_rcp_f32 v170,v170
v_rcp_f32 v171,v171
v_rcp_f32 v172,v172
v_rcp_f32 v173,v173
v_rcp_f32 v174,v174
v_rcp_f32 v175,v175
v_pk_mul_f32 v[40:41],v[168:169],v[40:41]
v_pk_mul_f32 v[42:43],v[170:171],v[42:43]
v_pk_mul_f32 v[44:45],v[172:173],v[44:45]
v_pk_mul_f32 v[46:47],v[174:175],v[46:47]
v_cvt_pk_bf16_f32 v176,v40,v41
v_cvt_pk_bf16_f32 v177,v42,v43
v_cvt_pk_bf16_f32 v178,v44,v45
v_cvt_pk_bf16_f32 v179,v46,v47
buffer_store_dwordx4 v[176:179],v0,s[20:23],s66 offen sc1
s_add_u32 s66,s66,114688
s_add_u32 s63,s63,1
s_waitcnt vmcnt(9)
v_mov_b32 v17,s57
buffer_store_dword v17,v26,s[20:23],s69 offen sc1
s_branch dec_301
nb_302:
buffer_load_dword v16,v2,s[20:23],s68 offen sc1
s_nop 3
s_mov_b32 s57,s63
v_pk_fma_f32 v[40:41],v[152:153],v[188:189],v[40:41] op_sel_hi:[1,0,1]
v_pk_fma_f32 v[42:43],v[154:155],v[188:189],v[42:43] op_sel_hi:[1,0,1]
v_pk_fma_f32 v[44:45],v[156:157],v[188:189],v[44:45] op_sel_hi:[1,0,1]
v_pk_fma_f32 v[46:47],v[158:159],v[188:189],v[46:47] op_sel_hi:[1,0,1]
v_pk_mul_f32 v[168:169],v[40:41],v[40:41]
v_pk_mul_f32 v[170:171],v[42:43],v[42:43]
v_pk_mul_f32 v[172:173],v[44:45],v[44:45]
v_pk_mul_f32 v[174:175],v[46:47],v[46:47]
v_pk_fma_f32 v[168:169],v[168:169],v[190:191],v[190:191] op_sel:[0,1,0] op_sel_hi:[1,1,0]
v_pk_fma_f32 v[170:171],v[170:171],v[190:191],v[190:191] op_sel:[0,1,0] op_sel_hi:[1,1,0]
v_pk_fma_f32 v[172:173],v[172:173],v[190:191],v[190:191] op_sel:[0,1,0] op_sel_hi:[1,1,0]
v_pk_fma_f32 v[174:175],v[174:175],v[190:191],v[190:191] op_sel:[0,1,0] op_sel_hi:[1,1,0]
v_pk_mul_f32 v[168:169],v[168:169],v[40:41]
v_pk_mul_f32 v[170:171],v[170:171],v[42:43]
v_pk_mul_f32 v[172:173],v[172:173],v[44:45]
v_pk_mul_f32 v[174:175],v[174:175],v[46:47]
v_exp_f32 v168,v168
v_exp_f32 v169,v169
v_exp_f32 v170,v170
v_exp_f32 v171,v171
v_exp_f32 v172,v172
v_exp_f32 v173,v173
v_exp_f32 v174,v174
v_exp_f32 v175,v175
v_pk_fma_f32 v[168:169],v[168:169],v[188:189],v[188:189] op_sel:[0,1,1] op_sel_hi:[1,1,1]
v_pk_fma_f32 v[170:171],v[170:171],v[188:189],v[188:189] op_sel:[0,1,1] op_sel_hi:[1,1,1]
v_pk_fma_f32 v[172:173],v[172:173],v[188:189],v[188:189] op_sel:[0,1,1] op_sel_hi:[1,1,1]
v_pk_fma_f32 v[174:175],v[174:175],v[188:189],v[188:189] op_sel:[0,1,1] op_sel_hi:[1,1,1]
v_rcp_f32 v168,v168
v_rcp_f32 v169,v169
v_rcp_f32 v170,v170
v_rcp_f32 v171,v171
v_rcp_f32 v172,v172
v_rcp_f32 v173,v173
v_rcp_f32 v174,v174
v_rcp_f32 v175,v175
v_pk_mul_f32 v[40:41],v[168:169],v[40:41]
v_pk_mul_f32 v[42:43],v[170:171],v[42:43]
v_pk_mul_f32 v[44:45],v[172:173],v[44:45]
v_pk_mul_f32 v[46:47],v[174:175],v[46:47]
v_cvt_pk_bf16_f32 v176,v40,v41
v_cvt_pk_bf16_f32 v177,v42,v43
v_cvt_pk_bf16_f32 v178,v44,v45
v_cvt_pk_bf16_f32 v179,v46,v47
buffer_store_dwordx4 v[176:179],v0,s[20:23],s66 offen sc1
s_add_u32 s66,s66,114688
s_add_u32 s63,s63,1
s_waitcnt vmcnt(2)
v_mov_b32 v17,s57
buffer_store_dword v17,v26,s[20:23],s69 offen sc1
s_waitcnt vmcnt(2)
v_cmp_gt_u32 vcc,s71,v16
s_cbranch_vccz lag_300
s_waitcnt vmcnt(1)
v_mov_b32 v17,s63
buffer_store_dword v17,v26,s[20:23],s69 offen sc1
s_cmp_ge_u32 s60,128
s_cbranch_scc1 done_289
plp_308:
buffer_load_dword v16,v2,s[20:23],s68 offen sc1
s_waitcnt vmcnt(0)
v_cmp_gt_u32 vcc,s71,v16
s_cbranch_vccz pok_309
s_sleep 4
s_sub_u32 s90,s90,1
s_cmp_gt_i32 s90,0
s_cbranch_scc1 plp_308
pok_309:
s_branch lag_300
done_289:
s_endpgm
fl_w1:
v_and_b32 v21,15,v1
v_lshrrev_b32 v22,4,v1
v_lshrrev_b32 v23,2,v21
v_and_b32 v24,3,v21
s_lshl_b32 s61,s50,15
v_lshl_add_u32 v25,v22,3,v23
s_load_dwordx2 s[4:5],s[0:1],64
s_mov_b32 s52,0
s_mov_b32 s53,s59
s_mul_i32 s54,s52,2097152
s_lshl_b32 s64,s53,8
s_add_u32 s54,s54,s64
s_lshl_b32 s64,s50,6
s_add_u32 s54,s54,s64
s_waitcnt lgkmcnt(0)
s_mov_b32 s28,s4
s_and_b32 s29,s5,0xffff
s_mov_b32 s30,0x200000
s_mov_b32 s31,0x20000
v_lshrrev_b32 v26,2,v1
v_and_b32 v27,3,v1
v_mul_u32_u24 v16,2048,v26
v_lshl_add_u32 v16,v27,4,v16
v_lshlrev_b32 v17,6,v25
v_lshl_add_u32 v17,v24,4,v17
v_add_u32 v17,s61,v17
s_xor_b32 s62,s50,0
s_mul_i32 s62,s62,524288
s_add_u32 s62,s62,s54
s_add_u32 m0,s61,0
s_nop 0
buffer_load_dwordx4 v16,s[28:31],s62 offen lds
s_add_u32 s62,s62,32768
s_add_u32 m0,m0,1024
s_waitcnt vmcnt(2)
buffer_load_dwordx4 v16,s[28:31],s62 offen lds
s_add_u32 s62,s62,32768
s_add_u32 m0,m0,1024
s_waitcnt vmcnt(2)
buffer_load_dwordx4 v16,s[28:31],s62 offen lds
s_add_u32 s62,s62,32768
s_add_u32 m0,m0,1024
s_waitcnt vmcnt(2)
buffer_load_dwordx4 v16,s[28:31],s62 offen lds
s_add_u32 s62,s62,32768
s_add_u32 m0,m0,1024
s_waitcnt vmcnt(2)
buffer_load_dwordx4 v16,s[28:31],s62 offen lds
s_add_u32 s62,s62,32768
s_add_u32 m0,m0,1024
s_waitcnt vmcnt(2)
buffer_load_dwordx4 v16,s[28:31],s62 offen lds
s_add_u32 s62,s62,32768
s_add_u32 m0,m0,1024
s_waitcnt vmcnt(2)
buffer_load_dwordx4 v16,s[28:31],s62 offen lds
s_add_u32 s62,s62,32768
s_add_u32 m0,m0,1024
s_waitcnt vmcnt(2)
buffer_load_dwordx4 v16,s[28:31],s62 offen lds
s_add_u32 s62,s62,32768
s_add_u32 m0,m0,1024
s_waitcnt vmcnt(2)
buffer_load_dwordx4 v16,s[28:31],s62 offen lds
s_add_u32 s62,s62,32768
s_add_u32 m0,m0,1024
s_waitcnt vmcnt(2)
buffer_load_dwordx4 v16,s[28:31],s62 offen lds
s_add_u32 s62,s62,32768
s_add_u32 m0,m0,1024
s_waitcnt vmcnt(2)
buffer_load_dwordx4 v16,s[28:31],s62 offen lds
s_add_u32 s62,s62,32768
s_add_u32 m0,m0,1024
s_waitcnt vmcnt(2)
buffer_load_dwordx4 v16,s[28:31],s62 offen lds
s_add_u32 s62,s62,32768
s_add_u32 m0,m0,1024
s_waitcnt vmcnt(2)
buffer_load_dwordx4 v16,s[28:31],s62 offen lds
s_add_u32 s62,s62,32768
s_add_u32 m0,m0,1024
s_waitcnt vmcnt(2)
buffer_load_dwordx4 v16,s[28:31],s62 offen lds
s_add_u32 s62,s62,32768
s_add_u32 m0,m0,1024
s_waitcnt vmcnt(2)
buffer_load_dwordx4 v16,s[28:31],s62 offen lds
s_add_u32 s62,s62,32768
s_add_u32 m0,m0,1024
s_waitcnt vmcnt(2)
buffer_load_dwordx4 v16,s[28:31],s62 offen lds
s_waitcnt vmcnt(2)
s_xor_b32 s62,s50,1
s_mul_i32 s62,s62,524288
s_add_u32 s62,s62,s54
s_add_u32 m0,s61,16384
s_nop 0
buffer_load_dwordx4 v16,s[28:31],s62 offen lds
s_add_u32 s62,s62,32768
s_add_u32 m0,m0,1024
s_waitcnt vmcnt(2)
buffer_load_dwordx4 v16,s[28:31],s62 offen lds
s_add_u32 s62,s62,32768
s_add_u32 m0,m0,1024
s_waitcnt vmcnt(2)
buffer_load_dwordx4 v16,s[28:31],s62 offen lds
s_add_u32 s62,s62,32768
s_add_u32 m0,m0,1024
s_waitcnt vmcnt(2)
buffer_load_dwordx4 v16,s[28:31],s62 offen lds
s_add_u32 s62,s62,32768
s_add_u32 m0,m0,1024
s_waitcnt vmcnt(2)
buffer_load_dwordx4 v16,s[28:31],s62 offen lds
s_add_u32 s62,s62,32768
s_add_u32 m0,m0,1024
s_waitcnt vmcnt(2)
buffer_load_dwordx4 v16,s[28:31],s62 offen lds
s_add_u32 s62,s62,32768
s_add_u32 m0,m0,1024
s_waitcnt vmcnt(2)
buffer_load_dwordx4 v16,s[28:31],s62 offen lds
s_add_u32 s62,s62,32768
s_add_u32 m0,m0,1024
s_waitcnt vmcnt(2)
buffer_load_dwordx4 v16,s[28:31],s62 offen lds
s_add_u32 s62,s62,32768
s_add_u32 m0,m0,1024
s_waitcnt vmcnt(2)
buffer_load_dwordx4 v16,s[28:31],s62 offen lds
s_add_u32 s62,s62,32768
s_add_u32 m0,m0,1024
s_waitcnt vmcnt(2)
buffer_load_dwordx4 v16,s[28:31],s62 offen lds
s_add_u32 s62,s62,32768
s_add_u32 m0,m0,1024
s_waitcnt vmcnt(2)
buffer_load_dwordx4 v16,s[28:31],s62 offen lds
s_add_u32 s62,s62,32768
s_add_u32 m0,m0,1024
s_waitcnt vmcnt(2)
buffer_load_dwordx4 v16,s[28:31],s62 offen lds
s_add_u32 s62,s62,32768
s_add_u32 m0,m0,1024
s_waitcnt vmcnt(2)
buffer_load_dwordx4 v16,s[28:31],s62 offen lds
s_add_u32 s62,s62,32768
s_add_u32 m0,m0,1024
s_waitcnt vmcnt(2)
buffer_load_dwordx4 v16,s[28:31],s62 offen lds
s_add_u32 s62,s62,32768
s_add_u32 m0,m0,1024
s_waitcnt vmcnt(2)
buffer_load_dwordx4 v16,s[28:31],s62 offen lds
s_add_u32 s62,s62,32768
s_add_u32 m0,m0,1024
s_waitcnt vmcnt(2)
buffer_load_dwordx4 v16,s[28:31],s62 offen lds
s_waitcnt vmcnt(2)
s_waitcnt vmcnt(16)
ds_read_b64_tr_b16 a[0:1],v17 offset:0
ds_read_b64_tr_b16 a[2:3],v17 offset:256
ds_read_b64_tr_b16 a[4:5],v17 offset:8
ds_read_b64_tr_b16 a[6:7],v17 offset:264
ds_read_b64_tr_b16 a[8:9],v17 offset:2048
ds_read_b64_tr_b16 a[10:11],v17 offset:2304
ds_read_b64_tr_b16 a[12:13],v17 offset:2056
ds_read_b64_tr_b16 a[14:15],v17 offset:2312
ds_read_b64_tr_b16 a[16:17],v17 offset:4096
ds_read_b64_tr_b16 a[18:19],v17 offset:4352
ds_read_b64_tr_b16 a[20:21],v17 offset:4104
ds_read_b64_tr_b16 a[22:23],v17 offset:4360
s_waitcnt lgkmcnt(0)
ds_read_b64_tr_b16 a[24:25],v17 offset:6144
ds_read_b64_tr_b16 a[26:27],v17 offset:6400
ds_read_b64_tr_b16 a[28:29],v17 offset:6152
ds_read_b64_tr_b16 a[30:31],v17 offset:6408
ds_read_b64_tr_b16 a[32:33],v17 offset:8192
ds_read_b64_tr_b16 a[34:35],v17 offset:8448
ds_read_b64_tr_b16 a[36:37],v17 offset:8200
ds_read_b64_tr_b16 a[38:39],v17 offset:8456
ds_read_b64_tr_b16 a[40:41],v17 offset:10240
ds_read_b64_tr_b16 a[42:43],v17 offset:10496
ds_read_b64_tr_b16 a[44:45],v17 offset:10248
ds_read_b64_tr_b16 a[46:47],v17 offset:10504
s_waitcnt lgkmcnt(0)
ds_read_b64_tr_b16 a[48:49],v17 offset:12288
ds_read_b64_tr_b16 a[50:51],v17 offset:12544
ds_read_b64_tr_b16 a[52:53],v17 offset:12296
ds_read_b64_tr_b16 a[54:55],v17 offset:12552
ds_read_b64_tr_b16 a[56:57],v17 offset:14336
ds_read_b64_tr_b16 a[58:59],v17 offset:14592
ds_read_b64_tr_b16 a[60:61],v17 offset:14344
ds_read_b64_tr_b16 a[62:63],v17 offset:14600
s_waitcnt lgkmcnt(0)
s_xor_b32 s62,s50,2
s_mul_i32 s62,s62,524288
s_add_u32 s62,s62,s54
s_add_u32 m0,s61,0
s_nop 0
buffer_load_dwordx4 v16,s[28:31],s62 offen lds
s_add_u32 s62,s62,32768
s_add_u32 m0,m0,1024
s_waitcnt vmcnt(2)
buffer_load_dwordx4 v16,s[28:31],s62 offen lds
s_add_u32 s62,s62,32768
s_add_u32 m0,m0,1024
s_waitcnt vmcnt(2)
buffer_load_dwordx4 v16,s[28:31],s62 offen lds
s_add_u32 s62,s62,32768
s_add_u32 m0,m0,1024
s_waitcnt vmcnt(2)
buffer_load_dwordx4 v16,s[28:31],s62 offen lds
s_add_u32 s62,s62,32768
s_add_u32 m0,m0,1024
s_waitcnt vmcnt(2)
buffer_load_dwordx4 v16,s[28:31],s62 offen lds
s_add_u32 s62,s62,32768
s_add_u32 m0,m0,1024
s_waitcnt vmcnt(2)
buffer_load_dwordx4 v16,s[28:31],s62 offen lds
s_add_u32 s62,s62,32768
s_add_u32 m0,m0,1024
s_waitcnt vmcnt(2)
buffer_load_dwordx4 v16,s[28:31],s62 offen lds
s_add_u32 s62,s62,32768
s_add_u32 m0,m0,1024
s_waitcnt vmcnt(2)
buffer_load_dwordx4 v16,s[28:31],s62 offen lds
s_add_u32 s62,s62,32768
s_add_u32 m0,m0,1024
s_waitcnt vmcnt(2)
buffer_load_dwordx4 v16,s[28:31],s62 offen lds
s_add_u32 s62,s62,32768
s_add_u32 m0,m0,1024
s_waitcnt vmcnt(2)
buffer_load_dwordx4 v16,s[28:31],s62 offen lds
s_add_u32 s62,s62,32768
s_add_u32 m0,m0,1024
s_waitcnt vmcnt(2)
buffer_load_dwordx4 v16,s[28:31],s62 offen lds
s_add_u32 s62,s62,32768
s_add_u32 m0,m0,1024
s_waitcnt vmcnt(2)
buffer_load_dwordx4 v16,s[28:31],s62 offen lds
s_add_u32 s62,s62,32768
s_add_u32 m0,m0,1024
s_waitcnt vmcnt(2)
buffer_load_dwordx4 v16,s[28:31],s62 offen lds
s_add_u32 s62,s62,32768
s_add_u32 m0,m0,1024
s_waitcnt vmcnt(2)
buffer_load_dwordx4 v16,s[28:31],s62 offen lds
s_add_u32 s62,s62,32768
s_add_u32 m0,m0,1024
s_waitcnt vmcnt(2)
buffer_load_dwordx4 v16,s[28:31],s62 offen lds
s_add_u32 s62,s62,32768
s_add_u32 m0,m0,1024
s_waitcnt vmcnt(2)
buffer_load_dwordx4 v16,s[28:31],s62 offen lds
s_waitcnt vmcnt(2)
s_waitcnt vmcnt(16)
ds_read_b64_tr_b16 a[64:65],v17 offset:16384
ds_read_b64_tr_b16 a[66:67],v17 offset:16640
ds_read_b64_tr_b16 a[68:69],v17 offset:16392
ds_read_b64_tr_b16 a[70:71],v17 offset:16648
ds_read_b64_tr_b16 a[72:73],v17 offset:18432
ds_read_b64_tr_b16 a[74:75],v17 offset:18688
ds_read_b64_tr_b16 a[76:77],v17 offset:18440
ds_read_b64_tr_b16 a[78:79],v17 offset:18696
ds_read_b64_tr_b16 a[80:81],v17 offset:20480
ds_read_b64_tr_b16 a[82:83],v17 offset:20736
ds_read_b64_tr_b16 a[84:85],v17 offset:20488
ds_read_b64_tr_b16 a[86:87],v17 offset:20744
s_waitcnt lgkmcnt(0)
ds_read_b64_tr_b16 a[88:89],v17 offset:22528
ds_read_b64_tr_b16 a[90:91],v17 offset:22784
ds_read_b64_tr_b16 a[92:93],v17 offset:22536
ds_read_b64_tr_b16 a[94:95],v17 offset:22792
ds_read_b64_tr_b16 a[96:97],v17 offset:24576
ds_read_b64_tr_b16 a[98:99],v17 offset:24832
ds_read_b64_tr_b16 a[100:101],v17 offset:24584
ds_read_b64_tr_b16 a[102:103],v17 offset:24840
ds_read_b64_tr_b16 a[104:105],v17 offset:26624
ds_read_b64_tr_b16 a[106:107],v17 offset:26880
ds_read_b64_tr_b16 a[108:109],v17 offset:26632
ds_read_b64_tr_b16 a[110:111],v17 offset:26888
s_waitcnt lgkmcnt(0)
ds_read_b64_tr_b16 a[112:113],v17 offset:28672
ds_read_b64_tr_b16 a[114:115],v17 offset:28928
ds_read_b64_tr_b16 a[116:117],v17 offset:28680
ds_read_b64_tr_b16 a[118:119],v17 offset:28936
ds_read_b64_tr_b16 a[120:121],v17 offset:30720
ds_read_b64_tr_b16 a[122:123],v17 offset:30976
ds_read_b64_tr_b16 a[124:125],v17 offset:30728
ds_read_b64_tr_b16 a[126:127],v17 offset:30984
s_waitcnt lgkmcnt(0)
s_xor_b32 s62,s50,3
s_mul_i32 s62,s62,524288
s_add_u32 s62,s62,s54
s_add_u32 m0,s61,16384
s_nop 0
buffer_load_dwordx4 v16,s[28:31],s62 offen lds
s_add_u32 s62,s62,32768
s_add_u32 m0,m0,1024
s_waitcnt vmcnt(2)
buffer_load_dwordx4 v16,s[28:31],s62 offen lds
s_add_u32 s62,s62,32768
s_add_u32 m0,m0,1024
s_waitcnt vmcnt(2)
buffer_load_dwordx4 v16,s[28:31],s62 offen lds
s_add_u32 s62,s62,32768
s_add_u32 m0,m0,1024
s_waitcnt vmcnt(2)
buffer_load_dwordx4 v16,s[28:31],s62 offen lds
s_add_u32 s62,s62,32768
s_add_u32 m0,m0,1024
s_waitcnt vmcnt(2)
buffer_load_dwordx4 v16,s[28:31],s62 offen lds
s_add_u32 s62,s62,32768
s_add_u32 m0,m0,1024
s_waitcnt vmcnt(2)
buffer_load_dwordx4 v16,s[28:31],s62 offen lds
s_add_u32 s62,s62,32768
s_add_u32 m0,m0,1024
s_waitcnt vmcnt(2)
buffer_load_dwordx4 v16,s[28:31],s62 offen lds
s_add_u32 s62,s62,32768
s_add_u32 m0,m0,1024
s_waitcnt vmcnt(2)
buffer_load_dwordx4 v16,s[28:31],s62 offen lds
s_add_u32 s62,s62,32768
s_add_u32 m0,m0,1024
s_waitcnt vmcnt(2)
buffer_load_dwordx4 v16,s[28:31],s62 offen lds
s_add_u32 s62,s62,32768
s_add_u32 m0,m0,1024
s_waitcnt vmcnt(2)
buffer_load_dwordx4 v16,s[28:31],s62 offen lds
s_add_u32 s62,s62,32768
s_add_u32 m0,m0,1024
s_waitcnt vmcnt(2)
buffer_load_dwordx4 v16,s[28:31],s62 offen lds
s_add_u32 s62,s62,32768
s_add_u32 m0,m0,1024
s_waitcnt vmcnt(2)
buffer_load_dwordx4 v16,s[28:31],s62 offen lds
s_add_u32 s62,s62,32768
s_add_u32 m0,m0,1024
s_waitcnt vmcnt(2)
buffer_load_dwordx4 v16,s[28:31],s62 offen lds
s_add_u32 s62,s62,32768
s_add_u32 m0,m0,1024
s_waitcnt vmcnt(2)
buffer_load_dwordx4 v16,s[28:31],s62 offen lds
s_add_u32 s62,s62,32768
s_add_u32 m0,m0,1024
s_waitcnt vmcnt(2)
buffer_load_dwordx4 v16,s[28:31],s62 offen lds
s_add_u32 s62,s62,32768
s_add_u32 m0,m0,1024
s_waitcnt vmcnt(2)
buffer_load_dwordx4 v16,s[28:31],s62 offen lds
s_waitcnt vmcnt(2)
s_waitcnt vmcnt(16)
ds_read_b64_tr_b16 a[128:129],v17 offset:0
ds_read_b64_tr_b16 a[130:131],v17 offset:256
ds_read_b64_tr_b16 a[132:133],v17 offset:8
ds_read_b64_tr_b16 a[134:135],v17 offset:264
ds_read_b64_tr_b16 a[136:137],v17 offset:2048
ds_read_b64_tr_b16 a[138:139],v17 offset:2304
ds_read_b64_tr_b16 a[140:141],v17 offset:2056
ds_read_b64_tr_b16 a[142:143],v17 offset:2312
ds_read_b64_tr_b16 a[144:145],v17 offset:4096
ds_read_b64_tr_b16 a[146:147],v17 offset:4352
ds_read_b64_tr_b16 a[148:149],v17 offset:4104
ds_read_b64_tr_b16 a[150:151],v17 offset:4360
s_waitcnt lgkmcnt(0)
ds_read_b64_tr_b16 a[152:153],v17 offset:6144
ds_read_b64_tr_b16 a[154:155],v17 offset:6400
ds_read_b64_tr_b16 a[156:157],v17 offset:6152
ds_read_b64_tr_b16 a[158:159],v17 offset:6408
ds_read_b64_tr_b16 a[160:161],v17 offset:8192
ds_read_b64_tr_b16 a[162:163],v17 offset:8448
ds_read_b64_tr_b16 a[164:165],v17 offset:8200
ds_read_b64_tr_b16 a[166:167],v17 offset:8456
ds_read_b64_tr_b16 a[168:169],v17 offset:10240
ds_read_b64_tr_b16 a[170:171],v17 offset:10496
ds_read_b64_tr_b16 a[172:173],v17 offset:10248
ds_read_b64_tr_b16 a[174:175],v17 offset:10504
s_waitcnt lgkmcnt(0)
ds_read_b64_tr_b16 a[176:177],v17 offset:12288
ds_read_b64_tr_b16 a[178:179],v17 offset:12544
ds_read_b64_tr_b16 a[180:181],v17 offset:12296
ds_read_b64_tr_b16 a[182:183],v17 offset:12552
ds_read_b64_tr_b16 a[184:185],v17 offset:14336
ds_read_b64_tr_b16 a[186:187],v17 offset:14592
ds_read_b64_tr_b16 a[188:189],v17 offset:14344
ds_read_b64_tr_b16 a[190:191],v17 offset:14600
s_waitcnt lgkmcnt(0)
s_waitcnt vmcnt(0)
ds_read_b64_tr_b16 a[192:193],v17 offset:16384
ds_read_b64_tr_b16 a[194:195],v17 offset:16640
ds_read_b64_tr_b16 a[196:197],v17 offset:16392
ds_read_b64_tr_b16 a[198:199],v17 offset:16648
ds_read_b64_tr_b16 a[200:201],v17 offset:18432
ds_read_b64_tr_b16 a[202:203],v17 offset:18688
ds_read_b64_tr_b16 a[204:205],v17 offset:18440
ds_read_b64_tr_b16 a[206:207],v17 offset:18696
ds_read_b64_tr_b16 a[208:209],v17 offset:20480
ds_read_b64_tr_b16 a[210:211],v17 offset:20736
ds_read_b64_tr_b16 a[212:213],v17 offset:20488
ds_read_b64_tr_b16 a[214:215],v17 offset:20744
s_waitcnt lgkmcnt(0)
ds_read_b64_tr_b16 a[216:217],v17 offset:22528
ds_read_b64_tr_b16 a[218:219],v17 offset:22784
ds_read_b64_tr_b16 a[220:221],v17 offset:22536
ds_read_b64_tr_b16 a[222:223],v17 offset:22792
ds_read_b64_tr_b16 a[224:225],v17 offset:24576
ds_read_b64_tr_b16 a[226:227],v17 offset:24832
ds_read_b64_tr_b16 a[228:229],v17 offset:24584
ds_read_b64_tr_b16 a[230:231],v17 offset:24840
ds_read_b64_tr_b16 a[232:233],v17 offset:26624
ds_read_b64_tr_b16 a[234:235],v17 offset:26880
ds_read_b64_tr_b16 a[236:237],v17 offset:26632
ds_read_b64_tr_b16 a[238:239],v17 offset:26888
s_waitcnt lgkmcnt(0)
ds_read_b64_tr_b16 a[240:241],v17 offset:28672
ds_read_b64_tr_b16 a[242:243],v17 offset:28928
ds_read_b64_tr_b16 a[244:245],v17 offset:28680
ds_read_b64_tr_b16 a[246:247],v17 offset:28936
ds_read_b64_tr_b16 a[248:249],v17 offset:30720
ds_read_b64_tr_b16 a[250:251],v17 offset:30976
ds_read_b64_tr_b16 a[252:253],v17 offset:30728
ds_read_b64_tr_b16 a[254:255],v17 offset:30984
s_waitcnt lgkmcnt(0)
s_mov_b32 s92,s2
s_and_b32 s93,s3,0xffff
s_mov_b32 s94,0x100
s_mov_b32 s95,0x20000
v_mbcnt_lo_u32_b32 v16,-1,0
v_mbcnt_hi_u32_b32 v16,-1,v16
v_mov_b32 v18,0
v_cmp_eq_u32 vcc,22,v16
s_nop 1
v_cndmask_b32 v18,v18,63,vcc
v_cmp_eq_u32 vcc,17,v16
s_nop 1
v_cndmask_b32 v18,v18,63,vcc
v_cmp_eq_u32 vcc,18,v16
s_nop 1
v_cndmask_b32 v18,v18,1,vcc
v_and_b32 v19,1,v16
v_cmp_eq_u32 vcc,1,v19
v_mov_b32 v19,8192
s_nop 0
v_cndmask_b32 v19,-1,v19,vcc
v_min_u32 v16,31,v16
v_lshlrev_b32 v16,2,v16
s_sub_u32 s66,s88,64
s_cmp_lg_u32 s50,0
s_cbranch_scc1 vot_315
vpoll_311:
buffer_load_dword v17,v16,s[92:95],s66 offen sc1
s_waitcnt vmcnt(0)
s_cmp_lg_u32 s56,2
s_cbranch_scc1 vck_312
v_cmp_eq_u32 vcc,v17,v19
s_and_b32 s64,vcc_lo,0xffff
s_cmp_eq_u32 s64,65535
s_cbranch_scc1 vck_312
s_mov_b32 s65,0
v_readlane_b32 s64,v17,1
s_lshr_b32 s64,s64,8
s_add_u32 s65,s65,s64
v_readlane_b32 s64,v17,3
s_lshr_b32 s64,s64,8
s_add_u32 s65,s65,s64
v_readlane_b32 s64,v17,5
s_lshr_b32 s64,s64,8
s_add_u32 s65,s65,s64
v_readlane_b32 s64,v17,7
s_lshr_b32 s64,s64,8
s_add_u32 s65,s65,s64
v_readlane_b32 s64,v17,9
s_lshr_b32 s64,s64,8
s_add_u32 s65,s65,s64
v_readlane_b32 s64,v17,11
s_lshr_b32 s64,s64,8
s_add_u32 s65,s65,s64
v_readlane_b32 s64,v17,13
s_lshr_b32 s64,s64,8
s_add_u32 s65,s65,s64
v_readlane_b32 s64,v17,15
s_lshr_b32 s64,s64,8
s_add_u32 s65,s65,s64
s_cmp_ge_u32 s65,256
s_cbranch_scc1 vok_314
s_branch vrt_313
vck_312:
v_cmp_gt_u32 vcc,v18,v17
s_cbranch_vccz vok_314
vrt_313:
s_sleep 48
s_sub_u32 s90,s90,1
s_cmp_gt_i32 s90,0
s_cbranch_scc1 vpoll_311
vok_314:
v_add_u32 v18,160512,v16
ds_write_b32 v18,v17
s_waitcnt lgkmcnt(0)
vot_315:
s_barrier
v_add_u32 v18,160512,v16
ds_read_b32 v17,v18
s_waitcnt lgkmcnt(0)
s_cmp_lg_u32 s56,2
s_cbranch_scc1 vfin_316
v_cmp_eq_u32 vcc,v17,v19
s_and_b32 s64,vcc_lo,0xffff
s_cmp_eq_u32 s64,65535
s_cbranch_scc1 vfin_316
s_mov_b32 s65,0
v_readlane_b32 s64,v17,1
s_lshr_b32 s64,s64,8
s_add_u32 s65,s65,s64
v_readlane_b32 s64,v17,3
s_lshr_b32 s64,s64,8
s_add_u32 s65,s65,s64
v_readlane_b32 s64,v17,5
s_lshr_b32 s64,s64,8
s_add_u32 s65,s65,s64
v_readlane_b32 s64,v17,7
s_lshr_b32 s64,s64,8
s_add_u32 s65,s65,s64
v_readlane_b32 s64,v17,9
s_lshr_b32 s64,s64,8
s_add_u32 s65,s65,s64
v_readlane_b32 s64,v17,11
s_lshr_b32 s64,s64,8
s_add_u32 s65,s65,s64
v_readlane_b32 s64,v17,13
s_lshr_b32 s64,s64,8
s_add_u32 s65,s65,s64
v_readlane_b32 s64,v17,15
s_lshr_b32 s64,s64,8
s_add_u32 s65,s65,s64
s_cmp_ge_u32 s65,256
s_cbranch_scc1 fl_fb
vfin_316:
s_and_b32 s56,s56,1
s_mov_b32 s67,0
s_barrier
v_lshlrev_b32 v0,4,v1
s_mov_b32 s60,0
s_lshl_b32 s70,s50,13
s_mov_b32 s55,0
v_mov_b32 v3,v0
s_mov_b32 s73,0xffff0000
s_lshl_b32 s64,s52,2
s_add_u32 s64,s64,s50
s_mul_i32 s61,s64,8192
s_add_u32 s61,s61,205520896
s_lshl_b32 s68,s64,8
s_add_u32 s68,s68,138548224
s_lshl_b32 s83,s53,2
s_add_u32 s83,s83,s50
s_mov_b32 s63,0
s_xor_b32 s64,s50,0
s_lshl_b32 s64,s64,13
v_add_u32 v8,s64,v0
v_mov_b32 v4,v8
s_xor_b32 s64,s50,1
s_lshl_b32 s64,s64,13
v_add_u32 v9,s64,v0
v_mov_b32 v5,v9
s_xor_b32 s64,s50,2
s_lshl_b32 s64,s64,13
v_add_u32 v10,s64,v0
v_mov_b32 v6,v10
s_xor_b32 s64,s50,3
s_lshl_b32 s64,s64,13
v_add_u32 v11,s64,v0
v_mov_b32 v7,v11
v_min_u32 v2,3,v1
v_lshlrev_b32 v2,7,v2
s_mul_i32 s68,s50,512
s_add_u32 s68,s68,138567680
s_add_u32 s62,s61,4096
s_lshl_b32 s66,s83,10
s_lshr_b32 s65,s83,3
s_lshl_b32 s65,s65,8
s_and_b32 s64,s83,7
s_lshl_b32 s64,s64,2
s_add_u32 s69,s64,s65
s_add_u32 s69,s69,138549248
s_lshl_b32 s69,s83,7
s_add_u32 s69,s69,138559488
s_add_u32 s82,s66,201326592
s_add_u32 s66,s66,209747968
s_lshl_b32 s64,s50,9
s_add_u32 s64,s64,131072
v_lshlrev_b32 v26,3,v1
v_add_u32 v19,s64,v26
v_lshl_add_u32 v26,v23,4,v21
v_lshlrev_b32 v26,3,v26
v_add_u32 v20,131072,v26
s_mov_b32 s74,0x22222222
s_mov_b32 s75,0x22222222
s_mov_b32 s76,0x44444444
s_mov_b32 s77,0x44444444
s_mov_b32 s78,0x88888888
s_mov_b32 s79,0x88888888
v_mov_b32 v208,0xbdd2d3e8
v_mov_b32 v209,0xc0135761
v_mov_b32 v210,0x3727c5ac
v_mov_b32 v211,0x3a800000
v_mov_b32 v12,0x3f803f80
v_mov_b32 v13,0x3f803f80
v_mov_b32 v14,0x3f803f80
v_mov_b32 v15,0x3f803f80
s_nop 1
v_mfma_f32_16x16x32_bf16 v[152:155],a[0:3],v[12:15],0
v_mfma_f32_16x16x32_bf16 v[156:159],a[4:7],v[12:15],0
v_mfma_f32_16x16x32_bf16 v[152:155],a[8:11],v[12:15],v[152:155]
v_mfma_f32_16x16x32_bf16 v[156:159],a[12:15],v[12:15],v[156:159]
v_mfma_f32_16x16x32_bf16 v[152:155],a[16:19],v[12:15],v[152:155]
v_mfma_f32_16x16x32_bf16 v[156:159],a[20:23],v[12:15],v[156:159]
v_mfma_f32_16x16x32_bf16 v[152:155],a[24:27],v[12:15],v[152:155]
v_mfma_f32_16x16x32_bf16 v[156:159],a[28:31],v[12:15],v[156:159]
v_mfma_f32_16x16x32_bf16 v[152:155],a[32:35],v[12:15],v[152:155]
v_mfma_f32_16x16x32_bf16 v[156:159],a[36:39],v[12:15],v[156:159]
v_mfma_f32_16x16x32_bf16 v[152:155],a[40:43],v[12:15],v[152:155]
v_mfma_f32_16x16x32_bf16 v[156:159],a[44:47],v[12:15],v[156:159]
v_mfma_f32_16x16x32_bf16 v[152:155],a[48:51],v[12:15],v[152:155]
v_mfma_f32_16x16x32_bf16 v[156:159],a[52:55],v[12:15],v[156:159]
v_mfma_f32_16x16x32_bf16 v[152:155],a[56:59],v[12:15],v[152:155]
v_mfma_f32_16x16x32_bf16 v[156:159],a[60:63],v[12:15],v[156:159]
v_mfma_f32_16x16x32_bf16 v[152:155],a[64:67],v[12:15],v[152:155]
v_mfma_f32_16x16x32_bf16 v[156:159],a[68:71],v[12:15],v[156:159]
v_mfma_f32_16x16x32_bf16 v[152:155],a[72:75],v[12:15],v[152:155]
v_mfma_f32_16x16x32_bf16 v[156:159],a[76:79],v[12:15],v[156:159]
v_mfma_f32_16x16x32_bf16 v[152:155],a[80:83],v[12:15],v[152:155]
v_mfma_f32_16x16x32_bf16 v[156:159],a[84:87],v[12:15],v[156:159]
v_mfma_f32_16x16x32_bf16 v[152:155],a[88:91],v[12:15],v[152:155]
v_mfma_f32_16x16x32_bf16 v[156:159],a[92:95],v[12:15],v[156:159]
v_mfma_f32_16x16x32_bf16 v[152:155],a[96:99],v[12:15],v[152:155]
v_mfma_f32_16x16x32_bf16 v[156:159],a[100:103],v[12:15],v[156:159]
v_mfma_f32_16x16x32_bf16 v[152:155],a[104:107],v[12:15],v[152:155]
v_mfma_f32_16x16x32_bf16 v[156:159],a[108:111],v[12:15],v[156:159]
v_mfma_f32_16x16x32_bf16 v[152:155],a[112:115],v[12:15],v[152:155]
v_mfma_f32_16x16x32_bf16 v[156:159],a[116:119],v[12:15],v[156:159]
v_mfma_f32_16x16x32_bf16 v[152:155],a[120:123],v[12:15],v[152:155]
v_mfma_f32_16x16x32_bf16 v[156:159],a[124:127],v[12:15],v[156:159]
v_mfma_f32_16x16x32_bf16 v[152:155],a[128:131],v[12:15],v[152:155]
v_mfma_f32_16x16x32_bf16 v[156:159],a[132:135],v[12:15],v[156:159]
v_mfma_f32_16x16x32_bf16 v[152:155],a[136:139],v[12:15],v[152:155]
v_mfma_f32_16x16x32_bf16 v[156:159],a[140:143],v[12:15],v[156:159]
v_mfma_f32_16x16x32_bf16 v[152:155],a[144:147],v[12:15],v[152:155]
v_mfma_f32_16x16x32_bf16 v[156:159],a[148:151],v[12:15],v[156:159]
v_mfma_f32_16x16x32_bf16 v[152:155],a[152:155],v[12:15],v[152:155]
v_mfma_f32_16x16x32_bf16 v[156:159],a[156:159],v[12:15],v[156:159]
v_mfma_f32_16x16x32_bf16 v[152:155],a[160:163],v[12:15],v[152:155]
v_mfma_f32_16x16x32_bf16 v[156:159],a[164:167],v[12:15],v[156:159]
v_mfma_f32_16x16x32_bf16 v[152:155],a[168:171],v[12:15],v[152:155]
v_mfma_f32_16x16x32_bf16 v[156:159],a[172:175],v[12:15],v[156:159]
v_mfma_f32_16x16x32_bf16 v[152:155],a[176:179],v[12:15],v[152:155]
v_mfma_f32_16x16x32_bf16 v[156:159],a[180:183],v[12:15],v[156:159]
v_mfma_f32_16x16x32_bf16 v[152:155],a[184:187],v[12:15],v[152:155]
v_mfma_f32_16x16x32_bf16 v[156:159],a[188:191],v[12:15],v[156:159]
v_mfma_f32_16x16x32_bf16 v[152:155],a[192:195],v[12:15],v[152:155]
v_mfma_f32_16x16x32_bf16 v[156:159],a[196:199],v[12:15],v[156:159]
v_mfma_f32_16x16x32_bf16 v[152:155],a[200:203],v[12:15],v[152:155]
v_mfma_f32_16x16x32_bf16 v[156:159],a[204:207],v[12:15],v[156:159]
v_mfma_f32_16x16x32_bf16 v[152:155],a[208:211],v[12:15],v[152:155]
v_mfma_f32_16x16x32_bf16 v[156:159],a[212:215],v[12:15],v[156:159]
v_mfma_f32_16x16x32_bf16 v[152:155],a[216:219],v[12:15],v[152:155]
v_mfma_f32_16x16x32_bf16 v[156:159],a[220:223],v[12:15],v[156:159]
v_mfma_f32_16x16x32_bf16 v[152:155],a[224:227],v[12:15],v[152:155]
v_mfma_f32_16x16x32_bf16 v[156:159],a[228:231],v[12:15],v[156:159]
v_mfma_f32_16x16x32_bf16 v[152:155],a[232:235],v[12:15],v[152:155]
v_mfma_f32_16x16x32_bf16 v[156:159],a[236:239],v[12:15],v[156:159]
v_mfma_f32_16x16x32_bf16 v[152:155],a[240:243],v[12:15],v[152:155]
v_mfma_f32_16x16x32_bf16 v[156:159],a[244:247],v[12:15],v[156:159]
v_mfma_f32_16x16x32_bf16 v[152:155],a[248:251],v[12:15],v[152:155]
v_mfma_f32_16x16x32_bf16 v[156:159],a[252:255],v[12:15],v[156:159]
v_lshlrev_b32 v26,2,v1
v_cmp_gt_u32 vcc,32,v1
s_nop 1
v_cndmask_b32 v26,2.0,v26,vcc
s_cmp_eq_u32 s56,1
s_cbranch_scc1 lfar_317
s_add_u32 s71,s60,1
s_add_u32 s53,s60,2
plp_325:
buffer_load_dword v16,v2,s[20:23],s68 offen sc1
s_waitcnt vmcnt(0)
v_cmp_gt_u32 vcc,s71,v16
s_cbranch_vccz pok_326
s_sleep 4
s_sub_u32 s90,s90,1
s_cmp_gt_i32 s90,0
s_cbranch_scc1 plp_325
pok_326:
lag_322:
s_mov_b32 m0,s70
s_nop 0
buffer_load_dwordx4 v3,s[20:23],s61 offen offset:0 lds
buffer_load_dwordx4 v3,s[20:23],s61 offen offset:1024 lds
buffer_load_dwordx4 v3,s[20:23],s61 offen offset:2048 lds
buffer_load_dwordx4 v3,s[20:23],s61 offen offset:3072 lds
s_add_u32 m0,s70,4096
s_nop 0
buffer_load_dwordx4 v3,s[20:23],s62 offen offset:0 lds
buffer_load_dwordx4 v3,s[20:23],s62 offen offset:1024 lds
buffer_load_dwordx4 v3,s[20:23],s62 offen offset:2048 lds
buffer_load_dwordx4 v3,s[20:23],s62 offen offset:3072 lds
s_add_u32 s61,s61,32768
s_add_u32 s62,s62,32768
s_add_u32 s70,s70,32768
s_and_b32 s70,s70,0x1ffff
buffer_load_dword v23,off,s[20:23],s66
buffer_load_dword v23,off,s[20:23],s66
dec_323:
v_cmp_gt_u32 vcc,s53,v16
s_cbranch_vccnz BN_321
BR_320:
s_waitcnt vmcnt(9)
ds_read_b128 v[64:67],v4 offset:0
s_waitcnt vmcnt(8)
ds_read_b128 v[68:71],v4 offset:1024
s_waitcnt vmcnt(7)
ds_read_b128 v[72:75],v4 offset:2048
s_waitcnt vmcnt(6)
ds_read_b128 v[76:79],v4 offset:3072
s_waitcnt lgkmcnt(3)
v_mfma_f32_16x16x32_bf16 v[32:35],a[0:3],v[64:67],0
s_add_u32 s71,s60,2
s_add_u32 s53,s60,3
s_mov_b32 s57,s63
v_mfma_f32_16x16x32_bf16 v[36:39],a[4:7],v[64:67],0
v_mfma_f32_16x16x32_bf16 v[48:51],v[12:15],v[64:67],0
v_mfma_f32_16x16x32_bf16 v[52:55],v[64:67],v[64:67],0
s_waitcnt lgkmcnt(2)
s_waitcnt vmcnt(5)
s_mov_b32 m0,s70
ds_read_b128 v[80:83],v4 offset:4096
v_mfma_f32_16x16x32_bf16 v[32:35],a[8:11],v[68:71],v[32:35]
buffer_load_dwordx4 v3,s[20:23],s61 offen offset:0 lds
v_mfma_f32_16x16x32_bf16 v[36:39],a[12:15],v[68:71],v[36:39]
v_mfma_f32_16x16x32_bf16 v[48:51],v[12:15],v[68:71],v[48:51]
v_mfma_f32_16x16x32_bf16 v[52:55],v[68:71],v[68:71],v[52:55]
s_waitcnt lgkmcnt(2)
s_waitcnt vmcnt(5)
ds_read_b128 v[84:87],v4 offset:5120
v_mfma_f32_16x16x32_bf16 v[32:35],a[16:19],v[72:75],v[32:35]
buffer_load_dwordx4 v3,s[20:23],s61 offen offset:1024 lds
v_mfma_f32_16x16x32_bf16 v[36:39],a[20:23],v[72:75],v[36:39]
v_mfma_f32_16x16x32_bf16 v[48:51],v[12:15],v[72:75],v[48:51]
v_mfma_f32_16x16x32_bf16 v[52:55],v[72:75],v[72:75],v[52:55]
s_waitcnt lgkmcnt(2)
s_waitcnt vmcnt(5)
ds_read_b128 v[88:91],v4 offset:6144
v_mfma_f32_16x16x32_bf16 v[32:35],a[24:27],v[76:79],v[32:35]
buffer_load_dwordx4 v3,s[20:23],s61 offen offset:2048 lds
v_mfma_f32_16x16x32_bf16 v[36:39],a[28:31],v[76:79],v[36:39]
v_mfma_f32_16x16x32_bf16 v[48:51],v[12:15],v[76:79],v[48:51]
v_mfma_f32_16x16x32_bf16 v[52:55],v[76:79],v[76:79],v[52:55]
s_waitcnt lgkmcnt(2)
s_waitcnt vmcnt(5)
ds_read_b128 v[92:95],v4 offset:7168
v_mfma_f32_16x16x32_bf16 v[32:35],a[32:35],v[80:83],v[32:35]
buffer_load_dwordx4 v3,s[20:23],s61 offen offset:3072 lds
v_mfma_f32_16x16x32_bf16 v[36:39],a[36:39],v[80:83],v[36:39]
v_mfma_f32_16x16x32_bf16 v[48:51],v[12:15],v[80:83],v[48:51]
v_mfma_f32_16x16x32_bf16 v[52:55],v[80:83],v[80:83],v[52:55]
s_waitcnt lgkmcnt(2)
s_barrier
ds_read_b128 v[96:99],v5 offset:0
v_mfma_f32_16x16x32_bf16 v[32:35],a[40:43],v[84:87],v[32:35]
ds_read_b128 v[100:103],v5 offset:1024
v_mfma_f32_16x16x32_bf16 v[36:39],a[44:47],v[84:87],v[36:39]
ds_read_b128 v[104:107],v5 offset:2048
v_mfma_f32_16x16x32_bf16 v[48:51],v[12:15],v[84:87],v[48:51]
s_add_u32 m0,s70,4096
ds_read_b128 v[108:111],v5 offset:3072
v_mfma_f32_16x16x32_bf16 v[52:55],v[84:87],v[84:87],v[52:55]
s_waitcnt lgkmcnt(5)
buffer_load_dwordx4 v3,s[20:23],s62 offen offset:0 lds
v_mfma_f32_16x16x32_bf16 v[32:35],a[48:51],v[88:91],v[32:35]
ds_read_b128 v[112:115],v5 offset:4096
v_mfma_f32_16x16x32_bf16 v[36:39],a[52:55],v[88:91],v[36:39]
buffer_load_dwordx4 v3,s[20:23],s62 offen offset:1024 lds
v_mfma_f32_16x16x32_bf16 v[48:51],v[12:15],v[88:91],v[48:51]
v_mfma_f32_16x16x32_bf16 v[52:55],v[88:91],v[88:91],v[52:55]
s_waitcnt lgkmcnt(5)
v_mfma_f32_16x16x32_bf16 v[32:35],a[56:59],v[92:95],v[32:35]
ds_read_b128 v[116:119],v5 offset:5120
v_mfma_f32_16x16x32_bf16 v[36:39],a[60:63],v[92:95],v[36:39]
buffer_load_dwordx4 v3,s[20:23],s62 offen offset:2048 lds
v_mfma_f32_16x16x32_bf16 v[48:51],v[12:15],v[92:95],v[48:51]
buffer_load_dword v16,v2,s[20:23],s68 offen sc1
v_mfma_f32_16x16x32_bf16 v[52:55],v[92:95],v[92:95],v[52:55]
s_waitcnt lgkmcnt(5)
v_mfma_f32_16x16x32_bf16 v[32:35],a[64:67],v[96:99],v[32:35]
ds_read_b128 v[120:123],v5 offset:6144
v_mfma_f32_16x16x32_bf16 v[36:39],a[68:71],v[96:99],v[36:39]
s_waitcnt lgkmcnt(5)
buffer_load_dwordx4 v3,s[20:23],s62 offen offset:3072 lds
v_mfma_f32_16x16x32_bf16 v[32:35],a[72:75],v[100:103],v[32:35]
ds_read_b128 v[124:127],v5 offset:7168
v_mfma_f32_16x16x32_bf16 v[36:39],a[76:79],v[100:103],v[36:39]
s_waitcnt lgkmcnt(5)
v_mfma_f32_16x16x32_bf16 v[32:35],a[80:83],v[104:107],v[32:35]
ds_read_b128 v[64:67],v6 offset:0
v_cndmask_b32 v49,v52,v53,s[74:75]
v_mfma_f32_16x16x32_bf16 v[36:39],a[84:87],v[104:107],v[36:39]
s_waitcnt lgkmcnt(5)
v_cndmask_b32 v49,v49,v54,s[76:77]
v_cndmask_b32 v49,v49,v55,s[78:79]
v_mfma_f32_16x16x32_bf16 v[32:35],a[88:91],v[108:111],v[32:35]
ds_read_b128 v[68:71],v6 offset:1024
v_mfma_f32_16x16x32_bf16 v[36:39],a[92:95],v[108:111],v[36:39]
s_waitcnt lgkmcnt(5)
ds_write_b64 v19,v[48:49]
v_mfma_f32_16x16x32_bf16 v[32:35],a[96:99],v[112:115],v[32:35]
ds_read_b128 v[72:75],v6 offset:2048
v_mfma_f32_16x16x32_bf16 v[36:39],a[100:103],v[112:115],v[36:39]
s_waitcnt lgkmcnt(6)
v_mfma_f32_16x16x32_bf16 v[32:35],a[104:107],v[116:119],v[32:35]
ds_read_b128 v[76:79],v6 offset:3072
v_mfma_f32_16x16x32_bf16 v[36:39],a[108:111],v[116:119],v[36:39]
s_waitcnt lgkmcnt(6)
v_mfma_f32_16x16x32_bf16 v[32:35],a[112:115],v[120:123],v[32:35]
s_waitcnt lgkmcnt(2)
s_barrier
ds_read_b128 v[80:83],v6 offset:4096
v_mfma_f32_16x16x32_bf16 v[36:39],a[116:119],v[120:123],v[36:39]
ds_read_b64 v[56:57],v20 offset:0
v_mfma_f32_16x16x32_bf16 v[32:35],a[120:123],v[124:127],v[32:35]
ds_read_b128 v[84:87],v6 offset:5120
v_mfma_f32_16x16x32_bf16 v[36:39],a[124:127],v[124:127],v[36:39]
ds_read_b64 v[58:59],v20 offset:512
v_mfma_f32_16x16x32_bf16 v[32:35],a[128:131],v[64:67],v[32:35]
ds_read_b128 v[88:91],v6 offset:6144
v_mfma_f32_16x16x32_bf16 v[36:39],a[132:135],v[64:67],v[36:39]
ds_read_b64 v[60:61],v20 offset:1024
v_mfma_f32_16x16x32_bf16 v[32:35],a[136:139],v[68:71],v[32:35]
ds_read_b128 v[92:95],v6 offset:7168
v_mfma_f32_16x16x32_bf16 v[36:39],a[140:143],v[68:71],v[36:39]
s_waitcnt lgkmcnt(8)
ds_read_b64 v[62:63],v20 offset:1536
v_mfma_f32_16x16x32_bf16 v[32:35],a[144:147],v[72:75],v[32:35]
ds_read_b128 v[96:99],v7 offset:0
v_mfma_f32_16x16x32_bf16 v[36:39],a[148:151],v[72:75],v[36:39]
s_waitcnt lgkmcnt(9)
s_waitcnt vmcnt(10)
v_mov_b32 v17,s57
buffer_store_dword v17,v26,s[20:23],s69 offen
v_mfma_f32_16x16x32_bf16 v[32:35],a[152:155],v[76:79],v[32:35]
ds_read_b128 v[100:103],v7 offset:1024
v_mfma_f32_16x16x32_bf16 v[36:39],a[156:159],v[76:79],v[36:39]
s_waitcnt lgkmcnt(9)
v_mfma_f32_16x16x32_bf16 v[32:35],a[160:163],v[80:83],v[32:35]
ds_read_b128 v[104:107],v7 offset:2048
v_mfma_f32_16x16x32_bf16 v[36:39],a[164:167],v[80:83],v[36:39]
s_waitcnt lgkmcnt(8)
s_waitcnt lgkmcnt(3)
v_add_f32 v56,v56,v58
v_mfma_f32_16x16x32_bf16 v[32:35],a[168:171],v[84:87],v[32:35]
ds_read_b128 v[108:111],v7 offset:3072
v_add_f32 v57,v57,v59
v_mfma_f32_16x16x32_bf16 v[36:39],a[172:175],v[84:87],v[36:39]
v_add_f32 v60,v60,v62
v_add_f32 v61,v61,v63
v_mfma_f32_16x16x32_bf16 v[32:35],a[176:179],v[88:91],v[32:35]
ds_read_b128 v[112:115],v7 offset:4096
v_add_f32 v56,v56,v60
v_mfma_f32_16x16x32_bf16 v[36:39],a[180:183],v[88:91],v[36:39]
v_add_f32 v57,v57,v61
v_mul_f32 v188,0xba800000,v56
v_mfma_f32_16x16x32_bf16 v[32:35],a[184:187],v[92:95],v[32:35]
ds_read_b128 v[116:119],v7 offset:5120
v_fma_f32 v58,v188,v188,-v210
v_mfma_f32_16x16x32_bf16 v[36:39],a[188:191],v[92:95],v[36:39]
s_waitcnt lgkmcnt(5)
v_fma_f32 v57,v57,v211,-v58
v_max_f32 v57,v210,v57
v_mfma_f32_16x16x32_bf16 v[32:35],a[192:195],v[96:99],v[32:35]
ds_read_b128 v[120:123],v7 offset:6144
v_mfma_f32_16x16x32_bf16 v[36:39],a[196:199],v[96:99],v[36:39]
s_waitcnt lgkmcnt(5)
v_rsq_f32 v58,v57
v_mfma_f32_16x16x32_bf16 v[32:35],a[200:203],v[100:103],v[32:35]
ds_read_b128 v[124:127],v7 offset:7168
v_mul_f32 v189,v57,v58
v_mfma_f32_16x16x32_bf16 v[36:39],a[204:207],v[100:103],v[36:39]
s_waitcnt lgkmcnt(5)
v_mul_f32 v190,v209,v58
v_mul_f32 v59,v58,v58
v_mfma_f32_16x16x32_bf16 v[32:35],a[208:211],v[104:107],v[32:35]
s_add_u32 s61,s61,32768
v_mul_f32 v191,v208,v58
v_mul_f32 v191,v191,v59
v_mfma_f32_16x16x32_bf16 v[36:39],a[212:215],v[104:107],v[36:39]
s_waitcnt lgkmcnt(4)
s_add_u32 s62,s62,32768
s_add_u32 s70,s70,32768
v_mfma_f32_16x16x32_bf16 v[32:35],a[216:219],v[108:111],v[32:35]
s_and_b32 s70,s70,0x1ffff
s_add_u32 s55,s55,32768
s_and_b32 s55,s55,0x1ffff
v_mfma_f32_16x16x32_bf16 v[36:39],a[220:223],v[108:111],v[36:39]
s_waitcnt lgkmcnt(3)
v_add_u32 v4,s55,v8
v_add_u32 v5,s55,v9
v_mfma_f32_16x16x32_bf16 v[32:35],a[224:227],v[112:115],v[32:35]
v_add_u32 v6,s55,v10
v_add_u32 v7,s55,v11
v_mfma_f32_16x16x32_bf16 v[36:39],a[228:231],v[112:115],v[36:39]
s_waitcnt lgkmcnt(2)
s_waitcnt vmcnt(9)
ds_read_b128 v[64:67],v4 offset:0
v_mfma_f32_16x16x32_bf16 v[32:35],a[232:235],v[116:119],v[32:35]
s_waitcnt vmcnt(8)
ds_read_b128 v[68:71],v4 offset:1024
v_mfma_f32_16x16x32_bf16 v[36:39],a[236:239],v[116:119],v[36:39]
s_waitcnt lgkmcnt(3)
s_waitcnt vmcnt(7)
ds_read_b128 v[72:75],v4 offset:2048
v_mfma_f32_16x16x32_bf16 v[32:35],a[240:243],v[120:123],v[32:35]
v_mfma_f32_16x16x32_bf16 v[36:39],a[244:247],v[120:123],v[36:39]
s_waitcnt lgkmcnt(3)
v_mfma_f32_16x16x32_bf16 v[40:43],a[248:251],v[124:127],v[32:35]
v_mfma_f32_16x16x32_bf16 v[44:47],a[252:255],v[124:127],v[36:39]
s_waitcnt vmcnt(2)
v_cmp_gt_u32 vcc,s53,v16
s_add_u32 s60,s60,1
s_cbranch_vccnz WN_319
.p2align 6
WR_318:
s_waitcnt lgkmcnt(2)
v_mfma_f32_16x16x32_bf16 v[32:35],a[0:3],v[64:67],0
s_waitcnt vmcnt(6)
s_add_u32 s71,s60,2
ds_read_b128 v[76:79],v4 offset:3072
v_mfma_f32_16x16x32_bf16 v[36:39],a[4:7],v[64:67],0
s_add_u32 s53,s60,3
s_mov_b32 s57,s63
v_mfma_f32_16x16x32_bf16 v[48:51],v[12:15],v[64:67],0
s_mov_b32 m0,s70
v_fma_f32 v40,v152,v188,v40
v_fma_f32 v41,v153,v188,v41
v_mul_f32 v168,v40,v40
v_mfma_f32_16x16x32_bf16 v[52:55],v[64:67],v[64:67],0
s_waitcnt lgkmcnt(2)
buffer_load_dwordx4 v3,s[20:23],s61 offen offset:0 lds
v_mul_f32 v169,v41,v41
v_fma_f32 v168,v168,v191,v190
v_mfma_f32_16x16x32_bf16 v[32:35],a[8:11],v[68:71],v[32:35]
s_waitcnt vmcnt(6)
ds_read_b128 v[80:83],v4 offset:4096
v_fma_f32 v169,v169,v191,v190
v_mul_f32 v168,v168,v40
v_mfma_f32_16x16x32_bf16 v[36:39],a[12:15],v[68:71],v[36:39]
v_exp_f32 v168,v168
v_mul_f32 v169,v169,v41
v_mfma_f32_16x16x32_bf16 v[48:51],v[12:15],v[68:71],v[48:51]
v_exp_f32 v169,v169
v_fma_f32 v168,v168,v189,v189
v_mfma_f32_16x16x32_bf16 v[52:55],v[68:71],v[68:71],v[52:55]
s_waitcnt lgkmcnt(2)
buffer_load_dwordx4 v3,s[20:23],s61 offen offset:1024 lds
v_rcp_f32 v168,v168
v_mfma_f32_16x16x32_bf16 v[32:35],a[16:19],v[72:75],v[32:35]
s_waitcnt vmcnt(6)
ds_read_b128 v[84:87],v4 offset:5120
v_fma_f32 v169,v169,v189,v189
v_mul_f32 v40,v168,v40
v_mfma_f32_16x16x32_bf16 v[36:39],a[20:23],v[72:75],v[36:39]
v_rcp_f32 v169,v169
v_fma_f32 v42,v154,v188,v42
v_mfma_f32_16x16x32_bf16 v[48:51],v[12:15],v[72:75],v[48:51]
v_mul_f32 v41,v169,v41
v_fma_f32 v43,v155,v188,v43
v_mul_f32 v170,v42,v42
v_mfma_f32_16x16x32_bf16 v[52:55],v[72:75],v[72:75],v[52:55]
s_waitcnt lgkmcnt(2)
buffer_load_dwordx4 v3,s[20:23],s61 offen offset:2048 lds
v_mul_f32 v171,v43,v43
v_fma_f32 v170,v170,v191,v190
v_mfma_f32_16x16x32_bf16 v[32:35],a[24:27],v[76:79],v[32:35]
s_waitcnt vmcnt(6)
ds_read_b128 v[88:91],v4 offset:6144
v_fma_f32 v171,v171,v191,v190
v_mfma_f32_16x16x32_bf16 v[36:39],a[28:31],v[76:79],v[36:39]
v_mul_f32 v170,v170,v42
v_mul_f32 v171,v171,v43
v_mfma_f32_16x16x32_bf16 v[48:51],v[12:15],v[76:79],v[48:51]
v_exp_f32 v170,v170
v_mfma_f32_16x16x32_bf16 v[52:55],v[76:79],v[76:79],v[52:55]
s_waitcnt lgkmcnt(2)
buffer_load_dwordx4 v3,s[20:23],s61 offen offset:3072 lds
v_fma_f32 v170,v170,v189,v189
v_mfma_f32_16x16x32_bf16 v[32:35],a[32:35],v[80:83],v[32:35]
s_waitcnt vmcnt(5)
ds_read_b128 v[92:95],v4 offset:7168
v_fma_f32 v44,v156,v188,v44
v_mfma_f32_16x16x32_bf16 v[36:39],a[36:39],v[80:83],v[36:39]
s_barrier
ds_read_b128 v[96:99],v5 offset:0
v_fma_f32 v45,v157,v188,v45
v_mfma_f32_16x16x32_bf16 v[48:51],v[12:15],v[80:83],v[48:51]
ds_read_b128 v[100:103],v5 offset:1024
v_mul_f32 v172,v44,v44
v_mfma_f32_16x16x32_bf16 v[52:55],v[80:83],v[80:83],v[52:55]
s_waitcnt lgkmcnt(4)
ds_read_b128 v[104:107],v5 offset:2048
v_mul_f32 v173,v45,v45
v_mfma_f32_16x16x32_bf16 v[32:35],a[40:43],v[84:87],v[32:35]
s_add_u32 m0,s70,4096
ds_read_b128 v[108:111],v5 offset:3072
v_fma_f32 v172,v172,v191,v190
v_mfma_f32_16x16x32_bf16 v[36:39],a[44:47],v[84:87],v[36:39]
buffer_load_dwordx4 v3,s[20:23],s62 offen offset:0 lds
v_fma_f32 v173,v173,v191,v190
v_mfma_f32_16x16x32_bf16 v[48:51],v[12:15],v[84:87],v[48:51]
s_waitcnt vmcnt(5)
v_mov_b32 v17,s57
buffer_store_dword v17,v26,s[20:23],s69 offen
v_mfma_f32_16x16x32_bf16 v[52:55],v[84:87],v[84:87],v[52:55]
s_waitcnt lgkmcnt(5)
v_exp_f32 v171,v171
v_mfma_f32_16x16x32_bf16 v[32:35],a[48:51],v[88:91],v[32:35]
ds_read_b128 v[112:115],v5 offset:4096
v_fma_f32 v171,v171,v189,v189
v_mfma_f32_16x16x32_bf16 v[36:39],a[52:55],v[88:91],v[36:39]
buffer_load_dwordx4 v3,s[20:23],s62 offen offset:1024 lds
v_mul_f32 v172,v172,v44
v_mfma_f32_16x16x32_bf16 v[48:51],v[12:15],v[88:91],v[48:51]
v_rcp_f32 v170,v170
v_mfma_f32_16x16x32_bf16 v[52:55],v[88:91],v[88:91],v[52:55]
s_waitcnt lgkmcnt(5)
v_rcp_f32 v171,v171
v_mfma_f32_16x16x32_bf16 v[32:35],a[56:59],v[92:95],v[32:35]
ds_read_b128 v[116:119],v5 offset:5120
v_mul_f32 v42,v170,v42
v_mfma_f32_16x16x32_bf16 v[36:39],a[60:63],v[92:95],v[36:39]
buffer_load_dwordx4 v3,s[20:23],s62 offen offset:2048 lds
v_mul_f32 v43,v171,v43
v_mfma_f32_16x16x32_bf16 v[48:51],v[12:15],v[92:95],v[48:51]
buffer_load_dword v16,v2,s[20:23],s68 offen sc1
v_mul_f32 v173,v173,v45
v_mfma_f32_16x16x32_bf16 v[52:55],v[92:95],v[92:95],v[52:55]
s_waitcnt lgkmcnt(5)
v_exp_f32 v172,v172
v_mfma_f32_16x16x32_bf16 v[32:35],a[64:67],v[96:99],v[32:35]
ds_read_b128 v[120:123],v5 offset:6144
v_fma_f32 v172,v172,v189,v189
v_mfma_f32_16x16x32_bf16 v[36:39],a[68:71],v[96:99],v[36:39]
s_waitcnt lgkmcnt(5)
buffer_load_dwordx4 v3,s[20:23],s62 offen offset:3072 lds
v_fma_f32 v46,v158,v188,v46
v_mfma_f32_16x16x32_bf16 v[32:35],a[72:75],v[100:103],v[32:35]
ds_read_b128 v[124:127],v5 offset:7168
v_fma_f32 v47,v159,v188,v47
v_mfma_f32_16x16x32_bf16 v[36:39],a[76:79],v[100:103],v[36:39]
s_waitcnt lgkmcnt(5)
v_exp_f32 v173,v173
v_mfma_f32_16x16x32_bf16 v[32:35],a[80:83],v[104:107],v[32:35]
ds_read_b128 v[64:67],v6 offset:0
v_cndmask_b32 v49,v52,v53,s[74:75]
v_mfma_f32_16x16x32_bf16 v[36:39],a[84:87],v[104:107],v[36:39]
s_waitcnt lgkmcnt(5)
v_cndmask_b32 v49,v49,v54,s[76:77]
v_cndmask_b32 v49,v49,v55,s[78:79]
v_mfma_f32_16x16x32_bf16 v[32:35],a[88:91],v[108:111],v[32:35]
ds_read_b128 v[68:71],v6 offset:1024
v_fma_f32 v173,v173,v189,v189
v_mfma_f32_16x16x32_bf16 v[36:39],a[92:95],v[108:111],v[36:39]
s_waitcnt lgkmcnt(5)
ds_write_b64 v19,v[48:49]
v_mfma_f32_16x16x32_bf16 v[32:35],a[96:99],v[112:115],v[32:35]
ds_read_b128 v[72:75],v6 offset:2048
v_mul_f32 v174,v46,v46
v_mfma_f32_16x16x32_bf16 v[36:39],a[100:103],v[112:115],v[36:39]
s_waitcnt lgkmcnt(6)
v_rcp_f32 v172,v172
v_mfma_f32_16x16x32_bf16 v[32:35],a[104:107],v[116:119],v[32:35]
ds_read_b128 v[76:79],v6 offset:3072
v_mul_f32 v44,v172,v44
v_mfma_f32_16x16x32_bf16 v[36:39],a[108:111],v[116:119],v[36:39]
s_waitcnt lgkmcnt(6)
v_rcp_f32 v173,v173
v_mfma_f32_16x16x32_bf16 v[32:35],a[112:115],v[120:123],v[32:35]
s_waitcnt lgkmcnt(2)
s_barrier
ds_read_b128 v[80:83],v6 offset:4096
v_mfma_f32_16x16x32_bf16 v[36:39],a[116:119],v[120:123],v[36:39]
ds_read_b64 v[56:57],v20 offset:0
v_mul_f32 v45,v173,v45
v_mfma_f32_16x16x32_bf16 v[32:35],a[120:123],v[124:127],v[32:35]
ds_read_b128 v[84:87],v6 offset:5120
v_mul_f32 v175,v47,v47
v_mfma_f32_16x16x32_bf16 v[36:39],a[124:127],v[124:127],v[36:39]
ds_read_b64 v[58:59],v20 offset:512
v_fma_f32 v174,v174,v191,v190
v_mfma_f32_16x16x32_bf16 v[32:35],a[128:131],v[64:67],v[32:35]
ds_read_b128 v[88:91],v6 offset:6144
v_fma_f32 v175,v175,v191,v190
v_mfma_f32_16x16x32_bf16 v[36:39],a[132:135],v[64:67],v[36:39]
ds_read_b64 v[60:61],v20 offset:1024
v_mul_f32 v174,v174,v46
v_mfma_f32_16x16x32_bf16 v[32:35],a[136:139],v[68:71],v[32:35]
ds_read_b128 v[92:95],v6 offset:7168
v_mul_f32 v175,v175,v47
v_mfma_f32_16x16x32_bf16 v[36:39],a[140:143],v[68:71],v[36:39]
s_waitcnt lgkmcnt(8)
ds_read_b64 v[62:63],v20 offset:1536
v_cvt_pk_bf16_f32 v176,v40,v41
v_mfma_f32_16x16x32_bf16 v[32:35],a[144:147],v[72:75],v[32:35]
ds_read_b128 v[96:99],v7 offset:0
v_cvt_pk_bf16_f32 v177,v42,v43
v_mfma_f32_16x16x32_bf16 v[36:39],a[148:151],v[72:75],v[36:39]
s_waitcnt lgkmcnt(9)
v_exp_f32 v174,v174
v_mfma_f32_16x16x32_bf16 v[32:35],a[152:155],v[76:79],v[32:35]
ds_read_b128 v[100:103],v7 offset:1024
v_fma_f32 v174,v174,v189,v189
v_mfma_f32_16x16x32_bf16 v[36:39],a[156:159],v[76:79],v[36:39]
s_waitcnt lgkmcnt(9)
v_exp_f32 v175,v175
v_mfma_f32_16x16x32_bf16 v[32:35],a[160:163],v[80:83],v[32:35]
ds_read_b128 v[104:107],v7 offset:2048
v_fma_f32 v175,v175,v189,v189
v_mfma_f32_16x16x32_bf16 v[36:39],a[164:167],v[80:83],v[36:39]
s_waitcnt lgkmcnt(8)
s_waitcnt lgkmcnt(3)
v_rcp_f32 v174,v174
v_mfma_f32_16x16x32_bf16 v[32:35],a[168:171],v[84:87],v[32:35]
ds_read_b128 v[108:111],v7 offset:3072
v_mul_f32 v46,v174,v46
v_mfma_f32_16x16x32_bf16 v[36:39],a[172:175],v[84:87],v[36:39]
v_rcp_f32 v175,v175
v_mfma_f32_16x16x32_bf16 v[32:35],a[176:179],v[88:91],v[32:35]
ds_read_b128 v[112:115],v7 offset:4096
v_mul_f32 v47,v175,v47
v_mfma_f32_16x16x32_bf16 v[36:39],a[180:183],v[88:91],v[36:39]
v_cvt_pk_bf16_f32 v178,v44,v45
v_cvt_pk_bf16_f32 v179,v46,v47
v_mfma_f32_16x16x32_bf16 v[32:35],a[184:187],v[92:95],v[32:35]
ds_read_b128 v[116:119],v7 offset:5120
v_add_f32 v56,v56,v58
v_mfma_f32_16x16x32_bf16 v[36:39],a[188:191],v[92:95],v[36:39]
s_waitcnt lgkmcnt(5)
buffer_store_dwordx4 v[176:179],v0,s[20:23],s66 offen sc1
v_mfma_f32_16x16x32_bf16 v[32:35],a[192:195],v[96:99],v[32:35]
s_add_u32 s66,s66,32768
s_add_u32 s63,s63,1
ds_read_b128 v[120:123],v7 offset:6144
v_mfma_f32_16x16x32_bf16 v[36:39],a[196:199],v[96:99],v[36:39]
s_waitcnt lgkmcnt(5)
v_add_f32 v57,v57,v59
v_add_f32 v60,v60,v62
v_mfma_f32_16x16x32_bf16 v[32:35],a[200:203],v[100:103],v[32:35]
ds_read_b128 v[124:127],v7 offset:7168
v_add_f32 v61,v61,v63
v_mfma_f32_16x16x32_bf16 v[36:39],a[204:207],v[100:103],v[36:39]
s_waitcnt lgkmcnt(5)
v_add_f32 v56,v56,v60
v_add_f32 v57,v57,v61
v_mfma_f32_16x16x32_bf16 v[32:35],a[208:211],v[104:107],v[32:35]
s_add_u32 s61,s61,32768
v_mul_f32 v188,0xba800000,v56
v_fma_f32 v58,v188,v188,-v210
v_mfma_f32_16x16x32_bf16 v[36:39],a[212:215],v[104:107],v[36:39]
s_waitcnt lgkmcnt(4)
v_fma_f32 v57,v57,v211,-v58
v_max_f32 v57,v210,v57
v_mfma_f32_16x16x32_bf16 v[32:35],a[216:219],v[108:111],v[32:35]
s_add_u32 s62,s62,32768
v_rsq_f32 v58,v57
v_mfma_f32_16x16x32_bf16 v[36:39],a[220:223],v[108:111],v[36:39]
s_waitcnt lgkmcnt(3)
v_mul_f32 v189,v57,v58
v_mul_f32 v190,v209,v58
v_mfma_f32_16x16x32_bf16 v[32:35],a[224:227],v[112:115],v[32:35]
s_add_u32 s70,s70,32768
v_mul_f32 v59,v58,v58
v_mul_f32 v191,v208,v58
v_mfma_f32_16x16x32_bf16 v[36:39],a[228:231],v[112:115],v[36:39]
s_waitcnt lgkmcnt(2)
s_and_b32 s70,s70,0x1ffff
v_mul_f32 v191,v191,v59
v_mfma_f32_16x16x32_bf16 v[32:35],a[232:235],v[116:119],v[32:35]
s_add_u32 s55,s55,32768
s_and_b32 s55,s55,0x1ffff
v_add_u32 v4,s55,v8
v_mfma_f32_16x16x32_bf16 v[36:39],a[236:239],v[116:119],v[36:39]
s_waitcnt lgkmcnt(1)
v_add_u32 v5,s55,v9
v_add_u32 v6,s55,v10
v_mfma_f32_16x16x32_bf16 v[32:35],a[240:243],v[120:123],v[32:35]
v_add_u32 v7,s55,v11
v_mfma_f32_16x16x32_bf16 v[36:39],a[244:247],v[120:123],v[36:39]
s_waitcnt lgkmcnt(0)
s_waitcnt vmcnt(10)
ds_read_b128 v[64:67],v4 offset:0
v_mfma_f32_16x16x32_bf16 v[40:43],a[248:251],v[124:127],v[32:35]
s_waitcnt vmcnt(9)
ds_read_b128 v[68:71],v4 offset:1024
v_mfma_f32_16x16x32_bf16 v[44:47],a[252:255],v[124:127],v[36:39]
s_waitcnt vmcnt(2)
v_cmp_gt_u32 vcc,s53,v16
ds_read_b128 v[72:75],v4 offset:2048
s_add_u32 s60,s60,1
s_cbranch_vccz WR_318
WN_319:
s_waitcnt lgkmcnt(2)
v_mfma_f32_16x16x32_bf16 v[32:35],a[0:3],v[64:67],0
s_waitcnt vmcnt(6)
s_add_u32 s71,s60,2
ds_read_b128 v[76:79],v4 offset:3072
v_mfma_f32_16x16x32_bf16 v[36:39],a[4:7],v[64:67],0
s_add_u32 s53,s60,3
s_mov_b32 s57,s63
v_mfma_f32_16x16x32_bf16 v[48:51],v[12:15],v[64:67],0
v_fma_f32 v40,v152,v188,v40
v_fma_f32 v41,v153,v188,v41
v_mul_f32 v168,v40,v40
v_mfma_f32_16x16x32_bf16 v[52:55],v[64:67],v[64:67],0
s_waitcnt lgkmcnt(2)
v_mul_f32 v169,v41,v41
v_fma_f32 v168,v168,v191,v190
v_fma_f32 v169,v169,v191,v190
v_mfma_f32_16x16x32_bf16 v[32:35],a[8:11],v[68:71],v[32:35]
s_waitcnt vmcnt(5)
ds_read_b128 v[80:83],v4 offset:4096
v_mul_f32 v168,v168,v40
v_mul_f32 v169,v169,v41
v_mfma_f32_16x16x32_bf16 v[36:39],a[12:15],v[68:71],v[36:39]
v_exp_f32 v168,v168
v_fma_f32 v42,v154,v188,v42
v_mfma_f32_16x16x32_bf16 v[48:51],v[12:15],v[68:71],v[48:51]
v_exp_f32 v169,v169
v_fma_f32 v168,v168,v189,v189
v_mfma_f32_16x16x32_bf16 v[52:55],v[68:71],v[68:71],v[52:55]
s_waitcnt lgkmcnt(2)
v_rcp_f32 v168,v168
v_fma_f32 v169,v169,v189,v189
v_mfma_f32_16x16x32_bf16 v[32:35],a[16:19],v[72:75],v[32:35]
s_waitcnt vmcnt(4)
ds_read_b128 v[84:87],v4 offset:5120
v_rcp_f32 v169,v169
v_mfma_f32_16x16x32_bf16 v[36:39],a[20:23],v[72:75],v[36:39]
v_mul_f32 v40,v168,v40
v_mul_f32 v41,v169,v41
v_fma_f32 v43,v155,v188,v43
v_mfma_f32_16x16x32_bf16 v[48:51],v[12:15],v[72:75],v[48:51]
v_mul_f32 v170,v42,v42
v_mul_f32 v171,v43,v43
v_mfma_f32_16x16x32_bf16 v[52:55],v[72:75],v[72:75],v[52:55]
s_waitcnt lgkmcnt(2)
v_fma_f32 v170,v170,v191,v190
v_fma_f32 v171,v171,v191,v190
v_mfma_f32_16x16x32_bf16 v[32:35],a[24:27],v[76:79],v[32:35]
s_waitcnt vmcnt(3)
ds_read_b128 v[88:91],v4 offset:6144
v_mul_f32 v170,v170,v42
v_mfma_f32_16x16x32_bf16 v[36:39],a[28:31],v[76:79],v[36:39]
v_exp_f32 v170,v170
v_mfma_f32_16x16x32_bf16 v[48:51],v[12:15],v[76:79],v[48:51]
v_mul_f32 v171,v171,v43
v_fma_f32 v170,v170,v189,v189
v_mfma_f32_16x16x32_bf16 v[52:55],v[76:79],v[76:79],v[52:55]
s_waitcnt lgkmcnt(2)
v_exp_f32 v171,v171
v_mfma_f32_16x16x32_bf16 v[32:35],a[32:35],v[80:83],v[32:35]
s_waitcnt vmcnt(1)
ds_read_b128 v[92:95],v4 offset:7168
v_fma_f32 v171,v171,v189,v189
v_mfma_f32_16x16x32_bf16 v[36:39],a[36:39],v[80:83],v[36:39]
s_barrier
ds_read_b128 v[96:99],v5 offset:0
v_fma_f32 v44,v156,v188,v44
v_mfma_f32_16x16x32_bf16 v[48:51],v[12:15],v[80:83],v[48:51]
ds_read_b128 v[100:103],v5 offset:1024
v_fma_f32 v45,v157,v188,v45
v_mfma_f32_16x16x32_bf16 v[52:55],v[80:83],v[80:83],v[52:55]
s_waitcnt lgkmcnt(4)
ds_read_b128 v[104:107],v5 offset:2048
v_mul_f32 v172,v44,v44
v_mfma_f32_16x16x32_bf16 v[32:35],a[40:43],v[84:87],v[32:35]
ds_read_b128 v[108:111],v5 offset:3072
v_mul_f32 v173,v45,v45
v_mfma_f32_16x16x32_bf16 v[36:39],a[44:47],v[84:87],v[36:39]
s_waitcnt vmcnt(0)
v_mov_b32 v17,s57
buffer_store_dword v17,v26,s[20:23],s69 offen
v_mfma_f32_16x16x32_bf16 v[48:51],v[12:15],v[84:87],v[48:51]
v_rcp_f32 v170,v170
v_mfma_f32_16x16x32_bf16 v[52:55],v[84:87],v[84:87],v[52:55]
s_waitcnt lgkmcnt(5)
v_rcp_f32 v171,v171
v_mfma_f32_16x16x32_bf16 v[32:35],a[48:51],v[88:91],v[32:35]
ds_read_b128 v[112:115],v5 offset:4096
v_mul_f32 v42,v170,v42
v_mfma_f32_16x16x32_bf16 v[36:39],a[52:55],v[88:91],v[36:39]
v_mul_f32 v43,v171,v43
v_fma_f32 v172,v172,v191,v190
v_mfma_f32_16x16x32_bf16 v[48:51],v[12:15],v[88:91],v[48:51]
v_fma_f32 v173,v173,v191,v190
v_mul_f32 v172,v172,v44
v_mfma_f32_16x16x32_bf16 v[52:55],v[88:91],v[88:91],v[52:55]
s_waitcnt lgkmcnt(5)
v_exp_f32 v172,v172
v_mfma_f32_16x16x32_bf16 v[32:35],a[56:59],v[92:95],v[32:35]
ds_read_b128 v[116:119],v5 offset:5120
v_mul_f32 v173,v173,v45
v_mfma_f32_16x16x32_bf16 v[36:39],a[60:63],v[92:95],v[36:39]
v_exp_f32 v173,v173
v_mfma_f32_16x16x32_bf16 v[48:51],v[12:15],v[92:95],v[48:51]
v_fma_f32 v172,v172,v189,v189
v_fma_f32 v173,v173,v189,v189
v_mfma_f32_16x16x32_bf16 v[52:55],v[92:95],v[92:95],v[52:55]
s_waitcnt lgkmcnt(5)
v_rcp_f32 v172,v172
v_mfma_f32_16x16x32_bf16 v[32:35],a[64:67],v[96:99],v[32:35]
ds_read_b128 v[120:123],v5 offset:6144
v_mul_f32 v44,v172,v44
v_mfma_f32_16x16x32_bf16 v[36:39],a[68:71],v[96:99],v[36:39]
s_waitcnt lgkmcnt(5)
v_rcp_f32 v173,v173
v_mfma_f32_16x16x32_bf16 v[32:35],a[72:75],v[100:103],v[32:35]
ds_read_b128 v[124:127],v5 offset:7168
v_mul_f32 v45,v173,v45
v_mfma_f32_16x16x32_bf16 v[36:39],a[76:79],v[100:103],v[36:39]
s_waitcnt lgkmcnt(5)
v_fma_f32 v46,v158,v188,v46
v_fma_f32 v47,v159,v188,v47
v_mfma_f32_16x16x32_bf16 v[32:35],a[80:83],v[104:107],v[32:35]
ds_read_b128 v[64:67],v6 offset:0
v_cndmask_b32 v49,v52,v53,s[74:75]
v_mfma_f32_16x16x32_bf16 v[36:39],a[84:87],v[104:107],v[36:39]
s_waitcnt lgkmcnt(5)
v_cndmask_b32 v49,v49,v54,s[76:77]
v_cndmask_b32 v49,v49,v55,s[78:79]
v_mfma_f32_16x16x32_bf16 v[32:35],a[88:91],v[108:111],v[32:35]
ds_read_b128 v[68:71],v6 offset:1024
v_mul_f32 v174,v46,v46
v_mfma_f32_16x16x32_bf16 v[36:39],a[92:95],v[108:111],v[36:39]
s_waitcnt lgkmcnt(5)
ds_write_b64 v19,v[48:49]
v_mfma_f32_16x16x32_bf16 v[32:35],a[96:99],v[112:115],v[32:35]
ds_read_b128 v[72:75],v6 offset:2048
v_mul_f32 v175,v47,v47
v_mfma_f32_16x16x32_bf16 v[36:39],a[100:103],v[112:115],v[36:39]
s_waitcnt lgkmcnt(6)
v_fma_f32 v174,v174,v191,v190
v_fma_f32 v175,v175,v191,v190
v_mfma_f32_16x16x32_bf16 v[32:35],a[104:107],v[116:119],v[32:35]
ds_read_b128 v[76:79],v6 offset:3072
v_mul_f32 v174,v174,v46
v_mfma_f32_16x16x32_bf16 v[36:39],a[108:111],v[116:119],v[36:39]
s_waitcnt lgkmcnt(6)
v_exp_f32 v174,v174
v_mfma_f32_16x16x32_bf16 v[32:35],a[112:115],v[120:123],v[32:35]
s_waitcnt lgkmcnt(2)
s_barrier
ds_read_b128 v[80:83],v6 offset:4096
v_mfma_f32_16x16x32_bf16 v[36:39],a[116:119],v[120:123],v[36:39]
ds_read_b64 v[56:57],v20 offset:0
v_mul_f32 v175,v175,v47
v_mfma_f32_16x16x32_bf16 v[32:35],a[120:123],v[124:127],v[32:35]
ds_read_b128 v[84:87],v6 offset:5120
v_fma_f32 v174,v174,v189,v189
v_mfma_f32_16x16x32_bf16 v[36:39],a[124:127],v[124:127],v[36:39]
ds_read_b64 v[58:59],v20 offset:512
v_cvt_pk_bf16_f32 v176,v40,v41
v_mfma_f32_16x16x32_bf16 v[32:35],a[128:131],v[64:67],v[32:35]
ds_read_b128 v[88:91],v6 offset:6144
v_cvt_pk_bf16_f32 v177,v42,v43
v_mfma_f32_16x16x32_bf16 v[36:39],a[132:135],v[64:67],v[36:39]
ds_read_b64 v[60:61],v20 offset:1024
v_cvt_pk_bf16_f32 v178,v44,v45
v_mfma_f32_16x16x32_bf16 v[32:35],a[136:139],v[68:71],v[32:35]
ds_read_b128 v[92:95],v6 offset:7168
v_mfma_f32_16x16x32_bf16 v[36:39],a[140:143],v[68:71],v[36:39]
s_waitcnt lgkmcnt(8)
ds_read_b64 v[62:63],v20 offset:1536
v_mfma_f32_16x16x32_bf16 v[32:35],a[144:147],v[72:75],v[32:35]
ds_read_b128 v[96:99],v7 offset:0
v_mfma_f32_16x16x32_bf16 v[36:39],a[148:151],v[72:75],v[36:39]
s_waitcnt lgkmcnt(9)
buffer_load_dword v16,v2,s[20:23],s68 offen sc1
v_mfma_f32_16x16x32_bf16 v[32:35],a[152:155],v[76:79],v[32:35]
ds_read_b128 v[100:103],v7 offset:1024
v_mfma_f32_16x16x32_bf16 v[36:39],a[156:159],v[76:79],v[36:39]
s_waitcnt lgkmcnt(9)
v_exp_f32 v175,v175
v_mfma_f32_16x16x32_bf16 v[32:35],a[160:163],v[80:83],v[32:35]
ds_read_b128 v[104:107],v7 offset:2048
v_fma_f32 v175,v175,v189,v189
v_mfma_f32_16x16x32_bf16 v[36:39],a[164:167],v[80:83],v[36:39]
s_waitcnt lgkmcnt(8)
s_waitcnt lgkmcnt(3)
v_rcp_f32 v174,v174
v_mfma_f32_16x16x32_bf16 v[32:35],a[168:171],v[84:87],v[32:35]
ds_read_b128 v[108:111],v7 offset:3072
v_mul_f32 v46,v174,v46
v_mfma_f32_16x16x32_bf16 v[36:39],a[172:175],v[84:87],v[36:39]
v_rcp_f32 v175,v175
v_mfma_f32_16x16x32_bf16 v[32:35],a[176:179],v[88:91],v[32:35]
ds_read_b128 v[112:115],v7 offset:4096
v_mul_f32 v47,v175,v47
v_mfma_f32_16x16x32_bf16 v[36:39],a[180:183],v[88:91],v[36:39]
v_cvt_pk_bf16_f32 v179,v46,v47
v_add_f32 v56,v56,v58
v_mfma_f32_16x16x32_bf16 v[32:35],a[184:187],v[92:95],v[32:35]
ds_read_b128 v[116:119],v7 offset:5120
v_add_f32 v57,v57,v59
v_mfma_f32_16x16x32_bf16 v[36:39],a[188:191],v[92:95],v[36:39]
s_waitcnt lgkmcnt(5)
buffer_store_dwordx4 v[176:179],v0,s[20:23],s66 offen sc1
v_mfma_f32_16x16x32_bf16 v[32:35],a[192:195],v[96:99],v[32:35]
s_add_u32 s66,s66,32768
s_add_u32 s63,s63,1
ds_read_b128 v[120:123],v7 offset:6144
v_mfma_f32_16x16x32_bf16 v[36:39],a[196:199],v[96:99],v[36:39]
s_waitcnt lgkmcnt(5)
v_add_f32 v60,v60,v62
v_add_f32 v61,v61,v63
v_mfma_f32_16x16x32_bf16 v[32:35],a[200:203],v[100:103],v[32:35]
ds_read_b128 v[124:127],v7 offset:7168
v_add_f32 v56,v56,v60
v_mfma_f32_16x16x32_bf16 v[36:39],a[204:207],v[100:103],v[36:39]
s_waitcnt lgkmcnt(5)
v_add_f32 v57,v57,v61
v_mul_f32 v188,0xba800000,v56
v_mfma_f32_16x16x32_bf16 v[32:35],a[208:211],v[104:107],v[32:35]
s_add_u32 s55,s55,32768
v_fma_f32 v58,v188,v188,-v210
v_fma_f32 v57,v57,v211,-v58
v_mfma_f32_16x16x32_bf16 v[36:39],a[212:215],v[104:107],v[36:39]
s_waitcnt lgkmcnt(4)
s_and_b32 s55,s55,0x1ffff
v_max_f32 v57,v210,v57
v_mfma_f32_16x16x32_bf16 v[32:35],a[216:219],v[108:111],v[32:35]
v_rsq_f32 v58,v57
v_mfma_f32_16x16x32_bf16 v[36:39],a[220:223],v[108:111],v[36:39]
s_waitcnt lgkmcnt(3)
v_mul_f32 v189,v57,v58
v_mul_f32 v190,v209,v58
v_mfma_f32_16x16x32_bf16 v[32:35],a[224:227],v[112:115],v[32:35]
v_mul_f32 v59,v58,v58
v_mul_f32 v191,v208,v58
v_mfma_f32_16x16x32_bf16 v[36:39],a[228:231],v[112:115],v[36:39]
s_waitcnt lgkmcnt(2)
v_mul_f32 v191,v191,v59
v_add_u32 v4,s55,v8
v_mfma_f32_16x16x32_bf16 v[32:35],a[232:235],v[116:119],v[32:35]
v_add_u32 v5,s55,v9
v_add_u32 v6,s55,v10
v_mfma_f32_16x16x32_bf16 v[36:39],a[236:239],v[116:119],v[36:39]
s_waitcnt lgkmcnt(1)
v_add_u32 v7,s55,v11
v_mfma_f32_16x16x32_bf16 v[32:35],a[240:243],v[120:123],v[32:35]
v_mfma_f32_16x16x32_bf16 v[36:39],a[244:247],v[120:123],v[36:39]
s_waitcnt lgkmcnt(0)
v_mfma_f32_16x16x32_bf16 v[40:43],a[248:251],v[124:127],v[32:35]
v_mfma_f32_16x16x32_bf16 v[44:47],a[252:255],v[124:127],v[36:39]
s_waitcnt vmcnt(1)
v_cmp_gt_u32 vcc,s71,v16
s_add_u32 s60,s60,1
s_branch endN_327
BN_321:
s_waitcnt vmcnt(9)
ds_read_b128 v[64:67],v4 offset:0
s_waitcnt vmcnt(8)
ds_read_b128 v[68:71],v4 offset:1024
s_waitcnt vmcnt(7)
ds_read_b128 v[72:75],v4 offset:2048
s_waitcnt vmcnt(6)
ds_read_b128 v[76:79],v4 offset:3072
s_waitcnt lgkmcnt(3)
v_mfma_f32_16x16x32_bf16 v[32:35],a[0:3],v[64:67],0
s_add_u32 s71,s60,2
s_add_u32 s53,s60,3
s_mov_b32 s57,s63
v_mfma_f32_16x16x32_bf16 v[36:39],a[4:7],v[64:67],0
v_mfma_f32_16x16x32_bf16 v[48:51],v[12:15],v[64:67],0
v_mfma_f32_16x16x32_bf16 v[52:55],v[64:67],v[64:67],0
s_waitcnt lgkmcnt(2)
s_waitcnt vmcnt(5)
ds_read_b128 v[80:83],v4 offset:4096
v_mfma_f32_16x16x32_bf16 v[32:35],a[8:11],v[68:71],v[32:35]
v_mfma_f32_16x16x32_bf16 v[36:39],a[12:15],v[68:71],v[36:39]
v_mfma_f32_16x16x32_bf16 v[48:51],v[12:15],v[68:71],v[48:51]
v_mfma_f32_16x16x32_bf16 v[52:55],v[68:71],v[68:71],v[52:55]
s_waitcnt lgkmcnt(2)
s_waitcnt vmcnt(4)
ds_read_b128 v[84:87],v4 offset:5120
v_mfma_f32_16x16x32_bf16 v[32:35],a[16:19],v[72:75],v[32:35]
v_mfma_f32_16x16x32_bf16 v[36:39],a[20:23],v[72:75],v[36:39]
v_mfma_f32_16x16x32_bf16 v[48:51],v[12:15],v[72:75],v[48:51]
v_mfma_f32_16x16x32_bf16 v[52:55],v[72:75],v[72:75],v[52:55]
s_waitcnt lgkmcnt(2)
s_waitcnt vmcnt(3)
ds_read_b128 v[88:91],v4 offset:6144
v_mfma_f32_16x16x32_bf16 v[32:35],a[24:27],v[76:79],v[32:35]
v_mfma_f32_16x16x32_bf16 v[36:39],a[28:31],v[76:79],v[36:39]
v_mfma_f32_16x16x32_bf16 v[48:51],v[12:15],v[76:79],v[48:51]
v_mfma_f32_16x16x32_bf16 v[52:55],v[76:79],v[76:79],v[52:55]
s_waitcnt lgkmcnt(2)
s_waitcnt vmcnt(2)
ds_read_b128 v[92:95],v4 offset:7168
v_mfma_f32_16x16x32_bf16 v[32:35],a[32:35],v[80:83],v[32:35]
v_mfma_f32_16x16x32_bf16 v[36:39],a[36:39],v[80:83],v[36:39]
v_mfma_f32_16x16x32_bf16 v[48:51],v[12:15],v[80:83],v[48:51]
v_mfma_f32_16x16x32_bf16 v[52:55],v[80:83],v[80:83],v[52:55]
s_waitcnt lgkmcnt(2)
s_barrier
ds_read_b128 v[96:99],v5 offset:0
v_mfma_f32_16x16x32_bf16 v[32:35],a[40:43],v[84:87],v[32:35]
ds_read_b128 v[100:103],v5 offset:1024
v_mfma_f32_16x16x32_bf16 v[36:39],a[44:47],v[84:87],v[36:39]
ds_read_b128 v[104:107],v5 offset:2048
v_mfma_f32_16x16x32_bf16 v[48:51],v[12:15],v[84:87],v[48:51]
ds_read_b128 v[108:111],v5 offset:3072
v_mfma_f32_16x16x32_bf16 v[52:55],v[84:87],v[84:87],v[52:55]
s_waitcnt lgkmcnt(5)
v_mfma_f32_16x16x32_bf16 v[32:35],a[48:51],v[88:91],v[32:35]
ds_read_b128 v[112:115],v5 offset:4096
v_mfma_f32_16x16x32_bf16 v[36:39],a[52:55],v[88:91],v[36:39]
v_mfma_f32_16x16x32_bf16 v[48:51],v[12:15],v[88:91],v[48:51]
v_mfma_f32_16x16x32_bf16 v[52:55],v[88:91],v[88:91],v[52:55]
s_waitcnt lgkmcnt(5)
v_mfma_f32_16x16x32_bf16 v[32:35],a[56:59],v[92:95],v[32:35]
ds_read_b128 v[116:119],v5 offset:5120
v_mfma_f32_16x16x32_bf16 v[36:39],a[60:63],v[92:95],v[36:39]
v_mfma_f32_16x16x32_bf16 v[48:51],v[12:15],v[92:95],v[48:51]
v_mfma_f32_16x16x32_bf16 v[52:55],v[92:95],v[92:95],v[52:55]
s_waitcnt lgkmcnt(5)
v_mfma_f32_16x16x32_bf16 v[32:35],a[64:67],v[96:99],v[32:35]
ds_read_b128 v[120:123],v5 offset:6144
v_mfma_f32_16x16x32_bf16 v[36:39],a[68:71],v[96:99],v[36:39]
s_waitcnt lgkmcnt(5)
v_mfma_f32_16x16x32_bf16 v[32:35],a[72:75],v[100:103],v[32:35]
ds_read_b128 v[124:127],v5 offset:7168
v_mfma_f32_16x16x32_bf16 v[36:39],a[76:79],v[100:103],v[36:39]
s_waitcnt lgkmcnt(5)
v_mfma_f32_16x16x32_bf16 v[32:35],a[80:83],v[104:107],v[32:35]
ds_read_b128 v[64:67],v6 offset:0
v_cndmask_b32 v49,v52,v53,s[74:75]
v_mfma_f32_16x16x32_bf16 v[36:39],a[84:87],v[104:107],v[36:39]
s_waitcnt lgkmcnt(5)
v_cndmask_b32 v49,v49,v54,s[76:77]
v_cndmask_b32 v49,v49,v55,s[78:79]
v_mfma_f32_16x16x32_bf16 v[32:35],a[88:91],v[108:111],v[32:35]
ds_read_b128 v[68:71],v6 offset:1024
v_mfma_f32_16x16x32_bf16 v[36:39],a[92:95],v[108:111],v[36:39]
s_waitcnt lgkmcnt(5)
ds_write_b64 v19,v[48:49]
v_mfma_f32_16x16x32_bf16 v[32:35],a[96:99],v[112:115],v[32:35]
ds_read_b128 v[72:75],v6 offset:2048
v_mfma_f32_16x16x32_bf16 v[36:39],a[100:103],v[112:115],v[36:39]
s_waitcnt lgkmcnt(6)
v_mfma_f32_16x16x32_bf16 v[32:35],a[104:107],v[116:119],v[32:35]
ds_read_b128 v[76:79],v6 offset:3072
v_mfma_f32_16x16x32_bf16 v[36:39],a[108:111],v[116:119],v[36:39]
s_waitcnt lgkmcnt(6)
v_mfma_f32_16x16x32_bf16 v[32:35],a[112:115],v[120:123],v[32:35]
s_waitcnt lgkmcnt(2)
s_barrier
ds_read_b128 v[80:83],v6 offset:4096
v_mfma_f32_16x16x32_bf16 v[36:39],a[116:119],v[120:123],v[36:39]
ds_read_b64 v[56:57],v20 offset:0
v_mfma_f32_16x16x32_bf16 v[32:35],a[120:123],v[124:127],v[32:35]
ds_read_b128 v[84:87],v6 offset:5120
v_mfma_f32_16x16x32_bf16 v[36:39],a[124:127],v[124:127],v[36:39]
ds_read_b64 v[58:59],v20 offset:512
v_mfma_f32_16x16x32_bf16 v[32:35],a[128:131],v[64:67],v[32:35]
ds_read_b128 v[88:91],v6 offset:6144
v_mfma_f32_16x16x32_bf16 v[36:39],a[132:135],v[64:67],v[36:39]
ds_read_b64 v[60:61],v20 offset:1024
v_mfma_f32_16x16x32_bf16 v[32:35],a[136:139],v[68:71],v[32:35]
ds_read_b128 v[92:95],v6 offset:7168
v_mfma_f32_16x16x32_bf16 v[36:39],a[140:143],v[68:71],v[36:39]
s_waitcnt lgkmcnt(8)
ds_read_b64 v[62:63],v20 offset:1536
v_mfma_f32_16x16x32_bf16 v[32:35],a[144:147],v[72:75],v[32:35]
ds_read_b128 v[96:99],v7 offset:0
v_mfma_f32_16x16x32_bf16 v[36:39],a[148:151],v[72:75],v[36:39]
s_waitcnt lgkmcnt(9)
buffer_load_dword v16,v2,s[20:23],s68 offen sc1
v_mfma_f32_16x16x32_bf16 v[32:35],a[152:155],v[76:79],v[32:35]
ds_read_b128 v[100:103],v7 offset:1024
v_mfma_f32_16x16x32_bf16 v[36:39],a[156:159],v[76:79],v[36:39]
s_waitcnt lgkmcnt(9)
s_waitcnt vmcnt(2)
v_mov_b32 v17,s57
buffer_store_dword v17,v26,s[20:23],s69 offen
v_mfma_f32_16x16x32_bf16 v[32:35],a[160:163],v[80:83],v[32:35]
ds_read_b128 v[104:107],v7 offset:2048
v_mfma_f32_16x16x32_bf16 v[36:39],a[164:167],v[80:83],v[36:39]
s_waitcnt lgkmcnt(8)
s_waitcnt lgkmcnt(3)
v_add_f32 v56,v56,v58
v_mfma_f32_16x16x32_bf16 v[32:35],a[168:171],v[84:87],v[32:35]
ds_read_b128 v[108:111],v7 offset:3072
v_add_f32 v57,v57,v59
v_mfma_f32_16x16x32_bf16 v[36:39],a[172:175],v[84:87],v[36:39]
v_add_f32 v60,v60,v62
v_add_f32 v61,v61,v63
v_mfma_f32_16x16x32_bf16 v[32:35],a[176:179],v[88:91],v[32:35]
ds_read_b128 v[112:115],v7 offset:4096
v_add_f32 v56,v56,v60
v_mfma_f32_16x16x32_bf16 v[36:39],a[180:183],v[88:91],v[36:39]
v_add_f32 v57,v57,v61
v_mul_f32 v188,0xba800000,v56
v_mfma_f32_16x16x32_bf16 v[32:35],a[184:187],v[92:95],v[32:35]
ds_read_b128 v[116:119],v7 offset:5120
v_fma_f32 v58,v188,v188,-v210
v_mfma_f32_16x16x32_bf16 v[36:39],a[188:191],v[92:95],v[36:39]
s_waitcnt lgkmcnt(5)
v_fma_f32 v57,v57,v211,-v58
v_max_f32 v57,v210,v57
v_mfma_f32_16x16x32_bf16 v[32:35],a[192:195],v[96:99],v[32:35]
ds_read_b128 v[120:123],v7 offset:6144
v_mfma_f32_16x16x32_bf16 v[36:39],a[196:199],v[96:99],v[36:39]
s_waitcnt lgkmcnt(5)
v_rsq_f32 v58,v57
v_mfma_f32_16x16x32_bf16 v[32:35],a[200:203],v[100:103],v[32:35]
ds_read_b128 v[124:127],v7 offset:7168
v_mul_f32 v189,v57,v58
v_mfma_f32_16x16x32_bf16 v[36:39],a[204:207],v[100:103],v[36:39]
s_waitcnt lgkmcnt(5)
v_mul_f32 v190,v209,v58
v_mul_f32 v59,v58,v58
v_mfma_f32_16x16x32_bf16 v[32:35],a[208:211],v[104:107],v[32:35]
s_add_u32 s55,s55,32768
v_mul_f32 v191,v208,v58
v_mul_f32 v191,v191,v59
v_mfma_f32_16x16x32_bf16 v[36:39],a[212:215],v[104:107],v[36:39]
s_waitcnt lgkmcnt(4)
s_and_b32 s55,s55,0x1ffff
v_add_u32 v4,s55,v8
v_mfma_f32_16x16x32_bf16 v[32:35],a[216:219],v[108:111],v[32:35]
v_add_u32 v5,s55,v9
v_add_u32 v6,s55,v10
v_mfma_f32_16x16x32_bf16 v[36:39],a[220:223],v[108:111],v[36:39]
s_waitcnt lgkmcnt(3)
v_add_u32 v7,s55,v11
v_mfma_f32_16x16x32_bf16 v[32:35],a[224:227],v[112:115],v[32:35]
v_mfma_f32_16x16x32_bf16 v[36:39],a[228:231],v[112:115],v[36:39]
s_waitcnt lgkmcnt(2)
v_mfma_f32_16x16x32_bf16 v[32:35],a[232:235],v[116:119],v[32:35]
v_mfma_f32_16x16x32_bf16 v[36:39],a[236:239],v[116:119],v[36:39]
s_waitcnt lgkmcnt(1)
v_mfma_f32_16x16x32_bf16 v[32:35],a[240:243],v[120:123],v[32:35]
v_mfma_f32_16x16x32_bf16 v[36:39],a[244:247],v[120:123],v[36:39]
s_waitcnt lgkmcnt(0)
v_mfma_f32_16x16x32_bf16 v[40:43],a[248:251],v[124:127],v[32:35]
v_mfma_f32_16x16x32_bf16 v[44:47],a[252:255],v[124:127],v[36:39]
s_waitcnt vmcnt(1)
v_cmp_gt_u32 vcc,s71,v16
s_add_u32 s60,s60,1
endN_327:
s_cbranch_vccnz nb_324
s_mov_b32 m0,s70
s_nop 0
buffer_load_dwordx4 v3,s[20:23],s61 offen offset:0 lds
buffer_load_dwordx4 v3,s[20:23],s61 offen offset:1024 lds
buffer_load_dwordx4 v3,s[20:23],s61 offen offset:2048 lds
buffer_load_dwordx4 v3,s[20:23],s61 offen offset:3072 lds
s_add_u32 m0,s70,4096
s_nop 0
buffer_load_dwordx4 v3,s[20:23],s62 offen offset:0 lds
buffer_load_dwordx4 v3,s[20:23],s62 offen offset:1024 lds
buffer_load_dwordx4 v3,s[20:23],s62 offen offset:2048 lds
buffer_load_dwordx4 v3,s[20:23],s62 offen offset:3072 lds
s_add_u32 s61,s61,32768
s_add_u32 s62,s62,32768
s_add_u32 s70,s70,32768
s_and_b32 s70,s70,0x1ffff
s_mov_b32 s57,s63
v_pk_fma_f32 v[40:41],v[152:153],v[188:189],v[40:41] op_sel_hi:[1,0,1]
v_pk_fma_f32 v[42:43],v[154:155],v[188:189],v[42:43] op_sel_hi:[1,0,1]
v_pk_fma_f32 v[44:45],v[156:157],v[188:189],v[44:45] op_sel_hi:[1,0,1]
v_pk_fma_f32 v[46:47],v[158:159],v[188:189],v[46:47] op_sel_hi:[1,0,1]
v_pk_mul_f32 v[168:169],v[40:41],v[40:41]
v_pk_mul_f32 v[170:171],v[42:43],v[42:43]
v_pk_mul_f32 v[172:173],v[44:45],v[44:45]
v_pk_mul_f32 v[174:175],v[46:47],v[46:47]
v_pk_fma_f32 v[168:169],v[168:169],v[190:191],v[190:191] op_sel:[0,1,0] op_sel_hi:[1,1,0]
v_pk_fma_f32 v[170:171],v[170:171],v[190:191],v[190:191] op_sel:[0,1,0] op_sel_hi:[1,1,0]
v_pk_fma_f32 v[172:173],v[172:173],v[190:191],v[190:191] op_sel:[0,1,0] op_sel_hi:[1,1,0]
v_pk_fma_f32 v[174:175],v[174:175],v[190:191],v[190:191] op_sel:[0,1,0] op_sel_hi:[1,1,0]
v_pk_mul_f32 v[168:169],v[168:169],v[40:41]
v_pk_mul_f32 v[170:171],v[170:171],v[42:43]
v_pk_mul_f32 v[172:173],v[172:173],v[44:45]
v_pk_mul_f32 v[174:175],v[174:175],v[46:47]
v_exp_f32 v168,v168
v_exp_f32 v169,v169
v_exp_f32 v170,v170
v_exp_f32 v171,v171
v_exp_f32 v172,v172
v_exp_f32 v173,v173
v_exp_f32 v174,v174
v_exp_f32 v175,v175
v_pk_fma_f32 v[168:169],v[168:169],v[188:189],v[188:189] op_sel:[0,1,1] op_sel_hi:[1,1,1]
v_pk_fma_f32 v[170:171],v[170:171],v[188:189],v[188:189] op_sel:[0,1,1] op_sel_hi:[1,1,1]
v_pk_fma_f32 v[172:173],v[172:173],v[188:189],v[188:189] op_sel:[0,1,1] op_sel_hi:[1,1,1]
v_pk_fma_f32 v[174:175],v[174:175],v[188:189],v[188:189] op_sel:[0,1,1] op_sel_hi:[1,1,1]
v_rcp_f32 v168,v168
v_rcp_f32 v169,v169
v_rcp_f32 v170,v170
v_rcp_f32 v171,v171
v_rcp_f32 v172,v172
v_rcp_f32 v173,v173
v_rcp_f32 v174,v174
v_rcp_f32 v175,v175
v_pk_mul_f32 v[40:41],v[168:169],v[40:41]
v_pk_mul_f32 v[42:43],v[170:171],v[42:43]
v_pk_mul_f32 v[44:45],v[172:173],v[44:45]
v_pk_mul_f32 v[46:47],v[174:175],v[46:47]
v_cvt_pk_bf16_f32 v176,v40,v41
v_cvt_pk_bf16_f32 v177,v42,v43
v_cvt_pk_bf16_f32 v178,v44,v45
v_cvt_pk_bf16_f32 v179,v46,v47
buffer_store_dwordx4 v[176:179],v0,s[20:23],s66 offen sc1
s_add_u32 s66,s66,32768
s_add_u32 s63,s63,1
s_waitcnt vmcnt(9)
v_mov_b32 v17,s57
buffer_store_dword v17,v26,s[20:23],s69 offen
s_branch dec_323
nb_324:
buffer_load_dword v16,v2,s[20:23],s68 offen sc1
s_nop 3
s_mov_b32 s57,s63
v_pk_fma_f32 v[40:41],v[152:153],v[188:189],v[40:41] op_sel_hi:[1,0,1]
v_pk_fma_f32 v[42:43],v[154:155],v[188:189],v[42:43] op_sel_hi:[1,0,1]
v_pk_fma_f32 v[44:45],v[156:157],v[188:189],v[44:45] op_sel_hi:[1,0,1]
v_pk_fma_f32 v[46:47],v[158:159],v[188:189],v[46:47] op_sel_hi:[1,0,1]
v_pk_mul_f32 v[168:169],v[40:41],v[40:41]
v_pk_mul_f32 v[170:171],v[42:43],v[42:43]
v_pk_mul_f32 v[172:173],v[44:45],v[44:45]
v_pk_mul_f32 v[174:175],v[46:47],v[46:47]
v_pk_fma_f32 v[168:169],v[168:169],v[190:191],v[190:191] op_sel:[0,1,0] op_sel_hi:[1,1,0]
v_pk_fma_f32 v[170:171],v[170:171],v[190:191],v[190:191] op_sel:[0,1,0] op_sel_hi:[1,1,0]
v_pk_fma_f32 v[172:173],v[172:173],v[190:191],v[190:191] op_sel:[0,1,0] op_sel_hi:[1,1,0]
v_pk_fma_f32 v[174:175],v[174:175],v[190:191],v[190:191] op_sel:[0,1,0] op_sel_hi:[1,1,0]
v_pk_mul_f32 v[168:169],v[168:169],v[40:41]
v_pk_mul_f32 v[170:171],v[170:171],v[42:43]
v_pk_mul_f32 v[172:173],v[172:173],v[44:45]
v_pk_mul_f32 v[174:175],v[174:175],v[46:47]
v_exp_f32 v168,v168
v_exp_f32 v169,v169
v_exp_f32 v170,v170
v_exp_f32 v171,v171
v_exp_f32 v172,v172
v_exp_f32 v173,v173
v_exp_f32 v174,v174
v_exp_f32 v175,v175
v_pk_fma_f32 v[168:169],v[168:169],v[188:189],v[188:189] op_sel:[0,1,1] op_sel_hi:[1,1,1]
v_pk_fma_f32 v[170:171],v[170:171],v[188:189],v[188:189] op_sel:[0,1,1] op_sel_hi:[1,1,1]
v_pk_fma_f32 v[172:173],v[172:173],v[188:189],v[188:189] op_sel:[0,1,1] op_sel_hi:[1,1,1]
v_pk_fma_f32 v[174:175],v[174:175],v[188:189],v[188:189] op_sel:[0,1,1] op_sel_hi:[1,1,1]
v_rcp_f32 v168,v168
v_rcp_f32 v169,v169
v_rcp_f32 v170,v170
v_rcp_f32 v171,v171
v_rcp_f32 v172,v172
v_rcp_f32 v173,v173
v_rcp_f32 v174,v174
v_rcp_f32 v175,v175
v_pk_mul_f32 v[40:41],v[168:169],v[40:41]
v_pk_mul_f32 v[42:43],v[170:171],v[42:43]
v_pk_mul_f32 v[44:45],v[172:173],v[44:45]
v_pk_mul_f32 v[46:47],v[174:175],v[46:47]
v_cvt_pk_bf16_f32 v176,v40,v41
v_cvt_pk_bf16_f32 v177,v42,v43
v_cvt_pk_bf16_f32 v178,v44,v45
v_cvt_pk_bf16_f32 v179,v46,v47
buffer_store_dwordx4 v[176:179],v0,s[20:23],s66 offen sc1
s_add_u32 s66,s66,32768
s_add_u32 s63,s63,1
s_waitcnt vmcnt(2)
v_mov_b32 v17,s57
buffer_store_dword v17,v26,s[20:23],s69 offen
s_waitcnt vmcnt(2)
v_cmp_gt_u32 vcc,s71,v16
s_cbranch_vccz lag_322
s_waitcnt vmcnt(1)
v_mov_b32 v17,s63
buffer_store_dword v17,v26,s[20:23],s69 offen
s_cmp_ge_u32 s60,128
s_cbranch_scc1 done_310
plp_330:
buffer_load_dword v16,v2,s[20:23],s68 offen sc1
s_waitcnt vmcnt(0)
v_cmp_gt_u32 vcc,s71,v16
s_cbranch_vccz pok_331
s_sleep 4
s_sub_u32 s90,s90,1
s_cmp_gt_i32 s90,0
s_cbranch_scc1 plp_330
pok_331:
s_branch lag_322
lfar_317:
s_add_u32 s71,s60,1
s_add_u32 s53,s60,2
plp_339:
buffer_load_dword v16,v2,s[20:23],s68 offen sc1
s_waitcnt vmcnt(0)
v_cmp_gt_u32 vcc,s71,v16
s_cbranch_vccz pok_340
s_sleep 4
s_sub_u32 s90,s90,1
s_cmp_gt_i32 s90,0
s_cbranch_scc1 plp_339
pok_340:
lag_336:
s_mov_b32 m0,s70
s_nop 0
buffer_load_dwordx4 v3,s[20:23],s61 offen offset:0 lds
buffer_load_dwordx4 v3,s[20:23],s61 offen offset:1024 lds
buffer_load_dwordx4 v3,s[20:23],s61 offen offset:2048 lds
buffer_load_dwordx4 v3,s[20:23],s61 offen offset:3072 lds
s_add_u32 m0,s70,4096
s_nop 0
buffer_load_dwordx4 v3,s[20:23],s62 offen offset:0 lds
buffer_load_dwordx4 v3,s[20:23],s62 offen offset:1024 lds
buffer_load_dwordx4 v3,s[20:23],s62 offen offset:2048 lds
buffer_load_dwordx4 v3,s[20:23],s62 offen offset:3072 lds
s_add_u32 s61,s61,32768
s_add_u32 s62,s62,32768
s_add_u32 s70,s70,32768
s_and_b32 s70,s70,0x1ffff
buffer_load_dword v23,off,s[20:23],s66
buffer_load_dword v23,off,s[20:23],s66
dec_337:
v_cmp_gt_u32 vcc,s53,v16
s_cbranch_vccnz BN_335
BR_334:
s_waitcnt vmcnt(9)
ds_read_b128 v[64:67],v4 offset:0
s_waitcnt vmcnt(8)
ds_read_b128 v[68:71],v4 offset:1024
s_waitcnt vmcnt(7)
ds_read_b128 v[72:75],v4 offset:2048
s_waitcnt vmcnt(6)
ds_read_b128 v[76:79],v4 offset:3072
s_waitcnt lgkmcnt(3)
v_mfma_f32_16x16x32_bf16 v[32:35],a[0:3],v[64:67],0
s_add_u32 s71,s60,2
s_add_u32 s53,s60,3
s_mov_b32 s57,s63
v_mfma_f32_16x16x32_bf16 v[36:39],a[4:7],v[64:67],0
v_mfma_f32_16x16x32_bf16 v[48:51],v[12:15],v[64:67],0
v_mfma_f32_16x16x32_bf16 v[52:55],v[64:67],v[64:67],0
s_waitcnt lgkmcnt(2)
s_waitcnt vmcnt(5)
s_mov_b32 m0,s70
ds_read_b128 v[80:83],v4 offset:4096
v_mfma_f32_16x16x32_bf16 v[32:35],a[8:11],v[68:71],v[32:35]
buffer_load_dwordx4 v3,s[20:23],s61 offen offset:0 lds
v_mfma_f32_16x16x32_bf16 v[36:39],a[12:15],v[68:71],v[36:39]
v_mfma_f32_16x16x32_bf16 v[48:51],v[12:15],v[68:71],v[48:51]
v_mfma_f32_16x16x32_bf16 v[52:55],v[68:71],v[68:71],v[52:55]
s_waitcnt lgkmcnt(2)
s_waitcnt vmcnt(5)
ds_read_b128 v[84:87],v4 offset:5120
v_mfma_f32_16x16x32_bf16 v[32:35],a[16:19],v[72:75],v[32:35]
buffer_load_dwordx4 v3,s[20:23],s61 offen offset:1024 lds
v_mfma_f32_16x16x32_bf16 v[36:39],a[20:23],v[72:75],v[36:39]
v_mfma_f32_16x16x32_bf16 v[48:51],v[12:15],v[72:75],v[48:51]
v_mfma_f32_16x16x32_bf16 v[52:55],v[72:75],v[72:75],v[52:55]
s_waitcnt lgkmcnt(2)
s_waitcnt vmcnt(5)
ds_read_b128 v[88:91],v4 offset:6144
v_mfma_f32_16x16x32_bf16 v[32:35],a[24:27],v[76:79],v[32:35]
buffer_load_dwordx4 v3,s[20:23],s61 offen offset:2048 lds
v_mfma_f32_16x16x32_bf16 v[36:39],a[28:31],v[76:79],v[36:39]
v_mfma_f32_16x16x32_bf16 v[48:51],v[12:15],v[76:79],v[48:51]
v_mfma_f32_16x16x32_bf16 v[52:55],v[76:79],v[76:79],v[52:55]
s_waitcnt lgkmcnt(2)
s_waitcnt vmcnt(5)
ds_read_b128 v[92:95],v4 offset:7168
v_mfma_f32_16x16x32_bf16 v[32:35],a[32:35],v[80:83],v[32:35]
buffer_load_dwordx4 v3,s[20:23],s61 offen offset:3072 lds
v_mfma_f32_16x16x32_bf16 v[36:39],a[36:39],v[80:83],v[36:39]
v_mfma_f32_16x16x32_bf16 v[48:51],v[12:15],v[80:83],v[48:51]
v_mfma_f32_16x16x32_bf16 v[52:55],v[80:83],v[80:83],v[52:55]
s_waitcnt lgkmcnt(2)
s_barrier
ds_read_b128 v[96:99],v5 offset:0
v_mfma_f32_16x16x32_bf16 v[32:35],a[40:43],v[84:87],v[32:35]
ds_read_b128 v[100:103],v5 offset:1024
v_mfma_f32_16x16x32_bf16 v[36:39],a[44:47],v[84:87],v[36:39]
ds_read_b128 v[104:107],v5 offset:2048
v_mfma_f32_16x16x32_bf16 v[48:51],v[12:15],v[84:87],v[48:51]
s_add_u32 m0,s70,4096
ds_read_b128 v[108:111],v5 offset:3072
v_mfma_f32_16x16x32_bf16 v[52:55],v[84:87],v[84:87],v[52:55]
s_waitcnt lgkmcnt(5)
buffer_load_dwordx4 v3,s[20:23],s62 offen offset:0 lds
v_mfma_f32_16x16x32_bf16 v[32:35],a[48:51],v[88:91],v[32:35]
ds_read_b128 v[112:115],v5 offset:4096
v_mfma_f32_16x16x32_bf16 v[36:39],a[52:55],v[88:91],v[36:39]
buffer_load_dwordx4 v3,s[20:23],s62 offen offset:1024 lds
v_mfma_f32_16x16x32_bf16 v[48:51],v[12:15],v[88:91],v[48:51]
v_mfma_f32_16x16x32_bf16 v[52:55],v[88:91],v[88:91],v[52:55]
s_waitcnt lgkmcnt(5)
v_mfma_f32_16x16x32_bf16 v[32:35],a[56:59],v[92:95],v[32:35]
ds_read_b128 v[116:119],v5 offset:5120
v_mfma_f32_16x16x32_bf16 v[36:39],a[60:63],v[92:95],v[36:39]
buffer_load_dwordx4 v3,s[20:23],s62 offen offset:2048 lds
v_mfma_f32_16x16x32_bf16 v[48:51],v[12:15],v[92:95],v[48:51]
buffer_load_dword v16,v2,s[20:23],s68 offen sc1
v_mfma_f32_16x16x32_bf16 v[52:55],v[92:95],v[92:95],v[52:55]
s_waitcnt lgkmcnt(5)
v_mfma_f32_16x16x32_bf16 v[32:35],a[64:67],v[96:99],v[32:35]
ds_read_b128 v[120:123],v5 offset:6144
v_mfma_f32_16x16x32_bf16 v[36:39],a[68:71],v[96:99],v[36:39]
s_waitcnt lgkmcnt(5)
buffer_load_dwordx4 v3,s[20:23],s62 offen offset:3072 lds
v_mfma_f32_16x16x32_bf16 v[32:35],a[72:75],v[100:103],v[32:35]
ds_read_b128 v[124:127],v5 offset:7168
v_mfma_f32_16x16x32_bf16 v[36:39],a[76:79],v[100:103],v[36:39]
s_waitcnt lgkmcnt(5)
v_mfma_f32_16x16x32_bf16 v[32:35],a[80:83],v[104:107],v[32:35]
ds_read_b128 v[64:67],v6 offset:0
v_cndmask_b32 v49,v52,v53,s[74:75]
v_mfma_f32_16x16x32_bf16 v[36:39],a[84:87],v[104:107],v[36:39]
s_waitcnt lgkmcnt(5)
v_cndmask_b32 v49,v49,v54,s[76:77]
v_cndmask_b32 v49,v49,v55,s[78:79]
v_mfma_f32_16x16x32_bf16 v[32:35],a[88:91],v[108:111],v[32:35]
ds_read_b128 v[68:71],v6 offset:1024
v_mfma_f32_16x16x32_bf16 v[36:39],a[92:95],v[108:111],v[36:39]
s_waitcnt lgkmcnt(5)
ds_write_b64 v19,v[48:49]
v_mfma_f32_16x16x32_bf16 v[32:35],a[96:99],v[112:115],v[32:35]
ds_read_b128 v[72:75],v6 offset:2048
v_mfma_f32_16x16x32_bf16 v[36:39],a[100:103],v[112:115],v[36:39]
s_waitcnt lgkmcnt(6)
v_mfma_f32_16x16x32_bf16 v[32:35],a[104:107],v[116:119],v[32:35]
ds_read_b128 v[76:79],v6 offset:3072
v_mfma_f32_16x16x32_bf16 v[36:39],a[108:111],v[116:119],v[36:39]
s_waitcnt lgkmcnt(6)
v_mfma_f32_16x16x32_bf16 v[32:35],a[112:115],v[120:123],v[32:35]
s_waitcnt lgkmcnt(2)
s_barrier
ds_read_b128 v[80:83],v6 offset:4096
v_mfma_f32_16x16x32_bf16 v[36:39],a[116:119],v[120:123],v[36:39]
ds_read_b64 v[56:57],v20 offset:0
v_mfma_f32_16x16x32_bf16 v[32:35],a[120:123],v[124:127],v[32:35]
ds_read_b128 v[84:87],v6 offset:5120
v_mfma_f32_16x16x32_bf16 v[36:39],a[124:127],v[124:127],v[36:39]
ds_read_b64 v[58:59],v20 offset:512
v_mfma_f32_16x16x32_bf16 v[32:35],a[128:131],v[64:67],v[32:35]
ds_read_b128 v[88:91],v6 offset:6144
v_mfma_f32_16x16x32_bf16 v[36:39],a[132:135],v[64:67],v[36:39]
ds_read_b64 v[60:61],v20 offset:1024
v_mfma_f32_16x16x32_bf16 v[32:35],a[136:139],v[68:71],v[32:35]
ds_read_b128 v[92:95],v6 offset:7168
v_mfma_f32_16x16x32_bf16 v[36:39],a[140:143],v[68:71],v[36:39]
s_waitcnt lgkmcnt(8)
ds_read_b64 v[62:63],v20 offset:1536
v_mfma_f32_16x16x32_bf16 v[32:35],a[144:147],v[72:75],v[32:35]
ds_read_b128 v[96:99],v7 offset:0
v_mfma_f32_16x16x32_bf16 v[36:39],a[148:151],v[72:75],v[36:39]
s_waitcnt lgkmcnt(9)
s_waitcnt vmcnt(10)
v_mov_b32 v17,s57
buffer_store_dword v17,v26,s[20:23],s69 offen sc1
v_mfma_f32_16x16x32_bf16 v[32:35],a[152:155],v[76:79],v[32:35]
ds_read_b128 v[100:103],v7 offset:1024
v_mfma_f32_16x16x32_bf16 v[36:39],a[156:159],v[76:79],v[36:39]
s_waitcnt lgkmcnt(9)
v_mfma_f32_16x16x32_bf16 v[32:35],a[160:163],v[80:83],v[32:35]
ds_read_b128 v[104:107],v7 offset:2048
v_mfma_f32_16x16x32_bf16 v[36:39],a[164:167],v[80:83],v[36:39]
s_waitcnt lgkmcnt(8)
s_waitcnt lgkmcnt(3)
v_add_f32 v56,v56,v58
v_mfma_f32_16x16x32_bf16 v[32:35],a[168:171],v[84:87],v[32:35]
ds_read_b128 v[108:111],v7 offset:3072
v_add_f32 v57,v57,v59
v_mfma_f32_16x16x32_bf16 v[36:39],a[172:175],v[84:87],v[36:39]
v_add_f32 v60,v60,v62
v_add_f32 v61,v61,v63
v_mfma_f32_16x16x32_bf16 v[32:35],a[176:179],v[88:91],v[32:35]
ds_read_b128 v[112:115],v7 offset:4096
v_add_f32 v56,v56,v60
v_mfma_f32_16x16x32_bf16 v[36:39],a[180:183],v[88:91],v[36:39]
v_add_f32 v57,v57,v61
v_mul_f32 v188,0xba800000,v56
v_mfma_f32_16x16x32_bf16 v[32:35],a[184:187],v[92:95],v[32:35]
ds_read_b128 v[116:119],v7 offset:5120
v_fma_f32 v58,v188,v188,-v210
v_mfma_f32_16x16x32_bf16 v[36:39],a[188:191],v[92:95],v[36:39]
s_waitcnt lgkmcnt(5)
v_fma_f32 v57,v57,v211,-v58
v_max_f32 v57,v210,v57
v_mfma_f32_16x16x32_bf16 v[32:35],a[192:195],v[96:99],v[32:35]
ds_read_b128 v[120:123],v7 offset:6144
v_mfma_f32_16x16x32_bf16 v[36:39],a[196:199],v[96:99],v[36:39]
s_waitcnt lgkmcnt(5)
v_rsq_f32 v58,v57
v_mfma_f32_16x16x32_bf16 v[32:35],a[200:203],v[100:103],v[32:35]
ds_read_b128 v[124:127],v7 offset:7168
v_mul_f32 v189,v57,v58
v_mfma_f32_16x16x32_bf16 v[36:39],a[204:207],v[100:103],v[36:39]
s_waitcnt lgkmcnt(5)
v_mul_f32 v190,v209,v58
v_mul_f32 v59,v58,v58
v_mfma_f32_16x16x32_bf16 v[32:35],a[208:211],v[104:107],v[32:35]
s_add_u32 s61,s61,32768
v_mul_f32 v191,v208,v58
v_mul_f32 v191,v191,v59
v_mfma_f32_16x16x32_bf16 v[36:39],a[212:215],v[104:107],v[36:39]
s_waitcnt lgkmcnt(4)
s_add_u32 s62,s62,32768
s_add_u32 s70,s70,32768
v_mfma_f32_16x16x32_bf16 v[32:35],a[216:219],v[108:111],v[32:35]
s_and_b32 s70,s70,0x1ffff
s_add_u32 s55,s55,32768
s_and_b32 s55,s55,0x1ffff
v_mfma_f32_16x16x32_bf16 v[36:39],a[220:223],v[108:111],v[36:39]
s_waitcnt lgkmcnt(3)
v_add_u32 v4,s55,v8
v_add_u32 v5,s55,v9
v_mfma_f32_16x16x32_bf16 v[32:35],a[224:227],v[112:115],v[32:35]
v_add_u32 v6,s55,v10
v_add_u32 v7,s55,v11
v_mfma_f32_16x16x32_bf16 v[36:39],a[228:231],v[112:115],v[36:39]
s_waitcnt lgkmcnt(2)
s_waitcnt vmcnt(9)
ds_read_b128 v[64:67],v4 offset:0
v_mfma_f32_16x16x32_bf16 v[32:35],a[232:235],v[116:119],v[32:35]
s_waitcnt vmcnt(8)
ds_read_b128 v[68:71],v4 offset:1024
v_mfma_f32_16x16x32_bf16 v[36:39],a[236:239],v[116:119],v[36:39]
s_waitcnt lgkmcnt(3)
s_waitcnt vmcnt(7)
ds_read_b128 v[72:75],v4 offset:2048
v_mfma_f32_16x16x32_bf16 v[32:35],a[240:243],v[120:123],v[32:35]
v_mfma_f32_16x16x32_bf16 v[36:39],a[244:247],v[120:123],v[36:39]
s_waitcnt lgkmcnt(3)
v_mfma_f32_16x16x32_bf16 v[40:43],a[248:251],v[124:127],v[32:35]
v_mfma_f32_16x16x32_bf16 v[44:47],a[252:255],v[124:127],v[36:39]
s_waitcnt vmcnt(2)
v_cmp_gt_u32 vcc,s53,v16
s_add_u32 s60,s60,1
s_cbranch_vccnz WN_333
.p2align 6
WR_332:
s_waitcnt lgkmcnt(2)
v_mfma_f32_16x16x32_bf16 v[32:35],a[0:3],v[64:67],0
s_waitcnt vmcnt(6)
s_add_u32 s71,s60,2
ds_read_b128 v[76:79],v4 offset:3072
v_mfma_f32_16x16x32_bf16 v[36:39],a[4:7],v[64:67],0
s_add_u32 s53,s60,3
s_mov_b32 s57,s63
v_mfma_f32_16x16x32_bf16 v[48:51],v[12:15],v[64:67],0
s_mov_b32 m0,s70
v_fma_f32 v40,v152,v188,v40
v_fma_f32 v41,v153,v188,v41
v_mul_f32 v168,v40,v40
v_mfma_f32_16x16x32_bf16 v[52:55],v[64:67],v[64:67],0
s_waitcnt lgkmcnt(2)
buffer_load_dwordx4 v3,s[20:23],s61 offen offset:0 lds
v_mul_f32 v169,v41,v41
v_fma_f32 v168,v168,v191,v190
v_mfma_f32_16x16x32_bf16 v[32:35],a[8:11],v[68:71],v[32:35]
s_waitcnt vmcnt(6)
ds_read_b128 v[80:83],v4 offset:4096
v_fma_f32 v169,v169,v191,v190
v_mul_f32 v168,v168,v40
v_mfma_f32_16x16x32_bf16 v[36:39],a[12:15],v[68:71],v[36:39]
v_exp_f32 v168,v168
v_mul_f32 v169,v169,v41
v_mfma_f32_16x16x32_bf16 v[48:51],v[12:15],v[68:71],v[48:51]
v_exp_f32 v169,v169
v_fma_f32 v168,v168,v189,v189
v_mfma_f32_16x16x32_bf16 v[52:55],v[68:71],v[68:71],v[52:55]
s_waitcnt lgkmcnt(2)
buffer_load_dwordx4 v3,s[20:23],s61 offen offset:1024 lds
v_rcp_f32 v168,v168
v_mfma_f32_16x16x32_bf16 v[32:35],a[16:19],v[72:75],v[32:35]
s_waitcnt vmcnt(6)
ds_read_b128 v[84:87],v4 offset:5120
v_fma_f32 v169,v169,v189,v189
v_mul_f32 v40,v168,v40
v_mfma_f32_16x16x32_bf16 v[36:39],a[20:23],v[72:75],v[36:39]
v_rcp_f32 v169,v169
v_fma_f32 v42,v154,v188,v42
v_mfma_f32_16x16x32_bf16 v[48:51],v[12:15],v[72:75],v[48:51]
v_mul_f32 v41,v169,v41
v_fma_f32 v43,v155,v188,v43
v_mul_f32 v170,v42,v42
v_mfma_f32_16x16x32_bf16 v[52:55],v[72:75],v[72:75],v[52:55]
s_waitcnt lgkmcnt(2)
buffer_load_dwordx4 v3,s[20:23],s61 offen offset:2048 lds
v_mul_f32 v171,v43,v43
v_fma_f32 v170,v170,v191,v190
v_mfma_f32_16x16x32_bf16 v[32:35],a[24:27],v[76:79],v[32:35]
s_waitcnt vmcnt(6)
ds_read_b128 v[88:91],v4 offset:6144
v_fma_f32 v171,v171,v191,v190
v_mfma_f32_16x16x32_bf16 v[36:39],a[28:31],v[76:79],v[36:39]
v_mul_f32 v170,v170,v42
v_mul_f32 v171,v171,v43
v_mfma_f32_16x16x32_bf16 v[48:51],v[12:15],v[76:79],v[48:51]
v_exp_f32 v170,v170
v_mfma_f32_16x16x32_bf16 v[52:55],v[76:79],v[76:79],v[52:55]
s_waitcnt lgkmcnt(2)
buffer_load_dwordx4 v3,s[20:23],s61 offen offset:3072 lds
v_fma_f32 v170,v170,v189,v189
v_mfma_f32_16x16x32_bf16 v[32:35],a[32:35],v[80:83],v[32:35]
s_waitcnt vmcnt(5)
ds_read_b128 v[92:95],v4 offset:7168
v_fma_f32 v44,v156,v188,v44
v_mfma_f32_16x16x32_bf16 v[36:39],a[36:39],v[80:83],v[36:39]
s_barrier
ds_read_b128 v[96:99],v5 offset:0
v_fma_f32 v45,v157,v188,v45
v_mfma_f32_16x16x32_bf16 v[48:51],v[12:15],v[80:83],v[48:51]
ds_read_b128 v[100:103],v5 offset:1024
v_mul_f32 v172,v44,v44
v_mfma_f32_16x16x32_bf16 v[52:55],v[80:83],v[80:83],v[52:55]
s_waitcnt lgkmcnt(4)
ds_read_b128 v[104:107],v5 offset:2048
v_mul_f32 v173,v45,v45
v_mfma_f32_16x16x32_bf16 v[32:35],a[40:43],v[84:87],v[32:35]
s_add_u32 m0,s70,4096
ds_read_b128 v[108:111],v5 offset:3072
v_fma_f32 v172,v172,v191,v190
v_mfma_f32_16x16x32_bf16 v[36:39],a[44:47],v[84:87],v[36:39]
buffer_load_dwordx4 v3,s[20:23],s62 offen offset:0 lds
v_fma_f32 v173,v173,v191,v190
v_mfma_f32_16x16x32_bf16 v[48:51],v[12:15],v[84:87],v[48:51]
s_waitcnt vmcnt(5)
v_mov_b32 v17,s57
buffer_store_dword v17,v26,s[20:23],s69 offen sc1
v_mfma_f32_16x16x32_bf16 v[52:55],v[84:87],v[84:87],v[52:55]
s_waitcnt lgkmcnt(5)
v_exp_f32 v171,v171
v_mfma_f32_16x16x32_bf16 v[32:35],a[48:51],v[88:91],v[32:35]
ds_read_b128 v[112:115],v5 offset:4096
v_fma_f32 v171,v171,v189,v189
v_mfma_f32_16x16x32_bf16 v[36:39],a[52:55],v[88:91],v[36:39]
buffer_load_dwordx4 v3,s[20:23],s62 offen offset:1024 lds
v_mul_f32 v172,v172,v44
v_mfma_f32_16x16x32_bf16 v[48:51],v[12:15],v[88:91],v[48:51]
v_rcp_f32 v170,v170
v_mfma_f32_16x16x32_bf16 v[52:55],v[88:91],v[88:91],v[52:55]
s_waitcnt lgkmcnt(5)
v_rcp_f32 v171,v171
v_mfma_f32_16x16x32_bf16 v[32:35],a[56:59],v[92:95],v[32:35]
ds_read_b128 v[116:119],v5 offset:5120
v_mul_f32 v42,v170,v42
v_mfma_f32_16x16x32_bf16 v[36:39],a[60:63],v[92:95],v[36:39]
buffer_load_dwordx4 v3,s[20:23],s62 offen offset:2048 lds
v_mul_f32 v43,v171,v43
v_mfma_f32_16x16x32_bf16 v[48:51],v[12:15],v[92:95],v[48:51]
buffer_load_dword v16,v2,s[20:23],s68 offen sc1
v_mul_f32 v173,v173,v45
v_mfma_f32_16x16x32_bf16 v[52:55],v[92:95],v[92:95],v[52:55]
s_waitcnt lgkmcnt(5)
v_exp_f32 v172,v172
v_mfma_f32_16x16x32_bf16 v[32:35],a[64:67],v[96:99],v[32:35]
ds_read_b128 v[120:123],v5 offset:6144
v_fma_f32 v172,v172,v189,v189
v_mfma_f32_16x16x32_bf16 v[36:39],a[68:71],v[96:99],v[36:39]
s_waitcnt lgkmcnt(5)
buffer_load_dwordx4 v3,s[20:23],s62 offen offset:3072 lds
v_fma_f32 v46,v158,v188,v46
v_mfma_f32_16x16x32_bf16 v[32:35],a[72:75],v[100:103],v[32:35]
ds_read_b128 v[124:127],v5 offset:7168
v_fma_f32 v47,v159,v188,v47
v_mfma_f32_16x16x32_bf16 v[36:39],a[76:79],v[100:103],v[36:39]
s_waitcnt lgkmcnt(5)
v_exp_f32 v173,v173
v_mfma_f32_16x16x32_bf16 v[32:35],a[80:83],v[104:107],v[32:35]
ds_read_b128 v[64:67],v6 offset:0
v_cndmask_b32 v49,v52,v53,s[74:75]
v_mfma_f32_16x16x32_bf16 v[36:39],a[84:87],v[104:107],v[36:39]
s_waitcnt lgkmcnt(5)
v_cndmask_b32 v49,v49,v54,s[76:77]
v_cndmask_b32 v49,v49,v55,s[78:79]
v_mfma_f32_16x16x32_bf16 v[32:35],a[88:91],v[108:111],v[32:35]
ds_read_b128 v[68:71],v6 offset:1024
v_fma_f32 v173,v173,v189,v189
v_mfma_f32_16x16x32_bf16 v[36:39],a[92:95],v[108:111],v[36:39]
s_waitcnt lgkmcnt(5)
ds_write_b64 v19,v[48:49]
v_mfma_f32_16x16x32_bf16 v[32:35],a[96:99],v[112:115],v[32:35]
ds_read_b128 v[72:75],v6 offset:2048
v_mul_f32 v174,v46,v46
v_mfma_f32_16x16x32_bf16 v[36:39],a[100:103],v[112:115],v[36:39]
s_waitcnt lgkmcnt(6)
v_rcp_f32 v172,v172
v_mfma_f32_16x16x32_bf16 v[32:35],a[104:107],v[116:119],v[32:35]
ds_read_b128 v[76:79],v6 offset:3072
v_mul_f32 v44,v172,v44
v_mfma_f32_16x16x32_bf16 v[36:39],a[108:111],v[116:119],v[36:39]
s_waitcnt lgkmcnt(6)
v_rcp_f32 v173,v173
v_mfma_f32_16x16x32_bf16 v[32:35],a[112:115],v[120:123],v[32:35]
s_waitcnt lgkmcnt(2)
s_barrier
ds_read_b128 v[80:83],v6 offset:4096
v_mfma_f32_16x16x32_bf16 v[36:39],a[116:119],v[120:123],v[36:39]
ds_read_b64 v[56:57],v20 offset:0
v_mul_f32 v45,v173,v45
v_mfma_f32_16x16x32_bf16 v[32:35],a[120:123],v[124:127],v[32:35]
ds_read_b128 v[84:87],v6 offset:5120
v_mul_f32 v175,v47,v47
v_mfma_f32_16x16x32_bf16 v[36:39],a[124:127],v[124:127],v[36:39]
ds_read_b64 v[58:59],v20 offset:512
v_fma_f32 v174,v174,v191,v190
v_mfma_f32_16x16x32_bf16 v[32:35],a[128:131],v[64:67],v[32:35]
ds_read_b128 v[88:91],v6 offset:6144
v_fma_f32 v175,v175,v191,v190
v_mfma_f32_16x16x32_bf16 v[36:39],a[132:135],v[64:67],v[36:39]
ds_read_b64 v[60:61],v20 offset:1024
v_mul_f32 v174,v174,v46
v_mfma_f32_16x16x32_bf16 v[32:35],a[136:139],v[68:71],v[32:35]
ds_read_b128 v[92:95],v6 offset:7168
v_mul_f32 v175,v175,v47
v_mfma_f32_16x16x32_bf16 v[36:39],a[140:143],v[68:71],v[36:39]
s_waitcnt lgkmcnt(8)
ds_read_b64 v[62:63],v20 offset:1536
v_cvt_pk_bf16_f32 v176,v40,v41
v_mfma_f32_16x16x32_bf16 v[32:35],a[144:147],v[72:75],v[32:35]
ds_read_b128 v[96:99],v7 offset:0
v_cvt_pk_bf16_f32 v177,v42,v43
v_mfma_f32_16x16x32_bf16 v[36:39],a[148:151],v[72:75],v[36:39]
s_waitcnt lgkmcnt(9)
v_exp_f32 v174,v174
v_mfma_f32_16x16x32_bf16 v[32:35],a[152:155],v[76:79],v[32:35]
ds_read_b128 v[100:103],v7 offset:1024
v_fma_f32 v174,v174,v189,v189
v_mfma_f32_16x16x32_bf16 v[36:39],a[156:159],v[76:79],v[36:39]
s_waitcnt lgkmcnt(9)
v_exp_f32 v175,v175
v_mfma_f32_16x16x32_bf16 v[32:35],a[160:163],v[80:83],v[32:35]
ds_read_b128 v[104:107],v7 offset:2048
v_fma_f32 v175,v175,v189,v189
v_mfma_f32_16x16x32_bf16 v[36:39],a[164:167],v[80:83],v[36:39]
s_waitcnt lgkmcnt(8)
s_waitcnt lgkmcnt(3)
v_rcp_f32 v174,v174
v_mfma_f32_16x16x32_bf16 v[32:35],a[168:171],v[84:87],v[32:35]
ds_read_b128 v[108:111],v7 offset:3072
v_mul_f32 v46,v174,v46
v_mfma_f32_16x16x32_bf16 v[36:39],a[172:175],v[84:87],v[36:39]
v_rcp_f32 v175,v175
v_mfma_f32_16x16x32_bf16 v[32:35],a[176:179],v[88:91],v[32:35]
ds_read_b128 v[112:115],v7 offset:4096
v_mul_f32 v47,v175,v47
v_mfma_f32_16x16x32_bf16 v[36:39],a[180:183],v[88:91],v[36:39]
v_cvt_pk_bf16_f32 v178,v44,v45
v_cvt_pk_bf16_f32 v179,v46,v47
v_mfma_f32_16x16x32_bf16 v[32:35],a[184:187],v[92:95],v[32:35]
ds_read_b128 v[116:119],v7 offset:5120
v_add_f32 v56,v56,v58
v_mfma_f32_16x16x32_bf16 v[36:39],a[188:191],v[92:95],v[36:39]
s_waitcnt lgkmcnt(5)
buffer_store_dwordx4 v[176:179],v0,s[20:23],s66 offen sc1
v_mfma_f32_16x16x32_bf16 v[32:35],a[192:195],v[96:99],v[32:35]
s_add_u32 s66,s66,32768
s_add_u32 s63,s63,1
ds_read_b128 v[120:123],v7 offset:6144
v_mfma_f32_16x16x32_bf16 v[36:39],a[196:199],v[96:99],v[36:39]
s_waitcnt lgkmcnt(5)
v_add_f32 v57,v57,v59
v_add_f32 v60,v60,v62
v_mfma_f32_16x16x32_bf16 v[32:35],a[200:203],v[100:103],v[32:35]
ds_read_b128 v[124:127],v7 offset:7168
v_add_f32 v61,v61,v63
v_mfma_f32_16x16x32_bf16 v[36:39],a[204:207],v[100:103],v[36:39]
s_waitcnt lgkmcnt(5)
v_add_f32 v56,v56,v60
v_add_f32 v57,v57,v61
v_mfma_f32_16x16x32_bf16 v[32:35],a[208:211],v[104:107],v[32:35]
s_add_u32 s61,s61,32768
v_mul_f32 v188,0xba800000,v56
v_fma_f32 v58,v188,v188,-v210
v_mfma_f32_16x16x32_bf16 v[36:39],a[212:215],v[104:107],v[36:39]
s_waitcnt lgkmcnt(4)
v_fma_f32 v57,v57,v211,-v58
v_max_f32 v57,v210,v57
v_mfma_f32_16x16x32_bf16 v[32:35],a[216:219],v[108:111],v[32:35]
s_add_u32 s62,s62,32768
v_rsq_f32 v58,v57
v_mfma_f32_16x16x32_bf16 v[36:39],a[220:223],v[108:111],v[36:39]
s_waitcnt lgkmcnt(3)
v_mul_f32 v189,v57,v58
v_mul_f32 v190,v209,v58
v_mfma_f32_16x16x32_bf16 v[32:35],a[224:227],v[112:115],v[32:35]
s_add_u32 s70,s70,32768
v_mul_f32 v59,v58,v58
v_mul_f32 v191,v208,v58
v_mfma_f32_16x16x32_bf16 v[36:39],a[228:231],v[112:115],v[36:39]
s_waitcnt lgkmcnt(2)
s_and_b32 s70,s70,0x1ffff
v_mul_f32 v191,v191,v59
v_mfma_f32_16x16x32_bf16 v[32:35],a[232:235],v[116:119],v[32:35]
s_add_u32 s55,s55,32768
s_and_b32 s55,s55,0x1ffff
v_add_u32 v4,s55,v8
v_mfma_f32_16x16x32_bf16 v[36:39],a[236:239],v[116:119],v[36:39]
s_waitcnt lgkmcnt(1)
v_add_u32 v5,s55,v9
v_add_u32 v6,s55,v10
v_mfma_f32_16x16x32_bf16 v[32:35],a[240:243],v[120:123],v[32:35]
v_add_u32 v7,s55,v11
v_mfma_f32_16x16x32_bf16 v[36:39],a[244:247],v[120:123],v[36:39]
s_waitcnt lgkmcnt(0)
s_waitcnt vmcnt(10)
ds_read_b128 v[64:67],v4 offset:0
v_mfma_f32_16x16x32_bf16 v[40:43],a[248:251],v[124:127],v[32:35]
s_waitcnt vmcnt(9)
ds_read_b128 v[68:71],v4 offset:1024
v_mfma_f32_16x16x32_bf16 v[44:47],a[252:255],v[124:127],v[36:39]
s_waitcnt vmcnt(2)
v_cmp_gt_u32 vcc,s53,v16
ds_read_b128 v[72:75],v4 offset:2048
s_add_u32 s60,s60,1
s_cbranch_vccz WR_332
WN_333:
s_waitcnt lgkmcnt(2)
v_mfma_f32_16x16x32_bf16 v[32:35],a[0:3],v[64:67],0
s_waitcnt vmcnt(6)
s_add_u32 s71,s60,2
ds_read_b128 v[76:79],v4 offset:3072
v_mfma_f32_16x16x32_bf16 v[36:39],a[4:7],v[64:67],0
s_add_u32 s53,s60,3
s_mov_b32 s57,s63
v_mfma_f32_16x16x32_bf16 v[48:51],v[12:15],v[64:67],0
v_fma_f32 v40,v152,v188,v40
v_fma_f32 v41,v153,v188,v41
v_mul_f32 v168,v40,v40
v_mfma_f32_16x16x32_bf16 v[52:55],v[64:67],v[64:67],0
s_waitcnt lgkmcnt(2)
v_mul_f32 v169,v41,v41
v_fma_f32 v168,v168,v191,v190
v_fma_f32 v169,v169,v191,v190
v_mfma_f32_16x16x32_bf16 v[32:35],a[8:11],v[68:71],v[32:35]
s_waitcnt vmcnt(5)
ds_read_b128 v[80:83],v4 offset:4096
v_mul_f32 v168,v168,v40
v_mul_f32 v169,v169,v41
v_mfma_f32_16x16x32_bf16 v[36:39],a[12:15],v[68:71],v[36:39]
v_exp_f32 v168,v168
v_fma_f32 v42,v154,v188,v42
v_mfma_f32_16x16x32_bf16 v[48:51],v[12:15],v[68:71],v[48:51]
v_exp_f32 v169,v169
v_fma_f32 v168,v168,v189,v189
v_mfma_f32_16x16x32_bf16 v[52:55],v[68:71],v[68:71],v[52:55]
s_waitcnt lgkmcnt(2)
v_rcp_f32 v168,v168
v_fma_f32 v169,v169,v189,v189
v_mfma_f32_16x16x32_bf16 v[32:35],a[16:19],v[72:75],v[32:35]
s_waitcnt vmcnt(4)
ds_read_b128 v[84:87],v4 offset:5120
v_rcp_f32 v169,v169
v_mfma_f32_16x16x32_bf16 v[36:39],a[20:23],v[72:75],v[36:39]
v_mul_f32 v40,v168,v40
v_mul_f32 v41,v169,v41
v_fma_f32 v43,v155,v188,v43
v_mfma_f32_16x16x32_bf16 v[48:51],v[12:15],v[72:75],v[48:51]
v_mul_f32 v170,v42,v42
v_mul_f32 v171,v43,v43
v_mfma_f32_16x16x32_bf16 v[52:55],v[72:75],v[72:75],v[52:55]
s_waitcnt lgkmcnt(2)
v_fma_f32 v170,v170,v191,v190
v_fma_f32 v171,v171,v191,v190
v_mfma_f32_16x16x32_bf16 v[32:35],a[24:27],v[76:79],v[32:35]
s_waitcnt vmcnt(3)
ds_read_b128 v[88:91],v4 offset:6144
v_mul_f32 v170,v170,v42
v_mfma_f32_16x16x32_bf16 v[36:39],a[28:31],v[76:79],v[36:39]
v_exp_f32 v170,v170
v_mfma_f32_16x16x32_bf16 v[48:51],v[12:15],v[76:79],v[48:51]
v_mul_f32 v171,v171,v43
v_fma_f32 v170,v170,v189,v189
v_mfma_f32_16x16x32_bf16 v[52:55],v[76:79],v[76:79],v[52:55]
s_waitcnt lgkmcnt(2)
v_exp_f32 v171,v171
v_mfma_f32_16x16x32_bf16 v[32:35],a[32:35],v[80:83],v[32:35]
s_waitcnt vmcnt(1)
ds_read_b128 v[92:95],v4 offset:7168
v_fma_f32 v171,v171,v189,v189
v_mfma_f32_16x16x32_bf16 v[36:39],a[36:39],v[80:83],v[36:39]
s_barrier
ds_read_b128 v[96:99],v5 offset:0
v_fma_f32 v44,v156,v188,v44
v_mfma_f32_16x16x32_bf16 v[48:51],v[12:15],v[80:83],v[48:51]
ds_read_b128 v[100:103],v5 offset:1024
v_fma_f32 v45,v157,v188,v45
v_mfma_f32_16x16x32_bf16 v[52:55],v[80:83],v[80:83],v[52:55]
s_waitcnt lgkmcnt(4)
ds_read_b128 v[104:107],v5 offset:2048
v_mul_f32 v172,v44,v44
v_mfma_f32_16x16x32_bf16 v[32:35],a[40:43],v[84:87],v[32:35]
ds_read_b128 v[108:111],v5 offset:3072
v_mul_f32 v173,v45,v45
v_mfma_f32_16x16x32_bf16 v[36:39],a[44:47],v[84:87],v[36:39]
s_waitcnt vmcnt(0)
v_mov_b32 v17,s57
buffer_store_dword v17,v26,s[20:23],s69 offen sc1
v_mfma_f32_16x16x32_bf16 v[48:51],v[12:15],v[84:87],v[48:51]
v_rcp_f32 v170,v170
v_mfma_f32_16x16x32_bf16 v[52:55],v[84:87],v[84:87],v[52:55]
s_waitcnt lgkmcnt(5)
v_rcp_f32 v171,v171
v_mfma_f32_16x16x32_bf16 v[32:35],a[48:51],v[88:91],v[32:35]
ds_read_b128 v[112:115],v5 offset:4096
v_mul_f32 v42,v170,v42
v_mfma_f32_16x16x32_bf16 v[36:39],a[52:55],v[88:91],v[36:39]
v_mul_f32 v43,v171,v43
v_fma_f32 v172,v172,v191,v190
v_mfma_f32_16x16x32_bf16 v[48:51],v[12:15],v[88:91],v[48:51]
v_fma_f32 v173,v173,v191,v190
v_mul_f32 v172,v172,v44
v_mfma_f32_16x16x32_bf16 v[52:55],v[88:91],v[88:91],v[52:55]
s_waitcnt lgkmcnt(5)
v_exp_f32 v172,v172
v_mfma_f32_16x16x32_bf16 v[32:35],a[56:59],v[92:95],v[32:35]
ds_read_b128 v[116:119],v5 offset:5120
v_mul_f32 v173,v173,v45
v_mfma_f32_16x16x32_bf16 v[36:39],a[60:63],v[92:95],v[36:39]
v_exp_f32 v173,v173
v_mfma_f32_16x16x32_bf16 v[48:51],v[12:15],v[92:95],v[48:51]
v_fma_f32 v172,v172,v189,v189
v_fma_f32 v173,v173,v189,v189
v_mfma_f32_16x16x32_bf16 v[52:55],v[92:95],v[92:95],v[52:55]
s_waitcnt lgkmcnt(5)
v_rcp_f32 v172,v172
v_mfma_f32_16x16x32_bf16 v[32:35],a[64:67],v[96:99],v[32:35]
ds_read_b128 v[120:123],v5 offset:6144
v_mul_f32 v44,v172,v44
v_mfma_f32_16x16x32_bf16 v[36:39],a[68:71],v[96:99],v[36:39]
s_waitcnt lgkmcnt(5)
v_rcp_f32 v173,v173
v_mfma_f32_16x16x32_bf16 v[32:35],a[72:75],v[100:103],v[32:35]
ds_read_b128 v[124:127],v5 offset:7168
v_mul_f32 v45,v173,v45
v_mfma_f32_16x16x32_bf16 v[36:39],a[76:79],v[100:103],v[36:39]
s_waitcnt lgkmcnt(5)
v_fma_f32 v46,v158,v188,v46
v_fma_f32 v47,v159,v188,v47
v_mfma_f32_16x16x32_bf16 v[32:35],a[80:83],v[104:107],v[32:35]
ds_read_b128 v[64:67],v6 offset:0
v_cndmask_b32 v49,v52,v53,s[74:75]
v_mfma_f32_16x16x32_bf16 v[36:39],a[84:87],v[104:107],v[36:39]
s_waitcnt lgkmcnt(5)
v_cndmask_b32 v49,v49,v54,s[76:77]
v_cndmask_b32 v49,v49,v55,s[78:79]
v_mfma_f32_16x16x32_bf16 v[32:35],a[88:91],v[108:111],v[32:35]
ds_read_b128 v[68:71],v6 offset:1024
v_mul_f32 v174,v46,v46
v_mfma_f32_16x16x32_bf16 v[36:39],a[92:95],v[108:111],v[36:39]
s_waitcnt lgkmcnt(5)
ds_write_b64 v19,v[48:49]
v_mfma_f32_16x16x32_bf16 v[32:35],a[96:99],v[112:115],v[32:35]
ds_read_b128 v[72:75],v6 offset:2048
v_mul_f32 v175,v47,v47
v_mfma_f32_16x16x32_bf16 v[36:39],a[100:103],v[112:115],v[36:39]
s_waitcnt lgkmcnt(6)
v_fma_f32 v174,v174,v191,v190
v_fma_f32 v175,v175,v191,v190
v_mfma_f32_16x16x32_bf16 v[32:35],a[104:107],v[116:119],v[32:35]
ds_read_b128 v[76:79],v6 offset:3072
v_mul_f32 v174,v174,v46
v_mfma_f32_16x16x32_bf16 v[36:39],a[108:111],v[116:119],v[36:39]
s_waitcnt lgkmcnt(6)
v_exp_f32 v174,v174
v_mfma_f32_16x16x32_bf16 v[32:35],a[112:115],v[120:123],v[32:35]
s_waitcnt lgkmcnt(2)
s_barrier
ds_read_b128 v[80:83],v6 offset:4096
v_mfma_f32_16x16x32_bf16 v[36:39],a[116:119],v[120:123],v[36:39]
ds_read_b64 v[56:57],v20 offset:0
v_mul_f32 v175,v175,v47
v_mfma_f32_16x16x32_bf16 v[32:35],a[120:123],v[124:127],v[32:35]
ds_read_b128 v[84:87],v6 offset:5120
v_fma_f32 v174,v174,v189,v189
v_mfma_f32_16x16x32_bf16 v[36:39],a[124:127],v[124:127],v[36:39]
ds_read_b64 v[58:59],v20 offset:512
v_cvt_pk_bf16_f32 v176,v40,v41
v_mfma_f32_16x16x32_bf16 v[32:35],a[128:131],v[64:67],v[32:35]
ds_read_b128 v[88:91],v6 offset:6144
v_cvt_pk_bf16_f32 v177,v42,v43
v_mfma_f32_16x16x32_bf16 v[36:39],a[132:135],v[64:67],v[36:39]
ds_read_b64 v[60:61],v20 offset:1024
v_cvt_pk_bf16_f32 v178,v44,v45
v_mfma_f32_16x16x32_bf16 v[32:35],a[136:139],v[68:71],v[32:35]
ds_read_b128 v[92:95],v6 offset:7168
v_mfma_f32_16x16x32_bf16 v[36:39],a[140:143],v[68:71],v[36:39]
s_waitcnt lgkmcnt(8)
ds_read_b64 v[62:63],v20 offset:1536
v_mfma_f32_16x16x32_bf16 v[32:35],a[144:147],v[72:75],v[32:35]
ds_read_b128 v[96:99],v7 offset:0
v_mfma_f32_16x16x32_bf16 v[36:39],a[148:151],v[72:75],v[36:39]
s_waitcnt lgkmcnt(9)
buffer_load_dword v16,v2,s[20:23],s68 offen sc1
v_mfma_f32_16x16x32_bf16 v[32:35],a[152:155],v[76:79],v[32:35]
ds_read_b128 v[100:103],v7 offset:1024
v_mfma_f32_16x16x32_bf16 v[36:39],a[156:159],v[76:79],v[36:39]
s_waitcnt lgkmcnt(9)
v_exp_f32 v175,v175
v_mfma_f32_16x16x32_bf16 v[32:35],a[160:163],v[80:83],v[32:35]
ds_read_b128 v[104:107],v7 offset:2048
v_fma_f32 v175,v175,v189,v189
v_mfma_f32_16x16x32_bf16 v[36:39],a[164:167],v[80:83],v[36:39]
s_waitcnt lgkmcnt(8)
s_waitcnt lgkmcnt(3)
v_rcp_f32 v174,v174
v_mfma_f32_16x16x32_bf16 v[32:35],a[168:171],v[84:87],v[32:35]
ds_read_b128 v[108:111],v7 offset:3072
v_mul_f32 v46,v174,v46
v_mfma_f32_16x16x32_bf16 v[36:39],a[172:175],v[84:87],v[36:39]
v_rcp_f32 v175,v175
v_mfma_f32_16x16x32_bf16 v[32:35],a[176:179],v[88:91],v[32:35]
ds_read_b128 v[112:115],v7 offset:4096
v_mul_f32 v47,v175,v47
v_mfma_f32_16x16x32_bf16 v[36:39],a[180:183],v[88:91],v[36:39]
v_cvt_pk_bf16_f32 v179,v46,v47
v_add_f32 v56,v56,v58
v_mfma_f32_16x16x32_bf16 v[32:35],a[184:187],v[92:95],v[32:35]
ds_read_b128 v[116:119],v7 offset:5120
v_add_f32 v57,v57,v59
v_mfma_f32_16x16x32_bf16 v[36:39],a[188:191],v[92:95],v[36:39]
s_waitcnt lgkmcnt(5)
buffer_store_dwordx4 v[176:179],v0,s[20:23],s66 offen sc1
v_mfma_f32_16x16x32_bf16 v[32:35],a[192:195],v[96:99],v[32:35]
s_add_u32 s66,s66,32768
s_add_u32 s63,s63,1
ds_read_b128 v[120:123],v7 offset:6144
v_mfma_f32_16x16x32_bf16 v[36:39],a[196:199],v[96:99],v[36:39]
s_waitcnt lgkmcnt(5)
v_add_f32 v60,v60,v62
v_add_f32 v61,v61,v63
v_mfma_f32_16x16x32_bf16 v[32:35],a[200:203],v[100:103],v[32:35]
ds_read_b128 v[124:127],v7 offset:7168
v_add_f32 v56,v56,v60
v_mfma_f32_16x16x32_bf16 v[36:39],a[204:207],v[100:103],v[36:39]
s_waitcnt lgkmcnt(5)
v_add_f32 v57,v57,v61
v_mul_f32 v188,0xba800000,v56
v_mfma_f32_16x16x32_bf16 v[32:35],a[208:211],v[104:107],v[32:35]
s_add_u32 s55,s55,32768
v_fma_f32 v58,v188,v188,-v210
v_fma_f32 v57,v57,v211,-v58
v_mfma_f32_16x16x32_bf16 v[36:39],a[212:215],v[104:107],v[36:39]
s_waitcnt lgkmcnt(4)
s_and_b32 s55,s55,0x1ffff
v_max_f32 v57,v210,v57
v_mfma_f32_16x16x32_bf16 v[32:35],a[216:219],v[108:111],v[32:35]
v_rsq_f32 v58,v57
v_mfma_f32_16x16x32_bf16 v[36:39],a[220:223],v[108:111],v[36:39]
s_waitcnt lgkmcnt(3)
v_mul_f32 v189,v57,v58
v_mul_f32 v190,v209,v58
v_mfma_f32_16x16x32_bf16 v[32:35],a[224:227],v[112:115],v[32:35]
v_mul_f32 v59,v58,v58
v_mul_f32 v191,v208,v58
v_mfma_f32_16x16x32_bf16 v[36:39],a[228:231],v[112:115],v[36:39]
s_waitcnt lgkmcnt(2)
v_mul_f32 v191,v191,v59
v_add_u32 v4,s55,v8
v_mfma_f32_16x16x32_bf16 v[32:35],a[232:235],v[116:119],v[32:35]
v_add_u32 v5,s55,v9
v_add_u32 v6,s55,v10
v_mfma_f32_16x16x32_bf16 v[36:39],a[236:239],v[116:119],v[36:39]
s_waitcnt lgkmcnt(1)
v_add_u32 v7,s55,v11
v_mfma_f32_16x16x32_bf16 v[32:35],a[240:243],v[120:123],v[32:35]
v_mfma_f32_16x16x32_bf16 v[36:39],a[244:247],v[120:123],v[36:39]
s_waitcnt lgkmcnt(0)
v_mfma_f32_16x16x32_bf16 v[40:43],a[248:251],v[124:127],v[32:35]
v_mfma_f32_16x16x32_bf16 v[44:47],a[252:255],v[124:127],v[36:39]
s_waitcnt vmcnt(1)
v_cmp_gt_u32 vcc,s71,v16
s_add_u32 s60,s60,1
s_branch endN_341
BN_335:
s_waitcnt vmcnt(9)
ds_read_b128 v[64:67],v4 offset:0
s_waitcnt vmcnt(8)
ds_read_b128 v[68:71],v4 offset:1024
s_waitcnt vmcnt(7)
ds_read_b128 v[72:75],v4 offset:2048
s_waitcnt vmcnt(6)
ds_read_b128 v[76:79],v4 offset:3072
s_waitcnt lgkmcnt(3)
v_mfma_f32_16x16x32_bf16 v[32:35],a[0:3],v[64:67],0
s_add_u32 s71,s60,2
s_add_u32 s53,s60,3
s_mov_b32 s57,s63
v_mfma_f32_16x16x32_bf16 v[36:39],a[4:7],v[64:67],0
v_mfma_f32_16x16x32_bf16 v[48:51],v[12:15],v[64:67],0
v_mfma_f32_16x16x32_bf16 v[52:55],v[64:67],v[64:67],0
s_waitcnt lgkmcnt(2)
s_waitcnt vmcnt(5)
ds_read_b128 v[80:83],v4 offset:4096
v_mfma_f32_16x16x32_bf16 v[32:35],a[8:11],v[68:71],v[32:35]
v_mfma_f32_16x16x32_bf16 v[36:39],a[12:15],v[68:71],v[36:39]
v_mfma_f32_16x16x32_bf16 v[48:51],v[12:15],v[68:71],v[48:51]
v_mfma_f32_16x16x32_bf16 v[52:55],v[68:71],v[68:71],v[52:55]
s_waitcnt lgkmcnt(2)
s_waitcnt vmcnt(4)
ds_read_b128 v[84:87],v4 offset:5120
v_mfma_f32_16x16x32_bf16 v[32:35],a[16:19],v[72:75],v[32:35]
v_mfma_f32_16x16x32_bf16 v[36:39],a[20:23],v[72:75],v[36:39]
v_mfma_f32_16x16x32_bf16 v[48:51],v[12:15],v[72:75],v[48:51]
v_mfma_f32_16x16x32_bf16 v[52:55],v[72:75],v[72:75],v[52:55]
s_waitcnt lgkmcnt(2)
s_waitcnt vmcnt(3)
ds_read_b128 v[88:91],v4 offset:6144
v_mfma_f32_16x16x32_bf16 v[32:35],a[24:27],v[76:79],v[32:35]
v_mfma_f32_16x16x32_bf16 v[36:39],a[28:31],v[76:79],v[36:39]
v_mfma_f32_16x16x32_bf16 v[48:51],v[12:15],v[76:79],v[48:51]
v_mfma_f32_16x16x32_bf16 v[52:55],v[76:79],v[76:79],v[52:55]
s_waitcnt lgkmcnt(2)
s_waitcnt vmcnt(2)
ds_read_b128 v[92:95],v4 offset:7168
v_mfma_f32_16x16x32_bf16 v[32:35],a[32:35],v[80:83],v[32:35]
v_mfma_f32_16x16x32_bf16 v[36:39],a[36:39],v[80:83],v[36:39]
v_mfma_f32_16x16x32_bf16 v[48:51],v[12:15],v[80:83],v[48:51]
v_mfma_f32_16x16x32_bf16 v[52:55],v[80:83],v[80:83],v[52:55]
s_waitcnt lgkmcnt(2)
s_barrier
ds_read_b128 v[96:99],v5 offset:0
v_mfma_f32_16x16x32_bf16 v[32:35],a[40:43],v[84:87],v[32:35]
ds_read_b128 v[100:103],v5 offset:1024
v_mfma_f32_16x16x32_bf16 v[36:39],a[44:47],v[84:87],v[36:39]
ds_read_b128 v[104:107],v5 offset:2048
v_mfma_f32_16x16x32_bf16 v[48:51],v[12:15],v[84:87],v[48:51]
ds_read_b128 v[108:111],v5 offset:3072
v_mfma_f32_16x16x32_bf16 v[52:55],v[84:87],v[84:87],v[52:55]
s_waitcnt lgkmcnt(5)
v_mfma_f32_16x16x32_bf16 v[32:35],a[48:51],v[88:91],v[32:35]
ds_read_b128 v[112:115],v5 offset:4096
v_mfma_f32_16x16x32_bf16 v[36:39],a[52:55],v[88:91],v[36:39]
v_mfma_f32_16x16x32_bf16 v[48:51],v[12:15],v[88:91],v[48:51]
v_mfma_f32_16x16x32_bf16 v[52:55],v[88:91],v[88:91],v[52:55]
s_waitcnt lgkmcnt(5)
v_mfma_f32_16x16x32_bf16 v[32:35],a[56:59],v[92:95],v[32:35]
ds_read_b128 v[116:119],v5 offset:5120
v_mfma_f32_16x16x32_bf16 v[36:39],a[60:63],v[92:95],v[36:39]
v_mfma_f32_16x16x32_bf16 v[48:51],v[12:15],v[92:95],v[48:51]
v_mfma_f32_16x16x32_bf16 v[52:55],v[92:95],v[92:95],v[52:55]
s_waitcnt lgkmcnt(5)
v_mfma_f32_16x16x32_bf16 v[32:35],a[64:67],v[96:99],v[32:35]
ds_read_b128 v[120:123],v5 offset:6144
v_mfma_f32_16x16x32_bf16 v[36:39],a[68:71],v[96:99],v[36:39]
s_waitcnt lgkmcnt(5)
v_mfma_f32_16x16x32_bf16 v[32:35],a[72:75],v[100:103],v[32:35]
ds_read_b128 v[124:127],v5 offset:7168
v_mfma_f32_16x16x32_bf16 v[36:39],a[76:79],v[100:103],v[36:39]
s_waitcnt lgkmcnt(5)
v_mfma_f32_16x16x32_bf16 v[32:35],a[80:83],v[104:107],v[32:35]
ds_read_b128 v[64:67],v6 offset:0
v_cndmask_b32 v49,v52,v53,s[74:75]
v_mfma_f32_16x16x32_bf16 v[36:39],a[84:87],v[104:107],v[36:39]
s_waitcnt lgkmcnt(5)
v_cndmask_b32 v49,v49,v54,s[76:77]
v_cndmask_b32 v49,v49,v55,s[78:79]
v_mfma_f32_16x16x32_bf16 v[32:35],a[88:91],v[108:111],v[32:35]
ds_read_b128 v[68:71],v6 offset:1024
v_mfma_f32_16x16x32_bf16 v[36:39],a[92:95],v[108:111],v[36:39]
s_waitcnt lgkmcnt(5)
ds_write_b64 v19,v[48:49]
v_mfma_f32_16x16x32_bf16 v[32:35],a[96:99],v[112:115],v[32:35]
ds_read_b128 v[72:75],v6 offset:2048
v_mfma_f32_16x16x32_bf16 v[36:39],a[100:103],v[112:115],v[36:39]
s_waitcnt lgkmcnt(6)
v_mfma_f32_16x16x32_bf16 v[32:35],a[104:107],v[116:119],v[32:35]
ds_read_b128 v[76:79],v6 offset:3072
v_mfma_f32_16x16x32_bf16 v[36:39],a[108:111],v[116:119],v[36:39]
s_waitcnt lgkmcnt(6)
v_mfma_f32_16x16x32_bf16 v[32:35],a[112:115],v[120:123],v[32:35]
s_waitcnt lgkmcnt(2)
s_barrier
ds_read_b128 v[80:83],v6 offset:4096
v_mfma_f32_16x16x32_bf16 v[36:39],a[116:119],v[120:123],v[36:39]
ds_read_b64 v[56:57],v20 offset:0
v_mfma_f32_16x16x32_bf16 v[32:35],a[120:123],v[124:127],v[32:35]
ds_read_b128 v[84:87],v6 offset:5120
v_mfma_f32_16x16x32_bf16 v[36:39],a[124:127],v[124:127],v[36:39]
ds_read_b64 v[58:59],v20 offset:512
v_mfma_f32_16x16x32_bf16 v[32:35],a[128:131],v[64:67],v[32:35]
ds_read_b128 v[88:91],v6 offset:6144
v_mfma_f32_16x16x32_bf16 v[36:39],a[132:135],v[64:67],v[36:39]
ds_read_b64 v[60:61],v20 offset:1024
v_mfma_f32_16x16x32_bf16 v[32:35],a[136:139],v[68:71],v[32:35]
ds_read_b128 v[92:95],v6 offset:7168
v_mfma_f32_16x16x32_bf16 v[36:39],a[140:143],v[68:71],v[36:39]
s_waitcnt lgkmcnt(8)
ds_read_b64 v[62:63],v20 offset:1536
v_mfma_f32_16x16x32_bf16 v[32:35],a[144:147],v[72:75],v[32:35]
ds_read_b128 v[96:99],v7 offset:0
v_mfma_f32_16x16x32_bf16 v[36:39],a[148:151],v[72:75],v[36:39]
s_waitcnt lgkmcnt(9)
buffer_load_dword v16,v2,s[20:23],s68 offen sc1
v_mfma_f32_16x16x32_bf16 v[32:35],a[152:155],v[76:79],v[32:35]
ds_read_b128 v[100:103],v7 offset:1024
v_mfma_f32_16x16x32_bf16 v[36:39],a[156:159],v[76:79],v[36:39]
s_waitcnt lgkmcnt(9)
s_waitcnt vmcnt(2)
v_mov_b32 v17,s57
buffer_store_dword v17,v26,s[20:23],s69 offen sc1
v_mfma_f32_16x16x32_bf16 v[32:35],a[160:163],v[80:83],v[32:35]
ds_read_b128 v[104:107],v7 offset:2048
v_mfma_f32_16x16x32_bf16 v[36:39],a[164:167],v[80:83],v[36:39]
s_waitcnt lgkmcnt(8)
s_waitcnt lgkmcnt(3)
v_add_f32 v56,v56,v58
v_mfma_f32_16x16x32_bf16 v[32:35],a[168:171],v[84:87],v[32:35]
ds_read_b128 v[108:111],v7 offset:3072
v_add_f32 v57,v57,v59
v_mfma_f32_16x16x32_bf16 v[36:39],a[172:175],v[84:87],v[36:39]
v_add_f32 v60,v60,v62
v_add_f32 v61,v61,v63
v_mfma_f32_16x16x32_bf16 v[32:35],a[176:179],v[88:91],v[32:35]
ds_read_b128 v[112:115],v7 offset:4096
v_add_f32 v56,v56,v60
v_mfma_f32_16x16x32_bf16 v[36:39],a[180:183],v[88:91],v[36:39]
v_add_f32 v57,v57,v61
v_mul_f32 v188,0xba800000,v56
v_mfma_f32_16x16x32_bf16 v[32:35],a[184:187],v[92:95],v[32:35]
ds_read_b128 v[116:119],v7 offset:5120
v_fma_f32 v58,v188,v188,-v210
v_mfma_f32_16x16x32_bf16 v[36:39],a[188:191],v[92:95],v[36:39]
s_waitcnt lgkmcnt(5)
v_fma_f32 v57,v57,v211,-v58
v_max_f32 v57,v210,v57
v_mfma_f32_16x16x32_bf16 v[32:35],a[192:195],v[96:99],v[32:35]
ds_read_b128 v[120:123],v7 offset:6144
v_mfma_f32_16x16x32_bf16 v[36:39],a[196:199],v[96:99],v[36:39]
s_waitcnt lgkmcnt(5)
v_rsq_f32 v58,v57
v_mfma_f32_16x16x32_bf16 v[32:35],a[200:203],v[100:103],v[32:35]
ds_read_b128 v[124:127],v7 offset:7168
v_mul_f32 v189,v57,v58
v_mfma_f32_16x16x32_bf16 v[36:39],a[204:207],v[100:103],v[36:39]
s_waitcnt lgkmcnt(5)
v_mul_f32 v190,v209,v58
v_mul_f32 v59,v58,v58
v_mfma_f32_16x16x32_bf16 v[32:35],a[208:211],v[104:107],v[32:35]
s_add_u32 s55,s55,32768
v_mul_f32 v191,v208,v58
v_mul_f32 v191,v191,v59
v_mfma_f32_16x16x32_bf16 v[36:39],a[212:215],v[104:107],v[36:39]
s_waitcnt lgkmcnt(4)
s_and_b32 s55,s55,0x1ffff
v_add_u32 v4,s55,v8
v_mfma_f32_16x16x32_bf16 v[32:35],a[216:219],v[108:111],v[32:35]
v_add_u32 v5,s55,v9
v_add_u32 v6,s55,v10
v_mfma_f32_16x16x32_bf16 v[36:39],a[220:223],v[108:111],v[36:39]
s_waitcnt lgkmcnt(3)
v_add_u32 v7,s55,v11
v_mfma_f32_16x16x32_bf16 v[32:35],a[224:227],v[112:115],v[32:35]
v_mfma_f32_16x16x32_bf16 v[36:39],a[228:231],v[112:115],v[36:39]
s_waitcnt lgkmcnt(2)
v_mfma_f32_16x16x32_bf16 v[32:35],a[232:235],v[116:119],v[32:35]
v_mfma_f32_16x16x32_bf16 v[36:39],a[236:239],v[116:119],v[36:39]
s_waitcnt lgkmcnt(1)
v_mfma_f32_16x16x32_bf16 v[32:35],a[240:243],v[120:123],v[32:35]
v_mfma_f32_16x16x32_bf16 v[36:39],a[244:247],v[120:123],v[36:39]
s_waitcnt lgkmcnt(0)
v_mfma_f32_16x16x32_bf16 v[40:43],a[248:251],v[124:127],v[32:35]
v_mfma_f32_16x16x32_bf16 v[44:47],a[252:255],v[124:127],v[36:39]
s_waitcnt vmcnt(1)
v_cmp_gt_u32 vcc,s71,v16
s_add_u32 s60,s60,1
endN_341:
s_cbranch_vccnz nb_338
s_mov_b32 m0,s70
s_nop 0
buffer_load_dwordx4 v3,s[20:23],s61 offen offset:0 lds
buffer_load_dwordx4 v3,s[20:23],s61 offen offset:1024 lds
buffer_load_dwordx4 v3,s[20:23],s61 offen offset:2048 lds
buffer_load_dwordx4 v3,s[20:23],s61 offen offset:3072 lds
s_add_u32 m0,s70,4096
s_nop 0
buffer_load_dwordx4 v3,s[20:23],s62 offen offset:0 lds
buffer_load_dwordx4 v3,s[20:23],s62 offen offset:1024 lds
buffer_load_dwordx4 v3,s[20:23],s62 offen offset:2048 lds
buffer_load_dwordx4 v3,s[20:23],s62 offen offset:3072 lds
s_add_u32 s61,s61,32768
s_add_u32 s62,s62,32768
s_add_u32 s70,s70,32768
s_and_b32 s70,s70,0x1ffff
s_mov_b32 s57,s63
v_pk_fma_f32 v[40:41],v[152:153],v[188:189],v[40:41] op_sel_hi:[1,0,1]
v_pk_fma_f32 v[42:43],v[154:155],v[188:189],v[42:43] op_sel_hi:[1,0,1]
v_pk_fma_f32 v[44:45],v[156:157],v[188:189],v[44:45] op_sel_hi:[1,0,1]
v_pk_fma_f32 v[46:47],v[158:159],v[188:189],v[46:47] op_sel_hi:[1,0,1]
v_pk_mul_f32 v[168:169],v[40:41],v[40:41]
v_pk_mul_f32 v[170:171],v[42:43],v[42:43]
v_pk_mul_f32 v[172:173],v[44:45],v[44:45]
v_pk_mul_f32 v[174:175],v[46:47],v[46:47]
v_pk_fma_f32 v[168:169],v[168:169],v[190:191],v[190:191] op_sel:[0,1,0] op_sel_hi:[1,1,0]
v_pk_fma_f32 v[170:171],v[170:171],v[190:191],v[190:191] op_sel:[0,1,0] op_sel_hi:[1,1,0]
v_pk_fma_f32 v[172:173],v[172:173],v[190:191],v[190:191] op_sel:[0,1,0] op_sel_hi:[1,1,0]
v_pk_fma_f32 v[174:175],v[174:175],v[190:191],v[190:191] op_sel:[0,1,0] op_sel_hi:[1,1,0]
v_pk_mul_f32 v[168:169],v[168:169],v[40:41]
v_pk_mul_f32 v[170:171],v[170:171],v[42:43]
v_pk_mul_f32 v[172:173],v[172:173],v[44:45]
v_pk_mul_f32 v[174:175],v[174:175],v[46:47]
v_exp_f32 v168,v168
v_exp_f32 v169,v169
v_exp_f32 v170,v170
v_exp_f32 v171,v171
v_exp_f32 v172,v172
v_exp_f32 v173,v173
v_exp_f32 v174,v174
v_exp_f32 v175,v175
v_pk_fma_f32 v[168:169],v[168:169],v[188:189],v[188:189] op_sel:[0,1,1] op_sel_hi:[1,1,1]
v_pk_fma_f32 v[170:171],v[170:171],v[188:189],v[188:189] op_sel:[0,1,1] op_sel_hi:[1,1,1]
v_pk_fma_f32 v[172:173],v[172:173],v[188:189],v[188:189] op_sel:[0,1,1] op_sel_hi:[1,1,1]
v_pk_fma_f32 v[174:175],v[174:175],v[188:189],v[188:189] op_sel:[0,1,1] op_sel_hi:[1,1,1]
v_rcp_f32 v168,v168
v_rcp_f32 v169,v169
v_rcp_f32 v170,v170
v_rcp_f32 v171,v171
v_rcp_f32 v172,v172
v_rcp_f32 v173,v173
v_rcp_f32 v174,v174
v_rcp_f32 v175,v175
v_pk_mul_f32 v[40:41],v[168:169],v[40:41]
v_pk_mul_f32 v[42:43],v[170:171],v[42:43]
v_pk_mul_f32 v[44:45],v[172:173],v[44:45]
v_pk_mul_f32 v[46:47],v[174:175],v[46:47]
v_cvt_pk_bf16_f32 v176,v40,v41
v_cvt_pk_bf16_f32 v177,v42,v43
v_cvt_pk_bf16_f32 v178,v44,v45
v_cvt_pk_bf16_f32 v179,v46,v47
buffer_store_dwordx4 v[176:179],v0,s[20:23],s66 offen sc1
s_add_u32 s66,s66,32768
s_add_u32 s63,s63,1
s_waitcnt vmcnt(9)
v_mov_b32 v17,s57
buffer_store_dword v17,v26,s[20:23],s69 offen sc1
s_branch dec_337
nb_338:
buffer_load_dword v16,v2,s[20:23],s68 offen sc1
s_nop 3
s_mov_b32 s57,s63
v_pk_fma_f32 v[40:41],v[152:153],v[188:189],v[40:41] op_sel_hi:[1,0,1]
v_pk_fma_f32 v[42:43],v[154:155],v[188:189],v[42:43] op_sel_hi:[1,0,1]
v_pk_fma_f32 v[44:45],v[156:157],v[188:189],v[44:45] op_sel_hi:[1,0,1]
v_pk_fma_f32 v[46:47],v[158:159],v[188:189],v[46:47] op_sel_hi:[1,0,1]
v_pk_mul_f32 v[168:169],v[40:41],v[40:41]
v_pk_mul_f32 v[170:171],v[42:43],v[42:43]
v_pk_mul_f32 v[172:173],v[44:45],v[44:45]
v_pk_mul_f32 v[174:175],v[46:47],v[46:47]
v_pk_fma_f32 v[168:169],v[168:169],v[190:191],v[190:191] op_sel:[0,1,0] op_sel_hi:[1,1,0]
v_pk_fma_f32 v[170:171],v[170:171],v[190:191],v[190:191] op_sel:[0,1,0] op_sel_hi:[1,1,0]
v_pk_fma_f32 v[172:173],v[172:173],v[190:191],v[190:191] op_sel:[0,1,0] op_sel_hi:[1,1,0]
v_pk_fma_f32 v[174:175],v[174:175],v[190:191],v[190:191] op_sel:[0,1,0] op_sel_hi:[1,1,0]
v_pk_mul_f32 v[168:169],v[168:169],v[40:41]
v_pk_mul_f32 v[170:171],v[170:171],v[42:43]
v_pk_mul_f32 v[172:173],v[172:173],v[44:45]
v_pk_mul_f32 v[174:175],v[174:175],v[46:47]
v_exp_f32 v168,v168
v_exp_f32 v169,v169
v_exp_f32 v170,v170
v_exp_f32 v171,v171
v_exp_f32 v172,v172
v_exp_f32 v173,v173
v_exp_f32 v174,v174
v_exp_f32 v175,v175
v_pk_fma_f32 v[168:169],v[168:169],v[188:189],v[188:189] op_sel:[0,1,1] op_sel_hi:[1,1,1]
v_pk_fma_f32 v[170:171],v[170:171],v[188:189],v[188:189] op_sel:[0,1,1] op_sel_hi:[1,1,1]
v_pk_fma_f32 v[172:173],v[172:173],v[188:189],v[188:189] op_sel:[0,1,1] op_sel_hi:[1,1,1]
v_pk_fma_f32 v[174:175],v[174:175],v[188:189],v[188:189] op_sel:[0,1,1] op_sel_hi:[1,1,1]
v_rcp_f32 v168,v168
v_rcp_f32 v169,v169
v_rcp_f32 v170,v170
v_rcp_f32 v171,v171
v_rcp_f32 v172,v172
v_rcp_f32 v173,v173
v_rcp_f32 v174,v174
v_rcp_f32 v175,v175
v_pk_mul_f32 v[40:41],v[168:169],v[40:41]
v_pk_mul_f32 v[42:43],v[170:171],v[42:43]
v_pk_mul_f32 v[44:45],v[172:173],v[44:45]
v_pk_mul_f32 v[46:47],v[174:175],v[46:47]
v_cvt_pk_bf16_f32 v176,v40,v41
v_cvt_pk_bf16_f32 v177,v42,v43
v_cvt_pk_bf16_f32 v178,v44,v45
v_cvt_pk_bf16_f32 v179,v46,v47
buffer_store_dwordx4 v[176:179],v0,s[20:23],s66 offen sc1
s_add_u32 s66,s66,32768
s_add_u32 s63,s63,1
s_waitcnt vmcnt(2)
v_mov_b32 v17,s57
buffer_store_dword v17,v26,s[20:23],s69 offen sc1
s_waitcnt vmcnt(2)
v_cmp_gt_u32 vcc,s71,v16
s_cbranch_vccz lag_336
s_waitcnt vmcnt(1)
v_mov_b32 v17,s63
buffer_store_dword v17,v26,s[20:23],s69 offen sc1
s_cmp_ge_u32 s60,128
s_cbranch_scc1 done_310
plp_344:
buffer_load_dword v16,v2,s[20:23],s68 offen sc1
s_waitcnt vmcnt(0)
v_cmp_gt_u32 vcc,s71,v16
s_cbranch_vccz pok_345
s_sleep 4
s_sub_u32 s90,s90,1
s_cmp_gt_i32 s90,0
s_cbranch_scc1 plp_344
pok_345:
s_branch lag_336
done_310:
s_endpgm
fl_w2:
v_and_b32 v21,15,v1
v_lshrrev_b32 v22,4,v1
v_lshrrev_b32 v23,2,v21
v_and_b32 v24,3,v21
s_lshl_b32 s61,s50,15
v_lshl_add_u32 v25,v22,3,v23
s_load_dwordx2 s[4:5],s[0:1],72
s_mov_b32 s52,0
s_mov_b32 s53,s59
s_mul_i32 s54,s52,2097152
s_lshl_b32 s64,s53,8
s_add_u32 s54,s54,s64
s_lshl_b32 s64,s50,6
s_add_u32 s54,s54,s64
s_waitcnt lgkmcnt(0)
s_mov_b32 s28,s4
s_and_b32 s29,s5,0xffff
s_mov_b32 s30,0x200000
s_mov_b32 s31,0x20000
v_lshrrev_b32 v26,2,v1
v_and_b32 v27,3,v1
v_mul_u32_u24 v16,2048,v26
v_lshl_add_u32 v16,v27,4,v16
v_lshlrev_b32 v17,6,v25
v_lshl_add_u32 v17,v24,4,v17
v_add_u32 v17,s61,v17
s_xor_b32 s62,s50,0
s_mul_i32 s62,s62,524288
s_add_u32 s62,s62,s54
s_add_u32 m0,s61,0
s_nop 0
buffer_load_dwordx4 v16,s[28:31],s62 offen lds
s_add_u32 s62,s62,32768
s_add_u32 m0,m0,1024
s_waitcnt vmcnt(2)
buffer_load_dwordx4 v16,s[28:31],s62 offen lds
s_add_u32 s62,s62,32768
s_add_u32 m0,m0,1024
s_waitcnt vmcnt(2)
buffer_load_dwordx4 v16,s[28:31],s62 offen lds
s_add_u32 s62,s62,32768
s_add_u32 m0,m0,1024
s_waitcnt vmcnt(2)
buffer_load_dwordx4 v16,s[28:31],s62 offen lds
s_add_u32 s62,s62,32768
s_add_u32 m0,m0,1024
s_waitcnt vmcnt(2)
buffer_load_dwordx4 v16,s[28:31],s62 offen lds
s_add_u32 s62,s62,32768
s_add_u32 m0,m0,1024
s_waitcnt vmcnt(2)
buffer_load_dwordx4 v16,s[28:31],s62 offen lds
s_add_u32 s62,s62,32768
s_add_u32 m0,m0,1024
s_waitcnt vmcnt(2)
buffer_load_dwordx4 v16,s[28:31],s62 offen lds
s_add_u32 s62,s62,32768
s_add_u32 m0,m0,1024
s_waitcnt vmcnt(2)
buffer_load_dwordx4 v16,s[28:31],s62 offen lds
s_add_u32 s62,s62,32768
s_add_u32 m0,m0,1024
s_waitcnt vmcnt(2)
buffer_load_dwordx4 v16,s[28:31],s62 offen lds
s_add_u32 s62,s62,32768
s_add_u32 m0,m0,1024
s_waitcnt vmcnt(2)
buffer_load_dwordx4 v16,s[28:31],s62 offen lds
s_add_u32 s62,s62,32768
s_add_u32 m0,m0,1024
s_waitcnt vmcnt(2)
buffer_load_dwordx4 v16,s[28:31],s62 offen lds
s_add_u32 s62,s62,32768
s_add_u32 m0,m0,1024
s_waitcnt vmcnt(2)
buffer_load_dwordx4 v16,s[28:31],s62 offen lds
s_add_u32 s62,s62,32768
s_add_u32 m0,m0,1024
s_waitcnt vmcnt(2)
buffer_load_dwordx4 v16,s[28:31],s62 offen lds
s_add_u32 s62,s62,32768
s_add_u32 m0,m0,1024
s_waitcnt vmcnt(2)
buffer_load_dwordx4 v16,s[28:31],s62 offen lds
s_add_u32 s62,s62,32768
s_add_u32 m0,m0,1024
s_waitcnt vmcnt(2)
buffer_load_dwordx4 v16,s[28:31],s62 offen lds
s_add_u32 s62,s62,32768
s_add_u32 m0,m0,1024
s_waitcnt vmcnt(2)
buffer_load_dwordx4 v16,s[28:31],s62 offen lds
s_waitcnt vmcnt(2)
s_xor_b32 s62,s50,1
s_mul_i32 s62,s62,524288
s_add_u32 s62,s62,s54
s_add_u32 m0,s61,16384
s_nop 0
buffer_load_dwordx4 v16,s[28:31],s62 offen lds
s_add_u32 s62,s62,32768
s_add_u32 m0,m0,1024
s_waitcnt vmcnt(2)
buffer_load_dwordx4 v16,s[28:31],s62 offen lds
s_add_u32 s62,s62,32768
s_add_u32 m0,m0,1024
s_waitcnt vmcnt(2)
buffer_load_dwordx4 v16,s[28:31],s62 offen lds
s_add_u32 s62,s62,32768
s_add_u32 m0,m0,1024
s_waitcnt vmcnt(2)
buffer_load_dwordx4 v16,s[28:31],s62 offen lds
s_add_u32 s62,s62,32768
s_add_u32 m0,m0,1024
s_waitcnt vmcnt(2)
buffer_load_dwordx4 v16,s[28:31],s62 offen lds
s_add_u32 s62,s62,32768
s_add_u32 m0,m0,1024
s_waitcnt vmcnt(2)
buffer_load_dwordx4 v16,s[28:31],s62 offen lds
s_add_u32 s62,s62,32768
s_add_u32 m0,m0,1024
s_waitcnt vmcnt(2)
buffer_load_dwordx4 v16,s[28:31],s62 offen lds
s_add_u32 s62,s62,32768
s_add_u32 m0,m0,1024
s_waitcnt vmcnt(2)
buffer_load_dwordx4 v16,s[28:31],s62 offen lds
s_add_u32 s62,s62,32768
s_add_u32 m0,m0,1024
s_waitcnt vmcnt(2)
buffer_load_dwordx4 v16,s[28:31],s62 offen lds
s_add_u32 s62,s62,32768
s_add_u32 m0,m0,1024
s_waitcnt vmcnt(2)
buffer_load_dwordx4 v16,s[28:31],s62 offen lds
s_add_u32 s62,s62,32768
s_add_u32 m0,m0,1024
s_waitcnt vmcnt(2)
buffer_load_dwordx4 v16,s[28:31],s62 offen lds
s_add_u32 s62,s62,32768
s_add_u32 m0,m0,1024
s_waitcnt vmcnt(2)
buffer_load_dwordx4 v16,s[28:31],s62 offen lds
s_add_u32 s62,s62,32768
s_add_u32 m0,m0,1024
s_waitcnt vmcnt(2)
buffer_load_dwordx4 v16,s[28:31],s62 offen lds
s_add_u32 s62,s62,32768
s_add_u32 m0,m0,1024
s_waitcnt vmcnt(2)
buffer_load_dwordx4 v16,s[28:31],s62 offen lds
s_add_u32 s62,s62,32768
s_add_u32 m0,m0,1024
s_waitcnt vmcnt(2)
buffer_load_dwordx4 v16,s[28:31],s62 offen lds
s_add_u32 s62,s62,32768
s_add_u32 m0,m0,1024
s_waitcnt vmcnt(2)
buffer_load_dwordx4 v16,s[28:31],s62 offen lds
s_waitcnt vmcnt(2)
s_waitcnt vmcnt(16)
ds_read_b64_tr_b16 a[0:1],v17 offset:0
ds_read_b64_tr_b16 a[2:3],v17 offset:256
ds_read_b64_tr_b16 a[4:5],v17 offset:8
ds_read_b64_tr_b16 a[6:7],v17 offset:264
ds_read_b64_tr_b16 a[8:9],v17 offset:2048
ds_read_b64_tr_b16 a[10:11],v17 offset:2304
ds_read_b64_tr_b16 a[12:13],v17 offset:2056
ds_read_b64_tr_b16 a[14:15],v17 offset:2312
ds_read_b64_tr_b16 a[16:17],v17 offset:4096
ds_read_b64_tr_b16 a[18:19],v17 offset:4352
ds_read_b64_tr_b16 a[20:21],v17 offset:4104
ds_read_b64_tr_b16 a[22:23],v17 offset:4360
s_waitcnt lgkmcnt(0)
ds_read_b64_tr_b16 a[24:25],v17 offset:6144
ds_read_b64_tr_b16 a[26:27],v17 offset:6400
ds_read_b64_tr_b16 a[28:29],v17 offset:6152
ds_read_b64_tr_b16 a[30:31],v17 offset:6408
ds_read_b64_tr_b16 a[32:33],v17 offset:8192
ds_read_b64_tr_b16 a[34:35],v17 offset:8448
ds_read_b64_tr_b16 a[36:37],v17 offset:8200
ds_read_b64_tr_b16 a[38:39],v17 offset:8456
ds_read_b64_tr_b16 a[40:41],v17 offset:10240
ds_read_b64_tr_b16 a[42:43],v17 offset:10496
ds_read_b64_tr_b16 a[44:45],v17 offset:10248
ds_read_b64_tr_b16 a[46:47],v17 offset:10504
s_waitcnt lgkmcnt(0)
ds_read_b64_tr_b16 a[48:49],v17 offset:12288
ds_read_b64_tr_b16 a[50:51],v17 offset:12544
ds_read_b64_tr_b16 a[52:53],v17 offset:12296
ds_read_b64_tr_b16 a[54:55],v17 offset:12552
ds_read_b64_tr_b16 a[56:57],v17 offset:14336
ds_read_b64_tr_b16 a[58:59],v17 offset:14592
ds_read_b64_tr_b16 a[60:61],v17 offset:14344
ds_read_b64_tr_b16 a[62:63],v17 offset:14600
s_waitcnt lgkmcnt(0)
s_xor_b32 s62,s50,2
s_mul_i32 s62,s62,524288
s_add_u32 s62,s62,s54
s_add_u32 m0,s61,0
s_nop 0
buffer_load_dwordx4 v16,s[28:31],s62 offen lds
s_add_u32 s62,s62,32768
s_add_u32 m0,m0,1024
s_waitcnt vmcnt(2)
buffer_load_dwordx4 v16,s[28:31],s62 offen lds
s_add_u32 s62,s62,32768
s_add_u32 m0,m0,1024
s_waitcnt vmcnt(2)
buffer_load_dwordx4 v16,s[28:31],s62 offen lds
s_add_u32 s62,s62,32768
s_add_u32 m0,m0,1024
s_waitcnt vmcnt(2)
buffer_load_dwordx4 v16,s[28:31],s62 offen lds
s_add_u32 s62,s62,32768
s_add_u32 m0,m0,1024
s_waitcnt vmcnt(2)
buffer_load_dwordx4 v16,s[28:31],s62 offen lds
s_add_u32 s62,s62,32768
s_add_u32 m0,m0,1024
s_waitcnt vmcnt(2)
buffer_load_dwordx4 v16,s[28:31],s62 offen lds
s_add_u32 s62,s62,32768
s_add_u32 m0,m0,1024
s_waitcnt vmcnt(2)
buffer_load_dwordx4 v16,s[28:31],s62 offen lds
s_add_u32 s62,s62,32768
s_add_u32 m0,m0,1024
s_waitcnt vmcnt(2)
buffer_load_dwordx4 v16,s[28:31],s62 offen lds
s_add_u32 s62,s62,32768
s_add_u32 m0,m0,1024
s_waitcnt vmcnt(2)
buffer_load_dwordx4 v16,s[28:31],s62 offen lds
s_add_u32 s62,s62,32768
s_add_u32 m0,m0,1024
s_waitcnt vmcnt(2)
buffer_load_dwordx4 v16,s[28:31],s62 offen lds
s_add_u32 s62,s62,32768
s_add_u32 m0,m0,1024
s_waitcnt vmcnt(2)
buffer_load_dwordx4 v16,s[28:31],s62 offen lds
s_add_u32 s62,s62,32768
s_add_u32 m0,m0,1024
s_waitcnt vmcnt(2)
buffer_load_dwordx4 v16,s[28:31],s62 offen lds
s_add_u32 s62,s62,32768
s_add_u32 m0,m0,1024
s_waitcnt vmcnt(2)
buffer_load_dwordx4 v16,s[28:31],s62 offen lds
s_add_u32 s62,s62,32768
s_add_u32 m0,m0,1024
s_waitcnt vmcnt(2)
buffer_load_dwordx4 v16,s[28:31],s62 offen lds
s_add_u32 s62,s62,32768
s_add_u32 m0,m0,1024
s_waitcnt vmcnt(2)
buffer_load_dwordx4 v16,s[28:31],s62 offen lds
s_add_u32 s62,s62,32768
s_add_u32 m0,m0,1024
s_waitcnt vmcnt(2)
buffer_load_dwordx4 v16,s[28:31],s62 offen lds
s_waitcnt vmcnt(2)
s_waitcnt vmcnt(16)
ds_read_b64_tr_b16 a[64:65],v17 offset:16384
ds_read_b64_tr_b16 a[66:67],v17 offset:16640
ds_read_b64_tr_b16 a[68:69],v17 offset:16392
ds_read_b64_tr_b16 a[70:71],v17 offset:16648
ds_read_b64_tr_b16 a[72:73],v17 offset:18432
ds_read_b64_tr_b16 a[74:75],v17 offset:18688
ds_read_b64_tr_b16 a[76:77],v17 offset:18440
ds_read_b64_tr_b16 a[78:79],v17 offset:18696
ds_read_b64_tr_b16 a[80:81],v17 offset:20480
ds_read_b64_tr_b16 a[82:83],v17 offset:20736
ds_read_b64_tr_b16 a[84:85],v17 offset:20488
ds_read_b64_tr_b16 a[86:87],v17 offset:20744
s_waitcnt lgkmcnt(0)
ds_read_b64_tr_b16 a[88:89],v17 offset:22528
ds_read_b64_tr_b16 a[90:91],v17 offset:22784
ds_read_b64_tr_b16 a[92:93],v17 offset:22536
ds_read_b64_tr_b16 a[94:95],v17 offset:22792
ds_read_b64_tr_b16 a[96:97],v17 offset:24576
ds_read_b64_tr_b16 a[98:99],v17 offset:24832
ds_read_b64_tr_b16 a[100:101],v17 offset:24584
ds_read_b64_tr_b16 a[102:103],v17 offset:24840
ds_read_b64_tr_b16 a[104:105],v17 offset:26624
ds_read_b64_tr_b16 a[106:107],v17 offset:26880
ds_read_b64_tr_b16 a[108:109],v17 offset:26632
ds_read_b64_tr_b16 a[110:111],v17 offset:26888
s_waitcnt lgkmcnt(0)
ds_read_b64_tr_b16 a[112:113],v17 offset:28672
ds_read_b64_tr_b16 a[114:115],v17 offset:28928
ds_read_b64_tr_b16 a[116:117],v17 offset:28680
ds_read_b64_tr_b16 a[118:119],v17 offset:28936
ds_read_b64_tr_b16 a[120:121],v17 offset:30720
ds_read_b64_tr_b16 a[122:123],v17 offset:30976
ds_read_b64_tr_b16 a[124:125],v17 offset:30728
ds_read_b64_tr_b16 a[126:127],v17 offset:30984
s_waitcnt lgkmcnt(0)
s_xor_b32 s62,s50,3
s_mul_i32 s62,s62,524288
s_add_u32 s62,s62,s54
s_add_u32 m0,s61,16384
s_nop 0
buffer_load_dwordx4 v16,s[28:31],s62 offen lds
s_add_u32 s62,s62,32768
s_add_u32 m0,m0,1024
s_waitcnt vmcnt(2)
buffer_load_dwordx4 v16,s[28:31],s62 offen lds
s_add_u32 s62,s62,32768
s_add_u32 m0,m0,1024
s_waitcnt vmcnt(2)
buffer_load_dwordx4 v16,s[28:31],s62 offen lds
s_add_u32 s62,s62,32768
s_add_u32 m0,m0,1024
s_waitcnt vmcnt(2)
buffer_load_dwordx4 v16,s[28:31],s62 offen lds
s_add_u32 s62,s62,32768
s_add_u32 m0,m0,1024
s_waitcnt vmcnt(2)
buffer_load_dwordx4 v16,s[28:31],s62 offen lds
s_add_u32 s62,s62,32768
s_add_u32 m0,m0,1024
s_waitcnt vmcnt(2)
buffer_load_dwordx4 v16,s[28:31],s62 offen lds
s_add_u32 s62,s62,32768
s_add_u32 m0,m0,1024
s_waitcnt vmcnt(2)
buffer_load_dwordx4 v16,s[28:31],s62 offen lds
s_add_u32 s62,s62,32768
s_add_u32 m0,m0,1024
s_waitcnt vmcnt(2)
buffer_load_dwordx4 v16,s[28:31],s62 offen lds
s_add_u32 s62,s62,32768
s_add_u32 m0,m0,1024
s_waitcnt vmcnt(2)
buffer_load_dwordx4 v16,s[28:31],s62 offen lds
s_add_u32 s62,s62,32768
s_add_u32 m0,m0,1024
s_waitcnt vmcnt(2)
buffer_load_dwordx4 v16,s[28:31],s62 offen lds
s_add_u32 s62,s62,32768
s_add_u32 m0,m0,1024
s_waitcnt vmcnt(2)
buffer_load_dwordx4 v16,s[28:31],s62 offen lds
s_add_u32 s62,s62,32768
s_add_u32 m0,m0,1024
s_waitcnt vmcnt(2)
buffer_load_dwordx4 v16,s[28:31],s62 offen lds
s_add_u32 s62,s62,32768
s_add_u32 m0,m0,1024
s_waitcnt vmcnt(2)
buffer_load_dwordx4 v16,s[28:31],s62 offen lds
s_add_u32 s62,s62,32768
s_add_u32 m0,m0,1024
s_waitcnt vmcnt(2)
buffer_load_dwordx4 v16,s[28:31],s62 offen lds
s_add_u32 s62,s62,32768
s_add_u32 m0,m0,1024
s_waitcnt vmcnt(2)
buffer_load_dwordx4 v16,s[28:31],s62 offen lds
s_add_u32 s62,s62,32768
s_add_u32 m0,m0,1024
s_waitcnt vmcnt(2)
buffer_load_dwordx4 v16,s[28:31],s62 offen lds
s_waitcnt vmcnt(2)
s_waitcnt vmcnt(16)
ds_read_b64_tr_b16 a[128:129],v17 offset:0
ds_read_b64_tr_b16 a[130:131],v17 offset:256
ds_read_b64_tr_b16 a[132:133],v17 offset:8
ds_read_b64_tr_b16 a[134:135],v17 offset:264
ds_read_b64_tr_b16 a[136:137],v17 offset:2048
ds_read_b64_tr_b16 a[138:139],v17 offset:2304
ds_read_b64_tr_b16 a[140:141],v17 offset:2056
ds_read_b64_tr_b16 a[142:143],v17 offset:2312
ds_read_b64_tr_b16 a[144:145],v17 offset:4096
ds_read_b64_tr_b16 a[146:147],v17 offset:4352
ds_read_b64_tr_b16 a[148:149],v17 offset:4104
ds_read_b64_tr_b16 a[150:151],v17 offset:4360
s_waitcnt lgkmcnt(0)
ds_read_b64_tr_b16 a[152:153],v17 offset:6144
ds_read_b64_tr_b16 a[154:155],v17 offset:6400
ds_read_b64_tr_b16 a[156:157],v17 offset:6152
ds_read_b64_tr_b16 a[158:159],v17 offset:6408
ds_read_b64_tr_b16 a[160:161],v17 offset:8192
ds_read_b64_tr_b16 a[162:163],v17 offset:8448
ds_read_b64_tr_b16 a[164:165],v17 offset:8200
ds_read_b64_tr_b16 a[166:167],v17 offset:8456
ds_read_b64_tr_b16 a[168:169],v17 offset:10240
ds_read_b64_tr_b16 a[170:171],v17 offset:10496
ds_read_b64_tr_b16 a[172:173],v17 offset:10248
ds_read_b64_tr_b16 a[174:175],v17 offset:10504
s_waitcnt lgkmcnt(0)
ds_read_b64_tr_b16 a[176:177],v17 offset:12288
ds_read_b64_tr_b16 a[178:179],v17 offset:12544
ds_read_b64_tr_b16 a[180:181],v17 offset:12296
ds_read_b64_tr_b16 a[182:183],v17 offset:12552
ds_read_b64_tr_b16 a[184:185],v17 offset:14336
ds_read_b64_tr_b16 a[186:187],v17 offset:14592
ds_read_b64_tr_b16 a[188:189],v17 offset:14344
ds_read_b64_tr_b16 a[190:191],v17 offset:14600
s_waitcnt lgkmcnt(0)
s_waitcnt vmcnt(0)
ds_read_b64_tr_b16 a[192:193],v17 offset:16384
ds_read_b64_tr_b16 a[194:195],v17 offset:16640
ds_read_b64_tr_b16 a[196:197],v17 offset:16392
ds_read_b64_tr_b16 a[198:199],v17 offset:16648
ds_read_b64_tr_b16 a[200:201],v17 offset:18432
ds_read_b64_tr_b16 a[202:203],v17 offset:18688
ds_read_b64_tr_b16 a[204:205],v17 offset:18440
ds_read_b64_tr_b16 a[206:207],v17 offset:18696
ds_read_b64_tr_b16 a[208:209],v17 offset:20480
ds_read_b64_tr_b16 a[210:211],v17 offset:20736
ds_read_b64_tr_b16 a[212:213],v17 offset:20488
ds_read_b64_tr_b16 a[214:215],v17 offset:20744
s_waitcnt lgkmcnt(0)
ds_read_b64_tr_b16 a[216:217],v17 offset:22528
ds_read_b64_tr_b16 a[218:219],v17 offset:22784
ds_read_b64_tr_b16 a[220:221],v17 offset:22536
ds_read_b64_tr_b16 a[222:223],v17 offset:22792
ds_read_b64_tr_b16 a[224:225],v17 offset:24576
ds_read_b64_tr_b16 a[226:227],v17 offset:24832
ds_read_b64_tr_b16 a[228:229],v17 offset:24584
ds_read_b64_tr_b16 a[230:231],v17 offset:24840
ds_read_b64_tr_b16 a[232:233],v17 offset:26624
ds_read_b64_tr_b16 a[234:235],v17 offset:26880
ds_read_b64_tr_b16 a[236:237],v17 offset:26632
ds_read_b64_tr_b16 a[238:239],v17 offset:26888
s_waitcnt lgkmcnt(0)
ds_read_b64_tr_b16 a[240:241],v17 offset:28672
ds_read_b64_tr_b16 a[242:243],v17 offset:28928
ds_read_b64_tr_b16 a[244:245],v17 offset:28680
ds_read_b64_tr_b16 a[246:247],v17 offset:28936
ds_read_b64_tr_b16 a[248:249],v17 offset:30720
ds_read_b64_tr_b16 a[250:251],v17 offset:30976
ds_read_b64_tr_b16 a[252:253],v17 offset:30728
ds_read_b64_tr_b16 a[254:255],v17 offset:30984
s_waitcnt lgkmcnt(0)
s_mov_b32 s92,s2
s_and_b32 s93,s3,0xffff
s_mov_b32 s94,0x100
s_mov_b32 s95,0x20000
v_mbcnt_lo_u32_b32 v16,-1,0
v_mbcnt_hi_u32_b32 v16,-1,v16
v_mov_b32 v18,0
v_cmp_eq_u32 vcc,22,v16
s_nop 1
v_cndmask_b32 v18,v18,63,vcc
v_cmp_eq_u32 vcc,17,v16
s_nop 1
v_cndmask_b32 v18,v18,63,vcc
v_cmp_eq_u32 vcc,18,v16
s_nop 1
v_cndmask_b32 v18,v18,1,vcc
v_and_b32 v19,1,v16
v_cmp_eq_u32 vcc,1,v19
v_mov_b32 v19,8192
s_nop 0
v_cndmask_b32 v19,-1,v19,vcc
v_min_u32 v16,31,v16
v_lshlrev_b32 v16,2,v16
s_sub_u32 s66,s88,64
s_cmp_lg_u32 s50,0
s_cbranch_scc1 vot_351
vpoll_347:
buffer_load_dword v17,v16,s[92:95],s66 offen sc1
s_waitcnt vmcnt(0)
s_cmp_lg_u32 s56,2
s_cbranch_scc1 vck_348
v_cmp_eq_u32 vcc,v17,v19
s_and_b32 s64,vcc_lo,0xffff
s_cmp_eq_u32 s64,65535
s_cbranch_scc1 vck_348
s_mov_b32 s65,0
v_readlane_b32 s64,v17,1
s_lshr_b32 s64,s64,8
s_add_u32 s65,s65,s64
v_readlane_b32 s64,v17,3
s_lshr_b32 s64,s64,8
s_add_u32 s65,s65,s64
v_readlane_b32 s64,v17,5
s_lshr_b32 s64,s64,8
s_add_u32 s65,s65,s64
v_readlane_b32 s64,v17,7
s_lshr_b32 s64,s64,8
s_add_u32 s65,s65,s64
v_readlane_b32 s64,v17,9
s_lshr_b32 s64,s64,8
s_add_u32 s65,s65,s64
v_readlane_b32 s64,v17,11
s_lshr_b32 s64,s64,8
s_add_u32 s65,s65,s64
v_readlane_b32 s64,v17,13
s_lshr_b32 s64,s64,8
s_add_u32 s65,s65,s64
v_readlane_b32 s64,v17,15
s_lshr_b32 s64,s64,8
s_add_u32 s65,s65,s64
s_cmp_ge_u32 s65,256
s_cbranch_scc1 vok_350
s_branch vrt_349
vck_348:
v_cmp_gt_u32 vcc,v18,v17
s_cbranch_vccz vok_350
vrt_349:
s_sleep 48
s_sub_u32 s90,s90,1
s_cmp_gt_i32 s90,0
s_cbranch_scc1 vpoll_347
vok_350:
v_add_u32 v18,160768,v16
ds_write_b32 v18,v17
s_waitcnt lgkmcnt(0)
vot_351:
s_barrier
v_add_u32 v18,160768,v16
ds_read_b32 v17,v18
s_waitcnt lgkmcnt(0)
s_cmp_lg_u32 s56,2
s_cbranch_scc1 vfin_352
v_cmp_eq_u32 vcc,v17,v19
s_and_b32 s64,vcc_lo,0xffff
s_cmp_eq_u32 s64,65535
s_cbranch_scc1 vfin_352
s_mov_b32 s65,0
v_readlane_b32 s64,v17,1
s_lshr_b32 s64,s64,8
s_add_u32 s65,s65,s64
v_readlane_b32 s64,v17,3
s_lshr_b32 s64,s64,8
s_add_u32 s65,s65,s64
v_readlane_b32 s64,v17,5
s_lshr_b32 s64,s64,8
s_add_u32 s65,s65,s64
v_readlane_b32 s64,v17,7
s_lshr_b32 s64,s64,8
s_add_u32 s65,s65,s64
v_readlane_b32 s64,v17,9
s_lshr_b32 s64,s64,8
s_add_u32 s65,s65,s64
v_readlane_b32 s64,v17,11
s_lshr_b32 s64,s64,8
s_add_u32 s65,s65,s64
v_readlane_b32 s64,v17,13
s_lshr_b32 s64,s64,8
s_add_u32 s65,s65,s64
v_readlane_b32 s64,v17,15
s_lshr_b32 s64,s64,8
s_add_u32 s65,s65,s64
s_cmp_ge_u32 s65,256
s_cbranch_scc1 fl_fb
vfin_352:
s_and_b32 s56,s56,1
s_mov_b32 s67,0
s_barrier
v_lshlrev_b32 v0,4,v1
s_mov_b32 s60,0
s_lshl_b32 s70,s50,13
s_mov_b32 s55,0
v_mov_b32 v3,v0
s_mov_b32 s73,0xffff0000
s_lshl_b32 s64,s52,2
s_add_u32 s64,s64,s50
s_mul_i32 s61,s64,8192
s_add_u32 s61,s61,209747968
s_lshl_b32 s68,s64,8
s_add_u32 s68,s68,138549248
s_lshl_b32 s83,s53,2
s_add_u32 s83,s83,s50
s_mov_b32 s63,0
s_xor_b32 s64,s50,0
s_lshl_b32 s64,s64,13
v_add_u32 v8,s64,v0
v_mov_b32 v4,v8
s_xor_b32 s64,s50,1
s_lshl_b32 s64,s64,13
v_add_u32 v9,s64,v0
v_mov_b32 v5,v9
s_xor_b32 s64,s50,2
s_lshl_b32 s64,s64,13
v_add_u32 v10,s64,v0
v_mov_b32 v6,v10
s_xor_b32 s64,s50,3
s_lshl_b32 s64,s64,13
v_add_u32 v11,s64,v0
v_mov_b32 v7,v11
v_min_u32 v2,7,v1
v_lshlrev_b32 v2,7,v2
s_mul_i32 s68,s50,1024
s_add_u32 s68,s68,138559488
s_lshr_b32 s64,s50,1
s_add_u32 s64,s64,1
s_sub_u32 s65,0,s64
s_bitcmp1_b32 s50,0
s_cselect_b32 s64,s64,s65
s_add_u32 s64,s64,16
v_add_u32 v26,s64,v21
v_lshrrev_b32 v27,4,v26
v_and_b32 v26,15,v26
v_lshl_add_u32 v26,v22,4,v26
v_lshlrev_b32 v26,4,v26
v_lshl_add_u32 v3,v27,15,v26
s_sub_u32 s61,s61,32768
s_and_b32 s64,s50,1
s_add_u32 s74,s64,1
s_add_u32 s75,s64,2
s_add_u32 s76,s64,3
s_add_u32 s62,s61,4096
s_lshl_b32 s66,s83,10
s_lshr_b32 s65,s83,3
s_lshl_b32 s65,s65,8
s_and_b32 s64,s83,7
s_lshl_b32 s64,s64,2
s_add_u32 s69,s64,s65
s_add_u32 s69,s69,138550272
s_add_u32 s82,s66,205520896
s_add_u32 s66,s66,214958080
v_cmp_eq_u32 vcc,0,v1
s_nop 1
v_cndmask_b32 v26,2.0,0,vcc
s_add_u32 s71,s60,s74
s_cmp_eq_u32 s60,127
s_cselect_b32 s71,128,s71
s_add_u32 s53,s60,s75
s_cmp_eq_u32 s60,126
s_cselect_b32 s53,128,s53
plp_360:
buffer_load_dword v16,v2,s[20:23],s68 offen sc1
s_waitcnt vmcnt(0)
v_cmp_gt_u32 vcc,s71,v16
s_cbranch_vccz pok_361
s_sleep 4
s_sub_u32 s90,s90,1
s_cmp_gt_i32 s90,0
s_cbranch_scc1 plp_360
pok_361:
lag_357:
s_mov_b32 m0,s70
s_nop 0
buffer_load_dwordx4 v3,s[20:23],s61 offen offset:0 lds
buffer_load_dwordx4 v3,s[20:23],s61 offen offset:1024 lds
buffer_load_dwordx4 v3,s[20:23],s61 offen offset:2048 lds
buffer_load_dwordx4 v3,s[20:23],s61 offen offset:3072 lds
s_add_u32 m0,s70,4096
s_nop 0
buffer_load_dwordx4 v3,s[20:23],s62 offen offset:0 lds
buffer_load_dwordx4 v3,s[20:23],s62 offen offset:1024 lds
buffer_load_dwordx4 v3,s[20:23],s62 offen offset:2048 lds
buffer_load_dwordx4 v3,s[20:23],s62 offen offset:3072 lds
s_add_u32 s61,s61,32768
s_add_u32 s62,s62,32768
s_add_u32 s70,s70,32768
s_and_b32 s70,s70,0x1ffff
buffer_load_dword v23,off,s[20:23],s66
buffer_load_dword v23,off,s[20:23],s66
dec_358:
v_cmp_gt_u32 vcc,s53,v16
s_cbranch_vccnz BN_356
BR_355:
s_waitcnt vmcnt(9)
ds_read_b128 v[64:67],v4 offset:0
s_waitcnt vmcnt(8)
ds_read_b128 v[68:71],v4 offset:1024
s_waitcnt vmcnt(7)
ds_read_b128 v[72:75],v4 offset:2048
s_waitcnt vmcnt(6)
ds_read_b128 v[76:79],v4 offset:3072
s_waitcnt lgkmcnt(3)
v_mfma_f32_16x16x32_bf16 v[32:35],a[0:3],v[64:67],0
s_add_u32 s71,s60,s75
s_cmp_eq_u32 s60,126
s_cselect_b32 s71,128,s71
buffer_load_dwordx4 v[160:163],v0,s[20:23],s82 offen
v_mfma_f32_16x16x32_bf16 v[36:39],a[4:7],v[64:67],0
s_waitcnt lgkmcnt(2)
s_waitcnt vmcnt(6)
s_mov_b32 m0,s70
s_add_u32 s82,s82,32768
ds_read_b128 v[80:83],v4 offset:4096
v_mfma_f32_16x16x32_bf16 v[32:35],a[8:11],v[68:71],v[32:35]
s_add_u32 s53,s60,s76
s_cmp_eq_u32 s60,125
s_cselect_b32 s53,128,s53
buffer_load_dwordx4 v3,s[20:23],s61 offen offset:0 lds
v_mfma_f32_16x16x32_bf16 v[36:39],a[12:15],v[68:71],v[36:39]
s_waitcnt lgkmcnt(2)
s_waitcnt vmcnt(6)
ds_read_b128 v[84:87],v4 offset:5120
v_mfma_f32_16x16x32_bf16 v[32:35],a[16:19],v[72:75],v[32:35]
s_mov_b32 s57,s63
buffer_load_dwordx4 v3,s[20:23],s61 offen offset:1024 lds
v_mfma_f32_16x16x32_bf16 v[36:39],a[20:23],v[72:75],v[36:39]
s_waitcnt lgkmcnt(2)
s_waitcnt vmcnt(6)
ds_read_b128 v[88:91],v4 offset:6144
v_mfma_f32_16x16x32_bf16 v[32:35],a[24:27],v[76:79],v[32:35]
buffer_load_dwordx4 v3,s[20:23],s61 offen offset:2048 lds
v_mfma_f32_16x16x32_bf16 v[36:39],a[28:31],v[76:79],v[36:39]
s_waitcnt lgkmcnt(2)
s_waitcnt vmcnt(6)
ds_read_b128 v[92:95],v4 offset:7168
v_mfma_f32_16x16x32_bf16 v[32:35],a[32:35],v[80:83],v[32:35]
buffer_load_dwordx4 v3,s[20:23],s61 offen offset:3072 lds
v_mfma_f32_16x16x32_bf16 v[36:39],a[36:39],v[80:83],v[36:39]
s_waitcnt lgkmcnt(2)
s_barrier
s_add_u32 m0,s70,4096
ds_read_b128 v[96:99],v5 offset:0
v_mfma_f32_16x16x32_bf16 v[32:35],a[40:43],v[84:87],v[32:35]
ds_read_b128 v[100:103],v5 offset:1024
buffer_load_dwordx4 v3,s[20:23],s62 offen offset:0 lds
v_mfma_f32_16x16x32_bf16 v[36:39],a[44:47],v[84:87],v[36:39]
s_waitcnt lgkmcnt(3)
ds_read_b128 v[104:107],v5 offset:2048
buffer_load_dwordx4 v3,s[20:23],s62 offen offset:1024 lds
v_mfma_f32_16x16x32_bf16 v[32:35],a[48:51],v[88:91],v[32:35]
ds_read_b128 v[108:111],v5 offset:3072
v_mfma_f32_16x16x32_bf16 v[36:39],a[52:55],v[88:91],v[36:39]
s_waitcnt lgkmcnt(4)
ds_read_b128 v[112:115],v5 offset:4096
buffer_load_dwordx4 v3,s[20:23],s62 offen offset:2048 lds
v_mfma_f32_16x16x32_bf16 v[32:35],a[56:59],v[92:95],v[32:35]
ds_read_b128 v[116:119],v5 offset:5120
v_mfma_f32_16x16x32_bf16 v[36:39],a[60:63],v[92:95],v[36:39]
s_waitcnt lgkmcnt(5)
buffer_load_dwordx4 v3,s[20:23],s62 offen offset:3072 lds
v_mfma_f32_16x16x32_bf16 v[32:35],a[64:67],v[96:99],v[32:35]
ds_read_b128 v[120:123],v5 offset:6144
v_mfma_f32_16x16x32_bf16 v[36:39],a[68:71],v[96:99],v[36:39]
s_waitcnt lgkmcnt(5)
v_mfma_f32_16x16x32_bf16 v[32:35],a[72:75],v[100:103],v[32:35]
ds_read_b128 v[124:127],v5 offset:7168
v_mfma_f32_16x16x32_bf16 v[36:39],a[76:79],v[100:103],v[36:39]
s_waitcnt lgkmcnt(5)
v_mfma_f32_16x16x32_bf16 v[32:35],a[80:83],v[104:107],v[32:35]
ds_read_b128 v[64:67],v6 offset:0
v_mfma_f32_16x16x32_bf16 v[36:39],a[84:87],v[104:107],v[36:39]
s_waitcnt lgkmcnt(5)
v_mfma_f32_16x16x32_bf16 v[32:35],a[88:91],v[108:111],v[32:35]
ds_read_b128 v[68:71],v6 offset:1024
v_mfma_f32_16x16x32_bf16 v[36:39],a[92:95],v[108:111],v[36:39]
s_waitcnt lgkmcnt(5)
v_mfma_f32_16x16x32_bf16 v[32:35],a[96:99],v[112:115],v[32:35]
ds_read_b128 v[72:75],v6 offset:2048
buffer_load_dword v16,v2,s[20:23],s68 offen sc1
v_mfma_f32_16x16x32_bf16 v[36:39],a[100:103],v[112:115],v[36:39]
s_waitcnt lgkmcnt(5)
v_mfma_f32_16x16x32_bf16 v[32:35],a[104:107],v[116:119],v[32:35]
ds_read_b128 v[76:79],v6 offset:3072
v_mfma_f32_16x16x32_bf16 v[36:39],a[108:111],v[116:119],v[36:39]
s_waitcnt lgkmcnt(5)
v_mfma_f32_16x16x32_bf16 v[32:35],a[112:115],v[120:123],v[32:35]
ds_read_b128 v[80:83],v6 offset:4096
v_mfma_f32_16x16x32_bf16 v[36:39],a[116:119],v[120:123],v[36:39]
s_waitcnt lgkmcnt(5)
v_mfma_f32_16x16x32_bf16 v[32:35],a[120:123],v[124:127],v[32:35]
ds_read_b128 v[84:87],v6 offset:5120
v_mfma_f32_16x16x32_bf16 v[36:39],a[124:127],v[124:127],v[36:39]
s_waitcnt lgkmcnt(5)
v_mfma_f32_16x16x32_bf16 v[32:35],a[128:131],v[64:67],v[32:35]
ds_read_b128 v[88:91],v6 offset:6144
v_mfma_f32_16x16x32_bf16 v[36:39],a[132:135],v[64:67],v[36:39]
s_waitcnt lgkmcnt(5)
v_mfma_f32_16x16x32_bf16 v[32:35],a[136:139],v[68:71],v[32:35]
ds_read_b128 v[92:95],v6 offset:7168
v_mfma_f32_16x16x32_bf16 v[36:39],a[140:143],v[68:71],v[36:39]
s_waitcnt lgkmcnt(5)
v_mfma_f32_16x16x32_bf16 v[32:35],a[144:147],v[72:75],v[32:35]
ds_read_b128 v[96:99],v7 offset:0
v_mfma_f32_16x16x32_bf16 v[36:39],a[148:151],v[72:75],v[36:39]
s_waitcnt lgkmcnt(5)
s_waitcnt vmcnt(11)
v_mov_b32 v17,s57
buffer_store_dword v17,v26,s[20:23],s69 offen sc1
v_mfma_f32_16x16x32_bf16 v[32:35],a[152:155],v[76:79],v[32:35]
ds_read_b128 v[100:103],v7 offset:1024
v_mfma_f32_16x16x32_bf16 v[36:39],a[156:159],v[76:79],v[36:39]
s_waitcnt lgkmcnt(5)
v_mfma_f32_16x16x32_bf16 v[32:35],a[160:163],v[80:83],v[32:35]
ds_read_b128 v[104:107],v7 offset:2048
v_mfma_f32_16x16x32_bf16 v[36:39],a[164:167],v[80:83],v[36:39]
s_waitcnt lgkmcnt(5)
v_mfma_f32_16x16x32_bf16 v[32:35],a[168:171],v[84:87],v[32:35]
ds_read_b128 v[108:111],v7 offset:3072
v_mfma_f32_16x16x32_bf16 v[36:39],a[172:175],v[84:87],v[36:39]
s_waitcnt lgkmcnt(5)
v_mfma_f32_16x16x32_bf16 v[32:35],a[176:179],v[88:91],v[32:35]
ds_read_b128 v[112:115],v7 offset:4096
v_mfma_f32_16x16x32_bf16 v[36:39],a[180:183],v[88:91],v[36:39]
s_waitcnt lgkmcnt(5)
v_mfma_f32_16x16x32_bf16 v[32:35],a[184:187],v[92:95],v[32:35]
ds_read_b128 v[116:119],v7 offset:5120
v_mfma_f32_16x16x32_bf16 v[36:39],a[188:191],v[92:95],v[36:39]
s_waitcnt lgkmcnt(5)
v_mfma_f32_16x16x32_bf16 v[32:35],a[192:195],v[96:99],v[32:35]
ds_read_b128 v[120:123],v7 offset:6144
v_mfma_f32_16x16x32_bf16 v[36:39],a[196:199],v[96:99],v[36:39]
s_waitcnt lgkmcnt(5)
v_mfma_f32_16x16x32_bf16 v[32:35],a[200:203],v[100:103],v[32:35]
s_waitcnt vmcnt(10)
ds_read_b128 v[124:127],v7 offset:7168
v_lshlrev_b32 v168,16,v160
v_mfma_f32_16x16x32_bf16 v[36:39],a[204:207],v[100:103],v[36:39]
s_waitcnt lgkmcnt(5)
v_and_b32 v169,s73,v160
v_lshlrev_b32 v170,16,v161
v_mfma_f32_16x16x32_bf16 v[32:35],a[208:211],v[104:107],v[32:35]
s_add_u32 s61,s61,32768
v_and_b32 v171,s73,v161
v_lshlrev_b32 v172,16,v162
v_mfma_f32_16x16x32_bf16 v[36:39],a[212:215],v[104:107],v[36:39]
s_waitcnt lgkmcnt(4)
v_and_b32 v173,s73,v162
v_lshlrev_b32 v174,16,v163
v_mfma_f32_16x16x32_bf16 v[32:35],a[216:219],v[108:111],v[32:35]
s_add_u32 s62,s62,32768
s_add_u32 s70,s70,32768
v_and_b32 v175,s73,v163
v_mfma_f32_16x16x32_bf16 v[36:39],a[220:223],v[108:111],v[36:39]
s_waitcnt lgkmcnt(3)
s_and_b32 s70,s70,0x1ffff
s_add_u32 s55,s55,32768
v_mfma_f32_16x16x32_bf16 v[32:35],a[224:227],v[112:115],v[32:35]
s_and_b32 s55,s55,0x1ffff
v_add_u32 v4,s55,v8
v_add_u32 v5,s55,v9
v_mfma_f32_16x16x32_bf16 v[36:39],a[228:231],v[112:115],v[36:39]
s_waitcnt lgkmcnt(2)
v_add_u32 v6,s55,v10
v_add_u32 v7,s55,v11
v_mfma_f32_16x16x32_bf16 v[32:35],a[232:235],v[116:119],v[32:35]
s_waitcnt vmcnt(9)
ds_read_b128 v[64:67],v4 offset:0
v_mfma_f32_16x16x32_bf16 v[36:39],a[236:239],v[116:119],v[36:39]
s_waitcnt lgkmcnt(2)
s_waitcnt vmcnt(8)
ds_read_b128 v[68:71],v4 offset:1024
v_mfma_f32_16x16x32_bf16 v[32:35],a[240:243],v[120:123],v[32:35]
s_waitcnt vmcnt(7)
ds_read_b128 v[72:75],v4 offset:2048
v_mfma_f32_16x16x32_bf16 v[36:39],a[244:247],v[120:123],v[36:39]
s_waitcnt lgkmcnt(3)
v_mfma_f32_16x16x32_bf16 v[40:43],a[248:251],v[124:127],v[32:35]
v_mfma_f32_16x16x32_bf16 v[44:47],a[252:255],v[124:127],v[36:39]
s_waitcnt vmcnt(1)
v_cmp_gt_u32 vcc,s53,v16
s_add_u32 s60,s60,1
s_cbranch_vccnz WN_354
.p2align 6
WR_353:
s_waitcnt lgkmcnt(2)
v_mfma_f32_16x16x32_bf16 v[32:35],a[0:3],v[64:67],0
s_waitcnt vmcnt(6)
s_mov_b32 m0,s70
ds_read_b128 v[76:79],v4 offset:3072
v_mfma_f32_16x16x32_bf16 v[36:39],a[4:7],v[64:67],0
s_waitcnt lgkmcnt(2)
s_add_u32 s71,s60,s75
s_cmp_eq_u32 s60,126
s_cselect_b32 s71,128,s71
buffer_load_dwordx4 v3,s[20:23],s61 offen offset:0 lds
v_mfma_f32_16x16x32_bf16 v[32:35],a[8:11],v[68:71],v[32:35]
s_waitcnt vmcnt(6)
ds_read_b128 v[80:83],v4 offset:4096
buffer_load_dwordx4 v[160:163],v0,s[20:23],s82 offen
v_add_f32 v40,v40,v168
v_mfma_f32_16x16x32_bf16 v[36:39],a[12:15],v[68:71],v[36:39]
s_waitcnt lgkmcnt(2)
s_add_u32 s82,s82,32768
buffer_load_dwordx4 v3,s[20:23],s61 offen offset:1024 lds
v_add_f32 v41,v41,v169
v_mfma_f32_16x16x32_bf16 v[32:35],a[16:19],v[72:75],v[32:35]
s_waitcnt vmcnt(7)
s_add_u32 s53,s60,s76
s_cmp_eq_u32 s60,125
s_cselect_b32 s53,128,s53
ds_read_b128 v[84:87],v4 offset:5120
v_mfma_f32_16x16x32_bf16 v[36:39],a[20:23],v[72:75],v[36:39]
s_waitcnt lgkmcnt(2)
s_mov_b32 s57,s63
buffer_load_dwordx4 v3,s[20:23],s61 offen offset:2048 lds
v_add_f32 v42,v42,v170
v_mfma_f32_16x16x32_bf16 v[32:35],a[24:27],v[76:79],v[32:35]
s_waitcnt vmcnt(7)
ds_read_b128 v[88:91],v4 offset:6144
v_add_f32 v43,v43,v171
v_add_f32 v44,v44,v172
v_mfma_f32_16x16x32_bf16 v[36:39],a[28:31],v[76:79],v[36:39]
s_waitcnt lgkmcnt(2)
buffer_load_dwordx4 v3,s[20:23],s61 offen offset:3072 lds
v_add_f32 v45,v45,v173
v_add_f32 v46,v46,v174
v_mfma_f32_16x16x32_bf16 v[32:35],a[32:35],v[80:83],v[32:35]
s_waitcnt vmcnt(7)
ds_read_b128 v[92:95],v4 offset:7168
v_add_f32 v47,v47,v175
v_cvt_pk_bf16_f32 v176,v40,v41
v_mfma_f32_16x16x32_bf16 v[36:39],a[36:39],v[80:83],v[36:39]
s_waitcnt lgkmcnt(2)
s_barrier
s_add_u32 m0,s70,4096
ds_read_b128 v[96:99],v5 offset:0
v_mfma_f32_16x16x32_bf16 v[32:35],a[40:43],v[84:87],v[32:35]
ds_read_b128 v[100:103],v5 offset:1024
buffer_load_dwordx4 v3,s[20:23],s62 offen offset:0 lds
v_cvt_pk_bf16_f32 v177,v42,v43
v_mfma_f32_16x16x32_bf16 v[36:39],a[44:47],v[84:87],v[36:39]
s_waitcnt lgkmcnt(3)
ds_read_b128 v[104:107],v5 offset:2048
buffer_load_dwordx4 v3,s[20:23],s62 offen offset:1024 lds
v_cvt_pk_bf16_f32 v178,v44,v45
v_mfma_f32_16x16x32_bf16 v[32:35],a[48:51],v[88:91],v[32:35]
ds_read_b128 v[108:111],v5 offset:3072
v_cvt_pk_bf16_f32 v179,v46,v47
v_mfma_f32_16x16x32_bf16 v[36:39],a[52:55],v[88:91],v[36:39]
s_waitcnt lgkmcnt(4)
ds_read_b128 v[112:115],v5 offset:4096
buffer_load_dwordx4 v3,s[20:23],s62 offen offset:2048 lds
v_mfma_f32_16x16x32_bf16 v[32:35],a[56:59],v[92:95],v[32:35]
ds_read_b128 v[116:119],v5 offset:5120
v_mfma_f32_16x16x32_bf16 v[36:39],a[60:63],v[92:95],v[36:39]
s_waitcnt lgkmcnt(5)
buffer_load_dwordx4 v3,s[20:23],s62 offen offset:3072 lds
v_mfma_f32_16x16x32_bf16 v[32:35],a[64:67],v[96:99],v[32:35]
ds_read_b128 v[120:123],v5 offset:6144
v_mfma_f32_16x16x32_bf16 v[36:39],a[68:71],v[96:99],v[36:39]
s_waitcnt lgkmcnt(5)
buffer_load_dword v16,v2,s[20:23],s68 offen sc1
v_mfma_f32_16x16x32_bf16 v[32:35],a[72:75],v[100:103],v[32:35]
ds_read_b128 v[124:127],v5 offset:7168
v_mfma_f32_16x16x32_bf16 v[36:39],a[76:79],v[100:103],v[36:39]
s_waitcnt lgkmcnt(5)
s_waitcnt vmcnt(10)
v_mov_b32 v17,s57
buffer_store_dword v17,v26,s[20:23],s69 offen sc1
v_mfma_f32_16x16x32_bf16 v[32:35],a[80:83],v[104:107],v[32:35]
ds_read_b128 v[64:67],v6 offset:0
v_mfma_f32_16x16x32_bf16 v[36:39],a[84:87],v[104:107],v[36:39]
s_waitcnt lgkmcnt(5)
buffer_store_dwordx4 v[176:179],v0,s[20:23],s66 offen sc1
v_mfma_f32_16x16x32_bf16 v[32:35],a[88:91],v[108:111],v[32:35]
s_add_u32 s66,s66,32768
s_add_u32 s63,s63,1
ds_read_b128 v[68:71],v6 offset:1024
v_mfma_f32_16x16x32_bf16 v[36:39],a[92:95],v[108:111],v[36:39]
s_waitcnt lgkmcnt(5)
v_mfma_f32_16x16x32_bf16 v[32:35],a[96:99],v[112:115],v[32:35]
ds_read_b128 v[72:75],v6 offset:2048
v_mfma_f32_16x16x32_bf16 v[36:39],a[100:103],v[112:115],v[36:39]
s_waitcnt lgkmcnt(5)
v_mfma_f32_16x16x32_bf16 v[32:35],a[104:107],v[116:119],v[32:35]
ds_read_b128 v[76:79],v6 offset:3072
v_mfma_f32_16x16x32_bf16 v[36:39],a[108:111],v[116:119],v[36:39]
s_waitcnt lgkmcnt(5)
v_mfma_f32_16x16x32_bf16 v[32:35],a[112:115],v[120:123],v[32:35]
ds_read_b128 v[80:83],v6 offset:4096
v_mfma_f32_16x16x32_bf16 v[36:39],a[116:119],v[120:123],v[36:39]
s_waitcnt lgkmcnt(5)
v_mfma_f32_16x16x32_bf16 v[32:35],a[120:123],v[124:127],v[32:35]
ds_read_b128 v[84:87],v6 offset:5120
v_mfma_f32_16x16x32_bf16 v[36:39],a[124:127],v[124:127],v[36:39]
s_waitcnt lgkmcnt(5)
v_mfma_f32_16x16x32_bf16 v[32:35],a[128:131],v[64:67],v[32:35]
ds_read_b128 v[88:91],v6 offset:6144
v_mfma_f32_16x16x32_bf16 v[36:39],a[132:135],v[64:67],v[36:39]
s_waitcnt lgkmcnt(5)
v_mfma_f32_16x16x32_bf16 v[32:35],a[136:139],v[68:71],v[32:35]
ds_read_b128 v[92:95],v6 offset:7168
v_mfma_f32_16x16x32_bf16 v[36:39],a[140:143],v[68:71],v[36:39]
s_waitcnt lgkmcnt(5)
v_mfma_f32_16x16x32_bf16 v[32:35],a[144:147],v[72:75],v[32:35]
ds_read_b128 v[96:99],v7 offset:0
v_mfma_f32_16x16x32_bf16 v[36:39],a[148:151],v[72:75],v[36:39]
s_waitcnt lgkmcnt(5)
v_mfma_f32_16x16x32_bf16 v[32:35],a[152:155],v[76:79],v[32:35]
ds_read_b128 v[100:103],v7 offset:1024
v_mfma_f32_16x16x32_bf16 v[36:39],a[156:159],v[76:79],v[36:39]
s_waitcnt lgkmcnt(5)
v_mfma_f32_16x16x32_bf16 v[32:35],a[160:163],v[80:83],v[32:35]
ds_read_b128 v[104:107],v7 offset:2048
v_mfma_f32_16x16x32_bf16 v[36:39],a[164:167],v[80:83],v[36:39]
s_waitcnt lgkmcnt(5)
v_mfma_f32_16x16x32_bf16 v[32:35],a[168:171],v[84:87],v[32:35]
ds_read_b128 v[108:111],v7 offset:3072
v_mfma_f32_16x16x32_bf16 v[36:39],a[172:175],v[84:87],v[36:39]
s_waitcnt lgkmcnt(5)
v_mfma_f32_16x16x32_bf16 v[32:35],a[176:179],v[88:91],v[32:35]
ds_read_b128 v[112:115],v7 offset:4096
v_mfma_f32_16x16x32_bf16 v[36:39],a[180:183],v[88:91],v[36:39]
s_waitcnt lgkmcnt(5)
v_mfma_f32_16x16x32_bf16 v[32:35],a[184:187],v[92:95],v[32:35]
ds_read_b128 v[116:119],v7 offset:5120
v_mfma_f32_16x16x32_bf16 v[36:39],a[188:191],v[92:95],v[36:39]
s_waitcnt lgkmcnt(5)
v_mfma_f32_16x16x32_bf16 v[32:35],a[192:195],v[96:99],v[32:35]
ds_read_b128 v[120:123],v7 offset:6144
v_mfma_f32_16x16x32_bf16 v[36:39],a[196:199],v[96:99],v[36:39]
s_waitcnt lgkmcnt(5)
v_mfma_f32_16x16x32_bf16 v[32:35],a[200:203],v[100:103],v[32:35]
s_waitcnt vmcnt(10)
ds_read_b128 v[124:127],v7 offset:7168
v_lshlrev_b32 v168,16,v160
v_mfma_f32_16x16x32_bf16 v[36:39],a[204:207],v[100:103],v[36:39]
s_waitcnt lgkmcnt(5)
v_and_b32 v169,s73,v160
v_lshlrev_b32 v170,16,v161
v_mfma_f32_16x16x32_bf16 v[32:35],a[208:211],v[104:107],v[32:35]
s_add_u32 s61,s61,32768
v_and_b32 v171,s73,v161
v_lshlrev_b32 v172,16,v162
v_mfma_f32_16x16x32_bf16 v[36:39],a[212:215],v[104:107],v[36:39]
s_waitcnt lgkmcnt(4)
v_and_b32 v173,s73,v162
v_lshlrev_b32 v174,16,v163
v_mfma_f32_16x16x32_bf16 v[32:35],a[216:219],v[108:111],v[32:35]
s_add_u32 s62,s62,32768
s_add_u32 s70,s70,32768
v_and_b32 v175,s73,v163
v_mfma_f32_16x16x32_bf16 v[36:39],a[220:223],v[108:111],v[36:39]
s_waitcnt lgkmcnt(3)
s_and_b32 s70,s70,0x1ffff
s_add_u32 s55,s55,32768
v_mfma_f32_16x16x32_bf16 v[32:35],a[224:227],v[112:115],v[32:35]
s_and_b32 s55,s55,0x1ffff
v_add_u32 v4,s55,v8
v_add_u32 v5,s55,v9
v_mfma_f32_16x16x32_bf16 v[36:39],a[228:231],v[112:115],v[36:39]
s_waitcnt lgkmcnt(2)
v_add_u32 v6,s55,v10
v_add_u32 v7,s55,v11
v_mfma_f32_16x16x32_bf16 v[32:35],a[232:235],v[116:119],v[32:35]
ds_read_b128 v[64:67],v4 offset:0
v_mfma_f32_16x16x32_bf16 v[36:39],a[236:239],v[116:119],v[36:39]
s_waitcnt lgkmcnt(2)
s_waitcnt vmcnt(9)
ds_read_b128 v[68:71],v4 offset:1024
v_mfma_f32_16x16x32_bf16 v[32:35],a[240:243],v[120:123],v[32:35]
s_waitcnt vmcnt(8)
ds_read_b128 v[72:75],v4 offset:2048
v_mfma_f32_16x16x32_bf16 v[36:39],a[244:247],v[120:123],v[36:39]
s_waitcnt lgkmcnt(3)
v_mfma_f32_16x16x32_bf16 v[40:43],a[248:251],v[124:127],v[32:35]
v_mfma_f32_16x16x32_bf16 v[44:47],a[252:255],v[124:127],v[36:39]
s_waitcnt vmcnt(2)
v_cmp_gt_u32 vcc,s53,v16
s_add_u32 s60,s60,1
s_cbranch_vccz WR_353
WN_354:
s_waitcnt lgkmcnt(2)
v_mfma_f32_16x16x32_bf16 v[32:35],a[0:3],v[64:67],0
s_waitcnt vmcnt(6)
ds_read_b128 v[76:79],v4 offset:3072
buffer_load_dwordx4 v[160:163],v0,s[20:23],s82 offen
v_mfma_f32_16x16x32_bf16 v[36:39],a[4:7],v[64:67],0
s_waitcnt lgkmcnt(2)
s_add_u32 s82,s82,32768
v_mfma_f32_16x16x32_bf16 v[32:35],a[8:11],v[68:71],v[32:35]
s_waitcnt vmcnt(6)
ds_read_b128 v[80:83],v4 offset:4096
v_add_f32 v40,v40,v168
v_add_f32 v41,v41,v169
v_mfma_f32_16x16x32_bf16 v[36:39],a[12:15],v[68:71],v[36:39]
s_waitcnt lgkmcnt(2)
s_add_u32 s71,s60,s75
s_cmp_eq_u32 s60,126
s_cselect_b32 s71,128,s71
v_mfma_f32_16x16x32_bf16 v[32:35],a[16:19],v[72:75],v[32:35]
s_waitcnt vmcnt(5)
ds_read_b128 v[84:87],v4 offset:5120
v_add_f32 v42,v42,v170
v_add_f32 v43,v43,v171
v_mfma_f32_16x16x32_bf16 v[36:39],a[20:23],v[72:75],v[36:39]
s_waitcnt lgkmcnt(2)
s_add_u32 s53,s60,s76
s_cmp_eq_u32 s60,125
s_cselect_b32 s53,128,s53
v_mfma_f32_16x16x32_bf16 v[32:35],a[24:27],v[76:79],v[32:35]
s_waitcnt vmcnt(4)
s_mov_b32 s57,s63
ds_read_b128 v[88:91],v4 offset:6144
v_add_f32 v44,v44,v172
v_mfma_f32_16x16x32_bf16 v[36:39],a[28:31],v[76:79],v[36:39]
s_waitcnt lgkmcnt(2)
v_add_f32 v45,v45,v173
v_add_f32 v46,v46,v174
v_mfma_f32_16x16x32_bf16 v[32:35],a[32:35],v[80:83],v[32:35]
s_waitcnt vmcnt(3)
ds_read_b128 v[92:95],v4 offset:7168
v_add_f32 v47,v47,v175
v_mfma_f32_16x16x32_bf16 v[36:39],a[36:39],v[80:83],v[36:39]
s_waitcnt lgkmcnt(2)
s_barrier
ds_read_b128 v[96:99],v5 offset:0
v_mfma_f32_16x16x32_bf16 v[32:35],a[40:43],v[84:87],v[32:35]
ds_read_b128 v[100:103],v5 offset:1024
v_cvt_pk_bf16_f32 v176,v40,v41
v_mfma_f32_16x16x32_bf16 v[36:39],a[44:47],v[84:87],v[36:39]
s_waitcnt lgkmcnt(3)
ds_read_b128 v[104:107],v5 offset:2048
v_cvt_pk_bf16_f32 v177,v42,v43
v_mfma_f32_16x16x32_bf16 v[32:35],a[48:51],v[88:91],v[32:35]
ds_read_b128 v[108:111],v5 offset:3072
v_cvt_pk_bf16_f32 v178,v44,v45
v_mfma_f32_16x16x32_bf16 v[36:39],a[52:55],v[88:91],v[36:39]
s_waitcnt lgkmcnt(4)
ds_read_b128 v[112:115],v5 offset:4096
v_cvt_pk_bf16_f32 v179,v46,v47
v_mfma_f32_16x16x32_bf16 v[32:35],a[56:59],v[92:95],v[32:35]
ds_read_b128 v[116:119],v5 offset:5120
v_mfma_f32_16x16x32_bf16 v[36:39],a[60:63],v[92:95],v[36:39]
s_waitcnt lgkmcnt(5)
v_mfma_f32_16x16x32_bf16 v[32:35],a[64:67],v[96:99],v[32:35]
ds_read_b128 v[120:123],v5 offset:6144
v_mfma_f32_16x16x32_bf16 v[36:39],a[68:71],v[96:99],v[36:39]
s_waitcnt lgkmcnt(5)
buffer_load_dword v16,v2,s[20:23],s68 offen sc1
v_mfma_f32_16x16x32_bf16 v[32:35],a[72:75],v[100:103],v[32:35]
ds_read_b128 v[124:127],v5 offset:7168
v_mfma_f32_16x16x32_bf16 v[36:39],a[76:79],v[100:103],v[36:39]
s_waitcnt lgkmcnt(5)
s_waitcnt vmcnt(2)
v_mov_b32 v17,s57
buffer_store_dword v17,v26,s[20:23],s69 offen sc1
v_mfma_f32_16x16x32_bf16 v[32:35],a[80:83],v[104:107],v[32:35]
ds_read_b128 v[64:67],v6 offset:0
v_mfma_f32_16x16x32_bf16 v[36:39],a[84:87],v[104:107],v[36:39]
s_waitcnt lgkmcnt(5)
buffer_store_dwordx4 v[176:179],v0,s[20:23],s66 offen sc1
v_mfma_f32_16x16x32_bf16 v[32:35],a[88:91],v[108:111],v[32:35]
s_add_u32 s66,s66,32768
s_add_u32 s63,s63,1
ds_read_b128 v[68:71],v6 offset:1024
v_mfma_f32_16x16x32_bf16 v[36:39],a[92:95],v[108:111],v[36:39]
s_waitcnt lgkmcnt(5)
v_mfma_f32_16x16x32_bf16 v[32:35],a[96:99],v[112:115],v[32:35]
ds_read_b128 v[72:75],v6 offset:2048
v_mfma_f32_16x16x32_bf16 v[36:39],a[100:103],v[112:115],v[36:39]
s_waitcnt lgkmcnt(5)
v_mfma_f32_16x16x32_bf16 v[32:35],a[104:107],v[116:119],v[32:35]
ds_read_b128 v[76:79],v6 offset:3072
v_mfma_f32_16x16x32_bf16 v[36:39],a[108:111],v[116:119],v[36:39]
s_waitcnt lgkmcnt(5)
v_mfma_f32_16x16x32_bf16 v[32:35],a[112:115],v[120:123],v[32:35]
ds_read_b128 v[80:83],v6 offset:4096
v_mfma_f32_16x16x32_bf16 v[36:39],a[116:119],v[120:123],v[36:39]
s_waitcnt lgkmcnt(5)
v_mfma_f32_16x16x32_bf16 v[32:35],a[120:123],v[124:127],v[32:35]
ds_read_b128 v[84:87],v6 offset:5120
v_mfma_f32_16x16x32_bf16 v[36:39],a[124:127],v[124:127],v[36:39]
s_waitcnt lgkmcnt(5)
v_mfma_f32_16x16x32_bf16 v[32:35],a[128:131],v[64:67],v[32:35]
ds_read_b128 v[88:91],v6 offset:6144
v_mfma_f32_16x16x32_bf16 v[36:39],a[132:135],v[64:67],v[36:39]
s_waitcnt lgkmcnt(5)
v_mfma_f32_16x16x32_bf16 v[32:35],a[136:139],v[68:71],v[32:35]
ds_read_b128 v[92:95],v6 offset:7168
v_mfma_f32_16x16x32_bf16 v[36:39],a[140:143],v[68:71],v[36:39]
s_waitcnt lgkmcnt(5)
v_mfma_f32_16x16x32_bf16 v[32:35],a[144:147],v[72:75],v[32:35]
ds_read_b128 v[96:99],v7 offset:0
v_mfma_f32_16x16x32_bf16 v[36:39],a[148:151],v[72:75],v[36:39]
s_waitcnt lgkmcnt(5)
v_mfma_f32_16x16x32_bf16 v[32:35],a[152:155],v[76:79],v[32:35]
ds_read_b128 v[100:103],v7 offset:1024
v_mfma_f32_16x16x32_bf16 v[36:39],a[156:159],v[76:79],v[36:39]
s_waitcnt lgkmcnt(5)
v_mfma_f32_16x16x32_bf16 v[32:35],a[160:163],v[80:83],v[32:35]
ds_read_b128 v[104:107],v7 offset:2048
v_mfma_f32_16x16x32_bf16 v[36:39],a[164:167],v[80:83],v[36:39]
s_waitcnt lgkmcnt(5)
v_mfma_f32_16x16x32_bf16 v[32:35],a[168:171],v[84:87],v[32:35]
ds_read_b128 v[108:111],v7 offset:3072
v_mfma_f32_16x16x32_bf16 v[36:39],a[172:175],v[84:87],v[36:39]
s_waitcnt lgkmcnt(5)
v_mfma_f32_16x16x32_bf16 v[32:35],a[176:179],v[88:91],v[32:35]
ds_read_b128 v[112:115],v7 offset:4096
v_mfma_f32_16x16x32_bf16 v[36:39],a[180:183],v[88:91],v[36:39]
s_waitcnt lgkmcnt(5)
v_mfma_f32_16x16x32_bf16 v[32:35],a[184:187],v[92:95],v[32:35]
ds_read_b128 v[116:119],v7 offset:5120
v_mfma_f32_16x16x32_bf16 v[36:39],a[188:191],v[92:95],v[36:39]
s_waitcnt lgkmcnt(5)
v_mfma_f32_16x16x32_bf16 v[32:35],a[192:195],v[96:99],v[32:35]
ds_read_b128 v[120:123],v7 offset:6144
v_mfma_f32_16x16x32_bf16 v[36:39],a[196:199],v[96:99],v[36:39]
s_waitcnt lgkmcnt(5)
v_mfma_f32_16x16x32_bf16 v[32:35],a[200:203],v[100:103],v[32:35]
s_waitcnt vmcnt(3)
ds_read_b128 v[124:127],v7 offset:7168
v_lshlrev_b32 v168,16,v160
v_mfma_f32_16x16x32_bf16 v[36:39],a[204:207],v[100:103],v[36:39]
s_waitcnt lgkmcnt(5)
v_and_b32 v169,s73,v160
v_lshlrev_b32 v170,16,v161
v_mfma_f32_16x16x32_bf16 v[32:35],a[208:211],v[104:107],v[32:35]
s_add_u32 s55,s55,32768
v_and_b32 v171,s73,v161
v_lshlrev_b32 v172,16,v162
v_mfma_f32_16x16x32_bf16 v[36:39],a[212:215],v[104:107],v[36:39]
s_waitcnt lgkmcnt(4)
v_and_b32 v173,s73,v162
v_lshlrev_b32 v174,16,v163
v_mfma_f32_16x16x32_bf16 v[32:35],a[216:219],v[108:111],v[32:35]
s_and_b32 s55,s55,0x1ffff
v_and_b32 v175,s73,v163
v_add_u32 v4,s55,v8
v_mfma_f32_16x16x32_bf16 v[36:39],a[220:223],v[108:111],v[36:39]
s_waitcnt lgkmcnt(3)
v_add_u32 v5,s55,v9
v_add_u32 v6,s55,v10
v_mfma_f32_16x16x32_bf16 v[32:35],a[224:227],v[112:115],v[32:35]
v_add_u32 v7,s55,v11
v_mfma_f32_16x16x32_bf16 v[36:39],a[228:231],v[112:115],v[36:39]
s_waitcnt lgkmcnt(2)
v_mfma_f32_16x16x32_bf16 v[32:35],a[232:235],v[116:119],v[32:35]
v_mfma_f32_16x16x32_bf16 v[36:39],a[236:239],v[116:119],v[36:39]
s_waitcnt lgkmcnt(1)
v_mfma_f32_16x16x32_bf16 v[32:35],a[240:243],v[120:123],v[32:35]
v_mfma_f32_16x16x32_bf16 v[36:39],a[244:247],v[120:123],v[36:39]
s_waitcnt lgkmcnt(0)
v_mfma_f32_16x16x32_bf16 v[40:43],a[248:251],v[124:127],v[32:35]
v_mfma_f32_16x16x32_bf16 v[44:47],a[252:255],v[124:127],v[36:39]
s_waitcnt vmcnt(2)
v_cmp_gt_u32 vcc,s71,v16
s_add_u32 s60,s60,1
s_branch endN_362
BN_356:
s_waitcnt vmcnt(9)
ds_read_b128 v[64:67],v4 offset:0
s_waitcnt vmcnt(8)
ds_read_b128 v[68:71],v4 offset:1024
s_waitcnt vmcnt(7)
ds_read_b128 v[72:75],v4 offset:2048
s_waitcnt vmcnt(6)
ds_read_b128 v[76:79],v4 offset:3072
s_waitcnt lgkmcnt(3)
v_mfma_f32_16x16x32_bf16 v[32:35],a[0:3],v[64:67],0
buffer_load_dwordx4 v[160:163],v0,s[20:23],s82 offen
v_mfma_f32_16x16x32_bf16 v[36:39],a[4:7],v[64:67],0
s_waitcnt lgkmcnt(2)
s_waitcnt vmcnt(6)
s_add_u32 s82,s82,32768
ds_read_b128 v[80:83],v4 offset:4096
v_mfma_f32_16x16x32_bf16 v[32:35],a[8:11],v[68:71],v[32:35]
s_add_u32 s71,s60,s75
s_cmp_eq_u32 s60,126
s_cselect_b32 s71,128,s71
v_mfma_f32_16x16x32_bf16 v[36:39],a[12:15],v[68:71],v[36:39]
s_waitcnt lgkmcnt(2)
s_waitcnt vmcnt(5)
ds_read_b128 v[84:87],v4 offset:5120
v_mfma_f32_16x16x32_bf16 v[32:35],a[16:19],v[72:75],v[32:35]
s_add_u32 s53,s60,s76
s_cmp_eq_u32 s60,125
s_cselect_b32 s53,128,s53
v_mfma_f32_16x16x32_bf16 v[36:39],a[20:23],v[72:75],v[36:39]
s_waitcnt lgkmcnt(2)
s_waitcnt vmcnt(4)
ds_read_b128 v[88:91],v4 offset:6144
v_mfma_f32_16x16x32_bf16 v[32:35],a[24:27],v[76:79],v[32:35]
s_mov_b32 s57,s63
v_mfma_f32_16x16x32_bf16 v[36:39],a[28:31],v[76:79],v[36:39]
s_waitcnt lgkmcnt(2)
s_waitcnt vmcnt(3)
ds_read_b128 v[92:95],v4 offset:7168
v_mfma_f32_16x16x32_bf16 v[32:35],a[32:35],v[80:83],v[32:35]
v_mfma_f32_16x16x32_bf16 v[36:39],a[36:39],v[80:83],v[36:39]
s_waitcnt lgkmcnt(2)
s_barrier
ds_read_b128 v[96:99],v5 offset:0
v_mfma_f32_16x16x32_bf16 v[32:35],a[40:43],v[84:87],v[32:35]
ds_read_b128 v[100:103],v5 offset:1024
v_mfma_f32_16x16x32_bf16 v[36:39],a[44:47],v[84:87],v[36:39]
s_waitcnt lgkmcnt(3)
ds_read_b128 v[104:107],v5 offset:2048
v_mfma_f32_16x16x32_bf16 v[32:35],a[48:51],v[88:91],v[32:35]
ds_read_b128 v[108:111],v5 offset:3072
v_mfma_f32_16x16x32_bf16 v[36:39],a[52:55],v[88:91],v[36:39]
s_waitcnt lgkmcnt(4)
ds_read_b128 v[112:115],v5 offset:4096
v_mfma_f32_16x16x32_bf16 v[32:35],a[56:59],v[92:95],v[32:35]
ds_read_b128 v[116:119],v5 offset:5120
v_mfma_f32_16x16x32_bf16 v[36:39],a[60:63],v[92:95],v[36:39]
s_waitcnt lgkmcnt(5)
v_mfma_f32_16x16x32_bf16 v[32:35],a[64:67],v[96:99],v[32:35]
ds_read_b128 v[120:123],v5 offset:6144
v_mfma_f32_16x16x32_bf16 v[36:39],a[68:71],v[96:99],v[36:39]
s_waitcnt lgkmcnt(5)
v_mfma_f32_16x16x32_bf16 v[32:35],a[72:75],v[100:103],v[32:35]
ds_read_b128 v[124:127],v5 offset:7168
v_mfma_f32_16x16x32_bf16 v[36:39],a[76:79],v[100:103],v[36:39]
s_waitcnt lgkmcnt(5)
v_mfma_f32_16x16x32_bf16 v[32:35],a[80:83],v[104:107],v[32:35]
ds_read_b128 v[64:67],v6 offset:0
v_mfma_f32_16x16x32_bf16 v[36:39],a[84:87],v[104:107],v[36:39]
s_waitcnt lgkmcnt(5)
v_mfma_f32_16x16x32_bf16 v[32:35],a[88:91],v[108:111],v[32:35]
ds_read_b128 v[68:71],v6 offset:1024
v_mfma_f32_16x16x32_bf16 v[36:39],a[92:95],v[108:111],v[36:39]
s_waitcnt lgkmcnt(5)
v_mfma_f32_16x16x32_bf16 v[32:35],a[96:99],v[112:115],v[32:35]
ds_read_b128 v[72:75],v6 offset:2048
v_mfma_f32_16x16x32_bf16 v[36:39],a[100:103],v[112:115],v[36:39]
s_waitcnt lgkmcnt(5)
v_mfma_f32_16x16x32_bf16 v[32:35],a[104:107],v[116:119],v[32:35]
ds_read_b128 v[76:79],v6 offset:3072
v_mfma_f32_16x16x32_bf16 v[36:39],a[108:111],v[116:119],v[36:39]
s_waitcnt lgkmcnt(5)
v_mfma_f32_16x16x32_bf16 v[32:35],a[112:115],v[120:123],v[32:35]
ds_read_b128 v[80:83],v6 offset:4096
v_mfma_f32_16x16x32_bf16 v[36:39],a[116:119],v[120:123],v[36:39]
s_waitcnt lgkmcnt(5)
v_mfma_f32_16x16x32_bf16 v[32:35],a[120:123],v[124:127],v[32:35]
ds_read_b128 v[84:87],v6 offset:5120
v_mfma_f32_16x16x32_bf16 v[36:39],a[124:127],v[124:127],v[36:39]
s_waitcnt lgkmcnt(5)
v_mfma_f32_16x16x32_bf16 v[32:35],a[128:131],v[64:67],v[32:35]
ds_read_b128 v[88:91],v6 offset:6144
v_mfma_f32_16x16x32_bf16 v[36:39],a[132:135],v[64:67],v[36:39]
s_waitcnt lgkmcnt(5)
v_mfma_f32_16x16x32_bf16 v[32:35],a[136:139],v[68:71],v[32:35]
ds_read_b128 v[92:95],v6 offset:7168
v_mfma_f32_16x16x32_bf16 v[36:39],a[140:143],v[68:71],v[36:39]
s_waitcnt lgkmcnt(5)
v_mfma_f32_16x16x32_bf16 v[32:35],a[144:147],v[72:75],v[32:35]
ds_read_b128 v[96:99],v7 offset:0
v_mfma_f32_16x16x32_bf16 v[36:39],a[148:151],v[72:75],v[36:39]
s_waitcnt lgkmcnt(5)
s_waitcnt vmcnt(2)
v_mov_b32 v17,s57
buffer_store_dword v17,v26,s[20:23],s69 offen sc1
v_mfma_f32_16x16x32_bf16 v[32:35],a[152:155],v[76:79],v[32:35]
ds_read_b128 v[100:103],v7 offset:1024
v_mfma_f32_16x16x32_bf16 v[36:39],a[156:159],v[76:79],v[36:39]
s_waitcnt lgkmcnt(5)
v_mfma_f32_16x16x32_bf16 v[32:35],a[160:163],v[80:83],v[32:35]
ds_read_b128 v[104:107],v7 offset:2048
buffer_load_dword v16,v2,s[20:23],s68 offen sc1
v_mfma_f32_16x16x32_bf16 v[36:39],a[164:167],v[80:83],v[36:39]
s_waitcnt lgkmcnt(5)
v_mfma_f32_16x16x32_bf16 v[32:35],a[168:171],v[84:87],v[32:35]
ds_read_b128 v[108:111],v7 offset:3072
v_mfma_f32_16x16x32_bf16 v[36:39],a[172:175],v[84:87],v[36:39]
s_waitcnt lgkmcnt(5)
v_mfma_f32_16x16x32_bf16 v[32:35],a[176:179],v[88:91],v[32:35]
ds_read_b128 v[112:115],v7 offset:4096
v_mfma_f32_16x16x32_bf16 v[36:39],a[180:183],v[88:91],v[36:39]
s_waitcnt lgkmcnt(5)
v_mfma_f32_16x16x32_bf16 v[32:35],a[184:187],v[92:95],v[32:35]
ds_read_b128 v[116:119],v7 offset:5120
v_mfma_f32_16x16x32_bf16 v[36:39],a[188:191],v[92:95],v[36:39]
s_waitcnt lgkmcnt(5)
v_mfma_f32_16x16x32_bf16 v[32:35],a[192:195],v[96:99],v[32:35]
ds_read_b128 v[120:123],v7 offset:6144
v_mfma_f32_16x16x32_bf16 v[36:39],a[196:199],v[96:99],v[36:39]
s_waitcnt lgkmcnt(5)
v_mfma_f32_16x16x32_bf16 v[32:35],a[200:203],v[100:103],v[32:35]
s_waitcnt vmcnt(2)
ds_read_b128 v[124:127],v7 offset:7168
v_lshlrev_b32 v168,16,v160
v_mfma_f32_16x16x32_bf16 v[36:39],a[204:207],v[100:103],v[36:39]
s_waitcnt lgkmcnt(5)
v_and_b32 v169,s73,v160
v_lshlrev_b32 v170,16,v161
v_mfma_f32_16x16x32_bf16 v[32:35],a[208:211],v[104:107],v[32:35]
s_add_u32 s55,s55,32768
v_and_b32 v171,s73,v161
v_lshlrev_b32 v172,16,v162
v_mfma_f32_16x16x32_bf16 v[36:39],a[212:215],v[104:107],v[36:39]
s_waitcnt lgkmcnt(4)
v_and_b32 v173,s73,v162
v_lshlrev_b32 v174,16,v163
v_mfma_f32_16x16x32_bf16 v[32:35],a[216:219],v[108:111],v[32:35]
s_and_b32 s55,s55,0x1ffff
v_and_b32 v175,s73,v163
v_add_u32 v4,s55,v8
v_mfma_f32_16x16x32_bf16 v[36:39],a[220:223],v[108:111],v[36:39]
s_waitcnt lgkmcnt(3)
v_add_u32 v5,s55,v9
v_add_u32 v6,s55,v10
v_mfma_f32_16x16x32_bf16 v[32:35],a[224:227],v[112:115],v[32:35]
v_add_u32 v7,s55,v11
v_mfma_f32_16x16x32_bf16 v[36:39],a[228:231],v[112:115],v[36:39]
s_waitcnt lgkmcnt(2)
v_mfma_f32_16x16x32_bf16 v[32:35],a[232:235],v[116:119],v[32:35]
v_mfma_f32_16x16x32_bf16 v[36:39],a[236:239],v[116:119],v[36:39]
s_waitcnt lgkmcnt(1)
v_mfma_f32_16x16x32_bf16 v[32:35],a[240:243],v[120:123],v[32:35]
v_mfma_f32_16x16x32_bf16 v[36:39],a[244:247],v[120:123],v[36:39]
s_waitcnt lgkmcnt(0)
v_mfma_f32_16x16x32_bf16 v[40:43],a[248:251],v[124:127],v[32:35]
v_mfma_f32_16x16x32_bf16 v[44:47],a[252:255],v[124:127],v[36:39]
s_waitcnt vmcnt(0)
v_cmp_gt_u32 vcc,s71,v16
s_add_u32 s60,s60,1
endN_362:
s_cbranch_vccnz nb_359
s_mov_b32 m0,s70
s_nop 0
buffer_load_dwordx4 v3,s[20:23],s61 offen offset:0 lds
buffer_load_dwordx4 v3,s[20:23],s61 offen offset:1024 lds
buffer_load_dwordx4 v3,s[20:23],s61 offen offset:2048 lds
buffer_load_dwordx4 v3,s[20:23],s61 offen offset:3072 lds
s_add_u32 m0,s70,4096
s_nop 0
buffer_load_dwordx4 v3,s[20:23],s62 offen offset:0 lds
buffer_load_dwordx4 v3,s[20:23],s62 offen offset:1024 lds
buffer_load_dwordx4 v3,s[20:23],s62 offen offset:2048 lds
buffer_load_dwordx4 v3,s[20:23],s62 offen offset:3072 lds
s_add_u32 s61,s61,32768
s_add_u32 s62,s62,32768
s_add_u32 s70,s70,32768
s_and_b32 s70,s70,0x1ffff
s_mov_b32 s57,s63
v_pk_add_f32 v[40:41],v[40:41],v[168:169]
v_pk_add_f32 v[42:43],v[42:43],v[170:171]
v_pk_add_f32 v[44:45],v[44:45],v[172:173]
v_pk_add_f32 v[46:47],v[46:47],v[174:175]
v_cvt_pk_bf16_f32 v176,v40,v41
v_cvt_pk_bf16_f32 v177,v42,v43
v_cvt_pk_bf16_f32 v178,v44,v45
v_cvt_pk_bf16_f32 v179,v46,v47
buffer_store_dwordx4 v[176:179],v0,s[20:23],s66 offen sc1
s_add_u32 s66,s66,32768
s_add_u32 s63,s63,1
s_waitcnt vmcnt(9)
v_mov_b32 v17,s57
buffer_store_dword v17,v26,s[20:23],s69 offen sc1
s_branch dec_358
nb_359:
buffer_load_dword v16,v2,s[20:23],s68 offen sc1
s_nop 3
s_mov_b32 s57,s63
v_pk_add_f32 v[40:41],v[40:41],v[168:169]
v_pk_add_f32 v[42:43],v[42:43],v[170:171]
v_pk_add_f32 v[44:45],v[44:45],v[172:173]
v_pk_add_f32 v[46:47],v[46:47],v[174:175]
v_cvt_pk_bf16_f32 v176,v40,v41
v_cvt_pk_bf16_f32 v177,v42,v43
v_cvt_pk_bf16_f32 v178,v44,v45
v_cvt_pk_bf16_f32 v179,v46,v47
buffer_store_dwordx4 v[176:179],v0,s[20:23],s66 offen sc1
s_add_u32 s66,s66,32768
s_add_u32 s63,s63,1
s_waitcnt vmcnt(2)
v_mov_b32 v17,s57
buffer_store_dword v17,v26,s[20:23],s69 offen sc1
s_waitcnt vmcnt(2)
v_cmp_gt_u32 vcc,s71,v16
s_cbranch_vccz lag_357
s_waitcnt vmcnt(1)
v_mov_b32 v17,s63
buffer_store_dword v17,v26,s[20:23],s69 offen sc1
s_cmp_ge_u32 s60,128
s_cbranch_scc1 done_346
plp_365:
buffer_load_dword v16,v2,s[20:23],s68 offen sc1
s_waitcnt vmcnt(0)
v_cmp_gt_u32 vcc,s71,v16
s_cbranch_vccz pok_366
s_sleep 4
s_sub_u32 s90,s90,1
s_cmp_gt_i32 s90,0
s_cbranch_scc1 plp_365
pok_366:
s_branch lag_357
done_346:
s_endpgm
fl_ln2:
s_mov_b32 s52,s59
s_mov_b32 s60,0
s_mov_b32 s73,0xffff0000
v_and_b32 v2,3,v1
v_lshrrev_b32 v3,2,v1
s_lshl_b32 s64,s52,2
v_add_u32 v4,s64,v2
s_lshl_b32 s65,s50,9
v_lshlrev_b32 v5,4,v3
v_add_u32 v5,s65,v5
v_lshl_add_u32 v8,v4,11,v5
v_lshlrev_b32 v9,1,v5
v_lshrrev_b32 v5,2,v3
v_and_b32 v3,3,v3
s_lshl_b32 s65,s50,13
v_lshlrev_b32 v5,10,v5
v_lshl_add_u32 v5,v3,8,v5
v_lshl_add_u32 v5,v4,4,v5
v_add_u32 v10,s65,v5
s_lshl_b32 s65,s50,9
v_lshlrev_b32 v5,3,v1
v_add_u32 v11,s65,v5
v_lshlrev_b32 v12,3,v2
v_and_b32 v13,7,v1
v_lshlrev_b32 v13,2,v13
s_mov_b32 s92,s2
s_and_b32 s93,s3,0xffff
s_mov_b32 s94,0x100
s_mov_b32 s95,0x20000
v_mbcnt_lo_u32_b32 v16,-1,0
v_mbcnt_hi_u32_b32 v16,-1,v16
v_mov_b32 v18,0
v_cmp_eq_u32 vcc,22,v16
s_nop 1
v_cndmask_b32 v18,v18,63,vcc
v_cmp_eq_u32 vcc,17,v16
s_nop 1
v_cndmask_b32 v18,v18,63,vcc
v_cmp_eq_u32 vcc,18,v16
s_nop 1
v_cndmask_b32 v18,v18,1,vcc
v_and_b32 v19,1,v16
v_cmp_eq_u32 vcc,1,v19
v_mov_b32 v19,8192
s_nop 0
v_cndmask_b32 v19,-1,v19,vcc
v_min_u32 v16,31,v16
v_lshlrev_b32 v16,2,v16
s_sub_u32 s66,s88,64
s_cmp_lg_u32 s50,0
s_cbranch_scc1 vot_372
vpoll_368:
buffer_load_dword v17,v16,s[92:95],s66 offen sc1
s_waitcnt vmcnt(0)
s_cmp_lg_u32 s56,2
s_cbranch_scc1 vck_369
v_cmp_eq_u32 vcc,v17,v19
s_and_b32 s64,vcc_lo,0xffff
s_cmp_eq_u32 s64,65535
s_cbranch_scc1 vck_369
s_mov_b32 s65,0
v_readlane_b32 s64,v17,1
s_lshr_b32 s64,s64,8
s_add_u32 s65,s65,s64
v_readlane_b32 s64,v17,3
s_lshr_b32 s64,s64,8
s_add_u32 s65,s65,s64
v_readlane_b32 s64,v17,5
s_lshr_b32 s64,s64,8
s_add_u32 s65,s65,s64
v_readlane_b32 s64,v17,7
s_lshr_b32 s64,s64,8
s_add_u32 s65,s65,s64
v_readlane_b32 s64,v17,9
s_lshr_b32 s64,s64,8
s_add_u32 s65,s65,s64
v_readlane_b32 s64,v17,11
s_lshr_b32 s64,s64,8
s_add_u32 s65,s65,s64
v_readlane_b32 s64,v17,13
s_lshr_b32 s64,s64,8
s_add_u32 s65,s65,s64
v_readlane_b32 s64,v17,15
s_lshr_b32 s64,s64,8
s_add_u32 s65,s65,s64
s_cmp_ge_u32 s65,256
s_cbranch_scc1 vok_371
s_branch vrt_370
vck_369:
v_cmp_gt_u32 vcc,v18,v17
s_cbranch_vccz vok_371
vrt_370:
s_sleep 48
s_sub_u32 s90,s90,1
s_cmp_gt_i32 s90,0
s_cbranch_scc1 vpoll_368
vok_371:
v_add_u32 v18,161024,v16
ds_write_b32 v18,v17
s_waitcnt lgkmcnt(0)
vot_372:
s_barrier
v_add_u32 v18,161024,v16
ds_read_b32 v17,v18
s_waitcnt lgkmcnt(0)
s_cmp_lg_u32 s56,2
s_cbranch_scc1 vfin_373
v_cmp_eq_u32 vcc,v17,v19
s_and_b32 s64,vcc_lo,0xffff
s_cmp_eq_u32 s64,65535
s_cbranch_scc1 vfin_373
s_mov_b32 s65,0
v_readlane_b32 s64,v17,1
s_lshr_b32 s64,s64,8
s_add_u32 s65,s65,s64
v_readlane_b32 s64,v17,3
s_lshr_b32 s64,s64,8
s_add_u32 s65,s65,s64
v_readlane_b32 s64,v17,5
s_lshr_b32 s64,s64,8
s_add_u32 s65,s65,s64
v_readlane_b32 s64,v17,7
s_lshr_b32 s64,s64,8
s_add_u32 s65,s65,s64
v_readlane_b32 s64,v17,9
s_lshr_b32 s64,s64,8
s_add_u32 s65,s65,s64
v_readlane_b32 s64,v17,11
s_lshr_b32 s64,s64,8
s_add_u32 s65,s65,s64
v_readlane_b32 s64,v17,13
s_lshr_b32 s64,s64,8
s_add_u32 s65,s65,s64
v_readlane_b32 s64,v17,15
s_lshr_b32 s64,s64,8
s_add_u32 s65,s65,s64
s_cmp_ge_u32 s65,256
s_cbranch_scc1 fl_fb
vfin_373:
s_and_b32 s56,s56,1
s_mov_b32 s67,0
s_mov_b32 s64,267403264
buffer_load_dwordx4 v[32:35],v9,s[20:23],s64 offen offset:0 sc1
buffer_load_dwordx4 v[36:39],v9,s[20:23],s64 offen offset:16 sc1
buffer_load_dwordx4 v[40:43],v9,s[20:23],s64 offen offset:512 sc1
buffer_load_dwordx4 v[44:47],v9,s[20:23],s64 offen offset:528 sc1
s_mov_b32 s64,267427840
buffer_load_dwordx4 v[64:67],v9,s[20:23],s64 offen offset:0 sc1
buffer_load_dwordx4 v[68:71],v9,s[20:23],s64 offen offset:16 sc1
buffer_load_dwordx4 v[72:75],v9,s[20:23],s64 offen offset:512 sc1
buffer_load_dwordx4 v[76:79],v9,s[20:23],s64 offen offset:528 sc1
s_mov_b32 s64,267452416
buffer_load_dwordx4 v[80:83],v9,s[20:23],s64 offen offset:0 sc1
buffer_load_dwordx4 v[84:87],v9,s[20:23],s64 offen offset:16 sc1
buffer_load_dwordx4 v[88:91],v9,s[20:23],s64 offen offset:512 sc1
buffer_load_dwordx4 v[92:95],v9,s[20:23],s64 offen offset:528 sc1
s_mov_b32 s64,267476992
buffer_load_dwordx4 v[96:99],v9,s[20:23],s64 offen offset:0 sc1
buffer_load_dwordx4 v[100:103],v9,s[20:23],s64 offen offset:16 sc1
buffer_load_dwordx4 v[104:107],v9,s[20:23],s64 offen offset:512 sc1
buffer_load_dwordx4 v[108:111],v9,s[20:23],s64 offen offset:528 sc1
s_waitcnt vmcnt(0)
v_pk_add_f32 v[32:33],v[32:33],v[64:65]
v_pk_add_f32 v[80:81],v[80:81],v[96:97]
v_pk_add_f32 v[34:35],v[34:35],v[66:67]
v_pk_add_f32 v[82:83],v[82:83],v[98:99]
v_pk_add_f32 v[36:37],v[36:37],v[68:69]
v_pk_add_f32 v[84:85],v[84:85],v[100:101]
v_pk_add_f32 v[38:39],v[38:39],v[70:71]
v_pk_add_f32 v[86:87],v[86:87],v[102:103]
v_pk_add_f32 v[40:41],v[40:41],v[72:73]
v_pk_add_f32 v[88:89],v[88:89],v[104:105]
v_pk_add_f32 v[42:43],v[42:43],v[74:75]
v_pk_add_f32 v[90:91],v[90:91],v[106:107]
v_pk_add_f32 v[44:45],v[44:45],v[76:77]
v_pk_add_f32 v[92:93],v[92:93],v[108:109]
v_pk_add_f32 v[46:47],v[46:47],v[78:79]
v_pk_add_f32 v[94:95],v[94:95],v[110:111]
v_pk_add_f32 v[32:33],v[32:33],v[80:81]
v_pk_add_f32 v[34:35],v[34:35],v[82:83]
v_pk_add_f32 v[36:37],v[36:37],v[84:85]
v_pk_add_f32 v[38:39],v[38:39],v[86:87]
v_pk_add_f32 v[40:41],v[40:41],v[88:89]
v_pk_add_f32 v[42:43],v[42:43],v[90:91]
v_pk_add_f32 v[44:45],v[44:45],v[92:93]
v_pk_add_f32 v[46:47],v[46:47],v[94:95]
v_cvt_pk_bf16_f32 v64,v32,v33
v_cvt_pk_bf16_f32 v65,v34,v35
v_cvt_pk_bf16_f32 v66,v36,v37
v_cvt_pk_bf16_f32 v67,v38,v39
v_cvt_pk_bf16_f32 v68,v40,v41
v_cvt_pk_bf16_f32 v69,v42,v43
v_cvt_pk_bf16_f32 v70,v44,v45
v_cvt_pk_bf16_f32 v71,v46,v47
v_lshlrev_b32 v32,16,v64
v_and_b32 v33,s73,v64
v_lshlrev_b32 v34,16,v65
v_and_b32 v35,s73,v65
v_lshlrev_b32 v36,16,v66
v_and_b32 v37,s73,v66
v_lshlrev_b32 v38,16,v67
v_and_b32 v39,s73,v67
v_lshlrev_b32 v40,16,v68
v_and_b32 v41,s73,v68
v_lshlrev_b32 v42,16,v69
v_and_b32 v43,s73,v69
v_lshlrev_b32 v44,16,v70
v_and_b32 v45,s73,v70
v_lshlrev_b32 v46,16,v71
v_and_b32 v47,s73,v71
v_add_f32 v32,1.0,v32
v_add_f32 v33,1.0,v33
v_add_f32 v34,1.0,v34
v_add_f32 v35,1.0,v35
v_add_f32 v36,1.0,v36
v_add_f32 v37,1.0,v37
v_add_f32 v38,1.0,v38
v_add_f32 v39,1.0,v39
v_add_f32 v40,1.0,v40
v_add_f32 v41,1.0,v41
v_add_f32 v42,1.0,v42
v_add_f32 v43,1.0,v43
v_add_f32 v44,1.0,v44
v_add_f32 v45,1.0,v45
v_add_f32 v46,1.0,v46
v_add_f32 v47,1.0,v47
s_mov_b32 s64,267399168
buffer_load_dwordx4 v[48:51],v9,s[20:23],s64 offen offset:0 sc1
buffer_load_dwordx4 v[52:55],v9,s[20:23],s64 offen offset:16 sc1
buffer_load_dwordx4 v[56:59],v9,s[20:23],s64 offen offset:512 sc1
buffer_load_dwordx4 v[60:63],v9,s[20:23],s64 offen offset:528 sc1
s_mov_b32 s64,267423744
buffer_load_dwordx4 v[64:67],v9,s[20:23],s64 offen offset:0 sc1
buffer_load_dwordx4 v[68:71],v9,s[20:23],s64 offen offset:16 sc1
buffer_load_dwordx4 v[72:75],v9,s[20:23],s64 offen offset:512 sc1
buffer_load_dwordx4 v[76:79],v9,s[20:23],s64 offen offset:528 sc1
s_mov_b32 s64,267448320
buffer_load_dwordx4 v[80:83],v9,s[20:23],s64 offen offset:0 sc1
buffer_load_dwordx4 v[84:87],v9,s[20:23],s64 offen offset:16 sc1
buffer_load_dwordx4 v[88:91],v9,s[20:23],s64 offen offset:512 sc1
buffer_load_dwordx4 v[92:95],v9,s[20:23],s64 offen offset:528 sc1
s_mov_b32 s64,267472896
buffer_load_dwordx4 v[96:99],v9,s[20:23],s64 offen offset:0 sc1
buffer_load_dwordx4 v[100:103],v9,s[20:23],s64 offen offset:16 sc1
buffer_load_dwordx4 v[104:107],v9,s[20:23],s64 offen offset:512 sc1
buffer_load_dwordx4 v[108:111],v9,s[20:23],s64 offen offset:528 sc1
s_waitcnt vmcnt(0)
v_pk_add_f32 v[48:49],v[48:49],v[64:65]
v_pk_add_f32 v[80:81],v[80:81],v[96:97]
v_pk_add_f32 v[50:51],v[50:51],v[66:67]
v_pk_add_f32 v[82:83],v[82:83],v[98:99]
v_pk_add_f32 v[52:53],v[52:53],v[68:69]
v_pk_add_f32 v[84:85],v[84:85],v[100:101]
v_pk_add_f32 v[54:55],v[54:55],v[70:71]
v_pk_add_f32 v[86:87],v[86:87],v[102:103]
v_pk_add_f32 v[56:57],v[56:57],v[72:73]
v_pk_add_f32 v[88:89],v[88:89],v[104:105]
v_pk_add_f32 v[58:59],v[58:59],v[74:75]
v_pk_add_f32 v[90:91],v[90:91],v[106:107]
v_pk_add_f32 v[60:61],v[60:61],v[76:77]
v_pk_add_f32 v[92:93],v[92:93],v[108:109]
v_pk_add_f32 v[62:63],v[62:63],v[78:79]
v_pk_add_f32 v[94:95],v[94:95],v[110:111]
v_pk_add_f32 v[48:49],v[48:49],v[80:81]
v_pk_add_f32 v[50:51],v[50:51],v[82:83]
v_pk_add_f32 v[52:53],v[52:53],v[84:85]
v_pk_add_f32 v[54:55],v[54:55],v[86:87]
v_pk_add_f32 v[56:57],v[56:57],v[88:89]
v_pk_add_f32 v[58:59],v[58:59],v[90:91]
v_pk_add_f32 v[60:61],v[60:61],v[92:93]
v_pk_add_f32 v[62:63],v[62:63],v[94:95]
v_cvt_pk_bf16_f32 v64,v48,v49
v_cvt_pk_bf16_f32 v65,v50,v51
v_cvt_pk_bf16_f32 v66,v52,v53
v_cvt_pk_bf16_f32 v67,v54,v55
v_cvt_pk_bf16_f32 v68,v56,v57
v_cvt_pk_bf16_f32 v69,v58,v59
v_cvt_pk_bf16_f32 v70,v60,v61
v_cvt_pk_bf16_f32 v71,v62,v63
v_lshlrev_b32 v48,16,v64
v_and_b32 v49,s73,v64
v_lshlrev_b32 v50,16,v65
v_and_b32 v51,s73,v65
v_lshlrev_b32 v52,16,v66
v_and_b32 v53,s73,v66
v_lshlrev_b32 v54,16,v67
v_and_b32 v55,s73,v67
v_lshlrev_b32 v56,16,v68
v_and_b32 v57,s73,v68
v_lshlrev_b32 v58,16,v69
v_and_b32 v59,s73,v69
v_lshlrev_b32 v60,16,v70
v_and_b32 v61,s73,v70
v_lshlrev_b32 v62,16,v71
v_and_b32 v63,s73,v71
s_mov_b32 s63,201326592
s_mov_b32 s66,205520896
s_lshl_b32 s64,s50,8
s_add_u32 s68,s64,138547200
s_lshl_b32 s65,s59,2
s_add_u32 s69,s64,s65
s_add_u32 s69,s69,138548224
s_lshl_b32 s64,s50,9
s_lshl_b32 s65,s59,7
s_add_u32 s69,s64,s65
s_add_u32 s69,s69,138567680
v_lshlrev_b32 v16,2,v1
v_cmp_gt_u32 vcc,32,v1
s_nop 1
v_cndmask_b32 v16,2.0,v16,vcc
s_cmp_eq_u32 s56,1
s_cbranch_scc1 lfar_374
s_add_u32 s64,s63,4096
buffer_load_dwordx4 v[64:67],v10,s[20:23],s63 offen sc1
buffer_load_dwordx4 v[68:71],v10,s[20:23],s64 offen sc1
buffer_load_dword v15,off,s[20:23],s68
buffer_load_dword v15,off,s[20:23],s68
top0_375:
s_waitcnt vmcnt(2)
v_max3_u32 v14,v64,v65,v66
v_max3_u32 v13,v67,v68,v69
v_max3_u32 v14,v14,v70,v71
v_max_u32 v14,v14,v13
v_cmp_eq_u32 vcc,-1,v14
s_cbranch_vccnz rt_377
go_378:
s_add_u32 s63,s63,32768
s_add_u32 s64,s63,4096
buffer_load_dwordx4 v[72:75],v10,s[20:23],s63 offen sc1
buffer_load_dwordx4 v[76:79],v10,s[20:23],s64 offen sc1
v_lshlrev_b32 v80,16,v64
v_and_b32 v81,s73,v64
v_lshlrev_b32 v82,16,v65
v_and_b32 v83,s73,v65
v_lshlrev_b32 v84,16,v66
v_and_b32 v85,s73,v66
v_lshlrev_b32 v86,16,v67
v_and_b32 v87,s73,v67
v_lshlrev_b32 v88,16,v68
v_and_b32 v89,s73,v68
v_lshlrev_b32 v90,16,v69
v_and_b32 v91,s73,v69
v_lshlrev_b32 v92,16,v70
v_and_b32 v93,s73,v70
v_lshlrev_b32 v94,16,v71
v_and_b32 v95,s73,v71
v_add_f32 v96,v80,v81
v_mul_f32 v97,v80,v80
v_add_f32 v98,v82,v83
v_mul_f32 v99,v81,v81
v_fmac_f32 v97,v82,v82
v_fmac_f32 v99,v83,v83
v_add_f32 v96,v96,v84
v_fmac_f32 v97,v84,v84
v_add_f32 v98,v98,v85
v_fmac_f32 v99,v85,v85
v_add_f32 v96,v96,v86
v_fmac_f32 v97,v86,v86
v_add_f32 v98,v98,v87
v_fmac_f32 v99,v87,v87
v_add_f32 v96,v96,v88
v_fmac_f32 v97,v88,v88
v_add_f32 v98,v98,v89
v_fmac_f32 v99,v89,v89
v_add_f32 v96,v96,v90
v_fmac_f32 v97,v90,v90
v_add_f32 v98,v98,v91
v_fmac_f32 v99,v91,v91
v_add_f32 v96,v96,v92
v_fmac_f32 v97,v92,v92
v_add_f32 v98,v98,v93
v_fmac_f32 v99,v93,v93
v_add_f32 v96,v96,v94
v_fmac_f32 v97,v94,v94
v_add_f32 v98,v98,v95
v_fmac_f32 v99,v95,v95
v_add_f32 v96,v96,v98
v_add_f32 v97,v97,v99
s_nop 0
v_add_f32_dpp v96,v96,v96 row_ror:4 row_mask:0xf bank_mask:0xf
v_add_f32_dpp v97,v97,v97 row_ror:4 row_mask:0xf bank_mask:0xf
s_nop 0
v_add_f32_dpp v96,v96,v96 row_ror:8 row_mask:0xf bank_mask:0xf
v_add_f32_dpp v97,v97,v97 row_ror:8 row_mask:0xf bank_mask:0xf
v_mov_b32 v98,v96
v_mov_b32 v99,v97
s_nop 0
v_permlane16_swap_b32 v98,v96
v_permlane16_swap_b32 v99,v97
v_add_f32 v96,v96,v98
v_add_f32 v97,v97,v99
v_mov_b32 v98,v96
v_mov_b32 v99,v97
s_nop 0
v_permlane32_swap_b32 v98,v96
v_permlane32_swap_b32 v99,v97
v_add_f32 v96,v96,v98
v_add_f32 v97,v97,v99
ds_write_b64 v11,v[96:97] offset:0
s_waitcnt lgkmcnt(0)
s_barrier
s_waitcnt vmcnt(2)
v_mov_b32 v15,s60
buffer_store_dword v15,v16,s[20:23],s69 offen
ds_read_b64 v[100:101],v12 offset:0
ds_read_b64 v[102:103],v12 offset:512
ds_read_b64 v[104:105],v12 offset:1024
ds_read_b64 v[106:107],v12 offset:1536
s_waitcnt lgkmcnt(0)
v_add_f32 v100,v100,v102
v_add_f32 v101,v101,v103
v_add_f32 v104,v104,v106
v_add_f32 v105,v105,v107
v_add_f32 v100,v100,v104
v_add_f32 v101,v101,v105
v_mul_f32 v96,0xba800000,v100
v_mul_f32 v102,v96,v96
v_mul_f32 v101,0x3a800000,v101
v_sub_f32 v101,v101,v102
v_max_f32 v101,0,v101
v_add_f32 v101,0x3727c5ac,v101
v_rsq_f32 v97,v101
s_nop 0
v_mul_f32 v96,v96,v97
v_fma_f32 v80,v80,v97,v96
v_fma_f32 v81,v81,v97,v96
v_fma_f32 v82,v82,v97,v96
v_fma_f32 v83,v83,v97,v96
v_fma_f32 v84,v84,v97,v96
v_fma_f32 v85,v85,v97,v96
v_fma_f32 v86,v86,v97,v96
v_fma_f32 v87,v87,v97,v96
v_fma_f32 v88,v88,v97,v96
v_fma_f32 v89,v89,v97,v96
v_fma_f32 v90,v90,v97,v96
v_fma_f32 v91,v91,v97,v96
v_fma_f32 v92,v92,v97,v96
v_fma_f32 v93,v93,v97,v96
v_fma_f32 v94,v94,v97,v96
v_fma_f32 v95,v95,v97,v96
v_fma_f32 v80,v80,v32,v48
v_fma_f32 v81,v81,v33,v49
v_fma_f32 v82,v82,v34,v50
v_fma_f32 v83,v83,v35,v51
v_fma_f32 v84,v84,v36,v52
v_fma_f32 v85,v85,v37,v53
v_fma_f32 v86,v86,v38,v54
v_fma_f32 v87,v87,v39,v55
v_fma_f32 v88,v88,v40,v56
v_fma_f32 v89,v89,v41,v57
v_fma_f32 v90,v90,v42,v58
v_fma_f32 v91,v91,v43,v59
v_fma_f32 v92,v92,v44,v60
v_fma_f32 v93,v93,v45,v61
v_fma_f32 v94,v94,v46,v62
v_fma_f32 v95,v95,v47,v63
v_cvt_pk_bf16_f32 v112,v80,v81
v_cvt_pk_bf16_f32 v113,v82,v83
v_cvt_pk_bf16_f32 v114,v84,v85
v_cvt_pk_bf16_f32 v115,v86,v87
v_cvt_pk_bf16_f32 v116,v88,v89
v_cvt_pk_bf16_f32 v117,v90,v91
v_cvt_pk_bf16_f32 v118,v92,v93
v_cvt_pk_bf16_f32 v119,v94,v95
s_add_u32 s64,s66,4096
buffer_store_dwordx4 v[112:115],v10,s[20:23],s66 offen sc1
buffer_store_dwordx4 v[116:119],v10,s[20:23],s64 offen sc1
s_add_u32 s66,s66,32768
s_add_u32 s60,s60,1
top1_376:
s_waitcnt vmcnt(2)
v_max3_u32 v14,v72,v73,v74
v_max3_u32 v13,v75,v76,v77
v_max3_u32 v14,v14,v78,v79
v_max_u32 v14,v14,v13
v_cmp_eq_u32 vcc,-1,v14
s_cbranch_vccnz rt_380
go_381:
s_add_u32 s63,s63,32768
s_add_u32 s64,s63,4096
buffer_load_dwordx4 v[64:67],v10,s[20:23],s63 offen sc1
buffer_load_dwordx4 v[68:71],v10,s[20:23],s64 offen sc1
v_lshlrev_b32 v80,16,v72
v_and_b32 v81,s73,v72
v_lshlrev_b32 v82,16,v73
v_and_b32 v83,s73,v73
v_lshlrev_b32 v84,16,v74
v_and_b32 v85,s73,v74
v_lshlrev_b32 v86,16,v75
v_and_b32 v87,s73,v75
v_lshlrev_b32 v88,16,v76
v_and_b32 v89,s73,v76
v_lshlrev_b32 v90,16,v77
v_and_b32 v91,s73,v77
v_lshlrev_b32 v92,16,v78
v_and_b32 v93,s73,v78
v_lshlrev_b32 v94,16,v79
v_and_b32 v95,s73,v79
v_add_f32 v96,v80,v81
v_mul_f32 v97,v80,v80
v_add_f32 v98,v82,v83
v_mul_f32 v99,v81,v81
v_fmac_f32 v97,v82,v82
v_fmac_f32 v99,v83,v83
v_add_f32 v96,v96,v84
v_fmac_f32 v97,v84,v84
v_add_f32 v98,v98,v85
v_fmac_f32 v99,v85,v85
v_add_f32 v96,v96,v86
v_fmac_f32 v97,v86,v86
v_add_f32 v98,v98,v87
v_fmac_f32 v99,v87,v87
v_add_f32 v96,v96,v88
v_fmac_f32 v97,v88,v88
v_add_f32 v98,v98,v89
v_fmac_f32 v99,v89,v89
v_add_f32 v96,v96,v90
v_fmac_f32 v97,v90,v90
v_add_f32 v98,v98,v91
v_fmac_f32 v99,v91,v91
v_add_f32 v96,v96,v92
v_fmac_f32 v97,v92,v92
v_add_f32 v98,v98,v93
v_fmac_f32 v99,v93,v93
v_add_f32 v96,v96,v94
v_fmac_f32 v97,v94,v94
v_add_f32 v98,v98,v95
v_fmac_f32 v99,v95,v95
v_add_f32 v96,v96,v98
v_add_f32 v97,v97,v99
s_nop 0
v_add_f32_dpp v96,v96,v96 row_ror:4 row_mask:0xf bank_mask:0xf
v_add_f32_dpp v97,v97,v97 row_ror:4 row_mask:0xf bank_mask:0xf
s_nop 0
v_add_f32_dpp v96,v96,v96 row_ror:8 row_mask:0xf bank_mask:0xf
v_add_f32_dpp v97,v97,v97 row_ror:8 row_mask:0xf bank_mask:0xf
v_mov_b32 v98,v96
v_mov_b32 v99,v97
s_nop 0
v_permlane16_swap_b32 v98,v96
v_permlane16_swap_b32 v99,v97
v_add_f32 v96,v96,v98
v_add_f32 v97,v97,v99
v_mov_b32 v98,v96
v_mov_b32 v99,v97
s_nop 0
v_permlane32_swap_b32 v98,v96
v_permlane32_swap_b32 v99,v97
v_add_f32 v96,v96,v98
v_add_f32 v97,v97,v99
ds_write_b64 v11,v[96:97] offset:2048
s_waitcnt lgkmcnt(0)
s_barrier
s_waitcnt vmcnt(2)
v_mov_b32 v15,s60
buffer_store_dword v15,v16,s[20:23],s69 offen
ds_read_b64 v[100:101],v12 offset:2048
ds_read_b64 v[102:103],v12 offset:2560
ds_read_b64 v[104:105],v12 offset:3072
ds_read_b64 v[106:107],v12 offset:3584
s_waitcnt lgkmcnt(0)
v_add_f32 v100,v100,v102
v_add_f32 v101,v101,v103
v_add_f32 v104,v104,v106
v_add_f32 v105,v105,v107
v_add_f32 v100,v100,v104
v_add_f32 v101,v101,v105
v_mul_f32 v96,0xba800000,v100
v_mul_f32 v102,v96,v96
v_mul_f32 v101,0x3a800000,v101
v_sub_f32 v101,v101,v102
v_max_f32 v101,0,v101
v_add_f32 v101,0x3727c5ac,v101
v_rsq_f32 v97,v101
s_nop 0
v_mul_f32 v96,v96,v97
v_fma_f32 v80,v80,v97,v96
v_fma_f32 v81,v81,v97,v96
v_fma_f32 v82,v82,v97,v96
v_fma_f32 v83,v83,v97,v96
v_fma_f32 v84,v84,v97,v96
v_fma_f32 v85,v85,v97,v96
v_fma_f32 v86,v86,v97,v96
v_fma_f32 v87,v87,v97,v96
v_fma_f32 v88,v88,v97,v96
v_fma_f32 v89,v89,v97,v96
v_fma_f32 v90,v90,v97,v96
v_fma_f32 v91,v91,v97,v96
v_fma_f32 v92,v92,v97,v96
v_fma_f32 v93,v93,v97,v96
v_fma_f32 v94,v94,v97,v96
v_fma_f32 v95,v95,v97,v96
v_fma_f32 v80,v80,v32,v48
v_fma_f32 v81,v81,v33,v49
v_fma_f32 v82,v82,v34,v50
v_fma_f32 v83,v83,v35,v51
v_fma_f32 v84,v84,v36,v52
v_fma_f32 v85,v85,v37,v53
v_fma_f32 v86,v86,v38,v54
v_fma_f32 v87,v87,v39,v55
v_fma_f32 v88,v88,v40,v56
v_fma_f32 v89,v89,v41,v57
v_fma_f32 v90,v90,v42,v58
v_fma_f32 v91,v91,v43,v59
v_fma_f32 v92,v92,v44,v60
v_fma_f32 v93,v93,v45,v61
v_fma_f32 v94,v94,v46,v62
v_fma_f32 v95,v95,v47,v63
v_cvt_pk_bf16_f32 v112,v80,v81
v_cvt_pk_bf16_f32 v113,v82,v83
v_cvt_pk_bf16_f32 v114,v84,v85
v_cvt_pk_bf16_f32 v115,v86,v87
v_cvt_pk_bf16_f32 v116,v88,v89
v_cvt_pk_bf16_f32 v117,v90,v91
v_cvt_pk_bf16_f32 v118,v92,v93
v_cvt_pk_bf16_f32 v119,v94,v95
s_add_u32 s64,s66,4096
buffer_store_dwordx4 v[112:115],v10,s[20:23],s66 offen sc1
buffer_store_dwordx4 v[116:119],v10,s[20:23],s64 offen sc1
s_add_u32 s66,s66,32768
s_add_u32 s60,s60,1
s_cmp_lt_u32 s60,128
s_cbranch_scc1 top0_375
s_waitcnt vmcnt(0)
v_mov_b32 v15,s60
buffer_store_dword v15,v16,s[20:23],s69 offen
s_branch done_367
rt_377:
s_add_u32 s64,s63,4096
buffer_load_dwordx4 v[64:67],v10,s[20:23],s63 offen sc1
buffer_load_dwordx4 v[68:71],v10,s[20:23],s64 offen sc1
s_waitcnt vmcnt(2)
v_mov_b32 v15,s60
buffer_store_dword v15,v16,s[20:23],s69 offen
s_waitcnt vmcnt(1)
v_max3_u32 v14,v64,v65,v66
v_max3_u32 v13,v67,v68,v69
v_max3_u32 v14,v14,v70,v71
v_max_u32 v14,v14,v13
v_cmp_eq_u32 vcc,-1,v14
s_cbranch_vccz go_378
lp_379:
s_sleep 1
s_add_u32 s64,s63,4096
buffer_load_dwordx4 v[64:67],v10,s[20:23],s63 offen sc1
buffer_load_dwordx4 v[68:71],v10,s[20:23],s64 offen sc1
s_waitcnt vmcnt(0)
v_max3_u32 v14,v64,v65,v66
v_max3_u32 v13,v67,v68,v69
v_max3_u32 v14,v14,v70,v71
v_max_u32 v14,v14,v13
v_cmp_eq_u32 vcc,-1,v14
s_cbranch_vccz go_378
s_sub_u32 s90,s90,1
s_cmp_gt_i32 s90,0
s_cbranch_scc1 lp_379
s_branch go_378
rt_380:
s_add_u32 s64,s63,4096
buffer_load_dwordx4 v[72:75],v10,s[20:23],s63 offen sc1
buffer_load_dwordx4 v[76:79],v10,s[20:23],s64 offen sc1
s_waitcnt vmcnt(2)
v_mov_b32 v15,s60
buffer_store_dword v15,v16,s[20:23],s69 offen
s_waitcnt vmcnt(1)
v_max3_u32 v14,v72,v73,v74
v_max3_u32 v13,v75,v76,v77
v_max3_u32 v14,v14,v78,v79
v_max_u32 v14,v14,v13
v_cmp_eq_u32 vcc,-1,v14
s_cbranch_vccz go_381
lp_382:
s_sleep 1
s_add_u32 s64,s63,4096
buffer_load_dwordx4 v[72:75],v10,s[20:23],s63 offen sc1
buffer_load_dwordx4 v[76:79],v10,s[20:23],s64 offen sc1
s_waitcnt vmcnt(0)
v_max3_u32 v14,v72,v73,v74
v_max3_u32 v13,v75,v76,v77
v_max3_u32 v14,v14,v78,v79
v_max_u32 v14,v14,v13
v_cmp_eq_u32 vcc,-1,v14
s_cbranch_vccz go_381
s_sub_u32 s90,s90,1
s_cmp_gt_i32 s90,0
s_cbranch_scc1 lp_382
s_branch go_381
lfar_374:
s_add_u32 s64,s63,4096
buffer_load_dwordx4 v[64:67],v10,s[20:23],s63 offen sc1
buffer_load_dwordx4 v[68:71],v10,s[20:23],s64 offen sc1
buffer_load_dword v15,off,s[20:23],s68
buffer_load_dword v15,off,s[20:23],s68
top0_383:
s_waitcnt vmcnt(2)
v_max3_u32 v14,v64,v65,v66
v_max3_u32 v13,v67,v68,v69
v_max3_u32 v14,v14,v70,v71
v_max_u32 v14,v14,v13
v_cmp_eq_u32 vcc,-1,v14
s_cbranch_vccnz rt_385
go_386:
s_add_u32 s63,s63,32768
s_add_u32 s64,s63,4096
buffer_load_dwordx4 v[72:75],v10,s[20:23],s63 offen sc1
buffer_load_dwordx4 v[76:79],v10,s[20:23],s64 offen sc1
v_lshlrev_b32 v80,16,v64
v_and_b32 v81,s73,v64
v_lshlrev_b32 v82,16,v65
v_and_b32 v83,s73,v65
v_lshlrev_b32 v84,16,v66
v_and_b32 v85,s73,v66
v_lshlrev_b32 v86,16,v67
v_and_b32 v87,s73,v67
v_lshlrev_b32 v88,16,v68
v_and_b32 v89,s73,v68
v_lshlrev_b32 v90,16,v69
v_and_b32 v91,s73,v69
v_lshlrev_b32 v92,16,v70
v_and_b32 v93,s73,v70
v_lshlrev_b32 v94,16,v71
v_and_b32 v95,s73,v71
v_add_f32 v96,v80,v81
v_mul_f32 v97,v80,v80
v_add_f32 v98,v82,v83
v_mul_f32 v99,v81,v81
v_fmac_f32 v97,v82,v82
v_fmac_f32 v99,v83,v83
v_add_f32 v96,v96,v84
v_fmac_f32 v97,v84,v84
v_add_f32 v98,v98,v85
v_fmac_f32 v99,v85,v85
v_add_f32 v96,v96,v86
v_fmac_f32 v97,v86,v86
v_add_f32 v98,v98,v87
v_fmac_f32 v99,v87,v87
v_add_f32 v96,v96,v88
v_fmac_f32 v97,v88,v88
v_add_f32 v98,v98,v89
v_fmac_f32 v99,v89,v89
v_add_f32 v96,v96,v90
v_fmac_f32 v97,v90,v90
v_add_f32 v98,v98,v91
v_fmac_f32 v99,v91,v91
v_add_f32 v96,v96,v92
v_fmac_f32 v97,v92,v92
v_add_f32 v98,v98,v93
v_fmac_f32 v99,v93,v93
v_add_f32 v96,v96,v94
v_fmac_f32 v97,v94,v94
v_add_f32 v98,v98,v95
v_fmac_f32 v99,v95,v95
v_add_f32 v96,v96,v98
v_add_f32 v97,v97,v99
s_nop 0
v_add_f32_dpp v96,v96,v96 row_ror:4 row_mask:0xf bank_mask:0xf
v_add_f32_dpp v97,v97,v97 row_ror:4 row_mask:0xf bank_mask:0xf
s_nop 0
v_add_f32_dpp v96,v96,v96 row_ror:8 row_mask:0xf bank_mask:0xf
v_add_f32_dpp v97,v97,v97 row_ror:8 row_mask:0xf bank_mask:0xf
v_mov_b32 v98,v96
v_mov_b32 v99,v97
s_nop 0
v_permlane16_swap_b32 v98,v96
v_permlane16_swap_b32 v99,v97
v_add_f32 v96,v96,v98
v_add_f32 v97,v97,v99
v_mov_b32 v98,v96
v_mov_b32 v99,v97
s_nop 0
v_permlane32_swap_b32 v98,v96
v_permlane32_swap_b32 v99,v97
v_add_f32 v96,v96,v98
v_add_f32 v97,v97,v99
ds_write_b64 v11,v[96:97] offset:0
s_waitcnt lgkmcnt(0)
s_barrier
s_waitcnt vmcnt(2)
v_mov_b32 v15,s60
buffer_store_dword v15,v16,s[20:23],s69 offen sc1
ds_read_b64 v[100:101],v12 offset:0
ds_read_b64 v[102:103],v12 offset:512
ds_read_b64 v[104:105],v12 offset:1024
ds_read_b64 v[106:107],v12 offset:1536
s_waitcnt lgkmcnt(0)
v_add_f32 v100,v100,v102
v_add_f32 v101,v101,v103
v_add_f32 v104,v104,v106
v_add_f32 v105,v105,v107
v_add_f32 v100,v100,v104
v_add_f32 v101,v101,v105
v_mul_f32 v96,0xba800000,v100
v_mul_f32 v102,v96,v96
v_mul_f32 v101,0x3a800000,v101
v_sub_f32 v101,v101,v102
v_max_f32 v101,0,v101
v_add_f32 v101,0x3727c5ac,v101
v_rsq_f32 v97,v101
s_nop 0
v_mul_f32 v96,v96,v97
v_fma_f32 v80,v80,v97,v96
v_fma_f32 v81,v81,v97,v96
v_fma_f32 v82,v82,v97,v96
v_fma_f32 v83,v83,v97,v96
v_fma_f32 v84,v84,v97,v96
v_fma_f32 v85,v85,v97,v96
v_fma_f32 v86,v86,v97,v96
v_fma_f32 v87,v87,v97,v96
v_fma_f32 v88,v88,v97,v96
v_fma_f32 v89,v89,v97,v96
v_fma_f32 v90,v90,v97,v96
v_fma_f32 v91,v91,v97,v96
v_fma_f32 v92,v92,v97,v96
v_fma_f32 v93,v93,v97,v96
v_fma_f32 v94,v94,v97,v96
v_fma_f32 v95,v95,v97,v96
v_fma_f32 v80,v80,v32,v48
v_fma_f32 v81,v81,v33,v49
v_fma_f32 v82,v82,v34,v50
v_fma_f32 v83,v83,v35,v51
v_fma_f32 v84,v84,v36,v52
v_fma_f32 v85,v85,v37,v53
v_fma_f32 v86,v86,v38,v54
v_fma_f32 v87,v87,v39,v55
v_fma_f32 v88,v88,v40,v56
v_fma_f32 v89,v89,v41,v57
v_fma_f32 v90,v90,v42,v58
v_fma_f32 v91,v91,v43,v59
v_fma_f32 v92,v92,v44,v60
v_fma_f32 v93,v93,v45,v61
v_fma_f32 v94,v94,v46,v62
v_fma_f32 v95,v95,v47,v63
v_cvt_pk_bf16_f32 v112,v80,v81
v_cvt_pk_bf16_f32 v113,v82,v83
v_cvt_pk_bf16_f32 v114,v84,v85
v_cvt_pk_bf16_f32 v115,v86,v87
v_cvt_pk_bf16_f32 v116,v88,v89
v_cvt_pk_bf16_f32 v117,v90,v91
v_cvt_pk_bf16_f32 v118,v92,v93
v_cvt_pk_bf16_f32 v119,v94,v95
s_add_u32 s64,s66,4096
buffer_store_dwordx4 v[112:115],v10,s[20:23],s66 offen sc1
buffer_store_dwordx4 v[116:119],v10,s[20:23],s64 offen sc1
s_add_u32 s66,s66,32768
s_add_u32 s60,s60,1
top1_384:
s_waitcnt vmcnt(2)
v_max3_u32 v14,v72,v73,v74
v_max3_u32 v13,v75,v76,v77
v_max3_u32 v14,v14,v78,v79
v_max_u32 v14,v14,v13
v_cmp_eq_u32 vcc,-1,v14
s_cbranch_vccnz rt_388
go_389:
s_add_u32 s63,s63,32768
s_add_u32 s64,s63,4096
buffer_load_dwordx4 v[64:67],v10,s[20:23],s63 offen sc1
buffer_load_dwordx4 v[68:71],v10,s[20:23],s64 offen sc1
v_lshlrev_b32 v80,16,v72
v_and_b32 v81,s73,v72
v_lshlrev_b32 v82,16,v73
v_and_b32 v83,s73,v73
v_lshlrev_b32 v84,16,v74
v_and_b32 v85,s73,v74
v_lshlrev_b32 v86,16,v75
v_and_b32 v87,s73,v75
v_lshlrev_b32 v88,16,v76
v_and_b32 v89,s73,v76
v_lshlrev_b32 v90,16,v77
v_and_b32 v91,s73,v77
v_lshlrev_b32 v92,16,v78
v_and_b32 v93,s73,v78
v_lshlrev_b32 v94,16,v79
v_and_b32 v95,s73,v79
v_add_f32 v96,v80,v81
v_mul_f32 v97,v80,v80
v_add_f32 v98,v82,v83
v_mul_f32 v99,v81,v81
v_fmac_f32 v97,v82,v82
v_fmac_f32 v99,v83,v83
v_add_f32 v96,v96,v84
v_fmac_f32 v97,v84,v84
v_add_f32 v98,v98,v85
v_fmac_f32 v99,v85,v85
v_add_f32 v96,v96,v86
v_fmac_f32 v97,v86,v86
v_add_f32 v98,v98,v87
v_fmac_f32 v99,v87,v87
v_add_f32 v96,v96,v88
v_fmac_f32 v97,v88,v88
v_add_f32 v98,v98,v89
v_fmac_f32 v99,v89,v89
v_add_f32 v96,v96,v90
v_fmac_f32 v97,v90,v90
v_add_f32 v98,v98,v91
v_fmac_f32 v99,v91,v91
v_add_f32 v96,v96,v92
v_fmac_f32 v97,v92,v92
v_add_f32 v98,v98,v93
v_fmac_f32 v99,v93,v93
v_add_f32 v96,v96,v94
v_fmac_f32 v97,v94,v94
v_add_f32 v98,v98,v95
v_fmac_f32 v99,v95,v95
v_add_f32 v96,v96,v98
v_add_f32 v97,v97,v99
s_nop 0
v_add_f32_dpp v96,v96,v96 row_ror:4 row_mask:0xf bank_mask:0xf
v_add_f32_dpp v97,v97,v97 row_ror:4 row_mask:0xf bank_mask:0xf
s_nop 0
v_add_f32_dpp v96,v96,v96 row_ror:8 row_mask:0xf bank_mask:0xf
v_add_f32_dpp v97,v97,v97 row_ror:8 row_mask:0xf bank_mask:0xf
v_mov_b32 v98,v96
v_mov_b32 v99,v97
s_nop 0
v_permlane16_swap_b32 v98,v96
v_permlane16_swap_b32 v99,v97
v_add_f32 v96,v96,v98
v_add_f32 v97,v97,v99
v_mov_b32 v98,v96
v_mov_b32 v99,v97
s_nop 0
v_permlane32_swap_b32 v98,v96
v_permlane32_swap_b32 v99,v97
v_add_f32 v96,v96,v98
v_add_f32 v97,v97,v99
ds_write_b64 v11,v[96:97] offset:2048
s_waitcnt lgkmcnt(0)
s_barrier
s_waitcnt vmcnt(2)
v_mov_b32 v15,s60
buffer_store_dword v15,v16,s[20:23],s69 offen sc1
ds_read_b64 v[100:101],v12 offset:2048
ds_read_b64 v[102:103],v12 offset:2560
ds_read_b64 v[104:105],v12 offset:3072
ds_read_b64 v[106:107],v12 offset:3584
s_waitcnt lgkmcnt(0)
v_add_f32 v100,v100,v102
v_add_f32 v101,v101,v103
v_add_f32 v104,v104,v106
v_add_f32 v105,v105,v107
v_add_f32 v100,v100,v104
v_add_f32 v101,v101,v105
v_mul_f32 v96,0xba800000,v100
v_mul_f32 v102,v96,v96
v_mul_f32 v101,0x3a800000,v101
v_sub_f32 v101,v101,v102
v_max_f32 v101,0,v101
v_add_f32 v101,0x3727c5ac,v101
v_rsq_f32 v97,v101
s_nop 0
v_mul_f32 v96,v96,v97
v_fma_f32 v80,v80,v97,v96
v_fma_f32 v81,v81,v97,v96
v_fma_f32 v82,v82,v97,v96
v_fma_f32 v83,v83,v97,v96
v_fma_f32 v84,v84,v97,v96
v_fma_f32 v85,v85,v97,v96
v_fma_f32 v86,v86,v97,v96
v_fma_f32 v87,v87,v97,v96
v_fma_f32 v88,v88,v97,v96
v_fma_f32 v89,v89,v97,v96
v_fma_f32 v90,v90,v97,v96
v_fma_f32 v91,v91,v97,v96
v_fma_f32 v92,v92,v97,v96
v_fma_f32 v93,v93,v97,v96
v_fma_f32 v94,v94,v97,v96
v_fma_f32 v95,v95,v97,v96
v_fma_f32 v80,v80,v32,v48
v_fma_f32 v81,v81,v33,v49
v_fma_f32 v82,v82,v34,v50
v_fma_f32 v83,v83,v35,v51
v_fma_f32 v84,v84,v36,v52
v_fma_f32 v85,v85,v37,v53
v_fma_f32 v86,v86,v38,v54
v_fma_f32 v87,v87,v39,v55
v_fma_f32 v88,v88,v40,v56
v_fma_f32 v89,v89,v41,v57
v_fma_f32 v90,v90,v42,v58
v_fma_f32 v91,v91,v43,v59
v_fma_f32 v92,v92,v44,v60
v_fma_f32 v93,v93,v45,v61
v_fma_f32 v94,v94,v46,v62
v_fma_f32 v95,v95,v47,v63
v_cvt_pk_bf16_f32 v112,v80,v81
v_cvt_pk_bf16_f32 v113,v82,v83
v_cvt_pk_bf16_f32 v114,v84,v85
v_cvt_pk_bf16_f32 v115,v86,v87
v_cvt_pk_bf16_f32 v116,v88,v89
v_cvt_pk_bf16_f32 v117,v90,v91
v_cvt_pk_bf16_f32 v118,v92,v93
v_cvt_pk_bf16_f32 v119,v94,v95
s_add_u32 s64,s66,4096
buffer_store_dwordx4 v[112:115],v10,s[20:23],s66 offen sc1
buffer_store_dwordx4 v[116:119],v10,s[20:23],s64 offen sc1
s_add_u32 s66,s66,32768
s_add_u32 s60,s60,1
s_cmp_lt_u32 s60,128
s_cbranch_scc1 top0_383
s_waitcnt vmcnt(0)
v_mov_b32 v15,s60
buffer_store_dword v15,v16,s[20:23],s69 offen sc1
s_branch done_367
rt_385:
s_add_u32 s64,s63,4096
buffer_load_dwordx4 v[64:67],v10,s[20:23],s63 offen sc1
buffer_load_dwordx4 v[68:71],v10,s[20:23],s64 offen sc1
s_waitcnt vmcnt(2)
v_mov_b32 v15,s60
buffer_store_dword v15,v16,s[20:23],s69 offen sc1
s_waitcnt vmcnt(1)
v_max3_u32 v14,v64,v65,v66
v_max3_u32 v13,v67,v68,v69
v_max3_u32 v14,v14,v70,v71
v_max_u32 v14,v14,v13
v_cmp_eq_u32 vcc,-1,v14
s_cbranch_vccz go_386
lp_387:
s_sleep 1
s_add_u32 s64,s63,4096
buffer_load_dwordx4 v[64:67],v10,s[20:23],s63 offen sc1
buffer_load_dwordx4 v[68:71],v10,s[20:23],s64 offen sc1
s_waitcnt vmcnt(0)
v_max3_u32 v14,v64,v65,v66
v_max3_u32 v13,v67,v68,v69
v_max3_u32 v14,v14,v70,v71
v_max_u32 v14,v14,v13
v_cmp_eq_u32 vcc,-1,v14
s_cbranch_vccz go_386
s_sub_u32 s90,s90,1
s_cmp_gt_i32 s90,0
s_cbranch_scc1 lp_387
s_branch go_386
rt_388:
s_add_u32 s64,s63,4096
buffer_load_dwordx4 v[72:75],v10,s[20:23],s63 offen sc1
buffer_load_dwordx4 v[76:79],v10,s[20:23],s64 offen sc1
s_waitcnt vmcnt(2)
v_mov_b32 v15,s60
buffer_store_dword v15,v16,s[20:23],s69 offen sc1
s_waitcnt vmcnt(1)
v_max3_u32 v14,v72,v73,v74
v_max3_u32 v13,v75,v76,v77
v_max3_u32 v14,v14,v78,v79
v_max_u32 v14,v14,v13
v_cmp_eq_u32 vcc,-1,v14
s_cbranch_vccz go_389
lp_390:
s_sleep 1
s_add_u32 s64,s63,4096
buffer_load_dwordx4 v[72:75],v10,s[20:23],s63 offen sc1
buffer_load_dwordx4 v[76:79],v10,s[20:23],s64 offen sc1
s_waitcnt vmcnt(0)
v_max3_u32 v14,v72,v73,v74
v_max3_u32 v13,v75,v76,v77
v_max3_u32 v14,v14,v78,v79
v_max_u32 v14,v14,v13
v_cmp_eq_u32 vcc,-1,v14
s_cbranch_vccz go_389
s_sub_u32 s90,s90,1
s_cmp_gt_i32 s90,0
s_cbranch_scc1 lp_390
s_branch go_389
done_367:
s_endpgm
fl_att:
s_mov_b32 s92,s2
s_and_b32 s93,s3,0xffff
s_mov_b32 s94,0x100
s_mov_b32 s95,0x20000
v_mbcnt_lo_u32_b32 v16,-1,0
v_mbcnt_hi_u32_b32 v16,-1,v16
v_mov_b32 v18,0
v_cmp_eq_u32 vcc,22,v16
s_nop 1
v_cndmask_b32 v18,v18,63,vcc
v_cmp_eq_u32 vcc,21,v16
s_nop 1
v_cndmask_b32 v18,v18,1,vcc
v_and_b32 v19,1,v16
v_cmp_eq_u32 vcc,1,v19
v_mov_b32 v19,8192
s_nop 0
v_cndmask_b32 v19,-1,v19,vcc
v_min_u32 v16,31,v16
v_lshlrev_b32 v16,2,v16
s_sub_u32 s66,s88,64
s_cmp_lg_u32 s50,0
s_cbranch_scc1 vot_395
vpoll_391:
buffer_load_dword v17,v16,s[92:95],s66 offen sc1
s_waitcnt vmcnt(0)
s_cmp_lg_u32 s56,2
s_cbranch_scc1 vck_392
v_cmp_eq_u32 vcc,v17,v19
s_and_b32 s64,vcc_lo,0xffff
s_cmp_eq_u32 s64,65535
s_cbranch_scc1 vck_392
s_mov_b32 s65,0
v_readlane_b32 s64,v17,1
s_lshr_b32 s64,s64,8
s_add_u32 s65,s65,s64
v_readlane_b32 s64,v17,3
s_lshr_b32 s64,s64,8
s_add_u32 s65,s65,s64
v_readlane_b32 s64,v17,5
s_lshr_b32 s64,s64,8
s_add_u32 s65,s65,s64
v_readlane_b32 s64,v17,7
s_lshr_b32 s64,s64,8
s_add_u32 s65,s65,s64
v_readlane_b32 s64,v17,9
s_lshr_b32 s64,s64,8
s_add_u32 s65,s65,s64
v_readlane_b32 s64,v17,11
s_lshr_b32 s64,s64,8
s_add_u32 s65,s65,s64
v_readlane_b32 s64,v17,13
s_lshr_b32 s64,s64,8
s_add_u32 s65,s65,s64
v_readlane_b32 s64,v17,15
s_lshr_b32 s64,s64,8
s_add_u32 s65,s65,s64
s_cmp_ge_u32 s65,256
s_cbranch_scc1 vok_394
s_branch vrt_393
vck_392:
v_cmp_gt_u32 vcc,v18,v17
s_cbranch_vccz vok_394
vrt_393:
s_sleep 8
s_sub_u32 s90,s90,1
s_cmp_gt_i32 s90,0
s_cbranch_scc1 vpoll_391
vok_394:
v_add_u32 v18,161280,v16
ds_write_b32 v18,v17
s_waitcnt lgkmcnt(0)
vot_395:
s_barrier
v_add_u32 v18,161280,v16
ds_read_b32 v17,v18
s_waitcnt lgkmcnt(0)
s_cmp_lg_u32 s56,2
s_cbranch_scc1 vfin_396
v_cmp_eq_u32 vcc,v17,v19
s_and_b32 s64,vcc_lo,0xffff
s_cmp_eq_u32 s64,65535
s_cbranch_scc1 vfin_396
s_mov_b32 s65,0
v_readlane_b32 s64,v17,1
s_lshr_b32 s64,s64,8
s_add_u32 s65,s65,s64
v_readlane_b32 s64,v17,3
s_lshr_b32 s64,s64,8
s_add_u32 s65,s65,s64
v_readlane_b32 s64,v17,5
s_lshr_b32 s64,s64,8
s_add_u32 s65,s65,s64
v_readlane_b32 s64,v17,7
s_lshr_b32 s64,s64,8
s_add_u32 s65,s65,s64
v_readlane_b32 s64,v17,9
s_lshr_b32 s64,s64,8
s_add_u32 s65,s65,s64
v_readlane_b32 s64,v17,11
s_lshr_b32 s64,s64,8
s_add_u32 s65,s65,s64
v_readlane_b32 s64,v17,13
s_lshr_b32 s64,s64,8
s_add_u32 s65,s65,s64
v_readlane_b32 s64,v17,15
s_lshr_b32 s64,s64,8
s_add_u32 s65,s65,s64
s_cmp_ge_u32 s65,256
s_cbranch_scc1 fl_fb
vfin_396:
s_and_b32 s56,s56,1
s_mov_b32 s67,0
v_readlane_b32 s65,v17,21
s_and_b32 s65,s65,2
s_lshl_b32 s67,s65,12
v_lshlrev_b32 v0,4,v1
v_and_b32 v21,15,v1
v_lshrrev_b32 v22,4,v1
v_and_b32 v23,7,v21
v_lshlrev_b32 v23,4,v23
v_lshl_add_u32 v3,v22,8,v23
v_and_b32 v23,31,v1
v_lshlrev_b32 v4,4,v23
v_and_b32 v23,3,v1
v_bfe_u32 v24,v1,2,1
v_lshlrev_b32 v23,14,v23
v_lshl_add_u32 v2,v24,7,v23
v_mov_b32 v7,0xff800000
s_and_b32 s54,s50,1
s_lshl_b32 s64,s54,4
v_lshlrev_b32 v23,2,v22
v_sub_u32 v23,v21,v23
v_add_u32 v23,s64,v23
v_cmp_le_i32 s[28:29],0,v23
v_cmp_le_i32 s[30:31],1,v23
v_cmp_le_i32 s[32:33],2,v23
v_cmp_le_i32 s[34:35],3,v23
v_cmp_le_i32 s[36:37],16,v23
v_cmp_le_i32 s[38:39],17,v23
v_cmp_le_i32 s[40:41],18,v23
v_cmp_le_i32 s[42:43],19,v23
s_mov_b32 s44,-1
s_mov_b32 s45,0
s_mov_b32 s80,0x3e0293ee
s_lshl_b32 s52,s59,1
s_lshr_b32 s64,s50,1
s_add_u32 s52,s52,s64
s_lshl_b32 s53,s52,15
s_lshl_b32 s68,s52,8
s_add_u32 s68,s68,s67
s_add_u32 s68,s68,138428416
s_lshl_b32 s69,s59,8
s_lshl_b32 s64,s64,2
s_add_u32 s69,s69,s64
s_lshl_b32 s64,s54,3
s_add_u32 s69,s69,s64
s_add_u32 s69,s69,138543104
s_lshl_b32 s66,s52,12
s_lshl_b32 s64,s54,17
s_add_u32 s66,s66,s64
s_add_u32 s66,s66,150994944
s_lshl_b32 s55,s54,10
s_xor_b32 s55,s55,0x2000
s_mov_b32 s60,0
s_add_u32 s64,s69,16
v_mov_b32 v6,124
s_mov_b64 exec,1
buffer_store_dword v6,off,s[20:23],s64 sc1
s_mov_b64 exec,-1
s_add_u32 s64,s69,32
v_mov_b32 v6,126
s_mov_b64 exec,1
buffer_store_dword v6,off,s[20:23],s64 sc1
s_mov_b64 exec,-1
s_mov_b32 s71,1
plp_397:
buffer_load_dword v5,v2,s[20:23],s68 offen sc1
s_waitcnt vmcnt(0)
v_cmp_gt_u32 vcc,s71,v5
s_cbranch_vccz pok_398
s_sleep 4
s_sub_u32 s90,s90,1
s_cmp_gt_i32 s90,0
s_cbranch_scc1 plp_397
pok_398:
s_add_u32 s64,s60,0
s_lshl_b32 s65,s64,11
s_and_b32 s65,s65,0x2000
s_xor_b32 s65,s65,s67
s_lshl_b32 s64,s64,19
s_add_u32 s64,s64,s65
s_add_u32 s92,s64,s53
s_add_u32 s93,s92,16384
s_add_u32 s94,s92,4096
s_add_u32 s95,s93,4096
s_xor_b32 s96,s92,s55
s_xor_b32 s97,s93,s55
buffer_load_dwordx4 a[0:3],v0,s[20:23],s96 offen offset:0
buffer_load_dwordx4 a[16:19],v0,s[20:23],s92 offen offset:0
buffer_load_dwordx4 a[32:35],v0,s[20:23],s92 offen offset:1024
buffer_load_dwordx4 a[4:7],v0,s[20:23],s96 offen offset:2048
buffer_load_dwordx4 a[20:23],v0,s[20:23],s92 offen offset:2048
buffer_load_dwordx4 a[36:39],v0,s[20:23],s92 offen offset:3072
buffer_load_dwordx4 a[8:11],v0,s[20:23],s97 offen offset:0
buffer_load_dwordx4 a[24:27],v0,s[20:23],s93 offen offset:0
buffer_load_dwordx4 a[40:43],v0,s[20:23],s93 offen offset:1024
buffer_load_dwordx4 a[12:15],v0,s[20:23],s97 offen offset:2048
buffer_load_dwordx4 a[28:31],v0,s[20:23],s93 offen offset:2048
buffer_load_dwordx4 a[44:47],v0,s[20:23],s93 offen offset:3072
buffer_load_dwordx4 a[48:51],v0,s[20:23],s94 offen offset:0
buffer_load_dwordx4 a[52:55],v0,s[20:23],s94 offen offset:1024
buffer_load_dwordx4 a[56:59],v0,s[20:23],s94 offen offset:2048
buffer_load_dwordx4 a[60:63],v0,s[20:23],s94 offen offset:3072
buffer_load_dwordx4 a[64:67],v0,s[20:23],s95 offen offset:0
buffer_load_dwordx4 a[68:71],v0,s[20:23],s95 offen offset:1024
buffer_load_dwordx4 a[72:75],v0,s[20:23],s95 offen offset:2048
buffer_load_dwordx4 a[76:79],v0,s[20:23],s95 offen offset:3072
s_waitcnt vmcnt(8)
top0_399:
v_mfma_f32_16x16x32_bf16 v[48:51],a[16:19],a[0:3],0
v_mfma_f32_16x16x32_bf16 v[52:55],a[32:35],a[0:3],0
v_mfma_f32_16x16x32_bf16 v[48:51],a[20:23],a[4:7],v[48:51]
v_mfma_f32_16x16x32_bf16 v[52:55],a[36:39],a[4:7],v[52:55]
v_mfma_f32_16x16x32_bf16 v[48:51],a[24:27],a[8:11],v[48:51]
v_mfma_f32_16x16x32_bf16 v[52:55],a[40:43],a[8:11],v[52:55]
v_mfma_f32_16x16x32_bf16 v[48:51],a[28:31],a[12:15],v[48:51]
v_mfma_f32_16x16x32_bf16 v[52:55],a[44:47],a[12:15],v[52:55]
s_nop 6
v_cndmask_b32 v48,v7,v48,s[28:29]
v_cndmask_b32 v49,v7,v49,s[30:31]
v_cndmask_b32 v50,v7,v50,s[32:33]
v_cndmask_b32 v51,v7,v51,s[34:35]
v_cndmask_b32 v52,v7,v52,s[36:37]
v_cndmask_b32 v53,v7,v53,s[38:39]
v_cndmask_b32 v54,v7,v54,s[40:41]
v_cndmask_b32 v55,v7,v55,s[42:43]
v_max3_f32 v72,v48,v49,v50
v_max3_f32 v72,v72,v51,v52
v_max3_f32 v72,v72,v53,v54
v_max_f32 v72,v72,v55
s_add_u32 s64,s60,0
s_lshl_b32 s65,s64,11
s_and_b32 s65,s65,0x2000
s_xor_b32 s65,s65,s67
s_lshl_b32 s64,s64,19
s_add_u32 s64,s64,s65
s_add_u32 s98,s64,s53
s_add_u32 s98,s98,67108864
s_add_u32 s99,s98,16384
s_lshr_b32 s71,s60,1
s_add_u32 s71,s71,1
s_waitcnt vmcnt(1)
v_cmp_gt_u32 vcc,s71,v5
s_cbranch_vccz ek_401
plp_404:
buffer_load_dword v5,v2,s[20:23],s68 offen sc1
s_waitcnt vmcnt(0)
v_cmp_gt_u32 vcc,s71,v5
s_cbranch_vccz pok_405
s_sleep 4
s_sub_u32 s90,s90,1
s_cmp_gt_i32 s90,0
s_cbranch_scc1 plp_404
pok_405:
ek_401:
buffer_load_dwordx4 v[16:19],v3,s[20:23],s98 offen offset:0
buffer_load_dwordx4 v[20:23],v3,s[20:23],s98 offen offset:128
buffer_load_dwordx4 v[24:27],v3,s[20:23],s99 offen offset:0
buffer_load_dwordx4 v[28:31],v3,s[20:23],s99 offen offset:128
buffer_load_dwordx4 v[32:35],v4,s[20:23],s98 offen offset:1024
buffer_load_dwordx4 v[36:39],v4,s[20:23],s98 offen offset:1536
buffer_load_dwordx4 v[40:43],v4,s[20:23],s99 offen offset:1024
buffer_load_dwordx4 v[44:47],v4,s[20:23],s99 offen offset:1536
s_barrier
s_add_u32 s64,s60,2
s_lshl_b32 s65,s64,11
s_and_b32 s65,s65,0x2000
s_xor_b32 s65,s65,s67
s_lshl_b32 s64,s64,19
s_add_u32 s64,s64,s65
s_add_u32 s92,s64,s53
s_add_u32 s93,s92,16384
s_add_u32 s94,s92,4096
s_add_u32 s95,s93,4096
s_xor_b32 s96,s92,s55
s_xor_b32 s97,s93,s55
buffer_load_dwordx4 a[80:83],v0,s[20:23],s96 offen offset:0
buffer_load_dwordx4 a[96:99],v0,s[20:23],s92 offen offset:0
buffer_load_dwordx4 a[112:115],v0,s[20:23],s92 offen offset:1024
buffer_load_dwordx4 a[84:87],v0,s[20:23],s96 offen offset:2048
buffer_load_dwordx4 a[100:103],v0,s[20:23],s92 offen offset:2048
buffer_load_dwordx4 a[116:119],v0,s[20:23],s92 offen offset:3072
buffer_load_dwordx4 a[88:91],v0,s[20:23],s97 offen offset:0
buffer_load_dwordx4 a[104:107],v0,s[20:23],s93 offen offset:0
buffer_load_dwordx4 a[120:123],v0,s[20:23],s93 offen offset:1024
buffer_load_dwordx4 a[92:95],v0,s[20:23],s97 offen offset:2048
buffer_load_dwordx4 a[108:111],v0,s[20:23],s93 offen offset:2048
buffer_load_dwordx4 a[124:127],v0,s[20:23],s93 offen offset:3072
s_waitcnt vmcnt(16)
v_mfma_f32_16x16x32_bf16 v[56:59],v[16:19],a[0:3],0
v_mfma_f32_16x16x32_bf16 v[56:59],v[20:23],a[4:7],v[56:59]
v_mfma_f32_16x16x32_bf16 v[56:59],v[24:27],a[8:11],v[56:59]
v_mfma_f32_16x16x32_bf16 v[56:59],v[28:31],a[12:15],v[56:59]
s_nop 7
v_cndmask_b32 v56,v7,v56,s[44:45]
v_cndmask_b32 v57,v7,v57,s[44:45]
v_cndmask_b32 v58,v7,v58,s[44:45]
v_cndmask_b32 v59,v7,v59,s[44:45]
v_max3_f32 v72,v72,v56,v57
v_max3_f32 v72,v72,v58,v59
v_mov_b32 v73,v72
s_nop 1
v_permlane16_swap_b32 v73,v72
v_max_f32 v72,v72,v73
v_mov_b32 v73,v72
s_nop 1
v_permlane32_swap_b32 v73,v72
v_max_f32 v72,v72,v73
v_mul_f32 v72,s80,v72
v_fma_f32 v48,v48,s80,-v72
v_fma_f32 v49,v49,s80,-v72
v_fma_f32 v50,v50,s80,-v72
v_fma_f32 v51,v51,s80,-v72
v_fma_f32 v52,v52,s80,-v72
v_fma_f32 v53,v53,s80,-v72
v_fma_f32 v54,v54,s80,-v72
v_fma_f32 v55,v55,s80,-v72
v_fma_f32 v56,v56,s80,-v72
v_fma_f32 v57,v57,s80,-v72
v_fma_f32 v58,v58,s80,-v72
v_fma_f32 v59,v59,s80,-v72
v_exp_f32 v48,v48
v_exp_f32 v49,v49
v_exp_f32 v50,v50
v_exp_f32 v51,v51
v_exp_f32 v52,v52
v_exp_f32 v53,v53
v_exp_f32 v54,v54
v_exp_f32 v55,v55
v_exp_f32 v56,v56
v_exp_f32 v57,v57
v_exp_f32 v58,v58
v_exp_f32 v59,v59
v_add_f32 v74,v48,v49
v_add_f32 v75,v50,v51
v_add_f32 v74,v74,v52
v_add_f32 v75,v75,v53
v_add_f32 v74,v74,v54
v_add_f32 v75,v75,v55
v_add_f32 v74,v74,v56
v_add_f32 v75,v75,v57
v_add_f32 v74,v74,v58
v_add_f32 v75,v75,v59
v_add_f32 v74,v74,v75
v_mov_b32 v73,v74
s_nop 1
v_permlane16_swap_b32 v73,v74
v_add_f32 v74,v74,v73
v_mov_b32 v73,v74
s_nop 1
v_permlane32_swap_b32 v73,v74
v_add_f32 v74,v74,v73
v_rcp_f32 v75,v74
s_nop 0
v_mul_f32 v48,v48,v75
v_mul_f32 v49,v49,v75
v_mul_f32 v50,v50,v75
v_mul_f32 v51,v51,v75
v_mul_f32 v52,v52,v75
v_mul_f32 v53,v53,v75
v_mul_f32 v54,v54,v75
v_mul_f32 v55,v55,v75
v_mul_f32 v56,v56,v75
v_mul_f32 v57,v57,v75
v_mul_f32 v58,v58,v75
v_mul_f32 v59,v59,v75
v_cvt_pk_bf16_f32 v64,v48,v49
v_cvt_pk_bf16_f32 v65,v50,v51
v_cvt_pk_bf16_f32 v66,v52,v53
v_cvt_pk_bf16_f32 v67,v54,v55
v_cvt_pk_bf16_f32 v68,v56,v57
v_cvt_pk_bf16_f32 v69,v58,v59
v_mfma_f32_16x16x32_bf16 v[80:83],a[48:51],v[64:67],0
v_mfma_f32_16x16x32_bf16 v[84:87],a[52:55],v[64:67],0
v_mfma_f32_16x16x32_bf16 v[88:91],a[56:59],v[64:67],0
v_mfma_f32_16x16x32_bf16 v[92:95],a[60:63],v[64:67],0
v_mfma_f32_16x16x32_bf16 v[96:99],a[64:67],v[64:67],0
v_mfma_f32_16x16x32_bf16 v[100:103],a[68:71],v[64:67],0
v_mfma_f32_16x16x32_bf16 v[104:107],a[72:75],v[64:67],0
v_mfma_f32_16x16x32_bf16 v[108:111],a[76:79],v[64:67],0
s_waitcnt vmcnt(12)
v_mfma_f32_16x16x16_bf16 v[80:83],v[32:33],v[68:69],v[80:83]
v_mfma_f32_16x16x16_bf16 v[84:87],v[34:35],v[68:69],v[84:87]
v_mfma_f32_16x16x16_bf16 v[88:91],v[36:37],v[68:69],v[88:91]
v_mfma_f32_16x16x16_bf16 v[92:95],v[38:39],v[68:69],v[92:95]
v_mfma_f32_16x16x16_bf16 v[96:99],v[40:41],v[68:69],v[96:99]
v_mfma_f32_16x16x16_bf16 v[100:103],v[42:43],v[68:69],v[100:103]
v_mfma_f32_16x16x16_bf16 v[104:107],v[44:45],v[68:69],v[104:107]
v_mfma_f32_16x16x16_bf16 v[108:111],v[46:47],v[68:69],v[108:111]
s_nop 0
v_cvt_pk_bf16_f32 v112,v80,v81
v_cvt_pk_bf16_f32 v113,v82,v83
v_cvt_pk_bf16_f32 v114,v84,v85
v_cvt_pk_bf16_f32 v115,v86,v87
buffer_store_dwordx4 v[112:115],v0,s[20:23],s66 offen offset:0 sc1
v_cvt_pk_bf16_f32 v116,v88,v89
v_cvt_pk_bf16_f32 v117,v90,v91
v_cvt_pk_bf16_f32 v118,v92,v93
v_cvt_pk_bf16_f32 v119,v94,v95
buffer_store_dwordx4 v[116:119],v0,s[20:23],s66 offen offset:1024 sc1
v_cvt_pk_bf16_f32 v112,v96,v97
v_cvt_pk_bf16_f32 v113,v98,v99
v_cvt_pk_bf16_f32 v114,v100,v101
v_cvt_pk_bf16_f32 v115,v102,v103
buffer_store_dwordx4 v[112:115],v0,s[20:23],s66 offen offset:2048 sc1
v_cvt_pk_bf16_f32 v116,v104,v105
v_cvt_pk_bf16_f32 v117,v106,v107
v_cvt_pk_bf16_f32 v118,v108,v109
v_cvt_pk_bf16_f32 v119,v110,v111
buffer_store_dwordx4 v[116:119],v0,s[20:23],s66 offen offset:3072 sc1
s_barrier
buffer_load_dwordx4 a[128:131],v0,s[20:23],s94 offen offset:0
buffer_load_dwordx4 a[132:135],v0,s[20:23],s94 offen offset:1024
buffer_load_dwordx4 a[136:139],v0,s[20:23],s94 offen offset:2048
buffer_load_dwordx4 a[140:143],v0,s[20:23],s94 offen offset:3072
buffer_load_dwordx4 a[144:147],v0,s[20:23],s95 offen offset:0
buffer_load_dwordx4 a[148:151],v0,s[20:23],s95 offen offset:1024
buffer_load_dwordx4 a[152:155],v0,s[20:23],s95 offen offset:2048
buffer_load_dwordx4 a[156:159],v0,s[20:23],s95 offen offset:3072
buffer_load_dword v5,v2,s[20:23],s68 offen sc1
s_add_u32 s66,s66,262144
s_add_u32 s60,s60,2
s_add_u32 s72,s60,s54
s_waitcnt vmcnt(9)
v_mov_b32 v6,s72
s_mov_b64 exec,1
buffer_store_dword v6,off,s[20:23],s69 sc1
s_mov_b64 exec,-1
top1_400:
v_mfma_f32_16x16x32_bf16 v[48:51],a[96:99],a[80:83],0
v_mfma_f32_16x16x32_bf16 v[52:55],a[112:115],a[80:83],0
v_mfma_f32_16x16x32_bf16 v[48:51],a[100:103],a[84:87],v[48:51]
v_mfma_f32_16x16x32_bf16 v[52:55],a[116:119],a[84:87],v[52:55]
v_mfma_f32_16x16x32_bf16 v[48:51],a[104:107],a[88:91],v[48:51]
v_mfma_f32_16x16x32_bf16 v[52:55],a[120:123],a[88:91],v[52:55]
v_mfma_f32_16x16x32_bf16 v[48:51],a[108:111],a[92:95],v[48:51]
v_mfma_f32_16x16x32_bf16 v[52:55],a[124:127],a[92:95],v[52:55]
s_nop 6
v_cndmask_b32 v48,v7,v48,s[28:29]
v_cndmask_b32 v49,v7,v49,s[30:31]
v_cndmask_b32 v50,v7,v50,s[32:33]
v_cndmask_b32 v51,v7,v51,s[34:35]
v_cndmask_b32 v52,v7,v52,s[36:37]
v_cndmask_b32 v53,v7,v53,s[38:39]
v_cndmask_b32 v54,v7,v54,s[40:41]
v_cndmask_b32 v55,v7,v55,s[42:43]
v_max3_f32 v72,v48,v49,v50
v_max3_f32 v72,v72,v51,v52
v_max3_f32 v72,v72,v53,v54
v_max_f32 v72,v72,v55
s_add_u32 s64,s60,0
s_lshl_b32 s65,s64,11
s_and_b32 s65,s65,0x2000
s_xor_b32 s65,s65,s67
s_lshl_b32 s64,s64,19
s_add_u32 s64,s64,s65
s_add_u32 s98,s64,s53
s_add_u32 s98,s98,67108864
s_add_u32 s99,s98,16384
s_lshr_b32 s71,s60,1
s_add_u32 s71,s71,1
s_waitcnt vmcnt(1)
v_cmp_gt_u32 vcc,s71,v5
s_cbranch_vccz ek_406
plp_409:
buffer_load_dword v5,v2,s[20:23],s68 offen sc1
s_waitcnt vmcnt(0)
v_cmp_gt_u32 vcc,s71,v5
s_cbranch_vccz pok_410
s_sleep 4
s_sub_u32 s90,s90,1
s_cmp_gt_i32 s90,0
s_cbranch_scc1 plp_409
pok_410:
ek_406:
buffer_load_dwordx4 v[16:19],v3,s[20:23],s98 offen offset:0
buffer_load_dwordx4 v[20:23],v3,s[20:23],s98 offen offset:128
buffer_load_dwordx4 v[24:27],v3,s[20:23],s99 offen offset:0
buffer_load_dwordx4 v[28:31],v3,s[20:23],s99 offen offset:128
buffer_load_dwordx4 v[32:35],v4,s[20:23],s98 offen offset:1024
buffer_load_dwordx4 v[36:39],v4,s[20:23],s98 offen offset:1536
buffer_load_dwordx4 v[40:43],v4,s[20:23],s99 offen offset:1024
buffer_load_dwordx4 v[44:47],v4,s[20:23],s99 offen offset:1536
s_barrier
s_cmp_lt_u32 s60,122
s_cbranch_scc1 pf_411
s_waitcnt vmcnt(0)
s_branch j1_412
pf_411:
s_add_u32 s64,s60,2
s_lshl_b32 s65,s64,11
s_and_b32 s65,s65,0x2000
s_xor_b32 s65,s65,s67
s_lshl_b32 s64,s64,19
s_add_u32 s64,s64,s65
s_add_u32 s92,s64,s53
s_add_u32 s93,s92,16384
s_add_u32 s94,s92,4096
s_add_u32 s95,s93,4096
s_xor_b32 s96,s92,s55
s_xor_b32 s97,s93,s55
buffer_load_dwordx4 a[0:3],v0,s[20:23],s96 offen offset:0
buffer_load_dwordx4 a[16:19],v0,s[20:23],s92 offen offset:0
buffer_load_dwordx4 a[32:35],v0,s[20:23],s92 offen offset:1024
buffer_load_dwordx4 a[4:7],v0,s[20:23],s96 offen offset:2048
buffer_load_dwordx4 a[20:23],v0,s[20:23],s92 offen offset:2048
buffer_load_dwordx4 a[36:39],v0,s[20:23],s92 offen offset:3072
buffer_load_dwordx4 a[8:11],v0,s[20:23],s97 offen offset:0
buffer_load_dwordx4 a[24:27],v0,s[20:23],s93 offen offset:0
buffer_load_dwordx4 a[40:43],v0,s[20:23],s93 offen offset:1024
buffer_load_dwordx4 a[12:15],v0,s[20:23],s97 offen offset:2048
buffer_load_dwordx4 a[28:31],v0,s[20:23],s93 offen offset:2048
buffer_load_dwordx4 a[44:47],v0,s[20:23],s93 offen offset:3072
j1_412:
s_waitcnt vmcnt(16)
v_mfma_f32_16x16x32_bf16 v[56:59],v[16:19],a[80:83],0
v_mfma_f32_16x16x32_bf16 v[56:59],v[20:23],a[84:87],v[56:59]
v_mfma_f32_16x16x32_bf16 v[56:59],v[24:27],a[88:91],v[56:59]
v_mfma_f32_16x16x32_bf16 v[56:59],v[28:31],a[92:95],v[56:59]
s_nop 7
v_cndmask_b32 v56,v7,v56,s[44:45]
v_cndmask_b32 v57,v7,v57,s[44:45]
v_cndmask_b32 v58,v7,v58,s[44:45]
v_cndmask_b32 v59,v7,v59,s[44:45]
v_max3_f32 v72,v72,v56,v57
v_max3_f32 v72,v72,v58,v59
v_mov_b32 v73,v72
s_nop 1
v_permlane16_swap_b32 v73,v72
v_max_f32 v72,v72,v73
v_mov_b32 v73,v72
s_nop 1
v_permlane32_swap_b32 v73,v72
v_max_f32 v72,v72,v73
v_mul_f32 v72,s80,v72
v_fma_f32 v48,v48,s80,-v72
v_fma_f32 v49,v49,s80,-v72
v_fma_f32 v50,v50,s80,-v72
v_fma_f32 v51,v51,s80,-v72
v_fma_f32 v52,v52,s80,-v72
v_fma_f32 v53,v53,s80,-v72
v_fma_f32 v54,v54,s80,-v72
v_fma_f32 v55,v55,s80,-v72
v_fma_f32 v56,v56,s80,-v72
v_fma_f32 v57,v57,s80,-v72
v_fma_f32 v58,v58,s80,-v72
v_fma_f32 v59,v59,s80,-v72
v_exp_f32 v48,v48
v_exp_f32 v49,v49
v_exp_f32 v50,v50
v_exp_f32 v51,v51
v_exp_f32 v52,v52
v_exp_f32 v53,v53
v_exp_f32 v54,v54
v_exp_f32 v55,v55
v_exp_f32 v56,v56
v_exp_f32 v57,v57
v_exp_f32 v58,v58
v_exp_f32 v59,v59
v_add_f32 v74,v48,v49
v_add_f32 v75,v50,v51
v_add_f32 v74,v74,v52
v_add_f32 v75,v75,v53
v_add_f32 v74,v74,v54
v_add_f32 v75,v75,v55
v_add_f32 v74,v74,v56
v_add_f32 v75,v75,v57
v_add_f32 v74,v74,v58
v_add_f32 v75,v75,v59
v_add_f32 v74,v74,v75
v_mov_b32 v73,v74
s_nop 1
v_permlane16_swap_b32 v73,v74
v_add_f32 v74,v74,v73
v_mov_b32 v73,v74
s_nop 1
v_permlane32_swap_b32 v73,v74
v_add_f32 v74,v74,v73
v_rcp_f32 v75,v74
s_nop 0
v_mul_f32 v48,v48,v75
v_mul_f32 v49,v49,v75
v_mul_f32 v50,v50,v75
v_mul_f32 v51,v51,v75
v_mul_f32 v52,v52,v75
v_mul_f32 v53,v53,v75
v_mul_f32 v54,v54,v75
v_mul_f32 v55,v55,v75
v_mul_f32 v56,v56,v75
v_mul_f32 v57,v57,v75
v_mul_f32 v58,v58,v75
v_mul_f32 v59,v59,v75
v_cvt_pk_bf16_f32 v64,v48,v49
v_cvt_pk_bf16_f32 v65,v50,v51
v_cvt_pk_bf16_f32 v66,v52,v53
v_cvt_pk_bf16_f32 v67,v54,v55
v_cvt_pk_bf16_f32 v68,v56,v57
v_cvt_pk_bf16_f32 v69,v58,v59
v_mfma_f32_16x16x32_bf16 v[80:83],a[128:131],v[64:67],0
v_mfma_f32_16x16x32_bf16 v[84:87],a[132:135],v[64:67],0
v_mfma_f32_16x16x32_bf16 v[88:91],a[136:139],v[64:67],0
v_mfma_f32_16x16x32_bf16 v[92:95],a[140:143],v[64:67],0
v_mfma_f32_16x16x32_bf16 v[96:99],a[144:147],v[64:67],0
v_mfma_f32_16x16x32_bf16 v[100:103],a[148:151],v[64:67],0
v_mfma_f32_16x16x32_bf16 v[104:107],a[152:155],v[64:67],0
v_mfma_f32_16x16x32_bf16 v[108:111],a[156:159],v[64:67],0
s_waitcnt vmcnt(12)
v_mfma_f32_16x16x16_bf16 v[80:83],v[32:33],v[68:69],v[80:83]
v_mfma_f32_16x16x16_bf16 v[84:87],v[34:35],v[68:69],v[84:87]
v_mfma_f32_16x16x16_bf16 v[88:91],v[36:37],v[68:69],v[88:91]
v_mfma_f32_16x16x16_bf16 v[92:95],v[38:39],v[68:69],v[92:95]
v_mfma_f32_16x16x16_bf16 v[96:99],v[40:41],v[68:69],v[96:99]
v_mfma_f32_16x16x16_bf16 v[100:103],v[42:43],v[68:69],v[100:103]
v_mfma_f32_16x16x16_bf16 v[104:107],v[44:45],v[68:69],v[104:107]
v_mfma_f32_16x16x16_bf16 v[108:111],v[46:47],v[68:69],v[108:111]
s_nop 0
v_cvt_pk_bf16_f32 v112,v80,v81
v_cvt_pk_bf16_f32 v113,v82,v83
v_cvt_pk_bf16_f32 v114,v84,v85
v_cvt_pk_bf16_f32 v115,v86,v87
buffer_store_dwordx4 v[112:115],v0,s[20:23],s66 offen offset:0 sc1
v_cvt_pk_bf16_f32 v116,v88,v89
v_cvt_pk_bf16_f32 v117,v90,v91
v_cvt_pk_bf16_f32 v118,v92,v93
v_cvt_pk_bf16_f32 v119,v94,v95
buffer_store_dwordx4 v[116:119],v0,s[20:23],s66 offen offset:1024 sc1
v_cvt_pk_bf16_f32 v112,v96,v97
v_cvt_pk_bf16_f32 v113,v98,v99
v_cvt_pk_bf16_f32 v114,v100,v101
v_cvt_pk_bf16_f32 v115,v102,v103
buffer_store_dwordx4 v[112:115],v0,s[20:23],s66 offen offset:2048 sc1
v_cvt_pk_bf16_f32 v116,v104,v105
v_cvt_pk_bf16_f32 v117,v106,v107
v_cvt_pk_bf16_f32 v118,v108,v109
v_cvt_pk_bf16_f32 v119,v110,v111
buffer_store_dwordx4 v[116:119],v0,s[20:23],s66 offen offset:3072 sc1
s_barrier
s_cmp_lt_u32 s60,122
s_cbranch_scc1 pf_413
s_waitcnt vmcnt(0)
s_branch j1_414
pf_413:
buffer_load_dwordx4 a[48:51],v0,s[20:23],s94 offen offset:0
buffer_load_dwordx4 a[52:55],v0,s[20:23],s94 offen offset:1024
buffer_load_dwordx4 a[56:59],v0,s[20:23],s94 offen offset:2048
buffer_load_dwordx4 a[60:63],v0,s[20:23],s94 offen offset:3072
buffer_load_dwordx4 a[64:67],v0,s[20:23],s95 offen offset:0
buffer_load_dwordx4 a[68:71],v0,s[20:23],s95 offen offset:1024
buffer_load_dwordx4 a[72:75],v0,s[20:23],s95 offen offset:2048
buffer_load_dwordx4 a[76:79],v0,s[20:23],s95 offen offset:3072
j1_414:
buffer_load_dword v5,v2,s[20:23],s68 offen sc1
s_add_u32 s66,s66,262144
s_add_u32 s60,s60,2
s_add_u32 s72,s60,s54
s_cmp_eq_u32 s60,124
s_cselect_b32 s72,128,s72
s_waitcnt vmcnt(9)
v_mov_b32 v6,s72
s_mov_b64 exec,1
buffer_store_dword v6,off,s[20:23],s69 sc1
s_mov_b64 exec,-1
s_cmp_lt_u32 s60,124
s_cbranch_scc1 top0_399
s_endpgm
fl_att2:
s_lshr_b32 s46,s59,4
s_and_b32 s59,s59,15
v_mbcnt_lo_u32_b32 v1,-1,0
v_mbcnt_hi_u32_b32 v1,-1,v1
v_lshlrev_b32 v0,4,v1
v_and_b32 v21,15,v1
v_lshrrev_b32 v22,4,v1
v_and_b32 v23,7,v21
v_lshlrev_b32 v23,4,v23
v_lshl_add_u32 v3,v22,8,v23
v_and_b32 v23,31,v1
v_lshlrev_b32 v4,4,v23
v_and_b32 v23,3,v1
v_bfe_u32 v24,v1,2,1
v_lshlrev_b32 v23,14,v23
v_lshl_add_u32 v2,v24,7,v23
v_mov_b32 v7,0xff800000
s_and_b32 s54,s50,1
s_lshl_b32 s64,s54,4
v_lshlrev_b32 v23,2,v22
v_sub_u32 v23,v21,v23
v_add_u32 v23,s64,v23
v_cmp_le_i32 s[28:29],0,v23
v_cmp_le_i32 s[30:31],1,v23
v_cmp_le_i32 s[32:33],2,v23
v_cmp_le_i32 s[34:35],3,v23
v_cmp_le_i32 s[36:37],16,v23
v_cmp_le_i32 s[38:39],17,v23
v_cmp_le_i32 s[40:41],18,v23
v_cmp_le_i32 s[42:43],19,v23
s_mov_b32 s44,-1
s_mov_b32 s45,0
s_mov_b32 s80,0x3e0293ee
s_lshl_b32 s52,s59,1
s_lshr_b32 s64,s50,1
s_add_u32 s52,s52,s64
s_lshl_b32 s53,s52,15
s_lshl_b32 s68,s52,8
s_add_u32 s68,s68,s67
s_add_u32 s68,s68,138428416
s_lshl_b32 s69,s59,8
s_lshl_b32 s64,s64,2
s_add_u32 s69,s69,s64
s_lshl_b32 s64,s54,3
s_add_u32 s69,s69,s64
s_add_u32 s69,s69,138543104
s_lshl_b32 s66,s52,12
s_lshl_b32 s64,s54,17
s_add_u32 s66,s66,s64
s_add_u32 s66,s66,150994944
s_lshl_b32 s55,s54,10
s_xor_b32 s55,s55,0x2000
s_mov_b32 s60,0
s_lshl_b32 s60,s46,1
s_add_u32 s60,s60,124
s_lshl_b32 s64,s60,17
s_add_u32 s66,s66,s64
s_lshl_b32 s47,s52,7
s_add_u32 s47,s47,s67
s_add_u32 s47,s47,138412032
v_and_b32 v23,1,v1
v_lshlrev_b32 v23,6,v23
s_mov_b32 s71,64
plp_415:
buffer_load_dword v5,v23,s[20:23],s47 offen sc1
s_waitcnt vmcnt(0)
v_cmp_gt_u32 vcc,s71,v5
s_cbranch_vccz pok_416
s_sleep 16
s_sub_u32 s90,s90,1
s_cmp_gt_i32 s90,0
s_cbranch_scc1 plp_415
pok_416:
s_add_u32 s64,s60,0
s_lshl_b32 s65,s64,11
s_and_b32 s65,s65,0x2000
s_xor_b32 s65,s65,s67
s_lshl_b32 s64,s64,19
s_add_u32 s64,s64,s65
s_add_u32 s92,s64,s53
s_add_u32 s93,s92,16384
s_add_u32 s94,s92,4096
s_add_u32 s95,s93,4096
s_xor_b32 s96,s92,s55
s_xor_b32 s97,s93,s55
buffer_load_dwordx4 a[0:3],v0,s[20:23],s96 offen offset:0
buffer_load_dwordx4 a[16:19],v0,s[20:23],s92 offen offset:0
buffer_load_dwordx4 a[32:35],v0,s[20:23],s92 offen offset:1024
buffer_load_dwordx4 a[4:7],v0,s[20:23],s96 offen offset:2048
buffer_load_dwordx4 a[20:23],v0,s[20:23],s92 offen offset:2048
buffer_load_dwordx4 a[36:39],v0,s[20:23],s92 offen offset:3072
buffer_load_dwordx4 a[8:11],v0,s[20:23],s97 offen offset:0
buffer_load_dwordx4 a[24:27],v0,s[20:23],s93 offen offset:0
buffer_load_dwordx4 a[40:43],v0,s[20:23],s93 offen offset:1024
buffer_load_dwordx4 a[12:15],v0,s[20:23],s97 offen offset:2048
buffer_load_dwordx4 a[28:31],v0,s[20:23],s93 offen offset:2048
buffer_load_dwordx4 a[44:47],v0,s[20:23],s93 offen offset:3072
buffer_load_dwordx4 a[48:51],v0,s[20:23],s94 offen offset:0
buffer_load_dwordx4 a[52:55],v0,s[20:23],s94 offen offset:1024
buffer_load_dwordx4 a[56:59],v0,s[20:23],s94 offen offset:2048
buffer_load_dwordx4 a[60:63],v0,s[20:23],s94 offen offset:3072
buffer_load_dwordx4 a[64:67],v0,s[20:23],s95 offen offset:0
buffer_load_dwordx4 a[68:71],v0,s[20:23],s95 offen offset:1024
buffer_load_dwordx4 a[72:75],v0,s[20:23],s95 offen offset:2048
buffer_load_dwordx4 a[76:79],v0,s[20:23],s95 offen offset:3072
s_waitcnt vmcnt(8)
top0_417:
v_mfma_f32_16x16x32_bf16 v[48:51],a[16:19],a[0:3],0
v_mfma_f32_16x16x32_bf16 v[52:55],a[32:35],a[0:3],0
v_mfma_f32_16x16x32_bf16 v[48:51],a[20:23],a[4:7],v[48:51]
v_mfma_f32_16x16x32_bf16 v[52:55],a[36:39],a[4:7],v[52:55]
v_mfma_f32_16x16x32_bf16 v[48:51],a[24:27],a[8:11],v[48:51]
v_mfma_f32_16x16x32_bf16 v[52:55],a[40:43],a[8:11],v[52:55]
v_mfma_f32_16x16x32_bf16 v[48:51],a[28:31],a[12:15],v[48:51]
v_mfma_f32_16x16x32_bf16 v[52:55],a[44:47],a[12:15],v[52:55]
s_nop 6
v_cndmask_b32 v48,v7,v48,s[28:29]
v_cndmask_b32 v49,v7,v49,s[30:31]
v_cndmask_b32 v50,v7,v50,s[32:33]
v_cndmask_b32 v51,v7,v51,s[34:35]
v_cndmask_b32 v52,v7,v52,s[36:37]
v_cndmask_b32 v53,v7,v53,s[38:39]
v_cndmask_b32 v54,v7,v54,s[40:41]
v_cndmask_b32 v55,v7,v55,s[42:43]
v_max3_f32 v72,v48,v49,v50
v_max3_f32 v72,v72,v51,v52
v_max3_f32 v72,v72,v53,v54
v_max_f32 v72,v72,v55
s_add_u32 s64,s60,0
s_lshl_b32 s65,s64,11
s_and_b32 s65,s65,0x2000
s_xor_b32 s65,s65,s67
s_lshl_b32 s64,s64,19
s_add_u32 s64,s64,s65
s_add_u32 s98,s64,s53
s_mov_b32 s71,118
plp_419:
buffer_load_dword v5,off,s[20:23],s69 sc1
s_waitcnt vmcnt(0)
v_cmp_gt_u32 vcc,s71,v5
s_cbranch_vccz pok_420
s_sleep 32
s_sub_u32 s90,s90,1
s_cmp_gt_i32 s90,0
s_cbranch_scc1 plp_419
pok_420:
s_lshl_b32 s64,s46,4
s_add_u32 s69,s69,s64
s_add_u32 s69,s69,16
s_add_u32 s98,s98,67108864
s_add_u32 s99,s98,16384
s_lshr_b32 s71,s60,1
s_add_u32 s71,s71,1
s_min_u32 s71,s71,63
plp_424:
buffer_load_dword v5,v2,s[20:23],s68 offen sc1
s_waitcnt vmcnt(0)
v_cmp_gt_u32 vcc,s71,v5
s_cbranch_vccz pok_425
s_sleep 4
s_sub_u32 s90,s90,1
s_cmp_gt_i32 s90,0
s_cbranch_scc1 plp_424
pok_425:
s_cmp_eq_u32 s60,126
s_cbranch_scc1 kd_422
ek_421:
buffer_load_dwordx4 v[16:19],v3,s[20:23],s98 offen offset:0
buffer_load_dwordx4 v[20:23],v3,s[20:23],s98 offen offset:128
buffer_load_dwordx4 v[24:27],v3,s[20:23],s99 offen offset:0
buffer_load_dwordx4 v[28:31],v3,s[20:23],s99 offen offset:128
buffer_load_dwordx4 v[32:35],v4,s[20:23],s98 offen offset:1024
buffer_load_dwordx4 v[36:39],v4,s[20:23],s98 offen offset:1536
buffer_load_dwordx4 v[40:43],v4,s[20:23],s99 offen offset:1024
buffer_load_dwordx4 v[44:47],v4,s[20:23],s99 offen offset:1536
s_branch kj_423
kd_422:
buffer_load_dwordx4 v[16:19],v3,s[20:23],s98 offen offset:0 sc1
buffer_load_dwordx4 v[20:23],v3,s[20:23],s98 offen offset:128 sc1
buffer_load_dwordx4 v[24:27],v3,s[20:23],s99 offen offset:0 sc1
buffer_load_dwordx4 v[28:31],v3,s[20:23],s99 offen offset:128 sc1
buffer_load_dwordx4 v[32:35],v4,s[20:23],s98 offen offset:1024 sc1
buffer_load_dwordx4 v[36:39],v4,s[20:23],s98 offen offset:1536 sc1
buffer_load_dwordx4 v[40:43],v4,s[20:23],s99 offen offset:1024 sc1
buffer_load_dwordx4 v[44:47],v4,s[20:23],s99 offen offset:1536 sc1
s_waitcnt vmcnt(4)
v_max3_u32 v5,v16,v17,v18
v_max3_u32 v6,v24,v25,v26
v_max3_u32 v5,v5,v19,v20
v_max3_u32 v6,v6,v21,v22
v_max3_u32 v5,v5,v27,v28
v_max3_u32 v6,v6,v29,v30
s_waitcnt vmcnt(0)
v_max3_u32 v5,v5,v32,v33
v_max3_u32 v6,v6,v34,v35
v_max3_u32 v5,v5,v36,v37
v_max3_u32 v6,v6,v38,v39
v_max3_u32 v5,v5,v40,v41
v_max3_u32 v6,v6,v42,v43
v_max3_u32 v5,v5,v44,v45
v_max3_u32 v6,v6,v46,v47
v_max3_u32 v5,v5,v23,v31
v_max_u32 v5,v5,v6
v_cmp_eq_u32 vcc,-1,v5
s_cbranch_vccz kj_423
s_sleep 1
s_sub_u32 s90,s90,1
s_cmp_gt_i32 s90,0
s_cbranch_scc1 kd_422
kj_423:
s_waitcnt vmcnt(4)
v_mfma_f32_16x16x32_bf16 v[56:59],v[16:19],a[0:3],0
v_mfma_f32_16x16x32_bf16 v[56:59],v[20:23],a[4:7],v[56:59]
v_mfma_f32_16x16x32_bf16 v[56:59],v[24:27],a[8:11],v[56:59]
v_mfma_f32_16x16x32_bf16 v[56:59],v[28:31],a[12:15],v[56:59]
s_nop 7
v_cndmask_b32 v56,v7,v56,s[44:45]
v_cndmask_b32 v57,v7,v57,s[44:45]
v_cndmask_b32 v58,v7,v58,s[44:45]
v_cndmask_b32 v59,v7,v59,s[44:45]
v_max3_f32 v72,v72,v56,v57
v_max3_f32 v72,v72,v58,v59
v_mov_b32 v73,v72
s_nop 1
v_permlane16_swap_b32 v73,v72
v_max_f32 v72,v72,v73
v_mov_b32 v73,v72
s_nop 1
v_permlane32_swap_b32 v73,v72
v_max_f32 v72,v72,v73
v_mul_f32 v72,s80,v72
v_fma_f32 v48,v48,s80,-v72
v_fma_f32 v49,v49,s80,-v72
v_fma_f32 v50,v50,s80,-v72
v_fma_f32 v51,v51,s80,-v72
v_fma_f32 v52,v52,s80,-v72
v_fma_f32 v53,v53,s80,-v72
v_fma_f32 v54,v54,s80,-v72
v_fma_f32 v55,v55,s80,-v72
v_fma_f32 v56,v56,s80,-v72
v_fma_f32 v57,v57,s80,-v72
v_fma_f32 v58,v58,s80,-v72
v_fma_f32 v59,v59,s80,-v72
v_exp_f32 v48,v48
v_exp_f32 v49,v49
v_exp_f32 v50,v50
v_exp_f32 v51,v51
v_exp_f32 v52,v52
v_exp_f32 v53,v53
v_exp_f32 v54,v54
v_exp_f32 v55,v55
v_exp_f32 v56,v56
v_exp_f32 v57,v57
v_exp_f32 v58,v58
v_exp_f32 v59,v59
v_add_f32 v74,v48,v49
v_add_f32 v75,v50,v51
v_add_f32 v74,v74,v52
v_add_f32 v75,v75,v53
v_add_f32 v74,v74,v54
v_add_f32 v75,v75,v55
v_add_f32 v74,v74,v56
v_add_f32 v75,v75,v57
v_add_f32 v74,v74,v58
v_add_f32 v75,v75,v59
v_add_f32 v74,v74,v75
v_mov_b32 v73,v74
s_nop 1
v_permlane16_swap_b32 v73,v74
v_add_f32 v74,v74,v73
v_mov_b32 v73,v74
s_nop 1
v_permlane32_swap_b32 v73,v74
v_add_f32 v74,v74,v73
v_rcp_f32 v75,v74
s_nop 0
v_mul_f32 v48,v48,v75
v_mul_f32 v49,v49,v75
v_mul_f32 v50,v50,v75
v_mul_f32 v51,v51,v75
v_mul_f32 v52,v52,v75
v_mul_f32 v53,v53,v75
v_mul_f32 v54,v54,v75
v_mul_f32 v55,v55,v75
v_mul_f32 v56,v56,v75
v_mul_f32 v57,v57,v75
v_mul_f32 v58,v58,v75
v_mul_f32 v59,v59,v75
v_cvt_pk_bf16_f32 v64,v48,v49
v_cvt_pk_bf16_f32 v65,v50,v51
v_cvt_pk_bf16_f32 v66,v52,v53
v_cvt_pk_bf16_f32 v67,v54,v55
v_cvt_pk_bf16_f32 v68,v56,v57
v_cvt_pk_bf16_f32 v69,v58,v59
v_mfma_f32_16x16x32_bf16 v[80:83],a[48:51],v[64:67],0
v_mfma_f32_16x16x32_bf16 v[84:87],a[52:55],v[64:67],0
v_mfma_f32_16x16x32_bf16 v[88:91],a[56:59],v[64:67],0
v_mfma_f32_16x16x32_bf16 v[92:95],a[60:63],v[64:67],0
v_mfma_f32_16x16x32_bf16 v[96:99],a[64:67],v[64:67],0
v_mfma_f32_16x16x32_bf16 v[100:103],a[68:71],v[64:67],0
v_mfma_f32_16x16x32_bf16 v[104:107],a[72:75],v[64:67],0
v_mfma_f32_16x16x32_bf16 v[108:111],a[76:79],v[64:67],0
s_waitcnt vmcnt(0)
v_mfma_f32_16x16x16_bf16 v[80:83],v[32:33],v[68:69],v[80:83]
v_mfma_f32_16x16x16_bf16 v[84:87],v[34:35],v[68:69],v[84:87]
v_mfma_f32_16x16x16_bf16 v[88:91],v[36:37],v[68:69],v[88:91]
v_mfma_f32_16x16x16_bf16 v[92:95],v[38:39],v[68:69],v[92:95]
v_mfma_f32_16x16x16_bf16 v[96:99],v[40:41],v[68:69],v[96:99]
v_mfma_f32_16x16x16_bf16 v[100:103],v[42:43],v[68:69],v[100:103]
v_mfma_f32_16x16x16_bf16 v[104:107],v[44:45],v[68:69],v[104:107]
v_mfma_f32_16x16x16_bf16 v[108:111],v[46:47],v[68:69],v[108:111]
s_nop 0
v_cvt_pk_bf16_f32 v112,v80,v81
v_cvt_pk_bf16_f32 v113,v82,v83
v_cvt_pk_bf16_f32 v114,v84,v85
v_cvt_pk_bf16_f32 v115,v86,v87
buffer_store_dwordx4 v[112:115],v0,s[20:23],s66 offen offset:0 sc1
v_cvt_pk_bf16_f32 v116,v88,v89
v_cvt_pk_bf16_f32 v117,v90,v91
v_cvt_pk_bf16_f32 v118,v92,v93
v_cvt_pk_bf16_f32 v119,v94,v95
buffer_store_dwordx4 v[116:119],v0,s[20:23],s66 offen offset:1024 sc1
v_cvt_pk_bf16_f32 v112,v96,v97
v_cvt_pk_bf16_f32 v113,v98,v99
v_cvt_pk_bf16_f32 v114,v100,v101
v_cvt_pk_bf16_f32 v115,v102,v103
buffer_store_dwordx4 v[112:115],v0,s[20:23],s66 offen offset:2048 sc1
v_cvt_pk_bf16_f32 v116,v104,v105
v_cvt_pk_bf16_f32 v117,v106,v107
v_cvt_pk_bf16_f32 v118,v108,v109
v_cvt_pk_bf16_f32 v119,v110,v111
buffer_store_dwordx4 v[116:119],v0,s[20:23],s66 offen offset:3072 sc1
s_waitcnt vmcnt(0)
v_mov_b32 v6,128
s_mov_b64 exec,1
buffer_store_dword v6,off,s[20:23],s69 sc1
s_mov_b64 exec,-1
s_endpgm
fl_rec:
s_load_dwordx8 s[4:11],s[0:1],8
s_load_dwordx2 s[12:13],s[0:1],40
s_mov_b32 s57,s58
v_mov_b32 v0,v1
s_waitcnt lgkmcnt(0)
s_mov_b32 s28,s6
s_and_b32 s29,s7,0xffff
s_mov_b32 s30,0x800000
s_mov_b32 s31,0x20000
s_mov_b32 s32,s8
s_and_b32 s33,s9,0xffff
s_mov_b32 s34,0x800000
s_mov_b32 s35,0x20000
s_mov_b32 s36,s10
s_and_b32 s37,s11,0xffff
s_mov_b32 s38,0x800000
s_mov_b32 s39,0x20000
s_mov_b32 s40,s12
s_and_b32 s41,s13,0xffff
s_mov_b32 s42,0x800000
s_mov_b32 s43,0x20000
s_mov_b32 s44,s4
s_and_b32 s45,s5,0xffff
s_mov_b32 s46,0x4000
s_mov_b32 s47,0x20000
s_lshr_b32 s58,s57,5
s_and_b32 s59,s57,31
v_and_b32 v20,63,v0
v_and_b32 v21,15,v20
v_lshrrev_b32 v22,4,v20
v_lshrrev_b32 v23,3,v20
v_and_b32 v24,7,v20
v_lshlrev_b32 v16,13,v23
v_lshl_add_u32 v16,v24,4,v16
v_lshrrev_b32 v23,2,v20
v_and_b32 v24,3,v20
v_lshlrev_b32 v17,11,v23
v_lshl_add_u32 v17,v24,4,v17
s_lshl_b32 s61,s50,15
s_add_u32 s61,s61,32768
s_lshl_b32 s62,s50,21
s_lshl_b32 s64,s57,7
s_add_u32 s62,s62,s64
s_lshl_b32 s63,s58,22
s_lshl_b32 s64,s50,20
s_add_u32 s63,s63,s64
s_lshl_b32 s64,s59,6
s_add_u32 s63,s63,s64
v_lshrrev_b32 v23,1,v22
v_lshlrev_b32 v25,4,v23
v_and_b32 v23,1,v22
v_lshl_add_u32 v25,v23,2,v25
v_lshrrev_b32 v23,3,v21
v_lshl_add_u32 v25,v23,3,v25
v_bfe_u32 v23,v21,2,1
v_add_u32 v25,v25,v23
v_lshlrev_b32 v28,4,v23
v_lshrrev_b32 v23,1,v22
v_lshl_add_u32 v28,v23,3,v28
v_lshrrev_b32 v23,3,v21
v_lshl_add_u32 v28,v23,2,v28
v_and_b32 v23,1,v22
v_lshl_add_u32 v28,v23,1,v28
v_and_b32 v24,3,v21
v_lshlrev_b32 v26,7,v28
v_add_u32 v26,s61,v26
v_lshl_add_u32 v18,v24,3,v26
v_lshl_add_u32 v19,v24,4,v26
v_lshlrev_b32 v26,6,v25
v_add_u32 v26,s61,v26
v_lshl_add_u32 v27,v24,3,v26
v_lshlrev_b32 v0,4,v20
v_add_u32 v7,s61,v0
s_and_b32 s64,s59,1
s_lshl_b32 s65,s64,18
s_add_u32 s70,s63,s65
s_sub_u32 s71,s63,s65
s_lshl_b32 s65,s64,13
s_add_u32 s72,s61,s65
s_sub_u32 s73,s61,s65
s_and_b32 s64,s57,7
s_lshl_b32 s65,s64,2
s_mov_b32 s66,0
s_lshl_b32 s65,s65,13
s_andn2_b32 s55,s57,7
s_lshl_b32 s55,s55,7
s_add_u32 s65,s65,s55
s_add_u32 s65,s65,384
v_and_b32 v29,3,v20
v_lshlrev_b32 v29,13,v29
v_add_u32 v29,s65,v29
v_and_b32 v15,4,v20
v_lshl_add_u32 v29,v15,4,v29
s_and_b32 s55,s57,31
s_add_u32 s66,s66,s55
s_lshl_b32 s66,s66,13
s_add_u32 s66,s66,8064
v_writelane_b32 v29,s66,8
s_add_u32 s66,s66,64
v_writelane_b32 v29,s66,9
s_cmp_eq_u32 s64,3
s_cselect_b32 s65,0,15
s_sub_u32 s66,s57,32
s_cmp_lt_u32 s66,31
s_cselect_b32 s66,256,0
s_or_b32 vcc_lo,s65,s66
s_mov_b32 vcc_hi,0
v_cndmask_b32 v29,-1,v29,vcc
s_lshl_b32 s68,s50,21
s_lshl_b32 s64,s58,22
s_lshl_b32 s65,s50,20
s_add_u32 s64,s64,s65
s_and_b32 s66,s59,15
s_lshl_b32 s65,s66,13
s_add_u32 s64,s64,s65
s_lshr_b32 s65,s59,4
s_lshl_b32 s65,s65,10
s_add_u32 s69,s64,s65
s_add_u32 s69,s69,384
s_lshr_b32 s66,s66,1
s_cmp_eq_u32 s66,3
s_cselect_b32 s65,0,4
v_and_b32 v30,3,v20
v_lshlrev_b32 v30,11,v30
v_and_b32 v31,4,v20
v_lshl_add_u32 v30,v31,4,v30
v_cmp_gt_u32 vcc,s65,v20
s_nop 1
v_cndmask_b32 v30,-1,v30,vcc
s_add_u32 s64,s68,262144
buffer_load_dword v31,v29,s[28:31],s64 offen
s_add_u32 s64,s68,524288
buffer_load_dword v31,v29,s[28:31],s64 offen
s_add_u32 s64,s68,786432
buffer_load_dword v31,v29,s[28:31],s64 offen
s_add_u32 s64,s62,0
s_add_u32 m0,s61,0
s_nop 0
buffer_load_dwordx4 v16,s[28:31],s64 offen lds
s_waitcnt vmcnt(10)
s_add_u32 s64,s62,65536
s_add_u32 m0,s61,1024
s_nop 0
buffer_load_dwordx4 v16,s[28:31],s64 offen lds
s_add_u32 s64,s68,1048576
buffer_load_dword v31,v29,s[28:31],s64 offen
s_waitcnt vmcnt(10)
s_add_u32 s64,s62,131072
s_add_u32 m0,s61,2048
s_nop 0
buffer_load_dwordx4 v16,s[28:31],s64 offen lds
s_waitcnt vmcnt(10)
s_add_u32 s64,s62,196608
s_add_u32 m0,s61,3072
s_nop 0
buffer_load_dwordx4 v16,s[28:31],s64 offen lds
s_waitcnt vmcnt(10)
s_add_u32 s64,s62,262144
s_add_u32 m0,s61,4096
s_nop 0
buffer_load_dwordx4 v16,s[28:31],s64 offen lds
s_waitcnt vmcnt(10)
s_add_u32 s64,s62,327680
s_add_u32 m0,s61,5120
s_nop 0
buffer_load_dwordx4 v16,s[28:31],s64 offen lds
s_add_u32 s64,s68,1310720
buffer_load_dword v31,v29,s[28:31],s64 offen
s_waitcnt vmcnt(10)
s_add_u32 s64,s62,393216
s_add_u32 m0,s61,6144
s_nop 0
buffer_load_dwordx4 v16,s[28:31],s64 offen lds
s_waitcnt vmcnt(10)
s_add_u32 s64,s62,458752
s_add_u32 m0,s61,7168
s_nop 0
buffer_load_dwordx4 v16,s[28:31],s64 offen lds
s_waitcnt vmcnt(10)
s_add_u32 s64,s62,524288
s_add_u32 m0,s61,8192
s_nop 0
buffer_load_dwordx4 v16,s[28:31],s64 offen lds
s_waitcnt vmcnt(10)
s_add_u32 s64,s62,589824
s_add_u32 m0,s61,9216
s_nop 0
buffer_load_dwordx4 v16,s[28:31],s64 offen lds
s_add_u32 s64,s68,1572864
buffer_load_dword v31,v29,s[28:31],s64 offen
s_waitcnt vmcnt(10)
s_add_u32 s64,s62,655360
s_add_u32 m0,s61,10240
s_nop 0
buffer_load_dwordx4 v16,s[28:31],s64 offen lds
s_waitcnt vmcnt(10)
s_add_u32 s64,s62,720896
s_add_u32 m0,s61,11264
s_nop 0
buffer_load_dwordx4 v16,s[28:31],s64 offen lds
s_waitcnt vmcnt(10)
s_add_u32 s64,s62,786432
s_add_u32 m0,s61,12288
s_nop 0
buffer_load_dwordx4 v16,s[28:31],s64 offen lds
s_waitcnt vmcnt(10)
s_add_u32 s64,s62,851968
s_add_u32 m0,s61,13312
s_nop 0
buffer_load_dwordx4 v16,s[28:31],s64 offen lds
s_add_u32 s64,s68,1835008
buffer_load_dword v31,v29,s[28:31],s64 offen
s_waitcnt vmcnt(10)
s_add_u32 s64,s62,917504
s_add_u32 m0,s61,14336
s_nop 0
buffer_load_dwordx4 v16,s[28:31],s64 offen lds
s_waitcnt vmcnt(10)
s_add_u32 s64,s62,983040
s_add_u32 m0,s61,15360
s_nop 0
buffer_load_dwordx4 v16,s[28:31],s64 offen lds
s_add_u32 s64,s62,1048576
s_add_u32 m0,s61,16384
s_nop 0
buffer_load_dwordx4 v16,s[28:31],s64 offen lds
s_waitcnt vmcnt(10)
s_add_u32 s64,s62,1114112
s_add_u32 m0,s61,17408
s_nop 0
buffer_load_dwordx4 v16,s[28:31],s64 offen lds
s_add_u32 s64,s68,0
buffer_load_dword v31,v29,s[32:35],s64 offen
s_waitcnt vmcnt(10)
s_add_u32 s64,s62,1179648
s_add_u32 m0,s61,18432
s_nop 0
buffer_load_dwordx4 v16,s[28:31],s64 offen lds
s_waitcnt vmcnt(10)
s_add_u32 s64,s62,1245184
s_add_u32 m0,s61,19456
s_nop 0
buffer_load_dwordx4 v16,s[28:31],s64 offen lds
s_waitcnt vmcnt(10)
s_add_u32 s64,s62,1310720
s_add_u32 m0,s61,20480
s_nop 0
buffer_load_dwordx4 v16,s[28:31],s64 offen lds
s_waitcnt vmcnt(10)
s_add_u32 s64,s62,1376256
s_add_u32 m0,s61,21504
s_nop 0
buffer_load_dwordx4 v16,s[28:31],s64 offen lds
s_add_u32 s64,s68,262144
buffer_load_dword v31,v29,s[32:35],s64 offen
s_waitcnt vmcnt(10)
s_add_u32 s64,s62,1441792
s_add_u32 m0,s61,22528
s_nop 0
buffer_load_dwordx4 v16,s[28:31],s64 offen lds
s_waitcnt vmcnt(10)
s_add_u32 s64,s62,1507328
s_add_u32 m0,s61,23552
s_nop 0
buffer_load_dwordx4 v16,s[28:31],s64 offen lds
s_waitcnt vmcnt(10)
s_add_u32 s64,s62,1572864
s_add_u32 m0,s61,24576
s_nop 0
buffer_load_dwordx4 v16,s[28:31],s64 offen lds
s_waitcnt vmcnt(10)
s_add_u32 s64,s62,1638400
s_add_u32 m0,s61,25600
s_nop 0
buffer_load_dwordx4 v16,s[28:31],s64 offen lds
s_add_u32 s64,s68,524288
buffer_load_dword v31,v29,s[32:35],s64 offen
s_waitcnt vmcnt(10)
s_add_u32 s64,s62,1703936
s_add_u32 m0,s61,26624
s_nop 0
buffer_load_dwordx4 v16,s[28:31],s64 offen lds
s_waitcnt vmcnt(10)
s_add_u32 s64,s62,1769472
s_add_u32 m0,s61,27648
s_nop 0
buffer_load_dwordx4 v16,s[28:31],s64 offen lds
s_waitcnt vmcnt(10)
s_add_u32 s64,s62,1835008
s_add_u32 m0,s61,28672
s_nop 0
buffer_load_dwordx4 v16,s[28:31],s64 offen lds
s_waitcnt vmcnt(10)
s_add_u32 s64,s62,1900544
s_add_u32 m0,s61,29696
s_nop 0
buffer_load_dwordx4 v16,s[28:31],s64 offen lds
s_add_u32 s64,s68,786432
buffer_load_dword v31,v29,s[32:35],s64 offen
s_waitcnt vmcnt(10)
s_add_u32 s64,s62,1966080
s_add_u32 m0,s61,30720
s_nop 0
buffer_load_dwordx4 v16,s[28:31],s64 offen lds
s_waitcnt vmcnt(10)
s_add_u32 s64,s62,2031616
s_add_u32 m0,s61,31744
s_nop 0
buffer_load_dwordx4 v16,s[28:31],s64 offen lds
s_waitcnt vmcnt(20)
ds_read_b64_tr_b16 a[0:1],v18 offset:0
ds_read_b64_tr_b16 a[2:3],v18 offset:128
ds_read_b64_tr_b16 a[4:5],v18 offset:4096
ds_read_b64_tr_b16 a[6:7],v18 offset:4224
ds_read_b64_tr_b16 a[8:9],v18 offset:32
ds_read_b64_tr_b16 a[10:11],v18 offset:160
ds_read_b64_tr_b16 a[12:13],v18 offset:4128
ds_read_b64_tr_b16 a[14:15],v18 offset:4256
ds_read_b64_tr_b16 a[16:17],v18 offset:64
ds_read_b64_tr_b16 a[18:19],v18 offset:192
ds_read_b64_tr_b16 a[20:21],v18 offset:4160
ds_read_b64_tr_b16 a[22:23],v18 offset:4288
ds_read_b64_tr_b16 a[24:25],v18 offset:96
ds_read_b64_tr_b16 a[26:27],v18 offset:224
ds_read_b64_tr_b16 a[28:29],v18 offset:4192
ds_read_b64_tr_b16 a[30:31],v18 offset:4320
s_waitcnt lgkmcnt(0)
ds_read_b64_tr_b16 a[64:65],v18 offset:8192
ds_read_b64_tr_b16 a[66:67],v18 offset:8320
ds_read_b64_tr_b16 a[68:69],v18 offset:12288
ds_read_b64_tr_b16 a[70:71],v18 offset:12416
ds_read_b64_tr_b16 a[72:73],v18 offset:8224
ds_read_b64_tr_b16 a[74:75],v18 offset:8352
ds_read_b64_tr_b16 a[76:77],v18 offset:12320
ds_read_b64_tr_b16 a[78:79],v18 offset:12448
ds_read_b64_tr_b16 a[80:81],v18 offset:8256
ds_read_b64_tr_b16 a[82:83],v18 offset:8384
ds_read_b64_tr_b16 a[84:85],v18 offset:12352
ds_read_b64_tr_b16 a[86:87],v18 offset:12480
ds_read_b64_tr_b16 a[88:89],v18 offset:8288
ds_read_b64_tr_b16 a[90:91],v18 offset:8416
ds_read_b64_tr_b16 a[92:93],v18 offset:12384
ds_read_b64_tr_b16 a[94:95],v18 offset:12512
s_waitcnt lgkmcnt(0)
s_add_u32 s64,s62,0
s_add_u32 m0,s61,0
s_nop 0
buffer_load_dwordx4 v16,s[32:35],s64 offen lds
s_waitcnt vmcnt(10)
s_add_u32 s64,s62,65536
s_add_u32 m0,s61,1024
s_nop 0
buffer_load_dwordx4 v16,s[32:35],s64 offen lds
s_add_u32 s64,s68,1048576
buffer_load_dword v31,v29,s[32:35],s64 offen
s_waitcnt vmcnt(10)
s_add_u32 s64,s62,131072
s_add_u32 m0,s61,2048
s_nop 0
buffer_load_dwordx4 v16,s[32:35],s64 offen lds
s_waitcnt vmcnt(10)
s_add_u32 s64,s62,196608
s_add_u32 m0,s61,3072
s_nop 0
buffer_load_dwordx4 v16,s[32:35],s64 offen lds
s_waitcnt vmcnt(10)
s_add_u32 s64,s62,262144
s_add_u32 m0,s61,4096
s_nop 0
buffer_load_dwordx4 v16,s[32:35],s64 offen lds
s_waitcnt vmcnt(10)
s_add_u32 s64,s62,327680
s_add_u32 m0,s61,5120
s_nop 0
buffer_load_dwordx4 v16,s[32:35],s64 offen lds
s_add_u32 s64,s68,1310720
buffer_load_dword v31,v29,s[32:35],s64 offen
s_waitcnt vmcnt(10)
s_add_u32 s64,s62,393216
s_add_u32 m0,s61,6144
s_nop 0
buffer_load_dwordx4 v16,s[32:35],s64 offen lds
s_waitcnt vmcnt(10)
s_add_u32 s64,s62,458752
s_add_u32 m0,s61,7168
s_nop 0
buffer_load_dwordx4 v16,s[32:35],s64 offen lds
s_waitcnt vmcnt(10)
s_add_u32 s64,s62,524288
s_add_u32 m0,s61,8192
s_nop 0
buffer_load_dwordx4 v16,s[32:35],s64 offen lds
s_waitcnt vmcnt(10)
s_add_u32 s64,s62,589824
s_add_u32 m0,s61,9216
s_nop 0
buffer_load_dwordx4 v16,s[32:35],s64 offen lds
s_add_u32 s64,s68,1572864
buffer_load_dword v31,v29,s[32:35],s64 offen
s_waitcnt vmcnt(10)
s_add_u32 s64,s62,655360
s_add_u32 m0,s61,10240
s_nop 0
buffer_load_dwordx4 v16,s[32:35],s64 offen lds
s_waitcnt vmcnt(10)
s_add_u32 s64,s62,720896
s_add_u32 m0,s61,11264
s_nop 0
buffer_load_dwordx4 v16,s[32:35],s64 offen lds
s_waitcnt vmcnt(10)
s_add_u32 s64,s62,786432
s_add_u32 m0,s61,12288
s_nop 0
buffer_load_dwordx4 v16,s[32:35],s64 offen lds
s_waitcnt vmcnt(10)
s_add_u32 s64,s62,851968
s_add_u32 m0,s61,13312
s_nop 0
buffer_load_dwordx4 v16,s[32:35],s64 offen lds
s_add_u32 s64,s68,1835008
buffer_load_dword v31,v29,s[32:35],s64 offen
s_waitcnt vmcnt(10)
s_add_u32 s64,s62,917504
s_add_u32 m0,s61,14336
s_nop 0
buffer_load_dwordx4 v16,s[32:35],s64 offen lds
s_waitcnt vmcnt(10)
s_add_u32 s64,s62,983040
s_add_u32 m0,s61,15360
s_nop 0
buffer_load_dwordx4 v16,s[32:35],s64 offen lds
s_waitcnt vmcnt(20)
ds_read_b64_tr_b16 a[128:129],v18 offset:16384
ds_read_b64_tr_b16 a[130:131],v18 offset:16512
ds_read_b64_tr_b16 a[132:133],v18 offset:20480
ds_read_b64_tr_b16 a[134:135],v18 offset:20608
ds_read_b64_tr_b16 a[136:137],v18 offset:16416
ds_read_b64_tr_b16 a[138:139],v18 offset:16544
ds_read_b64_tr_b16 a[140:141],v18 offset:20512
ds_read_b64_tr_b16 a[142:143],v18 offset:20640
ds_read_b64_tr_b16 a[144:145],v18 offset:16448
ds_read_b64_tr_b16 a[146:147],v18 offset:16576
ds_read_b64_tr_b16 a[148:149],v18 offset:20544
ds_read_b64_tr_b16 a[150:151],v18 offset:20672
ds_read_b64_tr_b16 a[152:153],v18 offset:16480
ds_read_b64_tr_b16 a[154:155],v18 offset:16608
ds_read_b64_tr_b16 a[156:157],v18 offset:20576
ds_read_b64_tr_b16 a[158:159],v18 offset:20704
s_waitcnt lgkmcnt(0)
ds_read_b64_tr_b16 a[192:193],v18 offset:24576
ds_read_b64_tr_b16 a[194:195],v18 offset:24704
ds_read_b64_tr_b16 a[196:197],v18 offset:28672
ds_read_b64_tr_b16 a[198:199],v18 offset:28800
ds_read_b64_tr_b16 a[200:201],v18 offset:24608
ds_read_b64_tr_b16 a[202:203],v18 offset:24736
ds_read_b64_tr_b16 a[204:205],v18 offset:28704
ds_read_b64_tr_b16 a[206:207],v18 offset:28832
ds_read_b64_tr_b16 a[208:209],v18 offset:24640
ds_read_b64_tr_b16 a[210:211],v18 offset:24768
ds_read_b64_tr_b16 a[212:213],v18 offset:28736
ds_read_b64_tr_b16 a[214:215],v18 offset:28864
ds_read_b64_tr_b16 a[216:217],v18 offset:24672
ds_read_b64_tr_b16 a[218:219],v18 offset:24800
ds_read_b64_tr_b16 a[220:221],v18 offset:28768
ds_read_b64_tr_b16 a[222:223],v18 offset:28896
s_waitcnt lgkmcnt(0)
s_add_u32 s64,s62,1048576
s_add_u32 m0,s61,16384
s_nop 0
buffer_load_dwordx4 v16,s[32:35],s64 offen lds
s_waitcnt vmcnt(10)
s_add_u32 s64,s62,1114112
s_add_u32 m0,s61,17408
s_nop 0
buffer_load_dwordx4 v16,s[32:35],s64 offen lds
s_add_u32 s64,s68,0
buffer_load_dword v31,v29,s[36:39],s64 offen
s_waitcnt vmcnt(10)
s_add_u32 s64,s62,1179648
s_add_u32 m0,s61,18432
s_nop 0
buffer_load_dwordx4 v16,s[32:35],s64 offen lds
s_waitcnt vmcnt(10)
s_add_u32 s64,s62,1245184
s_add_u32 m0,s61,19456
s_nop 0
buffer_load_dwordx4 v16,s[32:35],s64 offen lds
s_waitcnt vmcnt(10)
s_add_u32 s64,s62,1310720
s_add_u32 m0,s61,20480
s_nop 0
buffer_load_dwordx4 v16,s[32:35],s64 offen lds
s_waitcnt vmcnt(10)
s_add_u32 s64,s62,1376256
s_add_u32 m0,s61,21504
s_nop 0
buffer_load_dwordx4 v16,s[32:35],s64 offen lds
s_add_u32 s64,s68,262144
buffer_load_dword v31,v29,s[36:39],s64 offen
s_waitcnt vmcnt(10)
s_add_u32 s64,s62,1441792
s_add_u32 m0,s61,22528
s_nop 0
buffer_load_dwordx4 v16,s[32:35],s64 offen lds
s_waitcnt vmcnt(10)
s_add_u32 s64,s62,1507328
s_add_u32 m0,s61,23552
s_nop 0
buffer_load_dwordx4 v16,s[32:35],s64 offen lds
s_waitcnt vmcnt(10)
s_add_u32 s64,s62,1572864
s_add_u32 m0,s61,24576
s_nop 0
buffer_load_dwordx4 v16,s[32:35],s64 offen lds
s_waitcnt vmcnt(10)
s_add_u32 s64,s62,1638400
s_add_u32 m0,s61,25600
s_nop 0
buffer_load_dwordx4 v16,s[32:35],s64 offen lds
s_add_u32 s64,s68,524288
buffer_load_dword v31,v29,s[36:39],s64 offen
s_waitcnt vmcnt(10)
s_add_u32 s64,s62,1703936
s_add_u32 m0,s61,26624
s_nop 0
buffer_load_dwordx4 v16,s[32:35],s64 offen lds
s_waitcnt vmcnt(10)
s_add_u32 s64,s62,1769472
s_add_u32 m0,s61,27648
s_nop 0
buffer_load_dwordx4 v16,s[32:35],s64 offen lds
s_waitcnt vmcnt(10)
s_add_u32 s64,s62,1835008
s_add_u32 m0,s61,28672
s_nop 0
buffer_load_dwordx4 v16,s[32:35],s64 offen lds
s_waitcnt vmcnt(10)
s_add_u32 s64,s62,1900544
s_add_u32 m0,s61,29696
s_nop 0
buffer_load_dwordx4 v16,s[32:35],s64 offen lds
s_add_u32 s64,s68,786432
buffer_load_dword v31,v29,s[36:39],s64 offen
s_waitcnt vmcnt(10)
s_add_u32 s64,s62,1966080
s_add_u32 m0,s61,30720
s_nop 0
buffer_load_dwordx4 v16,s[32:35],s64 offen lds
s_waitcnt vmcnt(10)
s_add_u32 s64,s62,2031616
s_add_u32 m0,s61,31744
s_nop 0
buffer_load_dwordx4 v16,s[32:35],s64 offen lds
s_waitcnt vmcnt(20)
ds_read_b64_tr_b16 a[32:33],v18 offset:0
ds_read_b64_tr_b16 a[34:35],v18 offset:128
ds_read_b64_tr_b16 a[36:37],v18 offset:4096
ds_read_b64_tr_b16 a[38:39],v18 offset:4224
ds_read_b64_tr_b16 a[40:41],v18 offset:32
ds_read_b64_tr_b16 a[42:43],v18 offset:160
ds_read_b64_tr_b16 a[44:45],v18 offset:4128
ds_read_b64_tr_b16 a[46:47],v18 offset:4256
ds_read_b64_tr_b16 a[48:49],v18 offset:64
ds_read_b64_tr_b16 a[50:51],v18 offset:192
ds_read_b64_tr_b16 a[52:53],v18 offset:4160
ds_read_b64_tr_b16 a[54:55],v18 offset:4288
ds_read_b64_tr_b16 a[56:57],v18 offset:96
ds_read_b64_tr_b16 a[58:59],v18 offset:224
ds_read_b64_tr_b16 a[60:61],v18 offset:4192
ds_read_b64_tr_b16 a[62:63],v18 offset:4320
s_waitcnt lgkmcnt(0)
ds_read_b64_tr_b16 a[96:97],v18 offset:8192
ds_read_b64_tr_b16 a[98:99],v18 offset:8320
ds_read_b64_tr_b16 a[100:101],v18 offset:12288
ds_read_b64_tr_b16 a[102:103],v18 offset:12416
ds_read_b64_tr_b16 a[104:105],v18 offset:8224
ds_read_b64_tr_b16 a[106:107],v18 offset:8352
ds_read_b64_tr_b16 a[108:109],v18 offset:12320
ds_read_b64_tr_b16 a[110:111],v18 offset:12448
ds_read_b64_tr_b16 a[112:113],v18 offset:8256
ds_read_b64_tr_b16 a[114:115],v18 offset:8384
ds_read_b64_tr_b16 a[116:117],v18 offset:12352
ds_read_b64_tr_b16 a[118:119],v18 offset:12480
ds_read_b64_tr_b16 a[120:121],v18 offset:8288
ds_read_b64_tr_b16 a[122:123],v18 offset:8416
ds_read_b64_tr_b16 a[124:125],v18 offset:12384
ds_read_b64_tr_b16 a[126:127],v18 offset:12512
s_waitcnt lgkmcnt(0)
s_add_u32 s64,s62,0
s_add_u32 m0,s61,0
s_nop 0
buffer_load_dwordx4 v16,s[36:39],s64 offen lds
s_waitcnt vmcnt(10)
s_add_u32 s64,s62,65536
s_add_u32 m0,s61,1024
s_nop 0
buffer_load_dwordx4 v16,s[36:39],s64 offen lds
s_add_u32 s64,s68,1048576
buffer_load_dword v31,v29,s[36:39],s64 offen
s_waitcnt vmcnt(10)
s_add_u32 s64,s62,131072
s_add_u32 m0,s61,2048
s_nop 0
buffer_load_dwordx4 v16,s[36:39],s64 offen lds
s_waitcnt vmcnt(10)
s_add_u32 s64,s62,196608
s_add_u32 m0,s61,3072
s_nop 0
buffer_load_dwordx4 v16,s[36:39],s64 offen lds
s_waitcnt vmcnt(10)
s_add_u32 s64,s62,262144
s_add_u32 m0,s61,4096
s_nop 0
buffer_load_dwordx4 v16,s[36:39],s64 offen lds
s_waitcnt vmcnt(10)
s_add_u32 s64,s62,327680
s_add_u32 m0,s61,5120
s_nop 0
buffer_load_dwordx4 v16,s[36:39],s64 offen lds
s_add_u32 s64,s68,1310720
buffer_load_dword v31,v29,s[36:39],s64 offen
s_waitcnt vmcnt(10)
s_add_u32 s64,s62,393216
s_add_u32 m0,s61,6144
s_nop 0
buffer_load_dwordx4 v16,s[36:39],s64 offen lds
s_waitcnt vmcnt(10)
s_add_u32 s64,s62,458752
s_add_u32 m0,s61,7168
s_nop 0
buffer_load_dwordx4 v16,s[36:39],s64 offen lds
s_waitcnt vmcnt(10)
s_add_u32 s64,s62,524288
s_add_u32 m0,s61,8192
s_nop 0
buffer_load_dwordx4 v16,s[36:39],s64 offen lds
s_waitcnt vmcnt(10)
s_add_u32 s64,s62,589824
s_add_u32 m0,s61,9216
s_nop 0
buffer_load_dwordx4 v16,s[36:39],s64 offen lds
s_add_u32 s64,s68,1572864
buffer_load_dword v31,v29,s[36:39],s64 offen
s_waitcnt vmcnt(10)
s_add_u32 s64,s62,655360
s_add_u32 m0,s61,10240
s_nop 0
buffer_load_dwordx4 v16,s[36:39],s64 offen lds
s_waitcnt vmcnt(10)
s_add_u32 s64,s62,720896
s_add_u32 m0,s61,11264
s_nop 0
buffer_load_dwordx4 v16,s[36:39],s64 offen lds
s_waitcnt vmcnt(10)
s_add_u32 s64,s62,786432
s_add_u32 m0,s61,12288
s_nop 0
buffer_load_dwordx4 v16,s[36:39],s64 offen lds
s_waitcnt vmcnt(10)
s_add_u32 s64,s62,851968
s_add_u32 m0,s61,13312
s_nop 0
buffer_load_dwordx4 v16,s[36:39],s64 offen lds
s_add_u32 s64,s68,1835008
buffer_load_dword v31,v29,s[36:39],s64 offen
s_waitcnt vmcnt(10)
s_add_u32 s64,s62,917504
s_add_u32 m0,s61,14336
s_nop 0
buffer_load_dwordx4 v16,s[36:39],s64 offen lds
s_waitcnt vmcnt(10)
s_add_u32 s64,s62,983040
s_add_u32 m0,s61,15360
s_nop 0
buffer_load_dwordx4 v16,s[36:39],s64 offen lds
s_waitcnt vmcnt(20)
ds_read_b64_tr_b16 a[160:161],v18 offset:16384
ds_read_b64_tr_b16 a[162:163],v18 offset:16512
ds_read_b64_tr_b16 a[164:165],v18 offset:20480
ds_read_b64_tr_b16 a[166:167],v18 offset:20608
ds_read_b64_tr_b16 a[168:169],v18 offset:16416
ds_read_b64_tr_b16 a[170:171],v18 offset:16544
ds_read_b64_tr_b16 a[172:173],v18 offset:20512
ds_read_b64_tr_b16 a[174:175],v18 offset:20640
ds_read_b64_tr_b16 a[176:177],v18 offset:16448
ds_read_b64_tr_b16 a[178:179],v18 offset:16576
ds_read_b64_tr_b16 a[180:181],v18 offset:20544
ds_read_b64_tr_b16 a[182:183],v18 offset:20672
ds_read_b64_tr_b16 a[184:185],v18 offset:16480
ds_read_b64_tr_b16 a[186:187],v18 offset:16608
ds_read_b64_tr_b16 a[188:189],v18 offset:20576
ds_read_b64_tr_b16 a[190:191],v18 offset:20704
s_waitcnt lgkmcnt(0)
ds_read_b64_tr_b16 a[224:225],v18 offset:24576
ds_read_b64_tr_b16 a[226:227],v18 offset:24704
ds_read_b64_tr_b16 a[228:229],v18 offset:28672
ds_read_b64_tr_b16 a[230:231],v18 offset:28800
ds_read_b64_tr_b16 a[232:233],v18 offset:24608
ds_read_b64_tr_b16 a[234:235],v18 offset:24736
ds_read_b64_tr_b16 a[236:237],v18 offset:28704
ds_read_b64_tr_b16 a[238:239],v18 offset:28832
ds_read_b64_tr_b16 a[240:241],v18 offset:24640
ds_read_b64_tr_b16 a[242:243],v18 offset:24768
ds_read_b64_tr_b16 a[244:245],v18 offset:28736
ds_read_b64_tr_b16 a[246:247],v18 offset:28864
ds_read_b64_tr_b16 a[248:249],v18 offset:24672
ds_read_b64_tr_b16 a[250:251],v18 offset:24800
ds_read_b64_tr_b16 a[252:253],v18 offset:28768
ds_read_b64_tr_b16 a[254:255],v18 offset:28896
s_waitcnt lgkmcnt(0)
s_add_u32 s64,s62,1048576
s_add_u32 m0,s61,16384
s_nop 0
buffer_load_dwordx4 v16,s[36:39],s64 offen lds
s_waitcnt vmcnt(10)
s_add_u32 s64,s62,1114112
s_add_u32 m0,s61,17408
s_nop 0
buffer_load_dwordx4 v16,s[36:39],s64 offen lds
s_add_u32 s64,s69,0
buffer_load_dword v31,v30,s[40:43],s64 offen
s_waitcnt vmcnt(10)
s_add_u32 s64,s62,1179648
s_add_u32 m0,s61,18432
s_nop 0
buffer_load_dwordx4 v16,s[36:39],s64 offen lds
s_waitcnt vmcnt(10)
s_add_u32 s64,s62,1245184
s_add_u32 m0,s61,19456
s_nop 0
buffer_load_dwordx4 v16,s[36:39],s64 offen lds
s_waitcnt vmcnt(10)
s_add_u32 s64,s62,1310720
s_add_u32 m0,s61,20480
s_nop 0
buffer_load_dwordx4 v16,s[36:39],s64 offen lds
s_waitcnt vmcnt(10)
s_add_u32 s64,s62,1376256
s_add_u32 m0,s61,21504
s_nop 0
buffer_load_dwordx4 v16,s[36:39],s64 offen lds
s_add_u32 s64,s69,131072
buffer_load_dword v31,v30,s[40:43],s64 offen
s_waitcnt vmcnt(10)
s_add_u32 s64,s62,1441792
s_add_u32 m0,s61,22528
s_nop 0
buffer_load_dwordx4 v16,s[36:39],s64 offen lds
s_waitcnt vmcnt(10)
s_add_u32 s64,s62,1507328
s_add_u32 m0,s61,23552
s_nop 0
buffer_load_dwordx4 v16,s[36:39],s64 offen lds
s_waitcnt vmcnt(10)
s_add_u32 s64,s62,1572864
s_add_u32 m0,s61,24576
s_nop 0
buffer_load_dwordx4 v16,s[36:39],s64 offen lds
s_waitcnt vmcnt(10)
s_add_u32 s64,s62,1638400
s_add_u32 m0,s61,25600
s_nop 0
buffer_load_dwordx4 v16,s[36:39],s64 offen lds
s_add_u32 s64,s69,262144
buffer_load_dword v31,v30,s[40:43],s64 offen
s_waitcnt vmcnt(10)
s_add_u32 s64,s62,1703936
s_add_u32 m0,s61,26624
s_nop 0
buffer_load_dwordx4 v16,s[36:39],s64 offen lds
s_waitcnt vmcnt(10)
s_add_u32 s64,s62,1769472
s_add_u32 m0,s61,27648
s_nop 0
buffer_load_dwordx4 v16,s[36:39],s64 offen lds
s_waitcnt vmcnt(10)
s_add_u32 s64,s62,1835008
s_add_u32 m0,s61,28672
s_nop 0
buffer_load_dwordx4 v16,s[36:39],s64 offen lds
s_waitcnt vmcnt(10)
s_add_u32 s64,s62,1900544
s_add_u32 m0,s61,29696
s_nop 0
buffer_load_dwordx4 v16,s[36:39],s64 offen lds
s_add_u32 s64,s69,393216
buffer_load_dword v31,v30,s[40:43],s64 offen
s_waitcnt vmcnt(10)
s_add_u32 s64,s62,1966080
s_add_u32 m0,s61,30720
s_nop 0
buffer_load_dwordx4 v16,s[36:39],s64 offen lds
s_waitcnt vmcnt(10)
s_add_u32 s64,s62,2031616
s_add_u32 m0,s61,31744
s_nop 0
buffer_load_dwordx4 v16,s[36:39],s64 offen lds
s_mov_b32 s92,s2
s_and_b32 s93,s3,0xffff
s_mov_b32 s94,0x100
s_mov_b32 s95,0x20000
v_min_u32 v9,31,v20
v_lshlrev_b32 v9,2,v9
s_sub_u32 s64,s88,64
buffer_load_dword v9,v9,s[92:95],s64 offen sc1
v_lshlrev_b32 v10,12,v22
v_lshlrev_b32 v11,1,v21
v_add_u32 v10,v10,v11
s_lshl_b32 s64,s59,6
buffer_load_ushort v32,v10,s[44:47],s64 offen offset:0
buffer_load_ushort v33,v10,s[44:47],s64 offen offset:2048
buffer_load_ushort v34,v10,s[44:47],s64 offen offset:32
buffer_load_ushort v35,v10,s[44:47],s64 offen offset:2080
s_waitcnt vmcnt(25)
ds_read_b64_tr_b16 v[208:209],v19 offset:0
ds_read_b64_tr_b16 v[210:211],v19 offset:128
ds_read_b64_tr_b16 v[212:213],v19 offset:4096
ds_read_b64_tr_b16 v[214:215],v19 offset:4224
ds_read_b64_tr_b16 v[216:217],v19 offset:8
ds_read_b64_tr_b16 v[218:219],v19 offset:136
ds_read_b64_tr_b16 v[220:221],v19 offset:4104
ds_read_b64_tr_b16 v[222:223],v19 offset:4232
ds_read_b64_tr_b16 v[224:225],v19 offset:64
ds_read_b64_tr_b16 v[226:227],v19 offset:192
ds_read_b64_tr_b16 v[228:229],v19 offset:4160
ds_read_b64_tr_b16 v[230:231],v19 offset:4288
s_waitcnt lgkmcnt(0)
ds_read_b64_tr_b16 v[232:233],v19 offset:72
ds_read_b64_tr_b16 v[234:235],v19 offset:200
ds_read_b64_tr_b16 v[236:237],v19 offset:4168
ds_read_b64_tr_b16 v[238:239],v19 offset:4296
s_waitcnt lgkmcnt(0)
ds_read_b64_tr_b16 v[240:241],v19 offset:8192
ds_read_b64_tr_b16 v[242:243],v19 offset:8320
ds_read_b64_tr_b16 v[244:245],v19 offset:12288
ds_read_b64_tr_b16 v[246:247],v19 offset:12416
ds_read_b64_tr_b16 v[248:249],v19 offset:8200
ds_read_b64_tr_b16 v[250:251],v19 offset:8328
ds_read_b64_tr_b16 v[252:253],v19 offset:12296
ds_read_b64_tr_b16 v[254:255],v19 offset:12424
s_waitcnt lgkmcnt(0)
ds_read_b64_tr_b16 v[128:129],v19 offset:8256
ds_read_b64_tr_b16 v[130:131],v19 offset:8384
ds_read_b64_tr_b16 v[132:133],v19 offset:12352
ds_read_b64_tr_b16 v[134:135],v19 offset:12480
ds_read_b64_tr_b16 v[136:137],v19 offset:8264
ds_read_b64_tr_b16 v[138:139],v19 offset:8392
ds_read_b64_tr_b16 v[140:141],v19 offset:12360
ds_read_b64_tr_b16 v[142:143],v19 offset:12488
s_waitcnt lgkmcnt(0)
s_add_u32 s64,s70,0
s_add_u32 m0,s72,0
s_nop 0
buffer_load_dwordx4 v17,s[40:43],s64 offen lds
s_waitcnt vmcnt(10)
s_add_u32 s64,s70,32768
s_add_u32 m0,s72,1024
s_nop 0
buffer_load_dwordx4 v17,s[40:43],s64 offen lds
s_add_u32 s64,s69,524288
buffer_load_dword v31,v30,s[40:43],s64 offen
s_waitcnt vmcnt(10)
s_add_u32 s64,s70,65536
s_add_u32 m0,s72,2048
s_nop 0
buffer_load_dwordx4 v17,s[40:43],s64 offen lds
s_waitcnt vmcnt(10)
s_add_u32 s64,s70,98304
s_add_u32 m0,s72,3072
s_nop 0
buffer_load_dwordx4 v17,s[40:43],s64 offen lds
s_waitcnt vmcnt(10)
s_add_u32 s64,s70,131072
s_add_u32 m0,s72,4096
s_nop 0
buffer_load_dwordx4 v17,s[40:43],s64 offen lds
s_waitcnt vmcnt(10)
s_add_u32 s64,s70,163840
s_add_u32 m0,s72,5120
s_nop 0
buffer_load_dwordx4 v17,s[40:43],s64 offen lds
s_add_u32 s64,s69,655360
buffer_load_dword v31,v30,s[40:43],s64 offen
s_waitcnt vmcnt(10)
s_add_u32 s64,s70,196608
s_add_u32 m0,s72,6144
s_nop 0
buffer_load_dwordx4 v17,s[40:43],s64 offen lds
s_waitcnt vmcnt(10)
s_add_u32 s64,s70,229376
s_add_u32 m0,s72,7168
s_nop 0
buffer_load_dwordx4 v17,s[40:43],s64 offen lds
s_waitcnt vmcnt(10)
s_add_u32 s64,s71,262144
s_add_u32 m0,s73,8192
s_nop 0
buffer_load_dwordx4 v17,s[40:43],s64 offen lds
s_waitcnt vmcnt(10)
s_add_u32 s64,s71,294912
s_add_u32 m0,s73,9216
s_nop 0
buffer_load_dwordx4 v17,s[40:43],s64 offen lds
s_add_u32 s64,s69,786432
buffer_load_dword v31,v30,s[40:43],s64 offen
s_waitcnt vmcnt(10)
s_add_u32 s64,s71,327680
s_add_u32 m0,s73,10240
s_nop 0
buffer_load_dwordx4 v17,s[40:43],s64 offen lds
s_waitcnt vmcnt(10)
s_add_u32 s64,s71,360448
s_add_u32 m0,s73,11264
s_nop 0
buffer_load_dwordx4 v17,s[40:43],s64 offen lds
s_waitcnt vmcnt(10)
s_add_u32 s64,s71,393216
s_add_u32 m0,s73,12288
s_nop 0
buffer_load_dwordx4 v17,s[40:43],s64 offen lds
s_waitcnt vmcnt(10)
s_add_u32 s64,s71,425984
s_add_u32 m0,s73,13312
s_nop 0
buffer_load_dwordx4 v17,s[40:43],s64 offen lds
s_add_u32 s64,s69,917504
buffer_load_dword v31,v30,s[40:43],s64 offen
s_waitcnt vmcnt(10)
s_add_u32 s64,s71,458752
s_add_u32 m0,s73,14336
s_nop 0
buffer_load_dwordx4 v17,s[40:43],s64 offen lds
s_waitcnt vmcnt(10)
s_add_u32 s64,s71,491520
s_add_u32 m0,s73,15360
s_nop 0
buffer_load_dwordx4 v17,s[40:43],s64 offen lds
s_waitcnt vmcnt(20)
ds_read_b64_tr_b16 v[144:145],v19 offset:16384
ds_read_b64_tr_b16 v[146:147],v19 offset:16512
ds_read_b64_tr_b16 v[148:149],v19 offset:20480
ds_read_b64_tr_b16 v[150:151],v19 offset:20608
s_waitcnt lgkmcnt(0)
ds_read_b64_tr_b16 v[152:153],v19 offset:16392
ds_read_b64_tr_b16 v[154:155],v19 offset:16520
ds_read_b64_tr_b16 v[156:157],v19 offset:20488
ds_read_b64_tr_b16 v[158:159],v19 offset:20616
ds_read_b64_tr_b16 v[160:161],v19 offset:16448
ds_read_b64_tr_b16 v[162:163],v19 offset:16576
ds_read_b64_tr_b16 v[164:165],v19 offset:20544
ds_read_b64_tr_b16 v[166:167],v19 offset:20672
ds_read_b64_tr_b16 v[168:169],v19 offset:16456
ds_read_b64_tr_b16 v[170:171],v19 offset:16584
ds_read_b64_tr_b16 v[172:173],v19 offset:20552
ds_read_b64_tr_b16 v[174:175],v19 offset:20680
s_waitcnt lgkmcnt(0)
ds_read_b64_tr_b16 v[176:177],v19 offset:24576
ds_read_b64_tr_b16 v[178:179],v19 offset:24704
ds_read_b64_tr_b16 v[180:181],v19 offset:28672
ds_read_b64_tr_b16 v[182:183],v19 offset:28800
ds_read_b64_tr_b16 v[184:185],v19 offset:24584
ds_read_b64_tr_b16 v[186:187],v19 offset:24712
ds_read_b64_tr_b16 v[188:189],v19 offset:28680
ds_read_b64_tr_b16 v[190:191],v19 offset:28808
ds_read_b64_tr_b16 v[192:193],v19 offset:24640
ds_read_b64_tr_b16 v[194:195],v19 offset:24768
ds_read_b64_tr_b16 v[196:197],v19 offset:28736
ds_read_b64_tr_b16 v[198:199],v19 offset:28864
s_waitcnt lgkmcnt(0)
ds_read_b64_tr_b16 v[200:201],v19 offset:24648
ds_read_b64_tr_b16 v[202:203],v19 offset:24776
ds_read_b64_tr_b16 v[204:205],v19 offset:28744
ds_read_b64_tr_b16 v[206:207],v19 offset:28872
s_waitcnt lgkmcnt(0)
s_add_u32 s64,s70,524288
s_add_u32 m0,s72,16384
s_nop 0
buffer_load_dwordx4 v17,s[40:43],s64 offen lds
s_waitcnt vmcnt(10)
s_add_u32 s64,s70,557056
s_add_u32 m0,s72,17408
s_nop 0
buffer_load_dwordx4 v17,s[40:43],s64 offen lds
s_waitcnt vmcnt(10)
s_add_u32 s64,s70,589824
s_add_u32 m0,s72,18432
s_nop 0
buffer_load_dwordx4 v17,s[40:43],s64 offen lds
s_waitcnt vmcnt(10)
s_add_u32 s64,s70,622592
s_add_u32 m0,s72,19456
s_nop 0
buffer_load_dwordx4 v17,s[40:43],s64 offen lds
v_and_b32 v10,1,v20
v_cmp_eq_u32 vcc,1,v10
v_mov_b32 v10,8192
s_nop 0
v_cndmask_b32 v10,-1,v10,vcc
v_cmp_eq_u32 vcc,v9,v10
s_and_b32 s64,vcc_lo,0xffff
v_readlane_b32 s65,v9,21
s_cmp_eq_u32 s64,65535
s_cselect_b32 s65,s65,0
s_cmp_eq_u32 s56,2
s_cselect_b32 s65,s65,0
v_readlane_b32 s64,v9,22
s_cmp_ge_u32 s64,63
s_cselect_b32 s65,s65,0
s_and_b32 s64,s65,2
s_lshl_b32 s64,s64,12
s_or_b32 s64,s64,1
s_cmp_eq_u32 s65,0
s_cselect_b32 s65,0,s64
v_mov_b32 v10,2048
s_cmp_lg_u32 s50,0
s_cbranch_scc1 avs_100426
v_mov_b32 v9,s65
ds_write_b32 v10,v9
s_waitcnt lgkmcnt(0)
avs_100426:
s_barrier
ds_read_b32 v9,v10
s_waitcnt lgkmcnt(0)
v_readfirstlane_b32 s89,v9
s_cmp_lg_u32 s89,0
s_cselect_b32 s55,36,0
s_lshl_b32 s64,s58,14
s_lshl_b32 s65,s59,9
s_add_u32 s64,s64,s65
s_add_u32 s64,s64,134217728
s_lshl_b32 s65,s57,10
s_add_u32 s65,s65,134249984
s_lshl_b32 s66,s57,12
s_add_u32 s66,s66,134478336
v_mov_b32 v10,s66
v_mov_b32 v11,s65
v_cmp_gt_u32 vcc,12,v20
s_nop 1
v_cndmask_b32 v10,v10,v11,vcc
v_mov_b32 v11,s64
v_cmp_gt_u32 vcc,4,v20
s_nop 1
v_cndmask_b32 v10,v10,v11,vcc
v_lshl_add_u32 v10,v20,7,v10
v_cmp_gt_u32 vcc,s55,v20
s_nop 1
v_cndmask_b32 v10,2.0,v10,vcc
s_lshl_b32 s64,s50,19
buffer_load_dword v11,v10,s[20:23],s64 offen
s_waitcnt vmcnt(5)
ds_read_b64_tr_b16 v[48:49],v27 offset:0
ds_read_b64_tr_b16 v[50:51],v27 offset:128
ds_read_b64_tr_b16 v[52:53],v27 offset:2048
ds_read_b64_tr_b16 v[54:55],v27 offset:2176
ds_read_b64_tr_b16 v[56:57],v27 offset:32
ds_read_b64_tr_b16 v[58:59],v27 offset:160
ds_read_b64_tr_b16 v[60:61],v27 offset:2080
ds_read_b64_tr_b16 v[62:63],v27 offset:2208
s_add_u32 s64,s70,655360
s_add_u32 m0,s72,20480
s_nop 0
buffer_load_dwordx4 v17,s[40:43],s64 offen lds
s_add_u32 s64,s70,688128
s_add_u32 m0,s72,21504
s_nop 0
buffer_load_dwordx4 v17,s[40:43],s64 offen lds
s_add_u32 s64,s70,720896
s_add_u32 m0,s72,22528
s_nop 0
buffer_load_dwordx4 v17,s[40:43],s64 offen lds
ds_read_b64_tr_b16 v[64:65],v27 offset:4096
ds_read_b64_tr_b16 v[66:67],v27 offset:4224
ds_read_b64_tr_b16 v[68:69],v27 offset:6144
ds_read_b64_tr_b16 v[70:71],v27 offset:6272
ds_read_b64_tr_b16 v[72:73],v27 offset:4128
ds_read_b64_tr_b16 v[74:75],v27 offset:4256
ds_read_b64_tr_b16 v[76:77],v27 offset:6176
ds_read_b64_tr_b16 v[78:79],v27 offset:6304
s_add_u32 s64,s70,753664
s_add_u32 m0,s72,23552
s_nop 0
buffer_load_dwordx4 v17,s[40:43],s64 offen lds
s_add_u32 s64,s71,786432
s_add_u32 m0,s73,24576
s_nop 0
buffer_load_dwordx4 v17,s[40:43],s64 offen lds
s_add_u32 s64,s71,819200
s_add_u32 m0,s73,25600
s_nop 0
buffer_load_dwordx4 v17,s[40:43],s64 offen lds
s_waitcnt lgkmcnt(0)
ds_read_b64_tr_b16 v[80:81],v27 offset:8192
ds_read_b64_tr_b16 v[82:83],v27 offset:8320
ds_read_b64_tr_b16 v[84:85],v27 offset:10240
ds_read_b64_tr_b16 v[86:87],v27 offset:10368
ds_read_b64_tr_b16 v[88:89],v27 offset:8224
ds_read_b64_tr_b16 v[90:91],v27 offset:8352
ds_read_b64_tr_b16 v[92:93],v27 offset:10272
ds_read_b64_tr_b16 v[94:95],v27 offset:10400
s_add_u32 s64,s71,851968
s_add_u32 m0,s73,26624
s_nop 0
buffer_load_dwordx4 v17,s[40:43],s64 offen lds
s_add_u32 s64,s71,884736
s_add_u32 m0,s73,27648
s_nop 0
buffer_load_dwordx4 v17,s[40:43],s64 offen lds
s_add_u32 s64,s71,917504
s_add_u32 m0,s73,28672
s_nop 0
buffer_load_dwordx4 v17,s[40:43],s64 offen lds
ds_read_b64_tr_b16 v[96:97],v27 offset:12288
ds_read_b64_tr_b16 v[98:99],v27 offset:12416
ds_read_b64_tr_b16 v[100:101],v27 offset:14336
ds_read_b64_tr_b16 v[102:103],v27 offset:14464
ds_read_b64_tr_b16 v[104:105],v27 offset:12320
ds_read_b64_tr_b16 v[106:107],v27 offset:12448
ds_read_b64_tr_b16 v[108:109],v27 offset:14368
ds_read_b64_tr_b16 v[110:111],v27 offset:14496
s_add_u32 s64,s71,950272
s_add_u32 m0,s73,29696
s_nop 0
buffer_load_dwordx4 v17,s[40:43],s64 offen lds
s_add_u32 s64,s71,983040
s_add_u32 m0,s73,30720
s_nop 0
buffer_load_dwordx4 v17,s[40:43],s64 offen lds
s_add_u32 s64,s71,1015808
s_add_u32 m0,s73,31744
s_nop 0
buffer_load_dwordx4 v17,s[40:43],s64 offen lds
s_waitcnt lgkmcnt(0)
ds_write_b128 v7,v[128:131] offset:0
ds_write_b128 v7,v[132:135] offset:1024
ds_write_b128 v7,v[136:139] offset:2048
ds_write_b128 v7,v[140:143] offset:3072
ds_write_b128 v7,v[144:147] offset:4096
ds_write_b128 v7,v[148:151] offset:5120
ds_write_b128 v7,v[152:155] offset:6144
ds_write_b128 v7,v[156:159] offset:7168
ds_write_b128 v7,v[160:163] offset:8192
ds_write_b128 v7,v[164:167] offset:9216
ds_write_b128 v7,v[168:171] offset:10240
ds_write_b128 v7,v[172:175] offset:11264
s_waitcnt lgkmcnt(4)
ds_write_b128 v7,v[176:179] offset:12288
ds_write_b128 v7,v[180:183] offset:13312
ds_write_b128 v7,v[184:187] offset:14336
ds_write_b128 v7,v[188:191] offset:15360
s_waitcnt lgkmcnt(0)
v_mov_b32 v128,v96
v_mov_b32 v112,v192
v_mov_b32 v129,v97
v_mov_b32 v113,v193
v_mov_b32 v130,v98
v_mov_b32 v114,v194
v_mov_b32 v131,v99
v_mov_b32 v115,v195
v_mov_b32 v132,v100
v_mov_b32 v116,v196
v_mov_b32 v133,v101
v_mov_b32 v117,v197
v_mov_b32 v134,v102
v_mov_b32 v118,v198
v_mov_b32 v135,v103
v_mov_b32 v119,v199
v_mov_b32 v136,v104
v_mov_b32 v120,v200
v_mov_b32 v137,v105
v_mov_b32 v121,v201
v_mov_b32 v138,v106
v_mov_b32 v122,v202
v_mov_b32 v139,v107
v_mov_b32 v123,v203
v_mov_b32 v140,v108
v_mov_b32 v124,v204
v_mov_b32 v141,v109
v_mov_b32 v125,v205
v_mov_b32 v142,v110
v_mov_b32 v126,v206
v_mov_b32 v143,v111
v_mov_b32 v127,v207
s_waitcnt vmcnt(0)
ds_read_b64_tr_b16 v[144:145],v27 offset:16384
ds_read_b64_tr_b16 v[146:147],v27 offset:16512
ds_read_b64_tr_b16 v[148:149],v27 offset:18432
ds_read_b64_tr_b16 v[150:151],v27 offset:18560
ds_read_b64_tr_b16 v[152:153],v27 offset:16416
ds_read_b64_tr_b16 v[154:155],v27 offset:16544
ds_read_b64_tr_b16 v[156:157],v27 offset:18464
ds_read_b64_tr_b16 v[158:159],v27 offset:18592
ds_read_b64_tr_b16 v[160:161],v27 offset:20480
ds_read_b64_tr_b16 v[162:163],v27 offset:20608
ds_read_b64_tr_b16 v[164:165],v27 offset:22528
ds_read_b64_tr_b16 v[166:167],v27 offset:22656
ds_read_b64_tr_b16 v[168:169],v27 offset:20512
ds_read_b64_tr_b16 v[170:171],v27 offset:20640
ds_read_b64_tr_b16 v[172:173],v27 offset:22560
ds_read_b64_tr_b16 v[174:175],v27 offset:22688
s_waitcnt lgkmcnt(0)
ds_read_b64_tr_b16 v[176:177],v27 offset:24576
ds_read_b64_tr_b16 v[178:179],v27 offset:24704
ds_read_b64_tr_b16 v[180:181],v27 offset:26624
ds_read_b64_tr_b16 v[182:183],v27 offset:26752
ds_read_b64_tr_b16 v[184:185],v27 offset:24608
ds_read_b64_tr_b16 v[186:187],v27 offset:24736
ds_read_b64_tr_b16 v[188:189],v27 offset:26656
ds_read_b64_tr_b16 v[190:191],v27 offset:26784
ds_read_b64_tr_b16 v[192:193],v27 offset:28672
ds_read_b64_tr_b16 v[194:195],v27 offset:28800
ds_read_b64_tr_b16 v[196:197],v27 offset:30720
ds_read_b64_tr_b16 v[198:199],v27 offset:30848
ds_read_b64_tr_b16 v[200:201],v27 offset:28704
ds_read_b64_tr_b16 v[202:203],v27 offset:28832
ds_read_b64_tr_b16 v[204:205],v27 offset:30752
ds_read_b64_tr_b16 v[206:207],v27 offset:30880
s_waitcnt lgkmcnt(0)
ds_write_b128 v7,v[112:115] offset:16384
ds_write_b128 v7,v[116:119] offset:17408
ds_write_b128 v7,v[120:123] offset:18432
ds_write_b128 v7,v[124:127] offset:19456
ds_write_b128 v7,v[48:51] offset:20480
ds_write_b128 v7,v[52:55] offset:21504
ds_write_b128 v7,v[56:59] offset:22528
ds_write_b128 v7,v[60:63] offset:23552
ds_write_b128 v7,v[64:67] offset:24576
ds_write_b128 v7,v[68:71] offset:25600
ds_write_b128 v7,v[72:75] offset:26624
ds_write_b128 v7,v[76:79] offset:27648
s_waitcnt lgkmcnt(4)
ds_write_b128 v7,v[80:83] offset:28672
ds_write_b128 v7,v[84:87] offset:29696
ds_write_b128 v7,v[88:91] offset:30720
ds_write_b128 v7,v[92:95] offset:31744
s_waitcnt lgkmcnt(0)
v_and_b32 v23,1,v21
v_mov_b32 v1,0x4444
v_mov_b32 v24,0xeeee
v_cmp_eq_u32 vcc,1,v23
s_nop 1
v_cndmask_b32 v1,v1,v24,vcc
v_lshlrev_b32 v23,1,v22
v_sub_u32 v23,v21,v23
v_mov_b32 v5,0
v_mov_b32 v24,0x3f80
v_cmp_eq_u32 vcc,0,v23
s_nop 1
v_cndmask_b32 v5,v5,v24,vcc
v_mov_b32 v24,0x3f800000
v_cmp_eq_u32 vcc,1,v23
s_nop 1
v_cndmask_b32 v5,v5,v24,vcc
s_and_b32 s64,s50,1
s_lshl_b32 s64,s64,11
v_lshl_add_u32 v127,v20,2,s64
v_and_b32 v23,7,v21
v_lshrrev_b32 v24,3,v21
v_lshlrev_b32 v25,8,v24
v_lshl_add_u32 v25,v22,6,v25
v_lshl_add_u32 v4,v23,2,v25
v_lshrrev_b32 v25,1,v22
v_lshl_add_u32 v25,v25,3,v23
v_lshlrev_b32 v25,5,v25
v_and_b32 v26,1,v22
v_lshl_add_u32 v6,v26,4,v25
v_lshl_add_u32 v27,v22,3,v23
v_lshlrev_b32 v27,4,v27
s_mov_b32 s80,0x3e0293ee
s_mov_b32 s81,0xfffffffe
s_mov_b32 s84,0x00ff00ff
s_mov_b32 s85,0x00ff00ff
s_mov_b32 s86,-1
s_mov_b32 s87,0
s_cmp_gt_u32 s50,1
s_cselect_b32 s82,0xff00ff00,-1
s_cselect_b32 s83,0xff00ff00,0
s_lshl_b32 m0,s50,8
s_cmp_gt_u32 s50,1
s_cbranch_scc1 w23_100427
v_lshl_add_u32 v2,v24,9,v27
v_lshrrev_b32 v25,1,v22
v_lshl_add_u32 v25,v25,3,v23
v_lshlrev_b32 v25,4,v25
v_lshl_add_u32 v26,v26,1,v24
v_lshl_add_u32 v3,v26,2,v25
v_add_u32 v3,1024 + 256,v3
v_cndmask_b32 v6,2.0,v6,s[84:85]
v_mov_b32 v8,0x3f803f80
v_mov_b32 v9,0x3f803f80
v_mov_b32 v10,0x3f803f80
v_mov_b32 v11,0x3f803f80
v_mov_b32 v12,0x3f803f80
v_mov_b32 v13,0
v_mov_b32 v14,0
v_mov_b32 v15,0
s_branch jn_100428
w23_100427:
s_sub_u32 s64,s50,2
s_mul_i32 s64,s64,4160
v_lshrrev_b32 v25,1,v22
v_mul_u32_u24 v25,2080,v25
v_and_b32 v28,1,v23
v_mul_u32_u24 v28,1040,v28
v_add_u32 v25,v25,v28
v_lshrrev_b32 v28,1,v23
v_lshl_add_u32 v25,v28,6,v25
v_lshl_add_u32 v25,v26,5,v25
v_mul_u32_u24 v28,8448,v24
v_add3_u32 v2,v25,v28,s64
v_cndmask_b32 v3,2.0,v27,s[84:85]
v_mov_b32 v8,-1
v_mov_b32 v9,-1
v_mov_b32 v10,-1
v_mov_b32 v11,-1
jn_100428:
s_cmp_eq_u32 s89,0
s_cbranch_scc1 avn_100431
s_mov_b32 s56,0
s_and_b32 s67,s89,0x2000
s_branch avj_100432
avn_100431:
s_mov_b32 s92,s2
s_and_b32 s93,s3,0xffff
s_mov_b32 s94,0x100
s_mov_b32 s95,0x20000
v_mbcnt_lo_u32_b32 v16,-1,0
v_mbcnt_hi_u32_b32 v16,-1,v16
v_mov_b32 v18,0
v_cmp_eq_u32 vcc,22,v16
s_nop 1
v_cndmask_b32 v18,v18,63,vcc
v_cmp_eq_u32 vcc,21,v16
s_nop 1
v_cndmask_b32 v18,v18,1,vcc
v_and_b32 v19,1,v16
v_cmp_eq_u32 vcc,1,v19
v_mov_b32 v19,8192
s_nop 0
v_cndmask_b32 v19,-1,v19,vcc
v_min_u32 v16,31,v16
v_lshlrev_b32 v16,2,v16
s_sub_u32 s66,s88,64
s_cmp_lg_u32 s50,0
s_cbranch_scc1 vot_100437
vpoll_100433:
buffer_load_dword v17,v16,s[92:95],s66 offen sc1
s_waitcnt vmcnt(0)
s_cmp_lg_u32 s56,2
s_cbranch_scc1 vck_100434
v_cmp_eq_u32 vcc,v17,v19
s_and_b32 s64,vcc_lo,0xffff
s_cmp_eq_u32 s64,65535
s_cbranch_scc1 vck_100434
s_mov_b32 s65,0
v_readlane_b32 s64,v17,1
s_lshr_b32 s64,s64,8
s_add_u32 s65,s65,s64
v_readlane_b32 s64,v17,3
s_lshr_b32 s64,s64,8
s_add_u32 s65,s65,s64
v_readlane_b32 s64,v17,5
s_lshr_b32 s64,s64,8
s_add_u32 s65,s65,s64
v_readlane_b32 s64,v17,7
s_lshr_b32 s64,s64,8
s_add_u32 s65,s65,s64
v_readlane_b32 s64,v17,9
s_lshr_b32 s64,s64,8
s_add_u32 s65,s65,s64
v_readlane_b32 s64,v17,11
s_lshr_b32 s64,s64,8
s_add_u32 s65,s65,s64
v_readlane_b32 s64,v17,13
s_lshr_b32 s64,s64,8
s_add_u32 s65,s65,s64
v_readlane_b32 s64,v17,15
s_lshr_b32 s64,s64,8
s_add_u32 s65,s65,s64
s_cmp_ge_u32 s65,256
s_cbranch_scc1 vok_100436
s_branch vrt_100435
vck_100434:
v_cmp_gt_u32 vcc,v18,v17
s_cbranch_vccz vok_100436
vrt_100435:
s_sleep 8
s_sub_u32 s90,s90,1
s_cmp_gt_i32 s90,0
s_cbranch_scc1 vpoll_100433
vok_100436:
ds_write_b32 v16,v17 offset:1792
s_waitcnt lgkmcnt(0)
vot_100437:
s_barrier
v_add_u32 v18,1792,v16
ds_read_b32 v17,v18
s_waitcnt lgkmcnt(0)
s_cmp_lg_u32 s56,2
s_cbranch_scc1 vfin_100438
v_cmp_eq_u32 vcc,v17,v19
s_and_b32 s64,vcc_lo,0xffff
s_cmp_eq_u32 s64,65535
s_cbranch_scc1 vfin_100438
s_mov_b32 s65,0
v_readlane_b32 s64,v17,1
s_lshr_b32 s64,s64,8
s_add_u32 s65,s65,s64
v_readlane_b32 s64,v17,3
s_lshr_b32 s64,s64,8
s_add_u32 s65,s65,s64
v_readlane_b32 s64,v17,5
s_lshr_b32 s64,s64,8
s_add_u32 s65,s65,s64
v_readlane_b32 s64,v17,7
s_lshr_b32 s64,s64,8
s_add_u32 s65,s65,s64
v_readlane_b32 s64,v17,9
s_lshr_b32 s64,s64,8
s_add_u32 s65,s65,s64
v_readlane_b32 s64,v17,11
s_lshr_b32 s64,s64,8
s_add_u32 s65,s65,s64
v_readlane_b32 s64,v17,13
s_lshr_b32 s64,s64,8
s_add_u32 s65,s65,s64
v_readlane_b32 s64,v17,15
s_lshr_b32 s64,s64,8
s_add_u32 s65,s65,s64
s_cmp_ge_u32 s65,256
s_cbranch_scc1 fl_fb
vfin_100438:
s_and_b32 s56,s56,1
s_mov_b32 s67,0
v_readlane_b32 s65,v17,21
s_and_b32 s65,s65,2
s_lshl_b32 s67,s65,12
v_mbcnt_lo_u32_b32 v20,-1,0
v_mbcnt_hi_u32_b32 v20,-1,v20
s_lshl_b32 s64,s58,14
s_lshl_b32 s65,s59,9
s_add_u32 s64,s64,s65
s_add_u32 s64,s64,134217728
s_lshl_b32 s65,s57,10
s_add_u32 s65,s65,134249984
s_lshl_b32 s66,s57,12
s_add_u32 s66,s66,134478336
v_mov_b32 v21,s66
v_mov_b32 v22,s65
v_cmp_gt_u32 vcc,12,v20
s_nop 1
v_cndmask_b32 v21,v21,v22,vcc
v_mov_b32 v22,s64
v_cmp_gt_u32 vcc,4,v20
s_nop 1
v_cndmask_b32 v21,v21,v22,vcc
v_lshl_add_u32 v21,v20,7,v21
v_cmp_gt_u32 vcc,36,v20
s_nop 1
v_cndmask_b32 v21,2.0,v21,vcc
s_lshl_b32 s64,s50,19
buffer_load_dword v22,v21,s[20:23],s64 offen
s_waitcnt vmcnt(0)
avj_100432:
s_lshl_b32 s64,s58,14
s_lshl_b32 s65,s50,12
s_add_u32 s70,s64,s65
s_add_u32 s70,s70,134217728
s_lshl_b32 s65,s59,9
s_add_u32 s71,s64,s65
s_add_u32 s71,s71,134217728
s_xor_b32 s64,s58,1
s_lshl_b32 s64,s64,15
s_lshr_b32 s65,s50,1
s_lshl_b32 s65,s65,14
s_add_u32 s64,s64,s65
s_and_b32 s65,s50,1
s_lshl_b32 s65,s65,12
s_add_u32 s64,s64,s65
s_add_u32 s72,s64,s67
s_add_u32 s72,s72,142606336
s_lshl_b32 s64,s58,15
s_lshr_b32 s65,s59,4
s_lshl_b32 s65,s65,14
s_add_u32 s64,s64,s65
s_and_b32 s65,s59,15
s_lshl_b32 s65,s65,9
s_add_u32 s64,s64,s65
s_add_u32 s73,s64,s67
s_add_u32 s73,s73,142606336
s_cmp_eq_u32 s50,1
s_cselect_b32 s54,2048 - 256,0
s_sub_u32 s71,s71,s54
s_lshl_b32 s64,s58,15
s_lshl_b32 s65,s50,13
s_add_u32 s74,s64,s65
s_add_u32 s74,s74,134250496
s_lshl_b32 s64,s57,10
s_and_b32 s65,s50,1
s_lshl_b32 s65,s65,9
s_cmp_gt_u32 s50,1
s_cselect_b32 s65,0,s65
s_add_u32 s75,s64,s65
s_add_u32 s75,s75,134250496
s_lshl_b32 s64,s57,12
s_and_b32 s65,s64,0xffffe000
s_cmp_eq_u32 s50,3
s_cselect_b32 s66,1536,0
s_add_u32 s64,s64,s66
s_cmp_gt_u32 s50,1
s_cselect_b32 s76,s64,s65
s_add_u32 s76,s76,134479872
s_lshl_b32 s64,s57,14
s_and_b32 s65,s50,1
s_lshl_b32 s66,s65,11
s_add_u32 s77,s64,s66
s_cmp_gt_u32 s50,1
s_cselect_b32 s66,0,4096
s_add_u32 s77,s77,s66
s_add_u32 s77,s77,0
s_lshl_b32 s66,s65,9
s_add_u32 s66,s66,1024 + 128
s_lshl_b32 s65,s65,7
s_cmp_gt_u32 s50,1
s_cselect_b32 s65,s65,s66
s_add_u32 s78,s64,s65
s_add_u32 s78,s78,67108736
s_lshl_b32 s64,s57,6
s_add_u32 s68,s64,s67
s_add_u32 s69,s68,s64
s_add_u32 s69,s69,138428416
s_lshl_b32 s64,s50,14
s_add_u32 s69,s69,s64
s_and_b32 s64,s50,1
s_lshl_b32 s64,s64,11
s_sub_u32 s69,s69,s64
s_add_u32 s68,s68,138412032
s_mov_b32 s79,0
s_mov_b32 s91,0
s_mov_b32 s90,100000
s_barrier
s_cmp_eq_u32 s56,1
s_cbranch_scc1 recslow_100429
buffer_load_dword v119,off,s[20:23],s68 sc1
s_mov_b32 s55,0
s_cmp_lg_u32 s50,0
s_cbranch_scc1 np0_100441
v_mov_b32 v120,0
v_mov_b32 v121,0
s_cmp_lg_u32 s58,0
s_cbranch_scc1 z1_100442
v_mov_b32 v120,v32
v_mov_b32 v121,v33
v_mov_b32 v122,v34
v_mov_b32 v123,v35
v_lshl_or_b32 v120,v122,16,v120
v_lshl_or_b32 v121,v123,16,v121
v_min_u32 v120,s81,v120
v_min_u32 v121,s81,v121
z1_100442:
buffer_store_dword v120,v4,s[20:23],s71 offen
buffer_store_dword v121,v4,s[20:23],s71 offen offset:32
buffer_store_dword v120,v4,s[20:23],s73 offen sc1
buffer_store_dword v121,v4,s[20:23],s73 offen offset:32 sc1
np0_100441:
v_lshrrev_b32 v124,2,v0
v_bfe_u32 v125,v124,5,1
v_mul_u32_u24 v125,2048,v125
s_and_b32 s64,s50,1
s_lshl_b32 s64,s64,5
v_add3_u32 v4,v124,v125,s64
s_mov_b32 s61,1
s_mov_b32 s92,s70
s_mov_b32 s93,s72
s_mov_b32 s94,s76
s_add_u32 s95,s94,4096
s_mov_b32 s96,s74
s_add_u32 s97,s96,4096
s_mov_b32 s98,s75
s_barrier
v_mov_b32 v96,v104
v_mov_b32 v97,v105
v_mov_b32 v98,v106
v_mov_b32 v99,v107
v_mov_b32 v100,v108
v_mov_b32 v101,v109
v_mov_b32 v102,v110
v_mov_b32 v103,v111
v_mov_b32 v48,0
v_mov_b32 v49,0
v_mov_b32 v50,0
v_mov_b32 v51,0
v_mov_b32 v52,0
v_mov_b32 v53,0
v_mov_b32 v54,0
v_mov_b32 v55,0
v_mov_b32 v56,0
v_mov_b32 v57,0
v_mov_b32 v58,0
v_mov_b32 v59,0
v_mov_b32 v60,0
v_mov_b32 v61,0
v_mov_b32 v62,0
v_mov_b32 v63,0
v_mov_b32 v64,0
v_mov_b32 v65,0
v_mov_b32 v66,0
v_mov_b32 v67,0
v_mov_b32 v68,0
v_mov_b32 v69,0
v_mov_b32 v70,0
v_mov_b32 v71,0
v_mov_b32 v72,0
v_mov_b32 v73,0
v_mov_b32 v74,0
v_mov_b32 v75,0
v_mov_b32 v76,0
v_mov_b32 v77,0
v_mov_b32 v78,0
v_mov_b32 v79,0
v_mov_b32 v80,0
v_mov_b32 v81,0
v_mov_b32 v82,0
v_mov_b32 v83,0
v_mov_b32 v84,0
v_mov_b32 v85,0
v_mov_b32 v86,0
v_mov_b32 v87,0
v_mov_b32 v88,0
v_mov_b32 v89,0
v_mov_b32 v90,0
v_mov_b32 v91,0
v_mov_b32 v92,0
v_mov_b32 v93,0
v_mov_b32 v94,0
v_mov_b32 v95,0
s_cmp_gt_u32 s50,1
s_cbranch_scc0 loop0_100443x
.p2align 6
s_nop 0
s_nop 0
s_nop 0
s_nop 0
s_nop 0
s_nop 0
s_nop 0
loop_100439:
v_mov_b32 v125,0
s_nop 1
v_mfma_f32_16x16x1_4b_f32 v[48:63],v125,v125,0
v_mfma_f32_16x16x1_4b_f32 v[64:79],v125,v125,0
v_mfma_f32_16x16x1_4b_f32 v[80:95],v125,v125,0
s_max_u32 s66,s79,1
s_sub_u32 s66,s66,1
v_cndmask_b32 v126,2.0,v0,s[82:83]
s_add_u32 s64,s66,0
s_lshl_b32 s65,s64,12
s_and_b32 s65,s65,0x2000
s_xor_b32 s65,s65,s67
s_lshl_b32 s64,s64,20
s_add_u32 s65,s65,s64
s_add_u32 s101,s65,s78
buffer_store_dwordx4 v[112:115],v126,s[20:23],s101 offen sc1
s_nop 15
s_nop 15
s_nop 15
s_nop 7
buffer_load_dwordx4 v[16:19],v0,s[20:23],s92 offen offset:0 sc1
s_nop 7
buffer_load_dwordx4 v[20:23],v0,s[20:23],s92 offen offset:1024 sc1
s_nop 7
buffer_load_dwordx4 v[24:27],v0,s[20:23],s92 offen offset:2048 sc1
s_nop 7
buffer_load_dwordx4 v[28:31],v0,s[20:23],s92 offen offset:3072 sc1
v_mov_b32 v96,v104
v_mov_b32 v97,v105
v_mov_b32 v98,v106
v_mov_b32 v99,v107
v_mov_b32 v100,v108
v_mov_b32 v101,v109
v_mov_b32 v102,v110
v_mov_b32 v103,v111
s_branch ja_100444
loop0_100443x:
v_mov_b32 v125,0
s_nop 1
v_mfma_f32_16x16x1_4b_f32 v[48:63],v125,v125,0
v_mfma_f32_16x16x1_4b_f32 v[64:79],v125,v125,0
v_mfma_f32_16x16x1_4b_f32 v[80:95],v125,v125,0
s_max_u32 s66,s79,1
s_sub_u32 s66,s66,1
v_cndmask_b32 v126,2.0,v0,s[82:83]
s_add_u32 s64,s66,0
s_lshl_b32 s65,s64,12
s_and_b32 s65,s65,0x2000
s_xor_b32 s65,s65,s67
s_lshl_b32 s64,s64,20
s_add_u32 s65,s65,s64
s_add_u32 s101,s65,s78
buffer_store_dwordx4 v[112:115],v126,s[20:23],s101 offen sc1
s_nop 15
s_nop 3
buffer_load_dwordx4 v[16:19],v0,s[20:23],s92 offen offset:0 sc1
s_nop 7
buffer_load_dwordx4 v[20:23],v0,s[20:23],s92 offen offset:1024 sc1
s_nop 7
buffer_load_dwordx4 v[24:27],v0,s[20:23],s92 offen offset:2048 sc1
s_nop 7
buffer_load_dwordx4 v[28:31],v0,s[20:23],s92 offen offset:3072 sc1
ja_100444:
.p2align 5
s_nop 0
s_nop 0
s_cmp_lg_u32 s61,0
s_cbranch_scc1 pe_100445
pb_100446:
v_mov_b32 v126,s79
s_cmp_eq_u32 s79,63
s_cbranch_scc1 last_100440
s_add_u32 s64,s79,1
s_lshl_b32 s65,s64,12
s_and_b32 s65,s65,0x2000
s_xor_b32 s65,s65,s67
s_lshl_b32 s64,s64,20
s_add_u32 s65,s65,s64
s_add_u32 s99,s65,s77
s_waitcnt vmcnt(3)
v_max3_u32 v124,v16,v17,v18
v_max_u32 v124,v124,v19
v_cmp_eq_u32 vcc,-1,v124
v_cndmask_b32 v121,2.0,v127,s[86:87]
v_readfirstlane_b32 s91,v119
s_add_u32 s64,s79,1
s_cmp_gt_u32 s91,s64
s_cselect_b32 s99,s99,2.0
s_cselect_b32 s63,0,1
s_cbranch_vccnz flb_100475
seg_100451:
segb_100459:
v_smfmac_f32_16x16x64_bf16 v[48:51],v[16:19],a[0:7],v1
buffer_load_dword v125,off,s[20:23],s92 sc1
v_smfmac_f32_16x16x64_bf16 v[52:55],v[16:19],a[8:15],v1
buffer_load_dwordx4 v[32:35],v0,s[20:23],s93 offen offset:0 sc1
v_smfmac_f32_16x16x64_bf16 v[56:59],v[16:19],a[16:23],v1
s_waitcnt vmcnt(4)
v_max3_u32 v124,v20,v21,v22
v_smfmac_f32_16x16x64_bf16 v[60:63],v[16:19],a[24:31],v1
v_max_u32 v124,v124,v23
v_smfmac_f32_16x16x64_bf16 v[64:67],v[16:19],a[32:39],v1
v_cmp_eq_u32 vcc,-1,v124
v_smfmac_f32_16x16x64_bf16 v[68:71],v[16:19],a[40:47],v1
v_smfmac_f32_16x16x64_bf16 v[72:75],v[16:19],a[48:55],v1
s_cbranch_vccnz fl_100468
seg_100452:
v_smfmac_f32_16x16x64_bf16 v[76:79],v[16:19],a[56:63],v1
segb_100460:
v_smfmac_f32_16x16x64_bf16 v[48:51],v[20:23],a[64:71],v1
buffer_load_dword v125,off,s[20:23],s92 sc1
v_smfmac_f32_16x16x64_bf16 v[52:55],v[20:23],a[72:79],v1
buffer_load_dwordx4 v[36:39],v0,s[20:23],s93 offen offset:1024 sc1
v_smfmac_f32_16x16x64_bf16 v[56:59],v[20:23],a[80:87],v1
s_waitcnt vmcnt(5)
v_max3_u32 v124,v24,v25,v26
v_smfmac_f32_16x16x64_bf16 v[60:63],v[20:23],a[88:95],v1
v_max_u32 v124,v124,v27
v_smfmac_f32_16x16x64_bf16 v[64:67],v[20:23],a[96:103],v1
v_cmp_eq_u32 vcc,-1,v124
v_smfmac_f32_16x16x64_bf16 v[68:71],v[20:23],a[104:111],v1
v_smfmac_f32_16x16x64_bf16 v[72:75],v[20:23],a[112:119],v1
s_cbranch_vccnz fl_100469
seg_100453:
v_smfmac_f32_16x16x64_bf16 v[76:79],v[20:23],a[120:127],v1
segb_100461:
v_smfmac_f32_16x16x64_bf16 v[48:51],v[24:27],a[128:135],v1
buffer_load_dword v125,off,s[20:23],s92 sc1
v_smfmac_f32_16x16x64_bf16 v[52:55],v[24:27],a[136:143],v1
buffer_load_dwordx4 v[40:43],v0,s[20:23],s93 offen offset:2048 sc1
v_smfmac_f32_16x16x64_bf16 v[56:59],v[24:27],a[144:151],v1
buffer_load_dwordx4 v[44:47],v0,s[20:23],s93 offen offset:3072 sc1
s_waitcnt vmcnt(7)
v_max3_u32 v124,v28,v29,v30
v_smfmac_f32_16x16x64_bf16 v[60:63],v[24:27],a[152:159],v1
v_max_u32 v124,v124,v31
v_smfmac_f32_16x16x64_bf16 v[64:67],v[24:27],a[160:167],v1
v_cmp_eq_u32 vcc,-1,v124
v_smfmac_f32_16x16x64_bf16 v[68:71],v[24:27],a[168:175],v1
v_smfmac_f32_16x16x64_bf16 v[72:75],v[24:27],a[176:183],v1
s_cbranch_vccnz fl_100470
seg_100454:
v_smfmac_f32_16x16x64_bf16 v[76:79],v[24:27],a[184:191],v1
segb_100462:
v_smfmac_f32_16x16x64_bf16 v[48:51],v[28:31],a[192:199],v1
buffer_load_dword v125,off,s[20:23],s92 sc1
v_smfmac_f32_16x16x64_bf16 v[52:55],v[28:31],a[200:207],v1
buffer_store_dword v126,v121,s[20:23],s69 offen sc1
v_smfmac_f32_16x16x64_bf16 v[56:59],v[28:31],a[208:215],v1
s_waitcnt vmcnt(7)
v_max3_u32 v124,v32,v33,v34
v_smfmac_f32_16x16x64_bf16 v[60:63],v[28:31],a[216:223],v1
v_max_u32 v124,v124,v35
v_smfmac_f32_16x16x64_bf16 v[64:67],v[28:31],a[224:231],v1
v_cmp_eq_u32 vcc,-1,v124
v_smfmac_f32_16x16x64_bf16 v[68:71],v[28:31],a[232:239],v1
v_smfmac_f32_16x16x64_bf16 v[72:75],v[28:31],a[240:247],v1
s_cbranch_vccnz fl_100471
seg_100455:
v_smfmac_f32_16x16x64_bf16 v[76:79],v[28:31],a[248:255],v1
segb_100463:
v_smfmac_f32_16x16x64_bf16 v[48:51],v[32:35],a[0:7],v1
buffer_load_dword v125,off,s[20:23],s92 sc1
v_smfmac_f32_16x16x64_bf16 v[52:55],v[32:35],a[8:15],v1
v_smfmac_f32_16x16x64_bf16 v[56:59],v[32:35],a[16:23],v1
s_waitcnt vmcnt(6)
v_max3_u32 v124,v36,v37,v38
v_smfmac_f32_16x16x64_bf16 v[60:63],v[32:35],a[24:31],v1
v_max_u32 v124,v124,v39
v_smfmac_f32_16x16x64_bf16 v[64:67],v[32:35],a[32:39],v1
v_cmp_eq_u32 vcc,-1,v124
v_smfmac_f32_16x16x64_bf16 v[68:71],v[32:35],a[40:47],v1
v_smfmac_f32_16x16x64_bf16 v[72:75],v[32:35],a[48:55],v1
s_cbranch_vccnz fl_100472
seg_100456:
v_smfmac_f32_16x16x64_bf16 v[76:79],v[32:35],a[56:63],v1
segb_100464:
v_smfmac_f32_16x16x64_bf16 v[48:51],v[36:39],a[64:71],v1
buffer_load_dword v125,off,s[20:23],s92 sc1
s_waitcnt vmcnt(4)
v_max3_u32 v124,v40,v41,v42
v_smfmac_f32_16x16x64_bf16 v[52:55],v[36:39],a[72:79],v1
v_max3_u32 v124,v124,v43,v44
v_smfmac_f32_16x16x64_bf16 v[56:59],v[36:39],a[80:87],v1
v_max3_u32 v124,v124,v45,v46
v_smfmac_f32_16x16x64_bf16 v[60:63],v[36:39],a[88:95],v1
v_max_u32 v124,v124,v47
v_smfmac_f32_16x16x64_bf16 v[64:67],v[36:39],a[96:103],v1
v_cmp_eq_u32 vcc,-1,v124
v_smfmac_f32_16x16x64_bf16 v[68:71],v[36:39],a[104:111],v1
v_smfmac_f32_16x16x64_bf16 v[72:75],v[36:39],a[112:119],v1
s_cbranch_vccnz fl_100473
seg_100457:
v_smfmac_f32_16x16x64_bf16 v[76:79],v[36:39],a[120:127],v1
segb_100465:
v_smfmac_f32_16x16x64_bf16 v[48:51],v[40:43],a[128:135],v1
s_cmp_lg_u32 s61,0
s_cbranch_scc1 pq_100447
pk_100448:
buffer_load_dwordx4 v[104:107],v0,s[20:23],s99 offen
v_smfmac_f32_16x16x64_bf16 v[52:55],v[40:43],a[136:143],v1
buffer_load_dwordx4 v[108:111],v0,s[20:23],s99 offen offset:1024
s_add_u32 s64,s79,2
v_smfmac_f32_16x16x64_bf16 v[48:51],v[44:47],a[192:199],v1
s_and_b32 s64,s64,3
s_lshl_b32 s100,s64,19
v_smfmac_f32_16x16x64_bf16 v[52:55],v[44:47],a[200:207],v1
s_mov_b32 s61,s63
s_nop 1
v_add_f32 v48,v48,v49
v_smfmac_f32_16x16x64_bf16 v[56:59],v[40:43],a[144:151],v1
ds_write_addtid_b32 v48 offset:0
v_add_f32 v50,v50,v51
v_smfmac_f32_16x16x64_bf16 v[60:63],v[40:43],a[152:159],v1
ds_write_addtid_b32 v50 offset:1040
v_add_f32 v52,v52,v53
v_smfmac_f32_16x16x64_bf16 v[56:59],v[44:47],a[208:215],v1
ds_write_addtid_b32 v52 offset:2080
v_add_f32 v54,v54,v55
v_smfmac_f32_16x16x64_bf16 v[60:63],v[44:47],a[216:223],v1
ds_write_addtid_b32 v54 offset:3120
s_nop 1
v_add_f32 v56,v56,v57
v_smfmac_f32_16x16x64_bf16 v[64:67],v[40:43],a[160:167],v1
ds_write_addtid_b32 v56 offset:4160
v_add_f32 v58,v58,v59
v_smfmac_f32_16x16x64_bf16 v[68:71],v[40:43],a[168:175],v1
ds_write_addtid_b32 v58 offset:5200
v_add_f32 v60,v60,v61
v_smfmac_f32_16x16x64_bf16 v[64:67],v[44:47],a[224:231],v1
ds_write_addtid_b32 v60 offset:6240
v_add_f32 v62,v62,v63
v_smfmac_f32_16x16x64_bf16 v[68:71],v[44:47],a[232:239],v1
ds_write_addtid_b32 v62 offset:7280
s_nop 1
v_add_f32 v64,v64,v65
v_smfmac_f32_16x16x64_bf16 v[72:75],v[40:43],a[176:183],v1
ds_write_addtid_b32 v64 offset:8448
v_add_f32 v66,v66,v67
v_smfmac_f32_16x16x64_bf16 v[76:79],v[40:43],a[184:191],v1
ds_write_addtid_b32 v66 offset:9488
v_add_f32 v68,v68,v69
v_smfmac_f32_16x16x64_bf16 v[72:75],v[44:47],a[240:247],v1
ds_write_addtid_b32 v68 offset:10528
v_add_f32 v70,v70,v71
v_smfmac_f32_16x16x64_bf16 v[76:79],v[44:47],a[248:255],v1
ds_write_addtid_b32 v70 offset:11568
s_nop 1
v_add_f32 v72,v72,v73
v_smfmac_f32_16x16x64_bf16 v[80:83],v[16:19],v[208:215],v1
ds_write_addtid_b32 v72 offset:12608
v_add_f32 v74,v74,v75
v_smfmac_f32_16x16x64_bf16 v[80:83],v[32:35],v[208:215],v1
ds_write_addtid_b32 v74 offset:13648
v_add_f32 v76,v76,v77
ds_write_addtid_b32 v76 offset:14688
v_add_f32 v78,v78,v79
ds_write_addtid_b32 v78 offset:15728
doneA_100484:
s_waitcnt lgkmcnt(0)
s_barrier
s_cmp_gt_u32 s50,1
s_cbranch_scc1 w23_100485
v_smfmac_f32_16x16x64_bf16 v[84:87],v[16:19],v[216:223],v1
v_smfmac_f32_16x16x64_bf16 v[84:87],v[32:35],v[216:223],v1
v_smfmac_f32_16x16x64_bf16 v[88:91],v[16:19],v[224:231],v1
v_smfmac_f32_16x16x64_bf16 v[88:91],v[32:35],v[224:231],v1
v_smfmac_f32_16x16x64_bf16 v[92:95],v[16:19],v[232:239],v1
ds_read_b128 v[48:51],v7 offset:0
ds_read_b128 v[52:55],v7 offset:1024
v_smfmac_f32_16x16x64_bf16 v[92:95],v[32:35],v[232:239],v1
ds_read_b128 v[56:59],v7 offset:2048
ds_read_b128 v[60:63],v7 offset:3072
v_smfmac_f32_16x16x64_bf16 v[80:83],v[20:23],v[240:247],v1
ds_read_b128 v[64:67],v7 offset:4096
ds_read_b128 v[68:71],v7 offset:5120
v_smfmac_f32_16x16x64_bf16 v[80:83],v[36:39],v[240:247],v1
ds_read_b128 v[72:75],v7 offset:6144
ds_read_b128 v[76:79],v7 offset:7168
v_smfmac_f32_16x16x64_bf16 v[84:87],v[20:23],v[248:255],v1
v_smfmac_f32_16x16x64_bf16 v[84:87],v[36:39],v[248:255],v1
s_waitcnt lgkmcnt(6)
v_smfmac_f32_16x16x64_bf16 v[88:91],v[20:23],v[48:55],v1
v_smfmac_f32_16x16x64_bf16 v[88:91],v[36:39],v[48:55],v1
ds_read_b128 v[48:51],v7 offset:8192
ds_read_b128 v[52:55],v7 offset:9216
s_waitcnt lgkmcnt(6)
v_smfmac_f32_16x16x64_bf16 v[92:95],v[20:23],v[56:63],v1
v_smfmac_f32_16x16x64_bf16 v[92:95],v[36:39],v[56:63],v1
ds_read_b128 v[56:59],v7 offset:10240
ds_read_b128 v[60:63],v7 offset:11264
s_waitcnt lgkmcnt(6)
v_smfmac_f32_16x16x64_bf16 v[80:83],v[24:27],v[64:71],v1
v_smfmac_f32_16x16x64_bf16 v[80:83],v[40:43],v[64:71],v1
ds_read_b128 v[64:67],v7 offset:12288
ds_read_b128 v[68:71],v7 offset:13312
s_waitcnt lgkmcnt(6)
v_smfmac_f32_16x16x64_bf16 v[84:87],v[24:27],v[72:79],v1
v_smfmac_f32_16x16x64_bf16 v[84:87],v[40:43],v[72:79],v1
ds_read_b128 v[72:75],v7 offset:14336
ds_read_b128 v[76:79],v7 offset:15360
s_waitcnt lgkmcnt(6)
v_smfmac_f32_16x16x64_bf16 v[88:91],v[24:27],v[48:55],v1
v_smfmac_f32_16x16x64_bf16 v[88:91],v[40:43],v[48:55],v1
ds_read_b128 v[48:51],v7 offset:16384
ds_read_b128 v[52:55],v7 offset:17408
s_waitcnt lgkmcnt(6)
v_smfmac_f32_16x16x64_bf16 v[92:95],v[24:27],v[56:63],v1
v_smfmac_f32_16x16x64_bf16 v[92:95],v[40:43],v[56:63],v1
ds_read_b128 v[56:59],v7 offset:18432
ds_read_b128 v[60:63],v7 offset:19456
s_waitcnt lgkmcnt(6)
v_smfmac_f32_16x16x64_bf16 v[80:83],v[28:31],v[64:71],v1
v_smfmac_f32_16x16x64_bf16 v[80:83],v[44:47],v[64:71],v1
s_waitcnt lgkmcnt(4)
v_smfmac_f32_16x16x64_bf16 v[84:87],v[28:31],v[72:79],v1
v_smfmac_f32_16x16x64_bf16 v[84:87],v[44:47],v[72:79],v1
s_waitcnt lgkmcnt(2)
v_smfmac_f32_16x16x64_bf16 v[88:91],v[28:31],v[48:55],v1
v_add_f32 v80,v80,v81
v_smfmac_f32_16x16x64_bf16 v[88:91],v[44:47],v[48:55],v1
v_add_f32 v82,v82,v83
s_waitcnt lgkmcnt(0)
v_smfmac_f32_16x16x64_bf16 v[92:95],v[28:31],v[56:63],v1
v_cvt_pk_bf16_f32 v80,v80,v82
v_smfmac_f32_16x16x64_bf16 v[92:95],v[44:47],v[56:63],v1
buffer_load_dwordx4 v[16:19],v2,s[20:23],s94 offen offset:0 sc1
ds_write_addtid_b32 v80 offset:16896
v_add_f32 v84,v84,v85
buffer_load_dwordx4 v[32:35],v2,s[20:23],s94 offen offset:1536 sc1
buffer_load_dwordx4 v[20:23],v2,s[20:23],s95 offen offset:0 sc1
buffer_load_dwordx4 v[36:39],v2,s[20:23],s95 offen offset:1536 sc1
buffer_load_dword v120,v3,s[20:23],s94 offen offset:0 sc1
buffer_load_dword v121,v3,s[20:23],s94 offen offset:1536 sc1
buffer_load_dword v122,v3,s[20:23],s95 offen offset:0 sc1
buffer_load_dword v123,v3,s[20:23],s95 offen offset:1536 sc1
v_add_f32 v86,v86,v87
v_cvt_pk_bf16_f32 v84,v84,v86
v_add_f32 v88,v88,v89
v_add_f32 v90,v90,v91
v_cvt_pk_bf16_f32 v88,v88,v90
v_add_f32 v92,v92,v93
v_add_f32 v94,v94,v95
v_cvt_pk_bf16_f32 v92,v92,v94
ds_write_addtid_b32 v84 offset:17920
ds_write_addtid_b32 v88 offset:18944
ds_write_addtid_b32 v92 offset:19968
.p2align 5
s_nop 0
s_nop 0
s_nop 0
s_nop 0
s_nop 0
sp_100489:
s_waitcnt vmcnt(6)
v_pk_add_f32 v[16:17],v[16:17],v[32:33]
v_pk_add_f32 v[18:19],v[18:19],v[34:35]
s_waitcnt vmcnt(4)
v_pk_add_f32 v[20:21],v[20:21],v[36:37]
v_pk_add_f32 v[22:23],v[22:23],v[38:39]
v_pk_add_f32 v[16:17],v[16:17],v[20:21]
v_pk_add_f32 v[18:19],v[18:19],v[22:23]
v_max3_f32 v124,v16,v17,v18
v_pk_add_f32 v[20:21],v[16:17],v[18:19]
s_waitcnt vmcnt(0)
v_pk_add_f32 v[120:121],v[120:121],v[122:123]
v_add_f32 v120,v120,v121
v_max3_f32 v124,v124,v19,v120
v_add_f32 v20,v20,v120
v_cmp_u_f32 vcc,v20,v21
v_max_f32_dpp v124,v124,v124 row_ror:8 row_mask:0xf bank_mask:0xf
v_mov_b32 v125,v124
s_cbranch_vccnz srt_100491
sok_100490:
s_nop 0
v_permlane16_swap_b32 v125,v124
v_max_f32 v124,v124,v125
v_mov_b32 v125,v124
s_nop 1
v_permlane32_swap_b32 v125,v124
v_max_f32 v124,v124,v125
v_mul_f32 v124,s80,v124
v_fma_f32 v16,v16,s80,-v124
v_fma_f32 v17,v17,s80,-v124
v_fma_f32 v18,v18,s80,-v124
v_fma_f32 v19,v19,s80,-v124
v_fma_f32 v120,v120,s80,-v124
s_waitcnt lgkmcnt(0)
s_barrier
ds_read2st64_b32 v[112:113],v127 offset0:66 offset1:67
ds_read2st64_b32 v[114:115],v127 offset0:68 offset1:69
ds_read2st64_b32 v[116:117],v127 offset0:70 offset1:71
ds_read2st64_b32 v[118:119],v127 offset0:72 offset1:73
v_exp_f32 v16,v16
v_exp_f32 v17,v17
v_exp_f32 v18,v18
v_exp_f32 v19,v19
v_cvt_pk_bf16_f32 v48,v16,v17
v_cvt_pk_bf16_f32 v49,v18,v19
v_exp_f32 v120,v120
v_mov_b32_dpp v50,v48 row_ror:8 row_mask:0xf bank_mask:0xf
v_mov_b32_dpp v51,v49 row_ror:8 row_mask:0xf bank_mask:0xf
v_mov_b32_dpp v121,v120 row_ror:8 row_mask:0xf bank_mask:0xf
v_cvt_pk_bf16_f32 v52,v120,v121
v_mfma_f32_16x16x32_bf16 v[64:67],v[8:11],v[48:51],0
v_mov_b32 v53,v52
v_mfma_f32_16x16x32_bf16 v[56:59],v[96:99],v[48:51],0
v_mov_b32 v54,v52
v_mov_b32 v55,v52
v_mfma_f32_16x16x32_bf16 v[60:63],v[100:103],v[48:51],0
v_mfma_f32_16x16x32_bf16 v[64:67],v[12:15],v[52:55],v[64:67]
s_waitcnt lgkmcnt(0)
v_mfma_f32_16x16x32_bf16 v[56:59],v[112:115],v[52:55],v[56:59]
v_mfma_f32_16x16x32_bf16 v[60:63],v[116:119],v[52:55],v[60:63]
s_nop 0
v_rcp_f32 v66,v64
s_nop 2
v_pk_mul_f32 v[56:57],v[56:57],v[66:67] op_sel_hi:[1,0]
v_pk_mul_f32 v[58:59],v[58:59],v[66:67] op_sel_hi:[1,0]
s_nop 0
v_pk_mul_f32 v[60:61],v[60:61],v[66:67] op_sel_hi:[1,0]
v_pk_mul_f32 v[62:63],v[62:63],v[66:67] op_sel_hi:[1,0]
v_cvt_pk_bf16_f32 v120,v56,v57
v_cvt_pk_bf16_f32 v121,v58,v59
v_cvt_pk_bf16_f32 v122,v60,v61
v_cvt_pk_bf16_f32 v123,v62,v63
buffer_store_dwordx4 v[120:123],v6,s[20:23],s98 offen
s_barrier
ds_read_b128 v[48:51],v7 offset:20480
ds_read_b128 v[52:55],v7 offset:21504
ds_read_b128 v[56:59],v7 offset:22528
ds_read_b128 v[60:63],v7 offset:23552
ds_read_b128 v[64:67],v7 offset:24576
ds_read_b128 v[68:71],v7 offset:25600
ds_read_b128 v[72:75],v7 offset:26624
ds_read_b128 v[76:79],v7 offset:27648
ds_read_b128 v[80:83],v7 offset:28672
ds_read_b128 v[84:87],v7 offset:29696
ds_read_b128 v[88:91],v7 offset:30720
ds_read_b128 v[92:95],v7 offset:31744
v_mov_b32 v96,0
v_mov_b32 v97,0
v_mov_b32 v98,0
v_mov_b32 v99,0
v_mov_b32 v100,0
v_mov_b32 v101,0
v_mov_b32 v102,0
v_mov_b32 v103,0
s_nop 11
buffer_load_dwordx4 v[16:19],v0,s[20:23],s96 offen offset:0 sc1
v_mov_b32 v120,v5
v_mov_b32 v121,v5
v_mov_b32 v122,v5
v_mov_b32 v123,v5
s_nop 1
v_mfma_f32_16x16x32_bf16 v[112:115],v[120:123],v[112:115],0
buffer_load_dwordx4 v[20:23],v0,s[20:23],s96 offen offset:1024 sc1
v_mfma_f32_16x16x32_bf16 v[116:119],v[120:123],v[116:119],0
s_add_u32 s79,s79,1
s_and_b32 s64,s79,3
s_lshl_b32 s64,s64,19
s_lshl_b32 s65,s79,8
buffer_load_dwordx4 v[24:27],v0,s[20:23],s96 offen offset:2048 sc1
s_and_b32 s65,s65,0x2000
s_lshl_b32 s66,s79,16
s_xor_b32 s88,s73,s65
s_add_u32 s88,s88,s66
s_sub_u32 s88,s88,s54
s_add_u32 s89,s71,s64
s_add_u32 s92,s70,s64
s_xor_b32 s93,s72,s65
buffer_load_dwordx4 v[28:31],v0,s[20:23],s96 offen offset:3072 sc1
s_add_u32 s93,s93,s66
s_add_u32 s94,s76,s64
s_add_u32 s95,s94,4096
s_add_u32 s98,s75,s64
s_add_u32 s60,s74,s64
v_cvt_pk_bf16_f32 v112,v112,v113
v_cvt_pk_bf16_f32 v113,v114,v115
v_cvt_pk_bf16_f32 v114,v116,v117
buffer_load_dwordx4 v[32:35],v0,s[20:23],s97 offen offset:0 sc1
v_cvt_pk_bf16_f32 v115,v118,v119
s_nop 6
buffer_load_dwordx4 v[36:39],v0,s[20:23],s97 offen offset:1024 sc1
s_nop 7
buffer_load_dwordx4 v[40:43],v0,s[20:23],s97 offen offset:2048 sc1
s_nop 7
buffer_load_dwordx4 v[44:47],v0,s[20:23],s97 offen offset:3072 sc1
s_branch ogo_100486
.p2align 5
s_nop 0
s_nop 0
s_nop 0
s_nop 0
w23_100485:
ds_read_b128 v[48:51],v2 offset:0
ds_read_b128 v[52:55],v2 offset:256
ds_read_b128 v[56:59],v2 offset:512
ds_read_b128 v[60:63],v2 offset:768
ds_read_b128 v[64:67],v2 offset:16
ds_read_b128 v[68:71],v2 offset:272
ds_read_b128 v[72:75],v2 offset:528
ds_read_b128 v[76:79],v2 offset:784
s_waitcnt lgkmcnt(6)
v_pk_add_f32 v[48:49],v[48:49],v[52:53]
v_pk_add_f32 v[50:51],v[50:51],v[54:55]
s_waitcnt lgkmcnt(4)
v_pk_add_f32 v[56:57],v[56:57],v[60:61]
v_pk_add_f32 v[58:59],v[58:59],v[62:63]
v_pk_add_f32 v[48:49],v[48:49],v[56:57]
v_pk_add_f32 v[50:51],v[50:51],v[58:59]
v_cvt_pk_bf16_f32 v112,v48,v49
v_cvt_pk_bf16_f32 v113,v50,v51
s_waitcnt lgkmcnt(2)
v_pk_add_f32 v[64:65],v[64:65],v[68:69]
v_pk_add_f32 v[66:67],v[66:67],v[70:71]
s_waitcnt lgkmcnt(0)
v_pk_add_f32 v[72:73],v[72:73],v[76:77]
v_pk_add_f32 v[74:75],v[74:75],v[78:79]
v_pk_add_f32 v[64:65],v[64:65],v[72:73]
v_pk_add_f32 v[66:67],v[66:67],v[74:75]
v_cvt_pk_bf16_f32 v114,v64,v65
v_cvt_pk_bf16_f32 v115,v66,v67
s_nop 1
v_mfma_f32_16x16x32_bf16 v[116:119],v[96:99],v[112:115],0
v_mfma_f32_16x16x32_bf16 v[120:123],v[100:103],v[112:115],0
v_mfma_f32_16x16x32_bf16 v[12:15],v[112:115],v[112:115],0
ds_read_b128 v[48:51],v7 offset:0
ds_read_b128 v[52:55],v7 offset:1024
ds_read_b128 v[56:59],v7 offset:2048
ds_read_b128 v[60:63],v7 offset:3072
ds_read_b128 v[64:67],v7 offset:4096
buffer_store_dwordx4 v[116:119],v3,s[20:23],s94 offen
buffer_store_dwordx4 v[120:123],v3,s[20:23],s94 offen offset:512
s_nop 0
buffer_store_dwordx4 v[12:15],v3,s[20:23],s94 offen offset:1024
ds_read_b128 v[68:71],v7 offset:5120
ds_read_b128 v[72:75],v7 offset:6144
ds_read_b128 v[76:79],v7 offset:7168
v_smfmac_f32_16x16x64_bf16 v[84:87],v[16:19],v[216:223],v1
v_smfmac_f32_16x16x64_bf16 v[84:87],v[32:35],v[216:223],v1
v_smfmac_f32_16x16x64_bf16 v[88:91],v[16:19],v[224:231],v1
v_smfmac_f32_16x16x64_bf16 v[88:91],v[32:35],v[224:231],v1
v_smfmac_f32_16x16x64_bf16 v[92:95],v[16:19],v[232:239],v1
v_smfmac_f32_16x16x64_bf16 v[92:95],v[32:35],v[232:239],v1
v_smfmac_f32_16x16x64_bf16 v[80:83],v[20:23],v[240:247],v1
v_smfmac_f32_16x16x64_bf16 v[80:83],v[36:39],v[240:247],v1
v_smfmac_f32_16x16x64_bf16 v[84:87],v[20:23],v[248:255],v1
v_smfmac_f32_16x16x64_bf16 v[84:87],v[36:39],v[248:255],v1
s_waitcnt lgkmcnt(6)
v_smfmac_f32_16x16x64_bf16 v[88:91],v[20:23],v[48:55],v1
v_smfmac_f32_16x16x64_bf16 v[88:91],v[36:39],v[48:55],v1
ds_read_b128 v[48:51],v7 offset:8192
ds_read_b128 v[52:55],v7 offset:9216
s_waitcnt lgkmcnt(6)
v_smfmac_f32_16x16x64_bf16 v[92:95],v[20:23],v[56:63],v1
v_smfmac_f32_16x16x64_bf16 v[92:95],v[36:39],v[56:63],v1
ds_read_b128 v[56:59],v7 offset:10240
ds_read_b128 v[60:63],v7 offset:11264
s_waitcnt lgkmcnt(6)
v_smfmac_f32_16x16x64_bf16 v[80:83],v[24:27],v[64:71],v1
v_smfmac_f32_16x16x64_bf16 v[80:83],v[40:43],v[64:71],v1
ds_read_b128 v[64:67],v7 offset:12288
ds_read_b128 v[68:71],v7 offset:13312
s_waitcnt lgkmcnt(6)
v_smfmac_f32_16x16x64_bf16 v[84:87],v[24:27],v[72:79],v1
v_smfmac_f32_16x16x64_bf16 v[84:87],v[40:43],v[72:79],v1
ds_read_b128 v[72:75],v7 offset:14336
ds_read_b128 v[76:79],v7 offset:15360
s_waitcnt lgkmcnt(6)
v_smfmac_f32_16x16x64_bf16 v[88:91],v[24:27],v[48:55],v1
v_smfmac_f32_16x16x64_bf16 v[88:91],v[40:43],v[48:55],v1
ds_read_b128 v[48:51],v7 offset:16384
ds_read_b128 v[52:55],v7 offset:17408
s_waitcnt lgkmcnt(6)
v_smfmac_f32_16x16x64_bf16 v[92:95],v[24:27],v[56:63],v1
v_smfmac_f32_16x16x64_bf16 v[92:95],v[40:43],v[56:63],v1
ds_read_b128 v[56:59],v7 offset:18432
ds_read_b128 v[60:63],v7 offset:19456
s_waitcnt lgkmcnt(6)
v_smfmac_f32_16x16x64_bf16 v[80:83],v[28:31],v[64:71],v1
v_smfmac_f32_16x16x64_bf16 v[80:83],v[44:47],v[64:71],v1
s_waitcnt lgkmcnt(4)
v_smfmac_f32_16x16x64_bf16 v[84:87],v[28:31],v[72:79],v1
v_smfmac_f32_16x16x64_bf16 v[84:87],v[44:47],v[72:79],v1
s_waitcnt lgkmcnt(2)
v_smfmac_f32_16x16x64_bf16 v[88:91],v[28:31],v[48:55],v1
v_add_f32 v80,v80,v81
v_smfmac_f32_16x16x64_bf16 v[88:91],v[44:47],v[48:55],v1
v_add_f32 v82,v82,v83
s_waitcnt lgkmcnt(0)
v_smfmac_f32_16x16x64_bf16 v[92:95],v[28:31],v[56:63],v1
v_cvt_pk_bf16_f32 v80,v80,v82
v_smfmac_f32_16x16x64_bf16 v[92:95],v[44:47],v[56:63],v1
ds_write_addtid_b32 v80 offset:16896
v_add_f32 v84,v84,v85
v_add_f32 v86,v86,v87
v_cvt_pk_bf16_f32 v84,v84,v86
v_add_f32 v88,v88,v89
v_add_f32 v90,v90,v91
v_cvt_pk_bf16_f32 v88,v88,v90
s_nop 0
v_add_f32 v92,v92,v93
v_add_f32 v94,v94,v95
v_cvt_pk_bf16_f32 v92,v92,v94
ds_write_addtid_b32 v84 offset:17920
ds_write_addtid_b32 v88 offset:18944
ds_write_addtid_b32 v92 offset:19968
s_waitcnt lgkmcnt(0)
s_barrier
ds_read_b128 v[48:51],v7 offset:20480
ds_read_b128 v[52:55],v7 offset:21504
ds_read_b128 v[56:59],v7 offset:22528
ds_read_b128 v[60:63],v7 offset:23552
ds_read_b128 v[64:67],v7 offset:24576
ds_read_b128 v[68:71],v7 offset:25600
ds_read_b128 v[72:75],v7 offset:26624
ds_read_b128 v[76:79],v7 offset:27648
ds_read_b128 v[80:83],v7 offset:28672
ds_read_b128 v[84:87],v7 offset:29696
ds_read_b128 v[88:91],v7 offset:30720
ds_read_b128 v[92:95],v7 offset:31744
s_add_u32 s65,s76,s100
s_add_u32 s66,s75,s100
s_add_u32 s64,s71,s100
s_cmp_eq_u32 s50,2
s_cselect_b32 s66,s66,s64
buffer_store_dwordx4 v[8:11],v0,s[20:23],s65 offen
s_cmp_eq_u32 s50,2
s_cselect_b32 exec_hi,-1,0
buffer_store_dwordx4 v[8:11],v0,s[20:23],s66 offen
s_mov_b32 exec_hi,0
buffer_store_dwordx4 v[8:11],v0,s[20:23],s65 offen offset:1024
s_mov_b64 exec,-1
v_mov_b32 v96,0
v_mov_b32 v97,0
v_mov_b32 v98,0
v_mov_b32 v99,0
v_mov_b32 v100,0
v_mov_b32 v101,0
v_mov_b32 v102,0
v_mov_b32 v103,0
s_barrier
s_nop 15
s_nop 15
s_nop 7
buffer_load_dwordx4 v[16:19],v0,s[20:23],s96 offen offset:0 sc1
s_add_u32 s79,s79,1
s_and_b32 s64,s79,3
s_lshl_b32 s64,s64,19
s_lshl_b32 s65,s79,8
s_and_b32 s65,s65,0x2000
s_lshl_b32 s66,s79,16
s_xor_b32 s88,s73,s65
s_add_u32 s88,s88,s66
buffer_load_dwordx4 v[20:23],v0,s[20:23],s96 offen offset:1024 sc1
s_sub_u32 s88,s88,s54
s_add_u32 s89,s71,s64
s_add_u32 s92,s70,s64
s_xor_b32 s93,s72,s65
s_add_u32 s93,s93,s66
s_add_u32 s94,s76,s64
s_add_u32 s95,s94,4096
s_add_u32 s98,s75,s64
buffer_load_dwordx4 v[24:27],v0,s[20:23],s96 offen offset:2048 sc1
s_add_u32 s60,s74,s64
s_nop 6
buffer_load_dwordx4 v[28:31],v0,s[20:23],s96 offen offset:3072 sc1
s_nop 7
buffer_load_dwordx4 v[32:35],v0,s[20:23],s97 offen offset:0 sc1
s_nop 7
buffer_load_dwordx4 v[36:39],v0,s[20:23],s97 offen offset:1024 sc1
s_nop 7
buffer_load_dwordx4 v[40:43],v0,s[20:23],s97 offen offset:2048 sc1
s_nop 7
buffer_load_dwordx4 v[44:47],v0,s[20:23],s97 offen offset:3072 sc1
.p2align 5
s_nop 0
s_nop 0
s_nop 0
s_nop 0
ogo_100486:
s_waitcnt lgkmcnt(0)
s_waitcnt vmcnt(6)
v_max3_u32 v124,v16,v17,v18
v_max3_u32 v124,v124,v19,v20
v_max3_u32 v124,v124,v21,v22
v_max_u32 v124,v124,v23
v_cmp_eq_u32 vcc,-1,v124
s_cbranch_vccnz of_100492
v_smfmac_f32_16x16x64_bf16 v[96:99],v[16:19],v[48:55],v1
v_smfmac_f32_16x16x64_bf16 v[100:103],v[16:19],v[56:63],v1
v_smfmac_f32_16x16x64_bf16 v[96:99],v[20:23],v[64:71],v1
v_smfmac_f32_16x16x64_bf16 v[100:103],v[20:23],v[72:79],v1
s_waitcnt vmcnt(4)
v_max3_u32 v124,v24,v25,v26
v_max3_u32 v124,v124,v27,v28
v_max3_u32 v124,v124,v29,v30
v_max_u32 v124,v124,v31
v_cmp_eq_u32 vcc,-1,v124
s_cbranch_vccnz of_100493
v_smfmac_f32_16x16x64_bf16 v[96:99],v[24:27],v[80:87],v1
v_smfmac_f32_16x16x64_bf16 v[100:103],v[24:27],v[88:95],v1
v_smfmac_f32_16x16x64_bf16 v[96:99],v[28:31],v[128:135],v1
v_smfmac_f32_16x16x64_bf16 v[100:103],v[28:31],v[136:143],v1
s_waitcnt vmcnt(2)
v_max3_u32 v124,v32,v33,v34
v_max3_u32 v124,v124,v35,v36
v_max3_u32 v124,v124,v37,v38
v_max_u32 v124,v124,v39
v_cmp_eq_u32 vcc,-1,v124
s_cbranch_vccnz of_100494
v_smfmac_f32_16x16x64_bf16 v[96:99],v[32:35],v[144:151],v1
v_smfmac_f32_16x16x64_bf16 v[100:103],v[32:35],v[152:159],v1
v_smfmac_f32_16x16x64_bf16 v[96:99],v[36:39],v[160:167],v1
v_smfmac_f32_16x16x64_bf16 v[100:103],v[36:39],v[168:175],v1
s_waitcnt vmcnt(1)
v_max3_u32 v124,v40,v41,v42
v_max_u32 v124,v124,v43
v_cmp_eq_u32 vcc,-1,v124
s_cbranch_vccnz of_100495
v_smfmac_f32_16x16x64_bf16 v[96:99],v[40:43],v[176:183],v1
v_smfmac_f32_16x16x64_bf16 v[100:103],v[40:43],v[184:191],v1
s_waitcnt vmcnt(0)
v_max3_u32 v124,v44,v45,v46
v_max_u32 v124,v124,v47
v_cmp_eq_u32 vcc,-1,v124
s_cbranch_vccnz of_100496
v_smfmac_f32_16x16x64_bf16 v[96:99],v[44:47],v[192:199],v1
v_smfmac_f32_16x16x64_bf16 v[100:103],v[44:47],v[200:207],v1
oback_100503:
buffer_load_dword v119,off,s[20:23],s68 sc1
s_nop 3
v_add_f32 v96,v96,v97
v_add_f32 v98,v98,v99
s_nop 0
v_add_f32 v100,v100,v101
v_add_f32 v102,v102,v103
ds_write_addtid_b32 v96 offset:20992
ds_write_addtid_b32 v98 offset:23072
ds_write_addtid_b32 v100 offset:22016
ds_write_addtid_b32 v102 offset:24096
s_mov_b32 s96,s60
s_add_u32 s97,s60,4096
s_cmp_gt_u32 s50,1
s_waitcnt lgkmcnt(0)
s_barrier
s_cbranch_scc1 loop_100439
ds_read2st64_b32 v[48:49],v4 offset0:82 offset1:86
ds_read2st64_b32 v[50:51],v4 offset0:83 offset1:87
ds_read2st64_b32 v[52:53],v4 offset0:84 offset1:88
ds_read2st64_b32 v[54:55],v4 offset0:85 offset1:89
v_mov_b32 v96,v104
v_mov_b32 v97,v105
v_mov_b32 v98,v106
v_mov_b32 v99,v107
v_mov_b32 v100,v108
v_mov_b32 v101,v109
v_mov_b32 v102,v110
v_mov_b32 v103,v111
s_waitcnt lgkmcnt(2)
v_pk_add_f32 v[48:49],v[48:49],v[50:51]
s_waitcnt lgkmcnt(0)
v_pk_add_f32 v[52:53],v[52:53],v[54:55]
v_pk_add_f32 v[48:49],v[48:49],v[52:53]
v_cvt_pk_bf16_f32 v124,v48,v49
buffer_store_dword v124,v127,s[20:23],s89 offen
s_nop 7
buffer_store_dword v124,v127,s[20:23],s88 offen sc1
s_branch loop0_100443x
last_100440:
s_waitcnt vmcnt(3)
v_max3_u32 v124,v16,v17,v18
v_max_u32 v124,v124,v19
v_cmp_eq_u32 vcc,-1,v124
v_cndmask_b32 v121,2.0,v127,s[86:87]
s_cbranch_vccnz flb_100528
seg_100504:
segb_100512:
v_smfmac_f32_16x16x64_bf16 v[64:67],v[16:19],a[32:39],v1
buffer_load_dword v125,off,s[20:23],s92 sc1
buffer_load_dwordx4 v[32:35],v0,s[20:23],s93 offen offset:0 sc1
s_waitcnt vmcnt(4)
v_max3_u32 v124,v20,v21,v22
v_smfmac_f32_16x16x64_bf16 v[68:71],v[16:19],a[40:47],v1
v_max_u32 v124,v124,v23
v_cmp_eq_u32 vcc,-1,v124
v_smfmac_f32_16x16x64_bf16 v[72:75],v[16:19],a[48:55],v1
v_smfmac_f32_16x16x64_bf16 v[76:79],v[16:19],a[56:63],v1
s_cbranch_vccnz fl_100521
seg_100505:
segb_100513:
v_smfmac_f32_16x16x64_bf16 v[64:67],v[20:23],a[96:103],v1
buffer_load_dword v125,off,s[20:23],s92 sc1
buffer_load_dwordx4 v[36:39],v0,s[20:23],s93 offen offset:1024 sc1
s_waitcnt vmcnt(5)
v_max3_u32 v124,v24,v25,v26
v_smfmac_f32_16x16x64_bf16 v[68:71],v[20:23],a[104:111],v1
v_max_u32 v124,v124,v27
v_cmp_eq_u32 vcc,-1,v124
v_smfmac_f32_16x16x64_bf16 v[72:75],v[20:23],a[112:119],v1
v_smfmac_f32_16x16x64_bf16 v[76:79],v[20:23],a[120:127],v1
s_cbranch_vccnz fl_100522
seg_100506:
segb_100514:
v_smfmac_f32_16x16x64_bf16 v[64:67],v[24:27],a[160:167],v1
buffer_load_dword v125,off,s[20:23],s92 sc1
buffer_load_dwordx4 v[40:43],v0,s[20:23],s93 offen offset:2048 sc1
buffer_load_dwordx4 v[44:47],v0,s[20:23],s93 offen offset:3072 sc1
s_waitcnt vmcnt(7)
v_max3_u32 v124,v28,v29,v30
v_smfmac_f32_16x16x64_bf16 v[68:71],v[24:27],a[168:175],v1
v_max_u32 v124,v124,v31
v_cmp_eq_u32 vcc,-1,v124
v_smfmac_f32_16x16x64_bf16 v[72:75],v[24:27],a[176:183],v1
v_smfmac_f32_16x16x64_bf16 v[76:79],v[24:27],a[184:191],v1
s_cbranch_vccnz fl_100523
seg_100507:
segb_100515:
v_smfmac_f32_16x16x64_bf16 v[64:67],v[28:31],a[224:231],v1
buffer_load_dword v125,off,s[20:23],s92 sc1
buffer_store_dword v126,v121,s[20:23],s69 offen sc1
s_waitcnt vmcnt(7)
v_max3_u32 v124,v32,v33,v34
v_smfmac_f32_16x16x64_bf16 v[68:71],v[28:31],a[232:239],v1
v_max_u32 v124,v124,v35
v_cmp_eq_u32 vcc,-1,v124
v_smfmac_f32_16x16x64_bf16 v[72:75],v[28:31],a[240:247],v1
v_smfmac_f32_16x16x64_bf16 v[76:79],v[28:31],a[248:255],v1
s_cbranch_vccnz fl_100524
seg_100508:
segb_100516:
v_smfmac_f32_16x16x64_bf16 v[64:67],v[32:35],a[32:39],v1
buffer_load_dword v125,off,s[20:23],s92 sc1
s_waitcnt vmcnt(6)
v_max3_u32 v124,v36,v37,v38
v_smfmac_f32_16x16x64_bf16 v[68:71],v[32:35],a[40:47],v1
v_max_u32 v124,v124,v39
v_cmp_eq_u32 vcc,-1,v124
v_smfmac_f32_16x16x64_bf16 v[72:75],v[32:35],a[48:55],v1
v_smfmac_f32_16x16x64_bf16 v[76:79],v[32:35],a[56:63],v1
s_cbranch_vccnz fl_100525
seg_100509:
segb_100517:
v_smfmac_f32_16x16x64_bf16 v[64:67],v[36:39],a[96:103],v1
buffer_load_dword v125,off,s[20:23],s92 sc1
s_waitcnt vmcnt(4)
v_max3_u32 v124,v40,v41,v42
v_smfmac_f32_16x16x64_bf16 v[68:71],v[36:39],a[104:111],v1
v_max3_u32 v124,v124,v43,v44
v_max3_u32 v124,v124,v45,v46
v_max_u32 v124,v124,v47
v_cmp_eq_u32 vcc,-1,v124
v_smfmac_f32_16x16x64_bf16 v[72:75],v[36:39],a[112:119],v1
v_smfmac_f32_16x16x64_bf16 v[76:79],v[36:39],a[120:127],v1
s_cbranch_vccnz fl_100526
seg_100510:
segb_100518:
v_smfmac_f32_16x16x64_bf16 v[64:67],v[40:43],a[160:167],v1
v_smfmac_f32_16x16x64_bf16 v[68:71],v[40:43],a[168:175],v1
v_smfmac_f32_16x16x64_bf16 v[64:67],v[44:47],a[224:231],v1
v_smfmac_f32_16x16x64_bf16 v[68:71],v[44:47],a[232:239],v1
v_smfmac_f32_16x16x64_bf16 v[72:75],v[40:43],a[176:183],v1
s_nop 1
v_add_f32 v64,v64,v65
v_smfmac_f32_16x16x64_bf16 v[76:79],v[40:43],a[184:191],v1
ds_write_addtid_b32 v64 offset:8448
v_add_f32 v66,v66,v67
v_smfmac_f32_16x16x64_bf16 v[72:75],v[44:47],a[240:247],v1
ds_write_addtid_b32 v66 offset:9488
v_add_f32 v68,v68,v69
v_smfmac_f32_16x16x64_bf16 v[76:79],v[44:47],a[248:255],v1
ds_write_addtid_b32 v68 offset:10528
v_add_f32 v70,v70,v71
v_smfmac_f32_16x16x64_bf16 v[80:83],v[16:19],v[208:215],v1
ds_write_addtid_b32 v70 offset:11568
v_add_f32 v72,v72,v73
v_smfmac_f32_16x16x64_bf16 v[80:83],v[32:35],v[208:215],v1
ds_write_addtid_b32 v72 offset:12608
v_add_f32 v74,v74,v75
v_smfmac_f32_16x16x64_bf16 v[84:87],v[16:19],v[216:223],v1
ds_write_addtid_b32 v74 offset:13648
v_add_f32 v76,v76,v77
v_smfmac_f32_16x16x64_bf16 v[84:87],v[32:35],v[216:223],v1
ds_write_addtid_b32 v76 offset:14688
v_add_f32 v78,v78,v79
v_smfmac_f32_16x16x64_bf16 v[88:91],v[16:19],v[224:231],v1
ds_write_addtid_b32 v78 offset:15728
v_smfmac_f32_16x16x64_bf16 v[88:91],v[32:35],v[224:231],v1
v_smfmac_f32_16x16x64_bf16 v[92:95],v[16:19],v[232:239],v1
v_smfmac_f32_16x16x64_bf16 v[92:95],v[32:35],v[232:239],v1
doneA_100537:
s_waitcnt vmcnt(0) lgkmcnt(0)
s_add_u32 s64,s79,0
s_lshl_b32 s65,s64,12
s_and_b32 s65,s65,0x2000
s_xor_b32 s65,s65,s67
s_lshl_b32 s64,s64,20
s_add_u32 s65,s65,s64
s_add_u32 s101,s65,s78
v_smfmac_f32_16x16x64_bf16 v[80:83],v[20:23],v[240:247],v1
ds_read_b128 v[48:51],v7 offset:0
ds_read_b128 v[52:55],v7 offset:1024
v_smfmac_f32_16x16x64_bf16 v[80:83],v[36:39],v[240:247],v1
ds_read_b128 v[56:59],v7 offset:2048
ds_read_b128 v[60:63],v7 offset:3072
v_smfmac_f32_16x16x64_bf16 v[84:87],v[20:23],v[248:255],v1
ds_read_b128 v[64:67],v7 offset:4096
ds_read_b128 v[68:71],v7 offset:5120
v_smfmac_f32_16x16x64_bf16 v[84:87],v[36:39],v[248:255],v1
ds_read_b128 v[72:75],v7 offset:6144
ds_read_b128 v[76:79],v7 offset:7168
s_waitcnt lgkmcnt(6)
v_smfmac_f32_16x16x64_bf16 v[88:91],v[20:23],v[48:55],v1
v_smfmac_f32_16x16x64_bf16 v[88:91],v[36:39],v[48:55],v1
ds_read_b128 v[48:51],v7 offset:8192
ds_read_b128 v[52:55],v7 offset:9216
s_waitcnt lgkmcnt(6)
v_smfmac_f32_16x16x64_bf16 v[92:95],v[20:23],v[56:63],v1
v_smfmac_f32_16x16x64_bf16 v[92:95],v[36:39],v[56:63],v1
ds_read_b128 v[56:59],v7 offset:10240
ds_read_b128 v[60:63],v7 offset:11264
s_waitcnt lgkmcnt(6)
v_smfmac_f32_16x16x64_bf16 v[80:83],v[24:27],v[64:71],v1
v_smfmac_f32_16x16x64_bf16 v[80:83],v[40:43],v[64:71],v1
ds_read_b128 v[64:67],v7 offset:12288
ds_read_b128 v[68:71],v7 offset:13312
s_waitcnt lgkmcnt(6)
v_smfmac_f32_16x16x64_bf16 v[84:87],v[24:27],v[72:79],v1
v_smfmac_f32_16x16x64_bf16 v[84:87],v[40:43],v[72:79],v1
ds_read_b128 v[72:75],v7 offset:14336
ds_read_b128 v[76:79],v7 offset:15360
s_waitcnt lgkmcnt(6)
v_smfmac_f32_16x16x64_bf16 v[88:91],v[24:27],v[48:55],v1
v_smfmac_f32_16x16x64_bf16 v[88:91],v[40:43],v[48:55],v1
ds_read_b128 v[48:51],v7 offset:16384
ds_read_b128 v[52:55],v7 offset:17408
s_waitcnt lgkmcnt(6)
v_smfmac_f32_16x16x64_bf16 v[92:95],v[24:27],v[56:63],v1
v_smfmac_f32_16x16x64_bf16 v[92:95],v[40:43],v[56:63],v1
ds_read_b128 v[56:59],v7 offset:18432
ds_read_b128 v[60:63],v7 offset:19456
s_waitcnt lgkmcnt(6)
v_smfmac_f32_16x16x64_bf16 v[80:83],v[28:31],v[64:71],v1
v_smfmac_f32_16x16x64_bf16 v[80:83],v[44:47],v[64:71],v1
s_waitcnt lgkmcnt(4)
v_smfmac_f32_16x16x64_bf16 v[84:87],v[28:31],v[72:79],v1
v_smfmac_f32_16x16x64_bf16 v[84:87],v[44:47],v[72:79],v1
s_waitcnt lgkmcnt(2)
v_smfmac_f32_16x16x64_bf16 v[88:91],v[28:31],v[48:55],v1
v_add_f32 v80,v80,v81
v_smfmac_f32_16x16x64_bf16 v[88:91],v[44:47],v[48:55],v1
v_add_f32 v82,v82,v83
s_waitcnt lgkmcnt(0)
v_smfmac_f32_16x16x64_bf16 v[92:95],v[28:31],v[56:63],v1
v_cvt_pk_bf16_f32 v80,v80,v82
v_smfmac_f32_16x16x64_bf16 v[92:95],v[44:47],v[56:63],v1
ds_write_addtid_b32 v80 offset:16896
v_add_f32 v84,v84,v85
v_add_f32 v86,v86,v87
v_cvt_pk_bf16_f32 v84,v84,v86
v_add_f32 v88,v88,v89
v_add_f32 v90,v90,v91
v_cvt_pk_bf16_f32 v88,v88,v90
s_nop 0
v_add_f32 v92,v92,v93
v_add_f32 v94,v94,v95
v_cvt_pk_bf16_f32 v92,v92,v94
ds_write_addtid_b32 v84 offset:17920
ds_write_addtid_b32 v88 offset:18944
ds_write_addtid_b32 v92 offset:19968
s_waitcnt lgkmcnt(0)
s_barrier
s_cmp_gt_u32 s50,1
s_cbranch_scc1 l23_100538
ds_read2st64_b32 v[112:113],v127 offset0:66 offset1:67
ds_read2st64_b32 v[114:115],v127 offset0:68 offset1:69
ds_read2st64_b32 v[116:117],v127 offset0:70 offset1:71
ds_read2st64_b32 v[118:119],v127 offset0:72 offset1:73
s_waitcnt lgkmcnt(0)
v_mov_b32 v120,v5
v_mov_b32 v121,v5
v_mov_b32 v122,v5
v_mov_b32 v123,v5
s_nop 1
v_mfma_f32_16x16x32_bf16 v[112:115],v[120:123],v[112:115],0
v_mfma_f32_16x16x32_bf16 v[116:119],v[120:123],v[116:119],0
s_nop 4
v_cvt_pk_bf16_f32 v112,v112,v113
v_cvt_pk_bf16_f32 v113,v114,v115
s_nop 0
v_cvt_pk_bf16_f32 v114,v116,v117
v_cvt_pk_bf16_f32 v115,v118,v119
s_branch lj_100539
l23_100538:
ds_read_b128 v[48:51],v2 offset:0
ds_read_b128 v[52:55],v2 offset:256
ds_read_b128 v[56:59],v2 offset:512
ds_read_b128 v[60:63],v2 offset:768
ds_read_b128 v[64:67],v2 offset:16
ds_read_b128 v[68:71],v2 offset:272
ds_read_b128 v[72:75],v2 offset:528
ds_read_b128 v[76:79],v2 offset:784
s_waitcnt lgkmcnt(6)
v_pk_add_f32 v[48:49],v[48:49],v[52:53]
v_pk_add_f32 v[50:51],v[50:51],v[54:55]
s_waitcnt lgkmcnt(4)
v_pk_add_f32 v[56:57],v[56:57],v[60:61]
v_pk_add_f32 v[58:59],v[58:59],v[62:63]
v_pk_add_f32 v[48:49],v[48:49],v[56:57]
v_pk_add_f32 v[50:51],v[50:51],v[58:59]
v_cvt_pk_bf16_f32 v112,v48,v49
v_cvt_pk_bf16_f32 v113,v50,v51
s_waitcnt lgkmcnt(2)
v_pk_add_f32 v[64:65],v[64:65],v[68:69]
v_pk_add_f32 v[66:67],v[66:67],v[70:71]
s_waitcnt lgkmcnt(0)
v_pk_add_f32 v[72:73],v[72:73],v[76:77]
v_pk_add_f32 v[74:75],v[74:75],v[78:79]
v_pk_add_f32 v[64:65],v[64:65],v[72:73]
v_pk_add_f32 v[66:67],v[66:67],v[74:75]
v_cvt_pk_bf16_f32 v114,v64,v65
v_cvt_pk_bf16_f32 v115,v66,v67
lj_100539:
v_cndmask_b32 v120,2.0,v0,s[82:83]
v_cndmask_b32 v121,2.0,v127,s[86:87]
buffer_store_dwordx4 v[112:115],v120,s[20:23],s101 offen sc1
s_waitcnt vmcnt(0)
s_barrier
v_mov_b32 v126,64
buffer_store_dword v126,v121,s[20:23],s69 offen sc1
s_branch recfin_100430
pe_100445:
s_waitcnt vmcnt(5)
v_readfirstlane_b32 s91,v119
s_cmp_gt_u32 s91,s79
s_cbranch_scc0 pb_100446
s_add_u32 s64,s79,0
s_lshl_b32 s65,s64,12
s_and_b32 s65,s65,0x2000
s_xor_b32 s65,s65,s67
s_lshl_b32 s64,s64,20
s_add_u32 s65,s65,s64
s_add_u32 s62,s65,s77
buffer_load_dwordx4 v[96:99],v0,s[20:23],s62 offen
buffer_load_dwordx4 v[100:103],v0,s[20:23],s62 offen offset:1024
s_mov_b32 s61,0
s_branch pb_100446
pq_100447:
s_cmp_gt_u32 s91,s79
s_cbranch_scc1 pg_100450
pl_100449:
buffer_load_dword v124,off,s[20:23],s68 sc1
s_waitcnt vmcnt(0)
v_readfirstlane_b32 s91,v124
s_cmp_gt_u32 s91,s79
s_cbranch_scc1 pg_100450
s_sleep 2
s_sub_u32 s90,s90,1
s_cmp_gt_i32 s90,0
s_cbranch_scc1 pl_100449
pg_100450:
s_add_u32 s64,s79,0
s_lshl_b32 s65,s64,12
s_and_b32 s65,s65,0x2000
s_xor_b32 s65,s65,s67
s_lshl_b32 s64,s64,20
s_add_u32 s65,s65,s64
s_add_u32 s62,s65,s77
buffer_load_dwordx4 v[96:99],v0,s[20:23],s62 offen
buffer_load_dwordx4 v[100:103],v0,s[20:23],s62 offen offset:1024
s_waitcnt vmcnt(0)
s_branch pk_100448
fl_100467:
flb_100475:
buffer_load_dwordx4 v[16:19],v0,s[20:23],s92 offen offset:0 sc1
s_mov_b32 s55,1
buffer_load_dwordx4 v[32:35],v0,s[20:23],s93 offen offset:0 sc1
s_waitcnt vmcnt(4)
v_max3_u32 v124,v20,v21,v22
v_max_u32 v124,v124,v23
v_cmp_eq_u32 vcc,-1,v124
s_cbranch_vccnz dfl_100540
v_smfmac_f32_16x16x64_bf16 v[48:51],v[20:23],a[64:71],v1
buffer_load_dword v125,off,s[20:23],s92 sc1
v_smfmac_f32_16x16x64_bf16 v[52:55],v[20:23],a[72:79],v1
buffer_load_dwordx4 v[36:39],v0,s[20:23],s93 offen offset:1024 sc1
v_smfmac_f32_16x16x64_bf16 v[56:59],v[20:23],a[80:87],v1
s_waitcnt vmcnt(5)
v_max3_u32 v124,v24,v25,v26
v_smfmac_f32_16x16x64_bf16 v[60:63],v[20:23],a[88:95],v1
v_max_u32 v124,v124,v27
v_smfmac_f32_16x16x64_bf16 v[64:67],v[20:23],a[96:103],v1
v_cmp_eq_u32 vcc,-1,v124
v_smfmac_f32_16x16x64_bf16 v[68:71],v[20:23],a[104:111],v1
v_smfmac_f32_16x16x64_bf16 v[72:75],v[20:23],a[112:119],v1
v_smfmac_f32_16x16x64_bf16 v[76:79],v[20:23],a[120:127],v1
s_cbranch_vccnz dfl_100541
v_smfmac_f32_16x16x64_bf16 v[48:51],v[24:27],a[128:135],v1
buffer_load_dword v125,off,s[20:23],s92 sc1
v_smfmac_f32_16x16x64_bf16 v[52:55],v[24:27],a[136:143],v1
buffer_load_dwordx4 v[40:43],v0,s[20:23],s93 offen offset:2048 sc1
v_smfmac_f32_16x16x64_bf16 v[56:59],v[24:27],a[144:151],v1
buffer_load_dwordx4 v[44:47],v0,s[20:23],s93 offen offset:3072 sc1
s_waitcnt vmcnt(7)
v_max3_u32 v124,v28,v29,v30
v_smfmac_f32_16x16x64_bf16 v[60:63],v[24:27],a[152:159],v1
v_max_u32 v124,v124,v31
v_smfmac_f32_16x16x64_bf16 v[64:67],v[24:27],a[160:167],v1
v_cmp_eq_u32 vcc,-1,v124
v_smfmac_f32_16x16x64_bf16 v[68:71],v[24:27],a[168:175],v1
v_smfmac_f32_16x16x64_bf16 v[72:75],v[24:27],a[176:183],v1
v_smfmac_f32_16x16x64_bf16 v[76:79],v[24:27],a[184:191],v1
s_cbranch_vccnz dfl_100542
v_smfmac_f32_16x16x64_bf16 v[48:51],v[28:31],a[192:199],v1
buffer_load_dword v125,off,s[20:23],s92 sc1
v_smfmac_f32_16x16x64_bf16 v[52:55],v[28:31],a[200:207],v1
buffer_store_dword v126,v121,s[20:23],s69 offen sc1
v_smfmac_f32_16x16x64_bf16 v[56:59],v[28:31],a[208:215],v1
s_waitcnt vmcnt(8)
v_max3_u32 v124,v16,v17,v18
v_smfmac_f32_16x16x64_bf16 v[60:63],v[28:31],a[216:223],v1
v_max_u32 v124,v124,v19
v_smfmac_f32_16x16x64_bf16 v[64:67],v[28:31],a[224:231],v1
v_cmp_eq_u32 vcc,-1,v124
v_smfmac_f32_16x16x64_bf16 v[68:71],v[28:31],a[232:239],v1
v_smfmac_f32_16x16x64_bf16 v[72:75],v[28:31],a[240:247],v1
v_smfmac_f32_16x16x64_bf16 v[76:79],v[28:31],a[248:255],v1
s_cbranch_vccnz lfb_100547
s_mov_b32 s55,0
v_smfmac_f32_16x16x64_bf16 v[48:51],v[16:19],a[0:7],v1
v_smfmac_f32_16x16x64_bf16 v[52:55],v[16:19],a[8:15],v1
v_smfmac_f32_16x16x64_bf16 v[56:59],v[16:19],a[16:23],v1
s_waitcnt vmcnt(7)
v_max3_u32 v124,v32,v33,v34
v_max_u32 v124,v124,v35
v_cmp_eq_u32 vcc,-1,v124
v_smfmac_f32_16x16x64_bf16 v[60:63],v[16:19],a[24:31],v1
v_smfmac_f32_16x16x64_bf16 v[64:67],v[16:19],a[32:39],v1
v_smfmac_f32_16x16x64_bf16 v[68:71],v[16:19],a[40:47],v1
v_smfmac_f32_16x16x64_bf16 v[72:75],v[16:19],a[48:55],v1
v_smfmac_f32_16x16x64_bf16 v[76:79],v[16:19],a[56:63],v1
s_cbranch_vccnz flb_100479
s_branch segb_100463
fl_100468:
v_smfmac_f32_16x16x64_bf16 v[76:79],v[16:19],a[56:63],v1
flb_100476:
buffer_load_dwordx4 v[20:23],v0,s[20:23],s92 offen offset:1024 sc1
s_mov_b32 s55,2
buffer_load_dwordx4 v[36:39],v0,s[20:23],s93 offen offset:1024 sc1
s_waitcnt vmcnt(5)
v_max3_u32 v124,v24,v25,v26
v_max_u32 v124,v124,v27
v_cmp_eq_u32 vcc,-1,v124
s_cbranch_vccnz dfl_100541
v_smfmac_f32_16x16x64_bf16 v[48:51],v[24:27],a[128:135],v1
buffer_load_dword v125,off,s[20:23],s92 sc1
v_smfmac_f32_16x16x64_bf16 v[52:55],v[24:27],a[136:143],v1
buffer_load_dwordx4 v[40:43],v0,s[20:23],s93 offen offset:2048 sc1
v_smfmac_f32_16x16x64_bf16 v[56:59],v[24:27],a[144:151],v1
buffer_load_dwordx4 v[44:47],v0,s[20:23],s93 offen offset:3072 sc1
s_waitcnt vmcnt(7)
v_max3_u32 v124,v28,v29,v30
v_smfmac_f32_16x16x64_bf16 v[60:63],v[24:27],a[152:159],v1
v_max_u32 v124,v124,v31
v_smfmac_f32_16x16x64_bf16 v[64:67],v[24:27],a[160:167],v1
v_cmp_eq_u32 vcc,-1,v124
v_smfmac_f32_16x16x64_bf16 v[68:71],v[24:27],a[168:175],v1
v_smfmac_f32_16x16x64_bf16 v[72:75],v[24:27],a[176:183],v1
v_smfmac_f32_16x16x64_bf16 v[76:79],v[24:27],a[184:191],v1
s_cbranch_vccnz dfl_100542
v_smfmac_f32_16x16x64_bf16 v[48:51],v[28:31],a[192:199],v1
buffer_load_dword v125,off,s[20:23],s92 sc1
v_smfmac_f32_16x16x64_bf16 v[52:55],v[28:31],a[200:207],v1
buffer_store_dword v126,v121,s[20:23],s69 offen sc1
v_smfmac_f32_16x16x64_bf16 v[56:59],v[28:31],a[208:215],v1
s_waitcnt vmcnt(6)
v_max3_u32 v124,v20,v21,v22
v_smfmac_f32_16x16x64_bf16 v[60:63],v[28:31],a[216:223],v1
v_max_u32 v124,v124,v23
v_smfmac_f32_16x16x64_bf16 v[64:67],v[28:31],a[224:231],v1
v_cmp_eq_u32 vcc,-1,v124
v_smfmac_f32_16x16x64_bf16 v[68:71],v[28:31],a[232:239],v1
v_smfmac_f32_16x16x64_bf16 v[72:75],v[28:31],a[240:247],v1
v_smfmac_f32_16x16x64_bf16 v[76:79],v[28:31],a[248:255],v1
s_cbranch_vccnz lfb_100547
s_mov_b32 s55,0
v_smfmac_f32_16x16x64_bf16 v[48:51],v[20:23],a[64:71],v1
v_smfmac_f32_16x16x64_bf16 v[52:55],v[20:23],a[72:79],v1
v_smfmac_f32_16x16x64_bf16 v[56:59],v[20:23],a[80:87],v1
s_waitcnt vmcnt(7)
v_max3_u32 v124,v32,v33,v34
v_max_u32 v124,v124,v35
v_cmp_eq_u32 vcc,-1,v124
v_smfmac_f32_16x16x64_bf16 v[60:63],v[20:23],a[88:95],v1
v_smfmac_f32_16x16x64_bf16 v[64:67],v[20:23],a[96:103],v1
v_smfmac_f32_16x16x64_bf16 v[68:71],v[20:23],a[104:111],v1
v_smfmac_f32_16x16x64_bf16 v[72:75],v[20:23],a[112:119],v1
v_smfmac_f32_16x16x64_bf16 v[76:79],v[20:23],a[120:127],v1
s_cbranch_vccnz flb_100479
s_branch segb_100463
fl_100469:
v_smfmac_f32_16x16x64_bf16 v[76:79],v[20:23],a[120:127],v1
flb_100477:
buffer_load_dwordx4 v[24:27],v0,s[20:23],s92 offen offset:2048 sc1
s_mov_b32 s55,4
buffer_load_dwordx4 v[40:43],v0,s[20:23],s93 offen offset:2048 sc1
buffer_load_dwordx4 v[44:47],v0,s[20:23],s93 offen offset:3072 sc1
s_waitcnt vmcnt(7)
v_max3_u32 v124,v28,v29,v30
v_max_u32 v124,v124,v31
v_cmp_eq_u32 vcc,-1,v124
s_cbranch_vccnz dfl_100542
v_smfmac_f32_16x16x64_bf16 v[48:51],v[28:31],a[192:199],v1
buffer_load_dword v125,off,s[20:23],s92 sc1
v_smfmac_f32_16x16x64_bf16 v[52:55],v[28:31],a[200:207],v1
buffer_store_dword v126,v121,s[20:23],s69 offen sc1
v_smfmac_f32_16x16x64_bf16 v[56:59],v[28:31],a[208:215],v1
s_waitcnt vmcnt(4)
v_max3_u32 v124,v24,v25,v26
v_smfmac_f32_16x16x64_bf16 v[60:63],v[28:31],a[216:223],v1
v_max_u32 v124,v124,v27
v_smfmac_f32_16x16x64_bf16 v[64:67],v[28:31],a[224:231],v1
v_cmp_eq_u32 vcc,-1,v124
v_smfmac_f32_16x16x64_bf16 v[68:71],v[28:31],a[232:239],v1
v_smfmac_f32_16x16x64_bf16 v[72:75],v[28:31],a[240:247],v1
v_smfmac_f32_16x16x64_bf16 v[76:79],v[28:31],a[248:255],v1
s_cbranch_vccnz lfb_100547
s_mov_b32 s55,0
v_smfmac_f32_16x16x64_bf16 v[48:51],v[24:27],a[128:135],v1
v_smfmac_f32_16x16x64_bf16 v[52:55],v[24:27],a[136:143],v1
v_smfmac_f32_16x16x64_bf16 v[56:59],v[24:27],a[144:151],v1
s_waitcnt vmcnt(7)
v_max3_u32 v124,v32,v33,v34
v_max_u32 v124,v124,v35
v_cmp_eq_u32 vcc,-1,v124
v_smfmac_f32_16x16x64_bf16 v[60:63],v[24:27],a[152:159],v1
v_smfmac_f32_16x16x64_bf16 v[64:67],v[24:27],a[160:167],v1
v_smfmac_f32_16x16x64_bf16 v[68:71],v[24:27],a[168:175],v1
v_smfmac_f32_16x16x64_bf16 v[72:75],v[24:27],a[176:183],v1
v_smfmac_f32_16x16x64_bf16 v[76:79],v[24:27],a[184:191],v1
s_cbranch_vccnz flb_100479
s_branch segb_100463
fl_100470:
v_smfmac_f32_16x16x64_bf16 v[76:79],v[24:27],a[184:191],v1
flb_100478:
buffer_load_dwordx4 v[28:31],v0,s[20:23],s92 offen offset:3072 sc1
s_mov_b32 s55,8
buffer_store_dword v126,v121,s[20:23],s69 offen sc1
s_waitcnt vmcnt(1)
v_max3_u32 v124,v28,v29,v30
v_max_u32 v124,v124,v31
v_cmp_eq_u32 vcc,-1,v124
s_cbranch_vccnz lfb_100547
s_mov_b32 s55,0
v_smfmac_f32_16x16x64_bf16 v[48:51],v[28:31],a[192:199],v1
v_smfmac_f32_16x16x64_bf16 v[52:55],v[28:31],a[200:207],v1
v_smfmac_f32_16x16x64_bf16 v[56:59],v[28:31],a[208:215],v1
s_waitcnt vmcnt(7)
v_max3_u32 v124,v32,v33,v34
v_max_u32 v124,v124,v35
v_cmp_eq_u32 vcc,-1,v124
v_smfmac_f32_16x16x64_bf16 v[60:63],v[28:31],a[216:223],v1
v_smfmac_f32_16x16x64_bf16 v[64:67],v[28:31],a[224:231],v1
v_smfmac_f32_16x16x64_bf16 v[68:71],v[28:31],a[232:239],v1
v_smfmac_f32_16x16x64_bf16 v[72:75],v[28:31],a[240:247],v1
v_smfmac_f32_16x16x64_bf16 v[76:79],v[28:31],a[248:255],v1
s_cbranch_vccnz flb_100479
s_branch segb_100463
fl_100471:
v_smfmac_f32_16x16x64_bf16 v[76:79],v[28:31],a[248:255],v1
flb_100479:
buffer_load_dwordx4 v[32:35],v0,s[20:23],s93 offen offset:0 sc1
s_mov_b32 s55,240
s_bitcmp1_b32 s55,5
s_cbranch_scc0 rdn_100550
s_waitcnt vmcnt(6)
v_max3_u32 v124,v36,v37,v38
v_max_u32 v124,v124,v39
v_cmp_eq_u32 vcc,-1,v124
s_cbranch_vccnz rfa_100551
buffer_load_dword v125,off,s[20:23],s92 sc1
s_bitset0_b32 s55,5
v_smfmac_f32_16x16x64_bf16 v[48:51],v[36:39],a[64:71],v1
v_smfmac_f32_16x16x64_bf16 v[52:55],v[36:39],a[72:79],v1
v_smfmac_f32_16x16x64_bf16 v[56:59],v[36:39],a[80:87],v1
v_smfmac_f32_16x16x64_bf16 v[60:63],v[36:39],a[88:95],v1
v_smfmac_f32_16x16x64_bf16 v[64:67],v[36:39],a[96:103],v1
v_smfmac_f32_16x16x64_bf16 v[68:71],v[36:39],a[104:111],v1
v_smfmac_f32_16x16x64_bf16 v[72:75],v[36:39],a[112:119],v1
v_smfmac_f32_16x16x64_bf16 v[76:79],v[36:39],a[120:127],v1
s_cmp_eq_u32 s55,0
s_cbranch_scc1 segb_100465
s_branch rnx_100552
rdn_100550:
buffer_load_dword v125,off,s[20:23],s92 sc1
s_branch rnx_100552
rfa_100551:
buffer_load_dwordx4 v[36:39],v0,s[20:23],s93 offen offset:1024 sc1
rnx_100552:
s_bitcmp1_b32 s55,6
s_cbranch_scc0 rdn_100553
s_waitcnt vmcnt(5)
v_max3_u32 v124,v40,v41,v42
v_max_u32 v124,v124,v43
v_cmp_eq_u32 vcc,-1,v124
s_cbranch_vccnz rfa_100554
buffer_load_dword v125,off,s[20:23],s92 sc1
s_bitset0_b32 s55,6
s_cmp_eq_u32 s55,0
s_cbranch_scc1 segb_100465
s_branch rnx_100555
rdn_100553:
buffer_load_dword v125,off,s[20:23],s92 sc1
s_branch rnx_100555
rfa_100554:
buffer_load_dwordx4 v[40:43],v0,s[20:23],s93 offen offset:2048 sc1
rnx_100555:
s_bitcmp1_b32 s55,7
s_cbranch_scc0 rdn_100556
s_waitcnt vmcnt(5)
v_max3_u32 v124,v44,v45,v46
v_max_u32 v124,v124,v47
v_cmp_eq_u32 vcc,-1,v124
s_cbranch_vccnz rfa_100557
buffer_load_dword v125,off,s[20:23],s92 sc1
s_bitset0_b32 s55,7
s_cmp_eq_u32 s55,0
s_cbranch_scc1 segb_100465
s_branch rnx_100558
rdn_100556:
buffer_load_dword v125,off,s[20:23],s92 sc1
s_branch rnx_100558
rfa_100557:
buffer_load_dwordx4 v[44:47],v0,s[20:23],s93 offen offset:3072 sc1
rnx_100558:
rot_100549:
s_bitcmp1_b32 s55,4
s_cbranch_scc0 rdn_100559
s_waitcnt vmcnt(3)
v_max3_u32 v124,v32,v33,v34
v_max_u32 v124,v124,v35
v_cmp_eq_u32 vcc,-1,v124
s_cbranch_vccnz rfa_100560
buffer_load_dword v125,off,s[20:23],s92 sc1
s_bitset0_b32 s55,4
v_smfmac_f32_16x16x64_bf16 v[48:51],v[32:35],a[0:7],v1
v_smfmac_f32_16x16x64_bf16 v[52:55],v[32:35],a[8:15],v1
v_smfmac_f32_16x16x64_bf16 v[56:59],v[32:35],a[16:23],v1
v_smfmac_f32_16x16x64_bf16 v[60:63],v[32:35],a[24:31],v1
v_smfmac_f32_16x16x64_bf16 v[64:67],v[32:35],a[32:39],v1
v_smfmac_f32_16x16x64_bf16 v[68:71],v[32:35],a[40:47],v1
v_smfmac_f32_16x16x64_bf16 v[72:75],v[32:35],a[48:55],v1
v_smfmac_f32_16x16x64_bf16 v[76:79],v[32:35],a[56:63],v1
s_cmp_eq_u32 s55,0
s_cbranch_scc1 segb_100465
s_branch rnx_100561
rdn_100559:
buffer_load_dword v125,off,s[20:23],s92 sc1
s_branch rnx_100561
rfa_100560:
buffer_load_dwordx4 v[32:35],v0,s[20:23],s93 offen offset:0 sc1
rnx_100561:
s_bitcmp1_b32 s55,5
s_cbranch_scc0 rdn_100562
s_waitcnt vmcnt(3)
v_max3_u32 v124,v36,v37,v38
v_max_u32 v124,v124,v39
v_cmp_eq_u32 vcc,-1,v124
s_cbranch_vccnz rfa_100563
buffer_load_dword v125,off,s[20:23],s92 sc1
s_bitset0_b32 s55,5
v_smfmac_f32_16x16x64_bf16 v[48:51],v[36:39],a[64:71],v1
v_smfmac_f32_16x16x64_bf16 v[52:55],v[36:39],a[72:79],v1
v_smfmac_f32_16x16x64_bf16 v[56:59],v[36:39],a[80:87],v1
v_smfmac_f32_16x16x64_bf16 v[60:63],v[36:39],a[88:95],v1
v_smfmac_f32_16x16x64_bf16 v[64:67],v[36:39],a[96:103],v1
v_smfmac_f32_16x16x64_bf16 v[68:71],v[36:39],a[104:111],v1
v_smfmac_f32_16x16x64_bf16 v[72:75],v[36:39],a[112:119],v1
v_smfmac_f32_16x16x64_bf16 v[76:79],v[36:39],a[120:127],v1
s_cmp_eq_u32 s55,0
s_cbranch_scc1 segb_100465
s_branch rnx_100564
rdn_100562:
buffer_load_dword v125,off,s[20:23],s92 sc1
s_branch rnx_100564
rfa_100563:
buffer_load_dwordx4 v[36:39],v0,s[20:23],s93 offen offset:1024 sc1
rnx_100564:
s_bitcmp1_b32 s55,6
s_cbranch_scc0 rdn_100565
s_waitcnt vmcnt(3)
v_max3_u32 v124,v40,v41,v42
v_max_u32 v124,v124,v43
v_cmp_eq_u32 vcc,-1,v124
s_cbranch_vccnz rfa_100566
buffer_load_dword v125,off,s[20:23],s92 sc1
s_bitset0_b32 s55,6
s_cmp_eq_u32 s55,0
s_cbranch_scc1 segb_100465
s_branch rnx_100567
rdn_100565:
buffer_load_dword v125,off,s[20:23],s92 sc1
s_branch rnx_100567
rfa_100566:
buffer_load_dwordx4 v[40:43],v0,s[20:23],s93 offen offset:2048 sc1
rnx_100567:
s_bitcmp1_b32 s55,7
s_cbranch_scc0 rdn_100568
s_waitcnt vmcnt(3)
v_max3_u32 v124,v44,v45,v46
v_max_u32 v124,v124,v47
v_cmp_eq_u32 vcc,-1,v124
s_cbranch_vccnz rfa_100569
buffer_load_dword v125,off,s[20:23],s92 sc1
s_bitset0_b32 s55,7
s_cmp_eq_u32 s55,0
s_cbranch_scc1 segb_100465
s_branch rnx_100570
rdn_100568:
buffer_load_dword v125,off,s[20:23],s92 sc1
s_branch rnx_100570
rfa_100569:
buffer_load_dwordx4 v[44:47],v0,s[20:23],s93 offen offset:3072 sc1
rnx_100570:
s_sub_u32 s90,s90,1
s_cmp_gt_i32 s90,0
s_cbranch_scc1 rot_100549
s_mov_b32 s55,0
s_branch segb_100465
fl_100472:
v_smfmac_f32_16x16x64_bf16 v[76:79],v[32:35],a[56:63],v1
flb_100480:
buffer_load_dwordx4 v[36:39],v0,s[20:23],s93 offen offset:1024 sc1
s_mov_b32 s55,224
s_bitcmp1_b32 s55,6
s_cbranch_scc0 rdn_100572
s_waitcnt vmcnt(5)
v_max3_u32 v124,v40,v41,v42
v_max_u32 v124,v124,v43
v_cmp_eq_u32 vcc,-1,v124
s_cbranch_vccnz rfa_100573
buffer_load_dword v125,off,s[20:23],s92 sc1
s_bitset0_b32 s55,6
s_cmp_eq_u32 s55,0
s_cbranch_scc1 segb_100465
s_branch rnx_100574
rdn_100572:
buffer_load_dword v125,off,s[20:23],s92 sc1
s_branch rnx_100574
rfa_100573:
buffer_load_dwordx4 v[40:43],v0,s[20:23],s93 offen offset:2048 sc1
rnx_100574:
s_bitcmp1_b32 s55,7
s_cbranch_scc0 rdn_100575
s_waitcnt vmcnt(5)
v_max3_u32 v124,v44,v45,v46
v_max_u32 v124,v124,v47
v_cmp_eq_u32 vcc,-1,v124
s_cbranch_vccnz rfa_100576
buffer_load_dword v125,off,s[20:23],s92 sc1
s_bitset0_b32 s55,7
s_cmp_eq_u32 s55,0
s_cbranch_scc1 segb_100465
s_branch rnx_100577
rdn_100575:
buffer_load_dword v125,off,s[20:23],s92 sc1
s_branch rnx_100577
rfa_100576:
buffer_load_dwordx4 v[44:47],v0,s[20:23],s93 offen offset:3072 sc1
rnx_100577:
rot_100571:
s_bitcmp1_b32 s55,5
s_cbranch_scc0 rdn_100578
s_waitcnt vmcnt(2)
v_max3_u32 v124,v36,v37,v38
v_max_u32 v124,v124,v39
v_cmp_eq_u32 vcc,-1,v124
s_cbranch_vccnz rfa_100579
buffer_load_dword v125,off,s[20:23],s92 sc1
s_bitset0_b32 s55,5
v_smfmac_f32_16x16x64_bf16 v[48:51],v[36:39],a[64:71],v1
v_smfmac_f32_16x16x64_bf16 v[52:55],v[36:39],a[72:79],v1
v_smfmac_f32_16x16x64_bf16 v[56:59],v[36:39],a[80:87],v1
v_smfmac_f32_16x16x64_bf16 v[60:63],v[36:39],a[88:95],v1
v_smfmac_f32_16x16x64_bf16 v[64:67],v[36:39],a[96:103],v1
v_smfmac_f32_16x16x64_bf16 v[68:71],v[36:39],a[104:111],v1
v_smfmac_f32_16x16x64_bf16 v[72:75],v[36:39],a[112:119],v1
v_smfmac_f32_16x16x64_bf16 v[76:79],v[36:39],a[120:127],v1
s_cmp_eq_u32 s55,0
s_cbranch_scc1 segb_100465
s_branch rnx_100580
rdn_100578:
buffer_load_dword v125,off,s[20:23],s92 sc1
s_branch rnx_100580
rfa_100579:
buffer_load_dwordx4 v[36:39],v0,s[20:23],s93 offen offset:1024 sc1
rnx_100580:
s_bitcmp1_b32 s55,6
s_cbranch_scc0 rdn_100581
s_waitcnt vmcnt(2)
v_max3_u32 v124,v40,v41,v42
v_max_u32 v124,v124,v43
v_cmp_eq_u32 vcc,-1,v124
s_cbranch_vccnz rfa_100582
buffer_load_dword v125,off,s[20:23],s92 sc1
s_bitset0_b32 s55,6
s_cmp_eq_u32 s55,0
s_cbranch_scc1 segb_100465
s_branch rnx_100583
rdn_100581:
buffer_load_dword v125,off,s[20:23],s92 sc1
s_branch rnx_100583
rfa_100582:
buffer_load_dwordx4 v[40:43],v0,s[20:23],s93 offen offset:2048 sc1
rnx_100583:
s_bitcmp1_b32 s55,7
s_cbranch_scc0 rdn_100584
s_waitcnt vmcnt(2)
v_max3_u32 v124,v44,v45,v46
v_max_u32 v124,v124,v47
v_cmp_eq_u32 vcc,-1,v124
s_cbranch_vccnz rfa_100585
buffer_load_dword v125,off,s[20:23],s92 sc1
s_bitset0_b32 s55,7
s_cmp_eq_u32 s55,0
s_cbranch_scc1 segb_100465
s_branch rnx_100586
rdn_100584:
buffer_load_dword v125,off,s[20:23],s92 sc1
s_branch rnx_100586
rfa_100585:
buffer_load_dwordx4 v[44:47],v0,s[20:23],s93 offen offset:3072 sc1
rnx_100586:
s_sub_u32 s90,s90,1
s_cmp_gt_i32 s90,0
s_cbranch_scc1 rot_100571
s_mov_b32 s55,0
s_branch segb_100465
fl_100473:
v_smfmac_f32_16x16x64_bf16 v[76:79],v[36:39],a[120:127],v1
flb_100481:
s_mov_b32 s55,192
s_bitcmp1_b32 s55,6
s_cbranch_scc0 rdn_100588
s_waitcnt vmcnt(5)
v_max3_u32 v124,v40,v41,v42
v_max_u32 v124,v124,v43
v_cmp_eq_u32 vcc,-1,v124
s_cbranch_vccnz rfa_100589
buffer_load_dword v125,off,s[20:23],s92 sc1
s_bitset0_b32 s55,6
s_cmp_eq_u32 s55,0
s_cbranch_scc1 segb_100465
s_branch rnx_100590
rdn_100588:
buffer_load_dword v125,off,s[20:23],s92 sc1
s_branch rnx_100590
rfa_100589:
buffer_load_dwordx4 v[40:43],v0,s[20:23],s93 offen offset:2048 sc1
rnx_100590:
s_bitcmp1_b32 s55,7
s_cbranch_scc0 rdn_100591
s_waitcnt vmcnt(5)
v_max3_u32 v124,v44,v45,v46
v_max_u32 v124,v124,v47
v_cmp_eq_u32 vcc,-1,v124
s_cbranch_vccnz rfa_100592
buffer_load_dword v125,off,s[20:23],s92 sc1
s_bitset0_b32 s55,7
s_cmp_eq_u32 s55,0
s_cbranch_scc1 segb_100465
s_branch rnx_100593
rdn_100591:
buffer_load_dword v125,off,s[20:23],s92 sc1
s_branch rnx_100593
rfa_100592:
buffer_load_dwordx4 v[44:47],v0,s[20:23],s93 offen offset:3072 sc1
rnx_100593:
rot_100587:
s_bitcmp1_b32 s55,6
s_cbranch_scc0 rdn_100594
s_waitcnt vmcnt(1)
v_max3_u32 v124,v40,v41,v42
v_max_u32 v124,v124,v43
v_cmp_eq_u32 vcc,-1,v124
s_cbranch_vccnz rfa_100595
buffer_load_dword v125,off,s[20:23],s92 sc1
s_bitset0_b32 s55,6
s_cmp_eq_u32 s55,0
s_cbranch_scc1 segb_100465
s_branch rnx_100596
rdn_100594:
buffer_load_dword v125,off,s[20:23],s92 sc1
s_branch rnx_100596
rfa_100595:
buffer_load_dwordx4 v[40:43],v0,s[20:23],s93 offen offset:2048 sc1
rnx_100596:
s_bitcmp1_b32 s55,7
s_cbranch_scc0 rdn_100597
s_waitcnt vmcnt(1)
v_max3_u32 v124,v44,v45,v46
v_max_u32 v124,v124,v47
v_cmp_eq_u32 vcc,-1,v124
s_cbranch_vccnz rfa_100598
buffer_load_dword v125,off,s[20:23],s92 sc1
s_bitset0_b32 s55,7
s_cmp_eq_u32 s55,0
s_cbranch_scc1 segb_100465
s_branch rnx_100599
rdn_100597:
buffer_load_dword v125,off,s[20:23],s92 sc1
s_branch rnx_100599
rfa_100598:
buffer_load_dwordx4 v[44:47],v0,s[20:23],s93 offen offset:3072 sc1
rnx_100599:
s_sub_u32 s90,s90,1
s_cmp_gt_i32 s90,0
s_cbranch_scc1 rot_100587
s_mov_b32 s55,0
s_branch segb_100465
dfl_100540:
buffer_load_dwordx4 v[20:23],v0,s[20:23],s92 offen offset:1024 sc1
s_bitset1_b32 s55,1
buffer_load_dwordx4 v[36:39],v0,s[20:23],s93 offen offset:1024 sc1
s_waitcnt vmcnt(5)
v_max3_u32 v124,v24,v25,v26
v_max_u32 v124,v124,v27
v_cmp_eq_u32 vcc,-1,v124
s_cbranch_vccnz dfl_100541
s_branch dseg_100544
dfl_100541:
buffer_load_dwordx4 v[24:27],v0,s[20:23],s92 offen offset:2048 sc1
s_bitset1_b32 s55,2
buffer_load_dwordx4 v[40:43],v0,s[20:23],s93 offen offset:2048 sc1
buffer_load_dwordx4 v[44:47],v0,s[20:23],s93 offen offset:3072 sc1
s_waitcnt vmcnt(7)
v_max3_u32 v124,v28,v29,v30
v_max_u32 v124,v124,v31
v_cmp_eq_u32 vcc,-1,v124
s_cbranch_vccnz dfl_100542
s_branch dseg_100545
dfl_100542:
buffer_load_dwordx4 v[28:31],v0,s[20:23],s92 offen offset:3072 sc1
s_bitset1_b32 s55,3
buffer_store_dword v126,v121,s[20:23],s69 offen sc1
s_branch lap2_100546
dseg_100544:
v_smfmac_f32_16x16x64_bf16 v[48:51],v[24:27],a[128:135],v1
buffer_load_dword v125,off,s[20:23],s92 sc1
v_smfmac_f32_16x16x64_bf16 v[52:55],v[24:27],a[136:143],v1
buffer_load_dwordx4 v[40:43],v0,s[20:23],s93 offen offset:2048 sc1
v_smfmac_f32_16x16x64_bf16 v[56:59],v[24:27],a[144:151],v1
buffer_load_dwordx4 v[44:47],v0,s[20:23],s93 offen offset:3072 sc1
s_waitcnt vmcnt(7)
v_max3_u32 v124,v28,v29,v30
v_smfmac_f32_16x16x64_bf16 v[60:63],v[24:27],a[152:159],v1
v_max_u32 v124,v124,v31
v_smfmac_f32_16x16x64_bf16 v[64:67],v[24:27],a[160:167],v1
v_cmp_eq_u32 vcc,-1,v124
v_smfmac_f32_16x16x64_bf16 v[68:71],v[24:27],a[168:175],v1
v_smfmac_f32_16x16x64_bf16 v[72:75],v[24:27],a[176:183],v1
v_smfmac_f32_16x16x64_bf16 v[76:79],v[24:27],a[184:191],v1
s_cbranch_vccnz dfl_100542
dseg_100545:
v_smfmac_f32_16x16x64_bf16 v[48:51],v[28:31],a[192:199],v1
buffer_load_dword v125,off,s[20:23],s92 sc1
v_smfmac_f32_16x16x64_bf16 v[52:55],v[28:31],a[200:207],v1
buffer_store_dword v126,v121,s[20:23],s69 offen sc1
v_smfmac_f32_16x16x64_bf16 v[56:59],v[28:31],a[208:215],v1
v_smfmac_f32_16x16x64_bf16 v[60:63],v[28:31],a[216:223],v1
v_smfmac_f32_16x16x64_bf16 v[64:67],v[28:31],a[224:231],v1
v_smfmac_f32_16x16x64_bf16 v[68:71],v[28:31],a[232:239],v1
v_smfmac_f32_16x16x64_bf16 v[72:75],v[28:31],a[240:247],v1
v_smfmac_f32_16x16x64_bf16 v[76:79],v[28:31],a[248:255],v1
lap2_100546:
s_bitcmp1_b32 s55,0
s_cbranch_scc0 l2s_100600
s_waitcnt vmcnt(8)
v_max3_u32 v124,v16,v17,v18
v_max_u32 v124,v124,v19
v_cmp_eq_u32 vcc,-1,v124
s_cbranch_vccnz l2s_100600
s_bitset0_b32 s55,0
v_smfmac_f32_16x16x64_bf16 v[48:51],v[16:19],a[0:7],v1
v_smfmac_f32_16x16x64_bf16 v[52:55],v[16:19],a[8:15],v1
v_smfmac_f32_16x16x64_bf16 v[56:59],v[16:19],a[16:23],v1
v_smfmac_f32_16x16x64_bf16 v[60:63],v[16:19],a[24:31],v1
v_smfmac_f32_16x16x64_bf16 v[64:67],v[16:19],a[32:39],v1
v_smfmac_f32_16x16x64_bf16 v[68:71],v[16:19],a[40:47],v1
v_smfmac_f32_16x16x64_bf16 v[72:75],v[16:19],a[48:55],v1
v_smfmac_f32_16x16x64_bf16 v[76:79],v[16:19],a[56:63],v1
l2s_100600:
s_bitcmp1_b32 s55,1
s_cbranch_scc0 l2s_100602
s_waitcnt vmcnt(6)
v_max3_u32 v124,v20,v21,v22
v_max_u32 v124,v124,v23
v_cmp_eq_u32 vcc,-1,v124
s_cbranch_vccnz l2s_100602
s_bitset0_b32 s55,1
v_smfmac_f32_16x16x64_bf16 v[48:51],v[20:23],a[64:71],v1
v_smfmac_f32_16x16x64_bf16 v[52:55],v[20:23],a[72:79],v1
v_smfmac_f32_16x16x64_bf16 v[56:59],v[20:23],a[80:87],v1
v_smfmac_f32_16x16x64_bf16 v[60:63],v[20:23],a[88:95],v1
v_smfmac_f32_16x16x64_bf16 v[64:67],v[20:23],a[96:103],v1
v_smfmac_f32_16x16x64_bf16 v[68:71],v[20:23],a[104:111],v1
v_smfmac_f32_16x16x64_bf16 v[72:75],v[20:23],a[112:119],v1
v_smfmac_f32_16x16x64_bf16 v[76:79],v[20:23],a[120:127],v1
l2s_100602:
s_bitcmp1_b32 s55,2
s_cbranch_scc0 l2s_100604
s_waitcnt vmcnt(4)
v_max3_u32 v124,v24,v25,v26
v_max_u32 v124,v124,v27
v_cmp_eq_u32 vcc,-1,v124
s_cbranch_vccnz l2s_100604
s_bitset0_b32 s55,2
v_smfmac_f32_16x16x64_bf16 v[48:51],v[24:27],a[128:135],v1
v_smfmac_f32_16x16x64_bf16 v[52:55],v[24:27],a[136:143],v1
v_smfmac_f32_16x16x64_bf16 v[56:59],v[24:27],a[144:151],v1
v_smfmac_f32_16x16x64_bf16 v[60:63],v[24:27],a[152:159],v1
v_smfmac_f32_16x16x64_bf16 v[64:67],v[24:27],a[160:167],v1
v_smfmac_f32_16x16x64_bf16 v[68:71],v[24:27],a[168:175],v1
v_smfmac_f32_16x16x64_bf16 v[72:75],v[24:27],a[176:183],v1
v_smfmac_f32_16x16x64_bf16 v[76:79],v[24:27],a[184:191],v1
l2s_100604:
s_bitcmp1_b32 s55,3
s_cbranch_scc0 l2s_100606
s_waitcnt vmcnt(1)
v_max3_u32 v124,v28,v29,v30
v_max_u32 v124,v124,v31
v_cmp_eq_u32 vcc,-1,v124
s_cbranch_vccnz l2s_100606
s_bitset0_b32 s55,3
v_smfmac_f32_16x16x64_bf16 v[48:51],v[28:31],a[192:199],v1
v_smfmac_f32_16x16x64_bf16 v[52:55],v[28:31],a[200:207],v1
v_smfmac_f32_16x16x64_bf16 v[56:59],v[28:31],a[208:215],v1
v_smfmac_f32_16x16x64_bf16 v[60:63],v[28:31],a[216:223],v1
v_smfmac_f32_16x16x64_bf16 v[64:67],v[28:31],a[224:231],v1
v_smfmac_f32_16x16x64_bf16 v[68:71],v[28:31],a[232:239],v1
v_smfmac_f32_16x16x64_bf16 v[72:75],v[28:31],a[240:247],v1
v_smfmac_f32_16x16x64_bf16 v[76:79],v[28:31],a[248:255],v1
l2s_100606:
s_cmp_eq_u32 s55,0
s_cbranch_scc0 lfb_100547
Ldone_100548:
s_waitcnt vmcnt(7)
v_max3_u32 v124,v32,v33,v34
v_max_u32 v124,v124,v35
v_cmp_eq_u32 vcc,-1,v124
s_cbranch_vccnz flb_100479
s_branch segb_100463
lfb_100547:
s_bitcmp1_b32 s55,0
s_cbranch_scc0 dsk_100608
buffer_load_dwordx4 v[16:19],v0,s[20:23],s92 offen offset:0 sc1
dsk_100608:
s_bitcmp1_b32 s55,1
s_cbranch_scc0 dsk_100609
buffer_load_dwordx4 v[20:23],v0,s[20:23],s92 offen offset:1024 sc1
dsk_100609:
s_bitcmp1_b32 s55,2
s_cbranch_scc0 dsk_100610
buffer_load_dwordx4 v[24:27],v0,s[20:23],s92 offen offset:2048 sc1
dsk_100610:
s_bitcmp1_b32 s55,3
s_cbranch_scc0 dsk_100611
buffer_load_dwordx4 v[28:31],v0,s[20:23],s92 offen offset:3072 sc1
dsk_100611:
s_bitcmp1_b32 s55,0
s_cbranch_scc0 dsk_100612
s_waitcnt vmcnt(2)
v_max3_u32 v124,v16,v17,v18
v_max_u32 v124,v124,v19
v_cmp_eq_u32 vcc,-1,v124
s_cbranch_vccz dgo_100613
s_nop 15
buffer_load_dwordx4 v[104:107],v0,s[20:23],s92 offen offset:0 sc1
s_nop 15
buffer_load_dwordx4 v[108:111],v0,s[20:23],s92 offen offset:0 sc1
dlp_100614:
s_waitcnt vmcnt(2)
v_max3_u32 v124,v16,v17,v18
v_max_u32 v124,v124,v19
v_cmp_eq_u32 vcc,-1,v124
s_cbranch_vccz dgo_100613
buffer_load_dwordx4 v[16:19],v0,s[20:23],s92 offen offset:0 sc1
s_waitcnt vmcnt(2)
v_max3_u32 v124,v104,v105,v106
v_max_u32 v124,v124,v107
v_cmp_eq_u32 vcc,-1,v124
s_cbranch_vccz dcp_100616
buffer_load_dwordx4 v[104:107],v0,s[20:23],s92 offen offset:0 sc1
s_waitcnt vmcnt(2)
v_max3_u32 v124,v108,v109,v110
v_max_u32 v124,v124,v111
v_cmp_eq_u32 vcc,-1,v124
s_cbranch_vccz dcp_100617
buffer_load_dwordx4 v[108:111],v0,s[20:23],s92 offen offset:0 sc1
s_sub_u32 s90,s90,1
s_cmp_gt_i32 s90,0
s_cbranch_scc1 dlp_100614
s_branch dgo_100613
dcp_100616:
v_mov_b32 v16,v104
v_mov_b32 v17,v105
v_mov_b32 v18,v106
v_mov_b32 v19,v107
s_nop 1
s_branch dgo_100613
dcp_100617:
v_mov_b32 v16,v108
v_mov_b32 v17,v109
v_mov_b32 v18,v110
v_mov_b32 v19,v111
s_nop 1
dgo_100613:
v_smfmac_f32_16x16x64_bf16 v[48:51],v[16:19],a[0:7],v1
v_smfmac_f32_16x16x64_bf16 v[52:55],v[16:19],a[8:15],v1
v_smfmac_f32_16x16x64_bf16 v[56:59],v[16:19],a[16:23],v1
v_smfmac_f32_16x16x64_bf16 v[60:63],v[16:19],a[24:31],v1
v_smfmac_f32_16x16x64_bf16 v[64:67],v[16:19],a[32:39],v1
v_smfmac_f32_16x16x64_bf16 v[68:71],v[16:19],a[40:47],v1
v_smfmac_f32_16x16x64_bf16 v[72:75],v[16:19],a[48:55],v1
v_smfmac_f32_16x16x64_bf16 v[76:79],v[16:19],a[56:63],v1
dsk_100612:
s_bitcmp1_b32 s55,1
s_cbranch_scc0 dsk_100618
s_waitcnt vmcnt(2)
v_max3_u32 v124,v20,v21,v22
v_max_u32 v124,v124,v23
v_cmp_eq_u32 vcc,-1,v124
s_cbranch_vccz dgo_100619
s_nop 15
buffer_load_dwordx4 v[104:107],v0,s[20:23],s92 offen offset:1024 sc1
s_nop 15
buffer_load_dwordx4 v[108:111],v0,s[20:23],s92 offen offset:1024 sc1
dlp_100620:
s_waitcnt vmcnt(2)
v_max3_u32 v124,v20,v21,v22
v_max_u32 v124,v124,v23
v_cmp_eq_u32 vcc,-1,v124
s_cbranch_vccz dgo_100619
buffer_load_dwordx4 v[20:23],v0,s[20:23],s92 offen offset:1024 sc1
s_waitcnt vmcnt(2)
v_max3_u32 v124,v104,v105,v106
v_max_u32 v124,v124,v107
v_cmp_eq_u32 vcc,-1,v124
s_cbranch_vccz dcp_100622
buffer_load_dwordx4 v[104:107],v0,s[20:23],s92 offen offset:1024 sc1
s_waitcnt vmcnt(2)
v_max3_u32 v124,v108,v109,v110
v_max_u32 v124,v124,v111
v_cmp_eq_u32 vcc,-1,v124
s_cbranch_vccz dcp_100623
buffer_load_dwordx4 v[108:111],v0,s[20:23],s92 offen offset:1024 sc1
s_sub_u32 s90,s90,1
s_cmp_gt_i32 s90,0
s_cbranch_scc1 dlp_100620
s_branch dgo_100619
dcp_100622:
v_mov_b32 v20,v104
v_mov_b32 v21,v105
v_mov_b32 v22,v106
v_mov_b32 v23,v107
s_nop 1
s_branch dgo_100619
dcp_100623:
v_mov_b32 v20,v108
v_mov_b32 v21,v109
v_mov_b32 v22,v110
v_mov_b32 v23,v111
s_nop 1
dgo_100619:
v_smfmac_f32_16x16x64_bf16 v[48:51],v[20:23],a[64:71],v1
v_smfmac_f32_16x16x64_bf16 v[52:55],v[20:23],a[72:79],v1
v_smfmac_f32_16x16x64_bf16 v[56:59],v[20:23],a[80:87],v1
v_smfmac_f32_16x16x64_bf16 v[60:63],v[20:23],a[88:95],v1
v_smfmac_f32_16x16x64_bf16 v[64:67],v[20:23],a[96:103],v1
v_smfmac_f32_16x16x64_bf16 v[68:71],v[20:23],a[104:111],v1
v_smfmac_f32_16x16x64_bf16 v[72:75],v[20:23],a[112:119],v1
v_smfmac_f32_16x16x64_bf16 v[76:79],v[20:23],a[120:127],v1
dsk_100618:
s_bitcmp1_b32 s55,2
s_cbranch_scc0 dsk_100624
s_waitcnt vmcnt(2)
v_max3_u32 v124,v24,v25,v26
v_max_u32 v124,v124,v27
v_cmp_eq_u32 vcc,-1,v124
s_cbranch_vccz dgo_100625
s_nop 15
buffer_load_dwordx4 v[104:107],v0,s[20:23],s92 offen offset:2048 sc1
s_nop 15
buffer_load_dwordx4 v[108:111],v0,s[20:23],s92 offen offset:2048 sc1
dlp_100626:
s_waitcnt vmcnt(2)
v_max3_u32 v124,v24,v25,v26
v_max_u32 v124,v124,v27
v_cmp_eq_u32 vcc,-1,v124
s_cbranch_vccz dgo_100625
buffer_load_dwordx4 v[24:27],v0,s[20:23],s92 offen offset:2048 sc1
s_waitcnt vmcnt(2)
v_max3_u32 v124,v104,v105,v106
v_max_u32 v124,v124,v107
v_cmp_eq_u32 vcc,-1,v124
s_cbranch_vccz dcp_100628
buffer_load_dwordx4 v[104:107],v0,s[20:23],s92 offen offset:2048 sc1
s_waitcnt vmcnt(2)
v_max3_u32 v124,v108,v109,v110
v_max_u32 v124,v124,v111
v_cmp_eq_u32 vcc,-1,v124
s_cbranch_vccz dcp_100629
buffer_load_dwordx4 v[108:111],v0,s[20:23],s92 offen offset:2048 sc1
s_sub_u32 s90,s90,1
s_cmp_gt_i32 s90,0
s_cbranch_scc1 dlp_100626
s_branch dgo_100625
dcp_100628:
v_mov_b32 v24,v104
v_mov_b32 v25,v105
v_mov_b32 v26,v106
v_mov_b32 v27,v107
s_nop 1
s_branch dgo_100625
dcp_100629:
v_mov_b32 v24,v108
v_mov_b32 v25,v109
v_mov_b32 v26,v110
v_mov_b32 v27,v111
s_nop 1
dgo_100625:
v_smfmac_f32_16x16x64_bf16 v[48:51],v[24:27],a[128:135],v1
v_smfmac_f32_16x16x64_bf16 v[52:55],v[24:27],a[136:143],v1
v_smfmac_f32_16x16x64_bf16 v[56:59],v[24:27],a[144:151],v1
v_smfmac_f32_16x16x64_bf16 v[60:63],v[24:27],a[152:159],v1
v_smfmac_f32_16x16x64_bf16 v[64:67],v[24:27],a[160:167],v1
v_smfmac_f32_16x16x64_bf16 v[68:71],v[24:27],a[168:175],v1
v_smfmac_f32_16x16x64_bf16 v[72:75],v[24:27],a[176:183],v1
v_smfmac_f32_16x16x64_bf16 v[76:79],v[24:27],a[184:191],v1
dsk_100624:
s_bitcmp1_b32 s55,3
s_cbranch_scc0 dsk_100630
s_waitcnt vmcnt(2)
v_max3_u32 v124,v28,v29,v30
v_max_u32 v124,v124,v31
v_cmp_eq_u32 vcc,-1,v124
s_cbranch_vccz dgo_100631
s_nop 15
buffer_load_dwordx4 v[104:107],v0,s[20:23],s92 offen offset:3072 sc1
s_nop 15
buffer_load_dwordx4 v[108:111],v0,s[20:23],s92 offen offset:3072 sc1
dlp_100632:
s_waitcnt vmcnt(2)
v_max3_u32 v124,v28,v29,v30
v_max_u32 v124,v124,v31
v_cmp_eq_u32 vcc,-1,v124
s_cbranch_vccz dgo_100631
buffer_load_dwordx4 v[28:31],v0,s[20:23],s92 offen offset:3072 sc1
s_waitcnt vmcnt(2)
v_max3_u32 v124,v104,v105,v106
v_max_u32 v124,v124,v107
v_cmp_eq_u32 vcc,-1,v124
s_cbranch_vccz dcp_100634
buffer_load_dwordx4 v[104:107],v0,s[20:23],s92 offen offset:3072 sc1
s_waitcnt vmcnt(2)
v_max3_u32 v124,v108,v109,v110
v_max_u32 v124,v124,v111
v_cmp_eq_u32 vcc,-1,v124
s_cbranch_vccz dcp_100635
buffer_load_dwordx4 v[108:111],v0,s[20:23],s92 offen offset:3072 sc1
s_sub_u32 s90,s90,1
s_cmp_gt_i32 s90,0
s_cbranch_scc1 dlp_100632
s_branch dgo_100631
dcp_100634:
v_mov_b32 v28,v104
v_mov_b32 v29,v105
v_mov_b32 v30,v106
v_mov_b32 v31,v107
s_nop 1
s_branch dgo_100631
dcp_100635:
v_mov_b32 v28,v108
v_mov_b32 v29,v109
v_mov_b32 v30,v110
v_mov_b32 v31,v111
s_nop 1
dgo_100631:
v_smfmac_f32_16x16x64_bf16 v[48:51],v[28:31],a[192:199],v1
v_smfmac_f32_16x16x64_bf16 v[52:55],v[28:31],a[200:207],v1
v_smfmac_f32_16x16x64_bf16 v[56:59],v[28:31],a[208:215],v1
v_smfmac_f32_16x16x64_bf16 v[60:63],v[28:31],a[216:223],v1
v_smfmac_f32_16x16x64_bf16 v[64:67],v[28:31],a[224:231],v1
v_smfmac_f32_16x16x64_bf16 v[68:71],v[28:31],a[232:239],v1
v_smfmac_f32_16x16x64_bf16 v[72:75],v[28:31],a[240:247],v1
v_smfmac_f32_16x16x64_bf16 v[76:79],v[28:31],a[248:255],v1
dsk_100630:
s_mov_b32 s55,0
s_branch Ldone_100548
slowA_100483:
buffer_load_dwordx4 v[44:47],v0,s[20:23],s93 offen offset:3072 sc1
dsk_100636:
s_bitcmp1_b32 s55,7
s_cbranch_scc0 dsk_100637
s_waitcnt vmcnt(2)
v_max3_u32 v124,v44,v45,v46
v_max_u32 v124,v124,v47
v_cmp_eq_u32 vcc,-1,v124
s_cbranch_vccz dgo_100638
s_nop 15
s_nop 3
buffer_load_dwordx4 v[104:107],v0,s[20:23],s93 offen offset:3072 sc1
s_nop 15
s_nop 3
buffer_load_dwordx4 v[108:111],v0,s[20:23],s93 offen offset:3072 sc1
dlp_100639:
s_waitcnt vmcnt(2)
v_max3_u32 v124,v44,v45,v46
v_max_u32 v124,v124,v47
v_cmp_eq_u32 vcc,-1,v124
s_cbranch_vccz dgo_100638
buffer_load_dwordx4 v[44:47],v0,s[20:23],s93 offen offset:3072 sc1
s_waitcnt vmcnt(2)
v_max3_u32 v124,v104,v105,v106
v_max_u32 v124,v124,v107
v_cmp_eq_u32 vcc,-1,v124
s_cbranch_vccz dcp_100641
buffer_load_dwordx4 v[104:107],v0,s[20:23],s93 offen offset:3072 sc1
s_waitcnt vmcnt(2)
v_max3_u32 v124,v108,v109,v110
v_max_u32 v124,v124,v111
v_cmp_eq_u32 vcc,-1,v124
s_cbranch_vccz dcp_100642
buffer_load_dwordx4 v[108:111],v0,s[20:23],s93 offen offset:3072 sc1
s_sub_u32 s90,s90,1
s_cmp_gt_i32 s90,0
s_cbranch_scc1 dlp_100639
s_branch dgo_100638
dcp_100641:
v_mov_b32 v44,v104
v_mov_b32 v45,v105
v_mov_b32 v46,v106
v_mov_b32 v47,v107
s_nop 1
s_branch dgo_100638
dcp_100642:
v_mov_b32 v44,v108
v_mov_b32 v45,v109
v_mov_b32 v46,v110
v_mov_b32 v47,v111
s_nop 1
dgo_100638:
dsk_100637:
s_mov_b32 s55,0
s_branch segb_100465
srt_100491:
s_sub_u32 s90,s90,1
s_cmp_gt_i32 s90,0
s_cbranch_scc0 sok_100490
buffer_load_dwordx4 v[16:19],v2,s[20:23],s94 offen offset:0 sc1
buffer_load_dwordx4 v[32:35],v2,s[20:23],s94 offen offset:1536 sc1
buffer_load_dwordx4 v[20:23],v2,s[20:23],s95 offen offset:0 sc1
buffer_load_dwordx4 v[36:39],v2,s[20:23],s95 offen offset:1536 sc1
buffer_load_dword v120,v3,s[20:23],s94 offen offset:0 sc1
buffer_load_dword v121,v3,s[20:23],s94 offen offset:1536 sc1
buffer_load_dword v122,v3,s[20:23],s95 offen offset:0 sc1
buffer_load_dword v123,v3,s[20:23],s95 offen offset:1536 sc1
s_branch sp_100489
of_100492:
s_mov_b32 s55,3
buffer_load_dwordx4 v[16:19],v0,s[20:23],s96 offen offset:0 sc1
buffer_load_dwordx4 v[20:23],v0,s[20:23],s96 offen offset:1024 sc1
s_waitcnt vmcnt(6)
v_max3_u32 v124,v24,v25,v26
v_max3_u32 v124,v124,v27,v28
v_max3_u32 v124,v124,v29,v30
v_max_u32 v124,v124,v31
v_cmp_eq_u32 vcc,-1,v124
s_cbranch_vccnz ost_100644
v_smfmac_f32_16x16x64_bf16 v[96:99],v[24:27],v[80:87],v1
buffer_load_dword v120,off,s[20:23],s96 sc1
v_smfmac_f32_16x16x64_bf16 v[100:103],v[24:27],v[88:95],v1
buffer_load_dword v120,off,s[20:23],s96 sc1
v_smfmac_f32_16x16x64_bf16 v[96:99],v[28:31],v[128:135],v1
v_smfmac_f32_16x16x64_bf16 v[100:103],v[28:31],v[136:143],v1
ort_100645:
s_waitcnt vmcnt(6)
v_max3_u32 v124,v32,v33,v34
v_max3_u32 v124,v124,v35,v36
v_max3_u32 v124,v124,v37,v38
v_max_u32 v124,v124,v39
v_cmp_eq_u32 vcc,-1,v124
s_cbranch_vccnz ost_100646
v_smfmac_f32_16x16x64_bf16 v[96:99],v[32:35],v[144:151],v1
buffer_load_dword v120,off,s[20:23],s96 sc1
v_smfmac_f32_16x16x64_bf16 v[100:103],v[32:35],v[152:159],v1
buffer_load_dword v120,off,s[20:23],s96 sc1
v_smfmac_f32_16x16x64_bf16 v[96:99],v[36:39],v[160:167],v1
v_smfmac_f32_16x16x64_bf16 v[100:103],v[36:39],v[168:175],v1
ort_100647:
s_waitcnt vmcnt(7)
v_max3_u32 v124,v40,v41,v42
v_max_u32 v124,v124,v43
v_cmp_eq_u32 vcc,-1,v124
s_cbranch_vccnz ost_100648
v_smfmac_f32_16x16x64_bf16 v[96:99],v[40:43],v[176:183],v1
buffer_load_dword v120,off,s[20:23],s96 sc1
v_smfmac_f32_16x16x64_bf16 v[100:103],v[40:43],v[184:191],v1
ort_100649:
s_waitcnt vmcnt(7)
v_max3_u32 v124,v44,v45,v46
v_max_u32 v124,v124,v47
v_cmp_eq_u32 vcc,-1,v124
s_cbranch_vccnz ost_100650
v_smfmac_f32_16x16x64_bf16 v[96:99],v[44:47],v[192:199],v1
buffer_load_dword v120,off,s[20:23],s96 sc1
v_smfmac_f32_16x16x64_bf16 v[100:103],v[44:47],v[200:207],v1
ort_100651:
s_waitcnt vmcnt(6)
v_max3_u32 v124,v16,v17,v18
v_max3_u32 v124,v124,v19,v20
v_max3_u32 v124,v124,v21,v22
v_max_u32 v124,v124,v23
v_cmp_eq_u32 vcc,-1,v124
s_cbranch_vccnz olap2_100643
s_andn2_b32 s55,s55,3
v_smfmac_f32_16x16x64_bf16 v[96:99],v[16:19],v[48:55],v1
v_smfmac_f32_16x16x64_bf16 v[100:103],v[16:19],v[56:63],v1
v_smfmac_f32_16x16x64_bf16 v[96:99],v[20:23],v[64:71],v1
v_smfmac_f32_16x16x64_bf16 v[100:103],v[20:23],v[72:79],v1
s_cbranch_scc0 oback_100503
s_branch olap2_100643
ost_100644:
buffer_load_dwordx4 v[24:27],v0,s[20:23],s96 offen offset:2048 sc1
buffer_load_dwordx4 v[28:31],v0,s[20:23],s96 offen offset:3072 sc1
s_or_b32 s55,s55,12
s_branch ort_100645
ost_100646:
buffer_load_dwordx4 v[32:35],v0,s[20:23],s97 offen offset:0 sc1
buffer_load_dwordx4 v[36:39],v0,s[20:23],s97 offen offset:1024 sc1
s_or_b32 s55,s55,48
s_branch ort_100647
ost_100648:
buffer_load_dwordx4 v[40:43],v0,s[20:23],s97 offen offset:2048 sc1
s_or_b32 s55,s55,64
s_branch ort_100649
ost_100650:
buffer_load_dwordx4 v[44:47],v0,s[20:23],s97 offen offset:3072 sc1
s_or_b32 s55,s55,128
s_branch ort_100651
of_100493:
s_mov_b32 s55,12
buffer_load_dwordx4 v[24:27],v0,s[20:23],s96 offen offset:2048 sc1
buffer_load_dwordx4 v[28:31],v0,s[20:23],s96 offen offset:3072 sc1
s_waitcnt vmcnt(4)
v_max3_u32 v124,v32,v33,v34
v_max3_u32 v124,v124,v35,v36
v_max3_u32 v124,v124,v37,v38
v_max_u32 v124,v124,v39
v_cmp_eq_u32 vcc,-1,v124
s_cbranch_vccnz ost_100653
v_smfmac_f32_16x16x64_bf16 v[96:99],v[32:35],v[144:151],v1
buffer_load_dword v120,off,s[20:23],s96 sc1
v_smfmac_f32_16x16x64_bf16 v[100:103],v[32:35],v[152:159],v1
buffer_load_dword v120,off,s[20:23],s96 sc1
v_smfmac_f32_16x16x64_bf16 v[96:99],v[36:39],v[160:167],v1
v_smfmac_f32_16x16x64_bf16 v[100:103],v[36:39],v[168:175],v1
ort_100654:
s_waitcnt vmcnt(5)
v_max3_u32 v124,v40,v41,v42
v_max_u32 v124,v124,v43
v_cmp_eq_u32 vcc,-1,v124
s_cbranch_vccnz ost_100655
v_smfmac_f32_16x16x64_bf16 v[96:99],v[40:43],v[176:183],v1
buffer_load_dword v120,off,s[20:23],s96 sc1
v_smfmac_f32_16x16x64_bf16 v[100:103],v[40:43],v[184:191],v1
ort_100656:
s_waitcnt vmcnt(5)
v_max3_u32 v124,v44,v45,v46
v_max_u32 v124,v124,v47
v_cmp_eq_u32 vcc,-1,v124
s_cbranch_vccnz ost_100657
v_smfmac_f32_16x16x64_bf16 v[96:99],v[44:47],v[192:199],v1
buffer_load_dword v120,off,s[20:23],s96 sc1
v_smfmac_f32_16x16x64_bf16 v[100:103],v[44:47],v[200:207],v1
ort_100658:
s_waitcnt vmcnt(4)
v_max3_u32 v124,v24,v25,v26
v_max3_u32 v124,v124,v27,v28
v_max3_u32 v124,v124,v29,v30
v_max_u32 v124,v124,v31
v_cmp_eq_u32 vcc,-1,v124
s_cbranch_vccnz olap2_100643
s_andn2_b32 s55,s55,12
v_smfmac_f32_16x16x64_bf16 v[96:99],v[24:27],v[80:87],v1
v_smfmac_f32_16x16x64_bf16 v[100:103],v[24:27],v[88:95],v1
v_smfmac_f32_16x16x64_bf16 v[96:99],v[28:31],v[128:135],v1
v_smfmac_f32_16x16x64_bf16 v[100:103],v[28:31],v[136:143],v1
s_cbranch_scc0 oback_100503
s_branch olap2_100643
ost_100653:
buffer_load_dwordx4 v[32:35],v0,s[20:23],s97 offen offset:0 sc1
buffer_load_dwordx4 v[36:39],v0,s[20:23],s97 offen offset:1024 sc1
s_or_b32 s55,s55,48
s_branch ort_100654
ost_100655:
buffer_load_dwordx4 v[40:43],v0,s[20:23],s97 offen offset:2048 sc1
s_or_b32 s55,s55,64
s_branch ort_100656
ost_100657:
buffer_load_dwordx4 v[44:47],v0,s[20:23],s97 offen offset:3072 sc1
s_or_b32 s55,s55,128
s_branch ort_100658
of_100494:
s_mov_b32 s55,48
buffer_load_dwordx4 v[32:35],v0,s[20:23],s97 offen offset:0 sc1
buffer_load_dwordx4 v[36:39],v0,s[20:23],s97 offen offset:1024 sc1
s_waitcnt vmcnt(3)
v_max3_u32 v124,v40,v41,v42
v_max_u32 v124,v124,v43
v_cmp_eq_u32 vcc,-1,v124
s_cbranch_vccnz ost_100660
v_smfmac_f32_16x16x64_bf16 v[96:99],v[40:43],v[176:183],v1
buffer_load_dword v120,off,s[20:23],s96 sc1
v_smfmac_f32_16x16x64_bf16 v[100:103],v[40:43],v[184:191],v1
ort_100661:
s_waitcnt vmcnt(3)
v_max3_u32 v124,v44,v45,v46
v_max_u32 v124,v124,v47
v_cmp_eq_u32 vcc,-1,v124
s_cbranch_vccnz ost_100662
v_smfmac_f32_16x16x64_bf16 v[96:99],v[44:47],v[192:199],v1
buffer_load_dword v120,off,s[20:23],s96 sc1
v_smfmac_f32_16x16x64_bf16 v[100:103],v[44:47],v[200:207],v1
ort_100663:
s_waitcnt vmcnt(2)
v_max3_u32 v124,v32,v33,v34
v_max3_u32 v124,v124,v35,v36
v_max3_u32 v124,v124,v37,v38
v_max_u32 v124,v124,v39
v_cmp_eq_u32 vcc,-1,v124
s_cbranch_vccnz olap2_100643
s_andn2_b32 s55,s55,48
v_smfmac_f32_16x16x64_bf16 v[96:99],v[32:35],v[144:151],v1
v_smfmac_f32_16x16x64_bf16 v[100:103],v[32:35],v[152:159],v1
v_smfmac_f32_16x16x64_bf16 v[96:99],v[36:39],v[160:167],v1
v_smfmac_f32_16x16x64_bf16 v[100:103],v[36:39],v[168:175],v1
s_cbranch_scc0 oback_100503
s_branch olap2_100643
ost_100660:
buffer_load_dwordx4 v[40:43],v0,s[20:23],s97 offen offset:2048 sc1
s_or_b32 s55,s55,64
s_branch ort_100661
ost_100662:
buffer_load_dwordx4 v[44:47],v0,s[20:23],s97 offen offset:3072 sc1
s_or_b32 s55,s55,128
s_branch ort_100663
of_100495:
s_mov_b32 s55,64
buffer_load_dwordx4 v[40:43],v0,s[20:23],s97 offen offset:2048 sc1
s_waitcnt vmcnt(1)
v_max3_u32 v124,v44,v45,v46
v_max_u32 v124,v124,v47
v_cmp_eq_u32 vcc,-1,v124
s_cbranch_vccnz ost_100665
v_smfmac_f32_16x16x64_bf16 v[96:99],v[44:47],v[192:199],v1
buffer_load_dword v120,off,s[20:23],s96 sc1
v_smfmac_f32_16x16x64_bf16 v[100:103],v[44:47],v[200:207],v1
ort_100666:
s_waitcnt vmcnt(1)
v_max3_u32 v124,v40,v41,v42
v_max_u32 v124,v124,v43
v_cmp_eq_u32 vcc,-1,v124
s_cbranch_vccnz olap2_100643
s_andn2_b32 s55,s55,64
v_smfmac_f32_16x16x64_bf16 v[96:99],v[40:43],v[176:183],v1
v_smfmac_f32_16x16x64_bf16 v[100:103],v[40:43],v[184:191],v1
s_cbranch_scc0 oback_100503
s_branch olap2_100643
ost_100665:
buffer_load_dwordx4 v[44:47],v0,s[20:23],s97 offen offset:3072 sc1
s_or_b32 s55,s55,128
s_branch ort_100666
of_100496:
s_mov_b32 s55,128
s_branch oslow_100502
olap2_100643:
s_bitcmp1_b32 s55,0
s_cbranch_scc0 l2s_100668
s_waitcnt vmcnt(6)
v_max3_u32 v124,v16,v17,v18
v_max3_u32 v124,v124,v19,v20
v_max3_u32 v124,v124,v21,v22
v_max_u32 v124,v124,v23
v_cmp_eq_u32 vcc,-1,v124
s_cbranch_vccnz l2s_100668
s_andn2_b32 s55,s55,3
v_smfmac_f32_16x16x64_bf16 v[96:99],v[16:19],v[48:55],v1
v_smfmac_f32_16x16x64_bf16 v[100:103],v[16:19],v[56:63],v1
v_smfmac_f32_16x16x64_bf16 v[96:99],v[20:23],v[64:71],v1
v_smfmac_f32_16x16x64_bf16 v[100:103],v[20:23],v[72:79],v1
l2s_100668:
s_bitcmp1_b32 s55,2
s_cbranch_scc0 l2s_100669
s_waitcnt vmcnt(4)
v_max3_u32 v124,v24,v25,v26
v_max3_u32 v124,v124,v27,v28
v_max3_u32 v124,v124,v29,v30
v_max_u32 v124,v124,v31
v_cmp_eq_u32 vcc,-1,v124
s_cbranch_vccnz l2s_100669
s_andn2_b32 s55,s55,12
v_smfmac_f32_16x16x64_bf16 v[96:99],v[24:27],v[80:87],v1
v_smfmac_f32_16x16x64_bf16 v[100:103],v[24:27],v[88:95],v1
v_smfmac_f32_16x16x64_bf16 v[96:99],v[28:31],v[128:135],v1
v_smfmac_f32_16x16x64_bf16 v[100:103],v[28:31],v[136:143],v1
l2s_100669:
s_bitcmp1_b32 s55,4
s_cbranch_scc0 l2s_100670
s_waitcnt vmcnt(2)
v_max3_u32 v124,v32,v33,v34
v_max3_u32 v124,v124,v35,v36
v_max3_u32 v124,v124,v37,v38
v_max_u32 v124,v124,v39
v_cmp_eq_u32 vcc,-1,v124
s_cbranch_vccnz l2s_100670
s_andn2_b32 s55,s55,48
v_smfmac_f32_16x16x64_bf16 v[96:99],v[32:35],v[144:151],v1
v_smfmac_f32_16x16x64_bf16 v[100:103],v[32:35],v[152:159],v1
v_smfmac_f32_16x16x64_bf16 v[96:99],v[36:39],v[160:167],v1
v_smfmac_f32_16x16x64_bf16 v[100:103],v[36:39],v[168:175],v1
l2s_100670:
s_bitcmp1_b32 s55,6
s_cbranch_scc0 l2s_100671
s_waitcnt vmcnt(1)
v_max3_u32 v124,v40,v41,v42
v_max_u32 v124,v124,v43
v_cmp_eq_u32 vcc,-1,v124
s_cbranch_vccnz l2s_100671
s_andn2_b32 s55,s55,64
v_smfmac_f32_16x16x64_bf16 v[96:99],v[40:43],v[176:183],v1
v_smfmac_f32_16x16x64_bf16 v[100:103],v[40:43],v[184:191],v1
l2s_100671:
s_bitcmp1_b32 s55,7
s_cbranch_scc0 l2s_100672
s_waitcnt vmcnt(0)
v_max3_u32 v124,v44,v45,v46
v_max_u32 v124,v124,v47
v_cmp_eq_u32 vcc,-1,v124
s_cbranch_vccnz l2s_100672
s_andn2_b32 s55,s55,128
v_smfmac_f32_16x16x64_bf16 v[96:99],v[44:47],v[192:199],v1
v_smfmac_f32_16x16x64_bf16 v[100:103],v[44:47],v[200:207],v1
l2s_100672:
s_cmp_eq_u32 s55,0
s_cbranch_scc1 oback_100503
oslow_100502:
s_bitcmp1_b32 s55,0
s_cbranch_scc0 dsk_100673
buffer_load_dwordx4 v[16:19],v0,s[20:23],s96 offen offset:0 sc1
dsk_100673:
s_bitcmp1_b32 s55,1
s_cbranch_scc0 dsk_100674
buffer_load_dwordx4 v[20:23],v0,s[20:23],s96 offen offset:1024 sc1
dsk_100674:
s_bitcmp1_b32 s55,2
s_cbranch_scc0 dsk_100675
buffer_load_dwordx4 v[24:27],v0,s[20:23],s96 offen offset:2048 sc1
dsk_100675:
s_bitcmp1_b32 s55,3
s_cbranch_scc0 dsk_100676
buffer_load_dwordx4 v[28:31],v0,s[20:23],s96 offen offset:3072 sc1
dsk_100676:
s_bitcmp1_b32 s55,4
s_cbranch_scc0 dsk_100677
buffer_load_dwordx4 v[32:35],v0,s[20:23],s97 offen offset:0 sc1
dsk_100677:
s_bitcmp1_b32 s55,5
s_cbranch_scc0 dsk_100678
buffer_load_dwordx4 v[36:39],v0,s[20:23],s97 offen offset:1024 sc1
dsk_100678:
s_bitcmp1_b32 s55,6
s_cbranch_scc0 dsk_100679
buffer_load_dwordx4 v[40:43],v0,s[20:23],s97 offen offset:2048 sc1
dsk_100679:
s_bitcmp1_b32 s55,7
s_cbranch_scc0 dsk_100680
buffer_load_dwordx4 v[44:47],v0,s[20:23],s97 offen offset:3072 sc1
dsk_100680:
s_bitcmp1_b32 s55,0
s_cbranch_scc0 dsk_100681
s_waitcnt vmcnt(2)
v_max3_u32 v124,v16,v17,v18
v_max_u32 v124,v124,v19
v_cmp_eq_u32 vcc,-1,v124
s_cbranch_vccz dgo_100682
s_nop 15
buffer_load_dwordx4 v[116:119],v0,s[20:23],s96 offen offset:0 sc1
s_nop 15
buffer_load_dwordx4 v[120:123],v0,s[20:23],s96 offen offset:0 sc1
dlp_100683:
s_waitcnt vmcnt(2)
v_max3_u32 v124,v16,v17,v18
v_max_u32 v124,v124,v19
v_cmp_eq_u32 vcc,-1,v124
s_cbranch_vccz dgo_100682
buffer_load_dwordx4 v[16:19],v0,s[20:23],s96 offen offset:0 sc1
s_waitcnt vmcnt(2)
v_max3_u32 v124,v116,v117,v118
v_max_u32 v124,v124,v119
v_cmp_eq_u32 vcc,-1,v124
s_cbranch_vccz dcp_100685
buffer_load_dwordx4 v[116:119],v0,s[20:23],s96 offen offset:0 sc1
s_waitcnt vmcnt(2)
v_max3_u32 v124,v120,v121,v122
v_max_u32 v124,v124,v123
v_cmp_eq_u32 vcc,-1,v124
s_cbranch_vccz dcp_100686
buffer_load_dwordx4 v[120:123],v0,s[20:23],s96 offen offset:0 sc1
s_sub_u32 s90,s90,1
s_cmp_gt_i32 s90,0
s_cbranch_scc1 dlp_100683
s_branch dgo_100682
dcp_100685:
v_mov_b32 v16,v116
v_mov_b32 v17,v117
v_mov_b32 v18,v118
v_mov_b32 v19,v119
s_nop 1
s_branch dgo_100682
dcp_100686:
v_mov_b32 v16,v120
v_mov_b32 v17,v121
v_mov_b32 v18,v122
v_mov_b32 v19,v123
s_nop 1
dgo_100682:
v_smfmac_f32_16x16x64_bf16 v[96:99],v[16:19],v[48:55],v1
v_smfmac_f32_16x16x64_bf16 v[100:103],v[16:19],v[56:63],v1
dsk_100681:
s_bitcmp1_b32 s55,1
s_cbranch_scc0 dsk_100687
s_waitcnt vmcnt(2)
v_max3_u32 v124,v20,v21,v22
v_max_u32 v124,v124,v23
v_cmp_eq_u32 vcc,-1,v124
s_cbranch_vccz dgo_100688
s_nop 15
buffer_load_dwordx4 v[116:119],v0,s[20:23],s96 offen offset:1024 sc1
s_nop 15
buffer_load_dwordx4 v[120:123],v0,s[20:23],s96 offen offset:1024 sc1
dlp_100689:
s_waitcnt vmcnt(2)
v_max3_u32 v124,v20,v21,v22
v_max_u32 v124,v124,v23
v_cmp_eq_u32 vcc,-1,v124
s_cbranch_vccz dgo_100688
buffer_load_dwordx4 v[20:23],v0,s[20:23],s96 offen offset:1024 sc1
s_waitcnt vmcnt(2)
v_max3_u32 v124,v116,v117,v118
v_max_u32 v124,v124,v119
v_cmp_eq_u32 vcc,-1,v124
s_cbranch_vccz dcp_100691
buffer_load_dwordx4 v[116:119],v0,s[20:23],s96 offen offset:1024 sc1
s_waitcnt vmcnt(2)
v_max3_u32 v124,v120,v121,v122
v_max_u32 v124,v124,v123
v_cmp_eq_u32 vcc,-1,v124
s_cbranch_vccz dcp_100692
buffer_load_dwordx4 v[120:123],v0,s[20:23],s96 offen offset:1024 sc1
s_sub_u32 s90,s90,1
s_cmp_gt_i32 s90,0
s_cbranch_scc1 dlp_100689
s_branch dgo_100688
dcp_100691:
v_mov_b32 v20,v116
v_mov_b32 v21,v117
v_mov_b32 v22,v118
v_mov_b32 v23,v119
s_nop 1
s_branch dgo_100688
dcp_100692:
v_mov_b32 v20,v120
v_mov_b32 v21,v121
v_mov_b32 v22,v122
v_mov_b32 v23,v123
s_nop 1
dgo_100688:
v_smfmac_f32_16x16x64_bf16 v[96:99],v[20:23],v[64:71],v1
v_smfmac_f32_16x16x64_bf16 v[100:103],v[20:23],v[72:79],v1
dsk_100687:
s_bitcmp1_b32 s55,2
s_cbranch_scc0 dsk_100693
s_waitcnt vmcnt(2)
v_max3_u32 v124,v24,v25,v26
v_max_u32 v124,v124,v27
v_cmp_eq_u32 vcc,-1,v124
s_cbranch_vccz dgo_100694
s_nop 15
buffer_load_dwordx4 v[116:119],v0,s[20:23],s96 offen offset:2048 sc1
s_nop 15
buffer_load_dwordx4 v[120:123],v0,s[20:23],s96 offen offset:2048 sc1
dlp_100695:
s_waitcnt vmcnt(2)
v_max3_u32 v124,v24,v25,v26
v_max_u32 v124,v124,v27
v_cmp_eq_u32 vcc,-1,v124
s_cbranch_vccz dgo_100694
buffer_load_dwordx4 v[24:27],v0,s[20:23],s96 offen offset:2048 sc1
s_waitcnt vmcnt(2)
v_max3_u32 v124,v116,v117,v118
v_max_u32 v124,v124,v119
v_cmp_eq_u32 vcc,-1,v124
s_cbranch_vccz dcp_100697
buffer_load_dwordx4 v[116:119],v0,s[20:23],s96 offen offset:2048 sc1
s_waitcnt vmcnt(2)
v_max3_u32 v124,v120,v121,v122
v_max_u32 v124,v124,v123
v_cmp_eq_u32 vcc,-1,v124
s_cbranch_vccz dcp_100698
buffer_load_dwordx4 v[120:123],v0,s[20:23],s96 offen offset:2048 sc1
s_sub_u32 s90,s90,1
s_cmp_gt_i32 s90,0
s_cbranch_scc1 dlp_100695
s_branch dgo_100694
dcp_100697:
v_mov_b32 v24,v116
v_mov_b32 v25,v117
v_mov_b32 v26,v118
v_mov_b32 v27,v119
s_nop 1
s_branch dgo_100694
dcp_100698:
v_mov_b32 v24,v120
v_mov_b32 v25,v121
v_mov_b32 v26,v122
v_mov_b32 v27,v123
s_nop 1
dgo_100694:
v_smfmac_f32_16x16x64_bf16 v[96:99],v[24:27],v[80:87],v1
v_smfmac_f32_16x16x64_bf16 v[100:103],v[24:27],v[88:95],v1
dsk_100693:
s_bitcmp1_b32 s55,3
s_cbranch_scc0 dsk_100699
s_waitcnt vmcnt(2)
v_max3_u32 v124,v28,v29,v30
v_max_u32 v124,v124,v31
v_cmp_eq_u32 vcc,-1,v124
s_cbranch_vccz dgo_100700
s_nop 15
buffer_load_dwordx4 v[116:119],v0,s[20:23],s96 offen offset:3072 sc1
s_nop 15
buffer_load_dwordx4 v[120:123],v0,s[20:23],s96 offen offset:3072 sc1
dlp_100701:
s_waitcnt vmcnt(2)
v_max3_u32 v124,v28,v29,v30
v_max_u32 v124,v124,v31
v_cmp_eq_u32 vcc,-1,v124
s_cbranch_vccz dgo_100700
buffer_load_dwordx4 v[28:31],v0,s[20:23],s96 offen offset:3072 sc1
s_waitcnt vmcnt(2)
v_max3_u32 v124,v116,v117,v118
v_max_u32 v124,v124,v119
v_cmp_eq_u32 vcc,-1,v124
s_cbranch_vccz dcp_100703
buffer_load_dwordx4 v[116:119],v0,s[20:23],s96 offen offset:3072 sc1
s_waitcnt vmcnt(2)
v_max3_u32 v124,v120,v121,v122
v_max_u32 v124,v124,v123
v_cmp_eq_u32 vcc,-1,v124
s_cbranch_vccz dcp_100704
buffer_load_dwordx4 v[120:123],v0,s[20:23],s96 offen offset:3072 sc1
s_sub_u32 s90,s90,1
s_cmp_gt_i32 s90,0
s_cbranch_scc1 dlp_100701
s_branch dgo_100700
dcp_100703:
v_mov_b32 v28,v116
v_mov_b32 v29,v117
v_mov_b32 v30,v118
v_mov_b32 v31,v119
s_nop 1
s_branch dgo_100700
dcp_100704:
v_mov_b32 v28,v120
v_mov_b32 v29,v121
v_mov_b32 v30,v122
v_mov_b32 v31,v123
s_nop 1
dgo_100700:
v_smfmac_f32_16x16x64_bf16 v[96:99],v[28:31],v[128:135],v1
v_smfmac_f32_16x16x64_bf16 v[100:103],v[28:31],v[136:143],v1
dsk_100699:
s_bitcmp1_b32 s55,4
s_cbranch_scc0 dsk_100705
s_waitcnt vmcnt(2)
v_max3_u32 v124,v32,v33,v34
v_max_u32 v124,v124,v35
v_cmp_eq_u32 vcc,-1,v124
s_cbranch_vccz dgo_100706
s_nop 15
buffer_load_dwordx4 v[116:119],v0,s[20:23],s97 offen offset:0 sc1
s_nop 15
buffer_load_dwordx4 v[120:123],v0,s[20:23],s97 offen offset:0 sc1
dlp_100707:
s_waitcnt vmcnt(2)
v_max3_u32 v124,v32,v33,v34
v_max_u32 v124,v124,v35
v_cmp_eq_u32 vcc,-1,v124
s_cbranch_vccz dgo_100706
buffer_load_dwordx4 v[32:35],v0,s[20:23],s97 offen offset:0 sc1
s_waitcnt vmcnt(2)
v_max3_u32 v124,v116,v117,v118
v_max_u32 v124,v124,v119
v_cmp_eq_u32 vcc,-1,v124
s_cbranch_vccz dcp_100709
buffer_load_dwordx4 v[116:119],v0,s[20:23],s97 offen offset:0 sc1
s_waitcnt vmcnt(2)
v_max3_u32 v124,v120,v121,v122
v_max_u32 v124,v124,v123
v_cmp_eq_u32 vcc,-1,v124
s_cbranch_vccz dcp_100710
buffer_load_dwordx4 v[120:123],v0,s[20:23],s97 offen offset:0 sc1
s_sub_u32 s90,s90,1
s_cmp_gt_i32 s90,0
s_cbranch_scc1 dlp_100707
s_branch dgo_100706
dcp_100709:
v_mov_b32 v32,v116
v_mov_b32 v33,v117
v_mov_b32 v34,v118
v_mov_b32 v35,v119
s_nop 1
s_branch dgo_100706
dcp_100710:
v_mov_b32 v32,v120
v_mov_b32 v33,v121
v_mov_b32 v34,v122
v_mov_b32 v35,v123
s_nop 1
dgo_100706:
v_smfmac_f32_16x16x64_bf16 v[96:99],v[32:35],v[144:151],v1
v_smfmac_f32_16x16x64_bf16 v[100:103],v[32:35],v[152:159],v1
dsk_100705:
s_bitcmp1_b32 s55,5
s_cbranch_scc0 dsk_100711
s_waitcnt vmcnt(2)
v_max3_u32 v124,v36,v37,v38
v_max_u32 v124,v124,v39
v_cmp_eq_u32 vcc,-1,v124
s_cbranch_vccz dgo_100712
s_nop 15
buffer_load_dwordx4 v[116:119],v0,s[20:23],s97 offen offset:1024 sc1
s_nop 15
buffer_load_dwordx4 v[120:123],v0,s[20:23],s97 offen offset:1024 sc1
dlp_100713:
s_waitcnt vmcnt(2)
v_max3_u32 v124,v36,v37,v38
v_max_u32 v124,v124,v39
v_cmp_eq_u32 vcc,-1,v124
s_cbranch_vccz dgo_100712
buffer_load_dwordx4 v[36:39],v0,s[20:23],s97 offen offset:1024 sc1
s_waitcnt vmcnt(2)
v_max3_u32 v124,v116,v117,v118
v_max_u32 v124,v124,v119
v_cmp_eq_u32 vcc,-1,v124
s_cbranch_vccz dcp_100715
buffer_load_dwordx4 v[116:119],v0,s[20:23],s97 offen offset:1024 sc1
s_waitcnt vmcnt(2)
v_max3_u32 v124,v120,v121,v122
v_max_u32 v124,v124,v123
v_cmp_eq_u32 vcc,-1,v124
s_cbranch_vccz dcp_100716
buffer_load_dwordx4 v[120:123],v0,s[20:23],s97 offen offset:1024 sc1
s_sub_u32 s90,s90,1
s_cmp_gt_i32 s90,0
s_cbranch_scc1 dlp_100713
s_branch dgo_100712
dcp_100715:
v_mov_b32 v36,v116
v_mov_b32 v37,v117
v_mov_b32 v38,v118
v_mov_b32 v39,v119
s_nop 1
s_branch dgo_100712
dcp_100716:
v_mov_b32 v36,v120
v_mov_b32 v37,v121
v_mov_b32 v38,v122
v_mov_b32 v39,v123
s_nop 1
dgo_100712:
v_smfmac_f32_16x16x64_bf16 v[96:99],v[36:39],v[160:167],v1
v_smfmac_f32_16x16x64_bf16 v[100:103],v[36:39],v[168:175],v1
dsk_100711:
s_bitcmp1_b32 s55,6
s_cbranch_scc0 dsk_100717
s_waitcnt vmcnt(2)
v_max3_u32 v124,v40,v41,v42
v_max_u32 v124,v124,v43
v_cmp_eq_u32 vcc,-1,v124
s_cbranch_vccz dgo_100718
s_nop 15
buffer_load_dwordx4 v[116:119],v0,s[20:23],s97 offen offset:2048 sc1
s_nop 15
buffer_load_dwordx4 v[120:123],v0,s[20:23],s97 offen offset:2048 sc1
dlp_100719:
s_waitcnt vmcnt(2)
v_max3_u32 v124,v40,v41,v42
v_max_u32 v124,v124,v43
v_cmp_eq_u32 vcc,-1,v124
s_cbranch_vccz dgo_100718
buffer_load_dwordx4 v[40:43],v0,s[20:23],s97 offen offset:2048 sc1
s_waitcnt vmcnt(2)
v_max3_u32 v124,v116,v117,v118
v_max_u32 v124,v124,v119
v_cmp_eq_u32 vcc,-1,v124
s_cbranch_vccz dcp_100721
buffer_load_dwordx4 v[116:119],v0,s[20:23],s97 offen offset:2048 sc1
s_waitcnt vmcnt(2)
v_max3_u32 v124,v120,v121,v122
v_max_u32 v124,v124,v123
v_cmp_eq_u32 vcc,-1,v124
s_cbranch_vccz dcp_100722
buffer_load_dwordx4 v[120:123],v0,s[20:23],s97 offen offset:2048 sc1
s_sub_u32 s90,s90,1
s_cmp_gt_i32 s90,0
s_cbranch_scc1 dlp_100719
s_branch dgo_100718
dcp_100721:
v_mov_b32 v40,v116
v_mov_b32 v41,v117
v_mov_b32 v42,v118
v_mov_b32 v43,v119
s_nop 1
s_branch dgo_100718
dcp_100722:
v_mov_b32 v40,v120
v_mov_b32 v41,v121
v_mov_b32 v42,v122
v_mov_b32 v43,v123
s_nop 1
dgo_100718:
v_smfmac_f32_16x16x64_bf16 v[96:99],v[40:43],v[176:183],v1
v_smfmac_f32_16x16x64_bf16 v[100:103],v[40:43],v[184:191],v1
dsk_100717:
s_bitcmp1_b32 s55,7
s_cbranch_scc0 dsk_100723
s_waitcnt vmcnt(2)
v_max3_u32 v124,v44,v45,v46
v_max_u32 v124,v124,v47
v_cmp_eq_u32 vcc,-1,v124
s_cbranch_vccz dgo_100724
s_nop 15
buffer_load_dwordx4 v[116:119],v0,s[20:23],s97 offen offset:3072 sc1
s_nop 15
buffer_load_dwordx4 v[120:123],v0,s[20:23],s97 offen offset:3072 sc1
dlp_100725:
s_waitcnt vmcnt(2)
v_max3_u32 v124,v44,v45,v46
v_max_u32 v124,v124,v47
v_cmp_eq_u32 vcc,-1,v124
s_cbranch_vccz dgo_100724
buffer_load_dwordx4 v[44:47],v0,s[20:23],s97 offen offset:3072 sc1
s_waitcnt vmcnt(2)
v_max3_u32 v124,v116,v117,v118
v_max_u32 v124,v124,v119
v_cmp_eq_u32 vcc,-1,v124
s_cbranch_vccz dcp_100727
buffer_load_dwordx4 v[116:119],v0,s[20:23],s97 offen offset:3072 sc1
s_waitcnt vmcnt(2)
v_max3_u32 v124,v120,v121,v122
v_max_u32 v124,v124,v123
v_cmp_eq_u32 vcc,-1,v124
s_cbranch_vccz dcp_100728
buffer_load_dwordx4 v[120:123],v0,s[20:23],s97 offen offset:3072 sc1
s_sub_u32 s90,s90,1
s_cmp_gt_i32 s90,0
s_cbranch_scc1 dlp_100725
s_branch dgo_100724
dcp_100727:
v_mov_b32 v44,v116
v_mov_b32 v45,v117
v_mov_b32 v46,v118
v_mov_b32 v47,v119
s_nop 1
s_branch dgo_100724
dcp_100728:
v_mov_b32 v44,v120
v_mov_b32 v45,v121
v_mov_b32 v46,v122
v_mov_b32 v47,v123
s_nop 1
dgo_100724:
v_smfmac_f32_16x16x64_bf16 v[96:99],v[44:47],v[192:199],v1
v_smfmac_f32_16x16x64_bf16 v[100:103],v[44:47],v[200:207],v1
dsk_100723:
s_mov_b32 s55,0
s_branch oback_100503
fl_100520:
flb_100528:
buffer_load_dwordx4 v[16:19],v0,s[20:23],s92 offen offset:0 sc1
s_mov_b32 s55,1
buffer_load_dwordx4 v[32:35],v0,s[20:23],s93 offen offset:0 sc1
s_waitcnt vmcnt(4)
v_max3_u32 v124,v20,v21,v22
v_max_u32 v124,v124,v23
v_cmp_eq_u32 vcc,-1,v124
s_cbranch_vccnz dfl_100729
v_smfmac_f32_16x16x64_bf16 v[64:67],v[20:23],a[96:103],v1
buffer_load_dword v125,off,s[20:23],s92 sc1
buffer_load_dwordx4 v[36:39],v0,s[20:23],s93 offen offset:1024 sc1
s_waitcnt vmcnt(5)
v_max3_u32 v124,v24,v25,v26
v_smfmac_f32_16x16x64_bf16 v[68:71],v[20:23],a[104:111],v1
v_max_u32 v124,v124,v27
v_cmp_eq_u32 vcc,-1,v124
v_smfmac_f32_16x16x64_bf16 v[72:75],v[20:23],a[112:119],v1
v_smfmac_f32_16x16x64_bf16 v[76:79],v[20:23],a[120:127],v1
s_cbranch_vccnz dfl_100730
v_smfmac_f32_16x16x64_bf16 v[64:67],v[24:27],a[160:167],v1
buffer_load_dword v125,off,s[20:23],s92 sc1
buffer_load_dwordx4 v[40:43],v0,s[20:23],s93 offen offset:2048 sc1
buffer_load_dwordx4 v[44:47],v0,s[20:23],s93 offen offset:3072 sc1
s_waitcnt vmcnt(7)
v_max3_u32 v124,v28,v29,v30
v_smfmac_f32_16x16x64_bf16 v[68:71],v[24:27],a[168:175],v1
v_max_u32 v124,v124,v31
v_cmp_eq_u32 vcc,-1,v124
v_smfmac_f32_16x16x64_bf16 v[72:75],v[24:27],a[176:183],v1
v_smfmac_f32_16x16x64_bf16 v[76:79],v[24:27],a[184:191],v1
s_cbranch_vccnz dfl_100731
v_smfmac_f32_16x16x64_bf16 v[64:67],v[28:31],a[224:231],v1
buffer_load_dword v125,off,s[20:23],s92 sc1
buffer_store_dword v126,v121,s[20:23],s69 offen sc1
s_waitcnt vmcnt(8)
v_max3_u32 v124,v16,v17,v18
v_smfmac_f32_16x16x64_bf16 v[68:71],v[28:31],a[232:239],v1
v_max_u32 v124,v124,v19
v_cmp_eq_u32 vcc,-1,v124
v_smfmac_f32_16x16x64_bf16 v[72:75],v[28:31],a[240:247],v1
v_smfmac_f32_16x16x64_bf16 v[76:79],v[28:31],a[248:255],v1
s_cbranch_vccnz lfb_100736
s_mov_b32 s55,0
v_smfmac_f32_16x16x64_bf16 v[64:67],v[16:19],a[32:39],v1
s_waitcnt vmcnt(7)
v_max3_u32 v124,v32,v33,v34
v_max_u32 v124,v124,v35
v_cmp_eq_u32 vcc,-1,v124
v_smfmac_f32_16x16x64_bf16 v[68:71],v[16:19],a[40:47],v1
v_smfmac_f32_16x16x64_bf16 v[72:75],v[16:19],a[48:55],v1
v_smfmac_f32_16x16x64_bf16 v[76:79],v[16:19],a[56:63],v1
s_cbranch_vccnz flb_100532
s_branch segb_100516
fl_100521:
flb_100529:
buffer_load_dwordx4 v[20:23],v0,s[20:23],s92 offen offset:1024 sc1
s_mov_b32 s55,2
buffer_load_dwordx4 v[36:39],v0,s[20:23],s93 offen offset:1024 sc1
s_waitcnt vmcnt(5)
v_max3_u32 v124,v24,v25,v26
v_max_u32 v124,v124,v27
v_cmp_eq_u32 vcc,-1,v124
s_cbranch_vccnz dfl_100730
v_smfmac_f32_16x16x64_bf16 v[64:67],v[24:27],a[160:167],v1
buffer_load_dword v125,off,s[20:23],s92 sc1
buffer_load_dwordx4 v[40:43],v0,s[20:23],s93 offen offset:2048 sc1
buffer_load_dwordx4 v[44:47],v0,s[20:23],s93 offen offset:3072 sc1
s_waitcnt vmcnt(7)
v_max3_u32 v124,v28,v29,v30
v_smfmac_f32_16x16x64_bf16 v[68:71],v[24:27],a[168:175],v1
v_max_u32 v124,v124,v31
v_cmp_eq_u32 vcc,-1,v124
v_smfmac_f32_16x16x64_bf16 v[72:75],v[24:27],a[176:183],v1
v_smfmac_f32_16x16x64_bf16 v[76:79],v[24:27],a[184:191],v1
s_cbranch_vccnz dfl_100731
v_smfmac_f32_16x16x64_bf16 v[64:67],v[28:31],a[224:231],v1
buffer_load_dword v125,off,s[20:23],s92 sc1
buffer_store_dword v126,v121,s[20:23],s69 offen sc1
s_waitcnt vmcnt(6)
v_max3_u32 v124,v20,v21,v22
v_smfmac_f32_16x16x64_bf16 v[68:71],v[28:31],a[232:239],v1
v_max_u32 v124,v124,v23
v_cmp_eq_u32 vcc,-1,v124
v_smfmac_f32_16x16x64_bf16 v[72:75],v[28:31],a[240:247],v1
v_smfmac_f32_16x16x64_bf16 v[76:79],v[28:31],a[248:255],v1
s_cbranch_vccnz lfb_100736
s_mov_b32 s55,0
v_smfmac_f32_16x16x64_bf16 v[64:67],v[20:23],a[96:103],v1
s_waitcnt vmcnt(7)
v_max3_u32 v124,v32,v33,v34
v_max_u32 v124,v124,v35
v_cmp_eq_u32 vcc,-1,v124
v_smfmac_f32_16x16x64_bf16 v[68:71],v[20:23],a[104:111],v1
v_smfmac_f32_16x16x64_bf16 v[72:75],v[20:23],a[112:119],v1
v_smfmac_f32_16x16x64_bf16 v[76:79],v[20:23],a[120:127],v1
s_cbranch_vccnz flb_100532
s_branch segb_100516
fl_100522:
flb_100530:
buffer_load_dwordx4 v[24:27],v0,s[20:23],s92 offen offset:2048 sc1
s_mov_b32 s55,4
buffer_load_dwordx4 v[40:43],v0,s[20:23],s93 offen offset:2048 sc1
buffer_load_dwordx4 v[44:47],v0,s[20:23],s93 offen offset:3072 sc1
s_waitcnt vmcnt(7)
v_max3_u32 v124,v28,v29,v30
v_max_u32 v124,v124,v31
v_cmp_eq_u32 vcc,-1,v124
s_cbranch_vccnz dfl_100731
v_smfmac_f32_16x16x64_bf16 v[64:67],v[28:31],a[224:231],v1
buffer_load_dword v125,off,s[20:23],s92 sc1
buffer_store_dword v126,v121,s[20:23],s69 offen sc1
s_waitcnt vmcnt(4)
v_max3_u32 v124,v24,v25,v26
v_smfmac_f32_16x16x64_bf16 v[68:71],v[28:31],a[232:239],v1
v_max_u32 v124,v124,v27
v_cmp_eq_u32 vcc,-1,v124
v_smfmac_f32_16x16x64_bf16 v[72:75],v[28:31],a[240:247],v1
v_smfmac_f32_16x16x64_bf16 v[76:79],v[28:31],a[248:255],v1
s_cbranch_vccnz lfb_100736
s_mov_b32 s55,0
v_smfmac_f32_16x16x64_bf16 v[64:67],v[24:27],a[160:167],v1
s_waitcnt vmcnt(7)
v_max3_u32 v124,v32,v33,v34
v_max_u32 v124,v124,v35
v_cmp_eq_u32 vcc,-1,v124
v_smfmac_f32_16x16x64_bf16 v[68:71],v[24:27],a[168:175],v1
v_smfmac_f32_16x16x64_bf16 v[72:75],v[24:27],a[176:183],v1
v_smfmac_f32_16x16x64_bf16 v[76:79],v[24:27],a[184:191],v1
s_cbranch_vccnz flb_100532
s_branch segb_100516
fl_100523:
flb_100531:
buffer_load_dwordx4 v[28:31],v0,s[20:23],s92 offen offset:3072 sc1
s_mov_b32 s55,8
buffer_store_dword v126,v121,s[20:23],s69 offen sc1
s_waitcnt vmcnt(1)
v_max3_u32 v124,v28,v29,v30
v_max_u32 v124,v124,v31
v_cmp_eq_u32 vcc,-1,v124
s_cbranch_vccnz lfb_100736
s_mov_b32 s55,0
v_smfmac_f32_16x16x64_bf16 v[64:67],v[28:31],a[224:231],v1
s_waitcnt vmcnt(7)
v_max3_u32 v124,v32,v33,v34
v_max_u32 v124,v124,v35
v_cmp_eq_u32 vcc,-1,v124
v_smfmac_f32_16x16x64_bf16 v[68:71],v[28:31],a[232:239],v1
v_smfmac_f32_16x16x64_bf16 v[72:75],v[28:31],a[240:247],v1
v_smfmac_f32_16x16x64_bf16 v[76:79],v[28:31],a[248:255],v1
s_cbranch_vccnz flb_100532
s_branch segb_100516
fl_100524:
flb_100532:
buffer_load_dwordx4 v[32:35],v0,s[20:23],s93 offen offset:0 sc1
s_mov_b32 s55,240
s_bitcmp1_b32 s55,5
s_cbranch_scc0 rdn_100739
s_waitcnt vmcnt(6)
v_max3_u32 v124,v36,v37,v38
v_max_u32 v124,v124,v39
v_cmp_eq_u32 vcc,-1,v124
s_cbranch_vccnz rfa_100740
buffer_load_dword v125,off,s[20:23],s92 sc1
s_bitset0_b32 s55,5
v_smfmac_f32_16x16x64_bf16 v[64:67],v[36:39],a[96:103],v1
v_smfmac_f32_16x16x64_bf16 v[68:71],v[36:39],a[104:111],v1
v_smfmac_f32_16x16x64_bf16 v[72:75],v[36:39],a[112:119],v1
v_smfmac_f32_16x16x64_bf16 v[76:79],v[36:39],a[120:127],v1
s_cmp_eq_u32 s55,0
s_cbranch_scc1 segb_100518
s_branch rnx_100741
rdn_100739:
buffer_load_dword v125,off,s[20:23],s92 sc1
s_branch rnx_100741
rfa_100740:
buffer_load_dwordx4 v[36:39],v0,s[20:23],s93 offen offset:1024 sc1
rnx_100741:
s_bitcmp1_b32 s55,6
s_cbranch_scc0 rdn_100742
s_waitcnt vmcnt(5)
v_max3_u32 v124,v40,v41,v42
v_max_u32 v124,v124,v43
v_cmp_eq_u32 vcc,-1,v124
s_cbranch_vccnz rfa_100743
buffer_load_dword v125,off,s[20:23],s92 sc1
s_bitset0_b32 s55,6
s_cmp_eq_u32 s55,0
s_cbranch_scc1 segb_100518
s_branch rnx_100744
rdn_100742:
buffer_load_dword v125,off,s[20:23],s92 sc1
s_branch rnx_100744
rfa_100743:
buffer_load_dwordx4 v[40:43],v0,s[20:23],s93 offen offset:2048 sc1
rnx_100744:
s_bitcmp1_b32 s55,7
s_cbranch_scc0 rdn_100745
s_waitcnt vmcnt(5)
v_max3_u32 v124,v44,v45,v46
v_max_u32 v124,v124,v47
v_cmp_eq_u32 vcc,-1,v124
s_cbranch_vccnz rfa_100746
buffer_load_dword v125,off,s[20:23],s92 sc1
s_bitset0_b32 s55,7
s_cmp_eq_u32 s55,0
s_cbranch_scc1 segb_100518
s_branch rnx_100747
rdn_100745:
buffer_load_dword v125,off,s[20:23],s92 sc1
s_branch rnx_100747
rfa_100746:
buffer_load_dwordx4 v[44:47],v0,s[20:23],s93 offen offset:3072 sc1
rnx_100747:
rot_100738:
s_bitcmp1_b32 s55,4
s_cbranch_scc0 rdn_100748
s_waitcnt vmcnt(3)
v_max3_u32 v124,v32,v33,v34
v_max_u32 v124,v124,v35
v_cmp_eq_u32 vcc,-1,v124
s_cbranch_vccnz rfa_100749
buffer_load_dword v125,off,s[20:23],s92 sc1
s_bitset0_b32 s55,4
v_smfmac_f32_16x16x64_bf16 v[64:67],v[32:35],a[32:39],v1
v_smfmac_f32_16x16x64_bf16 v[68:71],v[32:35],a[40:47],v1
v_smfmac_f32_16x16x64_bf16 v[72:75],v[32:35],a[48:55],v1
v_smfmac_f32_16x16x64_bf16 v[76:79],v[32:35],a[56:63],v1
s_cmp_eq_u32 s55,0
s_cbranch_scc1 segb_100518
s_branch rnx_100750
rdn_100748:
buffer_load_dword v125,off,s[20:23],s92 sc1
s_branch rnx_100750
rfa_100749:
buffer_load_dwordx4 v[32:35],v0,s[20:23],s93 offen offset:0 sc1
rnx_100750:
s_bitcmp1_b32 s55,5
s_cbranch_scc0 rdn_100751
s_waitcnt vmcnt(3)
v_max3_u32 v124,v36,v37,v38
v_max_u32 v124,v124,v39
v_cmp_eq_u32 vcc,-1,v124
s_cbranch_vccnz rfa_100752
buffer_load_dword v125,off,s[20:23],s92 sc1
s_bitset0_b32 s55,5
v_smfmac_f32_16x16x64_bf16 v[64:67],v[36:39],a[96:103],v1
v_smfmac_f32_16x16x64_bf16 v[68:71],v[36:39],a[104:111],v1
v_smfmac_f32_16x16x64_bf16 v[72:75],v[36:39],a[112:119],v1
v_smfmac_f32_16x16x64_bf16 v[76:79],v[36:39],a[120:127],v1
s_cmp_eq_u32 s55,0
s_cbranch_scc1 segb_100518
s_branch rnx_100753
rdn_100751:
buffer_load_dword v125,off,s[20:23],s92 sc1
s_branch rnx_100753
rfa_100752:
buffer_load_dwordx4 v[36:39],v0,s[20:23],s93 offen offset:1024 sc1
rnx_100753:
s_bitcmp1_b32 s55,6
s_cbranch_scc0 rdn_100754
s_waitcnt vmcnt(3)
v_max3_u32 v124,v40,v41,v42
v_max_u32 v124,v124,v43
v_cmp_eq_u32 vcc,-1,v124
s_cbranch_vccnz rfa_100755
buffer_load_dword v125,off,s[20:23],s92 sc1
s_bitset0_b32 s55,6
s_cmp_eq_u32 s55,0
s_cbranch_scc1 segb_100518
s_branch rnx_100756
rdn_100754:
buffer_load_dword v125,off,s[20:23],s92 sc1
s_branch rnx_100756
rfa_100755:
buffer_load_dwordx4 v[40:43],v0,s[20:23],s93 offen offset:2048 sc1
rnx_100756:
s_bitcmp1_b32 s55,7
s_cbranch_scc0 rdn_100757
s_waitcnt vmcnt(3)
v_max3_u32 v124,v44,v45,v46
v_max_u32 v124,v124,v47
v_cmp_eq_u32 vcc,-1,v124
s_cbranch_vccnz rfa_100758
buffer_load_dword v125,off,s[20:23],s92 sc1
s_bitset0_b32 s55,7
s_cmp_eq_u32 s55,0
s_cbranch_scc1 segb_100518
s_branch rnx_100759
rdn_100757:
buffer_load_dword v125,off,s[20:23],s92 sc1
s_branch rnx_100759
rfa_100758:
buffer_load_dwordx4 v[44:47],v0,s[20:23],s93 offen offset:3072 sc1
rnx_100759:
s_sub_u32 s90,s90,1
s_cmp_gt_i32 s90,0
s_cbranch_scc1 rot_100738
s_mov_b32 s55,0
s_branch segb_100518
fl_100525:
flb_100533:
buffer_load_dwordx4 v[36:39],v0,s[20:23],s93 offen offset:1024 sc1
s_mov_b32 s55,224
s_bitcmp1_b32 s55,6
s_cbranch_scc0 rdn_100761
s_waitcnt vmcnt(5)
v_max3_u32 v124,v40,v41,v42
v_max_u32 v124,v124,v43
v_cmp_eq_u32 vcc,-1,v124
s_cbranch_vccnz rfa_100762
buffer_load_dword v125,off,s[20:23],s92 sc1
s_bitset0_b32 s55,6
s_cmp_eq_u32 s55,0
s_cbranch_scc1 segb_100518
s_branch rnx_100763
rdn_100761:
buffer_load_dword v125,off,s[20:23],s92 sc1
s_branch rnx_100763
rfa_100762:
buffer_load_dwordx4 v[40:43],v0,s[20:23],s93 offen offset:2048 sc1
rnx_100763:
s_bitcmp1_b32 s55,7
s_cbranch_scc0 rdn_100764
s_waitcnt vmcnt(5)
v_max3_u32 v124,v44,v45,v46
v_max_u32 v124,v124,v47
v_cmp_eq_u32 vcc,-1,v124
s_cbranch_vccnz rfa_100765
buffer_load_dword v125,off,s[20:23],s92 sc1
s_bitset0_b32 s55,7
s_cmp_eq_u32 s55,0
s_cbranch_scc1 segb_100518
s_branch rnx_100766
rdn_100764:
buffer_load_dword v125,off,s[20:23],s92 sc1
s_branch rnx_100766
rfa_100765:
buffer_load_dwordx4 v[44:47],v0,s[20:23],s93 offen offset:3072 sc1
rnx_100766:
rot_100760:
s_bitcmp1_b32 s55,5
s_cbranch_scc0 rdn_100767
s_waitcnt vmcnt(2)
v_max3_u32 v124,v36,v37,v38
v_max_u32 v124,v124,v39
v_cmp_eq_u32 vcc,-1,v124
s_cbranch_vccnz rfa_100768
buffer_load_dword v125,off,s[20:23],s92 sc1
s_bitset0_b32 s55,5
v_smfmac_f32_16x16x64_bf16 v[64:67],v[36:39],a[96:103],v1
v_smfmac_f32_16x16x64_bf16 v[68:71],v[36:39],a[104:111],v1
v_smfmac_f32_16x16x64_bf16 v[72:75],v[36:39],a[112:119],v1
v_smfmac_f32_16x16x64_bf16 v[76:79],v[36:39],a[120:127],v1
s_cmp_eq_u32 s55,0
s_cbranch_scc1 segb_100518
s_branch rnx_100769
rdn_100767:
buffer_load_dword v125,off,s[20:23],s92 sc1
s_branch rnx_100769
rfa_100768:
buffer_load_dwordx4 v[36:39],v0,s[20:23],s93 offen offset:1024 sc1
rnx_100769:
s_bitcmp1_b32 s55,6
s_cbranch_scc0 rdn_100770
s_waitcnt vmcnt(2)
v_max3_u32 v124,v40,v41,v42
v_max_u32 v124,v124,v43
v_cmp_eq_u32 vcc,-1,v124
s_cbranch_vccnz rfa_100771
buffer_load_dword v125,off,s[20:23],s92 sc1
s_bitset0_b32 s55,6
s_cmp_eq_u32 s55,0
s_cbranch_scc1 segb_100518
s_branch rnx_100772
rdn_100770:
buffer_load_dword v125,off,s[20:23],s92 sc1
s_branch rnx_100772
rfa_100771:
buffer_load_dwordx4 v[40:43],v0,s[20:23],s93 offen offset:2048 sc1
rnx_100772:
s_bitcmp1_b32 s55,7
s_cbranch_scc0 rdn_100773
s_waitcnt vmcnt(2)
v_max3_u32 v124,v44,v45,v46
v_max_u32 v124,v124,v47
v_cmp_eq_u32 vcc,-1,v124
s_cbranch_vccnz rfa_100774
buffer_load_dword v125,off,s[20:23],s92 sc1
s_bitset0_b32 s55,7
s_cmp_eq_u32 s55,0
s_cbranch_scc1 segb_100518
s_branch rnx_100775
rdn_100773:
buffer_load_dword v125,off,s[20:23],s92 sc1
s_branch rnx_100775
rfa_100774:
buffer_load_dwordx4 v[44:47],v0,s[20:23],s93 offen offset:3072 sc1
rnx_100775:
s_sub_u32 s90,s90,1
s_cmp_gt_i32 s90,0
s_cbranch_scc1 rot_100760
s_mov_b32 s55,0
s_branch segb_100518
fl_100526:
flb_100534:
s_mov_b32 s55,192
s_bitcmp1_b32 s55,6
s_cbranch_scc0 rdn_100777
s_waitcnt vmcnt(5)
v_max3_u32 v124,v40,v41,v42
v_max_u32 v124,v124,v43
v_cmp_eq_u32 vcc,-1,v124
s_cbranch_vccnz rfa_100778
buffer_load_dword v125,off,s[20:23],s92 sc1
s_bitset0_b32 s55,6
s_cmp_eq_u32 s55,0
s_cbranch_scc1 segb_100518
s_branch rnx_100779
rdn_100777:
buffer_load_dword v125,off,s[20:23],s92 sc1
s_branch rnx_100779
rfa_100778:
buffer_load_dwordx4 v[40:43],v0,s[20:23],s93 offen offset:2048 sc1
rnx_100779:
s_bitcmp1_b32 s55,7
s_cbranch_scc0 rdn_100780
s_waitcnt vmcnt(5)
v_max3_u32 v124,v44,v45,v46
v_max_u32 v124,v124,v47
v_cmp_eq_u32 vcc,-1,v124
s_cbranch_vccnz rfa_100781
buffer_load_dword v125,off,s[20:23],s92 sc1
s_bitset0_b32 s55,7
s_cmp_eq_u32 s55,0
s_cbranch_scc1 segb_100518
s_branch rnx_100782
rdn_100780:
buffer_load_dword v125,off,s[20:23],s92 sc1
s_branch rnx_100782
rfa_100781:
buffer_load_dwordx4 v[44:47],v0,s[20:23],s93 offen offset:3072 sc1
rnx_100782:
rot_100776:
s_bitcmp1_b32 s55,6
s_cbranch_scc0 rdn_100783
s_waitcnt vmcnt(1)
v_max3_u32 v124,v40,v41,v42
v_max_u32 v124,v124,v43
v_cmp_eq_u32 vcc,-1,v124
s_cbranch_vccnz rfa_100784
buffer_load_dword v125,off,s[20:23],s92 sc1
s_bitset0_b32 s55,6
s_cmp_eq_u32 s55,0
s_cbranch_scc1 segb_100518
s_branch rnx_100785
rdn_100783:
buffer_load_dword v125,off,s[20:23],s92 sc1
s_branch rnx_100785
rfa_100784:
buffer_load_dwordx4 v[40:43],v0,s[20:23],s93 offen offset:2048 sc1
rnx_100785:
s_bitcmp1_b32 s55,7
s_cbranch_scc0 rdn_100786
s_waitcnt vmcnt(1)
v_max3_u32 v124,v44,v45,v46
v_max_u32 v124,v124,v47
v_cmp_eq_u32 vcc,-1,v124
s_cbranch_vccnz rfa_100787
buffer_load_dword v125,off,s[20:23],s92 sc1
s_bitset0_b32 s55,7
s_cmp_eq_u32 s55,0
s_cbranch_scc1 segb_100518
s_branch rnx_100788
rdn_100786:
buffer_load_dword v125,off,s[20:23],s92 sc1
s_branch rnx_100788
rfa_100787:
buffer_load_dwordx4 v[44:47],v0,s[20:23],s93 offen offset:3072 sc1
rnx_100788:
s_sub_u32 s90,s90,1
s_cmp_gt_i32 s90,0
s_cbranch_scc1 rot_100776
s_mov_b32 s55,0
s_branch segb_100518
dfl_100729:
buffer_load_dwordx4 v[20:23],v0,s[20:23],s92 offen offset:1024 sc1
s_bitset1_b32 s55,1
buffer_load_dwordx4 v[36:39],v0,s[20:23],s93 offen offset:1024 sc1
s_waitcnt vmcnt(5)
v_max3_u32 v124,v24,v25,v26
v_max_u32 v124,v124,v27
v_cmp_eq_u32 vcc,-1,v124
s_cbranch_vccnz dfl_100730
s_branch dseg_100733
dfl_100730:
buffer_load_dwordx4 v[24:27],v0,s[20:23],s92 offen offset:2048 sc1
s_bitset1_b32 s55,2
buffer_load_dwordx4 v[40:43],v0,s[20:23],s93 offen offset:2048 sc1
buffer_load_dwordx4 v[44:47],v0,s[20:23],s93 offen offset:3072 sc1
s_waitcnt vmcnt(7)
v_max3_u32 v124,v28,v29,v30
v_max_u32 v124,v124,v31
v_cmp_eq_u32 vcc,-1,v124
s_cbranch_vccnz dfl_100731
s_branch dseg_100734
dfl_100731:
buffer_load_dwordx4 v[28:31],v0,s[20:23],s92 offen offset:3072 sc1
s_bitset1_b32 s55,3
buffer_store_dword v126,v121,s[20:23],s69 offen sc1
s_branch lap2_100735
dseg_100733:
v_smfmac_f32_16x16x64_bf16 v[64:67],v[24:27],a[160:167],v1
buffer_load_dword v125,off,s[20:23],s92 sc1
buffer_load_dwordx4 v[40:43],v0,s[20:23],s93 offen offset:2048 sc1
buffer_load_dwordx4 v[44:47],v0,s[20:23],s93 offen offset:3072 sc1
s_waitcnt vmcnt(7)
v_max3_u32 v124,v28,v29,v30
v_smfmac_f32_16x16x64_bf16 v[68:71],v[24:27],a[168:175],v1
v_max_u32 v124,v124,v31
v_cmp_eq_u32 vcc,-1,v124
v_smfmac_f32_16x16x64_bf16 v[72:75],v[24:27],a[176:183],v1
v_smfmac_f32_16x16x64_bf16 v[76:79],v[24:27],a[184:191],v1
s_cbranch_vccnz dfl_100731
dseg_100734:
v_smfmac_f32_16x16x64_bf16 v[64:67],v[28:31],a[224:231],v1
buffer_load_dword v125,off,s[20:23],s92 sc1
v_smfmac_f32_16x16x64_bf16 v[68:71],v[28:31],a[232:239],v1
buffer_store_dword v126,v121,s[20:23],s69 offen sc1
v_smfmac_f32_16x16x64_bf16 v[72:75],v[28:31],a[240:247],v1
v_smfmac_f32_16x16x64_bf16 v[76:79],v[28:31],a[248:255],v1
lap2_100735:
s_bitcmp1_b32 s55,0
s_cbranch_scc0 l2s_100789
s_waitcnt vmcnt(8)
v_max3_u32 v124,v16,v17,v18
v_max_u32 v124,v124,v19
v_cmp_eq_u32 vcc,-1,v124
s_cbranch_vccnz l2s_100789
s_bitset0_b32 s55,0
v_smfmac_f32_16x16x64_bf16 v[64:67],v[16:19],a[32:39],v1
v_smfmac_f32_16x16x64_bf16 v[68:71],v[16:19],a[40:47],v1
v_smfmac_f32_16x16x64_bf16 v[72:75],v[16:19],a[48:55],v1
v_smfmac_f32_16x16x64_bf16 v[76:79],v[16:19],a[56:63],v1
l2s_100789:
s_bitcmp1_b32 s55,1
s_cbranch_scc0 l2s_100791
s_waitcnt vmcnt(6)
v_max3_u32 v124,v20,v21,v22
v_max_u32 v124,v124,v23
v_cmp_eq_u32 vcc,-1,v124
s_cbranch_vccnz l2s_100791
s_bitset0_b32 s55,1
v_smfmac_f32_16x16x64_bf16 v[64:67],v[20:23],a[96:103],v1
v_smfmac_f32_16x16x64_bf16 v[68:71],v[20:23],a[104:111],v1
v_smfmac_f32_16x16x64_bf16 v[72:75],v[20:23],a[112:119],v1
v_smfmac_f32_16x16x64_bf16 v[76:79],v[20:23],a[120:127],v1
l2s_100791:
s_bitcmp1_b32 s55,2
s_cbranch_scc0 l2s_100793
s_waitcnt vmcnt(4)
v_max3_u32 v124,v24,v25,v26
v_max_u32 v124,v124,v27
v_cmp_eq_u32 vcc,-1,v124
s_cbranch_vccnz l2s_100793
s_bitset0_b32 s55,2
v_smfmac_f32_16x16x64_bf16 v[64:67],v[24:27],a[160:167],v1
v_smfmac_f32_16x16x64_bf16 v[68:71],v[24:27],a[168:175],v1
v_smfmac_f32_16x16x64_bf16 v[72:75],v[24:27],a[176:183],v1
v_smfmac_f32_16x16x64_bf16 v[76:79],v[24:27],a[184:191],v1
l2s_100793:
s_bitcmp1_b32 s55,3
s_cbranch_scc0 l2s_100795
s_waitcnt vmcnt(1)
v_max3_u32 v124,v28,v29,v30
v_max_u32 v124,v124,v31
v_cmp_eq_u32 vcc,-1,v124
s_cbranch_vccnz l2s_100795
s_bitset0_b32 s55,3
v_smfmac_f32_16x16x64_bf16 v[64:67],v[28:31],a[224:231],v1
v_smfmac_f32_16x16x64_bf16 v[68:71],v[28:31],a[232:239],v1
v_smfmac_f32_16x16x64_bf16 v[72:75],v[28:31],a[240:247],v1
v_smfmac_f32_16x16x64_bf16 v[76:79],v[28:31],a[248:255],v1
l2s_100795:
s_cmp_eq_u32 s55,0
s_cbranch_scc0 lfb_100736
Ldone_100737:
s_waitcnt vmcnt(7)
v_max3_u32 v124,v32,v33,v34
v_max_u32 v124,v124,v35
v_cmp_eq_u32 vcc,-1,v124
s_cbranch_vccnz flb_100532
s_branch segb_100516
lfb_100736:
s_bitcmp1_b32 s55,0
s_cbranch_scc0 dsk_100797
buffer_load_dwordx4 v[16:19],v0,s[20:23],s92 offen offset:0 sc1
dsk_100797:
s_bitcmp1_b32 s55,1
s_cbranch_scc0 dsk_100798
buffer_load_dwordx4 v[20:23],v0,s[20:23],s92 offen offset:1024 sc1
dsk_100798:
s_bitcmp1_b32 s55,2
s_cbranch_scc0 dsk_100799
buffer_load_dwordx4 v[24:27],v0,s[20:23],s92 offen offset:2048 sc1
dsk_100799:
s_bitcmp1_b32 s55,3
s_cbranch_scc0 dsk_100800
buffer_load_dwordx4 v[28:31],v0,s[20:23],s92 offen offset:3072 sc1
dsk_100800:
s_bitcmp1_b32 s55,0
s_cbranch_scc0 dsk_100801
s_waitcnt vmcnt(2)
v_max3_u32 v124,v16,v17,v18
v_max_u32 v124,v124,v19
v_cmp_eq_u32 vcc,-1,v124
s_cbranch_vccz dgo_100802
s_nop 15
buffer_load_dwordx4 v[104:107],v0,s[20:23],s92 offen offset:0 sc1
s_nop 15
buffer_load_dwordx4 v[108:111],v0,s[20:23],s92 offen offset:0 sc1
dlp_100803:
s_waitcnt vmcnt(2)
v_max3_u32 v124,v16,v17,v18
v_max_u32 v124,v124,v19
v_cmp_eq_u32 vcc,-1,v124
s_cbranch_vccz dgo_100802
buffer_load_dwordx4 v[16:19],v0,s[20:23],s92 offen offset:0 sc1
s_waitcnt vmcnt(2)
v_max3_u32 v124,v104,v105,v106
v_max_u32 v124,v124,v107
v_cmp_eq_u32 vcc,-1,v124
s_cbranch_vccz dcp_100805
buffer_load_dwordx4 v[104:107],v0,s[20:23],s92 offen offset:0 sc1
s_waitcnt vmcnt(2)
v_max3_u32 v124,v108,v109,v110
v_max_u32 v124,v124,v111
v_cmp_eq_u32 vcc,-1,v124
s_cbranch_vccz dcp_100806
buffer_load_dwordx4 v[108:111],v0,s[20:23],s92 offen offset:0 sc1
s_sub_u32 s90,s90,1
s_cmp_gt_i32 s90,0
s_cbranch_scc1 dlp_100803
s_branch dgo_100802
dcp_100805:
v_mov_b32 v16,v104
v_mov_b32 v17,v105
v_mov_b32 v18,v106
v_mov_b32 v19,v107
s_nop 1
s_branch dgo_100802
dcp_100806:
v_mov_b32 v16,v108
v_mov_b32 v17,v109
v_mov_b32 v18,v110
v_mov_b32 v19,v111
s_nop 1
dgo_100802:
v_smfmac_f32_16x16x64_bf16 v[64:67],v[16:19],a[32:39],v1
v_smfmac_f32_16x16x64_bf16 v[68:71],v[16:19],a[40:47],v1
v_smfmac_f32_16x16x64_bf16 v[72:75],v[16:19],a[48:55],v1
v_smfmac_f32_16x16x64_bf16 v[76:79],v[16:19],a[56:63],v1
dsk_100801:
s_bitcmp1_b32 s55,1
s_cbranch_scc0 dsk_100807
s_waitcnt vmcnt(2)
v_max3_u32 v124,v20,v21,v22
v_max_u32 v124,v124,v23
v_cmp_eq_u32 vcc,-1,v124
s_cbranch_vccz dgo_100808
s_nop 15
buffer_load_dwordx4 v[104:107],v0,s[20:23],s92 offen offset:1024 sc1
s_nop 15
buffer_load_dwordx4 v[108:111],v0,s[20:23],s92 offen offset:1024 sc1
dlp_100809:
s_waitcnt vmcnt(2)
v_max3_u32 v124,v20,v21,v22
v_max_u32 v124,v124,v23
v_cmp_eq_u32 vcc,-1,v124
s_cbranch_vccz dgo_100808
buffer_load_dwordx4 v[20:23],v0,s[20:23],s92 offen offset:1024 sc1
s_waitcnt vmcnt(2)
v_max3_u32 v124,v104,v105,v106
v_max_u32 v124,v124,v107
v_cmp_eq_u32 vcc,-1,v124
s_cbranch_vccz dcp_100811
buffer_load_dwordx4 v[104:107],v0,s[20:23],s92 offen offset:1024 sc1
s_waitcnt vmcnt(2)
v_max3_u32 v124,v108,v109,v110
v_max_u32 v124,v124,v111
v_cmp_eq_u32 vcc,-1,v124
s_cbranch_vccz dcp_100812
buffer_load_dwordx4 v[108:111],v0,s[20:23],s92 offen offset:1024 sc1
s_sub_u32 s90,s90,1
s_cmp_gt_i32 s90,0
s_cbranch_scc1 dlp_100809
s_branch dgo_100808
dcp_100811:
v_mov_b32 v20,v104
v_mov_b32 v21,v105
v_mov_b32 v22,v106
v_mov_b32 v23,v107
s_nop 1
s_branch dgo_100808
dcp_100812:
v_mov_b32 v20,v108
v_mov_b32 v21,v109
v_mov_b32 v22,v110
v_mov_b32 v23,v111
s_nop 1
dgo_100808:
v_smfmac_f32_16x16x64_bf16 v[64:67],v[20:23],a[96:103],v1
v_smfmac_f32_16x16x64_bf16 v[68:71],v[20:23],a[104:111],v1
v_smfmac_f32_16x16x64_bf16 v[72:75],v[20:23],a[112:119],v1
v_smfmac_f32_16x16x64_bf16 v[76:79],v[20:23],a[120:127],v1
dsk_100807:
s_bitcmp1_b32 s55,2
s_cbranch_scc0 dsk_100813
s_waitcnt vmcnt(2)
v_max3_u32 v124,v24,v25,v26
v_max_u32 v124,v124,v27
v_cmp_eq_u32 vcc,-1,v124
s_cbranch_vccz dgo_100814
s_nop 15
buffer_load_dwordx4 v[104:107],v0,s[20:23],s92 offen offset:2048 sc1
s_nop 15
buffer_load_dwordx4 v[108:111],v0,s[20:23],s92 offen offset:2048 sc1
dlp_100815:
s_waitcnt vmcnt(2)
v_max3_u32 v124,v24,v25,v26
v_max_u32 v124,v124,v27
v_cmp_eq_u32 vcc,-1,v124
s_cbranch_vccz dgo_100814
buffer_load_dwordx4 v[24:27],v0,s[20:23],s92 offen offset:2048 sc1
s_waitcnt vmcnt(2)
v_max3_u32 v124,v104,v105,v106
v_max_u32 v124,v124,v107
v_cmp_eq_u32 vcc,-1,v124
s_cbranch_vccz dcp_100817
buffer_load_dwordx4 v[104:107],v0,s[20:23],s92 offen offset:2048 sc1
s_waitcnt vmcnt(2)
v_max3_u32 v124,v108,v109,v110
v_max_u32 v124,v124,v111
v_cmp_eq_u32 vcc,-1,v124
s_cbranch_vccz dcp_100818
buffer_load_dwordx4 v[108:111],v0,s[20:23],s92 offen offset:2048 sc1
s_sub_u32 s90,s90,1
s_cmp_gt_i32 s90,0
s_cbranch_scc1 dlp_100815
s_branch dgo_100814
dcp_100817:
v_mov_b32 v24,v104
v_mov_b32 v25,v105
v_mov_b32 v26,v106
v_mov_b32 v27,v107
s_nop 1
s_branch dgo_100814
dcp_100818:
v_mov_b32 v24,v108
v_mov_b32 v25,v109
v_mov_b32 v26,v110
v_mov_b32 v27,v111
s_nop 1
dgo_100814:
v_smfmac_f32_16x16x64_bf16 v[64:67],v[24:27],a[160:167],v1
v_smfmac_f32_16x16x64_bf16 v[68:71],v[24:27],a[168:175],v1
v_smfmac_f32_16x16x64_bf16 v[72:75],v[24:27],a[176:183],v1
v_smfmac_f32_16x16x64_bf16 v[76:79],v[24:27],a[184:191],v1
dsk_100813:
s_bitcmp1_b32 s55,3
s_cbranch_scc0 dsk_100819
s_waitcnt vmcnt(2)
v_max3_u32 v124,v28,v29,v30
v_max_u32 v124,v124,v31
v_cmp_eq_u32 vcc,-1,v124
s_cbranch_vccz dgo_100820
s_nop 15
buffer_load_dwordx4 v[104:107],v0,s[20:23],s92 offen offset:3072 sc1
s_nop 15
buffer_load_dwordx4 v[108:111],v0,s[20:23],s92 offen offset:3072 sc1
dlp_100821:
s_waitcnt vmcnt(2)
v_max3_u32 v124,v28,v29,v30
v_max_u32 v124,v124,v31
v_cmp_eq_u32 vcc,-1,v124
s_cbranch_vccz dgo_100820
buffer_load_dwordx4 v[28:31],v0,s[20:23],s92 offen offset:3072 sc1
s_waitcnt vmcnt(2)
v_max3_u32 v124,v104,v105,v106
v_max_u32 v124,v124,v107
v_cmp_eq_u32 vcc,-1,v124
s_cbranch_vccz dcp_100823
buffer_load_dwordx4 v[104:107],v0,s[20:23],s92 offen offset:3072 sc1
s_waitcnt vmcnt(2)
v_max3_u32 v124,v108,v109,v110
v_max_u32 v124,v124,v111
v_cmp_eq_u32 vcc,-1,v124
s_cbranch_vccz dcp_100824
buffer_load_dwordx4 v[108:111],v0,s[20:23],s92 offen offset:3072 sc1
s_sub_u32 s90,s90,1
s_cmp_gt_i32 s90,0
s_cbranch_scc1 dlp_100821
s_branch dgo_100820
dcp_100823:
v_mov_b32 v28,v104
v_mov_b32 v29,v105
v_mov_b32 v30,v106
v_mov_b32 v31,v107
s_nop 1
s_branch dgo_100820
dcp_100824:
v_mov_b32 v28,v108
v_mov_b32 v29,v109
v_mov_b32 v30,v110
v_mov_b32 v31,v111
s_nop 1
dgo_100820:
v_smfmac_f32_16x16x64_bf16 v[64:67],v[28:31],a[224:231],v1
v_smfmac_f32_16x16x64_bf16 v[68:71],v[28:31],a[232:239],v1
v_smfmac_f32_16x16x64_bf16 v[72:75],v[28:31],a[240:247],v1
v_smfmac_f32_16x16x64_bf16 v[76:79],v[28:31],a[248:255],v1
dsk_100819:
s_mov_b32 s55,0
s_branch Ldone_100737
slowA_100536:
buffer_load_dwordx4 v[44:47],v0,s[20:23],s93 offen offset:3072 sc1
dsk_100825:
s_bitcmp1_b32 s55,7
s_cbranch_scc0 dsk_100826
s_waitcnt vmcnt(2)
v_max3_u32 v124,v44,v45,v46
v_max_u32 v124,v124,v47
v_cmp_eq_u32 vcc,-1,v124
s_cbranch_vccz dgo_100827
s_nop 15
s_nop 3
buffer_load_dwordx4 v[104:107],v0,s[20:23],s93 offen offset:3072 sc1
s_nop 15
s_nop 3
buffer_load_dwordx4 v[108:111],v0,s[20:23],s93 offen offset:3072 sc1
dlp_100828:
s_waitcnt vmcnt(2)
v_max3_u32 v124,v44,v45,v46
v_max_u32 v124,v124,v47
v_cmp_eq_u32 vcc,-1,v124
s_cbranch_vccz dgo_100827
buffer_load_dwordx4 v[44:47],v0,s[20:23],s93 offen offset:3072 sc1
s_waitcnt vmcnt(2)
v_max3_u32 v124,v104,v105,v106
v_max_u32 v124,v124,v107
v_cmp_eq_u32 vcc,-1,v124
s_cbranch_vccz dcp_100830
buffer_load_dwordx4 v[104:107],v0,s[20:23],s93 offen offset:3072 sc1
s_waitcnt vmcnt(2)
v_max3_u32 v124,v108,v109,v110
v_max_u32 v124,v124,v111
v_cmp_eq_u32 vcc,-1,v124
s_cbranch_vccz dcp_100831
buffer_load_dwordx4 v[108:111],v0,s[20:23],s93 offen offset:3072 sc1
s_sub_u32 s90,s90,1
s_cmp_gt_i32 s90,0
s_cbranch_scc1 dlp_100828
s_branch dgo_100827
dcp_100830:
v_mov_b32 v44,v104
v_mov_b32 v45,v105
v_mov_b32 v46,v106
v_mov_b32 v47,v107
s_nop 1
s_branch dgo_100827
dcp_100831:
v_mov_b32 v44,v108
v_mov_b32 v45,v109
v_mov_b32 v46,v110
v_mov_b32 v47,v111
s_nop 1
dgo_100827:
dsk_100826:
s_mov_b32 s55,0
s_branch segb_100518
recslow_100429:
buffer_load_dword v119,off,s[20:23],s68 sc1
s_mov_b32 s55,0
s_cmp_lg_u32 s50,0
s_cbranch_scc1 np0_100834
v_mov_b32 v120,0
v_mov_b32 v121,0
s_cmp_lg_u32 s58,0
s_cbranch_scc1 z1_100835
v_mov_b32 v120,v32
v_mov_b32 v121,v33
v_mov_b32 v122,v34
v_mov_b32 v123,v35
v_lshl_or_b32 v120,v122,16,v120
v_lshl_or_b32 v121,v123,16,v121
v_min_u32 v120,s81,v120
v_min_u32 v121,s81,v121
z1_100835:
buffer_store_dword v120,v4,s[20:23],s71 offen sc1
buffer_store_dword v121,v4,s[20:23],s71 offen offset:32 sc1
buffer_store_dword v120,v4,s[20:23],s73 offen sc1
buffer_store_dword v121,v4,s[20:23],s73 offen offset:32 sc1
np0_100834:
v_lshrrev_b32 v124,2,v0
v_bfe_u32 v125,v124,5,1
v_mul_u32_u24 v125,2048,v125
s_and_b32 s64,s50,1
s_lshl_b32 s64,s64,5
v_add3_u32 v4,v124,v125,s64
s_mov_b32 s61,1
s_mov_b32 s92,s70
s_mov_b32 s93,s72
s_mov_b32 s94,s76
s_add_u32 s95,s94,4096
s_mov_b32 s96,s74
s_add_u32 s97,s96,4096
s_mov_b32 s98,s75
s_barrier
v_mov_b32 v96,v104
v_mov_b32 v97,v105
v_mov_b32 v98,v106
v_mov_b32 v99,v107
v_mov_b32 v100,v108
v_mov_b32 v101,v109
v_mov_b32 v102,v110
v_mov_b32 v103,v111
v_mov_b32 v48,0
v_mov_b32 v49,0
v_mov_b32 v50,0
v_mov_b32 v51,0
v_mov_b32 v52,0
v_mov_b32 v53,0
v_mov_b32 v54,0
v_mov_b32 v55,0
v_mov_b32 v56,0
v_mov_b32 v57,0
v_mov_b32 v58,0
v_mov_b32 v59,0
v_mov_b32 v60,0
v_mov_b32 v61,0
v_mov_b32 v62,0
v_mov_b32 v63,0
v_mov_b32 v64,0
v_mov_b32 v65,0
v_mov_b32 v66,0
v_mov_b32 v67,0
v_mov_b32 v68,0
v_mov_b32 v69,0
v_mov_b32 v70,0
v_mov_b32 v71,0
v_mov_b32 v72,0
v_mov_b32 v73,0
v_mov_b32 v74,0
v_mov_b32 v75,0
v_mov_b32 v76,0
v_mov_b32 v77,0
v_mov_b32 v78,0
v_mov_b32 v79,0
v_mov_b32 v80,0
v_mov_b32 v81,0
v_mov_b32 v82,0
v_mov_b32 v83,0
v_mov_b32 v84,0
v_mov_b32 v85,0
v_mov_b32 v86,0
v_mov_b32 v87,0
v_mov_b32 v88,0
v_mov_b32 v89,0
v_mov_b32 v90,0
v_mov_b32 v91,0
v_mov_b32 v92,0
v_mov_b32 v93,0
v_mov_b32 v94,0
v_mov_b32 v95,0
s_cmp_gt_u32 s50,1
s_cbranch_scc0 loop0_100836x
.p2align 6
s_nop 0
s_nop 0
s_nop 0
s_nop 0
s_nop 0
s_nop 0
s_nop 0
loop_100832:
v_mov_b32 v125,0
s_nop 1
v_mfma_f32_16x16x1_4b_f32 v[48:63],v125,v125,0
v_mfma_f32_16x16x1_4b_f32 v[64:79],v125,v125,0
v_mfma_f32_16x16x1_4b_f32 v[80:95],v125,v125,0
s_max_u32 s66,s79,1
s_sub_u32 s66,s66,1
v_cndmask_b32 v126,2.0,v0,s[82:83]
s_add_u32 s64,s66,0
s_lshl_b32 s65,s64,12
s_and_b32 s65,s65,0x2000
s_xor_b32 s65,s65,s67
s_lshl_b32 s64,s64,20
s_add_u32 s65,s65,s64
s_add_u32 s101,s65,s78
buffer_store_dwordx4 v[112:115],v126,s[20:23],s101 offen sc1
s_nop 15
s_nop 15
s_nop 15
s_nop 7
buffer_load_dwordx4 v[16:19],v0,s[20:23],s92 offen offset:0 sc1
s_nop 7
buffer_load_dwordx4 v[20:23],v0,s[20:23],s92 offen offset:1024 sc1
s_nop 7
buffer_load_dwordx4 v[24:27],v0,s[20:23],s92 offen offset:2048 sc1
s_nop 7
buffer_load_dwordx4 v[28:31],v0,s[20:23],s92 offen offset:3072 sc1
v_mov_b32 v96,v104
v_mov_b32 v97,v105
v_mov_b32 v98,v106
v_mov_b32 v99,v107
v_mov_b32 v100,v108
v_mov_b32 v101,v109
v_mov_b32 v102,v110
v_mov_b32 v103,v111
s_branch ja_100837
loop0_100836x:
v_mov_b32 v125,0
s_nop 1
v_mfma_f32_16x16x1_4b_f32 v[48:63],v125,v125,0
v_mfma_f32_16x16x1_4b_f32 v[64:79],v125,v125,0
v_mfma_f32_16x16x1_4b_f32 v[80:95],v125,v125,0
s_max_u32 s66,s79,1
s_sub_u32 s66,s66,1
v_cndmask_b32 v126,2.0,v0,s[82:83]
s_add_u32 s64,s66,0
s_lshl_b32 s65,s64,12
s_and_b32 s65,s65,0x2000
s_xor_b32 s65,s65,s67
s_lshl_b32 s64,s64,20
s_add_u32 s65,s65,s64
s_add_u32 s101,s65,s78
buffer_store_dwordx4 v[112:115],v126,s[20:23],s101 offen sc1
s_nop 15
s_nop 3
buffer_load_dwordx4 v[16:19],v0,s[20:23],s92 offen offset:0 sc1
s_nop 7
buffer_load_dwordx4 v[20:23],v0,s[20:23],s92 offen offset:1024 sc1
s_nop 7
buffer_load_dwordx4 v[24:27],v0,s[20:23],s92 offen offset:2048 sc1
s_nop 7
buffer_load_dwordx4 v[28:31],v0,s[20:23],s92 offen offset:3072 sc1
ja_100837:
.p2align 5
s_nop 0
s_nop 0
s_cmp_lg_u32 s61,0
s_cbranch_scc1 pe_100838
pb_100839:
v_mov_b32 v126,s79
s_cmp_eq_u32 s79,63
s_cbranch_scc1 last_100833
s_add_u32 s64,s79,1
s_lshl_b32 s65,s64,12
s_and_b32 s65,s65,0x2000
s_xor_b32 s65,s65,s67
s_lshl_b32 s64,s64,20
s_add_u32 s65,s65,s64
s_add_u32 s99,s65,s77
s_waitcnt vmcnt(3)
v_max3_u32 v124,v16,v17,v18
v_max_u32 v124,v124,v19
v_cmp_eq_u32 vcc,-1,v124
v_cndmask_b32 v121,2.0,v127,s[86:87]
v_readfirstlane_b32 s91,v119
s_add_u32 s64,s79,1
s_cmp_gt_u32 s91,s64
s_cselect_b32 s99,s99,2.0
s_cselect_b32 s63,0,1
s_cbranch_vccnz flb_100868
seg_100844:
segb_100852:
v_smfmac_f32_16x16x64_bf16 v[48:51],v[16:19],a[0:7],v1
buffer_load_dword v125,off,s[20:23],s92 sc1
v_smfmac_f32_16x16x64_bf16 v[52:55],v[16:19],a[8:15],v1
buffer_load_dwordx4 v[32:35],v0,s[20:23],s93 offen offset:0 sc1
v_smfmac_f32_16x16x64_bf16 v[56:59],v[16:19],a[16:23],v1
s_waitcnt vmcnt(4)
v_max3_u32 v124,v20,v21,v22
v_smfmac_f32_16x16x64_bf16 v[60:63],v[16:19],a[24:31],v1
v_max_u32 v124,v124,v23
v_smfmac_f32_16x16x64_bf16 v[64:67],v[16:19],a[32:39],v1
v_cmp_eq_u32 vcc,-1,v124
v_smfmac_f32_16x16x64_bf16 v[68:71],v[16:19],a[40:47],v1
v_smfmac_f32_16x16x64_bf16 v[72:75],v[16:19],a[48:55],v1
s_cbranch_vccnz fl_100861
seg_100845:
v_smfmac_f32_16x16x64_bf16 v[76:79],v[16:19],a[56:63],v1
segb_100853:
v_smfmac_f32_16x16x64_bf16 v[48:51],v[20:23],a[64:71],v1
buffer_load_dword v125,off,s[20:23],s92 sc1
v_smfmac_f32_16x16x64_bf16 v[52:55],v[20:23],a[72:79],v1
buffer_load_dwordx4 v[36:39],v0,s[20:23],s93 offen offset:1024 sc1
v_smfmac_f32_16x16x64_bf16 v[56:59],v[20:23],a[80:87],v1
s_waitcnt vmcnt(5)
v_max3_u32 v124,v24,v25,v26
v_smfmac_f32_16x16x64_bf16 v[60:63],v[20:23],a[88:95],v1
v_max_u32 v124,v124,v27
v_smfmac_f32_16x16x64_bf16 v[64:67],v[20:23],a[96:103],v1
v_cmp_eq_u32 vcc,-1,v124
v_smfmac_f32_16x16x64_bf16 v[68:71],v[20:23],a[104:111],v1
v_smfmac_f32_16x16x64_bf16 v[72:75],v[20:23],a[112:119],v1
s_cbranch_vccnz fl_100862
seg_100846:
v_smfmac_f32_16x16x64_bf16 v[76:79],v[20:23],a[120:127],v1
segb_100854:
v_smfmac_f32_16x16x64_bf16 v[48:51],v[24:27],a[128:135],v1
buffer_load_dword v125,off,s[20:23],s92 sc1
v_smfmac_f32_16x16x64_bf16 v[52:55],v[24:27],a[136:143],v1
buffer_load_dwordx4 v[40:43],v0,s[20:23],s93 offen offset:2048 sc1
v_smfmac_f32_16x16x64_bf16 v[56:59],v[24:27],a[144:151],v1
buffer_load_dwordx4 v[44:47],v0,s[20:23],s93 offen offset:3072 sc1
s_waitcnt vmcnt(7)
v_max3_u32 v124,v28,v29,v30
v_smfmac_f32_16x16x64_bf16 v[60:63],v[24:27],a[152:159],v1
v_max_u32 v124,v124,v31
v_smfmac_f32_16x16x64_bf16 v[64:67],v[24:27],a[160:167],v1
v_cmp_eq_u32 vcc,-1,v124
v_smfmac_f32_16x16x64_bf16 v[68:71],v[24:27],a[168:175],v1
v_smfmac_f32_16x16x64_bf16 v[72:75],v[24:27],a[176:183],v1
s_cbranch_vccnz fl_100863
seg_100847:
v_smfmac_f32_16x16x64_bf16 v[76:79],v[24:27],a[184:191],v1
segb_100855:
v_smfmac_f32_16x16x64_bf16 v[48:51],v[28:31],a[192:199],v1
buffer_load_dword v125,off,s[20:23],s92 sc1
v_smfmac_f32_16x16x64_bf16 v[52:55],v[28:31],a[200:207],v1
buffer_store_dword v126,v121,s[20:23],s69 offen sc1
v_smfmac_f32_16x16x64_bf16 v[56:59],v[28:31],a[208:215],v1
s_waitcnt vmcnt(7)
v_max3_u32 v124,v32,v33,v34
v_smfmac_f32_16x16x64_bf16 v[60:63],v[28:31],a[216:223],v1
v_max_u32 v124,v124,v35
v_smfmac_f32_16x16x64_bf16 v[64:67],v[28:31],a[224:231],v1
v_cmp_eq_u32 vcc,-1,v124
v_smfmac_f32_16x16x64_bf16 v[68:71],v[28:31],a[232:239],v1
v_smfmac_f32_16x16x64_bf16 v[72:75],v[28:31],a[240:247],v1
s_cbranch_vccnz fl_100864
seg_100848:
v_smfmac_f32_16x16x64_bf16 v[76:79],v[28:31],a[248:255],v1
segb_100856:
v_smfmac_f32_16x16x64_bf16 v[48:51],v[32:35],a[0:7],v1
buffer_load_dword v125,off,s[20:23],s92 sc1
v_smfmac_f32_16x16x64_bf16 v[52:55],v[32:35],a[8:15],v1
v_smfmac_f32_16x16x64_bf16 v[56:59],v[32:35],a[16:23],v1
s_waitcnt vmcnt(6)
v_max3_u32 v124,v36,v37,v38
v_smfmac_f32_16x16x64_bf16 v[60:63],v[32:35],a[24:31],v1
v_max_u32 v124,v124,v39
v_smfmac_f32_16x16x64_bf16 v[64:67],v[32:35],a[32:39],v1
v_cmp_eq_u32 vcc,-1,v124
v_smfmac_f32_16x16x64_bf16 v[68:71],v[32:35],a[40:47],v1
v_smfmac_f32_16x16x64_bf16 v[72:75],v[32:35],a[48:55],v1
s_cbranch_vccnz fl_100865
seg_100849:
v_smfmac_f32_16x16x64_bf16 v[76:79],v[32:35],a[56:63],v1
segb_100857:
v_smfmac_f32_16x16x64_bf16 v[48:51],v[36:39],a[64:71],v1
buffer_load_dword v125,off,s[20:23],s92 sc1
s_waitcnt vmcnt(4)
v_max3_u32 v124,v40,v41,v42
v_smfmac_f32_16x16x64_bf16 v[52:55],v[36:39],a[72:79],v1
v_max3_u32 v124,v124,v43,v44
v_smfmac_f32_16x16x64_bf16 v[56:59],v[36:39],a[80:87],v1
v_max3_u32 v124,v124,v45,v46
v_smfmac_f32_16x16x64_bf16 v[60:63],v[36:39],a[88:95],v1
v_max_u32 v124,v124,v47
v_smfmac_f32_16x16x64_bf16 v[64:67],v[36:39],a[96:103],v1
v_cmp_eq_u32 vcc,-1,v124
v_smfmac_f32_16x16x64_bf16 v[68:71],v[36:39],a[104:111],v1
v_smfmac_f32_16x16x64_bf16 v[72:75],v[36:39],a[112:119],v1
s_cbranch_vccnz fl_100866
seg_100850:
v_smfmac_f32_16x16x64_bf16 v[76:79],v[36:39],a[120:127],v1
segb_100858:
v_smfmac_f32_16x16x64_bf16 v[48:51],v[40:43],a[128:135],v1
s_cmp_lg_u32 s61,0
s_cbranch_scc1 pq_100840
pk_100841:
buffer_load_dwordx4 v[104:107],v0,s[20:23],s99 offen
v_smfmac_f32_16x16x64_bf16 v[52:55],v[40:43],a[136:143],v1
buffer_load_dwordx4 v[108:111],v0,s[20:23],s99 offen offset:1024
s_add_u32 s64,s79,2
v_smfmac_f32_16x16x64_bf16 v[48:51],v[44:47],a[192:199],v1
s_and_b32 s64,s64,3
s_lshl_b32 s100,s64,19
v_smfmac_f32_16x16x64_bf16 v[52:55],v[44:47],a[200:207],v1
s_mov_b32 s61,s63
s_nop 1
v_add_f32 v48,v48,v49
v_smfmac_f32_16x16x64_bf16 v[56:59],v[40:43],a[144:151],v1
ds_write_addtid_b32 v48 offset:0
v_add_f32 v50,v50,v51
v_smfmac_f32_16x16x64_bf16 v[60:63],v[40:43],a[152:159],v1
ds_write_addtid_b32 v50 offset:1040
v_add_f32 v52,v52,v53
v_smfmac_f32_16x16x64_bf16 v[56:59],v[44:47],a[208:215],v1
ds_write_addtid_b32 v52 offset:2080
v_add_f32 v54,v54,v55
v_smfmac_f32_16x16x64_bf16 v[60:63],v[44:47],a[216:223],v1
ds_write_addtid_b32 v54 offset:3120
s_nop 1
v_add_f32 v56,v56,v57
v_smfmac_f32_16x16x64_bf16 v[64:67],v[40:43],a[160:167],v1
ds_write_addtid_b32 v56 offset:4160
v_add_f32 v58,v58,v59
v_smfmac_f32_16x16x64_bf16 v[68:71],v[40:43],a[168:175],v1
ds_write_addtid_b32 v58 offset:5200
v_add_f32 v60,v60,v61
v_smfmac_f32_16x16x64_bf16 v[64:67],v[44:47],a[224:231],v1
ds_write_addtid_b32 v60 offset:6240
v_add_f32 v62,v62,v63
v_smfmac_f32_16x16x64_bf16 v[68:71],v[44:47],a[232:239],v1
ds_write_addtid_b32 v62 offset:7280
s_nop 1
v_add_f32 v64,v64,v65
v_smfmac_f32_16x16x64_bf16 v[72:75],v[40:43],a[176:183],v1
ds_write_addtid_b32 v64 offset:8448
v_add_f32 v66,v66,v67
v_smfmac_f32_16x16x64_bf16 v[76:79],v[40:43],a[184:191],v1
ds_write_addtid_b32 v66 offset:9488
v_add_f32 v68,v68,v69
v_smfmac_f32_16x16x64_bf16 v[72:75],v[44:47],a[240:247],v1
ds_write_addtid_b32 v68 offset:10528
v_add_f32 v70,v70,v71
v_smfmac_f32_16x16x64_bf16 v[76:79],v[44:47],a[248:255],v1
ds_write_addtid_b32 v70 offset:11568
s_nop 1
v_add_f32 v72,v72,v73
v_smfmac_f32_16x16x64_bf16 v[80:83],v[16:19],v[208:215],v1
ds_write_addtid_b32 v72 offset:12608
v_add_f32 v74,v74,v75
v_smfmac_f32_16x16x64_bf16 v[80:83],v[32:35],v[208:215],v1
ds_write_addtid_b32 v74 offset:13648
v_add_f32 v76,v76,v77
ds_write_addtid_b32 v76 offset:14688
v_add_f32 v78,v78,v79
ds_write_addtid_b32 v78 offset:15728
doneA_100877:
s_waitcnt lgkmcnt(0)
s_barrier
s_cmp_gt_u32 s50,1
s_cbranch_scc1 w23_100878
v_smfmac_f32_16x16x64_bf16 v[84:87],v[16:19],v[216:223],v1
v_smfmac_f32_16x16x64_bf16 v[84:87],v[32:35],v[216:223],v1
v_smfmac_f32_16x16x64_bf16 v[88:91],v[16:19],v[224:231],v1
v_smfmac_f32_16x16x64_bf16 v[88:91],v[32:35],v[224:231],v1
v_smfmac_f32_16x16x64_bf16 v[92:95],v[16:19],v[232:239],v1
ds_read_b128 v[48:51],v7 offset:0
ds_read_b128 v[52:55],v7 offset:1024
v_smfmac_f32_16x16x64_bf16 v[92:95],v[32:35],v[232:239],v1
ds_read_b128 v[56:59],v7 offset:2048
ds_read_b128 v[60:63],v7 offset:3072
v_smfmac_f32_16x16x64_bf16 v[80:83],v[20:23],v[240:247],v1
ds_read_b128 v[64:67],v7 offset:4096
ds_read_b128 v[68:71],v7 offset:5120
v_smfmac_f32_16x16x64_bf16 v[80:83],v[36:39],v[240:247],v1
ds_read_b128 v[72:75],v7 offset:6144
ds_read_b128 v[76:79],v7 offset:7168
v_smfmac_f32_16x16x64_bf16 v[84:87],v[20:23],v[248:255],v1
v_smfmac_f32_16x16x64_bf16 v[84:87],v[36:39],v[248:255],v1
s_waitcnt lgkmcnt(6)
v_smfmac_f32_16x16x64_bf16 v[88:91],v[20:23],v[48:55],v1
v_smfmac_f32_16x16x64_bf16 v[88:91],v[36:39],v[48:55],v1
ds_read_b128 v[48:51],v7 offset:8192
ds_read_b128 v[52:55],v7 offset:9216
s_waitcnt lgkmcnt(6)
v_smfmac_f32_16x16x64_bf16 v[92:95],v[20:23],v[56:63],v1
v_smfmac_f32_16x16x64_bf16 v[92:95],v[36:39],v[56:63],v1
ds_read_b128 v[56:59],v7 offset:10240
ds_read_b128 v[60:63],v7 offset:11264
s_waitcnt lgkmcnt(6)
v_smfmac_f32_16x16x64_bf16 v[80:83],v[24:27],v[64:71],v1
v_smfmac_f32_16x16x64_bf16 v[80:83],v[40:43],v[64:71],v1
ds_read_b128 v[64:67],v7 offset:12288
ds_read_b128 v[68:71],v7 offset:13312
s_waitcnt lgkmcnt(6)
v_smfmac_f32_16x16x64_bf16 v[84:87],v[24:27],v[72:79],v1
v_smfmac_f32_16x16x64_bf16 v[84:87],v[40:43],v[72:79],v1
ds_read_b128 v[72:75],v7 offset:14336
ds_read_b128 v[76:79],v7 offset:15360
s_waitcnt lgkmcnt(6)
v_smfmac_f32_16x16x64_bf16 v[88:91],v[24:27],v[48:55],v1
v_smfmac_f32_16x16x64_bf16 v[88:91],v[40:43],v[48:55],v1
ds_read_b128 v[48:51],v7 offset:16384
ds_read_b128 v[52:55],v7 offset:17408
s_waitcnt lgkmcnt(6)
v_smfmac_f32_16x16x64_bf16 v[92:95],v[24:27],v[56:63],v1
v_smfmac_f32_16x16x64_bf16 v[92:95],v[40:43],v[56:63],v1
ds_read_b128 v[56:59],v7 offset:18432
ds_read_b128 v[60:63],v7 offset:19456
s_waitcnt lgkmcnt(6)
v_smfmac_f32_16x16x64_bf16 v[80:83],v[28:31],v[64:71],v1
v_smfmac_f32_16x16x64_bf16 v[80:83],v[44:47],v[64:71],v1
s_waitcnt lgkmcnt(4)
v_smfmac_f32_16x16x64_bf16 v[84:87],v[28:31],v[72:79],v1
v_smfmac_f32_16x16x64_bf16 v[84:87],v[44:47],v[72:79],v1
s_waitcnt lgkmcnt(2)
v_smfmac_f32_16x16x64_bf16 v[88:91],v[28:31],v[48:55],v1
v_add_f32 v80,v80,v81
v_smfmac_f32_16x16x64_bf16 v[88:91],v[44:47],v[48:55],v1
v_add_f32 v82,v82,v83
s_waitcnt lgkmcnt(0)
v_smfmac_f32_16x16x64_bf16 v[92:95],v[28:31],v[56:63],v1
v_cvt_pk_bf16_f32 v80,v80,v82
v_smfmac_f32_16x16x64_bf16 v[92:95],v[44:47],v[56:63],v1
buffer_load_dwordx4 v[16:19],v2,s[20:23],s94 offen offset:0 sc1
ds_write_addtid_b32 v80 offset:16896
v_add_f32 v84,v84,v85
buffer_load_dwordx4 v[32:35],v2,s[20:23],s94 offen offset:1536 sc1
buffer_load_dwordx4 v[20:23],v2,s[20:23],s95 offen offset:0 sc1
buffer_load_dwordx4 v[36:39],v2,s[20:23],s95 offen offset:1536 sc1
buffer_load_dword v120,v3,s[20:23],s94 offen offset:0 sc1
buffer_load_dword v121,v3,s[20:23],s94 offen offset:1536 sc1
buffer_load_dword v122,v3,s[20:23],s95 offen offset:0 sc1
buffer_load_dword v123,v3,s[20:23],s95 offen offset:1536 sc1
v_add_f32 v86,v86,v87
v_cvt_pk_bf16_f32 v84,v84,v86
v_add_f32 v88,v88,v89
v_add_f32 v90,v90,v91
v_cvt_pk_bf16_f32 v88,v88,v90
v_add_f32 v92,v92,v93
v_add_f32 v94,v94,v95
v_cvt_pk_bf16_f32 v92,v92,v94
ds_write_addtid_b32 v84 offset:17920
ds_write_addtid_b32 v88 offset:18944
ds_write_addtid_b32 v92 offset:19968
.p2align 5
s_nop 0
s_nop 0
s_nop 0
s_nop 0
s_nop 0
sp_100882:
s_waitcnt vmcnt(6)
v_pk_add_f32 v[16:17],v[16:17],v[32:33]
v_pk_add_f32 v[18:19],v[18:19],v[34:35]
s_waitcnt vmcnt(4)
v_pk_add_f32 v[20:21],v[20:21],v[36:37]
v_pk_add_f32 v[22:23],v[22:23],v[38:39]
v_pk_add_f32 v[16:17],v[16:17],v[20:21]
v_pk_add_f32 v[18:19],v[18:19],v[22:23]
v_max3_f32 v124,v16,v17,v18
v_pk_add_f32 v[20:21],v[16:17],v[18:19]
s_waitcnt vmcnt(0)
v_pk_add_f32 v[120:121],v[120:121],v[122:123]
v_add_f32 v120,v120,v121
v_max3_f32 v124,v124,v19,v120
v_add_f32 v20,v20,v120
v_cmp_u_f32 vcc,v20,v21
v_max_f32_dpp v124,v124,v124 row_ror:8 row_mask:0xf bank_mask:0xf
v_mov_b32 v125,v124
s_cbranch_vccnz srt_100884
sok_100883:
s_nop 0
v_permlane16_swap_b32 v125,v124
v_max_f32 v124,v124,v125
v_mov_b32 v125,v124
s_nop 1
v_permlane32_swap_b32 v125,v124
v_max_f32 v124,v124,v125
v_mul_f32 v124,s80,v124
v_fma_f32 v16,v16,s80,-v124
v_fma_f32 v17,v17,s80,-v124
v_fma_f32 v18,v18,s80,-v124
v_fma_f32 v19,v19,s80,-v124
v_fma_f32 v120,v120,s80,-v124
s_waitcnt lgkmcnt(0)
s_barrier
ds_read2st64_b32 v[112:113],v127 offset0:66 offset1:67
ds_read2st64_b32 v[114:115],v127 offset0:68 offset1:69
ds_read2st64_b32 v[116:117],v127 offset0:70 offset1:71
ds_read2st64_b32 v[118:119],v127 offset0:72 offset1:73
v_exp_f32 v16,v16
v_exp_f32 v17,v17
v_exp_f32 v18,v18
v_exp_f32 v19,v19
v_cvt_pk_bf16_f32 v48,v16,v17
v_cvt_pk_bf16_f32 v49,v18,v19
v_exp_f32 v120,v120
v_mov_b32_dpp v50,v48 row_ror:8 row_mask:0xf bank_mask:0xf
v_mov_b32_dpp v51,v49 row_ror:8 row_mask:0xf bank_mask:0xf
v_mov_b32_dpp v121,v120 row_ror:8 row_mask:0xf bank_mask:0xf
v_cvt_pk_bf16_f32 v52,v120,v121
v_mfma_f32_16x16x32_bf16 v[64:67],v[8:11],v[48:51],0
v_mov_b32 v53,v52
v_mfma_f32_16x16x32_bf16 v[56:59],v[96:99],v[48:51],0
v_mov_b32 v54,v52
v_mov_b32 v55,v52
v_mfma_f32_16x16x32_bf16 v[60:63],v[100:103],v[48:51],0
v_mfma_f32_16x16x32_bf16 v[64:67],v[12:15],v[52:55],v[64:67]
s_waitcnt lgkmcnt(0)
v_mfma_f32_16x16x32_bf16 v[56:59],v[112:115],v[52:55],v[56:59]
v_mfma_f32_16x16x32_bf16 v[60:63],v[116:119],v[52:55],v[60:63]
s_nop 0
v_rcp_f32 v66,v64
s_nop 2
v_pk_mul_f32 v[56:57],v[56:57],v[66:67] op_sel_hi:[1,0]
v_pk_mul_f32 v[58:59],v[58:59],v[66:67] op_sel_hi:[1,0]
s_nop 0
v_pk_mul_f32 v[60:61],v[60:61],v[66:67] op_sel_hi:[1,0]
v_pk_mul_f32 v[62:63],v[62:63],v[66:67] op_sel_hi:[1,0]
v_cvt_pk_bf16_f32 v120,v56,v57
v_cvt_pk_bf16_f32 v121,v58,v59
v_cvt_pk_bf16_f32 v122,v60,v61
v_cvt_pk_bf16_f32 v123,v62,v63
buffer_store_dwordx4 v[120:123],v6,s[20:23],s98 offen sc1
s_barrier
ds_read_b128 v[48:51],v7 offset:20480
ds_read_b128 v[52:55],v7 offset:21504
ds_read_b128 v[56:59],v7 offset:22528
ds_read_b128 v[60:63],v7 offset:23552
ds_read_b128 v[64:67],v7 offset:24576
ds_read_b128 v[68:71],v7 offset:25600
ds_read_b128 v[72:75],v7 offset:26624
ds_read_b128 v[76:79],v7 offset:27648
ds_read_b128 v[80:83],v7 offset:28672
ds_read_b128 v[84:87],v7 offset:29696
ds_read_b128 v[88:91],v7 offset:30720
ds_read_b128 v[92:95],v7 offset:31744
v_mov_b32 v96,0
v_mov_b32 v97,0
v_mov_b32 v98,0
v_mov_b32 v99,0
v_mov_b32 v100,0
v_mov_b32 v101,0
v_mov_b32 v102,0
v_mov_b32 v103,0
s_nop 11
buffer_load_dwordx4 v[16:19],v0,s[20:23],s96 offen offset:0 sc1
v_mov_b32 v120,v5
v_mov_b32 v121,v5
v_mov_b32 v122,v5
v_mov_b32 v123,v5
s_nop 1
v_mfma_f32_16x16x32_bf16 v[112:115],v[120:123],v[112:115],0
buffer_load_dwordx4 v[20:23],v0,s[20:23],s96 offen offset:1024 sc1
v_mfma_f32_16x16x32_bf16 v[116:119],v[120:123],v[116:119],0
s_add_u32 s79,s79,1
s_and_b32 s64,s79,3
s_lshl_b32 s64,s64,19
s_lshl_b32 s65,s79,8
buffer_load_dwordx4 v[24:27],v0,s[20:23],s96 offen offset:2048 sc1
s_and_b32 s65,s65,0x2000
s_lshl_b32 s66,s79,16
s_xor_b32 s88,s73,s65
s_add_u32 s88,s88,s66
s_sub_u32 s88,s88,s54
s_add_u32 s89,s71,s64
s_add_u32 s92,s70,s64
s_xor_b32 s93,s72,s65
buffer_load_dwordx4 v[28:31],v0,s[20:23],s96 offen offset:3072 sc1
s_add_u32 s93,s93,s66
s_add_u32 s94,s76,s64
s_add_u32 s95,s94,4096
s_add_u32 s98,s75,s64
s_add_u32 s60,s74,s64
v_cvt_pk_bf16_f32 v112,v112,v113
v_cvt_pk_bf16_f32 v113,v114,v115
v_cvt_pk_bf16_f32 v114,v116,v117
buffer_load_dwordx4 v[32:35],v0,s[20:23],s97 offen offset:0 sc1
v_cvt_pk_bf16_f32 v115,v118,v119
s_nop 6
buffer_load_dwordx4 v[36:39],v0,s[20:23],s97 offen offset:1024 sc1
s_nop 7
buffer_load_dwordx4 v[40:43],v0,s[20:23],s97 offen offset:2048 sc1
s_nop 7
buffer_load_dwordx4 v[44:47],v0,s[20:23],s97 offen offset:3072 sc1
s_branch ogo_100879
.p2align 5
s_nop 0
s_nop 0
s_nop 0
s_nop 0
w23_100878:
ds_read_b128 v[48:51],v2 offset:0
ds_read_b128 v[52:55],v2 offset:256
ds_read_b128 v[56:59],v2 offset:512
ds_read_b128 v[60:63],v2 offset:768
ds_read_b128 v[64:67],v2 offset:16
ds_read_b128 v[68:71],v2 offset:272
ds_read_b128 v[72:75],v2 offset:528
ds_read_b128 v[76:79],v2 offset:784
s_waitcnt lgkmcnt(6)
v_pk_add_f32 v[48:49],v[48:49],v[52:53]
v_pk_add_f32 v[50:51],v[50:51],v[54:55]
s_waitcnt lgkmcnt(4)
v_pk_add_f32 v[56:57],v[56:57],v[60:61]
v_pk_add_f32 v[58:59],v[58:59],v[62:63]
v_pk_add_f32 v[48:49],v[48:49],v[56:57]
v_pk_add_f32 v[50:51],v[50:51],v[58:59]
v_cvt_pk_bf16_f32 v112,v48,v49
v_cvt_pk_bf16_f32 v113,v50,v51
s_waitcnt lgkmcnt(2)
v_pk_add_f32 v[64:65],v[64:65],v[68:69]
v_pk_add_f32 v[66:67],v[66:67],v[70:71]
s_waitcnt lgkmcnt(0)
v_pk_add_f32 v[72:73],v[72:73],v[76:77]
v_pk_add_f32 v[74:75],v[74:75],v[78:79]
v_pk_add_f32 v[64:65],v[64:65],v[72:73]
v_pk_add_f32 v[66:67],v[66:67],v[74:75]
v_cvt_pk_bf16_f32 v114,v64,v65
v_cvt_pk_bf16_f32 v115,v66,v67
s_nop 1
v_mfma_f32_16x16x32_bf16 v[116:119],v[96:99],v[112:115],0
v_mfma_f32_16x16x32_bf16 v[120:123],v[100:103],v[112:115],0
v_mfma_f32_16x16x32_bf16 v[12:15],v[112:115],v[112:115],0
ds_read_b128 v[48:51],v7 offset:0
ds_read_b128 v[52:55],v7 offset:1024
ds_read_b128 v[56:59],v7 offset:2048
ds_read_b128 v[60:63],v7 offset:3072
ds_read_b128 v[64:67],v7 offset:4096
buffer_store_dwordx4 v[116:119],v3,s[20:23],s94 offen sc1
buffer_store_dwordx4 v[120:123],v3,s[20:23],s94 offen offset:512 sc1
s_nop 0
buffer_store_dwordx4 v[12:15],v3,s[20:23],s94 offen offset:1024 sc1
ds_read_b128 v[68:71],v7 offset:5120
ds_read_b128 v[72:75],v7 offset:6144
ds_read_b128 v[76:79],v7 offset:7168
v_smfmac_f32_16x16x64_bf16 v[84:87],v[16:19],v[216:223],v1
v_smfmac_f32_16x16x64_bf16 v[84:87],v[32:35],v[216:223],v1
v_smfmac_f32_16x16x64_bf16 v[88:91],v[16:19],v[224:231],v1
v_smfmac_f32_16x16x64_bf16 v[88:91],v[32:35],v[224:231],v1
v_smfmac_f32_16x16x64_bf16 v[92:95],v[16:19],v[232:239],v1
v_smfmac_f32_16x16x64_bf16 v[92:95],v[32:35],v[232:239],v1
v_smfmac_f32_16x16x64_bf16 v[80:83],v[20:23],v[240:247],v1
v_smfmac_f32_16x16x64_bf16 v[80:83],v[36:39],v[240:247],v1
v_smfmac_f32_16x16x64_bf16 v[84:87],v[20:23],v[248:255],v1
v_smfmac_f32_16x16x64_bf16 v[84:87],v[36:39],v[248:255],v1
s_waitcnt lgkmcnt(6)
v_smfmac_f32_16x16x64_bf16 v[88:91],v[20:23],v[48:55],v1
v_smfmac_f32_16x16x64_bf16 v[88:91],v[36:39],v[48:55],v1
ds_read_b128 v[48:51],v7 offset:8192
ds_read_b128 v[52:55],v7 offset:9216
s_waitcnt lgkmcnt(6)
v_smfmac_f32_16x16x64_bf16 v[92:95],v[20:23],v[56:63],v1
v_smfmac_f32_16x16x64_bf16 v[92:95],v[36:39],v[56:63],v1
ds_read_b128 v[56:59],v7 offset:10240
ds_read_b128 v[60:63],v7 offset:11264
s_waitcnt lgkmcnt(6)
v_smfmac_f32_16x16x64_bf16 v[80:83],v[24:27],v[64:71],v1
v_smfmac_f32_16x16x64_bf16 v[80:83],v[40:43],v[64:71],v1
ds_read_b128 v[64:67],v7 offset:12288
ds_read_b128 v[68:71],v7 offset:13312
s_waitcnt lgkmcnt(6)
v_smfmac_f32_16x16x64_bf16 v[84:87],v[24:27],v[72:79],v1
v_smfmac_f32_16x16x64_bf16 v[84:87],v[40:43],v[72:79],v1
ds_read_b128 v[72:75],v7 offset:14336
ds_read_b128 v[76:79],v7 offset:15360
s_waitcnt lgkmcnt(6)
v_smfmac_f32_16x16x64_bf16 v[88:91],v[24:27],v[48:55],v1
v_smfmac_f32_16x16x64_bf16 v[88:91],v[40:43],v[48:55],v1
ds_read_b128 v[48:51],v7 offset:16384
ds_read_b128 v[52:55],v7 offset:17408
s_waitcnt lgkmcnt(6)
v_smfmac_f32_16x16x64_bf16 v[92:95],v[24:27],v[56:63],v1
v_smfmac_f32_16x16x64_bf16 v[92:95],v[40:43],v[56:63],v1
ds_read_b128 v[56:59],v7 offset:18432
ds_read_b128 v[60:63],v7 offset:19456
s_waitcnt lgkmcnt(6)
v_smfmac_f32_16x16x64_bf16 v[80:83],v[28:31],v[64:71],v1
v_smfmac_f32_16x16x64_bf16 v[80:83],v[44:47],v[64:71],v1
s_waitcnt lgkmcnt(4)
v_smfmac_f32_16x16x64_bf16 v[84:87],v[28:31],v[72:79],v1
v_smfmac_f32_16x16x64_bf16 v[84:87],v[44:47],v[72:79],v1
s_waitcnt lgkmcnt(2)
v_smfmac_f32_16x16x64_bf16 v[88:91],v[28:31],v[48:55],v1
v_add_f32 v80,v80,v81
v_smfmac_f32_16x16x64_bf16 v[88:91],v[44:47],v[48:55],v1
v_add_f32 v82,v82,v83
s_waitcnt lgkmcnt(0)
v_smfmac_f32_16x16x64_bf16 v[92:95],v[28:31],v[56:63],v1
v_cvt_pk_bf16_f32 v80,v80,v82
v_smfmac_f32_16x16x64_bf16 v[92:95],v[44:47],v[56:63],v1
ds_write_addtid_b32 v80 offset:16896
v_add_f32 v84,v84,v85
v_add_f32 v86,v86,v87
v_cvt_pk_bf16_f32 v84,v84,v86
v_add_f32 v88,v88,v89
v_add_f32 v90,v90,v91
v_cvt_pk_bf16_f32 v88,v88,v90
s_nop 0
v_add_f32 v92,v92,v93
v_add_f32 v94,v94,v95
v_cvt_pk_bf16_f32 v92,v92,v94
ds_write_addtid_b32 v84 offset:17920
ds_write_addtid_b32 v88 offset:18944
ds_write_addtid_b32 v92 offset:19968
s_waitcnt lgkmcnt(0)
s_barrier
ds_read_b128 v[48:51],v7 offset:20480
ds_read_b128 v[52:55],v7 offset:21504
ds_read_b128 v[56:59],v7 offset:22528
ds_read_b128 v[60:63],v7 offset:23552
ds_read_b128 v[64:67],v7 offset:24576
ds_read_b128 v[68:71],v7 offset:25600
ds_read_b128 v[72:75],v7 offset:26624
ds_read_b128 v[76:79],v7 offset:27648
ds_read_b128 v[80:83],v7 offset:28672
ds_read_b128 v[84:87],v7 offset:29696
ds_read_b128 v[88:91],v7 offset:30720
ds_read_b128 v[92:95],v7 offset:31744
s_add_u32 s65,s76,s100
s_add_u32 s66,s75,s100
s_add_u32 s64,s71,s100
s_cmp_eq_u32 s50,2
s_cselect_b32 s66,s66,s64
buffer_store_dwordx4 v[8:11],v0,s[20:23],s65 offen sc1
s_cmp_eq_u32 s50,2
s_cselect_b32 exec_hi,-1,0
buffer_store_dwordx4 v[8:11],v0,s[20:23],s66 offen sc1
s_mov_b32 exec_hi,0
buffer_store_dwordx4 v[8:11],v0,s[20:23],s65 offen offset:1024 sc1
s_mov_b64 exec,-1
v_mov_b32 v96,0
v_mov_b32 v97,0
v_mov_b32 v98,0
v_mov_b32 v99,0
v_mov_b32 v100,0
v_mov_b32 v101,0
v_mov_b32 v102,0
v_mov_b32 v103,0
s_barrier
s_nop 15
s_nop 15
s_nop 7
buffer_load_dwordx4 v[16:19],v0,s[20:23],s96 offen offset:0 sc1
s_add_u32 s79,s79,1
s_and_b32 s64,s79,3
s_lshl_b32 s64,s64,19
s_lshl_b32 s65,s79,8
s_and_b32 s65,s65,0x2000
s_lshl_b32 s66,s79,16
s_xor_b32 s88,s73,s65
s_add_u32 s88,s88,s66
buffer_load_dwordx4 v[20:23],v0,s[20:23],s96 offen offset:1024 sc1
s_sub_u32 s88,s88,s54
s_add_u32 s89,s71,s64
s_add_u32 s92,s70,s64
s_xor_b32 s93,s72,s65
s_add_u32 s93,s93,s66
s_add_u32 s94,s76,s64
s_add_u32 s95,s94,4096
s_add_u32 s98,s75,s64
buffer_load_dwordx4 v[24:27],v0,s[20:23],s96 offen offset:2048 sc1
s_add_u32 s60,s74,s64
s_nop 6
buffer_load_dwordx4 v[28:31],v0,s[20:23],s96 offen offset:3072 sc1
s_nop 7
buffer_load_dwordx4 v[32:35],v0,s[20:23],s97 offen offset:0 sc1
s_nop 7
buffer_load_dwordx4 v[36:39],v0,s[20:23],s97 offen offset:1024 sc1
s_nop 7
buffer_load_dwordx4 v[40:43],v0,s[20:23],s97 offen offset:2048 sc1
s_nop 7
buffer_load_dwordx4 v[44:47],v0,s[20:23],s97 offen offset:3072 sc1
.p2align 5
s_nop 0
s_nop 0
s_nop 0
s_nop 0
ogo_100879:
s_waitcnt lgkmcnt(0)
s_waitcnt vmcnt(6)
v_max3_u32 v124,v16,v17,v18
v_max3_u32 v124,v124,v19,v20
v_max3_u32 v124,v124,v21,v22
v_max_u32 v124,v124,v23
v_cmp_eq_u32 vcc,-1,v124
s_cbranch_vccnz of_100885
v_smfmac_f32_16x16x64_bf16 v[96:99],v[16:19],v[48:55],v1
v_smfmac_f32_16x16x64_bf16 v[100:103],v[16:19],v[56:63],v1
v_smfmac_f32_16x16x64_bf16 v[96:99],v[20:23],v[64:71],v1
v_smfmac_f32_16x16x64_bf16 v[100:103],v[20:23],v[72:79],v1
s_waitcnt vmcnt(4)
v_max3_u32 v124,v24,v25,v26
v_max3_u32 v124,v124,v27,v28
v_max3_u32 v124,v124,v29,v30
v_max_u32 v124,v124,v31
v_cmp_eq_u32 vcc,-1,v124
s_cbranch_vccnz of_100886
v_smfmac_f32_16x16x64_bf16 v[96:99],v[24:27],v[80:87],v1
v_smfmac_f32_16x16x64_bf16 v[100:103],v[24:27],v[88:95],v1
v_smfmac_f32_16x16x64_bf16 v[96:99],v[28:31],v[128:135],v1
v_smfmac_f32_16x16x64_bf16 v[100:103],v[28:31],v[136:143],v1
s_waitcnt vmcnt(2)
v_max3_u32 v124,v32,v33,v34
v_max3_u32 v124,v124,v35,v36
v_max3_u32 v124,v124,v37,v38
v_max_u32 v124,v124,v39
v_cmp_eq_u32 vcc,-1,v124
s_cbranch_vccnz of_100887
v_smfmac_f32_16x16x64_bf16 v[96:99],v[32:35],v[144:151],v1
v_smfmac_f32_16x16x64_bf16 v[100:103],v[32:35],v[152:159],v1
v_smfmac_f32_16x16x64_bf16 v[96:99],v[36:39],v[160:167],v1
v_smfmac_f32_16x16x64_bf16 v[100:103],v[36:39],v[168:175],v1
s_waitcnt vmcnt(1)
v_max3_u32 v124,v40,v41,v42
v_max_u32 v124,v124,v43
v_cmp_eq_u32 vcc,-1,v124
s_cbranch_vccnz of_100888
v_smfmac_f32_16x16x64_bf16 v[96:99],v[40:43],v[176:183],v1
v_smfmac_f32_16x16x64_bf16 v[100:103],v[40:43],v[184:191],v1
s_waitcnt vmcnt(0)
v_max3_u32 v124,v44,v45,v46
v_max_u32 v124,v124,v47
v_cmp_eq_u32 vcc,-1,v124
s_cbranch_vccnz of_100889
v_smfmac_f32_16x16x64_bf16 v[96:99],v[44:47],v[192:199],v1
v_smfmac_f32_16x16x64_bf16 v[100:103],v[44:47],v[200:207],v1
oback_100896:
buffer_load_dword v119,off,s[20:23],s68 sc1
s_nop 3
v_add_f32 v96,v96,v97
v_add_f32 v98,v98,v99
s_nop 0
v_add_f32 v100,v100,v101
v_add_f32 v102,v102,v103
ds_write_addtid_b32 v96 offset:20992
ds_write_addtid_b32 v98 offset:23072
ds_write_addtid_b32 v100 offset:22016
ds_write_addtid_b32 v102 offset:24096
s_mov_b32 s96,s60
s_add_u32 s97,s60,4096
s_cmp_gt_u32 s50,1
s_waitcnt lgkmcnt(0)
s_barrier
s_cbranch_scc1 loop_100832
ds_read2st64_b32 v[48:49],v4 offset0:82 offset1:86
ds_read2st64_b32 v[50:51],v4 offset0:83 offset1:87
ds_read2st64_b32 v[52:53],v4 offset0:84 offset1:88
ds_read2st64_b32 v[54:55],v4 offset0:85 offset1:89
v_mov_b32 v96,v104
v_mov_b32 v97,v105
v_mov_b32 v98,v106
v_mov_b32 v99,v107
v_mov_b32 v100,v108
v_mov_b32 v101,v109
v_mov_b32 v102,v110
v_mov_b32 v103,v111
s_waitcnt lgkmcnt(2)
v_pk_add_f32 v[48:49],v[48:49],v[50:51]
s_waitcnt lgkmcnt(0)
v_pk_add_f32 v[52:53],v[52:53],v[54:55]
v_pk_add_f32 v[48:49],v[48:49],v[52:53]
v_cvt_pk_bf16_f32 v124,v48,v49
buffer_store_dword v124,v127,s[20:23],s89 offen sc1
s_nop 7
buffer_store_dword v124,v127,s[20:23],s88 offen sc1
s_branch loop0_100836x
last_100833:
s_waitcnt vmcnt(3)
v_max3_u32 v124,v16,v17,v18
v_max_u32 v124,v124,v19
v_cmp_eq_u32 vcc,-1,v124
v_cndmask_b32 v121,2.0,v127,s[86:87]
s_cbranch_vccnz flb_100921
seg_100897:
segb_100905:
v_smfmac_f32_16x16x64_bf16 v[64:67],v[16:19],a[32:39],v1
buffer_load_dword v125,off,s[20:23],s92 sc1
buffer_load_dwordx4 v[32:35],v0,s[20:23],s93 offen offset:0 sc1
s_waitcnt vmcnt(4)
v_max3_u32 v124,v20,v21,v22
v_smfmac_f32_16x16x64_bf16 v[68:71],v[16:19],a[40:47],v1
v_max_u32 v124,v124,v23
v_cmp_eq_u32 vcc,-1,v124
v_smfmac_f32_16x16x64_bf16 v[72:75],v[16:19],a[48:55],v1
v_smfmac_f32_16x16x64_bf16 v[76:79],v[16:19],a[56:63],v1
s_cbranch_vccnz fl_100914
seg_100898:
segb_100906:
v_smfmac_f32_16x16x64_bf16 v[64:67],v[20:23],a[96:103],v1
buffer_load_dword v125,off,s[20:23],s92 sc1
buffer_load_dwordx4 v[36:39],v0,s[20:23],s93 offen offset:1024 sc1
s_waitcnt vmcnt(5)
v_max3_u32 v124,v24,v25,v26
v_smfmac_f32_16x16x64_bf16 v[68:71],v[20:23],a[104:111],v1
v_max_u32 v124,v124,v27
v_cmp_eq_u32 vcc,-1,v124
v_smfmac_f32_16x16x64_bf16 v[72:75],v[20:23],a[112:119],v1
v_smfmac_f32_16x16x64_bf16 v[76:79],v[20:23],a[120:127],v1
s_cbranch_vccnz fl_100915
seg_100899:
segb_100907:
v_smfmac_f32_16x16x64_bf16 v[64:67],v[24:27],a[160:167],v1
buffer_load_dword v125,off,s[20:23],s92 sc1
buffer_load_dwordx4 v[40:43],v0,s[20:23],s93 offen offset:2048 sc1
buffer_load_dwordx4 v[44:47],v0,s[20:23],s93 offen offset:3072 sc1
s_waitcnt vmcnt(7)
v_max3_u32 v124,v28,v29,v30
v_smfmac_f32_16x16x64_bf16 v[68:71],v[24:27],a[168:175],v1
v_max_u32 v124,v124,v31
v_cmp_eq_u32 vcc,-1,v124
v_smfmac_f32_16x16x64_bf16 v[72:75],v[24:27],a[176:183],v1
v_smfmac_f32_16x16x64_bf16 v[76:79],v[24:27],a[184:191],v1
s_cbranch_vccnz fl_100916
seg_100900:
segb_100908:
v_smfmac_f32_16x16x64_bf16 v[64:67],v[28:31],a[224:231],v1
buffer_load_dword v125,off,s[20:23],s92 sc1
buffer_store_dword v126,v121,s[20:23],s69 offen sc1
s_waitcnt vmcnt(7)
v_max3_u32 v124,v32,v33,v34
v_smfmac_f32_16x16x64_bf16 v[68:71],v[28:31],a[232:239],v1
v_max_u32 v124,v124,v35
v_cmp_eq_u32 vcc,-1,v124
v_smfmac_f32_16x16x64_bf16 v[72:75],v[28:31],a[240:247],v1
v_smfmac_f32_16x16x64_bf16 v[76:79],v[28:31],a[248:255],v1
s_cbranch_vccnz fl_100917
seg_100901:
segb_100909:
v_smfmac_f32_16x16x64_bf16 v[64:67],v[32:35],a[32:39],v1
buffer_load_dword v125,off,s[20:23],s92 sc1
s_waitcnt vmcnt(6)
v_max3_u32 v124,v36,v37,v38
v_smfmac_f32_16x16x64_bf16 v[68:71],v[32:35],a[40:47],v1
v_max_u32 v124,v124,v39
v_cmp_eq_u32 vcc,-1,v124
v_smfmac_f32_16x16x64_bf16 v[72:75],v[32:35],a[48:55],v1
v_smfmac_f32_16x16x64_bf16 v[76:79],v[32:35],a[56:63],v1
s_cbranch_vccnz fl_100918
seg_100902:
segb_100910:
v_smfmac_f32_16x16x64_bf16 v[64:67],v[36:39],a[96:103],v1
buffer_load_dword v125,off,s[20:23],s92 sc1
s_waitcnt vmcnt(4)
v_max3_u32 v124,v40,v41,v42
v_smfmac_f32_16x16x64_bf16 v[68:71],v[36:39],a[104:111],v1
v_max3_u32 v124,v124,v43,v44
v_max3_u32 v124,v124,v45,v46
v_max_u32 v124,v124,v47
v_cmp_eq_u32 vcc,-1,v124
v_smfmac_f32_16x16x64_bf16 v[72:75],v[36:39],a[112:119],v1
v_smfmac_f32_16x16x64_bf16 v[76:79],v[36:39],a[120:127],v1
s_cbranch_vccnz fl_100919
seg_100903:
segb_100911:
v_smfmac_f32_16x16x64_bf16 v[64:67],v[40:43],a[160:167],v1
v_smfmac_f32_16x16x64_bf16 v[68:71],v[40:43],a[168:175],v1
v_smfmac_f32_16x16x64_bf16 v[64:67],v[44:47],a[224:231],v1
v_smfmac_f32_16x16x64_bf16 v[68:71],v[44:47],a[232:239],v1
v_smfmac_f32_16x16x64_bf16 v[72:75],v[40:43],a[176:183],v1
s_nop 1
v_add_f32 v64,v64,v65
v_smfmac_f32_16x16x64_bf16 v[76:79],v[40:43],a[184:191],v1
ds_write_addtid_b32 v64 offset:8448
v_add_f32 v66,v66,v67
v_smfmac_f32_16x16x64_bf16 v[72:75],v[44:47],a[240:247],v1
ds_write_addtid_b32 v66 offset:9488
v_add_f32 v68,v68,v69
v_smfmac_f32_16x16x64_bf16 v[76:79],v[44:47],a[248:255],v1
ds_write_addtid_b32 v68 offset:10528
v_add_f32 v70,v70,v71
v_smfmac_f32_16x16x64_bf16 v[80:83],v[16:19],v[208:215],v1
ds_write_addtid_b32 v70 offset:11568
v_add_f32 v72,v72,v73
v_smfmac_f32_16x16x64_bf16 v[80:83],v[32:35],v[208:215],v1
ds_write_addtid_b32 v72 offset:12608
v_add_f32 v74,v74,v75
v_smfmac_f32_16x16x64_bf16 v[84:87],v[16:19],v[216:223],v1
ds_write_addtid_b32 v74 offset:13648
v_add_f32 v76,v76,v77
v_smfmac_f32_16x16x64_bf16 v[84:87],v[32:35],v[216:223],v1
ds_write_addtid_b32 v76 offset:14688
v_add_f32 v78,v78,v79
v_smfmac_f32_16x16x64_bf16 v[88:91],v[16:19],v[224:231],v1
ds_write_addtid_b32 v78 offset:15728
v_smfmac_f32_16x16x64_bf16 v[88:91],v[32:35],v[224:231],v1
v_smfmac_f32_16x16x64_bf16 v[92:95],v[16:19],v[232:239],v1
v_smfmac_f32_16x16x64_bf16 v[92:95],v[32:35],v[232:239],v1
doneA_100930:
s_waitcnt vmcnt(0) lgkmcnt(0)
s_add_u32 s64,s79,0
s_lshl_b32 s65,s64,12
s_and_b32 s65,s65,0x2000
s_xor_b32 s65,s65,s67
s_lshl_b32 s64,s64,20
s_add_u32 s65,s65,s64
s_add_u32 s101,s65,s78
v_smfmac_f32_16x16x64_bf16 v[80:83],v[20:23],v[240:247],v1
ds_read_b128 v[48:51],v7 offset:0
ds_read_b128 v[52:55],v7 offset:1024
v_smfmac_f32_16x16x64_bf16 v[80:83],v[36:39],v[240:247],v1
ds_read_b128 v[56:59],v7 offset:2048
ds_read_b128 v[60:63],v7 offset:3072
v_smfmac_f32_16x16x64_bf16 v[84:87],v[20:23],v[248:255],v1
ds_read_b128 v[64:67],v7 offset:4096
ds_read_b128 v[68:71],v7 offset:5120
v_smfmac_f32_16x16x64_bf16 v[84:87],v[36:39],v[248:255],v1
ds_read_b128 v[72:75],v7 offset:6144
ds_read_b128 v[76:79],v7 offset:7168
s_waitcnt lgkmcnt(6)
v_smfmac_f32_16x16x64_bf16 v[88:91],v[20:23],v[48:55],v1
v_smfmac_f32_16x16x64_bf16 v[88:91],v[36:39],v[48:55],v1
ds_read_b128 v[48:51],v7 offset:8192
ds_read_b128 v[52:55],v7 offset:9216
s_waitcnt lgkmcnt(6)
v_smfmac_f32_16x16x64_bf16 v[92:95],v[20:23],v[56:63],v1
v_smfmac_f32_16x16x64_bf16 v[92:95],v[36:39],v[56:63],v1
ds_read_b128 v[56:59],v7 offset:10240
ds_read_b128 v[60:63],v7 offset:11264
s_waitcnt lgkmcnt(6)
v_smfmac_f32_16x16x64_bf16 v[80:83],v[24:27],v[64:71],v1
v_smfmac_f32_16x16x64_bf16 v[80:83],v[40:43],v[64:71],v1
ds_read_b128 v[64:67],v7 offset:12288
ds_read_b128 v[68:71],v7 offset:13312
s_waitcnt lgkmcnt(6)
v_smfmac_f32_16x16x64_bf16 v[84:87],v[24:27],v[72:79],v1
v_smfmac_f32_16x16x64_bf16 v[84:87],v[40:43],v[72:79],v1
ds_read_b128 v[72:75],v7 offset:14336
ds_read_b128 v[76:79],v7 offset:15360
s_waitcnt lgkmcnt(6)
v_smfmac_f32_16x16x64_bf16 v[88:91],v[24:27],v[48:55],v1
v_smfmac_f32_16x16x64_bf16 v[88:91],v[40:43],v[48:55],v1
ds_read_b128 v[48:51],v7 offset:16384
ds_read_b128 v[52:55],v7 offset:17408
s_waitcnt lgkmcnt(6)
v_smfmac_f32_16x16x64_bf16 v[92:95],v[24:27],v[56:63],v1
v_smfmac_f32_16x16x64_bf16 v[92:95],v[40:43],v[56:63],v1
ds_read_b128 v[56:59],v7 offset:18432
ds_read_b128 v[60:63],v7 offset:19456
s_waitcnt lgkmcnt(6)
v_smfmac_f32_16x16x64_bf16 v[80:83],v[28:31],v[64:71],v1
v_smfmac_f32_16x16x64_bf16 v[80:83],v[44:47],v[64:71],v1
s_waitcnt lgkmcnt(4)
v_smfmac_f32_16x16x64_bf16 v[84:87],v[28:31],v[72:79],v1
v_smfmac_f32_16x16x64_bf16 v[84:87],v[44:47],v[72:79],v1
s_waitcnt lgkmcnt(2)
v_smfmac_f32_16x16x64_bf16 v[88:91],v[28:31],v[48:55],v1
v_add_f32 v80,v80,v81
v_smfmac_f32_16x16x64_bf16 v[88:91],v[44:47],v[48:55],v1
v_add_f32 v82,v82,v83
s_waitcnt lgkmcnt(0)
v_smfmac_f32_16x16x64_bf16 v[92:95],v[28:31],v[56:63],v1
v_cvt_pk_bf16_f32 v80,v80,v82
v_smfmac_f32_16x16x64_bf16 v[92:95],v[44:47],v[56:63],v1
ds_write_addtid_b32 v80 offset:16896
v_add_f32 v84,v84,v85
v_add_f32 v86,v86,v87
v_cvt_pk_bf16_f32 v84,v84,v86
v_add_f32 v88,v88,v89
v_add_f32 v90,v90,v91
v_cvt_pk_bf16_f32 v88,v88,v90
s_nop 0
v_add_f32 v92,v92,v93
v_add_f32 v94,v94,v95
v_cvt_pk_bf16_f32 v92,v92,v94
ds_write_addtid_b32 v84 offset:17920
ds_write_addtid_b32 v88 offset:18944
ds_write_addtid_b32 v92 offset:19968
s_waitcnt lgkmcnt(0)
s_barrier
s_cmp_gt_u32 s50,1
s_cbranch_scc1 l23_100931
ds_read2st64_b32 v[112:113],v127 offset0:66 offset1:67
ds_read2st64_b32 v[114:115],v127 offset0:68 offset1:69
ds_read2st64_b32 v[116:117],v127 offset0:70 offset1:71
ds_read2st64_b32 v[118:119],v127 offset0:72 offset1:73
s_waitcnt lgkmcnt(0)
v_mov_b32 v120,v5
v_mov_b32 v121,v5
v_mov_b32 v122,v5
v_mov_b32 v123,v5
s_nop 1
v_mfma_f32_16x16x32_bf16 v[112:115],v[120:123],v[112:115],0
v_mfma_f32_16x16x32_bf16 v[116:119],v[120:123],v[116:119],0
s_nop 4
v_cvt_pk_bf16_f32 v112,v112,v113
v_cvt_pk_bf16_f32 v113,v114,v115
s_nop 0
v_cvt_pk_bf16_f32 v114,v116,v117
v_cvt_pk_bf16_f32 v115,v118,v119
s_branch lj_100932
l23_100931:
ds_read_b128 v[48:51],v2 offset:0
ds_read_b128 v[52:55],v2 offset:256
ds_read_b128 v[56:59],v2 offset:512
ds_read_b128 v[60:63],v2 offset:768
ds_read_b128 v[64:67],v2 offset:16
ds_read_b128 v[68:71],v2 offset:272
ds_read_b128 v[72:75],v2 offset:528
ds_read_b128 v[76:79],v2 offset:784
s_waitcnt lgkmcnt(6)
v_pk_add_f32 v[48:49],v[48:49],v[52:53]
v_pk_add_f32 v[50:51],v[50:51],v[54:55]
s_waitcnt lgkmcnt(4)
v_pk_add_f32 v[56:57],v[56:57],v[60:61]
v_pk_add_f32 v[58:59],v[58:59],v[62:63]
v_pk_add_f32 v[48:49],v[48:49],v[56:57]
v_pk_add_f32 v[50:51],v[50:51],v[58:59]
v_cvt_pk_bf16_f32 v112,v48,v49
v_cvt_pk_bf16_f32 v113,v50,v51
s_waitcnt lgkmcnt(2)
v_pk_add_f32 v[64:65],v[64:65],v[68:69]
v_pk_add_f32 v[66:67],v[66:67],v[70:71]
s_waitcnt lgkmcnt(0)
v_pk_add_f32 v[72:73],v[72:73],v[76:77]
v_pk_add_f32 v[74:75],v[74:75],v[78:79]
v_pk_add_f32 v[64:65],v[64:65],v[72:73]
v_pk_add_f32 v[66:67],v[66:67],v[74:75]
v_cvt_pk_bf16_f32 v114,v64,v65
v_cvt_pk_bf16_f32 v115,v66,v67
lj_100932:
v_cndmask_b32 v120,2.0,v0,s[82:83]
v_cndmask_b32 v121,2.0,v127,s[86:87]
buffer_store_dwordx4 v[112:115],v120,s[20:23],s101 offen sc1
s_waitcnt vmcnt(0)
s_barrier
v_mov_b32 v126,64
buffer_store_dword v126,v121,s[20:23],s69 offen sc1
s_branch recfin_100430
pe_100838:
s_waitcnt vmcnt(5)
v_readfirstlane_b32 s91,v119
s_cmp_gt_u32 s91,s79
s_cbranch_scc0 pb_100839
s_add_u32 s64,s79,0
s_lshl_b32 s65,s64,12
s_and_b32 s65,s65,0x2000
s_xor_b32 s65,s65,s67
s_lshl_b32 s64,s64,20
s_add_u32 s65,s65,s64
s_add_u32 s62,s65,s77
buffer_load_dwordx4 v[96:99],v0,s[20:23],s62 offen
buffer_load_dwordx4 v[100:103],v0,s[20:23],s62 offen offset:1024
s_mov_b32 s61,0
s_branch pb_100839
pq_100840:
s_cmp_gt_u32 s91,s79
s_cbranch_scc1 pg_100843
pl_100842:
buffer_load_dword v124,off,s[20:23],s68 sc1
s_waitcnt vmcnt(0)
v_readfirstlane_b32 s91,v124
s_cmp_gt_u32 s91,s79
s_cbranch_scc1 pg_100843
s_sleep 2
s_sub_u32 s90,s90,1
s_cmp_gt_i32 s90,0
s_cbranch_scc1 pl_100842
pg_100843:
s_add_u32 s64,s79,0
s_lshl_b32 s65,s64,12
s_and_b32 s65,s65,0x2000
s_xor_b32 s65,s65,s67
s_lshl_b32 s64,s64,20
s_add_u32 s65,s65,s64
s_add_u32 s62,s65,s77
buffer_load_dwordx4 v[96:99],v0,s[20:23],s62 offen
buffer_load_dwordx4 v[100:103],v0,s[20:23],s62 offen offset:1024
s_waitcnt vmcnt(0)
s_branch pk_100841
fl_100860:
flb_100868:
buffer_load_dwordx4 v[16:19],v0,s[20:23],s92 offen offset:0 sc1
s_mov_b32 s55,1
buffer_load_dwordx4 v[32:35],v0,s[20:23],s93 offen offset:0 sc1
s_waitcnt vmcnt(4)
v_max3_u32 v124,v20,v21,v22
v_max_u32 v124,v124,v23
v_cmp_eq_u32 vcc,-1,v124
s_cbranch_vccnz dfl_100933
v_smfmac_f32_16x16x64_bf16 v[48:51],v[20:23],a[64:71],v1
buffer_load_dword v125,off,s[20:23],s92 sc1
v_smfmac_f32_16x16x64_bf16 v[52:55],v[20:23],a[72:79],v1
buffer_load_dwordx4 v[36:39],v0,s[20:23],s93 offen offset:1024 sc1
v_smfmac_f32_16x16x64_bf16 v[56:59],v[20:23],a[80:87],v1
s_waitcnt vmcnt(5)
v_max3_u32 v124,v24,v25,v26
v_smfmac_f32_16x16x64_bf16 v[60:63],v[20:23],a[88:95],v1
v_max_u32 v124,v124,v27
v_smfmac_f32_16x16x64_bf16 v[64:67],v[20:23],a[96:103],v1
v_cmp_eq_u32 vcc,-1,v124
v_smfmac_f32_16x16x64_bf16 v[68:71],v[20:23],a[104:111],v1
v_smfmac_f32_16x16x64_bf16 v[72:75],v[20:23],a[112:119],v1
v_smfmac_f32_16x16x64_bf16 v[76:79],v[20:23],a[120:127],v1
s_cbranch_vccnz dfl_100934
v_smfmac_f32_16x16x64_bf16 v[48:51],v[24:27],a[128:135],v1
buffer_load_dword v125,off,s[20:23],s92 sc1
v_smfmac_f32_16x16x64_bf16 v[52:55],v[24:27],a[136:143],v1
buffer_load_dwordx4 v[40:43],v0,s[20:23],s93 offen offset:2048 sc1
v_smfmac_f32_16x16x64_bf16 v[56:59],v[24:27],a[144:151],v1
buffer_load_dwordx4 v[44:47],v0,s[20:23],s93 offen offset:3072 sc1
s_waitcnt vmcnt(7)
v_max3_u32 v124,v28,v29,v30
v_smfmac_f32_16x16x64_bf16 v[60:63],v[24:27],a[152:159],v1
v_max_u32 v124,v124,v31
v_smfmac_f32_16x16x64_bf16 v[64:67],v[24:27],a[160:167],v1
v_cmp_eq_u32 vcc,-1,v124
v_smfmac_f32_16x16x64_bf16 v[68:71],v[24:27],a[168:175],v1
v_smfmac_f32_16x16x64_bf16 v[72:75],v[24:27],a[176:183],v1
v_smfmac_f32_16x16x64_bf16 v[76:79],v[24:27],a[184:191],v1
s_cbranch_vccnz dfl_100935
v_smfmac_f32_16x16x64_bf16 v[48:51],v[28:31],a[192:199],v1
buffer_load_dword v125,off,s[20:23],s92 sc1
v_smfmac_f32_16x16x64_bf16 v[52:55],v[28:31],a[200:207],v1
buffer_store_dword v126,v121,s[20:23],s69 offen sc1
v_smfmac_f32_16x16x64_bf16 v[56:59],v[28:31],a[208:215],v1
s_waitcnt vmcnt(8)
v_max3_u32 v124,v16,v17,v18
v_smfmac_f32_16x16x64_bf16 v[60:63],v[28:31],a[216:223],v1
v_max_u32 v124,v124,v19
v_smfmac_f32_16x16x64_bf16 v[64:67],v[28:31],a[224:231],v1
v_cmp_eq_u32 vcc,-1,v124
v_smfmac_f32_16x16x64_bf16 v[68:71],v[28:31],a[232:239],v1
v_smfmac_f32_16x16x64_bf16 v[72:75],v[28:31],a[240:247],v1
v_smfmac_f32_16x16x64_bf16 v[76:79],v[28:31],a[248:255],v1
s_cbranch_vccnz lfb_100940
s_mov_b32 s55,0
v_smfmac_f32_16x16x64_bf16 v[48:51],v[16:19],a[0:7],v1
v_smfmac_f32_16x16x64_bf16 v[52:55],v[16:19],a[8:15],v1
v_smfmac_f32_16x16x64_bf16 v[56:59],v[16:19],a[16:23],v1
s_waitcnt vmcnt(7)
v_max3_u32 v124,v32,v33,v34
v_max_u32 v124,v124,v35
v_cmp_eq_u32 vcc,-1,v124
v_smfmac_f32_16x16x64_bf16 v[60:63],v[16:19],a[24:31],v1
v_smfmac_f32_16x16x64_bf16 v[64:67],v[16:19],a[32:39],v1
v_smfmac_f32_16x16x64_bf16 v[68:71],v[16:19],a[40:47],v1
v_smfmac_f32_16x16x64_bf16 v[72:75],v[16:19],a[48:55],v1
v_smfmac_f32_16x16x64_bf16 v[76:79],v[16:19],a[56:63],v1
s_cbranch_vccnz flb_100872
s_branch segb_100856
fl_100861:
v_smfmac_f32_16x16x64_bf16 v[76:79],v[16:19],a[56:63],v1
flb_100869:
buffer_load_dwordx4 v[20:23],v0,s[20:23],s92 offen offset:1024 sc1
s_mov_b32 s55,2
buffer_load_dwordx4 v[36:39],v0,s[20:23],s93 offen offset:1024 sc1
s_waitcnt vmcnt(5)
v_max3_u32 v124,v24,v25,v26
v_max_u32 v124,v124,v27
v_cmp_eq_u32 vcc,-1,v124
s_cbranch_vccnz dfl_100934
v_smfmac_f32_16x16x64_bf16 v[48:51],v[24:27],a[128:135],v1
buffer_load_dword v125,off,s[20:23],s92 sc1
v_smfmac_f32_16x16x64_bf16 v[52:55],v[24:27],a[136:143],v1
buffer_load_dwordx4 v[40:43],v0,s[20:23],s93 offen offset:2048 sc1
v_smfmac_f32_16x16x64_bf16 v[56:59],v[24:27],a[144:151],v1
buffer_load_dwordx4 v[44:47],v0,s[20:23],s93 offen offset:3072 sc1
s_waitcnt vmcnt(7)
v_max3_u32 v124,v28,v29,v30
v_smfmac_f32_16x16x64_bf16 v[60:63],v[24:27],a[152:159],v1
v_max_u32 v124,v124,v31
v_smfmac_f32_16x16x64_bf16 v[64:67],v[24:27],a[160:167],v1
v_cmp_eq_u32 vcc,-1,v124
v_smfmac_f32_16x16x64_bf16 v[68:71],v[24:27],a[168:175],v1
v_smfmac_f32_16x16x64_bf16 v[72:75],v[24:27],a[176:183],v1
v_smfmac_f32_16x16x64_bf16 v[76:79],v[24:27],a[184:191],v1
s_cbranch_vccnz dfl_100935
v_smfmac_f32_16x16x64_bf16 v[48:51],v[28:31],a[192:199],v1
buffer_load_dword v125,off,s[20:23],s92 sc1
v_smfmac_f32_16x16x64_bf16 v[52:55],v[28:31],a[200:207],v1
buffer_store_dword v126,v121,s[20:23],s69 offen sc1
v_smfmac_f32_16x16x64_bf16 v[56:59],v[28:31],a[208:215],v1
s_waitcnt vmcnt(6)
v_max3_u32 v124,v20,v21,v22
v_smfmac_f32_16x16x64_bf16 v[60:63],v[28:31],a[216:223],v1
v_max_u32 v124,v124,v23
v_smfmac_f32_16x16x64_bf16 v[64:67],v[28:31],a[224:231],v1
v_cmp_eq_u32 vcc,-1,v124
v_smfmac_f32_16x16x64_bf16 v[68:71],v[28:31],a[232:239],v1
v_smfmac_f32_16x16x64_bf16 v[72:75],v[28:31],a[240:247],v1
v_smfmac_f32_16x16x64_bf16 v[76:79],v[28:31],a[248:255],v1
s_cbranch_vccnz lfb_100940
s_mov_b32 s55,0
v_smfmac_f32_16x16x64_bf16 v[48:51],v[20:23],a[64:71],v1
v_smfmac_f32_16x16x64_bf16 v[52:55],v[20:23],a[72:79],v1
v_smfmac_f32_16x16x64_bf16 v[56:59],v[20:23],a[80:87],v1
s_waitcnt vmcnt(7)
v_max3_u32 v124,v32,v33,v34
v_max_u32 v124,v124,v35
v_cmp_eq_u32 vcc,-1,v124
v_smfmac_f32_16x16x64_bf16 v[60:63],v[20:23],a[88:95],v1
v_smfmac_f32_16x16x64_bf16 v[64:67],v[20:23],a[96:103],v1
v_smfmac_f32_16x16x64_bf16 v[68:71],v[20:23],a[104:111],v1
v_smfmac_f32_16x16x64_bf16 v[72:75],v[20:23],a[112:119],v1
v_smfmac_f32_16x16x64_bf16 v[76:79],v[20:23],a[120:127],v1
s_cbranch_vccnz flb_100872
s_branch segb_100856
fl_100862:
v_smfmac_f32_16x16x64_bf16 v[76:79],v[20:23],a[120:127],v1
flb_100870:
buffer_load_dwordx4 v[24:27],v0,s[20:23],s92 offen offset:2048 sc1
s_mov_b32 s55,4
buffer_load_dwordx4 v[40:43],v0,s[20:23],s93 offen offset:2048 sc1
buffer_load_dwordx4 v[44:47],v0,s[20:23],s93 offen offset:3072 sc1
s_waitcnt vmcnt(7)
v_max3_u32 v124,v28,v29,v30
v_max_u32 v124,v124,v31
v_cmp_eq_u32 vcc,-1,v124
s_cbranch_vccnz dfl_100935
v_smfmac_f32_16x16x64_bf16 v[48:51],v[28:31],a[192:199],v1
buffer_load_dword v125,off,s[20:23],s92 sc1
v_smfmac_f32_16x16x64_bf16 v[52:55],v[28:31],a[200:207],v1
buffer_store_dword v126,v121,s[20:23],s69 offen sc1
v_smfmac_f32_16x16x64_bf16 v[56:59],v[28:31],a[208:215],v1
s_waitcnt vmcnt(4)
v_max3_u32 v124,v24,v25,v26
v_smfmac_f32_16x16x64_bf16 v[60:63],v[28:31],a[216:223],v1
v_max_u32 v124,v124,v27
v_smfmac_f32_16x16x64_bf16 v[64:67],v[28:31],a[224:231],v1
v_cmp_eq_u32 vcc,-1,v124
v_smfmac_f32_16x16x64_bf16 v[68:71],v[28:31],a[232:239],v1
v_smfmac_f32_16x16x64_bf16 v[72:75],v[28:31],a[240:247],v1
v_smfmac_f32_16x16x64_bf16 v[76:79],v[28:31],a[248:255],v1
s_cbranch_vccnz lfb_100940
s_mov_b32 s55,0
v_smfmac_f32_16x16x64_bf16 v[48:51],v[24:27],a[128:135],v1
v_smfmac_f32_16x16x64_bf16 v[52:55],v[24:27],a[136:143],v1
v_smfmac_f32_16x16x64_bf16 v[56:59],v[24:27],a[144:151],v1
s_waitcnt vmcnt(7)
v_max3_u32 v124,v32,v33,v34
v_max_u32 v124,v124,v35
v_cmp_eq_u32 vcc,-1,v124
v_smfmac_f32_16x16x64_bf16 v[60:63],v[24:27],a[152:159],v1
v_smfmac_f32_16x16x64_bf16 v[64:67],v[24:27],a[160:167],v1
v_smfmac_f32_16x16x64_bf16 v[68:71],v[24:27],a[168:175],v1
v_smfmac_f32_16x16x64_bf16 v[72:75],v[24:27],a[176:183],v1
v_smfmac_f32_16x16x64_bf16 v[76:79],v[24:27],a[184:191],v1
s_cbranch_vccnz flb_100872
s_branch segb_100856
fl_100863:
v_smfmac_f32_16x16x64_bf16 v[76:79],v[24:27],a[184:191],v1
flb_100871:
buffer_load_dwordx4 v[28:31],v0,s[20:23],s92 offen offset:3072 sc1
s_mov_b32 s55,8
buffer_store_dword v126,v121,s[20:23],s69 offen sc1
s_waitcnt vmcnt(1)
v_max3_u32 v124,v28,v29,v30
v_max_u32 v124,v124,v31
v_cmp_eq_u32 vcc,-1,v124
s_cbranch_vccnz lfb_100940
s_mov_b32 s55,0
v_smfmac_f32_16x16x64_bf16 v[48:51],v[28:31],a[192:199],v1
v_smfmac_f32_16x16x64_bf16 v[52:55],v[28:31],a[200:207],v1
v_smfmac_f32_16x16x64_bf16 v[56:59],v[28:31],a[208:215],v1
s_waitcnt vmcnt(7)
v_max3_u32 v124,v32,v33,v34
v_max_u32 v124,v124,v35
v_cmp_eq_u32 vcc,-1,v124
v_smfmac_f32_16x16x64_bf16 v[60:63],v[28:31],a[216:223],v1
v_smfmac_f32_16x16x64_bf16 v[64:67],v[28:31],a[224:231],v1
v_smfmac_f32_16x16x64_bf16 v[68:71],v[28:31],a[232:239],v1
v_smfmac_f32_16x16x64_bf16 v[72:75],v[28:31],a[240:247],v1
v_smfmac_f32_16x16x64_bf16 v[76:79],v[28:31],a[248:255],v1
s_cbranch_vccnz flb_100872
s_branch segb_100856
fl_100864:
v_smfmac_f32_16x16x64_bf16 v[76:79],v[28:31],a[248:255],v1
flb_100872:
buffer_load_dwordx4 v[32:35],v0,s[20:23],s93 offen offset:0 sc1
s_mov_b32 s55,240
s_bitcmp1_b32 s55,5
s_cbranch_scc0 rdn_100943
s_waitcnt vmcnt(6)
v_max3_u32 v124,v36,v37,v38
v_max_u32 v124,v124,v39
v_cmp_eq_u32 vcc,-1,v124
s_cbranch_vccnz rfa_100944
buffer_load_dword v125,off,s[20:23],s92 sc1
s_bitset0_b32 s55,5
v_smfmac_f32_16x16x64_bf16 v[48:51],v[36:39],a[64:71],v1
v_smfmac_f32_16x16x64_bf16 v[52:55],v[36:39],a[72:79],v1
v_smfmac_f32_16x16x64_bf16 v[56:59],v[36:39],a[80:87],v1
v_smfmac_f32_16x16x64_bf16 v[60:63],v[36:39],a[88:95],v1
v_smfmac_f32_16x16x64_bf16 v[64:67],v[36:39],a[96:103],v1
v_smfmac_f32_16x16x64_bf16 v[68:71],v[36:39],a[104:111],v1
v_smfmac_f32_16x16x64_bf16 v[72:75],v[36:39],a[112:119],v1
v_smfmac_f32_16x16x64_bf16 v[76:79],v[36:39],a[120:127],v1
s_cmp_eq_u32 s55,0
s_cbranch_scc1 segb_100858
s_branch rnx_100945
rdn_100943:
buffer_load_dword v125,off,s[20:23],s92 sc1
s_branch rnx_100945
rfa_100944:
buffer_load_dwordx4 v[36:39],v0,s[20:23],s93 offen offset:1024 sc1
rnx_100945:
s_bitcmp1_b32 s55,6
s_cbranch_scc0 rdn_100946
s_waitcnt vmcnt(5)
v_max3_u32 v124,v40,v41,v42
v_max_u32 v124,v124,v43
v_cmp_eq_u32 vcc,-1,v124
s_cbranch_vccnz rfa_100947
buffer_load_dword v125,off,s[20:23],s92 sc1
s_bitset0_b32 s55,6
s_cmp_eq_u32 s55,0
s_cbranch_scc1 segb_100858
s_branch rnx_100948
rdn_100946:
buffer_load_dword v125,off,s[20:23],s92 sc1
s_branch rnx_100948
rfa_100947:
buffer_load_dwordx4 v[40:43],v0,s[20:23],s93 offen offset:2048 sc1
rnx_100948:
s_bitcmp1_b32 s55,7
s_cbranch_scc0 rdn_100949
s_waitcnt vmcnt(5)
v_max3_u32 v124,v44,v45,v46
v_max_u32 v124,v124,v47
v_cmp_eq_u32 vcc,-1,v124
s_cbranch_vccnz rfa_100950
buffer_load_dword v125,off,s[20:23],s92 sc1
s_bitset0_b32 s55,7
s_cmp_eq_u32 s55,0
s_cbranch_scc1 segb_100858
s_branch rnx_100951
rdn_100949:
buffer_load_dword v125,off,s[20:23],s92 sc1
s_branch rnx_100951
rfa_100950:
buffer_load_dwordx4 v[44:47],v0,s[20:23],s93 offen offset:3072 sc1
rnx_100951:
rot_100942:
s_bitcmp1_b32 s55,4
s_cbranch_scc0 rdn_100952
s_waitcnt vmcnt(3)
v_max3_u32 v124,v32,v33,v34
v_max_u32 v124,v124,v35
v_cmp_eq_u32 vcc,-1,v124
s_cbranch_vccnz rfa_100953
buffer_load_dword v125,off,s[20:23],s92 sc1
s_bitset0_b32 s55,4
v_smfmac_f32_16x16x64_bf16 v[48:51],v[32:35],a[0:7],v1
v_smfmac_f32_16x16x64_bf16 v[52:55],v[32:35],a[8:15],v1
v_smfmac_f32_16x16x64_bf16 v[56:59],v[32:35],a[16:23],v1
v_smfmac_f32_16x16x64_bf16 v[60:63],v[32:35],a[24:31],v1
v_smfmac_f32_16x16x64_bf16 v[64:67],v[32:35],a[32:39],v1
v_smfmac_f32_16x16x64_bf16 v[68:71],v[32:35],a[40:47],v1
v_smfmac_f32_16x16x64_bf16 v[72:75],v[32:35],a[48:55],v1
v_smfmac_f32_16x16x64_bf16 v[76:79],v[32:35],a[56:63],v1
s_cmp_eq_u32 s55,0
s_cbranch_scc1 segb_100858
s_branch rnx_100954
rdn_100952:
buffer_load_dword v125,off,s[20:23],s92 sc1
s_branch rnx_100954
rfa_100953:
buffer_load_dwordx4 v[32:35],v0,s[20:23],s93 offen offset:0 sc1
rnx_100954:
s_bitcmp1_b32 s55,5
s_cbranch_scc0 rdn_100955
s_waitcnt vmcnt(3)
v_max3_u32 v124,v36,v37,v38
v_max_u32 v124,v124,v39
v_cmp_eq_u32 vcc,-1,v124
s_cbranch_vccnz rfa_100956
buffer_load_dword v125,off,s[20:23],s92 sc1
s_bitset0_b32 s55,5
v_smfmac_f32_16x16x64_bf16 v[48:51],v[36:39],a[64:71],v1
v_smfmac_f32_16x16x64_bf16 v[52:55],v[36:39],a[72:79],v1
v_smfmac_f32_16x16x64_bf16 v[56:59],v[36:39],a[80:87],v1
v_smfmac_f32_16x16x64_bf16 v[60:63],v[36:39],a[88:95],v1
v_smfmac_f32_16x16x64_bf16 v[64:67],v[36:39],a[96:103],v1
v_smfmac_f32_16x16x64_bf16 v[68:71],v[36:39],a[104:111],v1
v_smfmac_f32_16x16x64_bf16 v[72:75],v[36:39],a[112:119],v1
v_smfmac_f32_16x16x64_bf16 v[76:79],v[36:39],a[120:127],v1
s_cmp_eq_u32 s55,0
s_cbranch_scc1 segb_100858
s_branch rnx_100957
rdn_100955:
buffer_load_dword v125,off,s[20:23],s92 sc1
s_branch rnx_100957
rfa_100956:
buffer_load_dwordx4 v[36:39],v0,s[20:23],s93 offen offset:1024 sc1
rnx_100957:
s_bitcmp1_b32 s55,6
s_cbranch_scc0 rdn_100958
s_waitcnt vmcnt(3)
v_max3_u32 v124,v40,v41,v42
v_max_u32 v124,v124,v43
v_cmp_eq_u32 vcc,-1,v124
s_cbranch_vccnz rfa_100959
buffer_load_dword v125,off,s[20:23],s92 sc1
s_bitset0_b32 s55,6
s_cmp_eq_u32 s55,0
s_cbranch_scc1 segb_100858
s_branch rnx_100960
rdn_100958:
buffer_load_dword v125,off,s[20:23],s92 sc1
s_branch rnx_100960
rfa_100959:
buffer_load_dwordx4 v[40:43],v0,s[20:23],s93 offen offset:2048 sc1
rnx_100960:
s_bitcmp1_b32 s55,7
s_cbranch_scc0 rdn_100961
s_waitcnt vmcnt(3)
v_max3_u32 v124,v44,v45,v46
v_max_u32 v124,v124,v47
v_cmp_eq_u32 vcc,-1,v124
s_cbranch_vccnz rfa_100962
buffer_load_dword v125,off,s[20:23],s92 sc1
s_bitset0_b32 s55,7
s_cmp_eq_u32 s55,0
s_cbranch_scc1 segb_100858
s_branch rnx_100963
rdn_100961:
buffer_load_dword v125,off,s[20:23],s92 sc1
s_branch rnx_100963
rfa_100962:
buffer_load_dwordx4 v[44:47],v0,s[20:23],s93 offen offset:3072 sc1
rnx_100963:
s_sub_u32 s90,s90,1
s_cmp_gt_i32 s90,0
s_cbranch_scc1 rot_100942
s_mov_b32 s55,0
s_branch segb_100858
fl_100865:
v_smfmac_f32_16x16x64_bf16 v[76:79],v[32:35],a[56:63],v1
flb_100873:
buffer_load_dwordx4 v[36:39],v0,s[20:23],s93 offen offset:1024 sc1
s_mov_b32 s55,224
s_bitcmp1_b32 s55,6
s_cbranch_scc0 rdn_100965
s_waitcnt vmcnt(5)
v_max3_u32 v124,v40,v41,v42
v_max_u32 v124,v124,v43
v_cmp_eq_u32 vcc,-1,v124
s_cbranch_vccnz rfa_100966
buffer_load_dword v125,off,s[20:23],s92 sc1
s_bitset0_b32 s55,6
s_cmp_eq_u32 s55,0
s_cbranch_scc1 segb_100858
s_branch rnx_100967
rdn_100965:
buffer_load_dword v125,off,s[20:23],s92 sc1
s_branch rnx_100967
rfa_100966:
buffer_load_dwordx4 v[40:43],v0,s[20:23],s93 offen offset:2048 sc1
rnx_100967:
s_bitcmp1_b32 s55,7
s_cbranch_scc0 rdn_100968
s_waitcnt vmcnt(5)
v_max3_u32 v124,v44,v45,v46
v_max_u32 v124,v124,v47
v_cmp_eq_u32 vcc,-1,v124
s_cbranch_vccnz rfa_100969
buffer_load_dword v125,off,s[20:23],s92 sc1
s_bitset0_b32 s55,7
s_cmp_eq_u32 s55,0
s_cbranch_scc1 segb_100858
s_branch rnx_100970
rdn_100968:
buffer_load_dword v125,off,s[20:23],s92 sc1
s_branch rnx_100970
rfa_100969:
buffer_load_dwordx4 v[44:47],v0,s[20:23],s93 offen offset:3072 sc1
rnx_100970:
rot_100964:
s_bitcmp1_b32 s55,5
s_cbranch_scc0 rdn_100971
s_waitcnt vmcnt(2)
v_max3_u32 v124,v36,v37,v38
v_max_u32 v124,v124,v39
v_cmp_eq_u32 vcc,-1,v124
s_cbranch_vccnz rfa_100972
buffer_load_dword v125,off,s[20:23],s92 sc1
s_bitset0_b32 s55,5
v_smfmac_f32_16x16x64_bf16 v[48:51],v[36:39],a[64:71],v1
v_smfmac_f32_16x16x64_bf16 v[52:55],v[36:39],a[72:79],v1
v_smfmac_f32_16x16x64_bf16 v[56:59],v[36:39],a[80:87],v1
v_smfmac_f32_16x16x64_bf16 v[60:63],v[36:39],a[88:95],v1
v_smfmac_f32_16x16x64_bf16 v[64:67],v[36:39],a[96:103],v1
v_smfmac_f32_16x16x64_bf16 v[68:71],v[36:39],a[104:111],v1
v_smfmac_f32_16x16x64_bf16 v[72:75],v[36:39],a[112:119],v1
v_smfmac_f32_16x16x64_bf16 v[76:79],v[36:39],a[120:127],v1
s_cmp_eq_u32 s55,0
s_cbranch_scc1 segb_100858
s_branch rnx_100973
rdn_100971:
buffer_load_dword v125,off,s[20:23],s92 sc1
s_branch rnx_100973
rfa_100972:
buffer_load_dwordx4 v[36:39],v0,s[20:23],s93 offen offset:1024 sc1
rnx_100973:
s_bitcmp1_b32 s55,6
s_cbranch_scc0 rdn_100974
s_waitcnt vmcnt(2)
v_max3_u32 v124,v40,v41,v42
v_max_u32 v124,v124,v43
v_cmp_eq_u32 vcc,-1,v124
s_cbranch_vccnz rfa_100975
buffer_load_dword v125,off,s[20:23],s92 sc1
s_bitset0_b32 s55,6
s_cmp_eq_u32 s55,0
s_cbranch_scc1 segb_100858
s_branch rnx_100976
rdn_100974:
buffer_load_dword v125,off,s[20:23],s92 sc1
s_branch rnx_100976
rfa_100975:
buffer_load_dwordx4 v[40:43],v0,s[20:23],s93 offen offset:2048 sc1
rnx_100976:
s_bitcmp1_b32 s55,7
s_cbranch_scc0 rdn_100977
s_waitcnt vmcnt(2)
v_max3_u32 v124,v44,v45,v46
v_max_u32 v124,v124,v47
v_cmp_eq_u32 vcc,-1,v124
s_cbranch_vccnz rfa_100978
buffer_load_dword v125,off,s[20:23],s92 sc1
s_bitset0_b32 s55,7
s_cmp_eq_u32 s55,0
s_cbranch_scc1 segb_100858
s_branch rnx_100979
rdn_100977:
buffer_load_dword v125,off,s[20:23],s92 sc1
s_branch rnx_100979
rfa_100978:
buffer_load_dwordx4 v[44:47],v0,s[20:23],s93 offen offset:3072 sc1
rnx_100979:
s_sub_u32 s90,s90,1
s_cmp_gt_i32 s90,0
s_cbranch_scc1 rot_100964
s_mov_b32 s55,0
s_branch segb_100858
fl_100866:
v_smfmac_f32_16x16x64_bf16 v[76:79],v[36:39],a[120:127],v1
flb_100874:
s_mov_b32 s55,192
s_bitcmp1_b32 s55,6
s_cbranch_scc0 rdn_100981
s_waitcnt vmcnt(5)
v_max3_u32 v124,v40,v41,v42
v_max_u32 v124,v124,v43
v_cmp_eq_u32 vcc,-1,v124
s_cbranch_vccnz rfa_100982
buffer_load_dword v125,off,s[20:23],s92 sc1
s_bitset0_b32 s55,6
s_cmp_eq_u32 s55,0
s_cbranch_scc1 segb_100858
s_branch rnx_100983
rdn_100981:
buffer_load_dword v125,off,s[20:23],s92 sc1
s_branch rnx_100983
rfa_100982:
buffer_load_dwordx4 v[40:43],v0,s[20:23],s93 offen offset:2048 sc1
rnx_100983:
s_bitcmp1_b32 s55,7
s_cbranch_scc0 rdn_100984
s_waitcnt vmcnt(5)
v_max3_u32 v124,v44,v45,v46
v_max_u32 v124,v124,v47
v_cmp_eq_u32 vcc,-1,v124
s_cbranch_vccnz rfa_100985
buffer_load_dword v125,off,s[20:23],s92 sc1
s_bitset0_b32 s55,7
s_cmp_eq_u32 s55,0
s_cbranch_scc1 segb_100858
s_branch rnx_100986
rdn_100984:
buffer_load_dword v125,off,s[20:23],s92 sc1
s_branch rnx_100986
rfa_100985:
buffer_load_dwordx4 v[44:47],v0,s[20:23],s93 offen offset:3072 sc1
rnx_100986:
rot_100980:
s_bitcmp1_b32 s55,6
s_cbranch_scc0 rdn_100987
s_waitcnt vmcnt(1)
v_max3_u32 v124,v40,v41,v42
v_max_u32 v124,v124,v43
v_cmp_eq_u32 vcc,-1,v124
s_cbranch_vccnz rfa_100988
buffer_load_dword v125,off,s[20:23],s92 sc1
s_bitset0_b32 s55,6
s_cmp_eq_u32 s55,0
s_cbranch_scc1 segb_100858
s_branch rnx_100989
rdn_100987:
buffer_load_dword v125,off,s[20:23],s92 sc1
s_branch rnx_100989
rfa_100988:
buffer_load_dwordx4 v[40:43],v0,s[20:23],s93 offen offset:2048 sc1
rnx_100989:
s_bitcmp1_b32 s55,7
s_cbranch_scc0 rdn_100990
s_waitcnt vmcnt(1)
v_max3_u32 v124,v44,v45,v46
v_max_u32 v124,v124,v47
v_cmp_eq_u32 vcc,-1,v124
s_cbranch_vccnz rfa_100991
buffer_load_dword v125,off,s[20:23],s92 sc1
s_bitset0_b32 s55,7
s_cmp_eq_u32 s55,0
s_cbranch_scc1 segb_100858
s_branch rnx_100992
rdn_100990:
buffer_load_dword v125,off,s[20:23],s92 sc1
s_branch rnx_100992
rfa_100991:
buffer_load_dwordx4 v[44:47],v0,s[20:23],s93 offen offset:3072 sc1
rnx_100992:
s_sub_u32 s90,s90,1
s_cmp_gt_i32 s90,0
s_cbranch_scc1 rot_100980
s_mov_b32 s55,0
s_branch segb_100858
dfl_100933:
buffer_load_dwordx4 v[20:23],v0,s[20:23],s92 offen offset:1024 sc1
s_bitset1_b32 s55,1
buffer_load_dwordx4 v[36:39],v0,s[20:23],s93 offen offset:1024 sc1
s_waitcnt vmcnt(5)
v_max3_u32 v124,v24,v25,v26
v_max_u32 v124,v124,v27
v_cmp_eq_u32 vcc,-1,v124
s_cbranch_vccnz dfl_100934
s_branch dseg_100937
dfl_100934:
buffer_load_dwordx4 v[24:27],v0,s[20:23],s92 offen offset:2048 sc1
s_bitset1_b32 s55,2
buffer_load_dwordx4 v[40:43],v0,s[20:23],s93 offen offset:2048 sc1
buffer_load_dwordx4 v[44:47],v0,s[20:23],s93 offen offset:3072 sc1
s_waitcnt vmcnt(7)
v_max3_u32 v124,v28,v29,v30
v_max_u32 v124,v124,v31
v_cmp_eq_u32 vcc,-1,v124
s_cbranch_vccnz dfl_100935
s_branch dseg_100938
dfl_100935:
buffer_load_dwordx4 v[28:31],v0,s[20:23],s92 offen offset:3072 sc1
s_bitset1_b32 s55,3
buffer_store_dword v126,v121,s[20:23],s69 offen sc1
s_branch lap2_100939
dseg_100937:
v_smfmac_f32_16x16x64_bf16 v[48:51],v[24:27],a[128:135],v1
buffer_load_dword v125,off,s[20:23],s92 sc1
v_smfmac_f32_16x16x64_bf16 v[52:55],v[24:27],a[136:143],v1
buffer_load_dwordx4 v[40:43],v0,s[20:23],s93 offen offset:2048 sc1
v_smfmac_f32_16x16x64_bf16 v[56:59],v[24:27],a[144:151],v1
buffer_load_dwordx4 v[44:47],v0,s[20:23],s93 offen offset:3072 sc1
s_waitcnt vmcnt(7)
v_max3_u32 v124,v28,v29,v30
v_smfmac_f32_16x16x64_bf16 v[60:63],v[24:27],a[152:159],v1
v_max_u32 v124,v124,v31
v_smfmac_f32_16x16x64_bf16 v[64:67],v[24:27],a[160:167],v1
v_cmp_eq_u32 vcc,-1,v124
v_smfmac_f32_16x16x64_bf16 v[68:71],v[24:27],a[168:175],v1
v_smfmac_f32_16x16x64_bf16 v[72:75],v[24:27],a[176:183],v1
v_smfmac_f32_16x16x64_bf16 v[76:79],v[24:27],a[184:191],v1
s_cbranch_vccnz dfl_100935
dseg_100938:
v_smfmac_f32_16x16x64_bf16 v[48:51],v[28:31],a[192:199],v1
buffer_load_dword v125,off,s[20:23],s92 sc1
v_smfmac_f32_16x16x64_bf16 v[52:55],v[28:31],a[200:207],v1
buffer_store_dword v126,v121,s[20:23],s69 offen sc1
v_smfmac_f32_16x16x64_bf16 v[56:59],v[28:31],a[208:215],v1
v_smfmac_f32_16x16x64_bf16 v[60:63],v[28:31],a[216:223],v1
v_smfmac_f32_16x16x64_bf16 v[64:67],v[28:31],a[224:231],v1
v_smfmac_f32_16x16x64_bf16 v[68:71],v[28:31],a[232:239],v1
v_smfmac_f32_16x16x64_bf16 v[72:75],v[28:31],a[240:247],v1
v_smfmac_f32_16x16x64_bf16 v[76:79],v[28:31],a[248:255],v1
lap2_100939:
s_bitcmp1_b32 s55,0
s_cbranch_scc0 l2s_100993
s_waitcnt vmcnt(8)
v_max3_u32 v124,v16,v17,v18
v_max_u32 v124,v124,v19
v_cmp_eq_u32 vcc,-1,v124
s_cbranch_vccnz l2s_100993
s_bitset0_b32 s55,0
v_smfmac_f32_16x16x64_bf16 v[48:51],v[16:19],a[0:7],v1
v_smfmac_f32_16x16x64_bf16 v[52:55],v[16:19],a[8:15],v1
v_smfmac_f32_16x16x64_bf16 v[56:59],v[16:19],a[16:23],v1
v_smfmac_f32_16x16x64_bf16 v[60:63],v[16:19],a[24:31],v1
v_smfmac_f32_16x16x64_bf16 v[64:67],v[16:19],a[32:39],v1
v_smfmac_f32_16x16x64_bf16 v[68:71],v[16:19],a[40:47],v1
v_smfmac_f32_16x16x64_bf16 v[72:75],v[16:19],a[48:55],v1
v_smfmac_f32_16x16x64_bf16 v[76:79],v[16:19],a[56:63],v1
l2s_100993:
s_bitcmp1_b32 s55,1
s_cbranch_scc0 l2s_100995
s_waitcnt vmcnt(6)
v_max3_u32 v124,v20,v21,v22
v_max_u32 v124,v124,v23
v_cmp_eq_u32 vcc,-1,v124
s_cbranch_vccnz l2s_100995
s_bitset0_b32 s55,1
v_smfmac_f32_16x16x64_bf16 v[48:51],v[20:23],a[64:71],v1
v_smfmac_f32_16x16x64_bf16 v[52:55],v[20:23],a[72:79],v1
v_smfmac_f32_16x16x64_bf16 v[56:59],v[20:23],a[80:87],v1
v_smfmac_f32_16x16x64_bf16 v[60:63],v[20:23],a[88:95],v1
v_smfmac_f32_16x16x64_bf16 v[64:67],v[20:23],a[96:103],v1
v_smfmac_f32_16x16x64_bf16 v[68:71],v[20:23],a[104:111],v1
v_smfmac_f32_16x16x64_bf16 v[72:75],v[20:23],a[112:119],v1
v_smfmac_f32_16x16x64_bf16 v[76:79],v[20:23],a[120:127],v1
l2s_100995:
s_bitcmp1_b32 s55,2
s_cbranch_scc0 l2s_100997
s_waitcnt vmcnt(4)
v_max3_u32 v124,v24,v25,v26
v_max_u32 v124,v124,v27
v_cmp_eq_u32 vcc,-1,v124
s_cbranch_vccnz l2s_100997
s_bitset0_b32 s55,2
v_smfmac_f32_16x16x64_bf16 v[48:51],v[24:27],a[128:135],v1
v_smfmac_f32_16x16x64_bf16 v[52:55],v[24:27],a[136:143],v1
v_smfmac_f32_16x16x64_bf16 v[56:59],v[24:27],a[144:151],v1
v_smfmac_f32_16x16x64_bf16 v[60:63],v[24:27],a[152:159],v1
v_smfmac_f32_16x16x64_bf16 v[64:67],v[24:27],a[160:167],v1
v_smfmac_f32_16x16x64_bf16 v[68:71],v[24:27],a[168:175],v1
v_smfmac_f32_16x16x64_bf16 v[72:75],v[24:27],a[176:183],v1
v_smfmac_f32_16x16x64_bf16 v[76:79],v[24:27],a[184:191],v1
l2s_100997:
s_bitcmp1_b32 s55,3
s_cbranch_scc0 l2s_100999
s_waitcnt vmcnt(1)
v_max3_u32 v124,v28,v29,v30
v_max_u32 v124,v124,v31
v_cmp_eq_u32 vcc,-1,v124
s_cbranch_vccnz l2s_100999
s_bitset0_b32 s55,3
v_smfmac_f32_16x16x64_bf16 v[48:51],v[28:31],a[192:199],v1
v_smfmac_f32_16x16x64_bf16 v[52:55],v[28:31],a[200:207],v1
v_smfmac_f32_16x16x64_bf16 v[56:59],v[28:31],a[208:215],v1
v_smfmac_f32_16x16x64_bf16 v[60:63],v[28:31],a[216:223],v1
v_smfmac_f32_16x16x64_bf16 v[64:67],v[28:31],a[224:231],v1
v_smfmac_f32_16x16x64_bf16 v[68:71],v[28:31],a[232:239],v1
v_smfmac_f32_16x16x64_bf16 v[72:75],v[28:31],a[240:247],v1
v_smfmac_f32_16x16x64_bf16 v[76:79],v[28:31],a[248:255],v1
l2s_100999:
s_cmp_eq_u32 s55,0
s_cbranch_scc0 lfb_100940
Ldone_100941:
s_waitcnt vmcnt(7)
v_max3_u32 v124,v32,v33,v34
v_max_u32 v124,v124,v35
v_cmp_eq_u32 vcc,-1,v124
s_cbranch_vccnz flb_100872
s_branch segb_100856
lfb_100940:
s_bitcmp1_b32 s55,0
s_cbranch_scc0 dsk_101001
buffer_load_dwordx4 v[16:19],v0,s[20:23],s92 offen offset:0 sc1
dsk_101001:
s_bitcmp1_b32 s55,1
s_cbranch_scc0 dsk_101002
buffer_load_dwordx4 v[20:23],v0,s[20:23],s92 offen offset:1024 sc1
dsk_101002:
s_bitcmp1_b32 s55,2
s_cbranch_scc0 dsk_101003
buffer_load_dwordx4 v[24:27],v0,s[20:23],s92 offen offset:2048 sc1
dsk_101003:
s_bitcmp1_b32 s55,3
s_cbranch_scc0 dsk_101004
buffer_load_dwordx4 v[28:31],v0,s[20:23],s92 offen offset:3072 sc1
dsk_101004:
s_bitcmp1_b32 s55,0
s_cbranch_scc0 dsk_101005
s_waitcnt vmcnt(2)
v_max3_u32 v124,v16,v17,v18
v_max_u32 v124,v124,v19
v_cmp_eq_u32 vcc,-1,v124
s_cbranch_vccz dgo_101006
s_nop 15
buffer_load_dwordx4 v[104:107],v0,s[20:23],s92 offen offset:0 sc1
s_nop 15
buffer_load_dwordx4 v[108:111],v0,s[20:23],s92 offen offset:0 sc1
dlp_101007:
s_waitcnt vmcnt(2)
v_max3_u32 v124,v16,v17,v18
v_max_u32 v124,v124,v19
v_cmp_eq_u32 vcc,-1,v124
s_cbranch_vccz dgo_101006
buffer_load_dwordx4 v[16:19],v0,s[20:23],s92 offen offset:0 sc1
s_waitcnt vmcnt(2)
v_max3_u32 v124,v104,v105,v106
v_max_u32 v124,v124,v107
v_cmp_eq_u32 vcc,-1,v124
s_cbranch_vccz dcp_101009
buffer_load_dwordx4 v[104:107],v0,s[20:23],s92 offen offset:0 sc1
s_waitcnt vmcnt(2)
v_max3_u32 v124,v108,v109,v110
v_max_u32 v124,v124,v111
v_cmp_eq_u32 vcc,-1,v124
s_cbranch_vccz dcp_101010
buffer_load_dwordx4 v[108:111],v0,s[20:23],s92 offen offset:0 sc1
s_sub_u32 s90,s90,1
s_cmp_gt_i32 s90,0
s_cbranch_scc1 dlp_101007
s_branch dgo_101006
dcp_101009:
v_mov_b32 v16,v104
v_mov_b32 v17,v105
v_mov_b32 v18,v106
v_mov_b32 v19,v107
s_nop 1
s_branch dgo_101006
dcp_101010:
v_mov_b32 v16,v108
v_mov_b32 v17,v109
v_mov_b32 v18,v110
v_mov_b32 v19,v111
s_nop 1
dgo_101006:
v_smfmac_f32_16x16x64_bf16 v[48:51],v[16:19],a[0:7],v1
v_smfmac_f32_16x16x64_bf16 v[52:55],v[16:19],a[8:15],v1
v_smfmac_f32_16x16x64_bf16 v[56:59],v[16:19],a[16:23],v1
v_smfmac_f32_16x16x64_bf16 v[60:63],v[16:19],a[24:31],v1
v_smfmac_f32_16x16x64_bf16 v[64:67],v[16:19],a[32:39],v1
v_smfmac_f32_16x16x64_bf16 v[68:71],v[16:19],a[40:47],v1
v_smfmac_f32_16x16x64_bf16 v[72:75],v[16:19],a[48:55],v1
v_smfmac_f32_16x16x64_bf16 v[76:79],v[16:19],a[56:63],v1
dsk_101005:
s_bitcmp1_b32 s55,1
s_cbranch_scc0 dsk_101011
s_waitcnt vmcnt(2)
v_max3_u32 v124,v20,v21,v22
v_max_u32 v124,v124,v23
v_cmp_eq_u32 vcc,-1,v124
s_cbranch_vccz dgo_101012
s_nop 15
buffer_load_dwordx4 v[104:107],v0,s[20:23],s92 offen offset:1024 sc1
s_nop 15
buffer_load_dwordx4 v[108:111],v0,s[20:23],s92 offen offset:1024 sc1
dlp_101013:
s_waitcnt vmcnt(2)
v_max3_u32 v124,v20,v21,v22
v_max_u32 v124,v124,v23
v_cmp_eq_u32 vcc,-1,v124
s_cbranch_vccz dgo_101012
buffer_load_dwordx4 v[20:23],v0,s[20:23],s92 offen offset:1024 sc1
s_waitcnt vmcnt(2)
v_max3_u32 v124,v104,v105,v106
v_max_u32 v124,v124,v107
v_cmp_eq_u32 vcc,-1,v124
s_cbranch_vccz dcp_101015
buffer_load_dwordx4 v[104:107],v0,s[20:23],s92 offen offset:1024 sc1
s_waitcnt vmcnt(2)
v_max3_u32 v124,v108,v109,v110
v_max_u32 v124,v124,v111
v_cmp_eq_u32 vcc,-1,v124
s_cbranch_vccz dcp_101016
buffer_load_dwordx4 v[108:111],v0,s[20:23],s92 offen offset:1024 sc1
s_sub_u32 s90,s90,1
s_cmp_gt_i32 s90,0
s_cbranch_scc1 dlp_101013
s_branch dgo_101012
dcp_101015:
v_mov_b32 v20,v104
v_mov_b32 v21,v105
v_mov_b32 v22,v106
v_mov_b32 v23,v107
s_nop 1
s_branch dgo_101012
dcp_101016:
v_mov_b32 v20,v108
v_mov_b32 v21,v109
v_mov_b32 v22,v110
v_mov_b32 v23,v111
s_nop 1
dgo_101012:
v_smfmac_f32_16x16x64_bf16 v[48:51],v[20:23],a[64:71],v1
v_smfmac_f32_16x16x64_bf16 v[52:55],v[20:23],a[72:79],v1
v_smfmac_f32_16x16x64_bf16 v[56:59],v[20:23],a[80:87],v1
v_smfmac_f32_16x16x64_bf16 v[60:63],v[20:23],a[88:95],v1
v_smfmac_f32_16x16x64_bf16 v[64:67],v[20:23],a[96:103],v1
v_smfmac_f32_16x16x64_bf16 v[68:71],v[20:23],a[104:111],v1
v_smfmac_f32_16x16x64_bf16 v[72:75],v[20:23],a[112:119],v1
v_smfmac_f32_16x16x64_bf16 v[76:79],v[20:23],a[120:127],v1
dsk_101011:
s_bitcmp1_b32 s55,2
s_cbranch_scc0 dsk_101017
s_waitcnt vmcnt(2)
v_max3_u32 v124,v24,v25,v26
v_max_u32 v124,v124,v27
v_cmp_eq_u32 vcc,-1,v124
s_cbranch_vccz dgo_101018
s_nop 15
buffer_load_dwordx4 v[104:107],v0,s[20:23],s92 offen offset:2048 sc1
s_nop 15
buffer_load_dwordx4 v[108:111],v0,s[20:23],s92 offen offset:2048 sc1
dlp_101019:
s_waitcnt vmcnt(2)
v_max3_u32 v124,v24,v25,v26
v_max_u32 v124,v124,v27
v_cmp_eq_u32 vcc,-1,v124
s_cbranch_vccz dgo_101018
buffer_load_dwordx4 v[24:27],v0,s[20:23],s92 offen offset:2048 sc1
s_waitcnt vmcnt(2)
v_max3_u32 v124,v104,v105,v106
v_max_u32 v124,v124,v107
v_cmp_eq_u32 vcc,-1,v124
s_cbranch_vccz dcp_101021
buffer_load_dwordx4 v[104:107],v0,s[20:23],s92 offen offset:2048 sc1
s_waitcnt vmcnt(2)
v_max3_u32 v124,v108,v109,v110
v_max_u32 v124,v124,v111
v_cmp_eq_u32 vcc,-1,v124
s_cbranch_vccz dcp_101022
buffer_load_dwordx4 v[108:111],v0,s[20:23],s92 offen offset:2048 sc1
s_sub_u32 s90,s90,1
s_cmp_gt_i32 s90,0
s_cbranch_scc1 dlp_101019
s_branch dgo_101018
dcp_101021:
v_mov_b32 v24,v104
v_mov_b32 v25,v105
v_mov_b32 v26,v106
v_mov_b32 v27,v107
s_nop 1
s_branch dgo_101018
dcp_101022:
v_mov_b32 v24,v108
v_mov_b32 v25,v109
v_mov_b32 v26,v110
v_mov_b32 v27,v111
s_nop 1
dgo_101018:
v_smfmac_f32_16x16x64_bf16 v[48:51],v[24:27],a[128:135],v1
v_smfmac_f32_16x16x64_bf16 v[52:55],v[24:27],a[136:143],v1
v_smfmac_f32_16x16x64_bf16 v[56:59],v[24:27],a[144:151],v1
v_smfmac_f32_16x16x64_bf16 v[60:63],v[24:27],a[152:159],v1
v_smfmac_f32_16x16x64_bf16 v[64:67],v[24:27],a[160:167],v1
v_smfmac_f32_16x16x64_bf16 v[68:71],v[24:27],a[168:175],v1
v_smfmac_f32_16x16x64_bf16 v[72:75],v[24:27],a[176:183],v1
v_smfmac_f32_16x16x64_bf16 v[76:79],v[24:27],a[184:191],v1
dsk_101017:
s_bitcmp1_b32 s55,3
s_cbranch_scc0 dsk_101023
s_waitcnt vmcnt(2)
v_max3_u32 v124,v28,v29,v30
v_max_u32 v124,v124,v31
v_cmp_eq_u32 vcc,-1,v124
s_cbranch_vccz dgo_101024
s_nop 15
buffer_load_dwordx4 v[104:107],v0,s[20:23],s92 offen offset:3072 sc1
s_nop 15
buffer_load_dwordx4 v[108:111],v0,s[20:23],s92 offen offset:3072 sc1
dlp_101025:
s_waitcnt vmcnt(2)
v_max3_u32 v124,v28,v29,v30
v_max_u32 v124,v124,v31
v_cmp_eq_u32 vcc,-1,v124
s_cbranch_vccz dgo_101024
buffer_load_dwordx4 v[28:31],v0,s[20:23],s92 offen offset:3072 sc1
s_waitcnt vmcnt(2)
v_max3_u32 v124,v104,v105,v106
v_max_u32 v124,v124,v107
v_cmp_eq_u32 vcc,-1,v124
s_cbranch_vccz dcp_101027
buffer_load_dwordx4 v[104:107],v0,s[20:23],s92 offen offset:3072 sc1
s_waitcnt vmcnt(2)
v_max3_u32 v124,v108,v109,v110
v_max_u32 v124,v124,v111
v_cmp_eq_u32 vcc,-1,v124
s_cbranch_vccz dcp_101028
buffer_load_dwordx4 v[108:111],v0,s[20:23],s92 offen offset:3072 sc1
s_sub_u32 s90,s90,1
s_cmp_gt_i32 s90,0
s_cbranch_scc1 dlp_101025
s_branch dgo_101024
dcp_101027:
v_mov_b32 v28,v104
v_mov_b32 v29,v105
v_mov_b32 v30,v106
v_mov_b32 v31,v107
s_nop 1
s_branch dgo_101024
dcp_101028:
v_mov_b32 v28,v108
v_mov_b32 v29,v109
v_mov_b32 v30,v110
v_mov_b32 v31,v111
s_nop 1
dgo_101024:
v_smfmac_f32_16x16x64_bf16 v[48:51],v[28:31],a[192:199],v1
v_smfmac_f32_16x16x64_bf16 v[52:55],v[28:31],a[200:207],v1
v_smfmac_f32_16x16x64_bf16 v[56:59],v[28:31],a[208:215],v1
v_smfmac_f32_16x16x64_bf16 v[60:63],v[28:31],a[216:223],v1
v_smfmac_f32_16x16x64_bf16 v[64:67],v[28:31],a[224:231],v1
v_smfmac_f32_16x16x64_bf16 v[68:71],v[28:31],a[232:239],v1
v_smfmac_f32_16x16x64_bf16 v[72:75],v[28:31],a[240:247],v1
v_smfmac_f32_16x16x64_bf16 v[76:79],v[28:31],a[248:255],v1
dsk_101023:
s_mov_b32 s55,0
s_branch Ldone_100941
slowA_100876:
buffer_load_dwordx4 v[44:47],v0,s[20:23],s93 offen offset:3072 sc1
dsk_101029:
s_bitcmp1_b32 s55,7
s_cbranch_scc0 dsk_101030
s_waitcnt vmcnt(2)
v_max3_u32 v124,v44,v45,v46
v_max_u32 v124,v124,v47
v_cmp_eq_u32 vcc,-1,v124
s_cbranch_vccz dgo_101031
s_nop 15
s_nop 3
buffer_load_dwordx4 v[104:107],v0,s[20:23],s93 offen offset:3072 sc1
s_nop 15
s_nop 3
buffer_load_dwordx4 v[108:111],v0,s[20:23],s93 offen offset:3072 sc1
dlp_101032:
s_waitcnt vmcnt(2)
v_max3_u32 v124,v44,v45,v46
v_max_u32 v124,v124,v47
v_cmp_eq_u32 vcc,-1,v124
s_cbranch_vccz dgo_101031
buffer_load_dwordx4 v[44:47],v0,s[20:23],s93 offen offset:3072 sc1
s_waitcnt vmcnt(2)
v_max3_u32 v124,v104,v105,v106
v_max_u32 v124,v124,v107
v_cmp_eq_u32 vcc,-1,v124
s_cbranch_vccz dcp_101034
buffer_load_dwordx4 v[104:107],v0,s[20:23],s93 offen offset:3072 sc1
s_waitcnt vmcnt(2)
v_max3_u32 v124,v108,v109,v110
v_max_u32 v124,v124,v111
v_cmp_eq_u32 vcc,-1,v124
s_cbranch_vccz dcp_101035
buffer_load_dwordx4 v[108:111],v0,s[20:23],s93 offen offset:3072 sc1
s_sub_u32 s90,s90,1
s_cmp_gt_i32 s90,0
s_cbranch_scc1 dlp_101032
s_branch dgo_101031
dcp_101034:
v_mov_b32 v44,v104
v_mov_b32 v45,v105
v_mov_b32 v46,v106
v_mov_b32 v47,v107
s_nop 1
s_branch dgo_101031
dcp_101035:
v_mov_b32 v44,v108
v_mov_b32 v45,v109
v_mov_b32 v46,v110
v_mov_b32 v47,v111
s_nop 1
dgo_101031:
dsk_101030:
s_mov_b32 s55,0
s_branch segb_100858
srt_100884:
s_sub_u32 s90,s90,1
s_cmp_gt_i32 s90,0
s_cbranch_scc0 sok_100883
buffer_load_dwordx4 v[16:19],v2,s[20:23],s94 offen offset:0 sc1
buffer_load_dwordx4 v[32:35],v2,s[20:23],s94 offen offset:1536 sc1
buffer_load_dwordx4 v[20:23],v2,s[20:23],s95 offen offset:0 sc1
buffer_load_dwordx4 v[36:39],v2,s[20:23],s95 offen offset:1536 sc1
buffer_load_dword v120,v3,s[20:23],s94 offen offset:0 sc1
buffer_load_dword v121,v3,s[20:23],s94 offen offset:1536 sc1
buffer_load_dword v122,v3,s[20:23],s95 offen offset:0 sc1
buffer_load_dword v123,v3,s[20:23],s95 offen offset:1536 sc1
s_branch sp_100882
of_100885:
s_mov_b32 s55,3
buffer_load_dwordx4 v[16:19],v0,s[20:23],s96 offen offset:0 sc1
buffer_load_dwordx4 v[20:23],v0,s[20:23],s96 offen offset:1024 sc1
s_waitcnt vmcnt(6)
v_max3_u32 v124,v24,v25,v26
v_max3_u32 v124,v124,v27,v28
v_max3_u32 v124,v124,v29,v30
v_max_u32 v124,v124,v31
v_cmp_eq_u32 vcc,-1,v124
s_cbranch_vccnz ost_101037
v_smfmac_f32_16x16x64_bf16 v[96:99],v[24:27],v[80:87],v1
buffer_load_dword v120,off,s[20:23],s96 sc1
v_smfmac_f32_16x16x64_bf16 v[100:103],v[24:27],v[88:95],v1
buffer_load_dword v120,off,s[20:23],s96 sc1
v_smfmac_f32_16x16x64_bf16 v[96:99],v[28:31],v[128:135],v1
v_smfmac_f32_16x16x64_bf16 v[100:103],v[28:31],v[136:143],v1
ort_101038:
s_waitcnt vmcnt(6)
v_max3_u32 v124,v32,v33,v34
v_max3_u32 v124,v124,v35,v36
v_max3_u32 v124,v124,v37,v38
v_max_u32 v124,v124,v39
v_cmp_eq_u32 vcc,-1,v124
s_cbranch_vccnz ost_101039
v_smfmac_f32_16x16x64_bf16 v[96:99],v[32:35],v[144:151],v1
buffer_load_dword v120,off,s[20:23],s96 sc1
v_smfmac_f32_16x16x64_bf16 v[100:103],v[32:35],v[152:159],v1
buffer_load_dword v120,off,s[20:23],s96 sc1
v_smfmac_f32_16x16x64_bf16 v[96:99],v[36:39],v[160:167],v1
v_smfmac_f32_16x16x64_bf16 v[100:103],v[36:39],v[168:175],v1
ort_101040:
s_waitcnt vmcnt(7)
v_max3_u32 v124,v40,v41,v42
v_max_u32 v124,v124,v43
v_cmp_eq_u32 vcc,-1,v124
s_cbranch_vccnz ost_101041
v_smfmac_f32_16x16x64_bf16 v[96:99],v[40:43],v[176:183],v1
buffer_load_dword v120,off,s[20:23],s96 sc1
v_smfmac_f32_16x16x64_bf16 v[100:103],v[40:43],v[184:191],v1
ort_101042:
s_waitcnt vmcnt(7)
v_max3_u32 v124,v44,v45,v46
v_max_u32 v124,v124,v47
v_cmp_eq_u32 vcc,-1,v124
s_cbranch_vccnz ost_101043
v_smfmac_f32_16x16x64_bf16 v[96:99],v[44:47],v[192:199],v1
buffer_load_dword v120,off,s[20:23],s96 sc1
v_smfmac_f32_16x16x64_bf16 v[100:103],v[44:47],v[200:207],v1
ort_101044:
s_waitcnt vmcnt(6)
v_max3_u32 v124,v16,v17,v18
v_max3_u32 v124,v124,v19,v20
v_max3_u32 v124,v124,v21,v22
v_max_u32 v124,v124,v23
v_cmp_eq_u32 vcc,-1,v124
s_cbranch_vccnz olap2_101036
s_andn2_b32 s55,s55,3
v_smfmac_f32_16x16x64_bf16 v[96:99],v[16:19],v[48:55],v1
v_smfmac_f32_16x16x64_bf16 v[100:103],v[16:19],v[56:63],v1
v_smfmac_f32_16x16x64_bf16 v[96:99],v[20:23],v[64:71],v1
v_smfmac_f32_16x16x64_bf16 v[100:103],v[20:23],v[72:79],v1
s_cbranch_scc0 oback_100896
s_branch olap2_101036
ost_101037:
buffer_load_dwordx4 v[24:27],v0,s[20:23],s96 offen offset:2048 sc1
buffer_load_dwordx4 v[28:31],v0,s[20:23],s96 offen offset:3072 sc1
s_or_b32 s55,s55,12
s_branch ort_101038
ost_101039:
buffer_load_dwordx4 v[32:35],v0,s[20:23],s97 offen offset:0 sc1
buffer_load_dwordx4 v[36:39],v0,s[20:23],s97 offen offset:1024 sc1
s_or_b32 s55,s55,48
s_branch ort_101040
ost_101041:
buffer_load_dwordx4 v[40:43],v0,s[20:23],s97 offen offset:2048 sc1
s_or_b32 s55,s55,64
s_branch ort_101042
ost_101043:
buffer_load_dwordx4 v[44:47],v0,s[20:23],s97 offen offset:3072 sc1
s_or_b32 s55,s55,128
s_branch ort_101044
of_100886:
s_mov_b32 s55,12
buffer_load_dwordx4 v[24:27],v0,s[20:23],s96 offen offset:2048 sc1
buffer_load_dwordx4 v[28:31],v0,s[20:23],s96 offen offset:3072 sc1
s_waitcnt vmcnt(4)
v_max3_u32 v124,v32,v33,v34
v_max3_u32 v124,v124,v35,v36
v_max3_u32 v124,v124,v37,v38
v_max_u32 v124,v124,v39
v_cmp_eq_u32 vcc,-1,v124
s_cbranch_vccnz ost_101046
v_smfmac_f32_16x16x64_bf16 v[96:99],v[32:35],v[144:151],v1
buffer_load_dword v120,off,s[20:23],s96 sc1
v_smfmac_f32_16x16x64_bf16 v[100:103],v[32:35],v[152:159],v1
buffer_load_dword v120,off,s[20:23],s96 sc1
v_smfmac_f32_16x16x64_bf16 v[96:99],v[36:39],v[160:167],v1
v_smfmac_f32_16x16x64_bf16 v[100:103],v[36:39],v[168:175],v1
ort_101047:
s_waitcnt vmcnt(5)
v_max3_u32 v124,v40,v41,v42
v_max_u32 v124,v124,v43
v_cmp_eq_u32 vcc,-1,v124
s_cbranch_vccnz ost_101048
v_smfmac_f32_16x16x64_bf16 v[96:99],v[40:43],v[176:183],v1
buffer_load_dword v120,off,s[20:23],s96 sc1
v_smfmac_f32_16x16x64_bf16 v[100:103],v[40:43],v[184:191],v1
ort_101049:
s_waitcnt vmcnt(5)
v_max3_u32 v124,v44,v45,v46
v_max_u32 v124,v124,v47
v_cmp_eq_u32 vcc,-1,v124
s_cbranch_vccnz ost_101050
v_smfmac_f32_16x16x64_bf16 v[96:99],v[44:47],v[192:199],v1
buffer_load_dword v120,off,s[20:23],s96 sc1
v_smfmac_f32_16x16x64_bf16 v[100:103],v[44:47],v[200:207],v1
ort_101051:
s_waitcnt vmcnt(4)
v_max3_u32 v124,v24,v25,v26
v_max3_u32 v124,v124,v27,v28
v_max3_u32 v124,v124,v29,v30
v_max_u32 v124,v124,v31
v_cmp_eq_u32 vcc,-1,v124
s_cbranch_vccnz olap2_101036
s_andn2_b32 s55,s55,12
v_smfmac_f32_16x16x64_bf16 v[96:99],v[24:27],v[80:87],v1
v_smfmac_f32_16x16x64_bf16 v[100:103],v[24:27],v[88:95],v1
v_smfmac_f32_16x16x64_bf16 v[96:99],v[28:31],v[128:135],v1
v_smfmac_f32_16x16x64_bf16 v[100:103],v[28:31],v[136:143],v1
s_cbranch_scc0 oback_100896
s_branch olap2_101036
ost_101046:
buffer_load_dwordx4 v[32:35],v0,s[20:23],s97 offen offset:0 sc1
buffer_load_dwordx4 v[36:39],v0,s[20:23],s97 offen offset:1024 sc1
s_or_b32 s55,s55,48
s_branch ort_101047
ost_101048:
buffer_load_dwordx4 v[40:43],v0,s[20:23],s97 offen offset:2048 sc1
s_or_b32 s55,s55,64
s_branch ort_101049
ost_101050:
buffer_load_dwordx4 v[44:47],v0,s[20:23],s97 offen offset:3072 sc1
s_or_b32 s55,s55,128
s_branch ort_101051
of_100887:
s_mov_b32 s55,48
buffer_load_dwordx4 v[32:35],v0,s[20:23],s97 offen offset:0 sc1
buffer_load_dwordx4 v[36:39],v0,s[20:23],s97 offen offset:1024 sc1
s_waitcnt vmcnt(3)
v_max3_u32 v124,v40,v41,v42
v_max_u32 v124,v124,v43
v_cmp_eq_u32 vcc,-1,v124
s_cbranch_vccnz ost_101053
v_smfmac_f32_16x16x64_bf16 v[96:99],v[40:43],v[176:183],v1
buffer_load_dword v120,off,s[20:23],s96 sc1
v_smfmac_f32_16x16x64_bf16 v[100:103],v[40:43],v[184:191],v1
ort_101054:
s_waitcnt vmcnt(3)
v_max3_u32 v124,v44,v45,v46
v_max_u32 v124,v124,v47
v_cmp_eq_u32 vcc,-1,v124
s_cbranch_vccnz ost_101055
v_smfmac_f32_16x16x64_bf16 v[96:99],v[44:47],v[192:199],v1
buffer_load_dword v120,off,s[20:23],s96 sc1
v_smfmac_f32_16x16x64_bf16 v[100:103],v[44:47],v[200:207],v1
ort_101056:
s_waitcnt vmcnt(2)
v_max3_u32 v124,v32,v33,v34
v_max3_u32 v124,v124,v35,v36
v_max3_u32 v124,v124,v37,v38
v_max_u32 v124,v124,v39
v_cmp_eq_u32 vcc,-1,v124
s_cbranch_vccnz olap2_101036
s_andn2_b32 s55,s55,48
v_smfmac_f32_16x16x64_bf16 v[96:99],v[32:35],v[144:151],v1
v_smfmac_f32_16x16x64_bf16 v[100:103],v[32:35],v[152:159],v1
v_smfmac_f32_16x16x64_bf16 v[96:99],v[36:39],v[160:167],v1
v_smfmac_f32_16x16x64_bf16 v[100:103],v[36:39],v[168:175],v1
s_cbranch_scc0 oback_100896
s_branch olap2_101036
ost_101053:
buffer_load_dwordx4 v[40:43],v0,s[20:23],s97 offen offset:2048 sc1
s_or_b32 s55,s55,64
s_branch ort_101054
ost_101055:
buffer_load_dwordx4 v[44:47],v0,s[20:23],s97 offen offset:3072 sc1
s_or_b32 s55,s55,128
s_branch ort_101056
of_100888:
s_mov_b32 s55,64
buffer_load_dwordx4 v[40:43],v0,s[20:23],s97 offen offset:2048 sc1
s_waitcnt vmcnt(1)
v_max3_u32 v124,v44,v45,v46
v_max_u32 v124,v124,v47
v_cmp_eq_u32 vcc,-1,v124
s_cbranch_vccnz ost_101058
v_smfmac_f32_16x16x64_bf16 v[96:99],v[44:47],v[192:199],v1
buffer_load_dword v120,off,s[20:23],s96 sc1
v_smfmac_f32_16x16x64_bf16 v[100:103],v[44:47],v[200:207],v1
ort_101059:
s_waitcnt vmcnt(1)
v_max3_u32 v124,v40,v41,v42
v_max_u32 v124,v124,v43
v_cmp_eq_u32 vcc,-1,v124
s_cbranch_vccnz olap2_101036
s_andn2_b32 s55,s55,64
v_smfmac_f32_16x16x64_bf16 v[96:99],v[40:43],v[176:183],v1
v_smfmac_f32_16x16x64_bf16 v[100:103],v[40:43],v[184:191],v1
s_cbranch_scc0 oback_100896
s_branch olap2_101036
ost_101058:
buffer_load_dwordx4 v[44:47],v0,s[20:23],s97 offen offset:3072 sc1
s_or_b32 s55,s55,128
s_branch ort_101059
of_100889:
s_mov_b32 s55,128
s_branch oslow_100895
olap2_101036:
s_bitcmp1_b32 s55,0
s_cbranch_scc0 l2s_101061
s_waitcnt vmcnt(6)
v_max3_u32 v124,v16,v17,v18
v_max3_u32 v124,v124,v19,v20
v_max3_u32 v124,v124,v21,v22
v_max_u32 v124,v124,v23
v_cmp_eq_u32 vcc,-1,v124
s_cbranch_vccnz l2s_101061
s_andn2_b32 s55,s55,3
v_smfmac_f32_16x16x64_bf16 v[96:99],v[16:19],v[48:55],v1
v_smfmac_f32_16x16x64_bf16 v[100:103],v[16:19],v[56:63],v1
v_smfmac_f32_16x16x64_bf16 v[96:99],v[20:23],v[64:71],v1
v_smfmac_f32_16x16x64_bf16 v[100:103],v[20:23],v[72:79],v1
l2s_101061:
s_bitcmp1_b32 s55,2
s_cbranch_scc0 l2s_101062
s_waitcnt vmcnt(4)
v_max3_u32 v124,v24,v25,v26
v_max3_u32 v124,v124,v27,v28
v_max3_u32 v124,v124,v29,v30
v_max_u32 v124,v124,v31
v_cmp_eq_u32 vcc,-1,v124
s_cbranch_vccnz l2s_101062
s_andn2_b32 s55,s55,12
v_smfmac_f32_16x16x64_bf16 v[96:99],v[24:27],v[80:87],v1
v_smfmac_f32_16x16x64_bf16 v[100:103],v[24:27],v[88:95],v1
v_smfmac_f32_16x16x64_bf16 v[96:99],v[28:31],v[128:135],v1
v_smfmac_f32_16x16x64_bf16 v[100:103],v[28:31],v[136:143],v1
l2s_101062:
s_bitcmp1_b32 s55,4
s_cbranch_scc0 l2s_101063
s_waitcnt vmcnt(2)
v_max3_u32 v124,v32,v33,v34
v_max3_u32 v124,v124,v35,v36
v_max3_u32 v124,v124,v37,v38
v_max_u32 v124,v124,v39
v_cmp_eq_u32 vcc,-1,v124
s_cbranch_vccnz l2s_101063
s_andn2_b32 s55,s55,48
v_smfmac_f32_16x16x64_bf16 v[96:99],v[32:35],v[144:151],v1
v_smfmac_f32_16x16x64_bf16 v[100:103],v[32:35],v[152:159],v1
v_smfmac_f32_16x16x64_bf16 v[96:99],v[36:39],v[160:167],v1
v_smfmac_f32_16x16x64_bf16 v[100:103],v[36:39],v[168:175],v1
l2s_101063:
s_bitcmp1_b32 s55,6
s_cbranch_scc0 l2s_101064
s_waitcnt vmcnt(1)
v_max3_u32 v124,v40,v41,v42
v_max_u32 v124,v124,v43
v_cmp_eq_u32 vcc,-1,v124
s_cbranch_vccnz l2s_101064
s_andn2_b32 s55,s55,64
v_smfmac_f32_16x16x64_bf16 v[96:99],v[40:43],v[176:183],v1
v_smfmac_f32_16x16x64_bf16 v[100:103],v[40:43],v[184:191],v1
l2s_101064:
s_bitcmp1_b32 s55,7
s_cbranch_scc0 l2s_101065
s_waitcnt vmcnt(0)
v_max3_u32 v124,v44,v45,v46
v_max_u32 v124,v124,v47
v_cmp_eq_u32 vcc,-1,v124
s_cbranch_vccnz l2s_101065
s_andn2_b32 s55,s55,128
v_smfmac_f32_16x16x64_bf16 v[96:99],v[44:47],v[192:199],v1
v_smfmac_f32_16x16x64_bf16 v[100:103],v[44:47],v[200:207],v1
l2s_101065:
s_cmp_eq_u32 s55,0
s_cbranch_scc1 oback_100896
oslow_100895:
s_bitcmp1_b32 s55,0
s_cbranch_scc0 dsk_101066
buffer_load_dwordx4 v[16:19],v0,s[20:23],s96 offen offset:0 sc1
dsk_101066:
s_bitcmp1_b32 s55,1
s_cbranch_scc0 dsk_101067
buffer_load_dwordx4 v[20:23],v0,s[20:23],s96 offen offset:1024 sc1
dsk_101067:
s_bitcmp1_b32 s55,2
s_cbranch_scc0 dsk_101068
buffer_load_dwordx4 v[24:27],v0,s[20:23],s96 offen offset:2048 sc1
dsk_101068:
s_bitcmp1_b32 s55,3
s_cbranch_scc0 dsk_101069
buffer_load_dwordx4 v[28:31],v0,s[20:23],s96 offen offset:3072 sc1
dsk_101069:
s_bitcmp1_b32 s55,4
s_cbranch_scc0 dsk_101070
buffer_load_dwordx4 v[32:35],v0,s[20:23],s97 offen offset:0 sc1
dsk_101070:
s_bitcmp1_b32 s55,5
s_cbranch_scc0 dsk_101071
buffer_load_dwordx4 v[36:39],v0,s[20:23],s97 offen offset:1024 sc1
dsk_101071:
s_bitcmp1_b32 s55,6
s_cbranch_scc0 dsk_101072
buffer_load_dwordx4 v[40:43],v0,s[20:23],s97 offen offset:2048 sc1
dsk_101072:
s_bitcmp1_b32 s55,7
s_cbranch_scc0 dsk_101073
buffer_load_dwordx4 v[44:47],v0,s[20:23],s97 offen offset:3072 sc1
dsk_101073:
s_bitcmp1_b32 s55,0
s_cbranch_scc0 dsk_101074
s_waitcnt vmcnt(2)
v_max3_u32 v124,v16,v17,v18
v_max_u32 v124,v124,v19
v_cmp_eq_u32 vcc,-1,v124
s_cbranch_vccz dgo_101075
s_nop 15
buffer_load_dwordx4 v[116:119],v0,s[20:23],s96 offen offset:0 sc1
s_nop 15
buffer_load_dwordx4 v[120:123],v0,s[20:23],s96 offen offset:0 sc1
dlp_101076:
s_waitcnt vmcnt(2)
v_max3_u32 v124,v16,v17,v18
v_max_u32 v124,v124,v19
v_cmp_eq_u32 vcc,-1,v124
s_cbranch_vccz dgo_101075
buffer_load_dwordx4 v[16:19],v0,s[20:23],s96 offen offset:0 sc1
s_waitcnt vmcnt(2)
v_max3_u32 v124,v116,v117,v118
v_max_u32 v124,v124,v119
v_cmp_eq_u32 vcc,-1,v124
s_cbranch_vccz dcp_101078
buffer_load_dwordx4 v[116:119],v0,s[20:23],s96 offen offset:0 sc1
s_waitcnt vmcnt(2)
v_max3_u32 v124,v120,v121,v122
v_max_u32 v124,v124,v123
v_cmp_eq_u32 vcc,-1,v124
s_cbranch_vccz dcp_101079
buffer_load_dwordx4 v[120:123],v0,s[20:23],s96 offen offset:0 sc1
s_sub_u32 s90,s90,1
s_cmp_gt_i32 s90,0
s_cbranch_scc1 dlp_101076
s_branch dgo_101075
dcp_101078:
v_mov_b32 v16,v116
v_mov_b32 v17,v117
v_mov_b32 v18,v118
v_mov_b32 v19,v119
s_nop 1
s_branch dgo_101075
dcp_101079:
v_mov_b32 v16,v120
v_mov_b32 v17,v121
v_mov_b32 v18,v122
v_mov_b32 v19,v123
s_nop 1
dgo_101075:
v_smfmac_f32_16x16x64_bf16 v[96:99],v[16:19],v[48:55],v1
v_smfmac_f32_16x16x64_bf16 v[100:103],v[16:19],v[56:63],v1
dsk_101074:
s_bitcmp1_b32 s55,1
s_cbranch_scc0 dsk_101080
s_waitcnt vmcnt(2)
v_max3_u32 v124,v20,v21,v22
v_max_u32 v124,v124,v23
v_cmp_eq_u32 vcc,-1,v124
s_cbranch_vccz dgo_101081
s_nop 15
buffer_load_dwordx4 v[116:119],v0,s[20:23],s96 offen offset:1024 sc1
s_nop 15
buffer_load_dwordx4 v[120:123],v0,s[20:23],s96 offen offset:1024 sc1
dlp_101082:
s_waitcnt vmcnt(2)
v_max3_u32 v124,v20,v21,v22
v_max_u32 v124,v124,v23
v_cmp_eq_u32 vcc,-1,v124
s_cbranch_vccz dgo_101081
buffer_load_dwordx4 v[20:23],v0,s[20:23],s96 offen offset:1024 sc1
s_waitcnt vmcnt(2)
v_max3_u32 v124,v116,v117,v118
v_max_u32 v124,v124,v119
v_cmp_eq_u32 vcc,-1,v124
s_cbranch_vccz dcp_101084
buffer_load_dwordx4 v[116:119],v0,s[20:23],s96 offen offset:1024 sc1
s_waitcnt vmcnt(2)
v_max3_u32 v124,v120,v121,v122
v_max_u32 v124,v124,v123
v_cmp_eq_u32 vcc,-1,v124
s_cbranch_vccz dcp_101085
buffer_load_dwordx4 v[120:123],v0,s[20:23],s96 offen offset:1024 sc1
s_sub_u32 s90,s90,1
s_cmp_gt_i32 s90,0
s_cbranch_scc1 dlp_101082
s_branch dgo_101081
dcp_101084:
v_mov_b32 v20,v116
v_mov_b32 v21,v117
v_mov_b32 v22,v118
v_mov_b32 v23,v119
s_nop 1
s_branch dgo_101081
dcp_101085:
v_mov_b32 v20,v120
v_mov_b32 v21,v121
v_mov_b32 v22,v122
v_mov_b32 v23,v123
s_nop 1
dgo_101081:
v_smfmac_f32_16x16x64_bf16 v[96:99],v[20:23],v[64:71],v1
v_smfmac_f32_16x16x64_bf16 v[100:103],v[20:23],v[72:79],v1
dsk_101080:
s_bitcmp1_b32 s55,2
s_cbranch_scc0 dsk_101086
s_waitcnt vmcnt(2)
v_max3_u32 v124,v24,v25,v26
v_max_u32 v124,v124,v27
v_cmp_eq_u32 vcc,-1,v124
s_cbranch_vccz dgo_101087
s_nop 15
buffer_load_dwordx4 v[116:119],v0,s[20:23],s96 offen offset:2048 sc1
s_nop 15
buffer_load_dwordx4 v[120:123],v0,s[20:23],s96 offen offset:2048 sc1
dlp_101088:
s_waitcnt vmcnt(2)
v_max3_u32 v124,v24,v25,v26
v_max_u32 v124,v124,v27
v_cmp_eq_u32 vcc,-1,v124
s_cbranch_vccz dgo_101087
buffer_load_dwordx4 v[24:27],v0,s[20:23],s96 offen offset:2048 sc1
s_waitcnt vmcnt(2)
v_max3_u32 v124,v116,v117,v118
v_max_u32 v124,v124,v119
v_cmp_eq_u32 vcc,-1,v124
s_cbranch_vccz dcp_101090
buffer_load_dwordx4 v[116:119],v0,s[20:23],s96 offen offset:2048 sc1
s_waitcnt vmcnt(2)
v_max3_u32 v124,v120,v121,v122
v_max_u32 v124,v124,v123
v_cmp_eq_u32 vcc,-1,v124
s_cbranch_vccz dcp_101091
buffer_load_dwordx4 v[120:123],v0,s[20:23],s96 offen offset:2048 sc1
s_sub_u32 s90,s90,1
s_cmp_gt_i32 s90,0
s_cbranch_scc1 dlp_101088
s_branch dgo_101087
dcp_101090:
v_mov_b32 v24,v116
v_mov_b32 v25,v117
v_mov_b32 v26,v118
v_mov_b32 v27,v119
s_nop 1
s_branch dgo_101087
dcp_101091:
v_mov_b32 v24,v120
v_mov_b32 v25,v121
v_mov_b32 v26,v122
v_mov_b32 v27,v123
s_nop 1
dgo_101087:
v_smfmac_f32_16x16x64_bf16 v[96:99],v[24:27],v[80:87],v1
v_smfmac_f32_16x16x64_bf16 v[100:103],v[24:27],v[88:95],v1
dsk_101086:
s_bitcmp1_b32 s55,3
s_cbranch_scc0 dsk_101092
s_waitcnt vmcnt(2)
v_max3_u32 v124,v28,v29,v30
v_max_u32 v124,v124,v31
v_cmp_eq_u32 vcc,-1,v124
s_cbranch_vccz dgo_101093
s_nop 15
buffer_load_dwordx4 v[116:119],v0,s[20:23],s96 offen offset:3072 sc1
s_nop 15
buffer_load_dwordx4 v[120:123],v0,s[20:23],s96 offen offset:3072 sc1
dlp_101094:
s_waitcnt vmcnt(2)
v_max3_u32 v124,v28,v29,v30
v_max_u32 v124,v124,v31
v_cmp_eq_u32 vcc,-1,v124
s_cbranch_vccz dgo_101093
buffer_load_dwordx4 v[28:31],v0,s[20:23],s96 offen offset:3072 sc1
s_waitcnt vmcnt(2)
v_max3_u32 v124,v116,v117,v118
v_max_u32 v124,v124,v119
v_cmp_eq_u32 vcc,-1,v124
s_cbranch_vccz dcp_101096
buffer_load_dwordx4 v[116:119],v0,s[20:23],s96 offen offset:3072 sc1
s_waitcnt vmcnt(2)
v_max3_u32 v124,v120,v121,v122
v_max_u32 v124,v124,v123
v_cmp_eq_u32 vcc,-1,v124
s_cbranch_vccz dcp_101097
buffer_load_dwordx4 v[120:123],v0,s[20:23],s96 offen offset:3072 sc1
s_sub_u32 s90,s90,1
s_cmp_gt_i32 s90,0
s_cbranch_scc1 dlp_101094
s_branch dgo_101093
dcp_101096:
v_mov_b32 v28,v116
v_mov_b32 v29,v117
v_mov_b32 v30,v118
v_mov_b32 v31,v119
s_nop 1
s_branch dgo_101093
dcp_101097:
v_mov_b32 v28,v120
v_mov_b32 v29,v121
v_mov_b32 v30,v122
v_mov_b32 v31,v123
s_nop 1
dgo_101093:
v_smfmac_f32_16x16x64_bf16 v[96:99],v[28:31],v[128:135],v1
v_smfmac_f32_16x16x64_bf16 v[100:103],v[28:31],v[136:143],v1
dsk_101092:
s_bitcmp1_b32 s55,4
s_cbranch_scc0 dsk_101098
s_waitcnt vmcnt(2)
v_max3_u32 v124,v32,v33,v34
v_max_u32 v124,v124,v35
v_cmp_eq_u32 vcc,-1,v124
s_cbranch_vccz dgo_101099
s_nop 15
buffer_load_dwordx4 v[116:119],v0,s[20:23],s97 offen offset:0 sc1
s_nop 15
buffer_load_dwordx4 v[120:123],v0,s[20:23],s97 offen offset:0 sc1
dlp_101100:
s_waitcnt vmcnt(2)
v_max3_u32 v124,v32,v33,v34
v_max_u32 v124,v124,v35
v_cmp_eq_u32 vcc,-1,v124
s_cbranch_vccz dgo_101099
buffer_load_dwordx4 v[32:35],v0,s[20:23],s97 offen offset:0 sc1
s_waitcnt vmcnt(2)
v_max3_u32 v124,v116,v117,v118
v_max_u32 v124,v124,v119
v_cmp_eq_u32 vcc,-1,v124
s_cbranch_vccz dcp_101102
buffer_load_dwordx4 v[116:119],v0,s[20:23],s97 offen offset:0 sc1
s_waitcnt vmcnt(2)
v_max3_u32 v124,v120,v121,v122
v_max_u32 v124,v124,v123
v_cmp_eq_u32 vcc,-1,v124
s_cbranch_vccz dcp_101103
buffer_load_dwordx4 v[120:123],v0,s[20:23],s97 offen offset:0 sc1
s_sub_u32 s90,s90,1
s_cmp_gt_i32 s90,0
s_cbranch_scc1 dlp_101100
s_branch dgo_101099
dcp_101102:
v_mov_b32 v32,v116
v_mov_b32 v33,v117
v_mov_b32 v34,v118
v_mov_b32 v35,v119
s_nop 1
s_branch dgo_101099
dcp_101103:
v_mov_b32 v32,v120
v_mov_b32 v33,v121
v_mov_b32 v34,v122
v_mov_b32 v35,v123
s_nop 1
dgo_101099:
v_smfmac_f32_16x16x64_bf16 v[96:99],v[32:35],v[144:151],v1
v_smfmac_f32_16x16x64_bf16 v[100:103],v[32:35],v[152:159],v1
dsk_101098:
s_bitcmp1_b32 s55,5
s_cbranch_scc0 dsk_101104
s_waitcnt vmcnt(2)
v_max3_u32 v124,v36,v37,v38
v_max_u32 v124,v124,v39
v_cmp_eq_u32 vcc,-1,v124
s_cbranch_vccz dgo_101105
s_nop 15
buffer_load_dwordx4 v[116:119],v0,s[20:23],s97 offen offset:1024 sc1
s_nop 15
buffer_load_dwordx4 v[120:123],v0,s[20:23],s97 offen offset:1024 sc1
dlp_101106:
s_waitcnt vmcnt(2)
v_max3_u32 v124,v36,v37,v38
v_max_u32 v124,v124,v39
v_cmp_eq_u32 vcc,-1,v124
s_cbranch_vccz dgo_101105
buffer_load_dwordx4 v[36:39],v0,s[20:23],s97 offen offset:1024 sc1
s_waitcnt vmcnt(2)
v_max3_u32 v124,v116,v117,v118
v_max_u32 v124,v124,v119
v_cmp_eq_u32 vcc,-1,v124
s_cbranch_vccz dcp_101108
buffer_load_dwordx4 v[116:119],v0,s[20:23],s97 offen offset:1024 sc1
s_waitcnt vmcnt(2)
v_max3_u32 v124,v120,v121,v122
v_max_u32 v124,v124,v123
v_cmp_eq_u32 vcc,-1,v124
s_cbranch_vccz dcp_101109
buffer_load_dwordx4 v[120:123],v0,s[20:23],s97 offen offset:1024 sc1
s_sub_u32 s90,s90,1
s_cmp_gt_i32 s90,0
s_cbranch_scc1 dlp_101106
s_branch dgo_101105
dcp_101108:
v_mov_b32 v36,v116
v_mov_b32 v37,v117
v_mov_b32 v38,v118
v_mov_b32 v39,v119
s_nop 1
s_branch dgo_101105
dcp_101109:
v_mov_b32 v36,v120
v_mov_b32 v37,v121
v_mov_b32 v38,v122
v_mov_b32 v39,v123
s_nop 1
dgo_101105:
v_smfmac_f32_16x16x64_bf16 v[96:99],v[36:39],v[160:167],v1
v_smfmac_f32_16x16x64_bf16 v[100:103],v[36:39],v[168:175],v1
dsk_101104:
s_bitcmp1_b32 s55,6
s_cbranch_scc0 dsk_101110
s_waitcnt vmcnt(2)
v_max3_u32 v124,v40,v41,v42
v_max_u32 v124,v124,v43
v_cmp_eq_u32 vcc,-1,v124
s_cbranch_vccz dgo_101111
s_nop 15
buffer_load_dwordx4 v[116:119],v0,s[20:23],s97 offen offset:2048 sc1
s_nop 15
buffer_load_dwordx4 v[120:123],v0,s[20:23],s97 offen offset:2048 sc1
dlp_101112:
s_waitcnt vmcnt(2)
v_max3_u32 v124,v40,v41,v42
v_max_u32 v124,v124,v43
v_cmp_eq_u32 vcc,-1,v124
s_cbranch_vccz dgo_101111
buffer_load_dwordx4 v[40:43],v0,s[20:23],s97 offen offset:2048 sc1
s_waitcnt vmcnt(2)
v_max3_u32 v124,v116,v117,v118
v_max_u32 v124,v124,v119
v_cmp_eq_u32 vcc,-1,v124
s_cbranch_vccz dcp_101114
buffer_load_dwordx4 v[116:119],v0,s[20:23],s97 offen offset:2048 sc1
s_waitcnt vmcnt(2)
v_max3_u32 v124,v120,v121,v122
v_max_u32 v124,v124,v123
v_cmp_eq_u32 vcc,-1,v124
s_cbranch_vccz dcp_101115
buffer_load_dwordx4 v[120:123],v0,s[20:23],s97 offen offset:2048 sc1
s_sub_u32 s90,s90,1
s_cmp_gt_i32 s90,0
s_cbranch_scc1 dlp_101112
s_branch dgo_101111
dcp_101114:
v_mov_b32 v40,v116
v_mov_b32 v41,v117
v_mov_b32 v42,v118
v_mov_b32 v43,v119
s_nop 1
s_branch dgo_101111
dcp_101115:
v_mov_b32 v40,v120
v_mov_b32 v41,v121
v_mov_b32 v42,v122
v_mov_b32 v43,v123
s_nop 1
dgo_101111:
v_smfmac_f32_16x16x64_bf16 v[96:99],v[40:43],v[176:183],v1
v_smfmac_f32_16x16x64_bf16 v[100:103],v[40:43],v[184:191],v1
dsk_101110:
s_bitcmp1_b32 s55,7
s_cbranch_scc0 dsk_101116
s_waitcnt vmcnt(2)
v_max3_u32 v124,v44,v45,v46
v_max_u32 v124,v124,v47
v_cmp_eq_u32 vcc,-1,v124
s_cbranch_vccz dgo_101117
s_nop 15
buffer_load_dwordx4 v[116:119],v0,s[20:23],s97 offen offset:3072 sc1
s_nop 15
buffer_load_dwordx4 v[120:123],v0,s[20:23],s97 offen offset:3072 sc1
dlp_101118:
s_waitcnt vmcnt(2)
v_max3_u32 v124,v44,v45,v46
v_max_u32 v124,v124,v47
v_cmp_eq_u32 vcc,-1,v124
s_cbranch_vccz dgo_101117
buffer_load_dwordx4 v[44:47],v0,s[20:23],s97 offen offset:3072 sc1
s_waitcnt vmcnt(2)
v_max3_u32 v124,v116,v117,v118
v_max_u32 v124,v124,v119
v_cmp_eq_u32 vcc,-1,v124
s_cbranch_vccz dcp_101120
buffer_load_dwordx4 v[116:119],v0,s[20:23],s97 offen offset:3072 sc1
s_waitcnt vmcnt(2)
v_max3_u32 v124,v120,v121,v122
v_max_u32 v124,v124,v123
v_cmp_eq_u32 vcc,-1,v124
s_cbranch_vccz dcp_101121
buffer_load_dwordx4 v[120:123],v0,s[20:23],s97 offen offset:3072 sc1
s_sub_u32 s90,s90,1
s_cmp_gt_i32 s90,0
s_cbranch_scc1 dlp_101118
s_branch dgo_101117
dcp_101120:
v_mov_b32 v44,v116
v_mov_b32 v45,v117
v_mov_b32 v46,v118
v_mov_b32 v47,v119
s_nop 1
s_branch dgo_101117
dcp_101121:
v_mov_b32 v44,v120
v_mov_b32 v45,v121
v_mov_b32 v46,v122
v_mov_b32 v47,v123
s_nop 1
dgo_101117:
v_smfmac_f32_16x16x64_bf16 v[96:99],v[44:47],v[192:199],v1
v_smfmac_f32_16x16x64_bf16 v[100:103],v[44:47],v[200:207],v1
dsk_101116:
s_mov_b32 s55,0
s_branch oback_100896
fl_100913:
flb_100921:
buffer_load_dwordx4 v[16:19],v0,s[20:23],s92 offen offset:0 sc1
s_mov_b32 s55,1
buffer_load_dwordx4 v[32:35],v0,s[20:23],s93 offen offset:0 sc1
s_waitcnt vmcnt(4)
v_max3_u32 v124,v20,v21,v22
v_max_u32 v124,v124,v23
v_cmp_eq_u32 vcc,-1,v124
s_cbranch_vccnz dfl_101122
v_smfmac_f32_16x16x64_bf16 v[64:67],v[20:23],a[96:103],v1
buffer_load_dword v125,off,s[20:23],s92 sc1
buffer_load_dwordx4 v[36:39],v0,s[20:23],s93 offen offset:1024 sc1
s_waitcnt vmcnt(5)
v_max3_u32 v124,v24,v25,v26
v_smfmac_f32_16x16x64_bf16 v[68:71],v[20:23],a[104:111],v1
v_max_u32 v124,v124,v27
v_cmp_eq_u32 vcc,-1,v124
v_smfmac_f32_16x16x64_bf16 v[72:75],v[20:23],a[112:119],v1
v_smfmac_f32_16x16x64_bf16 v[76:79],v[20:23],a[120:127],v1
s_cbranch_vccnz dfl_101123
v_smfmac_f32_16x16x64_bf16 v[64:67],v[24:27],a[160:167],v1
buffer_load_dword v125,off,s[20:23],s92 sc1
buffer_load_dwordx4 v[40:43],v0,s[20:23],s93 offen offset:2048 sc1
buffer_load_dwordx4 v[44:47],v0,s[20:23],s93 offen offset:3072 sc1
s_waitcnt vmcnt(7)
v_max3_u32 v124,v28,v29,v30
v_smfmac_f32_16x16x64_bf16 v[68:71],v[24:27],a[168:175],v1
v_max_u32 v124,v124,v31
v_cmp_eq_u32 vcc,-1,v124
v_smfmac_f32_16x16x64_bf16 v[72:75],v[24:27],a[176:183],v1
v_smfmac_f32_16x16x64_bf16 v[76:79],v[24:27],a[184:191],v1
s_cbranch_vccnz dfl_101124
v_smfmac_f32_16x16x64_bf16 v[64:67],v[28:31],a[224:231],v1
buffer_load_dword v125,off,s[20:23],s92 sc1
buffer_store_dword v126,v121,s[20:23],s69 offen sc1
s_waitcnt vmcnt(8)
v_max3_u32 v124,v16,v17,v18
v_smfmac_f32_16x16x64_bf16 v[68:71],v[28:31],a[232:239],v1
v_max_u32 v124,v124,v19
v_cmp_eq_u32 vcc,-1,v124
v_smfmac_f32_16x16x64_bf16 v[72:75],v[28:31],a[240:247],v1
v_smfmac_f32_16x16x64_bf16 v[76:79],v[28:31],a[248:255],v1
s_cbranch_vccnz lfb_101129
s_mov_b32 s55,0
v_smfmac_f32_16x16x64_bf16 v[64:67],v[16:19],a[32:39],v1
s_waitcnt vmcnt(7)
v_max3_u32 v124,v32,v33,v34
v_max_u32 v124,v124,v35
v_cmp_eq_u32 vcc,-1,v124
v_smfmac_f32_16x16x64_bf16 v[68:71],v[16:19],a[40:47],v1
v_smfmac_f32_16x16x64_bf16 v[72:75],v[16:19],a[48:55],v1
v_smfmac_f32_16x16x64_bf16 v[76:79],v[16:19],a[56:63],v1
s_cbranch_vccnz flb_100925
s_branch segb_100909
fl_100914:
flb_100922:
buffer_load_dwordx4 v[20:23],v0,s[20:23],s92 offen offset:1024 sc1
s_mov_b32 s55,2
buffer_load_dwordx4 v[36:39],v0,s[20:23],s93 offen offset:1024 sc1
s_waitcnt vmcnt(5)
v_max3_u32 v124,v24,v25,v26
v_max_u32 v124,v124,v27
v_cmp_eq_u32 vcc,-1,v124
s_cbranch_vccnz dfl_101123
v_smfmac_f32_16x16x64_bf16 v[64:67],v[24:27],a[160:167],v1
buffer_load_dword v125,off,s[20:23],s92 sc1
buffer_load_dwordx4 v[40:43],v0,s[20:23],s93 offen offset:2048 sc1
buffer_load_dwordx4 v[44:47],v0,s[20:23],s93 offen offset:3072 sc1
s_waitcnt vmcnt(7)
v_max3_u32 v124,v28,v29,v30
v_smfmac_f32_16x16x64_bf16 v[68:71],v[24:27],a[168:175],v1
v_max_u32 v124,v124,v31
v_cmp_eq_u32 vcc,-1,v124
v_smfmac_f32_16x16x64_bf16 v[72:75],v[24:27],a[176:183],v1
v_smfmac_f32_16x16x64_bf16 v[76:79],v[24:27],a[184:191],v1
s_cbranch_vccnz dfl_101124
v_smfmac_f32_16x16x64_bf16 v[64:67],v[28:31],a[224:231],v1
buffer_load_dword v125,off,s[20:23],s92 sc1
buffer_store_dword v126,v121,s[20:23],s69 offen sc1
s_waitcnt vmcnt(6)
v_max3_u32 v124,v20,v21,v22
v_smfmac_f32_16x16x64_bf16 v[68:71],v[28:31],a[232:239],v1
v_max_u32 v124,v124,v23
v_cmp_eq_u32 vcc,-1,v124
v_smfmac_f32_16x16x64_bf16 v[72:75],v[28:31],a[240:247],v1
v_smfmac_f32_16x16x64_bf16 v[76:79],v[28:31],a[248:255],v1
s_cbranch_vccnz lfb_101129
s_mov_b32 s55,0
v_smfmac_f32_16x16x64_bf16 v[64:67],v[20:23],a[96:103],v1
s_waitcnt vmcnt(7)
v_max3_u32 v124,v32,v33,v34
v_max_u32 v124,v124,v35
v_cmp_eq_u32 vcc,-1,v124
v_smfmac_f32_16x16x64_bf16 v[68:71],v[20:23],a[104:111],v1
v_smfmac_f32_16x16x64_bf16 v[72:75],v[20:23],a[112:119],v1
v_smfmac_f32_16x16x64_bf16 v[76:79],v[20:23],a[120:127],v1
s_cbranch_vccnz flb_100925
s_branch segb_100909
fl_100915:
flb_100923:
buffer_load_dwordx4 v[24:27],v0,s[20:23],s92 offen offset:2048 sc1
s_mov_b32 s55,4
buffer_load_dwordx4 v[40:43],v0,s[20:23],s93 offen offset:2048 sc1
buffer_load_dwordx4 v[44:47],v0,s[20:23],s93 offen offset:3072 sc1
s_waitcnt vmcnt(7)
v_max3_u32 v124,v28,v29,v30
v_max_u32 v124,v124,v31
v_cmp_eq_u32 vcc,-1,v124
s_cbranch_vccnz dfl_101124
v_smfmac_f32_16x16x64_bf16 v[64:67],v[28:31],a[224:231],v1
buffer_load_dword v125,off,s[20:23],s92 sc1
buffer_store_dword v126,v121,s[20:23],s69 offen sc1
s_waitcnt vmcnt(4)
v_max3_u32 v124,v24,v25,v26
v_smfmac_f32_16x16x64_bf16 v[68:71],v[28:31],a[232:239],v1
v_max_u32 v124,v124,v27
v_cmp_eq_u32 vcc,-1,v124
v_smfmac_f32_16x16x64_bf16 v[72:75],v[28:31],a[240:247],v1
v_smfmac_f32_16x16x64_bf16 v[76:79],v[28:31],a[248:255],v1
s_cbranch_vccnz lfb_101129
s_mov_b32 s55,0
v_smfmac_f32_16x16x64_bf16 v[64:67],v[24:27],a[160:167],v1
s_waitcnt vmcnt(7)
v_max3_u32 v124,v32,v33,v34
v_max_u32 v124,v124,v35
v_cmp_eq_u32 vcc,-1,v124
v_smfmac_f32_16x16x64_bf16 v[68:71],v[24:27],a[168:175],v1
v_smfmac_f32_16x16x64_bf16 v[72:75],v[24:27],a[176:183],v1
v_smfmac_f32_16x16x64_bf16 v[76:79],v[24:27],a[184:191],v1
s_cbranch_vccnz flb_100925
s_branch segb_100909
fl_100916:
flb_100924:
buffer_load_dwordx4 v[28:31],v0,s[20:23],s92 offen offset:3072 sc1
s_mov_b32 s55,8
buffer_store_dword v126,v121,s[20:23],s69 offen sc1
s_waitcnt vmcnt(1)
v_max3_u32 v124,v28,v29,v30
v_max_u32 v124,v124,v31
v_cmp_eq_u32 vcc,-1,v124
s_cbranch_vccnz lfb_101129
s_mov_b32 s55,0
v_smfmac_f32_16x16x64_bf16 v[64:67],v[28:31],a[224:231],v1
s_waitcnt vmcnt(7)
v_max3_u32 v124,v32,v33,v34
v_max_u32 v124,v124,v35
v_cmp_eq_u32 vcc,-1,v124
v_smfmac_f32_16x16x64_bf16 v[68:71],v[28:31],a[232:239],v1
v_smfmac_f32_16x16x64_bf16 v[72:75],v[28:31],a[240:247],v1
v_smfmac_f32_16x16x64_bf16 v[76:79],v[28:31],a[248:255],v1
s_cbranch_vccnz flb_100925
s_branch segb_100909
fl_100917:
flb_100925:
buffer_load_dwordx4 v[32:35],v0,s[20:23],s93 offen offset:0 sc1
s_mov_b32 s55,240
s_bitcmp1_b32 s55,5
s_cbranch_scc0 rdn_101132
s_waitcnt vmcnt(6)
v_max3_u32 v124,v36,v37,v38
v_max_u32 v124,v124,v39
v_cmp_eq_u32 vcc,-1,v124
s_cbranch_vccnz rfa_101133
buffer_load_dword v125,off,s[20:23],s92 sc1
s_bitset0_b32 s55,5
v_smfmac_f32_16x16x64_bf16 v[64:67],v[36:39],a[96:103],v1
v_smfmac_f32_16x16x64_bf16 v[68:71],v[36:39],a[104:111],v1
v_smfmac_f32_16x16x64_bf16 v[72:75],v[36:39],a[112:119],v1
v_smfmac_f32_16x16x64_bf16 v[76:79],v[36:39],a[120:127],v1
s_cmp_eq_u32 s55,0
s_cbranch_scc1 segb_100911
s_branch rnx_101134
rdn_101132:
buffer_load_dword v125,off,s[20:23],s92 sc1
s_branch rnx_101134
rfa_101133:
buffer_load_dwordx4 v[36:39],v0,s[20:23],s93 offen offset:1024 sc1
rnx_101134:
s_bitcmp1_b32 s55,6
s_cbranch_scc0 rdn_101135
s_waitcnt vmcnt(5)
v_max3_u32 v124,v40,v41,v42
v_max_u32 v124,v124,v43
v_cmp_eq_u32 vcc,-1,v124
s_cbranch_vccnz rfa_101136
buffer_load_dword v125,off,s[20:23],s92 sc1
s_bitset0_b32 s55,6
s_cmp_eq_u32 s55,0
s_cbranch_scc1 segb_100911
s_branch rnx_101137
rdn_101135:
buffer_load_dword v125,off,s[20:23],s92 sc1
s_branch rnx_101137
rfa_101136:
buffer_load_dwordx4 v[40:43],v0,s[20:23],s93 offen offset:2048 sc1
rnx_101137:
s_bitcmp1_b32 s55,7
s_cbranch_scc0 rdn_101138
s_waitcnt vmcnt(5)
v_max3_u32 v124,v44,v45,v46
v_max_u32 v124,v124,v47
v_cmp_eq_u32 vcc,-1,v124
s_cbranch_vccnz rfa_101139
buffer_load_dword v125,off,s[20:23],s92 sc1
s_bitset0_b32 s55,7
s_cmp_eq_u32 s55,0
s_cbranch_scc1 segb_100911
s_branch rnx_101140
rdn_101138:
buffer_load_dword v125,off,s[20:23],s92 sc1
s_branch rnx_101140
rfa_101139:
buffer_load_dwordx4 v[44:47],v0,s[20:23],s93 offen offset:3072 sc1
rnx_101140:
rot_101131:
s_bitcmp1_b32 s55,4
s_cbranch_scc0 rdn_101141
s_waitcnt vmcnt(3)
v_max3_u32 v124,v32,v33,v34
v_max_u32 v124,v124,v35
v_cmp_eq_u32 vcc,-1,v124
s_cbranch_vccnz rfa_101142
buffer_load_dword v125,off,s[20:23],s92 sc1
s_bitset0_b32 s55,4
v_smfmac_f32_16x16x64_bf16 v[64:67],v[32:35],a[32:39],v1
v_smfmac_f32_16x16x64_bf16 v[68:71],v[32:35],a[40:47],v1
v_smfmac_f32_16x16x64_bf16 v[72:75],v[32:35],a[48:55],v1
v_smfmac_f32_16x16x64_bf16 v[76:79],v[32:35],a[56:63],v1
s_cmp_eq_u32 s55,0
s_cbranch_scc1 segb_100911
s_branch rnx_101143
rdn_101141:
buffer_load_dword v125,off,s[20:23],s92 sc1
s_branch rnx_101143
rfa_101142:
buffer_load_dwordx4 v[32:35],v0,s[20:23],s93 offen offset:0 sc1
rnx_101143:
s_bitcmp1_b32 s55,5
s_cbranch_scc0 rdn_101144
s_waitcnt vmcnt(3)
v_max3_u32 v124,v36,v37,v38
v_max_u32 v124,v124,v39
v_cmp_eq_u32 vcc,-1,v124
s_cbranch_vccnz rfa_101145
buffer_load_dword v125,off,s[20:23],s92 sc1
s_bitset0_b32 s55,5
v_smfmac_f32_16x16x64_bf16 v[64:67],v[36:39],a[96:103],v1
v_smfmac_f32_16x16x64_bf16 v[68:71],v[36:39],a[104:111],v1
v_smfmac_f32_16x16x64_bf16 v[72:75],v[36:39],a[112:119],v1
v_smfmac_f32_16x16x64_bf16 v[76:79],v[36:39],a[120:127],v1
s_cmp_eq_u32 s55,0
s_cbranch_scc1 segb_100911
s_branch rnx_101146
rdn_101144:
buffer_load_dword v125,off,s[20:23],s92 sc1
s_branch rnx_101146
rfa_101145:
buffer_load_dwordx4 v[36:39],v0,s[20:23],s93 offen offset:1024 sc1
rnx_101146:
s_bitcmp1_b32 s55,6
s_cbranch_scc0 rdn_101147
s_waitcnt vmcnt(3)
v_max3_u32 v124,v40,v41,v42
v_max_u32 v124,v124,v43
v_cmp_eq_u32 vcc,-1,v124
s_cbranch_vccnz rfa_101148
buffer_load_dword v125,off,s[20:23],s92 sc1
s_bitset0_b32 s55,6
s_cmp_eq_u32 s55,0
s_cbranch_scc1 segb_100911
s_branch rnx_101149
rdn_101147:
buffer_load_dword v125,off,s[20:23],s92 sc1
s_branch rnx_101149
rfa_101148:
buffer_load_dwordx4 v[40:43],v0,s[20:23],s93 offen offset:2048 sc1
rnx_101149:
s_bitcmp1_b32 s55,7
s_cbranch_scc0 rdn_101150
s_waitcnt vmcnt(3)
v_max3_u32 v124,v44,v45,v46
v_max_u32 v124,v124,v47
v_cmp_eq_u32 vcc,-1,v124
s_cbranch_vccnz rfa_101151
buffer_load_dword v125,off,s[20:23],s92 sc1
s_bitset0_b32 s55,7
s_cmp_eq_u32 s55,0
s_cbranch_scc1 segb_100911
s_branch rnx_101152
rdn_101150:
buffer_load_dword v125,off,s[20:23],s92 sc1
s_branch rnx_101152
rfa_101151:
buffer_load_dwordx4 v[44:47],v0,s[20:23],s93 offen offset:3072 sc1
rnx_101152:
s_sub_u32 s90,s90,1
s_cmp_gt_i32 s90,0
s_cbranch_scc1 rot_101131
s_mov_b32 s55,0
s_branch segb_100911
fl_100918:
flb_100926:
buffer_load_dwordx4 v[36:39],v0,s[20:23],s93 offen offset:1024 sc1
s_mov_b32 s55,224
s_bitcmp1_b32 s55,6
s_cbranch_scc0 rdn_101154
s_waitcnt vmcnt(5)
v_max3_u32 v124,v40,v41,v42
v_max_u32 v124,v124,v43
v_cmp_eq_u32 vcc,-1,v124
s_cbranch_vccnz rfa_101155
buffer_load_dword v125,off,s[20:23],s92 sc1
s_bitset0_b32 s55,6
s_cmp_eq_u32 s55,0
s_cbranch_scc1 segb_100911
s_branch rnx_101156
rdn_101154:
buffer_load_dword v125,off,s[20:23],s92 sc1
s_branch rnx_101156
rfa_101155:
buffer_load_dwordx4 v[40:43],v0,s[20:23],s93 offen offset:2048 sc1
rnx_101156:
s_bitcmp1_b32 s55,7
s_cbranch_scc0 rdn_101157
s_waitcnt vmcnt(5)
v_max3_u32 v124,v44,v45,v46
v_max_u32 v124,v124,v47
v_cmp_eq_u32 vcc,-1,v124
s_cbranch_vccnz rfa_101158
buffer_load_dword v125,off,s[20:23],s92 sc1
s_bitset0_b32 s55,7
s_cmp_eq_u32 s55,0
s_cbranch_scc1 segb_100911
s_branch rnx_101159
rdn_101157:
buffer_load_dword v125,off,s[20:23],s92 sc1
s_branch rnx_101159
rfa_101158:
buffer_load_dwordx4 v[44:47],v0,s[20:23],s93 offen offset:3072 sc1
rnx_101159:
rot_101153:
s_bitcmp1_b32 s55,5
s_cbranch_scc0 rdn_101160
s_waitcnt vmcnt(2)
v_max3_u32 v124,v36,v37,v38
v_max_u32 v124,v124,v39
v_cmp_eq_u32 vcc,-1,v124
s_cbranch_vccnz rfa_101161
buffer_load_dword v125,off,s[20:23],s92 sc1
s_bitset0_b32 s55,5
v_smfmac_f32_16x16x64_bf16 v[64:67],v[36:39],a[96:103],v1
v_smfmac_f32_16x16x64_bf16 v[68:71],v[36:39],a[104:111],v1
v_smfmac_f32_16x16x64_bf16 v[72:75],v[36:39],a[112:119],v1
v_smfmac_f32_16x16x64_bf16 v[76:79],v[36:39],a[120:127],v1
s_cmp_eq_u32 s55,0
s_cbranch_scc1 segb_100911
s_branch rnx_101162
rdn_101160:
buffer_load_dword v125,off,s[20:23],s92 sc1
s_branch rnx_101162
rfa_101161:
buffer_load_dwordx4 v[36:39],v0,s[20:23],s93 offen offset:1024 sc1
rnx_101162:
s_bitcmp1_b32 s55,6
s_cbranch_scc0 rdn_101163
s_waitcnt vmcnt(2)
v_max3_u32 v124,v40,v41,v42
v_max_u32 v124,v124,v43
v_cmp_eq_u32 vcc,-1,v124
s_cbranch_vccnz rfa_101164
buffer_load_dword v125,off,s[20:23],s92 sc1
s_bitset0_b32 s55,6
s_cmp_eq_u32 s55,0
s_cbranch_scc1 segb_100911
s_branch rnx_101165
rdn_101163:
buffer_load_dword v125,off,s[20:23],s92 sc1
s_branch rnx_101165
rfa_101164:
buffer_load_dwordx4 v[40:43],v0,s[20:23],s93 offen offset:2048 sc1
rnx_101165:
s_bitcmp1_b32 s55,7
s_cbranch_scc0 rdn_101166
s_waitcnt vmcnt(2)
v_max3_u32 v124,v44,v45,v46
v_max_u32 v124,v124,v47
v_cmp_eq_u32 vcc,-1,v124
s_cbranch_vccnz rfa_101167
buffer_load_dword v125,off,s[20:23],s92 sc1
s_bitset0_b32 s55,7
s_cmp_eq_u32 s55,0
s_cbranch_scc1 segb_100911
s_branch rnx_101168
rdn_101166:
buffer_load_dword v125,off,s[20:23],s92 sc1
s_branch rnx_101168
rfa_101167:
buffer_load_dwordx4 v[44:47],v0,s[20:23],s93 offen offset:3072 sc1
rnx_101168:
s_sub_u32 s90,s90,1
s_cmp_gt_i32 s90,0
s_cbranch_scc1 rot_101153
s_mov_b32 s55,0
s_branch segb_100911
fl_100919:
flb_100927:
s_mov_b32 s55,192
s_bitcmp1_b32 s55,6
s_cbranch_scc0 rdn_101170
s_waitcnt vmcnt(5)
v_max3_u32 v124,v40,v41,v42
v_max_u32 v124,v124,v43
v_cmp_eq_u32 vcc,-1,v124
s_cbranch_vccnz rfa_101171
buffer_load_dword v125,off,s[20:23],s92 sc1
s_bitset0_b32 s55,6
s_cmp_eq_u32 s55,0
s_cbranch_scc1 segb_100911
s_branch rnx_101172
rdn_101170:
buffer_load_dword v125,off,s[20:23],s92 sc1
s_branch rnx_101172
rfa_101171:
buffer_load_dwordx4 v[40:43],v0,s[20:23],s93 offen offset:2048 sc1
rnx_101172:
s_bitcmp1_b32 s55,7
s_cbranch_scc0 rdn_101173
s_waitcnt vmcnt(5)
v_max3_u32 v124,v44,v45,v46
v_max_u32 v124,v124,v47
v_cmp_eq_u32 vcc,-1,v124
s_cbranch_vccnz rfa_101174
buffer_load_dword v125,off,s[20:23],s92 sc1
s_bitset0_b32 s55,7
s_cmp_eq_u32 s55,0
s_cbranch_scc1 segb_100911
s_branch rnx_101175
rdn_101173:
buffer_load_dword v125,off,s[20:23],s92 sc1
s_branch rnx_101175
rfa_101174:
buffer_load_dwordx4 v[44:47],v0,s[20:23],s93 offen offset:3072 sc1
rnx_101175:
rot_101169:
s_bitcmp1_b32 s55,6
s_cbranch_scc0 rdn_101176
s_waitcnt vmcnt(1)
v_max3_u32 v124,v40,v41,v42
v_max_u32 v124,v124,v43
v_cmp_eq_u32 vcc,-1,v124
s_cbranch_vccnz rfa_101177
buffer_load_dword v125,off,s[20:23],s92 sc1
s_bitset0_b32 s55,6
s_cmp_eq_u32 s55,0
s_cbranch_scc1 segb_100911
s_branch rnx_101178
rdn_101176:
buffer_load_dword v125,off,s[20:23],s92 sc1
s_branch rnx_101178
rfa_101177:
buffer_load_dwordx4 v[40:43],v0,s[20:23],s93 offen offset:2048 sc1
rnx_101178:
s_bitcmp1_b32 s55,7
s_cbranch_scc0 rdn_101179
s_waitcnt vmcnt(1)
v_max3_u32 v124,v44,v45,v46
v_max_u32 v124,v124,v47
v_cmp_eq_u32 vcc,-1,v124
s_cbranch_vccnz rfa_101180
buffer_load_dword v125,off,s[20:23],s92 sc1
s_bitset0_b32 s55,7
s_cmp_eq_u32 s55,0
s_cbranch_scc1 segb_100911
s_branch rnx_101181
rdn_101179:
buffer_load_dword v125,off,s[20:23],s92 sc1
s_branch rnx_101181
rfa_101180:
buffer_load_dwordx4 v[44:47],v0,s[20:23],s93 offen offset:3072 sc1
rnx_101181:
s_sub_u32 s90,s90,1
s_cmp_gt_i32 s90,0
s_cbranch_scc1 rot_101169
s_mov_b32 s55,0
s_branch segb_100911
dfl_101122:
buffer_load_dwordx4 v[20:23],v0,s[20:23],s92 offen offset:1024 sc1
s_bitset1_b32 s55,1
buffer_load_dwordx4 v[36:39],v0,s[20:23],s93 offen offset:1024 sc1
s_waitcnt vmcnt(5)
v_max3_u32 v124,v24,v25,v26
v_max_u32 v124,v124,v27
v_cmp_eq_u32 vcc,-1,v124
s_cbranch_vccnz dfl_101123
s_branch dseg_101126
dfl_101123:
buffer_load_dwordx4 v[24:27],v0,s[20:23],s92 offen offset:2048 sc1
s_bitset1_b32 s55,2
buffer_load_dwordx4 v[40:43],v0,s[20:23],s93 offen offset:2048 sc1
buffer_load_dwordx4 v[44:47],v0,s[20:23],s93 offen offset:3072 sc1
s_waitcnt vmcnt(7)
v_max3_u32 v124,v28,v29,v30
v_max_u32 v124,v124,v31
v_cmp_eq_u32 vcc,-1,v124
s_cbranch_vccnz dfl_101124
s_branch dseg_101127
dfl_101124:
buffer_load_dwordx4 v[28:31],v0,s[20:23],s92 offen offset:3072 sc1
s_bitset1_b32 s55,3
buffer_store_dword v126,v121,s[20:23],s69 offen sc1
s_branch lap2_101128
dseg_101126:
v_smfmac_f32_16x16x64_bf16 v[64:67],v[24:27],a[160:167],v1
buffer_load_dword v125,off,s[20:23],s92 sc1
buffer_load_dwordx4 v[40:43],v0,s[20:23],s93 offen offset:2048 sc1
buffer_load_dwordx4 v[44:47],v0,s[20:23],s93 offen offset:3072 sc1
s_waitcnt vmcnt(7)
v_max3_u32 v124,v28,v29,v30
v_smfmac_f32_16x16x64_bf16 v[68:71],v[24:27],a[168:175],v1
v_max_u32 v124,v124,v31
v_cmp_eq_u32 vcc,-1,v124
v_smfmac_f32_16x16x64_bf16 v[72:75],v[24:27],a[176:183],v1
v_smfmac_f32_16x16x64_bf16 v[76:79],v[24:27],a[184:191],v1
s_cbranch_vccnz dfl_101124
dseg_101127:
v_smfmac_f32_16x16x64_bf16 v[64:67],v[28:31],a[224:231],v1
buffer_load_dword v125,off,s[20:23],s92 sc1
v_smfmac_f32_16x16x64_bf16 v[68:71],v[28:31],a[232:239],v1
buffer_store_dword v126,v121,s[20:23],s69 offen sc1
v_smfmac_f32_16x16x64_bf16 v[72:75],v[28:31],a[240:247],v1
v_smfmac_f32_16x16x64_bf16 v[76:79],v[28:31],a[248:255],v1
lap2_101128:
s_bitcmp1_b32 s55,0
s_cbranch_scc0 l2s_101182
s_waitcnt vmcnt(8)
v_max3_u32 v124,v16,v17,v18
v_max_u32 v124,v124,v19
v_cmp_eq_u32 vcc,-1,v124
s_cbranch_vccnz l2s_101182
s_bitset0_b32 s55,0
v_smfmac_f32_16x16x64_bf16 v[64:67],v[16:19],a[32:39],v1
v_smfmac_f32_16x16x64_bf16 v[68:71],v[16:19],a[40:47],v1
v_smfmac_f32_16x16x64_bf16 v[72:75],v[16:19],a[48:55],v1
v_smfmac_f32_16x16x64_bf16 v[76:79],v[16:19],a[56:63],v1
l2s_101182:
s_bitcmp1_b32 s55,1
s_cbranch_scc0 l2s_101184
s_waitcnt vmcnt(6)
v_max3_u32 v124,v20,v21,v22
v_max_u32 v124,v124,v23
v_cmp_eq_u32 vcc,-1,v124
s_cbranch_vccnz l2s_101184
s_bitset0_b32 s55,1
v_smfmac_f32_16x16x64_bf16 v[64:67],v[20:23],a[96:103],v1
v_smfmac_f32_16x16x64_bf16 v[68:71],v[20:23],a[104:111],v1
v_smfmac_f32_16x16x64_bf16 v[72:75],v[20:23],a[112:119],v1
v_smfmac_f32_16x16x64_bf16 v[76:79],v[20:23],a[120:127],v1
l2s_101184:
s_bitcmp1_b32 s55,2
s_cbranch_scc0 l2s_101186
s_waitcnt vmcnt(4)
v_max3_u32 v124,v24,v25,v26
v_max_u32 v124,v124,v27
v_cmp_eq_u32 vcc,-1,v124
s_cbranch_vccnz l2s_101186
s_bitset0_b32 s55,2
v_smfmac_f32_16x16x64_bf16 v[64:67],v[24:27],a[160:167],v1
v_smfmac_f32_16x16x64_bf16 v[68:71],v[24:27],a[168:175],v1
v_smfmac_f32_16x16x64_bf16 v[72:75],v[24:27],a[176:183],v1
v_smfmac_f32_16x16x64_bf16 v[76:79],v[24:27],a[184:191],v1
l2s_101186:
s_bitcmp1_b32 s55,3
s_cbranch_scc0 l2s_101188
s_waitcnt vmcnt(1)
v_max3_u32 v124,v28,v29,v30
v_max_u32 v124,v124,v31
v_cmp_eq_u32 vcc,-1,v124
s_cbranch_vccnz l2s_101188
s_bitset0_b32 s55,3
v_smfmac_f32_16x16x64_bf16 v[64:67],v[28:31],a[224:231],v1
v_smfmac_f32_16x16x64_bf16 v[68:71],v[28:31],a[232:239],v1
v_smfmac_f32_16x16x64_bf16 v[72:75],v[28:31],a[240:247],v1
v_smfmac_f32_16x16x64_bf16 v[76:79],v[28:31],a[248:255],v1
l2s_101188:
s_cmp_eq_u32 s55,0
s_cbranch_scc0 lfb_101129
Ldone_101130:
s_waitcnt vmcnt(7)
v_max3_u32 v124,v32,v33,v34
v_max_u32 v124,v124,v35
v_cmp_eq_u32 vcc,-1,v124
s_cbranch_vccnz flb_100925
s_branch segb_100909
lfb_101129:
s_bitcmp1_b32 s55,0
s_cbranch_scc0 dsk_101190
buffer_load_dwordx4 v[16:19],v0,s[20:23],s92 offen offset:0 sc1
dsk_101190:
s_bitcmp1_b32 s55,1
s_cbranch_scc0 dsk_101191
buffer_load_dwordx4 v[20:23],v0,s[20:23],s92 offen offset:1024 sc1
dsk_101191:
s_bitcmp1_b32 s55,2
s_cbranch_scc0 dsk_101192
buffer_load_dwordx4 v[24:27],v0,s[20:23],s92 offen offset:2048 sc1
dsk_101192:
s_bitcmp1_b32 s55,3
s_cbranch_scc0 dsk_101193
buffer_load_dwordx4 v[28:31],v0,s[20:23],s92 offen offset:3072 sc1
dsk_101193:
s_bitcmp1_b32 s55,0
s_cbranch_scc0 dsk_101194
s_waitcnt vmcnt(2)
v_max3_u32 v124,v16,v17,v18
v_max_u32 v124,v124,v19
v_cmp_eq_u32 vcc,-1,v124
s_cbranch_vccz dgo_101195
s_nop 15
buffer_load_dwordx4 v[104:107],v0,s[20:23],s92 offen offset:0 sc1
s_nop 15
buffer_load_dwordx4 v[108:111],v0,s[20:23],s92 offen offset:0 sc1
dlp_101196:
s_waitcnt vmcnt(2)
v_max3_u32 v124,v16,v17,v18
v_max_u32 v124,v124,v19
v_cmp_eq_u32 vcc,-1,v124
s_cbranch_vccz dgo_101195
buffer_load_dwordx4 v[16:19],v0,s[20:23],s92 offen offset:0 sc1
s_waitcnt vmcnt(2)
v_max3_u32 v124,v104,v105,v106
v_max_u32 v124,v124,v107
v_cmp_eq_u32 vcc,-1,v124
s_cbranch_vccz dcp_101198
buffer_load_dwordx4 v[104:107],v0,s[20:23],s92 offen offset:0 sc1
s_waitcnt vmcnt(2)
v_max3_u32 v124,v108,v109,v110
v_max_u32 v124,v124,v111
v_cmp_eq_u32 vcc,-1,v124
s_cbranch_vccz dcp_101199
buffer_load_dwordx4 v[108:111],v0,s[20:23],s92 offen offset:0 sc1
s_sub_u32 s90,s90,1
s_cmp_gt_i32 s90,0
s_cbranch_scc1 dlp_101196
s_branch dgo_101195
dcp_101198:
v_mov_b32 v16,v104
v_mov_b32 v17,v105
v_mov_b32 v18,v106
v_mov_b32 v19,v107
s_nop 1
s_branch dgo_101195
dcp_101199:
v_mov_b32 v16,v108
v_mov_b32 v17,v109
v_mov_b32 v18,v110
v_mov_b32 v19,v111
s_nop 1
dgo_101195:
v_smfmac_f32_16x16x64_bf16 v[64:67],v[16:19],a[32:39],v1
v_smfmac_f32_16x16x64_bf16 v[68:71],v[16:19],a[40:47],v1
v_smfmac_f32_16x16x64_bf16 v[72:75],v[16:19],a[48:55],v1
v_smfmac_f32_16x16x64_bf16 v[76:79],v[16:19],a[56:63],v1
dsk_101194:
s_bitcmp1_b32 s55,1
s_cbranch_scc0 dsk_101200
s_waitcnt vmcnt(2)
v_max3_u32 v124,v20,v21,v22
v_max_u32 v124,v124,v23
v_cmp_eq_u32 vcc,-1,v124
s_cbranch_vccz dgo_101201
s_nop 15
buffer_load_dwordx4 v[104:107],v0,s[20:23],s92 offen offset:1024 sc1
s_nop 15
buffer_load_dwordx4 v[108:111],v0,s[20:23],s92 offen offset:1024 sc1
dlp_101202:
s_waitcnt vmcnt(2)
v_max3_u32 v124,v20,v21,v22
v_max_u32 v124,v124,v23
v_cmp_eq_u32 vcc,-1,v124
s_cbranch_vccz dgo_101201
buffer_load_dwordx4 v[20:23],v0,s[20:23],s92 offen offset:1024 sc1
s_waitcnt vmcnt(2)
v_max3_u32 v124,v104,v105,v106
v_max_u32 v124,v124,v107
v_cmp_eq_u32 vcc,-1,v124
s_cbranch_vccz dcp_101204
buffer_load_dwordx4 v[104:107],v0,s[20:23],s92 offen offset:1024 sc1
s_waitcnt vmcnt(2)
v_max3_u32 v124,v108,v109,v110
v_max_u32 v124,v124,v111
v_cmp_eq_u32 vcc,-1,v124
s_cbranch_vccz dcp_101205
buffer_load_dwordx4 v[108:111],v0,s[20:23],s92 offen offset:1024 sc1
s_sub_u32 s90,s90,1
s_cmp_gt_i32 s90,0
s_cbranch_scc1 dlp_101202
s_branch dgo_101201
dcp_101204:
v_mov_b32 v20,v104
v_mov_b32 v21,v105
v_mov_b32 v22,v106
v_mov_b32 v23,v107
s_nop 1
s_branch dgo_101201
dcp_101205:
v_mov_b32 v20,v108
v_mov_b32 v21,v109
v_mov_b32 v22,v110
v_mov_b32 v23,v111
s_nop 1
dgo_101201:
v_smfmac_f32_16x16x64_bf16 v[64:67],v[20:23],a[96:103],v1
v_smfmac_f32_16x16x64_bf16 v[68:71],v[20:23],a[104:111],v1
v_smfmac_f32_16x16x64_bf16 v[72:75],v[20:23],a[112:119],v1
v_smfmac_f32_16x16x64_bf16 v[76:79],v[20:23],a[120:127],v1
dsk_101200:
s_bitcmp1_b32 s55,2
s_cbranch_scc0 dsk_101206
s_waitcnt vmcnt(2)
v_max3_u32 v124,v24,v25,v26
v_max_u32 v124,v124,v27
v_cmp_eq_u32 vcc,-1,v124
s_cbranch_vccz dgo_101207
s_nop 15
buffer_load_dwordx4 v[104:107],v0,s[20:23],s92 offen offset:2048 sc1
s_nop 15
buffer_load_dwordx4 v[108:111],v0,s[20:23],s92 offen offset:2048 sc1
dlp_101208:
s_waitcnt vmcnt(2)
v_max3_u32 v124,v24,v25,v26
v_max_u32 v124,v124,v27
v_cmp_eq_u32 vcc,-1,v124
s_cbranch_vccz dgo_101207
buffer_load_dwordx4 v[24:27],v0,s[20:23],s92 offen offset:2048 sc1
s_waitcnt vmcnt(2)
v_max3_u32 v124,v104,v105,v106
v_max_u32 v124,v124,v107
v_cmp_eq_u32 vcc,-1,v124
s_cbranch_vccz dcp_101210
buffer_load_dwordx4 v[104:107],v0,s[20:23],s92 offen offset:2048 sc1
s_waitcnt vmcnt(2)
v_max3_u32 v124,v108,v109,v110
v_max_u32 v124,v124,v111
v_cmp_eq_u32 vcc,-1,v124
s_cbranch_vccz dcp_101211
buffer_load_dwordx4 v[108:111],v0,s[20:23],s92 offen offset:2048 sc1
s_sub_u32 s90,s90,1
s_cmp_gt_i32 s90,0
s_cbranch_scc1 dlp_101208
s_branch dgo_101207
dcp_101210:
v_mov_b32 v24,v104
v_mov_b32 v25,v105
v_mov_b32 v26,v106
v_mov_b32 v27,v107
s_nop 1
s_branch dgo_101207
dcp_101211:
v_mov_b32 v24,v108
v_mov_b32 v25,v109
v_mov_b32 v26,v110
v_mov_b32 v27,v111
s_nop 1
dgo_101207:
v_smfmac_f32_16x16x64_bf16 v[64:67],v[24:27],a[160:167],v1
v_smfmac_f32_16x16x64_bf16 v[68:71],v[24:27],a[168:175],v1
v_smfmac_f32_16x16x64_bf16 v[72:75],v[24:27],a[176:183],v1
v_smfmac_f32_16x16x64_bf16 v[76:79],v[24:27],a[184:191],v1
dsk_101206:
s_bitcmp1_b32 s55,3
s_cbranch_scc0 dsk_101212
s_waitcnt vmcnt(2)
v_max3_u32 v124,v28,v29,v30
v_max_u32 v124,v124,v31
v_cmp_eq_u32 vcc,-1,v124
s_cbranch_vccz dgo_101213
s_nop 15
buffer_load_dwordx4 v[104:107],v0,s[20:23],s92 offen offset:3072 sc1
s_nop 15
buffer_load_dwordx4 v[108:111],v0,s[20:23],s92 offen offset:3072 sc1
dlp_101214:
s_waitcnt vmcnt(2)
v_max3_u32 v124,v28,v29,v30
v_max_u32 v124,v124,v31
v_cmp_eq_u32 vcc,-1,v124
s_cbranch_vccz dgo_101213
buffer_load_dwordx4 v[28:31],v0,s[20:23],s92 offen offset:3072 sc1
s_waitcnt vmcnt(2)
v_max3_u32 v124,v104,v105,v106
v_max_u32 v124,v124,v107
v_cmp_eq_u32 vcc,-1,v124
s_cbranch_vccz dcp_101216
buffer_load_dwordx4 v[104:107],v0,s[20:23],s92 offen offset:3072 sc1
s_waitcnt vmcnt(2)
v_max3_u32 v124,v108,v109,v110
v_max_u32 v124,v124,v111
v_cmp_eq_u32 vcc,-1,v124
s_cbranch_vccz dcp_101217
buffer_load_dwordx4 v[108:111],v0,s[20:23],s92 offen offset:3072 sc1
s_sub_u32 s90,s90,1
s_cmp_gt_i32 s90,0
s_cbranch_scc1 dlp_101214
s_branch dgo_101213
dcp_101216:
v_mov_b32 v28,v104
v_mov_b32 v29,v105
v_mov_b32 v30,v106
v_mov_b32 v31,v107
s_nop 1
s_branch dgo_101213
dcp_101217:
v_mov_b32 v28,v108
v_mov_b32 v29,v109
v_mov_b32 v30,v110
v_mov_b32 v31,v111
s_nop 1
dgo_101213:
v_smfmac_f32_16x16x64_bf16 v[64:67],v[28:31],a[224:231],v1
v_smfmac_f32_16x16x64_bf16 v[68:71],v[28:31],a[232:239],v1
v_smfmac_f32_16x16x64_bf16 v[72:75],v[28:31],a[240:247],v1
v_smfmac_f32_16x16x64_bf16 v[76:79],v[28:31],a[248:255],v1
dsk_101212:
s_mov_b32 s55,0
s_branch Ldone_101130
slowA_100929:
buffer_load_dwordx4 v[44:47],v0,s[20:23],s93 offen offset:3072 sc1
dsk_101218:
s_bitcmp1_b32 s55,7
s_cbranch_scc0 dsk_101219
s_waitcnt vmcnt(2)
v_max3_u32 v124,v44,v45,v46
v_max_u32 v124,v124,v47
v_cmp_eq_u32 vcc,-1,v124
s_cbranch_vccz dgo_101220
s_nop 15
s_nop 3
buffer_load_dwordx4 v[104:107],v0,s[20:23],s93 offen offset:3072 sc1
s_nop 15
s_nop 3
buffer_load_dwordx4 v[108:111],v0,s[20:23],s93 offen offset:3072 sc1
dlp_101221:
s_waitcnt vmcnt(2)
v_max3_u32 v124,v44,v45,v46
v_max_u32 v124,v124,v47
v_cmp_eq_u32 vcc,-1,v124
s_cbranch_vccz dgo_101220
buffer_load_dwordx4 v[44:47],v0,s[20:23],s93 offen offset:3072 sc1
s_waitcnt vmcnt(2)
v_max3_u32 v124,v104,v105,v106
v_max_u32 v124,v124,v107
v_cmp_eq_u32 vcc,-1,v124
s_cbranch_vccz dcp_101223
buffer_load_dwordx4 v[104:107],v0,s[20:23],s93 offen offset:3072 sc1
s_waitcnt vmcnt(2)
v_max3_u32 v124,v108,v109,v110
v_max_u32 v124,v124,v111
v_cmp_eq_u32 vcc,-1,v124
s_cbranch_vccz dcp_101224
buffer_load_dwordx4 v[108:111],v0,s[20:23],s93 offen offset:3072 sc1
s_sub_u32 s90,s90,1
s_cmp_gt_i32 s90,0
s_cbranch_scc1 dlp_101221
s_branch dgo_101220
dcp_101223:
v_mov_b32 v44,v104
v_mov_b32 v45,v105
v_mov_b32 v46,v106
v_mov_b32 v47,v107
s_nop 1
s_branch dgo_101220
dcp_101224:
v_mov_b32 v44,v108
v_mov_b32 v45,v109
v_mov_b32 v46,v110
v_mov_b32 v47,v111
s_nop 1
dgo_101220:
dsk_101219:
s_mov_b32 s55,0
s_branch segb_100911
recfin_100430:
s_endpgm
.section .rodata,"a"
.p2align 6
.amdhsa_kernel flow_kernel
  .amdhsa_next_free_vgpr 512
  .amdhsa_next_free_sgpr 102
  .amdhsa_accum_offset 256
  .amdhsa_group_segment_fixed_size 0
  .amdhsa_kernarg_size 136
  .amdhsa_user_sgpr_count 2
  .amdhsa_user_sgpr_kernarg_segment_ptr 1
  .amdhsa_system_sgpr_workgroup_id_x 1
.end_amdhsa_kernel
```

```asm
; @launch kernel=flow_kernel grid=(256,1,1) block=(256,1,1) lds=163840
.amdgcn_target "amdgcn-amd-amdhsa--gfx950"
.text
.globl flow_kernel
.p2align 8
.type flow_kernel,@function
flow_kernel:
s_cmp_ge_u32 s2,256
s_cbranch_scc1 done_1
s_lshr_b32 s49,s2,3
s_load_dwordx2 s[18:19],s[0:1],128
s_load_dwordx2 s[2:3],s[0:1],120
s_load_dwordx2 s[4:5],s[0:1],0
s_getreg_b32 s51,hwreg(HW_REG_XCC_ID)
v_lshrrev_b32 v2,6,v0
v_and_b32 v1,63,v0
s_and_b32 s51,s51,7
v_readfirstlane_b32 s50,v2
s_mov_b32 s90,40000
s_mov_b32 s56,2
s_mov_b32 s88,64
s_lshl_b32 s64,s51,2
s_lshr_b32 s64,0x76325410,s64
s_and_b32 s64,s64,7
s_lshl_b32 s58,s64,5
s_add_u32 s58,s58,s49
s_waitcnt lgkmcnt(0)
s_mov_b32 s20,s18
s_and_b32 s21,s19,0xffff
s_mov_b32 s22,0x10000000
s_mov_b32 s23,0x20000
s_cmp_lg_u32 s50,0
s_cbranch_scc1 fl_disp0
s_mov_b32 s92,s2
s_and_b32 s93,s3,0xffff
s_mov_b32 s94,0x100
s_mov_b32 s95,0x20000
s_lshl_b32 s64,1,s49
v_mov_b32 v2,s64
v_mov_b32 v3,0x100
s_lshl_b32 s64,s51,3
s_mov_b64 exec,1
buffer_atomic_add_x2 v[2:3],off,s[92:95],s64 sc1
s_mov_b64 exec,-1
fl_disp0:
v_mbcnt_lo_u32_b32 v1,-1,0
v_mbcnt_hi_u32_b32 v1,-1,v1
s_sub_u32 s59,s58,64
s_cbranch_scc0 nx_3
s_branch fl_rec
nx_3:
s_cmp_lt_u32 s58,128
s_cbranch_scc0 nx_4
s_branch fl_qkv
nx_4:
s_cmp_ge_u32 s58,192
s_cbranch_scc1 fl_dutb
s_load_dwordx4 s[4:7],s[0:1],96
s_load_dwordx2 s[8:9],s[0:1],0
s_sub_u32 s59,s58,128
s_and_b32 s52,s59,15
s_lshr_b32 s53,s59,4
s_lshl_b32 s64,s50,6
v_add_u32 v14,s64,v1
v_lshrrev_b32 v2,4,v14
v_and_b32 v3,15,v14
v_mul_u32_u24 v13,196608,v2
v_lshl_add_u32 v13,v3,4,v13
s_mul_i32 s54,s53,3145728
s_lshl_b32 s64,s52,8
s_add_u32 s54,s54,s64
s_add_u32 s54,s54,0
v_lshlrev_b32 v15,1,v14
s_lshl_b32 s55,s53,9
s_mov_b32 s60,0
s_mov_b32 s73,0xffff0000
s_sub_u32 s61,s58,128
s_lshl_b32 s61,s61,15
v_lshlrev_b32 v25,6,v2
v_lshlrev_b32 v24,4,v1
v_and_b32 v2,3,v1
v_lshrrev_b32 v3,2,v1
s_lshl_b32 s64,s60,2
v_add_u32 v4,s64,v2
s_lshl_b32 s65,s50,9
v_lshlrev_b32 v5,4,v3
v_add_u32 v5,s65,v5
v_lshl_add_u32 v8,v4,11,v5
v_lshlrev_b32 v9,1,v5
v_lshrrev_b32 v5,2,v3
v_and_b32 v3,3,v3
s_lshl_b32 s65,s50,13
v_lshlrev_b32 v5,10,v5
v_lshl_add_u32 v5,v3,8,v5
v_lshl_add_u32 v5,v4,4,v5
v_add_u32 v10,s65,v5
s_lshl_b32 s65,s50,9
v_lshlrev_b32 v5,3,v1
v_add_u32 v11,s65,v5
v_lshlrev_b32 v12,3,v2
s_waitcnt lgkmcnt(0)
s_mov_b32 s24,s4
s_and_b32 s25,s5,0xffff
s_mov_b32 s26,0x800
s_mov_b32 s27,0x20000
s_mov_b32 s28,s6
s_and_b32 s29,s7,0xffff
s_mov_b32 s30,0xc00000
s_mov_b32 s31,0x20000
s_mov_b32 s32,s8
s_and_b32 s33,s9,0xffff
s_mov_b32 s34,0x400000
s_mov_b32 s35,0x20000
v_mov_b32 v28,-1
v_mov_b32 v20,0
v_mov_b32 v29,-1
v_mov_b32 v21,0
v_mov_b32 v30,-1
v_mov_b32 v22,0
v_mov_b32 v31,-1
v_mov_b32 v23,0
buffer_load_ushort v16,v15,s[24:27],s55 offen
buffer_load_dwordx4 v[96:99],v13,s[28:31],s54 offen offset:0 nt
s_add_u32 s54,s54,12288
buffer_load_dwordx4 v[100:103],v13,s[28:31],s54 offen offset:0 nt
s_add_u32 s54,s54,12288
buffer_load_dwordx4 v[104:107],v13,s[28:31],s54 offen offset:0 nt
s_add_u32 s54,s54,12288
buffer_load_dwordx4 v[108:111],v13,s[28:31],s54 offen offset:0 nt
s_add_u32 s54,s54,12288
buffer_load_dwordx4 v[112:115],v13,s[28:31],s54 offen offset:0 nt
s_add_u32 s54,s54,12288
buffer_load_dwordx4 v[116:119],v13,s[28:31],s54 offen offset:0 nt
s_add_u32 s54,s54,12288
buffer_load_dwordx4 v[120:123],v13,s[28:31],s54 offen offset:0 nt
s_add_u32 s54,s54,12288
buffer_load_dwordx4 v[124:127],v13,s[28:31],s54 offen offset:0 nt
s_add_u32 s54,s54,12288
buffer_load_dwordx4 v[128:131],v13,s[28:31],s54 offen offset:0 nt
s_add_u32 s54,s54,12288
buffer_load_dwordx4 v[132:135],v13,s[28:31],s54 offen offset:0 nt
s_add_u32 s54,s54,12288
buffer_load_dwordx4 v[136:139],v13,s[28:31],s54 offen offset:0 nt
s_add_u32 s54,s54,12288
buffer_load_dwordx4 v[140:143],v13,s[28:31],s54 offen offset:0 nt
s_add_u32 s54,s54,12288
buffer_load_dwordx4 v[144:147],v13,s[28:31],s54 offen offset:0 nt
s_add_u32 s54,s54,12288
buffer_load_dwordx4 v[148:151],v13,s[28:31],s54 offen offset:0 nt
s_add_u32 s54,s54,12288
buffer_load_dwordx4 v[152:155],v13,s[28:31],s54 offen offset:0 nt
s_add_u32 s54,s54,12288
buffer_load_dwordx4 v[156:159],v13,s[28:31],s54 offen offset:0 nt
s_add_u32 s64,s61,0
buffer_load_dwordx4 v[48:51],v8,s[32:35],s64 offen offset:0
buffer_load_dwordx4 v[52:55],v8,s[32:35],s64 offen offset:256
s_add_u32 s64,s61,8192
buffer_load_dwordx4 v[56:59],v8,s[32:35],s64 offen offset:0
buffer_load_dwordx4 v[60:63],v8,s[32:35],s64 offen offset:256
s_add_u32 s64,s61,16384
buffer_load_dwordx4 v[64:67],v8,s[32:35],s64 offen offset:0
buffer_load_dwordx4 v[68:71],v8,s[32:35],s64 offen offset:256
s_add_u32 s64,s61,24576
buffer_load_dwordx4 v[72:75],v8,s[32:35],s64 offen offset:0
buffer_load_dwordx4 v[76:79],v8,s[32:35],s64 offen offset:256
s_waitcnt vmcnt(24)
v_lshlrev_b32 v16,16,v16
v_mul_f32 v17,0xbfb8aa3b,v16
v_exp_f32 v17,v17
s_nop 0
v_add_f32 v17,1.0,v17
v_rcp_f32 v17,v17
s_nop 0
v_mul_f32 v17,v17,v16
v_cvt_pk_bf16_f32 v17,v17,v17
v_and_b32 v17,s73,v17
v_lshlrev_b32 v18,2,v14
ds_write_b32 v18,v17 offset:8192
s_waitcnt lgkmcnt(0)
s_barrier
ds_read_b128 v[32:35],v25 offset:8192
ds_read_b128 v[36:39],v25 offset:8208
ds_read_b128 v[40:43],v25 offset:8224
ds_read_b128 v[44:47],v25 offset:8240
v_mov_b32 v80,0
v_mov_b32 v81,0
v_mov_b32 v82,0
v_mov_b32 v83,0
v_mov_b32 v84,0
v_mov_b32 v85,0
v_mov_b32 v86,0
v_mov_b32 v87,0
s_waitcnt lgkmcnt(0)
s_waitcnt vmcnt(23)
v_lshlrev_b32 v16,16,v96
v_and_b32 v17,s73,v96
v_pk_fma_f32 v[80:81],v[16:17],v[32:33],v[80:81] op_sel:[0,0,0] op_sel_hi:[1,0,1]
v_lshlrev_b32 v18,16,v97
v_and_b32 v19,s73,v97
v_pk_fma_f32 v[82:83],v[18:19],v[32:33],v[82:83] op_sel:[0,0,0] op_sel_hi:[1,0,1]
v_lshlrev_b32 v16,16,v98
v_and_b32 v17,s73,v98
v_pk_fma_f32 v[84:85],v[16:17],v[32:33],v[84:85] op_sel:[0,0,0] op_sel_hi:[1,0,1]
v_lshlrev_b32 v18,16,v99
v_and_b32 v19,s73,v99
v_pk_fma_f32 v[86:87],v[18:19],v[32:33],v[86:87] op_sel:[0,0,0] op_sel_hi:[1,0,1]
s_waitcnt vmcnt(22)
v_lshlrev_b32 v16,16,v100
v_and_b32 v17,s73,v100
v_pk_fma_f32 v[80:81],v[16:17],v[32:33],v[80:81] op_sel:[0,1,0] op_sel_hi:[1,1,1]
v_lshlrev_b32 v18,16,v101
v_and_b32 v19,s73,v101
v_pk_fma_f32 v[82:83],v[18:19],v[32:33],v[82:83] op_sel:[0,1,0] op_sel_hi:[1,1,1]
v_lshlrev_b32 v16,16,v102
v_and_b32 v17,s73,v102
v_pk_fma_f32 v[84:85],v[16:17],v[32:33],v[84:85] op_sel:[0,1,0] op_sel_hi:[1,1,1]
v_lshlrev_b32 v18,16,v103
v_and_b32 v19,s73,v103
v_pk_fma_f32 v[86:87],v[18:19],v[32:33],v[86:87] op_sel:[0,1,0] op_sel_hi:[1,1,1]
s_waitcnt vmcnt(21)
v_lshlrev_b32 v16,16,v104
v_and_b32 v17,s73,v104
v_pk_fma_f32 v[80:81],v[16:17],v[34:35],v[80:81] op_sel:[0,0,0] op_sel_hi:[1,0,1]
v_lshlrev_b32 v18,16,v105
v_and_b32 v19,s73,v105
v_pk_fma_f32 v[82:83],v[18:19],v[34:35],v[82:83] op_sel:[0,0,0] op_sel_hi:[1,0,1]
v_lshlrev_b32 v16,16,v106
v_and_b32 v17,s73,v106
v_pk_fma_f32 v[84:85],v[16:17],v[34:35],v[84:85] op_sel:[0,0,0] op_sel_hi:[1,0,1]
v_lshlrev_b32 v18,16,v107
v_and_b32 v19,s73,v107
v_pk_fma_f32 v[86:87],v[18:19],v[34:35],v[86:87] op_sel:[0,0,0] op_sel_hi:[1,0,1]
s_waitcnt vmcnt(20)
v_lshlrev_b32 v16,16,v108
v_and_b32 v17,s73,v108
v_pk_fma_f32 v[80:81],v[16:17],v[34:35],v[80:81] op_sel:[0,1,0] op_sel_hi:[1,1,1]
v_lshlrev_b32 v18,16,v109
v_and_b32 v19,s73,v109
v_pk_fma_f32 v[82:83],v[18:19],v[34:35],v[82:83] op_sel:[0,1,0] op_sel_hi:[1,1,1]
v_lshlrev_b32 v16,16,v110
v_and_b32 v17,s73,v110
v_pk_fma_f32 v[84:85],v[16:17],v[34:35],v[84:85] op_sel:[0,1,0] op_sel_hi:[1,1,1]
v_lshlrev_b32 v18,16,v111
v_and_b32 v19,s73,v111
v_pk_fma_f32 v[86:87],v[18:19],v[34:35],v[86:87] op_sel:[0,1,0] op_sel_hi:[1,1,1]
s_waitcnt vmcnt(19)
v_lshlrev_b32 v16,16,v112
v_and_b32 v17,s73,v112
v_pk_fma_f32 v[80:81],v[16:17],v[36:37],v[80:81] op_sel:[0,0,0] op_sel_hi:[1,0,1]
v_lshlrev_b32 v18,16,v113
v_and_b32 v19,s73,v113
v_pk_fma_f32 v[82:83],v[18:19],v[36:37],v[82:83] op_sel:[0,0,0] op_sel_hi:[1,0,1]
v_lshlrev_b32 v16,16,v114
v_and_b32 v17,s73,v114
v_pk_fma_f32 v[84:85],v[16:17],v[36:37],v[84:85] op_sel:[0,0,0] op_sel_hi:[1,0,1]
v_lshlrev_b32 v18,16,v115
v_and_b32 v19,s73,v115
v_pk_fma_f32 v[86:87],v[18:19],v[36:37],v[86:87] op_sel:[0,0,0] op_sel_hi:[1,0,1]
s_waitcnt vmcnt(18)
v_lshlrev_b32 v16,16,v116
v_and_b32 v17,s73,v116
v_pk_fma_f32 v[80:81],v[16:17],v[36:37],v[80:81] op_sel:[0,1,0] op_sel_hi:[1,1,1]
v_lshlrev_b32 v18,16,v117
v_and_b32 v19,s73,v117
v_pk_fma_f32 v[82:83],v[18:19],v[36:37],v[82:83] op_sel:[0,1,0] op_sel_hi:[1,1,1]
v_lshlrev_b32 v16,16,v118
v_and_b32 v17,s73,v118
v_pk_fma_f32 v[84:85],v[16:17],v[36:37],v[84:85] op_sel:[0,1,0] op_sel_hi:[1,1,1]
v_lshlrev_b32 v18,16,v119
v_and_b32 v19,s73,v119
v_pk_fma_f32 v[86:87],v[18:19],v[36:37],v[86:87] op_sel:[0,1,0] op_sel_hi:[1,1,1]
s_waitcnt vmcnt(17)
v_lshlrev_b32 v16,16,v120
v_and_b32 v17,s73,v120
v_pk_fma_f32 v[80:81],v[16:17],v[38:39],v[80:81] op_sel:[0,0,0] op_sel_hi:[1,0,1]
v_lshlrev_b32 v18,16,v121
v_and_b32 v19,s73,v121
v_pk_fma_f32 v[82:83],v[18:19],v[38:39],v[82:83] op_sel:[0,0,0] op_sel_hi:[1,0,1]
v_lshlrev_b32 v16,16,v122
v_and_b32 v17,s73,v122
v_pk_fma_f32 v[84:85],v[16:17],v[38:39],v[84:85] op_sel:[0,0,0] op_sel_hi:[1,0,1]
v_lshlrev_b32 v18,16,v123
v_and_b32 v19,s73,v123
v_pk_fma_f32 v[86:87],v[18:19],v[38:39],v[86:87] op_sel:[0,0,0] op_sel_hi:[1,0,1]
s_waitcnt vmcnt(16)
v_lshlrev_b32 v16,16,v124
v_and_b32 v17,s73,v124
v_pk_fma_f32 v[80:81],v[16:17],v[38:39],v[80:81] op_sel:[0,1,0] op_sel_hi:[1,1,1]
v_lshlrev_b32 v18,16,v125
v_and_b32 v19,s73,v125
v_pk_fma_f32 v[82:83],v[18:19],v[38:39],v[82:83] op_sel:[0,1,0] op_sel_hi:[1,1,1]
v_lshlrev_b32 v16,16,v126
v_and_b32 v17,s73,v126
v_pk_fma_f32 v[84:85],v[16:17],v[38:39],v[84:85] op_sel:[0,1,0] op_sel_hi:[1,1,1]
v_lshlrev_b32 v18,16,v127
v_and_b32 v19,s73,v127
v_pk_fma_f32 v[86:87],v[18:19],v[38:39],v[86:87] op_sel:[0,1,0] op_sel_hi:[1,1,1]
s_waitcnt vmcnt(15)
v_lshlrev_b32 v16,16,v128
v_and_b32 v17,s73,v128
v_pk_fma_f32 v[80:81],v[16:17],v[40:41],v[80:81] op_sel:[0,0,0] op_sel_hi:[1,0,1]
v_lshlrev_b32 v18,16,v129
v_and_b32 v19,s73,v129
v_pk_fma_f32 v[82:83],v[18:19],v[40:41],v[82:83] op_sel:[0,0,0] op_sel_hi:[1,0,1]
v_lshlrev_b32 v16,16,v130
v_and_b32 v17,s73,v130
v_pk_fma_f32 v[84:85],v[16:17],v[40:41],v[84:85] op_sel:[0,0,0] op_sel_hi:[1,0,1]
v_lshlrev_b32 v18,16,v131
v_and_b32 v19,s73,v131
v_pk_fma_f32 v[86:87],v[18:19],v[40:41],v[86:87] op_sel:[0,0,0] op_sel_hi:[1,0,1]
s_waitcnt vmcnt(14)
v_lshlrev_b32 v16,16,v132
v_and_b32 v17,s73,v132
v_pk_fma_f32 v[80:81],v[16:17],v[40:41],v[80:81] op_sel:[0,1,0] op_sel_hi:[1,1,1]
v_lshlrev_b32 v18,16,v133
v_and_b32 v19,s73,v133
v_pk_fma_f32 v[82:83],v[18:19],v[40:41],v[82:83] op_sel:[0,1,0] op_sel_hi:[1,1,1]
v_lshlrev_b32 v16,16,v134
v_and_b32 v17,s73,v134
v_pk_fma_f32 v[84:85],v[16:17],v[40:41],v[84:85] op_sel:[0,1,0] op_sel_hi:[1,1,1]
v_lshlrev_b32 v18,16,v135
v_and_b32 v19,s73,v135
v_pk_fma_f32 v[86:87],v[18:19],v[40:41],v[86:87] op_sel:[0,1,0] op_sel_hi:[1,1,1]
s_waitcnt vmcnt(13)
v_lshlrev_b32 v16,16,v136
v_and_b32 v17,s73,v136
v_pk_fma_f32 v[80:81],v[16:17],v[42:43],v[80:81] op_sel:[0,0,0] op_sel_hi:[1,0,1]
v_lshlrev_b32 v18,16,v137
v_and_b32 v19,s73,v137
v_pk_fma_f32 v[82:83],v[18:19],v[42:43],v[82:83] op_sel:[0,0,0] op_sel_hi:[1,0,1]
v_lshlrev_b32 v16,16,v138
v_and_b32 v17,s73,v138
v_pk_fma_f32 v[84:85],v[16:17],v[42:43],v[84:85] op_sel:[0,0,0] op_sel_hi:[1,0,1]
v_lshlrev_b32 v18,16,v139
v_and_b32 v19,s73,v139
v_pk_fma_f32 v[86:87],v[18:19],v[42:43],v[86:87] op_sel:[0,0,0] op_sel_hi:[1,0,1]
s_waitcnt vmcnt(12)
v_lshlrev_b32 v16,16,v140
v_and_b32 v17,s73,v140
v_pk_fma_f32 v[80:81],v[16:17],v[42:43],v[80:81] op_sel:[0,1,0] op_sel_hi:[1,1,1]
v_lshlrev_b32 v18,16,v141
v_and_b32 v19,s73,v141
v_pk_fma_f32 v[82:83],v[18:19],v[42:43],v[82:83] op_sel:[0,1,0] op_sel_hi:[1,1,1]
v_lshlrev_b32 v16,16,v142
v_and_b32 v17,s73,v142
v_pk_fma_f32 v[84:85],v[16:17],v[42:43],v[84:85] op_sel:[0,1,0] op_sel_hi:[1,1,1]
v_lshlrev_b32 v18,16,v143
v_and_b32 v19,s73,v143
v_pk_fma_f32 v[86:87],v[18:19],v[42:43],v[86:87] op_sel:[0,1,0] op_sel_hi:[1,1,1]
s_waitcnt vmcnt(11)
v_lshlrev_b32 v16,16,v144
v_and_b32 v17,s73,v144
v_pk_fma_f32 v[80:81],v[16:17],v[44:45],v[80:81] op_sel:[0,0,0] op_sel_hi:[1,0,1]
v_lshlrev_b32 v18,16,v145
v_and_b32 v19,s73,v145
v_pk_fma_f32 v[82:83],v[18:19],v[44:45],v[82:83] op_sel:[0,0,0] op_sel_hi:[1,0,1]
v_lshlrev_b32 v16,16,v146
v_and_b32 v17,s73,v146
v_pk_fma_f32 v[84:85],v[16:17],v[44:45],v[84:85] op_sel:[0,0,0] op_sel_hi:[1,0,1]
v_lshlrev_b32 v18,16,v147
v_and_b32 v19,s73,v147
v_pk_fma_f32 v[86:87],v[18:19],v[44:45],v[86:87] op_sel:[0,0,0] op_sel_hi:[1,0,1]
s_waitcnt vmcnt(10)
v_lshlrev_b32 v16,16,v148
v_and_b32 v17,s73,v148
v_pk_fma_f32 v[80:81],v[16:17],v[44:45],v[80:81] op_sel:[0,1,0] op_sel_hi:[1,1,1]
v_lshlrev_b32 v18,16,v149
v_and_b32 v19,s73,v149
v_pk_fma_f32 v[82:83],v[18:19],v[44:45],v[82:83] op_sel:[0,1,0] op_sel_hi:[1,1,1]
v_lshlrev_b32 v16,16,v150
v_and_b32 v17,s73,v150
v_pk_fma_f32 v[84:85],v[16:17],v[44:45],v[84:85] op_sel:[0,1,0] op_sel_hi:[1,1,1]
v_lshlrev_b32 v18,16,v151
v_and_b32 v19,s73,v151
v_pk_fma_f32 v[86:87],v[18:19],v[44:45],v[86:87] op_sel:[0,1,0] op_sel_hi:[1,1,1]
s_waitcnt vmcnt(9)
v_lshlrev_b32 v16,16,v152
v_and_b32 v17,s73,v152
v_pk_fma_f32 v[80:81],v[16:17],v[46:47],v[80:81] op_sel:[0,0,0] op_sel_hi:[1,0,1]
v_lshlrev_b32 v18,16,v153
v_and_b32 v19,s73,v153
v_pk_fma_f32 v[82:83],v[18:19],v[46:47],v[82:83] op_sel:[0,0,0] op_sel_hi:[1,0,1]
v_lshlrev_b32 v16,16,v154
v_and_b32 v17,s73,v154
v_pk_fma_f32 v[84:85],v[16:17],v[46:47],v[84:85] op_sel:[0,0,0] op_sel_hi:[1,0,1]
v_lshlrev_b32 v18,16,v155
v_and_b32 v19,s73,v155
v_pk_fma_f32 v[86:87],v[18:19],v[46:47],v[86:87] op_sel:[0,0,0] op_sel_hi:[1,0,1]
s_waitcnt vmcnt(8)
v_lshlrev_b32 v16,16,v156
v_and_b32 v17,s73,v156
v_pk_fma_f32 v[80:81],v[16:17],v[46:47],v[80:81] op_sel:[0,1,0] op_sel_hi:[1,1,1]
v_lshlrev_b32 v18,16,v157
v_and_b32 v19,s73,v157
v_pk_fma_f32 v[82:83],v[18:19],v[46:47],v[82:83] op_sel:[0,1,0] op_sel_hi:[1,1,1]
v_lshlrev_b32 v16,16,v158
v_and_b32 v17,s73,v158
v_pk_fma_f32 v[84:85],v[16:17],v[46:47],v[84:85] op_sel:[0,1,0] op_sel_hi:[1,1,1]
v_lshlrev_b32 v18,16,v159
v_and_b32 v19,s73,v159
v_pk_fma_f32 v[86:87],v[18:19],v[46:47],v[86:87] op_sel:[0,1,0] op_sel_hi:[1,1,1]
v_lshlrev_b32 v18,5,v14
ds_write_b128 v18,v[80:83] offset:16384
ds_write_b128 v18,v[84:87] offset:16400
v_and_b32 v18,127,v14
v_lshlrev_b32 v18,2,v18
v_lshrrev_b32 v19,7,v14
v_mov_b32 v19,v18
s_waitcnt lgkmcnt(0)
s_barrier
ds_read_b32 v32,v19 offset:16384
ds_read_b32 v33,v19 offset:16896
ds_read_b32 v34,v19 offset:17408
ds_read_b32 v35,v19 offset:17920
ds_read_b32 v36,v19 offset:18432
ds_read_b32 v37,v19 offset:18944
ds_read_b32 v38,v19 offset:19456
ds_read_b32 v39,v19 offset:19968
ds_read_b32 v40,v19 offset:20480
ds_read_b32 v41,v19 offset:20992
ds_read_b32 v42,v19 offset:21504
ds_read_b32 v43,v19 offset:22016
s_waitcnt lgkmcnt(4)
ds_read_b32 v44,v19 offset:22528
ds_read_b32 v45,v19 offset:23040
ds_read_b32 v46,v19 offset:23552
ds_read_b32 v47,v19 offset:24064
s_waitcnt lgkmcnt(0)
v_pk_add_f32 v[32:33],v[32:33],v[40:41]
v_pk_add_f32 v[34:35],v[34:35],v[42:43]
v_pk_add_f32 v[36:37],v[36:37],v[44:45]
v_pk_add_f32 v[38:39],v[38:39],v[46:47]
v_pk_add_f32 v[32:33],v[32:33],v[36:37]
v_pk_add_f32 v[34:35],v[34:35],v[38:39]
v_pk_add_f32 v[32:33],v[32:33],v[34:35]
v_add_f32 v32,v32,v33
s_mul_i32 s64,s53,24576
s_lshl_b32 s65,s52,9
s_add_u32 s64,s64,s65
s_add_u32 s64,s64,267386880
buffer_store_dword v32,v18,s[20:23],s64 offen sc1
s_waitcnt vmcnt(0)
s_barrier
s_cmp_lg_u32 s50,0
s_cbranch_scc1 sig_5
s_mov_b32 s92,s2
s_and_b32 s93,s3,0xffff
s_mov_b32 s94,0x100
s_mov_b32 s95,0x20000
s_add_u32 s64,s88,0
v_mov_b32 v16,1
s_mov_b64 exec,1
buffer_atomic_add v16,off,s[92:95],s64 sc1
s_mov_b64 exec,-1
sig_5:
v_lshlrev_b32 v128,16,v48
v_and_b32 v129,s73,v48
v_lshlrev_b32 v130,16,v49
v_and_b32 v131,s73,v49
v_lshlrev_b32 v132,16,v50
v_and_b32 v133,s73,v50
v_lshlrev_b32 v134,16,v51
v_and_b32 v135,s73,v51
v_lshlrev_b32 v136,16,v52
v_and_b32 v137,s73,v52
v_lshlrev_b32 v138,16,v53
v_and_b32 v139,s73,v53
v_lshlrev_b32 v140,16,v54
v_and_b32 v141,s73,v54
v_lshlrev_b32 v142,16,v55
v_and_b32 v143,s73,v55
v_lshlrev_b32 v144,16,v56
v_and_b32 v145,s73,v56
v_lshlrev_b32 v146,16,v57
v_and_b32 v147,s73,v57
v_lshlrev_b32 v148,16,v58
v_and_b32 v149,s73,v58
v_lshlrev_b32 v150,16,v59
v_and_b32 v151,s73,v59
v_lshlrev_b32 v152,16,v60
v_and_b32 v153,s73,v60
v_lshlrev_b32 v154,16,v61
v_and_b32 v155,s73,v61
v_lshlrev_b32 v156,16,v62
v_and_b32 v157,s73,v62
v_lshlrev_b32 v158,16,v63
v_and_b32 v159,s73,v63
v_lshlrev_b32 v160,16,v64
v_and_b32 v161,s73,v64
v_lshlrev_b32 v162,16,v65
v_and_b32 v163,s73,v65
v_lshlrev_b32 v164,16,v66
v_and_b32 v165,s73,v66
v_lshlrev_b32 v166,16,v67
v_and_b32 v167,s73,v67
v_lshlrev_b32 v168,16,v68
v_and_b32 v169,s73,v68
v_lshlrev_b32 v170,16,v69
v_and_b32 v171,s73,v69
v_lshlrev_b32 v172,16,v70
v_and_b32 v173,s73,v70
v_lshlrev_b32 v174,16,v71
v_and_b32 v175,s73,v71
v_lshlrev_b32 v176,16,v72
v_and_b32 v177,s73,v72
v_lshlrev_b32 v178,16,v73
v_and_b32 v179,s73,v73
v_lshlrev_b32 v180,16,v74
v_and_b32 v181,s73,v74
v_lshlrev_b32 v182,16,v75
v_and_b32 v183,s73,v75
v_lshlrev_b32 v184,16,v76
v_and_b32 v185,s73,v76
v_lshlrev_b32 v186,16,v77
v_and_b32 v187,s73,v77
v_lshlrev_b32 v188,16,v78
v_and_b32 v189,s73,v78
v_lshlrev_b32 v190,16,v79
v_and_b32 v191,s73,v79
v_add_f32 v208,v128,v129
v_mul_f32 v209,v128,v128
v_add_f32 v210,v130,v131
v_mul_f32 v211,v129,v129
v_fmac_f32 v209,v130,v130
v_fmac_f32 v211,v131,v131
v_add_f32 v208,v208,v132
v_fmac_f32 v209,v132,v132
v_add_f32 v210,v210,v133
v_fmac_f32 v211,v133,v133
v_add_f32 v208,v208,v134
v_fmac_f32 v209,v134,v134
v_add_f32 v210,v210,v135
v_fmac_f32 v211,v135,v135
v_add_f32 v208,v208,v136
v_fmac_f32 v209,v136,v136
v_add_f32 v210,v210,v137
v_fmac_f32 v211,v137,v137
v_add_f32 v208,v208,v138
v_fmac_f32 v209,v138,v138
v_add_f32 v210,v210,v139
v_fmac_f32 v211,v139,v139
v_add_f32 v208,v208,v140
v_fmac_f32 v209,v140,v140
v_add_f32 v210,v210,v141
v_fmac_f32 v211,v141,v141
v_add_f32 v208,v208,v142
v_fmac_f32 v209,v142,v142
v_add_f32 v210,v210,v143
v_fmac_f32 v211,v143,v143
v_add_f32 v208,v208,v210
v_add_f32 v209,v209,v211
v_add_f32 v212,v144,v145
v_mul_f32 v213,v144,v144
v_add_f32 v214,v146,v147
v_mul_f32 v215,v145,v145
v_fmac_f32 v213,v146,v146
v_fmac_f32 v215,v147,v147
v_add_f32 v212,v212,v148
v_fmac_f32 v213,v148,v148
v_add_f32 v214,v214,v149
v_fmac_f32 v215,v149,v149
v_add_f32 v212,v212,v150
v_fmac_f32 v213,v150,v150
v_add_f32 v214,v214,v151
v_fmac_f32 v215,v151,v151
v_add_f32 v212,v212,v152
v_fmac_f32 v213,v152,v152
v_add_f32 v214,v214,v153
v_fmac_f32 v215,v153,v153
v_add_f32 v212,v212,v154
v_fmac_f32 v213,v154,v154
v_add_f32 v214,v214,v155
v_fmac_f32 v215,v155,v155
v_add_f32 v212,v212,v156
v_fmac_f32 v213,v156,v156
v_add_f32 v214,v214,v157
v_fmac_f32 v215,v157,v157
v_add_f32 v212,v212,v158
v_fmac_f32 v213,v158,v158
v_add_f32 v214,v214,v159
v_fmac_f32 v215,v159,v159
v_add_f32 v212,v212,v214
v_add_f32 v213,v213,v215
v_add_f32 v216,v160,v161
v_mul_f32 v217,v160,v160
v_add_f32 v218,v162,v163
v_mul_f32 v219,v161,v161
v_fmac_f32 v217,v162,v162
v_fmac_f32 v219,v163,v163
v_add_f32 v216,v216,v164
v_fmac_f32 v217,v164,v164
v_add_f32 v218,v218,v165
v_fmac_f32 v219,v165,v165
v_add_f32 v216,v216,v166
v_fmac_f32 v217,v166,v166
v_add_f32 v218,v218,v167
v_fmac_f32 v219,v167,v167
v_add_f32 v216,v216,v168
v_fmac_f32 v217,v168,v168
v_add_f32 v218,v218,v169
v_fmac_f32 v219,v169,v169
v_add_f32 v216,v216,v170
v_fmac_f32 v217,v170,v170
v_add_f32 v218,v218,v171
v_fmac_f32 v219,v171,v171
v_add_f32 v216,v216,v172
v_fmac_f32 v217,v172,v172
v_add_f32 v218,v218,v173
v_fmac_f32 v219,v173,v173
v_add_f32 v216,v216,v174
v_fmac_f32 v217,v174,v174
v_add_f32 v218,v218,v175
v_fmac_f32 v219,v175,v175
v_add_f32 v216,v216,v218
v_add_f32 v217,v217,v219
v_add_f32 v220,v176,v177
v_mul_f32 v221,v176,v176
v_add_f32 v222,v178,v179
v_mul_f32 v223,v177,v177
v_fmac_f32 v221,v178,v178
v_fmac_f32 v223,v179,v179
v_add_f32 v220,v220,v180
v_fmac_f32 v221,v180,v180
v_add_f32 v222,v222,v181
v_fmac_f32 v223,v181,v181
v_add_f32 v220,v220,v182
v_fmac_f32 v221,v182,v182
v_add_f32 v222,v222,v183
v_fmac_f32 v223,v183,v183
v_add_f32 v220,v220,v184
v_fmac_f32 v221,v184,v184
v_add_f32 v222,v222,v185
v_fmac_f32 v223,v185,v185
v_add_f32 v220,v220,v186
v_fmac_f32 v221,v186,v186
v_add_f32 v222,v222,v187
v_fmac_f32 v223,v187,v187
v_add_f32 v220,v220,v188
v_fmac_f32 v221,v188,v188
v_add_f32 v222,v222,v189
v_fmac_f32 v223,v189,v189
v_add_f32 v220,v220,v190
v_fmac_f32 v221,v190,v190
v_add_f32 v222,v222,v191
v_fmac_f32 v223,v191,v191
v_add_f32 v220,v220,v222
v_add_f32 v221,v221,v223
v_add_f32_dpp v208,v208,v208 row_ror:4 row_mask:0xf bank_mask:0xf
v_add_f32_dpp v209,v209,v209 row_ror:4 row_mask:0xf bank_mask:0xf
v_add_f32_dpp v212,v212,v212 row_ror:4 row_mask:0xf bank_mask:0xf
v_add_f32_dpp v213,v213,v213 row_ror:4 row_mask:0xf bank_mask:0xf
v_add_f32_dpp v216,v216,v216 row_ror:4 row_mask:0xf bank_mask:0xf
v_add_f32_dpp v217,v217,v217 row_ror:4 row_mask:0xf bank_mask:0xf
v_add_f32_dpp v220,v220,v220 row_ror:4 row_mask:0xf bank_mask:0xf
v_add_f32_dpp v221,v221,v221 row_ror:4 row_mask:0xf bank_mask:0xf
v_add_f32_dpp v208,v208,v208 row_ror:8 row_mask:0xf bank_mask:0xf
v_add_f32_dpp v209,v209,v209 row_ror:8 row_mask:0xf bank_mask:0xf
v_add_f32_dpp v212,v212,v212 row_ror:8 row_mask:0xf bank_mask:0xf
v_add_f32_dpp v213,v213,v213 row_ror:8 row_mask:0xf bank_mask:0xf
v_add_f32_dpp v216,v216,v216 row_ror:8 row_mask:0xf bank_mask:0xf
v_add_f32_dpp v217,v217,v217 row_ror:8 row_mask:0xf bank_mask:0xf
v_add_f32_dpp v220,v220,v220 row_ror:8 row_mask:0xf bank_mask:0xf
v_add_f32_dpp v221,v221,v221 row_ror:8 row_mask:0xf bank_mask:0xf
v_mov_b32 v210,v208
v_mov_b32 v211,v209
s_nop 0
v_permlane16_swap_b32 v210,v208
v_permlane16_swap_b32 v211,v209
v_add_f32 v208,v208,v210
v_add_f32 v209,v209,v211
v_mov_b32 v214,v212
v_mov_b32 v215,v213
s_nop 0
v_permlane16_swap_b32 v214,v212
v_permlane16_swap_b32 v215,v213
v_add_f32 v212,v212,v214
v_add_f32 v213,v213,v215
v_mov_b32 v218,v216
v_mov_b32 v219,v217
s_nop 0
v_permlane16_swap_b32 v218,v216
v_permlane16_swap_b32 v219,v217
v_add_f32 v216,v216,v218
v_add_f32 v217,v217,v219
v_mov_b32 v222,v220
v_mov_b32 v223,v221
s_nop 0
v_permlane16_swap_b32 v222,v220
v_permlane16_swap_b32 v223,v221
v_add_f32 v220,v220,v222
v_add_f32 v221,v221,v223
v_mov_b32 v210,v208
v_mov_b32 v211,v209
s_nop 0
v_permlane32_swap_b32 v210,v208
v_permlane32_swap_b32 v211,v209
v_add_f32 v208,v208,v210
v_add_f32 v209,v209,v211
v_mov_b32 v214,v212
v_mov_b32 v215,v213
s_nop 0
v_permlane32_swap_b32 v214,v212
v_permlane32_swap_b32 v215,v213
v_add_f32 v212,v212,v214
v_add_f32 v213,v213,v215
v_mov_b32 v218,v216
v_mov_b32 v219,v217
s_nop 0
v_permlane32_swap_b32 v218,v216
v_permlane32_swap_b32 v219,v217
v_add_f32 v216,v216,v218
v_add_f32 v217,v217,v219
v_mov_b32 v222,v220
v_mov_b32 v223,v221
s_nop 0
v_permlane32_swap_b32 v222,v220
v_permlane32_swap_b32 v223,v221
v_add_f32 v220,v220,v222
v_add_f32 v221,v221,v223
ds_write_b64 v11,v[208:209] offset:32768
ds_write_b64 v11,v[212:213] offset:34816
ds_write_b64 v11,v[216:217] offset:36864
ds_write_b64 v11,v[220:221] offset:38912
s_waitcnt lgkmcnt(0)
s_barrier
ds_read_b64 v[32:33],v12 offset:32768
ds_read_b64 v[34:35],v12 offset:33280
ds_read_b64 v[36:37],v12 offset:33792
ds_read_b64 v[38:39],v12 offset:34304
s_waitcnt lgkmcnt(0)
v_add_f32 v32,v32,v34
v_add_f32 v33,v33,v35
v_add_f32 v36,v36,v38
v_add_f32 v37,v37,v39
v_add_f32 v32,v32,v36
v_add_f32 v33,v33,v37
v_mul_f32 v208,0xba800000,v32
v_mul_f32 v34,v208,v208
v_mul_f32 v33,0x3a800000,v33
v_sub_f32 v33,v33,v34
v_max_f32 v33,0,v33
v_add_f32 v33,0x3727c5ac,v33
v_rsq_f32 v209,v33
s_nop 0
v_mul_f32 v208,v208,v209
v_fma_f32 v128,v128,v209,v208
v_fma_f32 v129,v129,v209,v208
v_fma_f32 v130,v130,v209,v208
v_fma_f32 v131,v131,v209,v208
v_fma_f32 v132,v132,v209,v208
v_fma_f32 v133,v133,v209,v208
v_fma_f32 v134,v134,v209,v208
v_fma_f32 v135,v135,v209,v208
v_fma_f32 v136,v136,v209,v208
v_fma_f32 v137,v137,v209,v208
v_fma_f32 v138,v138,v209,v208
v_fma_f32 v139,v139,v209,v208
v_fma_f32 v140,v140,v209,v208
v_fma_f32 v141,v141,v209,v208
v_fma_f32 v142,v142,v209,v208
v_fma_f32 v143,v143,v209,v208
ds_read_b64 v[32:33],v12 offset:34816
ds_read_b64 v[34:35],v12 offset:35328
ds_read_b64 v[36:37],v12 offset:35840
ds_read_b64 v[38:39],v12 offset:36352
s_waitcnt lgkmcnt(0)
v_add_f32 v32,v32,v34
v_add_f32 v33,v33,v35
v_add_f32 v36,v36,v38
v_add_f32 v37,v37,v39
v_add_f32 v32,v32,v36
v_add_f32 v33,v33,v37
v_mul_f32 v208,0xba800000,v32
v_mul_f32 v34,v208,v208
v_mul_f32 v33,0x3a800000,v33
v_sub_f32 v33,v33,v34
v_max_f32 v33,0,v33
v_add_f32 v33,0x3727c5ac,v33
v_rsq_f32 v209,v33
s_nop 0
v_mul_f32 v208,v208,v209
v_fma_f32 v144,v144,v209,v208
v_fma_f32 v145,v145,v209,v208
v_fma_f32 v146,v146,v209,v208
v_fma_f32 v147,v147,v209,v208
v_fma_f32 v148,v148,v209,v208
v_fma_f32 v149,v149,v209,v208
v_fma_f32 v150,v150,v209,v208
v_fma_f32 v151,v151,v209,v208
v_fma_f32 v152,v152,v209,v208
v_fma_f32 v153,v153,v209,v208
v_fma_f32 v154,v154,v209,v208
v_fma_f32 v155,v155,v209,v208
v_fma_f32 v156,v156,v209,v208
v_fma_f32 v157,v157,v209,v208
v_fma_f32 v158,v158,v209,v208
v_fma_f32 v159,v159,v209,v208
ds_read_b64 v[32:33],v12 offset:36864
ds_read_b64 v[34:35],v12 offset:37376
ds_read_b64 v[36:37],v12 offset:37888
ds_read_b64 v[38:39],v12 offset:38400
s_waitcnt lgkmcnt(0)
v_add_f32 v32,v32,v34
v_add_f32 v33,v33,v35
v_add_f32 v36,v36,v38
v_add_f32 v37,v37,v39
v_add_f32 v32,v32,v36
v_add_f32 v33,v33,v37
v_mul_f32 v208,0xba800000,v32
v_mul_f32 v34,v208,v208
v_mul_f32 v33,0x3a800000,v33
v_sub_f32 v33,v33,v34
v_max_f32 v33,0,v33
v_add_f32 v33,0x3727c5ac,v33
v_rsq_f32 v209,v33
s_nop 0
v_mul_f32 v208,v208,v209
v_fma_f32 v160,v160,v209,v208
v_fma_f32 v161,v161,v209,v208
v_fma_f32 v162,v162,v209,v208
v_fma_f32 v163,v163,v209,v208
v_fma_f32 v164,v164,v209,v208
v_fma_f32 v165,v165,v209,v208
v_fma_f32 v166,v166,v209,v208
v_fma_f32 v167,v167,v209,v208
v_fma_f32 v168,v168,v209,v208
v_fma_f32 v169,v169,v209,v208
v_fma_f32 v170,v170,v209,v208
v_fma_f32 v171,v171,v209,v208
v_fma_f32 v172,v172,v209,v208
v_fma_f32 v173,v173,v209,v208
v_fma_f32 v174,v174,v209,v208
v_fma_f32 v175,v175,v209,v208
ds_read_b64 v[32:33],v12 offset:38912
ds_read_b64 v[34:35],v12 offset:39424
ds_read_b64 v[36:37],v12 offset:39936
ds_read_b64 v[38:39],v12 offset:40448
s_waitcnt lgkmcnt(0)
v_add_f32 v32,v32,v34
v_add_f32 v33,v33,v35
v_add_f32 v36,v36,v38
v_add_f32 v37,v37,v39
v_add_f32 v32,v32,v36
v_add_f32 v33,v33,v37
v_mul_f32 v208,0xba800000,v32
v_mul_f32 v34,v208,v208
v_mul_f32 v33,0x3a800000,v33
v_sub_f32 v33,v33,v34
v_max_f32 v33,0,v33
v_add_f32 v33,0x3727c5ac,v33
v_rsq_f32 v209,v33
s_nop 0
v_mul_f32 v208,v208,v209
v_fma_f32 v176,v176,v209,v208
v_fma_f32 v177,v177,v209,v208
v_fma_f32 v178,v178,v209,v208
v_fma_f32 v179,v179,v209,v208
v_fma_f32 v180,v180,v209,v208
v_fma_f32 v181,v181,v209,v208
v_fma_f32 v182,v182,v209,v208
v_fma_f32 v183,v183,v209,v208
v_fma_f32 v184,v184,v209,v208
v_fma_f32 v185,v185,v209,v208
v_fma_f32 v186,v186,v209,v208
v_fma_f32 v187,v187,v209,v208
v_fma_f32 v188,v188,v209,v208
v_fma_f32 v189,v189,v209,v208
v_fma_f32 v190,v190,v209,v208
v_fma_f32 v191,v191,v209,v208
s_mov_b32 s92,s2
s_and_b32 s93,s3,0xffff
s_mov_b32 s94,0x100
s_mov_b32 s95,0x20000
v_mbcnt_lo_u32_b32 v16,-1,0
v_mbcnt_hi_u32_b32 v16,-1,v16
v_mov_b32 v18,0
v_cmp_eq_u32 vcc,16,v16
s_nop 1
v_cndmask_b32 v18,v18,64,vcc
v_and_b32 v19,1,v16
v_cmp_eq_u32 vcc,1,v19
v_mov_b32 v19,8192
s_nop 0
v_cndmask_b32 v19,-1,v19,vcc
v_min_u32 v16,31,v16
v_lshlrev_b32 v16,2,v16
s_sub_u32 s66,s88,64
s_cmp_lg_u32 s50,0
s_cbranch_scc1 vot_10
vpoll_6:
buffer_load_dword v17,v16,s[92:95],s66 offen sc1
s_waitcnt vmcnt(0)
s_cmp_lg_u32 s56,2
s_cbranch_scc1 vck_7
v_cmp_eq_u32 vcc,v17,v19
s_and_b32 s64,vcc_lo,0xffff
s_cmp_eq_u32 s64,65535
s_cbranch_scc1 vck_7
s_mov_b32 s65,0
v_readlane_b32 s64,v17,1
s_lshr_b32 s64,s64,8
s_add_u32 s65,s65,s64
v_readlane_b32 s64,v17,3
s_lshr_b32 s64,s64,8
s_add_u32 s65,s65,s64
v_readlane_b32 s64,v17,5
s_lshr_b32 s64,s64,8
s_add_u32 s65,s65,s64
v_readlane_b32 s64,v17,7
s_lshr_b32 s64,s64,8
s_add_u32 s65,s65,s64
v_readlane_b32 s64,v17,9
s_lshr_b32 s64,s64,8
s_add_u32 s65,s65,s64
v_readlane_b32 s64,v17,11
s_lshr_b32 s64,s64,8
s_add_u32 s65,s65,s64
v_readlane_b32 s64,v17,13
s_lshr_b32 s64,s64,8
s_add_u32 s65,s65,s64
v_readlane_b32 s64,v17,15
s_lshr_b32 s64,s64,8
s_add_u32 s65,s65,s64
s_cmp_ge_u32 s65,256
s_cbranch_scc1 vok_9
s_branch vrt_8
vck_7:
v_cmp_gt_u32 vcc,v18,v17
s_cbranch_vccz vok_9
vrt_8:
s_sleep 8
s_sub_u32 s90,s90,1
s_cmp_gt_i32 s90,0
s_cbranch_scc1 vpoll_6
vok_9:
v_add_u32 v18,160000,v16
ds_write_b32 v18,v17
s_waitcnt lgkmcnt(0)
vot_10:
s_barrier
v_add_u32 v18,160000,v16
ds_read_b32 v17,v18
s_waitcnt lgkmcnt(0)
s_cmp_lg_u32 s56,2
s_cbranch_scc1 vfin_11
v_cmp_eq_u32 vcc,v17,v19
s_and_b32 s64,vcc_lo,0xffff
s_cmp_eq_u32 s64,65535
s_cbranch_scc1 vfin_11
s_mov_b32 s65,0
v_readlane_b32 s64,v17,1
s_lshr_b32 s64,s64,8
s_add_u32 s65,s65,s64
v_readlane_b32 s64,v17,3
s_lshr_b32 s64,s64,8
s_add_u32 s65,s65,s64
v_readlane_b32 s64,v17,5
s_lshr_b32 s64,s64,8
s_add_u32 s65,s65,s64
v_readlane_b32 s64,v17,7
s_lshr_b32 s64,s64,8
s_add_u32 s65,s65,s64
v_readlane_b32 s64,v17,9
s_lshr_b32 s64,s64,8
s_add_u32 s65,s65,s64
v_readlane_b32 s64,v17,11
s_lshr_b32 s64,s64,8
s_add_u32 s65,s65,s64
v_readlane_b32 s64,v17,13
s_lshr_b32 s64,s64,8
s_add_u32 s65,s65,s64
v_readlane_b32 s64,v17,15
s_lshr_b32 s64,s64,8
s_add_u32 s65,s65,s64
s_cmp_ge_u32 s65,256
s_cbranch_scc1 fl_fb
vfin_11:
s_and_b32 s56,s56,1
v_lshlrev_b32 v18,5,v14
s_mov_b32 s64,267386880
buffer_load_dwordx4 v[32:35],v18,s[20:23],s64 offen offset:0 sc1
buffer_load_dwordx4 v[36:39],v18,s[20:23],s64 offen offset:16 sc1
s_mov_b32 s64,267411456
buffer_load_dwordx4 v[40:43],v18,s[20:23],s64 offen offset:0 sc1
buffer_load_dwordx4 v[44:47],v18,s[20:23],s64 offen offset:16 sc1
s_mov_b32 s64,267436032
buffer_load_dwordx4 v[48:51],v18,s[20:23],s64 offen offset:0 sc1
buffer_load_dwordx4 v[52:55],v18,s[20:23],s64 offen offset:16 sc1
s_mov_b32 s64,267460608
buffer_load_dwordx4 v[56:59],v18,s[20:23],s64 offen offset:0 sc1
buffer_load_dwordx4 v[60:63],v18,s[20:23],s64 offen offset:16 sc1
s_cmp_gt_u32 s50,1
s_cselect_b32 s64,1.0,0
s_waitcnt vmcnt(0)
v_pk_add_f32 v[32:33],v[32:33],v[40:41]
v_pk_add_f32 v[48:49],v[48:49],v[56:57]
v_pk_add_f32 v[34:35],v[34:35],v[42:43]
v_pk_add_f32 v[50:51],v[50:51],v[58:59]
v_pk_add_f32 v[36:37],v[36:37],v[44:45]
v_pk_add_f32 v[52:53],v[52:53],v[60:61]
v_pk_add_f32 v[38:39],v[38:39],v[46:47]
v_pk_add_f32 v[54:55],v[54:55],v[62:63]
v_pk_add_f32 v[32:33],v[32:33],v[48:49]
v_pk_add_f32 v[34:35],v[34:35],v[50:51]
v_pk_add_f32 v[36:37],v[36:37],v[52:53]
v_pk_add_f32 v[38:39],v[38:39],v[54:55]
v_cvt_pk_bf16_f32 v40,v32,v33
v_cvt_pk_bf16_f32 v41,v34,v35
v_cvt_pk_bf16_f32 v42,v36,v37
v_cvt_pk_bf16_f32 v43,v38,v39
v_lshlrev_b32 v32,16,v40
v_and_b32 v33,s73,v40
v_lshlrev_b32 v34,16,v41
v_and_b32 v35,s73,v41
v_lshlrev_b32 v36,16,v42
v_and_b32 v37,s73,v42
v_lshlrev_b32 v38,16,v43
v_and_b32 v39,s73,v43
v_add_f32 v32,s64,v32
v_add_f32 v33,s64,v33
v_add_f32 v34,s64,v34
v_add_f32 v35,s64,v35
v_add_f32 v36,s64,v36
v_add_f32 v37,s64,v37
v_add_f32 v38,s64,v38
v_add_f32 v39,s64,v39
ds_write_b128 v18,v[32:35] offset:0
ds_write_b128 v18,v[36:39] offset:16
s_waitcnt lgkmcnt(0)
s_barrier
ds_read_b128 v[112:115],v9 offset:0
ds_read_b128 v[116:119],v9 offset:16
ds_read_b128 v[120:123],v9 offset:512
ds_read_b128 v[124:127],v9 offset:528
ds_read_b128 v[96:99],v9 offset:4096
ds_read_b128 v[100:103],v9 offset:4112
ds_read_b128 v[104:107],v9 offset:4608
ds_read_b128 v[108:111],v9 offset:4624
s_add_u32 s61,s61,146800640
s_add_u32 s62,s61,4096
s_waitcnt lgkmcnt(0)
v_fma_f32 v128,v128,v96,v112
v_fma_f32 v129,v129,v97,v113
v_fma_f32 v130,v130,v98,v114
v_fma_f32 v131,v131,v99,v115
v_fma_f32 v132,v132,v100,v116
v_fma_f32 v133,v133,v101,v117
v_fma_f32 v134,v134,v102,v118
v_fma_f32 v135,v135,v103,v119
v_fma_f32 v136,v136,v104,v120
v_fma_f32 v137,v137,v105,v121
v_fma_f32 v138,v138,v106,v122
v_fma_f32 v139,v139,v107,v123
v_fma_f32 v140,v140,v108,v124
v_fma_f32 v141,v141,v109,v125
v_fma_f32 v142,v142,v110,v126
v_fma_f32 v143,v143,v111,v127
v_cvt_pk_bf16_f32 v48,v128,v129
v_cvt_pk_bf16_f32 v49,v130,v131
v_cvt_pk_bf16_f32 v50,v132,v133
v_cvt_pk_bf16_f32 v51,v134,v135
v_cvt_pk_bf16_f32 v52,v136,v137
v_cvt_pk_bf16_f32 v53,v138,v139
v_cvt_pk_bf16_f32 v54,v140,v141
v_cvt_pk_bf16_f32 v55,v142,v143
buffer_store_dwordx4 v[48:51],v10,s[20:23],s61 offen offset:0 sc1
buffer_store_dwordx4 v[52:55],v10,s[20:23],s62 offen offset:0 sc1
v_fma_f32 v144,v144,v96,v112
v_fma_f32 v145,v145,v97,v113
v_fma_f32 v146,v146,v98,v114
v_fma_f32 v147,v147,v99,v115
v_fma_f32 v148,v148,v100,v116
v_fma_f32 v149,v149,v101,v117
v_fma_f32 v150,v150,v102,v118
v_fma_f32 v151,v151,v103,v119
v_fma_f32 v152,v152,v104,v120
v_fma_f32 v153,v153,v105,v121
v_fma_f32 v154,v154,v106,v122
v_fma_f32 v155,v155,v107,v123
v_fma_f32 v156,v156,v108,v124
v_fma_f32 v157,v157,v109,v125
v_fma_f32 v158,v158,v110,v126
v_fma_f32 v159,v159,v111,v127
v_cvt_pk_bf16_f32 v56,v144,v145
v_cvt_pk_bf16_f32 v57,v146,v147
v_cvt_pk_bf16_f32 v58,v148,v149
v_cvt_pk_bf16_f32 v59,v150,v151
v_cvt_pk_bf16_f32 v60,v152,v153
v_cvt_pk_bf16_f32 v61,v154,v155
v_cvt_pk_bf16_f32 v62,v156,v157
v_cvt_pk_bf16_f32 v63,v158,v159
buffer_store_dwordx4 v[56:59],v10,s[20:23],s61 offen offset:64 sc1
buffer_store_dwordx4 v[60:63],v10,s[20:23],s62 offen offset:64 sc1
v_fma_f32 v160,v160,v96,v112
v_fma_f32 v161,v161,v97,v113
v_fma_f32 v162,v162,v98,v114
v_fma_f32 v163,v163,v99,v115
v_fma_f32 v164,v164,v100,v116
v_fma_f32 v165,v165,v101,v117
v_fma_f32 v166,v166,v102,v118
v_fma_f32 v167,v167,v103,v119
v_fma_f32 v168,v168,v104,v120
v_fma_f32 v169,v169,v105,v121
v_fma_f32 v170,v170,v106,v122
v_fma_f32 v171,v171,v107,v123
v_fma_f32 v172,v172,v108,v124
v_fma_f32 v173,v173,v109,v125
v_fma_f32 v174,v174,v110,v126
v_fma_f32 v175,v175,v111,v127
v_cvt_pk_bf16_f32 v64,v160,v161
v_cvt_pk_bf16_f32 v65,v162,v163
v_cvt_pk_bf16_f32 v66,v164,v165
v_cvt_pk_bf16_f32 v67,v166,v167
v_cvt_pk_bf16_f32 v68,v168,v169
v_cvt_pk_bf16_f32 v69,v170,v171
v_cvt_pk_bf16_f32 v70,v172,v173
v_cvt_pk_bf16_f32 v71,v174,v175
buffer_store_dwordx4 v[64:67],v10,s[20:23],s61 offen offset:128 sc1
buffer_store_dwordx4 v[68:71],v10,s[20:23],s62 offen offset:128 sc1
v_fma_f32 v176,v176,v96,v112
v_fma_f32 v177,v177,v97,v113
v_fma_f32 v178,v178,v98,v114
v_fma_f32 v179,v179,v99,v115
v_fma_f32 v180,v180,v100,v116
v_fma_f32 v181,v181,v101,v117
v_fma_f32 v182,v182,v102,v118
v_fma_f32 v183,v183,v103,v119
v_fma_f32 v184,v184,v104,v120
v_fma_f32 v185,v185,v105,v121
v_fma_f32 v186,v186,v106,v122
v_fma_f32 v187,v187,v107,v123
v_fma_f32 v188,v188,v108,v124
v_fma_f32 v189,v189,v109,v125
v_fma_f32 v190,v190,v110,v126
v_fma_f32 v191,v191,v111,v127
v_cvt_pk_bf16_f32 v72,v176,v177
v_cvt_pk_bf16_f32 v73,v178,v179
v_cvt_pk_bf16_f32 v74,v180,v181
v_cvt_pk_bf16_f32 v75,v182,v183
v_cvt_pk_bf16_f32 v76,v184,v185
v_cvt_pk_bf16_f32 v77,v186,v187
v_cvt_pk_bf16_f32 v78,v188,v189
v_cvt_pk_bf16_f32 v79,v190,v191
buffer_store_dwordx4 v[72:75],v10,s[20:23],s61 offen offset:192 sc1
buffer_store_dwordx4 v[76:79],v10,s[20:23],s62 offen offset:192 sc1
s_waitcnt vmcnt(0)
s_barrier
s_cmp_lg_u32 s50,0
s_cbranch_scc1 sig_12
s_mov_b32 s92,s2
s_and_b32 s93,s3,0xffff
s_mov_b32 s94,0x100
s_mov_b32 s95,0x20000
s_add_u32 s64,s88,12
v_mov_b32 v16,1
s_mov_b64 exec,1
buffer_atomic_add v16,off,s[92:95],s64 sc1
s_mov_b64 exec,-1
sig_12:
s_branch fl_disp
fl_dutb:
s_load_dwordx4 s[4:7],s[0:1],96
s_load_dwordx2 s[8:9],s[0:1],0
s_cmp_lg_u32 s58,220
s_cbranch_scc1 nomeas_13
s_cmp_lg_u32 s50,0
s_cbranch_scc1 nomeas_13
s_mov_b64 exec,1
s_mov_b32 s65,1
s_cmp_eq_u32 s56,1
s_cbranch_scc1 pub_14
s_mov_b32 s66,138526720
s_mov_b32 s67,138534912
s_mov_b32 s70,0x7fffffff
s_mov_b32 s71,0x7fffffff
s_mov_b32 s72,8
mlp_15:
s_memtime s[94:95]
s_waitcnt lgkmcnt(0)
buffer_store_dword v16,off,s[20:23],s66 sc1
s_waitcnt vmcnt(0)
s_memtime s[96:97]
s_waitcnt lgkmcnt(0)
s_sub_u32 s96,s96,s94
s_min_u32 s70,s70,s96
s_memtime s[94:95]
s_waitcnt lgkmcnt(0)
buffer_store_dword v16,off,s[20:23],s67 sc1
s_waitcnt vmcnt(0)
s_memtime s[96:97]
s_waitcnt lgkmcnt(0)
s_sub_u32 s96,s96,s94
s_min_u32 s71,s71,s96
s_sub_u32 s72,s72,1
s_cmp_gt_u32 s72,0
s_cbranch_scc1 mlp_15
s_cmp_gt_u32 s71,s70
s_cselect_b32 s65,2,1
pub_14:
s_mov_b32 s92,s2
s_and_b32 s93,s3,0xffff
s_mov_b32 s94,0x100
s_mov_b32 s95,0x20000
v_mov_b32 v16,s65
s_add_u32 s64,s88,20
buffer_store_dword v16,off,s[92:95],s64 sc1
s_mov_b64 exec,-1
nomeas_13:
s_barrier
s_sub_u32 s59,s58,192
s_and_b32 s52,s59,15
s_lshr_b32 s53,s59,4
s_lshl_b32 s64,s50,6
v_add_u32 v14,s64,v1
v_lshrrev_b32 v2,4,v14
v_and_b32 v3,15,v14
v_mul_u32_u24 v13,196608,v2
v_lshl_add_u32 v13,v3,4,v13
s_mul_i32 s54,s53,3145728
s_lshl_b32 s64,s52,9
s_add_u32 s54,s54,s64
s_add_u32 s54,s54,4096
v_lshlrev_b32 v15,1,v14
s_lshl_b32 s55,s53,9
s_mov_b32 s60,0
s_mov_b32 s73,0xffff0000
s_sub_u32 s61,s58,128
s_lshl_b32 s61,s61,15
v_lshlrev_b32 v25,6,v2
v_lshlrev_b32 v24,4,v1
v_and_b32 v2,3,v1
v_lshrrev_b32 v3,2,v1
s_lshl_b32 s64,s60,2
v_add_u32 v4,s64,v2
s_lshl_b32 s65,s50,9
v_lshlrev_b32 v5,4,v3
v_add_u32 v5,s65,v5
v_lshl_add_u32 v8,v4,11,v5
v_lshlrev_b32 v9,1,v5
v_lshrrev_b32 v5,2,v3
v_and_b32 v3,3,v3
s_lshl_b32 s65,s50,13
v_lshlrev_b32 v5,10,v5
v_lshl_add_u32 v5,v3,8,v5
v_lshl_add_u32 v5,v4,4,v5
v_add_u32 v10,s65,v5
s_lshl_b32 s65,s50,9
v_lshlrev_b32 v5,3,v1
v_add_u32 v11,s65,v5
v_lshlrev_b32 v12,3,v2
s_waitcnt lgkmcnt(0)
s_mov_b32 s24,s4
s_and_b32 s25,s5,0xffff
s_mov_b32 s26,0x800
s_mov_b32 s27,0x20000
s_mov_b32 s28,s6
s_and_b32 s29,s7,0xffff
s_mov_b32 s30,0xc00000
s_mov_b32 s31,0x20000
s_mov_b32 s32,s8
s_and_b32 s33,s9,0xffff
s_mov_b32 s34,0x400000
s_mov_b32 s35,0x20000
v_mov_b32 v28,-1
v_mov_b32 v20,0
v_mov_b32 v29,-1
v_mov_b32 v21,0
v_mov_b32 v30,-1
v_mov_b32 v22,0
v_mov_b32 v31,-1
v_mov_b32 v23,0
s_load_dwordx8 s[36:43],s[0:1],16
s_cmp_eq_u32 s58,220
s_cbranch_scc1 npf_16
s_lshl_b32 s64,s59,2
s_add_u32 s64,s64,s50
v_lshlrev_b32 v16,10,v1
v_lshlrev_b32 v17,7,v1
s_waitcnt lgkmcnt(0)
s_mov_b32 s68,s36
s_and_b32 s69,s37,0xffff
s_mov_b32 s70,0x800000
s_mov_b32 s71,0x20000
s_mov_b32 s72,s38
s_and_b32 s73,s39,0xffff
s_mov_b32 s74,0x800000
s_mov_b32 s75,0x20000
s_mov_b32 s76,s40
s_and_b32 s77,s41,0xffff
s_mov_b32 s78,0x800000
s_mov_b32 s79,0x20000
s_mov_b32 s92,s42
s_and_b32 s93,s43,0xffff
s_mov_b32 s94,0x800000
s_mov_b32 s95,0x20000
s_and_b32 s65,s64,127
s_lshl_b32 s65,s65,16
s_add_u32 s65,s65,384
s_cmp_ge_u32 s64,128
s_cselect_b64 s[44:45],s[72:73],s[68:69]
s_cselect_b64 s[46:47],s[74:75],s[70:71]
buffer_load_dword v26,v16,s[44:47],s65 offen
s_cselect_b64 s[44:45],s[92:93],s[76:77]
buffer_load_dword v26,v16,s[44:47],s65 offen
v_lshlrev_b32 v19,13,v1
s_and_b32 s65,s64,15
s_lshl_b32 s65,s65,19
s_add_u32 s65,s65,8064
s_cmp_ge_u32 s64,16
s_cselect_b64 s[44:45],s[72:73],s[68:69]
s_cmp_ge_u32 s64,32
s_cselect_b64 s[44:45],s[76:77],s[44:45]
s_cmp_ge_u32 s64,48
s_cselect_b32 s65,2.0,s65
buffer_load_dword v26,v19,s[44:47],s65 offen
s_lshl_b32 s65,s64,13
npf_16:
s_mov_b32 s73,0xffff0000
s_cmp_eq_u32 s58,220
s_cbranch_scc1 fl2_18
s_mov_b32 s62,s59
fl1_17:
s_lshl_b32 s64,s62,2
s_add_u32 s64,s64,s50
s_mul_i32 s64,s64,2048
s_add_u32 s64,s64,142606336
buffer_store_dwordx4 v[28:31],v24,s[20:23],s64 offen offset:0 sc1
buffer_store_dwordx4 v[28:31],v24,s[20:23],s64 offen offset:1024 sc1
s_lshl_b32 s64,s62,2
s_add_u32 s64,s64,s50
s_lshr_b32 s65,s64,6
s_lshl_b32 s65,s65,19
s_and_b32 s64,s64,63
s_mul_i32 s64,s64,2048
s_add_u32 s64,s64,134217728
s_add_u32 s64,s64,s65
buffer_store_dwordx4 v[28:31],v24,s[20:23],s64 offen offset:0 sc1
buffer_store_dwordx4 v[28:31],v24,s[20:23],s64 offen offset:1024 sc1
s_lshl_b32 s64,s62,2
s_add_u32 s64,s64,s50
s_lshr_b32 s65,s64,6
s_lshl_b32 s65,s65,19
s_and_b32 s64,s64,63
s_mul_i32 s64,s64,4096
s_add_u32 s64,s64,134479872
s_add_u32 s64,s64,s65
buffer_store_dwordx4 v[28:31],v24,s[20:23],s64 offen offset:0 sc1
buffer_store_dwordx4 v[28:31],v24,s[20:23],s64 offen offset:1024 sc1
buffer_store_dwordx4 v[28:31],v24,s[20:23],s64 offen offset:2048 sc1
buffer_store_dwordx4 v[28:31],v24,s[20:23],s64 offen offset:3072 sc1
s_lshl_b32 s64,s62,2
s_add_u32 s64,s64,s50
s_mul_i32 s64,s64,1024
s_add_u32 s64,s64,138412032
buffer_store_dwordx4 v[20:23],v24,s[20:23],s64 offen offset:0 sc1
s_cmp_eq_u32 s62,29
s_mov_b32 s62,28
s_cbranch_scc1 fl1_17
fl2_18:
s_waitcnt vmcnt(0)
s_barrier
s_cmp_lg_u32 s50,0
s_cbranch_scc1 sig_19
s_mov_b32 s92,s2
s_and_b32 s93,s3,0xffff
s_mov_b32 s94,0x100
s_mov_b32 s95,0x20000
s_add_u32 s64,s88,24
s_add_u32 s65,s88,32
s_cmp_eq_u32 s58,220
s_cselect_b32 s64,s65,s64
v_mov_b32 v16,1
s_mov_b64 exec,1
buffer_atomic_add v16,off,s[92:95],s64 sc1
s_mov_b64 exec,-1
sig_19:
s_mov_b32 s92,s2
s_and_b32 s93,s3,0xffff
s_mov_b32 s94,0x100
s_mov_b32 s95,0x20000
v_mbcnt_lo_u32_b32 v16,-1,0
v_mbcnt_hi_u32_b32 v16,-1,v16
v_mov_b32 v18,0
v_and_b32 v19,1,v16
v_cmp_eq_u32 vcc,1,v19
v_mov_b32 v19,8192
s_nop 0
v_cndmask_b32 v19,-1,v19,vcc
v_min_u32 v16,31,v16
v_lshlrev_b32 v16,2,v16
s_sub_u32 s66,s88,64
s_cmp_lg_u32 s50,0
s_cbranch_scc1 vot_24
s_mov_b32 s64,13
pre_26:
s_sleep 32
s_sub_u32 s64,s64,1
s_cmp_gt_i32 s64,0
s_cbranch_scc1 pre_26
vpoll_20:
buffer_load_dword v17,v16,s[92:95],s66 offen sc1
s_waitcnt vmcnt(0)
s_cmp_lg_u32 s56,2
s_cbranch_scc1 vck_21
v_cmp_eq_u32 vcc,v17,v19
s_and_b32 s64,vcc_lo,0xffff
s_cmp_eq_u32 s64,65535
s_cbranch_scc1 vck_21
s_mov_b32 s65,0
v_readlane_b32 s64,v17,1
s_lshr_b32 s64,s64,8
s_add_u32 s65,s65,s64
v_readlane_b32 s64,v17,3
s_lshr_b32 s64,s64,8
s_add_u32 s65,s65,s64
v_readlane_b32 s64,v17,5
s_lshr_b32 s64,s64,8
s_add_u32 s65,s65,s64
v_readlane_b32 s64,v17,7
s_lshr_b32 s64,s64,8
s_add_u32 s65,s65,s64
v_readlane_b32 s64,v17,9
s_lshr_b32 s64,s64,8
s_add_u32 s65,s65,s64
v_readlane_b32 s64,v17,11
s_lshr_b32 s64,s64,8
s_add_u32 s65,s65,s64
v_readlane_b32 s64,v17,13
s_lshr_b32 s64,s64,8
s_add_u32 s65,s65,s64
v_readlane_b32 s64,v17,15
s_lshr_b32 s64,s64,8
s_add_u32 s65,s65,s64
s_cmp_ge_u32 s65,256
s_cbranch_scc1 vok_23
s_branch vrt_22
vck_21:
v_cmp_gt_u32 vcc,v18,v17
s_cbranch_vccz vok_23
vrt_22:
s_sleep 48
s_sub_u32 s90,s90,1
s_cmp_gt_i32 s90,0
s_cbranch_scc1 vpoll_20
vok_23:
v_add_u32 v18,160256,v16
ds_write_b32 v18,v17
s_waitcnt lgkmcnt(0)
vot_24:
s_barrier
v_add_u32 v18,160256,v16
ds_read_b32 v17,v18
s_waitcnt lgkmcnt(0)
s_cmp_lg_u32 s56,2
s_cbranch_scc1 vfin_25
v_cmp_eq_u32 vcc,v17,v19
s_and_b32 s64,vcc_lo,0xffff
s_cmp_eq_u32 s64,65535
s_cbranch_scc1 vfin_25
s_mov_b32 s65,0
v_readlane_b32 s64,v17,1
s_lshr_b32 s64,s64,8
s_add_u32 s65,s65,s64
v_readlane_b32 s64,v17,3
s_lshr_b32 s64,s64,8
s_add_u32 s65,s65,s64
v_readlane_b32 s64,v17,5
s_lshr_b32 s64,s64,8
s_add_u32 s65,s65,s64
v_readlane_b32 s64,v17,7
s_lshr_b32 s64,s64,8
s_add_u32 s65,s65,s64
v_readlane_b32 s64,v17,9
s_lshr_b32 s64,s64,8
s_add_u32 s65,s65,s64
v_readlane_b32 s64,v17,11
s_lshr_b32 s64,s64,8
s_add_u32 s65,s65,s64
v_readlane_b32 s64,v17,13
s_lshr_b32 s64,s64,8
s_add_u32 s65,s65,s64
v_readlane_b32 s64,v17,15
s_lshr_b32 s64,s64,8
s_add_u32 s65,s65,s64
s_cmp_ge_u32 s65,256
s_cbranch_scc1 fl_fb
vfin_25:
s_and_b32 s56,s56,1
buffer_load_ushort v16,v15,s[24:27],s55 offen
buffer_load_dwordx4 v[96:99],v13,s[28:31],s54 offen offset:0 nt
buffer_load_dwordx4 v[160:163],v13,s[28:31],s54 offen offset:256 nt
s_add_u32 s54,s54,12288
s_waitcnt vmcnt(2)
buffer_load_dwordx4 v[100:103],v13,s[28:31],s54 offen offset:0 nt
buffer_load_dwordx4 v[164:167],v13,s[28:31],s54 offen offset:256 nt
s_add_u32 s54,s54,12288
s_waitcnt vmcnt(2)
buffer_load_dwordx4 v[104:107],v13,s[28:31],s54 offen offset:0 nt
buffer_load_dwordx4 v[168:171],v13,s[28:31],s54 offen offset:256 nt
s_add_u32 s54,s54,12288
s_waitcnt vmcnt(2)
buffer_load_dwordx4 v[108:111],v13,s[28:31],s54 offen offset:0 nt
buffer_load_dwordx4 v[172:175],v13,s[28:31],s54 offen offset:256 nt
s_add_u32 s54,s54,12288
s_waitcnt vmcnt(2)
buffer_load_dwordx4 v[112:115],v13,s[28:31],s54 offen offset:0 nt
buffer_load_dwordx4 v[176:179],v13,s[28:31],s54 offen offset:256 nt
s_add_u32 s54,s54,12288
s_waitcnt vmcnt(2)
buffer_load_dwordx4 v[116:119],v13,s[28:31],s54 offen offset:0 nt
buffer_load_dwordx4 v[180:183],v13,s[28:31],s54 offen offset:256 nt
s_add_u32 s54,s54,12288
s_waitcnt vmcnt(2)
buffer_load_dwordx4 v[120:123],v13,s[28:31],s54 offen offset:0 nt
buffer_load_dwordx4 v[184:187],v13,s[28:31],s54 offen offset:256 nt
s_add_u32 s54,s54,12288
s_waitcnt vmcnt(2)
buffer_load_dwordx4 v[124:127],v13,s[28:31],s54 offen offset:0 nt
buffer_load_dwordx4 v[188:191],v13,s[28:31],s54 offen offset:256 nt
s_add_u32 s54,s54,12288
s_waitcnt vmcnt(2)
buffer_load_dwordx4 v[128:131],v13,s[28:31],s54 offen offset:0 nt
buffer_load_dwordx4 v[192:195],v13,s[28:31],s54 offen offset:256 nt
s_add_u32 s54,s54,12288
s_waitcnt vmcnt(2)
buffer_load_dwordx4 v[132:135],v13,s[28:31],s54 offen offset:0 nt
buffer_load_dwordx4 v[196:199],v13,s[28:31],s54 offen offset:256 nt
s_add_u32 s54,s54,12288
s_waitcnt vmcnt(2)
buffer_load_dwordx4 v[136:139],v13,s[28:31],s54 offen offset:0 nt
buffer_load_dwordx4 v[200:203],v13,s[28:31],s54 offen offset:256 nt
s_add_u32 s54,s54,12288
s_waitcnt vmcnt(2)
buffer_load_dwordx4 v[140:143],v13,s[28:31],s54 offen offset:0 nt
buffer_load_dwordx4 v[204:207],v13,s[28:31],s54 offen offset:256 nt
s_add_u32 s54,s54,12288
s_waitcnt vmcnt(2)
buffer_load_dwordx4 v[144:147],v13,s[28:31],s54 offen offset:0 nt
buffer_load_dwordx4 v[208:211],v13,s[28:31],s54 offen offset:256 nt
s_add_u32 s54,s54,12288
s_waitcnt vmcnt(2)
buffer_load_dwordx4 v[148:151],v13,s[28:31],s54 offen offset:0 nt
buffer_load_dwordx4 v[212:215],v13,s[28:31],s54 offen offset:256 nt
s_add_u32 s54,s54,12288
s_waitcnt vmcnt(2)
buffer_load_dwordx4 v[152:155],v13,s[28:31],s54 offen offset:0 nt
buffer_load_dwordx4 v[216:219],v13,s[28:31],s54 offen offset:256 nt
s_add_u32 s54,s54,12288
s_waitcnt vmcnt(2)
buffer_load_dwordx4 v[156:159],v13,s[28:31],s54 offen offset:0 nt
buffer_load_dwordx4 v[220:223],v13,s[28:31],s54 offen offset:256 nt
s_waitcnt vmcnt(2)
s_add_u32 s64,s61,0
buffer_load_dwordx4 v[48:51],v8,s[32:35],s64 offen offset:0
buffer_load_dwordx4 v[52:55],v8,s[32:35],s64 offen offset:256
s_add_u32 s64,s61,8192
buffer_load_dwordx4 v[56:59],v8,s[32:35],s64 offen offset:0
buffer_load_dwordx4 v[60:63],v8,s[32:35],s64 offen offset:256
s_add_u32 s64,s61,16384
buffer_load_dwordx4 v[64:67],v8,s[32:35],s64 offen offset:0
buffer_load_dwordx4 v[68:71],v8,s[32:35],s64 offen offset:256
s_add_u32 s64,s61,24576
buffer_load_dwordx4 v[72:75],v8,s[32:35],s64 offen offset:0
buffer_load_dwordx4 v[76:79],v8,s[32:35],s64 offen offset:256
s_waitcnt vmcnt(40)
v_lshlrev_b32 v16,16,v16
v_mul_f32 v17,0xbfb8aa3b,v16
v_exp_f32 v17,v17
s_nop 0
v_add_f32 v17,1.0,v17
v_rcp_f32 v17,v17
s_nop 0
v_mul_f32 v17,v17,v16
v_cvt_pk_bf16_f32 v17,v17,v17
v_and_b32 v17,s73,v17
v_lshlrev_b32 v18,2,v14
ds_write_b32 v18,v17 offset:8192
s_waitcnt lgkmcnt(0)
s_barrier
ds_read_b128 v[32:35],v25 offset:8192
ds_read_b128 v[36:39],v25 offset:8208
ds_read_b128 v[40:43],v25 offset:8224
ds_read_b128 v[44:47],v25 offset:8240
v_mov_b32 v80,0
v_mov_b32 v81,0
v_mov_b32 v82,0
v_mov_b32 v83,0
v_mov_b32 v84,0
v_mov_b32 v85,0
v_mov_b32 v86,0
v_mov_b32 v87,0
v_mov_b32 v88,0
v_mov_b32 v89,0
v_mov_b32 v90,0
v_mov_b32 v91,0
v_mov_b32 v92,0
v_mov_b32 v93,0
v_mov_b32 v94,0
v_mov_b32 v95,0
s_waitcnt lgkmcnt(0)
s_waitcnt vmcnt(39)
v_lshlrev_b32 v16,16,v96
v_and_b32 v17,s73,v96
v_pk_fma_f32 v[80:81],v[16:17],v[32:33],v[80:81] op_sel:[0,0,0] op_sel_hi:[1,0,1]
v_lshlrev_b32 v18,16,v97
v_and_b32 v19,s73,v97
v_pk_fma_f32 v[82:83],v[18:19],v[32:33],v[82:83] op_sel:[0,0,0] op_sel_hi:[1,0,1]
v_lshlrev_b32 v16,16,v98
v_and_b32 v17,s73,v98
v_pk_fma_f32 v[84:85],v[16:17],v[32:33],v[84:85] op_sel:[0,0,0] op_sel_hi:[1,0,1]
v_lshlrev_b32 v18,16,v99
v_and_b32 v19,s73,v99
v_pk_fma_f32 v[86:87],v[18:19],v[32:33],v[86:87] op_sel:[0,0,0] op_sel_hi:[1,0,1]
s_waitcnt vmcnt(38)
v_lshlrev_b32 v16,16,v160
v_and_b32 v17,s73,v160
v_pk_fma_f32 v[88:89],v[16:17],v[32:33],v[88:89] op_sel:[0,0,0] op_sel_hi:[1,0,1]
v_lshlrev_b32 v18,16,v161
v_and_b32 v19,s73,v161
v_pk_fma_f32 v[90:91],v[18:19],v[32:33],v[90:91] op_sel:[0,0,0] op_sel_hi:[1,0,1]
v_lshlrev_b32 v16,16,v162
v_and_b32 v17,s73,v162
v_pk_fma_f32 v[92:93],v[16:17],v[32:33],v[92:93] op_sel:[0,0,0] op_sel_hi:[1,0,1]
v_lshlrev_b32 v18,16,v163
v_and_b32 v19,s73,v163
v_pk_fma_f32 v[94:95],v[18:19],v[32:33],v[94:95] op_sel:[0,0,0] op_sel_hi:[1,0,1]
s_waitcnt vmcnt(37)
v_lshlrev_b32 v16,16,v100
v_and_b32 v17,s73,v100
v_pk_fma_f32 v[80:81],v[16:17],v[32:33],v[80:81] op_sel:[0,1,0] op_sel_hi:[1,1,1]
v_lshlrev_b32 v18,16,v101
v_and_b32 v19,s73,v101
v_pk_fma_f32 v[82:83],v[18:19],v[32:33],v[82:83] op_sel:[0,1,0] op_sel_hi:[1,1,1]
v_lshlrev_b32 v16,16,v102
v_and_b32 v17,s73,v102
v_pk_fma_f32 v[84:85],v[16:17],v[32:33],v[84:85] op_sel:[0,1,0] op_sel_hi:[1,1,1]
v_lshlrev_b32 v18,16,v103
v_and_b32 v19,s73,v103
v_pk_fma_f32 v[86:87],v[18:19],v[32:33],v[86:87] op_sel:[0,1,0] op_sel_hi:[1,1,1]
s_waitcnt vmcnt(36)
v_lshlrev_b32 v16,16,v164
v_and_b32 v17,s73,v164
v_pk_fma_f32 v[88:89],v[16:17],v[32:33],v[88:89] op_sel:[0,1,0] op_sel_hi:[1,1,1]
v_lshlrev_b32 v18,16,v165
v_and_b32 v19,s73,v165
v_pk_fma_f32 v[90:91],v[18:19],v[32:33],v[90:91] op_sel:[0,1,0] op_sel_hi:[1,1,1]
v_lshlrev_b32 v16,16,v166
v_and_b32 v17,s73,v166
v_pk_fma_f32 v[92:93],v[16:17],v[32:33],v[92:93] op_sel:[0,1,0] op_sel_hi:[1,1,1]
v_lshlrev_b32 v18,16,v167
v_and_b32 v19,s73,v167
v_pk_fma_f32 v[94:95],v[18:19],v[32:33],v[94:95] op_sel:[0,1,0] op_sel_hi:[1,1,1]
s_waitcnt vmcnt(35)
v_lshlrev_b32 v16,16,v104
v_and_b32 v17,s73,v104
v_pk_fma_f32 v[80:81],v[16:17],v[34:35],v[80:81] op_sel:[0,0,0] op_sel_hi:[1,0,1]
v_lshlrev_b32 v18,16,v105
v_and_b32 v19,s73,v105
v_pk_fma_f32 v[82:83],v[18:19],v[34:35],v[82:83] op_sel:[0,0,0] op_sel_hi:[1,0,1]
v_lshlrev_b32 v16,16,v106
v_and_b32 v17,s73,v106
v_pk_fma_f32 v[84:85],v[16:17],v[34:35],v[84:85] op_sel:[0,0,0] op_sel_hi:[1,0,1]
v_lshlrev_b32 v18,16,v107
v_and_b32 v19,s73,v107
v_pk_fma_f32 v[86:87],v[18:19],v[34:35],v[86:87] op_sel:[0,0,0] op_sel_hi:[1,0,1]
s_waitcnt vmcnt(34)
v_lshlrev_b32 v16,16,v168
v_and_b32 v17,s73,v168
v_pk_fma_f32 v[88:89],v[16:17],v[34:35],v[88:89] op_sel:[0,0,0] op_sel_hi:[1,0,1]
v_lshlrev_b32 v18,16,v169
v_and_b32 v19,s73,v169
v_pk_fma_f32 v[90:91],v[18:19],v[34:35],v[90:91] op_sel:[0,0,0] op_sel_hi:[1,0,1]
v_lshlrev_b32 v16,16,v170
v_and_b32 v17,s73,v170
v_pk_fma_f32 v[92:93],v[16:17],v[34:35],v[92:93] op_sel:[0,0,0] op_sel_hi:[1,0,1]
v_lshlrev_b32 v18,16,v171
v_and_b32 v19,s73,v171
v_pk_fma_f32 v[94:95],v[18:19],v[34:35],v[94:95] op_sel:[0,0,0] op_sel_hi:[1,0,1]
s_waitcnt vmcnt(33)
v_lshlrev_b32 v16,16,v108
v_and_b32 v17,s73,v108
v_pk_fma_f32 v[80:81],v[16:17],v[34:35],v[80:81] op_sel:[0,1,0] op_sel_hi:[1,1,1]
v_lshlrev_b32 v18,16,v109
v_and_b32 v19,s73,v109
v_pk_fma_f32 v[82:83],v[18:19],v[34:35],v[82:83] op_sel:[0,1,0] op_sel_hi:[1,1,1]
v_lshlrev_b32 v16,16,v110
v_and_b32 v17,s73,v110
v_pk_fma_f32 v[84:85],v[16:17],v[34:35],v[84:85] op_sel:[0,1,0] op_sel_hi:[1,1,1]
v_lshlrev_b32 v18,16,v111
v_and_b32 v19,s73,v111
v_pk_fma_f32 v[86:87],v[18:19],v[34:35],v[86:87] op_sel:[0,1,0] op_sel_hi:[1,1,1]
s_waitcnt vmcnt(32)
v_lshlrev_b32 v16,16,v172
v_and_b32 v17,s73,v172
v_pk_fma_f32 v[88:89],v[16:17],v[34:35],v[88:89] op_sel:[0,1,0] op_sel_hi:[1,1,1]
v_lshlrev_b32 v18,16,v173
v_and_b32 v19,s73,v173
v_pk_fma_f32 v[90:91],v[18:19],v[34:35],v[90:91] op_sel:[0,1,0] op_sel_hi:[1,1,1]
v_lshlrev_b32 v16,16,v174
v_and_b32 v17,s73,v174
v_pk_fma_f32 v[92:93],v[16:17],v[34:35],v[92:93] op_sel:[0,1,0] op_sel_hi:[1,1,1]
v_lshlrev_b32 v18,16,v175
v_and_b32 v19,s73,v175
v_pk_fma_f32 v[94:95],v[18:19],v[34:35],v[94:95] op_sel:[0,1,0] op_sel_hi:[1,1,1]
s_waitcnt vmcnt(31)
v_lshlrev_b32 v16,16,v112
v_and_b32 v17,s73,v112
v_pk_fma_f32 v[80:81],v[16:17],v[36:37],v[80:81] op_sel:[0,0,0] op_sel_hi:[1,0,1]
v_lshlrev_b32 v18,16,v113
v_and_b32 v19,s73,v113
v_pk_fma_f32 v[82:83],v[18:19],v[36:37],v[82:83] op_sel:[0,0,0] op_sel_hi:[1,0,1]
v_lshlrev_b32 v16,16,v114
v_and_b32 v17,s73,v114
v_pk_fma_f32 v[84:85],v[16:17],v[36:37],v[84:85] op_sel:[0,0,0] op_sel_hi:[1,0,1]
v_lshlrev_b32 v18,16,v115
v_and_b32 v19,s73,v115
v_pk_fma_f32 v[86:87],v[18:19],v[36:37],v[86:87] op_sel:[0,0,0] op_sel_hi:[1,0,1]
s_waitcnt vmcnt(30)
v_lshlrev_b32 v16,16,v176
v_and_b32 v17,s73,v176
v_pk_fma_f32 v[88:89],v[16:17],v[36:37],v[88:89] op_sel:[0,0,0] op_sel_hi:[1,0,1]
v_lshlrev_b32 v18,16,v177
v_and_b32 v19,s73,v177
v_pk_fma_f32 v[90:91],v[18:19],v[36:37],v[90:91] op_sel:[0,0,0] op_sel_hi:[1,0,1]
v_lshlrev_b32 v16,16,v178
v_and_b32 v17,s73,v178
v_pk_fma_f32 v[92:93],v[16:17],v[36:37],v[92:93] op_sel:[0,0,0] op_sel_hi:[1,0,1]
v_lshlrev_b32 v18,16,v179
v_and_b32 v19,s73,v179
v_pk_fma_f32 v[94:95],v[18:19],v[36:37],v[94:95] op_sel:[0,0,0] op_sel_hi:[1,0,1]
s_waitcnt vmcnt(29)
v_lshlrev_b32 v16,16,v116
v_and_b32 v17,s73,v116
v_pk_fma_f32 v[80:81],v[16:17],v[36:37],v[80:81] op_sel:[0,1,0] op_sel_hi:[1,1,1]
v_lshlrev_b32 v18,16,v117
v_and_b32 v19,s73,v117
v_pk_fma_f32 v[82:83],v[18:19],v[36:37],v[82:83] op_sel:[0,1,0] op_sel_hi:[1,1,1]
v_lshlrev_b32 v16,16,v118
v_and_b32 v17,s73,v118
v_pk_fma_f32 v[84:85],v[16:17],v[36:37],v[84:85] op_sel:[0,1,0] op_sel_hi:[1,1,1]
v_lshlrev_b32 v18,16,v119
v_and_b32 v19,s73,v119
v_pk_fma_f32 v[86:87],v[18:19],v[36:37],v[86:87] op_sel:[0,1,0] op_sel_hi:[1,1,1]
s_waitcnt vmcnt(28)
v_lshlrev_b32 v16,16,v180
v_and_b32 v17,s73,v180
v_pk_fma_f32 v[88:89],v[16:17],v[36:37],v[88:89] op_sel:[0,1,0] op_sel_hi:[1,1,1]
v_lshlrev_b32 v18,16,v181
v_and_b32 v19,s73,v181
v_pk_fma_f32 v[90:91],v[18:19],v[36:37],v[90:91] op_sel:[0,1,0] op_sel_hi:[1,1,1]
v_lshlrev_b32 v16,16,v182
v_and_b32 v17,s73,v182
v_pk_fma_f32 v[92:93],v[16:17],v[36:37],v[92:93] op_sel:[0,1,0] op_sel_hi:[1,1,1]
v_lshlrev_b32 v18,16,v183
v_and_b32 v19,s73,v183
v_pk_fma_f32 v[94:95],v[18:19],v[36:37],v[94:95] op_sel:[0,1,0] op_sel_hi:[1,1,1]
s_waitcnt vmcnt(27)
v_lshlrev_b32 v16,16,v120
v_and_b32 v17,s73,v120
v_pk_fma_f32 v[80:81],v[16:17],v[38:39],v[80:81] op_sel:[0,0,0] op_sel_hi:[1,0,1]
v_lshlrev_b32 v18,16,v121
v_and_b32 v19,s73,v121
v_pk_fma_f32 v[82:83],v[18:19],v[38:39],v[82:83] op_sel:[0,0,0] op_sel_hi:[1,0,1]
v_lshlrev_b32 v16,16,v122
v_and_b32 v17,s73,v122
v_pk_fma_f32 v[84:85],v[16:17],v[38:39],v[84:85] op_sel:[0,0,0] op_sel_hi:[1,0,1]
v_lshlrev_b32 v18,16,v123
v_and_b32 v19,s73,v123
v_pk_fma_f32 v[86:87],v[18:19],v[38:39],v[86:87] op_sel:[0,0,0] op_sel_hi:[1,0,1]
s_waitcnt vmcnt(26)
v_lshlrev_b32 v16,16,v184
v_and_b32 v17,s73,v184
v_pk_fma_f32 v[88:89],v[16:17],v[38:39],v[88:89] op_sel:[0,0,0] op_sel_hi:[1,0,1]
v_lshlrev_b32 v18,16,v185
v_and_b32 v19,s73,v185
v_pk_fma_f32 v[90:91],v[18:19],v[38:39],v[90:91] op_sel:[0,0,0] op_sel_hi:[1,0,1]
v_lshlrev_b32 v16,16,v186
v_and_b32 v17,s73,v186
v_pk_fma_f32 v[92:93],v[16:17],v[38:39],v[92:93] op_sel:[0,0,0] op_sel_hi:[1,0,1]
v_lshlrev_b32 v18,16,v187
v_and_b32 v19,s73,v187
v_pk_fma_f32 v[94:95],v[18:19],v[38:39],v[94:95] op_sel:[0,0,0] op_sel_hi:[1,0,1]
s_waitcnt vmcnt(25)
v_lshlrev_b32 v16,16,v124
v_and_b32 v17,s73,v124
v_pk_fma_f32 v[80:81],v[16:17],v[38:39],v[80:81] op_sel:[0,1,0] op_sel_hi:[1,1,1]
v_lshlrev_b32 v18,16,v125
v_and_b32 v19,s73,v125
v_pk_fma_f32 v[82:83],v[18:19],v[38:39],v[82:83] op_sel:[0,1,0] op_sel_hi:[1,1,1]
v_lshlrev_b32 v16,16,v126
v_and_b32 v17,s73,v126
v_pk_fma_f32 v[84:85],v[16:17],v[38:39],v[84:85] op_sel:[0,1,0] op_sel_hi:[1,1,1]
v_lshlrev_b32 v18,16,v127
v_and_b32 v19,s73,v127
v_pk_fma_f32 v[86:87],v[18:19],v[38:39],v[86:87] op_sel:[0,1,0] op_sel_hi:[1,1,1]
s_waitcnt vmcnt(24)
v_lshlrev_b32 v16,16,v188
v_and_b32 v17,s73,v188
v_pk_fma_f32 v[88:89],v[16:17],v[38:39],v[88:89] op_sel:[0,1,0] op_sel_hi:[1,1,1]
v_lshlrev_b32 v18,16,v189
v_and_b32 v19,s73,v189
v_pk_fma_f32 v[90:91],v[18:19],v[38:39],v[90:91] op_sel:[0,1,0] op_sel_hi:[1,1,1]
v_lshlrev_b32 v16,16,v190
v_and_b32 v17,s73,v190
v_pk_fma_f32 v[92:93],v[16:17],v[38:39],v[92:93] op_sel:[0,1,0] op_sel_hi:[1,1,1]
v_lshlrev_b32 v18,16,v191
v_and_b32 v19,s73,v191
v_pk_fma_f32 v[94:95],v[18:19],v[38:39],v[94:95] op_sel:[0,1,0] op_sel_hi:[1,1,1]
s_waitcnt vmcnt(23)
v_lshlrev_b32 v16,16,v128
v_and_b32 v17,s73,v128
v_pk_fma_f32 v[80:81],v[16:17],v[40:41],v[80:81] op_sel:[0,0,0] op_sel_hi:[1,0,1]
v_lshlrev_b32 v18,16,v129
v_and_b32 v19,s73,v129
v_pk_fma_f32 v[82:83],v[18:19],v[40:41],v[82:83] op_sel:[0,0,0] op_sel_hi:[1,0,1]
v_lshlrev_b32 v16,16,v130
v_and_b32 v17,s73,v130
v_pk_fma_f32 v[84:85],v[16:17],v[40:41],v[84:85] op_sel:[0,0,0] op_sel_hi:[1,0,1]
v_lshlrev_b32 v18,16,v131
v_and_b32 v19,s73,v131
v_pk_fma_f32 v[86:87],v[18:19],v[40:41],v[86:87] op_sel:[0,0,0] op_sel_hi:[1,0,1]
s_waitcnt vmcnt(22)
v_lshlrev_b32 v16,16,v192
v_and_b32 v17,s73,v192
v_pk_fma_f32 v[88:89],v[16:17],v[40:41],v[88:89] op_sel:[0,0,0] op_sel_hi:[1,0,1]
v_lshlrev_b32 v18,16,v193
v_and_b32 v19,s73,v193
v_pk_fma_f32 v[90:91],v[18:19],v[40:41],v[90:91] op_sel:[0,0,0] op_sel_hi:[1,0,1]
v_lshlrev_b32 v16,16,v194
v_and_b32 v17,s73,v194
v_pk_fma_f32 v[92:93],v[16:17],v[40:41],v[92:93] op_sel:[0,0,0] op_sel_hi:[1,0,1]
v_lshlrev_b32 v18,16,v195
v_and_b32 v19,s73,v195
v_pk_fma_f32 v[94:95],v[18:19],v[40:41],v[94:95] op_sel:[0,0,0] op_sel_hi:[1,0,1]
s_waitcnt vmcnt(21)
v_lshlrev_b32 v16,16,v132
v_and_b32 v17,s73,v132
v_pk_fma_f32 v[80:81],v[16:17],v[40:41],v[80:81] op_sel:[0,1,0] op_sel_hi:[1,1,1]
v_lshlrev_b32 v18,16,v133
v_and_b32 v19,s73,v133
v_pk_fma_f32 v[82:83],v[18:19],v[40:41],v[82:83] op_sel:[0,1,0] op_sel_hi:[1,1,1]
v_lshlrev_b32 v16,16,v134
v_and_b32 v17,s73,v134
v_pk_fma_f32 v[84:85],v[16:17],v[40:41],v[84:85] op_sel:[0,1,0] op_sel_hi:[1,1,1]
v_lshlrev_b32 v18,16,v135
v_and_b32 v19,s73,v135
v_pk_fma_f32 v[86:87],v[18:19],v[40:41],v[86:87] op_sel:[0,1,0] op_sel_hi:[1,1,1]
s_waitcnt vmcnt(20)
v_lshlrev_b32 v16,16,v196
v_and_b32 v17,s73,v196
v_pk_fma_f32 v[88:89],v[16:17],v[40:41],v[88:89] op_sel:[0,1,0] op_sel_hi:[1,1,1]
v_lshlrev_b32 v18,16,v197
v_and_b32 v19,s73,v197
v_pk_fma_f32 v[90:91],v[18:19],v[40:41],v[90:91] op_sel:[0,1,0] op_sel_hi:[1,1,1]
v_lshlrev_b32 v16,16,v198
v_and_b32 v17,s73,v198
v_pk_fma_f32 v[92:93],v[16:17],v[40:41],v[92:93] op_sel:[0,1,0] op_sel_hi:[1,1,1]
v_lshlrev_b32 v18,16,v199
v_and_b32 v19,s73,v199
v_pk_fma_f32 v[94:95],v[18:19],v[40:41],v[94:95] op_sel:[0,1,0] op_sel_hi:[1,1,1]
s_waitcnt vmcnt(19)
v_lshlrev_b32 v16,16,v136
v_and_b32 v17,s73,v136
v_pk_fma_f32 v[80:81],v[16:17],v[42:43],v[80:81] op_sel:[0,0,0] op_sel_hi:[1,0,1]
v_lshlrev_b32 v18,16,v137
v_and_b32 v19,s73,v137
v_pk_fma_f32 v[82:83],v[18:19],v[42:43],v[82:83] op_sel:[0,0,0] op_sel_hi:[1,0,1]
v_lshlrev_b32 v16,16,v138
v_and_b32 v17,s73,v138
v_pk_fma_f32 v[84:85],v[16:17],v[42:43],v[84:85] op_sel:[0,0,0] op_sel_hi:[1,0,1]
v_lshlrev_b32 v18,16,v139
v_and_b32 v19,s73,v139
v_pk_fma_f32 v[86:87],v[18:19],v[42:43],v[86:87] op_sel:[0,0,0] op_sel_hi:[1,0,1]
s_waitcnt vmcnt(18)
v_lshlrev_b32 v16,16,v200
v_and_b32 v17,s73,v200
v_pk_fma_f32 v[88:89],v[16:17],v[42:43],v[88:89] op_sel:[0,0,0] op_sel_hi:[1,0,1]
v_lshlrev_b32 v18,16,v201
v_and_b32 v19,s73,v201
v_pk_fma_f32 v[90:91],v[18:19],v[42:43],v[90:91] op_sel:[0,0,0] op_sel_hi:[1,0,1]
v_lshlrev_b32 v16,16,v202
v_and_b32 v17,s73,v202
v_pk_fma_f32 v[92:93],v[16:17],v[42:43],v[92:93] op_sel:[0,0,0] op_sel_hi:[1,0,1]
v_lshlrev_b32 v18,16,v203
v_and_b32 v19,s73,v203
v_pk_fma_f32 v[94:95],v[18:19],v[42:43],v[94:95] op_sel:[0,0,0] op_sel_hi:[1,0,1]
s_waitcnt vmcnt(17)
v_lshlrev_b32 v16,16,v140
v_and_b32 v17,s73,v140
v_pk_fma_f32 v[80:81],v[16:17],v[42:43],v[80:81] op_sel:[0,1,0] op_sel_hi:[1,1,1]
v_lshlrev_b32 v18,16,v141
v_and_b32 v19,s73,v141
v_pk_fma_f32 v[82:83],v[18:19],v[42:43],v[82:83] op_sel:[0,1,0] op_sel_hi:[1,1,1]
v_lshlrev_b32 v16,16,v142
v_and_b32 v17,s73,v142
v_pk_fma_f32 v[84:85],v[16:17],v[42:43],v[84:85] op_sel:[0,1,0] op_sel_hi:[1,1,1]
v_lshlrev_b32 v18,16,v143
v_and_b32 v19,s73,v143
v_pk_fma_f32 v[86:87],v[18:19],v[42:43],v[86:87] op_sel:[0,1,0] op_sel_hi:[1,1,1]
s_waitcnt vmcnt(16)
v_lshlrev_b32 v16,16,v204
v_and_b32 v17,s73,v204
v_pk_fma_f32 v[88:89],v[16:17],v[42:43],v[88:89] op_sel:[0,1,0] op_sel_hi:[1,1,1]
v_lshlrev_b32 v18,16,v205
v_and_b32 v19,s73,v205
v_pk_fma_f32 v[90:91],v[18:19],v[42:43],v[90:91] op_sel:[0,1,0] op_sel_hi:[1,1,1]
v_lshlrev_b32 v16,16,v206
v_and_b32 v17,s73,v206
v_pk_fma_f32 v[92:93],v[16:17],v[42:43],v[92:93] op_sel:[0,1,0] op_sel_hi:[1,1,1]
v_lshlrev_b32 v18,16,v207
v_and_b32 v19,s73,v207
v_pk_fma_f32 v[94:95],v[18:19],v[42:43],v[94:95] op_sel:[0,1,0] op_sel_hi:[1,1,1]
s_waitcnt vmcnt(15)
v_lshlrev_b32 v16,16,v144
v_and_b32 v17,s73,v144
v_pk_fma_f32 v[80:81],v[16:17],v[44:45],v[80:81] op_sel:[0,0,0] op_sel_hi:[1,0,1]
v_lshlrev_b32 v18,16,v145
v_and_b32 v19,s73,v145
v_pk_fma_f32 v[82:83],v[18:19],v[44:45],v[82:83] op_sel:[0,0,0] op_sel_hi:[1,0,1]
v_lshlrev_b32 v16,16,v146
v_and_b32 v17,s73,v146
v_pk_fma_f32 v[84:85],v[16:17],v[44:45],v[84:85] op_sel:[0,0,0] op_sel_hi:[1,0,1]
v_lshlrev_b32 v18,16,v147
v_and_b32 v19,s73,v147
v_pk_fma_f32 v[86:87],v[18:19],v[44:45],v[86:87] op_sel:[0,0,0] op_sel_hi:[1,0,1]
s_waitcnt vmcnt(14)
v_lshlrev_b32 v16,16,v208
v_and_b32 v17,s73,v208
v_pk_fma_f32 v[88:89],v[16:17],v[44:45],v[88:89] op_sel:[0,0,0] op_sel_hi:[1,0,1]
v_lshlrev_b32 v18,16,v209
v_and_b32 v19,s73,v209
v_pk_fma_f32 v[90:91],v[18:19],v[44:45],v[90:91] op_sel:[0,0,0] op_sel_hi:[1,0,1]
v_lshlrev_b32 v16,16,v210
v_and_b32 v17,s73,v210
v_pk_fma_f32 v[92:93],v[16:17],v[44:45],v[92:93] op_sel:[0,0,0] op_sel_hi:[1,0,1]
v_lshlrev_b32 v18,16,v211
v_and_b32 v19,s73,v211
v_pk_fma_f32 v[94:95],v[18:19],v[44:45],v[94:95] op_sel:[0,0,0] op_sel_hi:[1,0,1]
s_waitcnt vmcnt(13)
v_lshlrev_b32 v16,16,v148
v_and_b32 v17,s73,v148
v_pk_fma_f32 v[80:81],v[16:17],v[44:45],v[80:81] op_sel:[0,1,0] op_sel_hi:[1,1,1]
v_lshlrev_b32 v18,16,v149
v_and_b32 v19,s73,v149
v_pk_fma_f32 v[82:83],v[18:19],v[44:45],v[82:83] op_sel:[0,1,0] op_sel_hi:[1,1,1]
v_lshlrev_b32 v16,16,v150
v_and_b32 v17,s73,v150
v_pk_fma_f32 v[84:85],v[16:17],v[44:45],v[84:85] op_sel:[0,1,0] op_sel_hi:[1,1,1]
v_lshlrev_b32 v18,16,v151
v_and_b32 v19,s73,v151
v_pk_fma_f32 v[86:87],v[18:19],v[44:45],v[86:87] op_sel:[0,1,0] op_sel_hi:[1,1,1]
s_waitcnt vmcnt(12)
v_lshlrev_b32 v16,16,v212
v_and_b32 v17,s73,v212
v_pk_fma_f32 v[88:89],v[16:17],v[44:45],v[88:89] op_sel:[0,1,0] op_sel_hi:[1,1,1]
v_lshlrev_b32 v18,16,v213
v_and_b32 v19,s73,v213
v_pk_fma_f32 v[90:91],v[18:19],v[44:45],v[90:91] op_sel:[0,1,0] op_sel_hi:[1,1,1]
v_lshlrev_b32 v16,16,v214
v_and_b32 v17,s73,v214
v_pk_fma_f32 v[92:93],v[16:17],v[44:45],v[92:93] op_sel:[0,1,0] op_sel_hi:[1,1,1]
v_lshlrev_b32 v18,16,v215
v_and_b32 v19,s73,v215
v_pk_fma_f32 v[94:95],v[18:19],v[44:45],v[94:95] op_sel:[0,1,0] op_sel_hi:[1,1,1]
s_waitcnt vmcnt(11)
v_lshlrev_b32 v16,16,v152
v_and_b32 v17,s73,v152
v_pk_fma_f32 v[80:81],v[16:17],v[46:47],v[80:81] op_sel:[0,0,0] op_sel_hi:[1,0,1]
v_lshlrev_b32 v18,16,v153
v_and_b32 v19,s73,v153
v_pk_fma_f32 v[82:83],v[18:19],v[46:47],v[82:83] op_sel:[0,0,0] op_sel_hi:[1,0,1]
v_lshlrev_b32 v16,16,v154
v_and_b32 v17,s73,v154
v_pk_fma_f32 v[84:85],v[16:17],v[46:47],v[84:85] op_sel:[0,0,0] op_sel_hi:[1,0,1]
v_lshlrev_b32 v18,16,v155
v_and_b32 v19,s73,v155
v_pk_fma_f32 v[86:87],v[18:19],v[46:47],v[86:87] op_sel:[0,0,0] op_sel_hi:[1,0,1]
s_waitcnt vmcnt(10)
v_lshlrev_b32 v16,16,v216
v_and_b32 v17,s73,v216
v_pk_fma_f32 v[88:89],v[16:17],v[46:47],v[88:89] op_sel:[0,0,0] op_sel_hi:[1,0,1]
v_lshlrev_b32 v18,16,v217
v_and_b32 v19,s73,v217
v_pk_fma_f32 v[90:91],v[18:19],v[46:47],v[90:91] op_sel:[0,0,0] op_sel_hi:[1,0,1]
v_lshlrev_b32 v16,16,v218
v_and_b32 v17,s73,v218
v_pk_fma_f32 v[92:93],v[16:17],v[46:47],v[92:93] op_sel:[0,0,0] op_sel_hi:[1,0,1]
v_lshlrev_b32 v18,16,v219
v_and_b32 v19,s73,v219
v_pk_fma_f32 v[94:95],v[18:19],v[46:47],v[94:95] op_sel:[0,0,0] op_sel_hi:[1,0,1]
s_waitcnt vmcnt(9)
v_lshlrev_b32 v16,16,v156
v_and_b32 v17,s73,v156
v_pk_fma_f32 v[80:81],v[16:17],v[46:47],v[80:81] op_sel:[0,1,0] op_sel_hi:[1,1,1]
v_lshlrev_b32 v18,16,v157
v_and_b32 v19,s73,v157
v_pk_fma_f32 v[82:83],v[18:19],v[46:47],v[82:83] op_sel:[0,1,0] op_sel_hi:[1,1,1]
v_lshlrev_b32 v16,16,v158
v_and_b32 v17,s73,v158
v_pk_fma_f32 v[84:85],v[16:17],v[46:47],v[84:85] op_sel:[0,1,0] op_sel_hi:[1,1,1]
v_lshlrev_b32 v18,16,v159
v_and_b32 v19,s73,v159
v_pk_fma_f32 v[86:87],v[18:19],v[46:47],v[86:87] op_sel:[0,1,0] op_sel_hi:[1,1,1]
s_waitcnt vmcnt(8)
v_lshlrev_b32 v16,16,v220
v_and_b32 v17,s73,v220
v_pk_fma_f32 v[88:89],v[16:17],v[46:47],v[88:89] op_sel:[0,1,0] op_sel_hi:[1,1,1]
v_lshlrev_b32 v18,16,v221
v_and_b32 v19,s73,v221
v_pk_fma_f32 v[90:91],v[18:19],v[46:47],v[90:91] op_sel:[0,1,0] op_sel_hi:[1,1,1]
v_lshlrev_b32 v16,16,v222
v_and_b32 v17,s73,v222
v_pk_fma_f32 v[92:93],v[16:17],v[46:47],v[92:93] op_sel:[0,1,0] op_sel_hi:[1,1,1]
v_lshlrev_b32 v18,16,v223
v_and_b32 v19,s73,v223
v_pk_fma_f32 v[94:95],v[18:19],v[46:47],v[94:95] op_sel:[0,1,0] op_sel_hi:[1,1,1]
v_lshlrev_b32 v18,5,v14
ds_write_b128 v18,v[80:83] offset:16384
ds_write_b128 v18,v[84:87] offset:16400
ds_write_b128 v18,v[88:91] offset:24576
ds_write_b128 v18,v[92:95] offset:24592
v_and_b32 v18,127,v14
v_lshlrev_b32 v18,2,v18
v_lshrrev_b32 v19,7,v14
v_lshl_add_u32 v19,v19,13,v18
s_waitcnt lgkmcnt(0)
s_barrier
ds_read_b32 v32,v19 offset:16384
ds_read_b32 v33,v19 offset:16896
ds_read_b32 v34,v19 offset:17408
ds_read_b32 v35,v19 offset:17920
ds_read_b32 v36,v19 offset:18432
ds_read_b32 v37,v19 offset:18944
ds_read_b32 v38,v19 offset:19456
ds_read_b32 v39,v19 offset:19968
ds_read_b32 v40,v19 offset:20480
ds_read_b32 v41,v19 offset:20992
ds_read_b32 v42,v19 offset:21504
ds_read_b32 v43,v19 offset:22016
s_waitcnt lgkmcnt(4)
ds_read_b32 v44,v19 offset:22528
ds_read_b32 v45,v19 offset:23040
ds_read_b32 v46,v19 offset:23552
ds_read_b32 v47,v19 offset:24064
s_waitcnt lgkmcnt(0)
v_pk_add_f32 v[32:33],v[32:33],v[40:41]
v_pk_add_f32 v[34:35],v[34:35],v[42:43]
v_pk_add_f32 v[36:37],v[36:37],v[44:45]
v_pk_add_f32 v[38:39],v[38:39],v[46:47]
v_pk_add_f32 v[32:33],v[32:33],v[36:37]
v_pk_add_f32 v[34:35],v[34:35],v[38:39]
v_pk_add_f32 v[32:33],v[32:33],v[34:35]
v_add_f32 v32,v32,v33
s_mul_i32 s64,s53,24576
s_lshl_b32 s65,s52,10
s_add_u32 s64,s64,s65
s_add_u32 s64,s64,267395072
v_lshlrev_b32 v18,2,v14
buffer_store_dword v32,v18,s[20:23],s64 offen sc1
s_cmp_eq_u32 s58,220
s_cbranch_scc1 fl2_28
s_mov_b32 s62,s59
fl1_27:
s_lshl_b32 s64,s62,2
s_add_u32 s64,s64,s50
s_mul_i32 s64,s64,14336
s_add_u32 s64,s64,143130624
buffer_store_dwordx4 v[28:31],v24,s[20:23],s64 offen offset:0 sc1
s_waitcnt vmcnt(2)
buffer_store_dwordx4 v[28:31],v24,s[20:23],s64 offen offset:1024 sc1
s_waitcnt vmcnt(2)
buffer_store_dwordx4 v[28:31],v24,s[20:23],s64 offen offset:2048 sc1
s_waitcnt vmcnt(2)
buffer_store_dwordx4 v[28:31],v24,s[20:23],s64 offen offset:3072 sc1
s_waitcnt vmcnt(2)
s_add_u32 s64,s64,4096
buffer_store_dwordx4 v[28:31],v24,s[20:23],s64 offen offset:0 sc1
s_waitcnt vmcnt(2)
buffer_store_dwordx4 v[28:31],v24,s[20:23],s64 offen offset:1024 sc1
s_waitcnt vmcnt(2)
buffer_store_dwordx4 v[28:31],v24,s[20:23],s64 offen offset:2048 sc1
s_waitcnt vmcnt(2)
buffer_store_dwordx4 v[28:31],v24,s[20:23],s64 offen offset:3072 sc1
s_waitcnt vmcnt(2)
s_add_u32 s64,s64,4096
buffer_store_dwordx4 v[28:31],v24,s[20:23],s64 offen offset:0 sc1
s_waitcnt vmcnt(2)
buffer_store_dwordx4 v[28:31],v24,s[20:23],s64 offen offset:1024 sc1
s_waitcnt vmcnt(2)
buffer_store_dwordx4 v[28:31],v24,s[20:23],s64 offen offset:2048 sc1
s_waitcnt vmcnt(2)
buffer_store_dwordx4 v[28:31],v24,s[20:23],s64 offen offset:3072 sc1
s_waitcnt vmcnt(2)
s_add_u32 s64,s64,4096
buffer_store_dwordx4 v[28:31],v24,s[20:23],s64 offen offset:0 sc1
s_waitcnt vmcnt(2)
buffer_store_dwordx4 v[28:31],v24,s[20:23],s64 offen offset:1024 sc1
s_waitcnt vmcnt(2)
s_lshl_b32 s64,s62,2
s_add_u32 s64,s64,s50
s_mul_i32 s64,s64,6144
s_add_u32 s64,s64,167772160
buffer_store_dwordx4 v[28:31],v24,s[20:23],s64 offen offset:0 sc1
s_waitcnt vmcnt(2)
buffer_store_dwordx4 v[28:31],v24,s[20:23],s64 offen offset:1024 sc1
s_waitcnt vmcnt(2)
buffer_store_dwordx4 v[28:31],v24,s[20:23],s64 offen offset:2048 sc1
s_waitcnt vmcnt(2)
buffer_store_dwordx4 v[28:31],v24,s[20:23],s64 offen offset:3072 sc1
s_waitcnt vmcnt(2)
s_add_u32 s64,s64,4096
buffer_store_dwordx4 v[28:31],v24,s[20:23],s64 offen offset:0 sc1
s_waitcnt vmcnt(2)
buffer_store_dwordx4 v[28:31],v24,s[20:23],s64 offen offset:1024 sc1
s_waitcnt vmcnt(2)
s_and_b32 s64,s62,31
s_lshl_b32 s64,s64,10
s_add_u32 s64,s64,209715200
s_bitcmp1_b32 s62,5
s_cselect_b32 s65,4227072,0
s_add_u32 s64,s64,s65
buffer_store_dwordx4 v[20:23],v24,s[20:23],s64 offen sc1
s_lshl_b32 s64,s62,10
s_add_u32 s64,s64,201326592
buffer_store_dwordx4 v[28:31],v24,s[20:23],s64 offen sc1
s_lshl_b32 s64,s62,14
s_lshl_b32 s65,s50,12
s_and_b32 s65,s65,0x2000
s_add_u32 s64,s64,s65
s_and_b32 s65,s50,1
s_lshl_b32 s65,s65,10
s_add_u32 s64,s64,s65
s_add_u32 s64,s64,133169152
buffer_store_dwordx4 v[28:31],v24,s[20:23],s64 offen sc1
s_cmp_eq_u32 s62,29
s_mov_b32 s62,28
s_cbranch_scc1 fl1_27
fl2_28:
s_waitcnt vmcnt(0)
s_barrier
s_cmp_lg_u32 s50,0
s_cbranch_scc1 sig_29
s_mov_b32 s92,s2
s_and_b32 s93,s3,0xffff
s_mov_b32 s94,0x100
s_mov_b32 s95,0x20000
s_add_u32 s64,s88,4
s_add_u32 s65,s88,8
s_cmp_eq_u32 s58,220
s_cselect_b32 s64,s65,s64
v_mov_b32 v16,1
s_mov_b64 exec,1
buffer_atomic_add v16,off,s[92:95],s64 sc1
s_mov_b64 exec,-1
sig_29:
v_lshlrev_b32 v128,16,v48
v_and_b32 v129,s73,v48
v_lshlrev_b32 v130,16,v49
v_and_b32 v131,s73,v49
v_lshlrev_b32 v132,16,v50
v_and_b32 v133,s73,v50
v_lshlrev_b32 v134,16,v51
v_and_b32 v135,s73,v51
v_lshlrev_b32 v136,16,v52
v_and_b32 v137,s73,v52
v_lshlrev_b32 v138,16,v53
v_and_b32 v139,s73,v53
v_lshlrev_b32 v140,16,v54
v_and_b32 v141,s73,v54
v_lshlrev_b32 v142,16,v55
v_and_b32 v143,s73,v55
v_lshlrev_b32 v144,16,v56
v_and_b32 v145,s73,v56
v_lshlrev_b32 v146,16,v57
v_and_b32 v147,s73,v57
v_lshlrev_b32 v148,16,v58
v_and_b32 v149,s73,v58
v_lshlrev_b32 v150,16,v59
v_and_b32 v151,s73,v59
v_lshlrev_b32 v152,16,v60
v_and_b32 v153,s73,v60
v_lshlrev_b32 v154,16,v61
v_and_b32 v155,s73,v61
v_lshlrev_b32 v156,16,v62
v_and_b32 v157,s73,v62
v_lshlrev_b32 v158,16,v63
v_and_b32 v159,s73,v63
v_lshlrev_b32 v160,16,v64
v_and_b32 v161,s73,v64
v_lshlrev_b32 v162,16,v65
v_and_b32 v163,s73,v65
v_lshlrev_b32 v164,16,v66
v_and_b32 v165,s73,v66
v_lshlrev_b32 v166,16,v67
v_and_b32 v167,s73,v67
v_lshlrev_b32 v168,16,v68
v_and_b32 v169,s73,v68
v_lshlrev_b32 v170,16,v69
v_and_b32 v171,s73,v69
v_lshlrev_b32 v172,16,v70
v_and_b32 v173,s73,v70
v_lshlrev_b32 v174,16,v71
v_and_b32 v175,s73,v71
v_lshlrev_b32 v176,16,v72
v_and_b32 v177,s73,v72
v_lshlrev_b32 v178,16,v73
v_and_b32 v179,s73,v73
v_lshlrev_b32 v180,16,v74
v_and_b32 v181,s73,v74
v_lshlrev_b32 v182,16,v75
v_and_b32 v183,s73,v75
v_lshlrev_b32 v184,16,v76
v_and_b32 v185,s73,v76
v_lshlrev_b32 v186,16,v77
v_and_b32 v187,s73,v77
v_lshlrev_b32 v188,16,v78
v_and_b32 v189,s73,v78
v_lshlrev_b32 v190,16,v79
v_and_b32 v191,s73,v79
v_add_f32 v208,v128,v129
v_mul_f32 v209,v128,v128
v_add_f32 v210,v130,v131
v_mul_f32 v211,v129,v129
v_fmac_f32 v209,v130,v130
v_fmac_f32 v211,v131,v131
v_add_f32 v208,v208,v132
v_fmac_f32 v209,v132,v132
v_add_f32 v210,v210,v133
v_fmac_f32 v211,v133,v133
v_add_f32 v208,v208,v134
v_fmac_f32 v209,v134,v134
v_add_f32 v210,v210,v135
v_fmac_f32 v211,v135,v135
v_add_f32 v208,v208,v136
v_fmac_f32 v209,v136,v136
v_add_f32 v210,v210,v137
v_fmac_f32 v211,v137,v137
v_add_f32 v208,v208,v138
v_fmac_f32 v209,v138,v138
v_add_f32 v210,v210,v139
v_fmac_f32 v211,v139,v139
v_add_f32 v208,v208,v140
v_fmac_f32 v209,v140,v140
v_add_f32 v210,v210,v141
v_fmac_f32 v211,v141,v141
v_add_f32 v208,v208,v142
v_fmac_f32 v209,v142,v142
v_add_f32 v210,v210,v143
v_fmac_f32 v211,v143,v143
v_add_f32 v208,v208,v210
v_add_f32 v209,v209,v211
v_add_f32 v212,v144,v145
v_mul_f32 v213,v144,v144
v_add_f32 v214,v146,v147
v_mul_f32 v215,v145,v145
v_fmac_f32 v213,v146,v146
v_fmac_f32 v215,v147,v147
v_add_f32 v212,v212,v148
v_fmac_f32 v213,v148,v148
v_add_f32 v214,v214,v149
v_fmac_f32 v215,v149,v149
v_add_f32 v212,v212,v150
v_fmac_f32 v213,v150,v150
v_add_f32 v214,v214,v151
v_fmac_f32 v215,v151,v151
v_add_f32 v212,v212,v152
v_fmac_f32 v213,v152,v152
v_add_f32 v214,v214,v153
v_fmac_f32 v215,v153,v153
v_add_f32 v212,v212,v154
v_fmac_f32 v213,v154,v154
v_add_f32 v214,v214,v155
v_fmac_f32 v215,v155,v155
v_add_f32 v212,v212,v156
v_fmac_f32 v213,v156,v156
v_add_f32 v214,v214,v157
v_fmac_f32 v215,v157,v157
v_add_f32 v212,v212,v158
v_fmac_f32 v213,v158,v158
v_add_f32 v214,v214,v159
v_fmac_f32 v215,v159,v159
v_add_f32 v212,v212,v214
v_add_f32 v213,v213,v215
v_add_f32 v216,v160,v161
v_mul_f32 v217,v160,v160
v_add_f32 v218,v162,v163
v_mul_f32 v219,v161,v161
v_fmac_f32 v217,v162,v162
v_fmac_f32 v219,v163,v163
v_add_f32 v216,v216,v164
v_fmac_f32 v217,v164,v164
v_add_f32 v218,v218,v165
v_fmac_f32 v219,v165,v165
v_add_f32 v216,v216,v166
v_fmac_f32 v217,v166,v166
v_add_f32 v218,v218,v167
v_fmac_f32 v219,v167,v167
v_add_f32 v216,v216,v168
v_fmac_f32 v217,v168,v168
v_add_f32 v218,v218,v169
v_fmac_f32 v219,v169,v169
v_add_f32 v216,v216,v170
v_fmac_f32 v217,v170,v170
v_add_f32 v218,v218,v171
v_fmac_f32 v219,v171,v171
v_add_f32 v216,v216,v172
v_fmac_f32 v217,v172,v172
v_add_f32 v218,v218,v173
v_fmac_f32 v219,v173,v173
v_add_f32 v216,v216,v174
v_fmac_f32 v217,v174,v174
v_add_f32 v218,v218,v175
v_fmac_f32 v219,v175,v175
v_add_f32 v216,v216,v218
v_add_f32 v217,v217,v219
v_add_f32 v220,v176,v177
v_mul_f32 v221,v176,v176
v_add_f32 v222,v178,v179
v_mul_f32 v223,v177,v177
v_fmac_f32 v221,v178,v178
v_fmac_f32 v223,v179,v179
v_add_f32 v220,v220,v180
v_fmac_f32 v221,v180,v180
v_add_f32 v222,v222,v181
v_fmac_f32 v223,v181,v181
v_add_f32 v220,v220,v182
v_fmac_f32 v221,v182,v182
v_add_f32 v222,v222,v183
v_fmac_f32 v223,v183,v183
v_add_f32 v220,v220,v184
v_fmac_f32 v221,v184,v184
v_add_f32 v222,v222,v185
v_fmac_f32 v223,v185,v185
v_add_f32 v220,v220,v186
v_fmac_f32 v221,v186,v186
v_add_f32 v222,v222,v187
v_fmac_f32 v223,v187,v187
v_add_f32 v220,v220,v188
v_fmac_f32 v221,v188,v188
v_add_f32 v222,v222,v189
v_fmac_f32 v223,v189,v189
v_add_f32 v220,v220,v190
v_fmac_f32 v221,v190,v190
v_add_f32 v222,v222,v191
v_fmac_f32 v223,v191,v191
v_add_f32 v220,v220,v222
v_add_f32 v221,v221,v223
v_add_f32_dpp v208,v208,v208 row_ror:4 row_mask:0xf bank_mask:0xf
v_add_f32_dpp v209,v209,v209 row_ror:4 row_mask:0xf bank_mask:0xf
v_add_f32_dpp v212,v212,v212 row_ror:4 row_mask:0xf bank_mask:0xf
v_add_f32_dpp v213,v213,v213 row_ror:4 row_mask:0xf bank_mask:0xf
v_add_f32_dpp v216,v216,v216 row_ror:4 row_mask:0xf bank_mask:0xf
v_add_f32_dpp v217,v217,v217 row_ror:4 row_mask:0xf bank_mask:0xf
v_add_f32_dpp v220,v220,v220 row_ror:4 row_mask:0xf bank_mask:0xf
v_add_f32_dpp v221,v221,v221 row_ror:4 row_mask:0xf bank_mask:0xf
v_add_f32_dpp v208,v208,v208 row_ror:8 row_mask:0xf bank_mask:0xf
v_add_f32_dpp v209,v209,v209 row_ror:8 row_mask:0xf bank_mask:0xf
v_add_f32_dpp v212,v212,v212 row_ror:8 row_mask:0xf bank_mask:0xf
v_add_f32_dpp v213,v213,v213 row_ror:8 row_mask:0xf bank_mask:0xf
v_add_f32_dpp v216,v216,v216 row_ror:8 row_mask:0xf bank_mask:0xf
v_add_f32_dpp v217,v217,v217 row_ror:8 row_mask:0xf bank_mask:0xf
v_add_f32_dpp v220,v220,v220 row_ror:8 row_mask:0xf bank_mask:0xf
v_add_f32_dpp v221,v221,v221 row_ror:8 row_mask:0xf bank_mask:0xf
v_mov_b32 v210,v208
v_mov_b32 v211,v209
s_nop 0
v_permlane16_swap_b32 v210,v208
v_permlane16_swap_b32 v211,v209
v_add_f32 v208,v208,v210
v_add_f32 v209,v209,v211
v_mov_b32 v214,v212
v_mov_b32 v215,v213
s_nop 0
v_permlane16_swap_b32 v214,v212
v_permlane16_swap_b32 v215,v213
v_add_f32 v212,v212,v214
v_add_f32 v213,v213,v215
v_mov_b32 v218,v216
v_mov_b32 v219,v217
s_nop 0
v_permlane16_swap_b32 v218,v216
v_permlane16_swap_b32 v219,v217
v_add_f32 v216,v216,v218
v_add_f32 v217,v217,v219
v_mov_b32 v222,v220
v_mov_b32 v223,v221
s_nop 0
v_permlane16_swap_b32 v222,v220
v_permlane16_swap_b32 v223,v221
v_add_f32 v220,v220,v222
v_add_f32 v221,v221,v223
v_mov_b32 v210,v208
v_mov_b32 v211,v209
s_nop 0
v_permlane32_swap_b32 v210,v208
v_permlane32_swap_b32 v211,v209
v_add_f32 v208,v208,v210
v_add_f32 v209,v209,v211
v_mov_b32 v214,v212
v_mov_b32 v215,v213
s_nop 0
v_permlane32_swap_b32 v214,v212
v_permlane32_swap_b32 v215,v213
v_add_f32 v212,v212,v214
v_add_f32 v213,v213,v215
v_mov_b32 v218,v216
v_mov_b32 v219,v217
s_nop 0
v_permlane32_swap_b32 v218,v216
v_permlane32_swap_b32 v219,v217
v_add_f32 v216,v216,v218
v_add_f32 v217,v217,v219
v_mov_b32 v222,v220
v_mov_b32 v223,v221
s_nop 0
v_permlane32_swap_b32 v222,v220
v_permlane32_swap_b32 v223,v221
v_add_f32 v220,v220,v222
v_add_f32 v221,v221,v223
ds_write_b64 v11,v[208:209] offset:32768
ds_write_b64 v11,v[212:213] offset:34816
ds_write_b64 v11,v[216:217] offset:36864
ds_write_b64 v11,v[220:221] offset:38912
s_waitcnt lgkmcnt(0)
s_barrier
ds_read_b64 v[32:33],v12 offset:32768
ds_read_b64 v[34:35],v12 offset:33280
ds_read_b64 v[36:37],v12 offset:33792
ds_read_b64 v[38:39],v12 offset:34304
s_waitcnt lgkmcnt(0)
v_add_f32 v32,v32,v34
v_add_f32 v33,v33,v35
v_add_f32 v36,v36,v38
v_add_f32 v37,v37,v39
v_add_f32 v32,v32,v36
v_add_f32 v33,v33,v37
v_mul_f32 v208,0xba800000,v32
v_mul_f32 v34,v208,v208
v_mul_f32 v33,0x3a800000,v33
v_sub_f32 v33,v33,v34
v_max_f32 v33,0,v33
v_add_f32 v33,0x3727c5ac,v33
v_rsq_f32 v209,v33
s_nop 0
v_mul_f32 v208,v208,v209
v_fma_f32 v128,v128,v209,v208
v_fma_f32 v129,v129,v209,v208
v_fma_f32 v130,v130,v209,v208
v_fma_f32 v131,v131,v209,v208
v_fma_f32 v132,v132,v209,v208
v_fma_f32 v133,v133,v209,v208
v_fma_f32 v134,v134,v209,v208
v_fma_f32 v135,v135,v209,v208
v_fma_f32 v136,v136,v209,v208
v_fma_f32 v137,v137,v209,v208
v_fma_f32 v138,v138,v209,v208
v_fma_f32 v139,v139,v209,v208
v_fma_f32 v140,v140,v209,v208
v_fma_f32 v141,v141,v209,v208
v_fma_f32 v142,v142,v209,v208
v_fma_f32 v143,v143,v209,v208
ds_read_b64 v[32:33],v12 offset:34816
ds_read_b64 v[34:35],v12 offset:35328
ds_read_b64 v[36:37],v12 offset:35840
ds_read_b64 v[38:39],v12 offset:36352
s_waitcnt lgkmcnt(0)
v_add_f32 v32,v32,v34
v_add_f32 v33,v33,v35
v_add_f32 v36,v36,v38
v_add_f32 v37,v37,v39
v_add_f32 v32,v32,v36
v_add_f32 v33,v33,v37
v_mul_f32 v208,0xba800000,v32
v_mul_f32 v34,v208,v208
v_mul_f32 v33,0x3a800000,v33
v_sub_f32 v33,v33,v34
v_max_f32 v33,0,v33
v_add_f32 v33,0x3727c5ac,v33
v_rsq_f32 v209,v33
s_nop 0
v_mul_f32 v208,v208,v209
v_fma_f32 v144,v144,v209,v208
v_fma_f32 v145,v145,v209,v208
v_fma_f32 v146,v146,v209,v208
v_fma_f32 v147,v147,v209,v208
v_fma_f32 v148,v148,v209,v208
v_fma_f32 v149,v149,v209,v208
v_fma_f32 v150,v150,v209,v208
v_fma_f32 v151,v151,v209,v208
v_fma_f32 v152,v152,v209,v208
v_fma_f32 v153,v153,v209,v208
v_fma_f32 v154,v154,v209,v208
v_fma_f32 v155,v155,v209,v208
v_fma_f32 v156,v156,v209,v208
v_fma_f32 v157,v157,v209,v208
v_fma_f32 v158,v158,v209,v208
v_fma_f32 v159,v159,v209,v208
ds_read_b64 v[32:33],v12 offset:36864
ds_read_b64 v[34:35],v12 offset:37376
ds_read_b64 v[36:37],v12 offset:37888
ds_read_b64 v[38:39],v12 offset:38400
s_waitcnt lgkmcnt(0)
v_add_f32 v32,v32,v34
v_add_f32 v33,v33,v35
v_add_f32 v36,v36,v38
v_add_f32 v37,v37,v39
v_add_f32 v32,v32,v36
v_add_f32 v33,v33,v37
v_mul_f32 v208,0xba800000,v32
v_mul_f32 v34,v208,v208
v_mul_f32 v33,0x3a800000,v33
v_sub_f32 v33,v33,v34
v_max_f32 v33,0,v33
v_add_f32 v33,0x3727c5ac,v33
v_rsq_f32 v209,v33
s_nop 0
v_mul_f32 v208,v208,v209
v_fma_f32 v160,v160,v209,v208
v_fma_f32 v161,v161,v209,v208
v_fma_f32 v162,v162,v209,v208
v_fma_f32 v163,v163,v209,v208
v_fma_f32 v164,v164,v209,v208
v_fma_f32 v165,v165,v209,v208
v_fma_f32 v166,v166,v209,v208
v_fma_f32 v167,v167,v209,v208
v_fma_f32 v168,v168,v209,v208
v_fma_f32 v169,v169,v209,v208
v_fma_f32 v170,v170,v209,v208
v_fma_f32 v171,v171,v209,v208
v_fma_f32 v172,v172,v209,v208
v_fma_f32 v173,v173,v209,v208
v_fma_f32 v174,v174,v209,v208
v_fma_f32 v175,v175,v209,v208
ds_read_b64 v[32:33],v12 offset:38912
ds_read_b64 v[34:35],v12 offset:39424
ds_read_b64 v[36:37],v12 offset:39936
ds_read_b64 v[38:39],v12 offset:40448
s_waitcnt lgkmcnt(0)
v_add_f32 v32,v32,v34
v_add_f32 v33,v33,v35
v_add_f32 v36,v36,v38
v_add_f32 v37,v37,v39
v_add_f32 v32,v32,v36
v_add_f32 v33,v33,v37
v_mul_f32 v208,0xba800000,v32
v_mul_f32 v34,v208,v208
v_mul_f32 v33,0x3a800000,v33
v_sub_f32 v33,v33,v34
v_max_f32 v33,0,v33
v_add_f32 v33,0x3727c5ac,v33
v_rsq_f32 v209,v33
s_nop 0
v_mul_f32 v208,v208,v209
v_fma_f32 v176,v176,v209,v208
v_fma_f32 v177,v177,v209,v208
v_fma_f32 v178,v178,v209,v208
v_fma_f32 v179,v179,v209,v208
v_fma_f32 v180,v180,v209,v208
v_fma_f32 v181,v181,v209,v208
v_fma_f32 v182,v182,v209,v208
v_fma_f32 v183,v183,v209,v208
v_fma_f32 v184,v184,v209,v208
v_fma_f32 v185,v185,v209,v208
v_fma_f32 v186,v186,v209,v208
v_fma_f32 v187,v187,v209,v208
v_fma_f32 v188,v188,v209,v208
v_fma_f32 v189,v189,v209,v208
v_fma_f32 v190,v190,v209,v208
v_fma_f32 v191,v191,v209,v208
s_mov_b32 s92,s2
s_and_b32 s93,s3,0xffff
s_mov_b32 s94,0x100
s_mov_b32 s95,0x20000
v_mbcnt_lo_u32_b32 v16,-1,0
v_mbcnt_hi_u32_b32 v16,-1,v16
v_mov_b32 v18,0
v_cmp_eq_u32 vcc,16,v16
s_nop 1
v_cndmask_b32 v18,v18,64,vcc
v_and_b32 v19,1,v16
v_cmp_eq_u32 vcc,1,v19
v_mov_b32 v19,8192
s_nop 0
v_cndmask_b32 v19,-1,v19,vcc
v_min_u32 v16,31,v16
v_lshlrev_b32 v16,2,v16
s_sub_u32 s66,s88,64
s_cmp_lg_u32 s50,0
s_cbranch_scc1 vot_34
vpoll_30:
buffer_load_dword v17,v16,s[92:95],s66 offen sc1
s_waitcnt vmcnt(0)
s_cmp_lg_u32 s56,2
s_cbranch_scc1 vck_31
v_cmp_eq_u32 vcc,v17,v19
s_and_b32 s64,vcc_lo,0xffff
s_cmp_eq_u32 s64,65535
s_cbranch_scc1 vck_31
s_mov_b32 s65,0
v_readlane_b32 s64,v17,1
s_lshr_b32 s64,s64,8
s_add_u32 s65,s65,s64
v_readlane_b32 s64,v17,3
s_lshr_b32 s64,s64,8
s_add_u32 s65,s65,s64
v_readlane_b32 s64,v17,5
s_lshr_b32 s64,s64,8
s_add_u32 s65,s65,s64
v_readlane_b32 s64,v17,7
s_lshr_b32 s64,s64,8
s_add_u32 s65,s65,s64
v_readlane_b32 s64,v17,9
s_lshr_b32 s64,s64,8
s_add_u32 s65,s65,s64
v_readlane_b32 s64,v17,11
s_lshr_b32 s64,s64,8
s_add_u32 s65,s65,s64
v_readlane_b32 s64,v17,13
s_lshr_b32 s64,s64,8
s_add_u32 s65,s65,s64
v_readlane_b32 s64,v17,15
s_lshr_b32 s64,s64,8
s_add_u32 s65,s65,s64
s_cmp_ge_u32 s65,256
s_cbranch_scc1 vok_33
s_branch vrt_32
vck_31:
v_cmp_gt_u32 vcc,v18,v17
s_cbranch_vccz vok_33
vrt_32:
s_sleep 8
s_sub_u32 s90,s90,1
s_cmp_gt_i32 s90,0
s_cbranch_scc1 vpoll_30
vok_33:
v_add_u32 v18,160512,v16
ds_write_b32 v18,v17
s_waitcnt lgkmcnt(0)
vot_34:
s_barrier
v_add_u32 v18,160512,v16
ds_read_b32 v17,v18
s_waitcnt lgkmcnt(0)
s_cmp_lg_u32 s56,2
s_cbranch_scc1 vfin_35
v_cmp_eq_u32 vcc,v17,v19
s_and_b32 s64,vcc_lo,0xffff
s_cmp_eq_u32 s64,65535
s_cbranch_scc1 vfin_35
s_mov_b32 s65,0
v_readlane_b32 s64,v17,1
s_lshr_b32 s64,s64,8
s_add_u32 s65,s65,s64
v_readlane_b32 s64,v17,3
s_lshr_b32 s64,s64,8
s_add_u32 s65,s65,s64
v_readlane_b32 s64,v17,5
s_lshr_b32 s64,s64,8
s_add_u32 s65,s65,s64
v_readlane_b32 s64,v17,7
s_lshr_b32 s64,s64,8
s_add_u32 s65,s65,s64
v_readlane_b32 s64,v17,9
s_lshr_b32 s64,s64,8
s_add_u32 s65,s65,s64
v_readlane_b32 s64,v17,11
s_lshr_b32 s64,s64,8
s_add_u32 s65,s65,s64
v_readlane_b32 s64,v17,13
s_lshr_b32 s64,s64,8
s_add_u32 s65,s65,s64
v_readlane_b32 s64,v17,15
s_lshr_b32 s64,s64,8
s_add_u32 s65,s65,s64
s_cmp_ge_u32 s65,256
s_cbranch_scc1 fl_fb
vfin_35:
s_and_b32 s56,s56,1
v_lshlrev_b32 v18,5,v14
s_mov_b32 s64,267386880
buffer_load_dwordx4 v[32:35],v18,s[20:23],s64 offen offset:0 sc1
buffer_load_dwordx4 v[36:39],v18,s[20:23],s64 offen offset:16 sc1
s_mov_b32 s64,267411456
buffer_load_dwordx4 v[40:43],v18,s[20:23],s64 offen offset:0 sc1
buffer_load_dwordx4 v[44:47],v18,s[20:23],s64 offen offset:16 sc1
s_mov_b32 s64,267436032
buffer_load_dwordx4 v[48:51],v18,s[20:23],s64 offen offset:0 sc1
buffer_load_dwordx4 v[52:55],v18,s[20:23],s64 offen offset:16 sc1
s_mov_b32 s64,267460608
buffer_load_dwordx4 v[56:59],v18,s[20:23],s64 offen offset:0 sc1
buffer_load_dwordx4 v[60:63],v18,s[20:23],s64 offen offset:16 sc1
s_cmp_gt_u32 s50,1
s_cselect_b32 s64,1.0,0
s_waitcnt vmcnt(0)
v_pk_add_f32 v[32:33],v[32:33],v[40:41]
v_pk_add_f32 v[48:49],v[48:49],v[56:57]
v_pk_add_f32 v[34:35],v[34:35],v[42:43]
v_pk_add_f32 v[50:51],v[50:51],v[58:59]
v_pk_add_f32 v[36:37],v[36:37],v[44:45]
v_pk_add_f32 v[52:53],v[52:53],v[60:61]
v_pk_add_f32 v[38:39],v[38:39],v[46:47]
v_pk_add_f32 v[54:55],v[54:55],v[62:63]
v_pk_add_f32 v[32:33],v[32:33],v[48:49]
v_pk_add_f32 v[34:35],v[34:35],v[50:51]
v_pk_add_f32 v[36:37],v[36:37],v[52:53]
v_pk_add_f32 v[38:39],v[38:39],v[54:55]
v_cvt_pk_bf16_f32 v40,v32,v33
v_cvt_pk_bf16_f32 v41,v34,v35
v_cvt_pk_bf16_f32 v42,v36,v37
v_cvt_pk_bf16_f32 v43,v38,v39
v_lshlrev_b32 v32,16,v40
v_and_b32 v33,s73,v40
v_lshlrev_b32 v34,16,v41
v_and_b32 v35,s73,v41
v_lshlrev_b32 v36,16,v42
v_and_b32 v37,s73,v42
v_lshlrev_b32 v38,16,v43
v_and_b32 v39,s73,v43
v_add_f32 v32,s64,v32
v_add_f32 v33,s64,v33
v_add_f32 v34,s64,v34
v_add_f32 v35,s64,v35
v_add_f32 v36,s64,v36
v_add_f32 v37,s64,v37
v_add_f32 v38,s64,v38
v_add_f32 v39,s64,v39
ds_write_b128 v18,v[32:35] offset:0
ds_write_b128 v18,v[36:39] offset:16
s_waitcnt lgkmcnt(0)
s_barrier
ds_read_b128 v[112:115],v9 offset:0
ds_read_b128 v[116:119],v9 offset:16
ds_read_b128 v[120:123],v9 offset:512
ds_read_b128 v[124:127],v9 offset:528
ds_read_b128 v[96:99],v9 offset:4096
ds_read_b128 v[100:103],v9 offset:4112
ds_read_b128 v[104:107],v9 offset:4608
ds_read_b128 v[108:111],v9 offset:4624
s_add_u32 s61,s61,146800640
s_add_u32 s62,s61,4096
s_waitcnt lgkmcnt(0)
v_fma_f32 v128,v128,v96,v112
v_fma_f32 v129,v129,v97,v113
v_fma_f32 v130,v130,v98,v114
v_fma_f32 v131,v131,v99,v115
v_fma_f32 v132,v132,v100,v116
v_fma_f32 v133,v133,v101,v117
v_fma_f32 v134,v134,v102,v118
v_fma_f32 v135,v135,v103,v119
v_fma_f32 v136,v136,v104,v120
v_fma_f32 v137,v137,v105,v121
v_fma_f32 v138,v138,v106,v122
v_fma_f32 v139,v139,v107,v123
v_fma_f32 v140,v140,v108,v124
v_fma_f32 v141,v141,v109,v125
v_fma_f32 v142,v142,v110,v126
v_fma_f32 v143,v143,v111,v127
v_cvt_pk_bf16_f32 v48,v128,v129
v_cvt_pk_bf16_f32 v49,v130,v131
v_cvt_pk_bf16_f32 v50,v132,v133
v_cvt_pk_bf16_f32 v51,v134,v135
v_cvt_pk_bf16_f32 v52,v136,v137
v_cvt_pk_bf16_f32 v53,v138,v139
v_cvt_pk_bf16_f32 v54,v140,v141
v_cvt_pk_bf16_f32 v55,v142,v143
buffer_store_dwordx4 v[48:51],v10,s[20:23],s61 offen offset:0 sc1
buffer_store_dwordx4 v[52:55],v10,s[20:23],s62 offen offset:0 sc1
v_fma_f32 v144,v144,v96,v112
v_fma_f32 v145,v145,v97,v113
v_fma_f32 v146,v146,v98,v114
v_fma_f32 v147,v147,v99,v115
v_fma_f32 v148,v148,v100,v116
v_fma_f32 v149,v149,v101,v117
v_fma_f32 v150,v150,v102,v118
v_fma_f32 v151,v151,v103,v119
v_fma_f32 v152,v152,v104,v120
v_fma_f32 v153,v153,v105,v121
v_fma_f32 v154,v154,v106,v122
v_fma_f32 v155,v155,v107,v123
v_fma_f32 v156,v156,v108,v124
v_fma_f32 v157,v157,v109,v125
v_fma_f32 v158,v158,v110,v126
v_fma_f32 v159,v159,v111,v127
v_cvt_pk_bf16_f32 v56,v144,v145
v_cvt_pk_bf16_f32 v57,v146,v147
v_cvt_pk_bf16_f32 v58,v148,v149
v_cvt_pk_bf16_f32 v59,v150,v151
v_cvt_pk_bf16_f32 v60,v152,v153
v_cvt_pk_bf16_f32 v61,v154,v155
v_cvt_pk_bf16_f32 v62,v156,v157
v_cvt_pk_bf16_f32 v63,v158,v159
buffer_store_dwordx4 v[56:59],v10,s[20:23],s61 offen offset:64 sc1
buffer_store_dwordx4 v[60:63],v10,s[20:23],s62 offen offset:64 sc1
v_fma_f32 v160,v160,v96,v112
v_fma_f32 v161,v161,v97,v113
v_fma_f32 v162,v162,v98,v114
v_fma_f32 v163,v163,v99,v115
v_fma_f32 v164,v164,v100,v116
v_fma_f32 v165,v165,v101,v117
v_fma_f32 v166,v166,v102,v118
v_fma_f32 v167,v167,v103,v119
v_fma_f32 v168,v168,v104,v120
v_fma_f32 v169,v169,v105,v121
v_fma_f32 v170,v170,v106,v122
v_fma_f32 v171,v171,v107,v123
v_fma_f32 v172,v172,v108,v124
v_fma_f32 v173,v173,v109,v125
v_fma_f32 v174,v174,v110,v126
v_fma_f32 v175,v175,v111,v127
v_cvt_pk_bf16_f32 v64,v160,v161
v_cvt_pk_bf16_f32 v65,v162,v163
v_cvt_pk_bf16_f32 v66,v164,v165
v_cvt_pk_bf16_f32 v67,v166,v167
v_cvt_pk_bf16_f32 v68,v168,v169
v_cvt_pk_bf16_f32 v69,v170,v171
v_cvt_pk_bf16_f32 v70,v172,v173
v_cvt_pk_bf16_f32 v71,v174,v175
buffer_store_dwordx4 v[64:67],v10,s[20:23],s61 offen offset:128 sc1
buffer_store_dwordx4 v[68:71],v10,s[20:23],s62 offen offset:128 sc1
v_fma_f32 v176,v176,v96,v112
v_fma_f32 v177,v177,v97,v113
v_fma_f32 v178,v178,v98,v114
v_fma_f32 v179,v179,v99,v115
v_fma_f32 v180,v180,v100,v116
v_fma_f32 v181,v181,v101,v117
v_fma_f32 v182,v182,v102,v118
v_fma_f32 v183,v183,v103,v119
v_fma_f32 v184,v184,v104,v120
v_fma_f32 v185,v185,v105,v121
v_fma_f32 v186,v186,v106,v122
v_fma_f32 v187,v187,v107,v123
v_fma_f32 v188,v188,v108,v124
v_fma_f32 v189,v189,v109,v125
v_fma_f32 v190,v190,v110,v126
v_fma_f32 v191,v191,v111,v127
v_cvt_pk_bf16_f32 v72,v176,v177
v_cvt_pk_bf16_f32 v73,v178,v179
v_cvt_pk_bf16_f32 v74,v180,v181
v_cvt_pk_bf16_f32 v75,v182,v183
v_cvt_pk_bf16_f32 v76,v184,v185
v_cvt_pk_bf16_f32 v77,v186,v187
v_cvt_pk_bf16_f32 v78,v188,v189
v_cvt_pk_bf16_f32 v79,v190,v191
buffer_store_dwordx4 v[72:75],v10,s[20:23],s61 offen offset:192 sc1
buffer_store_dwordx4 v[76:79],v10,s[20:23],s62 offen offset:192 sc1
s_waitcnt vmcnt(0)
s_barrier
s_cmp_lg_u32 s50,0
s_cbranch_scc1 sig_36
s_mov_b32 s92,s2
s_and_b32 s93,s3,0xffff
s_mov_b32 s94,0x100
s_mov_b32 s95,0x20000
s_add_u32 s64,s88,16
v_mov_b32 v16,1
s_mov_b64 exec,1
buffer_atomic_add v16,off,s[92:95],s64 sc1
s_mov_b64 exec,-1
sig_36:
fl_disp:
s_lshr_b32 s64,s58,2
s_sub_u32 s64,s64,55
s_andn2_b32 s64,s64,4
s_cmp_eq_u32 s64,0
s_cselect_b32 s64,48,0
s_xor_b32 s58,s58,s64
s_sub_u32 s59,s58,248
s_cbranch_scc1 nx_37
s_branch fl_w2
nx_37:
s_sub_u32 s59,s58,240
s_cbranch_scc1 nx_38
s_branch fl_w1
nx_38:
s_sub_u32 s59,s58,224
s_cbranch_scc1 nx_39
s_branch fl_att
nx_39:
s_sub_u32 s59,s58,220
s_cbranch_scc1 nx_40
s_branch fl_ln2
nx_40:
s_sub_u32 s59,s58,192
s_cbranch_scc1 nx_41
s_branch fl_w3
nx_41:
s_sub_u32 s59,s58,160
s_cbranch_scc1 nx_42
s_branch fl_w4
nx_42:
s_sub_u32 s59,s58,128
s_branch fl_wo
fl_fb:
s_mov_b32 s92,s2
s_and_b32 s93,s3,0xffff
s_mov_b32 s94,0x100
s_mov_b32 s95,0x20000
s_waitcnt vmcnt(0) lgkmcnt(0)
s_barrier
v_mov_b32 v4,0
s_cmp_lg_u32 s50,0
s_cbranch_scc1 norole_2
s_mov_b64 exec,1
v_mov_b32 v3,1
s_lshl_b32 s52,s51,2
s_add_u32 s52,s52,128
buffer_atomic_add v3,off,s[92:95],s52 sc0 sc1
s_waitcnt vmcnt(0)
ds_write_b32 v4,v3
s_waitcnt lgkmcnt(0)
s_mov_b64 exec,-1
norole_2:
s_barrier
ds_read_b32 v3,v4
v_mbcnt_lo_u32_b32 v16,-1,0
v_and_b32 v16,7,v16
v_lshlrev_b32 v16,2,v16
s_waitcnt lgkmcnt(0)
v_readfirstlane_b32 s49,v3
s_barrier
tp_43:
buffer_load_dword v17,v16,s[92:95],0 offen offset:128 sc1
s_waitcnt vmcnt(0)
v_readlane_b32 s72,v17,0
v_readlane_b32 s73,v17,1
v_readlane_b32 s74,v17,2
v_readlane_b32 s75,v17,3
v_readlane_b32 s76,v17,4
v_readlane_b32 s77,v17,5
v_readlane_b32 s78,v17,6
v_readlane_b32 s79,v17,7
s_add_u32 s65,s72,s73
s_add_u32 s65,s65,s74
s_add_u32 s65,s65,s75
s_add_u32 s65,s65,s76
s_add_u32 s65,s65,s77
s_add_u32 s65,s65,s78
s_add_u32 s65,s65,s79
s_cmp_ge_u32 s65,256
s_cbranch_scc1 tg_44
s_sleep 4
s_sub_u32 s90,s90,1
s_cmp_gt_i32 s90,0
s_cbranch_scc1 tp_43
tg_44:
s_min_u32 s65,s72,s73
s_min_u32 s65,s65,s74
s_min_u32 s65,s65,s75
s_min_u32 s65,s65,s76
s_min_u32 s65,s65,s77
s_min_u32 s65,s65,s78
s_min_u32 s65,s65,s79
s_mov_b32 s88,192
s_cmp_lt_u32 s65,32
s_cbranch_scc1 tsl_45
s_lshl_b32 s64,s51,2
s_lshr_b32 s64,0x76325410,s64
s_and_b32 s64,s64,7
s_lshl_b32 s58,s64,5
s_add_u32 s58,s58,s49
s_mov_b32 s56,0
s_branch fl_disp0
tsl_45:
s_mov_b32 s58,s49
s_cmp_gt_u32 s51,0
s_cselect_b32 s65,s72,0
s_add_u32 s58,s58,s65
s_cmp_gt_u32 s51,1
s_cselect_b32 s65,s73,0
s_add_u32 s58,s58,s65
s_cmp_gt_u32 s51,2
s_cselect_b32 s65,s74,0
s_add_u32 s58,s58,s65
s_cmp_gt_u32 s51,3
s_cselect_b32 s65,s75,0
s_add_u32 s58,s58,s65
s_cmp_gt_u32 s51,4
s_cselect_b32 s65,s76,0
s_add_u32 s58,s58,s65
s_cmp_gt_u32 s51,5
s_cselect_b32 s65,s77,0
s_add_u32 s58,s58,s65
s_cmp_gt_u32 s51,6
s_cselect_b32 s65,s78,0
s_add_u32 s58,s58,s65
s_mov_b32 s56,1
s_cmp_lt_u32 s58,256
s_cbranch_scc1 fl_disp0
done_1:
s_endpgm
fl_qkv:
v_and_b32 v21,15,v1
v_lshrrev_b32 v22,4,v1
v_lshrrev_b32 v23,2,v21
v_and_b32 v24,3,v21
s_lshl_b32 s61,s50,15
v_lshl_add_u32 v25,v22,3,v23
s_load_dwordx4 s[4:7],s[0:1],16
s_load_dwordx2 s[8:9],s[0:1],32
s_lshl_b32 s52,s59,7
s_and_b32 s64,s50,1
s_lshl_b32 s65,s64,6
s_add_u32 s53,s52,s65
s_lshr_b32 s65,s50,1
s_lshl_b32 s65,s65,6
s_add_u32 s52,s52,s65
s_lshl_b32 s54,s64,3
s_waitcnt lgkmcnt(0)
s_cmp_gt_u32 s50,1
s_cselect_b64 s[10:11],s[4:5],s[6:7]
s_mov_b32 s28,s10
s_and_b32 s29,s11,0xffff
s_mov_b32 s30,0x800000
s_mov_b32 s31,0x20000
s_mov_b32 s32,s8
s_and_b32 s33,s9,0xffff
s_mov_b32 s34,0x800000
s_mov_b32 s35,0x20000
s_and_b32 s64,s59,7
s_lshl_b32 s65,s64,3
s_and_b32 s66,s50,1
s_lshl_b32 s55,s66,2
s_add_u32 s65,s65,s55
s_lshl_b32 s66,s66,5
s_lshl_b32 s65,s65,13
s_andn2_b32 s55,s59,7
s_lshl_b32 s55,s55,7
s_add_u32 s65,s65,s55
s_add_u32 s65,s65,384
v_and_b32 v28,3,v1
v_lshlrev_b32 v28,13,v28
v_add_u32 v28,s65,v28
v_and_b32 v15,4,v1
v_lshl_add_u32 v28,v15,4,v28
s_and_b32 s55,s59,31
s_add_u32 s66,s66,s55
s_lshl_b32 s66,s66,13
s_add_u32 s66,s66,8064
v_writelane_b32 v28,s66,8
s_add_u32 s66,s66,64
v_writelane_b32 v28,s66,9
s_cmp_eq_u32 s64,3
s_cselect_b32 s65,0,15
s_sub_u32 s66,s59,32
s_cmp_lt_u32 s66,31
s_cselect_b32 s66,256,0
s_or_b32 vcc_lo,s65,s66
s_mov_b32 vcc_hi,0
v_cndmask_b32 v28,-1,v28,vcc
s_and_b32 s64,s59,7
s_lshl_b32 s65,s64,4
s_lshl_b32 s55,s50,2
s_add_u32 s65,s65,s55
s_lshl_b32 s66,s50,5
s_lshl_b32 s65,s65,13
s_andn2_b32 s55,s59,7
s_lshl_b32 s55,s55,7
s_add_u32 s65,s65,s55
s_add_u32 s65,s65,384
v_and_b32 v31,3,v1
v_lshlrev_b32 v31,13,v31
v_add_u32 v31,s65,v31
v_and_b32 v15,4,v1
v_lshl_add_u32 v31,v15,4,v31
s_and_b32 s55,s59,31
s_add_u32 s66,s66,s55
s_lshl_b32 s66,s66,13
s_add_u32 s66,s66,8064
v_writelane_b32 v31,s66,8
s_add_u32 s66,s66,64
v_writelane_b32 v31,s66,9
s_cmp_eq_u32 s64,3
s_cselect_b32 s65,0,15
s_sub_u32 s66,s59,32
s_cmp_lt_u32 s66,31
s_cselect_b32 s66,256,0
s_or_b32 vcc_lo,s65,s66
s_mov_b32 vcc_hi,0
v_cndmask_b32 v31,-1,v31,vcc
s_and_b32 s60,s50,1
s_lshl_b32 s60,s60,1
v_lshrrev_b32 v26,2,v1
v_and_b32 v27,3,v1
v_mul_u32_u24 v16,8192,v26
v_lshl_add_u32 v16,v27,4,v16
v_lshlrev_b32 v17,6,v25
v_lshl_add_u32 v17,v24,4,v17
v_add_u32 v17,s61,v17
s_mov_b32 s64,1048576
buffer_load_dword v29,v28,s[28:31],s64 offen
s_mov_b32 s64,1572864
buffer_load_dword v29,v28,s[28:31],s64 offen
s_add_u32 s62,s53,0
s_add_u32 m0,s61,0
s_nop 0
buffer_load_dwordx4 v16,s[28:31],s62 offen  lds
s_add_u32 s62,s62,131072
s_add_u32 m0,m0,1024
s_waitcnt vmcnt(10)
buffer_load_dwordx4 v16,s[28:31],s62 offen  lds
s_add_u32 s62,s62,131072
s_add_u32 m0,m0,1024
s_mov_b32 s64,0
buffer_load_dword v29,v31,s[32:35],s64 offen
s_waitcnt vmcnt(10)
buffer_load_dwordx4 v16,s[28:31],s62 offen  lds
s_add_u32 s62,s62,131072
s_add_u32 m0,m0,1024
s_waitcnt vmcnt(10)
buffer_load_dwordx4 v16,s[28:31],s62 offen  lds
s_add_u32 s62,s62,131072
s_add_u32 m0,m0,1024
s_waitcnt vmcnt(10)
buffer_load_dwordx4 v16,s[28:31],s62 offen  lds
s_add_u32 s62,s62,131072
s_add_u32 m0,m0,1024
s_waitcnt vmcnt(10)
buffer_load_dwordx4 v16,s[28:31],s62 offen  lds
s_add_u32 s62,s62,131072
s_add_u32 m0,m0,1024
s_waitcnt vmcnt(10)
buffer_load_dwordx4 v16,s[28:31],s62 offen  lds
s_add_u32 s62,s62,131072
s_add_u32 m0,m0,1024
s_waitcnt vmcnt(10)
buffer_load_dwordx4 v16,s[28:31],s62 offen  lds
s_add_u32 s62,s62,131072
s_add_u32 m0,m0,1024
s_waitcnt vmcnt(10)
buffer_load_dwordx4 v16,s[28:31],s62 offen  lds
s_add_u32 s62,s62,131072
s_add_u32 m0,m0,1024
s_waitcnt vmcnt(10)
buffer_load_dwordx4 v16,s[28:31],s62 offen  lds
s_add_u32 s62,s62,131072
s_add_u32 m0,m0,1024
s_mov_b32 s64,1048576
buffer_load_dword v29,v31,s[32:35],s64 offen
s_waitcnt vmcnt(10)
buffer_load_dwordx4 v16,s[28:31],s62 offen  lds
s_add_u32 s62,s62,131072
s_add_u32 m0,m0,1024
s_waitcnt vmcnt(10)
buffer_load_dwordx4 v16,s[28:31],s62 offen  lds
s_add_u32 s62,s62,131072
s_add_u32 m0,m0,1024
s_waitcnt vmcnt(10)
buffer_load_dwordx4 v16,s[28:31],s62 offen  lds
s_add_u32 s62,s62,131072
s_add_u32 m0,m0,1024
s_waitcnt vmcnt(10)
buffer_load_dwordx4 v16,s[28:31],s62 offen  lds
s_add_u32 s62,s62,131072
s_add_u32 m0,m0,1024
s_waitcnt vmcnt(10)
buffer_load_dwordx4 v16,s[28:31],s62 offen  lds
s_add_u32 s62,s62,131072
s_add_u32 m0,m0,1024
s_waitcnt vmcnt(10)
buffer_load_dwordx4 v16,s[28:31],s62 offen  lds
s_waitcnt vmcnt(10)
s_add_u32 s62,s52,0
s_add_u32 m0,s61,16384
s_nop 0
buffer_load_dwordx4 v16,s[32:35],s62 offen  lds
s_add_u32 s62,s62,131072
s_add_u32 m0,m0,1024
s_waitcnt vmcnt(10)
buffer_load_dwordx4 v16,s[32:35],s62 offen  lds
s_add_u32 s62,s62,131072
s_add_u32 m0,m0,1024
s_mov_b32 s64,2097152
buffer_load_dword v29,v28,s[28:31],s64 offen
s_waitcnt vmcnt(10)
buffer_load_dwordx4 v16,s[32:35],s62 offen  lds
s_add_u32 s62,s62,131072
s_add_u32 m0,m0,1024
s_waitcnt vmcnt(10)
buffer_load_dwordx4 v16,s[32:35],s62 offen  lds
s_add_u32 s62,s62,131072
s_add_u32 m0,m0,1024
s_waitcnt vmcnt(10)
buffer_load_dwordx4 v16,s[32:35],s62 offen  lds
s_add_u32 s62,s62,131072
s_add_u32 m0,m0,1024
s_waitcnt vmcnt(10)
buffer_load_dwordx4 v16,s[32:35],s62 offen  lds
s_add_u32 s62,s62,131072
s_add_u32 m0,m0,1024
s_mov_b32 s64,2621440
buffer_load_dword v29,v28,s[28:31],s64 offen
s_waitcnt vmcnt(10)
buffer_load_dwordx4 v16,s[32:35],s62 offen  lds
s_add_u32 s62,s62,131072
s_add_u32 m0,m0,1024
s_waitcnt vmcnt(10)
buffer_load_dwordx4 v16,s[32:35],s62 offen  lds
s_add_u32 s62,s62,131072
s_add_u32 m0,m0,1024
s_waitcnt vmcnt(10)
buffer_load_dwordx4 v16,s[32:35],s62 offen  lds
s_add_u32 s62,s62,131072
s_add_u32 m0,m0,1024
s_waitcnt vmcnt(10)
buffer_load_dwordx4 v16,s[32:35],s62 offen  lds
s_add_u32 s62,s62,131072
s_add_u32 m0,m0,1024
s_mov_b32 s64,3145728
buffer_load_dword v29,v28,s[28:31],s64 offen
s_waitcnt vmcnt(10)
buffer_load_dwordx4 v16,s[32:35],s62 offen  lds
s_add_u32 s62,s62,131072
s_add_u32 m0,m0,1024
s_waitcnt vmcnt(10)
buffer_load_dwordx4 v16,s[32:35],s62 offen  lds
s_add_u32 s62,s62,131072
s_add_u32 m0,m0,1024
s_waitcnt vmcnt(10)
buffer_load_dwordx4 v16,s[32:35],s62 offen  lds
s_add_u32 s62,s62,131072
s_add_u32 m0,m0,1024
s_waitcnt vmcnt(10)
buffer_load_dwordx4 v16,s[32:35],s62 offen  lds
s_add_u32 s62,s62,131072
s_add_u32 m0,m0,1024
s_mov_b32 s64,3670016
buffer_load_dword v29,v28,s[28:31],s64 offen
s_waitcnt vmcnt(10)
buffer_load_dwordx4 v16,s[32:35],s62 offen  lds
s_add_u32 s62,s62,131072
s_add_u32 m0,m0,1024
s_waitcnt vmcnt(10)
buffer_load_dwordx4 v16,s[32:35],s62 offen  lds
s_waitcnt vmcnt(10)
s_waitcnt vmcnt(20)
ds_read_b64_tr_b16 a[0:1],v17 offset:0
ds_read_b64_tr_b16 a[2:3],v17 offset:256
ds_read_b64_tr_b16 a[4:5],v17 offset:8
ds_read_b64_tr_b16 a[6:7],v17 offset:264
ds_read_b64_tr_b16 a[12:13],v17 offset:2048
ds_read_b64_tr_b16 a[14:15],v17 offset:2304
ds_read_b64_tr_b16 a[16:17],v17 offset:2056
ds_read_b64_tr_b16 a[18:19],v17 offset:2312
ds_read_b64_tr_b16 a[24:25],v17 offset:4096
ds_read_b64_tr_b16 a[26:27],v17 offset:4352
ds_read_b64_tr_b16 a[28:29],v17 offset:4104
ds_read_b64_tr_b16 a[30:31],v17 offset:4360
s_waitcnt lgkmcnt(0)
ds_read_b64_tr_b16 a[36:37],v17 offset:6144
ds_read_b64_tr_b16 a[38:39],v17 offset:6400
ds_read_b64_tr_b16 a[40:41],v17 offset:6152
ds_read_b64_tr_b16 a[42:43],v17 offset:6408
ds_read_b64_tr_b16 a[48:49],v17 offset:8192
ds_read_b64_tr_b16 a[50:51],v17 offset:8448
ds_read_b64_tr_b16 a[52:53],v17 offset:8200
ds_read_b64_tr_b16 a[54:55],v17 offset:8456
ds_read_b64_tr_b16 a[60:61],v17 offset:10240
ds_read_b64_tr_b16 a[62:63],v17 offset:10496
ds_read_b64_tr_b16 a[64:65],v17 offset:10248
ds_read_b64_tr_b16 a[66:67],v17 offset:10504
s_waitcnt lgkmcnt(0)
ds_read_b64_tr_b16 a[72:73],v17 offset:12288
ds_read_b64_tr_b16 a[74:75],v17 offset:12544
ds_read_b64_tr_b16 a[76:77],v17 offset:12296
ds_read_b64_tr_b16 a[78:79],v17 offset:12552
ds_read_b64_tr_b16 a[84:85],v17 offset:14336
ds_read_b64_tr_b16 a[86:87],v17 offset:14592
ds_read_b64_tr_b16 a[88:89],v17 offset:14344
ds_read_b64_tr_b16 a[90:91],v17 offset:14600
s_waitcnt lgkmcnt(0)
s_add_u32 s62,s53,2097152
s_add_u32 m0,s61,0
s_nop 0
buffer_load_dwordx4 v16,s[28:31],s62 offen  lds
s_add_u32 s62,s62,131072
s_add_u32 m0,m0,1024
s_waitcnt vmcnt(10)
buffer_load_dwordx4 v16,s[28:31],s62 offen  lds
s_add_u32 s62,s62,131072
s_add_u32 m0,m0,1024
s_mov_b32 s64,2097152
buffer_load_dword v29,v31,s[32:35],s64 offen
s_waitcnt vmcnt(10)
buffer_load_dwordx4 v16,s[28:31],s62 offen  lds
s_add_u32 s62,s62,131072
s_add_u32 m0,m0,1024
s_waitcnt vmcnt(10)
buffer_load_dwordx4 v16,s[28:31],s62 offen  lds
s_add_u32 s62,s62,131072
s_add_u32 m0,m0,1024
s_waitcnt vmcnt(10)
buffer_load_dwordx4 v16,s[28:31],s62 offen  lds
s_add_u32 s62,s62,131072
s_add_u32 m0,m0,1024
s_waitcnt vmcnt(10)
buffer_load_dwordx4 v16,s[28:31],s62 offen  lds
s_add_u32 s62,s62,131072
s_add_u32 m0,m0,1024
s_waitcnt vmcnt(10)
buffer_load_dwordx4 v16,s[28:31],s62 offen  lds
s_add_u32 s62,s62,131072
s_add_u32 m0,m0,1024
s_waitcnt vmcnt(10)
buffer_load_dwordx4 v16,s[28:31],s62 offen  lds
s_add_u32 s62,s62,131072
s_add_u32 m0,m0,1024
s_waitcnt vmcnt(10)
buffer_load_dwordx4 v16,s[28:31],s62 offen  lds
s_add_u32 s62,s62,131072
s_add_u32 m0,m0,1024
s_waitcnt vmcnt(10)
buffer_load_dwordx4 v16,s[28:31],s62 offen  lds
s_add_u32 s62,s62,131072
s_add_u32 m0,m0,1024
s_mov_b32 s64,3145728
buffer_load_dword v29,v31,s[32:35],s64 offen
s_waitcnt vmcnt(10)
buffer_load_dwordx4 v16,s[28:31],s62 offen  lds
s_add_u32 s62,s62,131072
s_add_u32 m0,m0,1024
s_waitcnt vmcnt(10)
buffer_load_dwordx4 v16,s[28:31],s62 offen  lds
s_add_u32 s62,s62,131072
s_add_u32 m0,m0,1024
s_waitcnt vmcnt(10)
buffer_load_dwordx4 v16,s[28:31],s62 offen  lds
s_add_u32 s62,s62,131072
s_add_u32 m0,m0,1024
s_waitcnt vmcnt(10)
buffer_load_dwordx4 v16,s[28:31],s62 offen  lds
s_add_u32 s62,s62,131072
s_add_u32 m0,m0,1024
s_waitcnt vmcnt(10)
buffer_load_dwordx4 v16,s[28:31],s62 offen  lds
s_add_u32 s62,s62,131072
s_add_u32 m0,m0,1024
s_waitcnt vmcnt(10)
buffer_load_dwordx4 v16,s[28:31],s62 offen  lds
s_waitcnt vmcnt(10)
s_waitcnt vmcnt(18)
v_add_u32 v18,s54,v17
ds_read_b64_tr_b16 a[8:9],v18 offset:16384
ds_read_b64_tr_b16 a[10:11],v18 offset:16640
ds_read_b64_tr_b16 a[20:21],v18 offset:18432
ds_read_b64_tr_b16 a[22:23],v18 offset:18688
ds_read_b64_tr_b16 a[32:33],v18 offset:20480
ds_read_b64_tr_b16 a[34:35],v18 offset:20736
ds_read_b64_tr_b16 a[44:45],v18 offset:22528
ds_read_b64_tr_b16 a[46:47],v18 offset:22784
ds_read_b64_tr_b16 a[56:57],v18 offset:24576
ds_read_b64_tr_b16 a[58:59],v18 offset:24832
ds_read_b64_tr_b16 a[68:69],v18 offset:26624
ds_read_b64_tr_b16 a[70:71],v18 offset:26880
s_waitcnt lgkmcnt(0)
ds_read_b64_tr_b16 a[80:81],v18 offset:28672
ds_read_b64_tr_b16 a[82:83],v18 offset:28928
ds_read_b64_tr_b16 a[92:93],v18 offset:30720
ds_read_b64_tr_b16 a[94:95],v18 offset:30976
s_waitcnt lgkmcnt(0)
s_add_u32 s62,s52,2097152
s_add_u32 m0,s61,16384
s_nop 0
buffer_load_dwordx4 v16,s[32:35],s62 offen  lds
s_add_u32 s62,s62,131072
s_add_u32 m0,m0,1024
s_waitcnt vmcnt(10)
buffer_load_dwordx4 v16,s[32:35],s62 offen  lds
s_add_u32 s62,s62,131072
s_add_u32 m0,m0,1024
s_mov_b32 s64,4194304
buffer_load_dword v29,v28,s[28:31],s64 offen
s_waitcnt vmcnt(10)
buffer_load_dwordx4 v16,s[32:35],s62 offen  lds
s_add_u32 s62,s62,131072
s_add_u32 m0,m0,1024
s_waitcnt vmcnt(10)
buffer_load_dwordx4 v16,s[32:35],s62 offen  lds
s_add_u32 s62,s62,131072
s_add_u32 m0,m0,1024
s_waitcnt vmcnt(10)
buffer_load_dwordx4 v16,s[32:35],s62 offen  lds
s_add_u32 s62,s62,131072
s_add_u32 m0,m0,1024
s_waitcnt vmcnt(10)
buffer_load_dwordx4 v16,s[32:35],s62 offen  lds
s_add_u32 s62,s62,131072
s_add_u32 m0,m0,1024
s_mov_b32 s64,4718592
buffer_load_dword v29,v28,s[28:31],s64 offen
s_waitcnt vmcnt(10)
buffer_load_dwordx4 v16,s[32:35],s62 offen  lds
s_add_u32 s62,s62,131072
s_add_u32 m0,m0,1024
s_waitcnt vmcnt(10)
buffer_load_dwordx4 v16,s[32:35],s62 offen  lds
s_add_u32 s62,s62,131072
s_add_u32 m0,m0,1024
s_waitcnt vmcnt(10)
buffer_load_dwordx4 v16,s[32:35],s62 offen  lds
s_add_u32 s62,s62,131072
s_add_u32 m0,m0,1024
s_waitcnt vmcnt(10)
buffer_load_dwordx4 v16,s[32:35],s62 offen  lds
s_add_u32 s62,s62,131072
s_add_u32 m0,m0,1024
s_mov_b32 s64,5242880
buffer_load_dword v29,v28,s[28:31],s64 offen
s_waitcnt vmcnt(10)
buffer_load_dwordx4 v16,s[32:35],s62 offen  lds
s_add_u32 s62,s62,131072
s_add_u32 m0,m0,1024
s_waitcnt vmcnt(10)
buffer_load_dwordx4 v16,s[32:35],s62 offen  lds
s_add_u32 s62,s62,131072
s_add_u32 m0,m0,1024
s_waitcnt vmcnt(10)
buffer_load_dwordx4 v16,s[32:35],s62 offen  lds
s_add_u32 s62,s62,131072
s_add_u32 m0,m0,1024
s_waitcnt vmcnt(10)
buffer_load_dwordx4 v16,s[32:35],s62 offen  lds
s_add_u32 s62,s62,131072
s_add_u32 m0,m0,1024
s_mov_b32 s64,5767168
buffer_load_dword v29,v28,s[28:31],s64 offen
s_waitcnt vmcnt(10)
buffer_load_dwordx4 v16,s[32:35],s62 offen  lds
s_add_u32 s62,s62,131072
s_add_u32 m0,m0,1024
s_waitcnt vmcnt(10)
buffer_load_dwordx4 v16,s[32:35],s62 offen  lds
s_waitcnt vmcnt(10)
s_waitcnt vmcnt(20)
ds_read_b64_tr_b16 a[96:97],v17 offset:0
ds_read_b64_tr_b16 a[98:99],v17 offset:256
ds_read_b64_tr_b16 a[100:101],v17 offset:8
ds_read_b64_tr_b16 a[102:103],v17 offset:264
ds_read_b64_tr_b16 a[108:109],v17 offset:2048
ds_read_b64_tr_b16 a[110:111],v17 offset:2304
ds_read_b64_tr_b16 a[112:113],v17 offset:2056
ds_read_b64_tr_b16 a[114:115],v17 offset:2312
ds_read_b64_tr_b16 a[120:121],v17 offset:4096
ds_read_b64_tr_b16 a[122:123],v17 offset:4352
ds_read_b64_tr_b16 a[124:125],v17 offset:4104
ds_read_b64_tr_b16 a[126:127],v17 offset:4360
s_waitcnt lgkmcnt(0)
ds_read_b64_tr_b16 a[132:133],v17 offset:6144
ds_read_b64_tr_b16 a[134:135],v17 offset:6400
ds_read_b64_tr_b16 a[136:137],v17 offset:6152
ds_read_b64_tr_b16 a[138:139],v17 offset:6408
ds_read_b64_tr_b16 a[144:145],v17 offset:8192
ds_read_b64_tr_b16 a[146:147],v17 offset:8448
ds_read_b64_tr_b16 a[148:149],v17 offset:8200
ds_read_b64_tr_b16 a[150:151],v17 offset:8456
ds_read_b64_tr_b16 a[156:157],v17 offset:10240
ds_read_b64_tr_b16 a[158:159],v17 offset:10496
ds_read_b64_tr_b16 a[160:161],v17 offset:10248
ds_read_b64_tr_b16 a[162:163],v17 offset:10504
s_waitcnt lgkmcnt(0)
ds_read_b64_tr_b16 a[168:169],v17 offset:12288
ds_read_b64_tr_b16 a[170:171],v17 offset:12544
ds_read_b64_tr_b16 a[172:173],v17 offset:12296
ds_read_b64_tr_b16 a[174:175],v17 offset:12552
ds_read_b64_tr_b16 a[180:181],v17 offset:14336
ds_read_b64_tr_b16 a[182:183],v17 offset:14592
ds_read_b64_tr_b16 a[184:185],v17 offset:14344
ds_read_b64_tr_b16 a[186:187],v17 offset:14600
s_waitcnt lgkmcnt(0)
s_add_u32 s62,s53,4194304
s_add_u32 m0,s61,0
s_nop 0
buffer_load_dwordx4 v16,s[28:31],s62 offen  lds
s_add_u32 s62,s62,131072
s_add_u32 m0,m0,1024
s_waitcnt vmcnt(10)
buffer_load_dwordx4 v16,s[28:31],s62 offen  lds
s_add_u32 s62,s62,131072
s_add_u32 m0,m0,1024
s_mov_b32 s64,4194304
buffer_load_dword v29,v31,s[32:35],s64 offen
s_waitcnt vmcnt(10)
buffer_load_dwordx4 v16,s[28:31],s62 offen  lds
s_add_u32 s62,s62,131072
s_add_u32 m0,m0,1024
s_waitcnt vmcnt(10)
buffer_load_dwordx4 v16,s[28:31],s62 offen  lds
s_add_u32 s62,s62,131072
s_add_u32 m0,m0,1024
s_waitcnt vmcnt(10)
buffer_load_dwordx4 v16,s[28:31],s62 offen  lds
s_add_u32 s62,s62,131072
s_add_u32 m0,m0,1024
s_waitcnt vmcnt(10)
buffer_load_dwordx4 v16,s[28:31],s62 offen  lds
s_add_u32 s62,s62,131072
s_add_u32 m0,m0,1024
s_waitcnt vmcnt(10)
buffer_load_dwordx4 v16,s[28:31],s62 offen  lds
s_add_u32 s62,s62,131072
s_add_u32 m0,m0,1024
s_waitcnt vmcnt(10)
buffer_load_dwordx4 v16,s[28:31],s62 offen  lds
s_add_u32 s62,s62,131072
s_add_u32 m0,m0,1024
s_waitcnt vmcnt(10)
buffer_load_dwordx4 v16,s[28:31],s62 offen  lds
s_add_u32 s62,s62,131072
s_add_u32 m0,m0,1024
s_waitcnt vmcnt(10)
buffer_load_dwordx4 v16,s[28:31],s62 offen  lds
s_add_u32 s62,s62,131072
s_add_u32 m0,m0,1024
s_mov_b32 s64,5242880
buffer_load_dword v29,v31,s[32:35],s64 offen
s_waitcnt vmcnt(10)
buffer_load_dwordx4 v16,s[28:31],s62 offen  lds
s_add_u32 s62,s62,131072
s_add_u32 m0,m0,1024
s_waitcnt vmcnt(10)
buffer_load_dwordx4 v16,s[28:31],s62 offen  lds
s_add_u32 s62,s62,131072
s_add_u32 m0,m0,1024
s_waitcnt vmcnt(10)
buffer_load_dwordx4 v16,s[28:31],s62 offen  lds
s_add_u32 s62,s62,131072
s_add_u32 m0,m0,1024
s_waitcnt vmcnt(10)
buffer_load_dwordx4 v16,s[28:31],s62 offen  lds
s_add_u32 s62,s62,131072
s_add_u32 m0,m0,1024
s_waitcnt vmcnt(10)
buffer_load_dwordx4 v16,s[28:31],s62 offen  lds
s_add_u32 s62,s62,131072
s_add_u32 m0,m0,1024
s_waitcnt vmcnt(10)
buffer_load_dwordx4 v16,s[28:31],s62 offen  lds
s_waitcnt vmcnt(10)
s_waitcnt vmcnt(18)
ds_read_b64_tr_b16 a[104:105],v18 offset:16384
ds_read_b64_tr_b16 a[106:107],v18 offset:16640
ds_read_b64_tr_b16 a[116:117],v18 offset:18432
ds_read_b64_tr_b16 a[118:119],v18 offset:18688
ds_read_b64_tr_b16 a[128:129],v18 offset:20480
ds_read_b64_tr_b16 a[130:131],v18 offset:20736
ds_read_b64_tr_b16 a[140:141],v18 offset:22528
ds_read_b64_tr_b16 a[142:143],v18 offset:22784
ds_read_b64_tr_b16 a[152:153],v18 offset:24576
ds_read_b64_tr_b16 a[154:155],v18 offset:24832
ds_read_b64_tr_b16 a[164:165],v18 offset:26624
ds_read_b64_tr_b16 a[166:167],v18 offset:26880
s_waitcnt lgkmcnt(0)
ds_read_b64_tr_b16 a[176:177],v18 offset:28672
ds_read_b64_tr_b16 a[178:179],v18 offset:28928
ds_read_b64_tr_b16 a[188:189],v18 offset:30720
ds_read_b64_tr_b16 a[190:191],v18 offset:30976
s_waitcnt lgkmcnt(0)
s_add_u32 s62,s52,4194304
s_add_u32 m0,s61,16384
s_nop 0
buffer_load_dwordx4 v16,s[32:35],s62 offen  lds
s_add_u32 s62,s62,131072
s_add_u32 m0,m0,1024
s_waitcnt vmcnt(10)
buffer_load_dwordx4 v16,s[32:35],s62 offen  lds
s_add_u32 s62,s62,131072
s_add_u32 m0,m0,1024
s_mov_b32 s64,6291456
buffer_load_dword v29,v28,s[28:31],s64 offen
s_waitcnt vmcnt(10)
buffer_load_dwordx4 v16,s[32:35],s62 offen  lds
s_add_u32 s62,s62,131072
s_add_u32 m0,m0,1024
s_waitcnt vmcnt(10)
buffer_load_dwordx4 v16,s[32:35],s62 offen  lds
s_add_u32 s62,s62,131072
s_add_u32 m0,m0,1024
s_waitcnt vmcnt(10)
buffer_load_dwordx4 v16,s[32:35],s62 offen  lds
s_add_u32 s62,s62,131072
s_add_u32 m0,m0,1024
s_waitcnt vmcnt(10)
buffer_load_dwordx4 v16,s[32:35],s62 offen  lds
s_add_u32 s62,s62,131072
s_add_u32 m0,m0,1024
s_mov_b32 s64,6815744
buffer_load_dword v29,v28,s[28:31],s64 offen
s_waitcnt vmcnt(10)
buffer_load_dwordx4 v16,s[32:35],s62 offen  lds
s_add_u32 s62,s62,131072
s_add_u32 m0,m0,1024
s_waitcnt vmcnt(10)
buffer_load_dwordx4 v16,s[32:35],s62 offen  lds
s_add_u32 s62,s62,131072
s_add_u32 m0,m0,1024
s_waitcnt vmcnt(10)
buffer_load_dwordx4 v16,s[32:35],s62 offen  lds
s_add_u32 s62,s62,131072
s_add_u32 m0,m0,1024
s_waitcnt vmcnt(10)
buffer_load_dwordx4 v16,s[32:35],s62 offen  lds
s_add_u32 s62,s62,131072
s_add_u32 m0,m0,1024
s_mov_b32 s64,7340032
buffer_load_dword v29,v28,s[28:31],s64 offen
s_waitcnt vmcnt(10)
buffer_load_dwordx4 v16,s[32:35],s62 offen  lds
s_add_u32 s62,s62,131072
s_add_u32 m0,m0,1024
s_waitcnt vmcnt(10)
buffer_load_dwordx4 v16,s[32:35],s62 offen  lds
s_add_u32 s62,s62,131072
s_add_u32 m0,m0,1024
s_waitcnt vmcnt(10)
buffer_load_dwordx4 v16,s[32:35],s62 offen  lds
s_add_u32 s62,s62,131072
s_add_u32 m0,m0,1024
s_waitcnt vmcnt(10)
buffer_load_dwordx4 v16,s[32:35],s62 offen  lds
s_add_u32 s62,s62,131072
s_add_u32 m0,m0,1024
s_mov_b32 s64,7864320
buffer_load_dword v29,v28,s[28:31],s64 offen
s_waitcnt vmcnt(10)
buffer_load_dwordx4 v16,s[32:35],s62 offen  lds
s_add_u32 s62,s62,131072
s_add_u32 m0,m0,1024
s_waitcnt vmcnt(10)
buffer_load_dwordx4 v16,s[32:35],s62 offen  lds
s_waitcnt vmcnt(10)
s_waitcnt vmcnt(20)
ds_read_b64_tr_b16 a[192:193],v17 offset:0
ds_read_b64_tr_b16 a[194:195],v17 offset:256
ds_read_b64_tr_b16 a[196:197],v17 offset:8
ds_read_b64_tr_b16 a[198:199],v17 offset:264
ds_read_b64_tr_b16 a[204:205],v17 offset:2048
ds_read_b64_tr_b16 a[206:207],v17 offset:2304
ds_read_b64_tr_b16 a[208:209],v17 offset:2056
ds_read_b64_tr_b16 a[210:211],v17 offset:2312
ds_read_b64_tr_b16 a[216:217],v17 offset:4096
ds_read_b64_tr_b16 a[218:219],v17 offset:4352
ds_read_b64_tr_b16 a[220:221],v17 offset:4104
ds_read_b64_tr_b16 a[222:223],v17 offset:4360
s_waitcnt lgkmcnt(0)
ds_read_b64_tr_b16 a[228:229],v17 offset:6144
ds_read_b64_tr_b16 a[230:231],v17 offset:6400
ds_read_b64_tr_b16 a[232:233],v17 offset:6152
ds_read_b64_tr_b16 a[234:235],v17 offset:6408
ds_read_b64_tr_b16 a[240:241],v17 offset:8192
ds_read_b64_tr_b16 a[242:243],v17 offset:8448
ds_read_b64_tr_b16 a[244:245],v17 offset:8200
ds_read_b64_tr_b16 a[246:247],v17 offset:8456
ds_read_b64_tr_b16 a[252:253],v17 offset:10240
ds_read_b64_tr_b16 a[254:255],v17 offset:10496
ds_read_b64_tr_b16 v[128:129],v17 offset:10248
ds_read_b64_tr_b16 v[130:131],v17 offset:10504
s_waitcnt lgkmcnt(0)
ds_read_b64_tr_b16 v[136:137],v17 offset:12288
ds_read_b64_tr_b16 v[138:139],v17 offset:12544
ds_read_b64_tr_b16 v[140:141],v17 offset:12296
ds_read_b64_tr_b16 v[142:143],v17 offset:12552
ds_read_b64_tr_b16 v[148:149],v17 offset:14336
ds_read_b64_tr_b16 v[150:151],v17 offset:14592
ds_read_b64_tr_b16 v[152:153],v17 offset:14344
ds_read_b64_tr_b16 v[154:155],v17 offset:14600
s_waitcnt lgkmcnt(0)
s_add_u32 s62,s53,6291456
s_add_u32 m0,s61,0
s_nop 0
buffer_load_dwordx4 v16,s[28:31],s62 offen  lds
s_add_u32 s62,s62,131072
s_add_u32 m0,m0,1024
s_waitcnt vmcnt(10)
buffer_load_dwordx4 v16,s[28:31],s62 offen  lds
s_add_u32 s62,s62,131072
s_add_u32 m0,m0,1024
s_mov_b32 s64,6291456
buffer_load_dword v29,v31,s[32:35],s64 offen
s_waitcnt vmcnt(10)
buffer_load_dwordx4 v16,s[28:31],s62 offen  lds
s_add_u32 s62,s62,131072
s_add_u32 m0,m0,1024
s_waitcnt vmcnt(10)
buffer_load_dwordx4 v16,s[28:31],s62 offen  lds
s_add_u32 s62,s62,131072
s_add_u32 m0,m0,1024
s_waitcnt vmcnt(10)
buffer_load_dwordx4 v16,s[28:31],s62 offen  lds
s_add_u32 s62,s62,131072
s_add_u32 m0,m0,1024
s_waitcnt vmcnt(10)
buffer_load_dwordx4 v16,s[28:31],s62 offen  lds
s_add_u32 s62,s62,131072
s_add_u32 m0,m0,1024
s_waitcnt vmcnt(10)
buffer_load_dwordx4 v16,s[28:31],s62 offen  lds
s_add_u32 s62,s62,131072
s_add_u32 m0,m0,1024
s_waitcnt vmcnt(10)
buffer_load_dwordx4 v16,s[28:31],s62 offen  lds
s_add_u32 s62,s62,131072
s_add_u32 m0,m0,1024
s_waitcnt vmcnt(10)
buffer_load_dwordx4 v16,s[28:31],s62 offen  lds
s_add_u32 s62,s62,131072
s_add_u32 m0,m0,1024
s_waitcnt vmcnt(10)
buffer_load_dwordx4 v16,s[28:31],s62 offen  lds
s_add_u32 s62,s62,131072
s_add_u32 m0,m0,1024
s_mov_b32 s64,7340032
buffer_load_dword v29,v31,s[32:35],s64 offen
s_waitcnt vmcnt(10)
buffer_load_dwordx4 v16,s[28:31],s62 offen  lds
s_add_u32 s62,s62,131072
s_add_u32 m0,m0,1024
s_waitcnt vmcnt(10)
buffer_load_dwordx4 v16,s[28:31],s62 offen  lds
s_add_u32 s62,s62,131072
s_add_u32 m0,m0,1024
s_waitcnt vmcnt(10)
buffer_load_dwordx4 v16,s[28:31],s62 offen  lds
s_add_u32 s62,s62,131072
s_add_u32 m0,m0,1024
s_waitcnt vmcnt(10)
buffer_load_dwordx4 v16,s[28:31],s62 offen  lds
s_add_u32 s62,s62,131072
s_add_u32 m0,m0,1024
s_waitcnt vmcnt(10)
buffer_load_dwordx4 v16,s[28:31],s62 offen  lds
s_add_u32 s62,s62,131072
s_add_u32 m0,m0,1024
s_waitcnt vmcnt(10)
buffer_load_dwordx4 v16,s[28:31],s62 offen  lds
s_waitcnt vmcnt(10)
s_waitcnt vmcnt(18)
ds_read_b64_tr_b16 a[200:201],v18 offset:16384
ds_read_b64_tr_b16 a[202:203],v18 offset:16640
ds_read_b64_tr_b16 a[212:213],v18 offset:18432
ds_read_b64_tr_b16 a[214:215],v18 offset:18688
ds_read_b64_tr_b16 a[224:225],v18 offset:20480
ds_read_b64_tr_b16 a[226:227],v18 offset:20736
ds_read_b64_tr_b16 a[236:237],v18 offset:22528
ds_read_b64_tr_b16 a[238:239],v18 offset:22784
ds_read_b64_tr_b16 a[248:249],v18 offset:24576
ds_read_b64_tr_b16 a[250:251],v18 offset:24832
ds_read_b64_tr_b16 v[132:133],v18 offset:26624
ds_read_b64_tr_b16 v[134:135],v18 offset:26880
s_waitcnt lgkmcnt(0)
ds_read_b64_tr_b16 v[144:145],v18 offset:28672
ds_read_b64_tr_b16 v[146:147],v18 offset:28928
ds_read_b64_tr_b16 v[156:157],v18 offset:30720
ds_read_b64_tr_b16 v[158:159],v18 offset:30976
s_waitcnt lgkmcnt(0)
s_mov_b32 s92,s2
s_and_b32 s93,s3,0xffff
s_mov_b32 s94,0x100
s_mov_b32 s95,0x20000
v_min_u32 v9,31,v1
v_lshlrev_b32 v9,2,v9
s_sub_u32 s64,s88,64
buffer_load_dword v9,v9,s[92:95],s64 offen sc1
s_add_u32 s62,s52,6291456
s_add_u32 m0,s61,16384
s_nop 0
buffer_load_dwordx4 v16,s[32:35],s62 offen  lds
s_add_u32 s62,s62,131072
s_add_u32 m0,m0,1024
s_waitcnt vmcnt(10)
buffer_load_dwordx4 v16,s[32:35],s62 offen  lds
s_add_u32 s62,s62,131072
s_add_u32 m0,m0,1024
s_waitcnt vmcnt(10)
buffer_load_dwordx4 v16,s[32:35],s62 offen  lds
s_add_u32 s62,s62,131072
s_add_u32 m0,m0,1024
s_waitcnt vmcnt(10)
buffer_load_dwordx4 v16,s[32:35],s62 offen  lds
s_add_u32 s62,s62,131072
s_add_u32 m0,m0,1024
s_waitcnt vmcnt(10)
buffer_load_dwordx4 v16,s[32:35],s62 offen  lds
s_add_u32 s62,s62,131072
s_add_u32 m0,m0,1024
s_waitcnt vmcnt(10)
buffer_load_dwordx4 v16,s[32:35],s62 offen  lds
s_add_u32 s62,s62,131072
s_add_u32 m0,m0,1024
s_waitcnt vmcnt(10)
buffer_load_dwordx4 v16,s[32:35],s62 offen  lds
s_add_u32 s62,s62,131072
s_add_u32 m0,m0,1024
s_waitcnt vmcnt(10)
buffer_load_dwordx4 v16,s[32:35],s62 offen  lds
s_add_u32 s62,s62,131072
s_add_u32 m0,m0,1024
s_waitcnt vmcnt(10)
buffer_load_dwordx4 v16,s[32:35],s62 offen  lds
s_add_u32 s62,s62,131072
s_add_u32 m0,m0,1024
s_waitcnt vmcnt(10)
buffer_load_dwordx4 v16,s[32:35],s62 offen  lds
s_add_u32 s62,s62,131072
s_add_u32 m0,m0,1024
s_waitcnt vmcnt(10)
buffer_load_dwordx4 v16,s[32:35],s62 offen  lds
s_add_u32 s62,s62,131072
s_add_u32 m0,m0,1024
s_waitcnt vmcnt(10)
buffer_load_dwordx4 v16,s[32:35],s62 offen  lds
s_add_u32 s62,s62,131072
s_add_u32 m0,m0,1024
s_waitcnt vmcnt(10)
buffer_load_dwordx4 v16,s[32:35],s62 offen  lds
s_add_u32 s62,s62,131072
s_add_u32 m0,m0,1024
s_waitcnt vmcnt(10)
buffer_load_dwordx4 v16,s[32:35],s62 offen  lds
s_add_u32 s62,s62,131072
s_add_u32 m0,m0,1024
s_waitcnt vmcnt(10)
buffer_load_dwordx4 v16,s[32:35],s62 offen  lds
s_add_u32 s62,s62,131072
s_add_u32 m0,m0,1024
s_waitcnt vmcnt(10)
buffer_load_dwordx4 v16,s[32:35],s62 offen  lds
s_waitcnt vmcnt(10)
s_waitcnt vmcnt(17)
ds_read_b64_tr_b16 v[160:161],v17 offset:0
ds_read_b64_tr_b16 v[162:163],v17 offset:256
ds_read_b64_tr_b16 v[164:165],v17 offset:8
ds_read_b64_tr_b16 v[166:167],v17 offset:264
ds_read_b64_tr_b16 v[172:173],v17 offset:2048
ds_read_b64_tr_b16 v[174:175],v17 offset:2304
ds_read_b64_tr_b16 v[176:177],v17 offset:2056
ds_read_b64_tr_b16 v[178:179],v17 offset:2312
ds_read_b64_tr_b16 v[184:185],v17 offset:4096
ds_read_b64_tr_b16 v[186:187],v17 offset:4352
ds_read_b64_tr_b16 v[188:189],v17 offset:4104
ds_read_b64_tr_b16 v[190:191],v17 offset:4360
s_waitcnt lgkmcnt(0)
ds_read_b64_tr_b16 v[196:197],v17 offset:6144
ds_read_b64_tr_b16 v[198:199],v17 offset:6400
ds_read_b64_tr_b16 v[200:201],v17 offset:6152
ds_read_b64_tr_b16 v[202:203],v17 offset:6408
ds_read_b64_tr_b16 v[208:209],v17 offset:8192
ds_read_b64_tr_b16 v[210:211],v17 offset:8448
ds_read_b64_tr_b16 v[212:213],v17 offset:8200
ds_read_b64_tr_b16 v[214:215],v17 offset:8456
ds_read_b64_tr_b16 v[220:221],v17 offset:10240
ds_read_b64_tr_b16 v[222:223],v17 offset:10496
ds_read_b64_tr_b16 v[224:225],v17 offset:10248
ds_read_b64_tr_b16 v[226:227],v17 offset:10504
s_waitcnt lgkmcnt(0)
ds_read_b64_tr_b16 v[232:233],v17 offset:12288
ds_read_b64_tr_b16 v[234:235],v17 offset:12544
ds_read_b64_tr_b16 v[236:237],v17 offset:12296
ds_read_b64_tr_b16 v[238:239],v17 offset:12552
ds_read_b64_tr_b16 v[244:245],v17 offset:14336
ds_read_b64_tr_b16 v[246:247],v17 offset:14592
ds_read_b64_tr_b16 v[248:249],v17 offset:14344
ds_read_b64_tr_b16 v[250:251],v17 offset:14600
s_waitcnt lgkmcnt(0)
s_waitcnt vmcnt(16)
v_and_b32 v10,1,v1
v_cmp_eq_u32 vcc,1,v10
v_mov_b32 v10,8192
s_nop 0
v_cndmask_b32 v10,-1,v10,vcc
v_cmp_eq_u32 vcc,v9,v10
s_and_b32 s64,vcc_lo,0xffff
v_readlane_b32 s65,v9,21
s_cmp_eq_u32 s64,65535
s_cselect_b32 s65,s65,0
s_cmp_eq_u32 s56,2
s_cselect_b32 s65,s65,0
v_readlane_b32 s64,v9,22
s_cmp_ge_u32 s64,63
s_cselect_b32 s65,s65,0
v_readlane_b32 s64,v9,19
s_cmp_ge_u32 s64,64
s_cselect_b32 s65,s65,0
s_and_b32 s64,s65,2
s_lshl_b32 s64,s64,12
s_or_b32 s64,s64,1
s_cmp_eq_u32 s65,0
s_cselect_b32 s65,0,s64
v_mov_b32 v10,131072
s_cmp_lg_u32 s50,0
s_cbranch_scc1 avs_49
v_and_b32 v9,3,v1
v_mad_u32_u24 v10,v9,64,0
v_lshlrev_b32 v10,7,v10
v_add_u32 v10,131072,v10
v_mov_b32 v9,s65
ds_write_b32 v10,v9
s_waitcnt lgkmcnt(0)
avs_49:
s_mul_i32 s64,s50,8192
s_add_u32 s64,s64,131072
v_mov_b32 v10,s64
s_barrier
ds_read_b32 v9,v10
s_waitcnt lgkmcnt(0)
v_readfirstlane_b32 s89,v9
s_cmp_eq_u32 s89,0
s_cbranch_scc1 qe_47
s_lshl_b32 s64,s50,13
s_add_u32 m0,s64,131072
s_add_u32 s64,s64,146800640
s_add_u32 s65,s64,4096
v_lshlrev_b32 v0,4,v1
buffer_load_dwordx4 v0,s[20:23],s64 offen offset:0 lds
buffer_load_dwordx4 v0,s[20:23],s64 offen offset:1024 lds
buffer_load_dwordx4 v0,s[20:23],s64 offen offset:2048 lds
buffer_load_dwordx4 v0,s[20:23],s64 offen offset:3072 lds
s_add_u32 m0,m0,4096
s_nop 0
buffer_load_dwordx4 v0,s[20:23],s65 offen offset:0 lds
buffer_load_dwordx4 v0,s[20:23],s65 offen offset:1024 lds
buffer_load_dwordx4 v0,s[20:23],s65 offen offset:2048 lds
buffer_load_dwordx4 v0,s[20:23],s65 offen offset:3072 lds
s_waitcnt vmcnt(8)
s_branch qj_48
qe_47:
s_waitcnt vmcnt(0)
qj_48:
ds_read_b64_tr_b16 v[168:169],v18 offset:16384
ds_read_b64_tr_b16 v[170:171],v18 offset:16640
ds_read_b64_tr_b16 v[180:181],v18 offset:18432
ds_read_b64_tr_b16 v[182:183],v18 offset:18688
ds_read_b64_tr_b16 v[192:193],v18 offset:20480
ds_read_b64_tr_b16 v[194:195],v18 offset:20736
ds_read_b64_tr_b16 v[204:205],v18 offset:22528
ds_read_b64_tr_b16 v[206:207],v18 offset:22784
ds_read_b64_tr_b16 v[216:217],v18 offset:24576
ds_read_b64_tr_b16 v[218:219],v18 offset:24832
ds_read_b64_tr_b16 v[228:229],v18 offset:26624
ds_read_b64_tr_b16 v[230:231],v18 offset:26880
s_waitcnt lgkmcnt(0)
ds_read_b64_tr_b16 v[240:241],v18 offset:28672
ds_read_b64_tr_b16 v[242:243],v18 offset:28928
ds_read_b64_tr_b16 v[252:253],v18 offset:30720
ds_read_b64_tr_b16 v[254:255],v18 offset:30976
s_waitcnt lgkmcnt(0)
s_cmp_eq_u32 s89,0
s_cbranch_scc1 avn_50
s_mov_b32 s56,0
s_and_b32 s67,s89,0x2000
s_branch avj_51
avn_50:
s_mov_b32 s92,s2
s_and_b32 s93,s3,0xffff
s_mov_b32 s94,0x100
s_mov_b32 s95,0x20000
v_mbcnt_lo_u32_b32 v16,-1,0
v_mbcnt_hi_u32_b32 v16,-1,v16
v_mov_b32 v18,0
v_cmp_eq_u32 vcc,22,v16
s_nop 1
v_cndmask_b32 v18,v18,63,vcc
v_cmp_eq_u32 vcc,19,v16
s_nop 1
v_cndmask_b32 v18,v18,64,vcc
v_cmp_eq_u32 vcc,21,v16
s_nop 1
v_cndmask_b32 v18,v18,1,vcc
v_and_b32 v19,1,v16
v_cmp_eq_u32 vcc,1,v19
v_mov_b32 v19,8192
s_nop 0
v_cndmask_b32 v19,-1,v19,vcc
v_min_u32 v16,31,v16
v_lshlrev_b32 v16,2,v16
s_sub_u32 s66,s88,64
s_cmp_lg_u32 s50,0
s_cbranch_scc1 vot_56
vpoll_52:
buffer_load_dword v17,v16,s[92:95],s66 offen sc1
s_waitcnt vmcnt(0)
s_cmp_lg_u32 s56,2
s_cbranch_scc1 vck_53
v_cmp_eq_u32 vcc,v17,v19
s_and_b32 s64,vcc_lo,0xffff
s_cmp_eq_u32 s64,65535
s_cbranch_scc1 vck_53
s_mov_b32 s65,0
v_readlane_b32 s64,v17,1
s_lshr_b32 s64,s64,8
s_add_u32 s65,s65,s64
v_readlane_b32 s64,v17,3
s_lshr_b32 s64,s64,8
s_add_u32 s65,s65,s64
v_readlane_b32 s64,v17,5
s_lshr_b32 s64,s64,8
s_add_u32 s65,s65,s64
v_readlane_b32 s64,v17,7
s_lshr_b32 s64,s64,8
s_add_u32 s65,s65,s64
v_readlane_b32 s64,v17,9
s_lshr_b32 s64,s64,8
s_add_u32 s65,s65,s64
v_readlane_b32 s64,v17,11
s_lshr_b32 s64,s64,8
s_add_u32 s65,s65,s64
v_readlane_b32 s64,v17,13
s_lshr_b32 s64,s64,8
s_add_u32 s65,s65,s64
v_readlane_b32 s64,v17,15
s_lshr_b32 s64,s64,8
s_add_u32 s65,s65,s64
s_cmp_ge_u32 s65,256
s_cbranch_scc1 vok_55
s_branch vrt_54
vck_53:
v_cmp_gt_u32 vcc,v18,v17
s_cbranch_vccz vok_55
vrt_54:
s_sleep 8
s_sub_u32 s90,s90,1
s_cmp_gt_i32 s90,0
s_cbranch_scc1 vpoll_52
vok_55:
v_add_u32 v18,160768,v16
ds_write_b32 v18,v17
s_waitcnt lgkmcnt(0)
vot_56:
s_barrier
v_add_u32 v18,160768,v16
ds_read_b32 v17,v18
s_waitcnt lgkmcnt(0)
s_cmp_lg_u32 s56,2
s_cbranch_scc1 vfin_57
v_cmp_eq_u32 vcc,v17,v19
s_and_b32 s64,vcc_lo,0xffff
s_cmp_eq_u32 s64,65535
s_cbranch_scc1 vfin_57
s_mov_b32 s65,0
v_readlane_b32 s64,v17,1
s_lshr_b32 s64,s64,8
s_add_u32 s65,s65,s64
v_readlane_b32 s64,v17,3
s_lshr_b32 s64,s64,8
s_add_u32 s65,s65,s64
v_readlane_b32 s64,v17,5
s_lshr_b32 s64,s64,8
s_add_u32 s65,s65,s64
v_readlane_b32 s64,v17,7
s_lshr_b32 s64,s64,8
s_add_u32 s65,s65,s64
v_readlane_b32 s64,v17,9
s_lshr_b32 s64,s64,8
s_add_u32 s65,s65,s64
v_readlane_b32 s64,v17,11
s_lshr_b32 s64,s64,8
s_add_u32 s65,s65,s64
v_readlane_b32 s64,v17,13
s_lshr_b32 s64,s64,8
s_add_u32 s65,s65,s64
v_readlane_b32 s64,v17,15
s_lshr_b32 s64,s64,8
s_add_u32 s65,s65,s64
s_cmp_ge_u32 s65,256
s_cbranch_scc1 fl_fb
vfin_57:
s_and_b32 s56,s56,1
s_mov_b32 s67,0
v_readlane_b32 s65,v17,21
s_and_b32 s65,s65,2
s_lshl_b32 s67,s65,12
s_barrier
s_lshl_b32 s64,s50,13
s_add_u32 m0,s64,131072
s_add_u32 s64,s64,146800640
s_add_u32 s65,s64,4096
v_lshlrev_b32 v0,4,v1
buffer_load_dwordx4 v0,s[20:23],s64 offen offset:0 lds
buffer_load_dwordx4 v0,s[20:23],s64 offen offset:1024 lds
buffer_load_dwordx4 v0,s[20:23],s64 offen offset:2048 lds
buffer_load_dwordx4 v0,s[20:23],s64 offen offset:3072 lds
s_add_u32 m0,m0,4096
s_nop 0
buffer_load_dwordx4 v0,s[20:23],s65 offen offset:0 lds
buffer_load_dwordx4 v0,s[20:23],s65 offen offset:1024 lds
buffer_load_dwordx4 v0,s[20:23],s65 offen offset:2048 lds
buffer_load_dwordx4 v0,s[20:23],s65 offen offset:3072 lds
avj_51:
s_barrier
v_lshlrev_b32 v0,4,v1
s_mov_b32 s60,0
s_lshl_b32 s63,s50,13
s_add_u32 s61,s63,146800640
s_mov_b32 s70,0
s_lshl_b32 s52,s59,14
s_and_b32 s64,s50,1
s_lshl_b32 s64,s64,11
s_add_u32 s53,s52,s64
s_lshl_b32 s64,s50,10
s_add_u32 s52,s52,s64
s_add_u32 s52,s52,4096
s_cmp_gt_u32 s50,1
s_cselect_b32 s54,0x2000,0
s_lshl_b32 s69,s59,6
s_add_u32 s69,s69,s67
s_add_u32 s69,s69,138412032
v_mov_b32 v4,v0
v_add_u32 v5,32768,v0
s_add_u32 s61,s61,32768
v_add_u32 v4,131072,v0
v_mov_b32 v5,v0
s_add_u32 m0,s70,s63
s_add_u32 s62,s61,4096
buffer_load_dwordx4 v0,s[20:23],s61 offen offset:0 lds
buffer_load_dwordx4 v0,s[20:23],s61 offen offset:1024 lds
buffer_load_dwordx4 v0,s[20:23],s61 offen offset:2048 lds
buffer_load_dwordx4 v0,s[20:23],s61 offen offset:3072 lds
s_add_u32 m0,m0,4096
s_nop 0
buffer_load_dwordx4 v0,s[20:23],s62 offen offset:0 lds
buffer_load_dwordx4 v0,s[20:23],s62 offen offset:1024 lds
buffer_load_dwordx4 v0,s[20:23],s62 offen offset:2048 lds
buffer_load_dwordx4 v0,s[20:23],s62 offen offset:3072 lds
s_add_u32 s61,s61,32768
s_add_u32 s70,s70,32768
s_and_b32 s70,s70,0x1ffff
s_waitcnt vmcnt(8)
s_barrier
ds_read_b128 v[64:67],v4 offset:0
ds_read_b128 v[68:71],v4 offset:1024
ds_read_b128 v[72:75],v4 offset:2048
ds_read_b128 v[76:79],v4 offset:3072
ds_read_b128 v[80:83],v4 offset:4096
top_58:
s_waitcnt lgkmcnt(4)
v_mfma_f32_16x16x32_bf16 v[32:35],a[0:3],v[64:67],0
ds_read_b128 v[84:87],v4 offset:5120
v_mfma_f32_16x16x32_bf16 v[36:39],a[4:7],v[64:67],0
v_mfma_f32_16x16x32_bf16 v[40:43],v[64:67],a[8:11],0
s_waitcnt lgkmcnt(4)
v_mfma_f32_16x16x32_bf16 v[32:35],a[12:15],v[68:71],v[32:35]
ds_read_b128 v[88:91],v4 offset:6144
s_sub_u32 s66,s60,1
s_lshr_b32 s64,s66,1
v_mfma_f32_16x16x32_bf16 v[36:39],a[16:19],v[68:71],v[36:39]
s_lshl_b32 s65,s64,12
s_and_b32 s65,s65,0x2000
v_mfma_f32_16x16x32_bf16 v[40:43],v[68:71],a[20:23],v[40:43]
s_xor_b32 s65,s65,s67
s_lshl_b32 s64,s64,20
s_waitcnt lgkmcnt(4)
v_mfma_f32_16x16x32_bf16 v[32:35],a[24:27],v[72:75],v[32:35]
ds_read_b128 v[92:95],v4 offset:7168
s_add_u32 s64,s64,s65
s_add_u32 s65,s64,s52
v_mfma_f32_16x16x32_bf16 v[36:39],a[28:31],v[72:75],v[36:39]
s_xor_b32 s64,s64,s54
s_add_u32 s66,s64,s53
v_mfma_f32_16x16x32_bf16 v[40:43],v[72:75],a[32:35],v[40:43]
s_cmp_eq_u32 s60,0
s_cselect_b32 s65,138608640,s65
s_waitcnt lgkmcnt(4)
v_mfma_f32_16x16x32_bf16 v[32:35],a[36:39],v[76:79],v[32:35]
ds_read_b128 v[96:99],v4 offset:8192
s_cselect_b32 s66,138608640,s66
v_mfma_f32_16x16x32_bf16 v[36:39],a[40:43],v[76:79],v[36:39]
v_cvt_pk_bf16_f32 v60,v44,v45
v_mfma_f32_16x16x32_bf16 v[40:43],v[76:79],a[44:47],v[40:43]
v_cvt_pk_bf16_f32 v61,v46,v47
s_waitcnt lgkmcnt(4)
v_mfma_f32_16x16x32_bf16 v[32:35],a[48:51],v[80:83],v[32:35]
ds_read_b128 v[100:103],v4 offset:9216
v_cvt_pk_bf16_f32 v62,v48,v49
v_mfma_f32_16x16x32_bf16 v[36:39],a[52:55],v[80:83],v[36:39]
v_cvt_pk_bf16_f32 v63,v50,v51
v_mfma_f32_16x16x32_bf16 v[40:43],v[80:83],a[56:59],v[40:43]
v_cvt_pk_bf16_f32 v58,v52,v53
s_waitcnt lgkmcnt(4)
v_mfma_f32_16x16x32_bf16 v[32:35],a[60:63],v[84:87],v[32:35]
ds_read_b128 v[104:107],v4 offset:10240
v_cvt_pk_bf16_f32 v59,v54,v55
v_mfma_f32_16x16x32_bf16 v[36:39],a[64:67],v[84:87],v[36:39]
buffer_store_dwordx4 v[60:63],v0,s[20:23],s66 offen offset:1024 sc1
v_mfma_f32_16x16x32_bf16 v[40:43],v[84:87],a[68:71],v[40:43]
buffer_store_dwordx4 v[56:59],v0,s[20:23],s65 offen sc1
s_waitcnt lgkmcnt(4)
v_mfma_f32_16x16x32_bf16 v[32:35],a[72:75],v[88:91],v[32:35]
ds_read_b128 v[108:111],v4 offset:11264
v_mfma_f32_16x16x32_bf16 v[36:39],a[76:79],v[88:91],v[36:39]
v_mfma_f32_16x16x32_bf16 v[40:43],v[88:91],a[80:83],v[40:43]
s_waitcnt lgkmcnt(4)
v_mfma_f32_16x16x32_bf16 v[32:35],a[84:87],v[92:95],v[32:35]
ds_read_b128 v[112:115],v4 offset:12288
v_mfma_f32_16x16x32_bf16 v[36:39],a[88:91],v[92:95],v[36:39]
v_mfma_f32_16x16x32_bf16 v[40:43],v[92:95],a[92:95],v[40:43]
s_waitcnt lgkmcnt(4)
v_mfma_f32_16x16x32_bf16 v[32:35],a[96:99],v[96:99],v[32:35]
ds_read_b128 v[116:119],v4 offset:13312
v_mfma_f32_16x16x32_bf16 v[36:39],a[100:103],v[96:99],v[36:39]
v_mfma_f32_16x16x32_bf16 v[40:43],v[96:99],a[104:107],v[40:43]
s_waitcnt lgkmcnt(4)
v_mfma_f32_16x16x32_bf16 v[32:35],a[108:111],v[100:103],v[32:35]
ds_read_b128 v[120:123],v4 offset:14336
v_mfma_f32_16x16x32_bf16 v[36:39],a[112:115],v[100:103],v[36:39]
v_mfma_f32_16x16x32_bf16 v[40:43],v[100:103],a[116:119],v[40:43]
s_waitcnt lgkmcnt(4)
v_mfma_f32_16x16x32_bf16 v[32:35],a[120:123],v[104:107],v[32:35]
ds_read_b128 v[124:127],v4 offset:15360
v_mfma_f32_16x16x32_bf16 v[36:39],a[124:127],v[104:107],v[36:39]
v_mfma_f32_16x16x32_bf16 v[40:43],v[104:107],a[128:131],v[40:43]
s_waitcnt lgkmcnt(4)
v_mfma_f32_16x16x32_bf16 v[32:35],a[132:135],v[108:111],v[32:35]
ds_read_b128 v[64:67],v4 offset:16384
v_mfma_f32_16x16x32_bf16 v[36:39],a[136:139],v[108:111],v[36:39]
v_mfma_f32_16x16x32_bf16 v[40:43],v[108:111],a[140:143],v[40:43]
s_waitcnt lgkmcnt(4)
v_mfma_f32_16x16x32_bf16 v[32:35],a[144:147],v[112:115],v[32:35]
ds_read_b128 v[68:71],v4 offset:17408
v_mfma_f32_16x16x32_bf16 v[36:39],a[148:151],v[112:115],v[36:39]
v_mfma_f32_16x16x32_bf16 v[40:43],v[112:115],a[152:155],v[40:43]
s_waitcnt lgkmcnt(4)
v_mfma_f32_16x16x32_bf16 v[32:35],a[156:159],v[116:119],v[32:35]
ds_read_b128 v[72:75],v4 offset:18432
v_mfma_f32_16x16x32_bf16 v[36:39],a[160:163],v[116:119],v[36:39]
v_mfma_f32_16x16x32_bf16 v[40:43],v[116:119],a[164:167],v[40:43]
s_waitcnt lgkmcnt(4)
v_mfma_f32_16x16x32_bf16 v[32:35],a[168:171],v[120:123],v[32:35]
ds_read_b128 v[76:79],v4 offset:19456
v_mfma_f32_16x16x32_bf16 v[36:39],a[172:175],v[120:123],v[36:39]
v_mfma_f32_16x16x32_bf16 v[40:43],v[120:123],a[176:179],v[40:43]
s_waitcnt lgkmcnt(4)
v_mfma_f32_16x16x32_bf16 v[32:35],a[180:183],v[124:127],v[32:35]
ds_read_b128 v[80:83],v4 offset:20480
v_mfma_f32_16x16x32_bf16 v[36:39],a[184:187],v[124:127],v[36:39]
s_waitcnt vmcnt(2)
s_cmp_eq_u32 s60,60
s_cbranch_scc1 hb_61
s_cmp_eq_u32 s60,16
s_cbranch_scc1 hc_63
hb2_62:
s_sub_u32 s64,s60,2
s_cmp_gt_u32 s64,128
s_cbranch_scc1 sk_60
s_waitcnt vmcnt(0)
sk_60:
s_cselect_b32 s64,1,s50
s_barrier
s_cmp_ge_u32 s60,126
s_cselect_b32 s61,146800640,s61
s_cmp_lg_u32 s64,0
s_cbranch_scc1 nf_59
s_lshr_b32 s64,s60,1
v_mov_b32 v6,s64
s_mov_b64 exec,1
buffer_store_dword v6,off,s[20:23],s69 sc1
s_mov_b64 exec,-1
nf_59:
v_mfma_f32_16x16x32_bf16 v[40:43],v[124:127],a[188:191],v[40:43]
s_waitcnt lgkmcnt(4)
v_mfma_f32_16x16x32_bf16 v[32:35],a[192:195],v[64:67],v[32:35]
ds_read_b128 v[84:87],v4 offset:21504
s_add_u32 m0,s70,s63
v_mfma_f32_16x16x32_bf16 v[36:39],a[196:199],v[64:67],v[36:39]
v_mfma_f32_16x16x32_bf16 v[40:43],v[64:67],a[200:203],v[40:43]
s_add_u32 s62,s61,4096
s_waitcnt lgkmcnt(4)
v_mfma_f32_16x16x32_bf16 v[32:35],a[204:207],v[68:71],v[32:35]
ds_read_b128 v[88:91],v4 offset:22528
v_mfma_f32_16x16x32_bf16 v[36:39],a[208:211],v[68:71],v[36:39]
buffer_load_dwordx4 v0,s[20:23],s61 offen offset:0 lds
v_mfma_f32_16x16x32_bf16 v[40:43],v[68:71],a[212:215],v[40:43]
s_waitcnt lgkmcnt(4)
v_mfma_f32_16x16x32_bf16 v[32:35],a[216:219],v[72:75],v[32:35]
ds_read_b128 v[92:95],v4 offset:23552
buffer_load_dwordx4 v0,s[20:23],s61 offen offset:1024 lds
v_mfma_f32_16x16x32_bf16 v[36:39],a[220:223],v[72:75],v[36:39]
v_mfma_f32_16x16x32_bf16 v[40:43],v[72:75],a[224:227],v[40:43]
buffer_load_dwordx4 v0,s[20:23],s61 offen offset:2048 lds
s_waitcnt lgkmcnt(4)
v_mfma_f32_16x16x32_bf16 v[32:35],a[228:231],v[76:79],v[32:35]
ds_read_b128 v[96:99],v4 offset:24576
v_mfma_f32_16x16x32_bf16 v[36:39],a[232:235],v[76:79],v[36:39]
buffer_load_dwordx4 v0,s[20:23],s61 offen offset:3072 lds
v_mfma_f32_16x16x32_bf16 v[40:43],v[76:79],a[236:239],v[40:43]
s_waitcnt lgkmcnt(4)
v_mfma_f32_16x16x32_bf16 v[32:35],a[240:243],v[80:83],v[32:35]
ds_read_b128 v[100:103],v4 offset:25600
s_add_u32 m0,m0,4096
v_mfma_f32_16x16x32_bf16 v[36:39],a[244:247],v[80:83],v[36:39]
v_mfma_f32_16x16x32_bf16 v[40:43],v[80:83],a[248:251],v[40:43]
buffer_load_dwordx4 v0,s[20:23],s62 offen offset:0 lds
s_waitcnt lgkmcnt(4)
v_mfma_f32_16x16x32_bf16 v[32:35],a[252:255],v[84:87],v[32:35]
ds_read_b128 v[104:107],v4 offset:26624
v_mfma_f32_16x16x32_bf16 v[36:39],v[128:131],v[84:87],v[36:39]
buffer_load_dwordx4 v0,s[20:23],s62 offen offset:1024 lds
v_mfma_f32_16x16x32_bf16 v[40:43],v[84:87],v[132:135],v[40:43]
s_waitcnt lgkmcnt(4)
v_mfma_f32_16x16x32_bf16 v[32:35],v[136:139],v[88:91],v[32:35]
ds_read_b128 v[108:111],v4 offset:27648
buffer_load_dwordx4 v0,s[20:23],s62 offen offset:2048 lds
v_mfma_f32_16x16x32_bf16 v[36:39],v[140:143],v[88:91],v[36:39]
v_mfma_f32_16x16x32_bf16 v[40:43],v[88:91],v[144:147],v[40:43]
buffer_load_dwordx4 v0,s[20:23],s62 offen offset:3072 lds
s_waitcnt lgkmcnt(4)
v_mfma_f32_16x16x32_bf16 v[32:35],v[148:151],v[92:95],v[32:35]
ds_read_b128 v[112:115],v4 offset:28672
v_mfma_f32_16x16x32_bf16 v[36:39],v[152:155],v[92:95],v[36:39]
s_add_u32 s61,s61,32768
v_mfma_f32_16x16x32_bf16 v[40:43],v[92:95],v[156:159],v[40:43]
s_waitcnt lgkmcnt(4)
v_mfma_f32_16x16x32_bf16 v[32:35],v[160:163],v[96:99],v[32:35]
ds_read_b128 v[116:119],v4 offset:29696
s_add_u32 s70,s70,32768
v_mfma_f32_16x16x32_bf16 v[36:39],v[164:167],v[96:99],v[36:39]
v_mfma_f32_16x16x32_bf16 v[40:43],v[96:99],v[168:171],v[40:43]
s_and_b32 s70,s70,0x1ffff
s_waitcnt lgkmcnt(4)
v_mfma_f32_16x16x32_bf16 v[32:35],v[172:175],v[100:103],v[32:35]
ds_read_b128 v[120:123],v4 offset:30720
v_mfma_f32_16x16x32_bf16 v[36:39],v[176:179],v[100:103],v[36:39]
v_mfma_f32_16x16x32_bf16 v[40:43],v[100:103],v[180:183],v[40:43]
s_waitcnt lgkmcnt(4)
v_mfma_f32_16x16x32_bf16 v[32:35],v[184:187],v[104:107],v[32:35]
ds_read_b128 v[124:127],v4 offset:31744
v_mfma_f32_16x16x32_bf16 v[36:39],v[188:191],v[104:107],v[36:39]
v_mfma_f32_16x16x32_bf16 v[40:43],v[104:107],v[192:195],v[40:43]
s_waitcnt lgkmcnt(4)
v_mfma_f32_16x16x32_bf16 v[32:35],v[196:199],v[108:111],v[32:35]
ds_read_b128 v[64:67],v5 offset:0
v_mfma_f32_16x16x32_bf16 v[36:39],v[200:203],v[108:111],v[36:39]
v_mfma_f32_16x16x32_bf16 v[40:43],v[108:111],v[204:207],v[40:43]
s_waitcnt lgkmcnt(4)
v_mfma_f32_16x16x32_bf16 v[32:35],v[208:211],v[112:115],v[32:35]
ds_read_b128 v[68:71],v5 offset:1024
v_mfma_f32_16x16x32_bf16 v[36:39],v[212:215],v[112:115],v[36:39]
v_mfma_f32_16x16x32_bf16 v[40:43],v[112:115],v[216:219],v[40:43]
s_waitcnt lgkmcnt(4)
v_mfma_f32_16x16x32_bf16 v[32:35],v[220:223],v[116:119],v[32:35]
ds_read_b128 v[72:75],v5 offset:2048
v_mfma_f32_16x16x32_bf16 v[36:39],v[224:227],v[116:119],v[36:39]
v_mfma_f32_16x16x32_bf16 v[40:43],v[116:119],v[228:231],v[40:43]
s_waitcnt lgkmcnt(4)
v_mfma_f32_16x16x32_bf16 v[32:35],v[232:235],v[120:123],v[32:35]
ds_read_b128 v[76:79],v5 offset:3072
v_mfma_f32_16x16x32_bf16 v[36:39],v[236:239],v[120:123],v[36:39]
v_mfma_f32_16x16x32_bf16 v[40:43],v[120:123],v[240:243],v[40:43]
s_waitcnt lgkmcnt(4)
v_mfma_f32_16x16x32_bf16 v[32:35],v[244:247],v[124:127],v[32:35]
ds_read_b128 v[80:83],v5 offset:4096
v_mfma_f32_16x16x32_bf16 v[36:39],v[248:251],v[124:127],v[36:39]
v_mfma_f32_16x16x32_bf16 v[40:43],v[124:127],v[252:255],v[40:43]
v_mov_b32 v4,v5
v_add_u32 v5,32768,v5
v_and_b32 v5,0x1ffff,v5
s_add_u32 s60,s60,1
s_waitcnt lgkmcnt(4)
v_mfma_f32_16x16x32_bf16 v[44:47],a[0:3],v[64:67],0
ds_read_b128 v[84:87],v4 offset:5120
v_mfma_f32_16x16x32_bf16 v[48:51],a[4:7],v[64:67],0
v_mfma_f32_16x16x32_bf16 v[52:55],v[64:67],a[8:11],0
s_waitcnt lgkmcnt(4)
v_mfma_f32_16x16x32_bf16 v[44:47],a[12:15],v[68:71],v[44:47]
ds_read_b128 v[88:91],v4 offset:6144
s_sub_u32 s66,s60,1
s_lshr_b32 s64,s66,1
v_mfma_f32_16x16x32_bf16 v[48:51],a[16:19],v[68:71],v[48:51]
s_lshl_b32 s65,s64,12
s_and_b32 s65,s65,0x2000
v_mfma_f32_16x16x32_bf16 v[52:55],v[68:71],a[20:23],v[52:55]
s_xor_b32 s65,s65,s67
s_lshl_b32 s64,s64,20
s_waitcnt lgkmcnt(4)
v_mfma_f32_16x16x32_bf16 v[44:47],a[24:27],v[72:75],v[44:47]
ds_read_b128 v[92:95],v4 offset:7168
s_add_u32 s64,s64,s65
s_add_u32 s65,s64,s52
v_mfma_f32_16x16x32_bf16 v[48:51],a[28:31],v[72:75],v[48:51]
s_xor_b32 s64,s64,s54
s_add_u32 s66,s64,s53
v_mfma_f32_16x16x32_bf16 v[52:55],v[72:75],a[32:35],v[52:55]
v_cvt_pk_bf16_f32 v60,v32,v33
v_cvt_pk_bf16_f32 v61,v34,v35
s_waitcnt lgkmcnt(4)
v_mfma_f32_16x16x32_bf16 v[44:47],a[36:39],v[76:79],v[44:47]
ds_read_b128 v[96:99],v4 offset:8192
v_cvt_pk_bf16_f32 v62,v36,v37
v_mfma_f32_16x16x32_bf16 v[48:51],a[40:43],v[76:79],v[48:51]
v_cvt_pk_bf16_f32 v63,v38,v39
v_mfma_f32_16x16x32_bf16 v[52:55],v[76:79],a[44:47],v[52:55]
v_cvt_pk_bf16_f32 v56,v40,v41
s_waitcnt lgkmcnt(4)
v_mfma_f32_16x16x32_bf16 v[44:47],a[48:51],v[80:83],v[44:47]
ds_read_b128 v[100:103],v4 offset:9216
v_cvt_pk_bf16_f32 v57,v42,v43
v_mfma_f32_16x16x32_bf16 v[48:51],a[52:55],v[80:83],v[48:51]
buffer_store_dwordx4 v[60:63],v0,s[20:23],s66 offen offset:0 sc1
v_mfma_f32_16x16x32_bf16 v[52:55],v[80:83],a[56:59],v[52:55]
s_waitcnt lgkmcnt(4)
v_mfma_f32_16x16x32_bf16 v[44:47],a[60:63],v[84:87],v[44:47]
ds_read_b128 v[104:107],v4 offset:10240
v_mfma_f32_16x16x32_bf16 v[48:51],a[64:67],v[84:87],v[48:51]
v_mfma_f32_16x16x32_bf16 v[52:55],v[84:87],a[68:71],v[52:55]
s_waitcnt lgkmcnt(4)
v_mfma_f32_16x16x32_bf16 v[44:47],a[72:75],v[88:91],v[44:47]
ds_read_b128 v[108:111],v4 offset:11264
v_mfma_f32_16x16x32_bf16 v[48:51],a[76:79],v[88:91],v[48:51]
v_mfma_f32_16x16x32_bf16 v[52:55],v[88:91],a[80:83],v[52:55]
s_waitcnt lgkmcnt(4)
v_mfma_f32_16x16x32_bf16 v[44:47],a[84:87],v[92:95],v[44:47]
ds_read_b128 v[112:115],v4 offset:12288
v_mfma_f32_16x16x32_bf16 v[48:51],a[88:91],v[92:95],v[48:51]
v_mfma_f32_16x16x32_bf16 v[52:55],v[92:95],a[92:95],v[52:55]
s_waitcnt lgkmcnt(4)
v_mfma_f32_16x16x32_bf16 v[44:47],a[96:99],v[96:99],v[44:47]
ds_read_b128 v[116:119],v4 offset:13312
v_mfma_f32_16x16x32_bf16 v[48:51],a[100:103],v[96:99],v[48:51]
v_mfma_f32_16x16x32_bf16 v[52:55],v[96:99],a[104:107],v[52:55]
s_waitcnt lgkmcnt(4)
v_mfma_f32_16x16x32_bf16 v[44:47],a[108:111],v[100:103],v[44:47]
ds_read_b128 v[120:123],v4 offset:14336
v_mfma_f32_16x16x32_bf16 v[48:51],a[112:115],v[100:103],v[48:51]
v_mfma_f32_16x16x32_bf16 v[52:55],v[100:103],a[116:119],v[52:55]
s_waitcnt lgkmcnt(4)
v_mfma_f32_16x16x32_bf16 v[44:47],a[120:123],v[104:107],v[44:47]
ds_read_b128 v[124:127],v4 offset:15360
v_mfma_f32_16x16x32_bf16 v[48:51],a[124:127],v[104:107],v[48:51]
v_mfma_f32_16x16x32_bf16 v[52:55],v[104:107],a[128:131],v[52:55]
s_waitcnt lgkmcnt(4)
v_mfma_f32_16x16x32_bf16 v[44:47],a[132:135],v[108:111],v[44:47]
ds_read_b128 v[64:67],v4 offset:16384
v_mfma_f32_16x16x32_bf16 v[48:51],a[136:139],v[108:111],v[48:51]
v_mfma_f32_16x16x32_bf16 v[52:55],v[108:111],a[140:143],v[52:55]
s_waitcnt lgkmcnt(4)
v_mfma_f32_16x16x32_bf16 v[44:47],a[144:147],v[112:115],v[44:47]
ds_read_b128 v[68:71],v4 offset:17408
v_mfma_f32_16x16x32_bf16 v[48:51],a[148:151],v[112:115],v[48:51]
v_mfma_f32_16x16x32_bf16 v[52:55],v[112:115],a[152:155],v[52:55]
s_waitcnt lgkmcnt(4)
v_mfma_f32_16x16x32_bf16 v[44:47],a[156:159],v[116:119],v[44:47]
ds_read_b128 v[72:75],v4 offset:18432
v_mfma_f32_16x16x32_bf16 v[48:51],a[160:163],v[116:119],v[48:51]
v_mfma_f32_16x16x32_bf16 v[52:55],v[116:119],a[164:167],v[52:55]
s_waitcnt lgkmcnt(4)
v_mfma_f32_16x16x32_bf16 v[44:47],a[168:171],v[120:123],v[44:47]
ds_read_b128 v[76:79],v4 offset:19456
v_mfma_f32_16x16x32_bf16 v[48:51],a[172:175],v[120:123],v[48:51]
v_mfma_f32_16x16x32_bf16 v[52:55],v[120:123],a[176:179],v[52:55]
s_waitcnt lgkmcnt(4)
v_mfma_f32_16x16x32_bf16 v[44:47],a[180:183],v[124:127],v[44:47]
ds_read_b128 v[80:83],v4 offset:20480
v_mfma_f32_16x16x32_bf16 v[48:51],a[184:187],v[124:127],v[48:51]
s_waitcnt vmcnt(1)
s_mov_b32 s64,s50
s_barrier
s_cmp_ge_u32 s60,126
s_cselect_b32 s61,146800640,s61
s_cmp_lg_u32 s64,0
s_cbranch_scc1 nf_64
s_lshr_b32 s64,s60,1
v_mov_b32 v6,s64
s_mov_b64 exec,1
buffer_store_dword v6,off,s[20:23],s69 sc1
s_mov_b64 exec,-1
nf_64:
v_mfma_f32_16x16x32_bf16 v[52:55],v[124:127],a[188:191],v[52:55]
s_waitcnt lgkmcnt(4)
v_mfma_f32_16x16x32_bf16 v[44:47],a[192:195],v[64:67],v[44:47]
ds_read_b128 v[84:87],v4 offset:21504
s_add_u32 m0,s70,s63
v_mfma_f32_16x16x32_bf16 v[48:51],a[196:199],v[64:67],v[48:51]
v_mfma_f32_16x16x32_bf16 v[52:55],v[64:67],a[200:203],v[52:55]
s_add_u32 s62,s61,4096
s_waitcnt lgkmcnt(4)
v_mfma_f32_16x16x32_bf16 v[44:47],a[204:207],v[68:71],v[44:47]
ds_read_b128 v[88:91],v4 offset:22528
v_mfma_f32_16x16x32_bf16 v[48:51],a[208:211],v[68:71],v[48:51]
buffer_load_dwordx4 v0,s[20:23],s61 offen offset:0 lds
v_mfma_f32_16x16x32_bf16 v[52:55],v[68:71],a[212:215],v[52:55]
s_waitcnt lgkmcnt(4)
v_mfma_f32_16x16x32_bf16 v[44:47],a[216:219],v[72:75],v[44:47]
ds_read_b128 v[92:95],v4 offset:23552
buffer_load_dwordx4 v0,s[20:23],s61 offen offset:1024 lds
v_mfma_f32_16x16x32_bf16 v[48:51],a[220:223],v[72:75],v[48:51]
v_mfma_f32_16x16x32_bf16 v[52:55],v[72:75],a[224:227],v[52:55]
buffer_load_dwordx4 v0,s[20:23],s61 offen offset:2048 lds
s_waitcnt lgkmcnt(4)
v_mfma_f32_16x16x32_bf16 v[44:47],a[228:231],v[76:79],v[44:47]
ds_read_b128 v[96:99],v4 offset:24576
v_mfma_f32_16x16x32_bf16 v[48:51],a[232:235],v[76:79],v[48:51]
buffer_load_dwordx4 v0,s[20:23],s61 offen offset:3072 lds
v_mfma_f32_16x16x32_bf16 v[52:55],v[76:79],a[236:239],v[52:55]
s_waitcnt lgkmcnt(4)
v_mfma_f32_16x16x32_bf16 v[44:47],a[240:243],v[80:83],v[44:47]
ds_read_b128 v[100:103],v4 offset:25600
s_add_u32 m0,m0,4096
v_mfma_f32_16x16x32_bf16 v[48:51],a[244:247],v[80:83],v[48:51]
v_mfma_f32_16x16x32_bf16 v[52:55],v[80:83],a[248:251],v[52:55]
buffer_load_dwordx4 v0,s[20:23],s62 offen offset:0 lds
s_waitcnt lgkmcnt(4)
v_mfma_f32_16x16x32_bf16 v[44:47],a[252:255],v[84:87],v[44:47]
ds_read_b128 v[104:107],v4 offset:26624
v_mfma_f32_16x16x32_bf16 v[48:51],v[128:131],v[84:87],v[48:51]
buffer_load_dwordx4 v0,s[20:23],s62 offen offset:1024 lds
v_mfma_f32_16x16x32_bf16 v[52:55],v[84:87],v[132:135],v[52:55]
s_waitcnt lgkmcnt(4)
v_mfma_f32_16x16x32_bf16 v[44:47],v[136:139],v[88:91],v[44:47]
ds_read_b128 v[108:111],v4 offset:27648
buffer_load_dwordx4 v0,s[20:23],s62 offen offset:2048 lds
v_mfma_f32_16x16x32_bf16 v[48:51],v[140:143],v[88:91],v[48:51]
v_mfma_f32_16x16x32_bf16 v[52:55],v[88:91],v[144:147],v[52:55]
buffer_load_dwordx4 v0,s[20:23],s62 offen offset:3072 lds
s_waitcnt lgkmcnt(4)
v_mfma_f32_16x16x32_bf16 v[44:47],v[148:151],v[92:95],v[44:47]
ds_read_b128 v[112:115],v4 offset:28672
v_mfma_f32_16x16x32_bf16 v[48:51],v[152:155],v[92:95],v[48:51]
s_add_u32 s61,s61,32768
v_mfma_f32_16x16x32_bf16 v[52:55],v[92:95],v[156:159],v[52:55]
s_waitcnt lgkmcnt(4)
v_mfma_f32_16x16x32_bf16 v[44:47],v[160:163],v[96:99],v[44:47]
ds_read_b128 v[116:119],v4 offset:29696
s_add_u32 s70,s70,32768
v_mfma_f32_16x16x32_bf16 v[48:51],v[164:167],v[96:99],v[48:51]
v_mfma_f32_16x16x32_bf16 v[52:55],v[96:99],v[168:171],v[52:55]
s_and_b32 s70,s70,0x1ffff
s_waitcnt lgkmcnt(4)
v_mfma_f32_16x16x32_bf16 v[44:47],v[172:175],v[100:103],v[44:47]
ds_read_b128 v[120:123],v4 offset:30720
v_mfma_f32_16x16x32_bf16 v[48:51],v[176:179],v[100:103],v[48:51]
v_mfma_f32_16x16x32_bf16 v[52:55],v[100:103],v[180:183],v[52:55]
s_waitcnt lgkmcnt(4)
v_mfma_f32_16x16x32_bf16 v[44:47],v[184:187],v[104:107],v[44:47]
ds_read_b128 v[124:127],v4 offset:31744
v_mfma_f32_16x16x32_bf16 v[48:51],v[188:191],v[104:107],v[48:51]
v_mfma_f32_16x16x32_bf16 v[52:55],v[104:107],v[192:195],v[52:55]
s_waitcnt lgkmcnt(4)
v_mfma_f32_16x16x32_bf16 v[44:47],v[196:199],v[108:111],v[44:47]
ds_read_b128 v[64:67],v5 offset:0
v_mfma_f32_16x16x32_bf16 v[48:51],v[200:203],v[108:111],v[48:51]
v_mfma_f32_16x16x32_bf16 v[52:55],v[108:111],v[204:207],v[52:55]
s_waitcnt lgkmcnt(4)
v_mfma_f32_16x16x32_bf16 v[44:47],v[208:211],v[112:115],v[44:47]
ds_read_b128 v[68:71],v5 offset:1024
v_mfma_f32_16x16x32_bf16 v[48:51],v[212:215],v[112:115],v[48:51]
v_mfma_f32_16x16x32_bf16 v[52:55],v[112:115],v[216:219],v[52:55]
s_waitcnt lgkmcnt(4)
v_mfma_f32_16x16x32_bf16 v[44:47],v[220:223],v[116:119],v[44:47]
ds_read_b128 v[72:75],v5 offset:2048
v_mfma_f32_16x16x32_bf16 v[48:51],v[224:227],v[116:119],v[48:51]
v_mfma_f32_16x16x32_bf16 v[52:55],v[116:119],v[228:231],v[52:55]
s_waitcnt lgkmcnt(4)
v_mfma_f32_16x16x32_bf16 v[44:47],v[232:235],v[120:123],v[44:47]
ds_read_b128 v[76:79],v5 offset:3072
v_mfma_f32_16x16x32_bf16 v[48:51],v[236:239],v[120:123],v[48:51]
v_mfma_f32_16x16x32_bf16 v[52:55],v[120:123],v[240:243],v[52:55]
s_waitcnt lgkmcnt(4)
v_mfma_f32_16x16x32_bf16 v[44:47],v[244:247],v[124:127],v[44:47]
ds_read_b128 v[80:83],v5 offset:4096
v_mfma_f32_16x16x32_bf16 v[48:51],v[248:251],v[124:127],v[48:51]
v_mfma_f32_16x16x32_bf16 v[52:55],v[124:127],v[252:255],v[52:55]
v_mov_b32 v4,v5
v_add_u32 v5,32768,v5
v_and_b32 v5,0x1ffff,v5
s_add_u32 s60,s60,1
s_cmp_lt_u32 s60,128
s_cbranch_scc1 top_58
s_sub_u32 s66,s60,1
s_lshr_b32 s64,s66,1
s_lshl_b32 s65,s64,12
s_and_b32 s65,s65,0x2000
s_xor_b32 s65,s65,s67
s_lshl_b32 s64,s64,20
s_add_u32 s64,s64,s65
s_add_u32 s65,s64,s52
s_xor_b32 s64,s64,s54
s_add_u32 s66,s64,s53
s_cmp_eq_u32 s60,0
s_cselect_b32 s65,138608640,s65
s_cselect_b32 s66,138608640,s66
v_cvt_pk_bf16_f32 v60,v44,v45
v_cvt_pk_bf16_f32 v61,v46,v47
v_cvt_pk_bf16_f32 v62,v48,v49
v_cvt_pk_bf16_f32 v63,v50,v51
v_cvt_pk_bf16_f32 v58,v52,v53
v_cvt_pk_bf16_f32 v59,v54,v55
buffer_store_dwordx4 v[60:63],v0,s[20:23],s66 offen offset:1024 sc1
buffer_store_dwordx4 v[56:59],v0,s[20:23],s65 offen sc1
s_waitcnt vmcnt(0) lgkmcnt(0)
s_barrier
s_cmp_lg_u32 s50,0
s_cbranch_scc1 done_46
v_mov_b32 v6,64
s_mov_b64 exec,1
buffer_store_dword v6,off,s[20:23],s69 sc1
s_mov_b64 exec,-1
done_46:
s_cmp_lt_u32 s59,32
s_cbranch_scc1 fl_att2
s_endpgm
hb_61:
s_mov_b32 s28,s2
s_and_b32 s29,s3,0xffff
s_mov_b32 s30,0x100
s_mov_b32 s31,0x20000
v_mbcnt_lo_u32_b32 v12,-1,0
v_mbcnt_hi_u32_b32 v12,-1,v12
v_mov_b32 v14,0
v_cmp_eq_u32 vcc,20,v12
s_nop 1
v_cndmask_b32 v14,v14,64,vcc
v_cmp_eq_u32 vcc,17,v12
s_nop 1
v_cndmask_b32 v14,v14,63,vcc
v_and_b32 v15,1,v12
v_cmp_eq_u32 vcc,1,v15
v_mov_b32 v15,8192
s_nop 0
v_cndmask_b32 v15,-1,v15,vcc
v_min_u32 v12,31,v12
v_lshlrev_b32 v12,2,v12
s_sub_u32 s66,s88,64
vpoll_65:
buffer_load_dword v13,v12,s[28:31],s66 offen sc1
s_waitcnt vmcnt(0)
vck_66:
v_cmp_gt_u32 vcc,v14,v13
s_cbranch_vccz vok_68
vrt_67:
s_sleep 8
s_sub_u32 s90,s90,1
s_cmp_gt_i32 s90,0
s_cbranch_scc1 vpoll_65
vok_68:
s_branch hb2_62
hc_63:
s_mov_b32 s28,s2
s_and_b32 s29,s3,0xffff
s_mov_b32 s30,0x100
s_mov_b32 s31,0x20000
v_mbcnt_lo_u32_b32 v12,-1,0
v_mbcnt_hi_u32_b32 v12,-1,v12
v_mov_b32 v14,0
v_cmp_eq_u32 vcc,17,v12
s_nop 1
v_cndmask_b32 v14,v14,63,vcc
v_and_b32 v15,1,v12
v_cmp_eq_u32 vcc,1,v15
v_mov_b32 v15,8192
s_nop 0
v_cndmask_b32 v15,-1,v15,vcc
v_min_u32 v12,31,v12
v_lshlrev_b32 v12,2,v12
s_sub_u32 s66,s88,64
vpoll_71:
buffer_load_dword v13,v12,s[28:31],s66 offen sc1
s_waitcnt vmcnt(0)
vck_72:
v_cmp_gt_u32 vcc,v14,v13
s_cbranch_vccz vok_74
vrt_73:
s_sleep 8
s_sub_u32 s90,s90,1
s_cmp_gt_i32 s90,0
s_cbranch_scc1 vpoll_71
vok_74:
s_branch hb2_62
fl_wo:
v_and_b32 v21,15,v1
v_lshrrev_b32 v22,4,v1
v_lshrrev_b32 v23,2,v21
v_and_b32 v24,3,v21
s_lshl_b32 s61,s50,15
v_lshl_add_u32 v25,v22,3,v23
s_load_dwordx2 s[4:5],s[0:1],40
s_load_dwordx2 s[6:7],s[0:1],0
s_lshr_b32 s52,s59,3
s_and_b32 s53,s59,7
s_mul_i32 s54,s52,2097152
s_lshl_b32 s64,s53,8
s_add_u32 s54,s54,s64
s_lshl_b32 s64,s50,6
s_add_u32 s54,s54,s64
s_waitcnt lgkmcnt(0)
s_mov_b32 s28,s4
s_and_b32 s29,s5,0xffff
s_mov_b32 s30,0x800000
s_mov_b32 s31,0x20000
s_mov_b32 s24,s6
s_and_b32 s25,s7,0xffff
s_mov_b32 s26,0x400000
s_mov_b32 s27,0x20000
v_lshrrev_b32 v26,2,v1
v_and_b32 v27,3,v1
v_mul_u32_u24 v16,2048,v26
v_lshl_add_u32 v16,v27,4,v16
v_lshlrev_b32 v17,6,v25
v_lshl_add_u32 v17,v24,4,v17
v_add_u32 v17,s61,v17
s_xor_b32 s62,s50,0
s_mul_i32 s62,s62,524288
s_add_u32 s62,s62,s54
s_add_u32 m0,s61,0
s_nop 0
buffer_load_dwordx4 v16,s[28:31],s62 offen  lds
s_add_u32 s62,s62,32768
s_add_u32 m0,m0,1024
s_waitcnt vmcnt(2)
buffer_load_dwordx4 v16,s[28:31],s62 offen  lds
s_add_u32 s62,s62,32768
s_add_u32 m0,m0,1024
s_waitcnt vmcnt(2)
buffer_load_dwordx4 v16,s[28:31],s62 offen  lds
s_add_u32 s62,s62,32768
s_add_u32 m0,m0,1024
s_waitcnt vmcnt(2)
buffer_load_dwordx4 v16,s[28:31],s62 offen  lds
s_add_u32 s62,s62,32768
s_add_u32 m0,m0,1024
s_waitcnt vmcnt(2)
buffer_load_dwordx4 v16,s[28:31],s62 offen  lds
s_add_u32 s62,s62,32768
s_add_u32 m0,m0,1024
s_waitcnt vmcnt(2)
buffer_load_dwordx4 v16,s[28:31],s62 offen  lds
s_add_u32 s62,s62,32768
s_add_u32 m0,m0,1024
s_waitcnt vmcnt(2)
buffer_load_dwordx4 v16,s[28:31],s62 offen  lds
s_add_u32 s62,s62,32768
s_add_u32 m0,m0,1024
s_waitcnt vmcnt(2)
buffer_load_dwordx4 v16,s[28:31],s62 offen  lds
s_add_u32 s62,s62,32768
s_add_u32 m0,m0,1024
s_waitcnt vmcnt(2)
buffer_load_dwordx4 v16,s[28:31],s62 offen  lds
s_add_u32 s62,s62,32768
s_add_u32 m0,m0,1024
s_waitcnt vmcnt(2)
buffer_load_dwordx4 v16,s[28:31],s62 offen  lds
s_add_u32 s62,s62,32768
s_add_u32 m0,m0,1024
s_waitcnt vmcnt(2)
buffer_load_dwordx4 v16,s[28:31],s62 offen  lds
s_add_u32 s62,s62,32768
s_add_u32 m0,m0,1024
s_waitcnt vmcnt(2)
buffer_load_dwordx4 v16,s[28:31],s62 offen  lds
s_add_u32 s62,s62,32768
s_add_u32 m0,m0,1024
s_waitcnt vmcnt(2)
buffer_load_dwordx4 v16,s[28:31],s62 offen  lds
s_add_u32 s62,s62,32768
s_add_u32 m0,m0,1024
s_waitcnt vmcnt(2)
buffer_load_dwordx4 v16,s[28:31],s62 offen  lds
s_add_u32 s62,s62,32768
s_add_u32 m0,m0,1024
s_waitcnt vmcnt(2)
buffer_load_dwordx4 v16,s[28:31],s62 offen  lds
s_add_u32 s62,s62,32768
s_add_u32 m0,m0,1024
s_waitcnt vmcnt(2)
buffer_load_dwordx4 v16,s[28:31],s62 offen  lds
s_waitcnt vmcnt(2)
s_xor_b32 s62,s50,1
s_mul_i32 s62,s62,524288
s_add_u32 s62,s62,s54
s_add_u32 m0,s61,16384
s_nop 0
buffer_load_dwordx4 v16,s[28:31],s62 offen  lds
s_add_u32 s62,s62,32768
s_add_u32 m0,m0,1024
s_waitcnt vmcnt(2)
buffer_load_dwordx4 v16,s[28:31],s62 offen  lds
s_add_u32 s62,s62,32768
s_add_u32 m0,m0,1024
s_waitcnt vmcnt(2)
buffer_load_dwordx4 v16,s[28:31],s62 offen  lds
s_add_u32 s62,s62,32768
s_add_u32 m0,m0,1024
s_waitcnt vmcnt(2)
buffer_load_dwordx4 v16,s[28:31],s62 offen  lds
s_add_u32 s62,s62,32768
s_add_u32 m0,m0,1024
s_waitcnt vmcnt(2)
buffer_load_dwordx4 v16,s[28:31],s62 offen  lds
s_add_u32 s62,s62,32768
s_add_u32 m0,m0,1024
s_waitcnt vmcnt(2)
buffer_load_dwordx4 v16,s[28:31],s62 offen  lds
s_add_u32 s62,s62,32768
s_add_u32 m0,m0,1024
s_waitcnt vmcnt(2)
buffer_load_dwordx4 v16,s[28:31],s62 offen  lds
s_add_u32 s62,s62,32768
s_add_u32 m0,m0,1024
s_waitcnt vmcnt(2)
buffer_load_dwordx4 v16,s[28:31],s62 offen  lds
s_add_u32 s62,s62,32768
s_add_u32 m0,m0,1024
s_waitcnt vmcnt(2)
buffer_load_dwordx4 v16,s[28:31],s62 offen  lds
s_add_u32 s62,s62,32768
s_add_u32 m0,m0,1024
s_waitcnt vmcnt(2)
buffer_load_dwordx4 v16,s[28:31],s62 offen  lds
s_add_u32 s62,s62,32768
s_add_u32 m0,m0,1024
s_waitcnt vmcnt(2)
buffer_load_dwordx4 v16,s[28:31],s62 offen  lds
s_add_u32 s62,s62,32768
s_add_u32 m0,m0,1024
s_waitcnt vmcnt(2)
buffer_load_dwordx4 v16,s[28:31],s62 offen  lds
s_add_u32 s62,s62,32768
s_add_u32 m0,m0,1024
s_waitcnt vmcnt(2)
buffer_load_dwordx4 v16,s[28:31],s62 offen  lds
s_add_u32 s62,s62,32768
s_add_u32 m0,m0,1024
s_waitcnt vmcnt(2)
buffer_load_dwordx4 v16,s[28:31],s62 offen  lds
s_add_u32 s62,s62,32768
s_add_u32 m0,m0,1024
s_waitcnt vmcnt(2)
buffer_load_dwordx4 v16,s[28:31],s62 offen  lds
s_add_u32 s62,s62,32768
s_add_u32 m0,m0,1024
s_waitcnt vmcnt(2)
buffer_load_dwordx4 v16,s[28:31],s62 offen  lds
s_waitcnt vmcnt(2)
s_waitcnt vmcnt(16)
ds_read_b64_tr_b16 a[0:1],v17 offset:0
ds_read_b64_tr_b16 a[2:3],v17 offset:256
ds_read_b64_tr_b16 a[4:5],v17 offset:8
ds_read_b64_tr_b16 a[6:7],v17 offset:264
ds_read_b64_tr_b16 a[8:9],v17 offset:2048
ds_read_b64_tr_b16 a[10:11],v17 offset:2304
ds_read_b64_tr_b16 a[12:13],v17 offset:2056
ds_read_b64_tr_b16 a[14:15],v17 offset:2312
ds_read_b64_tr_b16 a[16:17],v17 offset:4096
ds_read_b64_tr_b16 a[18:19],v17 offset:4352
ds_read_b64_tr_b16 a[20:21],v17 offset:4104
ds_read_b64_tr_b16 a[22:23],v17 offset:4360
s_waitcnt lgkmcnt(0)
ds_read_b64_tr_b16 a[24:25],v17 offset:6144
ds_read_b64_tr_b16 a[26:27],v17 offset:6400
ds_read_b64_tr_b16 a[28:29],v17 offset:6152
ds_read_b64_tr_b16 a[30:31],v17 offset:6408
ds_read_b64_tr_b16 a[32:33],v17 offset:8192
ds_read_b64_tr_b16 a[34:35],v17 offset:8448
ds_read_b64_tr_b16 a[36:37],v17 offset:8200
ds_read_b64_tr_b16 a[38:39],v17 offset:8456
ds_read_b64_tr_b16 a[40:41],v17 offset:10240
ds_read_b64_tr_b16 a[42:43],v17 offset:10496
ds_read_b64_tr_b16 a[44:45],v17 offset:10248
ds_read_b64_tr_b16 a[46:47],v17 offset:10504
s_waitcnt lgkmcnt(0)
ds_read_b64_tr_b16 a[48:49],v17 offset:12288
ds_read_b64_tr_b16 a[50:51],v17 offset:12544
ds_read_b64_tr_b16 a[52:53],v17 offset:12296
ds_read_b64_tr_b16 a[54:55],v17 offset:12552
ds_read_b64_tr_b16 a[56:57],v17 offset:14336
ds_read_b64_tr_b16 a[58:59],v17 offset:14592
ds_read_b64_tr_b16 a[60:61],v17 offset:14344
ds_read_b64_tr_b16 a[62:63],v17 offset:14600
s_waitcnt lgkmcnt(0)
s_xor_b32 s62,s50,2
s_mul_i32 s62,s62,524288
s_add_u32 s62,s62,s54
s_add_u32 m0,s61,0
s_nop 0
buffer_load_dwordx4 v16,s[28:31],s62 offen  lds
s_add_u32 s62,s62,32768
s_add_u32 m0,m0,1024
s_waitcnt vmcnt(2)
buffer_load_dwordx4 v16,s[28:31],s62 offen  lds
s_add_u32 s62,s62,32768
s_add_u32 m0,m0,1024
s_waitcnt vmcnt(2)
buffer_load_dwordx4 v16,s[28:31],s62 offen  lds
s_add_u32 s62,s62,32768
s_add_u32 m0,m0,1024
s_waitcnt vmcnt(2)
buffer_load_dwordx4 v16,s[28:31],s62 offen  lds
s_add_u32 s62,s62,32768
s_add_u32 m0,m0,1024
s_waitcnt vmcnt(2)
buffer_load_dwordx4 v16,s[28:31],s62 offen  lds
s_add_u32 s62,s62,32768
s_add_u32 m0,m0,1024
s_waitcnt vmcnt(2)
buffer_load_dwordx4 v16,s[28:31],s62 offen  lds
s_add_u32 s62,s62,32768
s_add_u32 m0,m0,1024
s_waitcnt vmcnt(2)
buffer_load_dwordx4 v16,s[28:31],s62 offen  lds
s_add_u32 s62,s62,32768
s_add_u32 m0,m0,1024
s_waitcnt vmcnt(2)
buffer_load_dwordx4 v16,s[28:31],s62 offen  lds
s_add_u32 s62,s62,32768
s_add_u32 m0,m0,1024
s_waitcnt vmcnt(2)
buffer_load_dwordx4 v16,s[28:31],s62 offen  lds
s_add_u32 s62,s62,32768
s_add_u32 m0,m0,1024
s_waitcnt vmcnt(2)
buffer_load_dwordx4 v16,s[28:31],s62 offen  lds
s_add_u32 s62,s62,32768
s_add_u32 m0,m0,1024
s_waitcnt vmcnt(2)
buffer_load_dwordx4 v16,s[28:31],s62 offen  lds
s_add_u32 s62,s62,32768
s_add_u32 m0,m0,1024
s_waitcnt vmcnt(2)
buffer_load_dwordx4 v16,s[28:31],s62 offen  lds
s_add_u32 s62,s62,32768
s_add_u32 m0,m0,1024
s_waitcnt vmcnt(2)
buffer_load_dwordx4 v16,s[28:31],s62 offen  lds
s_add_u32 s62,s62,32768
s_add_u32 m0,m0,1024
s_waitcnt vmcnt(2)
buffer_load_dwordx4 v16,s[28:31],s62 offen  lds
s_add_u32 s62,s62,32768
s_add_u32 m0,m0,1024
s_waitcnt vmcnt(2)
buffer_load_dwordx4 v16,s[28:31],s62 offen  lds
s_add_u32 s62,s62,32768
s_add_u32 m0,m0,1024
s_waitcnt vmcnt(2)
buffer_load_dwordx4 v16,s[28:31],s62 offen  lds
s_waitcnt vmcnt(2)
s_waitcnt vmcnt(16)
ds_read_b64_tr_b16 a[64:65],v17 offset:16384
ds_read_b64_tr_b16 a[66:67],v17 offset:16640
ds_read_b64_tr_b16 a[68:69],v17 offset:16392
ds_read_b64_tr_b16 a[70:71],v17 offset:16648
ds_read_b64_tr_b16 a[72:73],v17 offset:18432
ds_read_b64_tr_b16 a[74:75],v17 offset:18688
ds_read_b64_tr_b16 a[76:77],v17 offset:18440
ds_read_b64_tr_b16 a[78:79],v17 offset:18696
ds_read_b64_tr_b16 a[80:81],v17 offset:20480
ds_read_b64_tr_b16 a[82:83],v17 offset:20736
ds_read_b64_tr_b16 a[84:85],v17 offset:20488
ds_read_b64_tr_b16 a[86:87],v17 offset:20744
s_waitcnt lgkmcnt(0)
ds_read_b64_tr_b16 a[88:89],v17 offset:22528
ds_read_b64_tr_b16 a[90:91],v17 offset:22784
ds_read_b64_tr_b16 a[92:93],v17 offset:22536
ds_read_b64_tr_b16 a[94:95],v17 offset:22792
ds_read_b64_tr_b16 a[96:97],v17 offset:24576
ds_read_b64_tr_b16 a[98:99],v17 offset:24832
ds_read_b64_tr_b16 a[100:101],v17 offset:24584
ds_read_b64_tr_b16 a[102:103],v17 offset:24840
ds_read_b64_tr_b16 a[104:105],v17 offset:26624
ds_read_b64_tr_b16 a[106:107],v17 offset:26880
ds_read_b64_tr_b16 a[108:109],v17 offset:26632
ds_read_b64_tr_b16 a[110:111],v17 offset:26888
s_waitcnt lgkmcnt(0)
ds_read_b64_tr_b16 a[112:113],v17 offset:28672
ds_read_b64_tr_b16 a[114:115],v17 offset:28928
ds_read_b64_tr_b16 a[116:117],v17 offset:28680
ds_read_b64_tr_b16 a[118:119],v17 offset:28936
ds_read_b64_tr_b16 a[120:121],v17 offset:30720
ds_read_b64_tr_b16 a[122:123],v17 offset:30976
ds_read_b64_tr_b16 a[124:125],v17 offset:30728
ds_read_b64_tr_b16 a[126:127],v17 offset:30984
s_waitcnt lgkmcnt(0)
s_xor_b32 s62,s50,3
s_mul_i32 s62,s62,524288
s_add_u32 s62,s62,s54
s_add_u32 m0,s61,16384
s_nop 0
buffer_load_dwordx4 v16,s[28:31],s62 offen  lds
s_add_u32 s62,s62,32768
s_add_u32 m0,m0,1024
s_waitcnt vmcnt(2)
buffer_load_dwordx4 v16,s[28:31],s62 offen  lds
s_add_u32 s62,s62,32768
s_add_u32 m0,m0,1024
s_waitcnt vmcnt(2)
buffer_load_dwordx4 v16,s[28:31],s62 offen  lds
s_add_u32 s62,s62,32768
s_add_u32 m0,m0,1024
s_waitcnt vmcnt(2)
buffer_load_dwordx4 v16,s[28:31],s62 offen  lds
s_add_u32 s62,s62,32768
s_add_u32 m0,m0,1024
s_waitcnt vmcnt(2)
buffer_load_dwordx4 v16,s[28:31],s62 offen  lds
s_add_u32 s62,s62,32768
s_add_u32 m0,m0,1024
s_waitcnt vmcnt(2)
buffer_load_dwordx4 v16,s[28:31],s62 offen  lds
s_add_u32 s62,s62,32768
s_add_u32 m0,m0,1024
s_waitcnt vmcnt(2)
buffer_load_dwordx4 v16,s[28:31],s62 offen  lds
s_add_u32 s62,s62,32768
s_add_u32 m0,m0,1024
s_waitcnt vmcnt(2)
buffer_load_dwordx4 v16,s[28:31],s62 offen  lds
s_add_u32 s62,s62,32768
s_add_u32 m0,m0,1024
s_waitcnt vmcnt(2)
buffer_load_dwordx4 v16,s[28:31],s62 offen  lds
s_add_u32 s62,s62,32768
s_add_u32 m0,m0,1024
s_waitcnt vmcnt(2)
buffer_load_dwordx4 v16,s[28:31],s62 offen  lds
s_add_u32 s62,s62,32768
s_add_u32 m0,m0,1024
s_waitcnt vmcnt(2)
buffer_load_dwordx4 v16,s[28:31],s62 offen  lds
s_add_u32 s62,s62,32768
s_add_u32 m0,m0,1024
s_waitcnt vmcnt(2)
buffer_load_dwordx4 v16,s[28:31],s62 offen  lds
s_add_u32 s62,s62,32768
s_add_u32 m0,m0,1024
s_waitcnt vmcnt(2)
buffer_load_dwordx4 v16,s[28:31],s62 offen  lds
s_add_u32 s62,s62,32768
s_add_u32 m0,m0,1024
s_waitcnt vmcnt(2)
buffer_load_dwordx4 v16,s[28:31],s62 offen  lds
s_add_u32 s62,s62,32768
s_add_u32 m0,m0,1024
s_waitcnt vmcnt(2)
buffer_load_dwordx4 v16,s[28:31],s62 offen  lds
s_add_u32 s62,s62,32768
s_add_u32 m0,m0,1024
s_waitcnt vmcnt(2)
buffer_load_dwordx4 v16,s[28:31],s62 offen  lds
s_waitcnt vmcnt(2)
s_waitcnt vmcnt(16)
ds_read_b64_tr_b16 a[128:129],v17 offset:0
ds_read_b64_tr_b16 a[130:131],v17 offset:256
ds_read_b64_tr_b16 a[132:133],v17 offset:8
ds_read_b64_tr_b16 a[134:135],v17 offset:264
ds_read_b64_tr_b16 a[136:137],v17 offset:2048
ds_read_b64_tr_b16 a[138:139],v17 offset:2304
ds_read_b64_tr_b16 a[140:141],v17 offset:2056
ds_read_b64_tr_b16 a[142:143],v17 offset:2312
ds_read_b64_tr_b16 a[144:145],v17 offset:4096
ds_read_b64_tr_b16 a[146:147],v17 offset:4352
ds_read_b64_tr_b16 a[148:149],v17 offset:4104
ds_read_b64_tr_b16 a[150:151],v17 offset:4360
s_waitcnt lgkmcnt(0)
ds_read_b64_tr_b16 a[152:153],v17 offset:6144
ds_read_b64_tr_b16 a[154:155],v17 offset:6400
ds_read_b64_tr_b16 a[156:157],v17 offset:6152
ds_read_b64_tr_b16 a[158:159],v17 offset:6408
ds_read_b64_tr_b16 a[160:161],v17 offset:8192
ds_read_b64_tr_b16 a[162:163],v17 offset:8448
ds_read_b64_tr_b16 a[164:165],v17 offset:8200
ds_read_b64_tr_b16 a[166:167],v17 offset:8456
ds_read_b64_tr_b16 a[168:169],v17 offset:10240
ds_read_b64_tr_b16 a[170:171],v17 offset:10496
ds_read_b64_tr_b16 a[172:173],v17 offset:10248
ds_read_b64_tr_b16 a[174:175],v17 offset:10504
s_waitcnt lgkmcnt(0)
ds_read_b64_tr_b16 a[176:177],v17 offset:12288
ds_read_b64_tr_b16 a[178:179],v17 offset:12544
ds_read_b64_tr_b16 a[180:181],v17 offset:12296
ds_read_b64_tr_b16 a[182:183],v17 offset:12552
ds_read_b64_tr_b16 a[184:185],v17 offset:14336
ds_read_b64_tr_b16 a[186:187],v17 offset:14592
ds_read_b64_tr_b16 a[188:189],v17 offset:14344
ds_read_b64_tr_b16 a[190:191],v17 offset:14600
s_waitcnt lgkmcnt(0)
s_waitcnt vmcnt(0)
ds_read_b64_tr_b16 a[192:193],v17 offset:16384
ds_read_b64_tr_b16 a[194:195],v17 offset:16640
ds_read_b64_tr_b16 a[196:197],v17 offset:16392
ds_read_b64_tr_b16 a[198:199],v17 offset:16648
ds_read_b64_tr_b16 a[200:201],v17 offset:18432
ds_read_b64_tr_b16 a[202:203],v17 offset:18688
ds_read_b64_tr_b16 a[204:205],v17 offset:18440
ds_read_b64_tr_b16 a[206:207],v17 offset:18696
ds_read_b64_tr_b16 a[208:209],v17 offset:20480
ds_read_b64_tr_b16 a[210:211],v17 offset:20736
ds_read_b64_tr_b16 a[212:213],v17 offset:20488
ds_read_b64_tr_b16 a[214:215],v17 offset:20744
s_waitcnt lgkmcnt(0)
ds_read_b64_tr_b16 a[216:217],v17 offset:22528
ds_read_b64_tr_b16 a[218:219],v17 offset:22784
ds_read_b64_tr_b16 a[220:221],v17 offset:22536
ds_read_b64_tr_b16 a[222:223],v17 offset:22792
ds_read_b64_tr_b16 a[224:225],v17 offset:24576
ds_read_b64_tr_b16 a[226:227],v17 offset:24832
ds_read_b64_tr_b16 a[228:229],v17 offset:24584
ds_read_b64_tr_b16 a[230:231],v17 offset:24840
ds_read_b64_tr_b16 a[232:233],v17 offset:26624
ds_read_b64_tr_b16 a[234:235],v17 offset:26880
ds_read_b64_tr_b16 a[236:237],v17 offset:26632
ds_read_b64_tr_b16 a[238:239],v17 offset:26888
s_waitcnt lgkmcnt(0)
ds_read_b64_tr_b16 a[240:241],v17 offset:28672
ds_read_b64_tr_b16 a[242:243],v17 offset:28928
ds_read_b64_tr_b16 a[244:245],v17 offset:28680
ds_read_b64_tr_b16 a[246:247],v17 offset:28936
ds_read_b64_tr_b16 a[248:249],v17 offset:30720
ds_read_b64_tr_b16 a[250:251],v17 offset:30976
ds_read_b64_tr_b16 a[252:253],v17 offset:30728
ds_read_b64_tr_b16 a[254:255],v17 offset:30984
s_waitcnt lgkmcnt(0)
s_mov_b32 s92,s2
s_and_b32 s93,s3,0xffff
s_mov_b32 s94,0x100
s_mov_b32 s95,0x20000
v_mbcnt_lo_u32_b32 v16,-1,0
v_mbcnt_hi_u32_b32 v16,-1,v16
v_mov_b32 v18,0
v_cmp_eq_u32 vcc,22,v16
s_nop 1
v_cndmask_b32 v18,v18,63,vcc
v_cmp_eq_u32 vcc,17,v16
s_nop 1
v_cndmask_b32 v18,v18,63,vcc
v_cmp_eq_u32 vcc,18,v16
s_nop 1
v_cndmask_b32 v18,v18,1,vcc
v_and_b32 v19,1,v16
v_cmp_eq_u32 vcc,1,v19
v_mov_b32 v19,8192
s_nop 0
v_cndmask_b32 v19,-1,v19,vcc
v_min_u32 v16,31,v16
v_lshlrev_b32 v16,2,v16
s_sub_u32 s66,s88,64
s_cmp_lg_u32 s50,0
s_cbranch_scc1 vot_82
vpoll_78:
buffer_load_dword v17,v16,s[92:95],s66 offen sc1
s_waitcnt vmcnt(0)
s_cmp_lg_u32 s56,2
s_cbranch_scc1 vck_79
v_cmp_eq_u32 vcc,v17,v19
s_and_b32 s64,vcc_lo,0xffff
s_cmp_eq_u32 s64,65535
s_cbranch_scc1 vck_79
s_mov_b32 s65,0
v_readlane_b32 s64,v17,1
s_lshr_b32 s64,s64,8
s_add_u32 s65,s65,s64
v_readlane_b32 s64,v17,3
s_lshr_b32 s64,s64,8
s_add_u32 s65,s65,s64
v_readlane_b32 s64,v17,5
s_lshr_b32 s64,s64,8
s_add_u32 s65,s65,s64
v_readlane_b32 s64,v17,7
s_lshr_b32 s64,s64,8
s_add_u32 s65,s65,s64
v_readlane_b32 s64,v17,9
s_lshr_b32 s64,s64,8
s_add_u32 s65,s65,s64
v_readlane_b32 s64,v17,11
s_lshr_b32 s64,s64,8
s_add_u32 s65,s65,s64
v_readlane_b32 s64,v17,13
s_lshr_b32 s64,s64,8
s_add_u32 s65,s65,s64
v_readlane_b32 s64,v17,15
s_lshr_b32 s64,s64,8
s_add_u32 s65,s65,s64
s_cmp_ge_u32 s65,256
s_cbranch_scc1 vok_81
s_branch vrt_80
vck_79:
v_cmp_gt_u32 vcc,v18,v17
s_cbranch_vccz vok_81
vrt_80:
s_sleep 48
s_sub_u32 s90,s90,1
s_cmp_gt_i32 s90,0
s_cbranch_scc1 vpoll_78
vok_81:
v_add_u32 v18,161536,v16
ds_write_b32 v18,v17
s_waitcnt lgkmcnt(0)
vot_82:
s_barrier
v_add_u32 v18,161536,v16
ds_read_b32 v17,v18
s_waitcnt lgkmcnt(0)
s_cmp_lg_u32 s56,2
s_cbranch_scc1 vfin_83
v_cmp_eq_u32 vcc,v17,v19
s_and_b32 s64,vcc_lo,0xffff
s_cmp_eq_u32 s64,65535
s_cbranch_scc1 vfin_83
s_mov_b32 s65,0
v_readlane_b32 s64,v17,1
s_lshr_b32 s64,s64,8
s_add_u32 s65,s65,s64
v_readlane_b32 s64,v17,3
s_lshr_b32 s64,s64,8
s_add_u32 s65,s65,s64
v_readlane_b32 s64,v17,5
s_lshr_b32 s64,s64,8
s_add_u32 s65,s65,s64
v_readlane_b32 s64,v17,7
s_lshr_b32 s64,s64,8
s_add_u32 s65,s65,s64
v_readlane_b32 s64,v17,9
s_lshr_b32 s64,s64,8
s_add_u32 s65,s65,s64
v_readlane_b32 s64,v17,11
s_lshr_b32 s64,s64,8
s_add_u32 s65,s65,s64
v_readlane_b32 s64,v17,13
s_lshr_b32 s64,s64,8
s_add_u32 s65,s65,s64
v_readlane_b32 s64,v17,15
s_lshr_b32 s64,s64,8
s_add_u32 s65,s65,s64
s_cmp_ge_u32 s65,256
s_cbranch_scc1 fl_fb
vfin_83:
s_and_b32 s56,s56,1
s_mov_b32 s67,0
s_barrier
v_lshlrev_b32 v0,4,v1
s_mov_b32 s60,0
s_lshl_b32 s70,s50,13
s_mov_b32 s55,0
v_mov_b32 v3,v0
s_mov_b32 s73,0xffff0000
s_lshl_b32 s64,s52,2
s_add_u32 s64,s64,s50
s_mul_i32 s61,s64,8192
s_add_u32 s61,s61,150994944
s_lshl_b32 s68,s64,8
s_add_u32 s68,s68,138543104
s_lshl_b32 s83,s53,2
s_add_u32 s83,s83,s50
s_mov_b32 s63,0
s_xor_b32 s64,s50,0
s_lshl_b32 s64,s64,13
v_add_u32 v8,s64,v0
v_mov_b32 v4,v8
s_xor_b32 s64,s50,1
s_lshl_b32 s64,s64,13
v_add_u32 v9,s64,v0
v_mov_b32 v5,v9
s_xor_b32 s64,s50,2
s_lshl_b32 s64,s64,13
v_add_u32 v10,s64,v0
v_mov_b32 v6,v10
s_xor_b32 s64,s50,3
s_lshl_b32 s64,s64,13
v_add_u32 v11,s64,v0
v_mov_b32 v7,v11
v_min_u32 v2,11,v1
v_lshlrev_b32 v2,2,v2
s_add_u32 s62,s61,4096
s_lshl_b32 s66,s83,10
s_lshr_b32 s65,s83,3
s_lshl_b32 s65,s65,8
s_and_b32 s64,s83,7
s_lshl_b32 s64,s64,2
s_add_u32 s69,s64,s65
s_add_u32 s69,s69,138547200
s_mov_b32 s82,0
s_lshl_b32 s64,s53,2
s_add_u32 s64,s64,s50
s_mul_i32 s74,s64,24576
s_xor_b32 s64,s50,s52
s_sub_u32 s64,s64,1
s_max_i32 s64,s64,0
s_lshl_b32 s64,s64,11
s_add_u32 s74,s74,s64
s_add_u32 s74,s74,167772160
s_mov_b32 s75,0
s_mov_b32 s77,0
v_lshlrev_b32 v26,11,v21
v_lshl_add_u32 v26,v22,4,v26
s_lshl_b32 s64,s83,6
v_add_u32 v18,s64,v26
v_lshlrev_b32 v26,5,v22
s_lshl_b32 s64,s83,7
s_add_u32 s64,s64,267395072
buffer_load_dwordx4 v[152:155],v26,s[20:23],s64 offen offset:0 sc1
buffer_load_dwordx4 v[156:159],v26,s[20:23],s64 offen offset:16 sc1
s_add_u32 s64,s64,24576
buffer_load_dwordx4 v[128:131],v26,s[20:23],s64 offen offset:0 sc1
buffer_load_dwordx4 v[132:135],v26,s[20:23],s64 offen offset:16 sc1
s_add_u32 s64,s64,24576
buffer_load_dwordx4 v[136:139],v26,s[20:23],s64 offen offset:0 sc1
buffer_load_dwordx4 v[140:143],v26,s[20:23],s64 offen offset:16 sc1
s_add_u32 s64,s64,24576
buffer_load_dwordx4 v[144:147],v26,s[20:23],s64 offen offset:0 sc1
buffer_load_dwordx4 v[148:151],v26,s[20:23],s64 offen offset:16 sc1
s_add_u32 s64,s64,24576
s_waitcnt vmcnt(0)
v_pk_add_f32 v[152:153],v[152:153],v[128:129]
v_pk_add_f32 v[136:137],v[136:137],v[144:145]
v_pk_add_f32 v[154:155],v[154:155],v[130:131]
v_pk_add_f32 v[138:139],v[138:139],v[146:147]
v_pk_add_f32 v[156:157],v[156:157],v[132:133]
v_pk_add_f32 v[140:141],v[140:141],v[148:149]
v_pk_add_f32 v[158:159],v[158:159],v[134:135]
v_pk_add_f32 v[142:143],v[142:143],v[150:151]
v_pk_add_f32 v[152:153],v[152:153],v[136:137]
v_pk_add_f32 v[154:155],v[154:155],v[138:139]
v_pk_add_f32 v[156:157],v[156:157],v[140:141]
v_pk_add_f32 v[158:159],v[158:159],v[142:143]
v_cvt_pk_bf16_f32 v128,v152,v153
v_cvt_pk_bf16_f32 v129,v154,v155
v_cvt_pk_bf16_f32 v130,v156,v157
v_cvt_pk_bf16_f32 v131,v158,v159
v_lshlrev_b32 v152,16,v128
v_and_b32 v153,s73,v128
v_lshlrev_b32 v154,16,v129
v_and_b32 v155,s73,v129
v_lshlrev_b32 v156,16,v130
v_and_b32 v157,s73,v130
v_lshlrev_b32 v158,16,v131
v_and_b32 v159,s73,v131
v_mov_b32 v204,-1
v_mov_b32 v205,-1
v_mov_b32 v206,-1
v_mov_b32 v207,-1
v_cmp_eq_u32 vcc,0,v1
s_nop 1
v_cndmask_b32 v26,2.0,0,vcc
s_cmp_eq_u32 s50,s52
s_cbranch_scc1 lfin_84
s_add_u32 s71,s60,1
s_add_u32 s53,s60,2
plp_94:
buffer_load_dword v16,v2,s[20:23],s68 offen sc1
s_waitcnt vmcnt(0)
v_cmp_gt_u32 vcc,s71,v16
s_cbranch_vccz pok_95
s_sleep 4
s_sub_u32 s90,s90,1
s_cmp_gt_i32 s90,0
s_cbranch_scc1 plp_94
pok_95:
lag_91:
s_mov_b32 m0,s70
s_nop 0
buffer_load_dwordx4 v3,s[20:23],s61 offen offset:0 lds
buffer_load_dwordx4 v3,s[20:23],s61 offen offset:1024 lds
buffer_load_dwordx4 v3,s[20:23],s61 offen offset:2048 lds
buffer_load_dwordx4 v3,s[20:23],s61 offen offset:3072 lds
s_add_u32 m0,s70,4096
s_nop 0
buffer_load_dwordx4 v3,s[20:23],s62 offen offset:0 lds
buffer_load_dwordx4 v3,s[20:23],s62 offen offset:1024 lds
buffer_load_dwordx4 v3,s[20:23],s62 offen offset:2048 lds
buffer_load_dwordx4 v3,s[20:23],s62 offen offset:3072 lds
s_add_u32 s61,s61,131072
s_add_u32 s62,s62,131072
s_add_u32 s70,s70,32768
s_and_b32 s70,s70,0x1ffff
buffer_load_dword v23,off,s[20:23],s66
buffer_load_dword v23,off,s[20:23],s66
dec_92:
v_cmp_gt_u32 vcc,s53,v16
s_cbranch_vccnz BN_90
BR_89:
s_waitcnt vmcnt(9)
ds_read_b128 v[64:67],v4 offset:0
s_waitcnt vmcnt(8)
ds_read_b128 v[68:71],v4 offset:1024
s_waitcnt vmcnt(7)
ds_read_b128 v[72:75],v4 offset:2048
s_waitcnt vmcnt(6)
ds_read_b128 v[76:79],v4 offset:3072
s_waitcnt lgkmcnt(3)
v_mfma_f32_16x16x32_bf16 v[32:35],a[0:3],v[64:67],0
s_add_u32 s71,s60,2
s_add_u32 s53,s60,3
v_mfma_f32_16x16x32_bf16 v[36:39],a[4:7],v[64:67],0
s_waitcnt lgkmcnt(2)
s_waitcnt vmcnt(5)
ds_read_b128 v[80:83],v4 offset:4096
v_mfma_f32_16x16x32_bf16 v[32:35],a[8:11],v[68:71],v[32:35]
v_mfma_f32_16x16x32_bf16 v[36:39],a[12:15],v[68:71],v[36:39]
s_waitcnt lgkmcnt(2)
s_waitcnt vmcnt(4)
s_mov_b32 m0,s70
ds_read_b128 v[84:87],v4 offset:5120
v_mfma_f32_16x16x32_bf16 v[32:35],a[16:19],v[72:75],v[32:35]
buffer_load_dwordx4 v3,s[20:23],s61 offen offset:0 lds
v_mfma_f32_16x16x32_bf16 v[36:39],a[20:23],v[72:75],v[36:39]
s_waitcnt lgkmcnt(2)
s_waitcnt vmcnt(4)
ds_read_b128 v[88:91],v4 offset:6144
v_mfma_f32_16x16x32_bf16 v[32:35],a[24:27],v[76:79],v[32:35]
buffer_load_dwordx4 v3,s[20:23],s61 offen offset:1024 lds
v_mfma_f32_16x16x32_bf16 v[36:39],a[28:31],v[76:79],v[36:39]
s_waitcnt lgkmcnt(2)
s_waitcnt vmcnt(4)
ds_read_b128 v[92:95],v4 offset:7168
v_mfma_f32_16x16x32_bf16 v[32:35],a[32:35],v[80:83],v[32:35]
v_mfma_f32_16x16x32_bf16 v[36:39],a[36:39],v[80:83],v[36:39]
s_waitcnt lgkmcnt(2)
s_barrier
ds_read_b128 v[96:99],v5 offset:0
v_mfma_f32_16x16x32_bf16 v[32:35],a[40:43],v[84:87],v[32:35]
ds_read_b128 v[100:103],v5 offset:1024
buffer_load_dwordx4 v3,s[20:23],s61 offen offset:2048 lds
v_mfma_f32_16x16x32_bf16 v[36:39],a[44:47],v[84:87],v[36:39]
s_waitcnt lgkmcnt(3)
ds_read_b128 v[104:107],v5 offset:2048
v_mfma_f32_16x16x32_bf16 v[32:35],a[48:51],v[88:91],v[32:35]
ds_read_b128 v[108:111],v5 offset:3072
v_mfma_f32_16x16x32_bf16 v[36:39],a[52:55],v[88:91],v[36:39]
s_waitcnt lgkmcnt(4)
ds_read_b128 v[112:115],v5 offset:4096
buffer_load_dwordx4 v3,s[20:23],s61 offen offset:3072 lds
v_mfma_f32_16x16x32_bf16 v[32:35],a[56:59],v[92:95],v[32:35]
ds_read_b128 v[116:119],v5 offset:5120
v_mfma_f32_16x16x32_bf16 v[36:39],a[60:63],v[92:95],v[36:39]
s_waitcnt lgkmcnt(5)
s_add_u32 m0,s70,4096
v_mfma_f32_16x16x32_bf16 v[32:35],a[64:67],v[96:99],v[32:35]
ds_read_b128 v[120:123],v5 offset:6144
buffer_load_dwordx4 v3,s[20:23],s62 offen offset:0 lds
v_mfma_f32_16x16x32_bf16 v[36:39],a[68:71],v[96:99],v[36:39]
s_waitcnt lgkmcnt(5)
v_mfma_f32_16x16x32_bf16 v[32:35],a[72:75],v[100:103],v[32:35]
ds_read_b128 v[124:127],v5 offset:7168
v_mfma_f32_16x16x32_bf16 v[36:39],a[76:79],v[100:103],v[36:39]
s_waitcnt lgkmcnt(5)
buffer_load_dwordx4 v3,s[20:23],s62 offen offset:1024 lds
v_mfma_f32_16x16x32_bf16 v[32:35],a[80:83],v[104:107],v[32:35]
ds_read_b128 v[64:67],v6 offset:0
v_mfma_f32_16x16x32_bf16 v[36:39],a[84:87],v[104:107],v[36:39]
s_waitcnt lgkmcnt(5)
v_mfma_f32_16x16x32_bf16 v[32:35],a[88:91],v[108:111],v[32:35]
ds_read_b128 v[68:71],v6 offset:1024
v_mfma_f32_16x16x32_bf16 v[36:39],a[92:95],v[108:111],v[36:39]
s_waitcnt lgkmcnt(5)
buffer_load_dwordx4 v3,s[20:23],s62 offen offset:2048 lds
v_mfma_f32_16x16x32_bf16 v[32:35],a[96:99],v[112:115],v[32:35]
ds_read_b128 v[72:75],v6 offset:2048
buffer_load_dword v16,v2,s[20:23],s68 offen sc1
v_mfma_f32_16x16x32_bf16 v[36:39],a[100:103],v[112:115],v[36:39]
s_waitcnt lgkmcnt(5)
v_mfma_f32_16x16x32_bf16 v[32:35],a[104:107],v[116:119],v[32:35]
ds_read_b128 v[76:79],v6 offset:3072
buffer_load_dwordx4 v3,s[20:23],s62 offen offset:3072 lds
v_mfma_f32_16x16x32_bf16 v[36:39],a[108:111],v[116:119],v[36:39]
s_waitcnt lgkmcnt(5)
v_mfma_f32_16x16x32_bf16 v[32:35],a[112:115],v[120:123],v[32:35]
ds_read_b128 v[80:83],v6 offset:4096
v_mfma_f32_16x16x32_bf16 v[36:39],a[116:119],v[120:123],v[36:39]
s_waitcnt lgkmcnt(5)
v_mfma_f32_16x16x32_bf16 v[32:35],a[120:123],v[124:127],v[32:35]
ds_read_b128 v[84:87],v6 offset:5120
v_mfma_f32_16x16x32_bf16 v[36:39],a[124:127],v[124:127],v[36:39]
s_waitcnt lgkmcnt(5)
v_mfma_f32_16x16x32_bf16 v[32:35],a[128:131],v[64:67],v[32:35]
ds_read_b128 v[88:91],v6 offset:6144
v_mfma_f32_16x16x32_bf16 v[36:39],a[132:135],v[64:67],v[36:39]
s_waitcnt lgkmcnt(5)
v_mfma_f32_16x16x32_bf16 v[32:35],a[136:139],v[68:71],v[32:35]
ds_read_b128 v[92:95],v6 offset:7168
v_mfma_f32_16x16x32_bf16 v[36:39],a[140:143],v[68:71],v[36:39]
s_waitcnt lgkmcnt(5)
v_mfma_f32_16x16x32_bf16 v[32:35],a[144:147],v[72:75],v[32:35]
ds_read_b128 v[96:99],v7 offset:0
v_mfma_f32_16x16x32_bf16 v[36:39],a[148:151],v[72:75],v[36:39]
s_waitcnt lgkmcnt(5)
v_mfma_f32_16x16x32_bf16 v[32:35],a[152:155],v[76:79],v[32:35]
ds_read_b128 v[100:103],v7 offset:1024
v_mfma_f32_16x16x32_bf16 v[36:39],a[156:159],v[76:79],v[36:39]
s_waitcnt lgkmcnt(5)
v_mfma_f32_16x16x32_bf16 v[32:35],a[160:163],v[80:83],v[32:35]
ds_read_b128 v[104:107],v7 offset:2048
v_mfma_f32_16x16x32_bf16 v[36:39],a[164:167],v[80:83],v[36:39]
s_waitcnt lgkmcnt(5)
v_mfma_f32_16x16x32_bf16 v[32:35],a[168:171],v[84:87],v[32:35]
ds_read_b128 v[108:111],v7 offset:3072
v_mfma_f32_16x16x32_bf16 v[36:39],a[172:175],v[84:87],v[36:39]
s_waitcnt lgkmcnt(5)
v_mfma_f32_16x16x32_bf16 v[32:35],a[176:179],v[88:91],v[32:35]
ds_read_b128 v[112:115],v7 offset:4096
v_mfma_f32_16x16x32_bf16 v[36:39],a[180:183],v[88:91],v[36:39]
s_waitcnt lgkmcnt(5)
v_mfma_f32_16x16x32_bf16 v[32:35],a[184:187],v[92:95],v[32:35]
ds_read_b128 v[116:119],v7 offset:5120
v_mfma_f32_16x16x32_bf16 v[36:39],a[188:191],v[92:95],v[36:39]
s_waitcnt lgkmcnt(5)
v_mfma_f32_16x16x32_bf16 v[32:35],a[192:195],v[96:99],v[32:35]
ds_read_b128 v[120:123],v7 offset:6144
v_mfma_f32_16x16x32_bf16 v[36:39],a[196:199],v[96:99],v[36:39]
s_waitcnt lgkmcnt(5)
v_mfma_f32_16x16x32_bf16 v[32:35],a[200:203],v[100:103],v[32:35]
ds_read_b128 v[124:127],v7 offset:7168
v_mfma_f32_16x16x32_bf16 v[36:39],a[204:207],v[100:103],v[36:39]
s_waitcnt lgkmcnt(5)
s_add_u32 s61,s61,131072
s_add_u32 s62,s62,131072
v_mfma_f32_16x16x32_bf16 v[32:35],a[208:211],v[104:107],v[32:35]
s_add_u32 s70,s70,32768
s_and_b32 s70,s70,0x1ffff
s_add_u32 s55,s55,32768
v_mfma_f32_16x16x32_bf16 v[36:39],a[212:215],v[104:107],v[36:39]
s_waitcnt lgkmcnt(4)
s_and_b32 s55,s55,0x1ffff
v_add_u32 v4,s55,v8
v_mfma_f32_16x16x32_bf16 v[32:35],a[216:219],v[108:111],v[32:35]
v_add_u32 v5,s55,v9
v_add_u32 v6,s55,v10
v_mfma_f32_16x16x32_bf16 v[36:39],a[220:223],v[108:111],v[36:39]
s_waitcnt lgkmcnt(3)
v_add_u32 v7,s55,v11
v_mfma_f32_16x16x32_bf16 v[32:35],a[224:227],v[112:115],v[32:35]
s_waitcnt vmcnt(8)
ds_read_b128 v[64:67],v4 offset:0
v_mfma_f32_16x16x32_bf16 v[36:39],a[228:231],v[112:115],v[36:39]
s_waitcnt lgkmcnt(3)
s_waitcnt vmcnt(7)
ds_read_b128 v[68:71],v4 offset:1024
v_mfma_f32_16x16x32_bf16 v[32:35],a[232:235],v[116:119],v[32:35]
s_waitcnt vmcnt(6)
ds_read_b128 v[72:75],v4 offset:2048
v_mfma_f32_16x16x32_bf16 v[36:39],a[236:239],v[116:119],v[36:39]
s_waitcnt lgkmcnt(4)
v_mfma_f32_16x16x32_bf16 v[32:35],a[240:243],v[120:123],v[32:35]
v_mfma_f32_16x16x32_bf16 v[36:39],a[244:247],v[120:123],v[36:39]
s_waitcnt lgkmcnt(3)
v_mfma_f32_16x16x32_bf16 v[40:43],a[248:251],v[124:127],v[32:35]
v_mfma_f32_16x16x32_bf16 v[44:47],a[252:255],v[124:127],v[36:39]
s_waitcnt vmcnt(1)
v_cmp_gt_u32 vcc,s53,v16
s_add_u32 s60,s60,1
s_cbranch_vccnz WN_88
.p2align 6
WR_87:
s_waitcnt lgkmcnt(2)
v_mfma_f32_16x16x32_bf16 v[32:35],a[0:3],v[64:67],0
s_waitcnt vmcnt(5)
s_add_u32 s71,s60,2
ds_read_b128 v[76:79],v4 offset:3072
v_mfma_f32_16x16x32_bf16 v[36:39],a[4:7],v[64:67],0
s_waitcnt lgkmcnt(2)
s_add_u32 s53,s60,3
v_mfma_f32_16x16x32_bf16 v[32:35],a[8:11],v[68:71],v[32:35]
s_waitcnt vmcnt(4)
s_mov_b32 m0,s70
ds_read_b128 v[80:83],v4 offset:4096
v_mfma_f32_16x16x32_bf16 v[36:39],a[12:15],v[68:71],v[36:39]
s_waitcnt lgkmcnt(2)
buffer_load_dwordx4 v3,s[20:23],s61 offen offset:0 lds
s_add_u32 s64,s74,s75
s_cmp_eq_u32 s56,1
s_cbranch_scc1 b1_96
buffer_store_dwordx4 v[40:43],v0,s[20:23],s64 offen offset:0
buffer_store_dwordx4 v[44:47],v0,s[20:23],s64 offen offset:1024
b2_97:
v_mfma_f32_16x16x32_bf16 v[32:35],a[16:19],v[72:75],v[32:35]
s_waitcnt vmcnt(6)
s_add_u32 s75,s75,6144
ds_read_b128 v[84:87],v4 offset:5120
v_mfma_f32_16x16x32_bf16 v[36:39],a[20:23],v[72:75],v[36:39]
s_waitcnt lgkmcnt(2)
s_cmp_eq_u32 s75,24576
s_cselect_b32 s75,0,s75
v_mfma_f32_16x16x32_bf16 v[32:35],a[24:27],v[76:79],v[32:35]
s_waitcnt vmcnt(5)
ds_read_b128 v[88:91],v4 offset:6144
buffer_load_dwordx4 v3,s[20:23],s61 offen offset:1024 lds
v_mfma_f32_16x16x32_bf16 v[36:39],a[28:31],v[76:79],v[36:39]
s_waitcnt lgkmcnt(2)
v_mfma_f32_16x16x32_bf16 v[32:35],a[32:35],v[80:83],v[32:35]
s_waitcnt vmcnt(4)
ds_read_b128 v[92:95],v4 offset:7168
v_mfma_f32_16x16x32_bf16 v[36:39],a[36:39],v[80:83],v[36:39]
s_waitcnt lgkmcnt(2)
s_barrier
ds_read_b128 v[96:99],v5 offset:0
v_mfma_f32_16x16x32_bf16 v[32:35],a[40:43],v[84:87],v[32:35]
ds_read_b128 v[100:103],v5 offset:1024
buffer_load_dwordx4 v3,s[20:23],s61 offen offset:2048 lds
v_mfma_f32_16x16x32_bf16 v[36:39],a[44:47],v[84:87],v[36:39]
s_waitcnt lgkmcnt(3)
ds_read_b128 v[104:107],v5 offset:2048
v_mfma_f32_16x16x32_bf16 v[32:35],a[48:51],v[88:91],v[32:35]
ds_read_b128 v[108:111],v5 offset:3072
v_mfma_f32_16x16x32_bf16 v[36:39],a[52:55],v[88:91],v[36:39]
s_waitcnt lgkmcnt(4)
ds_read_b128 v[112:115],v5 offset:4096
buffer_load_dwordx4 v3,s[20:23],s61 offen offset:3072 lds
v_mfma_f32_16x16x32_bf16 v[32:35],a[56:59],v[92:95],v[32:35]
ds_read_b128 v[116:119],v5 offset:5120
v_mfma_f32_16x16x32_bf16 v[36:39],a[60:63],v[92:95],v[36:39]
s_waitcnt lgkmcnt(5)
s_add_u32 m0,s70,4096
v_mfma_f32_16x16x32_bf16 v[32:35],a[64:67],v[96:99],v[32:35]
ds_read_b128 v[120:123],v5 offset:6144
buffer_load_dwordx4 v3,s[20:23],s62 offen offset:0 lds
v_mfma_f32_16x16x32_bf16 v[36:39],a[68:71],v[96:99],v[36:39]
s_waitcnt lgkmcnt(5)
v_mfma_f32_16x16x32_bf16 v[32:35],a[72:75],v[100:103],v[32:35]
ds_read_b128 v[124:127],v5 offset:7168
v_mfma_f32_16x16x32_bf16 v[36:39],a[76:79],v[100:103],v[36:39]
s_waitcnt lgkmcnt(5)
buffer_load_dwordx4 v3,s[20:23],s62 offen offset:1024 lds
v_mfma_f32_16x16x32_bf16 v[32:35],a[80:83],v[104:107],v[32:35]
ds_read_b128 v[64:67],v6 offset:0
v_mfma_f32_16x16x32_bf16 v[36:39],a[84:87],v[104:107],v[36:39]
s_waitcnt lgkmcnt(5)
v_mfma_f32_16x16x32_bf16 v[32:35],a[88:91],v[108:111],v[32:35]
ds_read_b128 v[68:71],v6 offset:1024
v_mfma_f32_16x16x32_bf16 v[36:39],a[92:95],v[108:111],v[36:39]
s_waitcnt lgkmcnt(5)
buffer_load_dwordx4 v3,s[20:23],s62 offen offset:2048 lds
v_mfma_f32_16x16x32_bf16 v[32:35],a[96:99],v[112:115],v[32:35]
ds_read_b128 v[72:75],v6 offset:2048
buffer_load_dword v16,v2,s[20:23],s68 offen sc1
v_mfma_f32_16x16x32_bf16 v[36:39],a[100:103],v[112:115],v[36:39]
s_waitcnt lgkmcnt(5)
v_mfma_f32_16x16x32_bf16 v[32:35],a[104:107],v[116:119],v[32:35]
ds_read_b128 v[76:79],v6 offset:3072
buffer_load_dwordx4 v3,s[20:23],s62 offen offset:3072 lds
v_mfma_f32_16x16x32_bf16 v[36:39],a[108:111],v[116:119],v[36:39]
s_waitcnt lgkmcnt(5)
v_mfma_f32_16x16x32_bf16 v[32:35],a[112:115],v[120:123],v[32:35]
ds_read_b128 v[80:83],v6 offset:4096
v_mfma_f32_16x16x32_bf16 v[36:39],a[116:119],v[120:123],v[36:39]
s_waitcnt lgkmcnt(5)
v_mfma_f32_16x16x32_bf16 v[32:35],a[120:123],v[124:127],v[32:35]
ds_read_b128 v[84:87],v6 offset:5120
v_mfma_f32_16x16x32_bf16 v[36:39],a[124:127],v[124:127],v[36:39]
s_waitcnt lgkmcnt(5)
v_mfma_f32_16x16x32_bf16 v[32:35],a[128:131],v[64:67],v[32:35]
ds_read_b128 v[88:91],v6 offset:6144
v_mfma_f32_16x16x32_bf16 v[36:39],a[132:135],v[64:67],v[36:39]
s_waitcnt lgkmcnt(5)
v_mfma_f32_16x16x32_bf16 v[32:35],a[136:139],v[68:71],v[32:35]
ds_read_b128 v[92:95],v6 offset:7168
v_mfma_f32_16x16x32_bf16 v[36:39],a[140:143],v[68:71],v[36:39]
s_waitcnt lgkmcnt(5)
v_mfma_f32_16x16x32_bf16 v[32:35],a[144:147],v[72:75],v[32:35]
ds_read_b128 v[96:99],v7 offset:0
v_mfma_f32_16x16x32_bf16 v[36:39],a[148:151],v[72:75],v[36:39]
s_waitcnt lgkmcnt(5)
v_mfma_f32_16x16x32_bf16 v[32:35],a[152:155],v[76:79],v[32:35]
ds_read_b128 v[100:103],v7 offset:1024
v_mfma_f32_16x16x32_bf16 v[36:39],a[156:159],v[76:79],v[36:39]
s_waitcnt lgkmcnt(5)
v_mfma_f32_16x16x32_bf16 v[32:35],a[160:163],v[80:83],v[32:35]
ds_read_b128 v[104:107],v7 offset:2048
v_mfma_f32_16x16x32_bf16 v[36:39],a[164:167],v[80:83],v[36:39]
s_waitcnt lgkmcnt(5)
v_mfma_f32_16x16x32_bf16 v[32:35],a[168:171],v[84:87],v[32:35]
ds_read_b128 v[108:111],v7 offset:3072
v_mfma_f32_16x16x32_bf16 v[36:39],a[172:175],v[84:87],v[36:39]
s_waitcnt lgkmcnt(5)
v_mfma_f32_16x16x32_bf16 v[32:35],a[176:179],v[88:91],v[32:35]
ds_read_b128 v[112:115],v7 offset:4096
v_mfma_f32_16x16x32_bf16 v[36:39],a[180:183],v[88:91],v[36:39]
s_waitcnt lgkmcnt(5)
v_mfma_f32_16x16x32_bf16 v[32:35],a[184:187],v[92:95],v[32:35]
ds_read_b128 v[116:119],v7 offset:5120
v_mfma_f32_16x16x32_bf16 v[36:39],a[188:191],v[92:95],v[36:39]
s_waitcnt lgkmcnt(5)
v_mfma_f32_16x16x32_bf16 v[32:35],a[192:195],v[96:99],v[32:35]
ds_read_b128 v[120:123],v7 offset:6144
v_mfma_f32_16x16x32_bf16 v[36:39],a[196:199],v[96:99],v[36:39]
s_waitcnt lgkmcnt(5)
v_mfma_f32_16x16x32_bf16 v[32:35],a[200:203],v[100:103],v[32:35]
ds_read_b128 v[124:127],v7 offset:7168
v_mfma_f32_16x16x32_bf16 v[36:39],a[204:207],v[100:103],v[36:39]
s_waitcnt lgkmcnt(5)
s_add_u32 s61,s61,131072
s_add_u32 s62,s62,131072
v_mfma_f32_16x16x32_bf16 v[32:35],a[208:211],v[104:107],v[32:35]
s_add_u32 s70,s70,32768
s_and_b32 s70,s70,0x1ffff
s_add_u32 s55,s55,32768
v_mfma_f32_16x16x32_bf16 v[36:39],a[212:215],v[104:107],v[36:39]
s_waitcnt lgkmcnt(4)
s_and_b32 s55,s55,0x1ffff
v_add_u32 v4,s55,v8
v_mfma_f32_16x16x32_bf16 v[32:35],a[216:219],v[108:111],v[32:35]
v_add_u32 v5,s55,v9
v_add_u32 v6,s55,v10
v_mfma_f32_16x16x32_bf16 v[36:39],a[220:223],v[108:111],v[36:39]
s_waitcnt lgkmcnt(3)
v_add_u32 v7,s55,v11
v_mfma_f32_16x16x32_bf16 v[32:35],a[224:227],v[112:115],v[32:35]
s_waitcnt vmcnt(10)
ds_read_b128 v[64:67],v4 offset:0
v_mfma_f32_16x16x32_bf16 v[36:39],a[228:231],v[112:115],v[36:39]
s_waitcnt lgkmcnt(3)
s_waitcnt vmcnt(7)
ds_read_b128 v[68:71],v4 offset:1024
v_mfma_f32_16x16x32_bf16 v[32:35],a[232:235],v[116:119],v[32:35]
s_waitcnt vmcnt(6)
ds_read_b128 v[72:75],v4 offset:2048
v_mfma_f32_16x16x32_bf16 v[36:39],a[236:239],v[116:119],v[36:39]
s_waitcnt lgkmcnt(4)
v_mfma_f32_16x16x32_bf16 v[32:35],a[240:243],v[120:123],v[32:35]
v_mfma_f32_16x16x32_bf16 v[36:39],a[244:247],v[120:123],v[36:39]
s_waitcnt lgkmcnt(3)
v_mfma_f32_16x16x32_bf16 v[40:43],a[248:251],v[124:127],v[32:35]
v_mfma_f32_16x16x32_bf16 v[44:47],a[252:255],v[124:127],v[36:39]
s_waitcnt vmcnt(1)
v_cmp_gt_u32 vcc,s53,v16
s_add_u32 s60,s60,1
s_cbranch_vccz WR_87
WN_88:
s_waitcnt lgkmcnt(2)
v_mfma_f32_16x16x32_bf16 v[32:35],a[0:3],v[64:67],0
s_waitcnt vmcnt(5)
s_add_u32 s71,s60,2
ds_read_b128 v[76:79],v4 offset:3072
v_mfma_f32_16x16x32_bf16 v[36:39],a[4:7],v[64:67],0
s_waitcnt lgkmcnt(2)
s_add_u32 s53,s60,3
v_mfma_f32_16x16x32_bf16 v[32:35],a[8:11],v[68:71],v[32:35]
s_waitcnt vmcnt(4)
ds_read_b128 v[80:83],v4 offset:4096
v_mfma_f32_16x16x32_bf16 v[36:39],a[12:15],v[68:71],v[36:39]
s_waitcnt lgkmcnt(2)
s_add_u32 s64,s74,s75
s_cmp_eq_u32 s56,1
s_cbranch_scc1 b1_99
buffer_store_dwordx4 v[40:43],v0,s[20:23],s64 offen offset:0
buffer_store_dwordx4 v[44:47],v0,s[20:23],s64 offen offset:1024
b2_100:
v_mfma_f32_16x16x32_bf16 v[32:35],a[16:19],v[72:75],v[32:35]
s_waitcnt vmcnt(5)
s_add_u32 s75,s75,6144
ds_read_b128 v[84:87],v4 offset:5120
v_mfma_f32_16x16x32_bf16 v[36:39],a[20:23],v[72:75],v[36:39]
s_waitcnt lgkmcnt(2)
s_cmp_eq_u32 s75,24576
s_cselect_b32 s75,0,s75
v_mfma_f32_16x16x32_bf16 v[32:35],a[24:27],v[76:79],v[32:35]
s_waitcnt vmcnt(4)
ds_read_b128 v[88:91],v4 offset:6144
v_mfma_f32_16x16x32_bf16 v[36:39],a[28:31],v[76:79],v[36:39]
s_waitcnt lgkmcnt(2)
v_mfma_f32_16x16x32_bf16 v[32:35],a[32:35],v[80:83],v[32:35]
s_waitcnt vmcnt(2)
ds_read_b128 v[92:95],v4 offset:7168
v_mfma_f32_16x16x32_bf16 v[36:39],a[36:39],v[80:83],v[36:39]
s_waitcnt lgkmcnt(2)
s_barrier
ds_read_b128 v[96:99],v5 offset:0
v_mfma_f32_16x16x32_bf16 v[32:35],a[40:43],v[84:87],v[32:35]
ds_read_b128 v[100:103],v5 offset:1024
v_mfma_f32_16x16x32_bf16 v[36:39],a[44:47],v[84:87],v[36:39]
s_waitcnt lgkmcnt(3)
ds_read_b128 v[104:107],v5 offset:2048
v_mfma_f32_16x16x32_bf16 v[32:35],a[48:51],v[88:91],v[32:35]
ds_read_b128 v[108:111],v5 offset:3072
v_mfma_f32_16x16x32_bf16 v[36:39],a[52:55],v[88:91],v[36:39]
s_waitcnt lgkmcnt(4)
ds_read_b128 v[112:115],v5 offset:4096
v_mfma_f32_16x16x32_bf16 v[32:35],a[56:59],v[92:95],v[32:35]
ds_read_b128 v[116:119],v5 offset:5120
v_mfma_f32_16x16x32_bf16 v[36:39],a[60:63],v[92:95],v[36:39]
s_waitcnt lgkmcnt(5)
v_mfma_f32_16x16x32_bf16 v[32:35],a[64:67],v[96:99],v[32:35]
ds_read_b128 v[120:123],v5 offset:6144
v_mfma_f32_16x16x32_bf16 v[36:39],a[68:71],v[96:99],v[36:39]
s_waitcnt lgkmcnt(5)
v_mfma_f32_16x16x32_bf16 v[32:35],a[72:75],v[100:103],v[32:35]
ds_read_b128 v[124:127],v5 offset:7168
v_mfma_f32_16x16x32_bf16 v[36:39],a[76:79],v[100:103],v[36:39]
s_waitcnt lgkmcnt(5)
v_mfma_f32_16x16x32_bf16 v[32:35],a[80:83],v[104:107],v[32:35]
ds_read_b128 v[64:67],v6 offset:0
v_mfma_f32_16x16x32_bf16 v[36:39],a[84:87],v[104:107],v[36:39]
s_waitcnt lgkmcnt(5)
v_mfma_f32_16x16x32_bf16 v[32:35],a[88:91],v[108:111],v[32:35]
ds_read_b128 v[68:71],v6 offset:1024
v_mfma_f32_16x16x32_bf16 v[36:39],a[92:95],v[108:111],v[36:39]
s_waitcnt lgkmcnt(5)
v_mfma_f32_16x16x32_bf16 v[32:35],a[96:99],v[112:115],v[32:35]
ds_read_b128 v[72:75],v6 offset:2048
v_mfma_f32_16x16x32_bf16 v[36:39],a[100:103],v[112:115],v[36:39]
s_waitcnt lgkmcnt(5)
v_mfma_f32_16x16x32_bf16 v[32:35],a[104:107],v[116:119],v[32:35]
ds_read_b128 v[76:79],v6 offset:3072
v_mfma_f32_16x16x32_bf16 v[36:39],a[108:111],v[116:119],v[36:39]
s_waitcnt lgkmcnt(5)
v_mfma_f32_16x16x32_bf16 v[32:35],a[112:115],v[120:123],v[32:35]
ds_read_b128 v[80:83],v6 offset:4096
v_mfma_f32_16x16x32_bf16 v[36:39],a[116:119],v[120:123],v[36:39]
s_waitcnt lgkmcnt(5)
v_mfma_f32_16x16x32_bf16 v[32:35],a[120:123],v[124:127],v[32:35]
ds_read_b128 v[84:87],v6 offset:5120
v_mfma_f32_16x16x32_bf16 v[36:39],a[124:127],v[124:127],v[36:39]
s_waitcnt lgkmcnt(5)
v_mfma_f32_16x16x32_bf16 v[32:35],a[128:131],v[64:67],v[32:35]
ds_read_b128 v[88:91],v6 offset:6144
v_mfma_f32_16x16x32_bf16 v[36:39],a[132:135],v[64:67],v[36:39]
s_waitcnt lgkmcnt(5)
v_mfma_f32_16x16x32_bf16 v[32:35],a[136:139],v[68:71],v[32:35]
ds_read_b128 v[92:95],v6 offset:7168
v_mfma_f32_16x16x32_bf16 v[36:39],a[140:143],v[68:71],v[36:39]
s_waitcnt lgkmcnt(5)
v_mfma_f32_16x16x32_bf16 v[32:35],a[144:147],v[72:75],v[32:35]
ds_read_b128 v[96:99],v7 offset:0
v_mfma_f32_16x16x32_bf16 v[36:39],a[148:151],v[72:75],v[36:39]
s_waitcnt lgkmcnt(5)
v_mfma_f32_16x16x32_bf16 v[32:35],a[152:155],v[76:79],v[32:35]
ds_read_b128 v[100:103],v7 offset:1024
v_mfma_f32_16x16x32_bf16 v[36:39],a[156:159],v[76:79],v[36:39]
s_waitcnt lgkmcnt(5)
v_mfma_f32_16x16x32_bf16 v[32:35],a[160:163],v[80:83],v[32:35]
ds_read_b128 v[104:107],v7 offset:2048
buffer_load_dword v16,v2,s[20:23],s68 offen sc1
v_mfma_f32_16x16x32_bf16 v[36:39],a[164:167],v[80:83],v[36:39]
s_waitcnt lgkmcnt(5)
v_mfma_f32_16x16x32_bf16 v[32:35],a[168:171],v[84:87],v[32:35]
ds_read_b128 v[108:111],v7 offset:3072
v_mfma_f32_16x16x32_bf16 v[36:39],a[172:175],v[84:87],v[36:39]
s_waitcnt lgkmcnt(5)
v_mfma_f32_16x16x32_bf16 v[32:35],a[176:179],v[88:91],v[32:35]
ds_read_b128 v[112:115],v7 offset:4096
v_mfma_f32_16x16x32_bf16 v[36:39],a[180:183],v[88:91],v[36:39]
s_waitcnt lgkmcnt(5)
v_mfma_f32_16x16x32_bf16 v[32:35],a[184:187],v[92:95],v[32:35]
ds_read_b128 v[116:119],v7 offset:5120
v_mfma_f32_16x16x32_bf16 v[36:39],a[188:191],v[92:95],v[36:39]
s_waitcnt lgkmcnt(5)
v_mfma_f32_16x16x32_bf16 v[32:35],a[192:195],v[96:99],v[32:35]
ds_read_b128 v[120:123],v7 offset:6144
v_mfma_f32_16x16x32_bf16 v[36:39],a[196:199],v[96:99],v[36:39]
s_waitcnt lgkmcnt(5)
v_mfma_f32_16x16x32_bf16 v[32:35],a[200:203],v[100:103],v[32:35]
ds_read_b128 v[124:127],v7 offset:7168
v_mfma_f32_16x16x32_bf16 v[36:39],a[204:207],v[100:103],v[36:39]
s_waitcnt lgkmcnt(5)
s_add_u32 s55,s55,32768
s_and_b32 s55,s55,0x1ffff
v_mfma_f32_16x16x32_bf16 v[32:35],a[208:211],v[104:107],v[32:35]
v_add_u32 v4,s55,v8
v_add_u32 v5,s55,v9
v_mfma_f32_16x16x32_bf16 v[36:39],a[212:215],v[104:107],v[36:39]
s_waitcnt lgkmcnt(4)
v_add_u32 v6,s55,v10
v_add_u32 v7,s55,v11
v_mfma_f32_16x16x32_bf16 v[32:35],a[216:219],v[108:111],v[32:35]
v_mfma_f32_16x16x32_bf16 v[36:39],a[220:223],v[108:111],v[36:39]
s_waitcnt lgkmcnt(3)
v_mfma_f32_16x16x32_bf16 v[32:35],a[224:227],v[112:115],v[32:35]
v_mfma_f32_16x16x32_bf16 v[36:39],a[228:231],v[112:115],v[36:39]
s_waitcnt lgkmcnt(2)
v_mfma_f32_16x16x32_bf16 v[32:35],a[232:235],v[116:119],v[32:35]
v_mfma_f32_16x16x32_bf16 v[36:39],a[236:239],v[116:119],v[36:39]
s_waitcnt lgkmcnt(1)
v_mfma_f32_16x16x32_bf16 v[32:35],a[240:243],v[120:123],v[32:35]
v_mfma_f32_16x16x32_bf16 v[36:39],a[244:247],v[120:123],v[36:39]
s_waitcnt lgkmcnt(0)
v_mfma_f32_16x16x32_bf16 v[40:43],a[248:251],v[124:127],v[32:35]
v_mfma_f32_16x16x32_bf16 v[44:47],a[252:255],v[124:127],v[36:39]
s_waitcnt vmcnt(0)
v_cmp_gt_u32 vcc,s71,v16
s_add_u32 s60,s60,1
s_branch endN_98
BN_90:
s_waitcnt vmcnt(9)
ds_read_b128 v[64:67],v4 offset:0
s_waitcnt vmcnt(8)
ds_read_b128 v[68:71],v4 offset:1024
s_waitcnt vmcnt(7)
ds_read_b128 v[72:75],v4 offset:2048
s_waitcnt vmcnt(6)
ds_read_b128 v[76:79],v4 offset:3072
s_waitcnt lgkmcnt(3)
v_mfma_f32_16x16x32_bf16 v[32:35],a[0:3],v[64:67],0
s_add_u32 s71,s60,2
s_add_u32 s53,s60,3
v_mfma_f32_16x16x32_bf16 v[36:39],a[4:7],v[64:67],0
s_waitcnt lgkmcnt(2)
s_waitcnt vmcnt(5)
ds_read_b128 v[80:83],v4 offset:4096
v_mfma_f32_16x16x32_bf16 v[32:35],a[8:11],v[68:71],v[32:35]
v_mfma_f32_16x16x32_bf16 v[36:39],a[12:15],v[68:71],v[36:39]
s_waitcnt lgkmcnt(2)
s_waitcnt vmcnt(4)
ds_read_b128 v[84:87],v4 offset:5120
v_mfma_f32_16x16x32_bf16 v[32:35],a[16:19],v[72:75],v[32:35]
v_mfma_f32_16x16x32_bf16 v[36:39],a[20:23],v[72:75],v[36:39]
s_waitcnt lgkmcnt(2)
s_waitcnt vmcnt(3)
ds_read_b128 v[88:91],v4 offset:6144
v_mfma_f32_16x16x32_bf16 v[32:35],a[24:27],v[76:79],v[32:35]
v_mfma_f32_16x16x32_bf16 v[36:39],a[28:31],v[76:79],v[36:39]
s_waitcnt lgkmcnt(2)
s_waitcnt vmcnt(2)
ds_read_b128 v[92:95],v4 offset:7168
v_mfma_f32_16x16x32_bf16 v[32:35],a[32:35],v[80:83],v[32:35]
v_mfma_f32_16x16x32_bf16 v[36:39],a[36:39],v[80:83],v[36:39]
s_waitcnt lgkmcnt(2)
s_barrier
ds_read_b128 v[96:99],v5 offset:0
v_mfma_f32_16x16x32_bf16 v[32:35],a[40:43],v[84:87],v[32:35]
ds_read_b128 v[100:103],v5 offset:1024
v_mfma_f32_16x16x32_bf16 v[36:39],a[44:47],v[84:87],v[36:39]
s_waitcnt lgkmcnt(3)
ds_read_b128 v[104:107],v5 offset:2048
v_mfma_f32_16x16x32_bf16 v[32:35],a[48:51],v[88:91],v[32:35]
ds_read_b128 v[108:111],v5 offset:3072
v_mfma_f32_16x16x32_bf16 v[36:39],a[52:55],v[88:91],v[36:39]
s_waitcnt lgkmcnt(4)
ds_read_b128 v[112:115],v5 offset:4096
v_mfma_f32_16x16x32_bf16 v[32:35],a[56:59],v[92:95],v[32:35]
ds_read_b128 v[116:119],v5 offset:5120
v_mfma_f32_16x16x32_bf16 v[36:39],a[60:63],v[92:95],v[36:39]
s_waitcnt lgkmcnt(5)
v_mfma_f32_16x16x32_bf16 v[32:35],a[64:67],v[96:99],v[32:35]
ds_read_b128 v[120:123],v5 offset:6144
v_mfma_f32_16x16x32_bf16 v[36:39],a[68:71],v[96:99],v[36:39]
s_waitcnt lgkmcnt(5)
v_mfma_f32_16x16x32_bf16 v[32:35],a[72:75],v[100:103],v[32:35]
ds_read_b128 v[124:127],v5 offset:7168
v_mfma_f32_16x16x32_bf16 v[36:39],a[76:79],v[100:103],v[36:39]
s_waitcnt lgkmcnt(5)
v_mfma_f32_16x16x32_bf16 v[32:35],a[80:83],v[104:107],v[32:35]
ds_read_b128 v[64:67],v6 offset:0
v_mfma_f32_16x16x32_bf16 v[36:39],a[84:87],v[104:107],v[36:39]
s_waitcnt lgkmcnt(5)
v_mfma_f32_16x16x32_bf16 v[32:35],a[88:91],v[108:111],v[32:35]
ds_read_b128 v[68:71],v6 offset:1024
v_mfma_f32_16x16x32_bf16 v[36:39],a[92:95],v[108:111],v[36:39]
s_waitcnt lgkmcnt(5)
v_mfma_f32_16x16x32_bf16 v[32:35],a[96:99],v[112:115],v[32:35]
ds_read_b128 v[72:75],v6 offset:2048
v_mfma_f32_16x16x32_bf16 v[36:39],a[100:103],v[112:115],v[36:39]
s_waitcnt lgkmcnt(5)
v_mfma_f32_16x16x32_bf16 v[32:35],a[104:107],v[116:119],v[32:35]
ds_read_b128 v[76:79],v6 offset:3072
v_mfma_f32_16x16x32_bf16 v[36:39],a[108:111],v[116:119],v[36:39]
s_waitcnt lgkmcnt(5)
v_mfma_f32_16x16x32_bf16 v[32:35],a[112:115],v[120:123],v[32:35]
ds_read_b128 v[80:83],v6 offset:4096
v_mfma_f32_16x16x32_bf16 v[36:39],a[116:119],v[120:123],v[36:39]
s_waitcnt lgkmcnt(5)
v_mfma_f32_16x16x32_bf16 v[32:35],a[120:123],v[124:127],v[32:35]
ds_read_b128 v[84:87],v6 offset:5120
v_mfma_f32_16x16x32_bf16 v[36:39],a[124:127],v[124:127],v[36:39]
s_waitcnt lgkmcnt(5)
v_mfma_f32_16x16x32_bf16 v[32:35],a[128:131],v[64:67],v[32:35]
ds_read_b128 v[88:91],v6 offset:6144
v_mfma_f32_16x16x32_bf16 v[36:39],a[132:135],v[64:67],v[36:39]
s_waitcnt lgkmcnt(5)
v_mfma_f32_16x16x32_bf16 v[32:35],a[136:139],v[68:71],v[32:35]
ds_read_b128 v[92:95],v6 offset:7168
v_mfma_f32_16x16x32_bf16 v[36:39],a[140:143],v[68:71],v[36:39]
s_waitcnt lgkmcnt(5)
v_mfma_f32_16x16x32_bf16 v[32:35],a[144:147],v[72:75],v[32:35]
ds_read_b128 v[96:99],v7 offset:0
v_mfma_f32_16x16x32_bf16 v[36:39],a[148:151],v[72:75],v[36:39]
s_waitcnt lgkmcnt(5)
v_mfma_f32_16x16x32_bf16 v[32:35],a[152:155],v[76:79],v[32:35]
ds_read_b128 v[100:103],v7 offset:1024
v_mfma_f32_16x16x32_bf16 v[36:39],a[156:159],v[76:79],v[36:39]
s_waitcnt lgkmcnt(5)
v_mfma_f32_16x16x32_bf16 v[32:35],a[160:163],v[80:83],v[32:35]
ds_read_b128 v[104:107],v7 offset:2048
buffer_load_dword v16,v2,s[20:23],s68 offen sc1
v_mfma_f32_16x16x32_bf16 v[36:39],a[164:167],v[80:83],v[36:39]
s_waitcnt lgkmcnt(5)
v_mfma_f32_16x16x32_bf16 v[32:35],a[168:171],v[84:87],v[32:35]
ds_read_b128 v[108:111],v7 offset:3072
v_mfma_f32_16x16x32_bf16 v[36:39],a[172:175],v[84:87],v[36:39]
s_waitcnt lgkmcnt(5)
v_mfma_f32_16x16x32_bf16 v[32:35],a[176:179],v[88:91],v[32:35]
ds_read_b128 v[112:115],v7 offset:4096
v_mfma_f32_16x16x32_bf16 v[36:39],a[180:183],v[88:91],v[36:39]
s_waitcnt lgkmcnt(5)
v_mfma_f32_16x16x32_bf16 v[32:35],a[184:187],v[92:95],v[32:35]
ds_read_b128 v[116:119],v7 offset:5120
v_mfma_f32_16x16x32_bf16 v[36:39],a[188:191],v[92:95],v[36:39]
s_waitcnt lgkmcnt(5)
v_mfma_f32_16x16x32_bf16 v[32:35],a[192:195],v[96:99],v[32:35]
ds_read_b128 v[120:123],v7 offset:6144
v_mfma_f32_16x16x32_bf16 v[36:39],a[196:199],v[96:99],v[36:39]
s_waitcnt lgkmcnt(5)
v_mfma_f32_16x16x32_bf16 v[32:35],a[200:203],v[100:103],v[32:35]
ds_read_b128 v[124:127],v7 offset:7168
v_mfma_f32_16x16x32_bf16 v[36:39],a[204:207],v[100:103],v[36:39]
s_waitcnt lgkmcnt(5)
s_add_u32 s55,s55,32768
s_and_b32 s55,s55,0x1ffff
v_mfma_f32_16x16x32_bf16 v[32:35],a[208:211],v[104:107],v[32:35]
v_add_u32 v4,s55,v8
v_add_u32 v5,s55,v9
v_mfma_f32_16x16x32_bf16 v[36:39],a[212:215],v[104:107],v[36:39]
s_waitcnt lgkmcnt(4)
v_add_u32 v6,s55,v10
v_add_u32 v7,s55,v11
v_mfma_f32_16x16x32_bf16 v[32:35],a[216:219],v[108:111],v[32:35]
v_mfma_f32_16x16x32_bf16 v[36:39],a[220:223],v[108:111],v[36:39]
s_waitcnt lgkmcnt(3)
v_mfma_f32_16x16x32_bf16 v[32:35],a[224:227],v[112:115],v[32:35]
v_mfma_f32_16x16x32_bf16 v[36:39],a[228:231],v[112:115],v[36:39]
s_waitcnt lgkmcnt(2)
v_mfma_f32_16x16x32_bf16 v[32:35],a[232:235],v[116:119],v[32:35]
v_mfma_f32_16x16x32_bf16 v[36:39],a[236:239],v[116:119],v[36:39]
s_waitcnt lgkmcnt(1)
v_mfma_f32_16x16x32_bf16 v[32:35],a[240:243],v[120:123],v[32:35]
v_mfma_f32_16x16x32_bf16 v[36:39],a[244:247],v[120:123],v[36:39]
s_waitcnt lgkmcnt(0)
v_mfma_f32_16x16x32_bf16 v[40:43],a[248:251],v[124:127],v[32:35]
v_mfma_f32_16x16x32_bf16 v[44:47],a[252:255],v[124:127],v[36:39]
s_waitcnt vmcnt(0)
v_cmp_gt_u32 vcc,s71,v16
s_add_u32 s60,s60,1
endN_98:
s_cbranch_vccnz nb_93
s_mov_b32 m0,s70
s_nop 0
buffer_load_dwordx4 v3,s[20:23],s61 offen offset:0 lds
buffer_load_dwordx4 v3,s[20:23],s61 offen offset:1024 lds
buffer_load_dwordx4 v3,s[20:23],s61 offen offset:2048 lds
buffer_load_dwordx4 v3,s[20:23],s61 offen offset:3072 lds
s_add_u32 m0,s70,4096
s_nop 0
buffer_load_dwordx4 v3,s[20:23],s62 offen offset:0 lds
buffer_load_dwordx4 v3,s[20:23],s62 offen offset:1024 lds
buffer_load_dwordx4 v3,s[20:23],s62 offen offset:2048 lds
buffer_load_dwordx4 v3,s[20:23],s62 offen offset:3072 lds
s_add_u32 s61,s61,131072
s_add_u32 s62,s62,131072
s_add_u32 s70,s70,32768
s_and_b32 s70,s70,0x1ffff
s_add_u32 s64,s74,s75
s_cmp_eq_u32 s56,1
s_cbranch_scc1 b1_101
buffer_store_dwordx4 v[40:43],v0,s[20:23],s64 offen offset:0
buffer_store_dwordx4 v[44:47],v0,s[20:23],s64 offen offset:1024
b2_102:
s_add_u32 s75,s75,6144
s_cmp_eq_u32 s75,24576
s_cselect_b32 s75,0,s75
s_branch dec_92
nb_93:
buffer_load_dword v16,v2,s[20:23],s68 offen sc1
s_nop 3
s_add_u32 s64,s74,s75
s_cmp_eq_u32 s56,1
s_cbranch_scc1 b1_103
buffer_store_dwordx4 v[40:43],v0,s[20:23],s64 offen offset:0
buffer_store_dwordx4 v[44:47],v0,s[20:23],s64 offen offset:1024
b2_104:
s_add_u32 s75,s75,6144
s_cmp_eq_u32 s75,24576
s_cselect_b32 s75,0,s75
s_waitcnt vmcnt(2)
v_cmp_gt_u32 vcc,s71,v16
s_cbranch_vccz lag_91
s_cmp_ge_u32 s60,128
s_cbranch_scc1 done_77
plp_107:
buffer_load_dword v16,v2,s[20:23],s68 offen sc1
s_waitcnt vmcnt(0)
v_cmp_gt_u32 vcc,s71,v16
s_cbranch_vccz pok_108
s_sleep 4
s_sub_u32 s90,s90,1
s_cmp_gt_i32 s90,0
s_cbranch_scc1 plp_107
pok_108:
s_branch lag_91
lfin_84:
s_add_u32 s71,s60,1
s_add_u32 s53,s60,2
plp_128:
buffer_load_dword v16,v2,s[20:23],s68 offen sc1
s_waitcnt vmcnt(0)
v_cmp_gt_u32 vcc,s71,v16
s_cbranch_vccz pok_129
s_sleep 4
s_sub_u32 s90,s90,1
s_cmp_gt_i32 s90,0
s_cbranch_scc1 plp_128
pok_129:
lag_125:
s_mov_b32 m0,s70
s_nop 0
buffer_load_dwordx4 v3,s[20:23],s61 offen offset:0 lds
buffer_load_dwordx4 v3,s[20:23],s61 offen offset:1024 lds
buffer_load_dwordx4 v3,s[20:23],s61 offen offset:2048 lds
buffer_load_dwordx4 v3,s[20:23],s61 offen offset:3072 lds
s_add_u32 m0,s70,4096
s_nop 0
buffer_load_dwordx4 v3,s[20:23],s62 offen offset:0 lds
buffer_load_dwordx4 v3,s[20:23],s62 offen offset:1024 lds
buffer_load_dwordx4 v3,s[20:23],s62 offen offset:2048 lds
buffer_load_dwordx4 v3,s[20:23],s62 offen offset:3072 lds
s_add_u32 s61,s61,131072
s_add_u32 s62,s62,131072
s_add_u32 s70,s70,32768
s_and_b32 s70,s70,0x1ffff
dec_126:
v_cmp_gt_u32 vcc,s53,v16
s_cbranch_vccnz BN_124
BR_123:
s_waitcnt vmcnt(7)
ds_read_b128 v[64:67],v4 offset:0
s_waitcnt vmcnt(6)
ds_read_b128 v[68:71],v4 offset:1024
s_waitcnt vmcnt(5)
ds_read_b128 v[72:75],v4 offset:2048
s_waitcnt vmcnt(4)
ds_read_b128 v[76:79],v4 offset:3072
s_waitcnt lgkmcnt(3)
v_mfma_f32_16x16x32_bf16 v[32:35],a[0:3],v[64:67],0
s_add_u32 s71,s60,2
s_add_u32 s53,s60,3
v_mfma_f32_16x16x32_bf16 v[36:39],a[4:7],v[64:67],0
s_waitcnt lgkmcnt(2)
s_waitcnt vmcnt(3)
ds_read_b128 v[80:83],v4 offset:4096
v_mfma_f32_16x16x32_bf16 v[32:35],a[8:11],v[68:71],v[32:35]
v_mfma_f32_16x16x32_bf16 v[36:39],a[12:15],v[68:71],v[36:39]
s_waitcnt lgkmcnt(2)
s_waitcnt vmcnt(2)
s_mov_b32 m0,s70
ds_read_b128 v[84:87],v4 offset:5120
v_mfma_f32_16x16x32_bf16 v[32:35],a[16:19],v[72:75],v[32:35]
buffer_load_dwordx4 v3,s[20:23],s61 offen offset:0 lds
v_mfma_f32_16x16x32_bf16 v[36:39],a[20:23],v[72:75],v[36:39]
s_waitcnt lgkmcnt(2)
s_waitcnt vmcnt(2)
ds_read_b128 v[88:91],v4 offset:6144
v_mfma_f32_16x16x32_bf16 v[32:35],a[24:27],v[76:79],v[32:35]
buffer_load_dwordx4 v3,s[20:23],s61 offen offset:1024 lds
v_mfma_f32_16x16x32_bf16 v[36:39],a[28:31],v[76:79],v[36:39]
s_waitcnt lgkmcnt(2)
s_waitcnt vmcnt(2)
ds_read_b128 v[92:95],v4 offset:7168
v_mfma_f32_16x16x32_bf16 v[32:35],a[32:35],v[80:83],v[32:35]
v_mfma_f32_16x16x32_bf16 v[36:39],a[36:39],v[80:83],v[36:39]
s_waitcnt lgkmcnt(2)
s_barrier
ds_read_b128 v[96:99],v5 offset:0
v_mfma_f32_16x16x32_bf16 v[32:35],a[40:43],v[84:87],v[32:35]
ds_read_b128 v[100:103],v5 offset:1024
buffer_load_dwordx4 v3,s[20:23],s61 offen offset:2048 lds
v_mfma_f32_16x16x32_bf16 v[36:39],a[44:47],v[84:87],v[36:39]
s_waitcnt lgkmcnt(3)
ds_read_b128 v[104:107],v5 offset:2048
v_mfma_f32_16x16x32_bf16 v[32:35],a[48:51],v[88:91],v[32:35]
ds_read_b128 v[108:111],v5 offset:3072
v_mfma_f32_16x16x32_bf16 v[36:39],a[52:55],v[88:91],v[36:39]
s_waitcnt lgkmcnt(4)
ds_read_b128 v[112:115],v5 offset:4096
buffer_load_dwordx4 v3,s[20:23],s61 offen offset:3072 lds
v_mfma_f32_16x16x32_bf16 v[32:35],a[56:59],v[92:95],v[32:35]
s_cmp_eq_u32 s77,0
s_cselect_b32 s57,2.0,0
ds_read_b128 v[116:119],v5 offset:5120
v_mfma_f32_16x16x32_bf16 v[36:39],a[60:63],v[92:95],v[36:39]
s_waitcnt lgkmcnt(5)
s_add_u32 m0,s70,4096
v_or_b32 v21,s57,v0
v_mfma_f32_16x16x32_bf16 v[32:35],a[64:67],v[96:99],v[32:35]
ds_read_b128 v[120:123],v5 offset:6144
buffer_load_dwordx4 v3,s[20:23],s62 offen offset:0 lds
v_mfma_f32_16x16x32_bf16 v[36:39],a[68:71],v[96:99],v[36:39]
s_waitcnt lgkmcnt(5)
v_lshlrev_b32 v168,16,v160
v_and_b32 v169,s73,v160
v_mfma_f32_16x16x32_bf16 v[32:35],a[72:75],v[100:103],v[32:35]
ds_read_b128 v[124:127],v5 offset:7168
v_lshlrev_b32 v170,16,v161
v_mfma_f32_16x16x32_bf16 v[36:39],a[76:79],v[100:103],v[36:39]
s_waitcnt lgkmcnt(5)
buffer_load_dwordx4 v3,s[20:23],s62 offen offset:1024 lds
v_and_b32 v171,s73,v161
v_mfma_f32_16x16x32_bf16 v[32:35],a[80:83],v[104:107],v[32:35]
ds_read_b128 v[64:67],v6 offset:0
v_lshlrev_b32 v172,16,v162
v_mfma_f32_16x16x32_bf16 v[36:39],a[84:87],v[104:107],v[36:39]
s_waitcnt lgkmcnt(5)
v_and_b32 v173,s73,v162
v_lshlrev_b32 v174,16,v163
v_mfma_f32_16x16x32_bf16 v[32:35],a[88:91],v[108:111],v[32:35]
ds_read_b128 v[68:71],v6 offset:1024
v_and_b32 v175,s73,v163
v_mfma_f32_16x16x32_bf16 v[36:39],a[92:95],v[108:111],v[36:39]
s_waitcnt lgkmcnt(5)
buffer_load_dwordx4 v3,s[20:23],s62 offen offset:2048 lds
v_fma_f32 v168,v212,v152,v168
v_mfma_f32_16x16x32_bf16 v[32:35],a[96:99],v[112:115],v[32:35]
ds_read_b128 v[72:75],v6 offset:2048
buffer_load_dword v16,v2,s[20:23],s68 offen sc1
v_mfma_f32_16x16x32_bf16 v[36:39],a[100:103],v[112:115],v[36:39]
s_waitcnt lgkmcnt(5)
v_fma_f32 v169,v213,v153,v169
v_fma_f32 v170,v214,v154,v170
v_mfma_f32_16x16x32_bf16 v[32:35],a[104:107],v[116:119],v[32:35]
ds_read_b128 v[76:79],v6 offset:3072
buffer_load_dwordx4 v3,s[20:23],s62 offen offset:3072 lds
v_mfma_f32_16x16x32_bf16 v[36:39],a[108:111],v[116:119],v[36:39]
s_waitcnt lgkmcnt(5)
v_fma_f32 v171,v215,v155,v171
v_fma_f32 v172,v216,v156,v172
v_mfma_f32_16x16x32_bf16 v[32:35],a[112:115],v[120:123],v[32:35]
s_add_u32 s84,s74,s75
s_add_u32 s85,s84,4096
ds_read_b128 v[80:83],v6 offset:4096
v_mfma_f32_16x16x32_bf16 v[36:39],a[116:119],v[120:123],v[36:39]
s_waitcnt lgkmcnt(5)
buffer_load_dwordx4 v[128:131],v0,s[20:23],s84 offen offset:0 sc1
v_fma_f32 v173,v217,v157,v173
v_mfma_f32_16x16x32_bf16 v[32:35],a[120:123],v[124:127],v[32:35]
ds_read_b128 v[84:87],v6 offset:5120
v_fma_f32 v174,v218,v158,v174
v_mfma_f32_16x16x32_bf16 v[36:39],a[124:127],v[124:127],v[36:39]
s_waitcnt lgkmcnt(5)
buffer_load_dwordx4 v[132:135],v0,s[20:23],s84 offen offset:1024 sc1
v_fma_f32 v175,v219,v159,v175
v_mfma_f32_16x16x32_bf16 v[32:35],a[128:131],v[64:67],v[32:35]
ds_read_b128 v[88:91],v6 offset:6144
buffer_load_dwordx4 v[160:163],v18,s[24:27],s82 offen
v_mfma_f32_16x16x32_bf16 v[36:39],a[132:135],v[64:67],v[36:39]
s_waitcnt lgkmcnt(5)
s_add_u32 s82,s82,32768
buffer_load_dwordx4 v[136:139],v0,s[20:23],s84 offen offset:2048 sc1
v_mfma_f32_16x16x32_bf16 v[32:35],a[136:139],v[68:71],v[32:35]
ds_read_b128 v[92:95],v6 offset:7168
v_mfma_f32_16x16x32_bf16 v[36:39],a[140:143],v[68:71],v[36:39]
s_waitcnt lgkmcnt(5)
buffer_load_dwordx4 v[140:143],v0,s[20:23],s84 offen offset:3072 sc1
v_mfma_f32_16x16x32_bf16 v[32:35],a[144:147],v[72:75],v[32:35]
ds_read_b128 v[96:99],v7 offset:0
v_mfma_f32_16x16x32_bf16 v[36:39],a[148:151],v[72:75],v[36:39]
s_waitcnt lgkmcnt(5)
buffer_load_dwordx4 v[144:147],v0,s[20:23],s85 offen offset:0 sc1
v_mfma_f32_16x16x32_bf16 v[32:35],a[152:155],v[76:79],v[32:35]
ds_read_b128 v[100:103],v7 offset:1024
v_mfma_f32_16x16x32_bf16 v[36:39],a[156:159],v[76:79],v[36:39]
s_waitcnt lgkmcnt(5)
buffer_load_dwordx4 v[148:151],v0,s[20:23],s85 offen offset:1024 sc1
v_mfma_f32_16x16x32_bf16 v[32:35],a[160:163],v[80:83],v[32:35]
ds_read_b128 v[104:107],v7 offset:2048
v_mfma_f32_16x16x32_bf16 v[36:39],a[164:167],v[80:83],v[36:39]
s_waitcnt lgkmcnt(5)
v_mfma_f32_16x16x32_bf16 v[32:35],a[168:171],v[84:87],v[32:35]
ds_read_b128 v[108:111],v7 offset:3072
v_mfma_f32_16x16x32_bf16 v[36:39],a[172:175],v[84:87],v[36:39]
s_waitcnt lgkmcnt(5)
v_mfma_f32_16x16x32_bf16 v[32:35],a[176:179],v[88:91],v[32:35]
ds_read_b128 v[112:115],v7 offset:4096
v_mfma_f32_16x16x32_bf16 v[36:39],a[180:183],v[88:91],v[36:39]
s_waitcnt lgkmcnt(5)
v_mfma_f32_16x16x32_bf16 v[32:35],a[184:187],v[92:95],v[32:35]
ds_read_b128 v[116:119],v7 offset:5120
v_mfma_f32_16x16x32_bf16 v[36:39],a[188:191],v[92:95],v[36:39]
s_waitcnt lgkmcnt(5)
v_mfma_f32_16x16x32_bf16 v[32:35],a[192:195],v[96:99],v[32:35]
ds_read_b128 v[120:123],v7 offset:6144
v_mfma_f32_16x16x32_bf16 v[36:39],a[196:199],v[96:99],v[36:39]
s_waitcnt lgkmcnt(5)
v_mfma_f32_16x16x32_bf16 v[32:35],a[200:203],v[100:103],v[32:35]
ds_read_b128 v[124:127],v7 offset:7168
v_mfma_f32_16x16x32_bf16 v[36:39],a[204:207],v[100:103],v[36:39]
s_waitcnt lgkmcnt(5)
s_add_u32 s61,s61,131072
s_add_u32 s62,s62,131072
v_mfma_f32_16x16x32_bf16 v[32:35],a[208:211],v[104:107],v[32:35]
s_add_u32 s70,s70,32768
s_and_b32 s70,s70,0x1ffff
s_add_u32 s55,s55,32768
v_mfma_f32_16x16x32_bf16 v[36:39],a[212:215],v[104:107],v[36:39]
s_waitcnt lgkmcnt(4)
s_and_b32 s55,s55,0x1ffff
v_add_u32 v4,s55,v8
v_mfma_f32_16x16x32_bf16 v[32:35],a[216:219],v[108:111],v[32:35]
v_add_u32 v5,s55,v9
v_add_u32 v6,s55,v10
v_mfma_f32_16x16x32_bf16 v[36:39],a[220:223],v[108:111],v[36:39]
s_waitcnt lgkmcnt(3)
v_add_u32 v7,s55,v11
v_mfma_f32_16x16x32_bf16 v[32:35],a[224:227],v[112:115],v[32:35]
s_waitcnt vmcnt(15)
ds_read_b128 v[64:67],v4 offset:0
v_mfma_f32_16x16x32_bf16 v[36:39],a[228:231],v[112:115],v[36:39]
s_waitcnt lgkmcnt(3)
s_waitcnt vmcnt(14)
ds_read_b128 v[68:71],v4 offset:1024
v_mfma_f32_16x16x32_bf16 v[32:35],a[232:235],v[116:119],v[32:35]
s_waitcnt vmcnt(0)
s_cmp_eq_u32 s77,0
s_cbranch_scc1 go_138
ck_136:
v_max3_u32 v184,v128,v129,v130
v_max3_u32 v185,v140,v141,v142
v_max3_u32 v184,v184,v131,v132
v_max3_u32 v185,v185,v143,v144
v_max3_u32 v184,v184,v133,v134
v_max3_u32 v185,v185,v145,v146
v_max3_u32 v184,v184,v135,v136
v_max3_u32 v185,v185,v147,v148
v_max3_u32 v184,v184,v137,v138
v_max3_u32 v185,v185,v149,v150
v_max3_u32 v184,v184,v139,v151
v_max_u32 v184,v184,v185
v_cmp_eq_u32 vcc,-1,v184
s_cbranch_vccnz rt_137
go_138:
v_mfma_f32_16x16x32_bf16 v[36:39],a[236:239],v[116:119],v[36:39]
s_waitcnt lgkmcnt(3)
ds_read_b128 v[72:75],v4 offset:2048
v_add_f32 v128,v128,v136
v_mfma_f32_16x16x32_bf16 v[32:35],a[240:243],v[120:123],v[32:35]
v_add_f32 v129,v129,v137
v_add_f32 v130,v130,v138
v_add_f32 v131,v131,v139
v_mfma_f32_16x16x32_bf16 v[36:39],a[244:247],v[120:123],v[36:39]
s_waitcnt lgkmcnt(3)
v_add_f32 v132,v132,v140
v_add_f32 v133,v133,v141
v_add_f32 v134,v134,v142
v_mfma_f32_16x16x32_bf16 v[40:43],a[248:251],v[124:127],v[32:35]
v_add_f32 v135,v135,v143
v_add_f32 v128,v128,v144
v_add_f32 v129,v129,v145
v_mfma_f32_16x16x32_bf16 v[44:47],a[252:255],v[124:127],v[36:39]
v_add_f32 v130,v130,v146
v_add_f32 v131,v131,v147
v_add_f32 v132,v132,v148
v_add_f32 v133,v133,v149
v_add_f32 v134,v134,v150
v_add_f32 v135,v135,v151
v_fma_f32 v168,v128,v152,v168
v_fma_f32 v169,v129,v153,v169
v_fma_f32 v170,v130,v154,v170
v_fma_f32 v171,v131,v155,v171
v_fma_f32 v172,v132,v156,v172
v_fma_f32 v173,v133,v157,v173
v_fma_f32 v174,v134,v158,v174
v_fma_f32 v175,v135,v159,v175
v_cvt_pk_bf16_f32 v176,v168,v169
v_cvt_pk_bf16_f32 v177,v170,v171
v_cvt_pk_bf16_f32 v178,v172,v173
v_cvt_pk_bf16_f32 v179,v174,v175
s_add_u32 s64,s66,201326592
buffer_store_dwordx4 v[176:179],v21,s[20:23],s64 offen sc1
s_add_u32 s79,s66,201392128
s_cmp_ge_u32 s63,126
s_cselect_b32 s79,138641408,s79
buffer_store_dwordx4 v[204:207],v21,s[20:23],s79 offen sc1
s_cmp_eq_u32 s56,1
s_cbranch_scc1 b1_130
buffer_store_dwordx4 v[204:207],v21,s[20:23],s84 offen offset:0
buffer_store_dwordx4 v[204:207],v21,s[20:23],s84 offen offset:1024
b2_131:
s_cmp_eq_u32 s56,1
s_cbranch_scc1 b1_132
buffer_store_dwordx4 v[204:207],v21,s[20:23],s84 offen offset:2048
buffer_store_dwordx4 v[204:207],v21,s[20:23],s84 offen offset:3072
b2_133:
s_cmp_eq_u32 s56,1
s_cbranch_scc1 b1_134
buffer_store_dwordx4 v[204:207],v21,s[20:23],s85 offen offset:0
buffer_store_dwordx4 v[204:207],v21,s[20:23],s85 offen offset:1024
b2_135:
s_mul_i32 s64,s77,32768
s_add_u32 s66,s66,s64
s_mul_i32 s64,s77,6144
s_add_u32 s75,s75,s64
s_cmp_eq_u32 s75,24576
s_cselect_b32 s75,0,s75
s_add_u32 s63,s63,s77
s_mov_b32 s77,0
v_cmp_gt_u32 vcc,s53,v16
s_add_u32 s60,s60,1
s_cbranch_vccnz WN_122
.p2align 6
WR_121:
s_waitcnt lgkmcnt(2)
v_mfma_f32_16x16x32_bf16 v[32:35],a[0:3],v[64:67],0
s_waitcnt vmcnt(20)
s_add_u32 s71,s60,2
ds_read_b128 v[76:79],v4 offset:3072
v_mfma_f32_16x16x32_bf16 v[36:39],a[4:7],v[64:67],0
s_waitcnt lgkmcnt(2)
s_add_u32 s53,s60,3
v_mfma_f32_16x16x32_bf16 v[32:35],a[8:11],v[68:71],v[32:35]
s_waitcnt vmcnt(19)
s_mov_b32 m0,s70
ds_read_b128 v[80:83],v4 offset:4096
v_mfma_f32_16x16x32_bf16 v[36:39],a[12:15],v[68:71],v[36:39]
s_waitcnt lgkmcnt(2)
buffer_load_dwordx4 v3,s[20:23],s61 offen offset:0 lds
v_mov_b32 v212,v40
v_mfma_f32_16x16x32_bf16 v[32:35],a[16:19],v[72:75],v[32:35]
s_waitcnt vmcnt(19)
ds_read_b128 v[84:87],v4 offset:5120
v_mov_b32 v213,v41
v_mfma_f32_16x16x32_bf16 v[36:39],a[20:23],v[72:75],v[36:39]
s_waitcnt lgkmcnt(2)
v_mov_b32 v214,v42
v_mov_b32 v215,v43
v_mfma_f32_16x16x32_bf16 v[32:35],a[24:27],v[76:79],v[32:35]
s_waitcnt vmcnt(18)
ds_read_b128 v[88:91],v4 offset:6144
buffer_load_dwordx4 v3,s[20:23],s61 offen offset:1024 lds
v_mfma_f32_16x16x32_bf16 v[36:39],a[28:31],v[76:79],v[36:39]
s_waitcnt lgkmcnt(2)
v_mov_b32 v216,v44
v_mov_b32 v217,v45
v_mfma_f32_16x16x32_bf16 v[32:35],a[32:35],v[80:83],v[32:35]
s_waitcnt vmcnt(17)
ds_read_b128 v[92:95],v4 offset:7168
v_mov_b32 v218,v46
v_mfma_f32_16x16x32_bf16 v[36:39],a[36:39],v[80:83],v[36:39]
s_waitcnt lgkmcnt(2)
s_barrier
ds_read_b128 v[96:99],v5 offset:0
v_mfma_f32_16x16x32_bf16 v[32:35],a[40:43],v[84:87],v[32:35]
ds_read_b128 v[100:103],v5 offset:1024
buffer_load_dwordx4 v3,s[20:23],s61 offen offset:2048 lds
v_mfma_f32_16x16x32_bf16 v[36:39],a[44:47],v[84:87],v[36:39]
s_waitcnt lgkmcnt(3)
ds_read_b128 v[104:107],v5 offset:2048
v_mov_b32 v219,v47
v_mfma_f32_16x16x32_bf16 v[32:35],a[48:51],v[88:91],v[32:35]
s_mov_b32 s77,1
ds_read_b128 v[108:111],v5 offset:3072
v_mfma_f32_16x16x32_bf16 v[36:39],a[52:55],v[88:91],v[36:39]
s_waitcnt lgkmcnt(4)
ds_read_b128 v[112:115],v5 offset:4096
buffer_load_dwordx4 v3,s[20:23],s61 offen offset:3072 lds
v_mfma_f32_16x16x32_bf16 v[32:35],a[56:59],v[92:95],v[32:35]
s_waitcnt vmcnt(16)
s_cmp_eq_u32 s77,0
s_cselect_b32 s57,2.0,0
ds_read_b128 v[116:119],v5 offset:5120
v_mfma_f32_16x16x32_bf16 v[36:39],a[60:63],v[92:95],v[36:39]
s_waitcnt lgkmcnt(5)
s_add_u32 m0,s70,4096
v_or_b32 v21,s57,v0
v_mfma_f32_16x16x32_bf16 v[32:35],a[64:67],v[96:99],v[32:35]
ds_read_b128 v[120:123],v5 offset:6144
buffer_load_dwordx4 v3,s[20:23],s62 offen offset:0 lds
v_mfma_f32_16x16x32_bf16 v[36:39],a[68:71],v[96:99],v[36:39]
s_waitcnt lgkmcnt(5)
v_lshlrev_b32 v168,16,v160
v_and_b32 v169,s73,v160
v_mfma_f32_16x16x32_bf16 v[32:35],a[72:75],v[100:103],v[32:35]
ds_read_b128 v[124:127],v5 offset:7168
v_lshlrev_b32 v170,16,v161
v_mfma_f32_16x16x32_bf16 v[36:39],a[76:79],v[100:103],v[36:39]
s_waitcnt lgkmcnt(5)
buffer_load_dwordx4 v3,s[20:23],s62 offen offset:1024 lds
v_and_b32 v171,s73,v161
v_mfma_f32_16x16x32_bf16 v[32:35],a[80:83],v[104:107],v[32:35]
ds_read_b128 v[64:67],v6 offset:0
v_lshlrev_b32 v172,16,v162
v_mfma_f32_16x16x32_bf16 v[36:39],a[84:87],v[104:107],v[36:39]
s_waitcnt lgkmcnt(5)
v_and_b32 v173,s73,v162
v_lshlrev_b32 v174,16,v163
v_mfma_f32_16x16x32_bf16 v[32:35],a[88:91],v[108:111],v[32:35]
ds_read_b128 v[68:71],v6 offset:1024
v_and_b32 v175,s73,v163
v_mfma_f32_16x16x32_bf16 v[36:39],a[92:95],v[108:111],v[36:39]
s_waitcnt lgkmcnt(5)
buffer_load_dwordx4 v3,s[20:23],s62 offen offset:2048 lds
v_fma_f32 v168,v212,v152,v168
v_mfma_f32_16x16x32_bf16 v[32:35],a[96:99],v[112:115],v[32:35]
ds_read_b128 v[72:75],v6 offset:2048
buffer_load_dword v16,v2,s[20:23],s68 offen sc1
v_mfma_f32_16x16x32_bf16 v[36:39],a[100:103],v[112:115],v[36:39]
s_waitcnt lgkmcnt(5)
v_fma_f32 v169,v213,v153,v169
v_fma_f32 v170,v214,v154,v170
v_mfma_f32_16x16x32_bf16 v[32:35],a[104:107],v[116:119],v[32:35]
ds_read_b128 v[76:79],v6 offset:3072
buffer_load_dwordx4 v3,s[20:23],s62 offen offset:3072 lds
v_mfma_f32_16x16x32_bf16 v[36:39],a[108:111],v[116:119],v[36:39]
s_waitcnt lgkmcnt(5)
v_fma_f32 v171,v215,v155,v171
v_fma_f32 v172,v216,v156,v172
v_mfma_f32_16x16x32_bf16 v[32:35],a[112:115],v[120:123],v[32:35]
s_add_u32 s84,s74,s75
s_add_u32 s85,s84,4096
ds_read_b128 v[80:83],v6 offset:4096
v_mfma_f32_16x16x32_bf16 v[36:39],a[116:119],v[120:123],v[36:39]
s_waitcnt lgkmcnt(5)
buffer_load_dwordx4 v[128:131],v0,s[20:23],s84 offen offset:0 sc1
v_fma_f32 v173,v217,v157,v173
v_mfma_f32_16x16x32_bf16 v[32:35],a[120:123],v[124:127],v[32:35]
ds_read_b128 v[84:87],v6 offset:5120
v_fma_f32 v174,v218,v158,v174
v_mfma_f32_16x16x32_bf16 v[36:39],a[124:127],v[124:127],v[36:39]
s_waitcnt lgkmcnt(5)
buffer_load_dwordx4 v[132:135],v0,s[20:23],s84 offen offset:1024 sc1
v_fma_f32 v175,v219,v159,v175
v_mfma_f32_16x16x32_bf16 v[32:35],a[128:131],v[64:67],v[32:35]
ds_read_b128 v[88:91],v6 offset:6144
buffer_load_dwordx4 v[160:163],v18,s[24:27],s82 offen
v_mfma_f32_16x16x32_bf16 v[36:39],a[132:135],v[64:67],v[36:39]
s_waitcnt lgkmcnt(5)
s_add_u32 s82,s82,32768
buffer_load_dwordx4 v[136:139],v0,s[20:23],s84 offen offset:2048 sc1
v_mfma_f32_16x16x32_bf16 v[32:35],a[136:139],v[68:71],v[32:35]
ds_read_b128 v[92:95],v6 offset:7168
v_mfma_f32_16x16x32_bf16 v[36:39],a[140:143],v[68:71],v[36:39]
s_waitcnt lgkmcnt(5)
buffer_load_dwordx4 v[140:143],v0,s[20:23],s84 offen offset:3072 sc1
v_mfma_f32_16x16x32_bf16 v[32:35],a[144:147],v[72:75],v[32:35]
ds_read_b128 v[96:99],v7 offset:0
v_mfma_f32_16x16x32_bf16 v[36:39],a[148:151],v[72:75],v[36:39]
s_waitcnt lgkmcnt(5)
buffer_load_dwordx4 v[144:147],v0,s[20:23],s85 offen offset:0 sc1
v_mfma_f32_16x16x32_bf16 v[32:35],a[152:155],v[76:79],v[32:35]
ds_read_b128 v[100:103],v7 offset:1024
v_mfma_f32_16x16x32_bf16 v[36:39],a[156:159],v[76:79],v[36:39]
s_waitcnt lgkmcnt(5)
buffer_load_dwordx4 v[148:151],v0,s[20:23],s85 offen offset:1024 sc1
v_mfma_f32_16x16x32_bf16 v[32:35],a[160:163],v[80:83],v[32:35]
ds_read_b128 v[104:107],v7 offset:2048
v_mfma_f32_16x16x32_bf16 v[36:39],a[164:167],v[80:83],v[36:39]
s_waitcnt lgkmcnt(5)
v_mfma_f32_16x16x32_bf16 v[32:35],a[168:171],v[84:87],v[32:35]
ds_read_b128 v[108:111],v7 offset:3072
v_mfma_f32_16x16x32_bf16 v[36:39],a[172:175],v[84:87],v[36:39]
s_waitcnt lgkmcnt(5)
v_mfma_f32_16x16x32_bf16 v[32:35],a[176:179],v[88:91],v[32:35]
ds_read_b128 v[112:115],v7 offset:4096
v_mfma_f32_16x16x32_bf16 v[36:39],a[180:183],v[88:91],v[36:39]
s_waitcnt lgkmcnt(5)
v_mfma_f32_16x16x32_bf16 v[32:35],a[184:187],v[92:95],v[32:35]
ds_read_b128 v[116:119],v7 offset:5120
v_mfma_f32_16x16x32_bf16 v[36:39],a[188:191],v[92:95],v[36:39]
s_waitcnt lgkmcnt(5)
v_mfma_f32_16x16x32_bf16 v[32:35],a[192:195],v[96:99],v[32:35]
ds_read_b128 v[120:123],v7 offset:6144
v_mfma_f32_16x16x32_bf16 v[36:39],a[196:199],v[96:99],v[36:39]
s_waitcnt lgkmcnt(5)
v_mfma_f32_16x16x32_bf16 v[32:35],a[200:203],v[100:103],v[32:35]
ds_read_b128 v[124:127],v7 offset:7168
v_mfma_f32_16x16x32_bf16 v[36:39],a[204:207],v[100:103],v[36:39]
s_waitcnt lgkmcnt(5)
s_add_u32 s61,s61,131072
s_add_u32 s62,s62,131072
v_mfma_f32_16x16x32_bf16 v[32:35],a[208:211],v[104:107],v[32:35]
s_add_u32 s70,s70,32768
s_and_b32 s70,s70,0x1ffff
s_add_u32 s55,s55,32768
v_mfma_f32_16x16x32_bf16 v[36:39],a[212:215],v[104:107],v[36:39]
s_waitcnt lgkmcnt(4)
s_and_b32 s55,s55,0x1ffff
v_add_u32 v4,s55,v8
v_mfma_f32_16x16x32_bf16 v[32:35],a[216:219],v[108:111],v[32:35]
v_add_u32 v5,s55,v9
v_add_u32 v6,s55,v10
v_mfma_f32_16x16x32_bf16 v[36:39],a[220:223],v[108:111],v[36:39]
s_waitcnt lgkmcnt(3)
v_add_u32 v7,s55,v11
v_mfma_f32_16x16x32_bf16 v[32:35],a[224:227],v[112:115],v[32:35]
s_waitcnt vmcnt(15)
ds_read_b128 v[64:67],v4 offset:0
v_mfma_f32_16x16x32_bf16 v[36:39],a[228:231],v[112:115],v[36:39]
s_waitcnt lgkmcnt(3)
s_waitcnt vmcnt(14)
ds_read_b128 v[68:71],v4 offset:1024
v_mfma_f32_16x16x32_bf16 v[32:35],a[232:235],v[116:119],v[32:35]
s_waitcnt vmcnt(0)
s_cmp_eq_u32 s77,0
s_cbranch_scc1 go_147
ck_145:
v_max3_u32 v184,v128,v129,v130
v_max3_u32 v185,v140,v141,v142
v_max3_u32 v184,v184,v131,v132
v_max3_u32 v185,v185,v143,v144
v_max3_u32 v184,v184,v133,v134
v_max3_u32 v185,v185,v145,v146
v_max3_u32 v184,v184,v135,v136
v_max3_u32 v185,v185,v147,v148
v_max3_u32 v184,v184,v137,v138
v_max3_u32 v185,v185,v149,v150
v_max3_u32 v184,v184,v139,v151
v_max_u32 v184,v184,v185
v_cmp_eq_u32 vcc,-1,v184
s_cbranch_vccnz rt_146
go_147:
v_mfma_f32_16x16x32_bf16 v[36:39],a[236:239],v[116:119],v[36:39]
s_waitcnt lgkmcnt(3)
ds_read_b128 v[72:75],v4 offset:2048
v_add_f32 v128,v128,v136
v_mfma_f32_16x16x32_bf16 v[32:35],a[240:243],v[120:123],v[32:35]
v_add_f32 v129,v129,v137
v_add_f32 v130,v130,v138
v_add_f32 v131,v131,v139
v_mfma_f32_16x16x32_bf16 v[36:39],a[244:247],v[120:123],v[36:39]
s_waitcnt lgkmcnt(3)
v_add_f32 v132,v132,v140
v_add_f32 v133,v133,v141
v_add_f32 v134,v134,v142
v_mfma_f32_16x16x32_bf16 v[40:43],a[248:251],v[124:127],v[32:35]
v_add_f32 v135,v135,v143
v_add_f32 v128,v128,v144
v_add_f32 v129,v129,v145
v_mfma_f32_16x16x32_bf16 v[44:47],a[252:255],v[124:127],v[36:39]
v_add_f32 v130,v130,v146
v_add_f32 v131,v131,v147
v_add_f32 v132,v132,v148
v_add_f32 v133,v133,v149
v_add_f32 v134,v134,v150
v_add_f32 v135,v135,v151
v_fma_f32 v168,v128,v152,v168
v_fma_f32 v169,v129,v153,v169
v_fma_f32 v170,v130,v154,v170
v_fma_f32 v171,v131,v155,v171
v_fma_f32 v172,v132,v156,v172
v_fma_f32 v173,v133,v157,v173
v_fma_f32 v174,v134,v158,v174
v_fma_f32 v175,v135,v159,v175
v_cvt_pk_bf16_f32 v176,v168,v169
v_cvt_pk_bf16_f32 v177,v170,v171
v_cvt_pk_bf16_f32 v178,v172,v173
v_cvt_pk_bf16_f32 v179,v174,v175
s_add_u32 s64,s66,201326592
buffer_store_dwordx4 v[176:179],v21,s[20:23],s64 offen sc1
s_add_u32 s79,s66,201392128
s_cmp_ge_u32 s63,126
s_cselect_b32 s79,138641408,s79
buffer_store_dwordx4 v[204:207],v21,s[20:23],s79 offen sc1
s_cmp_eq_u32 s56,1
s_cbranch_scc1 b1_139
buffer_store_dwordx4 v[204:207],v21,s[20:23],s84 offen offset:0
buffer_store_dwordx4 v[204:207],v21,s[20:23],s84 offen offset:1024
b2_140:
s_cmp_eq_u32 s56,1
s_cbranch_scc1 b1_141
buffer_store_dwordx4 v[204:207],v21,s[20:23],s84 offen offset:2048
buffer_store_dwordx4 v[204:207],v21,s[20:23],s84 offen offset:3072
b2_142:
s_cmp_eq_u32 s56,1
s_cbranch_scc1 b1_143
buffer_store_dwordx4 v[204:207],v21,s[20:23],s85 offen offset:0
buffer_store_dwordx4 v[204:207],v21,s[20:23],s85 offen offset:1024
b2_144:
s_mul_i32 s64,s77,32768
s_add_u32 s66,s66,s64
s_mul_i32 s64,s77,6144
s_add_u32 s75,s75,s64
s_cmp_eq_u32 s75,24576
s_cselect_b32 s75,0,s75
s_add_u32 s63,s63,s77
s_mov_b32 s77,0
v_cmp_gt_u32 vcc,s53,v16
s_add_u32 s60,s60,1
s_cbranch_vccz WR_121
WN_122:
s_waitcnt lgkmcnt(2)
v_mfma_f32_16x16x32_bf16 v[32:35],a[0:3],v[64:67],0
s_waitcnt vmcnt(20)
s_add_u32 s71,s60,2
ds_read_b128 v[76:79],v4 offset:3072
v_mfma_f32_16x16x32_bf16 v[36:39],a[4:7],v[64:67],0
s_waitcnt lgkmcnt(2)
s_add_u32 s53,s60,3
v_mfma_f32_16x16x32_bf16 v[32:35],a[8:11],v[68:71],v[32:35]
s_waitcnt vmcnt(19)
ds_read_b128 v[80:83],v4 offset:4096
v_mov_b32 v212,v40
v_mfma_f32_16x16x32_bf16 v[36:39],a[12:15],v[68:71],v[36:39]
s_waitcnt lgkmcnt(2)
v_mov_b32 v213,v41
v_mov_b32 v214,v42
v_mfma_f32_16x16x32_bf16 v[32:35],a[16:19],v[72:75],v[32:35]
s_waitcnt vmcnt(18)
ds_read_b128 v[84:87],v4 offset:5120
v_mov_b32 v215,v43
v_mfma_f32_16x16x32_bf16 v[36:39],a[20:23],v[72:75],v[36:39]
s_waitcnt lgkmcnt(2)
v_mov_b32 v216,v44
v_mov_b32 v217,v45
v_mfma_f32_16x16x32_bf16 v[32:35],a[24:27],v[76:79],v[32:35]
s_waitcnt vmcnt(17)
ds_read_b128 v[88:91],v4 offset:6144
v_mov_b32 v218,v46
v_mfma_f32_16x16x32_bf16 v[36:39],a[28:31],v[76:79],v[36:39]
s_waitcnt lgkmcnt(2)
v_mov_b32 v219,v47
v_mfma_f32_16x16x32_bf16 v[32:35],a[32:35],v[80:83],v[32:35]
s_waitcnt vmcnt(15)
s_mov_b32 s77,1
ds_read_b128 v[92:95],v4 offset:7168
v_mfma_f32_16x16x32_bf16 v[36:39],a[36:39],v[80:83],v[36:39]
s_waitcnt lgkmcnt(2)
s_barrier
ds_read_b128 v[96:99],v5 offset:0
v_mfma_f32_16x16x32_bf16 v[32:35],a[40:43],v[84:87],v[32:35]
ds_read_b128 v[100:103],v5 offset:1024
v_mfma_f32_16x16x32_bf16 v[36:39],a[44:47],v[84:87],v[36:39]
s_waitcnt lgkmcnt(3)
ds_read_b128 v[104:107],v5 offset:2048
v_mfma_f32_16x16x32_bf16 v[32:35],a[48:51],v[88:91],v[32:35]
ds_read_b128 v[108:111],v5 offset:3072
v_mfma_f32_16x16x32_bf16 v[36:39],a[52:55],v[88:91],v[36:39]
s_waitcnt lgkmcnt(4)
ds_read_b128 v[112:115],v5 offset:4096
v_mfma_f32_16x16x32_bf16 v[32:35],a[56:59],v[92:95],v[32:35]
s_waitcnt vmcnt(12)
s_cmp_eq_u32 s77,0
s_cselect_b32 s57,2.0,0
ds_read_b128 v[116:119],v5 offset:5120
v_mfma_f32_16x16x32_bf16 v[36:39],a[60:63],v[92:95],v[36:39]
s_waitcnt lgkmcnt(5)
v_or_b32 v21,s57,v0
v_lshlrev_b32 v168,16,v160
v_mfma_f32_16x16x32_bf16 v[32:35],a[64:67],v[96:99],v[32:35]
ds_read_b128 v[120:123],v5 offset:6144
v_and_b32 v169,s73,v160
v_mfma_f32_16x16x32_bf16 v[36:39],a[68:71],v[96:99],v[36:39]
s_waitcnt lgkmcnt(5)
v_lshlrev_b32 v170,16,v161
v_and_b32 v171,s73,v161
v_mfma_f32_16x16x32_bf16 v[32:35],a[72:75],v[100:103],v[32:35]
ds_read_b128 v[124:127],v5 offset:7168
v_lshlrev_b32 v172,16,v162
v_mfma_f32_16x16x32_bf16 v[36:39],a[76:79],v[100:103],v[36:39]
s_waitcnt lgkmcnt(5)
v_and_b32 v173,s73,v162
v_lshlrev_b32 v174,16,v163
v_mfma_f32_16x16x32_bf16 v[32:35],a[80:83],v[104:107],v[32:35]
ds_read_b128 v[64:67],v6 offset:0
v_and_b32 v175,s73,v163
v_mfma_f32_16x16x32_bf16 v[36:39],a[84:87],v[104:107],v[36:39]
s_waitcnt lgkmcnt(5)
v_fma_f32 v168,v212,v152,v168
v_fma_f32 v169,v213,v153,v169
v_mfma_f32_16x16x32_bf16 v[32:35],a[88:91],v[108:111],v[32:35]
ds_read_b128 v[68:71],v6 offset:1024
v_fma_f32 v170,v214,v154,v170
v_mfma_f32_16x16x32_bf16 v[36:39],a[92:95],v[108:111],v[36:39]
s_waitcnt lgkmcnt(5)
v_fma_f32 v171,v215,v155,v171
v_fma_f32 v172,v216,v156,v172
v_mfma_f32_16x16x32_bf16 v[32:35],a[96:99],v[112:115],v[32:35]
ds_read_b128 v[72:75],v6 offset:2048
v_fma_f32 v173,v217,v157,v173
v_mfma_f32_16x16x32_bf16 v[36:39],a[100:103],v[112:115],v[36:39]
s_waitcnt lgkmcnt(5)
v_fma_f32 v174,v218,v158,v174
v_fma_f32 v175,v219,v159,v175
v_mfma_f32_16x16x32_bf16 v[32:35],a[104:107],v[116:119],v[32:35]
ds_read_b128 v[76:79],v6 offset:3072
v_mfma_f32_16x16x32_bf16 v[36:39],a[108:111],v[116:119],v[36:39]
s_waitcnt lgkmcnt(5)
buffer_load_dwordx4 v[160:163],v18,s[24:27],s82 offen
v_mfma_f32_16x16x32_bf16 v[32:35],a[112:115],v[120:123],v[32:35]
s_add_u32 s84,s74,s75
s_add_u32 s85,s84,4096
ds_read_b128 v[80:83],v6 offset:4096
v_mfma_f32_16x16x32_bf16 v[36:39],a[116:119],v[120:123],v[36:39]
s_waitcnt lgkmcnt(5)
s_add_u32 s82,s82,32768
buffer_load_dwordx4 v[128:131],v0,s[20:23],s84 offen offset:0 sc1
v_mfma_f32_16x16x32_bf16 v[32:35],a[120:123],v[124:127],v[32:35]
ds_read_b128 v[84:87],v6 offset:5120
v_mfma_f32_16x16x32_bf16 v[36:39],a[124:127],v[124:127],v[36:39]
s_waitcnt lgkmcnt(5)
buffer_load_dwordx4 v[132:135],v0,s[20:23],s84 offen offset:1024 sc1
v_mfma_f32_16x16x32_bf16 v[32:35],a[128:131],v[64:67],v[32:35]
ds_read_b128 v[88:91],v6 offset:6144
v_mfma_f32_16x16x32_bf16 v[36:39],a[132:135],v[64:67],v[36:39]
s_waitcnt lgkmcnt(5)
buffer_load_dwordx4 v[136:139],v0,s[20:23],s84 offen offset:2048 sc1
v_mfma_f32_16x16x32_bf16 v[32:35],a[136:139],v[68:71],v[32:35]
ds_read_b128 v[92:95],v6 offset:7168
v_mfma_f32_16x16x32_bf16 v[36:39],a[140:143],v[68:71],v[36:39]
s_waitcnt lgkmcnt(5)
buffer_load_dwordx4 v[140:143],v0,s[20:23],s84 offen offset:3072 sc1
v_mfma_f32_16x16x32_bf16 v[32:35],a[144:147],v[72:75],v[32:35]
ds_read_b128 v[96:99],v7 offset:0
v_mfma_f32_16x16x32_bf16 v[36:39],a[148:151],v[72:75],v[36:39]
s_waitcnt lgkmcnt(5)
buffer_load_dwordx4 v[144:147],v0,s[20:23],s85 offen offset:0 sc1
v_mfma_f32_16x16x32_bf16 v[32:35],a[152:155],v[76:79],v[32:35]
ds_read_b128 v[100:103],v7 offset:1024
v_mfma_f32_16x16x32_bf16 v[36:39],a[156:159],v[76:79],v[36:39]
s_waitcnt lgkmcnt(5)
buffer_load_dwordx4 v[148:151],v0,s[20:23],s85 offen offset:1024 sc1
v_mfma_f32_16x16x32_bf16 v[32:35],a[160:163],v[80:83],v[32:35]
ds_read_b128 v[104:107],v7 offset:2048
buffer_load_dword v16,v2,s[20:23],s68 offen sc1
v_mfma_f32_16x16x32_bf16 v[36:39],a[164:167],v[80:83],v[36:39]
s_waitcnt lgkmcnt(5)
v_mfma_f32_16x16x32_bf16 v[32:35],a[168:171],v[84:87],v[32:35]
ds_read_b128 v[108:111],v7 offset:3072
v_mfma_f32_16x16x32_bf16 v[36:39],a[172:175],v[84:87],v[36:39]
s_waitcnt lgkmcnt(5)
v_mfma_f32_16x16x32_bf16 v[32:35],a[176:179],v[88:91],v[32:35]
ds_read_b128 v[112:115],v7 offset:4096
v_mfma_f32_16x16x32_bf16 v[36:39],a[180:183],v[88:91],v[36:39]
s_waitcnt lgkmcnt(5)
v_mfma_f32_16x16x32_bf16 v[32:35],a[184:187],v[92:95],v[32:35]
ds_read_b128 v[116:119],v7 offset:5120
v_mfma_f32_16x16x32_bf16 v[36:39],a[188:191],v[92:95],v[36:39]
s_waitcnt lgkmcnt(5)
v_mfma_f32_16x16x32_bf16 v[32:35],a[192:195],v[96:99],v[32:35]
ds_read_b128 v[120:123],v7 offset:6144
v_mfma_f32_16x16x32_bf16 v[36:39],a[196:199],v[96:99],v[36:39]
s_waitcnt lgkmcnt(5)
v_mfma_f32_16x16x32_bf16 v[32:35],a[200:203],v[100:103],v[32:35]
s_waitcnt vmcnt(1)
ds_read_b128 v[124:127],v7 offset:7168
s_cmp_eq_u32 s77,0
s_cbranch_scc1 go_157
ck_155:
v_max3_u32 v184,v128,v129,v130
v_max3_u32 v185,v140,v141,v142
v_max3_u32 v184,v184,v131,v132
v_max3_u32 v185,v185,v143,v144
v_max3_u32 v184,v184,v133,v134
v_max3_u32 v185,v185,v145,v146
v_max3_u32 v184,v184,v135,v136
v_max3_u32 v185,v185,v147,v148
v_max3_u32 v184,v184,v137,v138
v_max3_u32 v185,v185,v149,v150
v_max3_u32 v184,v184,v139,v151
v_max_u32 v184,v184,v185
v_cmp_eq_u32 vcc,-1,v184
s_cbranch_vccnz rt_156
go_157:
v_mfma_f32_16x16x32_bf16 v[36:39],a[204:207],v[100:103],v[36:39]
s_waitcnt lgkmcnt(5)
s_add_u32 s55,s55,32768
s_and_b32 s55,s55,0x1ffff
v_add_f32 v128,v128,v136
v_mfma_f32_16x16x32_bf16 v[32:35],a[208:211],v[104:107],v[32:35]
v_add_u32 v4,s55,v8
v_add_u32 v5,s55,v9
v_add_f32 v129,v129,v137
v_mfma_f32_16x16x32_bf16 v[36:39],a[212:215],v[104:107],v[36:39]
s_waitcnt lgkmcnt(4)
v_add_u32 v6,s55,v10
v_add_u32 v7,s55,v11
v_add_f32 v130,v130,v138
v_mfma_f32_16x16x32_bf16 v[32:35],a[216:219],v[108:111],v[32:35]
v_add_f32 v131,v131,v139
v_add_f32 v132,v132,v140
v_add_f32 v133,v133,v141
v_mfma_f32_16x16x32_bf16 v[36:39],a[220:223],v[108:111],v[36:39]
s_waitcnt lgkmcnt(3)
v_add_f32 v134,v134,v142
v_add_f32 v135,v135,v143
v_add_f32 v128,v128,v144
v_mfma_f32_16x16x32_bf16 v[32:35],a[224:227],v[112:115],v[32:35]
v_add_f32 v129,v129,v145
v_add_f32 v130,v130,v146
v_add_f32 v131,v131,v147
v_mfma_f32_16x16x32_bf16 v[36:39],a[228:231],v[112:115],v[36:39]
s_waitcnt lgkmcnt(2)
v_add_f32 v132,v132,v148
v_add_f32 v133,v133,v149
v_add_f32 v134,v134,v150
v_mfma_f32_16x16x32_bf16 v[32:35],a[232:235],v[116:119],v[32:35]
v_add_f32 v135,v135,v151
v_fma_f32 v168,v128,v152,v168
v_fma_f32 v169,v129,v153,v169
v_mfma_f32_16x16x32_bf16 v[36:39],a[236:239],v[116:119],v[36:39]
s_waitcnt lgkmcnt(1)
v_fma_f32 v170,v130,v154,v170
v_fma_f32 v171,v131,v155,v171
v_fma_f32 v172,v132,v156,v172
v_mfma_f32_16x16x32_bf16 v[32:35],a[240:243],v[120:123],v[32:35]
v_fma_f32 v173,v133,v157,v173
v_fma_f32 v174,v134,v158,v174
v_fma_f32 v175,v135,v159,v175
v_mfma_f32_16x16x32_bf16 v[36:39],a[244:247],v[120:123],v[36:39]
s_waitcnt lgkmcnt(0)
v_cvt_pk_bf16_f32 v176,v168,v169
v_cvt_pk_bf16_f32 v177,v170,v171
v_cvt_pk_bf16_f32 v178,v172,v173
v_mfma_f32_16x16x32_bf16 v[40:43],a[248:251],v[124:127],v[32:35]
v_cvt_pk_bf16_f32 v179,v174,v175
v_mfma_f32_16x16x32_bf16 v[44:47],a[252:255],v[124:127],v[36:39]
s_waitcnt vmcnt(0)
s_add_u32 s64,s66,201326592
buffer_store_dwordx4 v[176:179],v21,s[20:23],s64 offen sc1
s_add_u32 s79,s66,201392128
s_cmp_ge_u32 s63,126
s_cselect_b32 s79,138641408,s79
buffer_store_dwordx4 v[204:207],v21,s[20:23],s79 offen sc1
s_cmp_eq_u32 s56,1
s_cbranch_scc1 b1_149
buffer_store_dwordx4 v[204:207],v21,s[20:23],s84 offen offset:0
buffer_store_dwordx4 v[204:207],v21,s[20:23],s84 offen offset:1024
b2_150:
s_cmp_eq_u32 s56,1
s_cbranch_scc1 b1_151
buffer_store_dwordx4 v[204:207],v21,s[20:23],s84 offen offset:2048
buffer_store_dwordx4 v[204:207],v21,s[20:23],s84 offen offset:3072
b2_152:
s_cmp_eq_u32 s56,1
s_cbranch_scc1 b1_153
buffer_store_dwordx4 v[204:207],v21,s[20:23],s85 offen offset:0
buffer_store_dwordx4 v[204:207],v21,s[20:23],s85 offen offset:1024
b2_154:
s_mul_i32 s64,s77,32768
s_add_u32 s66,s66,s64
s_mul_i32 s64,s77,6144
s_add_u32 s75,s75,s64
s_cmp_eq_u32 s75,24576
s_cselect_b32 s75,0,s75
s_add_u32 s63,s63,s77
s_mov_b32 s77,0
v_cmp_gt_u32 vcc,s71,v16
s_add_u32 s60,s60,1
s_branch endN_148
BN_124:
s_waitcnt vmcnt(7)
ds_read_b128 v[64:67],v4 offset:0
s_waitcnt vmcnt(6)
ds_read_b128 v[68:71],v4 offset:1024
s_waitcnt vmcnt(5)
ds_read_b128 v[72:75],v4 offset:2048
s_waitcnt vmcnt(4)
ds_read_b128 v[76:79],v4 offset:3072
s_waitcnt lgkmcnt(3)
v_mfma_f32_16x16x32_bf16 v[32:35],a[0:3],v[64:67],0
s_add_u32 s71,s60,2
s_add_u32 s53,s60,3
v_mfma_f32_16x16x32_bf16 v[36:39],a[4:7],v[64:67],0
s_waitcnt lgkmcnt(2)
s_waitcnt vmcnt(3)
ds_read_b128 v[80:83],v4 offset:4096
v_mfma_f32_16x16x32_bf16 v[32:35],a[8:11],v[68:71],v[32:35]
v_mfma_f32_16x16x32_bf16 v[36:39],a[12:15],v[68:71],v[36:39]
s_waitcnt lgkmcnt(2)
s_waitcnt vmcnt(2)
ds_read_b128 v[84:87],v4 offset:5120
v_mfma_f32_16x16x32_bf16 v[32:35],a[16:19],v[72:75],v[32:35]
v_mfma_f32_16x16x32_bf16 v[36:39],a[20:23],v[72:75],v[36:39]
s_waitcnt lgkmcnt(2)
s_waitcnt vmcnt(1)
ds_read_b128 v[88:91],v4 offset:6144
v_mfma_f32_16x16x32_bf16 v[32:35],a[24:27],v[76:79],v[32:35]
v_mfma_f32_16x16x32_bf16 v[36:39],a[28:31],v[76:79],v[36:39]
s_waitcnt lgkmcnt(2)
s_waitcnt vmcnt(0)
ds_read_b128 v[92:95],v4 offset:7168
v_mfma_f32_16x16x32_bf16 v[32:35],a[32:35],v[80:83],v[32:35]
v_mfma_f32_16x16x32_bf16 v[36:39],a[36:39],v[80:83],v[36:39]
s_waitcnt lgkmcnt(2)
s_barrier
ds_read_b128 v[96:99],v5 offset:0
v_mfma_f32_16x16x32_bf16 v[32:35],a[40:43],v[84:87],v[32:35]
ds_read_b128 v[100:103],v5 offset:1024
v_mfma_f32_16x16x32_bf16 v[36:39],a[44:47],v[84:87],v[36:39]
s_waitcnt lgkmcnt(3)
ds_read_b128 v[104:107],v5 offset:2048
v_mfma_f32_16x16x32_bf16 v[32:35],a[48:51],v[88:91],v[32:35]
ds_read_b128 v[108:111],v5 offset:3072
v_mfma_f32_16x16x32_bf16 v[36:39],a[52:55],v[88:91],v[36:39]
s_waitcnt lgkmcnt(4)
ds_read_b128 v[112:115],v5 offset:4096
v_mfma_f32_16x16x32_bf16 v[32:35],a[56:59],v[92:95],v[32:35]
s_cmp_eq_u32 s77,0
s_cselect_b32 s57,2.0,0
ds_read_b128 v[116:119],v5 offset:5120
v_mfma_f32_16x16x32_bf16 v[36:39],a[60:63],v[92:95],v[36:39]
s_waitcnt lgkmcnt(5)
v_or_b32 v21,s57,v0
v_lshlrev_b32 v168,16,v160
v_mfma_f32_16x16x32_bf16 v[32:35],a[64:67],v[96:99],v[32:35]
ds_read_b128 v[120:123],v5 offset:6144
v_and_b32 v169,s73,v160
v_mfma_f32_16x16x32_bf16 v[36:39],a[68:71],v[96:99],v[36:39]
s_waitcnt lgkmcnt(5)
v_lshlrev_b32 v170,16,v161
v_and_b32 v171,s73,v161
v_mfma_f32_16x16x32_bf16 v[32:35],a[72:75],v[100:103],v[32:35]
ds_read_b128 v[124:127],v5 offset:7168
v_lshlrev_b32 v172,16,v162
v_mfma_f32_16x16x32_bf16 v[36:39],a[76:79],v[100:103],v[36:39]
s_waitcnt lgkmcnt(5)
v_and_b32 v173,s73,v162
v_lshlrev_b32 v174,16,v163
v_mfma_f32_16x16x32_bf16 v[32:35],a[80:83],v[104:107],v[32:35]
ds_read_b128 v[64:67],v6 offset:0
v_and_b32 v175,s73,v163
v_mfma_f32_16x16x32_bf16 v[36:39],a[84:87],v[104:107],v[36:39]
s_waitcnt lgkmcnt(5)
v_fma_f32 v168,v212,v152,v168
v_fma_f32 v169,v213,v153,v169
v_mfma_f32_16x16x32_bf16 v[32:35],a[88:91],v[108:111],v[32:35]
ds_read_b128 v[68:71],v6 offset:1024
v_fma_f32 v170,v214,v154,v170
v_mfma_f32_16x16x32_bf16 v[36:39],a[92:95],v[108:111],v[36:39]
s_waitcnt lgkmcnt(5)
v_fma_f32 v171,v215,v155,v171
v_fma_f32 v172,v216,v156,v172
v_mfma_f32_16x16x32_bf16 v[32:35],a[96:99],v[112:115],v[32:35]
ds_read_b128 v[72:75],v6 offset:2048
v_fma_f32 v173,v217,v157,v173
v_mfma_f32_16x16x32_bf16 v[36:39],a[100:103],v[112:115],v[36:39]
s_waitcnt lgkmcnt(5)
v_fma_f32 v174,v218,v158,v174
v_fma_f32 v175,v219,v159,v175
v_mfma_f32_16x16x32_bf16 v[32:35],a[104:107],v[116:119],v[32:35]
ds_read_b128 v[76:79],v6 offset:3072
v_mfma_f32_16x16x32_bf16 v[36:39],a[108:111],v[116:119],v[36:39]
s_waitcnt lgkmcnt(5)
buffer_load_dwordx4 v[160:163],v18,s[24:27],s82 offen
v_mfma_f32_16x16x32_bf16 v[32:35],a[112:115],v[120:123],v[32:35]
s_add_u32 s84,s74,s75
s_add_u32 s85,s84,4096
ds_read_b128 v[80:83],v6 offset:4096
v_mfma_f32_16x16x32_bf16 v[36:39],a[116:119],v[120:123],v[36:39]
s_waitcnt lgkmcnt(5)
s_add_u32 s82,s82,32768
buffer_load_dwordx4 v[128:131],v0,s[20:23],s84 offen offset:0 sc1
v_mfma_f32_16x16x32_bf16 v[32:35],a[120:123],v[124:127],v[32:35]
ds_read_b128 v[84:87],v6 offset:5120
v_mfma_f32_16x16x32_bf16 v[36:39],a[124:127],v[124:127],v[36:39]
s_waitcnt lgkmcnt(5)
buffer_load_dwordx4 v[132:135],v0,s[20:23],s84 offen offset:1024 sc1
v_mfma_f32_16x16x32_bf16 v[32:35],a[128:131],v[64:67],v[32:35]
ds_read_b128 v[88:91],v6 offset:6144
v_mfma_f32_16x16x32_bf16 v[36:39],a[132:135],v[64:67],v[36:39]
s_waitcnt lgkmcnt(5)
buffer_load_dwordx4 v[136:139],v0,s[20:23],s84 offen offset:2048 sc1
v_mfma_f32_16x16x32_bf16 v[32:35],a[136:139],v[68:71],v[32:35]
ds_read_b128 v[92:95],v6 offset:7168
v_mfma_f32_16x16x32_bf16 v[36:39],a[140:143],v[68:71],v[36:39]
s_waitcnt lgkmcnt(5)
buffer_load_dwordx4 v[140:143],v0,s[20:23],s84 offen offset:3072 sc1
v_mfma_f32_16x16x32_bf16 v[32:35],a[144:147],v[72:75],v[32:35]
ds_read_b128 v[96:99],v7 offset:0
v_mfma_f32_16x16x32_bf16 v[36:39],a[148:151],v[72:75],v[36:39]
s_waitcnt lgkmcnt(5)
buffer_load_dwordx4 v[144:147],v0,s[20:23],s85 offen offset:0 sc1
v_mfma_f32_16x16x32_bf16 v[32:35],a[152:155],v[76:79],v[32:35]
ds_read_b128 v[100:103],v7 offset:1024
v_mfma_f32_16x16x32_bf16 v[36:39],a[156:159],v[76:79],v[36:39]
s_waitcnt lgkmcnt(5)
buffer_load_dwordx4 v[148:151],v0,s[20:23],s85 offen offset:1024 sc1
v_mfma_f32_16x16x32_bf16 v[32:35],a[160:163],v[80:83],v[32:35]
ds_read_b128 v[104:107],v7 offset:2048
buffer_load_dword v16,v2,s[20:23],s68 offen sc1
v_mfma_f32_16x16x32_bf16 v[36:39],a[164:167],v[80:83],v[36:39]
s_waitcnt lgkmcnt(5)
v_mfma_f32_16x16x32_bf16 v[32:35],a[168:171],v[84:87],v[32:35]
ds_read_b128 v[108:111],v7 offset:3072
v_mfma_f32_16x16x32_bf16 v[36:39],a[172:175],v[84:87],v[36:39]
s_waitcnt lgkmcnt(5)
v_mfma_f32_16x16x32_bf16 v[32:35],a[176:179],v[88:91],v[32:35]
ds_read_b128 v[112:115],v7 offset:4096
v_mfma_f32_16x16x32_bf16 v[36:39],a[180:183],v[88:91],v[36:39]
s_waitcnt lgkmcnt(5)
v_mfma_f32_16x16x32_bf16 v[32:35],a[184:187],v[92:95],v[32:35]
ds_read_b128 v[116:119],v7 offset:5120
v_mfma_f32_16x16x32_bf16 v[36:39],a[188:191],v[92:95],v[36:39]
s_waitcnt lgkmcnt(5)
v_mfma_f32_16x16x32_bf16 v[32:35],a[192:195],v[96:99],v[32:35]
ds_read_b128 v[120:123],v7 offset:6144
v_mfma_f32_16x16x32_bf16 v[36:39],a[196:199],v[96:99],v[36:39]
s_waitcnt lgkmcnt(5)
v_mfma_f32_16x16x32_bf16 v[32:35],a[200:203],v[100:103],v[32:35]
s_waitcnt vmcnt(1)
ds_read_b128 v[124:127],v7 offset:7168
s_cmp_eq_u32 s77,0
s_cbranch_scc1 go_166
ck_164:
v_max3_u32 v184,v128,v129,v130
v_max3_u32 v185,v140,v141,v142
v_max3_u32 v184,v184,v131,v132
v_max3_u32 v185,v185,v143,v144
v_max3_u32 v184,v184,v133,v134
v_max3_u32 v185,v185,v145,v146
v_max3_u32 v184,v184,v135,v136
v_max3_u32 v185,v185,v147,v148
v_max3_u32 v184,v184,v137,v138
v_max3_u32 v185,v185,v149,v150
v_max3_u32 v184,v184,v139,v151
v_max_u32 v184,v184,v185
v_cmp_eq_u32 vcc,-1,v184
s_cbranch_vccnz rt_165
go_166:
v_mfma_f32_16x16x32_bf16 v[36:39],a[204:207],v[100:103],v[36:39]
s_waitcnt lgkmcnt(5)
s_add_u32 s55,s55,32768
s_and_b32 s55,s55,0x1ffff
v_add_f32 v128,v128,v136
v_mfma_f32_16x16x32_bf16 v[32:35],a[208:211],v[104:107],v[32:35]
v_add_u32 v4,s55,v8
v_add_u32 v5,s55,v9
v_add_f32 v129,v129,v137
v_mfma_f32_16x16x32_bf16 v[36:39],a[212:215],v[104:107],v[36:39]
s_waitcnt lgkmcnt(4)
v_add_u32 v6,s55,v10
v_add_u32 v7,s55,v11
v_add_f32 v130,v130,v138
v_mfma_f32_16x16x32_bf16 v[32:35],a[216:219],v[108:111],v[32:35]
v_add_f32 v131,v131,v139
v_add_f32 v132,v132,v140
v_add_f32 v133,v133,v141
v_mfma_f32_16x16x32_bf16 v[36:39],a[220:223],v[108:111],v[36:39]
s_waitcnt lgkmcnt(3)
v_add_f32 v134,v134,v142
v_add_f32 v135,v135,v143
v_add_f32 v128,v128,v144
v_mfma_f32_16x16x32_bf16 v[32:35],a[224:227],v[112:115],v[32:35]
v_add_f32 v129,v129,v145
v_add_f32 v130,v130,v146
v_add_f32 v131,v131,v147
v_mfma_f32_16x16x32_bf16 v[36:39],a[228:231],v[112:115],v[36:39]
s_waitcnt lgkmcnt(2)
v_add_f32 v132,v132,v148
v_add_f32 v133,v133,v149
v_add_f32 v134,v134,v150
v_mfma_f32_16x16x32_bf16 v[32:35],a[232:235],v[116:119],v[32:35]
v_add_f32 v135,v135,v151
v_fma_f32 v168,v128,v152,v168
v_fma_f32 v169,v129,v153,v169
v_mfma_f32_16x16x32_bf16 v[36:39],a[236:239],v[116:119],v[36:39]
s_waitcnt lgkmcnt(1)
v_fma_f32 v170,v130,v154,v170
v_fma_f32 v171,v131,v155,v171
v_fma_f32 v172,v132,v156,v172
v_mfma_f32_16x16x32_bf16 v[32:35],a[240:243],v[120:123],v[32:35]
v_fma_f32 v173,v133,v157,v173
v_fma_f32 v174,v134,v158,v174
v_fma_f32 v175,v135,v159,v175
v_mfma_f32_16x16x32_bf16 v[36:39],a[244:247],v[120:123],v[36:39]
s_waitcnt lgkmcnt(0)
v_cvt_pk_bf16_f32 v176,v168,v169
v_cvt_pk_bf16_f32 v177,v170,v171
v_cvt_pk_bf16_f32 v178,v172,v173
v_mfma_f32_16x16x32_bf16 v[40:43],a[248:251],v[124:127],v[32:35]
v_cvt_pk_bf16_f32 v179,v174,v175
v_mfma_f32_16x16x32_bf16 v[44:47],a[252:255],v[124:127],v[36:39]
s_waitcnt vmcnt(0)
s_add_u32 s64,s66,201326592
buffer_store_dwordx4 v[176:179],v21,s[20:23],s64 offen sc1
s_add_u32 s79,s66,201392128
s_cmp_ge_u32 s63,126
s_cselect_b32 s79,138641408,s79
buffer_store_dwordx4 v[204:207],v21,s[20:23],s79 offen sc1
s_cmp_eq_u32 s56,1
s_cbranch_scc1 b1_158
buffer_store_dwordx4 v[204:207],v21,s[20:23],s84 offen offset:0
buffer_store_dwordx4 v[204:207],v21,s[20:23],s84 offen offset:1024
b2_159:
s_cmp_eq_u32 s56,1
s_cbranch_scc1 b1_160
buffer_store_dwordx4 v[204:207],v21,s[20:23],s84 offen offset:2048
buffer_store_dwordx4 v[204:207],v21,s[20:23],s84 offen offset:3072
b2_161:
s_cmp_eq_u32 s56,1
s_cbranch_scc1 b1_162
buffer_store_dwordx4 v[204:207],v21,s[20:23],s85 offen offset:0
buffer_store_dwordx4 v[204:207],v21,s[20:23],s85 offen offset:1024
b2_163:
s_mul_i32 s64,s77,32768
s_add_u32 s66,s66,s64
s_mul_i32 s64,s77,6144
s_add_u32 s75,s75,s64
s_cmp_eq_u32 s75,24576
s_cselect_b32 s75,0,s75
s_add_u32 s63,s63,s77
s_mov_b32 s77,0
v_cmp_gt_u32 vcc,s71,v16
s_add_u32 s60,s60,1
endN_148:
s_cbranch_vccnz nb_127
s_mov_b32 m0,s70
s_nop 0
buffer_load_dwordx4 v3,s[20:23],s61 offen offset:0 lds
buffer_load_dwordx4 v3,s[20:23],s61 offen offset:1024 lds
buffer_load_dwordx4 v3,s[20:23],s61 offen offset:2048 lds
buffer_load_dwordx4 v3,s[20:23],s61 offen offset:3072 lds
s_add_u32 m0,s70,4096
s_nop 0
buffer_load_dwordx4 v3,s[20:23],s62 offen offset:0 lds
buffer_load_dwordx4 v3,s[20:23],s62 offen offset:1024 lds
buffer_load_dwordx4 v3,s[20:23],s62 offen offset:2048 lds
buffer_load_dwordx4 v3,s[20:23],s62 offen offset:3072 lds
s_add_u32 s61,s61,131072
s_add_u32 s62,s62,131072
s_add_u32 s70,s70,32768
s_and_b32 s70,s70,0x1ffff
v_mov_b32 v212,v40
v_mov_b32 v213,v41
v_mov_b32 v214,v42
v_mov_b32 v215,v43
v_mov_b32 v216,v44
v_mov_b32 v217,v45
v_mov_b32 v218,v46
v_mov_b32 v219,v47
s_mov_b32 s77,1
s_branch dec_126
nb_127:
s_nop 3
s_mov_b32 s77,1
s_add_u32 s84,s74,s75
s_add_u32 s85,s84,4096
buffer_load_dwordx4 v[128:131],v0,s[20:23],s84 offen offset:0 sc1
buffer_load_dwordx4 v[132:135],v0,s[20:23],s84 offen offset:1024 sc1
buffer_load_dwordx4 v[136:139],v0,s[20:23],s84 offen offset:2048 sc1
buffer_load_dwordx4 v[140:143],v0,s[20:23],s84 offen offset:3072 sc1
buffer_load_dwordx4 v[144:147],v0,s[20:23],s85 offen offset:0 sc1
buffer_load_dwordx4 v[148:151],v0,s[20:23],s85 offen offset:1024 sc1
s_cmp_eq_u32 s77,0
s_cselect_b32 s57,2.0,0
v_or_b32 v21,s57,v0
v_lshlrev_b32 v168,16,v160
v_and_b32 v169,s73,v160
v_lshlrev_b32 v170,16,v161
v_and_b32 v171,s73,v161
v_lshlrev_b32 v172,16,v162
v_and_b32 v173,s73,v162
v_lshlrev_b32 v174,16,v163
v_and_b32 v175,s73,v163
v_pk_fma_f32 v[168:169],v[40:41],v[152:153],v[168:169]
v_pk_fma_f32 v[170:171],v[42:43],v[154:155],v[170:171]
v_pk_fma_f32 v[172:173],v[44:45],v[156:157],v[172:173]
v_pk_fma_f32 v[174:175],v[46:47],v[158:159],v[174:175]
s_waitcnt vmcnt(0)
s_cmp_eq_u32 s77,0
s_cbranch_scc1 go_175
ck_173:
v_max3_u32 v184,v128,v129,v130
v_max3_u32 v185,v140,v141,v142
v_max3_u32 v184,v184,v131,v132
v_max3_u32 v185,v185,v143,v144
v_max3_u32 v184,v184,v133,v134
v_max3_u32 v185,v185,v145,v146
v_max3_u32 v184,v184,v135,v136
v_max3_u32 v185,v185,v147,v148
v_max3_u32 v184,v184,v137,v138
v_max3_u32 v185,v185,v149,v150
v_max3_u32 v184,v184,v139,v151
v_max_u32 v184,v184,v185
v_cmp_eq_u32 vcc,-1,v184
s_cbranch_vccnz rt_174
go_175:
buffer_load_dword v16,v2,s[20:23],s68 offen sc1
v_pk_add_f32 v[128:129],v[128:129],v[136:137]
v_pk_add_f32 v[130:131],v[130:131],v[138:139]
v_pk_add_f32 v[132:133],v[132:133],v[140:141]
v_pk_add_f32 v[134:135],v[134:135],v[142:143]
v_pk_add_f32 v[128:129],v[128:129],v[144:145]
v_pk_add_f32 v[130:131],v[130:131],v[146:147]
v_pk_add_f32 v[132:133],v[132:133],v[148:149]
v_pk_add_f32 v[134:135],v[134:135],v[150:151]
v_pk_fma_f32 v[168:169],v[128:129],v[152:153],v[168:169]
v_pk_fma_f32 v[170:171],v[130:131],v[154:155],v[170:171]
v_pk_fma_f32 v[172:173],v[132:133],v[156:157],v[172:173]
v_pk_fma_f32 v[174:175],v[134:135],v[158:159],v[174:175]
v_cvt_pk_bf16_f32 v176,v168,v169
v_cvt_pk_bf16_f32 v177,v170,v171
v_cvt_pk_bf16_f32 v178,v172,v173
v_cvt_pk_bf16_f32 v179,v174,v175
s_add_u32 s64,s66,201326592
buffer_store_dwordx4 v[176:179],v21,s[20:23],s64 offen sc1
s_add_u32 s79,s66,201392128
s_cmp_ge_u32 s63,126
s_cselect_b32 s79,138641408,s79
buffer_store_dwordx4 v[204:207],v21,s[20:23],s79 offen sc1
s_cmp_eq_u32 s56,1
s_cbranch_scc1 b1_167
buffer_store_dwordx4 v[204:207],v21,s[20:23],s84 offen offset:0
buffer_store_dwordx4 v[204:207],v21,s[20:23],s84 offen offset:1024
b2_168:
s_cmp_eq_u32 s56,1
s_cbranch_scc1 b1_169
buffer_store_dwordx4 v[204:207],v21,s[20:23],s84 offen offset:2048
buffer_store_dwordx4 v[204:207],v21,s[20:23],s84 offen offset:3072
b2_170:
s_cmp_eq_u32 s56,1
s_cbranch_scc1 b1_171
buffer_store_dwordx4 v[204:207],v21,s[20:23],s85 offen offset:0
buffer_store_dwordx4 v[204:207],v21,s[20:23],s85 offen offset:1024
b2_172:
s_mul_i32 s64,s77,32768
s_add_u32 s66,s66,s64
s_mul_i32 s64,s77,6144
s_add_u32 s75,s75,s64
s_cmp_eq_u32 s75,24576
s_cselect_b32 s75,0,s75
s_add_u32 s63,s63,s77
s_mov_b32 s77,0
s_waitcnt vmcnt(8)
v_cmp_gt_u32 vcc,s71,v16
s_cbranch_vccz lag_125
s_cmp_ge_u32 s60,128
s_cbranch_scc1 done_77
plp_178:
buffer_load_dword v16,v2,s[20:23],s68 offen sc1
s_waitcnt vmcnt(0)
v_cmp_gt_u32 vcc,s71,v16
s_cbranch_vccz pok_179
s_sleep 4
s_sub_u32 s90,s90,1
s_cmp_gt_i32 s90,0
s_cbranch_scc1 plp_178
pok_179:
s_branch lag_125
b1_96:
s_nop 7
buffer_store_dwordx4 v[40:43],v0,s[20:23],s64 offen offset:0 sc1
buffer_store_dwordx4 v[44:47],v0,s[20:23],s64 offen offset:1024 sc1
s_branch b2_97
b1_99:
s_nop 7
buffer_store_dwordx4 v[40:43],v0,s[20:23],s64 offen offset:0 sc1
buffer_store_dwordx4 v[44:47],v0,s[20:23],s64 offen offset:1024 sc1
s_branch b2_100
b1_101:
s_nop 7
buffer_store_dwordx4 v[40:43],v0,s[20:23],s64 offen offset:0 sc1
buffer_store_dwordx4 v[44:47],v0,s[20:23],s64 offen offset:1024 sc1
s_branch b2_102
b1_103:
s_nop 7
buffer_store_dwordx4 v[40:43],v0,s[20:23],s64 offen offset:0 sc1
buffer_store_dwordx4 v[44:47],v0,s[20:23],s64 offen offset:1024 sc1
s_branch b2_104
b1_130:
s_nop 7
buffer_store_dwordx4 v[204:207],v21,s[20:23],s84 offen offset:0 sc1
buffer_store_dwordx4 v[204:207],v21,s[20:23],s84 offen offset:1024 sc1
s_branch b2_131
b1_132:
s_nop 7
buffer_store_dwordx4 v[204:207],v21,s[20:23],s84 offen offset:2048 sc1
buffer_store_dwordx4 v[204:207],v21,s[20:23],s84 offen offset:3072 sc1
s_branch b2_133
b1_134:
s_nop 7
buffer_store_dwordx4 v[204:207],v21,s[20:23],s85 offen offset:0 sc1
buffer_store_dwordx4 v[204:207],v21,s[20:23],s85 offen offset:1024 sc1
s_branch b2_135
rt_137:
s_sub_u32 s90,s90,1
s_cmp_gt_i32 s90,0
s_cbranch_scc0 go_138
s_add_u32 s84,s74,s75
s_add_u32 s85,s84,4096
buffer_load_dwordx4 v[128:131],v0,s[20:23],s84 offen offset:0 sc1
buffer_load_dwordx4 v[132:135],v0,s[20:23],s84 offen offset:1024 sc1
buffer_load_dwordx4 v[136:139],v0,s[20:23],s84 offen offset:2048 sc1
buffer_load_dwordx4 v[140:143],v0,s[20:23],s84 offen offset:3072 sc1
buffer_load_dwordx4 v[144:147],v0,s[20:23],s85 offen offset:0 sc1
buffer_load_dwordx4 v[148:151],v0,s[20:23],s85 offen offset:1024 sc1
s_waitcnt vmcnt(0)
s_branch ck_136
b1_139:
s_nop 7
buffer_store_dwordx4 v[204:207],v21,s[20:23],s84 offen offset:0 sc1
buffer_store_dwordx4 v[204:207],v21,s[20:23],s84 offen offset:1024 sc1
s_branch b2_140
b1_141:
s_nop 7
buffer_store_dwordx4 v[204:207],v21,s[20:23],s84 offen offset:2048 sc1
buffer_store_dwordx4 v[204:207],v21,s[20:23],s84 offen offset:3072 sc1
s_branch b2_142
b1_143:
s_nop 7
buffer_store_dwordx4 v[204:207],v21,s[20:23],s85 offen offset:0 sc1
buffer_store_dwordx4 v[204:207],v21,s[20:23],s85 offen offset:1024 sc1
s_branch b2_144
rt_146:
s_sub_u32 s90,s90,1
s_cmp_gt_i32 s90,0
s_cbranch_scc0 go_147
s_add_u32 s84,s74,s75
s_add_u32 s85,s84,4096
buffer_load_dwordx4 v[128:131],v0,s[20:23],s84 offen offset:0 sc1
buffer_load_dwordx4 v[132:135],v0,s[20:23],s84 offen offset:1024 sc1
buffer_load_dwordx4 v[136:139],v0,s[20:23],s84 offen offset:2048 sc1
buffer_load_dwordx4 v[140:143],v0,s[20:23],s84 offen offset:3072 sc1
buffer_load_dwordx4 v[144:147],v0,s[20:23],s85 offen offset:0 sc1
buffer_load_dwordx4 v[148:151],v0,s[20:23],s85 offen offset:1024 sc1
s_waitcnt vmcnt(0)
s_branch ck_145
b1_149:
s_nop 7
buffer_store_dwordx4 v[204:207],v21,s[20:23],s84 offen offset:0 sc1
buffer_store_dwordx4 v[204:207],v21,s[20:23],s84 offen offset:1024 sc1
s_branch b2_150
b1_151:
s_nop 7
buffer_store_dwordx4 v[204:207],v21,s[20:23],s84 offen offset:2048 sc1
buffer_store_dwordx4 v[204:207],v21,s[20:23],s84 offen offset:3072 sc1
s_branch b2_152
b1_153:
s_nop 7
buffer_store_dwordx4 v[204:207],v21,s[20:23],s85 offen offset:0 sc1
buffer_store_dwordx4 v[204:207],v21,s[20:23],s85 offen offset:1024 sc1
s_branch b2_154
rt_156:
s_sub_u32 s90,s90,1
s_cmp_gt_i32 s90,0
s_cbranch_scc0 go_157
s_add_u32 s84,s74,s75
s_add_u32 s85,s84,4096
buffer_load_dwordx4 v[128:131],v0,s[20:23],s84 offen offset:0 sc1
buffer_load_dwordx4 v[132:135],v0,s[20:23],s84 offen offset:1024 sc1
buffer_load_dwordx4 v[136:139],v0,s[20:23],s84 offen offset:2048 sc1
buffer_load_dwordx4 v[140:143],v0,s[20:23],s84 offen offset:3072 sc1
buffer_load_dwordx4 v[144:147],v0,s[20:23],s85 offen offset:0 sc1
buffer_load_dwordx4 v[148:151],v0,s[20:23],s85 offen offset:1024 sc1
s_waitcnt vmcnt(0)
s_branch ck_155
b1_158:
s_nop 7
buffer_store_dwordx4 v[204:207],v21,s[20:23],s84 offen offset:0 sc1
buffer_store_dwordx4 v[204:207],v21,s[20:23],s84 offen offset:1024 sc1
s_branch b2_159
b1_160:
s_nop 7
buffer_store_dwordx4 v[204:207],v21,s[20:23],s84 offen offset:2048 sc1
buffer_store_dwordx4 v[204:207],v21,s[20:23],s84 offen offset:3072 sc1
s_branch b2_161
b1_162:
s_nop 7
buffer_store_dwordx4 v[204:207],v21,s[20:23],s85 offen offset:0 sc1
buffer_store_dwordx4 v[204:207],v21,s[20:23],s85 offen offset:1024 sc1
s_branch b2_163
rt_165:
s_sub_u32 s90,s90,1
s_cmp_gt_i32 s90,0
s_cbranch_scc0 go_166
s_add_u32 s84,s74,s75
s_add_u32 s85,s84,4096
buffer_load_dwordx4 v[128:131],v0,s[20:23],s84 offen offset:0 sc1
buffer_load_dwordx4 v[132:135],v0,s[20:23],s84 offen offset:1024 sc1
buffer_load_dwordx4 v[136:139],v0,s[20:23],s84 offen offset:2048 sc1
buffer_load_dwordx4 v[140:143],v0,s[20:23],s84 offen offset:3072 sc1
buffer_load_dwordx4 v[144:147],v0,s[20:23],s85 offen offset:0 sc1
buffer_load_dwordx4 v[148:151],v0,s[20:23],s85 offen offset:1024 sc1
s_waitcnt vmcnt(0)
s_branch ck_164
b1_167:
s_nop 7
buffer_store_dwordx4 v[204:207],v21,s[20:23],s84 offen offset:0 sc1
buffer_store_dwordx4 v[204:207],v21,s[20:23],s84 offen offset:1024 sc1
s_branch b2_168
b1_169:
s_nop 7
buffer_store_dwordx4 v[204:207],v21,s[20:23],s84 offen offset:2048 sc1
buffer_store_dwordx4 v[204:207],v21,s[20:23],s84 offen offset:3072 sc1
s_branch b2_170
b1_171:
s_nop 7
buffer_store_dwordx4 v[204:207],v21,s[20:23],s85 offen offset:0 sc1
buffer_store_dwordx4 v[204:207],v21,s[20:23],s85 offen offset:1024 sc1
s_branch b2_172
rt_174:
s_sub_u32 s90,s90,1
s_cmp_gt_i32 s90,0
s_cbranch_scc0 go_175
s_add_u32 s84,s74,s75
s_add_u32 s85,s84,4096
buffer_load_dwordx4 v[128:131],v0,s[20:23],s84 offen offset:0 sc1
buffer_load_dwordx4 v[132:135],v0,s[20:23],s84 offen offset:1024 sc1
buffer_load_dwordx4 v[136:139],v0,s[20:23],s84 offen offset:2048 sc1
buffer_load_dwordx4 v[140:143],v0,s[20:23],s84 offen offset:3072 sc1
buffer_load_dwordx4 v[144:147],v0,s[20:23],s85 offen offset:0 sc1
buffer_load_dwordx4 v[148:151],v0,s[20:23],s85 offen offset:1024 sc1
s_waitcnt vmcnt(0)
s_branch ck_173
done_77:
s_endpgm
fl_w4:
v_and_b32 v21,15,v1
v_lshrrev_b32 v22,4,v1
v_lshrrev_b32 v23,2,v21
v_and_b32 v24,3,v21
s_lshl_b32 s61,s50,15
v_lshl_add_u32 v25,v22,3,v23
s_load_dwordx2 s[4:5],s[0:1],88
s_load_dwordx2 s[6:7],s[0:1],112
s_lshr_b32 s52,s59,3
s_and_b32 s53,s59,7
s_mul_i32 s54,s52,1835008
s_lshl_b32 s64,s53,8
s_add_u32 s54,s54,s64
s_lshl_b32 s64,s50,6
s_add_u32 s54,s54,s64
s_waitcnt lgkmcnt(0)
s_mov_b32 s28,s4
s_and_b32 s29,s5,0xffff
s_mov_b32 s30,0x700000
s_mov_b32 s31,0x20000
s_mov_b32 s24,s6
s_and_b32 s25,s7,0xffff
s_mov_b32 s26,0x400000
s_mov_b32 s27,0x20000
s_mov_b32 s92,s2
s_and_b32 s93,s3,0xffff
s_mov_b32 s94,0x100
s_mov_b32 s95,0x20000
v_mbcnt_lo_u32_b32 v16,-1,0
v_mbcnt_hi_u32_b32 v16,-1,v16
v_mov_b32 v18,0
v_cmp_eq_u32 vcc,17,v16
s_nop 1
v_cndmask_b32 v18,v18,63,vcc
v_and_b32 v19,1,v16
v_cmp_eq_u32 vcc,1,v19
v_mov_b32 v19,8192
s_nop 0
v_cndmask_b32 v19,-1,v19,vcc
v_min_u32 v16,31,v16
v_lshlrev_b32 v16,2,v16
s_sub_u32 s66,s88,64
s_cmp_lg_u32 s50,0
s_cbranch_scc1 vot_185
vpoll_181:
buffer_load_dword v17,v16,s[92:95],s66 offen sc1
s_waitcnt vmcnt(0)
s_cmp_lg_u32 s56,2
s_cbranch_scc1 vck_182
v_cmp_eq_u32 vcc,v17,v19
s_and_b32 s64,vcc_lo,0xffff
s_cmp_eq_u32 s64,65535
s_cbranch_scc1 vck_182
s_mov_b32 s65,0
v_readlane_b32 s64,v17,1
s_lshr_b32 s64,s64,8
s_add_u32 s65,s65,s64
v_readlane_b32 s64,v17,3
s_lshr_b32 s64,s64,8
s_add_u32 s65,s65,s64
v_readlane_b32 s64,v17,5
s_lshr_b32 s64,s64,8
s_add_u32 s65,s65,s64
v_readlane_b32 s64,v17,7
s_lshr_b32 s64,s64,8
s_add_u32 s65,s65,s64
v_readlane_b32 s64,v17,9
s_lshr_b32 s64,s64,8
s_add_u32 s65,s65,s64
v_readlane_b32 s64,v17,11
s_lshr_b32 s64,s64,8
s_add_u32 s65,s65,s64
v_readlane_b32 s64,v17,13
s_lshr_b32 s64,s64,8
s_add_u32 s65,s65,s64
v_readlane_b32 s64,v17,15
s_lshr_b32 s64,s64,8
s_add_u32 s65,s65,s64
s_cmp_ge_u32 s65,256
s_cbranch_scc1 vok_184
s_branch vrt_183
vck_182:
v_cmp_gt_u32 vcc,v18,v17
s_cbranch_vccz vok_184
vrt_183:
s_sleep 48
s_sub_u32 s90,s90,1
s_cmp_gt_i32 s90,0
s_cbranch_scc1 vpoll_181
vok_184:
v_add_u32 v18,159744,v16
ds_write_b32 v18,v17
s_waitcnt lgkmcnt(0)
vot_185:
s_barrier
v_add_u32 v18,159744,v16
ds_read_b32 v17,v18
s_waitcnt lgkmcnt(0)
s_cmp_lg_u32 s56,2
s_cbranch_scc1 vfin_186
v_cmp_eq_u32 vcc,v17,v19
s_and_b32 s64,vcc_lo,0xffff
s_cmp_eq_u32 s64,65535
s_cbranch_scc1 vfin_186
s_mov_b32 s65,0
v_readlane_b32 s64,v17,1
s_lshr_b32 s64,s64,8
s_add_u32 s65,s65,s64
v_readlane_b32 s64,v17,3
s_lshr_b32 s64,s64,8
s_add_u32 s65,s65,s64
v_readlane_b32 s64,v17,5
s_lshr_b32 s64,s64,8
s_add_u32 s65,s65,s64
v_readlane_b32 s64,v17,7
s_lshr_b32 s64,s64,8
s_add_u32 s65,s65,s64
v_readlane_b32 s64,v17,9
s_lshr_b32 s64,s64,8
s_add_u32 s65,s65,s64
v_readlane_b32 s64,v17,11
s_lshr_b32 s64,s64,8
s_add_u32 s65,s65,s64
v_readlane_b32 s64,v17,13
s_lshr_b32 s64,s64,8
s_add_u32 s65,s65,s64
v_readlane_b32 s64,v17,15
s_lshr_b32 s64,s64,8
s_add_u32 s65,s65,s64
s_cmp_ge_u32 s65,256
s_cbranch_scc1 fl_fb
vfin_186:
s_and_b32 s56,s56,1
v_lshrrev_b32 v26,2,v1
v_and_b32 v27,3,v1
v_mul_u32_u24 v16,2048,v26
v_lshl_add_u32 v16,v27,4,v16
v_lshlrev_b32 v17,6,v25
v_lshl_add_u32 v17,v24,4,v17
v_add_u32 v17,s61,v17
s_xor_b32 s62,s50,0
s_mul_i32 s62,s62,458752
s_add_u32 s62,s62,s54
s_add_u32 m0,s61,0
s_nop 0
buffer_load_dwordx4 v16,s[28:31],s62 offen nt lds
s_add_u32 s62,s62,32768
s_add_u32 m0,m0,1024
s_waitcnt vmcnt(2)
buffer_load_dwordx4 v16,s[28:31],s62 offen nt lds
s_add_u32 s62,s62,32768
s_add_u32 m0,m0,1024
s_waitcnt vmcnt(2)
buffer_load_dwordx4 v16,s[28:31],s62 offen nt lds
s_add_u32 s62,s62,32768
s_add_u32 m0,m0,1024
s_waitcnt vmcnt(2)
buffer_load_dwordx4 v16,s[28:31],s62 offen nt lds
s_add_u32 s62,s62,32768
s_add_u32 m0,m0,1024
s_waitcnt vmcnt(2)
buffer_load_dwordx4 v16,s[28:31],s62 offen nt lds
s_add_u32 s62,s62,32768
s_add_u32 m0,m0,1024
s_waitcnt vmcnt(2)
buffer_load_dwordx4 v16,s[28:31],s62 offen nt lds
s_add_u32 s62,s62,32768
s_add_u32 m0,m0,1024
s_waitcnt vmcnt(2)
buffer_load_dwordx4 v16,s[28:31],s62 offen nt lds
s_add_u32 s62,s62,32768
s_add_u32 m0,m0,1024
s_waitcnt vmcnt(2)
buffer_load_dwordx4 v16,s[28:31],s62 offen nt lds
s_add_u32 s62,s62,32768
s_add_u32 m0,m0,1024
s_waitcnt vmcnt(2)
buffer_load_dwordx4 v16,s[28:31],s62 offen nt lds
s_add_u32 s62,s62,32768
s_add_u32 m0,m0,1024
s_waitcnt vmcnt(2)
buffer_load_dwordx4 v16,s[28:31],s62 offen nt lds
s_add_u32 s62,s62,32768
s_add_u32 m0,m0,1024
s_waitcnt vmcnt(2)
buffer_load_dwordx4 v16,s[28:31],s62 offen nt lds
s_add_u32 s62,s62,32768
s_add_u32 m0,m0,1024
s_waitcnt vmcnt(2)
buffer_load_dwordx4 v16,s[28:31],s62 offen nt lds
s_add_u32 s62,s62,32768
s_add_u32 m0,m0,1024
s_waitcnt vmcnt(2)
buffer_load_dwordx4 v16,s[28:31],s62 offen nt lds
s_add_u32 s62,s62,32768
s_add_u32 m0,m0,1024
s_waitcnt vmcnt(2)
buffer_load_dwordx4 v16,s[28:31],s62 offen nt lds
s_waitcnt vmcnt(2)
s_xor_b32 s62,s50,1
s_mul_i32 s62,s62,458752
s_add_u32 s62,s62,s54
s_add_u32 m0,s61,16384
s_nop 0
buffer_load_dwordx4 v16,s[28:31],s62 offen nt lds
s_add_u32 s62,s62,32768
s_add_u32 m0,m0,1024
s_waitcnt vmcnt(2)
buffer_load_dwordx4 v16,s[28:31],s62 offen nt lds
s_add_u32 s62,s62,32768
s_add_u32 m0,m0,1024
s_waitcnt vmcnt(2)
buffer_load_dwordx4 v16,s[28:31],s62 offen nt lds
s_add_u32 s62,s62,32768
s_add_u32 m0,m0,1024
s_waitcnt vmcnt(2)
buffer_load_dwordx4 v16,s[28:31],s62 offen nt lds
s_add_u32 s62,s62,32768
s_add_u32 m0,m0,1024
s_waitcnt vmcnt(2)
buffer_load_dwordx4 v16,s[28:31],s62 offen nt lds
s_add_u32 s62,s62,32768
s_add_u32 m0,m0,1024
s_waitcnt vmcnt(2)
buffer_load_dwordx4 v16,s[28:31],s62 offen nt lds
s_add_u32 s62,s62,32768
s_add_u32 m0,m0,1024
s_waitcnt vmcnt(2)
buffer_load_dwordx4 v16,s[28:31],s62 offen nt lds
s_add_u32 s62,s62,32768
s_add_u32 m0,m0,1024
s_waitcnt vmcnt(2)
buffer_load_dwordx4 v16,s[28:31],s62 offen nt lds
s_add_u32 s62,s62,32768
s_add_u32 m0,m0,1024
s_waitcnt vmcnt(2)
buffer_load_dwordx4 v16,s[28:31],s62 offen nt lds
s_add_u32 s62,s62,32768
s_add_u32 m0,m0,1024
s_waitcnt vmcnt(2)
buffer_load_dwordx4 v16,s[28:31],s62 offen nt lds
s_add_u32 s62,s62,32768
s_add_u32 m0,m0,1024
s_waitcnt vmcnt(2)
buffer_load_dwordx4 v16,s[28:31],s62 offen nt lds
s_add_u32 s62,s62,32768
s_add_u32 m0,m0,1024
s_waitcnt vmcnt(2)
buffer_load_dwordx4 v16,s[28:31],s62 offen nt lds
s_add_u32 s62,s62,32768
s_add_u32 m0,m0,1024
s_waitcnt vmcnt(2)
buffer_load_dwordx4 v16,s[28:31],s62 offen nt lds
s_add_u32 s62,s62,32768
s_add_u32 m0,m0,1024
s_waitcnt vmcnt(2)
buffer_load_dwordx4 v16,s[28:31],s62 offen nt lds
s_waitcnt vmcnt(2)
s_waitcnt vmcnt(14)
ds_read_b64_tr_b16 a[0:1],v17 offset:0
ds_read_b64_tr_b16 a[2:3],v17 offset:256
ds_read_b64_tr_b16 a[4:5],v17 offset:8
ds_read_b64_tr_b16 a[6:7],v17 offset:264
ds_read_b64_tr_b16 a[8:9],v17 offset:2048
ds_read_b64_tr_b16 a[10:11],v17 offset:2304
ds_read_b64_tr_b16 a[12:13],v17 offset:2056
ds_read_b64_tr_b16 a[14:15],v17 offset:2312
ds_read_b64_tr_b16 a[16:17],v17 offset:4096
ds_read_b64_tr_b16 a[18:19],v17 offset:4352
ds_read_b64_tr_b16 a[20:21],v17 offset:4104
ds_read_b64_tr_b16 a[22:23],v17 offset:4360
s_waitcnt lgkmcnt(0)
ds_read_b64_tr_b16 a[24:25],v17 offset:6144
ds_read_b64_tr_b16 a[26:27],v17 offset:6400
ds_read_b64_tr_b16 a[28:29],v17 offset:6152
ds_read_b64_tr_b16 a[30:31],v17 offset:6408
ds_read_b64_tr_b16 a[32:33],v17 offset:8192
ds_read_b64_tr_b16 a[34:35],v17 offset:8448
ds_read_b64_tr_b16 a[36:37],v17 offset:8200
ds_read_b64_tr_b16 a[38:39],v17 offset:8456
ds_read_b64_tr_b16 a[40:41],v17 offset:10240
ds_read_b64_tr_b16 a[42:43],v17 offset:10496
ds_read_b64_tr_b16 a[44:45],v17 offset:10248
ds_read_b64_tr_b16 a[46:47],v17 offset:10504
s_waitcnt lgkmcnt(0)
ds_read_b64_tr_b16 a[48:49],v17 offset:12288
ds_read_b64_tr_b16 a[50:51],v17 offset:12544
ds_read_b64_tr_b16 a[52:53],v17 offset:12296
ds_read_b64_tr_b16 a[54:55],v17 offset:12552
s_waitcnt lgkmcnt(0)
s_xor_b32 s62,s50,2
s_mul_i32 s62,s62,458752
s_add_u32 s62,s62,s54
s_add_u32 m0,s61,0
s_nop 0
buffer_load_dwordx4 v16,s[28:31],s62 offen nt lds
s_add_u32 s62,s62,32768
s_add_u32 m0,m0,1024
s_waitcnt vmcnt(2)
buffer_load_dwordx4 v16,s[28:31],s62 offen nt lds
s_add_u32 s62,s62,32768
s_add_u32 m0,m0,1024
s_waitcnt vmcnt(2)
buffer_load_dwordx4 v16,s[28:31],s62 offen nt lds
s_add_u32 s62,s62,32768
s_add_u32 m0,m0,1024
s_waitcnt vmcnt(2)
buffer_load_dwordx4 v16,s[28:31],s62 offen nt lds
s_add_u32 s62,s62,32768
s_add_u32 m0,m0,1024
s_waitcnt vmcnt(2)
buffer_load_dwordx4 v16,s[28:31],s62 offen nt lds
s_add_u32 s62,s62,32768
s_add_u32 m0,m0,1024
s_waitcnt vmcnt(2)
buffer_load_dwordx4 v16,s[28:31],s62 offen nt lds
s_add_u32 s62,s62,32768
s_add_u32 m0,m0,1024
s_waitcnt vmcnt(2)
buffer_load_dwordx4 v16,s[28:31],s62 offen nt lds
s_add_u32 s62,s62,32768
s_add_u32 m0,m0,1024
s_waitcnt vmcnt(2)
buffer_load_dwordx4 v16,s[28:31],s62 offen nt lds
s_add_u32 s62,s62,32768
s_add_u32 m0,m0,1024
s_waitcnt vmcnt(2)
buffer_load_dwordx4 v16,s[28:31],s62 offen nt lds
s_add_u32 s62,s62,32768
s_add_u32 m0,m0,1024
s_waitcnt vmcnt(2)
buffer_load_dwordx4 v16,s[28:31],s62 offen nt lds
s_add_u32 s62,s62,32768
s_add_u32 m0,m0,1024
s_waitcnt vmcnt(2)
buffer_load_dwordx4 v16,s[28:31],s62 offen nt lds
s_add_u32 s62,s62,32768
s_add_u32 m0,m0,1024
s_waitcnt vmcnt(2)
buffer_load_dwordx4 v16,s[28:31],s62 offen nt lds
s_add_u32 s62,s62,32768
s_add_u32 m0,m0,1024
s_waitcnt vmcnt(2)
buffer_load_dwordx4 v16,s[28:31],s62 offen nt lds
s_add_u32 s62,s62,32768
s_add_u32 m0,m0,1024
s_waitcnt vmcnt(2)
buffer_load_dwordx4 v16,s[28:31],s62 offen nt lds
s_waitcnt vmcnt(2)
s_waitcnt vmcnt(14)
ds_read_b64_tr_b16 a[56:57],v17 offset:16384
ds_read_b64_tr_b16 a[58:59],v17 offset:16640
ds_read_b64_tr_b16 a[60:61],v17 offset:16392
ds_read_b64_tr_b16 a[62:63],v17 offset:16648
ds_read_b64_tr_b16 a[64:65],v17 offset:18432
ds_read_b64_tr_b16 a[66:67],v17 offset:18688
ds_read_b64_tr_b16 a[68:69],v17 offset:18440
ds_read_b64_tr_b16 a[70:71],v17 offset:18696
ds_read_b64_tr_b16 a[72:73],v17 offset:20480
ds_read_b64_tr_b16 a[74:75],v17 offset:20736
ds_read_b64_tr_b16 a[76:77],v17 offset:20488
ds_read_b64_tr_b16 a[78:79],v17 offset:20744
s_waitcnt lgkmcnt(0)
ds_read_b64_tr_b16 a[80:81],v17 offset:22528
ds_read_b64_tr_b16 a[82:83],v17 offset:22784
ds_read_b64_tr_b16 a[84:85],v17 offset:22536
ds_read_b64_tr_b16 a[86:87],v17 offset:22792
ds_read_b64_tr_b16 a[88:89],v17 offset:24576
ds_read_b64_tr_b16 a[90:91],v17 offset:24832
ds_read_b64_tr_b16 a[92:93],v17 offset:24584
ds_read_b64_tr_b16 a[94:95],v17 offset:24840
ds_read_b64_tr_b16 a[96:97],v17 offset:26624
ds_read_b64_tr_b16 a[98:99],v17 offset:26880
ds_read_b64_tr_b16 a[100:101],v17 offset:26632
ds_read_b64_tr_b16 a[102:103],v17 offset:26888
s_waitcnt lgkmcnt(0)
ds_read_b64_tr_b16 a[104:105],v17 offset:28672
ds_read_b64_tr_b16 a[106:107],v17 offset:28928
ds_read_b64_tr_b16 a[108:109],v17 offset:28680
ds_read_b64_tr_b16 a[110:111],v17 offset:28936
s_waitcnt lgkmcnt(0)
s_xor_b32 s62,s50,3
s_mul_i32 s62,s62,458752
s_add_u32 s62,s62,s54
s_add_u32 m0,s61,16384
s_nop 0
buffer_load_dwordx4 v16,s[28:31],s62 offen nt lds
s_add_u32 s62,s62,32768
s_add_u32 m0,m0,1024
s_waitcnt vmcnt(2)
buffer_load_dwordx4 v16,s[28:31],s62 offen nt lds
s_add_u32 s62,s62,32768
s_add_u32 m0,m0,1024
s_waitcnt vmcnt(2)
buffer_load_dwordx4 v16,s[28:31],s62 offen nt lds
s_add_u32 s62,s62,32768
s_add_u32 m0,m0,1024
s_waitcnt vmcnt(2)
buffer_load_dwordx4 v16,s[28:31],s62 offen nt lds
s_add_u32 s62,s62,32768
s_add_u32 m0,m0,1024
s_waitcnt vmcnt(2)
buffer_load_dwordx4 v16,s[28:31],s62 offen nt lds
s_add_u32 s62,s62,32768
s_add_u32 m0,m0,1024
s_waitcnt vmcnt(2)
buffer_load_dwordx4 v16,s[28:31],s62 offen nt lds
s_add_u32 s62,s62,32768
s_add_u32 m0,m0,1024
s_waitcnt vmcnt(2)
buffer_load_dwordx4 v16,s[28:31],s62 offen nt lds
s_add_u32 s62,s62,32768
s_add_u32 m0,m0,1024
s_waitcnt vmcnt(2)
buffer_load_dwordx4 v16,s[28:31],s62 offen nt lds
s_add_u32 s62,s62,32768
s_add_u32 m0,m0,1024
s_waitcnt vmcnt(2)
buffer_load_dwordx4 v16,s[28:31],s62 offen nt lds
s_add_u32 s62,s62,32768
s_add_u32 m0,m0,1024
s_waitcnt vmcnt(2)
buffer_load_dwordx4 v16,s[28:31],s62 offen nt lds
s_add_u32 s62,s62,32768
s_add_u32 m0,m0,1024
s_waitcnt vmcnt(2)
buffer_load_dwordx4 v16,s[28:31],s62 offen nt lds
s_add_u32 s62,s62,32768
s_add_u32 m0,m0,1024
s_waitcnt vmcnt(2)
buffer_load_dwordx4 v16,s[28:31],s62 offen nt lds
s_add_u32 s62,s62,32768
s_add_u32 m0,m0,1024
s_waitcnt vmcnt(2)
buffer_load_dwordx4 v16,s[28:31],s62 offen nt lds
s_add_u32 s62,s62,32768
s_add_u32 m0,m0,1024
s_waitcnt vmcnt(2)
buffer_load_dwordx4 v16,s[28:31],s62 offen nt lds
s_waitcnt vmcnt(2)
s_waitcnt vmcnt(14)
ds_read_b64_tr_b16 a[112:113],v17 offset:0
ds_read_b64_tr_b16 a[114:115],v17 offset:256
ds_read_b64_tr_b16 a[116:117],v17 offset:8
ds_read_b64_tr_b16 a[118:119],v17 offset:264
ds_read_b64_tr_b16 a[120:121],v17 offset:2048
ds_read_b64_tr_b16 a[122:123],v17 offset:2304
ds_read_b64_tr_b16 a[124:125],v17 offset:2056
ds_read_b64_tr_b16 a[126:127],v17 offset:2312
ds_read_b64_tr_b16 a[128:129],v17 offset:4096
ds_read_b64_tr_b16 a[130:131],v17 offset:4352
ds_read_b64_tr_b16 a[132:133],v17 offset:4104
ds_read_b64_tr_b16 a[134:135],v17 offset:4360
s_waitcnt lgkmcnt(0)
ds_read_b64_tr_b16 a[136:137],v17 offset:6144
ds_read_b64_tr_b16 a[138:139],v17 offset:6400
ds_read_b64_tr_b16 a[140:141],v17 offset:6152
ds_read_b64_tr_b16 a[142:143],v17 offset:6408
ds_read_b64_tr_b16 a[144:145],v17 offset:8192
ds_read_b64_tr_b16 a[146:147],v17 offset:8448
ds_read_b64_tr_b16 a[148:149],v17 offset:8200
ds_read_b64_tr_b16 a[150:151],v17 offset:8456
ds_read_b64_tr_b16 a[152:153],v17 offset:10240
ds_read_b64_tr_b16 a[154:155],v17 offset:10496
ds_read_b64_tr_b16 a[156:157],v17 offset:10248
ds_read_b64_tr_b16 a[158:159],v17 offset:10504
s_waitcnt lgkmcnt(0)
ds_read_b64_tr_b16 a[160:161],v17 offset:12288
ds_read_b64_tr_b16 a[162:163],v17 offset:12544
ds_read_b64_tr_b16 a[164:165],v17 offset:12296
ds_read_b64_tr_b16 a[166:167],v17 offset:12552
s_waitcnt lgkmcnt(0)
s_waitcnt vmcnt(0)
ds_read_b64_tr_b16 a[168:169],v17 offset:16384
ds_read_b64_tr_b16 a[170:171],v17 offset:16640
ds_read_b64_tr_b16 a[172:173],v17 offset:16392
ds_read_b64_tr_b16 a[174:175],v17 offset:16648
ds_read_b64_tr_b16 a[176:177],v17 offset:18432
ds_read_b64_tr_b16 a[178:179],v17 offset:18688
ds_read_b64_tr_b16 a[180:181],v17 offset:18440
ds_read_b64_tr_b16 a[182:183],v17 offset:18696
ds_read_b64_tr_b16 a[184:185],v17 offset:20480
ds_read_b64_tr_b16 a[186:187],v17 offset:20736
ds_read_b64_tr_b16 a[188:189],v17 offset:20488
ds_read_b64_tr_b16 a[190:191],v17 offset:20744
s_waitcnt lgkmcnt(0)
ds_read_b64_tr_b16 a[192:193],v17 offset:22528
ds_read_b64_tr_b16 a[194:195],v17 offset:22784
ds_read_b64_tr_b16 a[196:197],v17 offset:22536
ds_read_b64_tr_b16 a[198:199],v17 offset:22792
ds_read_b64_tr_b16 a[200:201],v17 offset:24576
ds_read_b64_tr_b16 a[202:203],v17 offset:24832
ds_read_b64_tr_b16 a[204:205],v17 offset:24584
ds_read_b64_tr_b16 a[206:207],v17 offset:24840
ds_read_b64_tr_b16 a[208:209],v17 offset:26624
ds_read_b64_tr_b16 a[210:211],v17 offset:26880
ds_read_b64_tr_b16 a[212:213],v17 offset:26632
ds_read_b64_tr_b16 a[214:215],v17 offset:26888
s_waitcnt lgkmcnt(0)
ds_read_b64_tr_b16 a[216:217],v17 offset:28672
ds_read_b64_tr_b16 a[218:219],v17 offset:28928
ds_read_b64_tr_b16 a[220:221],v17 offset:28680
ds_read_b64_tr_b16 a[222:223],v17 offset:28936
s_waitcnt lgkmcnt(0)
s_mov_b32 s92,s2
s_and_b32 s93,s3,0xffff
s_mov_b32 s94,0x100
s_mov_b32 s95,0x20000
v_mbcnt_lo_u32_b32 v16,-1,0
v_mbcnt_hi_u32_b32 v16,-1,v16
v_mov_b32 v18,0
v_cmp_eq_u32 vcc,22,v16
s_nop 1
v_cndmask_b32 v18,v18,63,vcc
v_cmp_eq_u32 vcc,17,v16
s_nop 1
v_cndmask_b32 v18,v18,63,vcc
v_cmp_eq_u32 vcc,18,v16
s_nop 1
v_cndmask_b32 v18,v18,1,vcc
v_and_b32 v19,1,v16
v_cmp_eq_u32 vcc,1,v19
v_mov_b32 v19,8192
s_nop 0
v_cndmask_b32 v19,-1,v19,vcc
v_min_u32 v16,31,v16
v_lshlrev_b32 v16,2,v16
s_sub_u32 s66,s88,64
s_cmp_lg_u32 s50,0
s_cbranch_scc1 vot_191
vpoll_187:
buffer_load_dword v17,v16,s[92:95],s66 offen sc1
s_waitcnt vmcnt(0)
s_cmp_lg_u32 s56,2
s_cbranch_scc1 vck_188
v_cmp_eq_u32 vcc,v17,v19
s_and_b32 s64,vcc_lo,0xffff
s_cmp_eq_u32 s64,65535
s_cbranch_scc1 vck_188
s_mov_b32 s65,0
v_readlane_b32 s64,v17,1
s_lshr_b32 s64,s64,8
s_add_u32 s65,s65,s64
v_readlane_b32 s64,v17,3
s_lshr_b32 s64,s64,8
s_add_u32 s65,s65,s64
v_readlane_b32 s64,v17,5
s_lshr_b32 s64,s64,8
s_add_u32 s65,s65,s64
v_readlane_b32 s64,v17,7
s_lshr_b32 s64,s64,8
s_add_u32 s65,s65,s64
v_readlane_b32 s64,v17,9
s_lshr_b32 s64,s64,8
s_add_u32 s65,s65,s64
v_readlane_b32 s64,v17,11
s_lshr_b32 s64,s64,8
s_add_u32 s65,s65,s64
v_readlane_b32 s64,v17,13
s_lshr_b32 s64,s64,8
s_add_u32 s65,s65,s64
v_readlane_b32 s64,v17,15
s_lshr_b32 s64,s64,8
s_add_u32 s65,s65,s64
s_cmp_ge_u32 s65,256
s_cbranch_scc1 vok_190
s_branch vrt_189
vck_188:
v_cmp_gt_u32 vcc,v18,v17
s_cbranch_vccz vok_190
vrt_189:
s_sleep 48
s_sub_u32 s90,s90,1
s_cmp_gt_i32 s90,0
s_cbranch_scc1 vpoll_187
vok_190:
v_add_u32 v18,160000,v16
ds_write_b32 v18,v17
s_waitcnt lgkmcnt(0)
vot_191:
s_barrier
v_add_u32 v18,160000,v16
ds_read_b32 v17,v18
s_waitcnt lgkmcnt(0)
s_cmp_lg_u32 s56,2
s_cbranch_scc1 vfin_192
v_cmp_eq_u32 vcc,v17,v19
s_and_b32 s64,vcc_lo,0xffff
s_cmp_eq_u32 s64,65535
s_cbranch_scc1 vfin_192
s_mov_b32 s65,0
v_readlane_b32 s64,v17,1
s_lshr_b32 s64,s64,8
s_add_u32 s65,s65,s64
v_readlane_b32 s64,v17,3
s_lshr_b32 s64,s64,8
s_add_u32 s65,s65,s64
v_readlane_b32 s64,v17,5
s_lshr_b32 s64,s64,8
s_add_u32 s65,s65,s64
v_readlane_b32 s64,v17,7
s_lshr_b32 s64,s64,8
s_add_u32 s65,s65,s64
v_readlane_b32 s64,v17,9
s_lshr_b32 s64,s64,8
s_add_u32 s65,s65,s64
v_readlane_b32 s64,v17,11
s_lshr_b32 s64,s64,8
s_add_u32 s65,s65,s64
v_readlane_b32 s64,v17,13
s_lshr_b32 s64,s64,8
s_add_u32 s65,s65,s64
v_readlane_b32 s64,v17,15
s_lshr_b32 s64,s64,8
s_add_u32 s65,s65,s64
s_cmp_ge_u32 s65,256
s_cbranch_scc1 fl_fb
vfin_192:
s_and_b32 s56,s56,1
s_mov_b32 s67,0
s_barrier
v_lshlrev_b32 v0,4,v1
s_mov_b32 s60,0
s_lshl_b32 s70,s50,13
s_mov_b32 s55,0
v_mov_b32 v3,v0
s_mov_b32 s73,0xffff0000
s_lshl_b32 s64,s52,2
s_add_u32 s64,s64,s50
s_mul_i32 s61,s64,7168
s_add_u32 s61,s61,219152384
s_lshl_b32 s68,s64,8
s_add_u32 s68,s68,138551296
s_lshl_b32 s83,s53,2
s_add_u32 s83,s83,s50
s_mov_b32 s63,0
s_xor_b32 s64,s50,0
s_lshl_b32 s64,s64,13
v_add_u32 v8,s64,v0
v_mov_b32 v4,v8
s_xor_b32 s64,s50,1
s_lshl_b32 s64,s64,13
v_add_u32 v9,s64,v0
v_mov_b32 v5,v9
s_xor_b32 s64,s50,2
s_lshl_b32 s64,s64,13
v_add_u32 v10,s64,v0
v_mov_b32 v6,v10
s_xor_b32 s64,s50,3
s_lshl_b32 s64,s64,13
v_add_u32 v11,s64,v0
v_mov_b32 v7,v11
v_min_u32 v2,6,v1
v_lshlrev_b32 v2,2,v2
s_add_u32 s62,s61,4096
s_lshl_b32 s66,s83,10
s_lshr_b32 s65,s83,3
s_lshl_b32 s65,s65,8
s_and_b32 s64,s83,7
s_lshl_b32 s64,s64,2
s_add_u32 s69,s64,s65
s_add_u32 s69,s69,138555392
s_add_u32 s82,s66,201326592
s_lshl_b32 s64,s53,2
s_add_u32 s64,s64,s50
s_mul_i32 s74,s64,24576
s_xor_b32 s64,s50,s52
s_sub_u32 s64,s64,1
s_max_i32 s64,s64,0
s_lshl_b32 s64,s64,11
s_add_u32 s74,s74,s64
s_add_u32 s74,s74,168558592
s_mov_b32 s75,0
s_mov_b32 s77,0
v_lshlrev_b32 v26,11,v21
v_lshl_add_u32 v26,v22,4,v26
s_lshl_b32 s64,s83,6
v_add_u32 v18,s64,v26
v_lshlrev_b32 v26,5,v22
s_lshl_b32 s64,s83,7
s_add_u32 s64,s64,267407360
buffer_load_dwordx4 v[152:155],v26,s[20:23],s64 offen offset:0 sc1
buffer_load_dwordx4 v[156:159],v26,s[20:23],s64 offen offset:16 sc1
s_add_u32 s64,s64,24576
buffer_load_dwordx4 v[128:131],v26,s[20:23],s64 offen offset:0 sc1
buffer_load_dwordx4 v[132:135],v26,s[20:23],s64 offen offset:16 sc1
s_add_u32 s64,s64,24576
buffer_load_dwordx4 v[136:139],v26,s[20:23],s64 offen offset:0 sc1
buffer_load_dwordx4 v[140:143],v26,s[20:23],s64 offen offset:16 sc1
s_add_u32 s64,s64,24576
buffer_load_dwordx4 v[144:147],v26,s[20:23],s64 offen offset:0 sc1
buffer_load_dwordx4 v[148:151],v26,s[20:23],s64 offen offset:16 sc1
s_add_u32 s64,s64,24576
s_waitcnt vmcnt(0)
v_pk_add_f32 v[152:153],v[152:153],v[128:129]
v_pk_add_f32 v[136:137],v[136:137],v[144:145]
v_pk_add_f32 v[154:155],v[154:155],v[130:131]
v_pk_add_f32 v[138:139],v[138:139],v[146:147]
v_pk_add_f32 v[156:157],v[156:157],v[132:133]
v_pk_add_f32 v[140:141],v[140:141],v[148:149]
v_pk_add_f32 v[158:159],v[158:159],v[134:135]
v_pk_add_f32 v[142:143],v[142:143],v[150:151]
v_pk_add_f32 v[152:153],v[152:153],v[136:137]
v_pk_add_f32 v[154:155],v[154:155],v[138:139]
v_pk_add_f32 v[156:157],v[156:157],v[140:141]
v_pk_add_f32 v[158:159],v[158:159],v[142:143]
v_cvt_pk_bf16_f32 v128,v152,v153
v_cvt_pk_bf16_f32 v129,v154,v155
v_cvt_pk_bf16_f32 v130,v156,v157
v_cvt_pk_bf16_f32 v131,v158,v159
v_lshlrev_b32 v152,16,v128
v_and_b32 v153,s73,v128
v_lshlrev_b32 v154,16,v129
v_and_b32 v155,s73,v129
v_lshlrev_b32 v156,16,v130
v_and_b32 v157,s73,v130
v_lshlrev_b32 v158,16,v131
v_and_b32 v159,s73,v131
v_mov_b32 v204,-1
v_mov_b32 v205,-1
v_mov_b32 v206,-1
v_mov_b32 v207,-1
v_cmp_eq_u32 vcc,0,v1
s_nop 1
v_cndmask_b32 v26,2.0,0,vcc
s_cmp_eq_u32 s50,s52
s_cbranch_scc1 lfin_193
s_add_u32 s71,s60,1
s_add_u32 s53,s60,2
plp_203:
buffer_load_dword v16,v2,s[20:23],s68 offen sc1
s_waitcnt vmcnt(0)
v_cmp_gt_u32 vcc,s71,v16
s_cbranch_vccz pok_204
s_sleep 4
s_sub_u32 s90,s90,1
s_cmp_gt_i32 s90,0
s_cbranch_scc1 plp_203
pok_204:
lag_200:
s_mov_b32 m0,s70
s_nop 0
buffer_load_dwordx4 v3,s[20:23],s61 offen offset:0 lds
buffer_load_dwordx4 v3,s[20:23],s61 offen offset:1024 lds
buffer_load_dwordx4 v3,s[20:23],s61 offen offset:2048 lds
buffer_load_dwordx4 v3,s[20:23],s61 offen offset:3072 lds
s_add_u32 m0,s70,4096
s_nop 0
buffer_load_dwordx4 v3,s[20:23],s62 offen offset:0 lds
buffer_load_dwordx4 v3,s[20:23],s62 offen offset:1024 lds
buffer_load_dwordx4 v3,s[20:23],s62 offen offset:2048 lds
s_add_u32 s61,s61,114688
s_add_u32 s62,s62,114688
s_add_u32 s70,s70,32768
s_and_b32 s70,s70,0x1ffff
buffer_load_dword v23,off,s[20:23],s66
buffer_load_dword v23,off,s[20:23],s66
dec_201:
v_cmp_gt_u32 vcc,s53,v16
s_cbranch_vccnz BN_199
BR_198:
s_waitcnt vmcnt(8)
ds_read_b128 v[64:67],v4 offset:0
s_waitcnt vmcnt(7)
ds_read_b128 v[68:71],v4 offset:1024
s_waitcnt vmcnt(6)
ds_read_b128 v[72:75],v4 offset:2048
s_waitcnt vmcnt(5)
ds_read_b128 v[76:79],v4 offset:3072
s_waitcnt lgkmcnt(3)
v_mfma_f32_16x16x32_bf16 v[32:35],a[0:3],v[64:67],0
s_add_u32 s71,s60,2
s_add_u32 s53,s60,3
v_mfma_f32_16x16x32_bf16 v[36:39],a[4:7],v[64:67],0
s_waitcnt lgkmcnt(2)
s_waitcnt vmcnt(4)
ds_read_b128 v[80:83],v4 offset:4096
v_mfma_f32_16x16x32_bf16 v[32:35],a[8:11],v[68:71],v[32:35]
v_mfma_f32_16x16x32_bf16 v[36:39],a[12:15],v[68:71],v[36:39]
s_waitcnt lgkmcnt(2)
s_waitcnt vmcnt(3)
s_mov_b32 m0,s70
ds_read_b128 v[84:87],v4 offset:5120
v_mfma_f32_16x16x32_bf16 v[32:35],a[16:19],v[72:75],v[32:35]
buffer_load_dwordx4 v3,s[20:23],s61 offen offset:0 lds
v_mfma_f32_16x16x32_bf16 v[36:39],a[20:23],v[72:75],v[36:39]
s_waitcnt lgkmcnt(2)
s_waitcnt vmcnt(3)
ds_read_b128 v[88:91],v4 offset:6144
v_mfma_f32_16x16x32_bf16 v[32:35],a[24:27],v[76:79],v[32:35]
buffer_load_dwordx4 v3,s[20:23],s61 offen offset:1024 lds
v_mfma_f32_16x16x32_bf16 v[36:39],a[28:31],v[76:79],v[36:39]
s_waitcnt lgkmcnt(2)
s_barrier
ds_read_b128 v[92:95],v5 offset:0
v_mfma_f32_16x16x32_bf16 v[32:35],a[32:35],v[80:83],v[32:35]
ds_read_b128 v[96:99],v5 offset:1024
v_mfma_f32_16x16x32_bf16 v[36:39],a[36:39],v[80:83],v[36:39]
s_waitcnt lgkmcnt(3)
ds_read_b128 v[100:103],v5 offset:2048
buffer_load_dwordx4 v3,s[20:23],s61 offen offset:2048 lds
v_mfma_f32_16x16x32_bf16 v[32:35],a[40:43],v[84:87],v[32:35]
ds_read_b128 v[104:107],v5 offset:3072
v_mfma_f32_16x16x32_bf16 v[36:39],a[44:47],v[84:87],v[36:39]
s_waitcnt lgkmcnt(4)
ds_read_b128 v[108:111],v5 offset:4096
v_mfma_f32_16x16x32_bf16 v[32:35],a[48:51],v[88:91],v[32:35]
ds_read_b128 v[112:115],v5 offset:5120
buffer_load_dwordx4 v3,s[20:23],s61 offen offset:3072 lds
v_mfma_f32_16x16x32_bf16 v[36:39],a[52:55],v[88:91],v[36:39]
s_waitcnt lgkmcnt(5)
v_mfma_f32_16x16x32_bf16 v[32:35],a[56:59],v[92:95],v[32:35]
ds_read_b128 v[116:119],v5 offset:6144
v_mfma_f32_16x16x32_bf16 v[36:39],a[60:63],v[92:95],v[36:39]
s_waitcnt lgkmcnt(5)
s_add_u32 m0,s70,4096
v_mfma_f32_16x16x32_bf16 v[32:35],a[64:67],v[96:99],v[32:35]
ds_read_b128 v[120:123],v6 offset:0
buffer_load_dwordx4 v3,s[20:23],s62 offen offset:0 lds
v_mfma_f32_16x16x32_bf16 v[36:39],a[68:71],v[96:99],v[36:39]
s_waitcnt lgkmcnt(5)
v_mfma_f32_16x16x32_bf16 v[32:35],a[72:75],v[100:103],v[32:35]
ds_read_b128 v[124:127],v6 offset:1024
v_mfma_f32_16x16x32_bf16 v[36:39],a[76:79],v[100:103],v[36:39]
s_waitcnt lgkmcnt(5)
buffer_load_dwordx4 v3,s[20:23],s62 offen offset:1024 lds
v_mfma_f32_16x16x32_bf16 v[32:35],a[80:83],v[104:107],v[32:35]
ds_read_b128 v[64:67],v6 offset:2048
v_mfma_f32_16x16x32_bf16 v[36:39],a[84:87],v[104:107],v[36:39]
s_waitcnt lgkmcnt(5)
buffer_load_dword v16,v2,s[20:23],s68 offen sc1
v_mfma_f32_16x16x32_bf16 v[32:35],a[88:91],v[108:111],v[32:35]
ds_read_b128 v[68:71],v6 offset:3072
buffer_load_dwordx4 v3,s[20:23],s62 offen offset:2048 lds
v_mfma_f32_16x16x32_bf16 v[36:39],a[92:95],v[108:111],v[36:39]
s_waitcnt lgkmcnt(5)
v_mfma_f32_16x16x32_bf16 v[32:35],a[96:99],v[112:115],v[32:35]
ds_read_b128 v[72:75],v6 offset:4096
v_mfma_f32_16x16x32_bf16 v[36:39],a[100:103],v[112:115],v[36:39]
s_waitcnt lgkmcnt(5)
v_mfma_f32_16x16x32_bf16 v[32:35],a[104:107],v[116:119],v[32:35]
ds_read_b128 v[76:79],v6 offset:5120
v_mfma_f32_16x16x32_bf16 v[36:39],a[108:111],v[116:119],v[36:39]
s_waitcnt lgkmcnt(5)
v_mfma_f32_16x16x32_bf16 v[32:35],a[112:115],v[120:123],v[32:35]
ds_read_b128 v[80:83],v6 offset:6144
v_mfma_f32_16x16x32_bf16 v[36:39],a[116:119],v[120:123],v[36:39]
s_waitcnt lgkmcnt(5)
v_mfma_f32_16x16x32_bf16 v[32:35],a[120:123],v[124:127],v[32:35]
ds_read_b128 v[84:87],v7 offset:0
v_mfma_f32_16x16x32_bf16 v[36:39],a[124:127],v[124:127],v[36:39]
s_waitcnt lgkmcnt(5)
v_mfma_f32_16x16x32_bf16 v[32:35],a[128:131],v[64:67],v[32:35]
ds_read_b128 v[88:91],v7 offset:1024
v_mfma_f32_16x16x32_bf16 v[36:39],a[132:135],v[64:67],v[36:39]
s_waitcnt lgkmcnt(5)
v_mfma_f32_16x16x32_bf16 v[32:35],a[136:139],v[68:71],v[32:35]
ds_read_b128 v[92:95],v7 offset:2048
v_mfma_f32_16x16x32_bf16 v[36:39],a[140:143],v[68:71],v[36:39]
s_waitcnt lgkmcnt(5)
v_mfma_f32_16x16x32_bf16 v[32:35],a[144:147],v[72:75],v[32:35]
ds_read_b128 v[96:99],v7 offset:3072
v_mfma_f32_16x16x32_bf16 v[36:39],a[148:151],v[72:75],v[36:39]
s_waitcnt lgkmcnt(5)
v_mfma_f32_16x16x32_bf16 v[32:35],a[152:155],v[76:79],v[32:35]
ds_read_b128 v[100:103],v7 offset:4096
v_mfma_f32_16x16x32_bf16 v[36:39],a[156:159],v[76:79],v[36:39]
s_waitcnt lgkmcnt(5)
v_mfma_f32_16x16x32_bf16 v[32:35],a[160:163],v[80:83],v[32:35]
ds_read_b128 v[104:107],v7 offset:5120
v_mfma_f32_16x16x32_bf16 v[36:39],a[164:167],v[80:83],v[36:39]
s_waitcnt lgkmcnt(5)
v_mfma_f32_16x16x32_bf16 v[32:35],a[168:171],v[84:87],v[32:35]
ds_read_b128 v[108:111],v7 offset:6144
v_mfma_f32_16x16x32_bf16 v[36:39],a[172:175],v[84:87],v[36:39]
s_waitcnt lgkmcnt(5)
s_add_u32 s61,s61,114688
s_add_u32 s62,s62,114688
v_mfma_f32_16x16x32_bf16 v[32:35],a[176:179],v[88:91],v[32:35]
s_add_u32 s70,s70,32768
s_and_b32 s70,s70,0x1ffff
s_add_u32 s55,s55,32768
v_mfma_f32_16x16x32_bf16 v[36:39],a[180:183],v[88:91],v[36:39]
s_waitcnt lgkmcnt(4)
s_and_b32 s55,s55,0x1ffff
v_add_u32 v4,s55,v8
v_mfma_f32_16x16x32_bf16 v[32:35],a[184:187],v[92:95],v[32:35]
v_add_u32 v5,s55,v9
v_add_u32 v6,s55,v10
v_mfma_f32_16x16x32_bf16 v[36:39],a[188:191],v[92:95],v[36:39]
s_waitcnt lgkmcnt(3)
v_add_u32 v7,s55,v11
v_mfma_f32_16x16x32_bf16 v[32:35],a[192:195],v[96:99],v[32:35]
s_waitcnt vmcnt(7)
ds_read_b128 v[64:67],v4 offset:0
v_mfma_f32_16x16x32_bf16 v[36:39],a[196:199],v[96:99],v[36:39]
s_waitcnt lgkmcnt(3)
s_waitcnt vmcnt(6)
ds_read_b128 v[68:71],v4 offset:1024
v_mfma_f32_16x16x32_bf16 v[32:35],a[200:203],v[100:103],v[32:35]
s_waitcnt vmcnt(5)
ds_read_b128 v[72:75],v4 offset:2048
v_mfma_f32_16x16x32_bf16 v[36:39],a[204:207],v[100:103],v[36:39]
s_waitcnt lgkmcnt(4)
v_mfma_f32_16x16x32_bf16 v[32:35],a[208:211],v[104:107],v[32:35]
v_mfma_f32_16x16x32_bf16 v[36:39],a[212:215],v[104:107],v[36:39]
s_waitcnt lgkmcnt(3)
v_mfma_f32_16x16x32_bf16 v[40:43],a[216:219],v[108:111],v[32:35]
v_mfma_f32_16x16x32_bf16 v[44:47],a[220:223],v[108:111],v[36:39]
s_waitcnt vmcnt(1)
v_cmp_gt_u32 vcc,s53,v16
s_add_u32 s60,s60,1
s_cbranch_vccnz WN_197
.p2align 6
WR_196:
s_waitcnt lgkmcnt(2)
v_mfma_f32_16x16x32_bf16 v[32:35],a[0:3],v[64:67],0
s_waitcnt vmcnt(4)
s_add_u32 s71,s60,2
ds_read_b128 v[76:79],v4 offset:3072
v_mfma_f32_16x16x32_bf16 v[36:39],a[4:7],v[64:67],0
s_waitcnt lgkmcnt(2)
s_add_u32 s53,s60,3
v_mfma_f32_16x16x32_bf16 v[32:35],a[8:11],v[68:71],v[32:35]
s_waitcnt vmcnt(3)
s_mov_b32 m0,s70
ds_read_b128 v[80:83],v4 offset:4096
v_mfma_f32_16x16x32_bf16 v[36:39],a[12:15],v[68:71],v[36:39]
s_waitcnt lgkmcnt(2)
buffer_load_dwordx4 v3,s[20:23],s61 offen offset:0 lds
s_add_u32 s64,s74,s75
s_cmp_eq_u32 s56,1
s_cbranch_scc1 b1_205
buffer_store_dwordx4 v[40:43],v0,s[20:23],s64 offen offset:0
buffer_store_dwordx4 v[44:47],v0,s[20:23],s64 offen offset:1024
b2_206:
v_mfma_f32_16x16x32_bf16 v[32:35],a[16:19],v[72:75],v[32:35]
s_waitcnt vmcnt(5)
s_add_u32 s75,s75,6144
ds_read_b128 v[84:87],v4 offset:5120
v_mfma_f32_16x16x32_bf16 v[36:39],a[20:23],v[72:75],v[36:39]
s_waitcnt lgkmcnt(2)
s_cmp_eq_u32 s75,24576
s_cselect_b32 s75,0,s75
v_mfma_f32_16x16x32_bf16 v[32:35],a[24:27],v[76:79],v[32:35]
s_waitcnt vmcnt(3)
ds_read_b128 v[88:91],v4 offset:6144
buffer_load_dwordx4 v3,s[20:23],s61 offen offset:1024 lds
v_mfma_f32_16x16x32_bf16 v[36:39],a[28:31],v[76:79],v[36:39]
s_waitcnt lgkmcnt(2)
s_barrier
ds_read_b128 v[92:95],v5 offset:0
v_mfma_f32_16x16x32_bf16 v[32:35],a[32:35],v[80:83],v[32:35]
ds_read_b128 v[96:99],v5 offset:1024
v_mfma_f32_16x16x32_bf16 v[36:39],a[36:39],v[80:83],v[36:39]
s_waitcnt lgkmcnt(3)
ds_read_b128 v[100:103],v5 offset:2048
buffer_load_dwordx4 v3,s[20:23],s61 offen offset:2048 lds
v_mfma_f32_16x16x32_bf16 v[32:35],a[40:43],v[84:87],v[32:35]
ds_read_b128 v[104:107],v5 offset:3072
v_mfma_f32_16x16x32_bf16 v[36:39],a[44:47],v[84:87],v[36:39]
s_waitcnt lgkmcnt(4)
ds_read_b128 v[108:111],v5 offset:4096
v_mfma_f32_16x16x32_bf16 v[32:35],a[48:51],v[88:91],v[32:35]
ds_read_b128 v[112:115],v5 offset:5120
buffer_load_dwordx4 v3,s[20:23],s61 offen offset:3072 lds
v_mfma_f32_16x16x32_bf16 v[36:39],a[52:55],v[88:91],v[36:39]
s_waitcnt lgkmcnt(5)
v_mfma_f32_16x16x32_bf16 v[32:35],a[56:59],v[92:95],v[32:35]
ds_read_b128 v[116:119],v5 offset:6144
v_mfma_f32_16x16x32_bf16 v[36:39],a[60:63],v[92:95],v[36:39]
s_waitcnt lgkmcnt(5)
s_add_u32 m0,s70,4096
v_mfma_f32_16x16x32_bf16 v[32:35],a[64:67],v[96:99],v[32:35]
ds_read_b128 v[120:123],v6 offset:0
buffer_load_dwordx4 v3,s[20:23],s62 offen offset:0 lds
v_mfma_f32_16x16x32_bf16 v[36:39],a[68:71],v[96:99],v[36:39]
s_waitcnt lgkmcnt(5)
v_mfma_f32_16x16x32_bf16 v[32:35],a[72:75],v[100:103],v[32:35]
ds_read_b128 v[124:127],v6 offset:1024
v_mfma_f32_16x16x32_bf16 v[36:39],a[76:79],v[100:103],v[36:39]
s_waitcnt lgkmcnt(5)
buffer_load_dwordx4 v3,s[20:23],s62 offen offset:1024 lds
v_mfma_f32_16x16x32_bf16 v[32:35],a[80:83],v[104:107],v[32:35]
ds_read_b128 v[64:67],v6 offset:2048
v_mfma_f32_16x16x32_bf16 v[36:39],a[84:87],v[104:107],v[36:39]
s_waitcnt lgkmcnt(5)
buffer_load_dword v16,v2,s[20:23],s68 offen sc1
v_mfma_f32_16x16x32_bf16 v[32:35],a[88:91],v[108:111],v[32:35]
ds_read_b128 v[68:71],v6 offset:3072
buffer_load_dwordx4 v3,s[20:23],s62 offen offset:2048 lds
v_mfma_f32_16x16x32_bf16 v[36:39],a[92:95],v[108:111],v[36:39]
s_waitcnt lgkmcnt(5)
v_mfma_f32_16x16x32_bf16 v[32:35],a[96:99],v[112:115],v[32:35]
ds_read_b128 v[72:75],v6 offset:4096
v_mfma_f32_16x16x32_bf16 v[36:39],a[100:103],v[112:115],v[36:39]
s_waitcnt lgkmcnt(5)
v_mfma_f32_16x16x32_bf16 v[32:35],a[104:107],v[116:119],v[32:35]
ds_read_b128 v[76:79],v6 offset:5120
v_mfma_f32_16x16x32_bf16 v[36:39],a[108:111],v[116:119],v[36:39]
s_waitcnt lgkmcnt(5)
v_mfma_f32_16x16x32_bf16 v[32:35],a[112:115],v[120:123],v[32:35]
ds_read_b128 v[80:83],v6 offset:6144
v_mfma_f32_16x16x32_bf16 v[36:39],a[116:119],v[120:123],v[36:39]
s_waitcnt lgkmcnt(5)
v_mfma_f32_16x16x32_bf16 v[32:35],a[120:123],v[124:127],v[32:35]
ds_read_b128 v[84:87],v7 offset:0
v_mfma_f32_16x16x32_bf16 v[36:39],a[124:127],v[124:127],v[36:39]
s_waitcnt lgkmcnt(5)
v_mfma_f32_16x16x32_bf16 v[32:35],a[128:131],v[64:67],v[32:35]
ds_read_b128 v[88:91],v7 offset:1024
v_mfma_f32_16x16x32_bf16 v[36:39],a[132:135],v[64:67],v[36:39]
s_waitcnt lgkmcnt(5)
v_mfma_f32_16x16x32_bf16 v[32:35],a[136:139],v[68:71],v[32:35]
ds_read_b128 v[92:95],v7 offset:2048
v_mfma_f32_16x16x32_bf16 v[36:39],a[140:143],v[68:71],v[36:39]
s_waitcnt lgkmcnt(5)
v_mfma_f32_16x16x32_bf16 v[32:35],a[144:147],v[72:75],v[32:35]
ds_read_b128 v[96:99],v7 offset:3072
v_mfma_f32_16x16x32_bf16 v[36:39],a[148:151],v[72:75],v[36:39]
s_waitcnt lgkmcnt(5)
v_mfma_f32_16x16x32_bf16 v[32:35],a[152:155],v[76:79],v[32:35]
ds_read_b128 v[100:103],v7 offset:4096
v_mfma_f32_16x16x32_bf16 v[36:39],a[156:159],v[76:79],v[36:39]
s_waitcnt lgkmcnt(5)
v_mfma_f32_16x16x32_bf16 v[32:35],a[160:163],v[80:83],v[32:35]
ds_read_b128 v[104:107],v7 offset:5120
v_mfma_f32_16x16x32_bf16 v[36:39],a[164:167],v[80:83],v[36:39]
s_waitcnt lgkmcnt(5)
v_mfma_f32_16x16x32_bf16 v[32:35],a[168:171],v[84:87],v[32:35]
ds_read_b128 v[108:111],v7 offset:6144
v_mfma_f32_16x16x32_bf16 v[36:39],a[172:175],v[84:87],v[36:39]
s_waitcnt lgkmcnt(5)
s_add_u32 s61,s61,114688
s_add_u32 s62,s62,114688
v_mfma_f32_16x16x32_bf16 v[32:35],a[176:179],v[88:91],v[32:35]
s_add_u32 s70,s70,32768
s_and_b32 s70,s70,0x1ffff
s_add_u32 s55,s55,32768
v_mfma_f32_16x16x32_bf16 v[36:39],a[180:183],v[88:91],v[36:39]
s_waitcnt lgkmcnt(4)
s_and_b32 s55,s55,0x1ffff
v_add_u32 v4,s55,v8
v_mfma_f32_16x16x32_bf16 v[32:35],a[184:187],v[92:95],v[32:35]
v_add_u32 v5,s55,v9
v_add_u32 v6,s55,v10
v_mfma_f32_16x16x32_bf16 v[36:39],a[188:191],v[92:95],v[36:39]
s_waitcnt lgkmcnt(3)
v_add_u32 v7,s55,v11
v_mfma_f32_16x16x32_bf16 v[32:35],a[192:195],v[96:99],v[32:35]
s_waitcnt vmcnt(9)
ds_read_b128 v[64:67],v4 offset:0
v_mfma_f32_16x16x32_bf16 v[36:39],a[196:199],v[96:99],v[36:39]
s_waitcnt lgkmcnt(3)
s_waitcnt vmcnt(6)
ds_read_b128 v[68:71],v4 offset:1024
v_mfma_f32_16x16x32_bf16 v[32:35],a[200:203],v[100:103],v[32:35]
s_waitcnt vmcnt(5)
ds_read_b128 v[72:75],v4 offset:2048
v_mfma_f32_16x16x32_bf16 v[36:39],a[204:207],v[100:103],v[36:39]
s_waitcnt lgkmcnt(4)
v_mfma_f32_16x16x32_bf16 v[32:35],a[208:211],v[104:107],v[32:35]
v_mfma_f32_16x16x32_bf16 v[36:39],a[212:215],v[104:107],v[36:39]
s_waitcnt lgkmcnt(3)
v_mfma_f32_16x16x32_bf16 v[40:43],a[216:219],v[108:111],v[32:35]
v_mfma_f32_16x16x32_bf16 v[44:47],a[220:223],v[108:111],v[36:39]
s_waitcnt vmcnt(1)
v_cmp_gt_u32 vcc,s53,v16
s_add_u32 s60,s60,1
s_cbranch_vccz WR_196
WN_197:
s_waitcnt lgkmcnt(2)
v_mfma_f32_16x16x32_bf16 v[32:35],a[0:3],v[64:67],0
s_waitcnt vmcnt(4)
s_add_u32 s71,s60,2
ds_read_b128 v[76:79],v4 offset:3072
v_mfma_f32_16x16x32_bf16 v[36:39],a[4:7],v[64:67],0
s_waitcnt lgkmcnt(2)
s_add_u32 s53,s60,3
v_mfma_f32_16x16x32_bf16 v[32:35],a[8:11],v[68:71],v[32:35]
s_waitcnt vmcnt(3)
ds_read_b128 v[80:83],v4 offset:4096
v_mfma_f32_16x16x32_bf16 v[36:39],a[12:15],v[68:71],v[36:39]
s_waitcnt lgkmcnt(2)
s_add_u32 s64,s74,s75
s_cmp_eq_u32 s56,1
s_cbranch_scc1 b1_208
buffer_store_dwordx4 v[40:43],v0,s[20:23],s64 offen offset:0
buffer_store_dwordx4 v[44:47],v0,s[20:23],s64 offen offset:1024
b2_209:
v_mfma_f32_16x16x32_bf16 v[32:35],a[16:19],v[72:75],v[32:35]
s_waitcnt vmcnt(4)
s_add_u32 s75,s75,6144
ds_read_b128 v[84:87],v4 offset:5120
v_mfma_f32_16x16x32_bf16 v[36:39],a[20:23],v[72:75],v[36:39]
s_waitcnt lgkmcnt(2)
s_cmp_eq_u32 s75,24576
s_cselect_b32 s75,0,s75
v_mfma_f32_16x16x32_bf16 v[32:35],a[24:27],v[76:79],v[32:35]
s_waitcnt vmcnt(2)
ds_read_b128 v[88:91],v4 offset:6144
v_mfma_f32_16x16x32_bf16 v[36:39],a[28:31],v[76:79],v[36:39]
s_waitcnt lgkmcnt(2)
s_barrier
ds_read_b128 v[92:95],v5 offset:0
v_mfma_f32_16x16x32_bf16 v[32:35],a[32:35],v[80:83],v[32:35]
ds_read_b128 v[96:99],v5 offset:1024
v_mfma_f32_16x16x32_bf16 v[36:39],a[36:39],v[80:83],v[36:39]
s_waitcnt lgkmcnt(3)
ds_read_b128 v[100:103],v5 offset:2048
v_mfma_f32_16x16x32_bf16 v[32:35],a[40:43],v[84:87],v[32:35]
ds_read_b128 v[104:107],v5 offset:3072
v_mfma_f32_16x16x32_bf16 v[36:39],a[44:47],v[84:87],v[36:39]
s_waitcnt lgkmcnt(4)
ds_read_b128 v[108:111],v5 offset:4096
v_mfma_f32_16x16x32_bf16 v[32:35],a[48:51],v[88:91],v[32:35]
ds_read_b128 v[112:115],v5 offset:5120
v_mfma_f32_16x16x32_bf16 v[36:39],a[52:55],v[88:91],v[36:39]
s_waitcnt lgkmcnt(5)
v_mfma_f32_16x16x32_bf16 v[32:35],a[56:59],v[92:95],v[32:35]
ds_read_b128 v[116:119],v5 offset:6144
v_mfma_f32_16x16x32_bf16 v[36:39],a[60:63],v[92:95],v[36:39]
s_waitcnt lgkmcnt(5)
v_mfma_f32_16x16x32_bf16 v[32:35],a[64:67],v[96:99],v[32:35]
ds_read_b128 v[120:123],v6 offset:0
v_mfma_f32_16x16x32_bf16 v[36:39],a[68:71],v[96:99],v[36:39]
s_waitcnt lgkmcnt(5)
v_mfma_f32_16x16x32_bf16 v[32:35],a[72:75],v[100:103],v[32:35]
ds_read_b128 v[124:127],v6 offset:1024
v_mfma_f32_16x16x32_bf16 v[36:39],a[76:79],v[100:103],v[36:39]
s_waitcnt lgkmcnt(5)
v_mfma_f32_16x16x32_bf16 v[32:35],a[80:83],v[104:107],v[32:35]
ds_read_b128 v[64:67],v6 offset:2048
v_mfma_f32_16x16x32_bf16 v[36:39],a[84:87],v[104:107],v[36:39]
s_waitcnt lgkmcnt(5)
v_mfma_f32_16x16x32_bf16 v[32:35],a[88:91],v[108:111],v[32:35]
ds_read_b128 v[68:71],v6 offset:3072
v_mfma_f32_16x16x32_bf16 v[36:39],a[92:95],v[108:111],v[36:39]
s_waitcnt lgkmcnt(5)
v_mfma_f32_16x16x32_bf16 v[32:35],a[96:99],v[112:115],v[32:35]
ds_read_b128 v[72:75],v6 offset:4096
v_mfma_f32_16x16x32_bf16 v[36:39],a[100:103],v[112:115],v[36:39]
s_waitcnt lgkmcnt(5)
v_mfma_f32_16x16x32_bf16 v[32:35],a[104:107],v[116:119],v[32:35]
ds_read_b128 v[76:79],v6 offset:5120
v_mfma_f32_16x16x32_bf16 v[36:39],a[108:111],v[116:119],v[36:39]
s_waitcnt lgkmcnt(5)
v_mfma_f32_16x16x32_bf16 v[32:35],a[112:115],v[120:123],v[32:35]
ds_read_b128 v[80:83],v6 offset:6144
v_mfma_f32_16x16x32_bf16 v[36:39],a[116:119],v[120:123],v[36:39]
s_waitcnt lgkmcnt(5)
v_mfma_f32_16x16x32_bf16 v[32:35],a[120:123],v[124:127],v[32:35]
ds_read_b128 v[84:87],v7 offset:0
v_mfma_f32_16x16x32_bf16 v[36:39],a[124:127],v[124:127],v[36:39]
s_waitcnt lgkmcnt(5)
v_mfma_f32_16x16x32_bf16 v[32:35],a[128:131],v[64:67],v[32:35]
ds_read_b128 v[88:91],v7 offset:1024
v_mfma_f32_16x16x32_bf16 v[36:39],a[132:135],v[64:67],v[36:39]
s_waitcnt lgkmcnt(5)
v_mfma_f32_16x16x32_bf16 v[32:35],a[136:139],v[68:71],v[32:35]
ds_read_b128 v[92:95],v7 offset:2048
v_mfma_f32_16x16x32_bf16 v[36:39],a[140:143],v[68:71],v[36:39]
s_waitcnt lgkmcnt(5)
buffer_load_dword v16,v2,s[20:23],s68 offen sc1
v_mfma_f32_16x16x32_bf16 v[32:35],a[144:147],v[72:75],v[32:35]
ds_read_b128 v[96:99],v7 offset:3072
v_mfma_f32_16x16x32_bf16 v[36:39],a[148:151],v[72:75],v[36:39]
s_waitcnt lgkmcnt(5)
v_mfma_f32_16x16x32_bf16 v[32:35],a[152:155],v[76:79],v[32:35]
ds_read_b128 v[100:103],v7 offset:4096
v_mfma_f32_16x16x32_bf16 v[36:39],a[156:159],v[76:79],v[36:39]
s_waitcnt lgkmcnt(5)
v_mfma_f32_16x16x32_bf16 v[32:35],a[160:163],v[80:83],v[32:35]
ds_read_b128 v[104:107],v7 offset:5120
v_mfma_f32_16x16x32_bf16 v[36:39],a[164:167],v[80:83],v[36:39]
s_waitcnt lgkmcnt(5)
v_mfma_f32_16x16x32_bf16 v[32:35],a[168:171],v[84:87],v[32:35]
ds_read_b128 v[108:111],v7 offset:6144
v_mfma_f32_16x16x32_bf16 v[36:39],a[172:175],v[84:87],v[36:39]
s_waitcnt lgkmcnt(5)
s_add_u32 s55,s55,32768
s_and_b32 s55,s55,0x1ffff
v_mfma_f32_16x16x32_bf16 v[32:35],a[176:179],v[88:91],v[32:35]
v_add_u32 v4,s55,v8
v_add_u32 v5,s55,v9
v_mfma_f32_16x16x32_bf16 v[36:39],a[180:183],v[88:91],v[36:39]
s_waitcnt lgkmcnt(4)
v_add_u32 v6,s55,v10
v_add_u32 v7,s55,v11
v_mfma_f32_16x16x32_bf16 v[32:35],a[184:187],v[92:95],v[32:35]
v_mfma_f32_16x16x32_bf16 v[36:39],a[188:191],v[92:95],v[36:39]
s_waitcnt lgkmcnt(3)
v_mfma_f32_16x16x32_bf16 v[32:35],a[192:195],v[96:99],v[32:35]
v_mfma_f32_16x16x32_bf16 v[36:39],a[196:199],v[96:99],v[36:39]
s_waitcnt lgkmcnt(2)
v_mfma_f32_16x16x32_bf16 v[32:35],a[200:203],v[100:103],v[32:35]
v_mfma_f32_16x16x32_bf16 v[36:39],a[204:207],v[100:103],v[36:39]
s_waitcnt lgkmcnt(1)
v_mfma_f32_16x16x32_bf16 v[32:35],a[208:211],v[104:107],v[32:35]
v_mfma_f32_16x16x32_bf16 v[36:39],a[212:215],v[104:107],v[36:39]
s_waitcnt lgkmcnt(0)
v_mfma_f32_16x16x32_bf16 v[40:43],a[216:219],v[108:111],v[32:35]
v_mfma_f32_16x16x32_bf16 v[44:47],a[220:223],v[108:111],v[36:39]
s_waitcnt vmcnt(0)
v_cmp_gt_u32 vcc,s71,v16
s_add_u32 s60,s60,1
s_branch endN_207
BN_199:
s_waitcnt vmcnt(8)
ds_read_b128 v[64:67],v4 offset:0
s_waitcnt vmcnt(7)
ds_read_b128 v[68:71],v4 offset:1024
s_waitcnt vmcnt(6)
ds_read_b128 v[72:75],v4 offset:2048
s_waitcnt vmcnt(5)
ds_read_b128 v[76:79],v4 offset:3072
s_waitcnt lgkmcnt(3)
v_mfma_f32_16x16x32_bf16 v[32:35],a[0:3],v[64:67],0
s_add_u32 s71,s60,2
s_add_u32 s53,s60,3
v_mfma_f32_16x16x32_bf16 v[36:39],a[4:7],v[64:67],0
s_waitcnt lgkmcnt(2)
s_waitcnt vmcnt(4)
ds_read_b128 v[80:83],v4 offset:4096
v_mfma_f32_16x16x32_bf16 v[32:35],a[8:11],v[68:71],v[32:35]
v_mfma_f32_16x16x32_bf16 v[36:39],a[12:15],v[68:71],v[36:39]
s_waitcnt lgkmcnt(2)
s_waitcnt vmcnt(3)
ds_read_b128 v[84:87],v4 offset:5120
v_mfma_f32_16x16x32_bf16 v[32:35],a[16:19],v[72:75],v[32:35]
v_mfma_f32_16x16x32_bf16 v[36:39],a[20:23],v[72:75],v[36:39]
s_waitcnt lgkmcnt(2)
s_waitcnt vmcnt(2)
ds_read_b128 v[88:91],v4 offset:6144
v_mfma_f32_16x16x32_bf16 v[32:35],a[24:27],v[76:79],v[32:35]
v_mfma_f32_16x16x32_bf16 v[36:39],a[28:31],v[76:79],v[36:39]
s_waitcnt lgkmcnt(2)
s_barrier
ds_read_b128 v[92:95],v5 offset:0
v_mfma_f32_16x16x32_bf16 v[32:35],a[32:35],v[80:83],v[32:35]
ds_read_b128 v[96:99],v5 offset:1024
v_mfma_f32_16x16x32_bf16 v[36:39],a[36:39],v[80:83],v[36:39]
s_waitcnt lgkmcnt(3)
ds_read_b128 v[100:103],v5 offset:2048
v_mfma_f32_16x16x32_bf16 v[32:35],a[40:43],v[84:87],v[32:35]
ds_read_b128 v[104:107],v5 offset:3072
v_mfma_f32_16x16x32_bf16 v[36:39],a[44:47],v[84:87],v[36:39]
s_waitcnt lgkmcnt(4)
ds_read_b128 v[108:111],v5 offset:4096
v_mfma_f32_16x16x32_bf16 v[32:35],a[48:51],v[88:91],v[32:35]
ds_read_b128 v[112:115],v5 offset:5120
v_mfma_f32_16x16x32_bf16 v[36:39],a[52:55],v[88:91],v[36:39]
s_waitcnt lgkmcnt(5)
v_mfma_f32_16x16x32_bf16 v[32:35],a[56:59],v[92:95],v[32:35]
ds_read_b128 v[116:119],v5 offset:6144
v_mfma_f32_16x16x32_bf16 v[36:39],a[60:63],v[92:95],v[36:39]
s_waitcnt lgkmcnt(5)
v_mfma_f32_16x16x32_bf16 v[32:35],a[64:67],v[96:99],v[32:35]
ds_read_b128 v[120:123],v6 offset:0
v_mfma_f32_16x16x32_bf16 v[36:39],a[68:71],v[96:99],v[36:39]
s_waitcnt lgkmcnt(5)
v_mfma_f32_16x16x32_bf16 v[32:35],a[72:75],v[100:103],v[32:35]
ds_read_b128 v[124:127],v6 offset:1024
v_mfma_f32_16x16x32_bf16 v[36:39],a[76:79],v[100:103],v[36:39]
s_waitcnt lgkmcnt(5)
v_mfma_f32_16x16x32_bf16 v[32:35],a[80:83],v[104:107],v[32:35]
ds_read_b128 v[64:67],v6 offset:2048
v_mfma_f32_16x16x32_bf16 v[36:39],a[84:87],v[104:107],v[36:39]
s_waitcnt lgkmcnt(5)
v_mfma_f32_16x16x32_bf16 v[32:35],a[88:91],v[108:111],v[32:35]
ds_read_b128 v[68:71],v6 offset:3072
v_mfma_f32_16x16x32_bf16 v[36:39],a[92:95],v[108:111],v[36:39]
s_waitcnt lgkmcnt(5)
v_mfma_f32_16x16x32_bf16 v[32:35],a[96:99],v[112:115],v[32:35]
ds_read_b128 v[72:75],v6 offset:4096
v_mfma_f32_16x16x32_bf16 v[36:39],a[100:103],v[112:115],v[36:39]
s_waitcnt lgkmcnt(5)
v_mfma_f32_16x16x32_bf16 v[32:35],a[104:107],v[116:119],v[32:35]
ds_read_b128 v[76:79],v6 offset:5120
v_mfma_f32_16x16x32_bf16 v[36:39],a[108:111],v[116:119],v[36:39]
s_waitcnt lgkmcnt(5)
v_mfma_f32_16x16x32_bf16 v[32:35],a[112:115],v[120:123],v[32:35]
ds_read_b128 v[80:83],v6 offset:6144
v_mfma_f32_16x16x32_bf16 v[36:39],a[116:119],v[120:123],v[36:39]
s_waitcnt lgkmcnt(5)
v_mfma_f32_16x16x32_bf16 v[32:35],a[120:123],v[124:127],v[32:35]
ds_read_b128 v[84:87],v7 offset:0
v_mfma_f32_16x16x32_bf16 v[36:39],a[124:127],v[124:127],v[36:39]
s_waitcnt lgkmcnt(5)
v_mfma_f32_16x16x32_bf16 v[32:35],a[128:131],v[64:67],v[32:35]
ds_read_b128 v[88:91],v7 offset:1024
v_mfma_f32_16x16x32_bf16 v[36:39],a[132:135],v[64:67],v[36:39]
s_waitcnt lgkmcnt(5)
v_mfma_f32_16x16x32_bf16 v[32:35],a[136:139],v[68:71],v[32:35]
ds_read_b128 v[92:95],v7 offset:2048
v_mfma_f32_16x16x32_bf16 v[36:39],a[140:143],v[68:71],v[36:39]
s_waitcnt lgkmcnt(5)
buffer_load_dword v16,v2,s[20:23],s68 offen sc1
v_mfma_f32_16x16x32_bf16 v[32:35],a[144:147],v[72:75],v[32:35]
ds_read_b128 v[96:99],v7 offset:3072
v_mfma_f32_16x16x32_bf16 v[36:39],a[148:151],v[72:75],v[36:39]
s_waitcnt lgkmcnt(5)
v_mfma_f32_16x16x32_bf16 v[32:35],a[152:155],v[76:79],v[32:35]
ds_read_b128 v[100:103],v7 offset:4096
v_mfma_f32_16x16x32_bf16 v[36:39],a[156:159],v[76:79],v[36:39]
s_waitcnt lgkmcnt(5)
v_mfma_f32_16x16x32_bf16 v[32:35],a[160:163],v[80:83],v[32:35]
ds_read_b128 v[104:107],v7 offset:5120
v_mfma_f32_16x16x32_bf16 v[36:39],a[164:167],v[80:83],v[36:39]
s_waitcnt lgkmcnt(5)
v_mfma_f32_16x16x32_bf16 v[32:35],a[168:171],v[84:87],v[32:35]
ds_read_b128 v[108:111],v7 offset:6144
v_mfma_f32_16x16x32_bf16 v[36:39],a[172:175],v[84:87],v[36:39]
s_waitcnt lgkmcnt(5)
s_add_u32 s55,s55,32768
s_and_b32 s55,s55,0x1ffff
v_mfma_f32_16x16x32_bf16 v[32:35],a[176:179],v[88:91],v[32:35]
v_add_u32 v4,s55,v8
v_add_u32 v5,s55,v9
v_mfma_f32_16x16x32_bf16 v[36:39],a[180:183],v[88:91],v[36:39]
s_waitcnt lgkmcnt(4)
v_add_u32 v6,s55,v10
v_add_u32 v7,s55,v11
v_mfma_f32_16x16x32_bf16 v[32:35],a[184:187],v[92:95],v[32:35]
v_mfma_f32_16x16x32_bf16 v[36:39],a[188:191],v[92:95],v[36:39]
s_waitcnt lgkmcnt(3)
v_mfma_f32_16x16x32_bf16 v[32:35],a[192:195],v[96:99],v[32:35]
v_mfma_f32_16x16x32_bf16 v[36:39],a[196:199],v[96:99],v[36:39]
s_waitcnt lgkmcnt(2)
v_mfma_f32_16x16x32_bf16 v[32:35],a[200:203],v[100:103],v[32:35]
v_mfma_f32_16x16x32_bf16 v[36:39],a[204:207],v[100:103],v[36:39]
s_waitcnt lgkmcnt(1)
v_mfma_f32_16x16x32_bf16 v[32:35],a[208:211],v[104:107],v[32:35]
v_mfma_f32_16x16x32_bf16 v[36:39],a[212:215],v[104:107],v[36:39]
s_waitcnt lgkmcnt(0)
v_mfma_f32_16x16x32_bf16 v[40:43],a[216:219],v[108:111],v[32:35]
v_mfma_f32_16x16x32_bf16 v[44:47],a[220:223],v[108:111],v[36:39]
s_waitcnt vmcnt(0)
v_cmp_gt_u32 vcc,s71,v16
s_add_u32 s60,s60,1
endN_207:
s_cbranch_vccnz nb_202
s_mov_b32 m0,s70
s_nop 0
buffer_load_dwordx4 v3,s[20:23],s61 offen offset:0 lds
buffer_load_dwordx4 v3,s[20:23],s61 offen offset:1024 lds
buffer_load_dwordx4 v3,s[20:23],s61 offen offset:2048 lds
buffer_load_dwordx4 v3,s[20:23],s61 offen offset:3072 lds
s_add_u32 m0,s70,4096
s_nop 0
buffer_load_dwordx4 v3,s[20:23],s62 offen offset:0 lds
buffer_load_dwordx4 v3,s[20:23],s62 offen offset:1024 lds
buffer_load_dwordx4 v3,s[20:23],s62 offen offset:2048 lds
s_add_u32 s61,s61,114688
s_add_u32 s62,s62,114688
s_add_u32 s70,s70,32768
s_and_b32 s70,s70,0x1ffff
s_add_u32 s64,s74,s75
s_cmp_eq_u32 s56,1
s_cbranch_scc1 b1_210
buffer_store_dwordx4 v[40:43],v0,s[20:23],s64 offen offset:0
buffer_store_dwordx4 v[44:47],v0,s[20:23],s64 offen offset:1024
b2_211:
s_add_u32 s75,s75,6144
s_cmp_eq_u32 s75,24576
s_cselect_b32 s75,0,s75
s_branch dec_201
nb_202:
buffer_load_dword v16,v2,s[20:23],s68 offen sc1
s_nop 3
s_add_u32 s64,s74,s75
s_cmp_eq_u32 s56,1
s_cbranch_scc1 b1_212
buffer_store_dwordx4 v[40:43],v0,s[20:23],s64 offen offset:0
buffer_store_dwordx4 v[44:47],v0,s[20:23],s64 offen offset:1024
b2_213:
s_add_u32 s75,s75,6144
s_cmp_eq_u32 s75,24576
s_cselect_b32 s75,0,s75
s_waitcnt vmcnt(2)
v_cmp_gt_u32 vcc,s71,v16
s_cbranch_vccz lag_200
s_cmp_ge_u32 s60,128
s_cbranch_scc1 done_180
plp_216:
buffer_load_dword v16,v2,s[20:23],s68 offen sc1
s_waitcnt vmcnt(0)
v_cmp_gt_u32 vcc,s71,v16
s_cbranch_vccz pok_217
s_sleep 4
s_sub_u32 s90,s90,1
s_cmp_gt_i32 s90,0
s_cbranch_scc1 plp_216
pok_217:
s_branch lag_200
lfin_193:
s_add_u32 s71,s60,1
s_add_u32 s53,s60,2
plp_237:
buffer_load_dword v16,v2,s[20:23],s68 offen sc1
s_waitcnt vmcnt(0)
v_cmp_gt_u32 vcc,s71,v16
s_cbranch_vccz pok_238
s_sleep 4
s_sub_u32 s90,s90,1
s_cmp_gt_i32 s90,0
s_cbranch_scc1 plp_237
pok_238:
lag_234:
s_mov_b32 m0,s70
s_nop 0
buffer_load_dwordx4 v3,s[20:23],s61 offen offset:0 lds
buffer_load_dwordx4 v3,s[20:23],s61 offen offset:1024 lds
buffer_load_dwordx4 v3,s[20:23],s61 offen offset:2048 lds
buffer_load_dwordx4 v3,s[20:23],s61 offen offset:3072 lds
s_add_u32 m0,s70,4096
s_nop 0
buffer_load_dwordx4 v3,s[20:23],s62 offen offset:0 lds
buffer_load_dwordx4 v3,s[20:23],s62 offen offset:1024 lds
buffer_load_dwordx4 v3,s[20:23],s62 offen offset:2048 lds
s_add_u32 s61,s61,114688
s_add_u32 s62,s62,114688
s_add_u32 s70,s70,32768
s_and_b32 s70,s70,0x1ffff
dec_235:
v_cmp_gt_u32 vcc,s53,v16
s_cbranch_vccnz BN_233
BR_232:
s_waitcnt vmcnt(6)
ds_read_b128 v[64:67],v4 offset:0
s_waitcnt vmcnt(5)
ds_read_b128 v[68:71],v4 offset:1024
s_waitcnt vmcnt(4)
ds_read_b128 v[72:75],v4 offset:2048
s_waitcnt vmcnt(3)
ds_read_b128 v[76:79],v4 offset:3072
s_waitcnt lgkmcnt(3)
v_mfma_f32_16x16x32_bf16 v[32:35],a[0:3],v[64:67],0
s_add_u32 s71,s60,2
s_add_u32 s53,s60,3
v_mfma_f32_16x16x32_bf16 v[36:39],a[4:7],v[64:67],0
s_waitcnt lgkmcnt(2)
s_waitcnt vmcnt(2)
ds_read_b128 v[80:83],v4 offset:4096
v_mfma_f32_16x16x32_bf16 v[32:35],a[8:11],v[68:71],v[32:35]
v_mfma_f32_16x16x32_bf16 v[36:39],a[12:15],v[68:71],v[36:39]
s_waitcnt lgkmcnt(2)
s_waitcnt vmcnt(1)
s_mov_b32 m0,s70
ds_read_b128 v[84:87],v4 offset:5120
v_mfma_f32_16x16x32_bf16 v[32:35],a[16:19],v[72:75],v[32:35]
buffer_load_dwordx4 v3,s[20:23],s61 offen offset:0 lds
v_mfma_f32_16x16x32_bf16 v[36:39],a[20:23],v[72:75],v[36:39]
s_waitcnt lgkmcnt(2)
s_waitcnt vmcnt(1)
ds_read_b128 v[88:91],v4 offset:6144
v_mfma_f32_16x16x32_bf16 v[32:35],a[24:27],v[76:79],v[32:35]
buffer_load_dwordx4 v3,s[20:23],s61 offen offset:1024 lds
v_mfma_f32_16x16x32_bf16 v[36:39],a[28:31],v[76:79],v[36:39]
s_waitcnt lgkmcnt(2)
s_barrier
ds_read_b128 v[92:95],v5 offset:0
v_mfma_f32_16x16x32_bf16 v[32:35],a[32:35],v[80:83],v[32:35]
ds_read_b128 v[96:99],v5 offset:1024
v_mfma_f32_16x16x32_bf16 v[36:39],a[36:39],v[80:83],v[36:39]
s_waitcnt lgkmcnt(3)
ds_read_b128 v[100:103],v5 offset:2048
buffer_load_dwordx4 v3,s[20:23],s61 offen offset:2048 lds
v_mfma_f32_16x16x32_bf16 v[32:35],a[40:43],v[84:87],v[32:35]
ds_read_b128 v[104:107],v5 offset:3072
v_mfma_f32_16x16x32_bf16 v[36:39],a[44:47],v[84:87],v[36:39]
s_waitcnt lgkmcnt(4)
ds_read_b128 v[108:111],v5 offset:4096
v_mfma_f32_16x16x32_bf16 v[32:35],a[48:51],v[88:91],v[32:35]
ds_read_b128 v[112:115],v5 offset:5120
buffer_load_dwordx4 v3,s[20:23],s61 offen offset:3072 lds
v_mfma_f32_16x16x32_bf16 v[36:39],a[52:55],v[88:91],v[36:39]
s_waitcnt lgkmcnt(5)
v_mfma_f32_16x16x32_bf16 v[32:35],a[56:59],v[92:95],v[32:35]
s_cmp_eq_u32 s77,0
s_cselect_b32 s57,2.0,0
ds_read_b128 v[116:119],v5 offset:6144
v_mfma_f32_16x16x32_bf16 v[36:39],a[60:63],v[92:95],v[36:39]
s_waitcnt lgkmcnt(5)
s_add_u32 m0,s70,4096
v_or_b32 v21,s57,v0
v_mfma_f32_16x16x32_bf16 v[32:35],a[64:67],v[96:99],v[32:35]
ds_read_b128 v[120:123],v6 offset:0
buffer_load_dwordx4 v3,s[20:23],s62 offen offset:0 lds
v_mfma_f32_16x16x32_bf16 v[36:39],a[68:71],v[96:99],v[36:39]
s_waitcnt lgkmcnt(5)
v_or_b32 v22,s57,v18
v_lshlrev_b32 v168,16,v160
v_mfma_f32_16x16x32_bf16 v[32:35],a[72:75],v[100:103],v[32:35]
ds_read_b128 v[124:127],v6 offset:1024
v_and_b32 v169,s73,v160
v_mfma_f32_16x16x32_bf16 v[36:39],a[76:79],v[100:103],v[36:39]
s_waitcnt lgkmcnt(5)
buffer_load_dwordx4 v3,s[20:23],s62 offen offset:1024 lds
v_lshlrev_b32 v170,16,v161
v_mfma_f32_16x16x32_bf16 v[32:35],a[80:83],v[104:107],v[32:35]
ds_read_b128 v[64:67],v6 offset:2048
v_and_b32 v171,s73,v161
v_mfma_f32_16x16x32_bf16 v[36:39],a[84:87],v[104:107],v[36:39]
s_waitcnt lgkmcnt(5)
buffer_load_dword v16,v2,s[20:23],s68 offen sc1
v_lshlrev_b32 v172,16,v162
v_mfma_f32_16x16x32_bf16 v[32:35],a[88:91],v[108:111],v[32:35]
ds_read_b128 v[68:71],v6 offset:3072
buffer_load_dwordx4 v3,s[20:23],s62 offen offset:2048 lds
v_mfma_f32_16x16x32_bf16 v[36:39],a[92:95],v[108:111],v[36:39]
s_waitcnt lgkmcnt(5)
v_and_b32 v173,s73,v162
v_lshlrev_b32 v174,16,v163
v_mfma_f32_16x16x32_bf16 v[32:35],a[96:99],v[112:115],v[32:35]
s_add_u32 s84,s74,s75
s_add_u32 s85,s84,4096
ds_read_b128 v[72:75],v6 offset:4096
v_mfma_f32_16x16x32_bf16 v[36:39],a[100:103],v[112:115],v[36:39]
s_waitcnt lgkmcnt(5)
buffer_load_dwordx4 v[128:131],v0,s[20:23],s84 offen offset:0 sc1
v_and_b32 v175,s73,v163
v_mfma_f32_16x16x32_bf16 v[32:35],a[104:107],v[116:119],v[32:35]
ds_read_b128 v[76:79],v6 offset:5120
v_lshlrev_b32 v176,16,v164
v_mfma_f32_16x16x32_bf16 v[36:39],a[108:111],v[116:119],v[36:39]
s_waitcnt lgkmcnt(5)
buffer_load_dwordx4 v[132:135],v0,s[20:23],s84 offen offset:1024 sc1
v_and_b32 v177,s73,v164
v_mfma_f32_16x16x32_bf16 v[32:35],a[112:115],v[120:123],v[32:35]
ds_read_b128 v[80:83],v6 offset:6144
v_lshlrev_b32 v178,16,v165
v_mfma_f32_16x16x32_bf16 v[36:39],a[116:119],v[120:123],v[36:39]
s_waitcnt lgkmcnt(5)
buffer_load_dwordx4 v[136:139],v0,s[20:23],s84 offen offset:2048 sc1
v_and_b32 v179,s73,v165
v_mfma_f32_16x16x32_bf16 v[32:35],a[120:123],v[124:127],v[32:35]
ds_read_b128 v[84:87],v7 offset:0
v_lshlrev_b32 v180,16,v166
v_mfma_f32_16x16x32_bf16 v[36:39],a[124:127],v[124:127],v[36:39]
s_waitcnt lgkmcnt(5)
buffer_load_dwordx4 v[140:143],v0,s[20:23],s84 offen offset:3072 sc1
v_and_b32 v181,s73,v166
v_mfma_f32_16x16x32_bf16 v[32:35],a[128:131],v[64:67],v[32:35]
ds_read_b128 v[88:91],v7 offset:1024
v_lshlrev_b32 v182,16,v167
v_mfma_f32_16x16x32_bf16 v[36:39],a[132:135],v[64:67],v[36:39]
s_waitcnt lgkmcnt(5)
buffer_load_dwordx4 v[144:147],v0,s[20:23],s85 offen offset:0 sc1
v_and_b32 v183,s73,v167
v_mfma_f32_16x16x32_bf16 v[32:35],a[136:139],v[68:71],v[32:35]
ds_read_b128 v[92:95],v7 offset:2048
v_add_f32 v212,v212,v176
v_mfma_f32_16x16x32_bf16 v[36:39],a[140:143],v[68:71],v[36:39]
s_waitcnt lgkmcnt(5)
buffer_load_dwordx4 v[148:151],v0,s[20:23],s85 offen offset:1024 sc1
v_add_f32 v213,v213,v177
v_mfma_f32_16x16x32_bf16 v[32:35],a[144:147],v[72:75],v[32:35]
ds_read_b128 v[96:99],v7 offset:3072
v_add_f32 v214,v214,v178
v_mfma_f32_16x16x32_bf16 v[36:39],a[148:151],v[72:75],v[36:39]
s_waitcnt lgkmcnt(5)
v_add_f32 v215,v215,v179
v_add_f32 v216,v216,v180
v_mfma_f32_16x16x32_bf16 v[32:35],a[152:155],v[76:79],v[32:35]
ds_read_b128 v[100:103],v7 offset:4096
v_add_f32 v217,v217,v181
v_mfma_f32_16x16x32_bf16 v[36:39],a[156:159],v[76:79],v[36:39]
s_waitcnt lgkmcnt(5)
v_add_f32 v218,v218,v182
v_add_f32 v219,v219,v183
v_mfma_f32_16x16x32_bf16 v[32:35],a[160:163],v[80:83],v[32:35]
ds_read_b128 v[104:107],v7 offset:5120
v_fma_f32 v168,v212,v152,v168
v_mfma_f32_16x16x32_bf16 v[36:39],a[164:167],v[80:83],v[36:39]
s_waitcnt lgkmcnt(5)
v_fma_f32 v169,v213,v153,v169
v_fma_f32 v170,v214,v154,v170
v_mfma_f32_16x16x32_bf16 v[32:35],a[168:171],v[84:87],v[32:35]
ds_read_b128 v[108:111],v7 offset:6144
v_fma_f32 v171,v215,v155,v171
v_mfma_f32_16x16x32_bf16 v[36:39],a[172:175],v[84:87],v[36:39]
s_waitcnt lgkmcnt(5)
v_fma_f32 v172,v216,v156,v172
v_fma_f32 v173,v217,v157,v173
v_mfma_f32_16x16x32_bf16 v[32:35],a[176:179],v[88:91],v[32:35]
s_add_u32 s61,s61,114688
v_fma_f32 v174,v218,v158,v174
v_fma_f32 v175,v219,v159,v175
v_mfma_f32_16x16x32_bf16 v[36:39],a[180:183],v[88:91],v[36:39]
s_waitcnt lgkmcnt(4)
s_add_u32 s62,s62,114688
buffer_load_dwordx4 v[160:163],v0,s[20:23],s82 offen
v_mfma_f32_16x16x32_bf16 v[32:35],a[184:187],v[92:95],v[32:35]
s_add_u32 s70,s70,32768
s_add_u32 s64,s82,13631488
buffer_load_dwordx4 v[164:167],v0,s[20:23],s64 offen
v_mfma_f32_16x16x32_bf16 v[36:39],a[188:191],v[92:95],v[36:39]
s_waitcnt lgkmcnt(3)
s_add_u32 s82,s82,32768
s_and_b32 s70,s70,0x1ffff
v_mfma_f32_16x16x32_bf16 v[32:35],a[192:195],v[96:99],v[32:35]
s_add_u32 s55,s55,32768
s_and_b32 s55,s55,0x1ffff
v_add_u32 v4,s55,v8
v_mfma_f32_16x16x32_bf16 v[36:39],a[196:199],v[96:99],v[36:39]
s_waitcnt lgkmcnt(2)
v_add_u32 v5,s55,v9
v_add_u32 v6,s55,v10
v_mfma_f32_16x16x32_bf16 v[32:35],a[200:203],v[100:103],v[32:35]
s_waitcnt vmcnt(2)
s_cmp_eq_u32 s77,0
s_cbranch_scc1 go_247
ck_245:
v_max3_u32 v184,v128,v129,v130
v_max3_u32 v185,v140,v141,v142
v_max3_u32 v184,v184,v131,v132
v_max3_u32 v185,v185,v143,v144
v_max3_u32 v184,v184,v133,v134
v_max3_u32 v185,v185,v145,v146
v_max3_u32 v184,v184,v135,v136
v_max3_u32 v185,v185,v147,v148
v_max3_u32 v184,v184,v137,v138
v_max3_u32 v185,v185,v149,v150
v_max3_u32 v184,v184,v139,v151
v_max_u32 v184,v184,v185
v_cmp_eq_u32 vcc,-1,v184
s_cbranch_vccnz rt_246
go_247:
v_mfma_f32_16x16x32_bf16 v[36:39],a[204:207],v[100:103],v[36:39]
s_waitcnt lgkmcnt(1)
v_add_u32 v7,s55,v11
v_add_f32 v128,v128,v136
v_add_f32 v129,v129,v137
v_mfma_f32_16x16x32_bf16 v[32:35],a[208:211],v[104:107],v[32:35]
ds_read_b128 v[64:67],v4 offset:0
v_add_f32 v130,v130,v138
v_add_f32 v131,v131,v139
v_mfma_f32_16x16x32_bf16 v[36:39],a[212:215],v[104:107],v[36:39]
s_waitcnt lgkmcnt(1)
ds_read_b128 v[68:71],v4 offset:1024
v_add_f32 v132,v132,v140
v_mfma_f32_16x16x32_bf16 v[40:43],a[216:219],v[108:111],v[32:35]
ds_read_b128 v[72:75],v4 offset:2048
v_add_f32 v133,v133,v141
v_add_f32 v134,v134,v142
v_mfma_f32_16x16x32_bf16 v[44:47],a[220:223],v[108:111],v[36:39]
v_add_f32 v135,v135,v143
v_add_f32 v128,v128,v144
v_add_f32 v129,v129,v145
v_add_f32 v130,v130,v146
v_add_f32 v131,v131,v147
v_add_f32 v132,v132,v148
v_add_f32 v133,v133,v149
v_add_f32 v134,v134,v150
v_add_f32 v135,v135,v151
v_fma_f32 v168,v128,v152,v168
v_fma_f32 v169,v129,v153,v169
v_fma_f32 v170,v130,v154,v170
v_fma_f32 v171,v131,v155,v171
v_fma_f32 v172,v132,v156,v172
v_fma_f32 v173,v133,v157,v173
v_fma_f32 v174,v134,v158,v174
v_fma_f32 v175,v135,v159,v175
v_cvt_pk_bf16_f32 v176,v168,v169
v_cvt_pk_bf16_f32 v177,v170,v171
v_cvt_pk_bf16_f32 v178,v172,v173
v_cvt_pk_bf16_f32 v179,v174,v175
s_and_b32 s64,s66,0xffff8000
buffer_store_dwordx4 v[176:179],v22,s[24:27],s64 offen nt
s_cmp_eq_u32 s56,1
s_cbranch_scc1 b1_239
buffer_store_dwordx4 v[204:207],v21,s[20:23],s84 offen offset:0
buffer_store_dwordx4 v[204:207],v21,s[20:23],s84 offen offset:1024
b2_240:
s_cmp_eq_u32 s56,1
s_cbranch_scc1 b1_241
buffer_store_dwordx4 v[204:207],v21,s[20:23],s84 offen offset:2048
buffer_store_dwordx4 v[204:207],v21,s[20:23],s84 offen offset:3072
b2_242:
s_cmp_eq_u32 s56,1
s_cbranch_scc1 b1_243
buffer_store_dwordx4 v[204:207],v21,s[20:23],s85 offen offset:0
buffer_store_dwordx4 v[204:207],v21,s[20:23],s85 offen offset:1024
b2_244:
s_mul_i32 s64,s77,32768
s_add_u32 s66,s66,s64
s_mul_i32 s64,s77,6144
s_add_u32 s75,s75,s64
s_cmp_eq_u32 s75,24576
s_cselect_b32 s75,0,s75
s_add_u32 s63,s63,s77
s_mov_b32 s77,0
v_cmp_gt_u32 vcc,s53,v16
s_add_u32 s60,s60,1
s_cbranch_vccnz WN_231
.p2align 6
WR_230:
s_waitcnt lgkmcnt(2)
v_mfma_f32_16x16x32_bf16 v[32:35],a[0:3],v[64:67],0
s_waitcnt vmcnt(19)
s_add_u32 s71,s60,2
ds_read_b128 v[76:79],v4 offset:3072
v_mfma_f32_16x16x32_bf16 v[36:39],a[4:7],v[64:67],0
s_waitcnt lgkmcnt(2)
s_add_u32 s53,s60,3
v_mfma_f32_16x16x32_bf16 v[32:35],a[8:11],v[68:71],v[32:35]
s_waitcnt vmcnt(18)
s_mov_b32 m0,s70
ds_read_b128 v[80:83],v4 offset:4096
v_mfma_f32_16x16x32_bf16 v[36:39],a[12:15],v[68:71],v[36:39]
s_waitcnt lgkmcnt(2)
buffer_load_dwordx4 v3,s[20:23],s61 offen offset:0 lds
v_mov_b32 v212,v40
v_mfma_f32_16x16x32_bf16 v[32:35],a[16:19],v[72:75],v[32:35]
s_waitcnt vmcnt(18)
ds_read_b128 v[84:87],v4 offset:5120
v_mov_b32 v213,v41
v_mfma_f32_16x16x32_bf16 v[36:39],a[20:23],v[72:75],v[36:39]
s_waitcnt lgkmcnt(2)
v_mov_b32 v214,v42
v_mov_b32 v215,v43
v_mfma_f32_16x16x32_bf16 v[32:35],a[24:27],v[76:79],v[32:35]
s_waitcnt vmcnt(16)
ds_read_b128 v[88:91],v4 offset:6144
buffer_load_dwordx4 v3,s[20:23],s61 offen offset:1024 lds
v_mfma_f32_16x16x32_bf16 v[36:39],a[28:31],v[76:79],v[36:39]
s_waitcnt lgkmcnt(2)
s_barrier
ds_read_b128 v[92:95],v5 offset:0
v_mfma_f32_16x16x32_bf16 v[32:35],a[32:35],v[80:83],v[32:35]
ds_read_b128 v[96:99],v5 offset:1024
v_mov_b32 v216,v44
v_mfma_f32_16x16x32_bf16 v[36:39],a[36:39],v[80:83],v[36:39]
s_waitcnt lgkmcnt(3)
ds_read_b128 v[100:103],v5 offset:2048
buffer_load_dwordx4 v3,s[20:23],s61 offen offset:2048 lds
v_mfma_f32_16x16x32_bf16 v[32:35],a[40:43],v[84:87],v[32:35]
ds_read_b128 v[104:107],v5 offset:3072
v_mov_b32 v217,v45
v_mfma_f32_16x16x32_bf16 v[36:39],a[44:47],v[84:87],v[36:39]
s_waitcnt lgkmcnt(4)
ds_read_b128 v[108:111],v5 offset:4096
v_mov_b32 v218,v46
v_mfma_f32_16x16x32_bf16 v[32:35],a[48:51],v[88:91],v[32:35]
ds_read_b128 v[112:115],v5 offset:5120
buffer_load_dwordx4 v3,s[20:23],s61 offen offset:3072 lds
v_mfma_f32_16x16x32_bf16 v[36:39],a[52:55],v[88:91],v[36:39]
s_waitcnt lgkmcnt(5)
v_mov_b32 v219,v47
v_mfma_f32_16x16x32_bf16 v[32:35],a[56:59],v[92:95],v[32:35]
s_mov_b32 s77,1
s_waitcnt vmcnt(11)
s_cmp_eq_u32 s77,0
s_cselect_b32 s57,2.0,0
ds_read_b128 v[116:119],v5 offset:6144
v_mfma_f32_16x16x32_bf16 v[36:39],a[60:63],v[92:95],v[36:39]
s_waitcnt lgkmcnt(5)
s_add_u32 m0,s70,4096
v_or_b32 v21,s57,v0
v_mfma_f32_16x16x32_bf16 v[32:35],a[64:67],v[96:99],v[32:35]
ds_read_b128 v[120:123],v6 offset:0
buffer_load_dwordx4 v3,s[20:23],s62 offen offset:0 lds
v_mfma_f32_16x16x32_bf16 v[36:39],a[68:71],v[96:99],v[36:39]
s_waitcnt lgkmcnt(5)
v_or_b32 v22,s57,v18
v_lshlrev_b32 v168,16,v160
v_mfma_f32_16x16x32_bf16 v[32:35],a[72:75],v[100:103],v[32:35]
ds_read_b128 v[124:127],v6 offset:1024
v_and_b32 v169,s73,v160
v_mfma_f32_16x16x32_bf16 v[36:39],a[76:79],v[100:103],v[36:39]
s_waitcnt lgkmcnt(5)
buffer_load_dwordx4 v3,s[20:23],s62 offen offset:1024 lds
v_lshlrev_b32 v170,16,v161
v_mfma_f32_16x16x32_bf16 v[32:35],a[80:83],v[104:107],v[32:35]
ds_read_b128 v[64:67],v6 offset:2048
v_and_b32 v171,s73,v161
v_mfma_f32_16x16x32_bf16 v[36:39],a[84:87],v[104:107],v[36:39]
s_waitcnt lgkmcnt(5)
buffer_load_dword v16,v2,s[20:23],s68 offen sc1
v_lshlrev_b32 v172,16,v162
v_mfma_f32_16x16x32_bf16 v[32:35],a[88:91],v[108:111],v[32:35]
ds_read_b128 v[68:71],v6 offset:3072
buffer_load_dwordx4 v3,s[20:23],s62 offen offset:2048 lds
v_mfma_f32_16x16x32_bf16 v[36:39],a[92:95],v[108:111],v[36:39]
s_waitcnt lgkmcnt(5)
v_and_b32 v173,s73,v162
v_lshlrev_b32 v174,16,v163
v_mfma_f32_16x16x32_bf16 v[32:35],a[96:99],v[112:115],v[32:35]
s_add_u32 s84,s74,s75
s_add_u32 s85,s84,4096
ds_read_b128 v[72:75],v6 offset:4096
v_mfma_f32_16x16x32_bf16 v[36:39],a[100:103],v[112:115],v[36:39]
s_waitcnt lgkmcnt(5)
buffer_load_dwordx4 v[128:131],v0,s[20:23],s84 offen offset:0 sc1
v_and_b32 v175,s73,v163
v_mfma_f32_16x16x32_bf16 v[32:35],a[104:107],v[116:119],v[32:35]
ds_read_b128 v[76:79],v6 offset:5120
v_lshlrev_b32 v176,16,v164
v_mfma_f32_16x16x32_bf16 v[36:39],a[108:111],v[116:119],v[36:39]
s_waitcnt lgkmcnt(5)
buffer_load_dwordx4 v[132:135],v0,s[20:23],s84 offen offset:1024 sc1
v_and_b32 v177,s73,v164
v_mfma_f32_16x16x32_bf16 v[32:35],a[112:115],v[120:123],v[32:35]
ds_read_b128 v[80:83],v6 offset:6144
v_lshlrev_b32 v178,16,v165
v_mfma_f32_16x16x32_bf16 v[36:39],a[116:119],v[120:123],v[36:39]
s_waitcnt lgkmcnt(5)
buffer_load_dwordx4 v[136:139],v0,s[20:23],s84 offen offset:2048 sc1
v_and_b32 v179,s73,v165
v_mfma_f32_16x16x32_bf16 v[32:35],a[120:123],v[124:127],v[32:35]
ds_read_b128 v[84:87],v7 offset:0
v_lshlrev_b32 v180,16,v166
v_mfma_f32_16x16x32_bf16 v[36:39],a[124:127],v[124:127],v[36:39]
s_waitcnt lgkmcnt(5)
buffer_load_dwordx4 v[140:143],v0,s[20:23],s84 offen offset:3072 sc1
v_and_b32 v181,s73,v166
v_mfma_f32_16x16x32_bf16 v[32:35],a[128:131],v[64:67],v[32:35]
ds_read_b128 v[88:91],v7 offset:1024
v_lshlrev_b32 v182,16,v167
v_mfma_f32_16x16x32_bf16 v[36:39],a[132:135],v[64:67],v[36:39]
s_waitcnt lgkmcnt(5)
buffer_load_dwordx4 v[144:147],v0,s[20:23],s85 offen offset:0 sc1
v_and_b32 v183,s73,v167
v_mfma_f32_16x16x32_bf16 v[32:35],a[136:139],v[68:71],v[32:35]
ds_read_b128 v[92:95],v7 offset:2048
v_add_f32 v212,v212,v176
v_mfma_f32_16x16x32_bf16 v[36:39],a[140:143],v[68:71],v[36:39]
s_waitcnt lgkmcnt(5)
buffer_load_dwordx4 v[148:151],v0,s[20:23],s85 offen offset:1024 sc1
v_add_f32 v213,v213,v177
v_mfma_f32_16x16x32_bf16 v[32:35],a[144:147],v[72:75],v[32:35]
ds_read_b128 v[96:99],v7 offset:3072
v_add_f32 v214,v214,v178
v_mfma_f32_16x16x32_bf16 v[36:39],a[148:151],v[72:75],v[36:39]
s_waitcnt lgkmcnt(5)
v_add_f32 v215,v215,v179
v_add_f32 v216,v216,v180
v_mfma_f32_16x16x32_bf16 v[32:35],a[152:155],v[76:79],v[32:35]
ds_read_b128 v[100:103],v7 offset:4096
v_add_f32 v217,v217,v181
v_mfma_f32_16x16x32_bf16 v[36:39],a[156:159],v[76:79],v[36:39]
s_waitcnt lgkmcnt(5)
v_add_f32 v218,v218,v182
v_add_f32 v219,v219,v183
v_mfma_f32_16x16x32_bf16 v[32:35],a[160:163],v[80:83],v[32:35]
ds_read_b128 v[104:107],v7 offset:5120
v_fma_f32 v168,v212,v152,v168
v_mfma_f32_16x16x32_bf16 v[36:39],a[164:167],v[80:83],v[36:39]
s_waitcnt lgkmcnt(5)
v_fma_f32 v169,v213,v153,v169
v_fma_f32 v170,v214,v154,v170
v_mfma_f32_16x16x32_bf16 v[32:35],a[168:171],v[84:87],v[32:35]
ds_read_b128 v[108:111],v7 offset:6144
v_fma_f32 v171,v215,v155,v171
v_mfma_f32_16x16x32_bf16 v[36:39],a[172:175],v[84:87],v[36:39]
s_waitcnt lgkmcnt(5)
v_fma_f32 v172,v216,v156,v172
v_fma_f32 v173,v217,v157,v173
v_mfma_f32_16x16x32_bf16 v[32:35],a[176:179],v[88:91],v[32:35]
s_add_u32 s61,s61,114688
v_fma_f32 v174,v218,v158,v174
v_fma_f32 v175,v219,v159,v175
v_mfma_f32_16x16x32_bf16 v[36:39],a[180:183],v[88:91],v[36:39]
s_waitcnt lgkmcnt(4)
s_add_u32 s62,s62,114688
buffer_load_dwordx4 v[160:163],v0,s[20:23],s82 offen
v_mfma_f32_16x16x32_bf16 v[32:35],a[184:187],v[92:95],v[32:35]
s_add_u32 s70,s70,32768
s_add_u32 s64,s82,13631488
buffer_load_dwordx4 v[164:167],v0,s[20:23],s64 offen
v_mfma_f32_16x16x32_bf16 v[36:39],a[188:191],v[92:95],v[36:39]
s_waitcnt lgkmcnt(3)
s_add_u32 s82,s82,32768
s_and_b32 s70,s70,0x1ffff
v_mfma_f32_16x16x32_bf16 v[32:35],a[192:195],v[96:99],v[32:35]
s_add_u32 s55,s55,32768
s_and_b32 s55,s55,0x1ffff
v_add_u32 v4,s55,v8
v_mfma_f32_16x16x32_bf16 v[36:39],a[196:199],v[96:99],v[36:39]
s_waitcnt lgkmcnt(2)
v_add_u32 v5,s55,v9
v_add_u32 v6,s55,v10
v_mfma_f32_16x16x32_bf16 v[32:35],a[200:203],v[100:103],v[32:35]
s_waitcnt vmcnt(2)
s_cmp_eq_u32 s77,0
s_cbranch_scc1 go_256
ck_254:
v_max3_u32 v184,v128,v129,v130
v_max3_u32 v185,v140,v141,v142
v_max3_u32 v184,v184,v131,v132
v_max3_u32 v185,v185,v143,v144
v_max3_u32 v184,v184,v133,v134
v_max3_u32 v185,v185,v145,v146
v_max3_u32 v184,v184,v135,v136
v_max3_u32 v185,v185,v147,v148
v_max3_u32 v184,v184,v137,v138
v_max3_u32 v185,v185,v149,v150
v_max3_u32 v184,v184,v139,v151
v_max_u32 v184,v184,v185
v_cmp_eq_u32 vcc,-1,v184
s_cbranch_vccnz rt_255
go_256:
v_mfma_f32_16x16x32_bf16 v[36:39],a[204:207],v[100:103],v[36:39]
s_waitcnt lgkmcnt(1)
v_add_u32 v7,s55,v11
v_add_f32 v128,v128,v136
v_add_f32 v129,v129,v137
v_mfma_f32_16x16x32_bf16 v[32:35],a[208:211],v[104:107],v[32:35]
ds_read_b128 v[64:67],v4 offset:0
v_add_f32 v130,v130,v138
v_add_f32 v131,v131,v139
v_mfma_f32_16x16x32_bf16 v[36:39],a[212:215],v[104:107],v[36:39]
s_waitcnt lgkmcnt(1)
ds_read_b128 v[68:71],v4 offset:1024
v_add_f32 v132,v132,v140
v_mfma_f32_16x16x32_bf16 v[40:43],a[216:219],v[108:111],v[32:35]
ds_read_b128 v[72:75],v4 offset:2048
v_add_f32 v133,v133,v141
v_add_f32 v134,v134,v142
v_mfma_f32_16x16x32_bf16 v[44:47],a[220:223],v[108:111],v[36:39]
v_add_f32 v135,v135,v143
v_add_f32 v128,v128,v144
v_add_f32 v129,v129,v145
v_add_f32 v130,v130,v146
v_add_f32 v131,v131,v147
v_add_f32 v132,v132,v148
v_add_f32 v133,v133,v149
v_add_f32 v134,v134,v150
v_add_f32 v135,v135,v151
v_fma_f32 v168,v128,v152,v168
v_fma_f32 v169,v129,v153,v169
v_fma_f32 v170,v130,v154,v170
v_fma_f32 v171,v131,v155,v171
v_fma_f32 v172,v132,v156,v172
v_fma_f32 v173,v133,v157,v173
v_fma_f32 v174,v134,v158,v174
v_fma_f32 v175,v135,v159,v175
v_cvt_pk_bf16_f32 v176,v168,v169
v_cvt_pk_bf16_f32 v177,v170,v171
v_cvt_pk_bf16_f32 v178,v172,v173
v_cvt_pk_bf16_f32 v179,v174,v175
s_and_b32 s64,s66,0xffff8000
buffer_store_dwordx4 v[176:179],v22,s[24:27],s64 offen nt
s_cmp_eq_u32 s56,1
s_cbranch_scc1 b1_248
buffer_store_dwordx4 v[204:207],v21,s[20:23],s84 offen offset:0
buffer_store_dwordx4 v[204:207],v21,s[20:23],s84 offen offset:1024
b2_249:
s_cmp_eq_u32 s56,1
s_cbranch_scc1 b1_250
buffer_store_dwordx4 v[204:207],v21,s[20:23],s84 offen offset:2048
buffer_store_dwordx4 v[204:207],v21,s[20:23],s84 offen offset:3072
b2_251:
s_cmp_eq_u32 s56,1
s_cbranch_scc1 b1_252
buffer_store_dwordx4 v[204:207],v21,s[20:23],s85 offen offset:0
buffer_store_dwordx4 v[204:207],v21,s[20:23],s85 offen offset:1024
b2_253:
s_mul_i32 s64,s77,32768
s_add_u32 s66,s66,s64
s_mul_i32 s64,s77,6144
s_add_u32 s75,s75,s64
s_cmp_eq_u32 s75,24576
s_cselect_b32 s75,0,s75
s_add_u32 s63,s63,s77
s_mov_b32 s77,0
v_cmp_gt_u32 vcc,s53,v16
s_add_u32 s60,s60,1
s_cbranch_vccz WR_230
WN_231:
s_waitcnt lgkmcnt(2)
v_mfma_f32_16x16x32_bf16 v[32:35],a[0:3],v[64:67],0
s_waitcnt vmcnt(19)
s_add_u32 s71,s60,2
ds_read_b128 v[76:79],v4 offset:3072
v_mfma_f32_16x16x32_bf16 v[36:39],a[4:7],v[64:67],0
s_waitcnt lgkmcnt(2)
s_add_u32 s53,s60,3
v_mfma_f32_16x16x32_bf16 v[32:35],a[8:11],v[68:71],v[32:35]
s_waitcnt vmcnt(18)
ds_read_b128 v[80:83],v4 offset:4096
v_mov_b32 v212,v40
v_mfma_f32_16x16x32_bf16 v[36:39],a[12:15],v[68:71],v[36:39]
s_waitcnt lgkmcnt(2)
v_mov_b32 v213,v41
v_mov_b32 v214,v42
v_mfma_f32_16x16x32_bf16 v[32:35],a[16:19],v[72:75],v[32:35]
s_waitcnt vmcnt(17)
ds_read_b128 v[84:87],v4 offset:5120
v_mov_b32 v215,v43
v_mfma_f32_16x16x32_bf16 v[36:39],a[20:23],v[72:75],v[36:39]
s_waitcnt lgkmcnt(2)
v_mov_b32 v216,v44
v_mov_b32 v217,v45
v_mfma_f32_16x16x32_bf16 v[32:35],a[24:27],v[76:79],v[32:35]
s_waitcnt vmcnt(15)
ds_read_b128 v[88:91],v4 offset:6144
v_mov_b32 v218,v46
v_mfma_f32_16x16x32_bf16 v[36:39],a[28:31],v[76:79],v[36:39]
s_waitcnt lgkmcnt(2)
s_barrier
ds_read_b128 v[92:95],v5 offset:0
v_mfma_f32_16x16x32_bf16 v[32:35],a[32:35],v[80:83],v[32:35]
ds_read_b128 v[96:99],v5 offset:1024
v_mov_b32 v219,v47
v_mfma_f32_16x16x32_bf16 v[36:39],a[36:39],v[80:83],v[36:39]
s_waitcnt lgkmcnt(3)
s_mov_b32 s77,1
ds_read_b128 v[100:103],v5 offset:2048
v_mfma_f32_16x16x32_bf16 v[32:35],a[40:43],v[84:87],v[32:35]
ds_read_b128 v[104:107],v5 offset:3072
v_mfma_f32_16x16x32_bf16 v[36:39],a[44:47],v[84:87],v[36:39]
s_waitcnt lgkmcnt(4)
ds_read_b128 v[108:111],v5 offset:4096
v_mfma_f32_16x16x32_bf16 v[32:35],a[48:51],v[88:91],v[32:35]
ds_read_b128 v[112:115],v5 offset:5120
v_mfma_f32_16x16x32_bf16 v[36:39],a[52:55],v[88:91],v[36:39]
s_waitcnt lgkmcnt(5)
v_mfma_f32_16x16x32_bf16 v[32:35],a[56:59],v[92:95],v[32:35]
s_waitcnt vmcnt(7)
s_cmp_eq_u32 s77,0
s_cselect_b32 s57,2.0,0
ds_read_b128 v[116:119],v5 offset:6144
v_mfma_f32_16x16x32_bf16 v[36:39],a[60:63],v[92:95],v[36:39]
s_waitcnt lgkmcnt(5)
v_or_b32 v21,s57,v0
v_or_b32 v22,s57,v18
v_mfma_f32_16x16x32_bf16 v[32:35],a[64:67],v[96:99],v[32:35]
ds_read_b128 v[120:123],v6 offset:0
v_lshlrev_b32 v168,16,v160
v_mfma_f32_16x16x32_bf16 v[36:39],a[68:71],v[96:99],v[36:39]
s_waitcnt lgkmcnt(5)
v_and_b32 v169,s73,v160
v_lshlrev_b32 v170,16,v161
v_mfma_f32_16x16x32_bf16 v[32:35],a[72:75],v[100:103],v[32:35]
ds_read_b128 v[124:127],v6 offset:1024
v_and_b32 v171,s73,v161
v_mfma_f32_16x16x32_bf16 v[36:39],a[76:79],v[100:103],v[36:39]
s_waitcnt lgkmcnt(5)
v_lshlrev_b32 v172,16,v162
v_and_b32 v173,s73,v162
v_mfma_f32_16x16x32_bf16 v[32:35],a[80:83],v[104:107],v[32:35]
ds_read_b128 v[64:67],v6 offset:2048
v_lshlrev_b32 v174,16,v163
v_mfma_f32_16x16x32_bf16 v[36:39],a[84:87],v[104:107],v[36:39]
s_waitcnt lgkmcnt(5)
v_and_b32 v175,s73,v163
v_lshlrev_b32 v176,16,v164
v_mfma_f32_16x16x32_bf16 v[32:35],a[88:91],v[108:111],v[32:35]
ds_read_b128 v[68:71],v6 offset:3072
v_and_b32 v177,s73,v164
v_mfma_f32_16x16x32_bf16 v[36:39],a[92:95],v[108:111],v[36:39]
s_waitcnt lgkmcnt(5)
v_lshlrev_b32 v178,16,v165
v_and_b32 v179,s73,v165
v_mfma_f32_16x16x32_bf16 v[32:35],a[96:99],v[112:115],v[32:35]
s_add_u32 s84,s74,s75
s_add_u32 s85,s84,4096
ds_read_b128 v[72:75],v6 offset:4096
buffer_load_dwordx4 v[128:131],v0,s[20:23],s84 offen offset:0 sc1
buffer_load_dwordx4 v[132:135],v0,s[20:23],s84 offen offset:1024 sc1
v_mfma_f32_16x16x32_bf16 v[36:39],a[100:103],v[112:115],v[36:39]
s_waitcnt lgkmcnt(5)
buffer_load_dwordx4 v[136:139],v0,s[20:23],s84 offen offset:2048 sc1
v_lshlrev_b32 v180,16,v166
v_mfma_f32_16x16x32_bf16 v[32:35],a[104:107],v[116:119],v[32:35]
ds_read_b128 v[76:79],v6 offset:5120
v_and_b32 v181,s73,v166
v_mfma_f32_16x16x32_bf16 v[36:39],a[108:111],v[116:119],v[36:39]
s_waitcnt lgkmcnt(5)
buffer_load_dwordx4 v[140:143],v0,s[20:23],s84 offen offset:3072 sc1
v_lshlrev_b32 v182,16,v167
v_mfma_f32_16x16x32_bf16 v[32:35],a[112:115],v[120:123],v[32:35]
ds_read_b128 v[80:83],v6 offset:6144
v_and_b32 v183,s73,v167
v_mfma_f32_16x16x32_bf16 v[36:39],a[116:119],v[120:123],v[36:39]
s_waitcnt lgkmcnt(5)
buffer_load_dwordx4 v[144:147],v0,s[20:23],s85 offen offset:0 sc1
v_add_f32 v212,v212,v176
v_mfma_f32_16x16x32_bf16 v[32:35],a[120:123],v[124:127],v[32:35]
ds_read_b128 v[84:87],v7 offset:0
v_add_f32 v213,v213,v177
v_mfma_f32_16x16x32_bf16 v[36:39],a[124:127],v[124:127],v[36:39]
s_waitcnt lgkmcnt(5)
buffer_load_dwordx4 v[148:151],v0,s[20:23],s85 offen offset:1024 sc1
v_add_f32 v214,v214,v178
v_mfma_f32_16x16x32_bf16 v[32:35],a[128:131],v[64:67],v[32:35]
ds_read_b128 v[88:91],v7 offset:1024
v_add_f32 v215,v215,v179
v_mfma_f32_16x16x32_bf16 v[36:39],a[132:135],v[64:67],v[36:39]
s_waitcnt lgkmcnt(5)
v_add_f32 v216,v216,v180
v_add_f32 v217,v217,v181
v_mfma_f32_16x16x32_bf16 v[32:35],a[136:139],v[68:71],v[32:35]
ds_read_b128 v[92:95],v7 offset:2048
v_add_f32 v218,v218,v182
v_mfma_f32_16x16x32_bf16 v[36:39],a[140:143],v[68:71],v[36:39]
s_waitcnt lgkmcnt(5)
buffer_load_dword v16,v2,s[20:23],s68 offen sc1
v_add_f32 v219,v219,v183
v_mfma_f32_16x16x32_bf16 v[32:35],a[144:147],v[72:75],v[32:35]
ds_read_b128 v[96:99],v7 offset:3072
v_fma_f32 v168,v212,v152,v168
v_mfma_f32_16x16x32_bf16 v[36:39],a[148:151],v[72:75],v[36:39]
s_waitcnt lgkmcnt(5)
v_fma_f32 v169,v213,v153,v169
v_fma_f32 v170,v214,v154,v170
v_mfma_f32_16x16x32_bf16 v[32:35],a[152:155],v[76:79],v[32:35]
ds_read_b128 v[100:103],v7 offset:4096
v_fma_f32 v171,v215,v155,v171
v_mfma_f32_16x16x32_bf16 v[36:39],a[156:159],v[76:79],v[36:39]
s_waitcnt lgkmcnt(5)
v_fma_f32 v172,v216,v156,v172
v_fma_f32 v173,v217,v157,v173
v_mfma_f32_16x16x32_bf16 v[32:35],a[160:163],v[80:83],v[32:35]
ds_read_b128 v[104:107],v7 offset:5120
v_fma_f32 v174,v218,v158,v174
v_mfma_f32_16x16x32_bf16 v[36:39],a[164:167],v[80:83],v[36:39]
s_waitcnt lgkmcnt(5)
v_fma_f32 v175,v219,v159,v175
v_mfma_f32_16x16x32_bf16 v[32:35],a[168:171],v[84:87],v[32:35]
ds_read_b128 v[108:111],v7 offset:6144
v_mfma_f32_16x16x32_bf16 v[36:39],a[172:175],v[84:87],v[36:39]
s_waitcnt lgkmcnt(5)
s_add_u32 s55,s55,32768
buffer_load_dwordx4 v[160:163],v0,s[20:23],s82 offen
v_mfma_f32_16x16x32_bf16 v[32:35],a[176:179],v[88:91],v[32:35]
s_and_b32 s55,s55,0x1ffff
s_add_u32 s64,s82,13631488
buffer_load_dwordx4 v[164:167],v0,s[20:23],s64 offen
v_mfma_f32_16x16x32_bf16 v[36:39],a[180:183],v[88:91],v[36:39]
s_waitcnt lgkmcnt(4)
s_add_u32 s82,s82,32768
v_add_u32 v4,s55,v8
v_mfma_f32_16x16x32_bf16 v[32:35],a[184:187],v[92:95],v[32:35]
s_waitcnt vmcnt(3)
s_cmp_eq_u32 s77,0
s_cbranch_scc1 go_266
ck_264:
v_max3_u32 v184,v128,v129,v130
v_max3_u32 v185,v140,v141,v142
v_max3_u32 v184,v184,v131,v132
v_max3_u32 v185,v185,v143,v144
v_max3_u32 v184,v184,v133,v134
v_max3_u32 v185,v185,v145,v146
v_max3_u32 v184,v184,v135,v136
v_max3_u32 v185,v185,v147,v148
v_max3_u32 v184,v184,v137,v138
v_max3_u32 v185,v185,v149,v150
v_max3_u32 v184,v184,v139,v151
v_max_u32 v184,v184,v185
v_cmp_eq_u32 vcc,-1,v184
s_cbranch_vccnz rt_265
go_266:
v_mfma_f32_16x16x32_bf16 v[36:39],a[188:191],v[92:95],v[36:39]
s_waitcnt lgkmcnt(3)
v_add_u32 v5,s55,v9
v_add_u32 v6,s55,v10
v_add_f32 v128,v128,v136
v_mfma_f32_16x16x32_bf16 v[32:35],a[192:195],v[96:99],v[32:35]
v_add_u32 v7,s55,v11
v_add_f32 v129,v129,v137
v_add_f32 v130,v130,v138
v_mfma_f32_16x16x32_bf16 v[36:39],a[196:199],v[96:99],v[36:39]
s_waitcnt lgkmcnt(2)
v_add_f32 v131,v131,v139
v_add_f32 v132,v132,v140
v_add_f32 v133,v133,v141
v_mfma_f32_16x16x32_bf16 v[32:35],a[200:203],v[100:103],v[32:35]
v_add_f32 v134,v134,v142
v_add_f32 v135,v135,v143
v_add_f32 v128,v128,v144
v_mfma_f32_16x16x32_bf16 v[36:39],a[204:207],v[100:103],v[36:39]
s_waitcnt lgkmcnt(1)
v_add_f32 v129,v129,v145
v_add_f32 v130,v130,v146
v_add_f32 v131,v131,v147
v_mfma_f32_16x16x32_bf16 v[32:35],a[208:211],v[104:107],v[32:35]
v_add_f32 v132,v132,v148
v_add_f32 v133,v133,v149
v_add_f32 v134,v134,v150
v_mfma_f32_16x16x32_bf16 v[36:39],a[212:215],v[104:107],v[36:39]
s_waitcnt lgkmcnt(0)
v_add_f32 v135,v135,v151
v_fma_f32 v168,v128,v152,v168
v_fma_f32 v169,v129,v153,v169
v_mfma_f32_16x16x32_bf16 v[40:43],a[216:219],v[108:111],v[32:35]
v_fma_f32 v170,v130,v154,v170
v_fma_f32 v171,v131,v155,v171
v_fma_f32 v172,v132,v156,v172
v_mfma_f32_16x16x32_bf16 v[44:47],a[220:223],v[108:111],v[36:39]
s_waitcnt vmcnt(2)
v_fma_f32 v173,v133,v157,v173
v_fma_f32 v174,v134,v158,v174
v_fma_f32 v175,v135,v159,v175
v_cvt_pk_bf16_f32 v176,v168,v169
v_cvt_pk_bf16_f32 v177,v170,v171
v_cvt_pk_bf16_f32 v178,v172,v173
v_cvt_pk_bf16_f32 v179,v174,v175
s_and_b32 s64,s66,0xffff8000
buffer_store_dwordx4 v[176:179],v22,s[24:27],s64 offen nt
s_cmp_eq_u32 s56,1
s_cbranch_scc1 b1_258
buffer_store_dwordx4 v[204:207],v21,s[20:23],s84 offen offset:0
buffer_store_dwordx4 v[204:207],v21,s[20:23],s84 offen offset:1024
b2_259:
s_cmp_eq_u32 s56,1
s_cbranch_scc1 b1_260
buffer_store_dwordx4 v[204:207],v21,s[20:23],s84 offen offset:2048
buffer_store_dwordx4 v[204:207],v21,s[20:23],s84 offen offset:3072
b2_261:
s_cmp_eq_u32 s56,1
s_cbranch_scc1 b1_262
buffer_store_dwordx4 v[204:207],v21,s[20:23],s85 offen offset:0
buffer_store_dwordx4 v[204:207],v21,s[20:23],s85 offen offset:1024
b2_263:
s_mul_i32 s64,s77,32768
s_add_u32 s66,s66,s64
s_mul_i32 s64,s77,6144
s_add_u32 s75,s75,s64
s_cmp_eq_u32 s75,24576
s_cselect_b32 s75,0,s75
s_add_u32 s63,s63,s77
s_mov_b32 s77,0
v_cmp_gt_u32 vcc,s71,v16
s_add_u32 s60,s60,1
s_branch endN_257
BN_233:
s_waitcnt vmcnt(6)
ds_read_b128 v[64:67],v4 offset:0
s_waitcnt vmcnt(5)
ds_read_b128 v[68:71],v4 offset:1024
s_waitcnt vmcnt(4)
ds_read_b128 v[72:75],v4 offset:2048
s_waitcnt vmcnt(3)
ds_read_b128 v[76:79],v4 offset:3072
s_waitcnt lgkmcnt(3)
v_mfma_f32_16x16x32_bf16 v[32:35],a[0:3],v[64:67],0
s_add_u32 s71,s60,2
s_add_u32 s53,s60,3
v_mfma_f32_16x16x32_bf16 v[36:39],a[4:7],v[64:67],0
s_waitcnt lgkmcnt(2)
s_waitcnt vmcnt(2)
ds_read_b128 v[80:83],v4 offset:4096
v_mfma_f32_16x16x32_bf16 v[32:35],a[8:11],v[68:71],v[32:35]
v_mfma_f32_16x16x32_bf16 v[36:39],a[12:15],v[68:71],v[36:39]
s_waitcnt lgkmcnt(2)
s_waitcnt vmcnt(1)
ds_read_b128 v[84:87],v4 offset:5120
v_mfma_f32_16x16x32_bf16 v[32:35],a[16:19],v[72:75],v[32:35]
v_mfma_f32_16x16x32_bf16 v[36:39],a[20:23],v[72:75],v[36:39]
s_waitcnt lgkmcnt(2)
s_waitcnt vmcnt(0)
ds_read_b128 v[88:91],v4 offset:6144
v_mfma_f32_16x16x32_bf16 v[32:35],a[24:27],v[76:79],v[32:35]
v_mfma_f32_16x16x32_bf16 v[36:39],a[28:31],v[76:79],v[36:39]
s_waitcnt lgkmcnt(2)
s_barrier
ds_read_b128 v[92:95],v5 offset:0
v_mfma_f32_16x16x32_bf16 v[32:35],a[32:35],v[80:83],v[32:35]
ds_read_b128 v[96:99],v5 offset:1024
v_mfma_f32_16x16x32_bf16 v[36:39],a[36:39],v[80:83],v[36:39]
s_waitcnt lgkmcnt(3)
ds_read_b128 v[100:103],v5 offset:2048
v_mfma_f32_16x16x32_bf16 v[32:35],a[40:43],v[84:87],v[32:35]
ds_read_b128 v[104:107],v5 offset:3072
v_mfma_f32_16x16x32_bf16 v[36:39],a[44:47],v[84:87],v[36:39]
s_waitcnt lgkmcnt(4)
ds_read_b128 v[108:111],v5 offset:4096
v_mfma_f32_16x16x32_bf16 v[32:35],a[48:51],v[88:91],v[32:35]
ds_read_b128 v[112:115],v5 offset:5120
v_mfma_f32_16x16x32_bf16 v[36:39],a[52:55],v[88:91],v[36:39]
s_waitcnt lgkmcnt(5)
v_mfma_f32_16x16x32_bf16 v[32:35],a[56:59],v[92:95],v[32:35]
s_cmp_eq_u32 s77,0
s_cselect_b32 s57,2.0,0
ds_read_b128 v[116:119],v5 offset:6144
v_mfma_f32_16x16x32_bf16 v[36:39],a[60:63],v[92:95],v[36:39]
s_waitcnt lgkmcnt(5)
v_or_b32 v21,s57,v0
v_or_b32 v22,s57,v18
v_mfma_f32_16x16x32_bf16 v[32:35],a[64:67],v[96:99],v[32:35]
ds_read_b128 v[120:123],v6 offset:0
v_lshlrev_b32 v168,16,v160
v_mfma_f32_16x16x32_bf16 v[36:39],a[68:71],v[96:99],v[36:39]
s_waitcnt lgkmcnt(5)
v_and_b32 v169,s73,v160
v_lshlrev_b32 v170,16,v161
v_mfma_f32_16x16x32_bf16 v[32:35],a[72:75],v[100:103],v[32:35]
ds_read_b128 v[124:127],v6 offset:1024
v_and_b32 v171,s73,v161
v_mfma_f32_16x16x32_bf16 v[36:39],a[76:79],v[100:103],v[36:39]
s_waitcnt lgkmcnt(5)
v_lshlrev_b32 v172,16,v162
v_and_b32 v173,s73,v162
v_mfma_f32_16x16x32_bf16 v[32:35],a[80:83],v[104:107],v[32:35]
ds_read_b128 v[64:67],v6 offset:2048
v_lshlrev_b32 v174,16,v163
v_mfma_f32_16x16x32_bf16 v[36:39],a[84:87],v[104:107],v[36:39]
s_waitcnt lgkmcnt(5)
v_and_b32 v175,s73,v163
v_lshlrev_b32 v176,16,v164
v_mfma_f32_16x16x32_bf16 v[32:35],a[88:91],v[108:111],v[32:35]
ds_read_b128 v[68:71],v6 offset:3072
v_and_b32 v177,s73,v164
v_mfma_f32_16x16x32_bf16 v[36:39],a[92:95],v[108:111],v[36:39]
s_waitcnt lgkmcnt(5)
v_lshlrev_b32 v178,16,v165
v_and_b32 v179,s73,v165
v_mfma_f32_16x16x32_bf16 v[32:35],a[96:99],v[112:115],v[32:35]
s_add_u32 s84,s74,s75
s_add_u32 s85,s84,4096
ds_read_b128 v[72:75],v6 offset:4096
buffer_load_dwordx4 v[128:131],v0,s[20:23],s84 offen offset:0 sc1
buffer_load_dwordx4 v[132:135],v0,s[20:23],s84 offen offset:1024 sc1
v_mfma_f32_16x16x32_bf16 v[36:39],a[100:103],v[112:115],v[36:39]
s_waitcnt lgkmcnt(5)
buffer_load_dwordx4 v[136:139],v0,s[20:23],s84 offen offset:2048 sc1
v_lshlrev_b32 v180,16,v166
v_mfma_f32_16x16x32_bf16 v[32:35],a[104:107],v[116:119],v[32:35]
ds_read_b128 v[76:79],v6 offset:5120
v_and_b32 v181,s73,v166
v_mfma_f32_16x16x32_bf16 v[36:39],a[108:111],v[116:119],v[36:39]
s_waitcnt lgkmcnt(5)
buffer_load_dwordx4 v[140:143],v0,s[20:23],s84 offen offset:3072 sc1
v_lshlrev_b32 v182,16,v167
v_mfma_f32_16x16x32_bf16 v[32:35],a[112:115],v[120:123],v[32:35]
ds_read_b128 v[80:83],v6 offset:6144
v_and_b32 v183,s73,v167
v_mfma_f32_16x16x32_bf16 v[36:39],a[116:119],v[120:123],v[36:39]
s_waitcnt lgkmcnt(5)
buffer_load_dwordx4 v[144:147],v0,s[20:23],s85 offen offset:0 sc1
v_add_f32 v212,v212,v176
v_mfma_f32_16x16x32_bf16 v[32:35],a[120:123],v[124:127],v[32:35]
ds_read_b128 v[84:87],v7 offset:0
v_add_f32 v213,v213,v177
v_mfma_f32_16x16x32_bf16 v[36:39],a[124:127],v[124:127],v[36:39]
s_waitcnt lgkmcnt(5)
buffer_load_dwordx4 v[148:151],v0,s[20:23],s85 offen offset:1024 sc1
v_add_f32 v214,v214,v178
v_mfma_f32_16x16x32_bf16 v[32:35],a[128:131],v[64:67],v[32:35]
ds_read_b128 v[88:91],v7 offset:1024
v_add_f32 v215,v215,v179
v_mfma_f32_16x16x32_bf16 v[36:39],a[132:135],v[64:67],v[36:39]
s_waitcnt lgkmcnt(5)
v_add_f32 v216,v216,v180
v_add_f32 v217,v217,v181
v_mfma_f32_16x16x32_bf16 v[32:35],a[136:139],v[68:71],v[32:35]
ds_read_b128 v[92:95],v7 offset:2048
v_add_f32 v218,v218,v182
v_mfma_f32_16x16x32_bf16 v[36:39],a[140:143],v[68:71],v[36:39]
s_waitcnt lgkmcnt(5)
buffer_load_dword v16,v2,s[20:23],s68 offen sc1
v_add_f32 v219,v219,v183
v_mfma_f32_16x16x32_bf16 v[32:35],a[144:147],v[72:75],v[32:35]
ds_read_b128 v[96:99],v7 offset:3072
v_fma_f32 v168,v212,v152,v168
v_mfma_f32_16x16x32_bf16 v[36:39],a[148:151],v[72:75],v[36:39]
s_waitcnt lgkmcnt(5)
v_fma_f32 v169,v213,v153,v169
v_fma_f32 v170,v214,v154,v170
v_mfma_f32_16x16x32_bf16 v[32:35],a[152:155],v[76:79],v[32:35]
ds_read_b128 v[100:103],v7 offset:4096
v_fma_f32 v171,v215,v155,v171
v_mfma_f32_16x16x32_bf16 v[36:39],a[156:159],v[76:79],v[36:39]
s_waitcnt lgkmcnt(5)
v_fma_f32 v172,v216,v156,v172
v_fma_f32 v173,v217,v157,v173
v_mfma_f32_16x16x32_bf16 v[32:35],a[160:163],v[80:83],v[32:35]
ds_read_b128 v[104:107],v7 offset:5120
v_fma_f32 v174,v218,v158,v174
v_mfma_f32_16x16x32_bf16 v[36:39],a[164:167],v[80:83],v[36:39]
s_waitcnt lgkmcnt(5)
v_fma_f32 v175,v219,v159,v175
v_mfma_f32_16x16x32_bf16 v[32:35],a[168:171],v[84:87],v[32:35]
ds_read_b128 v[108:111],v7 offset:6144
v_mfma_f32_16x16x32_bf16 v[36:39],a[172:175],v[84:87],v[36:39]
s_waitcnt lgkmcnt(5)
s_add_u32 s55,s55,32768
buffer_load_dwordx4 v[160:163],v0,s[20:23],s82 offen
v_mfma_f32_16x16x32_bf16 v[32:35],a[176:179],v[88:91],v[32:35]
s_and_b32 s55,s55,0x1ffff
s_add_u32 s64,s82,13631488
buffer_load_dwordx4 v[164:167],v0,s[20:23],s64 offen
v_mfma_f32_16x16x32_bf16 v[36:39],a[180:183],v[88:91],v[36:39]
s_waitcnt lgkmcnt(4)
s_add_u32 s82,s82,32768
v_add_u32 v4,s55,v8
v_mfma_f32_16x16x32_bf16 v[32:35],a[184:187],v[92:95],v[32:35]
s_waitcnt vmcnt(3)
s_cmp_eq_u32 s77,0
s_cbranch_scc1 go_275
ck_273:
v_max3_u32 v184,v128,v129,v130
v_max3_u32 v185,v140,v141,v142
v_max3_u32 v184,v184,v131,v132
v_max3_u32 v185,v185,v143,v144
v_max3_u32 v184,v184,v133,v134
v_max3_u32 v185,v185,v145,v146
v_max3_u32 v184,v184,v135,v136
v_max3_u32 v185,v185,v147,v148
v_max3_u32 v184,v184,v137,v138
v_max3_u32 v185,v185,v149,v150
v_max3_u32 v184,v184,v139,v151
v_max_u32 v184,v184,v185
v_cmp_eq_u32 vcc,-1,v184
s_cbranch_vccnz rt_274
go_275:
v_mfma_f32_16x16x32_bf16 v[36:39],a[188:191],v[92:95],v[36:39]
s_waitcnt lgkmcnt(3)
v_add_u32 v5,s55,v9
v_add_u32 v6,s55,v10
v_add_f32 v128,v128,v136
v_mfma_f32_16x16x32_bf16 v[32:35],a[192:195],v[96:99],v[32:35]
v_add_u32 v7,s55,v11
v_add_f32 v129,v129,v137
v_add_f32 v130,v130,v138
v_mfma_f32_16x16x32_bf16 v[36:39],a[196:199],v[96:99],v[36:39]
s_waitcnt lgkmcnt(2)
v_add_f32 v131,v131,v139
v_add_f32 v132,v132,v140
v_add_f32 v133,v133,v141
v_mfma_f32_16x16x32_bf16 v[32:35],a[200:203],v[100:103],v[32:35]
v_add_f32 v134,v134,v142
v_add_f32 v135,v135,v143
v_add_f32 v128,v128,v144
v_mfma_f32_16x16x32_bf16 v[36:39],a[204:207],v[100:103],v[36:39]
s_waitcnt lgkmcnt(1)
v_add_f32 v129,v129,v145
v_add_f32 v130,v130,v146
v_add_f32 v131,v131,v147
v_mfma_f32_16x16x32_bf16 v[32:35],a[208:211],v[104:107],v[32:35]
v_add_f32 v132,v132,v148
v_add_f32 v133,v133,v149
v_add_f32 v134,v134,v150
v_mfma_f32_16x16x32_bf16 v[36:39],a[212:215],v[104:107],v[36:39]
s_waitcnt lgkmcnt(0)
v_add_f32 v135,v135,v151
v_fma_f32 v168,v128,v152,v168
v_fma_f32 v169,v129,v153,v169
v_mfma_f32_16x16x32_bf16 v[40:43],a[216:219],v[108:111],v[32:35]
v_fma_f32 v170,v130,v154,v170
v_fma_f32 v171,v131,v155,v171
v_fma_f32 v172,v132,v156,v172
v_mfma_f32_16x16x32_bf16 v[44:47],a[220:223],v[108:111],v[36:39]
s_waitcnt vmcnt(2)
v_fma_f32 v173,v133,v157,v173
v_fma_f32 v174,v134,v158,v174
v_fma_f32 v175,v135,v159,v175
v_cvt_pk_bf16_f32 v176,v168,v169
v_cvt_pk_bf16_f32 v177,v170,v171
v_cvt_pk_bf16_f32 v178,v172,v173
v_cvt_pk_bf16_f32 v179,v174,v175
s_and_b32 s64,s66,0xffff8000
buffer_store_dwordx4 v[176:179],v22,s[24:27],s64 offen nt
s_cmp_eq_u32 s56,1
s_cbranch_scc1 b1_267
buffer_store_dwordx4 v[204:207],v21,s[20:23],s84 offen offset:0
buffer_store_dwordx4 v[204:207],v21,s[20:23],s84 offen offset:1024
b2_268:
s_cmp_eq_u32 s56,1
s_cbranch_scc1 b1_269
buffer_store_dwordx4 v[204:207],v21,s[20:23],s84 offen offset:2048
buffer_store_dwordx4 v[204:207],v21,s[20:23],s84 offen offset:3072
b2_270:
s_cmp_eq_u32 s56,1
s_cbranch_scc1 b1_271
buffer_store_dwordx4 v[204:207],v21,s[20:23],s85 offen offset:0
buffer_store_dwordx4 v[204:207],v21,s[20:23],s85 offen offset:1024
b2_272:
s_mul_i32 s64,s77,32768
s_add_u32 s66,s66,s64
s_mul_i32 s64,s77,6144
s_add_u32 s75,s75,s64
s_cmp_eq_u32 s75,24576
s_cselect_b32 s75,0,s75
s_add_u32 s63,s63,s77
s_mov_b32 s77,0
v_cmp_gt_u32 vcc,s71,v16
s_add_u32 s60,s60,1
endN_257:
s_cbranch_vccnz nb_236
s_mov_b32 m0,s70
s_nop 0
buffer_load_dwordx4 v3,s[20:23],s61 offen offset:0 lds
buffer_load_dwordx4 v3,s[20:23],s61 offen offset:1024 lds
buffer_load_dwordx4 v3,s[20:23],s61 offen offset:2048 lds
buffer_load_dwordx4 v3,s[20:23],s61 offen offset:3072 lds
s_add_u32 m0,s70,4096
s_nop 0
buffer_load_dwordx4 v3,s[20:23],s62 offen offset:0 lds
buffer_load_dwordx4 v3,s[20:23],s62 offen offset:1024 lds
buffer_load_dwordx4 v3,s[20:23],s62 offen offset:2048 lds
s_add_u32 s61,s61,114688
s_add_u32 s62,s62,114688
s_add_u32 s70,s70,32768
s_and_b32 s70,s70,0x1ffff
v_mov_b32 v212,v40
v_mov_b32 v213,v41
v_mov_b32 v214,v42
v_mov_b32 v215,v43
v_mov_b32 v216,v44
v_mov_b32 v217,v45
v_mov_b32 v218,v46
v_mov_b32 v219,v47
s_mov_b32 s77,1
s_branch dec_235
nb_236:
s_nop 3
s_mov_b32 s77,1
s_add_u32 s84,s74,s75
s_add_u32 s85,s84,4096
buffer_load_dwordx4 v[128:131],v0,s[20:23],s84 offen offset:0 sc1
buffer_load_dwordx4 v[132:135],v0,s[20:23],s84 offen offset:1024 sc1
buffer_load_dwordx4 v[136:139],v0,s[20:23],s84 offen offset:2048 sc1
buffer_load_dwordx4 v[140:143],v0,s[20:23],s84 offen offset:3072 sc1
buffer_load_dwordx4 v[144:147],v0,s[20:23],s85 offen offset:0 sc1
buffer_load_dwordx4 v[148:151],v0,s[20:23],s85 offen offset:1024 sc1
s_waitcnt vmcnt(13)
s_cmp_eq_u32 s77,0
s_cselect_b32 s57,2.0,0
v_or_b32 v21,s57,v0
v_or_b32 v22,s57,v18
v_lshlrev_b32 v168,16,v160
v_and_b32 v169,s73,v160
v_lshlrev_b32 v170,16,v161
v_and_b32 v171,s73,v161
v_lshlrev_b32 v172,16,v162
v_and_b32 v173,s73,v162
v_lshlrev_b32 v174,16,v163
v_and_b32 v175,s73,v163
v_lshlrev_b32 v176,16,v164
v_and_b32 v177,s73,v164
v_lshlrev_b32 v178,16,v165
v_and_b32 v179,s73,v165
v_lshlrev_b32 v180,16,v166
v_and_b32 v181,s73,v166
v_lshlrev_b32 v182,16,v167
v_and_b32 v183,s73,v167
v_pk_add_f32 v[40:41],v[40:41],v[176:177]
v_pk_add_f32 v[42:43],v[42:43],v[178:179]
v_pk_add_f32 v[44:45],v[44:45],v[180:181]
v_pk_add_f32 v[46:47],v[46:47],v[182:183]
v_pk_fma_f32 v[168:169],v[40:41],v[152:153],v[168:169]
v_pk_fma_f32 v[170:171],v[42:43],v[154:155],v[170:171]
v_pk_fma_f32 v[172:173],v[44:45],v[156:157],v[172:173]
v_pk_fma_f32 v[174:175],v[46:47],v[158:159],v[174:175]
s_waitcnt vmcnt(0)
s_cmp_eq_u32 s77,0
s_cbranch_scc1 go_284
ck_282:
v_max3_u32 v184,v128,v129,v130
v_max3_u32 v185,v140,v141,v142
v_max3_u32 v184,v184,v131,v132
v_max3_u32 v185,v185,v143,v144
v_max3_u32 v184,v184,v133,v134
v_max3_u32 v185,v185,v145,v146
v_max3_u32 v184,v184,v135,v136
v_max3_u32 v185,v185,v147,v148
v_max3_u32 v184,v184,v137,v138
v_max3_u32 v185,v185,v149,v150
v_max3_u32 v184,v184,v139,v151
v_max_u32 v184,v184,v185
v_cmp_eq_u32 vcc,-1,v184
s_cbranch_vccnz rt_283
go_284:
buffer_load_dword v16,v2,s[20:23],s68 offen sc1
v_pk_add_f32 v[128:129],v[128:129],v[136:137]
v_pk_add_f32 v[130:131],v[130:131],v[138:139]
v_pk_add_f32 v[132:133],v[132:133],v[140:141]
v_pk_add_f32 v[134:135],v[134:135],v[142:143]
v_pk_add_f32 v[128:129],v[128:129],v[144:145]
v_pk_add_f32 v[130:131],v[130:131],v[146:147]
v_pk_add_f32 v[132:133],v[132:133],v[148:149]
v_pk_add_f32 v[134:135],v[134:135],v[150:151]
v_pk_fma_f32 v[168:169],v[128:129],v[152:153],v[168:169]
v_pk_fma_f32 v[170:171],v[130:131],v[154:155],v[170:171]
v_pk_fma_f32 v[172:173],v[132:133],v[156:157],v[172:173]
v_pk_fma_f32 v[174:175],v[134:135],v[158:159],v[174:175]
v_cvt_pk_bf16_f32 v176,v168,v169
v_cvt_pk_bf16_f32 v177,v170,v171
v_cvt_pk_bf16_f32 v178,v172,v173
v_cvt_pk_bf16_f32 v179,v174,v175
s_and_b32 s64,s66,0xffff8000
buffer_store_dwordx4 v[176:179],v22,s[24:27],s64 offen nt
s_cmp_eq_u32 s56,1
s_cbranch_scc1 b1_276
buffer_store_dwordx4 v[204:207],v21,s[20:23],s84 offen offset:0
buffer_store_dwordx4 v[204:207],v21,s[20:23],s84 offen offset:1024
b2_277:
s_cmp_eq_u32 s56,1
s_cbranch_scc1 b1_278
buffer_store_dwordx4 v[204:207],v21,s[20:23],s84 offen offset:2048
buffer_store_dwordx4 v[204:207],v21,s[20:23],s84 offen offset:3072
b2_279:
s_cmp_eq_u32 s56,1
s_cbranch_scc1 b1_280
buffer_store_dwordx4 v[204:207],v21,s[20:23],s85 offen offset:0
buffer_store_dwordx4 v[204:207],v21,s[20:23],s85 offen offset:1024
b2_281:
s_mul_i32 s64,s77,32768
s_add_u32 s66,s66,s64
s_mul_i32 s64,s77,6144
s_add_u32 s75,s75,s64
s_cmp_eq_u32 s75,24576
s_cselect_b32 s75,0,s75
s_add_u32 s63,s63,s77
s_mov_b32 s77,0
s_waitcnt vmcnt(7)
v_cmp_gt_u32 vcc,s71,v16
s_cbranch_vccz lag_234
s_cmp_ge_u32 s60,128
s_cbranch_scc1 done_180
plp_287:
buffer_load_dword v16,v2,s[20:23],s68 offen sc1
s_waitcnt vmcnt(0)
v_cmp_gt_u32 vcc,s71,v16
s_cbranch_vccz pok_288
s_sleep 4
s_sub_u32 s90,s90,1
s_cmp_gt_i32 s90,0
s_cbranch_scc1 plp_287
pok_288:
s_branch lag_234
b1_205:
s_nop 7
buffer_store_dwordx4 v[40:43],v0,s[20:23],s64 offen offset:0 sc1
buffer_store_dwordx4 v[44:47],v0,s[20:23],s64 offen offset:1024 sc1
s_branch b2_206
b1_208:
s_nop 7
buffer_store_dwordx4 v[40:43],v0,s[20:23],s64 offen offset:0 sc1
buffer_store_dwordx4 v[44:47],v0,s[20:23],s64 offen offset:1024 sc1
s_branch b2_209
b1_210:
s_nop 7
buffer_store_dwordx4 v[40:43],v0,s[20:23],s64 offen offset:0 sc1
buffer_store_dwordx4 v[44:47],v0,s[20:23],s64 offen offset:1024 sc1
s_branch b2_211
b1_212:
s_nop 7
buffer_store_dwordx4 v[40:43],v0,s[20:23],s64 offen offset:0 sc1
buffer_store_dwordx4 v[44:47],v0,s[20:23],s64 offen offset:1024 sc1
s_branch b2_213
b1_239:
s_nop 7
buffer_store_dwordx4 v[204:207],v21,s[20:23],s84 offen offset:0 sc1
buffer_store_dwordx4 v[204:207],v21,s[20:23],s84 offen offset:1024 sc1
s_branch b2_240
b1_241:
s_nop 7
buffer_store_dwordx4 v[204:207],v21,s[20:23],s84 offen offset:2048 sc1
buffer_store_dwordx4 v[204:207],v21,s[20:23],s84 offen offset:3072 sc1
s_branch b2_242
b1_243:
s_nop 7
buffer_store_dwordx4 v[204:207],v21,s[20:23],s85 offen offset:0 sc1
buffer_store_dwordx4 v[204:207],v21,s[20:23],s85 offen offset:1024 sc1
s_branch b2_244
rt_246:
s_sub_u32 s90,s90,1
s_cmp_gt_i32 s90,0
s_cbranch_scc0 go_247
s_add_u32 s84,s74,s75
s_add_u32 s85,s84,4096
buffer_load_dwordx4 v[128:131],v0,s[20:23],s84 offen offset:0 sc1
buffer_load_dwordx4 v[132:135],v0,s[20:23],s84 offen offset:1024 sc1
buffer_load_dwordx4 v[136:139],v0,s[20:23],s84 offen offset:2048 sc1
buffer_load_dwordx4 v[140:143],v0,s[20:23],s84 offen offset:3072 sc1
buffer_load_dwordx4 v[144:147],v0,s[20:23],s85 offen offset:0 sc1
buffer_load_dwordx4 v[148:151],v0,s[20:23],s85 offen offset:1024 sc1
s_waitcnt vmcnt(0)
s_branch ck_245
b1_248:
s_nop 7
buffer_store_dwordx4 v[204:207],v21,s[20:23],s84 offen offset:0 sc1
buffer_store_dwordx4 v[204:207],v21,s[20:23],s84 offen offset:1024 sc1
s_branch b2_249
b1_250:
s_nop 7
buffer_store_dwordx4 v[204:207],v21,s[20:23],s84 offen offset:2048 sc1
buffer_store_dwordx4 v[204:207],v21,s[20:23],s84 offen offset:3072 sc1
s_branch b2_251
b1_252:
s_nop 7
buffer_store_dwordx4 v[204:207],v21,s[20:23],s85 offen offset:0 sc1
buffer_store_dwordx4 v[204:207],v21,s[20:23],s85 offen offset:1024 sc1
s_branch b2_253
rt_255:
s_sub_u32 s90,s90,1
s_cmp_gt_i32 s90,0
s_cbranch_scc0 go_256
s_add_u32 s84,s74,s75
s_add_u32 s85,s84,4096
buffer_load_dwordx4 v[128:131],v0,s[20:23],s84 offen offset:0 sc1
buffer_load_dwordx4 v[132:135],v0,s[20:23],s84 offen offset:1024 sc1
buffer_load_dwordx4 v[136:139],v0,s[20:23],s84 offen offset:2048 sc1
buffer_load_dwordx4 v[140:143],v0,s[20:23],s84 offen offset:3072 sc1
buffer_load_dwordx4 v[144:147],v0,s[20:23],s85 offen offset:0 sc1
buffer_load_dwordx4 v[148:151],v0,s[20:23],s85 offen offset:1024 sc1
s_waitcnt vmcnt(0)
s_branch ck_254
b1_258:
s_nop 7
buffer_store_dwordx4 v[204:207],v21,s[20:23],s84 offen offset:0 sc1
buffer_store_dwordx4 v[204:207],v21,s[20:23],s84 offen offset:1024 sc1
s_branch b2_259
b1_260:
s_nop 7
buffer_store_dwordx4 v[204:207],v21,s[20:23],s84 offen offset:2048 sc1
buffer_store_dwordx4 v[204:207],v21,s[20:23],s84 offen offset:3072 sc1
s_branch b2_261
b1_262:
s_nop 7
buffer_store_dwordx4 v[204:207],v21,s[20:23],s85 offen offset:0 sc1
buffer_store_dwordx4 v[204:207],v21,s[20:23],s85 offen offset:1024 sc1
s_branch b2_263
rt_265:
s_sub_u32 s90,s90,1
s_cmp_gt_i32 s90,0
s_cbranch_scc0 go_266
s_add_u32 s84,s74,s75
s_add_u32 s85,s84,4096
buffer_load_dwordx4 v[128:131],v0,s[20:23],s84 offen offset:0 sc1
buffer_load_dwordx4 v[132:135],v0,s[20:23],s84 offen offset:1024 sc1
buffer_load_dwordx4 v[136:139],v0,s[20:23],s84 offen offset:2048 sc1
buffer_load_dwordx4 v[140:143],v0,s[20:23],s84 offen offset:3072 sc1
buffer_load_dwordx4 v[144:147],v0,s[20:23],s85 offen offset:0 sc1
buffer_load_dwordx4 v[148:151],v0,s[20:23],s85 offen offset:1024 sc1
s_waitcnt vmcnt(0)
s_branch ck_264
b1_267:
s_nop 7
buffer_store_dwordx4 v[204:207],v21,s[20:23],s84 offen offset:0 sc1
buffer_store_dwordx4 v[204:207],v21,s[20:23],s84 offen offset:1024 sc1
s_branch b2_268
b1_269:
s_nop 7
buffer_store_dwordx4 v[204:207],v21,s[20:23],s84 offen offset:2048 sc1
buffer_store_dwordx4 v[204:207],v21,s[20:23],s84 offen offset:3072 sc1
s_branch b2_270
b1_271:
s_nop 7
buffer_store_dwordx4 v[204:207],v21,s[20:23],s85 offen offset:0 sc1
buffer_store_dwordx4 v[204:207],v21,s[20:23],s85 offen offset:1024 sc1
s_branch b2_272
rt_274:
s_sub_u32 s90,s90,1
s_cmp_gt_i32 s90,0
s_cbranch_scc0 go_275
s_add_u32 s84,s74,s75
s_add_u32 s85,s84,4096
buffer_load_dwordx4 v[128:131],v0,s[20:23],s84 offen offset:0 sc1
buffer_load_dwordx4 v[132:135],v0,s[20:23],s84 offen offset:1024 sc1
buffer_load_dwordx4 v[136:139],v0,s[20:23],s84 offen offset:2048 sc1
buffer_load_dwordx4 v[140:143],v0,s[20:23],s84 offen offset:3072 sc1
buffer_load_dwordx4 v[144:147],v0,s[20:23],s85 offen offset:0 sc1
buffer_load_dwordx4 v[148:151],v0,s[20:23],s85 offen offset:1024 sc1
s_waitcnt vmcnt(0)
s_branch ck_273
b1_276:
s_nop 7
buffer_store_dwordx4 v[204:207],v21,s[20:23],s84 offen offset:0 sc1
buffer_store_dwordx4 v[204:207],v21,s[20:23],s84 offen offset:1024 sc1
s_branch b2_277
b1_278:
s_nop 7
buffer_store_dwordx4 v[204:207],v21,s[20:23],s84 offen offset:2048 sc1
buffer_store_dwordx4 v[204:207],v21,s[20:23],s84 offen offset:3072 sc1
s_branch b2_279
b1_280:
s_nop 7
buffer_store_dwordx4 v[204:207],v21,s[20:23],s85 offen offset:0 sc1
buffer_store_dwordx4 v[204:207],v21,s[20:23],s85 offen offset:1024 sc1
s_branch b2_281
rt_283:
s_sub_u32 s90,s90,1
s_cmp_gt_i32 s90,0
s_cbranch_scc0 go_284
s_add_u32 s84,s74,s75
s_add_u32 s85,s84,4096
buffer_load_dwordx4 v[128:131],v0,s[20:23],s84 offen offset:0 sc1
buffer_load_dwordx4 v[132:135],v0,s[20:23],s84 offen offset:1024 sc1
buffer_load_dwordx4 v[136:139],v0,s[20:23],s84 offen offset:2048 sc1
buffer_load_dwordx4 v[140:143],v0,s[20:23],s84 offen offset:3072 sc1
buffer_load_dwordx4 v[144:147],v0,s[20:23],s85 offen offset:0 sc1
buffer_load_dwordx4 v[148:151],v0,s[20:23],s85 offen offset:1024 sc1
s_waitcnt vmcnt(0)
s_branch ck_282
done_180:
s_endpgm
fl_w3:
v_and_b32 v21,15,v1
v_lshrrev_b32 v22,4,v1
v_lshrrev_b32 v23,2,v21
v_and_b32 v24,3,v21
s_lshl_b32 s61,s50,15
v_lshl_add_u32 v25,v22,3,v23
s_load_dwordx2 s[4:5],s[0:1],80
s_mov_b32 s52,0
s_mov_b32 s53,s59
s_mul_i32 s54,s52,7340032
s_lshl_b32 s64,s53,8
s_add_u32 s54,s54,s64
s_lshl_b32 s64,s50,6
s_add_u32 s54,s54,s64
s_waitcnt lgkmcnt(0)
s_mov_b32 s28,s4
s_and_b32 s29,s5,0xffff
s_mov_b32 s30,0x700000
s_mov_b32 s31,0x20000
v_lshrrev_b32 v26,2,v1
v_and_b32 v27,3,v1
v_mul_u32_u24 v16,7168,v26
v_lshl_add_u32 v16,v27,4,v16
v_lshlrev_b32 v17,6,v25
v_lshl_add_u32 v17,v24,4,v17
v_add_u32 v17,s61,v17
s_xor_b32 s62,s50,0
s_mul_i32 s62,s62,1835008
s_add_u32 s62,s62,s54
s_add_u32 m0,s61,0
s_nop 0
buffer_load_dwordx4 v16,s[28:31],s62 offen nt lds
s_add_u32 s62,s62,114688
s_add_u32 m0,m0,1024
s_waitcnt vmcnt(2)
buffer_load_dwordx4 v16,s[28:31],s62 offen nt lds
s_add_u32 s62,s62,114688
s_add_u32 m0,m0,1024
s_waitcnt vmcnt(2)
buffer_load_dwordx4 v16,s[28:31],s62 offen nt lds
s_add_u32 s62,s62,114688
s_add_u32 m0,m0,1024
s_waitcnt vmcnt(2)
buffer_load_dwordx4 v16,s[28:31],s62 offen nt lds
s_add_u32 s62,s62,114688
s_add_u32 m0,m0,1024
s_waitcnt vmcnt(2)
buffer_load_dwordx4 v16,s[28:31],s62 offen nt lds
s_add_u32 s62,s62,114688
s_add_u32 m0,m0,1024
s_waitcnt vmcnt(2)
buffer_load_dwordx4 v16,s[28:31],s62 offen nt lds
s_add_u32 s62,s62,114688
s_add_u32 m0,m0,1024
s_waitcnt vmcnt(2)
buffer_load_dwordx4 v16,s[28:31],s62 offen nt lds
s_add_u32 s62,s62,114688
s_add_u32 m0,m0,1024
s_waitcnt vmcnt(2)
buffer_load_dwordx4 v16,s[28:31],s62 offen nt lds
s_add_u32 s62,s62,114688
s_add_u32 m0,m0,1024
s_waitcnt vmcnt(2)
buffer_load_dwordx4 v16,s[28:31],s62 offen nt lds
s_add_u32 s62,s62,114688
s_add_u32 m0,m0,1024
s_waitcnt vmcnt(2)
buffer_load_dwordx4 v16,s[28:31],s62 offen nt lds
s_add_u32 s62,s62,114688
s_add_u32 m0,m0,1024
s_waitcnt vmcnt(2)
buffer_load_dwordx4 v16,s[28:31],s62 offen nt lds
s_add_u32 s62,s62,114688
s_add_u32 m0,m0,1024
s_waitcnt vmcnt(2)
buffer_load_dwordx4 v16,s[28:31],s62 offen nt lds
s_add_u32 s62,s62,114688
s_add_u32 m0,m0,1024
s_waitcnt vmcnt(2)
buffer_load_dwordx4 v16,s[28:31],s62 offen nt lds
s_add_u32 s62,s62,114688
s_add_u32 m0,m0,1024
s_waitcnt vmcnt(2)
buffer_load_dwordx4 v16,s[28:31],s62 offen nt lds
s_add_u32 s62,s62,114688
s_add_u32 m0,m0,1024
s_waitcnt vmcnt(2)
buffer_load_dwordx4 v16,s[28:31],s62 offen nt lds
s_add_u32 s62,s62,114688
s_add_u32 m0,m0,1024
s_waitcnt vmcnt(2)
buffer_load_dwordx4 v16,s[28:31],s62 offen nt lds
s_waitcnt vmcnt(2)
s_xor_b32 s62,s50,1
s_mul_i32 s62,s62,1835008
s_add_u32 s62,s62,s54
s_add_u32 m0,s61,16384
s_nop 0
buffer_load_dwordx4 v16,s[28:31],s62 offen nt lds
s_add_u32 s62,s62,114688
s_add_u32 m0,m0,1024
s_waitcnt vmcnt(2)
buffer_load_dwordx4 v16,s[28:31],s62 offen nt lds
s_add_u32 s62,s62,114688
s_add_u32 m0,m0,1024
s_waitcnt vmcnt(2)
buffer_load_dwordx4 v16,s[28:31],s62 offen nt lds
s_add_u32 s62,s62,114688
s_add_u32 m0,m0,1024
s_waitcnt vmcnt(2)
buffer_load_dwordx4 v16,s[28:31],s62 offen nt lds
s_add_u32 s62,s62,114688
s_add_u32 m0,m0,1024
s_waitcnt vmcnt(2)
buffer_load_dwordx4 v16,s[28:31],s62 offen nt lds
s_add_u32 s62,s62,114688
s_add_u32 m0,m0,1024
s_waitcnt vmcnt(2)
buffer_load_dwordx4 v16,s[28:31],s62 offen nt lds
s_add_u32 s62,s62,114688
s_add_u32 m0,m0,1024
s_waitcnt vmcnt(2)
buffer_load_dwordx4 v16,s[28:31],s62 offen nt lds
s_add_u32 s62,s62,114688
s_add_u32 m0,m0,1024
s_waitcnt vmcnt(2)
buffer_load_dwordx4 v16,s[28:31],s62 offen nt lds
s_add_u32 s62,s62,114688
s_add_u32 m0,m0,1024
s_waitcnt vmcnt(2)
buffer_load_dwordx4 v16,s[28:31],s62 offen nt lds
s_add_u32 s62,s62,114688
s_add_u32 m0,m0,1024
s_waitcnt vmcnt(2)
buffer_load_dwordx4 v16,s[28:31],s62 offen nt lds
s_add_u32 s62,s62,114688
s_add_u32 m0,m0,1024
s_waitcnt vmcnt(2)
buffer_load_dwordx4 v16,s[28:31],s62 offen nt lds
s_add_u32 s62,s62,114688
s_add_u32 m0,m0,1024
s_waitcnt vmcnt(2)
buffer_load_dwordx4 v16,s[28:31],s62 offen nt lds
s_add_u32 s62,s62,114688
s_add_u32 m0,m0,1024
s_waitcnt vmcnt(2)
buffer_load_dwordx4 v16,s[28:31],s62 offen nt lds
s_add_u32 s62,s62,114688
s_add_u32 m0,m0,1024
s_waitcnt vmcnt(2)
buffer_load_dwordx4 v16,s[28:31],s62 offen nt lds
s_add_u32 s62,s62,114688
s_add_u32 m0,m0,1024
s_waitcnt vmcnt(2)
buffer_load_dwordx4 v16,s[28:31],s62 offen nt lds
s_add_u32 s62,s62,114688
s_add_u32 m0,m0,1024
s_waitcnt vmcnt(2)
buffer_load_dwordx4 v16,s[28:31],s62 offen nt lds
s_waitcnt vmcnt(2)
s_waitcnt vmcnt(16)
ds_read_b64_tr_b16 a[0:1],v17 offset:0
ds_read_b64_tr_b16 a[2:3],v17 offset:256
ds_read_b64_tr_b16 a[4:5],v17 offset:8
ds_read_b64_tr_b16 a[6:7],v17 offset:264
ds_read_b64_tr_b16 a[8:9],v17 offset:2048
ds_read_b64_tr_b16 a[10:11],v17 offset:2304
ds_read_b64_tr_b16 a[12:13],v17 offset:2056
ds_read_b64_tr_b16 a[14:15],v17 offset:2312
ds_read_b64_tr_b16 a[16:17],v17 offset:4096
ds_read_b64_tr_b16 a[18:19],v17 offset:4352
ds_read_b64_tr_b16 a[20:21],v17 offset:4104
ds_read_b64_tr_b16 a[22:23],v17 offset:4360
s_waitcnt lgkmcnt(0)
ds_read_b64_tr_b16 a[24:25],v17 offset:6144
ds_read_b64_tr_b16 a[26:27],v17 offset:6400
ds_read_b64_tr_b16 a[28:29],v17 offset:6152
ds_read_b64_tr_b16 a[30:31],v17 offset:6408
ds_read_b64_tr_b16 a[32:33],v17 offset:8192
ds_read_b64_tr_b16 a[34:35],v17 offset:8448
ds_read_b64_tr_b16 a[36:37],v17 offset:8200
ds_read_b64_tr_b16 a[38:39],v17 offset:8456
ds_read_b64_tr_b16 a[40:41],v17 offset:10240
ds_read_b64_tr_b16 a[42:43],v17 offset:10496
ds_read_b64_tr_b16 a[44:45],v17 offset:10248
ds_read_b64_tr_b16 a[46:47],v17 offset:10504
s_waitcnt lgkmcnt(0)
ds_read_b64_tr_b16 a[48:49],v17 offset:12288
ds_read_b64_tr_b16 a[50:51],v17 offset:12544
ds_read_b64_tr_b16 a[52:53],v17 offset:12296
ds_read_b64_tr_b16 a[54:55],v17 offset:12552
ds_read_b64_tr_b16 a[56:57],v17 offset:14336
ds_read_b64_tr_b16 a[58:59],v17 offset:14592
ds_read_b64_tr_b16 a[60:61],v17 offset:14344
ds_read_b64_tr_b16 a[62:63],v17 offset:14600
s_waitcnt lgkmcnt(0)
s_xor_b32 s62,s50,2
s_mul_i32 s62,s62,1835008
s_add_u32 s62,s62,s54
s_add_u32 m0,s61,0
s_nop 0
buffer_load_dwordx4 v16,s[28:31],s62 offen nt lds
s_add_u32 s62,s62,114688
s_add_u32 m0,m0,1024
s_waitcnt vmcnt(2)
buffer_load_dwordx4 v16,s[28:31],s62 offen nt lds
s_add_u32 s62,s62,114688
s_add_u32 m0,m0,1024
s_waitcnt vmcnt(2)
buffer_load_dwordx4 v16,s[28:31],s62 offen nt lds
s_add_u32 s62,s62,114688
s_add_u32 m0,m0,1024
s_waitcnt vmcnt(2)
buffer_load_dwordx4 v16,s[28:31],s62 offen nt lds
s_add_u32 s62,s62,114688
s_add_u32 m0,m0,1024
s_waitcnt vmcnt(2)
buffer_load_dwordx4 v16,s[28:31],s62 offen nt lds
s_add_u32 s62,s62,114688
s_add_u32 m0,m0,1024
s_waitcnt vmcnt(2)
buffer_load_dwordx4 v16,s[28:31],s62 offen nt lds
s_add_u32 s62,s62,114688
s_add_u32 m0,m0,1024
s_waitcnt vmcnt(2)
buffer_load_dwordx4 v16,s[28:31],s62 offen nt lds
s_add_u32 s62,s62,114688
s_add_u32 m0,m0,1024
s_waitcnt vmcnt(2)
buffer_load_dwordx4 v16,s[28:31],s62 offen nt lds
s_add_u32 s62,s62,114688
s_add_u32 m0,m0,1024
s_waitcnt vmcnt(2)
buffer_load_dwordx4 v16,s[28:31],s62 offen nt lds
s_add_u32 s62,s62,114688
s_add_u32 m0,m0,1024
s_waitcnt vmcnt(2)
buffer_load_dwordx4 v16,s[28:31],s62 offen nt lds
s_add_u32 s62,s62,114688
s_add_u32 m0,m0,1024
s_waitcnt vmcnt(2)
buffer_load_dwordx4 v16,s[28:31],s62 offen nt lds
s_add_u32 s62,s62,114688
s_add_u32 m0,m0,1024
s_waitcnt vmcnt(2)
buffer_load_dwordx4 v16,s[28:31],s62 offen nt lds
s_add_u32 s62,s62,114688
s_add_u32 m0,m0,1024
s_waitcnt vmcnt(2)
buffer_load_dwordx4 v16,s[28:31],s62 offen nt lds
s_add_u32 s62,s62,114688
s_add_u32 m0,m0,1024
s_waitcnt vmcnt(2)
buffer_load_dwordx4 v16,s[28:31],s62 offen nt lds
s_add_u32 s62,s62,114688
s_add_u32 m0,m0,1024
s_waitcnt vmcnt(2)
buffer_load_dwordx4 v16,s[28:31],s62 offen nt lds
s_add_u32 s62,s62,114688
s_add_u32 m0,m0,1024
s_waitcnt vmcnt(2)
buffer_load_dwordx4 v16,s[28:31],s62 offen nt lds
s_waitcnt vmcnt(2)
s_waitcnt vmcnt(16)
ds_read_b64_tr_b16 a[64:65],v17 offset:16384
ds_read_b64_tr_b16 a[66:67],v17 offset:16640
ds_read_b64_tr_b16 a[68:69],v17 offset:16392
ds_read_b64_tr_b16 a[70:71],v17 offset:16648
ds_read_b64_tr_b16 a[72:73],v17 offset:18432
ds_read_b64_tr_b16 a[74:75],v17 offset:18688
ds_read_b64_tr_b16 a[76:77],v17 offset:18440
ds_read_b64_tr_b16 a[78:79],v17 offset:18696
ds_read_b64_tr_b16 a[80:81],v17 offset:20480
ds_read_b64_tr_b16 a[82:83],v17 offset:20736
ds_read_b64_tr_b16 a[84:85],v17 offset:20488
ds_read_b64_tr_b16 a[86:87],v17 offset:20744
s_waitcnt lgkmcnt(0)
ds_read_b64_tr_b16 a[88:89],v17 offset:22528
ds_read_b64_tr_b16 a[90:91],v17 offset:22784
ds_read_b64_tr_b16 a[92:93],v17 offset:22536
ds_read_b64_tr_b16 a[94:95],v17 offset:22792
ds_read_b64_tr_b16 a[96:97],v17 offset:24576
ds_read_b64_tr_b16 a[98:99],v17 offset:24832
ds_read_b64_tr_b16 a[100:101],v17 offset:24584
ds_read_b64_tr_b16 a[102:103],v17 offset:24840
ds_read_b64_tr_b16 a[104:105],v17 offset:26624
ds_read_b64_tr_b16 a[106:107],v17 offset:26880
ds_read_b64_tr_b16 a[108:109],v17 offset:26632
ds_read_b64_tr_b16 a[110:111],v17 offset:26888
s_waitcnt lgkmcnt(0)
ds_read_b64_tr_b16 a[112:113],v17 offset:28672
ds_read_b64_tr_b16 a[114:115],v17 offset:28928
ds_read_b64_tr_b16 a[116:117],v17 offset:28680
ds_read_b64_tr_b16 a[118:119],v17 offset:28936
ds_read_b64_tr_b16 a[120:121],v17 offset:30720
ds_read_b64_tr_b16 a[122:123],v17 offset:30976
ds_read_b64_tr_b16 a[124:125],v17 offset:30728
ds_read_b64_tr_b16 a[126:127],v17 offset:30984
s_waitcnt lgkmcnt(0)
s_xor_b32 s62,s50,3
s_mul_i32 s62,s62,1835008
s_add_u32 s62,s62,s54
s_add_u32 m0,s61,16384
s_nop 0
buffer_load_dwordx4 v16,s[28:31],s62 offen nt lds
s_add_u32 s62,s62,114688
s_add_u32 m0,m0,1024
s_waitcnt vmcnt(2)
buffer_load_dwordx4 v16,s[28:31],s62 offen nt lds
s_add_u32 s62,s62,114688
s_add_u32 m0,m0,1024
s_waitcnt vmcnt(2)
buffer_load_dwordx4 v16,s[28:31],s62 offen nt lds
s_add_u32 s62,s62,114688
s_add_u32 m0,m0,1024
s_waitcnt vmcnt(2)
buffer_load_dwordx4 v16,s[28:31],s62 offen nt lds
s_add_u32 s62,s62,114688
s_add_u32 m0,m0,1024
s_waitcnt vmcnt(2)
buffer_load_dwordx4 v16,s[28:31],s62 offen nt lds
s_add_u32 s62,s62,114688
s_add_u32 m0,m0,1024
s_waitcnt vmcnt(2)
buffer_load_dwordx4 v16,s[28:31],s62 offen nt lds
s_add_u32 s62,s62,114688
s_add_u32 m0,m0,1024
s_waitcnt vmcnt(2)
buffer_load_dwordx4 v16,s[28:31],s62 offen nt lds
s_add_u32 s62,s62,114688
s_add_u32 m0,m0,1024
s_waitcnt vmcnt(2)
buffer_load_dwordx4 v16,s[28:31],s62 offen nt lds
s_add_u32 s62,s62,114688
s_add_u32 m0,m0,1024
s_waitcnt vmcnt(2)
buffer_load_dwordx4 v16,s[28:31],s62 offen nt lds
s_add_u32 s62,s62,114688
s_add_u32 m0,m0,1024
s_waitcnt vmcnt(2)
buffer_load_dwordx4 v16,s[28:31],s62 offen nt lds
s_add_u32 s62,s62,114688
s_add_u32 m0,m0,1024
s_waitcnt vmcnt(2)
buffer_load_dwordx4 v16,s[28:31],s62 offen nt lds
s_add_u32 s62,s62,114688
s_add_u32 m0,m0,1024
s_waitcnt vmcnt(2)
buffer_load_dwordx4 v16,s[28:31],s62 offen nt lds
s_add_u32 s62,s62,114688
s_add_u32 m0,m0,1024
s_waitcnt vmcnt(2)
buffer_load_dwordx4 v16,s[28:31],s62 offen nt lds
s_add_u32 s62,s62,114688
s_add_u32 m0,m0,1024
s_waitcnt vmcnt(2)
buffer_load_dwordx4 v16,s[28:31],s62 offen nt lds
s_add_u32 s62,s62,114688
s_add_u32 m0,m0,1024
s_waitcnt vmcnt(2)
buffer_load_dwordx4 v16,s[28:31],s62 offen nt lds
s_add_u32 s62,s62,114688
s_add_u32 m0,m0,1024
s_waitcnt vmcnt(2)
buffer_load_dwordx4 v16,s[28:31],s62 offen nt lds
s_waitcnt vmcnt(2)
s_waitcnt vmcnt(16)
ds_read_b64_tr_b16 a[128:129],v17 offset:0
ds_read_b64_tr_b16 a[130:131],v17 offset:256
ds_read_b64_tr_b16 a[132:133],v17 offset:8
ds_read_b64_tr_b16 a[134:135],v17 offset:264
ds_read_b64_tr_b16 a[136:137],v17 offset:2048
ds_read_b64_tr_b16 a[138:139],v17 offset:2304
ds_read_b64_tr_b16 a[140:141],v17 offset:2056
ds_read_b64_tr_b16 a[142:143],v17 offset:2312
ds_read_b64_tr_b16 a[144:145],v17 offset:4096
ds_read_b64_tr_b16 a[146:147],v17 offset:4352
ds_read_b64_tr_b16 a[148:149],v17 offset:4104
ds_read_b64_tr_b16 a[150:151],v17 offset:4360
s_waitcnt lgkmcnt(0)
ds_read_b64_tr_b16 a[152:153],v17 offset:6144
ds_read_b64_tr_b16 a[154:155],v17 offset:6400
ds_read_b64_tr_b16 a[156:157],v17 offset:6152
ds_read_b64_tr_b16 a[158:159],v17 offset:6408
ds_read_b64_tr_b16 a[160:161],v17 offset:8192
ds_read_b64_tr_b16 a[162:163],v17 offset:8448
ds_read_b64_tr_b16 a[164:165],v17 offset:8200
ds_read_b64_tr_b16 a[166:167],v17 offset:8456
ds_read_b64_tr_b16 a[168:169],v17 offset:10240
ds_read_b64_tr_b16 a[170:171],v17 offset:10496
ds_read_b64_tr_b16 a[172:173],v17 offset:10248
ds_read_b64_tr_b16 a[174:175],v17 offset:10504
s_waitcnt lgkmcnt(0)
ds_read_b64_tr_b16 a[176:177],v17 offset:12288
ds_read_b64_tr_b16 a[178:179],v17 offset:12544
ds_read_b64_tr_b16 a[180:181],v17 offset:12296
ds_read_b64_tr_b16 a[182:183],v17 offset:12552
ds_read_b64_tr_b16 a[184:185],v17 offset:14336
ds_read_b64_tr_b16 a[186:187],v17 offset:14592
ds_read_b64_tr_b16 a[188:189],v17 offset:14344
ds_read_b64_tr_b16 a[190:191],v17 offset:14600
s_waitcnt lgkmcnt(0)
s_waitcnt vmcnt(0)
ds_read_b64_tr_b16 a[192:193],v17 offset:16384
ds_read_b64_tr_b16 a[194:195],v17 offset:16640
ds_read_b64_tr_b16 a[196:197],v17 offset:16392
ds_read_b64_tr_b16 a[198:199],v17 offset:16648
ds_read_b64_tr_b16 a[200:201],v17 offset:18432
ds_read_b64_tr_b16 a[202:203],v17 offset:18688
ds_read_b64_tr_b16 a[204:205],v17 offset:18440
ds_read_b64_tr_b16 a[206:207],v17 offset:18696
ds_read_b64_tr_b16 a[208:209],v17 offset:20480
ds_read_b64_tr_b16 a[210:211],v17 offset:20736
ds_read_b64_tr_b16 a[212:213],v17 offset:20488
ds_read_b64_tr_b16 a[214:215],v17 offset:20744
s_waitcnt lgkmcnt(0)
ds_read_b64_tr_b16 a[216:217],v17 offset:22528
ds_read_b64_tr_b16 a[218:219],v17 offset:22784
ds_read_b64_tr_b16 a[220:221],v17 offset:22536
ds_read_b64_tr_b16 a[222:223],v17 offset:22792
ds_read_b64_tr_b16 a[224:225],v17 offset:24576
ds_read_b64_tr_b16 a[226:227],v17 offset:24832
ds_read_b64_tr_b16 a[228:229],v17 offset:24584
ds_read_b64_tr_b16 a[230:231],v17 offset:24840
ds_read_b64_tr_b16 a[232:233],v17 offset:26624
ds_read_b64_tr_b16 a[234:235],v17 offset:26880
ds_read_b64_tr_b16 a[236:237],v17 offset:26632
ds_read_b64_tr_b16 a[238:239],v17 offset:26888
s_waitcnt lgkmcnt(0)
ds_read_b64_tr_b16 a[240:241],v17 offset:28672
ds_read_b64_tr_b16 a[242:243],v17 offset:28928
ds_read_b64_tr_b16 a[244:245],v17 offset:28680
ds_read_b64_tr_b16 a[246:247],v17 offset:28936
ds_read_b64_tr_b16 a[248:249],v17 offset:30720
ds_read_b64_tr_b16 a[250:251],v17 offset:30976
ds_read_b64_tr_b16 a[252:253],v17 offset:30728
ds_read_b64_tr_b16 a[254:255],v17 offset:30984
s_waitcnt lgkmcnt(0)
s_mov_b32 s92,s2
s_and_b32 s93,s3,0xffff
s_mov_b32 s94,0x100
s_mov_b32 s95,0x20000
v_mbcnt_lo_u32_b32 v16,-1,0
v_mbcnt_hi_u32_b32 v16,-1,v16
v_mov_b32 v18,0
v_cmp_eq_u32 vcc,22,v16
s_nop 1
v_cndmask_b32 v18,v18,63,vcc
v_cmp_eq_u32 vcc,17,v16
s_nop 1
v_cndmask_b32 v18,v18,63,vcc
v_cmp_eq_u32 vcc,18,v16
s_nop 1
v_cndmask_b32 v18,v18,1,vcc
v_and_b32 v19,1,v16
v_cmp_eq_u32 vcc,1,v19
v_mov_b32 v19,8192
s_nop 0
v_cndmask_b32 v19,-1,v19,vcc
v_min_u32 v16,31,v16
v_lshlrev_b32 v16,2,v16
s_sub_u32 s66,s88,64
s_cmp_lg_u32 s50,0
s_cbranch_scc1 vot_294
vpoll_290:
buffer_load_dword v17,v16,s[92:95],s66 offen sc1
s_waitcnt vmcnt(0)
s_cmp_lg_u32 s56,2
s_cbranch_scc1 vck_291
v_cmp_eq_u32 vcc,v17,v19
s_and_b32 s64,vcc_lo,0xffff
s_cmp_eq_u32 s64,65535
s_cbranch_scc1 vck_291
s_mov_b32 s65,0
v_readlane_b32 s64,v17,1
s_lshr_b32 s64,s64,8
s_add_u32 s65,s65,s64
v_readlane_b32 s64,v17,3
s_lshr_b32 s64,s64,8
s_add_u32 s65,s65,s64
v_readlane_b32 s64,v17,5
s_lshr_b32 s64,s64,8
s_add_u32 s65,s65,s64
v_readlane_b32 s64,v17,7
s_lshr_b32 s64,s64,8
s_add_u32 s65,s65,s64
v_readlane_b32 s64,v17,9
s_lshr_b32 s64,s64,8
s_add_u32 s65,s65,s64
v_readlane_b32 s64,v17,11
s_lshr_b32 s64,s64,8
s_add_u32 s65,s65,s64
v_readlane_b32 s64,v17,13
s_lshr_b32 s64,s64,8
s_add_u32 s65,s65,s64
v_readlane_b32 s64,v17,15
s_lshr_b32 s64,s64,8
s_add_u32 s65,s65,s64
s_cmp_ge_u32 s65,256
s_cbranch_scc1 vok_293
s_branch vrt_292
vck_291:
v_cmp_gt_u32 vcc,v18,v17
s_cbranch_vccz vok_293
vrt_292:
s_sleep 48
s_sub_u32 s90,s90,1
s_cmp_gt_i32 s90,0
s_cbranch_scc1 vpoll_290
vok_293:
v_add_u32 v18,160256,v16
ds_write_b32 v18,v17
s_waitcnt lgkmcnt(0)
vot_294:
s_barrier
v_add_u32 v18,160256,v16
ds_read_b32 v17,v18
s_waitcnt lgkmcnt(0)
s_cmp_lg_u32 s56,2
s_cbranch_scc1 vfin_295
v_cmp_eq_u32 vcc,v17,v19
s_and_b32 s64,vcc_lo,0xffff
s_cmp_eq_u32 s64,65535
s_cbranch_scc1 vfin_295
s_mov_b32 s65,0
v_readlane_b32 s64,v17,1
s_lshr_b32 s64,s64,8
s_add_u32 s65,s65,s64
v_readlane_b32 s64,v17,3
s_lshr_b32 s64,s64,8
s_add_u32 s65,s65,s64
v_readlane_b32 s64,v17,5
s_lshr_b32 s64,s64,8
s_add_u32 s65,s65,s64
v_readlane_b32 s64,v17,7
s_lshr_b32 s64,s64,8
s_add_u32 s65,s65,s64
v_readlane_b32 s64,v17,9
s_lshr_b32 s64,s64,8
s_add_u32 s65,s65,s64
v_readlane_b32 s64,v17,11
s_lshr_b32 s64,s64,8
s_add_u32 s65,s65,s64
v_readlane_b32 s64,v17,13
s_lshr_b32 s64,s64,8
s_add_u32 s65,s65,s64
v_readlane_b32 s64,v17,15
s_lshr_b32 s64,s64,8
s_add_u32 s65,s65,s64
s_cmp_ge_u32 s65,256
s_cbranch_scc1 fl_fb
vfin_295:
s_and_b32 s56,s56,1
s_mov_b32 s67,0
s_barrier
v_lshlrev_b32 v0,4,v1
s_mov_b32 s60,0
s_lshl_b32 s70,s50,13
s_mov_b32 s55,0
v_mov_b32 v3,v0
s_mov_b32 s73,0xffff0000
s_lshl_b32 s64,s52,2
s_add_u32 s64,s64,s50
s_mul_i32 s61,s64,8192
s_add_u32 s61,s61,214958080
s_lshl_b32 s68,s64,8
s_add_u32 s68,s68,138550272
s_lshl_b32 s83,s53,2
s_add_u32 s83,s83,s50
s_mov_b32 s63,0
s_xor_b32 s64,s50,0
s_lshl_b32 s64,s64,13
v_add_u32 v8,s64,v0
v_mov_b32 v4,v8
s_xor_b32 s64,s50,1
s_lshl_b32 s64,s64,13
v_add_u32 v9,s64,v0
v_mov_b32 v5,v9
s_xor_b32 s64,s50,2
s_lshl_b32 s64,s64,13
v_add_u32 v10,s64,v0
v_mov_b32 v6,v10
s_xor_b32 s64,s50,3
s_lshl_b32 s64,s64,13
v_add_u32 v11,s64,v0
v_mov_b32 v7,v11
v_min_u32 v2,7,v1
v_lshlrev_b32 v2,2,v2
s_add_u32 s62,s61,4096
s_lshl_b32 s66,s83,10
s_mul_i32 s65,s83,147
s_lshr_b32 s65,s65,10
s_mul_i32 s69,s65,228
s_lshl_b32 s64,s83,2
s_add_u32 s69,s69,s64
s_add_u32 s69,s69,138551296
s_add_u32 s82,s66,201326592
s_add_u32 s66,s66,219152384
s_lshl_b32 s64,s50,9
s_add_u32 s64,s64,131072
v_lshlrev_b32 v26,3,v1
v_add_u32 v19,s64,v26
v_lshl_add_u32 v26,v23,4,v21
v_lshlrev_b32 v26,3,v26
v_add_u32 v20,131072,v26
s_mov_b32 s74,0x22222222
s_mov_b32 s75,0x22222222
s_mov_b32 s76,0x44444444
s_mov_b32 s77,0x44444444
s_mov_b32 s78,0x88888888
s_mov_b32 s79,0x88888888
v_mov_b32 v208,0xbdd2d3e8
v_mov_b32 v209,0xc0135761
v_mov_b32 v210,0x3727c5ac
v_mov_b32 v211,0x3a800000
v_mov_b32 v12,0x3f803f80
v_mov_b32 v13,0x3f803f80
v_mov_b32 v14,0x3f803f80
v_mov_b32 v15,0x3f803f80
s_nop 1
v_mfma_f32_16x16x32_bf16 v[152:155],a[0:3],v[12:15],0
v_mfma_f32_16x16x32_bf16 v[156:159],a[4:7],v[12:15],0
v_mfma_f32_16x16x32_bf16 v[152:155],a[8:11],v[12:15],v[152:155]
v_mfma_f32_16x16x32_bf16 v[156:159],a[12:15],v[12:15],v[156:159]
v_mfma_f32_16x16x32_bf16 v[152:155],a[16:19],v[12:15],v[152:155]
v_mfma_f32_16x16x32_bf16 v[156:159],a[20:23],v[12:15],v[156:159]
v_mfma_f32_16x16x32_bf16 v[152:155],a[24:27],v[12:15],v[152:155]
v_mfma_f32_16x16x32_bf16 v[156:159],a[28:31],v[12:15],v[156:159]
v_mfma_f32_16x16x32_bf16 v[152:155],a[32:35],v[12:15],v[152:155]
v_mfma_f32_16x16x32_bf16 v[156:159],a[36:39],v[12:15],v[156:159]
v_mfma_f32_16x16x32_bf16 v[152:155],a[40:43],v[12:15],v[152:155]
v_mfma_f32_16x16x32_bf16 v[156:159],a[44:47],v[12:15],v[156:159]
v_mfma_f32_16x16x32_bf16 v[152:155],a[48:51],v[12:15],v[152:155]
v_mfma_f32_16x16x32_bf16 v[156:159],a[52:55],v[12:15],v[156:159]
v_mfma_f32_16x16x32_bf16 v[152:155],a[56:59],v[12:15],v[152:155]
v_mfma_f32_16x16x32_bf16 v[156:159],a[60:63],v[12:15],v[156:159]
v_mfma_f32_16x16x32_bf16 v[152:155],a[64:67],v[12:15],v[152:155]
v_mfma_f32_16x16x32_bf16 v[156:159],a[68:71],v[12:15],v[156:159]
v_mfma_f32_16x16x32_bf16 v[152:155],a[72:75],v[12:15],v[152:155]
v_mfma_f32_16x16x32_bf16 v[156:159],a[76:79],v[12:15],v[156:159]
v_mfma_f32_16x16x32_bf16 v[152:155],a[80:83],v[12:15],v[152:155]
v_mfma_f32_16x16x32_bf16 v[156:159],a[84:87],v[12:15],v[156:159]
v_mfma_f32_16x16x32_bf16 v[152:155],a[88:91],v[12:15],v[152:155]
v_mfma_f32_16x16x32_bf16 v[156:159],a[92:95],v[12:15],v[156:159]
v_mfma_f32_16x16x32_bf16 v[152:155],a[96:99],v[12:15],v[152:155]
v_mfma_f32_16x16x32_bf16 v[156:159],a[100:103],v[12:15],v[156:159]
v_mfma_f32_16x16x32_bf16 v[152:155],a[104:107],v[12:15],v[152:155]
v_mfma_f32_16x16x32_bf16 v[156:159],a[108:111],v[12:15],v[156:159]
v_mfma_f32_16x16x32_bf16 v[152:155],a[112:115],v[12:15],v[152:155]
v_mfma_f32_16x16x32_bf16 v[156:159],a[116:119],v[12:15],v[156:159]
v_mfma_f32_16x16x32_bf16 v[152:155],a[120:123],v[12:15],v[152:155]
v_mfma_f32_16x16x32_bf16 v[156:159],a[124:127],v[12:15],v[156:159]
v_mfma_f32_16x16x32_bf16 v[152:155],a[128:131],v[12:15],v[152:155]
v_mfma_f32_16x16x32_bf16 v[156:159],a[132:135],v[12:15],v[156:159]
v_mfma_f32_16x16x32_bf16 v[152:155],a[136:139],v[12:15],v[152:155]
v_mfma_f32_16x16x32_bf16 v[156:159],a[140:143],v[12:15],v[156:159]
v_mfma_f32_16x16x32_bf16 v[152:155],a[144:147],v[12:15],v[152:155]
v_mfma_f32_16x16x32_bf16 v[156:159],a[148:151],v[12:15],v[156:159]
v_mfma_f32_16x16x32_bf16 v[152:155],a[152:155],v[12:15],v[152:155]
v_mfma_f32_16x16x32_bf16 v[156:159],a[156:159],v[12:15],v[156:159]
v_mfma_f32_16x16x32_bf16 v[152:155],a[160:163],v[12:15],v[152:155]
v_mfma_f32_16x16x32_bf16 v[156:159],a[164:167],v[12:15],v[156:159]
v_mfma_f32_16x16x32_bf16 v[152:155],a[168:171],v[12:15],v[152:155]
v_mfma_f32_16x16x32_bf16 v[156:159],a[172:175],v[12:15],v[156:159]
v_mfma_f32_16x16x32_bf16 v[152:155],a[176:179],v[12:15],v[152:155]
v_mfma_f32_16x16x32_bf16 v[156:159],a[180:183],v[12:15],v[156:159]
v_mfma_f32_16x16x32_bf16 v[152:155],a[184:187],v[12:15],v[152:155]
v_mfma_f32_16x16x32_bf16 v[156:159],a[188:191],v[12:15],v[156:159]
v_mfma_f32_16x16x32_bf16 v[152:155],a[192:195],v[12:15],v[152:155]
v_mfma_f32_16x16x32_bf16 v[156:159],a[196:199],v[12:15],v[156:159]
v_mfma_f32_16x16x32_bf16 v[152:155],a[200:203],v[12:15],v[152:155]
v_mfma_f32_16x16x32_bf16 v[156:159],a[204:207],v[12:15],v[156:159]
v_mfma_f32_16x16x32_bf16 v[152:155],a[208:211],v[12:15],v[152:155]
v_mfma_f32_16x16x32_bf16 v[156:159],a[212:215],v[12:15],v[156:159]
v_mfma_f32_16x16x32_bf16 v[152:155],a[216:219],v[12:15],v[152:155]
v_mfma_f32_16x16x32_bf16 v[156:159],a[220:223],v[12:15],v[156:159]
v_mfma_f32_16x16x32_bf16 v[152:155],a[224:227],v[12:15],v[152:155]
v_mfma_f32_16x16x32_bf16 v[156:159],a[228:231],v[12:15],v[156:159]
v_mfma_f32_16x16x32_bf16 v[152:155],a[232:235],v[12:15],v[152:155]
v_mfma_f32_16x16x32_bf16 v[156:159],a[236:239],v[12:15],v[156:159]
v_mfma_f32_16x16x32_bf16 v[152:155],a[240:243],v[12:15],v[152:155]
v_mfma_f32_16x16x32_bf16 v[156:159],a[244:247],v[12:15],v[156:159]
v_mfma_f32_16x16x32_bf16 v[152:155],a[248:251],v[12:15],v[152:155]
v_mfma_f32_16x16x32_bf16 v[156:159],a[252:255],v[12:15],v[156:159]
v_cmp_eq_u32 vcc,0,v1
s_nop 1
v_cndmask_b32 v26,2.0,0,vcc
s_add_u32 s71,s60,1
s_add_u32 s53,s60,2
plp_303:
buffer_load_dword v16,v2,s[20:23],s68 offen sc1
s_waitcnt vmcnt(0)
v_cmp_gt_u32 vcc,s71,v16
s_cbranch_vccz pok_304
s_sleep 4
s_sub_u32 s90,s90,1
s_cmp_gt_i32 s90,0
s_cbranch_scc1 plp_303
pok_304:
lag_300:
s_mov_b32 m0,s70
s_nop 0
buffer_load_dwordx4 v3,s[20:23],s61 offen offset:0 lds
buffer_load_dwordx4 v3,s[20:23],s61 offen offset:1024 lds
buffer_load_dwordx4 v3,s[20:23],s61 offen offset:2048 lds
buffer_load_dwordx4 v3,s[20:23],s61 offen offset:3072 lds
s_add_u32 m0,s70,4096
s_nop 0
buffer_load_dwordx4 v3,s[20:23],s62 offen offset:0 lds
buffer_load_dwordx4 v3,s[20:23],s62 offen offset:1024 lds
buffer_load_dwordx4 v3,s[20:23],s62 offen offset:2048 lds
buffer_load_dwordx4 v3,s[20:23],s62 offen offset:3072 lds
s_add_u32 s61,s61,32768
s_add_u32 s62,s62,32768
s_add_u32 s70,s70,32768
s_and_b32 s70,s70,0x1ffff
buffer_load_dword v23,off,s[20:23],s66
buffer_load_dword v23,off,s[20:23],s66
dec_301:
v_cmp_gt_u32 vcc,s53,v16
s_cbranch_vccnz BN_299
BR_298:
s_waitcnt vmcnt(9)
ds_read_b128 v[64:67],v4 offset:0
s_waitcnt vmcnt(8)
ds_read_b128 v[68:71],v4 offset:1024
s_waitcnt vmcnt(7)
ds_read_b128 v[72:75],v4 offset:2048
s_waitcnt vmcnt(6)
ds_read_b128 v[76:79],v4 offset:3072
s_waitcnt lgkmcnt(3)
v_mfma_f32_16x16x32_bf16 v[32:35],a[0:3],v[64:67],0
s_add_u32 s71,s60,2
s_add_u32 s53,s60,3
s_mov_b32 s57,s63
v_mfma_f32_16x16x32_bf16 v[36:39],a[4:7],v[64:67],0
v_mfma_f32_16x16x32_bf16 v[48:51],v[12:15],v[64:67],0
v_mfma_f32_16x16x32_bf16 v[52:55],v[64:67],v[64:67],0
s_waitcnt lgkmcnt(2)
s_waitcnt vmcnt(5)
s_mov_b32 m0,s70
ds_read_b128 v[80:83],v4 offset:4096
v_mfma_f32_16x16x32_bf16 v[32:35],a[8:11],v[68:71],v[32:35]
buffer_load_dwordx4 v3,s[20:23],s61 offen offset:0 lds
v_mfma_f32_16x16x32_bf16 v[36:39],a[12:15],v[68:71],v[36:39]
v_mfma_f32_16x16x32_bf16 v[48:51],v[12:15],v[68:71],v[48:51]
v_mfma_f32_16x16x32_bf16 v[52:55],v[68:71],v[68:71],v[52:55]
s_waitcnt lgkmcnt(2)
s_waitcnt vmcnt(5)
ds_read_b128 v[84:87],v4 offset:5120
v_mfma_f32_16x16x32_bf16 v[32:35],a[16:19],v[72:75],v[32:35]
buffer_load_dwordx4 v3,s[20:23],s61 offen offset:1024 lds
v_mfma_f32_16x16x32_bf16 v[36:39],a[20:23],v[72:75],v[36:39]
v_mfma_f32_16x16x32_bf16 v[48:51],v[12:15],v[72:75],v[48:51]
v_mfma_f32_16x16x32_bf16 v[52:55],v[72:75],v[72:75],v[52:55]
s_waitcnt lgkmcnt(2)
s_waitcnt vmcnt(5)
ds_read_b128 v[88:91],v4 offset:6144
v_mfma_f32_16x16x32_bf16 v[32:35],a[24:27],v[76:79],v[32:35]
buffer_load_dwordx4 v3,s[20:23],s61 offen offset:2048 lds
v_mfma_f32_16x16x32_bf16 v[36:39],a[28:31],v[76:79],v[36:39]
v_mfma_f32_16x16x32_bf16 v[48:51],v[12:15],v[76:79],v[48:51]
v_mfma_f32_16x16x32_bf16 v[52:55],v[76:79],v[76:79],v[52:55]
s_waitcnt lgkmcnt(2)
s_waitcnt vmcnt(5)
ds_read_b128 v[92:95],v4 offset:7168
v_mfma_f32_16x16x32_bf16 v[32:35],a[32:35],v[80:83],v[32:35]
buffer_load_dwordx4 v3,s[20:23],s61 offen offset:3072 lds
v_mfma_f32_16x16x32_bf16 v[36:39],a[36:39],v[80:83],v[36:39]
v_mfma_f32_16x16x32_bf16 v[48:51],v[12:15],v[80:83],v[48:51]
v_mfma_f32_16x16x32_bf16 v[52:55],v[80:83],v[80:83],v[52:55]
s_waitcnt lgkmcnt(2)
s_barrier
ds_read_b128 v[96:99],v5 offset:0
v_mfma_f32_16x16x32_bf16 v[32:35],a[40:43],v[84:87],v[32:35]
ds_read_b128 v[100:103],v5 offset:1024
v_mfma_f32_16x16x32_bf16 v[36:39],a[44:47],v[84:87],v[36:39]
ds_read_b128 v[104:107],v5 offset:2048
v_mfma_f32_16x16x32_bf16 v[48:51],v[12:15],v[84:87],v[48:51]
s_add_u32 m0,s70,4096
ds_read_b128 v[108:111],v5 offset:3072
v_mfma_f32_16x16x32_bf16 v[52:55],v[84:87],v[84:87],v[52:55]
s_waitcnt lgkmcnt(5)
buffer_load_dwordx4 v3,s[20:23],s62 offen offset:0 lds
v_mfma_f32_16x16x32_bf16 v[32:35],a[48:51],v[88:91],v[32:35]
ds_read_b128 v[112:115],v5 offset:4096
v_mfma_f32_16x16x32_bf16 v[36:39],a[52:55],v[88:91],v[36:39]
buffer_load_dwordx4 v3,s[20:23],s62 offen offset:1024 lds
v_mfma_f32_16x16x32_bf16 v[48:51],v[12:15],v[88:91],v[48:51]
v_mfma_f32_16x16x32_bf16 v[52:55],v[88:91],v[88:91],v[52:55]
s_waitcnt lgkmcnt(5)
v_mfma_f32_16x16x32_bf16 v[32:35],a[56:59],v[92:95],v[32:35]
ds_read_b128 v[116:119],v5 offset:5120
v_mfma_f32_16x16x32_bf16 v[36:39],a[60:63],v[92:95],v[36:39]
buffer_load_dwordx4 v3,s[20:23],s62 offen offset:2048 lds
v_mfma_f32_16x16x32_bf16 v[48:51],v[12:15],v[92:95],v[48:51]
buffer_load_dword v16,v2,s[20:23],s68 offen sc1
v_mfma_f32_16x16x32_bf16 v[52:55],v[92:95],v[92:95],v[52:55]
s_waitcnt lgkmcnt(5)
v_mfma_f32_16x16x32_bf16 v[32:35],a[64:67],v[96:99],v[32:35]
ds_read_b128 v[120:123],v5 offset:6144
v_mfma_f32_16x16x32_bf16 v[36:39],a[68:71],v[96:99],v[36:39]
s_waitcnt lgkmcnt(5)
buffer_load_dwordx4 v3,s[20:23],s62 offen offset:3072 lds
v_mfma_f32_16x16x32_bf16 v[32:35],a[72:75],v[100:103],v[32:35]
ds_read_b128 v[124:127],v5 offset:7168
v_mfma_f32_16x16x32_bf16 v[36:39],a[76:79],v[100:103],v[36:39]
s_waitcnt lgkmcnt(5)
v_mfma_f32_16x16x32_bf16 v[32:35],a[80:83],v[104:107],v[32:35]
ds_read_b128 v[64:67],v6 offset:0
v_cndmask_b32 v49,v52,v53,s[74:75]
v_mfma_f32_16x16x32_bf16 v[36:39],a[84:87],v[104:107],v[36:39]
s_waitcnt lgkmcnt(5)
v_cndmask_b32 v49,v49,v54,s[76:77]
v_cndmask_b32 v49,v49,v55,s[78:79]
v_mfma_f32_16x16x32_bf16 v[32:35],a[88:91],v[108:111],v[32:35]
ds_read_b128 v[68:71],v6 offset:1024
v_mfma_f32_16x16x32_bf16 v[36:39],a[92:95],v[108:111],v[36:39]
s_waitcnt lgkmcnt(5)
ds_write_b64 v19,v[48:49]
v_mfma_f32_16x16x32_bf16 v[32:35],a[96:99],v[112:115],v[32:35]
ds_read_b128 v[72:75],v6 offset:2048
v_mfma_f32_16x16x32_bf16 v[36:39],a[100:103],v[112:115],v[36:39]
s_waitcnt lgkmcnt(6)
v_mfma_f32_16x16x32_bf16 v[32:35],a[104:107],v[116:119],v[32:35]
ds_read_b128 v[76:79],v6 offset:3072
v_mfma_f32_16x16x32_bf16 v[36:39],a[108:111],v[116:119],v[36:39]
s_waitcnt lgkmcnt(6)
v_mfma_f32_16x16x32_bf16 v[32:35],a[112:115],v[120:123],v[32:35]
s_waitcnt lgkmcnt(2)
s_barrier
ds_read_b128 v[80:83],v6 offset:4096
v_mfma_f32_16x16x32_bf16 v[36:39],a[116:119],v[120:123],v[36:39]
ds_read_b64 v[56:57],v20 offset:0
v_mfma_f32_16x16x32_bf16 v[32:35],a[120:123],v[124:127],v[32:35]
ds_read_b128 v[84:87],v6 offset:5120
v_mfma_f32_16x16x32_bf16 v[36:39],a[124:127],v[124:127],v[36:39]
ds_read_b64 v[58:59],v20 offset:512
v_mfma_f32_16x16x32_bf16 v[32:35],a[128:131],v[64:67],v[32:35]
ds_read_b128 v[88:91],v6 offset:6144
v_mfma_f32_16x16x32_bf16 v[36:39],a[132:135],v[64:67],v[36:39]
ds_read_b64 v[60:61],v20 offset:1024
v_mfma_f32_16x16x32_bf16 v[32:35],a[136:139],v[68:71],v[32:35]
ds_read_b128 v[92:95],v6 offset:7168
v_mfma_f32_16x16x32_bf16 v[36:39],a[140:143],v[68:71],v[36:39]
s_waitcnt lgkmcnt(8)
ds_read_b64 v[62:63],v20 offset:1536
v_mfma_f32_16x16x32_bf16 v[32:35],a[144:147],v[72:75],v[32:35]
ds_read_b128 v[96:99],v7 offset:0
v_mfma_f32_16x16x32_bf16 v[36:39],a[148:151],v[72:75],v[36:39]
s_waitcnt lgkmcnt(9)
s_waitcnt vmcnt(10)
v_mov_b32 v17,s57
buffer_store_dword v17,v26,s[20:23],s69 offen sc1
v_mfma_f32_16x16x32_bf16 v[32:35],a[152:155],v[76:79],v[32:35]
ds_read_b128 v[100:103],v7 offset:1024
v_mfma_f32_16x16x32_bf16 v[36:39],a[156:159],v[76:79],v[36:39]
s_waitcnt lgkmcnt(9)
v_mfma_f32_16x16x32_bf16 v[32:35],a[160:163],v[80:83],v[32:35]
ds_read_b128 v[104:107],v7 offset:2048
v_mfma_f32_16x16x32_bf16 v[36:39],a[164:167],v[80:83],v[36:39]
s_waitcnt lgkmcnt(8)
s_waitcnt lgkmcnt(3)
v_add_f32 v56,v56,v58
v_mfma_f32_16x16x32_bf16 v[32:35],a[168:171],v[84:87],v[32:35]
ds_read_b128 v[108:111],v7 offset:3072
v_add_f32 v57,v57,v59
v_mfma_f32_16x16x32_bf16 v[36:39],a[172:175],v[84:87],v[36:39]
v_add_f32 v60,v60,v62
v_add_f32 v61,v61,v63
v_mfma_f32_16x16x32_bf16 v[32:35],a[176:179],v[88:91],v[32:35]
ds_read_b128 v[112:115],v7 offset:4096
v_add_f32 v56,v56,v60
v_mfma_f32_16x16x32_bf16 v[36:39],a[180:183],v[88:91],v[36:39]
v_add_f32 v57,v57,v61
v_mul_f32 v188,0xba800000,v56
v_mfma_f32_16x16x32_bf16 v[32:35],a[184:187],v[92:95],v[32:35]
ds_read_b128 v[116:119],v7 offset:5120
v_fma_f32 v58,v188,v188,-v210
v_mfma_f32_16x16x32_bf16 v[36:39],a[188:191],v[92:95],v[36:39]
s_waitcnt lgkmcnt(5)
v_fma_f32 v57,v57,v211,-v58
v_max_f32 v57,v210,v57
v_mfma_f32_16x16x32_bf16 v[32:35],a[192:195],v[96:99],v[32:35]
ds_read_b128 v[120:123],v7 offset:6144
v_mfma_f32_16x16x32_bf16 v[36:39],a[196:199],v[96:99],v[36:39]
s_waitcnt lgkmcnt(5)
v_rsq_f32 v58,v57
v_mfma_f32_16x16x32_bf16 v[32:35],a[200:203],v[100:103],v[32:35]
ds_read_b128 v[124:127],v7 offset:7168
v_mul_f32 v189,v57,v58
v_mfma_f32_16x16x32_bf16 v[36:39],a[204:207],v[100:103],v[36:39]
s_waitcnt lgkmcnt(5)
v_mul_f32 v190,v209,v58
v_mul_f32 v59,v58,v58
v_mfma_f32_16x16x32_bf16 v[32:35],a[208:211],v[104:107],v[32:35]
s_add_u32 s61,s61,32768
v_mul_f32 v191,v208,v58
v_mul_f32 v191,v191,v59
v_mfma_f32_16x16x32_bf16 v[36:39],a[212:215],v[104:107],v[36:39]
s_waitcnt lgkmcnt(4)
s_add_u32 s62,s62,32768
s_add_u32 s70,s70,32768
v_mfma_f32_16x16x32_bf16 v[32:35],a[216:219],v[108:111],v[32:35]
s_and_b32 s70,s70,0x1ffff
s_add_u32 s55,s55,32768
s_and_b32 s55,s55,0x1ffff
v_mfma_f32_16x16x32_bf16 v[36:39],a[220:223],v[108:111],v[36:39]
s_waitcnt lgkmcnt(3)
v_add_u32 v4,s55,v8
v_add_u32 v5,s55,v9
v_mfma_f32_16x16x32_bf16 v[32:35],a[224:227],v[112:115],v[32:35]
v_add_u32 v6,s55,v10
v_add_u32 v7,s55,v11
v_mfma_f32_16x16x32_bf16 v[36:39],a[228:231],v[112:115],v[36:39]
s_waitcnt lgkmcnt(2)
s_waitcnt vmcnt(9)
ds_read_b128 v[64:67],v4 offset:0
v_mfma_f32_16x16x32_bf16 v[32:35],a[232:235],v[116:119],v[32:35]
s_waitcnt vmcnt(8)
ds_read_b128 v[68:71],v4 offset:1024
v_mfma_f32_16x16x32_bf16 v[36:39],a[236:239],v[116:119],v[36:39]
s_waitcnt lgkmcnt(3)
s_waitcnt vmcnt(7)
ds_read_b128 v[72:75],v4 offset:2048
v_mfma_f32_16x16x32_bf16 v[32:35],a[240:243],v[120:123],v[32:35]
v_mfma_f32_16x16x32_bf16 v[36:39],a[244:247],v[120:123],v[36:39]
s_waitcnt lgkmcnt(3)
v_mfma_f32_16x16x32_bf16 v[40:43],a[248:251],v[124:127],v[32:35]
v_mfma_f32_16x16x32_bf16 v[44:47],a[252:255],v[124:127],v[36:39]
s_waitcnt vmcnt(2)
v_cmp_gt_u32 vcc,s53,v16
s_add_u32 s60,s60,1
s_cbranch_vccnz WN_297
.p2align 6
WR_296:
s_waitcnt lgkmcnt(2)
v_mfma_f32_16x16x32_bf16 v[32:35],a[0:3],v[64:67],0
s_waitcnt vmcnt(6)
s_add_u32 s71,s60,2
ds_read_b128 v[76:79],v4 offset:3072
v_mfma_f32_16x16x32_bf16 v[36:39],a[4:7],v[64:67],0
s_add_u32 s53,s60,3
s_mov_b32 s57,s63
v_mfma_f32_16x16x32_bf16 v[48:51],v[12:15],v[64:67],0
s_mov_b32 m0,s70
v_fma_f32 v40,v152,v188,v40
v_fma_f32 v41,v153,v188,v41
v_mul_f32 v168,v40,v40
v_mfma_f32_16x16x32_bf16 v[52:55],v[64:67],v[64:67],0
s_waitcnt lgkmcnt(2)
buffer_load_dwordx4 v3,s[20:23],s61 offen offset:0 lds
v_mul_f32 v169,v41,v41
v_fma_f32 v168,v168,v191,v190
v_mfma_f32_16x16x32_bf16 v[32:35],a[8:11],v[68:71],v[32:35]
s_waitcnt vmcnt(6)
ds_read_b128 v[80:83],v4 offset:4096
v_fma_f32 v169,v169,v191,v190
v_mul_f32 v168,v168,v40
v_mfma_f32_16x16x32_bf16 v[36:39],a[12:15],v[68:71],v[36:39]
v_exp_f32 v168,v168
v_mul_f32 v169,v169,v41
v_mfma_f32_16x16x32_bf16 v[48:51],v[12:15],v[68:71],v[48:51]
v_exp_f32 v169,v169
v_fma_f32 v168,v168,v189,v189
v_mfma_f32_16x16x32_bf16 v[52:55],v[68:71],v[68:71],v[52:55]
s_waitcnt lgkmcnt(2)
buffer_load_dwordx4 v3,s[20:23],s61 offen offset:1024 lds
v_rcp_f32 v168,v168
v_mfma_f32_16x16x32_bf16 v[32:35],a[16:19],v[72:75],v[32:35]
s_waitcnt vmcnt(6)
ds_read_b128 v[84:87],v4 offset:5120
v_fma_f32 v169,v169,v189,v189
v_mul_f32 v40,v168,v40
v_mfma_f32_16x16x32_bf16 v[36:39],a[20:23],v[72:75],v[36:39]
v_rcp_f32 v169,v169
v_fma_f32 v42,v154,v188,v42
v_mfma_f32_16x16x32_bf16 v[48:51],v[12:15],v[72:75],v[48:51]
v_mul_f32 v41,v169,v41
v_fma_f32 v43,v155,v188,v43
v_mul_f32 v170,v42,v42
v_mfma_f32_16x16x32_bf16 v[52:55],v[72:75],v[72:75],v[52:55]
s_waitcnt lgkmcnt(2)
buffer_load_dwordx4 v3,s[20:23],s61 offen offset:2048 lds
v_mul_f32 v171,v43,v43
v_fma_f32 v170,v170,v191,v190
v_mfma_f32_16x16x32_bf16 v[32:35],a[24:27],v[76:79],v[32:35]
s_waitcnt vmcnt(6)
ds_read_b128 v[88:91],v4 offset:6144
v_fma_f32 v171,v171,v191,v190
v_mfma_f32_16x16x32_bf16 v[36:39],a[28:31],v[76:79],v[36:39]
v_mul_f32 v170,v170,v42
v_mul_f32 v171,v171,v43
v_mfma_f32_16x16x32_bf16 v[48:51],v[12:15],v[76:79],v[48:51]
v_exp_f32 v170,v170
v_mfma_f32_16x16x32_bf16 v[52:55],v[76:79],v[76:79],v[52:55]
s_waitcnt lgkmcnt(2)
buffer_load_dwordx4 v3,s[20:23],s61 offen offset:3072 lds
v_fma_f32 v170,v170,v189,v189
v_mfma_f32_16x16x32_bf16 v[32:35],a[32:35],v[80:83],v[32:35]
s_waitcnt vmcnt(5)
ds_read_b128 v[92:95],v4 offset:7168
v_fma_f32 v44,v156,v188,v44
v_mfma_f32_16x16x32_bf16 v[36:39],a[36:39],v[80:83],v[36:39]
s_barrier
ds_read_b128 v[96:99],v5 offset:0
v_fma_f32 v45,v157,v188,v45
v_mfma_f32_16x16x32_bf16 v[48:51],v[12:15],v[80:83],v[48:51]
ds_read_b128 v[100:103],v5 offset:1024
v_mul_f32 v172,v44,v44
v_mfma_f32_16x16x32_bf16 v[52:55],v[80:83],v[80:83],v[52:55]
s_waitcnt lgkmcnt(4)
ds_read_b128 v[104:107],v5 offset:2048
v_mul_f32 v173,v45,v45
v_mfma_f32_16x16x32_bf16 v[32:35],a[40:43],v[84:87],v[32:35]
s_add_u32 m0,s70,4096
ds_read_b128 v[108:111],v5 offset:3072
v_fma_f32 v172,v172,v191,v190
v_mfma_f32_16x16x32_bf16 v[36:39],a[44:47],v[84:87],v[36:39]
buffer_load_dwordx4 v3,s[20:23],s62 offen offset:0 lds
v_fma_f32 v173,v173,v191,v190
v_mfma_f32_16x16x32_bf16 v[48:51],v[12:15],v[84:87],v[48:51]
s_waitcnt vmcnt(5)
v_mov_b32 v17,s57
buffer_store_dword v17,v26,s[20:23],s69 offen sc1
v_mfma_f32_16x16x32_bf16 v[52:55],v[84:87],v[84:87],v[52:55]
s_waitcnt lgkmcnt(5)
v_exp_f32 v171,v171
v_mfma_f32_16x16x32_bf16 v[32:35],a[48:51],v[88:91],v[32:35]
ds_read_b128 v[112:115],v5 offset:4096
v_fma_f32 v171,v171,v189,v189
v_mfma_f32_16x16x32_bf16 v[36:39],a[52:55],v[88:91],v[36:39]
buffer_load_dwordx4 v3,s[20:23],s62 offen offset:1024 lds
v_mul_f32 v172,v172,v44
v_mfma_f32_16x16x32_bf16 v[48:51],v[12:15],v[88:91],v[48:51]
v_rcp_f32 v170,v170
v_mfma_f32_16x16x32_bf16 v[52:55],v[88:91],v[88:91],v[52:55]
s_waitcnt lgkmcnt(5)
v_rcp_f32 v171,v171
v_mfma_f32_16x16x32_bf16 v[32:35],a[56:59],v[92:95],v[32:35]
ds_read_b128 v[116:119],v5 offset:5120
v_mul_f32 v42,v170,v42
v_mfma_f32_16x16x32_bf16 v[36:39],a[60:63],v[92:95],v[36:39]
buffer_load_dwordx4 v3,s[20:23],s62 offen offset:2048 lds
v_mul_f32 v43,v171,v43
v_mfma_f32_16x16x32_bf16 v[48:51],v[12:15],v[92:95],v[48:51]
buffer_load_dword v16,v2,s[20:23],s68 offen sc1
v_mul_f32 v173,v173,v45
v_mfma_f32_16x16x32_bf16 v[52:55],v[92:95],v[92:95],v[52:55]
s_waitcnt lgkmcnt(5)
v_exp_f32 v172,v172
v_mfma_f32_16x16x32_bf16 v[32:35],a[64:67],v[96:99],v[32:35]
ds_read_b128 v[120:123],v5 offset:6144
v_fma_f32 v172,v172,v189,v189
v_mfma_f32_16x16x32_bf16 v[36:39],a[68:71],v[96:99],v[36:39]
s_waitcnt lgkmcnt(5)
buffer_load_dwordx4 v3,s[20:23],s62 offen offset:3072 lds
v_fma_f32 v46,v158,v188,v46
v_mfma_f32_16x16x32_bf16 v[32:35],a[72:75],v[100:103],v[32:35]
ds_read_b128 v[124:127],v5 offset:7168
v_fma_f32 v47,v159,v188,v47
v_mfma_f32_16x16x32_bf16 v[36:39],a[76:79],v[100:103],v[36:39]
s_waitcnt lgkmcnt(5)
v_exp_f32 v173,v173
v_mfma_f32_16x16x32_bf16 v[32:35],a[80:83],v[104:107],v[32:35]
ds_read_b128 v[64:67],v6 offset:0
v_cndmask_b32 v49,v52,v53,s[74:75]
v_mfma_f32_16x16x32_bf16 v[36:39],a[84:87],v[104:107],v[36:39]
s_waitcnt lgkmcnt(5)
v_cndmask_b32 v49,v49,v54,s[76:77]
v_cndmask_b32 v49,v49,v55,s[78:79]
v_mfma_f32_16x16x32_bf16 v[32:35],a[88:91],v[108:111],v[32:35]
ds_read_b128 v[68:71],v6 offset:1024
v_fma_f32 v173,v173,v189,v189
v_mfma_f32_16x16x32_bf16 v[36:39],a[92:95],v[108:111],v[36:39]
s_waitcnt lgkmcnt(5)
ds_write_b64 v19,v[48:49]
v_mfma_f32_16x16x32_bf16 v[32:35],a[96:99],v[112:115],v[32:35]
ds_read_b128 v[72:75],v6 offset:2048
v_mul_f32 v174,v46,v46
v_mfma_f32_16x16x32_bf16 v[36:39],a[100:103],v[112:115],v[36:39]
s_waitcnt lgkmcnt(6)
v_rcp_f32 v172,v172
v_mfma_f32_16x16x32_bf16 v[32:35],a[104:107],v[116:119],v[32:35]
ds_read_b128 v[76:79],v6 offset:3072
v_mul_f32 v44,v172,v44
v_mfma_f32_16x16x32_bf16 v[36:39],a[108:111],v[116:119],v[36:39]
s_waitcnt lgkmcnt(6)
v_rcp_f32 v173,v173
v_mfma_f32_16x16x32_bf16 v[32:35],a[112:115],v[120:123],v[32:35]
s_waitcnt lgkmcnt(2)
s_barrier
ds_read_b128 v[80:83],v6 offset:4096
v_mfma_f32_16x16x32_bf16 v[36:39],a[116:119],v[120:123],v[36:39]
ds_read_b64 v[56:57],v20 offset:0
v_mul_f32 v45,v173,v45
v_mfma_f32_16x16x32_bf16 v[32:35],a[120:123],v[124:127],v[32:35]
ds_read_b128 v[84:87],v6 offset:5120
v_mul_f32 v175,v47,v47
v_mfma_f32_16x16x32_bf16 v[36:39],a[124:127],v[124:127],v[36:39]
ds_read_b64 v[58:59],v20 offset:512
v_fma_f32 v174,v174,v191,v190
v_mfma_f32_16x16x32_bf16 v[32:35],a[128:131],v[64:67],v[32:35]
ds_read_b128 v[88:91],v6 offset:6144
v_fma_f32 v175,v175,v191,v190
v_mfma_f32_16x16x32_bf16 v[36:39],a[132:135],v[64:67],v[36:39]
ds_read_b64 v[60:61],v20 offset:1024
v_mul_f32 v174,v174,v46
v_mfma_f32_16x16x32_bf16 v[32:35],a[136:139],v[68:71],v[32:35]
ds_read_b128 v[92:95],v6 offset:7168
v_mul_f32 v175,v175,v47
v_mfma_f32_16x16x32_bf16 v[36:39],a[140:143],v[68:71],v[36:39]
s_waitcnt lgkmcnt(8)
ds_read_b64 v[62:63],v20 offset:1536
v_cvt_pk_bf16_f32 v176,v40,v41
v_mfma_f32_16x16x32_bf16 v[32:35],a[144:147],v[72:75],v[32:35]
ds_read_b128 v[96:99],v7 offset:0
v_cvt_pk_bf16_f32 v177,v42,v43
v_mfma_f32_16x16x32_bf16 v[36:39],a[148:151],v[72:75],v[36:39]
s_waitcnt lgkmcnt(9)
v_exp_f32 v174,v174
v_mfma_f32_16x16x32_bf16 v[32:35],a[152:155],v[76:79],v[32:35]
ds_read_b128 v[100:103],v7 offset:1024
v_fma_f32 v174,v174,v189,v189
v_mfma_f32_16x16x32_bf16 v[36:39],a[156:159],v[76:79],v[36:39]
s_waitcnt lgkmcnt(9)
v_exp_f32 v175,v175
v_mfma_f32_16x16x32_bf16 v[32:35],a[160:163],v[80:83],v[32:35]
ds_read_b128 v[104:107],v7 offset:2048
v_fma_f32 v175,v175,v189,v189
v_mfma_f32_16x16x32_bf16 v[36:39],a[164:167],v[80:83],v[36:39]
s_waitcnt lgkmcnt(8)
s_waitcnt lgkmcnt(3)
v_rcp_f32 v174,v174
v_mfma_f32_16x16x32_bf16 v[32:35],a[168:171],v[84:87],v[32:35]
ds_read_b128 v[108:111],v7 offset:3072
v_mul_f32 v46,v174,v46
v_mfma_f32_16x16x32_bf16 v[36:39],a[172:175],v[84:87],v[36:39]
v_rcp_f32 v175,v175
v_mfma_f32_16x16x32_bf16 v[32:35],a[176:179],v[88:91],v[32:35]
ds_read_b128 v[112:115],v7 offset:4096
v_mul_f32 v47,v175,v47
v_mfma_f32_16x16x32_bf16 v[36:39],a[180:183],v[88:91],v[36:39]
v_cvt_pk_bf16_f32 v178,v44,v45
v_cvt_pk_bf16_f32 v179,v46,v47
v_mfma_f32_16x16x32_bf16 v[32:35],a[184:187],v[92:95],v[32:35]
ds_read_b128 v[116:119],v7 offset:5120
v_add_f32 v56,v56,v58
v_mfma_f32_16x16x32_bf16 v[36:39],a[188:191],v[92:95],v[36:39]
s_waitcnt lgkmcnt(5)
buffer_store_dwordx4 v[176:179],v0,s[20:23],s66 offen sc1
v_mfma_f32_16x16x32_bf16 v[32:35],a[192:195],v[96:99],v[32:35]
s_add_u32 s66,s66,114688
s_add_u32 s63,s63,1
ds_read_b128 v[120:123],v7 offset:6144
v_mfma_f32_16x16x32_bf16 v[36:39],a[196:199],v[96:99],v[36:39]
s_waitcnt lgkmcnt(5)
v_add_f32 v57,v57,v59
v_add_f32 v60,v60,v62
v_mfma_f32_16x16x32_bf16 v[32:35],a[200:203],v[100:103],v[32:35]
ds_read_b128 v[124:127],v7 offset:7168
v_add_f32 v61,v61,v63
v_mfma_f32_16x16x32_bf16 v[36:39],a[204:207],v[100:103],v[36:39]
s_waitcnt lgkmcnt(5)
v_add_f32 v56,v56,v60
v_add_f32 v57,v57,v61
v_mfma_f32_16x16x32_bf16 v[32:35],a[208:211],v[104:107],v[32:35]
s_add_u32 s61,s61,32768
v_mul_f32 v188,0xba800000,v56
v_fma_f32 v58,v188,v188,-v210
v_mfma_f32_16x16x32_bf16 v[36:39],a[212:215],v[104:107],v[36:39]
s_waitcnt lgkmcnt(4)
v_fma_f32 v57,v57,v211,-v58
v_max_f32 v57,v210,v57
v_mfma_f32_16x16x32_bf16 v[32:35],a[216:219],v[108:111],v[32:35]
s_add_u32 s62,s62,32768
v_rsq_f32 v58,v57
v_mfma_f32_16x16x32_bf16 v[36:39],a[220:223],v[108:111],v[36:39]
s_waitcnt lgkmcnt(3)
v_mul_f32 v189,v57,v58
v_mul_f32 v190,v209,v58
v_mfma_f32_16x16x32_bf16 v[32:35],a[224:227],v[112:115],v[32:35]
s_add_u32 s70,s70,32768
v_mul_f32 v59,v58,v58
v_mul_f32 v191,v208,v58
v_mfma_f32_16x16x32_bf16 v[36:39],a[228:231],v[112:115],v[36:39]
s_waitcnt lgkmcnt(2)
s_and_b32 s70,s70,0x1ffff
v_mul_f32 v191,v191,v59
v_mfma_f32_16x16x32_bf16 v[32:35],a[232:235],v[116:119],v[32:35]
s_add_u32 s55,s55,32768
s_and_b32 s55,s55,0x1ffff
v_add_u32 v4,s55,v8
v_mfma_f32_16x16x32_bf16 v[36:39],a[236:239],v[116:119],v[36:39]
s_waitcnt lgkmcnt(1)
v_add_u32 v5,s55,v9
v_add_u32 v6,s55,v10
v_mfma_f32_16x16x32_bf16 v[32:35],a[240:243],v[120:123],v[32:35]
v_add_u32 v7,s55,v11
v_mfma_f32_16x16x32_bf16 v[36:39],a[244:247],v[120:123],v[36:39]
s_waitcnt lgkmcnt(0)
s_waitcnt vmcnt(10)
ds_read_b128 v[64:67],v4 offset:0
v_mfma_f32_16x16x32_bf16 v[40:43],a[248:251],v[124:127],v[32:35]
s_waitcnt vmcnt(9)
ds_read_b128 v[68:71],v4 offset:1024
v_mfma_f32_16x16x32_bf16 v[44:47],a[252:255],v[124:127],v[36:39]
s_waitcnt vmcnt(2)
v_cmp_gt_u32 vcc,s53,v16
ds_read_b128 v[72:75],v4 offset:2048
s_add_u32 s60,s60,1
s_cbranch_vccz WR_296
WN_297:
s_waitcnt lgkmcnt(2)
v_mfma_f32_16x16x32_bf16 v[32:35],a[0:3],v[64:67],0
s_waitcnt vmcnt(6)
s_add_u32 s71,s60,2
ds_read_b128 v[76:79],v4 offset:3072
v_mfma_f32_16x16x32_bf16 v[36:39],a[4:7],v[64:67],0
s_add_u32 s53,s60,3
s_mov_b32 s57,s63
v_mfma_f32_16x16x32_bf16 v[48:51],v[12:15],v[64:67],0
v_fma_f32 v40,v152,v188,v40
v_fma_f32 v41,v153,v188,v41
v_mul_f32 v168,v40,v40
v_mfma_f32_16x16x32_bf16 v[52:55],v[64:67],v[64:67],0
s_waitcnt lgkmcnt(2)
v_mul_f32 v169,v41,v41
v_fma_f32 v168,v168,v191,v190
v_fma_f32 v169,v169,v191,v190
v_mfma_f32_16x16x32_bf16 v[32:35],a[8:11],v[68:71],v[32:35]
s_waitcnt vmcnt(5)
ds_read_b128 v[80:83],v4 offset:4096
v_mul_f32 v168,v168,v40
v_mul_f32 v169,v169,v41
v_mfma_f32_16x16x32_bf16 v[36:39],a[12:15],v[68:71],v[36:39]
v_exp_f32 v168,v168
v_fma_f32 v42,v154,v188,v42
v_mfma_f32_16x16x32_bf16 v[48:51],v[12:15],v[68:71],v[48:51]
v_exp_f32 v169,v169
v_fma_f32 v168,v168,v189,v189
v_mfma_f32_16x16x32_bf16 v[52:55],v[68:71],v[68:71],v[52:55]
s_waitcnt lgkmcnt(2)
v_rcp_f32 v168,v168
v_fma_f32 v169,v169,v189,v189
v_mfma_f32_16x16x32_bf16 v[32:35],a[16:19],v[72:75],v[32:35]
s_waitcnt vmcnt(4)
ds_read_b128 v[84:87],v4 offset:5120
v_rcp_f32 v169,v169
v_mfma_f32_16x16x32_bf16 v[36:39],a[20:23],v[72:75],v[36:39]
v_mul_f32 v40,v168,v40
v_mul_f32 v41,v169,v41
v_fma_f32 v43,v155,v188,v43
v_mfma_f32_16x16x32_bf16 v[48:51],v[12:15],v[72:75],v[48:51]
v_mul_f32 v170,v42,v42
v_mul_f32 v171,v43,v43
v_mfma_f32_16x16x32_bf16 v[52:55],v[72:75],v[72:75],v[52:55]
s_waitcnt lgkmcnt(2)
v_fma_f32 v170,v170,v191,v190
v_fma_f32 v171,v171,v191,v190
v_mfma_f32_16x16x32_bf16 v[32:35],a[24:27],v[76:79],v[32:35]
s_waitcnt vmcnt(3)
ds_read_b128 v[88:91],v4 offset:6144
v_mul_f32 v170,v170,v42
v_mfma_f32_16x16x32_bf16 v[36:39],a[28:31],v[76:79],v[36:39]
v_exp_f32 v170,v170
v_mfma_f32_16x16x32_bf16 v[48:51],v[12:15],v[76:79],v[48:51]
v_mul_f32 v171,v171,v43
v_fma_f32 v170,v170,v189,v189
v_mfma_f32_16x16x32_bf16 v[52:55],v[76:79],v[76:79],v[52:55]
s_waitcnt lgkmcnt(2)
v_exp_f32 v171,v171
v_mfma_f32_16x16x32_bf16 v[32:35],a[32:35],v[80:83],v[32:35]
s_waitcnt vmcnt(1)
ds_read_b128 v[92:95],v4 offset:7168
v_fma_f32 v171,v171,v189,v189
v_mfma_f32_16x16x32_bf16 v[36:39],a[36:39],v[80:83],v[36:39]
s_barrier
ds_read_b128 v[96:99],v5 offset:0
v_fma_f32 v44,v156,v188,v44
v_mfma_f32_16x16x32_bf16 v[48:51],v[12:15],v[80:83],v[48:51]
ds_read_b128 v[100:103],v5 offset:1024
v_fma_f32 v45,v157,v188,v45
v_mfma_f32_16x16x32_bf16 v[52:55],v[80:83],v[80:83],v[52:55]
s_waitcnt lgkmcnt(4)
ds_read_b128 v[104:107],v5 offset:2048
v_mul_f32 v172,v44,v44
v_mfma_f32_16x16x32_bf16 v[32:35],a[40:43],v[84:87],v[32:35]
ds_read_b128 v[108:111],v5 offset:3072
v_mul_f32 v173,v45,v45
v_mfma_f32_16x16x32_bf16 v[36:39],a[44:47],v[84:87],v[36:39]
s_waitcnt vmcnt(0)
v_mov_b32 v17,s57
buffer_store_dword v17,v26,s[20:23],s69 offen sc1
v_mfma_f32_16x16x32_bf16 v[48:51],v[12:15],v[84:87],v[48:51]
v_rcp_f32 v170,v170
v_mfma_f32_16x16x32_bf16 v[52:55],v[84:87],v[84:87],v[52:55]
s_waitcnt lgkmcnt(5)
v_rcp_f32 v171,v171
v_mfma_f32_16x16x32_bf16 v[32:35],a[48:51],v[88:91],v[32:35]
ds_read_b128 v[112:115],v5 offset:4096
v_mul_f32 v42,v170,v42
v_mfma_f32_16x16x32_bf16 v[36:39],a[52:55],v[88:91],v[36:39]
v_mul_f32 v43,v171,v43
v_fma_f32 v172,v172,v191,v190
v_mfma_f32_16x16x32_bf16 v[48:51],v[12:15],v[88:91],v[48:51]
v_fma_f32 v173,v173,v191,v190
v_mul_f32 v172,v172,v44
v_mfma_f32_16x16x32_bf16 v[52:55],v[88:91],v[88:91],v[52:55]
s_waitcnt lgkmcnt(5)
v_exp_f32 v172,v172
v_mfma_f32_16x16x32_bf16 v[32:35],a[56:59],v[92:95],v[32:35]
ds_read_b128 v[116:119],v5 offset:5120
v_mul_f32 v173,v173,v45
v_mfma_f32_16x16x32_bf16 v[36:39],a[60:63],v[92:95],v[36:39]
v_exp_f32 v173,v173
v_mfma_f32_16x16x32_bf16 v[48:51],v[12:15],v[92:95],v[48:51]
v_fma_f32 v172,v172,v189,v189
v_fma_f32 v173,v173,v189,v189
v_mfma_f32_16x16x32_bf16 v[52:55],v[92:95],v[92:95],v[52:55]
s_waitcnt lgkmcnt(5)
v_rcp_f32 v172,v172
v_mfma_f32_16x16x32_bf16 v[32:35],a[64:67],v[96:99],v[32:35]
ds_read_b128 v[120:123],v5 offset:6144
v_mul_f32 v44,v172,v44
v_mfma_f32_16x16x32_bf16 v[36:39],a[68:71],v[96:99],v[36:39]
s_waitcnt lgkmcnt(5)
v_rcp_f32 v173,v173
v_mfma_f32_16x16x32_bf16 v[32:35],a[72:75],v[100:103],v[32:35]
ds_read_b128 v[124:127],v5 offset:7168
v_mul_f32 v45,v173,v45
v_mfma_f32_16x16x32_bf16 v[36:39],a[76:79],v[100:103],v[36:39]
s_waitcnt lgkmcnt(5)
v_fma_f32 v46,v158,v188,v46
v_fma_f32 v47,v159,v188,v47
v_mfma_f32_16x16x32_bf16 v[32:35],a[80:83],v[104:107],v[32:35]
ds_read_b128 v[64:67],v6 offset:0
v_cndmask_b32 v49,v52,v53,s[74:75]
v_mfma_f32_16x16x32_bf16 v[36:39],a[84:87],v[104:107],v[36:39]
s_waitcnt lgkmcnt(5)
v_cndmask_b32 v49,v49,v54,s[76:77]
v_cndmask_b32 v49,v49,v55,s[78:79]
v_mfma_f32_16x16x32_bf16 v[32:35],a[88:91],v[108:111],v[32:35]
ds_read_b128 v[68:71],v6 offset:1024
v_mul_f32 v174,v46,v46
v_mfma_f32_16x16x32_bf16 v[36:39],a[92:95],v[108:111],v[36:39]
s_waitcnt lgkmcnt(5)
ds_write_b64 v19,v[48:49]
v_mfma_f32_16x16x32_bf16 v[32:35],a[96:99],v[112:115],v[32:35]
ds_read_b128 v[72:75],v6 offset:2048
v_mul_f32 v175,v47,v47
v_mfma_f32_16x16x32_bf16 v[36:39],a[100:103],v[112:115],v[36:39]
s_waitcnt lgkmcnt(6)
v_fma_f32 v174,v174,v191,v190
v_fma_f32 v175,v175,v191,v190
v_mfma_f32_16x16x32_bf16 v[32:35],a[104:107],v[116:119],v[32:35]
ds_read_b128 v[76:79],v6 offset:3072
v_mul_f32 v174,v174,v46
v_mfma_f32_16x16x32_bf16 v[36:39],a[108:111],v[116:119],v[36:39]
s_waitcnt lgkmcnt(6)
v_exp_f32 v174,v174
v_mfma_f32_16x16x32_bf16 v[32:35],a[112:115],v[120:123],v[32:35]
s_waitcnt lgkmcnt(2)
s_barrier
ds_read_b128 v[80:83],v6 offset:4096
v_mfma_f32_16x16x32_bf16 v[36:39],a[116:119],v[120:123],v[36:39]
ds_read_b64 v[56:57],v20 offset:0
v_mul_f32 v175,v175,v47
v_mfma_f32_16x16x32_bf16 v[32:35],a[120:123],v[124:127],v[32:35]
ds_read_b128 v[84:87],v6 offset:5120
v_fma_f32 v174,v174,v189,v189
v_mfma_f32_16x16x32_bf16 v[36:39],a[124:127],v[124:127],v[36:39]
ds_read_b64 v[58:59],v20 offset:512
v_cvt_pk_bf16_f32 v176,v40,v41
v_mfma_f32_16x16x32_bf16 v[32:35],a[128:131],v[64:67],v[32:35]
ds_read_b128 v[88:91],v6 offset:6144
v_cvt_pk_bf16_f32 v177,v42,v43
v_mfma_f32_16x16x32_bf16 v[36:39],a[132:135],v[64:67],v[36:39]
ds_read_b64 v[60:61],v20 offset:1024
v_cvt_pk_bf16_f32 v178,v44,v45
v_mfma_f32_16x16x32_bf16 v[32:35],a[136:139],v[68:71],v[32:35]
ds_read_b128 v[92:95],v6 offset:7168
v_mfma_f32_16x16x32_bf16 v[36:39],a[140:143],v[68:71],v[36:39]
s_waitcnt lgkmcnt(8)
ds_read_b64 v[62:63],v20 offset:1536
v_mfma_f32_16x16x32_bf16 v[32:35],a[144:147],v[72:75],v[32:35]
ds_read_b128 v[96:99],v7 offset:0
v_mfma_f32_16x16x32_bf16 v[36:39],a[148:151],v[72:75],v[36:39]
s_waitcnt lgkmcnt(9)
buffer_load_dword v16,v2,s[20:23],s68 offen sc1
v_mfma_f32_16x16x32_bf16 v[32:35],a[152:155],v[76:79],v[32:35]
ds_read_b128 v[100:103],v7 offset:1024
v_mfma_f32_16x16x32_bf16 v[36:39],a[156:159],v[76:79],v[36:39]
s_waitcnt lgkmcnt(9)
v_exp_f32 v175,v175
v_mfma_f32_16x16x32_bf16 v[32:35],a[160:163],v[80:83],v[32:35]
ds_read_b128 v[104:107],v7 offset:2048
v_fma_f32 v175,v175,v189,v189
v_mfma_f32_16x16x32_bf16 v[36:39],a[164:167],v[80:83],v[36:39]
s_waitcnt lgkmcnt(8)
s_waitcnt lgkmcnt(3)
v_rcp_f32 v174,v174
v_mfma_f32_16x16x32_bf16 v[32:35],a[168:171],v[84:87],v[32:35]
ds_read_b128 v[108:111],v7 offset:3072
v_mul_f32 v46,v174,v46
v_mfma_f32_16x16x32_bf16 v[36:39],a[172:175],v[84:87],v[36:39]
v_rcp_f32 v175,v175
v_mfma_f32_16x16x32_bf16 v[32:35],a[176:179],v[88:91],v[32:35]
ds_read_b128 v[112:115],v7 offset:4096
v_mul_f32 v47,v175,v47
v_mfma_f32_16x16x32_bf16 v[36:39],a[180:183],v[88:91],v[36:39]
v_cvt_pk_bf16_f32 v179,v46,v47
v_add_f32 v56,v56,v58
v_mfma_f32_16x16x32_bf16 v[32:35],a[184:187],v[92:95],v[32:35]
ds_read_b128 v[116:119],v7 offset:5120
v_add_f32 v57,v57,v59
v_mfma_f32_16x16x32_bf16 v[36:39],a[188:191],v[92:95],v[36:39]
s_waitcnt lgkmcnt(5)
buffer_store_dwordx4 v[176:179],v0,s[20:23],s66 offen sc1
v_mfma_f32_16x16x32_bf16 v[32:35],a[192:195],v[96:99],v[32:35]
s_add_u32 s66,s66,114688
s_add_u32 s63,s63,1
ds_read_b128 v[120:123],v7 offset:6144
v_mfma_f32_16x16x32_bf16 v[36:39],a[196:199],v[96:99],v[36:39]
s_waitcnt lgkmcnt(5)
v_add_f32 v60,v60,v62
v_add_f32 v61,v61,v63
v_mfma_f32_16x16x32_bf16 v[32:35],a[200:203],v[100:103],v[32:35]
ds_read_b128 v[124:127],v7 offset:7168
v_add_f32 v56,v56,v60
v_mfma_f32_16x16x32_bf16 v[36:39],a[204:207],v[100:103],v[36:39]
s_waitcnt lgkmcnt(5)
v_add_f32 v57,v57,v61
v_mul_f32 v188,0xba800000,v56
v_mfma_f32_16x16x32_bf16 v[32:35],a[208:211],v[104:107],v[32:35]
s_add_u32 s55,s55,32768
v_fma_f32 v58,v188,v188,-v210
v_fma_f32 v57,v57,v211,-v58
v_mfma_f32_16x16x32_bf16 v[36:39],a[212:215],v[104:107],v[36:39]
s_waitcnt lgkmcnt(4)
s_and_b32 s55,s55,0x1ffff
v_max_f32 v57,v210,v57
v_mfma_f32_16x16x32_bf16 v[32:35],a[216:219],v[108:111],v[32:35]
v_rsq_f32 v58,v57
v_mfma_f32_16x16x32_bf16 v[36:39],a[220:223],v[108:111],v[36:39]
s_waitcnt lgkmcnt(3)
v_mul_f32 v189,v57,v58
v_mul_f32 v190,v209,v58
v_mfma_f32_16x16x32_bf16 v[32:35],a[224:227],v[112:115],v[32:35]
v_mul_f32 v59,v58,v58
v_mul_f32 v191,v208,v58
v_mfma_f32_16x16x32_bf16 v[36:39],a[228:231],v[112:115],v[36:39]
s_waitcnt lgkmcnt(2)
v_mul_f32 v191,v191,v59
v_add_u32 v4,s55,v8
v_mfma_f32_16x16x32_bf16 v[32:35],a[232:235],v[116:119],v[32:35]
v_add_u32 v5,s55,v9
v_add_u32 v6,s55,v10
v_mfma_f32_16x16x32_bf16 v[36:39],a[236:239],v[116:119],v[36:39]
s_waitcnt lgkmcnt(1)
v_add_u32 v7,s55,v11
v_mfma_f32_16x16x32_bf16 v[32:35],a[240:243],v[120:123],v[32:35]
v_mfma_f32_16x16x32_bf16 v[36:39],a[244:247],v[120:123],v[36:39]
s_waitcnt lgkmcnt(0)
v_mfma_f32_16x16x32_bf16 v[40:43],a[248:251],v[124:127],v[32:35]
v_mfma_f32_16x16x32_bf16 v[44:47],a[252:255],v[124:127],v[36:39]
s_waitcnt vmcnt(1)
v_cmp_gt_u32 vcc,s71,v16
s_add_u32 s60,s60,1
s_branch endN_305
BN_299:
s_waitcnt vmcnt(9)
ds_read_b128 v[64:67],v4 offset:0
s_waitcnt vmcnt(8)
ds_read_b128 v[68:71],v4 offset:1024
s_waitcnt vmcnt(7)
ds_read_b128 v[72:75],v4 offset:2048
s_waitcnt vmcnt(6)
ds_read_b128 v[76:79],v4 offset:3072
s_waitcnt lgkmcnt(3)
v_mfma_f32_16x16x32_bf16 v[32:35],a[0:3],v[64:67],0
s_add_u32 s71,s60,2
s_add_u32 s53,s60,3
s_mov_b32 s57,s63
v_mfma_f32_16x16x32_bf16 v[36:39],a[4:7],v[64:67],0
v_mfma_f32_16x16x32_bf16 v[48:51],v[12:15],v[64:67],0
v_mfma_f32_16x16x32_bf16 v[52:55],v[64:67],v[64:67],0
s_waitcnt lgkmcnt(2)
s_waitcnt vmcnt(5)
ds_read_b128 v[80:83],v4 offset:4096
v_mfma_f32_16x16x32_bf16 v[32:35],a[8:11],v[68:71],v[32:35]
v_mfma_f32_16x16x32_bf16 v[36:39],a[12:15],v[68:71],v[36:39]
v_mfma_f32_16x16x32_bf16 v[48:51],v[12:15],v[68:71],v[48:51]
v_mfma_f32_16x16x32_bf16 v[52:55],v[68:71],v[68:71],v[52:55]
s_waitcnt lgkmcnt(2)
s_waitcnt vmcnt(4)
ds_read_b128 v[84:87],v4 offset:5120
v_mfma_f32_16x16x32_bf16 v[32:35],a[16:19],v[72:75],v[32:35]
v_mfma_f32_16x16x32_bf16 v[36:39],a[20:23],v[72:75],v[36:39]
v_mfma_f32_16x16x32_bf16 v[48:51],v[12:15],v[72:75],v[48:51]
v_mfma_f32_16x16x32_bf16 v[52:55],v[72:75],v[72:75],v[52:55]
s_waitcnt lgkmcnt(2)
s_waitcnt vmcnt(3)
ds_read_b128 v[88:91],v4 offset:6144
v_mfma_f32_16x16x32_bf16 v[32:35],a[24:27],v[76:79],v[32:35]
v_mfma_f32_16x16x32_bf16 v[36:39],a[28:31],v[76:79],v[36:39]
v_mfma_f32_16x16x32_bf16 v[48:51],v[12:15],v[76:79],v[48:51]
v_mfma_f32_16x16x32_bf16 v[52:55],v[76:79],v[76:79],v[52:55]
s_waitcnt lgkmcnt(2)
s_waitcnt vmcnt(2)
ds_read_b128 v[92:95],v4 offset:7168
v_mfma_f32_16x16x32_bf16 v[32:35],a[32:35],v[80:83],v[32:35]
v_mfma_f32_16x16x32_bf16 v[36:39],a[36:39],v[80:83],v[36:39]
v_mfma_f32_16x16x32_bf16 v[48:51],v[12:15],v[80:83],v[48:51]
v_mfma_f32_16x16x32_bf16 v[52:55],v[80:83],v[80:83],v[52:55]
s_waitcnt lgkmcnt(2)
s_barrier
ds_read_b128 v[96:99],v5 offset:0
v_mfma_f32_16x16x32_bf16 v[32:35],a[40:43],v[84:87],v[32:35]
ds_read_b128 v[100:103],v5 offset:1024
v_mfma_f32_16x16x32_bf16 v[36:39],a[44:47],v[84:87],v[36:39]
ds_read_b128 v[104:107],v5 offset:2048
v_mfma_f32_16x16x32_bf16 v[48:51],v[12:15],v[84:87],v[48:51]
ds_read_b128 v[108:111],v5 offset:3072
v_mfma_f32_16x16x32_bf16 v[52:55],v[84:87],v[84:87],v[52:55]
s_waitcnt lgkmcnt(5)
v_mfma_f32_16x16x32_bf16 v[32:35],a[48:51],v[88:91],v[32:35]
ds_read_b128 v[112:115],v5 offset:4096
v_mfma_f32_16x16x32_bf16 v[36:39],a[52:55],v[88:91],v[36:39]
v_mfma_f32_16x16x32_bf16 v[48:51],v[12:15],v[88:91],v[48:51]
v_mfma_f32_16x16x32_bf16 v[52:55],v[88:91],v[88:91],v[52:55]
s_waitcnt lgkmcnt(5)
v_mfma_f32_16x16x32_bf16 v[32:35],a[56:59],v[92:95],v[32:35]
ds_read_b128 v[116:119],v5 offset:5120
v_mfma_f32_16x16x32_bf16 v[36:39],a[60:63],v[92:95],v[36:39]
v_mfma_f32_16x16x32_bf16 v[48:51],v[12:15],v[92:95],v[48:51]
v_mfma_f32_16x16x32_bf16 v[52:55],v[92:95],v[92:95],v[52:55]
s_waitcnt lgkmcnt(5)
v_mfma_f32_16x16x32_bf16 v[32:35],a[64:67],v[96:99],v[32:35]
ds_read_b128 v[120:123],v5 offset:6144
v_mfma_f32_16x16x32_bf16 v[36:39],a[68:71],v[96:99],v[36:39]
s_waitcnt lgkmcnt(5)
v_mfma_f32_16x16x32_bf16 v[32:35],a[72:75],v[100:103],v[32:35]
ds_read_b128 v[124:127],v5 offset:7168
v_mfma_f32_16x16x32_bf16 v[36:39],a[76:79],v[100:103],v[36:39]
s_waitcnt lgkmcnt(5)
v_mfma_f32_16x16x32_bf16 v[32:35],a[80:83],v[104:107],v[32:35]
ds_read_b128 v[64:67],v6 offset:0
v_cndmask_b32 v49,v52,v53,s[74:75]
v_mfma_f32_16x16x32_bf16 v[36:39],a[84:87],v[104:107],v[36:39]
s_waitcnt lgkmcnt(5)
v_cndmask_b32 v49,v49,v54,s[76:77]
v_cndmask_b32 v49,v49,v55,s[78:79]
v_mfma_f32_16x16x32_bf16 v[32:35],a[88:91],v[108:111],v[32:35]
ds_read_b128 v[68:71],v6 offset:1024
v_mfma_f32_16x16x32_bf16 v[36:39],a[92:95],v[108:111],v[36:39]
s_waitcnt lgkmcnt(5)
ds_write_b64 v19,v[48:49]
v_mfma_f32_16x16x32_bf16 v[32:35],a[96:99],v[112:115],v[32:35]
ds_read_b128 v[72:75],v6 offset:2048
v_mfma_f32_16x16x32_bf16 v[36:39],a[100:103],v[112:115],v[36:39]
s_waitcnt lgkmcnt(6)
v_mfma_f32_16x16x32_bf16 v[32:35],a[104:107],v[116:119],v[32:35]
ds_read_b128 v[76:79],v6 offset:3072
v_mfma_f32_16x16x32_bf16 v[36:39],a[108:111],v[116:119],v[36:39]
s_waitcnt lgkmcnt(6)
v_mfma_f32_16x16x32_bf16 v[32:35],a[112:115],v[120:123],v[32:35]
s_waitcnt lgkmcnt(2)
s_barrier
ds_read_b128 v[80:83],v6 offset:4096
v_mfma_f32_16x16x32_bf16 v[36:39],a[116:119],v[120:123],v[36:39]
ds_read_b64 v[56:57],v20 offset:0
v_mfma_f32_16x16x32_bf16 v[32:35],a[120:123],v[124:127],v[32:35]
ds_read_b128 v[84:87],v6 offset:5120
v_mfma_f32_16x16x32_bf16 v[36:39],a[124:127],v[124:127],v[36:39]
ds_read_b64 v[58:59],v20 offset:512
v_mfma_f32_16x16x32_bf16 v[32:35],a[128:131],v[64:67],v[32:35]
ds_read_b128 v[88:91],v6 offset:6144
v_mfma_f32_16x16x32_bf16 v[36:39],a[132:135],v[64:67],v[36:39]
ds_read_b64 v[60:61],v20 offset:1024
v_mfma_f32_16x16x32_bf16 v[32:35],a[136:139],v[68:71],v[32:35]
ds_read_b128 v[92:95],v6 offset:7168
v_mfma_f32_16x16x32_bf16 v[36:39],a[140:143],v[68:71],v[36:39]
s_waitcnt lgkmcnt(8)
ds_read_b64 v[62:63],v20 offset:1536
v_mfma_f32_16x16x32_bf16 v[32:35],a[144:147],v[72:75],v[32:35]
ds_read_b128 v[96:99],v7 offset:0
v_mfma_f32_16x16x32_bf16 v[36:39],a[148:151],v[72:75],v[36:39]
s_waitcnt lgkmcnt(9)
buffer_load_dword v16,v2,s[20:23],s68 offen sc1
v_mfma_f32_16x16x32_bf16 v[32:35],a[152:155],v[76:79],v[32:35]
ds_read_b128 v[100:103],v7 offset:1024
v_mfma_f32_16x16x32_bf16 v[36:39],a[156:159],v[76:79],v[36:39]
s_waitcnt lgkmcnt(9)
s_waitcnt vmcnt(2)
v_mov_b32 v17,s57
buffer_store_dword v17,v26,s[20:23],s69 offen sc1
v_mfma_f32_16x16x32_bf16 v[32:35],a[160:163],v[80:83],v[32:35]
ds_read_b128 v[104:107],v7 offset:2048
v_mfma_f32_16x16x32_bf16 v[36:39],a[164:167],v[80:83],v[36:39]
s_waitcnt lgkmcnt(8)
s_waitcnt lgkmcnt(3)
v_add_f32 v56,v56,v58
v_mfma_f32_16x16x32_bf16 v[32:35],a[168:171],v[84:87],v[32:35]
ds_read_b128 v[108:111],v7 offset:3072
v_add_f32 v57,v57,v59
v_mfma_f32_16x16x32_bf16 v[36:39],a[172:175],v[84:87],v[36:39]
v_add_f32 v60,v60,v62
v_add_f32 v61,v61,v63
v_mfma_f32_16x16x32_bf16 v[32:35],a[176:179],v[88:91],v[32:35]
ds_read_b128 v[112:115],v7 offset:4096
v_add_f32 v56,v56,v60
v_mfma_f32_16x16x32_bf16 v[36:39],a[180:183],v[88:91],v[36:39]
v_add_f32 v57,v57,v61
v_mul_f32 v188,0xba800000,v56
v_mfma_f32_16x16x32_bf16 v[32:35],a[184:187],v[92:95],v[32:35]
ds_read_b128 v[116:119],v7 offset:5120
v_fma_f32 v58,v188,v188,-v210
v_mfma_f32_16x16x32_bf16 v[36:39],a[188:191],v[92:95],v[36:39]
s_waitcnt lgkmcnt(5)
v_fma_f32 v57,v57,v211,-v58
v_max_f32 v57,v210,v57
v_mfma_f32_16x16x32_bf16 v[32:35],a[192:195],v[96:99],v[32:35]
ds_read_b128 v[120:123],v7 offset:6144
v_mfma_f32_16x16x32_bf16 v[36:39],a[196:199],v[96:99],v[36:39]
s_waitcnt lgkmcnt(5)
v_rsq_f32 v58,v57
v_mfma_f32_16x16x32_bf16 v[32:35],a[200:203],v[100:103],v[32:35]
ds_read_b128 v[124:127],v7 offset:7168
v_mul_f32 v189,v57,v58
v_mfma_f32_16x16x32_bf16 v[36:39],a[204:207],v[100:103],v[36:39]
s_waitcnt lgkmcnt(5)
v_mul_f32 v190,v209,v58
v_mul_f32 v59,v58,v58
v_mfma_f32_16x16x32_bf16 v[32:35],a[208:211],v[104:107],v[32:35]
s_add_u32 s55,s55,32768
v_mul_f32 v191,v208,v58
v_mul_f32 v191,v191,v59
v_mfma_f32_16x16x32_bf16 v[36:39],a[212:215],v[104:107],v[36:39]
s_waitcnt lgkmcnt(4)
s_and_b32 s55,s55,0x1ffff
v_add_u32 v4,s55,v8
v_mfma_f32_16x16x32_bf16 v[32:35],a[216:219],v[108:111],v[32:35]
v_add_u32 v5,s55,v9
v_add_u32 v6,s55,v10
v_mfma_f32_16x16x32_bf16 v[36:39],a[220:223],v[108:111],v[36:39]
s_waitcnt lgkmcnt(3)
v_add_u32 v7,s55,v11
v_mfma_f32_16x16x32_bf16 v[32:35],a[224:227],v[112:115],v[32:35]
v_mfma_f32_16x16x32_bf16 v[36:39],a[228:231],v[112:115],v[36:39]
s_waitcnt lgkmcnt(2)
v_mfma_f32_16x16x32_bf16 v[32:35],a[232:235],v[116:119],v[32:35]
v_mfma_f32_16x16x32_bf16 v[36:39],a[236:239],v[116:119],v[36:39]
s_waitcnt lgkmcnt(1)
v_mfma_f32_16x16x32_bf16 v[32:35],a[240:243],v[120:123],v[32:35]
v_mfma_f32_16x16x32_bf16 v[36:39],a[244:247],v[120:123],v[36:39]
s_waitcnt lgkmcnt(0)
v_mfma_f32_16x16x32_bf16 v[40:43],a[248:251],v[124:127],v[32:35]
v_mfma_f32_16x16x32_bf16 v[44:47],a[252:255],v[124:127],v[36:39]
s_waitcnt vmcnt(1)
v_cmp_gt_u32 vcc,s71,v16
s_add_u32 s60,s60,1
endN_305:
s_cbranch_vccnz nb_302
s_mov_b32 m0,s70
s_nop 0
buffer_load_dwordx4 v3,s[20:23],s61 offen offset:0 lds
buffer_load_dwordx4 v3,s[20:23],s61 offen offset:1024 lds
buffer_load_dwordx4 v3,s[20:23],s61 offen offset:2048 lds
buffer_load_dwordx4 v3,s[20:23],s61 offen offset:3072 lds
s_add_u32 m0,s70,4096
s_nop 0
buffer_load_dwordx4 v3,s[20:23],s62 offen offset:0 lds
buffer_load_dwordx4 v3,s[20:23],s62 offen offset:1024 lds
buffer_load_dwordx4 v3,s[20:23],s62 offen offset:2048 lds
buffer_load_dwordx4 v3,s[20:23],s62 offen offset:3072 lds
s_add_u32 s61,s61,32768
s_add_u32 s62,s62,32768
s_add_u32 s70,s70,32768
s_and_b32 s70,s70,0x1ffff
s_mov_b32 s57,s63
v_pk_fma_f32 v[40:41],v[152:153],v[188:189],v[40:41] op_sel_hi:[1,0,1]
v_pk_fma_f32 v[42:43],v[154:155],v[188:189],v[42:43] op_sel_hi:[1,0,1]
v_pk_fma_f32 v[44:45],v[156:157],v[188:189],v[44:45] op_sel_hi:[1,0,1]
v_pk_fma_f32 v[46:47],v[158:159],v[188:189],v[46:47] op_sel_hi:[1,0,1]
v_pk_mul_f32 v[168:169],v[40:41],v[40:41]
v_pk_mul_f32 v[170:171],v[42:43],v[42:43]
v_pk_mul_f32 v[172:173],v[44:45],v[44:45]
v_pk_mul_f32 v[174:175],v[46:47],v[46:47]
v_pk_fma_f32 v[168:169],v[168:169],v[190:191],v[190:191] op_sel:[0,1,0] op_sel_hi:[1,1,0]
v_pk_fma_f32 v[170:171],v[170:171],v[190:191],v[190:191] op_sel:[0,1,0] op_sel_hi:[1,1,0]
v_pk_fma_f32 v[172:173],v[172:173],v[190:191],v[190:191] op_sel:[0,1,0] op_sel_hi:[1,1,0]
v_pk_fma_f32 v[174:175],v[174:175],v[190:191],v[190:191] op_sel:[0,1,0] op_sel_hi:[1,1,0]
v_pk_mul_f32 v[168:169],v[168:169],v[40:41]
v_pk_mul_f32 v[170:171],v[170:171],v[42:43]
v_pk_mul_f32 v[172:173],v[172:173],v[44:45]
v_pk_mul_f32 v[174:175],v[174:175],v[46:47]
v_exp_f32 v168,v168
v_exp_f32 v169,v169
v_exp_f32 v170,v170
v_exp_f32 v171,v171
v_exp_f32 v172,v172
v_exp_f32 v173,v173
v_exp_f32 v174,v174
v_exp_f32 v175,v175
v_pk_fma_f32 v[168:169],v[168:169],v[188:189],v[188:189] op_sel:[0,1,1] op_sel_hi:[1,1,1]
v_pk_fma_f32 v[170:171],v[170:171],v[188:189],v[188:189] op_sel:[0,1,1] op_sel_hi:[1,1,1]
v_pk_fma_f32 v[172:173],v[172:173],v[188:189],v[188:189] op_sel:[0,1,1] op_sel_hi:[1,1,1]
v_pk_fma_f32 v[174:175],v[174:175],v[188:189],v[188:189] op_sel:[0,1,1] op_sel_hi:[1,1,1]
v_rcp_f32 v168,v168
v_rcp_f32 v169,v169
v_rcp_f32 v170,v170
v_rcp_f32 v171,v171
v_rcp_f32 v172,v172
v_rcp_f32 v173,v173
v_rcp_f32 v174,v174
v_rcp_f32 v175,v175
v_pk_mul_f32 v[40:41],v[168:169],v[40:41]
v_pk_mul_f32 v[42:43],v[170:171],v[42:43]
v_pk_mul_f32 v[44:45],v[172:173],v[44:45]
v_pk_mul_f32 v[46:47],v[174:175],v[46:47]
v_cvt_pk_bf16_f32 v176,v40,v41
v_cvt_pk_bf16_f32 v177,v42,v43
v_cvt_pk_bf16_f32 v178,v44,v45
v_cvt_pk_bf16_f32 v179,v46,v47
buffer_store_dwordx4 v[176:179],v0,s[20:23],s66 offen sc1
s_add_u32 s66,s66,114688
s_add_u32 s63,s63,1
s_waitcnt vmcnt(9)
v_mov_b32 v17,s57
buffer_store_dword v17,v26,s[20:23],s69 offen sc1
s_branch dec_301
nb_302:
buffer_load_dword v16,v2,s[20:23],s68 offen sc1
s_nop 3
s_mov_b32 s57,s63
v_pk_fma_f32 v[40:41],v[152:153],v[188:189],v[40:41] op_sel_hi:[1,0,1]
v_pk_fma_f32 v[42:43],v[154:155],v[188:189],v[42:43] op_sel_hi:[1,0,1]
v_pk_fma_f32 v[44:45],v[156:157],v[188:189],v[44:45] op_sel_hi:[1,0,1]
v_pk_fma_f32 v[46:47],v[158:159],v[188:189],v[46:47] op_sel_hi:[1,0,1]
v_pk_mul_f32 v[168:169],v[40:41],v[40:41]
v_pk_mul_f32 v[170:171],v[42:43],v[42:43]
v_pk_mul_f32 v[172:173],v[44:45],v[44:45]
v_pk_mul_f32 v[174:175],v[46:47],v[46:47]
v_pk_fma_f32 v[168:169],v[168:169],v[190:191],v[190:191] op_sel:[0,1,0] op_sel_hi:[1,1,0]
v_pk_fma_f32 v[170:171],v[170:171],v[190:191],v[190:191] op_sel:[0,1,0] op_sel_hi:[1,1,0]
v_pk_fma_f32 v[172:173],v[172:173],v[190:191],v[190:191] op_sel:[0,1,0] op_sel_hi:[1,1,0]
v_pk_fma_f32 v[174:175],v[174:175],v[190:191],v[190:191] op_sel:[0,1,0] op_sel_hi:[1,1,0]
v_pk_mul_f32 v[168:169],v[168:169],v[40:41]
v_pk_mul_f32 v[170:171],v[170:171],v[42:43]
v_pk_mul_f32 v[172:173],v[172:173],v[44:45]
v_pk_mul_f32 v[174:175],v[174:175],v[46:47]
v_exp_f32 v168,v168
v_exp_f32 v169,v169
v_exp_f32 v170,v170
v_exp_f32 v171,v171
v_exp_f32 v172,v172
v_exp_f32 v173,v173
v_exp_f32 v174,v174
v_exp_f32 v175,v175
v_pk_fma_f32 v[168:169],v[168:169],v[188:189],v[188:189] op_sel:[0,1,1] op_sel_hi:[1,1,1]
v_pk_fma_f32 v[170:171],v[170:171],v[188:189],v[188:189] op_sel:[0,1,1] op_sel_hi:[1,1,1]
v_pk_fma_f32 v[172:173],v[172:173],v[188:189],v[188:189] op_sel:[0,1,1] op_sel_hi:[1,1,1]
v_pk_fma_f32 v[174:175],v[174:175],v[188:189],v[188:189] op_sel:[0,1,1] op_sel_hi:[1,1,1]
v_rcp_f32 v168,v168
v_rcp_f32 v169,v169
v_rcp_f32 v170,v170
v_rcp_f32 v171,v171
v_rcp_f32 v172,v172
v_rcp_f32 v173,v173
v_rcp_f32 v174,v174
v_rcp_f32 v175,v175
v_pk_mul_f32 v[40:41],v[168:169],v[40:41]
v_pk_mul_f32 v[42:43],v[170:171],v[42:43]
v_pk_mul_f32 v[44:45],v[172:173],v[44:45]
v_pk_mul_f32 v[46:47],v[174:175],v[46:47]
v_cvt_pk_bf16_f32 v176,v40,v41
v_cvt_pk_bf16_f32 v177,v42,v43
v_cvt_pk_bf16_f32 v178,v44,v45
v_cvt_pk_bf16_f32 v179,v46,v47
buffer_store_dwordx4 v[176:179],v0,s[20:23],s66 offen sc1
s_add_u32 s66,s66,114688
s_add_u32 s63,s63,1
s_waitcnt vmcnt(2)
v_mov_b32 v17,s57
buffer_store_dword v17,v26,s[20:23],s69 offen sc1
s_waitcnt vmcnt(2)
v_cmp_gt_u32 vcc,s71,v16
s_cbranch_vccz lag_300
s_waitcnt vmcnt(1)
v_mov_b32 v17,s63
buffer_store_dword v17,v26,s[20:23],s69 offen sc1
s_cmp_ge_u32 s60,128
s_cbranch_scc1 done_289
plp_308:
buffer_load_dword v16,v2,s[20:23],s68 offen sc1
s_waitcnt vmcnt(0)
v_cmp_gt_u32 vcc,s71,v16
s_cbranch_vccz pok_309
s_sleep 4
s_sub_u32 s90,s90,1
s_cmp_gt_i32 s90,0
s_cbranch_scc1 plp_308
pok_309:
s_branch lag_300
done_289:
s_endpgm
fl_w1:
v_and_b32 v21,15,v1
v_lshrrev_b32 v22,4,v1
v_lshrrev_b32 v23,2,v21
v_and_b32 v24,3,v21
s_lshl_b32 s61,s50,15
v_lshl_add_u32 v25,v22,3,v23
s_load_dwordx2 s[4:5],s[0:1],64
s_mov_b32 s52,0
s_mov_b32 s53,s59
s_mul_i32 s54,s52,2097152
s_lshl_b32 s64,s53,8
s_add_u32 s54,s54,s64
s_lshl_b32 s64,s50,6
s_add_u32 s54,s54,s64
s_waitcnt lgkmcnt(0)
s_mov_b32 s28,s4
s_and_b32 s29,s5,0xffff
s_mov_b32 s30,0x200000
s_mov_b32 s31,0x20000
v_lshrrev_b32 v26,2,v1
v_and_b32 v27,3,v1
v_mul_u32_u24 v16,2048,v26
v_lshl_add_u32 v16,v27,4,v16
v_lshlrev_b32 v17,6,v25
v_lshl_add_u32 v17,v24,4,v17
v_add_u32 v17,s61,v17
s_xor_b32 s62,s50,0
s_mul_i32 s62,s62,524288
s_add_u32 s62,s62,s54
s_add_u32 m0,s61,0
s_nop 0
buffer_load_dwordx4 v16,s[28:31],s62 offen nt lds
s_add_u32 s62,s62,32768
s_add_u32 m0,m0,1024
s_waitcnt vmcnt(2)
buffer_load_dwordx4 v16,s[28:31],s62 offen nt lds
s_add_u32 s62,s62,32768
s_add_u32 m0,m0,1024
s_waitcnt vmcnt(2)
buffer_load_dwordx4 v16,s[28:31],s62 offen nt lds
s_add_u32 s62,s62,32768
s_add_u32 m0,m0,1024
s_waitcnt vmcnt(2)
buffer_load_dwordx4 v16,s[28:31],s62 offen nt lds
s_add_u32 s62,s62,32768
s_add_u32 m0,m0,1024
s_waitcnt vmcnt(2)
buffer_load_dwordx4 v16,s[28:31],s62 offen nt lds
s_add_u32 s62,s62,32768
s_add_u32 m0,m0,1024
s_waitcnt vmcnt(2)
buffer_load_dwordx4 v16,s[28:31],s62 offen nt lds
s_add_u32 s62,s62,32768
s_add_u32 m0,m0,1024
s_waitcnt vmcnt(2)
buffer_load_dwordx4 v16,s[28:31],s62 offen nt lds
s_add_u32 s62,s62,32768
s_add_u32 m0,m0,1024
s_waitcnt vmcnt(2)
buffer_load_dwordx4 v16,s[28:31],s62 offen nt lds
s_add_u32 s62,s62,32768
s_add_u32 m0,m0,1024
s_waitcnt vmcnt(2)
buffer_load_dwordx4 v16,s[28:31],s62 offen nt lds
s_add_u32 s62,s62,32768
s_add_u32 m0,m0,1024
s_waitcnt vmcnt(2)
buffer_load_dwordx4 v16,s[28:31],s62 offen nt lds
s_add_u32 s62,s62,32768
s_add_u32 m0,m0,1024
s_waitcnt vmcnt(2)
buffer_load_dwordx4 v16,s[28:31],s62 offen nt lds
s_add_u32 s62,s62,32768
s_add_u32 m0,m0,1024
s_waitcnt vmcnt(2)
buffer_load_dwordx4 v16,s[28:31],s62 offen nt lds
s_add_u32 s62,s62,32768
s_add_u32 m0,m0,1024
s_waitcnt vmcnt(2)
buffer_load_dwordx4 v16,s[28:31],s62 offen nt lds
s_add_u32 s62,s62,32768
s_add_u32 m0,m0,1024
s_waitcnt vmcnt(2)
buffer_load_dwordx4 v16,s[28:31],s62 offen nt lds
s_add_u32 s62,s62,32768
s_add_u32 m0,m0,1024
s_waitcnt vmcnt(2)
buffer_load_dwordx4 v16,s[28:31],s62 offen nt lds
s_add_u32 s62,s62,32768
s_add_u32 m0,m0,1024
s_waitcnt vmcnt(2)
buffer_load_dwordx4 v16,s[28:31],s62 offen nt lds
s_waitcnt vmcnt(2)
s_xor_b32 s62,s50,1
s_mul_i32 s62,s62,524288
s_add_u32 s62,s62,s54
s_add_u32 m0,s61,16384
s_nop 0
buffer_load_dwordx4 v16,s[28:31],s62 offen nt lds
s_add_u32 s62,s62,32768
s_add_u32 m0,m0,1024
s_waitcnt vmcnt(2)
buffer_load_dwordx4 v16,s[28:31],s62 offen nt lds
s_add_u32 s62,s62,32768
s_add_u32 m0,m0,1024
s_waitcnt vmcnt(2)
buffer_load_dwordx4 v16,s[28:31],s62 offen nt lds
s_add_u32 s62,s62,32768
s_add_u32 m0,m0,1024
s_waitcnt vmcnt(2)
buffer_load_dwordx4 v16,s[28:31],s62 offen nt lds
s_add_u32 s62,s62,32768
s_add_u32 m0,m0,1024
s_waitcnt vmcnt(2)
buffer_load_dwordx4 v16,s[28:31],s62 offen nt lds
s_add_u32 s62,s62,32768
s_add_u32 m0,m0,1024
s_waitcnt vmcnt(2)
buffer_load_dwordx4 v16,s[28:31],s62 offen nt lds
s_add_u32 s62,s62,32768
s_add_u32 m0,m0,1024
s_waitcnt vmcnt(2)
buffer_load_dwordx4 v16,s[28:31],s62 offen nt lds
s_add_u32 s62,s62,32768
s_add_u32 m0,m0,1024
s_waitcnt vmcnt(2)
buffer_load_dwordx4 v16,s[28:31],s62 offen nt lds
s_add_u32 s62,s62,32768
s_add_u32 m0,m0,1024
s_waitcnt vmcnt(2)
buffer_load_dwordx4 v16,s[28:31],s62 offen nt lds
s_add_u32 s62,s62,32768
s_add_u32 m0,m0,1024
s_waitcnt vmcnt(2)
buffer_load_dwordx4 v16,s[28:31],s62 offen nt lds
s_add_u32 s62,s62,32768
s_add_u32 m0,m0,1024
s_waitcnt vmcnt(2)
buffer_load_dwordx4 v16,s[28:31],s62 offen nt lds
s_add_u32 s62,s62,32768
s_add_u32 m0,m0,1024
s_waitcnt vmcnt(2)
buffer_load_dwordx4 v16,s[28:31],s62 offen nt lds
s_add_u32 s62,s62,32768
s_add_u32 m0,m0,1024
s_waitcnt vmcnt(2)
buffer_load_dwordx4 v16,s[28:31],s62 offen nt lds
s_add_u32 s62,s62,32768
s_add_u32 m0,m0,1024
s_waitcnt vmcnt(2)
buffer_load_dwordx4 v16,s[28:31],s62 offen nt lds
s_add_u32 s62,s62,32768
s_add_u32 m0,m0,1024
s_waitcnt vmcnt(2)
buffer_load_dwordx4 v16,s[28:31],s62 offen nt lds
s_add_u32 s62,s62,32768
s_add_u32 m0,m0,1024
s_waitcnt vmcnt(2)
buffer_load_dwordx4 v16,s[28:31],s62 offen nt lds
s_waitcnt vmcnt(2)
s_waitcnt vmcnt(16)
ds_read_b64_tr_b16 a[0:1],v17 offset:0
ds_read_b64_tr_b16 a[2:3],v17 offset:256
ds_read_b64_tr_b16 a[4:5],v17 offset:8
ds_read_b64_tr_b16 a[6:7],v17 offset:264
ds_read_b64_tr_b16 a[8:9],v17 offset:2048
ds_read_b64_tr_b16 a[10:11],v17 offset:2304
ds_read_b64_tr_b16 a[12:13],v17 offset:2056
ds_read_b64_tr_b16 a[14:15],v17 offset:2312
ds_read_b64_tr_b16 a[16:17],v17 offset:4096
ds_read_b64_tr_b16 a[18:19],v17 offset:4352
ds_read_b64_tr_b16 a[20:21],v17 offset:4104
ds_read_b64_tr_b16 a[22:23],v17 offset:4360
s_waitcnt lgkmcnt(0)
ds_read_b64_tr_b16 a[24:25],v17 offset:6144
ds_read_b64_tr_b16 a[26:27],v17 offset:6400
ds_read_b64_tr_b16 a[28:29],v17 offset:6152
ds_read_b64_tr_b16 a[30:31],v17 offset:6408
ds_read_b64_tr_b16 a[32:33],v17 offset:8192
ds_read_b64_tr_b16 a[34:35],v17 offset:8448
ds_read_b64_tr_b16 a[36:37],v17 offset:8200
ds_read_b64_tr_b16 a[38:39],v17 offset:8456
ds_read_b64_tr_b16 a[40:41],v17 offset:10240
ds_read_b64_tr_b16 a[42:43],v17 offset:10496
ds_read_b64_tr_b16 a[44:45],v17 offset:10248
ds_read_b64_tr_b16 a[46:47],v17 offset:10504
s_waitcnt lgkmcnt(0)
ds_read_b64_tr_b16 a[48:49],v17 offset:12288
ds_read_b64_tr_b16 a[50:51],v17 offset:12544
ds_read_b64_tr_b16 a[52:53],v17 offset:12296
ds_read_b64_tr_b16 a[54:55],v17 offset:12552
ds_read_b64_tr_b16 a[56:57],v17 offset:14336
ds_read_b64_tr_b16 a[58:59],v17 offset:14592
ds_read_b64_tr_b16 a[60:61],v17 offset:14344
ds_read_b64_tr_b16 a[62:63],v17 offset:14600
s_waitcnt lgkmcnt(0)
s_xor_b32 s62,s50,2
s_mul_i32 s62,s62,524288
s_add_u32 s62,s62,s54
s_add_u32 m0,s61,0
s_nop 0
buffer_load_dwordx4 v16,s[28:31],s62 offen nt lds
s_add_u32 s62,s62,32768
s_add_u32 m0,m0,1024
s_waitcnt vmcnt(2)
buffer_load_dwordx4 v16,s[28:31],s62 offen nt lds
s_add_u32 s62,s62,32768
s_add_u32 m0,m0,1024
s_waitcnt vmcnt(2)
buffer_load_dwordx4 v16,s[28:31],s62 offen nt lds
s_add_u32 s62,s62,32768
s_add_u32 m0,m0,1024
s_waitcnt vmcnt(2)
buffer_load_dwordx4 v16,s[28:31],s62 offen nt lds
s_add_u32 s62,s62,32768
s_add_u32 m0,m0,1024
s_waitcnt vmcnt(2)
buffer_load_dwordx4 v16,s[28:31],s62 offen nt lds
s_add_u32 s62,s62,32768
s_add_u32 m0,m0,1024
s_waitcnt vmcnt(2)
buffer_load_dwordx4 v16,s[28:31],s62 offen nt lds
s_add_u32 s62,s62,32768
s_add_u32 m0,m0,1024
s_waitcnt vmcnt(2)
buffer_load_dwordx4 v16,s[28:31],s62 offen nt lds
s_add_u32 s62,s62,32768
s_add_u32 m0,m0,1024
s_waitcnt vmcnt(2)
buffer_load_dwordx4 v16,s[28:31],s62 offen nt lds
s_add_u32 s62,s62,32768
s_add_u32 m0,m0,1024
s_waitcnt vmcnt(2)
buffer_load_dwordx4 v16,s[28:31],s62 offen nt lds
s_add_u32 s62,s62,32768
s_add_u32 m0,m0,1024
s_waitcnt vmcnt(2)
buffer_load_dwordx4 v16,s[28:31],s62 offen nt lds
s_add_u32 s62,s62,32768
s_add_u32 m0,m0,1024
s_waitcnt vmcnt(2)
buffer_load_dwordx4 v16,s[28:31],s62 offen nt lds
s_add_u32 s62,s62,32768
s_add_u32 m0,m0,1024
s_waitcnt vmcnt(2)
buffer_load_dwordx4 v16,s[28:31],s62 offen nt lds
s_add_u32 s62,s62,32768
s_add_u32 m0,m0,1024
s_waitcnt vmcnt(2)
buffer_load_dwordx4 v16,s[28:31],s62 offen nt lds
s_add_u32 s62,s62,32768
s_add_u32 m0,m0,1024
s_waitcnt vmcnt(2)
buffer_load_dwordx4 v16,s[28:31],s62 offen nt lds
s_add_u32 s62,s62,32768
s_add_u32 m0,m0,1024
s_waitcnt vmcnt(2)
buffer_load_dwordx4 v16,s[28:31],s62 offen nt lds
s_add_u32 s62,s62,32768
s_add_u32 m0,m0,1024
s_waitcnt vmcnt(2)
buffer_load_dwordx4 v16,s[28:31],s62 offen nt lds
s_waitcnt vmcnt(2)
s_waitcnt vmcnt(16)
ds_read_b64_tr_b16 a[64:65],v17 offset:16384
ds_read_b64_tr_b16 a[66:67],v17 offset:16640
ds_read_b64_tr_b16 a[68:69],v17 offset:16392
ds_read_b64_tr_b16 a[70:71],v17 offset:16648
ds_read_b64_tr_b16 a[72:73],v17 offset:18432
ds_read_b64_tr_b16 a[74:75],v17 offset:18688
ds_read_b64_tr_b16 a[76:77],v17 offset:18440
ds_read_b64_tr_b16 a[78:79],v17 offset:18696
ds_read_b64_tr_b16 a[80:81],v17 offset:20480
ds_read_b64_tr_b16 a[82:83],v17 offset:20736
ds_read_b64_tr_b16 a[84:85],v17 offset:20488
ds_read_b64_tr_b16 a[86:87],v17 offset:20744
s_waitcnt lgkmcnt(0)
ds_read_b64_tr_b16 a[88:89],v17 offset:22528
ds_read_b64_tr_b16 a[90:91],v17 offset:22784
ds_read_b64_tr_b16 a[92:93],v17 offset:22536
ds_read_b64_tr_b16 a[94:95],v17 offset:22792
ds_read_b64_tr_b16 a[96:97],v17 offset:24576
ds_read_b64_tr_b16 a[98:99],v17 offset:24832
ds_read_b64_tr_b16 a[100:101],v17 offset:24584
ds_read_b64_tr_b16 a[102:103],v17 offset:24840
ds_read_b64_tr_b16 a[104:105],v17 offset:26624
ds_read_b64_tr_b16 a[106:107],v17 offset:26880
ds_read_b64_tr_b16 a[108:109],v17 offset:26632
ds_read_b64_tr_b16 a[110:111],v17 offset:26888
s_waitcnt lgkmcnt(0)
ds_read_b64_tr_b16 a[112:113],v17 offset:28672
ds_read_b64_tr_b16 a[114:115],v17 offset:28928
ds_read_b64_tr_b16 a[116:117],v17 offset:28680
ds_read_b64_tr_b16 a[118:119],v17 offset:28936
ds_read_b64_tr_b16 a[120:121],v17 offset:30720
ds_read_b64_tr_b16 a[122:123],v17 offset:30976
ds_read_b64_tr_b16 a[124:125],v17 offset:30728
ds_read_b64_tr_b16 a[126:127],v17 offset:30984
s_waitcnt lgkmcnt(0)
s_xor_b32 s62,s50,3
s_mul_i32 s62,s62,524288
s_add_u32 s62,s62,s54
s_add_u32 m0,s61,16384
s_nop 0
buffer_load_dwordx4 v16,s[28:31],s62 offen nt lds
s_add_u32 s62,s62,32768
s_add_u32 m0,m0,1024
s_waitcnt vmcnt(2)
buffer_load_dwordx4 v16,s[28:31],s62 offen nt lds
s_add_u32 s62,s62,32768
s_add_u32 m0,m0,1024
s_waitcnt vmcnt(2)
buffer_load_dwordx4 v16,s[28:31],s62 offen nt lds
s_add_u32 s62,s62,32768
s_add_u32 m0,m0,1024
s_waitcnt vmcnt(2)
buffer_load_dwordx4 v16,s[28:31],s62 offen nt lds
s_add_u32 s62,s62,32768
s_add_u32 m0,m0,1024
s_waitcnt vmcnt(2)
buffer_load_dwordx4 v16,s[28:31],s62 offen nt lds
s_add_u32 s62,s62,32768
s_add_u32 m0,m0,1024
s_waitcnt vmcnt(2)
buffer_load_dwordx4 v16,s[28:31],s62 offen nt lds
s_add_u32 s62,s62,32768
s_add_u32 m0,m0,1024
s_waitcnt vmcnt(2)
buffer_load_dwordx4 v16,s[28:31],s62 offen nt lds
s_add_u32 s62,s62,32768
s_add_u32 m0,m0,1024
s_waitcnt vmcnt(2)
buffer_load_dwordx4 v16,s[28:31],s62 offen nt lds
s_add_u32 s62,s62,32768
s_add_u32 m0,m0,1024
s_waitcnt vmcnt(2)
buffer_load_dwordx4 v16,s[28:31],s62 offen nt lds
s_add_u32 s62,s62,32768
s_add_u32 m0,m0,1024
s_waitcnt vmcnt(2)
buffer_load_dwordx4 v16,s[28:31],s62 offen nt lds
s_add_u32 s62,s62,32768
s_add_u32 m0,m0,1024
s_waitcnt vmcnt(2)
buffer_load_dwordx4 v16,s[28:31],s62 offen nt lds
s_add_u32 s62,s62,32768
s_add_u32 m0,m0,1024
s_waitcnt vmcnt(2)
buffer_load_dwordx4 v16,s[28:31],s62 offen nt lds
s_add_u32 s62,s62,32768
s_add_u32 m0,m0,1024
s_waitcnt vmcnt(2)
buffer_load_dwordx4 v16,s[28:31],s62 offen nt lds
s_add_u32 s62,s62,32768
s_add_u32 m0,m0,1024
s_waitcnt vmcnt(2)
buffer_load_dwordx4 v16,s[28:31],s62 offen nt lds
s_add_u32 s62,s62,32768
s_add_u32 m0,m0,1024
s_waitcnt vmcnt(2)
buffer_load_dwordx4 v16,s[28:31],s62 offen nt lds
s_add_u32 s62,s62,32768
s_add_u32 m0,m0,1024
s_waitcnt vmcnt(2)
buffer_load_dwordx4 v16,s[28:31],s62 offen nt lds
s_waitcnt vmcnt(2)
s_waitcnt vmcnt(16)
ds_read_b64_tr_b16 a[128:129],v17 offset:0
ds_read_b64_tr_b16 a[130:131],v17 offset:256
ds_read_b64_tr_b16 a[132:133],v17 offset:8
ds_read_b64_tr_b16 a[134:135],v17 offset:264
ds_read_b64_tr_b16 a[136:137],v17 offset:2048
ds_read_b64_tr_b16 a[138:139],v17 offset:2304
ds_read_b64_tr_b16 a[140:141],v17 offset:2056
ds_read_b64_tr_b16 a[142:143],v17 offset:2312
ds_read_b64_tr_b16 a[144:145],v17 offset:4096
ds_read_b64_tr_b16 a[146:147],v17 offset:4352
ds_read_b64_tr_b16 a[148:149],v17 offset:4104
ds_read_b64_tr_b16 a[150:151],v17 offset:4360
s_waitcnt lgkmcnt(0)
ds_read_b64_tr_b16 a[152:153],v17 offset:6144
ds_read_b64_tr_b16 a[154:155],v17 offset:6400
ds_read_b64_tr_b16 a[156:157],v17 offset:6152
ds_read_b64_tr_b16 a[158:159],v17 offset:6408
ds_read_b64_tr_b16 a[160:161],v17 offset:8192
ds_read_b64_tr_b16 a[162:163],v17 offset:8448
ds_read_b64_tr_b16 a[164:165],v17 offset:8200
ds_read_b64_tr_b16 a[166:167],v17 offset:8456
ds_read_b64_tr_b16 a[168:169],v17 offset:10240
ds_read_b64_tr_b16 a[170:171],v17 offset:10496
ds_read_b64_tr_b16 a[172:173],v17 offset:10248
ds_read_b64_tr_b16 a[174:175],v17 offset:10504
s_waitcnt lgkmcnt(0)
ds_read_b64_tr_b16 a[176:177],v17 offset:12288
ds_read_b64_tr_b16 a[178:179],v17 offset:12544
ds_read_b64_tr_b16 a[180:181],v17 offset:12296
ds_read_b64_tr_b16 a[182:183],v17 offset:12552
ds_read_b64_tr_b16 a[184:185],v17 offset:14336
ds_read_b64_tr_b16 a[186:187],v17 offset:14592
ds_read_b64_tr_b16 a[188:189],v17 offset:14344
ds_read_b64_tr_b16 a[190:191],v17 offset:14600
s_waitcnt lgkmcnt(0)
s_waitcnt vmcnt(0)
ds_read_b64_tr_b16 a[192:193],v17 offset:16384
ds_read_b64_tr_b16 a[194:195],v17 offset:16640
ds_read_b64_tr_b16 a[196:197],v17 offset:16392
ds_read_b64_tr_b16 a[198:199],v17 offset:16648
ds_read_b64_tr_b16 a[200:201],v17 offset:18432
ds_read_b64_tr_b16 a[202:203],v17 offset:18688
ds_read_b64_tr_b16 a[204:205],v17 offset:18440
ds_read_b64_tr_b16 a[206:207],v17 offset:18696
ds_read_b64_tr_b16 a[208:209],v17 offset:20480
ds_read_b64_tr_b16 a[210:211],v17 offset:20736
ds_read_b64_tr_b16 a[212:213],v17 offset:20488
ds_read_b64_tr_b16 a[214:215],v17 offset:20744
s_waitcnt lgkmcnt(0)
ds_read_b64_tr_b16 a[216:217],v17 offset:22528
ds_read_b64_tr_b16 a[218:219],v17 offset:22784
ds_read_b64_tr_b16 a[220:221],v17 offset:22536
ds_read_b64_tr_b16 a[222:223],v17 offset:22792
ds_read_b64_tr_b16 a[224:225],v17 offset:24576
ds_read_b64_tr_b16 a[226:227],v17 offset:24832
ds_read_b64_tr_b16 a[228:229],v17 offset:24584
ds_read_b64_tr_b16 a[230:231],v17 offset:24840
ds_read_b64_tr_b16 a[232:233],v17 offset:26624
ds_read_b64_tr_b16 a[234:235],v17 offset:26880
ds_read_b64_tr_b16 a[236:237],v17 offset:26632
ds_read_b64_tr_b16 a[238:239],v17 offset:26888
s_waitcnt lgkmcnt(0)
ds_read_b64_tr_b16 a[240:241],v17 offset:28672
ds_read_b64_tr_b16 a[242:243],v17 offset:28928
ds_read_b64_tr_b16 a[244:245],v17 offset:28680
ds_read_b64_tr_b16 a[246:247],v17 offset:28936
ds_read_b64_tr_b16 a[248:249],v17 offset:30720
ds_read_b64_tr_b16 a[250:251],v17 offset:30976
ds_read_b64_tr_b16 a[252:253],v17 offset:30728
ds_read_b64_tr_b16 a[254:255],v17 offset:30984
s_waitcnt lgkmcnt(0)
s_mov_b32 s92,s2
s_and_b32 s93,s3,0xffff
s_mov_b32 s94,0x100
s_mov_b32 s95,0x20000
v_mbcnt_lo_u32_b32 v16,-1,0
v_mbcnt_hi_u32_b32 v16,-1,v16
v_mov_b32 v18,0
v_cmp_eq_u32 vcc,22,v16
s_nop 1
v_cndmask_b32 v18,v18,63,vcc
v_cmp_eq_u32 vcc,17,v16
s_nop 1
v_cndmask_b32 v18,v18,63,vcc
v_cmp_eq_u32 vcc,18,v16
s_nop 1
v_cndmask_b32 v18,v18,1,vcc
v_and_b32 v19,1,v16
v_cmp_eq_u32 vcc,1,v19
v_mov_b32 v19,8192
s_nop 0
v_cndmask_b32 v19,-1,v19,vcc
v_min_u32 v16,31,v16
v_lshlrev_b32 v16,2,v16
s_sub_u32 s66,s88,64
s_cmp_lg_u32 s50,0
s_cbranch_scc1 vot_315
vpoll_311:
buffer_load_dword v17,v16,s[92:95],s66 offen sc1
s_waitcnt vmcnt(0)
s_cmp_lg_u32 s56,2
s_cbranch_scc1 vck_312
v_cmp_eq_u32 vcc,v17,v19
s_and_b32 s64,vcc_lo,0xffff
s_cmp_eq_u32 s64,65535
s_cbranch_scc1 vck_312
s_mov_b32 s65,0
v_readlane_b32 s64,v17,1
s_lshr_b32 s64,s64,8
s_add_u32 s65,s65,s64
v_readlane_b32 s64,v17,3
s_lshr_b32 s64,s64,8
s_add_u32 s65,s65,s64
v_readlane_b32 s64,v17,5
s_lshr_b32 s64,s64,8
s_add_u32 s65,s65,s64
v_readlane_b32 s64,v17,7
s_lshr_b32 s64,s64,8
s_add_u32 s65,s65,s64
v_readlane_b32 s64,v17,9
s_lshr_b32 s64,s64,8
s_add_u32 s65,s65,s64
v_readlane_b32 s64,v17,11
s_lshr_b32 s64,s64,8
s_add_u32 s65,s65,s64
v_readlane_b32 s64,v17,13
s_lshr_b32 s64,s64,8
s_add_u32 s65,s65,s64
v_readlane_b32 s64,v17,15
s_lshr_b32 s64,s64,8
s_add_u32 s65,s65,s64
s_cmp_ge_u32 s65,256
s_cbranch_scc1 vok_314
s_branch vrt_313
vck_312:
v_cmp_gt_u32 vcc,v18,v17
s_cbranch_vccz vok_314
vrt_313:
s_sleep 48
s_sub_u32 s90,s90,1
s_cmp_gt_i32 s90,0
s_cbranch_scc1 vpoll_311
vok_314:
v_add_u32 v18,160512,v16
ds_write_b32 v18,v17
s_waitcnt lgkmcnt(0)
vot_315:
s_barrier
v_add_u32 v18,160512,v16
ds_read_b32 v17,v18
s_waitcnt lgkmcnt(0)
s_cmp_lg_u32 s56,2
s_cbranch_scc1 vfin_316
v_cmp_eq_u32 vcc,v17,v19
s_and_b32 s64,vcc_lo,0xffff
s_cmp_eq_u32 s64,65535
s_cbranch_scc1 vfin_316
s_mov_b32 s65,0
v_readlane_b32 s64,v17,1
s_lshr_b32 s64,s64,8
s_add_u32 s65,s65,s64
v_readlane_b32 s64,v17,3
s_lshr_b32 s64,s64,8
s_add_u32 s65,s65,s64
v_readlane_b32 s64,v17,5
s_lshr_b32 s64,s64,8
s_add_u32 s65,s65,s64
v_readlane_b32 s64,v17,7
s_lshr_b32 s64,s64,8
s_add_u32 s65,s65,s64
v_readlane_b32 s64,v17,9
s_lshr_b32 s64,s64,8
s_add_u32 s65,s65,s64
v_readlane_b32 s64,v17,11
s_lshr_b32 s64,s64,8
s_add_u32 s65,s65,s64
v_readlane_b32 s64,v17,13
s_lshr_b32 s64,s64,8
s_add_u32 s65,s65,s64
v_readlane_b32 s64,v17,15
s_lshr_b32 s64,s64,8
s_add_u32 s65,s65,s64
s_cmp_ge_u32 s65,256
s_cbranch_scc1 fl_fb
vfin_316:
s_and_b32 s56,s56,1
s_mov_b32 s67,0
s_barrier
v_lshlrev_b32 v0,4,v1
s_mov_b32 s60,0
s_lshl_b32 s70,s50,13
s_mov_b32 s55,0
v_mov_b32 v3,v0
s_mov_b32 s73,0xffff0000
s_lshl_b32 s64,s52,2
s_add_u32 s64,s64,s50
s_mul_i32 s61,s64,8192
s_add_u32 s61,s61,205520896
s_lshl_b32 s68,s64,8
s_add_u32 s68,s68,138548224
s_lshl_b32 s83,s53,2
s_add_u32 s83,s83,s50
s_mov_b32 s63,0
s_xor_b32 s64,s50,0
s_lshl_b32 s64,s64,13
v_add_u32 v8,s64,v0
v_mov_b32 v4,v8
s_xor_b32 s64,s50,1
s_lshl_b32 s64,s64,13
v_add_u32 v9,s64,v0
v_mov_b32 v5,v9
s_xor_b32 s64,s50,2
s_lshl_b32 s64,s64,13
v_add_u32 v10,s64,v0
v_mov_b32 v6,v10
s_xor_b32 s64,s50,3
s_lshl_b32 s64,s64,13
v_add_u32 v11,s64,v0
v_mov_b32 v7,v11
v_min_u32 v2,3,v1
v_lshlrev_b32 v2,7,v2
s_mul_i32 s68,s50,512
s_add_u32 s68,s68,138567680
s_add_u32 s62,s61,4096
s_lshl_b32 s66,s83,10
s_lshr_b32 s65,s83,3
s_lshl_b32 s65,s65,8
s_and_b32 s64,s83,7
s_lshl_b32 s64,s64,2
s_add_u32 s69,s64,s65
s_add_u32 s69,s69,138549248
s_lshl_b32 s69,s83,7
s_add_u32 s69,s69,138559488
s_add_u32 s82,s66,201326592
s_add_u32 s66,s66,209747968
s_lshl_b32 s64,s50,9
s_add_u32 s64,s64,131072
v_lshlrev_b32 v26,3,v1
v_add_u32 v19,s64,v26
v_lshl_add_u32 v26,v23,4,v21
v_lshlrev_b32 v26,3,v26
v_add_u32 v20,131072,v26
s_mov_b32 s74,0x22222222
s_mov_b32 s75,0x22222222
s_mov_b32 s76,0x44444444
s_mov_b32 s77,0x44444444
s_mov_b32 s78,0x88888888
s_mov_b32 s79,0x88888888
v_mov_b32 v208,0xbdd2d3e8
v_mov_b32 v209,0xc0135761
v_mov_b32 v210,0x3727c5ac
v_mov_b32 v211,0x3a800000
v_mov_b32 v12,0x3f803f80
v_mov_b32 v13,0x3f803f80
v_mov_b32 v14,0x3f803f80
v_mov_b32 v15,0x3f803f80
s_nop 1
v_mfma_f32_16x16x32_bf16 v[152:155],a[0:3],v[12:15],0
v_mfma_f32_16x16x32_bf16 v[156:159],a[4:7],v[12:15],0
v_mfma_f32_16x16x32_bf16 v[152:155],a[8:11],v[12:15],v[152:155]
v_mfma_f32_16x16x32_bf16 v[156:159],a[12:15],v[12:15],v[156:159]
v_mfma_f32_16x16x32_bf16 v[152:155],a[16:19],v[12:15],v[152:155]
v_mfma_f32_16x16x32_bf16 v[156:159],a[20:23],v[12:15],v[156:159]
v_mfma_f32_16x16x32_bf16 v[152:155],a[24:27],v[12:15],v[152:155]
v_mfma_f32_16x16x32_bf16 v[156:159],a[28:31],v[12:15],v[156:159]
v_mfma_f32_16x16x32_bf16 v[152:155],a[32:35],v[12:15],v[152:155]
v_mfma_f32_16x16x32_bf16 v[156:159],a[36:39],v[12:15],v[156:159]
v_mfma_f32_16x16x32_bf16 v[152:155],a[40:43],v[12:15],v[152:155]
v_mfma_f32_16x16x32_bf16 v[156:159],a[44:47],v[12:15],v[156:159]
v_mfma_f32_16x16x32_bf16 v[152:155],a[48:51],v[12:15],v[152:155]
v_mfma_f32_16x16x32_bf16 v[156:159],a[52:55],v[12:15],v[156:159]
v_mfma_f32_16x16x32_bf16 v[152:155],a[56:59],v[12:15],v[152:155]
v_mfma_f32_16x16x32_bf16 v[156:159],a[60:63],v[12:15],v[156:159]
v_mfma_f32_16x16x32_bf16 v[152:155],a[64:67],v[12:15],v[152:155]
v_mfma_f32_16x16x32_bf16 v[156:159],a[68:71],v[12:15],v[156:159]
v_mfma_f32_16x16x32_bf16 v[152:155],a[72:75],v[12:15],v[152:155]
v_mfma_f32_16x16x32_bf16 v[156:159],a[76:79],v[12:15],v[156:159]
v_mfma_f32_16x16x32_bf16 v[152:155],a[80:83],v[12:15],v[152:155]
v_mfma_f32_16x16x32_bf16 v[156:159],a[84:87],v[12:15],v[156:159]
v_mfma_f32_16x16x32_bf16 v[152:155],a[88:91],v[12:15],v[152:155]
v_mfma_f32_16x16x32_bf16 v[156:159],a[92:95],v[12:15],v[156:159]
v_mfma_f32_16x16x32_bf16 v[152:155],a[96:99],v[12:15],v[152:155]
v_mfma_f32_16x16x32_bf16 v[156:159],a[100:103],v[12:15],v[156:159]
v_mfma_f32_16x16x32_bf16 v[152:155],a[104:107],v[12:15],v[152:155]
v_mfma_f32_16x16x32_bf16 v[156:159],a[108:111],v[12:15],v[156:159]
v_mfma_f32_16x16x32_bf16 v[152:155],a[112:115],v[12:15],v[152:155]
v_mfma_f32_16x16x32_bf16 v[156:159],a[116:119],v[12:15],v[156:159]
v_mfma_f32_16x16x32_bf16 v[152:155],a[120:123],v[12:15],v[152:155]
v_mfma_f32_16x16x32_bf16 v[156:159],a[124:127],v[12:15],v[156:159]
v_mfma_f32_16x16x32_bf16 v[152:155],a[128:131],v[12:15],v[152:155]
v_mfma_f32_16x16x32_bf16 v[156:159],a[132:135],v[12:15],v[156:159]
v_mfma_f32_16x16x32_bf16 v[152:155],a[136:139],v[12:15],v[152:155]
v_mfma_f32_16x16x32_bf16 v[156:159],a[140:143],v[12:15],v[156:159]
v_mfma_f32_16x16x32_bf16 v[152:155],a[144:147],v[12:15],v[152:155]
v_mfma_f32_16x16x32_bf16 v[156:159],a[148:151],v[12:15],v[156:159]
v_mfma_f32_16x16x32_bf16 v[152:155],a[152:155],v[12:15],v[152:155]
v_mfma_f32_16x16x32_bf16 v[156:159],a[156:159],v[12:15],v[156:159]
v_mfma_f32_16x16x32_bf16 v[152:155],a[160:163],v[12:15],v[152:155]
v_mfma_f32_16x16x32_bf16 v[156:159],a[164:167],v[12:15],v[156:159]
v_mfma_f32_16x16x32_bf16 v[152:155],a[168:171],v[12:15],v[152:155]
v_mfma_f32_16x16x32_bf16 v[156:159],a[172:175],v[12:15],v[156:159]
v_mfma_f32_16x16x32_bf16 v[152:155],a[176:179],v[12:15],v[152:155]
v_mfma_f32_16x16x32_bf16 v[156:159],a[180:183],v[12:15],v[156:159]
v_mfma_f32_16x16x32_bf16 v[152:155],a[184:187],v[12:15],v[152:155]
v_mfma_f32_16x16x32_bf16 v[156:159],a[188:191],v[12:15],v[156:159]
v_mfma_f32_16x16x32_bf16 v[152:155],a[192:195],v[12:15],v[152:155]
v_mfma_f32_16x16x32_bf16 v[156:159],a[196:199],v[12:15],v[156:159]
v_mfma_f32_16x16x32_bf16 v[152:155],a[200:203],v[12:15],v[152:155]
v_mfma_f32_16x16x32_bf16 v[156:159],a[204:207],v[12:15],v[156:159]
v_mfma_f32_16x16x32_bf16 v[152:155],a[208:211],v[12:15],v[152:155]
v_mfma_f32_16x16x32_bf16 v[156:159],a[212:215],v[12:15],v[156:159]
v_mfma_f32_16x16x32_bf16 v[152:155],a[216:219],v[12:15],v[152:155]
v_mfma_f32_16x16x32_bf16 v[156:159],a[220:223],v[12:15],v[156:159]
v_mfma_f32_16x16x32_bf16 v[152:155],a[224:227],v[12:15],v[152:155]
v_mfma_f32_16x16x32_bf16 v[156:159],a[228:231],v[12:15],v[156:159]
v_mfma_f32_16x16x32_bf16 v[152:155],a[232:235],v[12:15],v[152:155]
v_mfma_f32_16x16x32_bf16 v[156:159],a[236:239],v[12:15],v[156:159]
v_mfma_f32_16x16x32_bf16 v[152:155],a[240:243],v[12:15],v[152:155]
v_mfma_f32_16x16x32_bf16 v[156:159],a[244:247],v[12:15],v[156:159]
v_mfma_f32_16x16x32_bf16 v[152:155],a[248:251],v[12:15],v[152:155]
v_mfma_f32_16x16x32_bf16 v[156:159],a[252:255],v[12:15],v[156:159]
v_lshlrev_b32 v26,2,v1
v_cmp_gt_u32 vcc,32,v1
s_nop 1
v_cndmask_b32 v26,2.0,v26,vcc
s_cmp_eq_u32 s56,1
s_cbranch_scc1 lfar_317
s_add_u32 s71,s60,1
s_add_u32 s53,s60,2
plp_325:
buffer_load_dword v16,v2,s[20:23],s68 offen sc1
s_waitcnt vmcnt(0)
v_cmp_gt_u32 vcc,s71,v16
s_cbranch_vccz pok_326
s_sleep 4
s_sub_u32 s90,s90,1
s_cmp_gt_i32 s90,0
s_cbranch_scc1 plp_325
pok_326:
lag_322:
s_mov_b32 m0,s70
s_nop 0
buffer_load_dwordx4 v3,s[20:23],s61 offen offset:0 lds
buffer_load_dwordx4 v3,s[20:23],s61 offen offset:1024 lds
buffer_load_dwordx4 v3,s[20:23],s61 offen offset:2048 lds
buffer_load_dwordx4 v3,s[20:23],s61 offen offset:3072 lds
s_add_u32 m0,s70,4096
s_nop 0
buffer_load_dwordx4 v3,s[20:23],s62 offen offset:0 lds
buffer_load_dwordx4 v3,s[20:23],s62 offen offset:1024 lds
buffer_load_dwordx4 v3,s[20:23],s62 offen offset:2048 lds
buffer_load_dwordx4 v3,s[20:23],s62 offen offset:3072 lds
s_add_u32 s61,s61,32768
s_add_u32 s62,s62,32768
s_add_u32 s70,s70,32768
s_and_b32 s70,s70,0x1ffff
buffer_load_dword v23,off,s[20:23],s66
buffer_load_dword v23,off,s[20:23],s66
dec_323:
v_cmp_gt_u32 vcc,s53,v16
s_cbranch_vccnz BN_321
BR_320:
s_waitcnt vmcnt(9)
ds_read_b128 v[64:67],v4 offset:0
s_waitcnt vmcnt(8)
ds_read_b128 v[68:71],v4 offset:1024
s_waitcnt vmcnt(7)
ds_read_b128 v[72:75],v4 offset:2048
s_waitcnt vmcnt(6)
ds_read_b128 v[76:79],v4 offset:3072
s_waitcnt lgkmcnt(3)
v_mfma_f32_16x16x32_bf16 v[32:35],a[0:3],v[64:67],0
s_add_u32 s71,s60,2
s_add_u32 s53,s60,3
s_mov_b32 s57,s63
v_mfma_f32_16x16x32_bf16 v[36:39],a[4:7],v[64:67],0
v_mfma_f32_16x16x32_bf16 v[48:51],v[12:15],v[64:67],0
v_mfma_f32_16x16x32_bf16 v[52:55],v[64:67],v[64:67],0
s_waitcnt lgkmcnt(2)
s_waitcnt vmcnt(5)
s_mov_b32 m0,s70
ds_read_b128 v[80:83],v4 offset:4096
v_mfma_f32_16x16x32_bf16 v[32:35],a[8:11],v[68:71],v[32:35]
buffer_load_dwordx4 v3,s[20:23],s61 offen offset:0 lds
v_mfma_f32_16x16x32_bf16 v[36:39],a[12:15],v[68:71],v[36:39]
v_mfma_f32_16x16x32_bf16 v[48:51],v[12:15],v[68:71],v[48:51]
v_mfma_f32_16x16x32_bf16 v[52:55],v[68:71],v[68:71],v[52:55]
s_waitcnt lgkmcnt(2)
s_waitcnt vmcnt(5)
ds_read_b128 v[84:87],v4 offset:5120
v_mfma_f32_16x16x32_bf16 v[32:35],a[16:19],v[72:75],v[32:35]
buffer_load_dwordx4 v3,s[20:23],s61 offen offset:1024 lds
v_mfma_f32_16x16x32_bf16 v[36:39],a[20:23],v[72:75],v[36:39]
v_mfma_f32_16x16x32_bf16 v[48:51],v[12:15],v[72:75],v[48:51]
v_mfma_f32_16x16x32_bf16 v[52:55],v[72:75],v[72:75],v[52:55]
s_waitcnt lgkmcnt(2)
s_waitcnt vmcnt(5)
ds_read_b128 v[88:91],v4 offset:6144
v_mfma_f32_16x16x32_bf16 v[32:35],a[24:27],v[76:79],v[32:35]
buffer_load_dwordx4 v3,s[20:23],s61 offen offset:2048 lds
v_mfma_f32_16x16x32_bf16 v[36:39],a[28:31],v[76:79],v[36:39]
v_mfma_f32_16x16x32_bf16 v[48:51],v[12:15],v[76:79],v[48:51]
v_mfma_f32_16x16x32_bf16 v[52:55],v[76:79],v[76:79],v[52:55]
s_waitcnt lgkmcnt(2)
s_waitcnt vmcnt(5)
ds_read_b128 v[92:95],v4 offset:7168
v_mfma_f32_16x16x32_bf16 v[32:35],a[32:35],v[80:83],v[32:35]
buffer_load_dwordx4 v3,s[20:23],s61 offen offset:3072 lds
v_mfma_f32_16x16x32_bf16 v[36:39],a[36:39],v[80:83],v[36:39]
v_mfma_f32_16x16x32_bf16 v[48:51],v[12:15],v[80:83],v[48:51]
v_mfma_f32_16x16x32_bf16 v[52:55],v[80:83],v[80:83],v[52:55]
s_waitcnt lgkmcnt(2)
s_barrier
ds_read_b128 v[96:99],v5 offset:0
v_mfma_f32_16x16x32_bf16 v[32:35],a[40:43],v[84:87],v[32:35]
ds_read_b128 v[100:103],v5 offset:1024
v_mfma_f32_16x16x32_bf16 v[36:39],a[44:47],v[84:87],v[36:39]
ds_read_b128 v[104:107],v5 offset:2048
v_mfma_f32_16x16x32_bf16 v[48:51],v[12:15],v[84:87],v[48:51]
s_add_u32 m0,s70,4096
ds_read_b128 v[108:111],v5 offset:3072
v_mfma_f32_16x16x32_bf16 v[52:55],v[84:87],v[84:87],v[52:55]
s_waitcnt lgkmcnt(5)
buffer_load_dwordx4 v3,s[20:23],s62 offen offset:0 lds
v_mfma_f32_16x16x32_bf16 v[32:35],a[48:51],v[88:91],v[32:35]
ds_read_b128 v[112:115],v5 offset:4096
v_mfma_f32_16x16x32_bf16 v[36:39],a[52:55],v[88:91],v[36:39]
buffer_load_dwordx4 v3,s[20:23],s62 offen offset:1024 lds
v_mfma_f32_16x16x32_bf16 v[48:51],v[12:15],v[88:91],v[48:51]
v_mfma_f32_16x16x32_bf16 v[52:55],v[88:91],v[88:91],v[52:55]
s_waitcnt lgkmcnt(5)
v_mfma_f32_16x16x32_bf16 v[32:35],a[56:59],v[92:95],v[32:35]
ds_read_b128 v[116:119],v5 offset:5120
v_mfma_f32_16x16x32_bf16 v[36:39],a[60:63],v[92:95],v[36:39]
buffer_load_dwordx4 v3,s[20:23],s62 offen offset:2048 lds
v_mfma_f32_16x16x32_bf16 v[48:51],v[12:15],v[92:95],v[48:51]
buffer_load_dword v16,v2,s[20:23],s68 offen sc1
v_mfma_f32_16x16x32_bf16 v[52:55],v[92:95],v[92:95],v[52:55]
s_waitcnt lgkmcnt(5)
v_mfma_f32_16x16x32_bf16 v[32:35],a[64:67],v[96:99],v[32:35]
ds_read_b128 v[120:123],v5 offset:6144
v_mfma_f32_16x16x32_bf16 v[36:39],a[68:71],v[96:99],v[36:39]
s_waitcnt lgkmcnt(5)
buffer_load_dwordx4 v3,s[20:23],s62 offen offset:3072 lds
v_mfma_f32_16x16x32_bf16 v[32:35],a[72:75],v[100:103],v[32:35]
ds_read_b128 v[124:127],v5 offset:7168
v_mfma_f32_16x16x32_bf16 v[36:39],a[76:79],v[100:103],v[36:39]
s_waitcnt lgkmcnt(5)
v_mfma_f32_16x16x32_bf16 v[32:35],a[80:83],v[104:107],v[32:35]
ds_read_b128 v[64:67],v6 offset:0
v_cndmask_b32 v49,v52,v53,s[74:75]
v_mfma_f32_16x16x32_bf16 v[36:39],a[84:87],v[104:107],v[36:39]
s_waitcnt lgkmcnt(5)
v_cndmask_b32 v49,v49,v54,s[76:77]
v_cndmask_b32 v49,v49,v55,s[78:79]
v_mfma_f32_16x16x32_bf16 v[32:35],a[88:91],v[108:111],v[32:35]
ds_read_b128 v[68:71],v6 offset:1024
v_mfma_f32_16x16x32_bf16 v[36:39],a[92:95],v[108:111],v[36:39]
s_waitcnt lgkmcnt(5)
ds_write_b64 v19,v[48:49]
v_mfma_f32_16x16x32_bf16 v[32:35],a[96:99],v[112:115],v[32:35]
ds_read_b128 v[72:75],v6 offset:2048
v_mfma_f32_16x16x32_bf16 v[36:39],a[100:103],v[112:115],v[36:39]
s_waitcnt lgkmcnt(6)
v_mfma_f32_16x16x32_bf16 v[32:35],a[104:107],v[116:119],v[32:35]
ds_read_b128 v[76:79],v6 offset:3072
v_mfma_f32_16x16x32_bf16 v[36:39],a[108:111],v[116:119],v[36:39]
s_waitcnt lgkmcnt(6)
v_mfma_f32_16x16x32_bf16 v[32:35],a[112:115],v[120:123],v[32:35]
s_waitcnt lgkmcnt(2)
s_barrier
ds_read_b128 v[80:83],v6 offset:4096
v_mfma_f32_16x16x32_bf16 v[36:39],a[116:119],v[120:123],v[36:39]
ds_read_b64 v[56:57],v20 offset:0
v_mfma_f32_16x16x32_bf16 v[32:35],a[120:123],v[124:127],v[32:35]
ds_read_b128 v[84:87],v6 offset:5120
v_mfma_f32_16x16x32_bf16 v[36:39],a[124:127],v[124:127],v[36:39]
ds_read_b64 v[58:59],v20 offset:512
v_mfma_f32_16x16x32_bf16 v[32:35],a[128:131],v[64:67],v[32:35]
ds_read_b128 v[88:91],v6 offset:6144
v_mfma_f32_16x16x32_bf16 v[36:39],a[132:135],v[64:67],v[36:39]
ds_read_b64 v[60:61],v20 offset:1024
v_mfma_f32_16x16x32_bf16 v[32:35],a[136:139],v[68:71],v[32:35]
ds_read_b128 v[92:95],v6 offset:7168
v_mfma_f32_16x16x32_bf16 v[36:39],a[140:143],v[68:71],v[36:39]
s_waitcnt lgkmcnt(8)
ds_read_b64 v[62:63],v20 offset:1536
v_mfma_f32_16x16x32_bf16 v[32:35],a[144:147],v[72:75],v[32:35]
ds_read_b128 v[96:99],v7 offset:0
v_mfma_f32_16x16x32_bf16 v[36:39],a[148:151],v[72:75],v[36:39]
s_waitcnt lgkmcnt(9)
s_waitcnt vmcnt(10)
v_mov_b32 v17,s57
buffer_store_dword v17,v26,s[20:23],s69 offen
v_mfma_f32_16x16x32_bf16 v[32:35],a[152:155],v[76:79],v[32:35]
ds_read_b128 v[100:103],v7 offset:1024
v_mfma_f32_16x16x32_bf16 v[36:39],a[156:159],v[76:79],v[36:39]
s_waitcnt lgkmcnt(9)
v_mfma_f32_16x16x32_bf16 v[32:35],a[160:163],v[80:83],v[32:35]
ds_read_b128 v[104:107],v7 offset:2048
v_mfma_f32_16x16x32_bf16 v[36:39],a[164:167],v[80:83],v[36:39]
s_waitcnt lgkmcnt(8)
s_waitcnt lgkmcnt(3)
v_add_f32 v56,v56,v58
v_mfma_f32_16x16x32_bf16 v[32:35],a[168:171],v[84:87],v[32:35]
ds_read_b128 v[108:111],v7 offset:3072
v_add_f32 v57,v57,v59
v_mfma_f32_16x16x32_bf16 v[36:39],a[172:175],v[84:87],v[36:39]
v_add_f32 v60,v60,v62
v_add_f32 v61,v61,v63
v_mfma_f32_16x16x32_bf16 v[32:35],a[176:179],v[88:91],v[32:35]
ds_read_b128 v[112:115],v7 offset:4096
v_add_f32 v56,v56,v60
v_mfma_f32_16x16x32_bf16 v[36:39],a[180:183],v[88:91],v[36:39]
v_add_f32 v57,v57,v61
v_mul_f32 v188,0xba800000,v56
v_mfma_f32_16x16x32_bf16 v[32:35],a[184:187],v[92:95],v[32:35]
ds_read_b128 v[116:119],v7 offset:5120
v_fma_f32 v58,v188,v188,-v210
v_mfma_f32_16x16x32_bf16 v[36:39],a[188:191],v[92:95],v[36:39]
s_waitcnt lgkmcnt(5)
v_fma_f32 v57,v57,v211,-v58
v_max_f32 v57,v210,v57
v_mfma_f32_16x16x32_bf16 v[32:35],a[192:195],v[96:99],v[32:35]
ds_read_b128 v[120:123],v7 offset:6144
v_mfma_f32_16x16x32_bf16 v[36:39],a[196:199],v[96:99],v[36:39]
s_waitcnt lgkmcnt(5)
v_rsq_f32 v58,v57
v_mfma_f32_16x16x32_bf16 v[32:35],a[200:203],v[100:103],v[32:35]
ds_read_b128 v[124:127],v7 offset:7168
v_mul_f32 v189,v57,v58
v_mfma_f32_16x16x32_bf16 v[36:39],a[204:207],v[100:103],v[36:39]
s_waitcnt lgkmcnt(5)
v_mul_f32 v190,v209,v58
v_mul_f32 v59,v58,v58
v_mfma_f32_16x16x32_bf16 v[32:35],a[208:211],v[104:107],v[32:35]
s_add_u32 s61,s61,32768
v_mul_f32 v191,v208,v58
v_mul_f32 v191,v191,v59
v_mfma_f32_16x16x32_bf16 v[36:39],a[212:215],v[104:107],v[36:39]
s_waitcnt lgkmcnt(4)
s_add_u32 s62,s62,32768
s_add_u32 s70,s70,32768
v_mfma_f32_16x16x32_bf16 v[32:35],a[216:219],v[108:111],v[32:35]
s_and_b32 s70,s70,0x1ffff
s_add_u32 s55,s55,32768
s_and_b32 s55,s55,0x1ffff
v_mfma_f32_16x16x32_bf16 v[36:39],a[220:223],v[108:111],v[36:39]
s_waitcnt lgkmcnt(3)
v_add_u32 v4,s55,v8
v_add_u32 v5,s55,v9
v_mfma_f32_16x16x32_bf16 v[32:35],a[224:227],v[112:115],v[32:35]
v_add_u32 v6,s55,v10
v_add_u32 v7,s55,v11
v_mfma_f32_16x16x32_bf16 v[36:39],a[228:231],v[112:115],v[36:39]
s_waitcnt lgkmcnt(2)
s_waitcnt vmcnt(9)
ds_read_b128 v[64:67],v4 offset:0
v_mfma_f32_16x16x32_bf16 v[32:35],a[232:235],v[116:119],v[32:35]
s_waitcnt vmcnt(8)
ds_read_b128 v[68:71],v4 offset:1024
v_mfma_f32_16x16x32_bf16 v[36:39],a[236:239],v[116:119],v[36:39]
s_waitcnt lgkmcnt(3)
s_waitcnt vmcnt(7)
ds_read_b128 v[72:75],v4 offset:2048
v_mfma_f32_16x16x32_bf16 v[32:35],a[240:243],v[120:123],v[32:35]
v_mfma_f32_16x16x32_bf16 v[36:39],a[244:247],v[120:123],v[36:39]
s_waitcnt lgkmcnt(3)
v_mfma_f32_16x16x32_bf16 v[40:43],a[248:251],v[124:127],v[32:35]
v_mfma_f32_16x16x32_bf16 v[44:47],a[252:255],v[124:127],v[36:39]
s_waitcnt vmcnt(2)
v_cmp_gt_u32 vcc,s53,v16
s_add_u32 s60,s60,1
s_cbranch_vccnz WN_319
.p2align 6
WR_318:
s_waitcnt lgkmcnt(2)
v_mfma_f32_16x16x32_bf16 v[32:35],a[0:3],v[64:67],0
s_waitcnt vmcnt(6)
s_add_u32 s71,s60,2
ds_read_b128 v[76:79],v4 offset:3072
v_mfma_f32_16x16x32_bf16 v[36:39],a[4:7],v[64:67],0
s_add_u32 s53,s60,3
s_mov_b32 s57,s63
v_mfma_f32_16x16x32_bf16 v[48:51],v[12:15],v[64:67],0
s_mov_b32 m0,s70
v_fma_f32 v40,v152,v188,v40
v_fma_f32 v41,v153,v188,v41
v_mul_f32 v168,v40,v40
v_mfma_f32_16x16x32_bf16 v[52:55],v[64:67],v[64:67],0
s_waitcnt lgkmcnt(2)
buffer_load_dwordx4 v3,s[20:23],s61 offen offset:0 lds
v_mul_f32 v169,v41,v41
v_fma_f32 v168,v168,v191,v190
v_mfma_f32_16x16x32_bf16 v[32:35],a[8:11],v[68:71],v[32:35]
s_waitcnt vmcnt(6)
ds_read_b128 v[80:83],v4 offset:4096
v_fma_f32 v169,v169,v191,v190
v_mul_f32 v168,v168,v40
v_mfma_f32_16x16x32_bf16 v[36:39],a[12:15],v[68:71],v[36:39]
v_exp_f32 v168,v168
v_mul_f32 v169,v169,v41
v_mfma_f32_16x16x32_bf16 v[48:51],v[12:15],v[68:71],v[48:51]
v_exp_f32 v169,v169
v_fma_f32 v168,v168,v189,v189
v_mfma_f32_16x16x32_bf16 v[52:55],v[68:71],v[68:71],v[52:55]
s_waitcnt lgkmcnt(2)
buffer_load_dwordx4 v3,s[20:23],s61 offen offset:1024 lds
v_rcp_f32 v168,v168
v_mfma_f32_16x16x32_bf16 v[32:35],a[16:19],v[72:75],v[32:35]
s_waitcnt vmcnt(6)
ds_read_b128 v[84:87],v4 offset:5120
v_fma_f32 v169,v169,v189,v189
v_mul_f32 v40,v168,v40
v_mfma_f32_16x16x32_bf16 v[36:39],a[20:23],v[72:75],v[36:39]
v_rcp_f32 v169,v169
v_fma_f32 v42,v154,v188,v42
v_mfma_f32_16x16x32_bf16 v[48:51],v[12:15],v[72:75],v[48:51]
v_mul_f32 v41,v169,v41
v_fma_f32 v43,v155,v188,v43
v_mul_f32 v170,v42,v42
v_mfma_f32_16x16x32_bf16 v[52:55],v[72:75],v[72:75],v[52:55]
s_waitcnt lgkmcnt(2)
buffer_load_dwordx4 v3,s[20:23],s61 offen offset:2048 lds
v_mul_f32 v171,v43,v43
v_fma_f32 v170,v170,v191,v190
v_mfma_f32_16x16x32_bf16 v[32:35],a[24:27],v[76:79],v[32:35]
s_waitcnt vmcnt(6)
ds_read_b128 v[88:91],v4 offset:6144
v_fma_f32 v171,v171,v191,v190
v_mfma_f32_16x16x32_bf16 v[36:39],a[28:31],v[76:79],v[36:39]
v_mul_f32 v170,v170,v42
v_mul_f32 v171,v171,v43
v_mfma_f32_16x16x32_bf16 v[48:51],v[12:15],v[76:79],v[48:51]
v_exp_f32 v170,v170
v_mfma_f32_16x16x32_bf16 v[52:55],v[76:79],v[76:79],v[52:55]
s_waitcnt lgkmcnt(2)
buffer_load_dwordx4 v3,s[20:23],s61 offen offset:3072 lds
v_fma_f32 v170,v170,v189,v189
v_mfma_f32_16x16x32_bf16 v[32:35],a[32:35],v[80:83],v[32:35]
s_waitcnt vmcnt(5)
ds_read_b128 v[92:95],v4 offset:7168
v_fma_f32 v44,v156,v188,v44
v_mfma_f32_16x16x32_bf16 v[36:39],a[36:39],v[80:83],v[36:39]
s_barrier
ds_read_b128 v[96:99],v5 offset:0
v_fma_f32 v45,v157,v188,v45
v_mfma_f32_16x16x32_bf16 v[48:51],v[12:15],v[80:83],v[48:51]
ds_read_b128 v[100:103],v5 offset:1024
v_mul_f32 v172,v44,v44
v_mfma_f32_16x16x32_bf16 v[52:55],v[80:83],v[80:83],v[52:55]
s_waitcnt lgkmcnt(4)
ds_read_b128 v[104:107],v5 offset:2048
v_mul_f32 v173,v45,v45
v_mfma_f32_16x16x32_bf16 v[32:35],a[40:43],v[84:87],v[32:35]
s_add_u32 m0,s70,4096
ds_read_b128 v[108:111],v5 offset:3072
v_fma_f32 v172,v172,v191,v190
v_mfma_f32_16x16x32_bf16 v[36:39],a[44:47],v[84:87],v[36:39]
buffer_load_dwordx4 v3,s[20:23],s62 offen offset:0 lds
v_fma_f32 v173,v173,v191,v190
v_mfma_f32_16x16x32_bf16 v[48:51],v[12:15],v[84:87],v[48:51]
s_waitcnt vmcnt(5)
v_mov_b32 v17,s57
buffer_store_dword v17,v26,s[20:23],s69 offen
v_mfma_f32_16x16x32_bf16 v[52:55],v[84:87],v[84:87],v[52:55]
s_waitcnt lgkmcnt(5)
v_exp_f32 v171,v171
v_mfma_f32_16x16x32_bf16 v[32:35],a[48:51],v[88:91],v[32:35]
ds_read_b128 v[112:115],v5 offset:4096
v_fma_f32 v171,v171,v189,v189
v_mfma_f32_16x16x32_bf16 v[36:39],a[52:55],v[88:91],v[36:39]
buffer_load_dwordx4 v3,s[20:23],s62 offen offset:1024 lds
v_mul_f32 v172,v172,v44
v_mfma_f32_16x16x32_bf16 v[48:51],v[12:15],v[88:91],v[48:51]
v_rcp_f32 v170,v170
v_mfma_f32_16x16x32_bf16 v[52:55],v[88:91],v[88:91],v[52:55]
s_waitcnt lgkmcnt(5)
v_rcp_f32 v171,v171
v_mfma_f32_16x16x32_bf16 v[32:35],a[56:59],v[92:95],v[32:35]
ds_read_b128 v[116:119],v5 offset:5120
v_mul_f32 v42,v170,v42
v_mfma_f32_16x16x32_bf16 v[36:39],a[60:63],v[92:95],v[36:39]
buffer_load_dwordx4 v3,s[20:23],s62 offen offset:2048 lds
v_mul_f32 v43,v171,v43
v_mfma_f32_16x16x32_bf16 v[48:51],v[12:15],v[92:95],v[48:51]
buffer_load_dword v16,v2,s[20:23],s68 offen sc1
v_mul_f32 v173,v173,v45
v_mfma_f32_16x16x32_bf16 v[52:55],v[92:95],v[92:95],v[52:55]
s_waitcnt lgkmcnt(5)
v_exp_f32 v172,v172
v_mfma_f32_16x16x32_bf16 v[32:35],a[64:67],v[96:99],v[32:35]
ds_read_b128 v[120:123],v5 offset:6144
v_fma_f32 v172,v172,v189,v189
v_mfma_f32_16x16x32_bf16 v[36:39],a[68:71],v[96:99],v[36:39]
s_waitcnt lgkmcnt(5)
buffer_load_dwordx4 v3,s[20:23],s62 offen offset:3072 lds
v_fma_f32 v46,v158,v188,v46
v_mfma_f32_16x16x32_bf16 v[32:35],a[72:75],v[100:103],v[32:35]
ds_read_b128 v[124:127],v5 offset:7168
v_fma_f32 v47,v159,v188,v47
v_mfma_f32_16x16x32_bf16 v[36:39],a[76:79],v[100:103],v[36:39]
s_waitcnt lgkmcnt(5)
v_exp_f32 v173,v173
v_mfma_f32_16x16x32_bf16 v[32:35],a[80:83],v[104:107],v[32:35]
ds_read_b128 v[64:67],v6 offset:0
v_cndmask_b32 v49,v52,v53,s[74:75]
v_mfma_f32_16x16x32_bf16 v[36:39],a[84:87],v[104:107],v[36:39]
s_waitcnt lgkmcnt(5)
v_cndmask_b32 v49,v49,v54,s[76:77]
v_cndmask_b32 v49,v49,v55,s[78:79]
v_mfma_f32_16x16x32_bf16 v[32:35],a[88:91],v[108:111],v[32:35]
ds_read_b128 v[68:71],v6 offset:1024
v_fma_f32 v173,v173,v189,v189
v_mfma_f32_16x16x32_bf16 v[36:39],a[92:95],v[108:111],v[36:39]
s_waitcnt lgkmcnt(5)
ds_write_b64 v19,v[48:49]
v_mfma_f32_16x16x32_bf16 v[32:35],a[96:99],v[112:115],v[32:35]
ds_read_b128 v[72:75],v6 offset:2048
v_mul_f32 v174,v46,v46
v_mfma_f32_16x16x32_bf16 v[36:39],a[100:103],v[112:115],v[36:39]
s_waitcnt lgkmcnt(6)
v_rcp_f32 v172,v172
v_mfma_f32_16x16x32_bf16 v[32:35],a[104:107],v[116:119],v[32:35]
ds_read_b128 v[76:79],v6 offset:3072
v_mul_f32 v44,v172,v44
v_mfma_f32_16x16x32_bf16 v[36:39],a[108:111],v[116:119],v[36:39]
s_waitcnt lgkmcnt(6)
v_rcp_f32 v173,v173
v_mfma_f32_16x16x32_bf16 v[32:35],a[112:115],v[120:123],v[32:35]
s_waitcnt lgkmcnt(2)
s_barrier
ds_read_b128 v[80:83],v6 offset:4096
v_mfma_f32_16x16x32_bf16 v[36:39],a[116:119],v[120:123],v[36:39]
ds_read_b64 v[56:57],v20 offset:0
v_mul_f32 v45,v173,v45
v_mfma_f32_16x16x32_bf16 v[32:35],a[120:123],v[124:127],v[32:35]
ds_read_b128 v[84:87],v6 offset:5120
v_mul_f32 v175,v47,v47
v_mfma_f32_16x16x32_bf16 v[36:39],a[124:127],v[124:127],v[36:39]
ds_read_b64 v[58:59],v20 offset:512
v_fma_f32 v174,v174,v191,v190
v_mfma_f32_16x16x32_bf16 v[32:35],a[128:131],v[64:67],v[32:35]
ds_read_b128 v[88:91],v6 offset:6144
v_fma_f32 v175,v175,v191,v190
v_mfma_f32_16x16x32_bf16 v[36:39],a[132:135],v[64:67],v[36:39]
ds_read_b64 v[60:61],v20 offset:1024
v_mul_f32 v174,v174,v46
v_mfma_f32_16x16x32_bf16 v[32:35],a[136:139],v[68:71],v[32:35]
ds_read_b128 v[92:95],v6 offset:7168
v_mul_f32 v175,v175,v47
v_mfma_f32_16x16x32_bf16 v[36:39],a[140:143],v[68:71],v[36:39]
s_waitcnt lgkmcnt(8)
ds_read_b64 v[62:63],v20 offset:1536
v_cvt_pk_bf16_f32 v176,v40,v41
v_mfma_f32_16x16x32_bf16 v[32:35],a[144:147],v[72:75],v[32:35]
ds_read_b128 v[96:99],v7 offset:0
v_cvt_pk_bf16_f32 v177,v42,v43
v_mfma_f32_16x16x32_bf16 v[36:39],a[148:151],v[72:75],v[36:39]
s_waitcnt lgkmcnt(9)
v_exp_f32 v174,v174
v_mfma_f32_16x16x32_bf16 v[32:35],a[152:155],v[76:79],v[32:35]
ds_read_b128 v[100:103],v7 offset:1024
v_fma_f32 v174,v174,v189,v189
v_mfma_f32_16x16x32_bf16 v[36:39],a[156:159],v[76:79],v[36:39]
s_waitcnt lgkmcnt(9)
v_exp_f32 v175,v175
v_mfma_f32_16x16x32_bf16 v[32:35],a[160:163],v[80:83],v[32:35]
ds_read_b128 v[104:107],v7 offset:2048
v_fma_f32 v175,v175,v189,v189
v_mfma_f32_16x16x32_bf16 v[36:39],a[164:167],v[80:83],v[36:39]
s_waitcnt lgkmcnt(8)
s_waitcnt lgkmcnt(3)
v_rcp_f32 v174,v174
v_mfma_f32_16x16x32_bf16 v[32:35],a[168:171],v[84:87],v[32:35]
ds_read_b128 v[108:111],v7 offset:3072
v_mul_f32 v46,v174,v46
v_mfma_f32_16x16x32_bf16 v[36:39],a[172:175],v[84:87],v[36:39]
v_rcp_f32 v175,v175
v_mfma_f32_16x16x32_bf16 v[32:35],a[176:179],v[88:91],v[32:35]
ds_read_b128 v[112:115],v7 offset:4096
v_mul_f32 v47,v175,v47
v_mfma_f32_16x16x32_bf16 v[36:39],a[180:183],v[88:91],v[36:39]
v_cvt_pk_bf16_f32 v178,v44,v45
v_cvt_pk_bf16_f32 v179,v46,v47
v_mfma_f32_16x16x32_bf16 v[32:35],a[184:187],v[92:95],v[32:35]
ds_read_b128 v[116:119],v7 offset:5120
v_add_f32 v56,v56,v58
v_mfma_f32_16x16x32_bf16 v[36:39],a[188:191],v[92:95],v[36:39]
s_waitcnt lgkmcnt(5)
buffer_store_dwordx4 v[176:179],v0,s[20:23],s66 offen sc1
v_mfma_f32_16x16x32_bf16 v[32:35],a[192:195],v[96:99],v[32:35]
s_add_u32 s66,s66,32768
s_add_u32 s63,s63,1
ds_read_b128 v[120:123],v7 offset:6144
v_mfma_f32_16x16x32_bf16 v[36:39],a[196:199],v[96:99],v[36:39]
s_waitcnt lgkmcnt(5)
v_add_f32 v57,v57,v59
v_add_f32 v60,v60,v62
v_mfma_f32_16x16x32_bf16 v[32:35],a[200:203],v[100:103],v[32:35]
ds_read_b128 v[124:127],v7 offset:7168
v_add_f32 v61,v61,v63
v_mfma_f32_16x16x32_bf16 v[36:39],a[204:207],v[100:103],v[36:39]
s_waitcnt lgkmcnt(5)
v_add_f32 v56,v56,v60
v_add_f32 v57,v57,v61
v_mfma_f32_16x16x32_bf16 v[32:35],a[208:211],v[104:107],v[32:35]
s_add_u32 s61,s61,32768
v_mul_f32 v188,0xba800000,v56
v_fma_f32 v58,v188,v188,-v210
v_mfma_f32_16x16x32_bf16 v[36:39],a[212:215],v[104:107],v[36:39]
s_waitcnt lgkmcnt(4)
v_fma_f32 v57,v57,v211,-v58
v_max_f32 v57,v210,v57
v_mfma_f32_16x16x32_bf16 v[32:35],a[216:219],v[108:111],v[32:35]
s_add_u32 s62,s62,32768
v_rsq_f32 v58,v57
v_mfma_f32_16x16x32_bf16 v[36:39],a[220:223],v[108:111],v[36:39]
s_waitcnt lgkmcnt(3)
v_mul_f32 v189,v57,v58
v_mul_f32 v190,v209,v58
v_mfma_f32_16x16x32_bf16 v[32:35],a[224:227],v[112:115],v[32:35]
s_add_u32 s70,s70,32768
v_mul_f32 v59,v58,v58
v_mul_f32 v191,v208,v58
v_mfma_f32_16x16x32_bf16 v[36:39],a[228:231],v[112:115],v[36:39]
s_waitcnt lgkmcnt(2)
s_and_b32 s70,s70,0x1ffff
v_mul_f32 v191,v191,v59
v_mfma_f32_16x16x32_bf16 v[32:35],a[232:235],v[116:119],v[32:35]
s_add_u32 s55,s55,32768
s_and_b32 s55,s55,0x1ffff
v_add_u32 v4,s55,v8
v_mfma_f32_16x16x32_bf16 v[36:39],a[236:239],v[116:119],v[36:39]
s_waitcnt lgkmcnt(1)
v_add_u32 v5,s55,v9
v_add_u32 v6,s55,v10
v_mfma_f32_16x16x32_bf16 v[32:35],a[240:243],v[120:123],v[32:35]
v_add_u32 v7,s55,v11
v_mfma_f32_16x16x32_bf16 v[36:39],a[244:247],v[120:123],v[36:39]
s_waitcnt lgkmcnt(0)
s_waitcnt vmcnt(10)
ds_read_b128 v[64:67],v4 offset:0
v_mfma_f32_16x16x32_bf16 v[40:43],a[248:251],v[124:127],v[32:35]
s_waitcnt vmcnt(9)
ds_read_b128 v[68:71],v4 offset:1024
v_mfma_f32_16x16x32_bf16 v[44:47],a[252:255],v[124:127],v[36:39]
s_waitcnt vmcnt(2)
v_cmp_gt_u32 vcc,s53,v16
ds_read_b128 v[72:75],v4 offset:2048
s_add_u32 s60,s60,1
s_cbranch_vccz WR_318
WN_319:
s_waitcnt lgkmcnt(2)
v_mfma_f32_16x16x32_bf16 v[32:35],a[0:3],v[64:67],0
s_waitcnt vmcnt(6)
s_add_u32 s71,s60,2
ds_read_b128 v[76:79],v4 offset:3072
v_mfma_f32_16x16x32_bf16 v[36:39],a[4:7],v[64:67],0
s_add_u32 s53,s60,3
s_mov_b32 s57,s63
v_mfma_f32_16x16x32_bf16 v[48:51],v[12:15],v[64:67],0
v_fma_f32 v40,v152,v188,v40
v_fma_f32 v41,v153,v188,v41
v_mul_f32 v168,v40,v40
v_mfma_f32_16x16x32_bf16 v[52:55],v[64:67],v[64:67],0
s_waitcnt lgkmcnt(2)
v_mul_f32 v169,v41,v41
v_fma_f32 v168,v168,v191,v190
v_fma_f32 v169,v169,v191,v190
v_mfma_f32_16x16x32_bf16 v[32:35],a[8:11],v[68:71],v[32:35]
s_waitcnt vmcnt(5)
ds_read_b128 v[80:83],v4 offset:4096
v_mul_f32 v168,v168,v40
v_mul_f32 v169,v169,v41
v_mfma_f32_16x16x32_bf16 v[36:39],a[12:15],v[68:71],v[36:39]
v_exp_f32 v168,v168
v_fma_f32 v42,v154,v188,v42
v_mfma_f32_16x16x32_bf16 v[48:51],v[12:15],v[68:71],v[48:51]
v_exp_f32 v169,v169
v_fma_f32 v168,v168,v189,v189
v_mfma_f32_16x16x32_bf16 v[52:55],v[68:71],v[68:71],v[52:55]
s_waitcnt lgkmcnt(2)
v_rcp_f32 v168,v168
v_fma_f32 v169,v169,v189,v189
v_mfma_f32_16x16x32_bf16 v[32:35],a[16:19],v[72:75],v[32:35]
s_waitcnt vmcnt(4)
ds_read_b128 v[84:87],v4 offset:5120
v_rcp_f32 v169,v169
v_mfma_f32_16x16x32_bf16 v[36:39],a[20:23],v[72:75],v[36:39]
v_mul_f32 v40,v168,v40
v_mul_f32 v41,v169,v41
v_fma_f32 v43,v155,v188,v43
v_mfma_f32_16x16x32_bf16 v[48:51],v[12:15],v[72:75],v[48:51]
v_mul_f32 v170,v42,v42
v_mul_f32 v171,v43,v43
v_mfma_f32_16x16x32_bf16 v[52:55],v[72:75],v[72:75],v[52:55]
s_waitcnt lgkmcnt(2)
v_fma_f32 v170,v170,v191,v190
v_fma_f32 v171,v171,v191,v190
v_mfma_f32_16x16x32_bf16 v[32:35],a[24:27],v[76:79],v[32:35]
s_waitcnt vmcnt(3)
ds_read_b128 v[88:91],v4 offset:6144
v_mul_f32 v170,v170,v42
v_mfma_f32_16x16x32_bf16 v[36:39],a[28:31],v[76:79],v[36:39]
v_exp_f32 v170,v170
v_mfma_f32_16x16x32_bf16 v[48:51],v[12:15],v[76:79],v[48:51]
v_mul_f32 v171,v171,v43
v_fma_f32 v170,v170,v189,v189
v_mfma_f32_16x16x32_bf16 v[52:55],v[76:79],v[76:79],v[52:55]
s_waitcnt lgkmcnt(2)
v_exp_f32 v171,v171
v_mfma_f32_16x16x32_bf16 v[32:35],a[32:35],v[80:83],v[32:35]
s_waitcnt vmcnt(1)
ds_read_b128 v[92:95],v4 offset:7168
v_fma_f32 v171,v171,v189,v189
v_mfma_f32_16x16x32_bf16 v[36:39],a[36:39],v[80:83],v[36:39]
s_barrier
ds_read_b128 v[96:99],v5 offset:0
v_fma_f32 v44,v156,v188,v44
v_mfma_f32_16x16x32_bf16 v[48:51],v[12:15],v[80:83],v[48:51]
ds_read_b128 v[100:103],v5 offset:1024
v_fma_f32 v45,v157,v188,v45
v_mfma_f32_16x16x32_bf16 v[52:55],v[80:83],v[80:83],v[52:55]
s_waitcnt lgkmcnt(4)
ds_read_b128 v[104:107],v5 offset:2048
v_mul_f32 v172,v44,v44
v_mfma_f32_16x16x32_bf16 v[32:35],a[40:43],v[84:87],v[32:35]
ds_read_b128 v[108:111],v5 offset:3072
v_mul_f32 v173,v45,v45
v_mfma_f32_16x16x32_bf16 v[36:39],a[44:47],v[84:87],v[36:39]
s_waitcnt vmcnt(0)
v_mov_b32 v17,s57
buffer_store_dword v17,v26,s[20:23],s69 offen
v_mfma_f32_16x16x32_bf16 v[48:51],v[12:15],v[84:87],v[48:51]
v_rcp_f32 v170,v170
v_mfma_f32_16x16x32_bf16 v[52:55],v[84:87],v[84:87],v[52:55]
s_waitcnt lgkmcnt(5)
v_rcp_f32 v171,v171
v_mfma_f32_16x16x32_bf16 v[32:35],a[48:51],v[88:91],v[32:35]
ds_read_b128 v[112:115],v5 offset:4096
v_mul_f32 v42,v170,v42
v_mfma_f32_16x16x32_bf16 v[36:39],a[52:55],v[88:91],v[36:39]
v_mul_f32 v43,v171,v43
v_fma_f32 v172,v172,v191,v190
v_mfma_f32_16x16x32_bf16 v[48:51],v[12:15],v[88:91],v[48:51]
v_fma_f32 v173,v173,v191,v190
v_mul_f32 v172,v172,v44
v_mfma_f32_16x16x32_bf16 v[52:55],v[88:91],v[88:91],v[52:55]
s_waitcnt lgkmcnt(5)
v_exp_f32 v172,v172
v_mfma_f32_16x16x32_bf16 v[32:35],a[56:59],v[92:95],v[32:35]
ds_read_b128 v[116:119],v5 offset:5120
v_mul_f32 v173,v173,v45
v_mfma_f32_16x16x32_bf16 v[36:39],a[60:63],v[92:95],v[36:39]
v_exp_f32 v173,v173
v_mfma_f32_16x16x32_bf16 v[48:51],v[12:15],v[92:95],v[48:51]
v_fma_f32 v172,v172,v189,v189
v_fma_f32 v173,v173,v189,v189
v_mfma_f32_16x16x32_bf16 v[52:55],v[92:95],v[92:95],v[52:55]
s_waitcnt lgkmcnt(5)
v_rcp_f32 v172,v172
v_mfma_f32_16x16x32_bf16 v[32:35],a[64:67],v[96:99],v[32:35]
ds_read_b128 v[120:123],v5 offset:6144
v_mul_f32 v44,v172,v44
v_mfma_f32_16x16x32_bf16 v[36:39],a[68:71],v[96:99],v[36:39]
s_waitcnt lgkmcnt(5)
v_rcp_f32 v173,v173
v_mfma_f32_16x16x32_bf16 v[32:35],a[72:75],v[100:103],v[32:35]
ds_read_b128 v[124:127],v5 offset:7168
v_mul_f32 v45,v173,v45
v_mfma_f32_16x16x32_bf16 v[36:39],a[76:79],v[100:103],v[36:39]
s_waitcnt lgkmcnt(5)
v_fma_f32 v46,v158,v188,v46
v_fma_f32 v47,v159,v188,v47
v_mfma_f32_16x16x32_bf16 v[32:35],a[80:83],v[104:107],v[32:35]
ds_read_b128 v[64:67],v6 offset:0
v_cndmask_b32 v49,v52,v53,s[74:75]
v_mfma_f32_16x16x32_bf16 v[36:39],a[84:87],v[104:107],v[36:39]
s_waitcnt lgkmcnt(5)
v_cndmask_b32 v49,v49,v54,s[76:77]
v_cndmask_b32 v49,v49,v55,s[78:79]
v_mfma_f32_16x16x32_bf16 v[32:35],a[88:91],v[108:111],v[32:35]
ds_read_b128 v[68:71],v6 offset:1024
v_mul_f32 v174,v46,v46
v_mfma_f32_16x16x32_bf16 v[36:39],a[92:95],v[108:111],v[36:39]
s_waitcnt lgkmcnt(5)
ds_write_b64 v19,v[48:49]
v_mfma_f32_16x16x32_bf16 v[32:35],a[96:99],v[112:115],v[32:35]
ds_read_b128 v[72:75],v6 offset:2048
v_mul_f32 v175,v47,v47
v_mfma_f32_16x16x32_bf16 v[36:39],a[100:103],v[112:115],v[36:39]
s_waitcnt lgkmcnt(6)
v_fma_f32 v174,v174,v191,v190
v_fma_f32 v175,v175,v191,v190
v_mfma_f32_16x16x32_bf16 v[32:35],a[104:107],v[116:119],v[32:35]
ds_read_b128 v[76:79],v6 offset:3072
v_mul_f32 v174,v174,v46
v_mfma_f32_16x16x32_bf16 v[36:39],a[108:111],v[116:119],v[36:39]
s_waitcnt lgkmcnt(6)
v_exp_f32 v174,v174
v_mfma_f32_16x16x32_bf16 v[32:35],a[112:115],v[120:123],v[32:35]
s_waitcnt lgkmcnt(2)
s_barrier
ds_read_b128 v[80:83],v6 offset:4096
v_mfma_f32_16x16x32_bf16 v[36:39],a[116:119],v[120:123],v[36:39]
ds_read_b64 v[56:57],v20 offset:0
v_mul_f32 v175,v175,v47
v_mfma_f32_16x16x32_bf16 v[32:35],a[120:123],v[124:127],v[32:35]
ds_read_b128 v[84:87],v6 offset:5120
v_fma_f32 v174,v174,v189,v189
v_mfma_f32_16x16x32_bf16 v[36:39],a[124:127],v[124:127],v[36:39]
ds_read_b64 v[58:59],v20 offset:512
v_cvt_pk_bf16_f32 v176,v40,v41
v_mfma_f32_16x16x32_bf16 v[32:35],a[128:131],v[64:67],v[32:35]
ds_read_b128 v[88:91],v6 offset:6144
v_cvt_pk_bf16_f32 v177,v42,v43
v_mfma_f32_16x16x32_bf16 v[36:39],a[132:135],v[64:67],v[36:39]
ds_read_b64 v[60:61],v20 offset:1024
v_cvt_pk_bf16_f32 v178,v44,v45
v_mfma_f32_16x16x32_bf16 v[32:35],a[136:139],v[68:71],v[32:35]
ds_read_b128 v[92:95],v6 offset:7168
v_mfma_f32_16x16x32_bf16 v[36:39],a[140:143],v[68:71],v[36:39]
s_waitcnt lgkmcnt(8)
ds_read_b64 v[62:63],v20 offset:1536
v_mfma_f32_16x16x32_bf16 v[32:35],a[144:147],v[72:75],v[32:35]
ds_read_b128 v[96:99],v7 offset:0
v_mfma_f32_16x16x32_bf16 v[36:39],a[148:151],v[72:75],v[36:39]
s_waitcnt lgkmcnt(9)
buffer_load_dword v16,v2,s[20:23],s68 offen sc1
v_mfma_f32_16x16x32_bf16 v[32:35],a[152:155],v[76:79],v[32:35]
ds_read_b128 v[100:103],v7 offset:1024
v_mfma_f32_16x16x32_bf16 v[36:39],a[156:159],v[76:79],v[36:39]
s_waitcnt lgkmcnt(9)
v_exp_f32 v175,v175
v_mfma_f32_16x16x32_bf16 v[32:35],a[160:163],v[80:83],v[32:35]
ds_read_b128 v[104:107],v7 offset:2048
v_fma_f32 v175,v175,v189,v189
v_mfma_f32_16x16x32_bf16 v[36:39],a[164:167],v[80:83],v[36:39]
s_waitcnt lgkmcnt(8)
s_waitcnt lgkmcnt(3)
v_rcp_f32 v174,v174
v_mfma_f32_16x16x32_bf16 v[32:35],a[168:171],v[84:87],v[32:35]
ds_read_b128 v[108:111],v7 offset:3072
v_mul_f32 v46,v174,v46
v_mfma_f32_16x16x32_bf16 v[36:39],a[172:175],v[84:87],v[36:39]
v_rcp_f32 v175,v175
v_mfma_f32_16x16x32_bf16 v[32:35],a[176:179],v[88:91],v[32:35]
ds_read_b128 v[112:115],v7 offset:4096
v_mul_f32 v47,v175,v47
v_mfma_f32_16x16x32_bf16 v[36:39],a[180:183],v[88:91],v[36:39]
v_cvt_pk_bf16_f32 v179,v46,v47
v_add_f32 v56,v56,v58
v_mfma_f32_16x16x32_bf16 v[32:35],a[184:187],v[92:95],v[32:35]
ds_read_b128 v[116:119],v7 offset:5120
v_add_f32 v57,v57,v59
v_mfma_f32_16x16x32_bf16 v[36:39],a[188:191],v[92:95],v[36:39]
s_waitcnt lgkmcnt(5)
buffer_store_dwordx4 v[176:179],v0,s[20:23],s66 offen sc1
v_mfma_f32_16x16x32_bf16 v[32:35],a[192:195],v[96:99],v[32:35]
s_add_u32 s66,s66,32768
s_add_u32 s63,s63,1
ds_read_b128 v[120:123],v7 offset:6144
v_mfma_f32_16x16x32_bf16 v[36:39],a[196:199],v[96:99],v[36:39]
s_waitcnt lgkmcnt(5)
v_add_f32 v60,v60,v62
v_add_f32 v61,v61,v63
v_mfma_f32_16x16x32_bf16 v[32:35],a[200:203],v[100:103],v[32:35]
ds_read_b128 v[124:127],v7 offset:7168
v_add_f32 v56,v56,v60
v_mfma_f32_16x16x32_bf16 v[36:39],a[204:207],v[100:103],v[36:39]
s_waitcnt lgkmcnt(5)
v_add_f32 v57,v57,v61
v_mul_f32 v188,0xba800000,v56
v_mfma_f32_16x16x32_bf16 v[32:35],a[208:211],v[104:107],v[32:35]
s_add_u32 s55,s55,32768
v_fma_f32 v58,v188,v188,-v210
v_fma_f32 v57,v57,v211,-v58
v_mfma_f32_16x16x32_bf16 v[36:39],a[212:215],v[104:107],v[36:39]
s_waitcnt lgkmcnt(4)
s_and_b32 s55,s55,0x1ffff
v_max_f32 v57,v210,v57
v_mfma_f32_16x16x32_bf16 v[32:35],a[216:219],v[108:111],v[32:35]
v_rsq_f32 v58,v57
v_mfma_f32_16x16x32_bf16 v[36:39],a[220:223],v[108:111],v[36:39]
s_waitcnt lgkmcnt(3)
v_mul_f32 v189,v57,v58
v_mul_f32 v190,v209,v58
v_mfma_f32_16x16x32_bf16 v[32:35],a[224:227],v[112:115],v[32:35]
v_mul_f32 v59,v58,v58
v_mul_f32 v191,v208,v58
v_mfma_f32_16x16x32_bf16 v[36:39],a[228:231],v[112:115],v[36:39]
s_waitcnt lgkmcnt(2)
v_mul_f32 v191,v191,v59
v_add_u32 v4,s55,v8
v_mfma_f32_16x16x32_bf16 v[32:35],a[232:235],v[116:119],v[32:35]
v_add_u32 v5,s55,v9
v_add_u32 v6,s55,v10
v_mfma_f32_16x16x32_bf16 v[36:39],a[236:239],v[116:119],v[36:39]
s_waitcnt lgkmcnt(1)
v_add_u32 v7,s55,v11
v_mfma_f32_16x16x32_bf16 v[32:35],a[240:243],v[120:123],v[32:35]
v_mfma_f32_16x16x32_bf16 v[36:39],a[244:247],v[120:123],v[36:39]
s_waitcnt lgkmcnt(0)
v_mfma_f32_16x16x32_bf16 v[40:43],a[248:251],v[124:127],v[32:35]
v_mfma_f32_16x16x32_bf16 v[44:47],a[252:255],v[124:127],v[36:39]
s_waitcnt vmcnt(1)
v_cmp_gt_u32 vcc,s71,v16
s_add_u32 s60,s60,1
s_branch endN_327
BN_321:
s_waitcnt vmcnt(9)
ds_read_b128 v[64:67],v4 offset:0
s_waitcnt vmcnt(8)
ds_read_b128 v[68:71],v4 offset:1024
s_waitcnt vmcnt(7)
ds_read_b128 v[72:75],v4 offset:2048
s_waitcnt vmcnt(6)
ds_read_b128 v[76:79],v4 offset:3072
s_waitcnt lgkmcnt(3)
v_mfma_f32_16x16x32_bf16 v[32:35],a[0:3],v[64:67],0
s_add_u32 s71,s60,2
s_add_u32 s53,s60,3
s_mov_b32 s57,s63
v_mfma_f32_16x16x32_bf16 v[36:39],a[4:7],v[64:67],0
v_mfma_f32_16x16x32_bf16 v[48:51],v[12:15],v[64:67],0
v_mfma_f32_16x16x32_bf16 v[52:55],v[64:67],v[64:67],0
s_waitcnt lgkmcnt(2)
s_waitcnt vmcnt(5)
ds_read_b128 v[80:83],v4 offset:4096
v_mfma_f32_16x16x32_bf16 v[32:35],a[8:11],v[68:71],v[32:35]
v_mfma_f32_16x16x32_bf16 v[36:39],a[12:15],v[68:71],v[36:39]
v_mfma_f32_16x16x32_bf16 v[48:51],v[12:15],v[68:71],v[48:51]
v_mfma_f32_16x16x32_bf16 v[52:55],v[68:71],v[68:71],v[52:55]
s_waitcnt lgkmcnt(2)
s_waitcnt vmcnt(4)
ds_read_b128 v[84:87],v4 offset:5120
v_mfma_f32_16x16x32_bf16 v[32:35],a[16:19],v[72:75],v[32:35]
v_mfma_f32_16x16x32_bf16 v[36:39],a[20:23],v[72:75],v[36:39]
v_mfma_f32_16x16x32_bf16 v[48:51],v[12:15],v[72:75],v[48:51]
v_mfma_f32_16x16x32_bf16 v[52:55],v[72:75],v[72:75],v[52:55]
s_waitcnt lgkmcnt(2)
s_waitcnt vmcnt(3)
ds_read_b128 v[88:91],v4 offset:6144
v_mfma_f32_16x16x32_bf16 v[32:35],a[24:27],v[76:79],v[32:35]
v_mfma_f32_16x16x32_bf16 v[36:39],a[28:31],v[76:79],v[36:39]
v_mfma_f32_16x16x32_bf16 v[48:51],v[12:15],v[76:79],v[48:51]
v_mfma_f32_16x16x32_bf16 v[52:55],v[76:79],v[76:79],v[52:55]
s_waitcnt lgkmcnt(2)
s_waitcnt vmcnt(2)
ds_read_b128 v[92:95],v4 offset:7168
v_mfma_f32_16x16x32_bf16 v[32:35],a[32:35],v[80:83],v[32:35]
v_mfma_f32_16x16x32_bf16 v[36:39],a[36:39],v[80:83],v[36:39]
v_mfma_f32_16x16x32_bf16 v[48:51],v[12:15],v[80:83],v[48:51]
v_mfma_f32_16x16x32_bf16 v[52:55],v[80:83],v[80:83],v[52:55]
s_waitcnt lgkmcnt(2)
s_barrier
ds_read_b128 v[96:99],v5 offset:0
v_mfma_f32_16x16x32_bf16 v[32:35],a[40:43],v[84:87],v[32:35]
ds_read_b128 v[100:103],v5 offset:1024
v_mfma_f32_16x16x32_bf16 v[36:39],a[44:47],v[84:87],v[36:39]
ds_read_b128 v[104:107],v5 offset:2048
v_mfma_f32_16x16x32_bf16 v[48:51],v[12:15],v[84:87],v[48:51]
ds_read_b128 v[108:111],v5 offset:3072
v_mfma_f32_16x16x32_bf16 v[52:55],v[84:87],v[84:87],v[52:55]
s_waitcnt lgkmcnt(5)
v_mfma_f32_16x16x32_bf16 v[32:35],a[48:51],v[88:91],v[32:35]
ds_read_b128 v[112:115],v5 offset:4096
v_mfma_f32_16x16x32_bf16 v[36:39],a[52:55],v[88:91],v[36:39]
v_mfma_f32_16x16x32_bf16 v[48:51],v[12:15],v[88:91],v[48:51]
v_mfma_f32_16x16x32_bf16 v[52:55],v[88:91],v[88:91],v[52:55]
s_waitcnt lgkmcnt(5)
v_mfma_f32_16x16x32_bf16 v[32:35],a[56:59],v[92:95],v[32:35]
ds_read_b128 v[116:119],v5 offset:5120
v_mfma_f32_16x16x32_bf16 v[36:39],a[60:63],v[92:95],v[36:39]
v_mfma_f32_16x16x32_bf16 v[48:51],v[12:15],v[92:95],v[48:51]
v_mfma_f32_16x16x32_bf16 v[52:55],v[92:95],v[92:95],v[52:55]
s_waitcnt lgkmcnt(5)
v_mfma_f32_16x16x32_bf16 v[32:35],a[64:67],v[96:99],v[32:35]
ds_read_b128 v[120:123],v5 offset:6144
v_mfma_f32_16x16x32_bf16 v[36:39],a[68:71],v[96:99],v[36:39]
s_waitcnt lgkmcnt(5)
v_mfma_f32_16x16x32_bf16 v[32:35],a[72:75],v[100:103],v[32:35]
ds_read_b128 v[124:127],v5 offset:7168
v_mfma_f32_16x16x32_bf16 v[36:39],a[76:79],v[100:103],v[36:39]
s_waitcnt lgkmcnt(5)
v_mfma_f32_16x16x32_bf16 v[32:35],a[80:83],v[104:107],v[32:35]
ds_read_b128 v[64:67],v6 offset:0
v_cndmask_b32 v49,v52,v53,s[74:75]
v_mfma_f32_16x16x32_bf16 v[36:39],a[84:87],v[104:107],v[36:39]
s_waitcnt lgkmcnt(5)
v_cndmask_b32 v49,v49,v54,s[76:77]
v_cndmask_b32 v49,v49,v55,s[78:79]
v_mfma_f32_16x16x32_bf16 v[32:35],a[88:91],v[108:111],v[32:35]
ds_read_b128 v[68:71],v6 offset:1024
v_mfma_f32_16x16x32_bf16 v[36:39],a[92:95],v[108:111],v[36:39]
s_waitcnt lgkmcnt(5)
ds_write_b64 v19,v[48:49]
v_mfma_f32_16x16x32_bf16 v[32:35],a[96:99],v[112:115],v[32:35]
ds_read_b128 v[72:75],v6 offset:2048
v_mfma_f32_16x16x32_bf16 v[36:39],a[100:103],v[112:115],v[36:39]
s_waitcnt lgkmcnt(6)
v_mfma_f32_16x16x32_bf16 v[32:35],a[104:107],v[116:119],v[32:35]
ds_read_b128 v[76:79],v6 offset:3072
v_mfma_f32_16x16x32_bf16 v[36:39],a[108:111],v[116:119],v[36:39]
s_waitcnt lgkmcnt(6)
v_mfma_f32_16x16x32_bf16 v[32:35],a[112:115],v[120:123],v[32:35]
s_waitcnt lgkmcnt(2)
s_barrier
ds_read_b128 v[80:83],v6 offset:4096
v_mfma_f32_16x16x32_bf16 v[36:39],a[116:119],v[120:123],v[36:39]
ds_read_b64 v[56:57],v20 offset:0
v_mfma_f32_16x16x32_bf16 v[32:35],a[120:123],v[124:127],v[32:35]
ds_read_b128 v[84:87],v6 offset:5120
v_mfma_f32_16x16x32_bf16 v[36:39],a[124:127],v[124:127],v[36:39]
ds_read_b64 v[58:59],v20 offset:512
v_mfma_f32_16x16x32_bf16 v[32:35],a[128:131],v[64:67],v[32:35]
ds_read_b128 v[88:91],v6 offset:6144
v_mfma_f32_16x16x32_bf16 v[36:39],a[132:135],v[64:67],v[36:39]
ds_read_b64 v[60:61],v20 offset:1024
v_mfma_f32_16x16x32_bf16 v[32:35],a[136:139],v[68:71],v[32:35]
ds_read_b128 v[92:95],v6 offset:7168
v_mfma_f32_16x16x32_bf16 v[36:39],a[140:143],v[68:71],v[36:39]
s_waitcnt lgkmcnt(8)
ds_read_b64 v[62:63],v20 offset:1536
v_mfma_f32_16x16x32_bf16 v[32:35],a[144:147],v[72:75],v[32:35]
ds_read_b128 v[96:99],v7 offset:0
v_mfma_f32_16x16x32_bf16 v[36:39],a[148:151],v[72:75],v[36:39]
s_waitcnt lgkmcnt(9)
buffer_load_dword v16,v2,s[20:23],s68 offen sc1
v_mfma_f32_16x16x32_bf16 v[32:35],a[152:155],v[76:79],v[32:35]
ds_read_b128 v[100:103],v7 offset:1024
v_mfma_f32_16x16x32_bf16 v[36:39],a[156:159],v[76:79],v[36:39]
s_waitcnt lgkmcnt(9)
s_waitcnt vmcnt(2)
v_mov_b32 v17,s57
buffer_store_dword v17,v26,s[20:23],s69 offen
v_mfma_f32_16x16x32_bf16 v[32:35],a[160:163],v[80:83],v[32:35]
ds_read_b128 v[104:107],v7 offset:2048
v_mfma_f32_16x16x32_bf16 v[36:39],a[164:167],v[80:83],v[36:39]
s_waitcnt lgkmcnt(8)
s_waitcnt lgkmcnt(3)
v_add_f32 v56,v56,v58
v_mfma_f32_16x16x32_bf16 v[32:35],a[168:171],v[84:87],v[32:35]
ds_read_b128 v[108:111],v7 offset:3072
v_add_f32 v57,v57,v59
v_mfma_f32_16x16x32_bf16 v[36:39],a[172:175],v[84:87],v[36:39]
v_add_f32 v60,v60,v62
v_add_f32 v61,v61,v63
v_mfma_f32_16x16x32_bf16 v[32:35],a[176:179],v[88:91],v[32:35]
ds_read_b128 v[112:115],v7 offset:4096
v_add_f32 v56,v56,v60
v_mfma_f32_16x16x32_bf16 v[36:39],a[180:183],v[88:91],v[36:39]
v_add_f32 v57,v57,v61
v_mul_f32 v188,0xba800000,v56
v_mfma_f32_16x16x32_bf16 v[32:35],a[184:187],v[92:95],v[32:35]
ds_read_b128 v[116:119],v7 offset:5120
v_fma_f32 v58,v188,v188,-v210
v_mfma_f32_16x16x32_bf16 v[36:39],a[188:191],v[92:95],v[36:39]
s_waitcnt lgkmcnt(5)
v_fma_f32 v57,v57,v211,-v58
v_max_f32 v57,v210,v57
v_mfma_f32_16x16x32_bf16 v[32:35],a[192:195],v[96:99],v[32:35]
ds_read_b128 v[120:123],v7 offset:6144
v_mfma_f32_16x16x32_bf16 v[36:39],a[196:199],v[96:99],v[36:39]
s_waitcnt lgkmcnt(5)
v_rsq_f32 v58,v57
v_mfma_f32_16x16x32_bf16 v[32:35],a[200:203],v[100:103],v[32:35]
ds_read_b128 v[124:127],v7 offset:7168
v_mul_f32 v189,v57,v58
v_mfma_f32_16x16x32_bf16 v[36:39],a[204:207],v[100:103],v[36:39]
s_waitcnt lgkmcnt(5)
v_mul_f32 v190,v209,v58
v_mul_f32 v59,v58,v58
v_mfma_f32_16x16x32_bf16 v[32:35],a[208:211],v[104:107],v[32:35]
s_add_u32 s55,s55,32768
v_mul_f32 v191,v208,v58
v_mul_f32 v191,v191,v59
v_mfma_f32_16x16x32_bf16 v[36:39],a[212:215],v[104:107],v[36:39]
s_waitcnt lgkmcnt(4)
s_and_b32 s55,s55,0x1ffff
v_add_u32 v4,s55,v8
v_mfma_f32_16x16x32_bf16 v[32:35],a[216:219],v[108:111],v[32:35]
v_add_u32 v5,s55,v9
v_add_u32 v6,s55,v10
v_mfma_f32_16x16x32_bf16 v[36:39],a[220:223],v[108:111],v[36:39]
s_waitcnt lgkmcnt(3)
v_add_u32 v7,s55,v11
v_mfma_f32_16x16x32_bf16 v[32:35],a[224:227],v[112:115],v[32:35]
v_mfma_f32_16x16x32_bf16 v[36:39],a[228:231],v[112:115],v[36:39]
s_waitcnt lgkmcnt(2)
v_mfma_f32_16x16x32_bf16 v[32:35],a[232:235],v[116:119],v[32:35]
v_mfma_f32_16x16x32_bf16 v[36:39],a[236:239],v[116:119],v[36:39]
s_waitcnt lgkmcnt(1)
v_mfma_f32_16x16x32_bf16 v[32:35],a[240:243],v[120:123],v[32:35]
v_mfma_f32_16x16x32_bf16 v[36:39],a[244:247],v[120:123],v[36:39]
s_waitcnt lgkmcnt(0)
v_mfma_f32_16x16x32_bf16 v[40:43],a[248:251],v[124:127],v[32:35]
v_mfma_f32_16x16x32_bf16 v[44:47],a[252:255],v[124:127],v[36:39]
s_waitcnt vmcnt(1)
v_cmp_gt_u32 vcc,s71,v16
s_add_u32 s60,s60,1
endN_327:
s_cbranch_vccnz nb_324
s_mov_b32 m0,s70
s_nop 0
buffer_load_dwordx4 v3,s[20:23],s61 offen offset:0 lds
buffer_load_dwordx4 v3,s[20:23],s61 offen offset:1024 lds
buffer_load_dwordx4 v3,s[20:23],s61 offen offset:2048 lds
buffer_load_dwordx4 v3,s[20:23],s61 offen offset:3072 lds
s_add_u32 m0,s70,4096
s_nop 0
buffer_load_dwordx4 v3,s[20:23],s62 offen offset:0 lds
buffer_load_dwordx4 v3,s[20:23],s62 offen offset:1024 lds
buffer_load_dwordx4 v3,s[20:23],s62 offen offset:2048 lds
buffer_load_dwordx4 v3,s[20:23],s62 offen offset:3072 lds
s_add_u32 s61,s61,32768
s_add_u32 s62,s62,32768
s_add_u32 s70,s70,32768
s_and_b32 s70,s70,0x1ffff
s_mov_b32 s57,s63
v_pk_fma_f32 v[40:41],v[152:153],v[188:189],v[40:41] op_sel_hi:[1,0,1]
v_pk_fma_f32 v[42:43],v[154:155],v[188:189],v[42:43] op_sel_hi:[1,0,1]
v_pk_fma_f32 v[44:45],v[156:157],v[188:189],v[44:45] op_sel_hi:[1,0,1]
v_pk_fma_f32 v[46:47],v[158:159],v[188:189],v[46:47] op_sel_hi:[1,0,1]
v_pk_mul_f32 v[168:169],v[40:41],v[40:41]
v_pk_mul_f32 v[170:171],v[42:43],v[42:43]
v_pk_mul_f32 v[172:173],v[44:45],v[44:45]
v_pk_mul_f32 v[174:175],v[46:47],v[46:47]
v_pk_fma_f32 v[168:169],v[168:169],v[190:191],v[190:191] op_sel:[0,1,0] op_sel_hi:[1,1,0]
v_pk_fma_f32 v[170:171],v[170:171],v[190:191],v[190:191] op_sel:[0,1,0] op_sel_hi:[1,1,0]
v_pk_fma_f32 v[172:173],v[172:173],v[190:191],v[190:191] op_sel:[0,1,0] op_sel_hi:[1,1,0]
v_pk_fma_f32 v[174:175],v[174:175],v[190:191],v[190:191] op_sel:[0,1,0] op_sel_hi:[1,1,0]
v_pk_mul_f32 v[168:169],v[168:169],v[40:41]
v_pk_mul_f32 v[170:171],v[170:171],v[42:43]
v_pk_mul_f32 v[172:173],v[172:173],v[44:45]
v_pk_mul_f32 v[174:175],v[174:175],v[46:47]
v_exp_f32 v168,v168
v_exp_f32 v169,v169
v_exp_f32 v170,v170
v_exp_f32 v171,v171
v_exp_f32 v172,v172
v_exp_f32 v173,v173
v_exp_f32 v174,v174
v_exp_f32 v175,v175
v_pk_fma_f32 v[168:169],v[168:169],v[188:189],v[188:189] op_sel:[0,1,1] op_sel_hi:[1,1,1]
v_pk_fma_f32 v[170:171],v[170:171],v[188:189],v[188:189] op_sel:[0,1,1] op_sel_hi:[1,1,1]
v_pk_fma_f32 v[172:173],v[172:173],v[188:189],v[188:189] op_sel:[0,1,1] op_sel_hi:[1,1,1]
v_pk_fma_f32 v[174:175],v[174:175],v[188:189],v[188:189] op_sel:[0,1,1] op_sel_hi:[1,1,1]
v_rcp_f32 v168,v168
v_rcp_f32 v169,v169
v_rcp_f32 v170,v170
v_rcp_f32 v171,v171
v_rcp_f32 v172,v172
v_rcp_f32 v173,v173
v_rcp_f32 v174,v174
v_rcp_f32 v175,v175
v_pk_mul_f32 v[40:41],v[168:169],v[40:41]
v_pk_mul_f32 v[42:43],v[170:171],v[42:43]
v_pk_mul_f32 v[44:45],v[172:173],v[44:45]
v_pk_mul_f32 v[46:47],v[174:175],v[46:47]
v_cvt_pk_bf16_f32 v176,v40,v41
v_cvt_pk_bf16_f32 v177,v42,v43
v_cvt_pk_bf16_f32 v178,v44,v45
v_cvt_pk_bf16_f32 v179,v46,v47
buffer_store_dwordx4 v[176:179],v0,s[20:23],s66 offen sc1
s_add_u32 s66,s66,32768
s_add_u32 s63,s63,1
s_waitcnt vmcnt(9)
v_mov_b32 v17,s57
buffer_store_dword v17,v26,s[20:23],s69 offen
s_branch dec_323
nb_324:
buffer_load_dword v16,v2,s[20:23],s68 offen sc1
s_nop 3
s_mov_b32 s57,s63
v_pk_fma_f32 v[40:41],v[152:153],v[188:189],v[40:41] op_sel_hi:[1,0,1]
v_pk_fma_f32 v[42:43],v[154:155],v[188:189],v[42:43] op_sel_hi:[1,0,1]
v_pk_fma_f32 v[44:45],v[156:157],v[188:189],v[44:45] op_sel_hi:[1,0,1]
v_pk_fma_f32 v[46:47],v[158:159],v[188:189],v[46:47] op_sel_hi:[1,0,1]
v_pk_mul_f32 v[168:169],v[40:41],v[40:41]
v_pk_mul_f32 v[170:171],v[42:43],v[42:43]
v_pk_mul_f32 v[172:173],v[44:45],v[44:45]
v_pk_mul_f32 v[174:175],v[46:47],v[46:47]
v_pk_fma_f32 v[168:169],v[168:169],v[190:191],v[190:191] op_sel:[0,1,0] op_sel_hi:[1,1,0]
v_pk_fma_f32 v[170:171],v[170:171],v[190:191],v[190:191] op_sel:[0,1,0] op_sel_hi:[1,1,0]
v_pk_fma_f32 v[172:173],v[172:173],v[190:191],v[190:191] op_sel:[0,1,0] op_sel_hi:[1,1,0]
v_pk_fma_f32 v[174:175],v[174:175],v[190:191],v[190:191] op_sel:[0,1,0] op_sel_hi:[1,1,0]
v_pk_mul_f32 v[168:169],v[168:169],v[40:41]
v_pk_mul_f32 v[170:171],v[170:171],v[42:43]
v_pk_mul_f32 v[172:173],v[172:173],v[44:45]
v_pk_mul_f32 v[174:175],v[174:175],v[46:47]
v_exp_f32 v168,v168
v_exp_f32 v169,v169
v_exp_f32 v170,v170
v_exp_f32 v171,v171
v_exp_f32 v172,v172
v_exp_f32 v173,v173
v_exp_f32 v174,v174
v_exp_f32 v175,v175
v_pk_fma_f32 v[168:169],v[168:169],v[188:189],v[188:189] op_sel:[0,1,1] op_sel_hi:[1,1,1]
v_pk_fma_f32 v[170:171],v[170:171],v[188:189],v[188:189] op_sel:[0,1,1] op_sel_hi:[1,1,1]
v_pk_fma_f32 v[172:173],v[172:173],v[188:189],v[188:189] op_sel:[0,1,1] op_sel_hi:[1,1,1]
v_pk_fma_f32 v[174:175],v[174:175],v[188:189],v[188:189] op_sel:[0,1,1] op_sel_hi:[1,1,1]
v_rcp_f32 v168,v168
v_rcp_f32 v169,v169
v_rcp_f32 v170,v170
v_rcp_f32 v171,v171
v_rcp_f32 v172,v172
v_rcp_f32 v173,v173
v_rcp_f32 v174,v174
v_rcp_f32 v175,v175
v_pk_mul_f32 v[40:41],v[168:169],v[40:41]
v_pk_mul_f32 v[42:43],v[170:171],v[42:43]
v_pk_mul_f32 v[44:45],v[172:173],v[44:45]
v_pk_mul_f32 v[46:47],v[174:175],v[46:47]
v_cvt_pk_bf16_f32 v176,v40,v41
v_cvt_pk_bf16_f32 v177,v42,v43
v_cvt_pk_bf16_f32 v178,v44,v45
v_cvt_pk_bf16_f32 v179,v46,v47
buffer_store_dwordx4 v[176:179],v0,s[20:23],s66 offen sc1
s_add_u32 s66,s66,32768
s_add_u32 s63,s63,1
s_waitcnt vmcnt(2)
v_mov_b32 v17,s57
buffer_store_dword v17,v26,s[20:23],s69 offen
s_waitcnt vmcnt(2)
v_cmp_gt_u32 vcc,s71,v16
s_cbranch_vccz lag_322
s_waitcnt vmcnt(1)
v_mov_b32 v17,s63
buffer_store_dword v17,v26,s[20:23],s69 offen
s_cmp_ge_u32 s60,128
s_cbranch_scc1 done_310
plp_330:
buffer_load_dword v16,v2,s[20:23],s68 offen sc1
s_waitcnt vmcnt(0)
v_cmp_gt_u32 vcc,s71,v16
s_cbranch_vccz pok_331
s_sleep 4
s_sub_u32 s90,s90,1
s_cmp_gt_i32 s90,0
s_cbranch_scc1 plp_330
pok_331:
s_branch lag_322
lfar_317:
s_add_u32 s71,s60,1
s_add_u32 s53,s60,2
plp_339:
buffer_load_dword v16,v2,s[20:23],s68 offen sc1
s_waitcnt vmcnt(0)
v_cmp_gt_u32 vcc,s71,v16
s_cbranch_vccz pok_340
s_sleep 4
s_sub_u32 s90,s90,1
s_cmp_gt_i32 s90,0
s_cbranch_scc1 plp_339
pok_340:
lag_336:
s_mov_b32 m0,s70
s_nop 0
buffer_load_dwordx4 v3,s[20:23],s61 offen offset:0 lds
buffer_load_dwordx4 v3,s[20:23],s61 offen offset:1024 lds
buffer_load_dwordx4 v3,s[20:23],s61 offen offset:2048 lds
buffer_load_dwordx4 v3,s[20:23],s61 offen offset:3072 lds
s_add_u32 m0,s70,4096
s_nop 0
buffer_load_dwordx4 v3,s[20:23],s62 offen offset:0 lds
buffer_load_dwordx4 v3,s[20:23],s62 offen offset:1024 lds
buffer_load_dwordx4 v3,s[20:23],s62 offen offset:2048 lds
buffer_load_dwordx4 v3,s[20:23],s62 offen offset:3072 lds
s_add_u32 s61,s61,32768
s_add_u32 s62,s62,32768
s_add_u32 s70,s70,32768
s_and_b32 s70,s70,0x1ffff
buffer_load_dword v23,off,s[20:23],s66
buffer_load_dword v23,off,s[20:23],s66
dec_337:
v_cmp_gt_u32 vcc,s53,v16
s_cbranch_vccnz BN_335
BR_334:
s_waitcnt vmcnt(9)
ds_read_b128 v[64:67],v4 offset:0
s_waitcnt vmcnt(8)
ds_read_b128 v[68:71],v4 offset:1024
s_waitcnt vmcnt(7)
ds_read_b128 v[72:75],v4 offset:2048
s_waitcnt vmcnt(6)
ds_read_b128 v[76:79],v4 offset:3072
s_waitcnt lgkmcnt(3)
v_mfma_f32_16x16x32_bf16 v[32:35],a[0:3],v[64:67],0
s_add_u32 s71,s60,2
s_add_u32 s53,s60,3
s_mov_b32 s57,s63
v_mfma_f32_16x16x32_bf16 v[36:39],a[4:7],v[64:67],0
v_mfma_f32_16x16x32_bf16 v[48:51],v[12:15],v[64:67],0
v_mfma_f32_16x16x32_bf16 v[52:55],v[64:67],v[64:67],0
s_waitcnt lgkmcnt(2)
s_waitcnt vmcnt(5)
s_mov_b32 m0,s70
ds_read_b128 v[80:83],v4 offset:4096
v_mfma_f32_16x16x32_bf16 v[32:35],a[8:11],v[68:71],v[32:35]
buffer_load_dwordx4 v3,s[20:23],s61 offen offset:0 lds
v_mfma_f32_16x16x32_bf16 v[36:39],a[12:15],v[68:71],v[36:39]
v_mfma_f32_16x16x32_bf16 v[48:51],v[12:15],v[68:71],v[48:51]
v_mfma_f32_16x16x32_bf16 v[52:55],v[68:71],v[68:71],v[52:55]
s_waitcnt lgkmcnt(2)
s_waitcnt vmcnt(5)
ds_read_b128 v[84:87],v4 offset:5120
v_mfma_f32_16x16x32_bf16 v[32:35],a[16:19],v[72:75],v[32:35]
buffer_load_dwordx4 v3,s[20:23],s61 offen offset:1024 lds
v_mfma_f32_16x16x32_bf16 v[36:39],a[20:23],v[72:75],v[36:39]
v_mfma_f32_16x16x32_bf16 v[48:51],v[12:15],v[72:75],v[48:51]
v_mfma_f32_16x16x32_bf16 v[52:55],v[72:75],v[72:75],v[52:55]
s_waitcnt lgkmcnt(2)
s_waitcnt vmcnt(5)
ds_read_b128 v[88:91],v4 offset:6144
v_mfma_f32_16x16x32_bf16 v[32:35],a[24:27],v[76:79],v[32:35]
buffer_load_dwordx4 v3,s[20:23],s61 offen offset:2048 lds
v_mfma_f32_16x16x32_bf16 v[36:39],a[28:31],v[76:79],v[36:39]
v_mfma_f32_16x16x32_bf16 v[48:51],v[12:15],v[76:79],v[48:51]
v_mfma_f32_16x16x32_bf16 v[52:55],v[76:79],v[76:79],v[52:55]
s_waitcnt lgkmcnt(2)
s_waitcnt vmcnt(5)
ds_read_b128 v[92:95],v4 offset:7168
v_mfma_f32_16x16x32_bf16 v[32:35],a[32:35],v[80:83],v[32:35]
buffer_load_dwordx4 v3,s[20:23],s61 offen offset:3072 lds
v_mfma_f32_16x16x32_bf16 v[36:39],a[36:39],v[80:83],v[36:39]
v_mfma_f32_16x16x32_bf16 v[48:51],v[12:15],v[80:83],v[48:51]
v_mfma_f32_16x16x32_bf16 v[52:55],v[80:83],v[80:83],v[52:55]
s_waitcnt lgkmcnt(2)
s_barrier
ds_read_b128 v[96:99],v5 offset:0
v_mfma_f32_16x16x32_bf16 v[32:35],a[40:43],v[84:87],v[32:35]
ds_read_b128 v[100:103],v5 offset:1024
v_mfma_f32_16x16x32_bf16 v[36:39],a[44:47],v[84:87],v[36:39]
ds_read_b128 v[104:107],v5 offset:2048
v_mfma_f32_16x16x32_bf16 v[48:51],v[12:15],v[84:87],v[48:51]
s_add_u32 m0,s70,4096
ds_read_b128 v[108:111],v5 offset:3072
v_mfma_f32_16x16x32_bf16 v[52:55],v[84:87],v[84:87],v[52:55]
s_waitcnt lgkmcnt(5)
buffer_load_dwordx4 v3,s[20:23],s62 offen offset:0 lds
v_mfma_f32_16x16x32_bf16 v[32:35],a[48:51],v[88:91],v[32:35]
ds_read_b128 v[112:115],v5 offset:4096
v_mfma_f32_16x16x32_bf16 v[36:39],a[52:55],v[88:91],v[36:39]
buffer_load_dwordx4 v3,s[20:23],s62 offen offset:1024 lds
v_mfma_f32_16x16x32_bf16 v[48:51],v[12:15],v[88:91],v[48:51]
v_mfma_f32_16x16x32_bf16 v[52:55],v[88:91],v[88:91],v[52:55]
s_waitcnt lgkmcnt(5)
v_mfma_f32_16x16x32_bf16 v[32:35],a[56:59],v[92:95],v[32:35]
ds_read_b128 v[116:119],v5 offset:5120
v_mfma_f32_16x16x32_bf16 v[36:39],a[60:63],v[92:95],v[36:39]
buffer_load_dwordx4 v3,s[20:23],s62 offen offset:2048 lds
v_mfma_f32_16x16x32_bf16 v[48:51],v[12:15],v[92:95],v[48:51]
buffer_load_dword v16,v2,s[20:23],s68 offen sc1
v_mfma_f32_16x16x32_bf16 v[52:55],v[92:95],v[92:95],v[52:55]
s_waitcnt lgkmcnt(5)
v_mfma_f32_16x16x32_bf16 v[32:35],a[64:67],v[96:99],v[32:35]
ds_read_b128 v[120:123],v5 offset:6144
v_mfma_f32_16x16x32_bf16 v[36:39],a[68:71],v[96:99],v[36:39]
s_waitcnt lgkmcnt(5)
buffer_load_dwordx4 v3,s[20:23],s62 offen offset:3072 lds
v_mfma_f32_16x16x32_bf16 v[32:35],a[72:75],v[100:103],v[32:35]
ds_read_b128 v[124:127],v5 offset:7168
v_mfma_f32_16x16x32_bf16 v[36:39],a[76:79],v[100:103],v[36:39]
s_waitcnt lgkmcnt(5)
v_mfma_f32_16x16x32_bf16 v[32:35],a[80:83],v[104:107],v[32:35]
ds_read_b128 v[64:67],v6 offset:0
v_cndmask_b32 v49,v52,v53,s[74:75]
v_mfma_f32_16x16x32_bf16 v[36:39],a[84:87],v[104:107],v[36:39]
s_waitcnt lgkmcnt(5)
v_cndmask_b32 v49,v49,v54,s[76:77]
v_cndmask_b32 v49,v49,v55,s[78:79]
v_mfma_f32_16x16x32_bf16 v[32:35],a[88:91],v[108:111],v[32:35]
ds_read_b128 v[68:71],v6 offset:1024
v_mfma_f32_16x16x32_bf16 v[36:39],a[92:95],v[108:111],v[36:39]
s_waitcnt lgkmcnt(5)
ds_write_b64 v19,v[48:49]
v_mfma_f32_16x16x32_bf16 v[32:35],a[96:99],v[112:115],v[32:35]
ds_read_b128 v[72:75],v6 offset:2048
v_mfma_f32_16x16x32_bf16 v[36:39],a[100:103],v[112:115],v[36:39]
s_waitcnt lgkmcnt(6)
v_mfma_f32_16x16x32_bf16 v[32:35],a[104:107],v[116:119],v[32:35]
ds_read_b128 v[76:79],v6 offset:3072
v_mfma_f32_16x16x32_bf16 v[36:39],a[108:111],v[116:119],v[36:39]
s_waitcnt lgkmcnt(6)
v_mfma_f32_16x16x32_bf16 v[32:35],a[112:115],v[120:123],v[32:35]
s_waitcnt lgkmcnt(2)
s_barrier
ds_read_b128 v[80:83],v6 offset:4096
v_mfma_f32_16x16x32_bf16 v[36:39],a[116:119],v[120:123],v[36:39]
ds_read_b64 v[56:57],v20 offset:0
v_mfma_f32_16x16x32_bf16 v[32:35],a[120:123],v[124:127],v[32:35]
ds_read_b128 v[84:87],v6 offset:5120
v_mfma_f32_16x16x32_bf16 v[36:39],a[124:127],v[124:127],v[36:39]
ds_read_b64 v[58:59],v20 offset:512
v_mfma_f32_16x16x32_bf16 v[32:35],a[128:131],v[64:67],v[32:35]
ds_read_b128 v[88:91],v6 offset:6144
v_mfma_f32_16x16x32_bf16 v[36:39],a[132:135],v[64:67],v[36:39]
ds_read_b64 v[60:61],v20 offset:1024
v_mfma_f32_16x16x32_bf16 v[32:35],a[136:139],v[68:71],v[32:35]
ds_read_b128 v[92:95],v6 offset:7168
v_mfma_f32_16x16x32_bf16 v[36:39],a[140:143],v[68:71],v[36:39]
s_waitcnt lgkmcnt(8)
ds_read_b64 v[62:63],v20 offset:1536
v_mfma_f32_16x16x32_bf16 v[32:35],a[144:147],v[72:75],v[32:35]
ds_read_b128 v[96:99],v7 offset:0
v_mfma_f32_16x16x32_bf16 v[36:39],a[148:151],v[72:75],v[36:39]
s_waitcnt lgkmcnt(9)
s_waitcnt vmcnt(10)
v_mov_b32 v17,s57
buffer_store_dword v17,v26,s[20:23],s69 offen sc1
v_mfma_f32_16x16x32_bf16 v[32:35],a[152:155],v[76:79],v[32:35]
ds_read_b128 v[100:103],v7 offset:1024
v_mfma_f32_16x16x32_bf16 v[36:39],a[156:159],v[76:79],v[36:39]
s_waitcnt lgkmcnt(9)
v_mfma_f32_16x16x32_bf16 v[32:35],a[160:163],v[80:83],v[32:35]
ds_read_b128 v[104:107],v7 offset:2048
v_mfma_f32_16x16x32_bf16 v[36:39],a[164:167],v[80:83],v[36:39]
s_waitcnt lgkmcnt(8)
s_waitcnt lgkmcnt(3)
v_add_f32 v56,v56,v58
v_mfma_f32_16x16x32_bf16 v[32:35],a[168:171],v[84:87],v[32:35]
ds_read_b128 v[108:111],v7 offset:3072
v_add_f32 v57,v57,v59
v_mfma_f32_16x16x32_bf16 v[36:39],a[172:175],v[84:87],v[36:39]
v_add_f32 v60,v60,v62
v_add_f32 v61,v61,v63
v_mfma_f32_16x16x32_bf16 v[32:35],a[176:179],v[88:91],v[32:35]
ds_read_b128 v[112:115],v7 offset:4096
v_add_f32 v56,v56,v60
v_mfma_f32_16x16x32_bf16 v[36:39],a[180:183],v[88:91],v[36:39]
v_add_f32 v57,v57,v61
v_mul_f32 v188,0xba800000,v56
v_mfma_f32_16x16x32_bf16 v[32:35],a[184:187],v[92:95],v[32:35]
ds_read_b128 v[116:119],v7 offset:5120
v_fma_f32 v58,v188,v188,-v210
v_mfma_f32_16x16x32_bf16 v[36:39],a[188:191],v[92:95],v[36:39]
s_waitcnt lgkmcnt(5)
v_fma_f32 v57,v57,v211,-v58
v_max_f32 v57,v210,v57
v_mfma_f32_16x16x32_bf16 v[32:35],a[192:195],v[96:99],v[32:35]
ds_read_b128 v[120:123],v7 offset:6144
v_mfma_f32_16x16x32_bf16 v[36:39],a[196:199],v[96:99],v[36:39]
s_waitcnt lgkmcnt(5)
v_rsq_f32 v58,v57
v_mfma_f32_16x16x32_bf16 v[32:35],a[200:203],v[100:103],v[32:35]
ds_read_b128 v[124:127],v7 offset:7168
v_mul_f32 v189,v57,v58
v_mfma_f32_16x16x32_bf16 v[36:39],a[204:207],v[100:103],v[36:39]
s_waitcnt lgkmcnt(5)
v_mul_f32 v190,v209,v58
v_mul_f32 v59,v58,v58
v_mfma_f32_16x16x32_bf16 v[32:35],a[208:211],v[104:107],v[32:35]
s_add_u32 s61,s61,32768
v_mul_f32 v191,v208,v58
v_mul_f32 v191,v191,v59
v_mfma_f32_16x16x32_bf16 v[36:39],a[212:215],v[104:107],v[36:39]
s_waitcnt lgkmcnt(4)
s_add_u32 s62,s62,32768
s_add_u32 s70,s70,32768
v_mfma_f32_16x16x32_bf16 v[32:35],a[216:219],v[108:111],v[32:35]
s_and_b32 s70,s70,0x1ffff
s_add_u32 s55,s55,32768
s_and_b32 s55,s55,0x1ffff
v_mfma_f32_16x16x32_bf16 v[36:39],a[220:223],v[108:111],v[36:39]
s_waitcnt lgkmcnt(3)
v_add_u32 v4,s55,v8
v_add_u32 v5,s55,v9
v_mfma_f32_16x16x32_bf16 v[32:35],a[224:227],v[112:115],v[32:35]
v_add_u32 v6,s55,v10
v_add_u32 v7,s55,v11
v_mfma_f32_16x16x32_bf16 v[36:39],a[228:231],v[112:115],v[36:39]
s_waitcnt lgkmcnt(2)
s_waitcnt vmcnt(9)
ds_read_b128 v[64:67],v4 offset:0
v_mfma_f32_16x16x32_bf16 v[32:35],a[232:235],v[116:119],v[32:35]
s_waitcnt vmcnt(8)
ds_read_b128 v[68:71],v4 offset:1024
v_mfma_f32_16x16x32_bf16 v[36:39],a[236:239],v[116:119],v[36:39]
s_waitcnt lgkmcnt(3)
s_waitcnt vmcnt(7)
ds_read_b128 v[72:75],v4 offset:2048
v_mfma_f32_16x16x32_bf16 v[32:35],a[240:243],v[120:123],v[32:35]
v_mfma_f32_16x16x32_bf16 v[36:39],a[244:247],v[120:123],v[36:39]
s_waitcnt lgkmcnt(3)
v_mfma_f32_16x16x32_bf16 v[40:43],a[248:251],v[124:127],v[32:35]
v_mfma_f32_16x16x32_bf16 v[44:47],a[252:255],v[124:127],v[36:39]
s_waitcnt vmcnt(2)
v_cmp_gt_u32 vcc,s53,v16
s_add_u32 s60,s60,1
s_cbranch_vccnz WN_333
.p2align 6
WR_332:
s_waitcnt lgkmcnt(2)
v_mfma_f32_16x16x32_bf16 v[32:35],a[0:3],v[64:67],0
s_waitcnt vmcnt(6)
s_add_u32 s71,s60,2
ds_read_b128 v[76:79],v4 offset:3072
v_mfma_f32_16x16x32_bf16 v[36:39],a[4:7],v[64:67],0
s_add_u32 s53,s60,3
s_mov_b32 s57,s63
v_mfma_f32_16x16x32_bf16 v[48:51],v[12:15],v[64:67],0
s_mov_b32 m0,s70
v_fma_f32 v40,v152,v188,v40
v_fma_f32 v41,v153,v188,v41
v_mul_f32 v168,v40,v40
v_mfma_f32_16x16x32_bf16 v[52:55],v[64:67],v[64:67],0
s_waitcnt lgkmcnt(2)
buffer_load_dwordx4 v3,s[20:23],s61 offen offset:0 lds
v_mul_f32 v169,v41,v41
v_fma_f32 v168,v168,v191,v190
v_mfma_f32_16x16x32_bf16 v[32:35],a[8:11],v[68:71],v[32:35]
s_waitcnt vmcnt(6)
ds_read_b128 v[80:83],v4 offset:4096
v_fma_f32 v169,v169,v191,v190
v_mul_f32 v168,v168,v40
v_mfma_f32_16x16x32_bf16 v[36:39],a[12:15],v[68:71],v[36:39]
v_exp_f32 v168,v168
v_mul_f32 v169,v169,v41
v_mfma_f32_16x16x32_bf16 v[48:51],v[12:15],v[68:71],v[48:51]
v_exp_f32 v169,v169
v_fma_f32 v168,v168,v189,v189
v_mfma_f32_16x16x32_bf16 v[52:55],v[68:71],v[68:71],v[52:55]
s_waitcnt lgkmcnt(2)
buffer_load_dwordx4 v3,s[20:23],s61 offen offset:1024 lds
v_rcp_f32 v168,v168
v_mfma_f32_16x16x32_bf16 v[32:35],a[16:19],v[72:75],v[32:35]
s_waitcnt vmcnt(6)
ds_read_b128 v[84:87],v4 offset:5120
v_fma_f32 v169,v169,v189,v189
v_mul_f32 v40,v168,v40
v_mfma_f32_16x16x32_bf16 v[36:39],a[20:23],v[72:75],v[36:39]
v_rcp_f32 v169,v169
v_fma_f32 v42,v154,v188,v42
v_mfma_f32_16x16x32_bf16 v[48:51],v[12:15],v[72:75],v[48:51]
v_mul_f32 v41,v169,v41
v_fma_f32 v43,v155,v188,v43
v_mul_f32 v170,v42,v42
v_mfma_f32_16x16x32_bf16 v[52:55],v[72:75],v[72:75],v[52:55]
s_waitcnt lgkmcnt(2)
buffer_load_dwordx4 v3,s[20:23],s61 offen offset:2048 lds
v_mul_f32 v171,v43,v43
v_fma_f32 v170,v170,v191,v190
v_mfma_f32_16x16x32_bf16 v[32:35],a[24:27],v[76:79],v[32:35]
s_waitcnt vmcnt(6)
ds_read_b128 v[88:91],v4 offset:6144
v_fma_f32 v171,v171,v191,v190
v_mfma_f32_16x16x32_bf16 v[36:39],a[28:31],v[76:79],v[36:39]
v_mul_f32 v170,v170,v42
v_mul_f32 v171,v171,v43
v_mfma_f32_16x16x32_bf16 v[48:51],v[12:15],v[76:79],v[48:51]
v_exp_f32 v170,v170
v_mfma_f32_16x16x32_bf16 v[52:55],v[76:79],v[76:79],v[52:55]
s_waitcnt lgkmcnt(2)
buffer_load_dwordx4 v3,s[20:23],s61 offen offset:3072 lds
v_fma_f32 v170,v170,v189,v189
v_mfma_f32_16x16x32_bf16 v[32:35],a[32:35],v[80:83],v[32:35]
s_waitcnt vmcnt(5)
ds_read_b128 v[92:95],v4 offset:7168
v_fma_f32 v44,v156,v188,v44
v_mfma_f32_16x16x32_bf16 v[36:39],a[36:39],v[80:83],v[36:39]
s_barrier
ds_read_b128 v[96:99],v5 offset:0
v_fma_f32 v45,v157,v188,v45
v_mfma_f32_16x16x32_bf16 v[48:51],v[12:15],v[80:83],v[48:51]
ds_read_b128 v[100:103],v5 offset:1024
v_mul_f32 v172,v44,v44
v_mfma_f32_16x16x32_bf16 v[52:55],v[80:83],v[80:83],v[52:55]
s_waitcnt lgkmcnt(4)
ds_read_b128 v[104:107],v5 offset:2048
v_mul_f32 v173,v45,v45
v_mfma_f32_16x16x32_bf16 v[32:35],a[40:43],v[84:87],v[32:35]
s_add_u32 m0,s70,4096
ds_read_b128 v[108:111],v5 offset:3072
v_fma_f32 v172,v172,v191,v190
v_mfma_f32_16x16x32_bf16 v[36:39],a[44:47],v[84:87],v[36:39]
buffer_load_dwordx4 v3,s[20:23],s62 offen offset:0 lds
v_fma_f32 v173,v173,v191,v190
v_mfma_f32_16x16x32_bf16 v[48:51],v[12:15],v[84:87],v[48:51]
s_waitcnt vmcnt(5)
v_mov_b32 v17,s57
buffer_store_dword v17,v26,s[20:23],s69 offen sc1
v_mfma_f32_16x16x32_bf16 v[52:55],v[84:87],v[84:87],v[52:55]
s_waitcnt lgkmcnt(5)
v_exp_f32 v171,v171
v_mfma_f32_16x16x32_bf16 v[32:35],a[48:51],v[88:91],v[32:35]
ds_read_b128 v[112:115],v5 offset:4096
v_fma_f32 v171,v171,v189,v189
v_mfma_f32_16x16x32_bf16 v[36:39],a[52:55],v[88:91],v[36:39]
buffer_load_dwordx4 v3,s[20:23],s62 offen offset:1024 lds
v_mul_f32 v172,v172,v44
v_mfma_f32_16x16x32_bf16 v[48:51],v[12:15],v[88:91],v[48:51]
v_rcp_f32 v170,v170
v_mfma_f32_16x16x32_bf16 v[52:55],v[88:91],v[88:91],v[52:55]
s_waitcnt lgkmcnt(5)
v_rcp_f32 v171,v171
v_mfma_f32_16x16x32_bf16 v[32:35],a[56:59],v[92:95],v[32:35]
ds_read_b128 v[116:119],v5 offset:5120
v_mul_f32 v42,v170,v42
v_mfma_f32_16x16x32_bf16 v[36:39],a[60:63],v[92:95],v[36:39]
buffer_load_dwordx4 v3,s[20:23],s62 offen offset:2048 lds
v_mul_f32 v43,v171,v43
v_mfma_f32_16x16x32_bf16 v[48:51],v[12:15],v[92:95],v[48:51]
buffer_load_dword v16,v2,s[20:23],s68 offen sc1
v_mul_f32 v173,v173,v45
v_mfma_f32_16x16x32_bf16 v[52:55],v[92:95],v[92:95],v[52:55]
s_waitcnt lgkmcnt(5)
v_exp_f32 v172,v172
v_mfma_f32_16x16x32_bf16 v[32:35],a[64:67],v[96:99],v[32:35]
ds_read_b128 v[120:123],v5 offset:6144
v_fma_f32 v172,v172,v189,v189
v_mfma_f32_16x16x32_bf16 v[36:39],a[68:71],v[96:99],v[36:39]
s_waitcnt lgkmcnt(5)
buffer_load_dwordx4 v3,s[20:23],s62 offen offset:3072 lds
v_fma_f32 v46,v158,v188,v46
v_mfma_f32_16x16x32_bf16 v[32:35],a[72:75],v[100:103],v[32:35]
ds_read_b128 v[124:127],v5 offset:7168
v_fma_f32 v47,v159,v188,v47
v_mfma_f32_16x16x32_bf16 v[36:39],a[76:79],v[100:103],v[36:39]
s_waitcnt lgkmcnt(5)
v_exp_f32 v173,v173
v_mfma_f32_16x16x32_bf16 v[32:35],a[80:83],v[104:107],v[32:35]
ds_read_b128 v[64:67],v6 offset:0
v_cndmask_b32 v49,v52,v53,s[74:75]
v_mfma_f32_16x16x32_bf16 v[36:39],a[84:87],v[104:107],v[36:39]
s_waitcnt lgkmcnt(5)
v_cndmask_b32 v49,v49,v54,s[76:77]
v_cndmask_b32 v49,v49,v55,s[78:79]
v_mfma_f32_16x16x32_bf16 v[32:35],a[88:91],v[108:111],v[32:35]
ds_read_b128 v[68:71],v6 offset:1024
v_fma_f32 v173,v173,v189,v189
v_mfma_f32_16x16x32_bf16 v[36:39],a[92:95],v[108:111],v[36:39]
s_waitcnt lgkmcnt(5)
ds_write_b64 v19,v[48:49]
v_mfma_f32_16x16x32_bf16 v[32:35],a[96:99],v[112:115],v[32:35]
ds_read_b128 v[72:75],v6 offset:2048
v_mul_f32 v174,v46,v46
v_mfma_f32_16x16x32_bf16 v[36:39],a[100:103],v[112:115],v[36:39]
s_waitcnt lgkmcnt(6)
v_rcp_f32 v172,v172
v_mfma_f32_16x16x32_bf16 v[32:35],a[104:107],v[116:119],v[32:35]
ds_read_b128 v[76:79],v6 offset:3072
v_mul_f32 v44,v172,v44
v_mfma_f32_16x16x32_bf16 v[36:39],a[108:111],v[116:119],v[36:39]
s_waitcnt lgkmcnt(6)
v_rcp_f32 v173,v173
v_mfma_f32_16x16x32_bf16 v[32:35],a[112:115],v[120:123],v[32:35]
s_waitcnt lgkmcnt(2)
s_barrier
ds_read_b128 v[80:83],v6 offset:4096
v_mfma_f32_16x16x32_bf16 v[36:39],a[116:119],v[120:123],v[36:39]
ds_read_b64 v[56:57],v20 offset:0
v_mul_f32 v45,v173,v45
v_mfma_f32_16x16x32_bf16 v[32:35],a[120:123],v[124:127],v[32:35]
ds_read_b128 v[84:87],v6 offset:5120
v_mul_f32 v175,v47,v47
v_mfma_f32_16x16x32_bf16 v[36:39],a[124:127],v[124:127],v[36:39]
ds_read_b64 v[58:59],v20 offset:512
v_fma_f32 v174,v174,v191,v190
v_mfma_f32_16x16x32_bf16 v[32:35],a[128:131],v[64:67],v[32:35]
ds_read_b128 v[88:91],v6 offset:6144
v_fma_f32 v175,v175,v191,v190
v_mfma_f32_16x16x32_bf16 v[36:39],a[132:135],v[64:67],v[36:39]
ds_read_b64 v[60:61],v20 offset:1024
v_mul_f32 v174,v174,v46
v_mfma_f32_16x16x32_bf16 v[32:35],a[136:139],v[68:71],v[32:35]
ds_read_b128 v[92:95],v6 offset:7168
v_mul_f32 v175,v175,v47
v_mfma_f32_16x16x32_bf16 v[36:39],a[140:143],v[68:71],v[36:39]
s_waitcnt lgkmcnt(8)
ds_read_b64 v[62:63],v20 offset:1536
v_cvt_pk_bf16_f32 v176,v40,v41
v_mfma_f32_16x16x32_bf16 v[32:35],a[144:147],v[72:75],v[32:35]
ds_read_b128 v[96:99],v7 offset:0
v_cvt_pk_bf16_f32 v177,v42,v43
v_mfma_f32_16x16x32_bf16 v[36:39],a[148:151],v[72:75],v[36:39]
s_waitcnt lgkmcnt(9)
v_exp_f32 v174,v174
v_mfma_f32_16x16x32_bf16 v[32:35],a[152:155],v[76:79],v[32:35]
ds_read_b128 v[100:103],v7 offset:1024
v_fma_f32 v174,v174,v189,v189
v_mfma_f32_16x16x32_bf16 v[36:39],a[156:159],v[76:79],v[36:39]
s_waitcnt lgkmcnt(9)
v_exp_f32 v175,v175
v_mfma_f32_16x16x32_bf16 v[32:35],a[160:163],v[80:83],v[32:35]
ds_read_b128 v[104:107],v7 offset:2048
v_fma_f32 v175,v175,v189,v189
v_mfma_f32_16x16x32_bf16 v[36:39],a[164:167],v[80:83],v[36:39]
s_waitcnt lgkmcnt(8)
s_waitcnt lgkmcnt(3)
v_rcp_f32 v174,v174
v_mfma_f32_16x16x32_bf16 v[32:35],a[168:171],v[84:87],v[32:35]
ds_read_b128 v[108:111],v7 offset:3072
v_mul_f32 v46,v174,v46
v_mfma_f32_16x16x32_bf16 v[36:39],a[172:175],v[84:87],v[36:39]
v_rcp_f32 v175,v175
v_mfma_f32_16x16x32_bf16 v[32:35],a[176:179],v[88:91],v[32:35]
ds_read_b128 v[112:115],v7 offset:4096
v_mul_f32 v47,v175,v47
v_mfma_f32_16x16x32_bf16 v[36:39],a[180:183],v[88:91],v[36:39]
v_cvt_pk_bf16_f32 v178,v44,v45
v_cvt_pk_bf16_f32 v179,v46,v47
v_mfma_f32_16x16x32_bf16 v[32:35],a[184:187],v[92:95],v[32:35]
ds_read_b128 v[116:119],v7 offset:5120
v_add_f32 v56,v56,v58
v_mfma_f32_16x16x32_bf16 v[36:39],a[188:191],v[92:95],v[36:39]
s_waitcnt lgkmcnt(5)
buffer_store_dwordx4 v[176:179],v0,s[20:23],s66 offen sc1
v_mfma_f32_16x16x32_bf16 v[32:35],a[192:195],v[96:99],v[32:35]
s_add_u32 s66,s66,32768
s_add_u32 s63,s63,1
ds_read_b128 v[120:123],v7 offset:6144
v_mfma_f32_16x16x32_bf16 v[36:39],a[196:199],v[96:99],v[36:39]
s_waitcnt lgkmcnt(5)
v_add_f32 v57,v57,v59
v_add_f32 v60,v60,v62
v_mfma_f32_16x16x32_bf16 v[32:35],a[200:203],v[100:103],v[32:35]
ds_read_b128 v[124:127],v7 offset:7168
v_add_f32 v61,v61,v63
v_mfma_f32_16x16x32_bf16 v[36:39],a[204:207],v[100:103],v[36:39]
s_waitcnt lgkmcnt(5)
v_add_f32 v56,v56,v60
v_add_f32 v57,v57,v61
v_mfma_f32_16x16x32_bf16 v[32:35],a[208:211],v[104:107],v[32:35]
s_add_u32 s61,s61,32768
v_mul_f32 v188,0xba800000,v56
v_fma_f32 v58,v188,v188,-v210
v_mfma_f32_16x16x32_bf16 v[36:39],a[212:215],v[104:107],v[36:39]
s_waitcnt lgkmcnt(4)
v_fma_f32 v57,v57,v211,-v58
v_max_f32 v57,v210,v57
v_mfma_f32_16x16x32_bf16 v[32:35],a[216:219],v[108:111],v[32:35]
s_add_u32 s62,s62,32768
v_rsq_f32 v58,v57
v_mfma_f32_16x16x32_bf16 v[36:39],a[220:223],v[108:111],v[36:39]
s_waitcnt lgkmcnt(3)
v_mul_f32 v189,v57,v58
v_mul_f32 v190,v209,v58
v_mfma_f32_16x16x32_bf16 v[32:35],a[224:227],v[112:115],v[32:35]
s_add_u32 s70,s70,32768
v_mul_f32 v59,v58,v58
v_mul_f32 v191,v208,v58
v_mfma_f32_16x16x32_bf16 v[36:39],a[228:231],v[112:115],v[36:39]
s_waitcnt lgkmcnt(2)
s_and_b32 s70,s70,0x1ffff
v_mul_f32 v191,v191,v59
v_mfma_f32_16x16x32_bf16 v[32:35],a[232:235],v[116:119],v[32:35]
s_add_u32 s55,s55,32768
s_and_b32 s55,s55,0x1ffff
v_add_u32 v4,s55,v8
v_mfma_f32_16x16x32_bf16 v[36:39],a[236:239],v[116:119],v[36:39]
s_waitcnt lgkmcnt(1)
v_add_u32 v5,s55,v9
v_add_u32 v6,s55,v10
v_mfma_f32_16x16x32_bf16 v[32:35],a[240:243],v[120:123],v[32:35]
v_add_u32 v7,s55,v11
v_mfma_f32_16x16x32_bf16 v[36:39],a[244:247],v[120:123],v[36:39]
s_waitcnt lgkmcnt(0)
s_waitcnt vmcnt(10)
ds_read_b128 v[64:67],v4 offset:0
v_mfma_f32_16x16x32_bf16 v[40:43],a[248:251],v[124:127],v[32:35]
s_waitcnt vmcnt(9)
ds_read_b128 v[68:71],v4 offset:1024
v_mfma_f32_16x16x32_bf16 v[44:47],a[252:255],v[124:127],v[36:39]
s_waitcnt vmcnt(2)
v_cmp_gt_u32 vcc,s53,v16
ds_read_b128 v[72:75],v4 offset:2048
s_add_u32 s60,s60,1
s_cbranch_vccz WR_332
WN_333:
s_waitcnt lgkmcnt(2)
v_mfma_f32_16x16x32_bf16 v[32:35],a[0:3],v[64:67],0
s_waitcnt vmcnt(6)
s_add_u32 s71,s60,2
ds_read_b128 v[76:79],v4 offset:3072
v_mfma_f32_16x16x32_bf16 v[36:39],a[4:7],v[64:67],0
s_add_u32 s53,s60,3
s_mov_b32 s57,s63
v_mfma_f32_16x16x32_bf16 v[48:51],v[12:15],v[64:67],0
v_fma_f32 v40,v152,v188,v40
v_fma_f32 v41,v153,v188,v41
v_mul_f32 v168,v40,v40
v_mfma_f32_16x16x32_bf16 v[52:55],v[64:67],v[64:67],0
s_waitcnt lgkmcnt(2)
v_mul_f32 v169,v41,v41
v_fma_f32 v168,v168,v191,v190
v_fma_f32 v169,v169,v191,v190
v_mfma_f32_16x16x32_bf16 v[32:35],a[8:11],v[68:71],v[32:35]
s_waitcnt vmcnt(5)
ds_read_b128 v[80:83],v4 offset:4096
v_mul_f32 v168,v168,v40
v_mul_f32 v169,v169,v41
v_mfma_f32_16x16x32_bf16 v[36:39],a[12:15],v[68:71],v[36:39]
v_exp_f32 v168,v168
v_fma_f32 v42,v154,v188,v42
v_mfma_f32_16x16x32_bf16 v[48:51],v[12:15],v[68:71],v[48:51]
v_exp_f32 v169,v169
v_fma_f32 v168,v168,v189,v189
v_mfma_f32_16x16x32_bf16 v[52:55],v[68:71],v[68:71],v[52:55]
s_waitcnt lgkmcnt(2)
v_rcp_f32 v168,v168
v_fma_f32 v169,v169,v189,v189
v_mfma_f32_16x16x32_bf16 v[32:35],a[16:19],v[72:75],v[32:35]
s_waitcnt vmcnt(4)
ds_read_b128 v[84:87],v4 offset:5120
v_rcp_f32 v169,v169
v_mfma_f32_16x16x32_bf16 v[36:39],a[20:23],v[72:75],v[36:39]
v_mul_f32 v40,v168,v40
v_mul_f32 v41,v169,v41
v_fma_f32 v43,v155,v188,v43
v_mfma_f32_16x16x32_bf16 v[48:51],v[12:15],v[72:75],v[48:51]
v_mul_f32 v170,v42,v42
v_mul_f32 v171,v43,v43
v_mfma_f32_16x16x32_bf16 v[52:55],v[72:75],v[72:75],v[52:55]
s_waitcnt lgkmcnt(2)
v_fma_f32 v170,v170,v191,v190
v_fma_f32 v171,v171,v191,v190
v_mfma_f32_16x16x32_bf16 v[32:35],a[24:27],v[76:79],v[32:35]
s_waitcnt vmcnt(3)
ds_read_b128 v[88:91],v4 offset:6144
v_mul_f32 v170,v170,v42
v_mfma_f32_16x16x32_bf16 v[36:39],a[28:31],v[76:79],v[36:39]
v_exp_f32 v170,v170
v_mfma_f32_16x16x32_bf16 v[48:51],v[12:15],v[76:79],v[48:51]
v_mul_f32 v171,v171,v43
v_fma_f32 v170,v170,v189,v189
v_mfma_f32_16x16x32_bf16 v[52:55],v[76:79],v[76:79],v[52:55]
s_waitcnt lgkmcnt(2)
v_exp_f32 v171,v171
v_mfma_f32_16x16x32_bf16 v[32:35],a[32:35],v[80:83],v[32:35]
s_waitcnt vmcnt(1)
ds_read_b128 v[92:95],v4 offset:7168
v_fma_f32 v171,v171,v189,v189
v_mfma_f32_16x16x32_bf16 v[36:39],a[36:39],v[80:83],v[36:39]
s_barrier
ds_read_b128 v[96:99],v5 offset:0
v_fma_f32 v44,v156,v188,v44
v_mfma_f32_16x16x32_bf16 v[48:51],v[12:15],v[80:83],v[48:51]
ds_read_b128 v[100:103],v5 offset:1024
v_fma_f32 v45,v157,v188,v45
v_mfma_f32_16x16x32_bf16 v[52:55],v[80:83],v[80:83],v[52:55]
s_waitcnt lgkmcnt(4)
ds_read_b128 v[104:107],v5 offset:2048
v_mul_f32 v172,v44,v44
v_mfma_f32_16x16x32_bf16 v[32:35],a[40:43],v[84:87],v[32:35]
ds_read_b128 v[108:111],v5 offset:3072
v_mul_f32 v173,v45,v45
v_mfma_f32_16x16x32_bf16 v[36:39],a[44:47],v[84:87],v[36:39]
s_waitcnt vmcnt(0)
v_mov_b32 v17,s57
buffer_store_dword v17,v26,s[20:23],s69 offen sc1
v_mfma_f32_16x16x32_bf16 v[48:51],v[12:15],v[84:87],v[48:51]
v_rcp_f32 v170,v170
v_mfma_f32_16x16x32_bf16 v[52:55],v[84:87],v[84:87],v[52:55]
s_waitcnt lgkmcnt(5)
v_rcp_f32 v171,v171
v_mfma_f32_16x16x32_bf16 v[32:35],a[48:51],v[88:91],v[32:35]
ds_read_b128 v[112:115],v5 offset:4096
v_mul_f32 v42,v170,v42
v_mfma_f32_16x16x32_bf16 v[36:39],a[52:55],v[88:91],v[36:39]
v_mul_f32 v43,v171,v43
v_fma_f32 v172,v172,v191,v190
v_mfma_f32_16x16x32_bf16 v[48:51],v[12:15],v[88:91],v[48:51]
v_fma_f32 v173,v173,v191,v190
v_mul_f32 v172,v172,v44
v_mfma_f32_16x16x32_bf16 v[52:55],v[88:91],v[88:91],v[52:55]
s_waitcnt lgkmcnt(5)
v_exp_f32 v172,v172
v_mfma_f32_16x16x32_bf16 v[32:35],a[56:59],v[92:95],v[32:35]
ds_read_b128 v[116:119],v5 offset:5120
v_mul_f32 v173,v173,v45
v_mfma_f32_16x16x32_bf16 v[36:39],a[60:63],v[92:95],v[36:39]
v_exp_f32 v173,v173
v_mfma_f32_16x16x32_bf16 v[48:51],v[12:15],v[92:95],v[48:51]
v_fma_f32 v172,v172,v189,v189
v_fma_f32 v173,v173,v189,v189
v_mfma_f32_16x16x32_bf16 v[52:55],v[92:95],v[92:95],v[52:55]
s_waitcnt lgkmcnt(5)
v_rcp_f32 v172,v172
v_mfma_f32_16x16x32_bf16 v[32:35],a[64:67],v[96:99],v[32:35]
ds_read_b128 v[120:123],v5 offset:6144
v_mul_f32 v44,v172,v44
v_mfma_f32_16x16x32_bf16 v[36:39],a[68:71],v[96:99],v[36:39]
s_waitcnt lgkmcnt(5)
v_rcp_f32 v173,v173
v_mfma_f32_16x16x32_bf16 v[32:35],a[72:75],v[100:103],v[32:35]
ds_read_b128 v[124:127],v5 offset:7168
v_mul_f32 v45,v173,v45
v_mfma_f32_16x16x32_bf16 v[36:39],a[76:79],v[100:103],v[36:39]
s_waitcnt lgkmcnt(5)
v_fma_f32 v46,v158,v188,v46
v_fma_f32 v47,v159,v188,v47
v_mfma_f32_16x16x32_bf16 v[32:35],a[80:83],v[104:107],v[32:35]
ds_read_b128 v[64:67],v6 offset:0
v_cndmask_b32 v49,v52,v53,s[74:75]
v_mfma_f32_16x16x32_bf16 v[36:39],a[84:87],v[104:107],v[36:39]
s_waitcnt lgkmcnt(5)
v_cndmask_b32 v49,v49,v54,s[76:77]
v_cndmask_b32 v49,v49,v55,s[78:79]
v_mfma_f32_16x16x32_bf16 v[32:35],a[88:91],v[108:111],v[32:35]
ds_read_b128 v[68:71],v6 offset:1024
v_mul_f32 v174,v46,v46
v_mfma_f32_16x16x32_bf16 v[36:39],a[92:95],v[108:111],v[36:39]
s_waitcnt lgkmcnt(5)
ds_write_b64 v19,v[48:49]
v_mfma_f32_16x16x32_bf16 v[32:35],a[96:99],v[112:115],v[32:35]
ds_read_b128 v[72:75],v6 offset:2048
v_mul_f32 v175,v47,v47
v_mfma_f32_16x16x32_bf16 v[36:39],a[100:103],v[112:115],v[36:39]
s_waitcnt lgkmcnt(6)
v_fma_f32 v174,v174,v191,v190
v_fma_f32 v175,v175,v191,v190
v_mfma_f32_16x16x32_bf16 v[32:35],a[104:107],v[116:119],v[32:35]
ds_read_b128 v[76:79],v6 offset:3072
v_mul_f32 v174,v174,v46
v_mfma_f32_16x16x32_bf16 v[36:39],a[108:111],v[116:119],v[36:39]
s_waitcnt lgkmcnt(6)
v_exp_f32 v174,v174
v_mfma_f32_16x16x32_bf16 v[32:35],a[112:115],v[120:123],v[32:35]
s_waitcnt lgkmcnt(2)
s_barrier
ds_read_b128 v[80:83],v6 offset:4096
v_mfma_f32_16x16x32_bf16 v[36:39],a[116:119],v[120:123],v[36:39]
ds_read_b64 v[56:57],v20 offset:0
v_mul_f32 v175,v175,v47
v_mfma_f32_16x16x32_bf16 v[32:35],a[120:123],v[124:127],v[32:35]
ds_read_b128 v[84:87],v6 offset:5120
v_fma_f32 v174,v174,v189,v189
v_mfma_f32_16x16x32_bf16 v[36:39],a[124:127],v[124:127],v[36:39]
ds_read_b64 v[58:59],v20 offset:512
v_cvt_pk_bf16_f32 v176,v40,v41
v_mfma_f32_16x16x32_bf16 v[32:35],a[128:131],v[64:67],v[32:35]
ds_read_b128 v[88:91],v6 offset:6144
v_cvt_pk_bf16_f32 v177,v42,v43
v_mfma_f32_16x16x32_bf16 v[36:39],a[132:135],v[64:67],v[36:39]
ds_read_b64 v[60:61],v20 offset:1024
v_cvt_pk_bf16_f32 v178,v44,v45
v_mfma_f32_16x16x32_bf16 v[32:35],a[136:139],v[68:71],v[32:35]
ds_read_b128 v[92:95],v6 offset:7168
v_mfma_f32_16x16x32_bf16 v[36:39],a[140:143],v[68:71],v[36:39]
s_waitcnt lgkmcnt(8)
ds_read_b64 v[62:63],v20 offset:1536
v_mfma_f32_16x16x32_bf16 v[32:35],a[144:147],v[72:75],v[32:35]
ds_read_b128 v[96:99],v7 offset:0
v_mfma_f32_16x16x32_bf16 v[36:39],a[148:151],v[72:75],v[36:39]
s_waitcnt lgkmcnt(9)
buffer_load_dword v16,v2,s[20:23],s68 offen sc1
v_mfma_f32_16x16x32_bf16 v[32:35],a[152:155],v[76:79],v[32:35]
ds_read_b128 v[100:103],v7 offset:1024
v_mfma_f32_16x16x32_bf16 v[36:39],a[156:159],v[76:79],v[36:39]
s_waitcnt lgkmcnt(9)
v_exp_f32 v175,v175
v_mfma_f32_16x16x32_bf16 v[32:35],a[160:163],v[80:83],v[32:35]
ds_read_b128 v[104:107],v7 offset:2048
v_fma_f32 v175,v175,v189,v189
v_mfma_f32_16x16x32_bf16 v[36:39],a[164:167],v[80:83],v[36:39]
s_waitcnt lgkmcnt(8)
s_waitcnt lgkmcnt(3)
v_rcp_f32 v174,v174
v_mfma_f32_16x16x32_bf16 v[32:35],a[168:171],v[84:87],v[32:35]
ds_read_b128 v[108:111],v7 offset:3072
v_mul_f32 v46,v174,v46
v_mfma_f32_16x16x32_bf16 v[36:39],a[172:175],v[84:87],v[36:39]
v_rcp_f32 v175,v175
v_mfma_f32_16x16x32_bf16 v[32:35],a[176:179],v[88:91],v[32:35]
ds_read_b128 v[112:115],v7 offset:4096
v_mul_f32 v47,v175,v47
v_mfma_f32_16x16x32_bf16 v[36:39],a[180:183],v[88:91],v[36:39]
v_cvt_pk_bf16_f32 v179,v46,v47
v_add_f32 v56,v56,v58
v_mfma_f32_16x16x32_bf16 v[32:35],a[184:187],v[92:95],v[32:35]
ds_read_b128 v[116:119],v7 offset:5120
v_add_f32 v57,v57,v59
v_mfma_f32_16x16x32_bf16 v[36:39],a[188:191],v[92:95],v[36:39]
s_waitcnt lgkmcnt(5)
buffer_store_dwordx4 v[176:179],v0,s[20:23],s66 offen sc1
v_mfma_f32_16x16x32_bf16 v[32:35],a[192:195],v[96:99],v[32:35]
s_add_u32 s66,s66,32768
s_add_u32 s63,s63,1
ds_read_b128 v[120:123],v7 offset:6144
v_mfma_f32_16x16x32_bf16 v[36:39],a[196:199],v[96:99],v[36:39]
s_waitcnt lgkmcnt(5)
v_add_f32 v60,v60,v62
v_add_f32 v61,v61,v63
v_mfma_f32_16x16x32_bf16 v[32:35],a[200:203],v[100:103],v[32:35]
ds_read_b128 v[124:127],v7 offset:7168
v_add_f32 v56,v56,v60
v_mfma_f32_16x16x32_bf16 v[36:39],a[204:207],v[100:103],v[36:39]
s_waitcnt lgkmcnt(5)
v_add_f32 v57,v57,v61
v_mul_f32 v188,0xba800000,v56
v_mfma_f32_16x16x32_bf16 v[32:35],a[208:211],v[104:107],v[32:35]
s_add_u32 s55,s55,32768
v_fma_f32 v58,v188,v188,-v210
v_fma_f32 v57,v57,v211,-v58
v_mfma_f32_16x16x32_bf16 v[36:39],a[212:215],v[104:107],v[36:39]
s_waitcnt lgkmcnt(4)
s_and_b32 s55,s55,0x1ffff
v_max_f32 v57,v210,v57
v_mfma_f32_16x16x32_bf16 v[32:35],a[216:219],v[108:111],v[32:35]
v_rsq_f32 v58,v57
v_mfma_f32_16x16x32_bf16 v[36:39],a[220:223],v[108:111],v[36:39]
s_waitcnt lgkmcnt(3)
v_mul_f32 v189,v57,v58
v_mul_f32 v190,v209,v58
v_mfma_f32_16x16x32_bf16 v[32:35],a[224:227],v[112:115],v[32:35]
v_mul_f32 v59,v58,v58
v_mul_f32 v191,v208,v58
v_mfma_f32_16x16x32_bf16 v[36:39],a[228:231],v[112:115],v[36:39]
s_waitcnt lgkmcnt(2)
v_mul_f32 v191,v191,v59
v_add_u32 v4,s55,v8
v_mfma_f32_16x16x32_bf16 v[32:35],a[232:235],v[116:119],v[32:35]
v_add_u32 v5,s55,v9
v_add_u32 v6,s55,v10
v_mfma_f32_16x16x32_bf16 v[36:39],a[236:239],v[116:119],v[36:39]
s_waitcnt lgkmcnt(1)
v_add_u32 v7,s55,v11
v_mfma_f32_16x16x32_bf16 v[32:35],a[240:243],v[120:123],v[32:35]
v_mfma_f32_16x16x32_bf16 v[36:39],a[244:247],v[120:123],v[36:39]
s_waitcnt lgkmcnt(0)
v_mfma_f32_16x16x32_bf16 v[40:43],a[248:251],v[124:127],v[32:35]
v_mfma_f32_16x16x32_bf16 v[44:47],a[252:255],v[124:127],v[36:39]
s_waitcnt vmcnt(1)
v_cmp_gt_u32 vcc,s71,v16
s_add_u32 s60,s60,1
s_branch endN_341
BN_335:
s_waitcnt vmcnt(9)
ds_read_b128 v[64:67],v4 offset:0
s_waitcnt vmcnt(8)
ds_read_b128 v[68:71],v4 offset:1024
s_waitcnt vmcnt(7)
ds_read_b128 v[72:75],v4 offset:2048
s_waitcnt vmcnt(6)
ds_read_b128 v[76:79],v4 offset:3072
s_waitcnt lgkmcnt(3)
v_mfma_f32_16x16x32_bf16 v[32:35],a[0:3],v[64:67],0
s_add_u32 s71,s60,2
s_add_u32 s53,s60,3
s_mov_b32 s57,s63
v_mfma_f32_16x16x32_bf16 v[36:39],a[4:7],v[64:67],0
v_mfma_f32_16x16x32_bf16 v[48:51],v[12:15],v[64:67],0
v_mfma_f32_16x16x32_bf16 v[52:55],v[64:67],v[64:67],0
s_waitcnt lgkmcnt(2)
s_waitcnt vmcnt(5)
ds_read_b128 v[80:83],v4 offset:4096
v_mfma_f32_16x16x32_bf16 v[32:35],a[8:11],v[68:71],v[32:35]
v_mfma_f32_16x16x32_bf16 v[36:39],a[12:15],v[68:71],v[36:39]
v_mfma_f32_16x16x32_bf16 v[48:51],v[12:15],v[68:71],v[48:51]
v_mfma_f32_16x16x32_bf16 v[52:55],v[68:71],v[68:71],v[52:55]
s_waitcnt lgkmcnt(2)
s_waitcnt vmcnt(4)
ds_read_b128 v[84:87],v4 offset:5120
v_mfma_f32_16x16x32_bf16 v[32:35],a[16:19],v[72:75],v[32:35]
v_mfma_f32_16x16x32_bf16 v[36:39],a[20:23],v[72:75],v[36:39]
v_mfma_f32_16x16x32_bf16 v[48:51],v[12:15],v[72:75],v[48:51]
v_mfma_f32_16x16x32_bf16 v[52:55],v[72:75],v[72:75],v[52:55]
s_waitcnt lgkmcnt(2)
s_waitcnt vmcnt(3)
ds_read_b128 v[88:91],v4 offset:6144
v_mfma_f32_16x16x32_bf16 v[32:35],a[24:27],v[76:79],v[32:35]
v_mfma_f32_16x16x32_bf16 v[36:39],a[28:31],v[76:79],v[36:39]
v_mfma_f32_16x16x32_bf16 v[48:51],v[12:15],v[76:79],v[48:51]
v_mfma_f32_16x16x32_bf16 v[52:55],v[76:79],v[76:79],v[52:55]
s_waitcnt lgkmcnt(2)
s_waitcnt vmcnt(2)
ds_read_b128 v[92:95],v4 offset:7168
v_mfma_f32_16x16x32_bf16 v[32:35],a[32:35],v[80:83],v[32:35]
v_mfma_f32_16x16x32_bf16 v[36:39],a[36:39],v[80:83],v[36:39]
v_mfma_f32_16x16x32_bf16 v[48:51],v[12:15],v[80:83],v[48:51]
v_mfma_f32_16x16x32_bf16 v[52:55],v[80:83],v[80:83],v[52:55]
s_waitcnt lgkmcnt(2)
s_barrier
ds_read_b128 v[96:99],v5 offset:0
v_mfma_f32_16x16x32_bf16 v[32:35],a[40:43],v[84:87],v[32:35]
ds_read_b128 v[100:103],v5 offset:1024
v_mfma_f32_16x16x32_bf16 v[36:39],a[44:47],v[84:87],v[36:39]
ds_read_b128 v[104:107],v5 offset:2048
v_mfma_f32_16x16x32_bf16 v[48:51],v[12:15],v[84:87],v[48:51]
ds_read_b128 v[108:111],v5 offset:3072
v_mfma_f32_16x16x32_bf16 v[52:55],v[84:87],v[84:87],v[52:55]
s_waitcnt lgkmcnt(5)
v_mfma_f32_16x16x32_bf16 v[32:35],a[48:51],v[88:91],v[32:35]
ds_read_b128 v[112:115],v5 offset:4096
v_mfma_f32_16x16x32_bf16 v[36:39],a[52:55],v[88:91],v[36:39]
v_mfma_f32_16x16x32_bf16 v[48:51],v[12:15],v[88:91],v[48:51]
v_mfma_f32_16x16x32_bf16 v[52:55],v[88:91],v[88:91],v[52:55]
s_waitcnt lgkmcnt(5)
v_mfma_f32_16x16x32_bf16 v[32:35],a[56:59],v[92:95],v[32:35]
ds_read_b128 v[116:119],v5 offset:5120
v_mfma_f32_16x16x32_bf16 v[36:39],a[60:63],v[92:95],v[36:39]
v_mfma_f32_16x16x32_bf16 v[48:51],v[12:15],v[92:95],v[48:51]
v_mfma_f32_16x16x32_bf16 v[52:55],v[92:95],v[92:95],v[52:55]
s_waitcnt lgkmcnt(5)
v_mfma_f32_16x16x32_bf16 v[32:35],a[64:67],v[96:99],v[32:35]
ds_read_b128 v[120:123],v5 offset:6144
v_mfma_f32_16x16x32_bf16 v[36:39],a[68:71],v[96:99],v[36:39]
s_waitcnt lgkmcnt(5)
v_mfma_f32_16x16x32_bf16 v[32:35],a[72:75],v[100:103],v[32:35]
ds_read_b128 v[124:127],v5 offset:7168
v_mfma_f32_16x16x32_bf16 v[36:39],a[76:79],v[100:103],v[36:39]
s_waitcnt lgkmcnt(5)
v_mfma_f32_16x16x32_bf16 v[32:35],a[80:83],v[104:107],v[32:35]
ds_read_b128 v[64:67],v6 offset:0
v_cndmask_b32 v49,v52,v53,s[74:75]
v_mfma_f32_16x16x32_bf16 v[36:39],a[84:87],v[104:107],v[36:39]
s_waitcnt lgkmcnt(5)
v_cndmask_b32 v49,v49,v54,s[76:77]
v_cndmask_b32 v49,v49,v55,s[78:79]
v_mfma_f32_16x16x32_bf16 v[32:35],a[88:91],v[108:111],v[32:35]
ds_read_b128 v[68:71],v6 offset:1024
v_mfma_f32_16x16x32_bf16 v[36:39],a[92:95],v[108:111],v[36:39]
s_waitcnt lgkmcnt(5)
ds_write_b64 v19,v[48:49]
v_mfma_f32_16x16x32_bf16 v[32:35],a[96:99],v[112:115],v[32:35]
ds_read_b128 v[72:75],v6 offset:2048
v_mfma_f32_16x16x32_bf16 v[36:39],a[100:103],v[112:115],v[36:39]
s_waitcnt lgkmcnt(6)
v_mfma_f32_16x16x32_bf16 v[32:35],a[104:107],v[116:119],v[32:35]
ds_read_b128 v[76:79],v6 offset:3072
v_mfma_f32_16x16x32_bf16 v[36:39],a[108:111],v[116:119],v[36:39]
s_waitcnt lgkmcnt(6)
v_mfma_f32_16x16x32_bf16 v[32:35],a[112:115],v[120:123],v[32:35]
s_waitcnt lgkmcnt(2)
s_barrier
ds_read_b128 v[80:83],v6 offset:4096
v_mfma_f32_16x16x32_bf16 v[36:39],a[116:119],v[120:123],v[36:39]
ds_read_b64 v[56:57],v20 offset:0
v_mfma_f32_16x16x32_bf16 v[32:35],a[120:123],v[124:127],v[32:35]
ds_read_b128 v[84:87],v6 offset:5120
v_mfma_f32_16x16x32_bf16 v[36:39],a[124:127],v[124:127],v[36:39]
ds_read_b64 v[58:59],v20 offset:512
v_mfma_f32_16x16x32_bf16 v[32:35],a[128:131],v[64:67],v[32:35]
ds_read_b128 v[88:91],v6 offset:6144
v_mfma_f32_16x16x32_bf16 v[36:39],a[132:135],v[64:67],v[36:39]
ds_read_b64 v[60:61],v20 offset:1024
v_mfma_f32_16x16x32_bf16 v[32:35],a[136:139],v[68:71],v[32:35]
ds_read_b128 v[92:95],v6 offset:7168
v_mfma_f32_16x16x32_bf16 v[36:39],a[140:143],v[68:71],v[36:39]
s_waitcnt lgkmcnt(8)
ds_read_b64 v[62:63],v20 offset:1536
v_mfma_f32_16x16x32_bf16 v[32:35],a[144:147],v[72:75],v[32:35]
ds_read_b128 v[96:99],v7 offset:0
v_mfma_f32_16x16x32_bf16 v[36:39],a[148:151],v[72:75],v[36:39]
s_waitcnt lgkmcnt(9)
buffer_load_dword v16,v2,s[20:23],s68 offen sc1
v_mfma_f32_16x16x32_bf16 v[32:35],a[152:155],v[76:79],v[32:35]
ds_read_b128 v[100:103],v7 offset:1024
v_mfma_f32_16x16x32_bf16 v[36:39],a[156:159],v[76:79],v[36:39]
s_waitcnt lgkmcnt(9)
s_waitcnt vmcnt(2)
v_mov_b32 v17,s57
buffer_store_dword v17,v26,s[20:23],s69 offen sc1
v_mfma_f32_16x16x32_bf16 v[32:35],a[160:163],v[80:83],v[32:35]
ds_read_b128 v[104:107],v7 offset:2048
v_mfma_f32_16x16x32_bf16 v[36:39],a[164:167],v[80:83],v[36:39]
s_waitcnt lgkmcnt(8)
s_waitcnt lgkmcnt(3)
v_add_f32 v56,v56,v58
v_mfma_f32_16x16x32_bf16 v[32:35],a[168:171],v[84:87],v[32:35]
ds_read_b128 v[108:111],v7 offset:3072
v_add_f32 v57,v57,v59
v_mfma_f32_16x16x32_bf16 v[36:39],a[172:175],v[84:87],v[36:39]
v_add_f32 v60,v60,v62
v_add_f32 v61,v61,v63
v_mfma_f32_16x16x32_bf16 v[32:35],a[176:179],v[88:91],v[32:35]
ds_read_b128 v[112:115],v7 offset:4096
v_add_f32 v56,v56,v60
v_mfma_f32_16x16x32_bf16 v[36:39],a[180:183],v[88:91],v[36:39]
v_add_f32 v57,v57,v61
v_mul_f32 v188,0xba800000,v56
v_mfma_f32_16x16x32_bf16 v[32:35],a[184:187],v[92:95],v[32:35]
ds_read_b128 v[116:119],v7 offset:5120
v_fma_f32 v58,v188,v188,-v210
v_mfma_f32_16x16x32_bf16 v[36:39],a[188:191],v[92:95],v[36:39]
s_waitcnt lgkmcnt(5)
v_fma_f32 v57,v57,v211,-v58
v_max_f32 v57,v210,v57
v_mfma_f32_16x16x32_bf16 v[32:35],a[192:195],v[96:99],v[32:35]
ds_read_b128 v[120:123],v7 offset:6144
v_mfma_f32_16x16x32_bf16 v[36:39],a[196:199],v[96:99],v[36:39]
s_waitcnt lgkmcnt(5)
v_rsq_f32 v58,v57
v_mfma_f32_16x16x32_bf16 v[32:35],a[200:203],v[100:103],v[32:35]
ds_read_b128 v[124:127],v7 offset:7168
v_mul_f32 v189,v57,v58
v_mfma_f32_16x16x32_bf16 v[36:39],a[204:207],v[100:103],v[36:39]
s_waitcnt lgkmcnt(5)
v_mul_f32 v190,v209,v58
v_mul_f32 v59,v58,v58
v_mfma_f32_16x16x32_bf16 v[32:35],a[208:211],v[104:107],v[32:35]
s_add_u32 s55,s55,32768
v_mul_f32 v191,v208,v58
v_mul_f32 v191,v191,v59
v_mfma_f32_16x16x32_bf16 v[36:39],a[212:215],v[104:107],v[36:39]
s_waitcnt lgkmcnt(4)
s_and_b32 s55,s55,0x1ffff
v_add_u32 v4,s55,v8
v_mfma_f32_16x16x32_bf16 v[32:35],a[216:219],v[108:111],v[32:35]
v_add_u32 v5,s55,v9
v_add_u32 v6,s55,v10
v_mfma_f32_16x16x32_bf16 v[36:39],a[220:223],v[108:111],v[36:39]
s_waitcnt lgkmcnt(3)
v_add_u32 v7,s55,v11
v_mfma_f32_16x16x32_bf16 v[32:35],a[224:227],v[112:115],v[32:35]
v_mfma_f32_16x16x32_bf16 v[36:39],a[228:231],v[112:115],v[36:39]
s_waitcnt lgkmcnt(2)
v_mfma_f32_16x16x32_bf16 v[32:35],a[232:235],v[116:119],v[32:35]
v_mfma_f32_16x16x32_bf16 v[36:39],a[236:239],v[116:119],v[36:39]
s_waitcnt lgkmcnt(1)
v_mfma_f32_16x16x32_bf16 v[32:35],a[240:243],v[120:123],v[32:35]
v_mfma_f32_16x16x32_bf16 v[36:39],a[244:247],v[120:123],v[36:39]
s_waitcnt lgkmcnt(0)
v_mfma_f32_16x16x32_bf16 v[40:43],a[248:251],v[124:127],v[32:35]
v_mfma_f32_16x16x32_bf16 v[44:47],a[252:255],v[124:127],v[36:39]
s_waitcnt vmcnt(1)
v_cmp_gt_u32 vcc,s71,v16
s_add_u32 s60,s60,1
endN_341:
s_cbranch_vccnz nb_338
s_mov_b32 m0,s70
s_nop 0
buffer_load_dwordx4 v3,s[20:23],s61 offen offset:0 lds
buffer_load_dwordx4 v3,s[20:23],s61 offen offset:1024 lds
buffer_load_dwordx4 v3,s[20:23],s61 offen offset:2048 lds
buffer_load_dwordx4 v3,s[20:23],s61 offen offset:3072 lds
s_add_u32 m0,s70,4096
s_nop 0
buffer_load_dwordx4 v3,s[20:23],s62 offen offset:0 lds
buffer_load_dwordx4 v3,s[20:23],s62 offen offset:1024 lds
buffer_load_dwordx4 v3,s[20:23],s62 offen offset:2048 lds
buffer_load_dwordx4 v3,s[20:23],s62 offen offset:3072 lds
s_add_u32 s61,s61,32768
s_add_u32 s62,s62,32768
s_add_u32 s70,s70,32768
s_and_b32 s70,s70,0x1ffff
s_mov_b32 s57,s63
v_pk_fma_f32 v[40:41],v[152:153],v[188:189],v[40:41] op_sel_hi:[1,0,1]
v_pk_fma_f32 v[42:43],v[154:155],v[188:189],v[42:43] op_sel_hi:[1,0,1]
v_pk_fma_f32 v[44:45],v[156:157],v[188:189],v[44:45] op_sel_hi:[1,0,1]
v_pk_fma_f32 v[46:47],v[158:159],v[188:189],v[46:47] op_sel_hi:[1,0,1]
v_pk_mul_f32 v[168:169],v[40:41],v[40:41]
v_pk_mul_f32 v[170:171],v[42:43],v[42:43]
v_pk_mul_f32 v[172:173],v[44:45],v[44:45]
v_pk_mul_f32 v[174:175],v[46:47],v[46:47]
v_pk_fma_f32 v[168:169],v[168:169],v[190:191],v[190:191] op_sel:[0,1,0] op_sel_hi:[1,1,0]
v_pk_fma_f32 v[170:171],v[170:171],v[190:191],v[190:191] op_sel:[0,1,0] op_sel_hi:[1,1,0]
v_pk_fma_f32 v[172:173],v[172:173],v[190:191],v[190:191] op_sel:[0,1,0] op_sel_hi:[1,1,0]
v_pk_fma_f32 v[174:175],v[174:175],v[190:191],v[190:191] op_sel:[0,1,0] op_sel_hi:[1,1,0]
v_pk_mul_f32 v[168:169],v[168:169],v[40:41]
v_pk_mul_f32 v[170:171],v[170:171],v[42:43]
v_pk_mul_f32 v[172:173],v[172:173],v[44:45]
v_pk_mul_f32 v[174:175],v[174:175],v[46:47]
v_exp_f32 v168,v168
v_exp_f32 v169,v169
v_exp_f32 v170,v170
v_exp_f32 v171,v171
v_exp_f32 v172,v172
v_exp_f32 v173,v173
v_exp_f32 v174,v174
v_exp_f32 v175,v175
v_pk_fma_f32 v[168:169],v[168:169],v[188:189],v[188:189] op_sel:[0,1,1] op_sel_hi:[1,1,1]
v_pk_fma_f32 v[170:171],v[170:171],v[188:189],v[188:189] op_sel:[0,1,1] op_sel_hi:[1,1,1]
v_pk_fma_f32 v[172:173],v[172:173],v[188:189],v[188:189] op_sel:[0,1,1] op_sel_hi:[1,1,1]
v_pk_fma_f32 v[174:175],v[174:175],v[188:189],v[188:189] op_sel:[0,1,1] op_sel_hi:[1,1,1]
v_rcp_f32 v168,v168
v_rcp_f32 v169,v169
v_rcp_f32 v170,v170
v_rcp_f32 v171,v171
v_rcp_f32 v172,v172
v_rcp_f32 v173,v173
v_rcp_f32 v174,v174
v_rcp_f32 v175,v175
v_pk_mul_f32 v[40:41],v[168:169],v[40:41]
v_pk_mul_f32 v[42:43],v[170:171],v[42:43]
v_pk_mul_f32 v[44:45],v[172:173],v[44:45]
v_pk_mul_f32 v[46:47],v[174:175],v[46:47]
v_cvt_pk_bf16_f32 v176,v40,v41
v_cvt_pk_bf16_f32 v177,v42,v43
v_cvt_pk_bf16_f32 v178,v44,v45
v_cvt_pk_bf16_f32 v179,v46,v47
buffer_store_dwordx4 v[176:179],v0,s[20:23],s66 offen sc1
s_add_u32 s66,s66,32768
s_add_u32 s63,s63,1
s_waitcnt vmcnt(9)
v_mov_b32 v17,s57
buffer_store_dword v17,v26,s[20:23],s69 offen sc1
s_branch dec_337
nb_338:
buffer_load_dword v16,v2,s[20:23],s68 offen sc1
s_nop 3
s_mov_b32 s57,s63
v_pk_fma_f32 v[40:41],v[152:153],v[188:189],v[40:41] op_sel_hi:[1,0,1]
v_pk_fma_f32 v[42:43],v[154:155],v[188:189],v[42:43] op_sel_hi:[1,0,1]
v_pk_fma_f32 v[44:45],v[156:157],v[188:189],v[44:45] op_sel_hi:[1,0,1]
v_pk_fma_f32 v[46:47],v[158:159],v[188:189],v[46:47] op_sel_hi:[1,0,1]
v_pk_mul_f32 v[168:169],v[40:41],v[40:41]
v_pk_mul_f32 v[170:171],v[42:43],v[42:43]
v_pk_mul_f32 v[172:173],v[44:45],v[44:45]
v_pk_mul_f32 v[174:175],v[46:47],v[46:47]
v_pk_fma_f32 v[168:169],v[168:169],v[190:191],v[190:191] op_sel:[0,1,0] op_sel_hi:[1,1,0]
v_pk_fma_f32 v[170:171],v[170:171],v[190:191],v[190:191] op_sel:[0,1,0] op_sel_hi:[1,1,0]
v_pk_fma_f32 v[172:173],v[172:173],v[190:191],v[190:191] op_sel:[0,1,0] op_sel_hi:[1,1,0]
v_pk_fma_f32 v[174:175],v[174:175],v[190:191],v[190:191] op_sel:[0,1,0] op_sel_hi:[1,1,0]
v_pk_mul_f32 v[168:169],v[168:169],v[40:41]
v_pk_mul_f32 v[170:171],v[170:171],v[42:43]
v_pk_mul_f32 v[172:173],v[172:173],v[44:45]
v_pk_mul_f32 v[174:175],v[174:175],v[46:47]
v_exp_f32 v168,v168
v_exp_f32 v169,v169
v_exp_f32 v170,v170
v_exp_f32 v171,v171
v_exp_f32 v172,v172
v_exp_f32 v173,v173
v_exp_f32 v174,v174
v_exp_f32 v175,v175
v_pk_fma_f32 v[168:169],v[168:169],v[188:189],v[188:189] op_sel:[0,1,1] op_sel_hi:[1,1,1]
v_pk_fma_f32 v[170:171],v[170:171],v[188:189],v[188:189] op_sel:[0,1,1] op_sel_hi:[1,1,1]
v_pk_fma_f32 v[172:173],v[172:173],v[188:189],v[188:189] op_sel:[0,1,1] op_sel_hi:[1,1,1]
v_pk_fma_f32 v[174:175],v[174:175],v[188:189],v[188:189] op_sel:[0,1,1] op_sel_hi:[1,1,1]
v_rcp_f32 v168,v168
v_rcp_f32 v169,v169
v_rcp_f32 v170,v170
v_rcp_f32 v171,v171
v_rcp_f32 v172,v172
v_rcp_f32 v173,v173
v_rcp_f32 v174,v174
v_rcp_f32 v175,v175
v_pk_mul_f32 v[40:41],v[168:169],v[40:41]
v_pk_mul_f32 v[42:43],v[170:171],v[42:43]
v_pk_mul_f32 v[44:45],v[172:173],v[44:45]
v_pk_mul_f32 v[46:47],v[174:175],v[46:47]
v_cvt_pk_bf16_f32 v176,v40,v41
v_cvt_pk_bf16_f32 v177,v42,v43
v_cvt_pk_bf16_f32 v178,v44,v45
v_cvt_pk_bf16_f32 v179,v46,v47
buffer_store_dwordx4 v[176:179],v0,s[20:23],s66 offen sc1
s_add_u32 s66,s66,32768
s_add_u32 s63,s63,1
s_waitcnt vmcnt(2)
v_mov_b32 v17,s57
buffer_store_dword v17,v26,s[20:23],s69 offen sc1
s_waitcnt vmcnt(2)
v_cmp_gt_u32 vcc,s71,v16
s_cbranch_vccz lag_336
s_waitcnt vmcnt(1)
v_mov_b32 v17,s63
buffer_store_dword v17,v26,s[20:23],s69 offen sc1
s_cmp_ge_u32 s60,128
s_cbranch_scc1 done_310
plp_344:
buffer_load_dword v16,v2,s[20:23],s68 offen sc1
s_waitcnt vmcnt(0)
v_cmp_gt_u32 vcc,s71,v16
s_cbranch_vccz pok_345
s_sleep 4
s_sub_u32 s90,s90,1
s_cmp_gt_i32 s90,0
s_cbranch_scc1 plp_344
pok_345:
s_branch lag_336
done_310:
s_endpgm
fl_w2:
v_and_b32 v21,15,v1
v_lshrrev_b32 v22,4,v1
v_lshrrev_b32 v23,2,v21
v_and_b32 v24,3,v21
s_lshl_b32 s61,s50,15
v_lshl_add_u32 v25,v22,3,v23
s_load_dwordx2 s[4:5],s[0:1],72
s_mov_b32 s52,0
s_mov_b32 s53,s59
s_mul_i32 s54,s52,2097152
s_lshl_b32 s64,s53,8
s_add_u32 s54,s54,s64
s_lshl_b32 s64,s50,6
s_add_u32 s54,s54,s64
s_waitcnt lgkmcnt(0)
s_mov_b32 s28,s4
s_and_b32 s29,s5,0xffff
s_mov_b32 s30,0x200000
s_mov_b32 s31,0x20000
v_lshrrev_b32 v26,2,v1
v_and_b32 v27,3,v1
v_mul_u32_u24 v16,2048,v26
v_lshl_add_u32 v16,v27,4,v16
v_lshlrev_b32 v17,6,v25
v_lshl_add_u32 v17,v24,4,v17
v_add_u32 v17,s61,v17
s_xor_b32 s62,s50,0
s_mul_i32 s62,s62,524288
s_add_u32 s62,s62,s54
s_add_u32 m0,s61,0
s_nop 0
buffer_load_dwordx4 v16,s[28:31],s62 offen nt lds
s_add_u32 s62,s62,32768
s_add_u32 m0,m0,1024
s_waitcnt vmcnt(2)
buffer_load_dwordx4 v16,s[28:31],s62 offen nt lds
s_add_u32 s62,s62,32768
s_add_u32 m0,m0,1024
s_waitcnt vmcnt(2)
buffer_load_dwordx4 v16,s[28:31],s62 offen nt lds
s_add_u32 s62,s62,32768
s_add_u32 m0,m0,1024
s_waitcnt vmcnt(2)
buffer_load_dwordx4 v16,s[28:31],s62 offen nt lds
s_add_u32 s62,s62,32768
s_add_u32 m0,m0,1024
s_waitcnt vmcnt(2)
buffer_load_dwordx4 v16,s[28:31],s62 offen nt lds
s_add_u32 s62,s62,32768
s_add_u32 m0,m0,1024
s_waitcnt vmcnt(2)
buffer_load_dwordx4 v16,s[28:31],s62 offen nt lds
s_add_u32 s62,s62,32768
s_add_u32 m0,m0,1024
s_waitcnt vmcnt(2)
buffer_load_dwordx4 v16,s[28:31],s62 offen nt lds
s_add_u32 s62,s62,32768
s_add_u32 m0,m0,1024
s_waitcnt vmcnt(2)
buffer_load_dwordx4 v16,s[28:31],s62 offen nt lds
s_add_u32 s62,s62,32768
s_add_u32 m0,m0,1024
s_waitcnt vmcnt(2)
buffer_load_dwordx4 v16,s[28:31],s62 offen nt lds
s_add_u32 s62,s62,32768
s_add_u32 m0,m0,1024
s_waitcnt vmcnt(2)
buffer_load_dwordx4 v16,s[28:31],s62 offen nt lds
s_add_u32 s62,s62,32768
s_add_u32 m0,m0,1024
s_waitcnt vmcnt(2)
buffer_load_dwordx4 v16,s[28:31],s62 offen nt lds
s_add_u32 s62,s62,32768
s_add_u32 m0,m0,1024
s_waitcnt vmcnt(2)
buffer_load_dwordx4 v16,s[28:31],s62 offen nt lds
s_add_u32 s62,s62,32768
s_add_u32 m0,m0,1024
s_waitcnt vmcnt(2)
buffer_load_dwordx4 v16,s[28:31],s62 offen nt lds
s_add_u32 s62,s62,32768
s_add_u32 m0,m0,1024
s_waitcnt vmcnt(2)
buffer_load_dwordx4 v16,s[28:31],s62 offen nt lds
s_add_u32 s62,s62,32768
s_add_u32 m0,m0,1024
s_waitcnt vmcnt(2)
buffer_load_dwordx4 v16,s[28:31],s62 offen nt lds
s_add_u32 s62,s62,32768
s_add_u32 m0,m0,1024
s_waitcnt vmcnt(2)
buffer_load_dwordx4 v16,s[28:31],s62 offen nt lds
s_waitcnt vmcnt(2)
s_xor_b32 s62,s50,1
s_mul_i32 s62,s62,524288
s_add_u32 s62,s62,s54
s_add_u32 m0,s61,16384
s_nop 0
buffer_load_dwordx4 v16,s[28:31],s62 offen nt lds
s_add_u32 s62,s62,32768
s_add_u32 m0,m0,1024
s_waitcnt vmcnt(2)
buffer_load_dwordx4 v16,s[28:31],s62 offen nt lds
s_add_u32 s62,s62,32768
s_add_u32 m0,m0,1024
s_waitcnt vmcnt(2)
buffer_load_dwordx4 v16,s[28:31],s62 offen nt lds
s_add_u32 s62,s62,32768
s_add_u32 m0,m0,1024
s_waitcnt vmcnt(2)
buffer_load_dwordx4 v16,s[28:31],s62 offen nt lds
s_add_u32 s62,s62,32768
s_add_u32 m0,m0,1024
s_waitcnt vmcnt(2)
buffer_load_dwordx4 v16,s[28:31],s62 offen nt lds
s_add_u32 s62,s62,32768
s_add_u32 m0,m0,1024
s_waitcnt vmcnt(2)
buffer_load_dwordx4 v16,s[28:31],s62 offen nt lds
s_add_u32 s62,s62,32768
s_add_u32 m0,m0,1024
s_waitcnt vmcnt(2)
buffer_load_dwordx4 v16,s[28:31],s62 offen nt lds
s_add_u32 s62,s62,32768
s_add_u32 m0,m0,1024
s_waitcnt vmcnt(2)
buffer_load_dwordx4 v16,s[28:31],s62 offen nt lds
s_add_u32 s62,s62,32768
s_add_u32 m0,m0,1024
s_waitcnt vmcnt(2)
buffer_load_dwordx4 v16,s[28:31],s62 offen nt lds
s_add_u32 s62,s62,32768
s_add_u32 m0,m0,1024
s_waitcnt vmcnt(2)
buffer_load_dwordx4 v16,s[28:31],s62 offen nt lds
s_add_u32 s62,s62,32768
s_add_u32 m0,m0,1024
s_waitcnt vmcnt(2)
buffer_load_dwordx4 v16,s[28:31],s62 offen nt lds
s_add_u32 s62,s62,32768
s_add_u32 m0,m0,1024
s_waitcnt vmcnt(2)
buffer_load_dwordx4 v16,s[28:31],s62 offen nt lds
s_add_u32 s62,s62,32768
s_add_u32 m0,m0,1024
s_waitcnt vmcnt(2)
buffer_load_dwordx4 v16,s[28:31],s62 offen nt lds
s_add_u32 s62,s62,32768
s_add_u32 m0,m0,1024
s_waitcnt vmcnt(2)
buffer_load_dwordx4 v16,s[28:31],s62 offen nt lds
s_add_u32 s62,s62,32768
s_add_u32 m0,m0,1024
s_waitcnt vmcnt(2)
buffer_load_dwordx4 v16,s[28:31],s62 offen nt lds
s_add_u32 s62,s62,32768
s_add_u32 m0,m0,1024
s_waitcnt vmcnt(2)
buffer_load_dwordx4 v16,s[28:31],s62 offen nt lds
s_waitcnt vmcnt(2)
s_waitcnt vmcnt(16)
ds_read_b64_tr_b16 a[0:1],v17 offset:0
ds_read_b64_tr_b16 a[2:3],v17 offset:256
ds_read_b64_tr_b16 a[4:5],v17 offset:8
ds_read_b64_tr_b16 a[6:7],v17 offset:264
ds_read_b64_tr_b16 a[8:9],v17 offset:2048
ds_read_b64_tr_b16 a[10:11],v17 offset:2304
ds_read_b64_tr_b16 a[12:13],v17 offset:2056
ds_read_b64_tr_b16 a[14:15],v17 offset:2312
ds_read_b64_tr_b16 a[16:17],v17 offset:4096
ds_read_b64_tr_b16 a[18:19],v17 offset:4352
ds_read_b64_tr_b16 a[20:21],v17 offset:4104
ds_read_b64_tr_b16 a[22:23],v17 offset:4360
s_waitcnt lgkmcnt(0)
ds_read_b64_tr_b16 a[24:25],v17 offset:6144
ds_read_b64_tr_b16 a[26:27],v17 offset:6400
ds_read_b64_tr_b16 a[28:29],v17 offset:6152
ds_read_b64_tr_b16 a[30:31],v17 offset:6408
ds_read_b64_tr_b16 a[32:33],v17 offset:8192
ds_read_b64_tr_b16 a[34:35],v17 offset:8448
ds_read_b64_tr_b16 a[36:37],v17 offset:8200
ds_read_b64_tr_b16 a[38:39],v17 offset:8456
ds_read_b64_tr_b16 a[40:41],v17 offset:10240
ds_read_b64_tr_b16 a[42:43],v17 offset:10496
ds_read_b64_tr_b16 a[44:45],v17 offset:10248
ds_read_b64_tr_b16 a[46:47],v17 offset:10504
s_waitcnt lgkmcnt(0)
ds_read_b64_tr_b16 a[48:49],v17 offset:12288
ds_read_b64_tr_b16 a[50:51],v17 offset:12544
ds_read_b64_tr_b16 a[52:53],v17 offset:12296
ds_read_b64_tr_b16 a[54:55],v17 offset:12552
ds_read_b64_tr_b16 a[56:57],v17 offset:14336
ds_read_b64_tr_b16 a[58:59],v17 offset:14592
ds_read_b64_tr_b16 a[60:61],v17 offset:14344
ds_read_b64_tr_b16 a[62:63],v17 offset:14600
s_waitcnt lgkmcnt(0)
s_xor_b32 s62,s50,2
s_mul_i32 s62,s62,524288
s_add_u32 s62,s62,s54
s_add_u32 m0,s61,0
s_nop 0
buffer_load_dwordx4 v16,s[28:31],s62 offen nt lds
s_add_u32 s62,s62,32768
s_add_u32 m0,m0,1024
s_waitcnt vmcnt(2)
buffer_load_dwordx4 v16,s[28:31],s62 offen nt lds
s_add_u32 s62,s62,32768
s_add_u32 m0,m0,1024
s_waitcnt vmcnt(2)
buffer_load_dwordx4 v16,s[28:31],s62 offen nt lds
s_add_u32 s62,s62,32768
s_add_u32 m0,m0,1024
s_waitcnt vmcnt(2)
buffer_load_dwordx4 v16,s[28:31],s62 offen nt lds
s_add_u32 s62,s62,32768
s_add_u32 m0,m0,1024
s_waitcnt vmcnt(2)
buffer_load_dwordx4 v16,s[28:31],s62 offen nt lds
s_add_u32 s62,s62,32768
s_add_u32 m0,m0,1024
s_waitcnt vmcnt(2)
buffer_load_dwordx4 v16,s[28:31],s62 offen nt lds
s_add_u32 s62,s62,32768
s_add_u32 m0,m0,1024
s_waitcnt vmcnt(2)
buffer_load_dwordx4 v16,s[28:31],s62 offen nt lds
s_add_u32 s62,s62,32768
s_add_u32 m0,m0,1024
s_waitcnt vmcnt(2)
buffer_load_dwordx4 v16,s[28:31],s62 offen nt lds
s_add_u32 s62,s62,32768
s_add_u32 m0,m0,1024
s_waitcnt vmcnt(2)
buffer_load_dwordx4 v16,s[28:31],s62 offen nt lds
s_add_u32 s62,s62,32768
s_add_u32 m0,m0,1024
s_waitcnt vmcnt(2)
buffer_load_dwordx4 v16,s[28:31],s62 offen nt lds
s_add_u32 s62,s62,32768
s_add_u32 m0,m0,1024
s_waitcnt vmcnt(2)
buffer_load_dwordx4 v16,s[28:31],s62 offen nt lds
s_add_u32 s62,s62,32768
s_add_u32 m0,m0,1024
s_waitcnt vmcnt(2)
buffer_load_dwordx4 v16,s[28:31],s62 offen nt lds
s_add_u32 s62,s62,32768
s_add_u32 m0,m0,1024
s_waitcnt vmcnt(2)
buffer_load_dwordx4 v16,s[28:31],s62 offen nt lds
s_add_u32 s62,s62,32768
s_add_u32 m0,m0,1024
s_waitcnt vmcnt(2)
buffer_load_dwordx4 v16,s[28:31],s62 offen nt lds
s_add_u32 s62,s62,32768
s_add_u32 m0,m0,1024
s_waitcnt vmcnt(2)
buffer_load_dwordx4 v16,s[28:31],s62 offen nt lds
s_add_u32 s62,s62,32768
s_add_u32 m0,m0,1024
s_waitcnt vmcnt(2)
buffer_load_dwordx4 v16,s[28:31],s62 offen nt lds
s_waitcnt vmcnt(2)
s_waitcnt vmcnt(16)
ds_read_b64_tr_b16 a[64:65],v17 offset:16384
ds_read_b64_tr_b16 a[66:67],v17 offset:16640
ds_read_b64_tr_b16 a[68:69],v17 offset:16392
ds_read_b64_tr_b16 a[70:71],v17 offset:16648
ds_read_b64_tr_b16 a[72:73],v17 offset:18432
ds_read_b64_tr_b16 a[74:75],v17 offset:18688
ds_read_b64_tr_b16 a[76:77],v17 offset:18440
ds_read_b64_tr_b16 a[78:79],v17 offset:18696
ds_read_b64_tr_b16 a[80:81],v17 offset:20480
ds_read_b64_tr_b16 a[82:83],v17 offset:20736
ds_read_b64_tr_b16 a[84:85],v17 offset:20488
ds_read_b64_tr_b16 a[86:87],v17 offset:20744
s_waitcnt lgkmcnt(0)
ds_read_b64_tr_b16 a[88:89],v17 offset:22528
ds_read_b64_tr_b16 a[90:91],v17 offset:22784
ds_read_b64_tr_b16 a[92:93],v17 offset:22536
ds_read_b64_tr_b16 a[94:95],v17 offset:22792
ds_read_b64_tr_b16 a[96:97],v17 offset:24576
ds_read_b64_tr_b16 a[98:99],v17 offset:24832
ds_read_b64_tr_b16 a[100:101],v17 offset:24584
ds_read_b64_tr_b16 a[102:103],v17 offset:24840
ds_read_b64_tr_b16 a[104:105],v17 offset:26624
ds_read_b64_tr_b16 a[106:107],v17 offset:26880
ds_read_b64_tr_b16 a[108:109],v17 offset:26632
ds_read_b64_tr_b16 a[110:111],v17 offset:26888
s_waitcnt lgkmcnt(0)
ds_read_b64_tr_b16 a[112:113],v17 offset:28672
ds_read_b64_tr_b16 a[114:115],v17 offset:28928
ds_read_b64_tr_b16 a[116:117],v17 offset:28680
ds_read_b64_tr_b16 a[118:119],v17 offset:28936
ds_read_b64_tr_b16 a[120:121],v17 offset:30720
ds_read_b64_tr_b16 a[122:123],v17 offset:30976
ds_read_b64_tr_b16 a[124:125],v17 offset:30728
ds_read_b64_tr_b16 a[126:127],v17 offset:30984
s_waitcnt lgkmcnt(0)
s_xor_b32 s62,s50,3
s_mul_i32 s62,s62,524288
s_add_u32 s62,s62,s54
s_add_u32 m0,s61,16384
s_nop 0
buffer_load_dwordx4 v16,s[28:31],s62 offen nt lds
s_add_u32 s62,s62,32768
s_add_u32 m0,m0,1024
s_waitcnt vmcnt(2)
buffer_load_dwordx4 v16,s[28:31],s62 offen nt lds
s_add_u32 s62,s62,32768
s_add_u32 m0,m0,1024
s_waitcnt vmcnt(2)
buffer_load_dwordx4 v16,s[28:31],s62 offen nt lds
s_add_u32 s62,s62,32768
s_add_u32 m0,m0,1024
s_waitcnt vmcnt(2)
buffer_load_dwordx4 v16,s[28:31],s62 offen nt lds
s_add_u32 s62,s62,32768
s_add_u32 m0,m0,1024
s_waitcnt vmcnt(2)
buffer_load_dwordx4 v16,s[28:31],s62 offen nt lds
s_add_u32 s62,s62,32768
s_add_u32 m0,m0,1024
s_waitcnt vmcnt(2)
buffer_load_dwordx4 v16,s[28:31],s62 offen nt lds
s_add_u32 s62,s62,32768
s_add_u32 m0,m0,1024
s_waitcnt vmcnt(2)
buffer_load_dwordx4 v16,s[28:31],s62 offen nt lds
s_add_u32 s62,s62,32768
s_add_u32 m0,m0,1024
s_waitcnt vmcnt(2)
buffer_load_dwordx4 v16,s[28:31],s62 offen nt lds
s_add_u32 s62,s62,32768
s_add_u32 m0,m0,1024
s_waitcnt vmcnt(2)
buffer_load_dwordx4 v16,s[28:31],s62 offen nt lds
s_add_u32 s62,s62,32768
s_add_u32 m0,m0,1024
s_waitcnt vmcnt(2)
buffer_load_dwordx4 v16,s[28:31],s62 offen nt lds
s_add_u32 s62,s62,32768
s_add_u32 m0,m0,1024
s_waitcnt vmcnt(2)
buffer_load_dwordx4 v16,s[28:31],s62 offen nt lds
s_add_u32 s62,s62,32768
s_add_u32 m0,m0,1024
s_waitcnt vmcnt(2)
buffer_load_dwordx4 v16,s[28:31],s62 offen nt lds
s_add_u32 s62,s62,32768
s_add_u32 m0,m0,1024
s_waitcnt vmcnt(2)
buffer_load_dwordx4 v16,s[28:31],s62 offen nt lds
s_add_u32 s62,s62,32768
s_add_u32 m0,m0,1024
s_waitcnt vmcnt(2)
buffer_load_dwordx4 v16,s[28:31],s62 offen nt lds
s_add_u32 s62,s62,32768
s_add_u32 m0,m0,1024
s_waitcnt vmcnt(2)
buffer_load_dwordx4 v16,s[28:31],s62 offen nt lds
s_add_u32 s62,s62,32768
s_add_u32 m0,m0,1024
s_waitcnt vmcnt(2)
buffer_load_dwordx4 v16,s[28:31],s62 offen nt lds
s_waitcnt vmcnt(2)
s_waitcnt vmcnt(16)
ds_read_b64_tr_b16 a[128:129],v17 offset:0
ds_read_b64_tr_b16 a[130:131],v17 offset:256
ds_read_b64_tr_b16 a[132:133],v17 offset:8
ds_read_b64_tr_b16 a[134:135],v17 offset:264
ds_read_b64_tr_b16 a[136:137],v17 offset:2048
ds_read_b64_tr_b16 a[138:139],v17 offset:2304
ds_read_b64_tr_b16 a[140:141],v17 offset:2056
ds_read_b64_tr_b16 a[142:143],v17 offset:2312
ds_read_b64_tr_b16 a[144:145],v17 offset:4096
ds_read_b64_tr_b16 a[146:147],v17 offset:4352
ds_read_b64_tr_b16 a[148:149],v17 offset:4104
ds_read_b64_tr_b16 a[150:151],v17 offset:4360
s_waitcnt lgkmcnt(0)
ds_read_b64_tr_b16 a[152:153],v17 offset:6144
ds_read_b64_tr_b16 a[154:155],v17 offset:6400
ds_read_b64_tr_b16 a[156:157],v17 offset:6152
ds_read_b64_tr_b16 a[158:159],v17 offset:6408
ds_read_b64_tr_b16 a[160:161],v17 offset:8192
ds_read_b64_tr_b16 a[162:163],v17 offset:8448
ds_read_b64_tr_b16 a[164:165],v17 offset:8200
ds_read_b64_tr_b16 a[166:167],v17 offset:8456
ds_read_b64_tr_b16 a[168:169],v17 offset:10240
ds_read_b64_tr_b16 a[170:171],v17 offset:10496
ds_read_b64_tr_b16 a[172:173],v17 offset:10248
ds_read_b64_tr_b16 a[174:175],v17 offset:10504
s_waitcnt lgkmcnt(0)
ds_read_b64_tr_b16 a[176:177],v17 offset:12288
ds_read_b64_tr_b16 a[178:179],v17 offset:12544
ds_read_b64_tr_b16 a[180:181],v17 offset:12296
ds_read_b64_tr_b16 a[182:183],v17 offset:12552
ds_read_b64_tr_b16 a[184:185],v17 offset:14336
ds_read_b64_tr_b16 a[186:187],v17 offset:14592
ds_read_b64_tr_b16 a[188:189],v17 offset:14344
ds_read_b64_tr_b16 a[190:191],v17 offset:14600
s_waitcnt lgkmcnt(0)
s_waitcnt vmcnt(0)
ds_read_b64_tr_b16 a[192:193],v17 offset:16384
ds_read_b64_tr_b16 a[194:195],v17 offset:16640
ds_read_b64_tr_b16 a[196:197],v17 offset:16392
ds_read_b64_tr_b16 a[198:199],v17 offset:16648
ds_read_b64_tr_b16 a[200:201],v17 offset:18432
ds_read_b64_tr_b16 a[202:203],v17 offset:18688
ds_read_b64_tr_b16 a[204:205],v17 offset:18440
ds_read_b64_tr_b16 a[206:207],v17 offset:18696
ds_read_b64_tr_b16 a[208:209],v17 offset:20480
ds_read_b64_tr_b16 a[210:211],v17 offset:20736
ds_read_b64_tr_b16 a[212:213],v17 offset:20488
ds_read_b64_tr_b16 a[214:215],v17 offset:20744
s_waitcnt lgkmcnt(0)
ds_read_b64_tr_b16 a[216:217],v17 offset:22528
ds_read_b64_tr_b16 a[218:219],v17 offset:22784
ds_read_b64_tr_b16 a[220:221],v17 offset:22536
ds_read_b64_tr_b16 a[222:223],v17 offset:22792
ds_read_b64_tr_b16 a[224:225],v17 offset:24576
ds_read_b64_tr_b16 a[226:227],v17 offset:24832
ds_read_b64_tr_b16 a[228:229],v17 offset:24584
ds_read_b64_tr_b16 a[230:231],v17 offset:24840
ds_read_b64_tr_b16 a[232:233],v17 offset:26624
ds_read_b64_tr_b16 a[234:235],v17 offset:26880
ds_read_b64_tr_b16 a[236:237],v17 offset:26632
ds_read_b64_tr_b16 a[238:239],v17 offset:26888
s_waitcnt lgkmcnt(0)
ds_read_b64_tr_b16 a[240:241],v17 offset:28672
ds_read_b64_tr_b16 a[242:243],v17 offset:28928
ds_read_b64_tr_b16 a[244:245],v17 offset:28680
ds_read_b64_tr_b16 a[246:247],v17 offset:28936
ds_read_b64_tr_b16 a[248:249],v17 offset:30720
ds_read_b64_tr_b16 a[250:251],v17 offset:30976
ds_read_b64_tr_b16 a[252:253],v17 offset:30728
ds_read_b64_tr_b16 a[254:255],v17 offset:30984
s_waitcnt lgkmcnt(0)
s_mov_b32 s92,s2
s_and_b32 s93,s3,0xffff
s_mov_b32 s94,0x100
s_mov_b32 s95,0x20000
v_mbcnt_lo_u32_b32 v16,-1,0
v_mbcnt_hi_u32_b32 v16,-1,v16
v_mov_b32 v18,0
v_cmp_eq_u32 vcc,22,v16
s_nop 1
v_cndmask_b32 v18,v18,63,vcc
v_cmp_eq_u32 vcc,17,v16
s_nop 1
v_cndmask_b32 v18,v18,63,vcc
v_cmp_eq_u32 vcc,18,v16
s_nop 1
v_cndmask_b32 v18,v18,1,vcc
v_and_b32 v19,1,v16
v_cmp_eq_u32 vcc,1,v19
v_mov_b32 v19,8192
s_nop 0
v_cndmask_b32 v19,-1,v19,vcc
v_min_u32 v16,31,v16
v_lshlrev_b32 v16,2,v16
s_sub_u32 s66,s88,64
s_cmp_lg_u32 s50,0
s_cbranch_scc1 vot_351
vpoll_347:
buffer_load_dword v17,v16,s[92:95],s66 offen sc1
s_waitcnt vmcnt(0)
s_cmp_lg_u32 s56,2
s_cbranch_scc1 vck_348
v_cmp_eq_u32 vcc,v17,v19
s_and_b32 s64,vcc_lo,0xffff
s_cmp_eq_u32 s64,65535
s_cbranch_scc1 vck_348
s_mov_b32 s65,0
v_readlane_b32 s64,v17,1
s_lshr_b32 s64,s64,8
s_add_u32 s65,s65,s64
v_readlane_b32 s64,v17,3
s_lshr_b32 s64,s64,8
s_add_u32 s65,s65,s64
v_readlane_b32 s64,v17,5
s_lshr_b32 s64,s64,8
s_add_u32 s65,s65,s64
v_readlane_b32 s64,v17,7
s_lshr_b32 s64,s64,8
s_add_u32 s65,s65,s64
v_readlane_b32 s64,v17,9
s_lshr_b32 s64,s64,8
s_add_u32 s65,s65,s64
v_readlane_b32 s64,v17,11
s_lshr_b32 s64,s64,8
s_add_u32 s65,s65,s64
v_readlane_b32 s64,v17,13
s_lshr_b32 s64,s64,8
s_add_u32 s65,s65,s64
v_readlane_b32 s64,v17,15
s_lshr_b32 s64,s64,8
s_add_u32 s65,s65,s64
s_cmp_ge_u32 s65,256
s_cbranch_scc1 vok_350
s_branch vrt_349
vck_348:
v_cmp_gt_u32 vcc,v18,v17
s_cbranch_vccz vok_350
vrt_349:
s_sleep 48
s_sub_u32 s90,s90,1
s_cmp_gt_i32 s90,0
s_cbranch_scc1 vpoll_347
vok_350:
v_add_u32 v18,160768,v16
ds_write_b32 v18,v17
s_waitcnt lgkmcnt(0)
vot_351:
s_barrier
v_add_u32 v18,160768,v16
ds_read_b32 v17,v18
s_waitcnt lgkmcnt(0)
s_cmp_lg_u32 s56,2
s_cbranch_scc1 vfin_352
v_cmp_eq_u32 vcc,v17,v19
s_and_b32 s64,vcc_lo,0xffff
s_cmp_eq_u32 s64,65535
s_cbranch_scc1 vfin_352
s_mov_b32 s65,0
v_readlane_b32 s64,v17,1
s_lshr_b32 s64,s64,8
s_add_u32 s65,s65,s64
v_readlane_b32 s64,v17,3
s_lshr_b32 s64,s64,8
s_add_u32 s65,s65,s64
v_readlane_b32 s64,v17,5
s_lshr_b32 s64,s64,8
s_add_u32 s65,s65,s64
v_readlane_b32 s64,v17,7
s_lshr_b32 s64,s64,8
s_add_u32 s65,s65,s64
v_readlane_b32 s64,v17,9
s_lshr_b32 s64,s64,8
s_add_u32 s65,s65,s64
v_readlane_b32 s64,v17,11
s_lshr_b32 s64,s64,8
s_add_u32 s65,s65,s64
v_readlane_b32 s64,v17,13
s_lshr_b32 s64,s64,8
s_add_u32 s65,s65,s64
v_readlane_b32 s64,v17,15
s_lshr_b32 s64,s64,8
s_add_u32 s65,s65,s64
s_cmp_ge_u32 s65,256
s_cbranch_scc1 fl_fb
vfin_352:
s_and_b32 s56,s56,1
s_mov_b32 s67,0
s_barrier
v_lshlrev_b32 v0,4,v1
s_mov_b32 s60,0
s_lshl_b32 s70,s50,13
s_mov_b32 s55,0
v_mov_b32 v3,v0
s_mov_b32 s73,0xffff0000
s_lshl_b32 s64,s52,2
s_add_u32 s64,s64,s50
s_mul_i32 s61,s64,8192
s_add_u32 s61,s61,209747968
s_lshl_b32 s68,s64,8
s_add_u32 s68,s68,138549248
s_lshl_b32 s83,s53,2
s_add_u32 s83,s83,s50
s_mov_b32 s63,0
s_xor_b32 s64,s50,0
s_lshl_b32 s64,s64,13
v_add_u32 v8,s64,v0
v_mov_b32 v4,v8
s_xor_b32 s64,s50,1
s_lshl_b32 s64,s64,13
v_add_u32 v9,s64,v0
v_mov_b32 v5,v9
s_xor_b32 s64,s50,2
s_lshl_b32 s64,s64,13
v_add_u32 v10,s64,v0
v_mov_b32 v6,v10
s_xor_b32 s64,s50,3
s_lshl_b32 s64,s64,13
v_add_u32 v11,s64,v0
v_mov_b32 v7,v11
v_min_u32 v2,7,v1
v_lshlrev_b32 v2,7,v2
s_mul_i32 s68,s50,1024
s_add_u32 s68,s68,138559488
s_lshr_b32 s64,s50,1
s_add_u32 s64,s64,1
s_sub_u32 s65,0,s64
s_bitcmp1_b32 s50,0
s_cselect_b32 s64,s64,s65
s_add_u32 s64,s64,16
v_add_u32 v26,s64,v21
v_lshrrev_b32 v27,4,v26
v_and_b32 v26,15,v26
v_lshl_add_u32 v26,v22,4,v26
v_lshlrev_b32 v26,4,v26
v_lshl_add_u32 v3,v27,15,v26
s_sub_u32 s61,s61,32768
s_and_b32 s64,s50,1
s_add_u32 s74,s64,1
s_add_u32 s75,s64,2
s_add_u32 s76,s64,3
s_add_u32 s62,s61,4096
s_lshl_b32 s66,s83,10
s_lshr_b32 s65,s83,3
s_lshl_b32 s65,s65,8
s_and_b32 s64,s83,7
s_lshl_b32 s64,s64,2
s_add_u32 s69,s64,s65
s_add_u32 s69,s69,138550272
s_add_u32 s82,s66,205520896
s_add_u32 s66,s66,214958080
v_cmp_eq_u32 vcc,0,v1
s_nop 1
v_cndmask_b32 v26,2.0,0,vcc
s_add_u32 s71,s60,s74
s_cmp_eq_u32 s60,127
s_cselect_b32 s71,128,s71
s_add_u32 s53,s60,s75
s_cmp_eq_u32 s60,126
s_cselect_b32 s53,128,s53
plp_360:
buffer_load_dword v16,v2,s[20:23],s68 offen sc1
s_waitcnt vmcnt(0)
v_cmp_gt_u32 vcc,s71,v16
s_cbranch_vccz pok_361
s_sleep 4
s_sub_u32 s90,s90,1
s_cmp_gt_i32 s90,0
s_cbranch_scc1 plp_360
pok_361:
lag_357:
s_mov_b32 m0,s70
s_nop 0
buffer_load_dwordx4 v3,s[20:23],s61 offen offset:0 lds
buffer_load_dwordx4 v3,s[20:23],s61 offen offset:1024 lds
buffer_load_dwordx4 v3,s[20:23],s61 offen offset:2048 lds
buffer_load_dwordx4 v3,s[20:23],s61 offen offset:3072 lds
s_add_u32 m0,s70,4096
s_nop 0
buffer_load_dwordx4 v3,s[20:23],s62 offen offset:0 lds
buffer_load_dwordx4 v3,s[20:23],s62 offen offset:1024 lds
buffer_load_dwordx4 v3,s[20:23],s62 offen offset:2048 lds
buffer_load_dwordx4 v3,s[20:23],s62 offen offset:3072 lds
s_add_u32 s61,s61,32768
s_add_u32 s62,s62,32768
s_add_u32 s70,s70,32768
s_and_b32 s70,s70,0x1ffff
buffer_load_dword v23,off,s[20:23],s66
buffer_load_dword v23,off,s[20:23],s66
dec_358:
v_cmp_gt_u32 vcc,s53,v16
s_cbranch_vccnz BN_356
BR_355:
s_waitcnt vmcnt(9)
ds_read_b128 v[64:67],v4 offset:0
s_waitcnt vmcnt(8)
ds_read_b128 v[68:71],v4 offset:1024
s_waitcnt vmcnt(7)
ds_read_b128 v[72:75],v4 offset:2048
s_waitcnt vmcnt(6)
ds_read_b128 v[76:79],v4 offset:3072
s_waitcnt lgkmcnt(3)
v_mfma_f32_16x16x32_bf16 v[32:35],a[0:3],v[64:67],0
s_add_u32 s71,s60,s75
s_cmp_eq_u32 s60,126
s_cselect_b32 s71,128,s71
buffer_load_dwordx4 v[160:163],v0,s[20:23],s82 offen
v_mfma_f32_16x16x32_bf16 v[36:39],a[4:7],v[64:67],0
s_waitcnt lgkmcnt(2)
s_waitcnt vmcnt(6)
s_mov_b32 m0,s70
s_add_u32 s82,s82,32768
ds_read_b128 v[80:83],v4 offset:4096
v_mfma_f32_16x16x32_bf16 v[32:35],a[8:11],v[68:71],v[32:35]
s_add_u32 s53,s60,s76
s_cmp_eq_u32 s60,125
s_cselect_b32 s53,128,s53
buffer_load_dwordx4 v3,s[20:23],s61 offen offset:0 lds
v_mfma_f32_16x16x32_bf16 v[36:39],a[12:15],v[68:71],v[36:39]
s_waitcnt lgkmcnt(2)
s_waitcnt vmcnt(6)
ds_read_b128 v[84:87],v4 offset:5120
v_mfma_f32_16x16x32_bf16 v[32:35],a[16:19],v[72:75],v[32:35]
s_mov_b32 s57,s63
buffer_load_dwordx4 v3,s[20:23],s61 offen offset:1024 lds
v_mfma_f32_16x16x32_bf16 v[36:39],a[20:23],v[72:75],v[36:39]
s_waitcnt lgkmcnt(2)
s_waitcnt vmcnt(6)
ds_read_b128 v[88:91],v4 offset:6144
v_mfma_f32_16x16x32_bf16 v[32:35],a[24:27],v[76:79],v[32:35]
buffer_load_dwordx4 v3,s[20:23],s61 offen offset:2048 lds
v_mfma_f32_16x16x32_bf16 v[36:39],a[28:31],v[76:79],v[36:39]
s_waitcnt lgkmcnt(2)
s_waitcnt vmcnt(6)
ds_read_b128 v[92:95],v4 offset:7168
v_mfma_f32_16x16x32_bf16 v[32:35],a[32:35],v[80:83],v[32:35]
buffer_load_dwordx4 v3,s[20:23],s61 offen offset:3072 lds
v_mfma_f32_16x16x32_bf16 v[36:39],a[36:39],v[80:83],v[36:39]
s_waitcnt lgkmcnt(2)
s_barrier
s_add_u32 m0,s70,4096
ds_read_b128 v[96:99],v5 offset:0
v_mfma_f32_16x16x32_bf16 v[32:35],a[40:43],v[84:87],v[32:35]
ds_read_b128 v[100:103],v5 offset:1024
buffer_load_dwordx4 v3,s[20:23],s62 offen offset:0 lds
v_mfma_f32_16x16x32_bf16 v[36:39],a[44:47],v[84:87],v[36:39]
s_waitcnt lgkmcnt(3)
ds_read_b128 v[104:107],v5 offset:2048
buffer_load_dwordx4 v3,s[20:23],s62 offen offset:1024 lds
v_mfma_f32_16x16x32_bf16 v[32:35],a[48:51],v[88:91],v[32:35]
ds_read_b128 v[108:111],v5 offset:3072
v_mfma_f32_16x16x32_bf16 v[36:39],a[52:55],v[88:91],v[36:39]
s_waitcnt lgkmcnt(4)
ds_read_b128 v[112:115],v5 offset:4096
buffer_load_dwordx4 v3,s[20:23],s62 offen offset:2048 lds
v_mfma_f32_16x16x32_bf16 v[32:35],a[56:59],v[92:95],v[32:35]
ds_read_b128 v[116:119],v5 offset:5120
v_mfma_f32_16x16x32_bf16 v[36:39],a[60:63],v[92:95],v[36:39]
s_waitcnt lgkmcnt(5)
buffer_load_dwordx4 v3,s[20:23],s62 offen offset:3072 lds
v_mfma_f32_16x16x32_bf16 v[32:35],a[64:67],v[96:99],v[32:35]
ds_read_b128 v[120:123],v5 offset:6144
v_mfma_f32_16x16x32_bf16 v[36:39],a[68:71],v[96:99],v[36:39]
s_waitcnt lgkmcnt(5)
v_mfma_f32_16x16x32_bf16 v[32:35],a[72:75],v[100:103],v[32:35]
ds_read_b128 v[124:127],v5 offset:7168
v_mfma_f32_16x16x32_bf16 v[36:39],a[76:79],v[100:103],v[36:39]
s_waitcnt lgkmcnt(5)
v_mfma_f32_16x16x32_bf16 v[32:35],a[80:83],v[104:107],v[32:35]
ds_read_b128 v[64:67],v6 offset:0
v_mfma_f32_16x16x32_bf16 v[36:39],a[84:87],v[104:107],v[36:39]
s_waitcnt lgkmcnt(5)
v_mfma_f32_16x16x32_bf16 v[32:35],a[88:91],v[108:111],v[32:35]
ds_read_b128 v[68:71],v6 offset:1024
v_mfma_f32_16x16x32_bf16 v[36:39],a[92:95],v[108:111],v[36:39]
s_waitcnt lgkmcnt(5)
v_mfma_f32_16x16x32_bf16 v[32:35],a[96:99],v[112:115],v[32:35]
ds_read_b128 v[72:75],v6 offset:2048
buffer_load_dword v16,v2,s[20:23],s68 offen sc1
v_mfma_f32_16x16x32_bf16 v[36:39],a[100:103],v[112:115],v[36:39]
s_waitcnt lgkmcnt(5)
v_mfma_f32_16x16x32_bf16 v[32:35],a[104:107],v[116:119],v[32:35]
ds_read_b128 v[76:79],v6 offset:3072
v_mfma_f32_16x16x32_bf16 v[36:39],a[108:111],v[116:119],v[36:39]
s_waitcnt lgkmcnt(5)
v_mfma_f32_16x16x32_bf16 v[32:35],a[112:115],v[120:123],v[32:35]
ds_read_b128 v[80:83],v6 offset:4096
v_mfma_f32_16x16x32_bf16 v[36:39],a[116:119],v[120:123],v[36:39]
s_waitcnt lgkmcnt(5)
v_mfma_f32_16x16x32_bf16 v[32:35],a[120:123],v[124:127],v[32:35]
ds_read_b128 v[84:87],v6 offset:5120
v_mfma_f32_16x16x32_bf16 v[36:39],a[124:127],v[124:127],v[36:39]
s_waitcnt lgkmcnt(5)
v_mfma_f32_16x16x32_bf16 v[32:35],a[128:131],v[64:67],v[32:35]
ds_read_b128 v[88:91],v6 offset:6144
v_mfma_f32_16x16x32_bf16 v[36:39],a[132:135],v[64:67],v[36:39]
s_waitcnt lgkmcnt(5)
v_mfma_f32_16x16x32_bf16 v[32:35],a[136:139],v[68:71],v[32:35]
ds_read_b128 v[92:95],v6 offset:7168
v_mfma_f32_16x16x32_bf16 v[36:39],a[140:143],v[68:71],v[36:39]
s_waitcnt lgkmcnt(5)
v_mfma_f32_16x16x32_bf16 v[32:35],a[144:147],v[72:75],v[32:35]
ds_read_b128 v[96:99],v7 offset:0
v_mfma_f32_16x16x32_bf16 v[36:39],a[148:151],v[72:75],v[36:39]
s_waitcnt lgkmcnt(5)
s_waitcnt vmcnt(11)
v_mov_b32 v17,s57
buffer_store_dword v17,v26,s[20:23],s69 offen sc1
v_mfma_f32_16x16x32_bf16 v[32:35],a[152:155],v[76:79],v[32:35]
ds_read_b128 v[100:103],v7 offset:1024
v_mfma_f32_16x16x32_bf16 v[36:39],a[156:159],v[76:79],v[36:39]
s_waitcnt lgkmcnt(5)
v_mfma_f32_16x16x32_bf16 v[32:35],a[160:163],v[80:83],v[32:35]
ds_read_b128 v[104:107],v7 offset:2048
v_mfma_f32_16x16x32_bf16 v[36:39],a[164:167],v[80:83],v[36:39]
s_waitcnt lgkmcnt(5)
v_mfma_f32_16x16x32_bf16 v[32:35],a[168:171],v[84:87],v[32:35]
ds_read_b128 v[108:111],v7 offset:3072
v_mfma_f32_16x16x32_bf16 v[36:39],a[172:175],v[84:87],v[36:39]
s_waitcnt lgkmcnt(5)
v_mfma_f32_16x16x32_bf16 v[32:35],a[176:179],v[88:91],v[32:35]
ds_read_b128 v[112:115],v7 offset:4096
v_mfma_f32_16x16x32_bf16 v[36:39],a[180:183],v[88:91],v[36:39]
s_waitcnt lgkmcnt(5)
v_mfma_f32_16x16x32_bf16 v[32:35],a[184:187],v[92:95],v[32:35]
ds_read_b128 v[116:119],v7 offset:5120
v_mfma_f32_16x16x32_bf16 v[36:39],a[188:191],v[92:95],v[36:39]
s_waitcnt lgkmcnt(5)
v_mfma_f32_16x16x32_bf16 v[32:35],a[192:195],v[96:99],v[32:35]
ds_read_b128 v[120:123],v7 offset:6144
v_mfma_f32_16x16x32_bf16 v[36:39],a[196:199],v[96:99],v[36:39]
s_waitcnt lgkmcnt(5)
v_mfma_f32_16x16x32_bf16 v[32:35],a[200:203],v[100:103],v[32:35]
s_waitcnt vmcnt(10)
ds_read_b128 v[124:127],v7 offset:7168
v_lshlrev_b32 v168,16,v160
v_mfma_f32_16x16x32_bf16 v[36:39],a[204:207],v[100:103],v[36:39]
s_waitcnt lgkmcnt(5)
v_and_b32 v169,s73,v160
v_lshlrev_b32 v170,16,v161
v_mfma_f32_16x16x32_bf16 v[32:35],a[208:211],v[104:107],v[32:35]
s_add_u32 s61,s61,32768
v_and_b32 v171,s73,v161
v_lshlrev_b32 v172,16,v162
v_mfma_f32_16x16x32_bf16 v[36:39],a[212:215],v[104:107],v[36:39]
s_waitcnt lgkmcnt(4)
v_and_b32 v173,s73,v162
v_lshlrev_b32 v174,16,v163
v_mfma_f32_16x16x32_bf16 v[32:35],a[216:219],v[108:111],v[32:35]
s_add_u32 s62,s62,32768
s_add_u32 s70,s70,32768
v_and_b32 v175,s73,v163
v_mfma_f32_16x16x32_bf16 v[36:39],a[220:223],v[108:111],v[36:39]
s_waitcnt lgkmcnt(3)
s_and_b32 s70,s70,0x1ffff
s_add_u32 s55,s55,32768
v_mfma_f32_16x16x32_bf16 v[32:35],a[224:227],v[112:115],v[32:35]
s_and_b32 s55,s55,0x1ffff
v_add_u32 v4,s55,v8
v_add_u32 v5,s55,v9
v_mfma_f32_16x16x32_bf16 v[36:39],a[228:231],v[112:115],v[36:39]
s_waitcnt lgkmcnt(2)
v_add_u32 v6,s55,v10
v_add_u32 v7,s55,v11
v_mfma_f32_16x16x32_bf16 v[32:35],a[232:235],v[116:119],v[32:35]
s_waitcnt vmcnt(9)
ds_read_b128 v[64:67],v4 offset:0
v_mfma_f32_16x16x32_bf16 v[36:39],a[236:239],v[116:119],v[36:39]
s_waitcnt lgkmcnt(2)
s_waitcnt vmcnt(8)
ds_read_b128 v[68:71],v4 offset:1024
v_mfma_f32_16x16x32_bf16 v[32:35],a[240:243],v[120:123],v[32:35]
s_waitcnt vmcnt(7)
ds_read_b128 v[72:75],v4 offset:2048
v_mfma_f32_16x16x32_bf16 v[36:39],a[244:247],v[120:123],v[36:39]
s_waitcnt lgkmcnt(3)
v_mfma_f32_16x16x32_bf16 v[40:43],a[248:251],v[124:127],v[32:35]
v_mfma_f32_16x16x32_bf16 v[44:47],a[252:255],v[124:127],v[36:39]
s_waitcnt vmcnt(1)
v_cmp_gt_u32 vcc,s53,v16
s_add_u32 s60,s60,1
s_cbranch_vccnz WN_354
.p2align 6
WR_353:
s_waitcnt lgkmcnt(2)
v_mfma_f32_16x16x32_bf16 v[32:35],a[0:3],v[64:67],0
s_waitcnt vmcnt(6)
s_mov_b32 m0,s70
ds_read_b128 v[76:79],v4 offset:3072
v_mfma_f32_16x16x32_bf16 v[36:39],a[4:7],v[64:67],0
s_waitcnt lgkmcnt(2)
s_add_u32 s71,s60,s75
s_cmp_eq_u32 s60,126
s_cselect_b32 s71,128,s71
buffer_load_dwordx4 v3,s[20:23],s61 offen offset:0 lds
v_mfma_f32_16x16x32_bf16 v[32:35],a[8:11],v[68:71],v[32:35]
s_waitcnt vmcnt(6)
ds_read_b128 v[80:83],v4 offset:4096
buffer_load_dwordx4 v[160:163],v0,s[20:23],s82 offen
v_add_f32 v40,v40,v168
v_mfma_f32_16x16x32_bf16 v[36:39],a[12:15],v[68:71],v[36:39]
s_waitcnt lgkmcnt(2)
s_add_u32 s82,s82,32768
buffer_load_dwordx4 v3,s[20:23],s61 offen offset:1024 lds
v_add_f32 v41,v41,v169
v_mfma_f32_16x16x32_bf16 v[32:35],a[16:19],v[72:75],v[32:35]
s_waitcnt vmcnt(7)
s_add_u32 s53,s60,s76
s_cmp_eq_u32 s60,125
s_cselect_b32 s53,128,s53
ds_read_b128 v[84:87],v4 offset:5120
v_mfma_f32_16x16x32_bf16 v[36:39],a[20:23],v[72:75],v[36:39]
s_waitcnt lgkmcnt(2)
s_mov_b32 s57,s63
buffer_load_dwordx4 v3,s[20:23],s61 offen offset:2048 lds
v_add_f32 v42,v42,v170
v_mfma_f32_16x16x32_bf16 v[32:35],a[24:27],v[76:79],v[32:35]
s_waitcnt vmcnt(7)
ds_read_b128 v[88:91],v4 offset:6144
v_add_f32 v43,v43,v171
v_add_f32 v44,v44,v172
v_mfma_f32_16x16x32_bf16 v[36:39],a[28:31],v[76:79],v[36:39]
s_waitcnt lgkmcnt(2)
buffer_load_dwordx4 v3,s[20:23],s61 offen offset:3072 lds
v_add_f32 v45,v45,v173
v_add_f32 v46,v46,v174
v_mfma_f32_16x16x32_bf16 v[32:35],a[32:35],v[80:83],v[32:35]
s_waitcnt vmcnt(7)
ds_read_b128 v[92:95],v4 offset:7168
v_add_f32 v47,v47,v175
v_cvt_pk_bf16_f32 v176,v40,v41
v_mfma_f32_16x16x32_bf16 v[36:39],a[36:39],v[80:83],v[36:39]
s_waitcnt lgkmcnt(2)
s_barrier
s_add_u32 m0,s70,4096
ds_read_b128 v[96:99],v5 offset:0
v_mfma_f32_16x16x32_bf16 v[32:35],a[40:43],v[84:87],v[32:35]
ds_read_b128 v[100:103],v5 offset:1024
buffer_load_dwordx4 v3,s[20:23],s62 offen offset:0 lds
v_cvt_pk_bf16_f32 v177,v42,v43
v_mfma_f32_16x16x32_bf16 v[36:39],a[44:47],v[84:87],v[36:39]
s_waitcnt lgkmcnt(3)
ds_read_b128 v[104:107],v5 offset:2048
buffer_load_dwordx4 v3,s[20:23],s62 offen offset:1024 lds
v_cvt_pk_bf16_f32 v178,v44,v45
v_mfma_f32_16x16x32_bf16 v[32:35],a[48:51],v[88:91],v[32:35]
ds_read_b128 v[108:111],v5 offset:3072
v_cvt_pk_bf16_f32 v179,v46,v47
v_mfma_f32_16x16x32_bf16 v[36:39],a[52:55],v[88:91],v[36:39]
s_waitcnt lgkmcnt(4)
ds_read_b128 v[112:115],v5 offset:4096
buffer_load_dwordx4 v3,s[20:23],s62 offen offset:2048 lds
v_mfma_f32_16x16x32_bf16 v[32:35],a[56:59],v[92:95],v[32:35]
ds_read_b128 v[116:119],v5 offset:5120
v_mfma_f32_16x16x32_bf16 v[36:39],a[60:63],v[92:95],v[36:39]
s_waitcnt lgkmcnt(5)
buffer_load_dwordx4 v3,s[20:23],s62 offen offset:3072 lds
v_mfma_f32_16x16x32_bf16 v[32:35],a[64:67],v[96:99],v[32:35]
ds_read_b128 v[120:123],v5 offset:6144
v_mfma_f32_16x16x32_bf16 v[36:39],a[68:71],v[96:99],v[36:39]
s_waitcnt lgkmcnt(5)
buffer_load_dword v16,v2,s[20:23],s68 offen sc1
v_mfma_f32_16x16x32_bf16 v[32:35],a[72:75],v[100:103],v[32:35]
ds_read_b128 v[124:127],v5 offset:7168
v_mfma_f32_16x16x32_bf16 v[36:39],a[76:79],v[100:103],v[36:39]
s_waitcnt lgkmcnt(5)
s_waitcnt vmcnt(10)
v_mov_b32 v17,s57
buffer_store_dword v17,v26,s[20:23],s69 offen sc1
v_mfma_f32_16x16x32_bf16 v[32:35],a[80:83],v[104:107],v[32:35]
ds_read_b128 v[64:67],v6 offset:0
v_mfma_f32_16x16x32_bf16 v[36:39],a[84:87],v[104:107],v[36:39]
s_waitcnt lgkmcnt(5)
buffer_store_dwordx4 v[176:179],v0,s[20:23],s66 offen sc1
v_mfma_f32_16x16x32_bf16 v[32:35],a[88:91],v[108:111],v[32:35]
s_add_u32 s66,s66,32768
s_add_u32 s63,s63,1
ds_read_b128 v[68:71],v6 offset:1024
v_mfma_f32_16x16x32_bf16 v[36:39],a[92:95],v[108:111],v[36:39]
s_waitcnt lgkmcnt(5)
v_mfma_f32_16x16x32_bf16 v[32:35],a[96:99],v[112:115],v[32:35]
ds_read_b128 v[72:75],v6 offset:2048
v_mfma_f32_16x16x32_bf16 v[36:39],a[100:103],v[112:115],v[36:39]
s_waitcnt lgkmcnt(5)
v_mfma_f32_16x16x32_bf16 v[32:35],a[104:107],v[116:119],v[32:35]
ds_read_b128 v[76:79],v6 offset:3072
v_mfma_f32_16x16x32_bf16 v[36:39],a[108:111],v[116:119],v[36:39]
s_waitcnt lgkmcnt(5)
v_mfma_f32_16x16x32_bf16 v[32:35],a[112:115],v[120:123],v[32:35]
ds_read_b128 v[80:83],v6 offset:4096
v_mfma_f32_16x16x32_bf16 v[36:39],a[116:119],v[120:123],v[36:39]
s_waitcnt lgkmcnt(5)
v_mfma_f32_16x16x32_bf16 v[32:35],a[120:123],v[124:127],v[32:35]
ds_read_b128 v[84:87],v6 offset:5120
v_mfma_f32_16x16x32_bf16 v[36:39],a[124:127],v[124:127],v[36:39]
s_waitcnt lgkmcnt(5)
v_mfma_f32_16x16x32_bf16 v[32:35],a[128:131],v[64:67],v[32:35]
ds_read_b128 v[88:91],v6 offset:6144
v_mfma_f32_16x16x32_bf16 v[36:39],a[132:135],v[64:67],v[36:39]
s_waitcnt lgkmcnt(5)
v_mfma_f32_16x16x32_bf16 v[32:35],a[136:139],v[68:71],v[32:35]
ds_read_b128 v[92:95],v6 offset:7168
v_mfma_f32_16x16x32_bf16 v[36:39],a[140:143],v[68:71],v[36:39]
s_waitcnt lgkmcnt(5)
v_mfma_f32_16x16x32_bf16 v[32:35],a[144:147],v[72:75],v[32:35]
ds_read_b128 v[96:99],v7 offset:0
v_mfma_f32_16x16x32_bf16 v[36:39],a[148:151],v[72:75],v[36:39]
s_waitcnt lgkmcnt(5)
v_mfma_f32_16x16x32_bf16 v[32:35],a[152:155],v[76:79],v[32:35]
ds_read_b128 v[100:103],v7 offset:1024
v_mfma_f32_16x16x32_bf16 v[36:39],a[156:159],v[76:79],v[36:39]
s_waitcnt lgkmcnt(5)
v_mfma_f32_16x16x32_bf16 v[32:35],a[160:163],v[80:83],v[32:35]
ds_read_b128 v[104:107],v7 offset:2048
v_mfma_f32_16x16x32_bf16 v[36:39],a[164:167],v[80:83],v[36:39]
s_waitcnt lgkmcnt(5)
v_mfma_f32_16x16x32_bf16 v[32:35],a[168:171],v[84:87],v[32:35]
ds_read_b128 v[108:111],v7 offset:3072
v_mfma_f32_16x16x32_bf16 v[36:39],a[172:175],v[84:87],v[36:39]
s_waitcnt lgkmcnt(5)
v_mfma_f32_16x16x32_bf16 v[32:35],a[176:179],v[88:91],v[32:35]
ds_read_b128 v[112:115],v7 offset:4096
v_mfma_f32_16x16x32_bf16 v[36:39],a[180:183],v[88:91],v[36:39]
s_waitcnt lgkmcnt(5)
v_mfma_f32_16x16x32_bf16 v[32:35],a[184:187],v[92:95],v[32:35]
ds_read_b128 v[116:119],v7 offset:5120
v_mfma_f32_16x16x32_bf16 v[36:39],a[188:191],v[92:95],v[36:39]
s_waitcnt lgkmcnt(5)
v_mfma_f32_16x16x32_bf16 v[32:35],a[192:195],v[96:99],v[32:35]
ds_read_b128 v[120:123],v7 offset:6144
v_mfma_f32_16x16x32_bf16 v[36:39],a[196:199],v[96:99],v[36:39]
s_waitcnt lgkmcnt(5)
v_mfma_f32_16x16x32_bf16 v[32:35],a[200:203],v[100:103],v[32:35]
s_waitcnt vmcnt(10)
ds_read_b128 v[124:127],v7 offset:7168
v_lshlrev_b32 v168,16,v160
v_mfma_f32_16x16x32_bf16 v[36:39],a[204:207],v[100:103],v[36:39]
s_waitcnt lgkmcnt(5)
v_and_b32 v169,s73,v160
v_lshlrev_b32 v170,16,v161
v_mfma_f32_16x16x32_bf16 v[32:35],a[208:211],v[104:107],v[32:35]
s_add_u32 s61,s61,32768
v_and_b32 v171,s73,v161
v_lshlrev_b32 v172,16,v162
v_mfma_f32_16x16x32_bf16 v[36:39],a[212:215],v[104:107],v[36:39]
s_waitcnt lgkmcnt(4)
v_and_b32 v173,s73,v162
v_lshlrev_b32 v174,16,v163
v_mfma_f32_16x16x32_bf16 v[32:35],a[216:219],v[108:111],v[32:35]
s_add_u32 s62,s62,32768
s_add_u32 s70,s70,32768
v_and_b32 v175,s73,v163
v_mfma_f32_16x16x32_bf16 v[36:39],a[220:223],v[108:111],v[36:39]
s_waitcnt lgkmcnt(3)
s_and_b32 s70,s70,0x1ffff
s_add_u32 s55,s55,32768
v_mfma_f32_16x16x32_bf16 v[32:35],a[224:227],v[112:115],v[32:35]
s_and_b32 s55,s55,0x1ffff
v_add_u32 v4,s55,v8
v_add_u32 v5,s55,v9
v_mfma_f32_16x16x32_bf16 v[36:39],a[228:231],v[112:115],v[36:39]
s_waitcnt lgkmcnt(2)
v_add_u32 v6,s55,v10
v_add_u32 v7,s55,v11
v_mfma_f32_16x16x32_bf16 v[32:35],a[232:235],v[116:119],v[32:35]
ds_read_b128 v[64:67],v4 offset:0
v_mfma_f32_16x16x32_bf16 v[36:39],a[236:239],v[116:119],v[36:39]
s_waitcnt lgkmcnt(2)
s_waitcnt vmcnt(9)
ds_read_b128 v[68:71],v4 offset:1024
v_mfma_f32_16x16x32_bf16 v[32:35],a[240:243],v[120:123],v[32:35]
s_waitcnt vmcnt(8)
ds_read_b128 v[72:75],v4 offset:2048
v_mfma_f32_16x16x32_bf16 v[36:39],a[244:247],v[120:123],v[36:39]
s_waitcnt lgkmcnt(3)
v_mfma_f32_16x16x32_bf16 v[40:43],a[248:251],v[124:127],v[32:35]
v_mfma_f32_16x16x32_bf16 v[44:47],a[252:255],v[124:127],v[36:39]
s_waitcnt vmcnt(2)
v_cmp_gt_u32 vcc,s53,v16
s_add_u32 s60,s60,1
s_cbranch_vccz WR_353
WN_354:
s_waitcnt lgkmcnt(2)
v_mfma_f32_16x16x32_bf16 v[32:35],a[0:3],v[64:67],0
s_waitcnt vmcnt(6)
ds_read_b128 v[76:79],v4 offset:3072
buffer_load_dwordx4 v[160:163],v0,s[20:23],s82 offen
v_mfma_f32_16x16x32_bf16 v[36:39],a[4:7],v[64:67],0
s_waitcnt lgkmcnt(2)
s_add_u32 s82,s82,32768
v_mfma_f32_16x16x32_bf16 v[32:35],a[8:11],v[68:71],v[32:35]
s_waitcnt vmcnt(6)
ds_read_b128 v[80:83],v4 offset:4096
v_add_f32 v40,v40,v168
v_add_f32 v41,v41,v169
v_mfma_f32_16x16x32_bf16 v[36:39],a[12:15],v[68:71],v[36:39]
s_waitcnt lgkmcnt(2)
s_add_u32 s71,s60,s75
s_cmp_eq_u32 s60,126
s_cselect_b32 s71,128,s71
v_mfma_f32_16x16x32_bf16 v[32:35],a[16:19],v[72:75],v[32:35]
s_waitcnt vmcnt(5)
ds_read_b128 v[84:87],v4 offset:5120
v_add_f32 v42,v42,v170
v_add_f32 v43,v43,v171
v_mfma_f32_16x16x32_bf16 v[36:39],a[20:23],v[72:75],v[36:39]
s_waitcnt lgkmcnt(2)
s_add_u32 s53,s60,s76
s_cmp_eq_u32 s60,125
s_cselect_b32 s53,128,s53
v_mfma_f32_16x16x32_bf16 v[32:35],a[24:27],v[76:79],v[32:35]
s_waitcnt vmcnt(4)
s_mov_b32 s57,s63
ds_read_b128 v[88:91],v4 offset:6144
v_add_f32 v44,v44,v172
v_mfma_f32_16x16x32_bf16 v[36:39],a[28:31],v[76:79],v[36:39]
s_waitcnt lgkmcnt(2)
v_add_f32 v45,v45,v173
v_add_f32 v46,v46,v174
v_mfma_f32_16x16x32_bf16 v[32:35],a[32:35],v[80:83],v[32:35]
s_waitcnt vmcnt(3)
ds_read_b128 v[92:95],v4 offset:7168
v_add_f32 v47,v47,v175
v_mfma_f32_16x16x32_bf16 v[36:39],a[36:39],v[80:83],v[36:39]
s_waitcnt lgkmcnt(2)
s_barrier
ds_read_b128 v[96:99],v5 offset:0
v_mfma_f32_16x16x32_bf16 v[32:35],a[40:43],v[84:87],v[32:35]
ds_read_b128 v[100:103],v5 offset:1024
v_cvt_pk_bf16_f32 v176,v40,v41
v_mfma_f32_16x16x32_bf16 v[36:39],a[44:47],v[84:87],v[36:39]
s_waitcnt lgkmcnt(3)
ds_read_b128 v[104:107],v5 offset:2048
v_cvt_pk_bf16_f32 v177,v42,v43
v_mfma_f32_16x16x32_bf16 v[32:35],a[48:51],v[88:91],v[32:35]
ds_read_b128 v[108:111],v5 offset:3072
v_cvt_pk_bf16_f32 v178,v44,v45
v_mfma_f32_16x16x32_bf16 v[36:39],a[52:55],v[88:91],v[36:39]
s_waitcnt lgkmcnt(4)
ds_read_b128 v[112:115],v5 offset:4096
v_cvt_pk_bf16_f32 v179,v46,v47
v_mfma_f32_16x16x32_bf16 v[32:35],a[56:59],v[92:95],v[32:35]
ds_read_b128 v[116:119],v5 offset:5120
v_mfma_f32_16x16x32_bf16 v[36:39],a[60:63],v[92:95],v[36:39]
s_waitcnt lgkmcnt(5)
v_mfma_f32_16x16x32_bf16 v[32:35],a[64:67],v[96:99],v[32:35]
ds_read_b128 v[120:123],v5 offset:6144
v_mfma_f32_16x16x32_bf16 v[36:39],a[68:71],v[96:99],v[36:39]
s_waitcnt lgkmcnt(5)
buffer_load_dword v16,v2,s[20:23],s68 offen sc1
v_mfma_f32_16x16x32_bf16 v[32:35],a[72:75],v[100:103],v[32:35]
ds_read_b128 v[124:127],v5 offset:7168
v_mfma_f32_16x16x32_bf16 v[36:39],a[76:79],v[100:103],v[36:39]
s_waitcnt lgkmcnt(5)
s_waitcnt vmcnt(2)
v_mov_b32 v17,s57
buffer_store_dword v17,v26,s[20:23],s69 offen sc1
v_mfma_f32_16x16x32_bf16 v[32:35],a[80:83],v[104:107],v[32:35]
ds_read_b128 v[64:67],v6 offset:0
v_mfma_f32_16x16x32_bf16 v[36:39],a[84:87],v[104:107],v[36:39]
s_waitcnt lgkmcnt(5)
buffer_store_dwordx4 v[176:179],v0,s[20:23],s66 offen sc1
v_mfma_f32_16x16x32_bf16 v[32:35],a[88:91],v[108:111],v[32:35]
s_add_u32 s66,s66,32768
s_add_u32 s63,s63,1
ds_read_b128 v[68:71],v6 offset:1024
v_mfma_f32_16x16x32_bf16 v[36:39],a[92:95],v[108:111],v[36:39]
s_waitcnt lgkmcnt(5)
v_mfma_f32_16x16x32_bf16 v[32:35],a[96:99],v[112:115],v[32:35]
ds_read_b128 v[72:75],v6 offset:2048
v_mfma_f32_16x16x32_bf16 v[36:39],a[100:103],v[112:115],v[36:39]
s_waitcnt lgkmcnt(5)
v_mfma_f32_16x16x32_bf16 v[32:35],a[104:107],v[116:119],v[32:35]
ds_read_b128 v[76:79],v6 offset:3072
v_mfma_f32_16x16x32_bf16 v[36:39],a[108:111],v[116:119],v[36:39]
s_waitcnt lgkmcnt(5)
v_mfma_f32_16x16x32_bf16 v[32:35],a[112:115],v[120:123],v[32:35]
ds_read_b128 v[80:83],v6 offset:4096
v_mfma_f32_16x16x32_bf16 v[36:39],a[116:119],v[120:123],v[36:39]
s_waitcnt lgkmcnt(5)
v_mfma_f32_16x16x32_bf16 v[32:35],a[120:123],v[124:127],v[32:35]
ds_read_b128 v[84:87],v6 offset:5120
v_mfma_f32_16x16x32_bf16 v[36:39],a[124:127],v[124:127],v[36:39]
s_waitcnt lgkmcnt(5)
v_mfma_f32_16x16x32_bf16 v[32:35],a[128:131],v[64:67],v[32:35]
ds_read_b128 v[88:91],v6 offset:6144
v_mfma_f32_16x16x32_bf16 v[36:39],a[132:135],v[64:67],v[36:39]
s_waitcnt lgkmcnt(5)
v_mfma_f32_16x16x32_bf16 v[32:35],a[136:139],v[68:71],v[32:35]
ds_read_b128 v[92:95],v6 offset:7168
v_mfma_f32_16x16x32_bf16 v[36:39],a[140:143],v[68:71],v[36:39]
s_waitcnt lgkmcnt(5)
v_mfma_f32_16x16x32_bf16 v[32:35],a[144:147],v[72:75],v[32:35]
ds_read_b128 v[96:99],v7 offset:0
v_mfma_f32_16x16x32_bf16 v[36:39],a[148:151],v[72:75],v[36:39]
s_waitcnt lgkmcnt(5)
v_mfma_f32_16x16x32_bf16 v[32:35],a[152:155],v[76:79],v[32:35]
ds_read_b128 v[100:103],v7 offset:1024
v_mfma_f32_16x16x32_bf16 v[36:39],a[156:159],v[76:79],v[36:39]
s_waitcnt lgkmcnt(5)
v_mfma_f32_16x16x32_bf16 v[32:35],a[160:163],v[80:83],v[32:35]
ds_read_b128 v[104:107],v7 offset:2048
v_mfma_f32_16x16x32_bf16 v[36:39],a[164:167],v[80:83],v[36:39]
s_waitcnt lgkmcnt(5)
v_mfma_f32_16x16x32_bf16 v[32:35],a[168:171],v[84:87],v[32:35]
ds_read_b128 v[108:111],v7 offset:3072
v_mfma_f32_16x16x32_bf16 v[36:39],a[172:175],v[84:87],v[36:39]
s_waitcnt lgkmcnt(5)
v_mfma_f32_16x16x32_bf16 v[32:35],a[176:179],v[88:91],v[32:35]
ds_read_b128 v[112:115],v7 offset:4096
v_mfma_f32_16x16x32_bf16 v[36:39],a[180:183],v[88:91],v[36:39]
s_waitcnt lgkmcnt(5)
v_mfma_f32_16x16x32_bf16 v[32:35],a[184:187],v[92:95],v[32:35]
ds_read_b128 v[116:119],v7 offset:5120
v_mfma_f32_16x16x32_bf16 v[36:39],a[188:191],v[92:95],v[36:39]
s_waitcnt lgkmcnt(5)
v_mfma_f32_16x16x32_bf16 v[32:35],a[192:195],v[96:99],v[32:35]
ds_read_b128 v[120:123],v7 offset:6144
v_mfma_f32_16x16x32_bf16 v[36:39],a[196:199],v[96:99],v[36:39]
s_waitcnt lgkmcnt(5)
v_mfma_f32_16x16x32_bf16 v[32:35],a[200:203],v[100:103],v[32:35]
s_waitcnt vmcnt(3)
ds_read_b128 v[124:127],v7 offset:7168
v_lshlrev_b32 v168,16,v160
v_mfma_f32_16x16x32_bf16 v[36:39],a[204:207],v[100:103],v[36:39]
s_waitcnt lgkmcnt(5)
v_and_b32 v169,s73,v160
v_lshlrev_b32 v170,16,v161
v_mfma_f32_16x16x32_bf16 v[32:35],a[208:211],v[104:107],v[32:35]
s_add_u32 s55,s55,32768
v_and_b32 v171,s73,v161
v_lshlrev_b32 v172,16,v162
v_mfma_f32_16x16x32_bf16 v[36:39],a[212:215],v[104:107],v[36:39]
s_waitcnt lgkmcnt(4)
v_and_b32 v173,s73,v162
v_lshlrev_b32 v174,16,v163
v_mfma_f32_16x16x32_bf16 v[32:35],a[216:219],v[108:111],v[32:35]
s_and_b32 s55,s55,0x1ffff
v_and_b32 v175,s73,v163
v_add_u32 v4,s55,v8
v_mfma_f32_16x16x32_bf16 v[36:39],a[220:223],v[108:111],v[36:39]
s_waitcnt lgkmcnt(3)
v_add_u32 v5,s55,v9
v_add_u32 v6,s55,v10
v_mfma_f32_16x16x32_bf16 v[32:35],a[224:227],v[112:115],v[32:35]
v_add_u32 v7,s55,v11
v_mfma_f32_16x16x32_bf16 v[36:39],a[228:231],v[112:115],v[36:39]
s_waitcnt lgkmcnt(2)
v_mfma_f32_16x16x32_bf16 v[32:35],a[232:235],v[116:119],v[32:35]
v_mfma_f32_16x16x32_bf16 v[36:39],a[236:239],v[116:119],v[36:39]
s_waitcnt lgkmcnt(1)
v_mfma_f32_16x16x32_bf16 v[32:35],a[240:243],v[120:123],v[32:35]
v_mfma_f32_16x16x32_bf16 v[36:39],a[244:247],v[120:123],v[36:39]
s_waitcnt lgkmcnt(0)
v_mfma_f32_16x16x32_bf16 v[40:43],a[248:251],v[124:127],v[32:35]
v_mfma_f32_16x16x32_bf16 v[44:47],a[252:255],v[124:127],v[36:39]
s_waitcnt vmcnt(2)
v_cmp_gt_u32 vcc,s71,v16
s_add_u32 s60,s60,1
s_branch endN_362
BN_356:
s_waitcnt vmcnt(9)
ds_read_b128 v[64:67],v4 offset:0
s_waitcnt vmcnt(8)
ds_read_b128 v[68:71],v4 offset:1024
s_waitcnt vmcnt(7)
ds_read_b128 v[72:75],v4 offset:2048
s_waitcnt vmcnt(6)
ds_read_b128 v[76:79],v4 offset:3072
s_waitcnt lgkmcnt(3)
v_mfma_f32_16x16x32_bf16 v[32:35],a[0:3],v[64:67],0
buffer_load_dwordx4 v[160:163],v0,s[20:23],s82 offen
v_mfma_f32_16x16x32_bf16 v[36:39],a[4:7],v[64:67],0
s_waitcnt lgkmcnt(2)
s_waitcnt vmcnt(6)
s_add_u32 s82,s82,32768
ds_read_b128 v[80:83],v4 offset:4096
v_mfma_f32_16x16x32_bf16 v[32:35],a[8:11],v[68:71],v[32:35]
s_add_u32 s71,s60,s75
s_cmp_eq_u32 s60,126
s_cselect_b32 s71,128,s71
v_mfma_f32_16x16x32_bf16 v[36:39],a[12:15],v[68:71],v[36:39]
s_waitcnt lgkmcnt(2)
s_waitcnt vmcnt(5)
ds_read_b128 v[84:87],v4 offset:5120
v_mfma_f32_16x16x32_bf16 v[32:35],a[16:19],v[72:75],v[32:35]
s_add_u32 s53,s60,s76
s_cmp_eq_u32 s60,125
s_cselect_b32 s53,128,s53
v_mfma_f32_16x16x32_bf16 v[36:39],a[20:23],v[72:75],v[36:39]
s_waitcnt lgkmcnt(2)
s_waitcnt vmcnt(4)
ds_read_b128 v[88:91],v4 offset:6144
v_mfma_f32_16x16x32_bf16 v[32:35],a[24:27],v[76:79],v[32:35]
s_mov_b32 s57,s63
v_mfma_f32_16x16x32_bf16 v[36:39],a[28:31],v[76:79],v[36:39]
s_waitcnt lgkmcnt(2)
s_waitcnt vmcnt(3)
ds_read_b128 v[92:95],v4 offset:7168
v_mfma_f32_16x16x32_bf16 v[32:35],a[32:35],v[80:83],v[32:35]
v_mfma_f32_16x16x32_bf16 v[36:39],a[36:39],v[80:83],v[36:39]
s_waitcnt lgkmcnt(2)
s_barrier
ds_read_b128 v[96:99],v5 offset:0
v_mfma_f32_16x16x32_bf16 v[32:35],a[40:43],v[84:87],v[32:35]
ds_read_b128 v[100:103],v5 offset:1024
v_mfma_f32_16x16x32_bf16 v[36:39],a[44:47],v[84:87],v[36:39]
s_waitcnt lgkmcnt(3)
ds_read_b128 v[104:107],v5 offset:2048
v_mfma_f32_16x16x32_bf16 v[32:35],a[48:51],v[88:91],v[32:35]
ds_read_b128 v[108:111],v5 offset:3072
v_mfma_f32_16x16x32_bf16 v[36:39],a[52:55],v[88:91],v[36:39]
s_waitcnt lgkmcnt(4)
ds_read_b128 v[112:115],v5 offset:4096
v_mfma_f32_16x16x32_bf16 v[32:35],a[56:59],v[92:95],v[32:35]
ds_read_b128 v[116:119],v5 offset:5120
v_mfma_f32_16x16x32_bf16 v[36:39],a[60:63],v[92:95],v[36:39]
s_waitcnt lgkmcnt(5)
v_mfma_f32_16x16x32_bf16 v[32:35],a[64:67],v[96:99],v[32:35]
ds_read_b128 v[120:123],v5 offset:6144
v_mfma_f32_16x16x32_bf16 v[36:39],a[68:71],v[96:99],v[36:39]
s_waitcnt lgkmcnt(5)
v_mfma_f32_16x16x32_bf16 v[32:35],a[72:75],v[100:103],v[32:35]
ds_read_b128 v[124:127],v5 offset:7168
v_mfma_f32_16x16x32_bf16 v[36:39],a[76:79],v[100:103],v[36:39]
s_waitcnt lgkmcnt(5)
v_mfma_f32_16x16x32_bf16 v[32:35],a[80:83],v[104:107],v[32:35]
ds_read_b128 v[64:67],v6 offset:0
v_mfma_f32_16x16x32_bf16 v[36:39],a[84:87],v[104:107],v[36:39]
s_waitcnt lgkmcnt(5)
v_mfma_f32_16x16x32_bf16 v[32:35],a[88:91],v[108:111],v[32:35]
ds_read_b128 v[68:71],v6 offset:1024
v_mfma_f32_16x16x32_bf16 v[36:39],a[92:95],v[108:111],v[36:39]
s_waitcnt lgkmcnt(5)
v_mfma_f32_16x16x32_bf16 v[32:35],a[96:99],v[112:115],v[32:35]
ds_read_b128 v[72:75],v6 offset:2048
v_mfma_f32_16x16x32_bf16 v[36:39],a[100:103],v[112:115],v[36:39]
s_waitcnt lgkmcnt(5)
v_mfma_f32_16x16x32_bf16 v[32:35],a[104:107],v[116:119],v[32:35]
ds_read_b128 v[76:79],v6 offset:3072
v_mfma_f32_16x16x32_bf16 v[36:39],a[108:111],v[116:119],v[36:39]
s_waitcnt lgkmcnt(5)
v_mfma_f32_16x16x32_bf16 v[32:35],a[112:115],v[120:123],v[32:35]
ds_read_b128 v[80:83],v6 offset:4096
v_mfma_f32_16x16x32_bf16 v[36:39],a[116:119],v[120:123],v[36:39]
s_waitcnt lgkmcnt(5)
v_mfma_f32_16x16x32_bf16 v[32:35],a[120:123],v[124:127],v[32:35]
ds_read_b128 v[84:87],v6 offset:5120
v_mfma_f32_16x16x32_bf16 v[36:39],a[124:127],v[124:127],v[36:39]
s_waitcnt lgkmcnt(5)
v_mfma_f32_16x16x32_bf16 v[32:35],a[128:131],v[64:67],v[32:35]
ds_read_b128 v[88:91],v6 offset:6144
v_mfma_f32_16x16x32_bf16 v[36:39],a[132:135],v[64:67],v[36:39]
s_waitcnt lgkmcnt(5)
v_mfma_f32_16x16x32_bf16 v[32:35],a[136:139],v[68:71],v[32:35]
ds_read_b128 v[92:95],v6 offset:7168
v_mfma_f32_16x16x32_bf16 v[36:39],a[140:143],v[68:71],v[36:39]
s_waitcnt lgkmcnt(5)
v_mfma_f32_16x16x32_bf16 v[32:35],a[144:147],v[72:75],v[32:35]
ds_read_b128 v[96:99],v7 offset:0
v_mfma_f32_16x16x32_bf16 v[36:39],a[148:151],v[72:75],v[36:39]
s_waitcnt lgkmcnt(5)
s_waitcnt vmcnt(2)
v_mov_b32 v17,s57
buffer_store_dword v17,v26,s[20:23],s69 offen sc1
v_mfma_f32_16x16x32_bf16 v[32:35],a[152:155],v[76:79],v[32:35]
ds_read_b128 v[100:103],v7 offset:1024
v_mfma_f32_16x16x32_bf16 v[36:39],a[156:159],v[76:79],v[36:39]
s_waitcnt lgkmcnt(5)
v_mfma_f32_16x16x32_bf16 v[32:35],a[160:163],v[80:83],v[32:35]
ds_read_b128 v[104:107],v7 offset:2048
buffer_load_dword v16,v2,s[20:23],s68 offen sc1
v_mfma_f32_16x16x32_bf16 v[36:39],a[164:167],v[80:83],v[36:39]
s_waitcnt lgkmcnt(5)
v_mfma_f32_16x16x32_bf16 v[32:35],a[168:171],v[84:87],v[32:35]
ds_read_b128 v[108:111],v7 offset:3072
v_mfma_f32_16x16x32_bf16 v[36:39],a[172:175],v[84:87],v[36:39]
s_waitcnt lgkmcnt(5)
v_mfma_f32_16x16x32_bf16 v[32:35],a[176:179],v[88:91],v[32:35]
ds_read_b128 v[112:115],v7 offset:4096
v_mfma_f32_16x16x32_bf16 v[36:39],a[180:183],v[88:91],v[36:39]
s_waitcnt lgkmcnt(5)
v_mfma_f32_16x16x32_bf16 v[32:35],a[184:187],v[92:95],v[32:35]
ds_read_b128 v[116:119],v7 offset:5120
v_mfma_f32_16x16x32_bf16 v[36:39],a[188:191],v[92:95],v[36:39]
s_waitcnt lgkmcnt(5)
v_mfma_f32_16x16x32_bf16 v[32:35],a[192:195],v[96:99],v[32:35]
ds_read_b128 v[120:123],v7 offset:6144
v_mfma_f32_16x16x32_bf16 v[36:39],a[196:199],v[96:99],v[36:39]
s_waitcnt lgkmcnt(5)
v_mfma_f32_16x16x32_bf16 v[32:35],a[200:203],v[100:103],v[32:35]
s_waitcnt vmcnt(2)
ds_read_b128 v[124:127],v7 offset:7168
v_lshlrev_b32 v168,16,v160
v_mfma_f32_16x16x32_bf16 v[36:39],a[204:207],v[100:103],v[36:39]
s_waitcnt lgkmcnt(5)
v_and_b32 v169,s73,v160
v_lshlrev_b32 v170,16,v161
v_mfma_f32_16x16x32_bf16 v[32:35],a[208:211],v[104:107],v[32:35]
s_add_u32 s55,s55,32768
v_and_b32 v171,s73,v161
v_lshlrev_b32 v172,16,v162
v_mfma_f32_16x16x32_bf16 v[36:39],a[212:215],v[104:107],v[36:39]
s_waitcnt lgkmcnt(4)
v_and_b32 v173,s73,v162
v_lshlrev_b32 v174,16,v163
v_mfma_f32_16x16x32_bf16 v[32:35],a[216:219],v[108:111],v[32:35]
s_and_b32 s55,s55,0x1ffff
v_and_b32 v175,s73,v163
v_add_u32 v4,s55,v8
v_mfma_f32_16x16x32_bf16 v[36:39],a[220:223],v[108:111],v[36:39]
s_waitcnt lgkmcnt(3)
v_add_u32 v5,s55,v9
v_add_u32 v6,s55,v10
v_mfma_f32_16x16x32_bf16 v[32:35],a[224:227],v[112:115],v[32:35]
v_add_u32 v7,s55,v11
v_mfma_f32_16x16x32_bf16 v[36:39],a[228:231],v[112:115],v[36:39]
s_waitcnt lgkmcnt(2)
v_mfma_f32_16x16x32_bf16 v[32:35],a[232:235],v[116:119],v[32:35]
v_mfma_f32_16x16x32_bf16 v[36:39],a[236:239],v[116:119],v[36:39]
s_waitcnt lgkmcnt(1)
v_mfma_f32_16x16x32_bf16 v[32:35],a[240:243],v[120:123],v[32:35]
v_mfma_f32_16x16x32_bf16 v[36:39],a[244:247],v[120:123],v[36:39]
s_waitcnt lgkmcnt(0)
v_mfma_f32_16x16x32_bf16 v[40:43],a[248:251],v[124:127],v[32:35]
v_mfma_f32_16x16x32_bf16 v[44:47],a[252:255],v[124:127],v[36:39]
s_waitcnt vmcnt(0)
v_cmp_gt_u32 vcc,s71,v16
s_add_u32 s60,s60,1
endN_362:
s_cbranch_vccnz nb_359
s_mov_b32 m0,s70
s_nop 0
buffer_load_dwordx4 v3,s[20:23],s61 offen offset:0 lds
buffer_load_dwordx4 v3,s[20:23],s61 offen offset:1024 lds
buffer_load_dwordx4 v3,s[20:23],s61 offen offset:2048 lds
buffer_load_dwordx4 v3,s[20:23],s61 offen offset:3072 lds
s_add_u32 m0,s70,4096
s_nop 0
buffer_load_dwordx4 v3,s[20:23],s62 offen offset:0 lds
buffer_load_dwordx4 v3,s[20:23],s62 offen offset:1024 lds
buffer_load_dwordx4 v3,s[20:23],s62 offen offset:2048 lds
buffer_load_dwordx4 v3,s[20:23],s62 offen offset:3072 lds
s_add_u32 s61,s61,32768
s_add_u32 s62,s62,32768
s_add_u32 s70,s70,32768
s_and_b32 s70,s70,0x1ffff
s_mov_b32 s57,s63
v_pk_add_f32 v[40:41],v[40:41],v[168:169]
v_pk_add_f32 v[42:43],v[42:43],v[170:171]
v_pk_add_f32 v[44:45],v[44:45],v[172:173]
v_pk_add_f32 v[46:47],v[46:47],v[174:175]
v_cvt_pk_bf16_f32 v176,v40,v41
v_cvt_pk_bf16_f32 v177,v42,v43
v_cvt_pk_bf16_f32 v178,v44,v45
v_cvt_pk_bf16_f32 v179,v46,v47
buffer_store_dwordx4 v[176:179],v0,s[20:23],s66 offen sc1
s_add_u32 s66,s66,32768
s_add_u32 s63,s63,1
s_waitcnt vmcnt(9)
v_mov_b32 v17,s57
buffer_store_dword v17,v26,s[20:23],s69 offen sc1
s_branch dec_358
nb_359:
buffer_load_dword v16,v2,s[20:23],s68 offen sc1
s_nop 3
s_mov_b32 s57,s63
v_pk_add_f32 v[40:41],v[40:41],v[168:169]
v_pk_add_f32 v[42:43],v[42:43],v[170:171]
v_pk_add_f32 v[44:45],v[44:45],v[172:173]
v_pk_add_f32 v[46:47],v[46:47],v[174:175]
v_cvt_pk_bf16_f32 v176,v40,v41
v_cvt_pk_bf16_f32 v177,v42,v43
v_cvt_pk_bf16_f32 v178,v44,v45
v_cvt_pk_bf16_f32 v179,v46,v47
buffer_store_dwordx4 v[176:179],v0,s[20:23],s66 offen sc1
s_add_u32 s66,s66,32768
s_add_u32 s63,s63,1
s_waitcnt vmcnt(2)
v_mov_b32 v17,s57
buffer_store_dword v17,v26,s[20:23],s69 offen sc1
s_waitcnt vmcnt(2)
v_cmp_gt_u32 vcc,s71,v16
s_cbranch_vccz lag_357
s_waitcnt vmcnt(1)
v_mov_b32 v17,s63
buffer_store_dword v17,v26,s[20:23],s69 offen sc1
s_cmp_ge_u32 s60,128
s_cbranch_scc1 done_346
plp_365:
buffer_load_dword v16,v2,s[20:23],s68 offen sc1
s_waitcnt vmcnt(0)
v_cmp_gt_u32 vcc,s71,v16
s_cbranch_vccz pok_366
s_sleep 4
s_sub_u32 s90,s90,1
s_cmp_gt_i32 s90,0
s_cbranch_scc1 plp_365
pok_366:
s_branch lag_357
done_346:
s_endpgm
fl_ln2:
s_mov_b32 s52,s59
s_mov_b32 s60,0
s_mov_b32 s73,0xffff0000
v_and_b32 v2,3,v1
v_lshrrev_b32 v3,2,v1
s_lshl_b32 s64,s52,2
v_add_u32 v4,s64,v2
s_lshl_b32 s65,s50,9
v_lshlrev_b32 v5,4,v3
v_add_u32 v5,s65,v5
v_lshl_add_u32 v8,v4,11,v5
v_lshlrev_b32 v9,1,v5
v_lshrrev_b32 v5,2,v3
v_and_b32 v3,3,v3
s_lshl_b32 s65,s50,13
v_lshlrev_b32 v5,10,v5
v_lshl_add_u32 v5,v3,8,v5
v_lshl_add_u32 v5,v4,4,v5
v_add_u32 v10,s65,v5
s_lshl_b32 s65,s50,9
v_lshlrev_b32 v5,3,v1
v_add_u32 v11,s65,v5
v_lshlrev_b32 v12,3,v2
v_and_b32 v13,7,v1
v_lshlrev_b32 v13,2,v13
s_mov_b32 s92,s2
s_and_b32 s93,s3,0xffff
s_mov_b32 s94,0x100
s_mov_b32 s95,0x20000
v_mbcnt_lo_u32_b32 v16,-1,0
v_mbcnt_hi_u32_b32 v16,-1,v16
v_mov_b32 v18,0
v_cmp_eq_u32 vcc,22,v16
s_nop 1
v_cndmask_b32 v18,v18,63,vcc
v_cmp_eq_u32 vcc,17,v16
s_nop 1
v_cndmask_b32 v18,v18,63,vcc
v_cmp_eq_u32 vcc,18,v16
s_nop 1
v_cndmask_b32 v18,v18,1,vcc
v_and_b32 v19,1,v16
v_cmp_eq_u32 vcc,1,v19
v_mov_b32 v19,8192
s_nop 0
v_cndmask_b32 v19,-1,v19,vcc
v_min_u32 v16,31,v16
v_lshlrev_b32 v16,2,v16
s_sub_u32 s66,s88,64
s_cmp_lg_u32 s50,0
s_cbranch_scc1 vot_372
vpoll_368:
buffer_load_dword v17,v16,s[92:95],s66 offen sc1
s_waitcnt vmcnt(0)
s_cmp_lg_u32 s56,2
s_cbranch_scc1 vck_369
v_cmp_eq_u32 vcc,v17,v19
s_and_b32 s64,vcc_lo,0xffff
s_cmp_eq_u32 s64,65535
s_cbranch_scc1 vck_369
s_mov_b32 s65,0
v_readlane_b32 s64,v17,1
s_lshr_b32 s64,s64,8
s_add_u32 s65,s65,s64
v_readlane_b32 s64,v17,3
s_lshr_b32 s64,s64,8
s_add_u32 s65,s65,s64
v_readlane_b32 s64,v17,5
s_lshr_b32 s64,s64,8
s_add_u32 s65,s65,s64
v_readlane_b32 s64,v17,7
s_lshr_b32 s64,s64,8
s_add_u32 s65,s65,s64
v_readlane_b32 s64,v17,9
s_lshr_b32 s64,s64,8
s_add_u32 s65,s65,s64
v_readlane_b32 s64,v17,11
s_lshr_b32 s64,s64,8
s_add_u32 s65,s65,s64
v_readlane_b32 s64,v17,13
s_lshr_b32 s64,s64,8
s_add_u32 s65,s65,s64
v_readlane_b32 s64,v17,15
s_lshr_b32 s64,s64,8
s_add_u32 s65,s65,s64
s_cmp_ge_u32 s65,256
s_cbranch_scc1 vok_371
s_branch vrt_370
vck_369:
v_cmp_gt_u32 vcc,v18,v17
s_cbranch_vccz vok_371
vrt_370:
s_sleep 48
s_sub_u32 s90,s90,1
s_cmp_gt_i32 s90,0
s_cbranch_scc1 vpoll_368
vok_371:
v_add_u32 v18,161024,v16
ds_write_b32 v18,v17
s_waitcnt lgkmcnt(0)
vot_372:
s_barrier
v_add_u32 v18,161024,v16
ds_read_b32 v17,v18
s_waitcnt lgkmcnt(0)
s_cmp_lg_u32 s56,2
s_cbranch_scc1 vfin_373
v_cmp_eq_u32 vcc,v17,v19
s_and_b32 s64,vcc_lo,0xffff
s_cmp_eq_u32 s64,65535
s_cbranch_scc1 vfin_373
s_mov_b32 s65,0
v_readlane_b32 s64,v17,1
s_lshr_b32 s64,s64,8
s_add_u32 s65,s65,s64
v_readlane_b32 s64,v17,3
s_lshr_b32 s64,s64,8
s_add_u32 s65,s65,s64
v_readlane_b32 s64,v17,5
s_lshr_b32 s64,s64,8
s_add_u32 s65,s65,s64
v_readlane_b32 s64,v17,7
s_lshr_b32 s64,s64,8
s_add_u32 s65,s65,s64
v_readlane_b32 s64,v17,9
s_lshr_b32 s64,s64,8
s_add_u32 s65,s65,s64
v_readlane_b32 s64,v17,11
s_lshr_b32 s64,s64,8
s_add_u32 s65,s65,s64
v_readlane_b32 s64,v17,13
s_lshr_b32 s64,s64,8
s_add_u32 s65,s65,s64
v_readlane_b32 s64,v17,15
s_lshr_b32 s64,s64,8
s_add_u32 s65,s65,s64
s_cmp_ge_u32 s65,256
s_cbranch_scc1 fl_fb
vfin_373:
s_and_b32 s56,s56,1
s_mov_b32 s67,0
s_mov_b32 s64,267403264
buffer_load_dwordx4 v[32:35],v9,s[20:23],s64 offen offset:0 sc1
buffer_load_dwordx4 v[36:39],v9,s[20:23],s64 offen offset:16 sc1
buffer_load_dwordx4 v[40:43],v9,s[20:23],s64 offen offset:512 sc1
buffer_load_dwordx4 v[44:47],v9,s[20:23],s64 offen offset:528 sc1
s_mov_b32 s64,267427840
buffer_load_dwordx4 v[64:67],v9,s[20:23],s64 offen offset:0 sc1
buffer_load_dwordx4 v[68:71],v9,s[20:23],s64 offen offset:16 sc1
buffer_load_dwordx4 v[72:75],v9,s[20:23],s64 offen offset:512 sc1
buffer_load_dwordx4 v[76:79],v9,s[20:23],s64 offen offset:528 sc1
s_mov_b32 s64,267452416
buffer_load_dwordx4 v[80:83],v9,s[20:23],s64 offen offset:0 sc1
buffer_load_dwordx4 v[84:87],v9,s[20:23],s64 offen offset:16 sc1
buffer_load_dwordx4 v[88:91],v9,s[20:23],s64 offen offset:512 sc1
buffer_load_dwordx4 v[92:95],v9,s[20:23],s64 offen offset:528 sc1
s_mov_b32 s64,267476992
buffer_load_dwordx4 v[96:99],v9,s[20:23],s64 offen offset:0 sc1
buffer_load_dwordx4 v[100:103],v9,s[20:23],s64 offen offset:16 sc1
buffer_load_dwordx4 v[104:107],v9,s[20:23],s64 offen offset:512 sc1
buffer_load_dwordx4 v[108:111],v9,s[20:23],s64 offen offset:528 sc1
s_waitcnt vmcnt(0)
v_pk_add_f32 v[32:33],v[32:33],v[64:65]
v_pk_add_f32 v[80:81],v[80:81],v[96:97]
v_pk_add_f32 v[34:35],v[34:35],v[66:67]
v_pk_add_f32 v[82:83],v[82:83],v[98:99]
v_pk_add_f32 v[36:37],v[36:37],v[68:69]
v_pk_add_f32 v[84:85],v[84:85],v[100:101]
v_pk_add_f32 v[38:39],v[38:39],v[70:71]
v_pk_add_f32 v[86:87],v[86:87],v[102:103]
v_pk_add_f32 v[40:41],v[40:41],v[72:73]
v_pk_add_f32 v[88:89],v[88:89],v[104:105]
v_pk_add_f32 v[42:43],v[42:43],v[74:75]
v_pk_add_f32 v[90:91],v[90:91],v[106:107]
v_pk_add_f32 v[44:45],v[44:45],v[76:77]
v_pk_add_f32 v[92:93],v[92:93],v[108:109]
v_pk_add_f32 v[46:47],v[46:47],v[78:79]
v_pk_add_f32 v[94:95],v[94:95],v[110:111]
v_pk_add_f32 v[32:33],v[32:33],v[80:81]
v_pk_add_f32 v[34:35],v[34:35],v[82:83]
v_pk_add_f32 v[36:37],v[36:37],v[84:85]
v_pk_add_f32 v[38:39],v[38:39],v[86:87]
v_pk_add_f32 v[40:41],v[40:41],v[88:89]
v_pk_add_f32 v[42:43],v[42:43],v[90:91]
v_pk_add_f32 v[44:45],v[44:45],v[92:93]
v_pk_add_f32 v[46:47],v[46:47],v[94:95]
v_cvt_pk_bf16_f32 v64,v32,v33
v_cvt_pk_bf16_f32 v65,v34,v35
v_cvt_pk_bf16_f32 v66,v36,v37
v_cvt_pk_bf16_f32 v67,v38,v39
v_cvt_pk_bf16_f32 v68,v40,v41
v_cvt_pk_bf16_f32 v69,v42,v43
v_cvt_pk_bf16_f32 v70,v44,v45
v_cvt_pk_bf16_f32 v71,v46,v47
v_lshlrev_b32 v32,16,v64
v_and_b32 v33,s73,v64
v_lshlrev_b32 v34,16,v65
v_and_b32 v35,s73,v65
v_lshlrev_b32 v36,16,v66
v_and_b32 v37,s73,v66
v_lshlrev_b32 v38,16,v67
v_and_b32 v39,s73,v67
v_lshlrev_b32 v40,16,v68
v_and_b32 v41,s73,v68
v_lshlrev_b32 v42,16,v69
v_and_b32 v43,s73,v69
v_lshlrev_b32 v44,16,v70
v_and_b32 v45,s73,v70
v_lshlrev_b32 v46,16,v71
v_and_b32 v47,s73,v71
v_add_f32 v32,1.0,v32
v_add_f32 v33,1.0,v33
v_add_f32 v34,1.0,v34
v_add_f32 v35,1.0,v35
v_add_f32 v36,1.0,v36
v_add_f32 v37,1.0,v37
v_add_f32 v38,1.0,v38
v_add_f32 v39,1.0,v39
v_add_f32 v40,1.0,v40
v_add_f32 v41,1.0,v41
v_add_f32 v42,1.0,v42
v_add_f32 v43,1.0,v43
v_add_f32 v44,1.0,v44
v_add_f32 v45,1.0,v45
v_add_f32 v46,1.0,v46
v_add_f32 v47,1.0,v47
s_mov_b32 s64,267399168
buffer_load_dwordx4 v[48:51],v9,s[20:23],s64 offen offset:0 sc1
buffer_load_dwordx4 v[52:55],v9,s[20:23],s64 offen offset:16 sc1
buffer_load_dwordx4 v[56:59],v9,s[20:23],s64 offen offset:512 sc1
buffer_load_dwordx4 v[60:63],v9,s[20:23],s64 offen offset:528 sc1
s_mov_b32 s64,267423744
buffer_load_dwordx4 v[64:67],v9,s[20:23],s64 offen offset:0 sc1
buffer_load_dwordx4 v[68:71],v9,s[20:23],s64 offen offset:16 sc1
buffer_load_dwordx4 v[72:75],v9,s[20:23],s64 offen offset:512 sc1
buffer_load_dwordx4 v[76:79],v9,s[20:23],s64 offen offset:528 sc1
s_mov_b32 s64,267448320
buffer_load_dwordx4 v[80:83],v9,s[20:23],s64 offen offset:0 sc1
buffer_load_dwordx4 v[84:87],v9,s[20:23],s64 offen offset:16 sc1
buffer_load_dwordx4 v[88:91],v9,s[20:23],s64 offen offset:512 sc1
buffer_load_dwordx4 v[92:95],v9,s[20:23],s64 offen offset:528 sc1
s_mov_b32 s64,267472896
buffer_load_dwordx4 v[96:99],v9,s[20:23],s64 offen offset:0 sc1
buffer_load_dwordx4 v[100:103],v9,s[20:23],s64 offen offset:16 sc1
buffer_load_dwordx4 v[104:107],v9,s[20:23],s64 offen offset:512 sc1
buffer_load_dwordx4 v[108:111],v9,s[20:23],s64 offen offset:528 sc1
s_waitcnt vmcnt(0)
v_pk_add_f32 v[48:49],v[48:49],v[64:65]
v_pk_add_f32 v[80:81],v[80:81],v[96:97]
v_pk_add_f32 v[50:51],v[50:51],v[66:67]
v_pk_add_f32 v[82:83],v[82:83],v[98:99]
v_pk_add_f32 v[52:53],v[52:53],v[68:69]
v_pk_add_f32 v[84:85],v[84:85],v[100:101]
v_pk_add_f32 v[54:55],v[54:55],v[70:71]
v_pk_add_f32 v[86:87],v[86:87],v[102:103]
v_pk_add_f32 v[56:57],v[56:57],v[72:73]
v_pk_add_f32 v[88:89],v[88:89],v[104:105]
v_pk_add_f32 v[58:59],v[58:59],v[74:75]
v_pk_add_f32 v[90:91],v[90:91],v[106:107]
v_pk_add_f32 v[60:61],v[60:61],v[76:77]
v_pk_add_f32 v[92:93],v[92:93],v[108:109]
v_pk_add_f32 v[62:63],v[62:63],v[78:79]
v_pk_add_f32 v[94:95],v[94:95],v[110:111]
v_pk_add_f32 v[48:49],v[48:49],v[80:81]
v_pk_add_f32 v[50:51],v[50:51],v[82:83]
v_pk_add_f32 v[52:53],v[52:53],v[84:85]
v_pk_add_f32 v[54:55],v[54:55],v[86:87]
v_pk_add_f32 v[56:57],v[56:57],v[88:89]
v_pk_add_f32 v[58:59],v[58:59],v[90:91]
v_pk_add_f32 v[60:61],v[60:61],v[92:93]
v_pk_add_f32 v[62:63],v[62:63],v[94:95]
v_cvt_pk_bf16_f32 v64,v48,v49
v_cvt_pk_bf16_f32 v65,v50,v51
v_cvt_pk_bf16_f32 v66,v52,v53
v_cvt_pk_bf16_f32 v67,v54,v55
v_cvt_pk_bf16_f32 v68,v56,v57
v_cvt_pk_bf16_f32 v69,v58,v59
v_cvt_pk_bf16_f32 v70,v60,v61
v_cvt_pk_bf16_f32 v71,v62,v63
v_lshlrev_b32 v48,16,v64
v_and_b32 v49,s73,v64
v_lshlrev_b32 v50,16,v65
v_and_b32 v51,s73,v65
v_lshlrev_b32 v52,16,v66
v_and_b32 v53,s73,v66
v_lshlrev_b32 v54,16,v67
v_and_b32 v55,s73,v67
v_lshlrev_b32 v56,16,v68
v_and_b32 v57,s73,v68
v_lshlrev_b32 v58,16,v69
v_and_b32 v59,s73,v69
v_lshlrev_b32 v60,16,v70
v_and_b32 v61,s73,v70
v_lshlrev_b32 v62,16,v71
v_and_b32 v63,s73,v71
s_mov_b32 s63,201326592
s_mov_b32 s66,205520896
s_lshl_b32 s64,s50,8
s_add_u32 s68,s64,138547200
s_lshl_b32 s65,s59,2
s_add_u32 s69,s64,s65
s_add_u32 s69,s69,138548224
s_lshl_b32 s64,s50,9
s_lshl_b32 s65,s59,7
s_add_u32 s69,s64,s65
s_add_u32 s69,s69,138567680
v_lshlrev_b32 v16,2,v1
v_cmp_gt_u32 vcc,32,v1
s_nop 1
v_cndmask_b32 v16,2.0,v16,vcc
s_cmp_eq_u32 s56,1
s_cbranch_scc1 lfar_374
s_add_u32 s64,s63,4096
buffer_load_dwordx4 v[64:67],v10,s[20:23],s63 offen sc1
buffer_load_dwordx4 v[68:71],v10,s[20:23],s64 offen sc1
buffer_load_dword v15,off,s[20:23],s68
buffer_load_dword v15,off,s[20:23],s68
top0_375:
s_waitcnt vmcnt(2)
v_max3_u32 v14,v64,v65,v66
v_max3_u32 v13,v67,v68,v69
v_max3_u32 v14,v14,v70,v71
v_max_u32 v14,v14,v13
v_cmp_eq_u32 vcc,-1,v14
s_cbranch_vccnz rt_377
go_378:
s_add_u32 s63,s63,32768
s_add_u32 s64,s63,4096
buffer_load_dwordx4 v[72:75],v10,s[20:23],s63 offen sc1
buffer_load_dwordx4 v[76:79],v10,s[20:23],s64 offen sc1
v_lshlrev_b32 v80,16,v64
v_and_b32 v81,s73,v64
v_lshlrev_b32 v82,16,v65
v_and_b32 v83,s73,v65
v_lshlrev_b32 v84,16,v66
v_and_b32 v85,s73,v66
v_lshlrev_b32 v86,16,v67
v_and_b32 v87,s73,v67
v_lshlrev_b32 v88,16,v68
v_and_b32 v89,s73,v68
v_lshlrev_b32 v90,16,v69
v_and_b32 v91,s73,v69
v_lshlrev_b32 v92,16,v70
v_and_b32 v93,s73,v70
v_lshlrev_b32 v94,16,v71
v_and_b32 v95,s73,v71
v_add_f32 v96,v80,v81
v_mul_f32 v97,v80,v80
v_add_f32 v98,v82,v83
v_mul_f32 v99,v81,v81
v_fmac_f32 v97,v82,v82
v_fmac_f32 v99,v83,v83
v_add_f32 v96,v96,v84
v_fmac_f32 v97,v84,v84
v_add_f32 v98,v98,v85
v_fmac_f32 v99,v85,v85
v_add_f32 v96,v96,v86
v_fmac_f32 v97,v86,v86
v_add_f32 v98,v98,v87
v_fmac_f32 v99,v87,v87
v_add_f32 v96,v96,v88
v_fmac_f32 v97,v88,v88
v_add_f32 v98,v98,v89
v_fmac_f32 v99,v89,v89
v_add_f32 v96,v96,v90
v_fmac_f32 v97,v90,v90
v_add_f32 v98,v98,v91
v_fmac_f32 v99,v91,v91
v_add_f32 v96,v96,v92
v_fmac_f32 v97,v92,v92
v_add_f32 v98,v98,v93
v_fmac_f32 v99,v93,v93
v_add_f32 v96,v96,v94
v_fmac_f32 v97,v94,v94
v_add_f32 v98,v98,v95
v_fmac_f32 v99,v95,v95
v_add_f32 v96,v96,v98
v_add_f32 v97,v97,v99
s_nop 0
v_add_f32_dpp v96,v96,v96 row_ror:4 row_mask:0xf bank_mask:0xf
v_add_f32_dpp v97,v97,v97 row_ror:4 row_mask:0xf bank_mask:0xf
s_nop 0
v_add_f32_dpp v96,v96,v96 row_ror:8 row_mask:0xf bank_mask:0xf
v_add_f32_dpp v97,v97,v97 row_ror:8 row_mask:0xf bank_mask:0xf
v_mov_b32 v98,v96
v_mov_b32 v99,v97
s_nop 0
v_permlane16_swap_b32 v98,v96
v_permlane16_swap_b32 v99,v97
v_add_f32 v96,v96,v98
v_add_f32 v97,v97,v99
v_mov_b32 v98,v96
v_mov_b32 v99,v97
s_nop 0
v_permlane32_swap_b32 v98,v96
v_permlane32_swap_b32 v99,v97
v_add_f32 v96,v96,v98
v_add_f32 v97,v97,v99
ds_write_b64 v11,v[96:97] offset:0
s_waitcnt lgkmcnt(0)
s_barrier
s_waitcnt vmcnt(2)
v_mov_b32 v15,s60
buffer_store_dword v15,v16,s[20:23],s69 offen
ds_read_b64 v[100:101],v12 offset:0
ds_read_b64 v[102:103],v12 offset:512
ds_read_b64 v[104:105],v12 offset:1024
ds_read_b64 v[106:107],v12 offset:1536
s_waitcnt lgkmcnt(0)
v_add_f32 v100,v100,v102
v_add_f32 v101,v101,v103
v_add_f32 v104,v104,v106
v_add_f32 v105,v105,v107
v_add_f32 v100,v100,v104
v_add_f32 v101,v101,v105
v_mul_f32 v96,0xba800000,v100
v_mul_f32 v102,v96,v96
v_mul_f32 v101,0x3a800000,v101
v_sub_f32 v101,v101,v102
v_max_f32 v101,0,v101
v_add_f32 v101,0x3727c5ac,v101
v_rsq_f32 v97,v101
s_nop 0
v_mul_f32 v96,v96,v97
v_fma_f32 v80,v80,v97,v96
v_fma_f32 v81,v81,v97,v96
v_fma_f32 v82,v82,v97,v96
v_fma_f32 v83,v83,v97,v96
v_fma_f32 v84,v84,v97,v96
v_fma_f32 v85,v85,v97,v96
v_fma_f32 v86,v86,v97,v96
v_fma_f32 v87,v87,v97,v96
v_fma_f32 v88,v88,v97,v96
v_fma_f32 v89,v89,v97,v96
v_fma_f32 v90,v90,v97,v96
v_fma_f32 v91,v91,v97,v96
v_fma_f32 v92,v92,v97,v96
v_fma_f32 v93,v93,v97,v96
v_fma_f32 v94,v94,v97,v96
v_fma_f32 v95,v95,v97,v96
v_fma_f32 v80,v80,v32,v48
v_fma_f32 v81,v81,v33,v49
v_fma_f32 v82,v82,v34,v50
v_fma_f32 v83,v83,v35,v51
v_fma_f32 v84,v84,v36,v52
v_fma_f32 v85,v85,v37,v53
v_fma_f32 v86,v86,v38,v54
v_fma_f32 v87,v87,v39,v55
v_fma_f32 v88,v88,v40,v56
v_fma_f32 v89,v89,v41,v57
v_fma_f32 v90,v90,v42,v58
v_fma_f32 v91,v91,v43,v59
v_fma_f32 v92,v92,v44,v60
v_fma_f32 v93,v93,v45,v61
v_fma_f32 v94,v94,v46,v62
v_fma_f32 v95,v95,v47,v63
v_cvt_pk_bf16_f32 v112,v80,v81
v_cvt_pk_bf16_f32 v113,v82,v83
v_cvt_pk_bf16_f32 v114,v84,v85
v_cvt_pk_bf16_f32 v115,v86,v87
v_cvt_pk_bf16_f32 v116,v88,v89
v_cvt_pk_bf16_f32 v117,v90,v91
v_cvt_pk_bf16_f32 v118,v92,v93
v_cvt_pk_bf16_f32 v119,v94,v95
s_add_u32 s64,s66,4096
buffer_store_dwordx4 v[112:115],v10,s[20:23],s66 offen sc1
buffer_store_dwordx4 v[116:119],v10,s[20:23],s64 offen sc1
s_add_u32 s66,s66,32768
s_add_u32 s60,s60,1
top1_376:
s_waitcnt vmcnt(2)
v_max3_u32 v14,v72,v73,v74
v_max3_u32 v13,v75,v76,v77
v_max3_u32 v14,v14,v78,v79
v_max_u32 v14,v14,v13
v_cmp_eq_u32 vcc,-1,v14
s_cbranch_vccnz rt_380
go_381:
s_add_u32 s63,s63,32768
s_add_u32 s64,s63,4096
buffer_load_dwordx4 v[64:67],v10,s[20:23],s63 offen sc1
buffer_load_dwordx4 v[68:71],v10,s[20:23],s64 offen sc1
v_lshlrev_b32 v80,16,v72
v_and_b32 v81,s73,v72
v_lshlrev_b32 v82,16,v73
v_and_b32 v83,s73,v73
v_lshlrev_b32 v84,16,v74
v_and_b32 v85,s73,v74
v_lshlrev_b32 v86,16,v75
v_and_b32 v87,s73,v75
v_lshlrev_b32 v88,16,v76
v_and_b32 v89,s73,v76
v_lshlrev_b32 v90,16,v77
v_and_b32 v91,s73,v77
v_lshlrev_b32 v92,16,v78
v_and_b32 v93,s73,v78
v_lshlrev_b32 v94,16,v79
v_and_b32 v95,s73,v79
v_add_f32 v96,v80,v81
v_mul_f32 v97,v80,v80
v_add_f32 v98,v82,v83
v_mul_f32 v99,v81,v81
v_fmac_f32 v97,v82,v82
v_fmac_f32 v99,v83,v83
v_add_f32 v96,v96,v84
v_fmac_f32 v97,v84,v84
v_add_f32 v98,v98,v85
v_fmac_f32 v99,v85,v85
v_add_f32 v96,v96,v86
v_fmac_f32 v97,v86,v86
v_add_f32 v98,v98,v87
v_fmac_f32 v99,v87,v87
v_add_f32 v96,v96,v88
v_fmac_f32 v97,v88,v88
v_add_f32 v98,v98,v89
v_fmac_f32 v99,v89,v89
v_add_f32 v96,v96,v90
v_fmac_f32 v97,v90,v90
v_add_f32 v98,v98,v91
v_fmac_f32 v99,v91,v91
v_add_f32 v96,v96,v92
v_fmac_f32 v97,v92,v92
v_add_f32 v98,v98,v93
v_fmac_f32 v99,v93,v93
v_add_f32 v96,v96,v94
v_fmac_f32 v97,v94,v94
v_add_f32 v98,v98,v95
v_fmac_f32 v99,v95,v95
v_add_f32 v96,v96,v98
v_add_f32 v97,v97,v99
s_nop 0
v_add_f32_dpp v96,v96,v96 row_ror:4 row_mask:0xf bank_mask:0xf
v_add_f32_dpp v97,v97,v97 row_ror:4 row_mask:0xf bank_mask:0xf
s_nop 0
v_add_f32_dpp v96,v96,v96 row_ror:8 row_mask:0xf bank_mask:0xf
v_add_f32_dpp v97,v97,v97 row_ror:8 row_mask:0xf bank_mask:0xf
v_mov_b32 v98,v96
v_mov_b32 v99,v97
s_nop 0
v_permlane16_swap_b32 v98,v96
v_permlane16_swap_b32 v99,v97
v_add_f32 v96,v96,v98
v_add_f32 v97,v97,v99
v_mov_b32 v98,v96
v_mov_b32 v99,v97
s_nop 0
v_permlane32_swap_b32 v98,v96
v_permlane32_swap_b32 v99,v97
v_add_f32 v96,v96,v98
v_add_f32 v97,v97,v99
ds_write_b64 v11,v[96:97] offset:2048
s_waitcnt lgkmcnt(0)
s_barrier
s_waitcnt vmcnt(2)
v_mov_b32 v15,s60
buffer_store_dword v15,v16,s[20:23],s69 offen
ds_read_b64 v[100:101],v12 offset:2048
ds_read_b64 v[102:103],v12 offset:2560
ds_read_b64 v[104:105],v12 offset:3072
ds_read_b64 v[106:107],v12 offset:3584
s_waitcnt lgkmcnt(0)
v_add_f32 v100,v100,v102
v_add_f32 v101,v101,v103
v_add_f32 v104,v104,v106
v_add_f32 v105,v105,v107
v_add_f32 v100,v100,v104
v_add_f32 v101,v101,v105
v_mul_f32 v96,0xba800000,v100
v_mul_f32 v102,v96,v96
v_mul_f32 v101,0x3a800000,v101
v_sub_f32 v101,v101,v102
v_max_f32 v101,0,v101
v_add_f32 v101,0x3727c5ac,v101
v_rsq_f32 v97,v101
s_nop 0
v_mul_f32 v96,v96,v97
v_fma_f32 v80,v80,v97,v96
v_fma_f32 v81,v81,v97,v96
v_fma_f32 v82,v82,v97,v96
v_fma_f32 v83,v83,v97,v96
v_fma_f32 v84,v84,v97,v96
v_fma_f32 v85,v85,v97,v96
v_fma_f32 v86,v86,v97,v96
v_fma_f32 v87,v87,v97,v96
v_fma_f32 v88,v88,v97,v96
v_fma_f32 v89,v89,v97,v96
v_fma_f32 v90,v90,v97,v96
v_fma_f32 v91,v91,v97,v96
v_fma_f32 v92,v92,v97,v96
v_fma_f32 v93,v93,v97,v96
v_fma_f32 v94,v94,v97,v96
v_fma_f32 v95,v95,v97,v96
v_fma_f32 v80,v80,v32,v48
v_fma_f32 v81,v81,v33,v49
v_fma_f32 v82,v82,v34,v50
v_fma_f32 v83,v83,v35,v51
v_fma_f32 v84,v84,v36,v52
v_fma_f32 v85,v85,v37,v53
v_fma_f32 v86,v86,v38,v54
v_fma_f32 v87,v87,v39,v55
v_fma_f32 v88,v88,v40,v56
v_fma_f32 v89,v89,v41,v57
v_fma_f32 v90,v90,v42,v58
v_fma_f32 v91,v91,v43,v59
v_fma_f32 v92,v92,v44,v60
v_fma_f32 v93,v93,v45,v61
v_fma_f32 v94,v94,v46,v62
v_fma_f32 v95,v95,v47,v63
v_cvt_pk_bf16_f32 v112,v80,v81
v_cvt_pk_bf16_f32 v113,v82,v83
v_cvt_pk_bf16_f32 v114,v84,v85
v_cvt_pk_bf16_f32 v115,v86,v87
v_cvt_pk_bf16_f32 v116,v88,v89
v_cvt_pk_bf16_f32 v117,v90,v91
v_cvt_pk_bf16_f32 v118,v92,v93
v_cvt_pk_bf16_f32 v119,v94,v95
s_add_u32 s64,s66,4096
buffer_store_dwordx4 v[112:115],v10,s[20:23],s66 offen sc1
buffer_store_dwordx4 v[116:119],v10,s[20:23],s64 offen sc1
s_add_u32 s66,s66,32768
s_add_u32 s60,s60,1
s_cmp_lt_u32 s60,128
s_cbranch_scc1 top0_375
s_waitcnt vmcnt(0)
v_mov_b32 v15,s60
buffer_store_dword v15,v16,s[20:23],s69 offen
s_branch done_367
rt_377:
s_add_u32 s64,s63,4096
buffer_load_dwordx4 v[64:67],v10,s[20:23],s63 offen sc1
buffer_load_dwordx4 v[68:71],v10,s[20:23],s64 offen sc1
s_waitcnt vmcnt(2)
v_mov_b32 v15,s60
buffer_store_dword v15,v16,s[20:23],s69 offen
s_waitcnt vmcnt(1)
v_max3_u32 v14,v64,v65,v66
v_max3_u32 v13,v67,v68,v69
v_max3_u32 v14,v14,v70,v71
v_max_u32 v14,v14,v13
v_cmp_eq_u32 vcc,-1,v14
s_cbranch_vccz go_378
lp_379:
s_sleep 1
s_add_u32 s64,s63,4096
buffer_load_dwordx4 v[64:67],v10,s[20:23],s63 offen sc1
buffer_load_dwordx4 v[68:71],v10,s[20:23],s64 offen sc1
s_waitcnt vmcnt(0)
v_max3_u32 v14,v64,v65,v66
v_max3_u32 v13,v67,v68,v69
v_max3_u32 v14,v14,v70,v71
v_max_u32 v14,v14,v13
v_cmp_eq_u32 vcc,-1,v14
s_cbranch_vccz go_378
s_sub_u32 s90,s90,1
s_cmp_gt_i32 s90,0
s_cbranch_scc1 lp_379
s_branch go_378
rt_380:
s_add_u32 s64,s63,4096
buffer_load_dwordx4 v[72:75],v10,s[20:23],s63 offen sc1
buffer_load_dwordx4 v[76:79],v10,s[20:23],s64 offen sc1
s_waitcnt vmcnt(2)
v_mov_b32 v15,s60
buffer_store_dword v15,v16,s[20:23],s69 offen
s_waitcnt vmcnt(1)
v_max3_u32 v14,v72,v73,v74
v_max3_u32 v13,v75,v76,v77
v_max3_u32 v14,v14,v78,v79
v_max_u32 v14,v14,v13
v_cmp_eq_u32 vcc,-1,v14
s_cbranch_vccz go_381
lp_382:
s_sleep 1
s_add_u32 s64,s63,4096
buffer_load_dwordx4 v[72:75],v10,s[20:23],s63 offen sc1
buffer_load_dwordx4 v[76:79],v10,s[20:23],s64 offen sc1
s_waitcnt vmcnt(0)
v_max3_u32 v14,v72,v73,v74
v_max3_u32 v13,v75,v76,v77
v_max3_u32 v14,v14,v78,v79
v_max_u32 v14,v14,v13
v_cmp_eq_u32 vcc,-1,v14
s_cbranch_vccz go_381
s_sub_u32 s90,s90,1
s_cmp_gt_i32 s90,0
s_cbranch_scc1 lp_382
s_branch go_381
lfar_374:
s_add_u32 s64,s63,4096
buffer_load_dwordx4 v[64:67],v10,s[20:23],s63 offen sc1
buffer_load_dwordx4 v[68:71],v10,s[20:23],s64 offen sc1
buffer_load_dword v15,off,s[20:23],s68
buffer_load_dword v15,off,s[20:23],s68
top0_383:
s_waitcnt vmcnt(2)
v_max3_u32 v14,v64,v65,v66
v_max3_u32 v13,v67,v68,v69
v_max3_u32 v14,v14,v70,v71
v_max_u32 v14,v14,v13
v_cmp_eq_u32 vcc,-1,v14
s_cbranch_vccnz rt_385
go_386:
s_add_u32 s63,s63,32768
s_add_u32 s64,s63,4096
buffer_load_dwordx4 v[72:75],v10,s[20:23],s63 offen sc1
buffer_load_dwordx4 v[76:79],v10,s[20:23],s64 offen sc1
v_lshlrev_b32 v80,16,v64
v_and_b32 v81,s73,v64
v_lshlrev_b32 v82,16,v65
v_and_b32 v83,s73,v65
v_lshlrev_b32 v84,16,v66
v_and_b32 v85,s73,v66
v_lshlrev_b32 v86,16,v67
v_and_b32 v87,s73,v67
v_lshlrev_b32 v88,16,v68
v_and_b32 v89,s73,v68
v_lshlrev_b32 v90,16,v69
v_and_b32 v91,s73,v69
v_lshlrev_b32 v92,16,v70
v_and_b32 v93,s73,v70
v_lshlrev_b32 v94,16,v71
v_and_b32 v95,s73,v71
v_add_f32 v96,v80,v81
v_mul_f32 v97,v80,v80
v_add_f32 v98,v82,v83
v_mul_f32 v99,v81,v81
v_fmac_f32 v97,v82,v82
v_fmac_f32 v99,v83,v83
v_add_f32 v96,v96,v84
v_fmac_f32 v97,v84,v84
v_add_f32 v98,v98,v85
v_fmac_f32 v99,v85,v85
v_add_f32 v96,v96,v86
v_fmac_f32 v97,v86,v86
v_add_f32 v98,v98,v87
v_fmac_f32 v99,v87,v87
v_add_f32 v96,v96,v88
v_fmac_f32 v97,v88,v88
v_add_f32 v98,v98,v89
v_fmac_f32 v99,v89,v89
v_add_f32 v96,v96,v90
v_fmac_f32 v97,v90,v90
v_add_f32 v98,v98,v91
v_fmac_f32 v99,v91,v91
v_add_f32 v96,v96,v92
v_fmac_f32 v97,v92,v92
v_add_f32 v98,v98,v93
v_fmac_f32 v99,v93,v93
v_add_f32 v96,v96,v94
v_fmac_f32 v97,v94,v94
v_add_f32 v98,v98,v95
v_fmac_f32 v99,v95,v95
v_add_f32 v96,v96,v98
v_add_f32 v97,v97,v99
s_nop 0
v_add_f32_dpp v96,v96,v96 row_ror:4 row_mask:0xf bank_mask:0xf
v_add_f32_dpp v97,v97,v97 row_ror:4 row_mask:0xf bank_mask:0xf
s_nop 0
v_add_f32_dpp v96,v96,v96 row_ror:8 row_mask:0xf bank_mask:0xf
v_add_f32_dpp v97,v97,v97 row_ror:8 row_mask:0xf bank_mask:0xf
v_mov_b32 v98,v96
v_mov_b32 v99,v97
s_nop 0
v_permlane16_swap_b32 v98,v96
v_permlane16_swap_b32 v99,v97
v_add_f32 v96,v96,v98
v_add_f32 v97,v97,v99
v_mov_b32 v98,v96
v_mov_b32 v99,v97
s_nop 0
v_permlane32_swap_b32 v98,v96
v_permlane32_swap_b32 v99,v97
v_add_f32 v96,v96,v98
v_add_f32 v97,v97,v99
ds_write_b64 v11,v[96:97] offset:0
s_waitcnt lgkmcnt(0)
s_barrier
s_waitcnt vmcnt(2)
v_mov_b32 v15,s60
buffer_store_dword v15,v16,s[20:23],s69 offen sc1
ds_read_b64 v[100:101],v12 offset:0
ds_read_b64 v[102:103],v12 offset:512
ds_read_b64 v[104:105],v12 offset:1024
ds_read_b64 v[106:107],v12 offset:1536
s_waitcnt lgkmcnt(0)
v_add_f32 v100,v100,v102
v_add_f32 v101,v101,v103
v_add_f32 v104,v104,v106
v_add_f32 v105,v105,v107
v_add_f32 v100,v100,v104
v_add_f32 v101,v101,v105
v_mul_f32 v96,0xba800000,v100
v_mul_f32 v102,v96,v96
v_mul_f32 v101,0x3a800000,v101
v_sub_f32 v101,v101,v102
v_max_f32 v101,0,v101
v_add_f32 v101,0x3727c5ac,v101
v_rsq_f32 v97,v101
s_nop 0
v_mul_f32 v96,v96,v97
v_fma_f32 v80,v80,v97,v96
v_fma_f32 v81,v81,v97,v96
v_fma_f32 v82,v82,v97,v96
v_fma_f32 v83,v83,v97,v96
v_fma_f32 v84,v84,v97,v96
v_fma_f32 v85,v85,v97,v96
v_fma_f32 v86,v86,v97,v96
v_fma_f32 v87,v87,v97,v96
v_fma_f32 v88,v88,v97,v96
v_fma_f32 v89,v89,v97,v96
v_fma_f32 v90,v90,v97,v96
v_fma_f32 v91,v91,v97,v96
v_fma_f32 v92,v92,v97,v96
v_fma_f32 v93,v93,v97,v96
v_fma_f32 v94,v94,v97,v96
v_fma_f32 v95,v95,v97,v96
v_fma_f32 v80,v80,v32,v48
v_fma_f32 v81,v81,v33,v49
v_fma_f32 v82,v82,v34,v50
v_fma_f32 v83,v83,v35,v51
v_fma_f32 v84,v84,v36,v52
v_fma_f32 v85,v85,v37,v53
v_fma_f32 v86,v86,v38,v54
v_fma_f32 v87,v87,v39,v55
v_fma_f32 v88,v88,v40,v56
v_fma_f32 v89,v89,v41,v57
v_fma_f32 v90,v90,v42,v58
v_fma_f32 v91,v91,v43,v59
v_fma_f32 v92,v92,v44,v60
v_fma_f32 v93,v93,v45,v61
v_fma_f32 v94,v94,v46,v62
v_fma_f32 v95,v95,v47,v63
v_cvt_pk_bf16_f32 v112,v80,v81
v_cvt_pk_bf16_f32 v113,v82,v83
v_cvt_pk_bf16_f32 v114,v84,v85
v_cvt_pk_bf16_f32 v115,v86,v87
v_cvt_pk_bf16_f32 v116,v88,v89
v_cvt_pk_bf16_f32 v117,v90,v91
v_cvt_pk_bf16_f32 v118,v92,v93
v_cvt_pk_bf16_f32 v119,v94,v95
s_add_u32 s64,s66,4096
buffer_store_dwordx4 v[112:115],v10,s[20:23],s66 offen sc1
buffer_store_dwordx4 v[116:119],v10,s[20:23],s64 offen sc1
s_add_u32 s66,s66,32768
s_add_u32 s60,s60,1
top1_384:
s_waitcnt vmcnt(2)
v_max3_u32 v14,v72,v73,v74
v_max3_u32 v13,v75,v76,v77
v_max3_u32 v14,v14,v78,v79
v_max_u32 v14,v14,v13
v_cmp_eq_u32 vcc,-1,v14
s_cbranch_vccnz rt_388
go_389:
s_add_u32 s63,s63,32768
s_add_u32 s64,s63,4096
buffer_load_dwordx4 v[64:67],v10,s[20:23],s63 offen sc1
buffer_load_dwordx4 v[68:71],v10,s[20:23],s64 offen sc1
v_lshlrev_b32 v80,16,v72
v_and_b32 v81,s73,v72
v_lshlrev_b32 v82,16,v73
v_and_b32 v83,s73,v73
v_lshlrev_b32 v84,16,v74
v_and_b32 v85,s73,v74
v_lshlrev_b32 v86,16,v75
v_and_b32 v87,s73,v75
v_lshlrev_b32 v88,16,v76
v_and_b32 v89,s73,v76
v_lshlrev_b32 v90,16,v77
v_and_b32 v91,s73,v77
v_lshlrev_b32 v92,16,v78
v_and_b32 v93,s73,v78
v_lshlrev_b32 v94,16,v79
v_and_b32 v95,s73,v79
v_add_f32 v96,v80,v81
v_mul_f32 v97,v80,v80
v_add_f32 v98,v82,v83
v_mul_f32 v99,v81,v81
v_fmac_f32 v97,v82,v82
v_fmac_f32 v99,v83,v83
v_add_f32 v96,v96,v84
v_fmac_f32 v97,v84,v84
v_add_f32 v98,v98,v85
v_fmac_f32 v99,v85,v85
v_add_f32 v96,v96,v86
v_fmac_f32 v97,v86,v86
v_add_f32 v98,v98,v87
v_fmac_f32 v99,v87,v87
v_add_f32 v96,v96,v88
v_fmac_f32 v97,v88,v88
v_add_f32 v98,v98,v89
v_fmac_f32 v99,v89,v89
v_add_f32 v96,v96,v90
v_fmac_f32 v97,v90,v90
v_add_f32 v98,v98,v91
v_fmac_f32 v99,v91,v91
v_add_f32 v96,v96,v92
v_fmac_f32 v97,v92,v92
v_add_f32 v98,v98,v93
v_fmac_f32 v99,v93,v93
v_add_f32 v96,v96,v94
v_fmac_f32 v97,v94,v94
v_add_f32 v98,v98,v95
v_fmac_f32 v99,v95,v95
v_add_f32 v96,v96,v98
v_add_f32 v97,v97,v99
s_nop 0
v_add_f32_dpp v96,v96,v96 row_ror:4 row_mask:0xf bank_mask:0xf
v_add_f32_dpp v97,v97,v97 row_ror:4 row_mask:0xf bank_mask:0xf
s_nop 0
v_add_f32_dpp v96,v96,v96 row_ror:8 row_mask:0xf bank_mask:0xf
v_add_f32_dpp v97,v97,v97 row_ror:8 row_mask:0xf bank_mask:0xf
v_mov_b32 v98,v96
v_mov_b32 v99,v97
s_nop 0
v_permlane16_swap_b32 v98,v96
v_permlane16_swap_b32 v99,v97
v_add_f32 v96,v96,v98
v_add_f32 v97,v97,v99
v_mov_b32 v98,v96
v_mov_b32 v99,v97
s_nop 0
v_permlane32_swap_b32 v98,v96
v_permlane32_swap_b32 v99,v97
v_add_f32 v96,v96,v98
v_add_f32 v97,v97,v99
ds_write_b64 v11,v[96:97] offset:2048
s_waitcnt lgkmcnt(0)
s_barrier
s_waitcnt vmcnt(2)
v_mov_b32 v15,s60
buffer_store_dword v15,v16,s[20:23],s69 offen sc1
ds_read_b64 v[100:101],v12 offset:2048
ds_read_b64 v[102:103],v12 offset:2560
ds_read_b64 v[104:105],v12 offset:3072
ds_read_b64 v[106:107],v12 offset:3584
s_waitcnt lgkmcnt(0)
v_add_f32 v100,v100,v102
v_add_f32 v101,v101,v103
v_add_f32 v104,v104,v106
v_add_f32 v105,v105,v107
v_add_f32 v100,v100,v104
v_add_f32 v101,v101,v105
v_mul_f32 v96,0xba800000,v100
v_mul_f32 v102,v96,v96
v_mul_f32 v101,0x3a800000,v101
v_sub_f32 v101,v101,v102
v_max_f32 v101,0,v101
v_add_f32 v101,0x3727c5ac,v101
v_rsq_f32 v97,v101
s_nop 0
v_mul_f32 v96,v96,v97
v_fma_f32 v80,v80,v97,v96
v_fma_f32 v81,v81,v97,v96
v_fma_f32 v82,v82,v97,v96
v_fma_f32 v83,v83,v97,v96
v_fma_f32 v84,v84,v97,v96
v_fma_f32 v85,v85,v97,v96
v_fma_f32 v86,v86,v97,v96
v_fma_f32 v87,v87,v97,v96
v_fma_f32 v88,v88,v97,v96
v_fma_f32 v89,v89,v97,v96
v_fma_f32 v90,v90,v97,v96
v_fma_f32 v91,v91,v97,v96
v_fma_f32 v92,v92,v97,v96
v_fma_f32 v93,v93,v97,v96
v_fma_f32 v94,v94,v97,v96
v_fma_f32 v95,v95,v97,v96
v_fma_f32 v80,v80,v32,v48
v_fma_f32 v81,v81,v33,v49
v_fma_f32 v82,v82,v34,v50
v_fma_f32 v83,v83,v35,v51
v_fma_f32 v84,v84,v36,v52
v_fma_f32 v85,v85,v37,v53
v_fma_f32 v86,v86,v38,v54
v_fma_f32 v87,v87,v39,v55
v_fma_f32 v88,v88,v40,v56
v_fma_f32 v89,v89,v41,v57
v_fma_f32 v90,v90,v42,v58
v_fma_f32 v91,v91,v43,v59
v_fma_f32 v92,v92,v44,v60
v_fma_f32 v93,v93,v45,v61
v_fma_f32 v94,v94,v46,v62
v_fma_f32 v95,v95,v47,v63
v_cvt_pk_bf16_f32 v112,v80,v81
v_cvt_pk_bf16_f32 v113,v82,v83
v_cvt_pk_bf16_f32 v114,v84,v85
v_cvt_pk_bf16_f32 v115,v86,v87
v_cvt_pk_bf16_f32 v116,v88,v89
v_cvt_pk_bf16_f32 v117,v90,v91
v_cvt_pk_bf16_f32 v118,v92,v93
v_cvt_pk_bf16_f32 v119,v94,v95
s_add_u32 s64,s66,4096
buffer_store_dwordx4 v[112:115],v10,s[20:23],s66 offen sc1
buffer_store_dwordx4 v[116:119],v10,s[20:23],s64 offen sc1
s_add_u32 s66,s66,32768
s_add_u32 s60,s60,1
s_cmp_lt_u32 s60,128
s_cbranch_scc1 top0_383
s_waitcnt vmcnt(0)
v_mov_b32 v15,s60
buffer_store_dword v15,v16,s[20:23],s69 offen sc1
s_branch done_367
rt_385:
s_add_u32 s64,s63,4096
buffer_load_dwordx4 v[64:67],v10,s[20:23],s63 offen sc1
buffer_load_dwordx4 v[68:71],v10,s[20:23],s64 offen sc1
s_waitcnt vmcnt(2)
v_mov_b32 v15,s60
buffer_store_dword v15,v16,s[20:23],s69 offen sc1
s_waitcnt vmcnt(1)
v_max3_u32 v14,v64,v65,v66
v_max3_u32 v13,v67,v68,v69
v_max3_u32 v14,v14,v70,v71
v_max_u32 v14,v14,v13
v_cmp_eq_u32 vcc,-1,v14
s_cbranch_vccz go_386
lp_387:
s_sleep 1
s_add_u32 s64,s63,4096
buffer_load_dwordx4 v[64:67],v10,s[20:23],s63 offen sc1
buffer_load_dwordx4 v[68:71],v10,s[20:23],s64 offen sc1
s_waitcnt vmcnt(0)
v_max3_u32 v14,v64,v65,v66
v_max3_u32 v13,v67,v68,v69
v_max3_u32 v14,v14,v70,v71
v_max_u32 v14,v14,v13
v_cmp_eq_u32 vcc,-1,v14
s_cbranch_vccz go_386
s_sub_u32 s90,s90,1
s_cmp_gt_i32 s90,0
s_cbranch_scc1 lp_387
s_branch go_386
rt_388:
s_add_u32 s64,s63,4096
buffer_load_dwordx4 v[72:75],v10,s[20:23],s63 offen sc1
buffer_load_dwordx4 v[76:79],v10,s[20:23],s64 offen sc1
s_waitcnt vmcnt(2)
v_mov_b32 v15,s60
buffer_store_dword v15,v16,s[20:23],s69 offen sc1
s_waitcnt vmcnt(1)
v_max3_u32 v14,v72,v73,v74
v_max3_u32 v13,v75,v76,v77
v_max3_u32 v14,v14,v78,v79
v_max_u32 v14,v14,v13
v_cmp_eq_u32 vcc,-1,v14
s_cbranch_vccz go_389
lp_390:
s_sleep 1
s_add_u32 s64,s63,4096
buffer_load_dwordx4 v[72:75],v10,s[20:23],s63 offen sc1
buffer_load_dwordx4 v[76:79],v10,s[20:23],s64 offen sc1
s_waitcnt vmcnt(0)
v_max3_u32 v14,v72,v73,v74
v_max3_u32 v13,v75,v76,v77
v_max3_u32 v14,v14,v78,v79
v_max_u32 v14,v14,v13
v_cmp_eq_u32 vcc,-1,v14
s_cbranch_vccz go_389
s_sub_u32 s90,s90,1
s_cmp_gt_i32 s90,0
s_cbranch_scc1 lp_390
s_branch go_389
done_367:
s_endpgm
fl_att:
s_mov_b32 s92,s2
s_and_b32 s93,s3,0xffff
s_mov_b32 s94,0x100
s_mov_b32 s95,0x20000
v_mbcnt_lo_u32_b32 v16,-1,0
v_mbcnt_hi_u32_b32 v16,-1,v16
v_mov_b32 v18,0
v_cmp_eq_u32 vcc,22,v16
s_nop 1
v_cndmask_b32 v18,v18,63,vcc
v_cmp_eq_u32 vcc,21,v16
s_nop 1
v_cndmask_b32 v18,v18,1,vcc
v_and_b32 v19,1,v16
v_cmp_eq_u32 vcc,1,v19
v_mov_b32 v19,8192
s_nop 0
v_cndmask_b32 v19,-1,v19,vcc
v_min_u32 v16,31,v16
v_lshlrev_b32 v16,2,v16
s_sub_u32 s66,s88,64
s_cmp_lg_u32 s50,0
s_cbranch_scc1 vot_395
vpoll_391:
buffer_load_dword v17,v16,s[92:95],s66 offen sc1
s_waitcnt vmcnt(0)
s_cmp_lg_u32 s56,2
s_cbranch_scc1 vck_392
v_cmp_eq_u32 vcc,v17,v19
s_and_b32 s64,vcc_lo,0xffff
s_cmp_eq_u32 s64,65535
s_cbranch_scc1 vck_392
s_mov_b32 s65,0
v_readlane_b32 s64,v17,1
s_lshr_b32 s64,s64,8
s_add_u32 s65,s65,s64
v_readlane_b32 s64,v17,3
s_lshr_b32 s64,s64,8
s_add_u32 s65,s65,s64
v_readlane_b32 s64,v17,5
s_lshr_b32 s64,s64,8
s_add_u32 s65,s65,s64
v_readlane_b32 s64,v17,7
s_lshr_b32 s64,s64,8
s_add_u32 s65,s65,s64
v_readlane_b32 s64,v17,9
s_lshr_b32 s64,s64,8
s_add_u32 s65,s65,s64
v_readlane_b32 s64,v17,11
s_lshr_b32 s64,s64,8
s_add_u32 s65,s65,s64
v_readlane_b32 s64,v17,13
s_lshr_b32 s64,s64,8
s_add_u32 s65,s65,s64
v_readlane_b32 s64,v17,15
s_lshr_b32 s64,s64,8
s_add_u32 s65,s65,s64
s_cmp_ge_u32 s65,256
s_cbranch_scc1 vok_394
s_branch vrt_393
vck_392:
v_cmp_gt_u32 vcc,v18,v17
s_cbranch_vccz vok_394
vrt_393:
s_sleep 8
s_sub_u32 s90,s90,1
s_cmp_gt_i32 s90,0
s_cbranch_scc1 vpoll_391
vok_394:
v_add_u32 v18,161280,v16
ds_write_b32 v18,v17
s_waitcnt lgkmcnt(0)
vot_395:
s_barrier
v_add_u32 v18,161280,v16
ds_read_b32 v17,v18
s_waitcnt lgkmcnt(0)
s_cmp_lg_u32 s56,2
s_cbranch_scc1 vfin_396
v_cmp_eq_u32 vcc,v17,v19
s_and_b32 s64,vcc_lo,0xffff
s_cmp_eq_u32 s64,65535
s_cbranch_scc1 vfin_396
s_mov_b32 s65,0
v_readlane_b32 s64,v17,1
s_lshr_b32 s64,s64,8
s_add_u32 s65,s65,s64
v_readlane_b32 s64,v17,3
s_lshr_b32 s64,s64,8
s_add_u32 s65,s65,s64
v_readlane_b32 s64,v17,5
s_lshr_b32 s64,s64,8
s_add_u32 s65,s65,s64
v_readlane_b32 s64,v17,7
s_lshr_b32 s64,s64,8
s_add_u32 s65,s65,s64
v_readlane_b32 s64,v17,9
s_lshr_b32 s64,s64,8
s_add_u32 s65,s65,s64
v_readlane_b32 s64,v17,11
s_lshr_b32 s64,s64,8
s_add_u32 s65,s65,s64
v_readlane_b32 s64,v17,13
s_lshr_b32 s64,s64,8
s_add_u32 s65,s65,s64
v_readlane_b32 s64,v17,15
s_lshr_b32 s64,s64,8
s_add_u32 s65,s65,s64
s_cmp_ge_u32 s65,256
s_cbranch_scc1 fl_fb
vfin_396:
s_and_b32 s56,s56,1
s_mov_b32 s67,0
v_readlane_b32 s65,v17,21
s_and_b32 s65,s65,2
s_lshl_b32 s67,s65,12
v_lshlrev_b32 v0,4,v1
v_and_b32 v21,15,v1
v_lshrrev_b32 v22,4,v1
v_and_b32 v23,7,v21
v_lshlrev_b32 v23,4,v23
v_lshl_add_u32 v3,v22,8,v23
v_and_b32 v23,31,v1
v_lshlrev_b32 v4,4,v23
v_and_b32 v23,3,v1
v_bfe_u32 v24,v1,2,1
v_lshlrev_b32 v23,14,v23
v_lshl_add_u32 v2,v24,7,v23
v_mov_b32 v7,0xff800000
s_and_b32 s54,s50,1
s_lshl_b32 s64,s54,4
v_lshlrev_b32 v23,2,v22
v_sub_u32 v23,v21,v23
v_add_u32 v23,s64,v23
v_cmp_le_i32 s[28:29],0,v23
v_cmp_le_i32 s[30:31],1,v23
v_cmp_le_i32 s[32:33],2,v23
v_cmp_le_i32 s[34:35],3,v23
v_cmp_le_i32 s[36:37],16,v23
v_cmp_le_i32 s[38:39],17,v23
v_cmp_le_i32 s[40:41],18,v23
v_cmp_le_i32 s[42:43],19,v23
s_mov_b32 s44,-1
s_mov_b32 s45,0
s_mov_b32 s80,0x3e0293ee
s_lshl_b32 s52,s59,1
s_lshr_b32 s64,s50,1
s_add_u32 s52,s52,s64
s_lshl_b32 s53,s52,15
s_lshl_b32 s68,s52,8
s_add_u32 s68,s68,s67
s_add_u32 s68,s68,138428416
s_lshl_b32 s69,s59,8
s_lshl_b32 s64,s64,2
s_add_u32 s69,s69,s64
s_lshl_b32 s64,s54,3
s_add_u32 s69,s69,s64
s_add_u32 s69,s69,138543104
s_lshl_b32 s66,s52,12
s_lshl_b32 s64,s54,17
s_add_u32 s66,s66,s64
s_add_u32 s66,s66,150994944
s_lshl_b32 s55,s54,10
s_xor_b32 s55,s55,0x2000
s_mov_b32 s60,0
s_add_u32 s64,s69,16
v_mov_b32 v6,124
s_mov_b64 exec,1
buffer_store_dword v6,off,s[20:23],s64 sc1
s_mov_b64 exec,-1
s_add_u32 s64,s69,32
v_mov_b32 v6,126
s_mov_b64 exec,1
buffer_store_dword v6,off,s[20:23],s64 sc1
s_mov_b64 exec,-1
s_mov_b32 s71,1
plp_397:
buffer_load_dword v5,v2,s[20:23],s68 offen sc1
s_waitcnt vmcnt(0)
v_cmp_gt_u32 vcc,s71,v5
s_cbranch_vccz pok_398
s_sleep 4
s_sub_u32 s90,s90,1
s_cmp_gt_i32 s90,0
s_cbranch_scc1 plp_397
pok_398:
s_add_u32 s64,s60,0
s_lshl_b32 s65,s64,11
s_and_b32 s65,s65,0x2000
s_xor_b32 s65,s65,s67
s_lshl_b32 s64,s64,19
s_add_u32 s64,s64,s65
s_add_u32 s92,s64,s53
s_add_u32 s93,s92,16384
s_add_u32 s94,s92,4096
s_add_u32 s95,s93,4096
s_xor_b32 s96,s92,s55
s_xor_b32 s97,s93,s55
buffer_load_dwordx4 a[0:3],v0,s[20:23],s96 offen offset:0
buffer_load_dwordx4 a[16:19],v0,s[20:23],s92 offen offset:0
buffer_load_dwordx4 a[32:35],v0,s[20:23],s92 offen offset:1024
buffer_load_dwordx4 a[4:7],v0,s[20:23],s96 offen offset:2048
buffer_load_dwordx4 a[20:23],v0,s[20:23],s92 offen offset:2048
buffer_load_dwordx4 a[36:39],v0,s[20:23],s92 offen offset:3072
buffer_load_dwordx4 a[8:11],v0,s[20:23],s97 offen offset:0
buffer_load_dwordx4 a[24:27],v0,s[20:23],s93 offen offset:0
buffer_load_dwordx4 a[40:43],v0,s[20:23],s93 offen offset:1024
buffer_load_dwordx4 a[12:15],v0,s[20:23],s97 offen offset:2048
buffer_load_dwordx4 a[28:31],v0,s[20:23],s93 offen offset:2048
buffer_load_dwordx4 a[44:47],v0,s[20:23],s93 offen offset:3072
buffer_load_dwordx4 a[48:51],v0,s[20:23],s94 offen offset:0
buffer_load_dwordx4 a[52:55],v0,s[20:23],s94 offen offset:1024
buffer_load_dwordx4 a[56:59],v0,s[20:23],s94 offen offset:2048
buffer_load_dwordx4 a[60:63],v0,s[20:23],s94 offen offset:3072
buffer_load_dwordx4 a[64:67],v0,s[20:23],s95 offen offset:0
buffer_load_dwordx4 a[68:71],v0,s[20:23],s95 offen offset:1024
buffer_load_dwordx4 a[72:75],v0,s[20:23],s95 offen offset:2048
buffer_load_dwordx4 a[76:79],v0,s[20:23],s95 offen offset:3072
s_waitcnt vmcnt(8)
top0_399:
v_mfma_f32_16x16x32_bf16 v[48:51],a[16:19],a[0:3],0
v_mfma_f32_16x16x32_bf16 v[52:55],a[32:35],a[0:3],0
v_mfma_f32_16x16x32_bf16 v[48:51],a[20:23],a[4:7],v[48:51]
v_mfma_f32_16x16x32_bf16 v[52:55],a[36:39],a[4:7],v[52:55]
v_mfma_f32_16x16x32_bf16 v[48:51],a[24:27],a[8:11],v[48:51]
v_mfma_f32_16x16x32_bf16 v[52:55],a[40:43],a[8:11],v[52:55]
v_mfma_f32_16x16x32_bf16 v[48:51],a[28:31],a[12:15],v[48:51]
v_mfma_f32_16x16x32_bf16 v[52:55],a[44:47],a[12:15],v[52:55]
s_nop 6
v_cndmask_b32 v48,v7,v48,s[28:29]
v_cndmask_b32 v49,v7,v49,s[30:31]
v_cndmask_b32 v50,v7,v50,s[32:33]
v_cndmask_b32 v51,v7,v51,s[34:35]
v_cndmask_b32 v52,v7,v52,s[36:37]
v_cndmask_b32 v53,v7,v53,s[38:39]
v_cndmask_b32 v54,v7,v54,s[40:41]
v_cndmask_b32 v55,v7,v55,s[42:43]
v_max3_f32 v72,v48,v49,v50
v_max3_f32 v72,v72,v51,v52
v_max3_f32 v72,v72,v53,v54
v_max_f32 v72,v72,v55
s_add_u32 s64,s60,0
s_lshl_b32 s65,s64,11
s_and_b32 s65,s65,0x2000
s_xor_b32 s65,s65,s67
s_lshl_b32 s64,s64,19
s_add_u32 s64,s64,s65
s_add_u32 s98,s64,s53
s_add_u32 s98,s98,67108864
s_add_u32 s99,s98,16384
s_lshr_b32 s71,s60,1
s_add_u32 s71,s71,1
s_waitcnt vmcnt(1)
v_cmp_gt_u32 vcc,s71,v5
s_cbranch_vccz ek_401
plp_404:
buffer_load_dword v5,v2,s[20:23],s68 offen sc1
s_waitcnt vmcnt(0)
v_cmp_gt_u32 vcc,s71,v5
s_cbranch_vccz pok_405
s_sleep 4
s_sub_u32 s90,s90,1
s_cmp_gt_i32 s90,0
s_cbranch_scc1 plp_404
pok_405:
ek_401:
buffer_load_dwordx4 v[16:19],v3,s[20:23],s98 offen offset:0
buffer_load_dwordx4 v[20:23],v3,s[20:23],s98 offen offset:128
buffer_load_dwordx4 v[24:27],v3,s[20:23],s99 offen offset:0
buffer_load_dwordx4 v[28:31],v3,s[20:23],s99 offen offset:128
buffer_load_dwordx4 v[32:35],v4,s[20:23],s98 offen offset:1024
buffer_load_dwordx4 v[36:39],v4,s[20:23],s98 offen offset:1536
buffer_load_dwordx4 v[40:43],v4,s[20:23],s99 offen offset:1024
buffer_load_dwordx4 v[44:47],v4,s[20:23],s99 offen offset:1536
s_barrier
s_add_u32 s64,s60,2
s_lshl_b32 s65,s64,11
s_and_b32 s65,s65,0x2000
s_xor_b32 s65,s65,s67
s_lshl_b32 s64,s64,19
s_add_u32 s64,s64,s65
s_add_u32 s92,s64,s53
s_add_u32 s93,s92,16384
s_add_u32 s94,s92,4096
s_add_u32 s95,s93,4096
s_xor_b32 s96,s92,s55
s_xor_b32 s97,s93,s55
buffer_load_dwordx4 a[80:83],v0,s[20:23],s96 offen offset:0
buffer_load_dwordx4 a[96:99],v0,s[20:23],s92 offen offset:0
buffer_load_dwordx4 a[112:115],v0,s[20:23],s92 offen offset:1024
buffer_load_dwordx4 a[84:87],v0,s[20:23],s96 offen offset:2048
buffer_load_dwordx4 a[100:103],v0,s[20:23],s92 offen offset:2048
buffer_load_dwordx4 a[116:119],v0,s[20:23],s92 offen offset:3072
buffer_load_dwordx4 a[88:91],v0,s[20:23],s97 offen offset:0
buffer_load_dwordx4 a[104:107],v0,s[20:23],s93 offen offset:0
buffer_load_dwordx4 a[120:123],v0,s[20:23],s93 offen offset:1024
buffer_load_dwordx4 a[92:95],v0,s[20:23],s97 offen offset:2048
buffer_load_dwordx4 a[108:111],v0,s[20:23],s93 offen offset:2048
buffer_load_dwordx4 a[124:127],v0,s[20:23],s93 offen offset:3072
s_waitcnt vmcnt(16)
v_mfma_f32_16x16x32_bf16 v[56:59],v[16:19],a[0:3],0
v_mfma_f32_16x16x32_bf16 v[56:59],v[20:23],a[4:7],v[56:59]
v_mfma_f32_16x16x32_bf16 v[56:59],v[24:27],a[8:11],v[56:59]
v_mfma_f32_16x16x32_bf16 v[56:59],v[28:31],a[12:15],v[56:59]
s_nop 7
v_cndmask_b32 v56,v7,v56,s[44:45]
v_cndmask_b32 v57,v7,v57,s[44:45]
v_cndmask_b32 v58,v7,v58,s[44:45]
v_cndmask_b32 v59,v7,v59,s[44:45]
v_max3_f32 v72,v72,v56,v57
v_max3_f32 v72,v72,v58,v59
v_mov_b32 v73,v72
s_nop 1
v_permlane16_swap_b32 v73,v72
v_max_f32 v72,v72,v73
v_mov_b32 v73,v72
s_nop 1
v_permlane32_swap_b32 v73,v72
v_max_f32 v72,v72,v73
v_mul_f32 v72,s80,v72
v_fma_f32 v48,v48,s80,-v72
v_fma_f32 v49,v49,s80,-v72
v_fma_f32 v50,v50,s80,-v72
v_fma_f32 v51,v51,s80,-v72
v_fma_f32 v52,v52,s80,-v72
v_fma_f32 v53,v53,s80,-v72
v_fma_f32 v54,v54,s80,-v72
v_fma_f32 v55,v55,s80,-v72
v_fma_f32 v56,v56,s80,-v72
v_fma_f32 v57,v57,s80,-v72
v_fma_f32 v58,v58,s80,-v72
v_fma_f32 v59,v59,s80,-v72
v_exp_f32 v48,v48
v_exp_f32 v49,v49
v_exp_f32 v50,v50
v_exp_f32 v51,v51
v_exp_f32 v52,v52
v_exp_f32 v53,v53
v_exp_f32 v54,v54
v_exp_f32 v55,v55
v_exp_f32 v56,v56
v_exp_f32 v57,v57
v_exp_f32 v58,v58
v_exp_f32 v59,v59
v_add_f32 v74,v48,v49
v_add_f32 v75,v50,v51
v_add_f32 v74,v74,v52
v_add_f32 v75,v75,v53
v_add_f32 v74,v74,v54
v_add_f32 v75,v75,v55
v_add_f32 v74,v74,v56
v_add_f32 v75,v75,v57
v_add_f32 v74,v74,v58
v_add_f32 v75,v75,v59
v_add_f32 v74,v74,v75
v_mov_b32 v73,v74
s_nop 1
v_permlane16_swap_b32 v73,v74
v_add_f32 v74,v74,v73
v_mov_b32 v73,v74
s_nop 1
v_permlane32_swap_b32 v73,v74
v_add_f32 v74,v74,v73
v_rcp_f32 v75,v74
s_nop 0
v_mul_f32 v48,v48,v75
v_mul_f32 v49,v49,v75
v_mul_f32 v50,v50,v75
v_mul_f32 v51,v51,v75
v_mul_f32 v52,v52,v75
v_mul_f32 v53,v53,v75
v_mul_f32 v54,v54,v75
v_mul_f32 v55,v55,v75
v_mul_f32 v56,v56,v75
v_mul_f32 v57,v57,v75
v_mul_f32 v58,v58,v75
v_mul_f32 v59,v59,v75
v_cvt_pk_bf16_f32 v64,v48,v49
v_cvt_pk_bf16_f32 v65,v50,v51
v_cvt_pk_bf16_f32 v66,v52,v53
v_cvt_pk_bf16_f32 v67,v54,v55
v_cvt_pk_bf16_f32 v68,v56,v57
v_cvt_pk_bf16_f32 v69,v58,v59
v_mfma_f32_16x16x32_bf16 v[80:83],a[48:51],v[64:67],0
v_mfma_f32_16x16x32_bf16 v[84:87],a[52:55],v[64:67],0
v_mfma_f32_16x16x32_bf16 v[88:91],a[56:59],v[64:67],0
v_mfma_f32_16x16x32_bf16 v[92:95],a[60:63],v[64:67],0
v_mfma_f32_16x16x32_bf16 v[96:99],a[64:67],v[64:67],0
v_mfma_f32_16x16x32_bf16 v[100:103],a[68:71],v[64:67],0
v_mfma_f32_16x16x32_bf16 v[104:107],a[72:75],v[64:67],0
v_mfma_f32_16x16x32_bf16 v[108:111],a[76:79],v[64:67],0
s_waitcnt vmcnt(12)
v_mfma_f32_16x16x16_bf16 v[80:83],v[32:33],v[68:69],v[80:83]
v_mfma_f32_16x16x16_bf16 v[84:87],v[34:35],v[68:69],v[84:87]
v_mfma_f32_16x16x16_bf16 v[88:91],v[36:37],v[68:69],v[88:91]
v_mfma_f32_16x16x16_bf16 v[92:95],v[38:39],v[68:69],v[92:95]
v_mfma_f32_16x16x16_bf16 v[96:99],v[40:41],v[68:69],v[96:99]
v_mfma_f32_16x16x16_bf16 v[100:103],v[42:43],v[68:69],v[100:103]
v_mfma_f32_16x16x16_bf16 v[104:107],v[44:45],v[68:69],v[104:107]
v_mfma_f32_16x16x16_bf16 v[108:111],v[46:47],v[68:69],v[108:111]
s_nop 0
v_cvt_pk_bf16_f32 v112,v80,v81
v_cvt_pk_bf16_f32 v113,v82,v83
v_cvt_pk_bf16_f32 v114,v84,v85
v_cvt_pk_bf16_f32 v115,v86,v87
buffer_store_dwordx4 v[112:115],v0,s[20:23],s66 offen offset:0 sc1
v_cvt_pk_bf16_f32 v116,v88,v89
v_cvt_pk_bf16_f32 v117,v90,v91
v_cvt_pk_bf16_f32 v118,v92,v93
v_cvt_pk_bf16_f32 v119,v94,v95
buffer_store_dwordx4 v[116:119],v0,s[20:23],s66 offen offset:1024 sc1
v_cvt_pk_bf16_f32 v112,v96,v97
v_cvt_pk_bf16_f32 v113,v98,v99
v_cvt_pk_bf16_f32 v114,v100,v101
v_cvt_pk_bf16_f32 v115,v102,v103
buffer_store_dwordx4 v[112:115],v0,s[20:23],s66 offen offset:2048 sc1
v_cvt_pk_bf16_f32 v116,v104,v105
v_cvt_pk_bf16_f32 v117,v106,v107
v_cvt_pk_bf16_f32 v118,v108,v109
v_cvt_pk_bf16_f32 v119,v110,v111
buffer_store_dwordx4 v[116:119],v0,s[20:23],s66 offen offset:3072 sc1
s_barrier
buffer_load_dwordx4 a[128:131],v0,s[20:23],s94 offen offset:0
buffer_load_dwordx4 a[132:135],v0,s[20:23],s94 offen offset:1024
buffer_load_dwordx4 a[136:139],v0,s[20:23],s94 offen offset:2048
buffer_load_dwordx4 a[140:143],v0,s[20:23],s94 offen offset:3072
buffer_load_dwordx4 a[144:147],v0,s[20:23],s95 offen offset:0
buffer_load_dwordx4 a[148:151],v0,s[20:23],s95 offen offset:1024
buffer_load_dwordx4 a[152:155],v0,s[20:23],s95 offen offset:2048
buffer_load_dwordx4 a[156:159],v0,s[20:23],s95 offen offset:3072
buffer_load_dword v5,v2,s[20:23],s68 offen sc1
s_add_u32 s66,s66,262144
s_add_u32 s60,s60,2
s_add_u32 s72,s60,s54
s_waitcnt vmcnt(9)
v_mov_b32 v6,s72
s_mov_b64 exec,1
buffer_store_dword v6,off,s[20:23],s69 sc1
s_mov_b64 exec,-1
top1_400:
v_mfma_f32_16x16x32_bf16 v[48:51],a[96:99],a[80:83],0
v_mfma_f32_16x16x32_bf16 v[52:55],a[112:115],a[80:83],0
v_mfma_f32_16x16x32_bf16 v[48:51],a[100:103],a[84:87],v[48:51]
v_mfma_f32_16x16x32_bf16 v[52:55],a[116:119],a[84:87],v[52:55]
v_mfma_f32_16x16x32_bf16 v[48:51],a[104:107],a[88:91],v[48:51]
v_mfma_f32_16x16x32_bf16 v[52:55],a[120:123],a[88:91],v[52:55]
v_mfma_f32_16x16x32_bf16 v[48:51],a[108:111],a[92:95],v[48:51]
v_mfma_f32_16x16x32_bf16 v[52:55],a[124:127],a[92:95],v[52:55]
s_nop 6
v_cndmask_b32 v48,v7,v48,s[28:29]
v_cndmask_b32 v49,v7,v49,s[30:31]
v_cndmask_b32 v50,v7,v50,s[32:33]
v_cndmask_b32 v51,v7,v51,s[34:35]
v_cndmask_b32 v52,v7,v52,s[36:37]
v_cndmask_b32 v53,v7,v53,s[38:39]
v_cndmask_b32 v54,v7,v54,s[40:41]
v_cndmask_b32 v55,v7,v55,s[42:43]
v_max3_f32 v72,v48,v49,v50
v_max3_f32 v72,v72,v51,v52
v_max3_f32 v72,v72,v53,v54
v_max_f32 v72,v72,v55
s_add_u32 s64,s60,0
s_lshl_b32 s65,s64,11
s_and_b32 s65,s65,0x2000
s_xor_b32 s65,s65,s67
s_lshl_b32 s64,s64,19
s_add_u32 s64,s64,s65
s_add_u32 s98,s64,s53
s_add_u32 s98,s98,67108864
s_add_u32 s99,s98,16384
s_lshr_b32 s71,s60,1
s_add_u32 s71,s71,1
s_waitcnt vmcnt(1)
v_cmp_gt_u32 vcc,s71,v5
s_cbranch_vccz ek_406
plp_409:
buffer_load_dword v5,v2,s[20:23],s68 offen sc1
s_waitcnt vmcnt(0)
v_cmp_gt_u32 vcc,s71,v5
s_cbranch_vccz pok_410
s_sleep 4
s_sub_u32 s90,s90,1
s_cmp_gt_i32 s90,0
s_cbranch_scc1 plp_409
pok_410:
ek_406:
buffer_load_dwordx4 v[16:19],v3,s[20:23],s98 offen offset:0
buffer_load_dwordx4 v[20:23],v3,s[20:23],s98 offen offset:128
buffer_load_dwordx4 v[24:27],v3,s[20:23],s99 offen offset:0
buffer_load_dwordx4 v[28:31],v3,s[20:23],s99 offen offset:128
buffer_load_dwordx4 v[32:35],v4,s[20:23],s98 offen offset:1024
buffer_load_dwordx4 v[36:39],v4,s[20:23],s98 offen offset:1536
buffer_load_dwordx4 v[40:43],v4,s[20:23],s99 offen offset:1024
buffer_load_dwordx4 v[44:47],v4,s[20:23],s99 offen offset:1536
s_barrier
s_cmp_lt_u32 s60,122
s_cbranch_scc1 pf_411
s_waitcnt vmcnt(0)
s_branch j1_412
pf_411:
s_add_u32 s64,s60,2
s_lshl_b32 s65,s64,11
s_and_b32 s65,s65,0x2000
s_xor_b32 s65,s65,s67
s_lshl_b32 s64,s64,19
s_add_u32 s64,s64,s65
s_add_u32 s92,s64,s53
s_add_u32 s93,s92,16384
s_add_u32 s94,s92,4096
s_add_u32 s95,s93,4096
s_xor_b32 s96,s92,s55
s_xor_b32 s97,s93,s55
buffer_load_dwordx4 a[0:3],v0,s[20:23],s96 offen offset:0
buffer_load_dwordx4 a[16:19],v0,s[20:23],s92 offen offset:0
buffer_load_dwordx4 a[32:35],v0,s[20:23],s92 offen offset:1024
buffer_load_dwordx4 a[4:7],v0,s[20:23],s96 offen offset:2048
buffer_load_dwordx4 a[20:23],v0,s[20:23],s92 offen offset:2048
buffer_load_dwordx4 a[36:39],v0,s[20:23],s92 offen offset:3072
buffer_load_dwordx4 a[8:11],v0,s[20:23],s97 offen offset:0
buffer_load_dwordx4 a[24:27],v0,s[20:23],s93 offen offset:0
buffer_load_dwordx4 a[40:43],v0,s[20:23],s93 offen offset:1024
buffer_load_dwordx4 a[12:15],v0,s[20:23],s97 offen offset:2048
buffer_load_dwordx4 a[28:31],v0,s[20:23],s93 offen offset:2048
buffer_load_dwordx4 a[44:47],v0,s[20:23],s93 offen offset:3072
j1_412:
s_waitcnt vmcnt(16)
v_mfma_f32_16x16x32_bf16 v[56:59],v[16:19],a[80:83],0
v_mfma_f32_16x16x32_bf16 v[56:59],v[20:23],a[84:87],v[56:59]
v_mfma_f32_16x16x32_bf16 v[56:59],v[24:27],a[88:91],v[56:59]
v_mfma_f32_16x16x32_bf16 v[56:59],v[28:31],a[92:95],v[56:59]
s_nop 7
v_cndmask_b32 v56,v7,v56,s[44:45]
v_cndmask_b32 v57,v7,v57,s[44:45]
v_cndmask_b32 v58,v7,v58,s[44:45]
v_cndmask_b32 v59,v7,v59,s[44:45]
v_max3_f32 v72,v72,v56,v57
v_max3_f32 v72,v72,v58,v59
v_mov_b32 v73,v72
s_nop 1
v_permlane16_swap_b32 v73,v72
v_max_f32 v72,v72,v73
v_mov_b32 v73,v72
s_nop 1
v_permlane32_swap_b32 v73,v72
v_max_f32 v72,v72,v73
v_mul_f32 v72,s80,v72
v_fma_f32 v48,v48,s80,-v72
v_fma_f32 v49,v49,s80,-v72
v_fma_f32 v50,v50,s80,-v72
v_fma_f32 v51,v51,s80,-v72
v_fma_f32 v52,v52,s80,-v72
v_fma_f32 v53,v53,s80,-v72
v_fma_f32 v54,v54,s80,-v72
v_fma_f32 v55,v55,s80,-v72
v_fma_f32 v56,v56,s80,-v72
v_fma_f32 v57,v57,s80,-v72
v_fma_f32 v58,v58,s80,-v72
v_fma_f32 v59,v59,s80,-v72
v_exp_f32 v48,v48
v_exp_f32 v49,v49
v_exp_f32 v50,v50
v_exp_f32 v51,v51
v_exp_f32 v52,v52
v_exp_f32 v53,v53
v_exp_f32 v54,v54
v_exp_f32 v55,v55
v_exp_f32 v56,v56
v_exp_f32 v57,v57
v_exp_f32 v58,v58
v_exp_f32 v59,v59
v_add_f32 v74,v48,v49
v_add_f32 v75,v50,v51
v_add_f32 v74,v74,v52
v_add_f32 v75,v75,v53
v_add_f32 v74,v74,v54
v_add_f32 v75,v75,v55
v_add_f32 v74,v74,v56
v_add_f32 v75,v75,v57
v_add_f32 v74,v74,v58
v_add_f32 v75,v75,v59
v_add_f32 v74,v74,v75
v_mov_b32 v73,v74
s_nop 1
v_permlane16_swap_b32 v73,v74
v_add_f32 v74,v74,v73
v_mov_b32 v73,v74
s_nop 1
v_permlane32_swap_b32 v73,v74
v_add_f32 v74,v74,v73
v_rcp_f32 v75,v74
s_nop 0
v_mul_f32 v48,v48,v75
v_mul_f32 v49,v49,v75
v_mul_f32 v50,v50,v75
v_mul_f32 v51,v51,v75
v_mul_f32 v52,v52,v75
v_mul_f32 v53,v53,v75
v_mul_f32 v54,v54,v75
v_mul_f32 v55,v55,v75
v_mul_f32 v56,v56,v75
v_mul_f32 v57,v57,v75
v_mul_f32 v58,v58,v75
v_mul_f32 v59,v59,v75
v_cvt_pk_bf16_f32 v64,v48,v49
v_cvt_pk_bf16_f32 v65,v50,v51
v_cvt_pk_bf16_f32 v66,v52,v53
v_cvt_pk_bf16_f32 v67,v54,v55
v_cvt_pk_bf16_f32 v68,v56,v57
v_cvt_pk_bf16_f32 v69,v58,v59
v_mfma_f32_16x16x32_bf16 v[80:83],a[128:131],v[64:67],0
v_mfma_f32_16x16x32_bf16 v[84:87],a[132:135],v[64:67],0
v_mfma_f32_16x16x32_bf16 v[88:91],a[136:139],v[64:67],0
v_mfma_f32_16x16x32_bf16 v[92:95],a[140:143],v[64:67],0
v_mfma_f32_16x16x32_bf16 v[96:99],a[144:147],v[64:67],0
v_mfma_f32_16x16x32_bf16 v[100:103],a[148:151],v[64:67],0
v_mfma_f32_16x16x32_bf16 v[104:107],a[152:155],v[64:67],0
v_mfma_f32_16x16x32_bf16 v[108:111],a[156:159],v[64:67],0
s_waitcnt vmcnt(12)
v_mfma_f32_16x16x16_bf16 v[80:83],v[32:33],v[68:69],v[80:83]
v_mfma_f32_16x16x16_bf16 v[84:87],v[34:35],v[68:69],v[84:87]
v_mfma_f32_16x16x16_bf16 v[88:91],v[36:37],v[68:69],v[88:91]
v_mfma_f32_16x16x16_bf16 v[92:95],v[38:39],v[68:69],v[92:95]
v_mfma_f32_16x16x16_bf16 v[96:99],v[40:41],v[68:69],v[96:99]
v_mfma_f32_16x16x16_bf16 v[100:103],v[42:43],v[68:69],v[100:103]
v_mfma_f32_16x16x16_bf16 v[104:107],v[44:45],v[68:69],v[104:107]
v_mfma_f32_16x16x16_bf16 v[108:111],v[46:47],v[68:69],v[108:111]
s_nop 0
v_cvt_pk_bf16_f32 v112,v80,v81
v_cvt_pk_bf16_f32 v113,v82,v83
v_cvt_pk_bf16_f32 v114,v84,v85
v_cvt_pk_bf16_f32 v115,v86,v87
buffer_store_dwordx4 v[112:115],v0,s[20:23],s66 offen offset:0 sc1
v_cvt_pk_bf16_f32 v116,v88,v89
v_cvt_pk_bf16_f32 v117,v90,v91
v_cvt_pk_bf16_f32 v118,v92,v93
v_cvt_pk_bf16_f32 v119,v94,v95
buffer_store_dwordx4 v[116:119],v0,s[20:23],s66 offen offset:1024 sc1
v_cvt_pk_bf16_f32 v112,v96,v97
v_cvt_pk_bf16_f32 v113,v98,v99
v_cvt_pk_bf16_f32 v114,v100,v101
v_cvt_pk_bf16_f32 v115,v102,v103
buffer_store_dwordx4 v[112:115],v0,s[20:23],s66 offen offset:2048 sc1
v_cvt_pk_bf16_f32 v116,v104,v105
v_cvt_pk_bf16_f32 v117,v106,v107
v_cvt_pk_bf16_f32 v118,v108,v109
v_cvt_pk_bf16_f32 v119,v110,v111
buffer_store_dwordx4 v[116:119],v0,s[20:23],s66 offen offset:3072 sc1
s_barrier
s_cmp_lt_u32 s60,122
s_cbranch_scc1 pf_413
s_waitcnt vmcnt(0)
s_branch j1_414
pf_413:
buffer_load_dwordx4 a[48:51],v0,s[20:23],s94 offen offset:0
buffer_load_dwordx4 a[52:55],v0,s[20:23],s94 offen offset:1024
buffer_load_dwordx4 a[56:59],v0,s[20:23],s94 offen offset:2048
buffer_load_dwordx4 a[60:63],v0,s[20:23],s94 offen offset:3072
buffer_load_dwordx4 a[64:67],v0,s[20:23],s95 offen offset:0
buffer_load_dwordx4 a[68:71],v0,s[20:23],s95 offen offset:1024
buffer_load_dwordx4 a[72:75],v0,s[20:23],s95 offen offset:2048
buffer_load_dwordx4 a[76:79],v0,s[20:23],s95 offen offset:3072
j1_414:
buffer_load_dword v5,v2,s[20:23],s68 offen sc1
s_add_u32 s66,s66,262144
s_add_u32 s60,s60,2
s_add_u32 s72,s60,s54
s_cmp_eq_u32 s60,124
s_cselect_b32 s72,128,s72
s_waitcnt vmcnt(9)
v_mov_b32 v6,s72
s_mov_b64 exec,1
buffer_store_dword v6,off,s[20:23],s69 sc1
s_mov_b64 exec,-1
s_cmp_lt_u32 s60,124
s_cbranch_scc1 top0_399
s_endpgm
fl_att2:
s_lshr_b32 s46,s59,4
s_and_b32 s59,s59,15
v_mbcnt_lo_u32_b32 v1,-1,0
v_mbcnt_hi_u32_b32 v1,-1,v1
v_lshlrev_b32 v0,4,v1
v_and_b32 v21,15,v1
v_lshrrev_b32 v22,4,v1
v_and_b32 v23,7,v21
v_lshlrev_b32 v23,4,v23
v_lshl_add_u32 v3,v22,8,v23
v_and_b32 v23,31,v1
v_lshlrev_b32 v4,4,v23
v_and_b32 v23,3,v1
v_bfe_u32 v24,v1,2,1
v_lshlrev_b32 v23,14,v23
v_lshl_add_u32 v2,v24,7,v23
v_mov_b32 v7,0xff800000
s_and_b32 s54,s50,1
s_lshl_b32 s64,s54,4
v_lshlrev_b32 v23,2,v22
v_sub_u32 v23,v21,v23
v_add_u32 v23,s64,v23
v_cmp_le_i32 s[28:29],0,v23
v_cmp_le_i32 s[30:31],1,v23
v_cmp_le_i32 s[32:33],2,v23
v_cmp_le_i32 s[34:35],3,v23
v_cmp_le_i32 s[36:37],16,v23
v_cmp_le_i32 s[38:39],17,v23
v_cmp_le_i32 s[40:41],18,v23
v_cmp_le_i32 s[42:43],19,v23
s_mov_b32 s44,-1
s_mov_b32 s45,0
s_mov_b32 s80,0x3e0293ee
s_lshl_b32 s52,s59,1
s_lshr_b32 s64,s50,1
s_add_u32 s52,s52,s64
s_lshl_b32 s53,s52,15
s_lshl_b32 s68,s52,8
s_add_u32 s68,s68,s67
s_add_u32 s68,s68,138428416
s_lshl_b32 s69,s59,8
s_lshl_b32 s64,s64,2
s_add_u32 s69,s69,s64
s_lshl_b32 s64,s54,3
s_add_u32 s69,s69,s64
s_add_u32 s69,s69,138543104
s_lshl_b32 s66,s52,12
s_lshl_b32 s64,s54,17
s_add_u32 s66,s66,s64
s_add_u32 s66,s66,150994944
s_lshl_b32 s55,s54,10
s_xor_b32 s55,s55,0x2000
s_mov_b32 s60,0
s_lshl_b32 s60,s46,1
s_add_u32 s60,s60,124
s_lshl_b32 s64,s60,17
s_add_u32 s66,s66,s64
s_lshl_b32 s47,s52,7
s_add_u32 s47,s47,s67
s_add_u32 s47,s47,138412032
v_and_b32 v23,1,v1
v_lshlrev_b32 v23,6,v23
s_mov_b32 s71,64
plp_415:
buffer_load_dword v5,v23,s[20:23],s47 offen sc1
s_waitcnt vmcnt(0)
v_cmp_gt_u32 vcc,s71,v5
s_cbranch_vccz pok_416
s_sleep 16
s_sub_u32 s90,s90,1
s_cmp_gt_i32 s90,0
s_cbranch_scc1 plp_415
pok_416:
s_add_u32 s64,s60,0
s_lshl_b32 s65,s64,11
s_and_b32 s65,s65,0x2000
s_xor_b32 s65,s65,s67
s_lshl_b32 s64,s64,19
s_add_u32 s64,s64,s65
s_add_u32 s92,s64,s53
s_add_u32 s93,s92,16384
s_add_u32 s94,s92,4096
s_add_u32 s95,s93,4096
s_xor_b32 s96,s92,s55
s_xor_b32 s97,s93,s55
buffer_load_dwordx4 a[0:3],v0,s[20:23],s96 offen offset:0
buffer_load_dwordx4 a[16:19],v0,s[20:23],s92 offen offset:0
buffer_load_dwordx4 a[32:35],v0,s[20:23],s92 offen offset:1024
buffer_load_dwordx4 a[4:7],v0,s[20:23],s96 offen offset:2048
buffer_load_dwordx4 a[20:23],v0,s[20:23],s92 offen offset:2048
buffer_load_dwordx4 a[36:39],v0,s[20:23],s92 offen offset:3072
buffer_load_dwordx4 a[8:11],v0,s[20:23],s97 offen offset:0
buffer_load_dwordx4 a[24:27],v0,s[20:23],s93 offen offset:0
buffer_load_dwordx4 a[40:43],v0,s[20:23],s93 offen offset:1024
buffer_load_dwordx4 a[12:15],v0,s[20:23],s97 offen offset:2048
buffer_load_dwordx4 a[28:31],v0,s[20:23],s93 offen offset:2048
buffer_load_dwordx4 a[44:47],v0,s[20:23],s93 offen offset:3072
buffer_load_dwordx4 a[48:51],v0,s[20:23],s94 offen offset:0
buffer_load_dwordx4 a[52:55],v0,s[20:23],s94 offen offset:1024
buffer_load_dwordx4 a[56:59],v0,s[20:23],s94 offen offset:2048
buffer_load_dwordx4 a[60:63],v0,s[20:23],s94 offen offset:3072
buffer_load_dwordx4 a[64:67],v0,s[20:23],s95 offen offset:0
buffer_load_dwordx4 a[68:71],v0,s[20:23],s95 offen offset:1024
buffer_load_dwordx4 a[72:75],v0,s[20:23],s95 offen offset:2048
buffer_load_dwordx4 a[76:79],v0,s[20:23],s95 offen offset:3072
s_waitcnt vmcnt(8)
top0_417:
v_mfma_f32_16x16x32_bf16 v[48:51],a[16:19],a[0:3],0
v_mfma_f32_16x16x32_bf16 v[52:55],a[32:35],a[0:3],0
v_mfma_f32_16x16x32_bf16 v[48:51],a[20:23],a[4:7],v[48:51]
v_mfma_f32_16x16x32_bf16 v[52:55],a[36:39],a[4:7],v[52:55]
v_mfma_f32_16x16x32_bf16 v[48:51],a[24:27],a[8:11],v[48:51]
v_mfma_f32_16x16x32_bf16 v[52:55],a[40:43],a[8:11],v[52:55]
v_mfma_f32_16x16x32_bf16 v[48:51],a[28:31],a[12:15],v[48:51]
v_mfma_f32_16x16x32_bf16 v[52:55],a[44:47],a[12:15],v[52:55]
s_nop 6
v_cndmask_b32 v48,v7,v48,s[28:29]
v_cndmask_b32 v49,v7,v49,s[30:31]
v_cndmask_b32 v50,v7,v50,s[32:33]
v_cndmask_b32 v51,v7,v51,s[34:35]
v_cndmask_b32 v52,v7,v52,s[36:37]
v_cndmask_b32 v53,v7,v53,s[38:39]
v_cndmask_b32 v54,v7,v54,s[40:41]
v_cndmask_b32 v55,v7,v55,s[42:43]
v_max3_f32 v72,v48,v49,v50
v_max3_f32 v72,v72,v51,v52
v_max3_f32 v72,v72,v53,v54
v_max_f32 v72,v72,v55
s_add_u32 s64,s60,0
s_lshl_b32 s65,s64,11
s_and_b32 s65,s65,0x2000
s_xor_b32 s65,s65,s67
s_lshl_b32 s64,s64,19
s_add_u32 s64,s64,s65
s_add_u32 s98,s64,s53
s_mov_b32 s71,118
plp_419:
buffer_load_dword v5,off,s[20:23],s69 sc1
s_waitcnt vmcnt(0)
v_cmp_gt_u32 vcc,s71,v5
s_cbranch_vccz pok_420
s_sleep 32
s_sub_u32 s90,s90,1
s_cmp_gt_i32 s90,0
s_cbranch_scc1 plp_419
pok_420:
s_lshl_b32 s64,s46,4
s_add_u32 s69,s69,s64
s_add_u32 s69,s69,16
s_add_u32 s98,s98,67108864
s_add_u32 s99,s98,16384
s_lshr_b32 s71,s60,1
s_add_u32 s71,s71,1
s_min_u32 s71,s71,63
plp_424:
buffer_load_dword v5,v2,s[20:23],s68 offen sc1
s_waitcnt vmcnt(0)
v_cmp_gt_u32 vcc,s71,v5
s_cbranch_vccz pok_425
s_sleep 4
s_sub_u32 s90,s90,1
s_cmp_gt_i32 s90,0
s_cbranch_scc1 plp_424
pok_425:
s_cmp_eq_u32 s60,126
s_cbranch_scc1 kd_422
ek_421:
buffer_load_dwordx4 v[16:19],v3,s[20:23],s98 offen offset:0
buffer_load_dwordx4 v[20:23],v3,s[20:23],s98 offen offset:128
buffer_load_dwordx4 v[24:27],v3,s[20:23],s99 offen offset:0
buffer_load_dwordx4 v[28:31],v3,s[20:23],s99 offen offset:128
buffer_load_dwordx4 v[32:35],v4,s[20:23],s98 offen offset:1024
buffer_load_dwordx4 v[36:39],v4,s[20:23],s98 offen offset:1536
buffer_load_dwordx4 v[40:43],v4,s[20:23],s99 offen offset:1024
buffer_load_dwordx4 v[44:47],v4,s[20:23],s99 offen offset:1536
s_branch kj_423
kd_422:
buffer_load_dwordx4 v[16:19],v3,s[20:23],s98 offen offset:0 sc1
buffer_load_dwordx4 v[20:23],v3,s[20:23],s98 offen offset:128 sc1
buffer_load_dwordx4 v[24:27],v3,s[20:23],s99 offen offset:0 sc1
buffer_load_dwordx4 v[28:31],v3,s[20:23],s99 offen offset:128 sc1
buffer_load_dwordx4 v[32:35],v4,s[20:23],s98 offen offset:1024 sc1
buffer_load_dwordx4 v[36:39],v4,s[20:23],s98 offen offset:1536 sc1
buffer_load_dwordx4 v[40:43],v4,s[20:23],s99 offen offset:1024 sc1
buffer_load_dwordx4 v[44:47],v4,s[20:23],s99 offen offset:1536 sc1
s_waitcnt vmcnt(4)
v_max3_u32 v5,v16,v17,v18
v_max3_u32 v6,v24,v25,v26
v_max3_u32 v5,v5,v19,v20
v_max3_u32 v6,v6,v21,v22
v_max3_u32 v5,v5,v27,v28
v_max3_u32 v6,v6,v29,v30
s_waitcnt vmcnt(0)
v_max3_u32 v5,v5,v32,v33
v_max3_u32 v6,v6,v34,v35
v_max3_u32 v5,v5,v36,v37
v_max3_u32 v6,v6,v38,v39
v_max3_u32 v5,v5,v40,v41
v_max3_u32 v6,v6,v42,v43
v_max3_u32 v5,v5,v44,v45
v_max3_u32 v6,v6,v46,v47
v_max3_u32 v5,v5,v23,v31
v_max_u32 v5,v5,v6
v_cmp_eq_u32 vcc,-1,v5
s_cbranch_vccz kj_423
s_sleep 1
s_sub_u32 s90,s90,1
s_cmp_gt_i32 s90,0
s_cbranch_scc1 kd_422
kj_423:
s_waitcnt vmcnt(4)
v_mfma_f32_16x16x32_bf16 v[56:59],v[16:19],a[0:3],0
v_mfma_f32_16x16x32_bf16 v[56:59],v[20:23],a[4:7],v[56:59]
v_mfma_f32_16x16x32_bf16 v[56:59],v[24:27],a[8:11],v[56:59]
v_mfma_f32_16x16x32_bf16 v[56:59],v[28:31],a[12:15],v[56:59]
s_nop 7
v_cndmask_b32 v56,v7,v56,s[44:45]
v_cndmask_b32 v57,v7,v57,s[44:45]
v_cndmask_b32 v58,v7,v58,s[44:45]
v_cndmask_b32 v59,v7,v59,s[44:45]
v_max3_f32 v72,v72,v56,v57
v_max3_f32 v72,v72,v58,v59
v_mov_b32 v73,v72
s_nop 1
v_permlane16_swap_b32 v73,v72
v_max_f32 v72,v72,v73
v_mov_b32 v73,v72
s_nop 1
v_permlane32_swap_b32 v73,v72
v_max_f32 v72,v72,v73
v_mul_f32 v72,s80,v72
v_fma_f32 v48,v48,s80,-v72
v_fma_f32 v49,v49,s80,-v72
v_fma_f32 v50,v50,s80,-v72
v_fma_f32 v51,v51,s80,-v72
v_fma_f32 v52,v52,s80,-v72
v_fma_f32 v53,v53,s80,-v72
v_fma_f32 v54,v54,s80,-v72
v_fma_f32 v55,v55,s80,-v72
v_fma_f32 v56,v56,s80,-v72
v_fma_f32 v57,v57,s80,-v72
v_fma_f32 v58,v58,s80,-v72
v_fma_f32 v59,v59,s80,-v72
v_exp_f32 v48,v48
v_exp_f32 v49,v49
v_exp_f32 v50,v50
v_exp_f32 v51,v51
v_exp_f32 v52,v52
v_exp_f32 v53,v53
v_exp_f32 v54,v54
v_exp_f32 v55,v55
v_exp_f32 v56,v56
v_exp_f32 v57,v57
v_exp_f32 v58,v58
v_exp_f32 v59,v59
v_add_f32 v74,v48,v49
v_add_f32 v75,v50,v51
v_add_f32 v74,v74,v52
v_add_f32 v75,v75,v53
v_add_f32 v74,v74,v54
v_add_f32 v75,v75,v55
v_add_f32 v74,v74,v56
v_add_f32 v75,v75,v57
v_add_f32 v74,v74,v58
v_add_f32 v75,v75,v59
v_add_f32 v74,v74,v75
v_mov_b32 v73,v74
s_nop 1
v_permlane16_swap_b32 v73,v74
v_add_f32 v74,v74,v73
v_mov_b32 v73,v74
s_nop 1
v_permlane32_swap_b32 v73,v74
v_add_f32 v74,v74,v73
v_rcp_f32 v75,v74
s_nop 0
v_mul_f32 v48,v48,v75
v_mul_f32 v49,v49,v75
v_mul_f32 v50,v50,v75
v_mul_f32 v51,v51,v75
v_mul_f32 v52,v52,v75
v_mul_f32 v53,v53,v75
v_mul_f32 v54,v54,v75
v_mul_f32 v55,v55,v75
v_mul_f32 v56,v56,v75
v_mul_f32 v57,v57,v75
v_mul_f32 v58,v58,v75
v_mul_f32 v59,v59,v75
v_cvt_pk_bf16_f32 v64,v48,v49
v_cvt_pk_bf16_f32 v65,v50,v51
v_cvt_pk_bf16_f32 v66,v52,v53
v_cvt_pk_bf16_f32 v67,v54,v55
v_cvt_pk_bf16_f32 v68,v56,v57
v_cvt_pk_bf16_f32 v69,v58,v59
v_mfma_f32_16x16x32_bf16 v[80:83],a[48:51],v[64:67],0
v_mfma_f32_16x16x32_bf16 v[84:87],a[52:55],v[64:67],0
v_mfma_f32_16x16x32_bf16 v[88:91],a[56:59],v[64:67],0
v_mfma_f32_16x16x32_bf16 v[92:95],a[60:63],v[64:67],0
v_mfma_f32_16x16x32_bf16 v[96:99],a[64:67],v[64:67],0
v_mfma_f32_16x16x32_bf16 v[100:103],a[68:71],v[64:67],0
v_mfma_f32_16x16x32_bf16 v[104:107],a[72:75],v[64:67],0
v_mfma_f32_16x16x32_bf16 v[108:111],a[76:79],v[64:67],0
s_waitcnt vmcnt(0)
v_mfma_f32_16x16x16_bf16 v[80:83],v[32:33],v[68:69],v[80:83]
v_mfma_f32_16x16x16_bf16 v[84:87],v[34:35],v[68:69],v[84:87]
v_mfma_f32_16x16x16_bf16 v[88:91],v[36:37],v[68:69],v[88:91]
v_mfma_f32_16x16x16_bf16 v[92:95],v[38:39],v[68:69],v[92:95]
v_mfma_f32_16x16x16_bf16 v[96:99],v[40:41],v[68:69],v[96:99]
v_mfma_f32_16x16x16_bf16 v[100:103],v[42:43],v[68:69],v[100:103]
v_mfma_f32_16x16x16_bf16 v[104:107],v[44:45],v[68:69],v[104:107]
v_mfma_f32_16x16x16_bf16 v[108:111],v[46:47],v[68:69],v[108:111]
s_nop 0
v_cvt_pk_bf16_f32 v112,v80,v81
v_cvt_pk_bf16_f32 v113,v82,v83
v_cvt_pk_bf16_f32 v114,v84,v85
v_cvt_pk_bf16_f32 v115,v86,v87
buffer_store_dwordx4 v[112:115],v0,s[20:23],s66 offen offset:0 sc1
v_cvt_pk_bf16_f32 v116,v88,v89
v_cvt_pk_bf16_f32 v117,v90,v91
v_cvt_pk_bf16_f32 v118,v92,v93
v_cvt_pk_bf16_f32 v119,v94,v95
buffer_store_dwordx4 v[116:119],v0,s[20:23],s66 offen offset:1024 sc1
v_cvt_pk_bf16_f32 v112,v96,v97
v_cvt_pk_bf16_f32 v113,v98,v99
v_cvt_pk_bf16_f32 v114,v100,v101
v_cvt_pk_bf16_f32 v115,v102,v103
buffer_store_dwordx4 v[112:115],v0,s[20:23],s66 offen offset:2048 sc1
v_cvt_pk_bf16_f32 v116,v104,v105
v_cvt_pk_bf16_f32 v117,v106,v107
v_cvt_pk_bf16_f32 v118,v108,v109
v_cvt_pk_bf16_f32 v119,v110,v111
buffer_store_dwordx4 v[116:119],v0,s[20:23],s66 offen offset:3072 sc1
s_waitcnt vmcnt(0)
v_mov_b32 v6,128
s_mov_b64 exec,1
buffer_store_dword v6,off,s[20:23],s69 sc1
s_mov_b64 exec,-1
s_endpgm
fl_rec:
s_load_dwordx8 s[4:11],s[0:1],8
s_load_dwordx2 s[12:13],s[0:1],40
s_mov_b32 s57,s58
v_mov_b32 v0,v1
s_waitcnt lgkmcnt(0)
s_mov_b32 s28,s6
s_and_b32 s29,s7,0xffff
s_mov_b32 s30,0x800000
s_mov_b32 s31,0x20000
s_mov_b32 s32,s8
s_and_b32 s33,s9,0xffff
s_mov_b32 s34,0x800000
s_mov_b32 s35,0x20000
s_mov_b32 s36,s10
s_and_b32 s37,s11,0xffff
s_mov_b32 s38,0x800000
s_mov_b32 s39,0x20000
s_mov_b32 s40,s12
s_and_b32 s41,s13,0xffff
s_mov_b32 s42,0x800000
s_mov_b32 s43,0x20000
s_mov_b32 s44,s4
s_and_b32 s45,s5,0xffff
s_mov_b32 s46,0x4000
s_mov_b32 s47,0x20000
s_lshr_b32 s58,s57,5
s_and_b32 s59,s57,31
v_and_b32 v20,63,v0
v_and_b32 v21,15,v20
v_lshrrev_b32 v22,4,v20
v_lshrrev_b32 v23,3,v20
v_and_b32 v24,7,v20
v_lshlrev_b32 v16,13,v23
v_lshl_add_u32 v16,v24,4,v16
v_lshrrev_b32 v23,2,v20
v_and_b32 v24,3,v20
v_lshlrev_b32 v17,11,v23
v_lshl_add_u32 v17,v24,4,v17
s_lshl_b32 s61,s50,15
s_add_u32 s61,s61,32768
s_lshl_b32 s62,s50,21
s_lshl_b32 s64,s57,7
s_add_u32 s62,s62,s64
s_lshl_b32 s63,s58,22
s_lshl_b32 s64,s50,20
s_add_u32 s63,s63,s64
s_lshl_b32 s64,s59,6
s_add_u32 s63,s63,s64
v_lshrrev_b32 v23,1,v22
v_lshlrev_b32 v25,4,v23
v_and_b32 v23,1,v22
v_lshl_add_u32 v25,v23,2,v25
v_lshrrev_b32 v23,3,v21
v_lshl_add_u32 v25,v23,3,v25
v_bfe_u32 v23,v21,2,1
v_add_u32 v25,v25,v23
v_lshlrev_b32 v28,4,v23
v_lshrrev_b32 v23,1,v22
v_lshl_add_u32 v28,v23,3,v28
v_lshrrev_b32 v23,3,v21
v_lshl_add_u32 v28,v23,2,v28
v_and_b32 v23,1,v22
v_lshl_add_u32 v28,v23,1,v28
v_and_b32 v24,3,v21
v_lshlrev_b32 v26,7,v28
v_add_u32 v26,s61,v26
v_lshl_add_u32 v18,v24,3,v26
v_lshl_add_u32 v19,v24,4,v26
v_lshlrev_b32 v26,6,v25
v_add_u32 v26,s61,v26
v_lshl_add_u32 v27,v24,3,v26
v_lshlrev_b32 v0,4,v20
v_add_u32 v7,s61,v0
s_and_b32 s64,s59,1
s_lshl_b32 s65,s64,18
s_add_u32 s70,s63,s65
s_sub_u32 s71,s63,s65
s_lshl_b32 s65,s64,13
s_add_u32 s72,s61,s65
s_sub_u32 s73,s61,s65
s_and_b32 s64,s57,7
s_lshl_b32 s65,s64,2
s_mov_b32 s66,0
s_lshl_b32 s65,s65,13
s_andn2_b32 s55,s57,7
s_lshl_b32 s55,s55,7
s_add_u32 s65,s65,s55
s_add_u32 s65,s65,384
v_and_b32 v29,3,v20
v_lshlrev_b32 v29,13,v29
v_add_u32 v29,s65,v29
v_and_b32 v15,4,v20
v_lshl_add_u32 v29,v15,4,v29
s_and_b32 s55,s57,31
s_add_u32 s66,s66,s55
s_lshl_b32 s66,s66,13
s_add_u32 s66,s66,8064
v_writelane_b32 v29,s66,8
s_add_u32 s66,s66,64
v_writelane_b32 v29,s66,9
s_cmp_eq_u32 s64,3
s_cselect_b32 s65,0,15
s_sub_u32 s66,s57,32
s_cmp_lt_u32 s66,31
s_cselect_b32 s66,256,0
s_or_b32 vcc_lo,s65,s66
s_mov_b32 vcc_hi,0
v_cndmask_b32 v29,-1,v29,vcc
s_lshl_b32 s68,s50,21
s_lshl_b32 s64,s58,22
s_lshl_b32 s65,s50,20
s_add_u32 s64,s64,s65
s_and_b32 s66,s59,15
s_lshl_b32 s65,s66,13
s_add_u32 s64,s64,s65
s_lshr_b32 s65,s59,4
s_lshl_b32 s65,s65,10
s_add_u32 s69,s64,s65
s_add_u32 s69,s69,384
s_lshr_b32 s66,s66,1
s_cmp_eq_u32 s66,3
s_cselect_b32 s65,0,4
v_and_b32 v30,3,v20
v_lshlrev_b32 v30,11,v30
v_and_b32 v31,4,v20
v_lshl_add_u32 v30,v31,4,v30
v_cmp_gt_u32 vcc,s65,v20
s_nop 1
v_cndmask_b32 v30,-1,v30,vcc
s_add_u32 s64,s68,262144
buffer_load_dword v31,v29,s[28:31],s64 offen
s_add_u32 s64,s68,524288
buffer_load_dword v31,v29,s[28:31],s64 offen
s_add_u32 s64,s68,786432
buffer_load_dword v31,v29,s[28:31],s64 offen
s_add_u32 s64,s62,0
s_add_u32 m0,s61,0
s_nop 0
buffer_load_dwordx4 v16,s[28:31],s64 offen  lds
s_waitcnt vmcnt(10)
s_add_u32 s64,s62,65536
s_add_u32 m0,s61,1024
s_nop 0
buffer_load_dwordx4 v16,s[28:31],s64 offen  lds
s_add_u32 s64,s68,1048576
buffer_load_dword v31,v29,s[28:31],s64 offen
s_waitcnt vmcnt(10)
s_add_u32 s64,s62,131072
s_add_u32 m0,s61,2048
s_nop 0
buffer_load_dwordx4 v16,s[28:31],s64 offen  lds
s_waitcnt vmcnt(10)
s_add_u32 s64,s62,196608
s_add_u32 m0,s61,3072
s_nop 0
buffer_load_dwordx4 v16,s[28:31],s64 offen  lds
s_waitcnt vmcnt(10)
s_add_u32 s64,s62,262144
s_add_u32 m0,s61,4096
s_nop 0
buffer_load_dwordx4 v16,s[28:31],s64 offen  lds
s_waitcnt vmcnt(10)
s_add_u32 s64,s62,327680
s_add_u32 m0,s61,5120
s_nop 0
buffer_load_dwordx4 v16,s[28:31],s64 offen  lds
s_add_u32 s64,s68,1310720
buffer_load_dword v31,v29,s[28:31],s64 offen
s_waitcnt vmcnt(10)
s_add_u32 s64,s62,393216
s_add_u32 m0,s61,6144
s_nop 0
buffer_load_dwordx4 v16,s[28:31],s64 offen  lds
s_waitcnt vmcnt(10)
s_add_u32 s64,s62,458752
s_add_u32 m0,s61,7168
s_nop 0
buffer_load_dwordx4 v16,s[28:31],s64 offen  lds
s_waitcnt vmcnt(10)
s_add_u32 s64,s62,524288
s_add_u32 m0,s61,8192
s_nop 0
buffer_load_dwordx4 v16,s[28:31],s64 offen  lds
s_waitcnt vmcnt(10)
s_add_u32 s64,s62,589824
s_add_u32 m0,s61,9216
s_nop 0
buffer_load_dwordx4 v16,s[28:31],s64 offen  lds
s_add_u32 s64,s68,1572864
buffer_load_dword v31,v29,s[28:31],s64 offen
s_waitcnt vmcnt(10)
s_add_u32 s64,s62,655360
s_add_u32 m0,s61,10240
s_nop 0
buffer_load_dwordx4 v16,s[28:31],s64 offen  lds
s_waitcnt vmcnt(10)
s_add_u32 s64,s62,720896
s_add_u32 m0,s61,11264
s_nop 0
buffer_load_dwordx4 v16,s[28:31],s64 offen  lds
s_waitcnt vmcnt(10)
s_add_u32 s64,s62,786432
s_add_u32 m0,s61,12288
s_nop 0
buffer_load_dwordx4 v16,s[28:31],s64 offen  lds
s_waitcnt vmcnt(10)
s_add_u32 s64,s62,851968
s_add_u32 m0,s61,13312
s_nop 0
buffer_load_dwordx4 v16,s[28:31],s64 offen  lds
s_add_u32 s64,s68,1835008
buffer_load_dword v31,v29,s[28:31],s64 offen
s_waitcnt vmcnt(10)
s_add_u32 s64,s62,917504
s_add_u32 m0,s61,14336
s_nop 0
buffer_load_dwordx4 v16,s[28:31],s64 offen  lds
s_waitcnt vmcnt(10)
s_add_u32 s64,s62,983040
s_add_u32 m0,s61,15360
s_nop 0
buffer_load_dwordx4 v16,s[28:31],s64 offen  lds
s_add_u32 s64,s62,1048576
s_add_u32 m0,s61,16384
s_nop 0
buffer_load_dwordx4 v16,s[28:31],s64 offen  lds
s_waitcnt vmcnt(10)
s_add_u32 s64,s62,1114112
s_add_u32 m0,s61,17408
s_nop 0
buffer_load_dwordx4 v16,s[28:31],s64 offen  lds
s_add_u32 s64,s68,0
buffer_load_dword v31,v29,s[32:35],s64 offen
s_waitcnt vmcnt(10)
s_add_u32 s64,s62,1179648
s_add_u32 m0,s61,18432
s_nop 0
buffer_load_dwordx4 v16,s[28:31],s64 offen  lds
s_waitcnt vmcnt(10)
s_add_u32 s64,s62,1245184
s_add_u32 m0,s61,19456
s_nop 0
buffer_load_dwordx4 v16,s[28:31],s64 offen  lds
s_waitcnt vmcnt(10)
s_add_u32 s64,s62,1310720
s_add_u32 m0,s61,20480
s_nop 0
buffer_load_dwordx4 v16,s[28:31],s64 offen  lds
s_waitcnt vmcnt(10)
s_add_u32 s64,s62,1376256
s_add_u32 m0,s61,21504
s_nop 0
buffer_load_dwordx4 v16,s[28:31],s64 offen  lds
s_add_u32 s64,s68,262144
buffer_load_dword v31,v29,s[32:35],s64 offen
s_waitcnt vmcnt(10)
s_add_u32 s64,s62,1441792
s_add_u32 m0,s61,22528
s_nop 0
buffer_load_dwordx4 v16,s[28:31],s64 offen  lds
s_waitcnt vmcnt(10)
s_add_u32 s64,s62,1507328
s_add_u32 m0,s61,23552
s_nop 0
buffer_load_dwordx4 v16,s[28:31],s64 offen  lds
s_waitcnt vmcnt(10)
s_add_u32 s64,s62,1572864
s_add_u32 m0,s61,24576
s_nop 0
buffer_load_dwordx4 v16,s[28:31],s64 offen  lds
s_waitcnt vmcnt(10)
s_add_u32 s64,s62,1638400
s_add_u32 m0,s61,25600
s_nop 0
buffer_load_dwordx4 v16,s[28:31],s64 offen  lds
s_add_u32 s64,s68,524288
buffer_load_dword v31,v29,s[32:35],s64 offen
s_waitcnt vmcnt(10)
s_add_u32 s64,s62,1703936
s_add_u32 m0,s61,26624
s_nop 0
buffer_load_dwordx4 v16,s[28:31],s64 offen  lds
s_waitcnt vmcnt(10)
s_add_u32 s64,s62,1769472
s_add_u32 m0,s61,27648
s_nop 0
buffer_load_dwordx4 v16,s[28:31],s64 offen  lds
s_waitcnt vmcnt(10)
s_add_u32 s64,s62,1835008
s_add_u32 m0,s61,28672
s_nop 0
buffer_load_dwordx4 v16,s[28:31],s64 offen  lds
s_waitcnt vmcnt(10)
s_add_u32 s64,s62,1900544
s_add_u32 m0,s61,29696
s_nop 0
buffer_load_dwordx4 v16,s[28:31],s64 offen  lds
s_add_u32 s64,s68,786432
buffer_load_dword v31,v29,s[32:35],s64 offen
s_waitcnt vmcnt(10)
s_add_u32 s64,s62,1966080
s_add_u32 m0,s61,30720
s_nop 0
buffer_load_dwordx4 v16,s[28:31],s64 offen  lds
s_waitcnt vmcnt(10)
s_add_u32 s64,s62,2031616
s_add_u32 m0,s61,31744
s_nop 0
buffer_load_dwordx4 v16,s[28:31],s64 offen  lds
s_waitcnt vmcnt(20)
ds_read_b64_tr_b16 a[0:1],v18 offset:0
ds_read_b64_tr_b16 a[2:3],v18 offset:128
ds_read_b64_tr_b16 a[4:5],v18 offset:4096
ds_read_b64_tr_b16 a[6:7],v18 offset:4224
ds_read_b64_tr_b16 a[8:9],v18 offset:32
ds_read_b64_tr_b16 a[10:11],v18 offset:160
ds_read_b64_tr_b16 a[12:13],v18 offset:4128
ds_read_b64_tr_b16 a[14:15],v18 offset:4256
ds_read_b64_tr_b16 a[16:17],v18 offset:64
ds_read_b64_tr_b16 a[18:19],v18 offset:192
ds_read_b64_tr_b16 a[20:21],v18 offset:4160
ds_read_b64_tr_b16 a[22:23],v18 offset:4288
ds_read_b64_tr_b16 a[24:25],v18 offset:96
ds_read_b64_tr_b16 a[26:27],v18 offset:224
ds_read_b64_tr_b16 a[28:29],v18 offset:4192
ds_read_b64_tr_b16 a[30:31],v18 offset:4320
s_waitcnt lgkmcnt(0)
ds_read_b64_tr_b16 a[64:65],v18 offset:8192
ds_read_b64_tr_b16 a[66:67],v18 offset:8320
ds_read_b64_tr_b16 a[68:69],v18 offset:12288
ds_read_b64_tr_b16 a[70:71],v18 offset:12416
ds_read_b64_tr_b16 a[72:73],v18 offset:8224
ds_read_b64_tr_b16 a[74:75],v18 offset:8352
ds_read_b64_tr_b16 a[76:77],v18 offset:12320
ds_read_b64_tr_b16 a[78:79],v18 offset:12448
ds_read_b64_tr_b16 a[80:81],v18 offset:8256
ds_read_b64_tr_b16 a[82:83],v18 offset:8384
ds_read_b64_tr_b16 a[84:85],v18 offset:12352
ds_read_b64_tr_b16 a[86:87],v18 offset:12480
ds_read_b64_tr_b16 a[88:89],v18 offset:8288
ds_read_b64_tr_b16 a[90:91],v18 offset:8416
ds_read_b64_tr_b16 a[92:93],v18 offset:12384
ds_read_b64_tr_b16 a[94:95],v18 offset:12512
s_waitcnt lgkmcnt(0)
s_add_u32 s64,s62,0
s_add_u32 m0,s61,0
s_nop 0
buffer_load_dwordx4 v16,s[32:35],s64 offen  lds
s_waitcnt vmcnt(10)
s_add_u32 s64,s62,65536
s_add_u32 m0,s61,1024
s_nop 0
buffer_load_dwordx4 v16,s[32:35],s64 offen  lds
s_add_u32 s64,s68,1048576
buffer_load_dword v31,v29,s[32:35],s64 offen
s_waitcnt vmcnt(10)
s_add_u32 s64,s62,131072
s_add_u32 m0,s61,2048
s_nop 0
buffer_load_dwordx4 v16,s[32:35],s64 offen  lds
s_waitcnt vmcnt(10)
s_add_u32 s64,s62,196608
s_add_u32 m0,s61,3072
s_nop 0
buffer_load_dwordx4 v16,s[32:35],s64 offen  lds
s_waitcnt vmcnt(10)
s_add_u32 s64,s62,262144
s_add_u32 m0,s61,4096
s_nop 0
buffer_load_dwordx4 v16,s[32:35],s64 offen  lds
s_waitcnt vmcnt(10)
s_add_u32 s64,s62,327680
s_add_u32 m0,s61,5120
s_nop 0
buffer_load_dwordx4 v16,s[32:35],s64 offen  lds
s_add_u32 s64,s68,1310720
buffer_load_dword v31,v29,s[32:35],s64 offen
s_waitcnt vmcnt(10)
s_add_u32 s64,s62,393216
s_add_u32 m0,s61,6144
s_nop 0
buffer_load_dwordx4 v16,s[32:35],s64 offen  lds
s_waitcnt vmcnt(10)
s_add_u32 s64,s62,458752
s_add_u32 m0,s61,7168
s_nop 0
buffer_load_dwordx4 v16,s[32:35],s64 offen  lds
s_waitcnt vmcnt(10)
s_add_u32 s64,s62,524288
s_add_u32 m0,s61,8192
s_nop 0
buffer_load_dwordx4 v16,s[32:35],s64 offen  lds
s_waitcnt vmcnt(10)
s_add_u32 s64,s62,589824
s_add_u32 m0,s61,9216
s_nop 0
buffer_load_dwordx4 v16,s[32:35],s64 offen  lds
s_add_u32 s64,s68,1572864
buffer_load_dword v31,v29,s[32:35],s64 offen
s_waitcnt vmcnt(10)
s_add_u32 s64,s62,655360
s_add_u32 m0,s61,10240
s_nop 0
buffer_load_dwordx4 v16,s[32:35],s64 offen  lds
s_waitcnt vmcnt(10)
s_add_u32 s64,s62,720896
s_add_u32 m0,s61,11264
s_nop 0
buffer_load_dwordx4 v16,s[32:35],s64 offen  lds
s_waitcnt vmcnt(10)
s_add_u32 s64,s62,786432
s_add_u32 m0,s61,12288
s_nop 0
buffer_load_dwordx4 v16,s[32:35],s64 offen  lds
s_waitcnt vmcnt(10)
s_add_u32 s64,s62,851968
s_add_u32 m0,s61,13312
s_nop 0
buffer_load_dwordx4 v16,s[32:35],s64 offen  lds
s_add_u32 s64,s68,1835008
buffer_load_dword v31,v29,s[32:35],s64 offen
s_waitcnt vmcnt(10)
s_add_u32 s64,s62,917504
s_add_u32 m0,s61,14336
s_nop 0
buffer_load_dwordx4 v16,s[32:35],s64 offen  lds
s_waitcnt vmcnt(10)
s_add_u32 s64,s62,983040
s_add_u32 m0,s61,15360
s_nop 0
buffer_load_dwordx4 v16,s[32:35],s64 offen  lds
s_waitcnt vmcnt(20)
ds_read_b64_tr_b16 a[128:129],v18 offset:16384
ds_read_b64_tr_b16 a[130:131],v18 offset:16512
ds_read_b64_tr_b16 a[132:133],v18 offset:20480
ds_read_b64_tr_b16 a[134:135],v18 offset:20608
ds_read_b64_tr_b16 a[136:137],v18 offset:16416
ds_read_b64_tr_b16 a[138:139],v18 offset:16544
ds_read_b64_tr_b16 a[140:141],v18 offset:20512
ds_read_b64_tr_b16 a[142:143],v18 offset:20640
ds_read_b64_tr_b16 a[144:145],v18 offset:16448
ds_read_b64_tr_b16 a[146:147],v18 offset:16576
ds_read_b64_tr_b16 a[148:149],v18 offset:20544
ds_read_b64_tr_b16 a[150:151],v18 offset:20672
ds_read_b64_tr_b16 a[152:153],v18 offset:16480
ds_read_b64_tr_b16 a[154:155],v18 offset:16608
ds_read_b64_tr_b16 a[156:157],v18 offset:20576
ds_read_b64_tr_b16 a[158:159],v18 offset:20704
s_waitcnt lgkmcnt(0)
ds_read_b64_tr_b16 a[192:193],v18 offset:24576
ds_read_b64_tr_b16 a[194:195],v18 offset:24704
ds_read_b64_tr_b16 a[196:197],v18 offset:28672
ds_read_b64_tr_b16 a[198:199],v18 offset:28800
ds_read_b64_tr_b16 a[200:201],v18 offset:24608
ds_read_b64_tr_b16 a[202:203],v18 offset:24736
ds_read_b64_tr_b16 a[204:205],v18 offset:28704
ds_read_b64_tr_b16 a[206:207],v18 offset:28832
ds_read_b64_tr_b16 a[208:209],v18 offset:24640
ds_read_b64_tr_b16 a[210:211],v18 offset:24768
ds_read_b64_tr_b16 a[212:213],v18 offset:28736
ds_read_b64_tr_b16 a[214:215],v18 offset:28864
ds_read_b64_tr_b16 a[216:217],v18 offset:24672
ds_read_b64_tr_b16 a[218:219],v18 offset:24800
ds_read_b64_tr_b16 a[220:221],v18 offset:28768
ds_read_b64_tr_b16 a[222:223],v18 offset:28896
s_waitcnt lgkmcnt(0)
s_add_u32 s64,s62,1048576
s_add_u32 m0,s61,16384
s_nop 0
buffer_load_dwordx4 v16,s[32:35],s64 offen  lds
s_waitcnt vmcnt(10)
s_add_u32 s64,s62,1114112
s_add_u32 m0,s61,17408
s_nop 0
buffer_load_dwordx4 v16,s[32:35],s64 offen  lds
s_add_u32 s64,s68,0
buffer_load_dword v31,v29,s[36:39],s64 offen
s_waitcnt vmcnt(10)
s_add_u32 s64,s62,1179648
s_add_u32 m0,s61,18432
s_nop 0
buffer_load_dwordx4 v16,s[32:35],s64 offen  lds
s_waitcnt vmcnt(10)
s_add_u32 s64,s62,1245184
s_add_u32 m0,s61,19456
s_nop 0
buffer_load_dwordx4 v16,s[32:35],s64 offen  lds
s_waitcnt vmcnt(10)
s_add_u32 s64,s62,1310720
s_add_u32 m0,s61,20480
s_nop 0
buffer_load_dwordx4 v16,s[32:35],s64 offen  lds
s_waitcnt vmcnt(10)
s_add_u32 s64,s62,1376256
s_add_u32 m0,s61,21504
s_nop 0
buffer_load_dwordx4 v16,s[32:35],s64 offen  lds
s_add_u32 s64,s68,262144
buffer_load_dword v31,v29,s[36:39],s64 offen
s_waitcnt vmcnt(10)
s_add_u32 s64,s62,1441792
s_add_u32 m0,s61,22528
s_nop 0
buffer_load_dwordx4 v16,s[32:35],s64 offen  lds
s_waitcnt vmcnt(10)
s_add_u32 s64,s62,1507328
s_add_u32 m0,s61,23552
s_nop 0
buffer_load_dwordx4 v16,s[32:35],s64 offen  lds
s_waitcnt vmcnt(10)
s_add_u32 s64,s62,1572864
s_add_u32 m0,s61,24576
s_nop 0
buffer_load_dwordx4 v16,s[32:35],s64 offen  lds
s_waitcnt vmcnt(10)
s_add_u32 s64,s62,1638400
s_add_u32 m0,s61,25600
s_nop 0
buffer_load_dwordx4 v16,s[32:35],s64 offen  lds
s_add_u32 s64,s68,524288
buffer_load_dword v31,v29,s[36:39],s64 offen
s_waitcnt vmcnt(10)
s_add_u32 s64,s62,1703936
s_add_u32 m0,s61,26624
s_nop 0
buffer_load_dwordx4 v16,s[32:35],s64 offen  lds
s_waitcnt vmcnt(10)
s_add_u32 s64,s62,1769472
s_add_u32 m0,s61,27648
s_nop 0
buffer_load_dwordx4 v16,s[32:35],s64 offen  lds
s_waitcnt vmcnt(10)
s_add_u32 s64,s62,1835008
s_add_u32 m0,s61,28672
s_nop 0
buffer_load_dwordx4 v16,s[32:35],s64 offen  lds
s_waitcnt vmcnt(10)
s_add_u32 s64,s62,1900544
s_add_u32 m0,s61,29696
s_nop 0
buffer_load_dwordx4 v16,s[32:35],s64 offen  lds
s_add_u32 s64,s68,786432
buffer_load_dword v31,v29,s[36:39],s64 offen
s_waitcnt vmcnt(10)
s_add_u32 s64,s62,1966080
s_add_u32 m0,s61,30720
s_nop 0
buffer_load_dwordx4 v16,s[32:35],s64 offen  lds
s_waitcnt vmcnt(10)
s_add_u32 s64,s62,2031616
s_add_u32 m0,s61,31744
s_nop 0
buffer_load_dwordx4 v16,s[32:35],s64 offen  lds
s_waitcnt vmcnt(20)
ds_read_b64_tr_b16 a[32:33],v18 offset:0
ds_read_b64_tr_b16 a[34:35],v18 offset:128
ds_read_b64_tr_b16 a[36:37],v18 offset:4096
ds_read_b64_tr_b16 a[38:39],v18 offset:4224
ds_read_b64_tr_b16 a[40:41],v18 offset:32
ds_read_b64_tr_b16 a[42:43],v18 offset:160
ds_read_b64_tr_b16 a[44:45],v18 offset:4128
ds_read_b64_tr_b16 a[46:47],v18 offset:4256
ds_read_b64_tr_b16 a[48:49],v18 offset:64
ds_read_b64_tr_b16 a[50:51],v18 offset:192
ds_read_b64_tr_b16 a[52:53],v18 offset:4160
ds_read_b64_tr_b16 a[54:55],v18 offset:4288
ds_read_b64_tr_b16 a[56:57],v18 offset:96
ds_read_b64_tr_b16 a[58:59],v18 offset:224
ds_read_b64_tr_b16 a[60:61],v18 offset:4192
ds_read_b64_tr_b16 a[62:63],v18 offset:4320
s_waitcnt lgkmcnt(0)
ds_read_b64_tr_b16 a[96:97],v18 offset:8192
ds_read_b64_tr_b16 a[98:99],v18 offset:8320
ds_read_b64_tr_b16 a[100:101],v18 offset:12288
ds_read_b64_tr_b16 a[102:103],v18 offset:12416
ds_read_b64_tr_b16 a[104:105],v18 offset:8224
ds_read_b64_tr_b16 a[106:107],v18 offset:8352
ds_read_b64_tr_b16 a[108:109],v18 offset:12320
ds_read_b64_tr_b16 a[110:111],v18 offset:12448
ds_read_b64_tr_b16 a[112:113],v18 offset:8256
ds_read_b64_tr_b16 a[114:115],v18 offset:8384
ds_read_b64_tr_b16 a[116:117],v18 offset:12352
ds_read_b64_tr_b16 a[118:119],v18 offset:12480
ds_read_b64_tr_b16 a[120:121],v18 offset:8288
ds_read_b64_tr_b16 a[122:123],v18 offset:8416
ds_read_b64_tr_b16 a[124:125],v18 offset:12384
ds_read_b64_tr_b16 a[126:127],v18 offset:12512
s_waitcnt lgkmcnt(0)
s_add_u32 s64,s62,0
s_add_u32 m0,s61,0
s_nop 0
buffer_load_dwordx4 v16,s[36:39],s64 offen nt lds
s_waitcnt vmcnt(10)
s_add_u32 s64,s62,65536
s_add_u32 m0,s61,1024
s_nop 0
buffer_load_dwordx4 v16,s[36:39],s64 offen nt lds
s_add_u32 s64,s68,1048576
buffer_load_dword v31,v29,s[36:39],s64 offen
s_waitcnt vmcnt(10)
s_add_u32 s64,s62,131072
s_add_u32 m0,s61,2048
s_nop 0
buffer_load_dwordx4 v16,s[36:39],s64 offen nt lds
s_waitcnt vmcnt(10)
s_add_u32 s64,s62,196608
s_add_u32 m0,s61,3072
s_nop 0
buffer_load_dwordx4 v16,s[36:39],s64 offen nt lds
s_waitcnt vmcnt(10)
s_add_u32 s64,s62,262144
s_add_u32 m0,s61,4096
s_nop 0
buffer_load_dwordx4 v16,s[36:39],s64 offen nt lds
s_waitcnt vmcnt(10)
s_add_u32 s64,s62,327680
s_add_u32 m0,s61,5120
s_nop 0
buffer_load_dwordx4 v16,s[36:39],s64 offen nt lds
s_add_u32 s64,s68,1310720
buffer_load_dword v31,v29,s[36:39],s64 offen
s_waitcnt vmcnt(10)
s_add_u32 s64,s62,393216
s_add_u32 m0,s61,6144
s_nop 0
buffer_load_dwordx4 v16,s[36:39],s64 offen nt lds
s_waitcnt vmcnt(10)
s_add_u32 s64,s62,458752
s_add_u32 m0,s61,7168
s_nop 0
buffer_load_dwordx4 v16,s[36:39],s64 offen nt lds
s_waitcnt vmcnt(10)
s_add_u32 s64,s62,524288
s_add_u32 m0,s61,8192
s_nop 0
buffer_load_dwordx4 v16,s[36:39],s64 offen nt lds
s_waitcnt vmcnt(10)
s_add_u32 s64,s62,589824
s_add_u32 m0,s61,9216
s_nop 0
buffer_load_dwordx4 v16,s[36:39],s64 offen nt lds
s_add_u32 s64,s68,1572864
buffer_load_dword v31,v29,s[36:39],s64 offen
s_waitcnt vmcnt(10)
s_add_u32 s64,s62,655360
s_add_u32 m0,s61,10240
s_nop 0
buffer_load_dwordx4 v16,s[36:39],s64 offen nt lds
s_waitcnt vmcnt(10)
s_add_u32 s64,s62,720896
s_add_u32 m0,s61,11264
s_nop 0
buffer_load_dwordx4 v16,s[36:39],s64 offen nt lds
s_waitcnt vmcnt(10)
s_add_u32 s64,s62,786432
s_add_u32 m0,s61,12288
s_nop 0
buffer_load_dwordx4 v16,s[36:39],s64 offen nt lds
s_waitcnt vmcnt(10)
s_add_u32 s64,s62,851968
s_add_u32 m0,s61,13312
s_nop 0
buffer_load_dwordx4 v16,s[36:39],s64 offen nt lds
s_add_u32 s64,s68,1835008
buffer_load_dword v31,v29,s[36:39],s64 offen
s_waitcnt vmcnt(10)
s_add_u32 s64,s62,917504
s_add_u32 m0,s61,14336
s_nop 0
buffer_load_dwordx4 v16,s[36:39],s64 offen nt lds
s_waitcnt vmcnt(10)
s_add_u32 s64,s62,983040
s_add_u32 m0,s61,15360
s_nop 0
buffer_load_dwordx4 v16,s[36:39],s64 offen nt lds
s_waitcnt vmcnt(20)
ds_read_b64_tr_b16 a[160:161],v18 offset:16384
ds_read_b64_tr_b16 a[162:163],v18 offset:16512
ds_read_b64_tr_b16 a[164:165],v18 offset:20480
ds_read_b64_tr_b16 a[166:167],v18 offset:20608
ds_read_b64_tr_b16 a[168:169],v18 offset:16416
ds_read_b64_tr_b16 a[170:171],v18 offset:16544
ds_read_b64_tr_b16 a[172:173],v18 offset:20512
ds_read_b64_tr_b16 a[174:175],v18 offset:20640
ds_read_b64_tr_b16 a[176:177],v18 offset:16448
ds_read_b64_tr_b16 a[178:179],v18 offset:16576
ds_read_b64_tr_b16 a[180:181],v18 offset:20544
ds_read_b64_tr_b16 a[182:183],v18 offset:20672
ds_read_b64_tr_b16 a[184:185],v18 offset:16480
ds_read_b64_tr_b16 a[186:187],v18 offset:16608
ds_read_b64_tr_b16 a[188:189],v18 offset:20576
ds_read_b64_tr_b16 a[190:191],v18 offset:20704
s_waitcnt lgkmcnt(0)
ds_read_b64_tr_b16 a[224:225],v18 offset:24576
ds_read_b64_tr_b16 a[226:227],v18 offset:24704
ds_read_b64_tr_b16 a[228:229],v18 offset:28672
ds_read_b64_tr_b16 a[230:231],v18 offset:28800
ds_read_b64_tr_b16 a[232:233],v18 offset:24608
ds_read_b64_tr_b16 a[234:235],v18 offset:24736
ds_read_b64_tr_b16 a[236:237],v18 offset:28704
ds_read_b64_tr_b16 a[238:239],v18 offset:28832
ds_read_b64_tr_b16 a[240:241],v18 offset:24640
ds_read_b64_tr_b16 a[242:243],v18 offset:24768
ds_read_b64_tr_b16 a[244:245],v18 offset:28736
ds_read_b64_tr_b16 a[246:247],v18 offset:28864
ds_read_b64_tr_b16 a[248:249],v18 offset:24672
ds_read_b64_tr_b16 a[250:251],v18 offset:24800
ds_read_b64_tr_b16 a[252:253],v18 offset:28768
ds_read_b64_tr_b16 a[254:255],v18 offset:28896
s_waitcnt lgkmcnt(0)
s_add_u32 s64,s62,1048576
s_add_u32 m0,s61,16384
s_nop 0
buffer_load_dwordx4 v16,s[36:39],s64 offen nt lds
s_waitcnt vmcnt(10)
s_add_u32 s64,s62,1114112
s_add_u32 m0,s61,17408
s_nop 0
buffer_load_dwordx4 v16,s[36:39],s64 offen nt lds
s_add_u32 s64,s69,0
buffer_load_dword v31,v30,s[40:43],s64 offen
s_waitcnt vmcnt(10)
s_add_u32 s64,s62,1179648
s_add_u32 m0,s61,18432
s_nop 0
buffer_load_dwordx4 v16,s[36:39],s64 offen nt lds
s_waitcnt vmcnt(10)
s_add_u32 s64,s62,1245184
s_add_u32 m0,s61,19456
s_nop 0
buffer_load_dwordx4 v16,s[36:39],s64 offen nt lds
s_waitcnt vmcnt(10)
s_add_u32 s64,s62,1310720
s_add_u32 m0,s61,20480
s_nop 0
buffer_load_dwordx4 v16,s[36:39],s64 offen nt lds
s_waitcnt vmcnt(10)
s_add_u32 s64,s62,1376256
s_add_u32 m0,s61,21504
s_nop 0
buffer_load_dwordx4 v16,s[36:39],s64 offen nt lds
s_add_u32 s64,s69,131072
buffer_load_dword v31,v30,s[40:43],s64 offen
s_waitcnt vmcnt(10)
s_add_u32 s64,s62,1441792
s_add_u32 m0,s61,22528
s_nop 0
buffer_load_dwordx4 v16,s[36:39],s64 offen nt lds
s_waitcnt vmcnt(10)
s_add_u32 s64,s62,1507328
s_add_u32 m0,s61,23552
s_nop 0
buffer_load_dwordx4 v16,s[36:39],s64 offen nt lds
s_waitcnt vmcnt(10)
s_add_u32 s64,s62,1572864
s_add_u32 m0,s61,24576
s_nop 0
buffer_load_dwordx4 v16,s[36:39],s64 offen nt lds
s_waitcnt vmcnt(10)
s_add_u32 s64,s62,1638400
s_add_u32 m0,s61,25600
s_nop 0
buffer_load_dwordx4 v16,s[36:39],s64 offen nt lds
s_add_u32 s64,s69,262144
buffer_load_dword v31,v30,s[40:43],s64 offen
s_waitcnt vmcnt(10)
s_add_u32 s64,s62,1703936
s_add_u32 m0,s61,26624
s_nop 0
buffer_load_dwordx4 v16,s[36:39],s64 offen nt lds
s_waitcnt vmcnt(10)
s_add_u32 s64,s62,1769472
s_add_u32 m0,s61,27648
s_nop 0
buffer_load_dwordx4 v16,s[36:39],s64 offen nt lds
s_waitcnt vmcnt(10)
s_add_u32 s64,s62,1835008
s_add_u32 m0,s61,28672
s_nop 0
buffer_load_dwordx4 v16,s[36:39],s64 offen nt lds
s_waitcnt vmcnt(10)
s_add_u32 s64,s62,1900544
s_add_u32 m0,s61,29696
s_nop 0
buffer_load_dwordx4 v16,s[36:39],s64 offen nt lds
s_add_u32 s64,s69,393216
buffer_load_dword v31,v30,s[40:43],s64 offen
s_waitcnt vmcnt(10)
s_add_u32 s64,s62,1966080
s_add_u32 m0,s61,30720
s_nop 0
buffer_load_dwordx4 v16,s[36:39],s64 offen nt lds
s_waitcnt vmcnt(10)
s_add_u32 s64,s62,2031616
s_add_u32 m0,s61,31744
s_nop 0
buffer_load_dwordx4 v16,s[36:39],s64 offen nt lds
s_mov_b32 s92,s2
s_and_b32 s93,s3,0xffff
s_mov_b32 s94,0x100
s_mov_b32 s95,0x20000
v_min_u32 v9,31,v20
v_lshlrev_b32 v9,2,v9
s_sub_u32 s64,s88,64
buffer_load_dword v9,v9,s[92:95],s64 offen sc1
v_lshlrev_b32 v10,12,v22
v_lshlrev_b32 v11,1,v21
v_add_u32 v10,v10,v11
s_lshl_b32 s64,s59,6
buffer_load_ushort v32,v10,s[44:47],s64 offen offset:0
buffer_load_ushort v33,v10,s[44:47],s64 offen offset:2048
buffer_load_ushort v34,v10,s[44:47],s64 offen offset:32
buffer_load_ushort v35,v10,s[44:47],s64 offen offset:2080
s_waitcnt vmcnt(25)
ds_read_b64_tr_b16 v[208:209],v19 offset:0
ds_read_b64_tr_b16 v[210:211],v19 offset:128
ds_read_b64_tr_b16 v[212:213],v19 offset:4096
ds_read_b64_tr_b16 v[214:215],v19 offset:4224
ds_read_b64_tr_b16 v[216:217],v19 offset:8
ds_read_b64_tr_b16 v[218:219],v19 offset:136
ds_read_b64_tr_b16 v[220:221],v19 offset:4104
ds_read_b64_tr_b16 v[222:223],v19 offset:4232
ds_read_b64_tr_b16 v[224:225],v19 offset:64
ds_read_b64_tr_b16 v[226:227],v19 offset:192
ds_read_b64_tr_b16 v[228:229],v19 offset:4160
ds_read_b64_tr_b16 v[230:231],v19 offset:4288
s_waitcnt lgkmcnt(0)
ds_read_b64_tr_b16 v[232:233],v19 offset:72
ds_read_b64_tr_b16 v[234:235],v19 offset:200
ds_read_b64_tr_b16 v[236:237],v19 offset:4168
ds_read_b64_tr_b16 v[238:239],v19 offset:4296
s_waitcnt lgkmcnt(0)
ds_read_b64_tr_b16 v[240:241],v19 offset:8192
ds_read_b64_tr_b16 v[242:243],v19 offset:8320
ds_read_b64_tr_b16 v[244:245],v19 offset:12288
ds_read_b64_tr_b16 v[246:247],v19 offset:12416
ds_read_b64_tr_b16 v[248:249],v19 offset:8200
ds_read_b64_tr_b16 v[250:251],v19 offset:8328
ds_read_b64_tr_b16 v[252:253],v19 offset:12296
ds_read_b64_tr_b16 v[254:255],v19 offset:12424
s_waitcnt lgkmcnt(0)
ds_read_b64_tr_b16 v[128:129],v19 offset:8256
ds_read_b64_tr_b16 v[130:131],v19 offset:8384
ds_read_b64_tr_b16 v[132:133],v19 offset:12352
ds_read_b64_tr_b16 v[134:135],v19 offset:12480
ds_read_b64_tr_b16 v[136:137],v19 offset:8264
ds_read_b64_tr_b16 v[138:139],v19 offset:8392
ds_read_b64_tr_b16 v[140:141],v19 offset:12360
ds_read_b64_tr_b16 v[142:143],v19 offset:12488
s_waitcnt lgkmcnt(0)
s_add_u32 s64,s70,0
s_add_u32 m0,s72,0
s_nop 0
buffer_load_dwordx4 v17,s[40:43],s64 offen  lds
s_waitcnt vmcnt(10)
s_add_u32 s64,s70,32768
s_add_u32 m0,s72,1024
s_nop 0
buffer_load_dwordx4 v17,s[40:43],s64 offen  lds
s_add_u32 s64,s69,524288
buffer_load_dword v31,v30,s[40:43],s64 offen
s_waitcnt vmcnt(10)
s_add_u32 s64,s70,65536
s_add_u32 m0,s72,2048
s_nop 0
buffer_load_dwordx4 v17,s[40:43],s64 offen  lds
s_waitcnt vmcnt(10)
s_add_u32 s64,s70,98304
s_add_u32 m0,s72,3072
s_nop 0
buffer_load_dwordx4 v17,s[40:43],s64 offen  lds
s_waitcnt vmcnt(10)
s_add_u32 s64,s70,131072
s_add_u32 m0,s72,4096
s_nop 0
buffer_load_dwordx4 v17,s[40:43],s64 offen  lds
s_waitcnt vmcnt(10)
s_add_u32 s64,s70,163840
s_add_u32 m0,s72,5120
s_nop 0
buffer_load_dwordx4 v17,s[40:43],s64 offen  lds
s_add_u32 s64,s69,655360
buffer_load_dword v31,v30,s[40:43],s64 offen
s_waitcnt vmcnt(10)
s_add_u32 s64,s70,196608
s_add_u32 m0,s72,6144
s_nop 0
buffer_load_dwordx4 v17,s[40:43],s64 offen  lds
s_waitcnt vmcnt(10)
s_add_u32 s64,s70,229376
s_add_u32 m0,s72,7168
s_nop 0
buffer_load_dwordx4 v17,s[40:43],s64 offen  lds
s_waitcnt vmcnt(10)
s_add_u32 s64,s71,262144
s_add_u32 m0,s73,8192
s_nop 0
buffer_load_dwordx4 v17,s[40:43],s64 offen  lds
s_waitcnt vmcnt(10)
s_add_u32 s64,s71,294912
s_add_u32 m0,s73,9216
s_nop 0
buffer_load_dwordx4 v17,s[40:43],s64 offen  lds
s_add_u32 s64,s69,786432
buffer_load_dword v31,v30,s[40:43],s64 offen
s_waitcnt vmcnt(10)
s_add_u32 s64,s71,327680
s_add_u32 m0,s73,10240
s_nop 0
buffer_load_dwordx4 v17,s[40:43],s64 offen  lds
s_waitcnt vmcnt(10)
s_add_u32 s64,s71,360448
s_add_u32 m0,s73,11264
s_nop 0
buffer_load_dwordx4 v17,s[40:43],s64 offen  lds
s_waitcnt vmcnt(10)
s_add_u32 s64,s71,393216
s_add_u32 m0,s73,12288
s_nop 0
buffer_load_dwordx4 v17,s[40:43],s64 offen  lds
s_waitcnt vmcnt(10)
s_add_u32 s64,s71,425984
s_add_u32 m0,s73,13312
s_nop 0
buffer_load_dwordx4 v17,s[40:43],s64 offen  lds
s_add_u32 s64,s69,917504
buffer_load_dword v31,v30,s[40:43],s64 offen
s_waitcnt vmcnt(10)
s_add_u32 s64,s71,458752
s_add_u32 m0,s73,14336
s_nop 0
buffer_load_dwordx4 v17,s[40:43],s64 offen  lds
s_waitcnt vmcnt(10)
s_add_u32 s64,s71,491520
s_add_u32 m0,s73,15360
s_nop 0
buffer_load_dwordx4 v17,s[40:43],s64 offen  lds
s_waitcnt vmcnt(20)
ds_read_b64_tr_b16 v[144:145],v19 offset:16384
ds_read_b64_tr_b16 v[146:147],v19 offset:16512
ds_read_b64_tr_b16 v[148:149],v19 offset:20480
ds_read_b64_tr_b16 v[150:151],v19 offset:20608
s_waitcnt lgkmcnt(0)
ds_read_b64_tr_b16 v[152:153],v19 offset:16392
ds_read_b64_tr_b16 v[154:155],v19 offset:16520
ds_read_b64_tr_b16 v[156:157],v19 offset:20488
ds_read_b64_tr_b16 v[158:159],v19 offset:20616
ds_read_b64_tr_b16 v[160:161],v19 offset:16448
ds_read_b64_tr_b16 v[162:163],v19 offset:16576
ds_read_b64_tr_b16 v[164:165],v19 offset:20544
ds_read_b64_tr_b16 v[166:167],v19 offset:20672
ds_read_b64_tr_b16 v[168:169],v19 offset:16456
ds_read_b64_tr_b16 v[170:171],v19 offset:16584
ds_read_b64_tr_b16 v[172:173],v19 offset:20552
ds_read_b64_tr_b16 v[174:175],v19 offset:20680
s_waitcnt lgkmcnt(0)
ds_read_b64_tr_b16 v[176:177],v19 offset:24576
ds_read_b64_tr_b16 v[178:179],v19 offset:24704
ds_read_b64_tr_b16 v[180:181],v19 offset:28672
ds_read_b64_tr_b16 v[182:183],v19 offset:28800
ds_read_b64_tr_b16 v[184:185],v19 offset:24584
ds_read_b64_tr_b16 v[186:187],v19 offset:24712
ds_read_b64_tr_b16 v[188:189],v19 offset:28680
ds_read_b64_tr_b16 v[190:191],v19 offset:28808
ds_read_b64_tr_b16 v[192:193],v19 offset:24640
ds_read_b64_tr_b16 v[194:195],v19 offset:24768
ds_read_b64_tr_b16 v[196:197],v19 offset:28736
ds_read_b64_tr_b16 v[198:199],v19 offset:28864
s_waitcnt lgkmcnt(0)
ds_read_b64_tr_b16 v[200:201],v19 offset:24648
ds_read_b64_tr_b16 v[202:203],v19 offset:24776
ds_read_b64_tr_b16 v[204:205],v19 offset:28744
ds_read_b64_tr_b16 v[206:207],v19 offset:28872
s_waitcnt lgkmcnt(0)
s_add_u32 s64,s70,524288
s_add_u32 m0,s72,16384
s_nop 0
buffer_load_dwordx4 v17,s[40:43],s64 offen  lds
s_waitcnt vmcnt(10)
s_add_u32 s64,s70,557056
s_add_u32 m0,s72,17408
s_nop 0
buffer_load_dwordx4 v17,s[40:43],s64 offen  lds
s_waitcnt vmcnt(10)
s_add_u32 s64,s70,589824
s_add_u32 m0,s72,18432
s_nop 0
buffer_load_dwordx4 v17,s[40:43],s64 offen  lds
s_waitcnt vmcnt(10)
s_add_u32 s64,s70,622592
s_add_u32 m0,s72,19456
s_nop 0
buffer_load_dwordx4 v17,s[40:43],s64 offen  lds
v_and_b32 v10,1,v20
v_cmp_eq_u32 vcc,1,v10
v_mov_b32 v10,8192
s_nop 0
v_cndmask_b32 v10,-1,v10,vcc
v_cmp_eq_u32 vcc,v9,v10
s_and_b32 s64,vcc_lo,0xffff
v_readlane_b32 s65,v9,21
s_cmp_eq_u32 s64,65535
s_cselect_b32 s65,s65,0
s_cmp_eq_u32 s56,2
s_cselect_b32 s65,s65,0
v_readlane_b32 s64,v9,22
s_cmp_ge_u32 s64,63
s_cselect_b32 s65,s65,0
s_and_b32 s64,s65,2
s_lshl_b32 s64,s64,12
s_or_b32 s64,s64,1
s_cmp_eq_u32 s65,0
s_cselect_b32 s65,0,s64
v_mov_b32 v10,2048
s_cmp_lg_u32 s50,0
s_cbranch_scc1 avs_100426
v_mov_b32 v9,s65
ds_write_b32 v10,v9
s_waitcnt lgkmcnt(0)
avs_100426:
s_barrier
ds_read_b32 v9,v10
s_waitcnt lgkmcnt(0)
v_readfirstlane_b32 s89,v9
s_cmp_lg_u32 s89,0
s_cselect_b32 s55,36,0
s_lshl_b32 s64,s58,14
s_lshl_b32 s65,s59,9
s_add_u32 s64,s64,s65
s_add_u32 s64,s64,134217728
s_lshl_b32 s65,s57,10
s_add_u32 s65,s65,134249984
s_lshl_b32 s66,s57,12
s_add_u32 s66,s66,134478336
v_mov_b32 v10,s66
v_mov_b32 v11,s65
v_cmp_gt_u32 vcc,12,v20
s_nop 1
v_cndmask_b32 v10,v10,v11,vcc
v_mov_b32 v11,s64
v_cmp_gt_u32 vcc,4,v20
s_nop 1
v_cndmask_b32 v10,v10,v11,vcc
v_lshl_add_u32 v10,v20,7,v10
v_cmp_gt_u32 vcc,s55,v20
s_nop 1
v_cndmask_b32 v10,2.0,v10,vcc
s_lshl_b32 s64,s50,19
buffer_load_dword v11,v10,s[20:23],s64 offen
s_waitcnt vmcnt(5)
ds_read_b64_tr_b16 v[48:49],v27 offset:0
ds_read_b64_tr_b16 v[50:51],v27 offset:128
ds_read_b64_tr_b16 v[52:53],v27 offset:2048
ds_read_b64_tr_b16 v[54:55],v27 offset:2176
ds_read_b64_tr_b16 v[56:57],v27 offset:32
ds_read_b64_tr_b16 v[58:59],v27 offset:160
ds_read_b64_tr_b16 v[60:61],v27 offset:2080
ds_read_b64_tr_b16 v[62:63],v27 offset:2208
s_add_u32 s64,s70,655360
s_add_u32 m0,s72,20480
s_nop 0
buffer_load_dwordx4 v17,s[40:43],s64 offen  lds
s_add_u32 s64,s70,688128
s_add_u32 m0,s72,21504
s_nop 0
buffer_load_dwordx4 v17,s[40:43],s64 offen  lds
s_add_u32 s64,s70,720896
s_add_u32 m0,s72,22528
s_nop 0
buffer_load_dwordx4 v17,s[40:43],s64 offen  lds
ds_read_b64_tr_b16 v[64:65],v27 offset:4096
ds_read_b64_tr_b16 v[66:67],v27 offset:4224
ds_read_b64_tr_b16 v[68:69],v27 offset:6144
ds_read_b64_tr_b16 v[70:71],v27 offset:6272
ds_read_b64_tr_b16 v[72:73],v27 offset:4128
ds_read_b64_tr_b16 v[74:75],v27 offset:4256
ds_read_b64_tr_b16 v[76:77],v27 offset:6176
ds_read_b64_tr_b16 v[78:79],v27 offset:6304
s_add_u32 s64,s70,753664
s_add_u32 m0,s72,23552
s_nop 0
buffer_load_dwordx4 v17,s[40:43],s64 offen  lds
s_add_u32 s64,s71,786432
s_add_u32 m0,s73,24576
s_nop 0
buffer_load_dwordx4 v17,s[40:43],s64 offen  lds
s_add_u32 s64,s71,819200
s_add_u32 m0,s73,25600
s_nop 0
buffer_load_dwordx4 v17,s[40:43],s64 offen  lds
s_waitcnt lgkmcnt(0)
ds_read_b64_tr_b16 v[80:81],v27 offset:8192
ds_read_b64_tr_b16 v[82:83],v27 offset:8320
ds_read_b64_tr_b16 v[84:85],v27 offset:10240
ds_read_b64_tr_b16 v[86:87],v27 offset:10368
ds_read_b64_tr_b16 v[88:89],v27 offset:8224
ds_read_b64_tr_b16 v[90:91],v27 offset:8352
ds_read_b64_tr_b16 v[92:93],v27 offset:10272
ds_read_b64_tr_b16 v[94:95],v27 offset:10400
s_add_u32 s64,s71,851968
s_add_u32 m0,s73,26624
s_nop 0
buffer_load_dwordx4 v17,s[40:43],s64 offen  lds
s_add_u32 s64,s71,884736
s_add_u32 m0,s73,27648
s_nop 0
buffer_load_dwordx4 v17,s[40:43],s64 offen  lds
s_add_u32 s64,s71,917504
s_add_u32 m0,s73,28672
s_nop 0
buffer_load_dwordx4 v17,s[40:43],s64 offen  lds
ds_read_b64_tr_b16 v[96:97],v27 offset:12288
ds_read_b64_tr_b16 v[98:99],v27 offset:12416
ds_read_b64_tr_b16 v[100:101],v27 offset:14336
ds_read_b64_tr_b16 v[102:103],v27 offset:14464
ds_read_b64_tr_b16 v[104:105],v27 offset:12320
ds_read_b64_tr_b16 v[106:107],v27 offset:12448
ds_read_b64_tr_b16 v[108:109],v27 offset:14368
ds_read_b64_tr_b16 v[110:111],v27 offset:14496
s_add_u32 s64,s71,950272
s_add_u32 m0,s73,29696
s_nop 0
buffer_load_dwordx4 v17,s[40:43],s64 offen  lds
s_add_u32 s64,s71,983040
s_add_u32 m0,s73,30720
s_nop 0
buffer_load_dwordx4 v17,s[40:43],s64 offen  lds
s_add_u32 s64,s71,1015808
s_add_u32 m0,s73,31744
s_nop 0
buffer_load_dwordx4 v17,s[40:43],s64 offen  lds
s_waitcnt lgkmcnt(0)
ds_write_b128 v7,v[128:131] offset:0
ds_write_b128 v7,v[132:135] offset:1024
ds_write_b128 v7,v[136:139] offset:2048
ds_write_b128 v7,v[140:143] offset:3072
ds_write_b128 v7,v[144:147] offset:4096
ds_write_b128 v7,v[148:151] offset:5120
ds_write_b128 v7,v[152:155] offset:6144
ds_write_b128 v7,v[156:159] offset:7168
ds_write_b128 v7,v[160:163] offset:8192
ds_write_b128 v7,v[164:167] offset:9216
ds_write_b128 v7,v[168:171] offset:10240
ds_write_b128 v7,v[172:175] offset:11264
s_waitcnt lgkmcnt(4)
ds_write_b128 v7,v[176:179] offset:12288
ds_write_b128 v7,v[180:183] offset:13312
ds_write_b128 v7,v[184:187] offset:14336
ds_write_b128 v7,v[188:191] offset:15360
s_waitcnt lgkmcnt(0)
v_mov_b32 v128,v96
v_mov_b32 v112,v192
v_mov_b32 v129,v97
v_mov_b32 v113,v193
v_mov_b32 v130,v98
v_mov_b32 v114,v194
v_mov_b32 v131,v99
v_mov_b32 v115,v195
v_mov_b32 v132,v100
v_mov_b32 v116,v196
v_mov_b32 v133,v101
v_mov_b32 v117,v197
v_mov_b32 v134,v102
v_mov_b32 v118,v198
v_mov_b32 v135,v103
v_mov_b32 v119,v199
v_mov_b32 v136,v104
v_mov_b32 v120,v200
v_mov_b32 v137,v105
v_mov_b32 v121,v201
v_mov_b32 v138,v106
v_mov_b32 v122,v202
v_mov_b32 v139,v107
v_mov_b32 v123,v203
v_mov_b32 v140,v108
v_mov_b32 v124,v204
v_mov_b32 v141,v109
v_mov_b32 v125,v205
v_mov_b32 v142,v110
v_mov_b32 v126,v206
v_mov_b32 v143,v111
v_mov_b32 v127,v207
s_waitcnt vmcnt(0)
ds_read_b64_tr_b16 v[144:145],v27 offset:16384
ds_read_b64_tr_b16 v[146:147],v27 offset:16512
ds_read_b64_tr_b16 v[148:149],v27 offset:18432
ds_read_b64_tr_b16 v[150:151],v27 offset:18560
ds_read_b64_tr_b16 v[152:153],v27 offset:16416
ds_read_b64_tr_b16 v[154:155],v27 offset:16544
ds_read_b64_tr_b16 v[156:157],v27 offset:18464
ds_read_b64_tr_b16 v[158:159],v27 offset:18592
ds_read_b64_tr_b16 v[160:161],v27 offset:20480
ds_read_b64_tr_b16 v[162:163],v27 offset:20608
ds_read_b64_tr_b16 v[164:165],v27 offset:22528
ds_read_b64_tr_b16 v[166:167],v27 offset:22656
ds_read_b64_tr_b16 v[168:169],v27 offset:20512
ds_read_b64_tr_b16 v[170:171],v27 offset:20640
ds_read_b64_tr_b16 v[172:173],v27 offset:22560
ds_read_b64_tr_b16 v[174:175],v27 offset:22688
s_waitcnt lgkmcnt(0)
ds_read_b64_tr_b16 v[176:177],v27 offset:24576
ds_read_b64_tr_b16 v[178:179],v27 offset:24704
ds_read_b64_tr_b16 v[180:181],v27 offset:26624
ds_read_b64_tr_b16 v[182:183],v27 offset:26752
ds_read_b64_tr_b16 v[184:185],v27 offset:24608
ds_read_b64_tr_b16 v[186:187],v27 offset:24736
ds_read_b64_tr_b16 v[188:189],v27 offset:26656
ds_read_b64_tr_b16 v[190:191],v27 offset:26784
ds_read_b64_tr_b16 v[192:193],v27 offset:28672
ds_read_b64_tr_b16 v[194:195],v27 offset:28800
ds_read_b64_tr_b16 v[196:197],v27 offset:30720
ds_read_b64_tr_b16 v[198:199],v27 offset:30848
ds_read_b64_tr_b16 v[200:201],v27 offset:28704
ds_read_b64_tr_b16 v[202:203],v27 offset:28832
ds_read_b64_tr_b16 v[204:205],v27 offset:30752
ds_read_b64_tr_b16 v[206:207],v27 offset:30880
s_waitcnt lgkmcnt(0)
ds_write_b128 v7,v[112:115] offset:16384
ds_write_b128 v7,v[116:119] offset:17408
ds_write_b128 v7,v[120:123] offset:18432
ds_write_b128 v7,v[124:127] offset:19456
ds_write_b128 v7,v[48:51] offset:20480
ds_write_b128 v7,v[52:55] offset:21504
ds_write_b128 v7,v[56:59] offset:22528
ds_write_b128 v7,v[60:63] offset:23552
ds_write_b128 v7,v[64:67] offset:24576
ds_write_b128 v7,v[68:71] offset:25600
ds_write_b128 v7,v[72:75] offset:26624
ds_write_b128 v7,v[76:79] offset:27648
s_waitcnt lgkmcnt(4)
ds_write_b128 v7,v[80:83] offset:28672
ds_write_b128 v7,v[84:87] offset:29696
ds_write_b128 v7,v[88:91] offset:30720
ds_write_b128 v7,v[92:95] offset:31744
s_waitcnt lgkmcnt(0)
v_and_b32 v23,1,v21
v_mov_b32 v1,0x4444
v_mov_b32 v24,0xeeee
v_cmp_eq_u32 vcc,1,v23
s_nop 1
v_cndmask_b32 v1,v1,v24,vcc
v_lshlrev_b32 v23,1,v22
v_sub_u32 v23,v21,v23
v_mov_b32 v5,0
v_mov_b32 v24,0x3f80
v_cmp_eq_u32 vcc,0,v23
s_nop 1
v_cndmask_b32 v5,v5,v24,vcc
v_mov_b32 v24,0x3f800000
v_cmp_eq_u32 vcc,1,v23
s_nop 1
v_cndmask_b32 v5,v5,v24,vcc
s_and_b32 s64,s50,1
s_lshl_b32 s64,s64,11
v_lshl_add_u32 v127,v20,2,s64
v_and_b32 v23,7,v21
v_lshrrev_b32 v24,3,v21
v_lshlrev_b32 v25,8,v24
v_lshl_add_u32 v25,v22,6,v25
v_lshl_add_u32 v4,v23,2,v25
v_lshrrev_b32 v25,1,v22
v_lshl_add_u32 v25,v25,3,v23
v_lshlrev_b32 v25,5,v25
v_and_b32 v26,1,v22
v_lshl_add_u32 v6,v26,4,v25
v_lshl_add_u32 v27,v22,3,v23
v_lshlrev_b32 v27,4,v27
s_mov_b32 s80,0x3e0293ee
s_mov_b32 s81,0xfffffffe
s_mov_b32 s84,0x00ff00ff
s_mov_b32 s85,0x00ff00ff
s_mov_b32 s86,-1
s_mov_b32 s87,0
s_cmp_gt_u32 s50,1
s_cselect_b32 s82,0xff00ff00,-1
s_cselect_b32 s83,0xff00ff00,0
s_lshl_b32 m0,s50,8
s_cmp_gt_u32 s50,1
s_cbranch_scc1 w23_100427
v_lshl_add_u32 v2,v24,9,v27
v_lshrrev_b32 v25,1,v22
v_lshl_add_u32 v25,v25,3,v23
v_lshlrev_b32 v25,4,v25
v_lshl_add_u32 v26,v26,1,v24
v_lshl_add_u32 v3,v26,2,v25
v_add_u32 v3,1024 + 256,v3
v_cndmask_b32 v6,2.0,v6,s[84:85]
v_mov_b32 v8,0x3f803f80
v_mov_b32 v9,0x3f803f80
v_mov_b32 v10,0x3f803f80
v_mov_b32 v11,0x3f803f80
v_mov_b32 v12,0x3f803f80
v_mov_b32 v13,0
v_mov_b32 v14,0
v_mov_b32 v15,0
s_branch jn_100428
w23_100427:
s_sub_u32 s64,s50,2
s_mul_i32 s64,s64,4160
v_lshrrev_b32 v25,1,v22
v_mul_u32_u24 v25,2080,v25
v_and_b32 v28,1,v23
v_mul_u32_u24 v28,1040,v28
v_add_u32 v25,v25,v28
v_lshrrev_b32 v28,1,v23
v_lshl_add_u32 v25,v28,6,v25
v_lshl_add_u32 v25,v26,5,v25
v_mul_u32_u24 v28,8448,v24
v_add3_u32 v2,v25,v28,s64
v_cndmask_b32 v3,2.0,v27,s[84:85]
v_mov_b32 v8,-1
v_mov_b32 v9,-1
v_mov_b32 v10,-1
v_mov_b32 v11,-1
jn_100428:
s_cmp_eq_u32 s89,0
s_cbranch_scc1 avn_100431
s_mov_b32 s56,0
s_and_b32 s67,s89,0x2000
s_branch avj_100432
avn_100431:
s_mov_b32 s92,s2
s_and_b32 s93,s3,0xffff
s_mov_b32 s94,0x100
s_mov_b32 s95,0x20000
v_mbcnt_lo_u32_b32 v16,-1,0
v_mbcnt_hi_u32_b32 v16,-1,v16
v_mov_b32 v18,0
v_cmp_eq_u32 vcc,22,v16
s_nop 1
v_cndmask_b32 v18,v18,63,vcc
v_cmp_eq_u32 vcc,21,v16
s_nop 1
v_cndmask_b32 v18,v18,1,vcc
v_and_b32 v19,1,v16
v_cmp_eq_u32 vcc,1,v19
v_mov_b32 v19,8192
s_nop 0
v_cndmask_b32 v19,-1,v19,vcc
v_min_u32 v16,31,v16
v_lshlrev_b32 v16,2,v16
s_sub_u32 s66,s88,64
s_cmp_lg_u32 s50,0
s_cbranch_scc1 vot_100437
vpoll_100433:
buffer_load_dword v17,v16,s[92:95],s66 offen sc1
s_waitcnt vmcnt(0)
s_cmp_lg_u32 s56,2
s_cbranch_scc1 vck_100434
v_cmp_eq_u32 vcc,v17,v19
s_and_b32 s64,vcc_lo,0xffff
s_cmp_eq_u32 s64,65535
s_cbranch_scc1 vck_100434
s_mov_b32 s65,0
v_readlane_b32 s64,v17,1
s_lshr_b32 s64,s64,8
s_add_u32 s65,s65,s64
v_readlane_b32 s64,v17,3
s_lshr_b32 s64,s64,8
s_add_u32 s65,s65,s64
v_readlane_b32 s64,v17,5
s_lshr_b32 s64,s64,8
s_add_u32 s65,s65,s64
v_readlane_b32 s64,v17,7
s_lshr_b32 s64,s64,8
s_add_u32 s65,s65,s64
v_readlane_b32 s64,v17,9
s_lshr_b32 s64,s64,8
s_add_u32 s65,s65,s64
v_readlane_b32 s64,v17,11
s_lshr_b32 s64,s64,8
s_add_u32 s65,s65,s64
v_readlane_b32 s64,v17,13
s_lshr_b32 s64,s64,8
s_add_u32 s65,s65,s64
v_readlane_b32 s64,v17,15
s_lshr_b32 s64,s64,8
s_add_u32 s65,s65,s64
s_cmp_ge_u32 s65,256
s_cbranch_scc1 vok_100436
s_branch vrt_100435
vck_100434:
v_cmp_gt_u32 vcc,v18,v17
s_cbranch_vccz vok_100436
vrt_100435:
s_sleep 8
s_sub_u32 s90,s90,1
s_cmp_gt_i32 s90,0
s_cbranch_scc1 vpoll_100433
vok_100436:
ds_write_b32 v16,v17 offset:1792
s_waitcnt lgkmcnt(0)
vot_100437:
s_barrier
v_add_u32 v18,1792,v16
ds_read_b32 v17,v18
s_waitcnt lgkmcnt(0)
s_cmp_lg_u32 s56,2
s_cbranch_scc1 vfin_100438
v_cmp_eq_u32 vcc,v17,v19
s_and_b32 s64,vcc_lo,0xffff
s_cmp_eq_u32 s64,65535
s_cbranch_scc1 vfin_100438
s_mov_b32 s65,0
v_readlane_b32 s64,v17,1
s_lshr_b32 s64,s64,8
s_add_u32 s65,s65,s64
v_readlane_b32 s64,v17,3
s_lshr_b32 s64,s64,8
s_add_u32 s65,s65,s64
v_readlane_b32 s64,v17,5
s_lshr_b32 s64,s64,8
s_add_u32 s65,s65,s64
v_readlane_b32 s64,v17,7
s_lshr_b32 s64,s64,8
s_add_u32 s65,s65,s64
v_readlane_b32 s64,v17,9
s_lshr_b32 s64,s64,8
s_add_u32 s65,s65,s64
v_readlane_b32 s64,v17,11
s_lshr_b32 s64,s64,8
s_add_u32 s65,s65,s64
v_readlane_b32 s64,v17,13
s_lshr_b32 s64,s64,8
s_add_u32 s65,s65,s64
v_readlane_b32 s64,v17,15
s_lshr_b32 s64,s64,8
s_add_u32 s65,s65,s64
s_cmp_ge_u32 s65,256
s_cbranch_scc1 fl_fb
vfin_100438:
s_and_b32 s56,s56,1
s_mov_b32 s67,0
v_readlane_b32 s65,v17,21
s_and_b32 s65,s65,2
s_lshl_b32 s67,s65,12
v_mbcnt_lo_u32_b32 v20,-1,0
v_mbcnt_hi_u32_b32 v20,-1,v20
s_lshl_b32 s64,s58,14
s_lshl_b32 s65,s59,9
s_add_u32 s64,s64,s65
s_add_u32 s64,s64,134217728
s_lshl_b32 s65,s57,10
s_add_u32 s65,s65,134249984
s_lshl_b32 s66,s57,12
s_add_u32 s66,s66,134478336
v_mov_b32 v21,s66
v_mov_b32 v22,s65
v_cmp_gt_u32 vcc,12,v20
s_nop 1
v_cndmask_b32 v21,v21,v22,vcc
v_mov_b32 v22,s64
v_cmp_gt_u32 vcc,4,v20
s_nop 1
v_cndmask_b32 v21,v21,v22,vcc
v_lshl_add_u32 v21,v20,7,v21
v_cmp_gt_u32 vcc,36,v20
s_nop 1
v_cndmask_b32 v21,2.0,v21,vcc
s_lshl_b32 s64,s50,19
buffer_load_dword v22,v21,s[20:23],s64 offen
s_waitcnt vmcnt(0)
avj_100432:
s_lshl_b32 s64,s58,14
s_lshl_b32 s65,s50,12
s_add_u32 s70,s64,s65
s_add_u32 s70,s70,134217728
s_lshl_b32 s65,s59,9
s_add_u32 s71,s64,s65
s_add_u32 s71,s71,134217728
s_xor_b32 s64,s58,1
s_lshl_b32 s64,s64,15
s_lshr_b32 s65,s50,1
s_lshl_b32 s65,s65,14
s_add_u32 s64,s64,s65
s_and_b32 s65,s50,1
s_lshl_b32 s65,s65,12
s_add_u32 s64,s64,s65
s_add_u32 s72,s64,s67
s_add_u32 s72,s72,142606336
s_lshl_b32 s64,s58,15
s_lshr_b32 s65,s59,4
s_lshl_b32 s65,s65,14
s_add_u32 s64,s64,s65
s_and_b32 s65,s59,15
s_lshl_b32 s65,s65,9
s_add_u32 s64,s64,s65
s_add_u32 s73,s64,s67
s_add_u32 s73,s73,142606336
s_cmp_eq_u32 s50,1
s_cselect_b32 s54,2048 - 256,0
s_sub_u32 s71,s71,s54
s_lshl_b32 s64,s58,15
s_lshl_b32 s65,s50,13
s_add_u32 s74,s64,s65
s_add_u32 s74,s74,134250496
s_lshl_b32 s64,s57,10
s_and_b32 s65,s50,1
s_lshl_b32 s65,s65,9
s_cmp_gt_u32 s50,1
s_cselect_b32 s65,0,s65
s_add_u32 s75,s64,s65
s_add_u32 s75,s75,134250496
s_lshl_b32 s64,s57,12
s_and_b32 s65,s64,0xffffe000
s_cmp_eq_u32 s50,3
s_cselect_b32 s66,1536,0
s_add_u32 s64,s64,s66
s_cmp_gt_u32 s50,1
s_cselect_b32 s76,s64,s65
s_add_u32 s76,s76,134479872
s_lshl_b32 s64,s57,14
s_and_b32 s65,s50,1
s_lshl_b32 s66,s65,11
s_add_u32 s77,s64,s66
s_cmp_gt_u32 s50,1
s_cselect_b32 s66,0,4096
s_add_u32 s77,s77,s66
s_add_u32 s77,s77,0
s_lshl_b32 s66,s65,9
s_add_u32 s66,s66,1024 + 128
s_lshl_b32 s65,s65,7
s_cmp_gt_u32 s50,1
s_cselect_b32 s65,s65,s66
s_add_u32 s78,s64,s65
s_add_u32 s78,s78,67108736
s_lshl_b32 s64,s57,6
s_add_u32 s68,s64,s67
s_add_u32 s69,s68,s64
s_add_u32 s69,s69,138428416
s_lshl_b32 s64,s50,14
s_add_u32 s69,s69,s64
s_and_b32 s64,s50,1
s_lshl_b32 s64,s64,11
s_sub_u32 s69,s69,s64
s_add_u32 s68,s68,138412032
s_mov_b32 s79,0
s_mov_b32 s91,0
s_mov_b32 s90,100000
s_barrier
s_cmp_eq_u32 s56,1
s_cbranch_scc1 recslow_100429
buffer_load_dword v119,off,s[20:23],s68 sc1
s_mov_b32 s55,0
s_cmp_lg_u32 s50,0
s_cbranch_scc1 np0_100441
v_mov_b32 v120,0
v_mov_b32 v121,0
s_cmp_lg_u32 s58,0
s_cbranch_scc1 z1_100442
v_mov_b32 v120,v32
v_mov_b32 v121,v33
v_mov_b32 v122,v34
v_mov_b32 v123,v35
v_lshl_or_b32 v120,v122,16,v120
v_lshl_or_b32 v121,v123,16,v121
v_min_u32 v120,s81,v120
v_min_u32 v121,s81,v121
z1_100442:
buffer_store_dword v120,v4,s[20:23],s71 offen
buffer_store_dword v121,v4,s[20:23],s71 offen offset:32
buffer_store_dword v120,v4,s[20:23],s73 offen sc1
buffer_store_dword v121,v4,s[20:23],s73 offen offset:32 sc1
np0_100441:
v_lshrrev_b32 v124,2,v0
v_bfe_u32 v125,v124,5,1
v_mul_u32_u24 v125,2048,v125
s_and_b32 s64,s50,1
s_lshl_b32 s64,s64,5
v_add3_u32 v4,v124,v125,s64
s_mov_b32 s61,1
s_mov_b32 s92,s70
s_mov_b32 s93,s72
s_mov_b32 s94,s76
s_add_u32 s95,s94,4096
s_mov_b32 s96,s74
s_add_u32 s97,s96,4096
s_mov_b32 s98,s75
s_barrier
v_mov_b32 v96,v104
v_mov_b32 v97,v105
v_mov_b32 v98,v106
v_mov_b32 v99,v107
v_mov_b32 v100,v108
v_mov_b32 v101,v109
v_mov_b32 v102,v110
v_mov_b32 v103,v111
v_mov_b32 v48,0
v_mov_b32 v49,0
v_mov_b32 v50,0
v_mov_b32 v51,0
v_mov_b32 v52,0
v_mov_b32 v53,0
v_mov_b32 v54,0
v_mov_b32 v55,0
v_mov_b32 v56,0
v_mov_b32 v57,0
v_mov_b32 v58,0
v_mov_b32 v59,0
v_mov_b32 v60,0
v_mov_b32 v61,0
v_mov_b32 v62,0
v_mov_b32 v63,0
v_mov_b32 v64,0
v_mov_b32 v65,0
v_mov_b32 v66,0
v_mov_b32 v67,0
v_mov_b32 v68,0
v_mov_b32 v69,0
v_mov_b32 v70,0
v_mov_b32 v71,0
v_mov_b32 v72,0
v_mov_b32 v73,0
v_mov_b32 v74,0
v_mov_b32 v75,0
v_mov_b32 v76,0
v_mov_b32 v77,0
v_mov_b32 v78,0
v_mov_b32 v79,0
v_mov_b32 v80,0
v_mov_b32 v81,0
v_mov_b32 v82,0
v_mov_b32 v83,0
v_mov_b32 v84,0
v_mov_b32 v85,0
v_mov_b32 v86,0
v_mov_b32 v87,0
v_mov_b32 v88,0
v_mov_b32 v89,0
v_mov_b32 v90,0
v_mov_b32 v91,0
v_mov_b32 v92,0
v_mov_b32 v93,0
v_mov_b32 v94,0
v_mov_b32 v95,0
s_cmp_gt_u32 s50,1
s_cbranch_scc0 loop0_100443x
.p2align 6
s_nop 0
s_nop 0
s_nop 0
s_nop 0
s_nop 0
s_nop 0
s_nop 0
loop_100439:
v_mov_b32 v125,0
s_nop 1
v_mfma_f32_16x16x1_4b_f32 v[48:63],v125,v125,0
v_mfma_f32_16x16x1_4b_f32 v[64:79],v125,v125,0
v_mfma_f32_16x16x1_4b_f32 v[80:95],v125,v125,0
s_max_u32 s66,s79,1
s_sub_u32 s66,s66,1
v_cndmask_b32 v126,2.0,v0,s[82:83]
s_add_u32 s64,s66,0
s_lshl_b32 s65,s64,12
s_and_b32 s65,s65,0x2000
s_xor_b32 s65,s65,s67
s_lshl_b32 s64,s64,20
s_add_u32 s65,s65,s64
s_add_u32 s101,s65,s78
buffer_store_dwordx4 v[112:115],v126,s[20:23],s101 offen sc1
s_nop 15
s_nop 15
s_nop 15
s_nop 7
buffer_load_dwordx4 v[16:19],v0,s[20:23],s92 offen offset:0 sc1
s_nop 7
buffer_load_dwordx4 v[20:23],v0,s[20:23],s92 offen offset:1024 sc1
s_nop 7
buffer_load_dwordx4 v[24:27],v0,s[20:23],s92 offen offset:2048 sc1
s_nop 7
buffer_load_dwordx4 v[28:31],v0,s[20:23],s92 offen offset:3072 sc1
v_mov_b32 v96,v104
v_mov_b32 v97,v105
v_mov_b32 v98,v106
v_mov_b32 v99,v107
v_mov_b32 v100,v108
v_mov_b32 v101,v109
v_mov_b32 v102,v110
v_mov_b32 v103,v111
s_branch ja_100444
loop0_100443x:
v_mov_b32 v125,0
s_nop 1
v_mfma_f32_16x16x1_4b_f32 v[48:63],v125,v125,0
v_mfma_f32_16x16x1_4b_f32 v[64:79],v125,v125,0
v_mfma_f32_16x16x1_4b_f32 v[80:95],v125,v125,0
s_max_u32 s66,s79,1
s_sub_u32 s66,s66,1
v_cndmask_b32 v126,2.0,v0,s[82:83]
s_add_u32 s64,s66,0
s_lshl_b32 s65,s64,12
s_and_b32 s65,s65,0x2000
s_xor_b32 s65,s65,s67
s_lshl_b32 s64,s64,20
s_add_u32 s65,s65,s64
s_add_u32 s101,s65,s78
buffer_store_dwordx4 v[112:115],v126,s[20:23],s101 offen sc1
s_nop 15
s_nop 3
buffer_load_dwordx4 v[16:19],v0,s[20:23],s92 offen offset:0 sc1
s_nop 7
buffer_load_dwordx4 v[20:23],v0,s[20:23],s92 offen offset:1024 sc1
s_nop 7
buffer_load_dwordx4 v[24:27],v0,s[20:23],s92 offen offset:2048 sc1
s_nop 7
buffer_load_dwordx4 v[28:31],v0,s[20:23],s92 offen offset:3072 sc1
ja_100444:
.p2align 5
s_nop 0
s_nop 0
s_cmp_lg_u32 s61,0
s_cbranch_scc1 pe_100445
pb_100446:
v_mov_b32 v126,s79
s_cmp_eq_u32 s79,63
s_cbranch_scc1 last_100440
s_add_u32 s64,s79,1
s_lshl_b32 s65,s64,12
s_and_b32 s65,s65,0x2000
s_xor_b32 s65,s65,s67
s_lshl_b32 s64,s64,20
s_add_u32 s65,s65,s64
s_add_u32 s99,s65,s77
s_waitcnt vmcnt(3)
v_max3_u32 v124,v16,v17,v18
v_max_u32 v124,v124,v19
v_cmp_eq_u32 vcc,-1,v124
v_cndmask_b32 v121,2.0,v127,s[86:87]
v_readfirstlane_b32 s91,v119
s_add_u32 s64,s79,1
s_cmp_gt_u32 s91,s64
s_cselect_b32 s99,s99,2.0
s_cselect_b32 s63,0,1
s_cbranch_vccnz flb_100475
seg_100451:
segb_100459:
v_smfmac_f32_16x16x64_bf16 v[48:51],v[16:19],a[0:7],v1
buffer_load_dword v125,off,s[20:23],s92 sc1
v_smfmac_f32_16x16x64_bf16 v[52:55],v[16:19],a[8:15],v1
buffer_load_dwordx4 v[32:35],v0,s[20:23],s93 offen offset:0 sc1
v_smfmac_f32_16x16x64_bf16 v[56:59],v[16:19],a[16:23],v1
s_waitcnt vmcnt(4)
v_max3_u32 v124,v20,v21,v22
v_smfmac_f32_16x16x64_bf16 v[60:63],v[16:19],a[24:31],v1
v_max_u32 v124,v124,v23
v_smfmac_f32_16x16x64_bf16 v[64:67],v[16:19],a[32:39],v1
v_cmp_eq_u32 vcc,-1,v124
v_smfmac_f32_16x16x64_bf16 v[68:71],v[16:19],a[40:47],v1
v_smfmac_f32_16x16x64_bf16 v[72:75],v[16:19],a[48:55],v1
s_cbranch_vccnz fl_100468
seg_100452:
v_smfmac_f32_16x16x64_bf16 v[76:79],v[16:19],a[56:63],v1
segb_100460:
v_smfmac_f32_16x16x64_bf16 v[48:51],v[20:23],a[64:71],v1
buffer_load_dword v125,off,s[20:23],s92 sc1
v_smfmac_f32_16x16x64_bf16 v[52:55],v[20:23],a[72:79],v1
buffer_load_dwordx4 v[36:39],v0,s[20:23],s93 offen offset:1024 sc1
v_smfmac_f32_16x16x64_bf16 v[56:59],v[20:23],a[80:87],v1
s_waitcnt vmcnt(5)
v_max3_u32 v124,v24,v25,v26
v_smfmac_f32_16x16x64_bf16 v[60:63],v[20:23],a[88:95],v1
v_max_u32 v124,v124,v27
v_smfmac_f32_16x16x64_bf16 v[64:67],v[20:23],a[96:103],v1
v_cmp_eq_u32 vcc,-1,v124
v_smfmac_f32_16x16x64_bf16 v[68:71],v[20:23],a[104:111],v1
v_smfmac_f32_16x16x64_bf16 v[72:75],v[20:23],a[112:119],v1
s_cbranch_vccnz fl_100469
seg_100453:
v_smfmac_f32_16x16x64_bf16 v[76:79],v[20:23],a[120:127],v1
segb_100461:
v_smfmac_f32_16x16x64_bf16 v[48:51],v[24:27],a[128:135],v1
buffer_load_dword v125,off,s[20:23],s92 sc1
v_smfmac_f32_16x16x64_bf16 v[52:55],v[24:27],a[136:143],v1
buffer_load_dwordx4 v[40:43],v0,s[20:23],s93 offen offset:2048 sc1
v_smfmac_f32_16x16x64_bf16 v[56:59],v[24:27],a[144:151],v1
buffer_load_dwordx4 v[44:47],v0,s[20:23],s93 offen offset:3072 sc1
s_waitcnt vmcnt(7)
v_max3_u32 v124,v28,v29,v30
v_smfmac_f32_16x16x64_bf16 v[60:63],v[24:27],a[152:159],v1
v_max_u32 v124,v124,v31
v_smfmac_f32_16x16x64_bf16 v[64:67],v[24:27],a[160:167],v1
v_cmp_eq_u32 vcc,-1,v124
v_smfmac_f32_16x16x64_bf16 v[68:71],v[24:27],a[168:175],v1
v_smfmac_f32_16x16x64_bf16 v[72:75],v[24:27],a[176:183],v1
s_cbranch_vccnz fl_100470
seg_100454:
v_smfmac_f32_16x16x64_bf16 v[76:79],v[24:27],a[184:191],v1
segb_100462:
v_smfmac_f32_16x16x64_bf16 v[48:51],v[28:31],a[192:199],v1
buffer_load_dword v125,off,s[20:23],s92 sc1
v_smfmac_f32_16x16x64_bf16 v[52:55],v[28:31],a[200:207],v1
buffer_store_dword v126,v121,s[20:23],s69 offen sc1
v_smfmac_f32_16x16x64_bf16 v[56:59],v[28:31],a[208:215],v1
s_waitcnt vmcnt(7)
v_max3_u32 v124,v32,v33,v34
v_smfmac_f32_16x16x64_bf16 v[60:63],v[28:31],a[216:223],v1
v_max_u32 v124,v124,v35
v_smfmac_f32_16x16x64_bf16 v[64:67],v[28:31],a[224:231],v1
v_cmp_eq_u32 vcc,-1,v124
v_smfmac_f32_16x16x64_bf16 v[68:71],v[28:31],a[232:239],v1
v_smfmac_f32_16x16x64_bf16 v[72:75],v[28:31],a[240:247],v1
s_cbranch_vccnz fl_100471
seg_100455:
v_smfmac_f32_16x16x64_bf16 v[76:79],v[28:31],a[248:255],v1
segb_100463:
v_smfmac_f32_16x16x64_bf16 v[48:51],v[32:35],a[0:7],v1
buffer_load_dword v125,off,s[20:23],s92 sc1
v_smfmac_f32_16x16x64_bf16 v[52:55],v[32:35],a[8:15],v1
v_smfmac_f32_16x16x64_bf16 v[56:59],v[32:35],a[16:23],v1
s_waitcnt vmcnt(6)
v_max3_u32 v124,v36,v37,v38
v_smfmac_f32_16x16x64_bf16 v[60:63],v[32:35],a[24:31],v1
v_max_u32 v124,v124,v39
v_smfmac_f32_16x16x64_bf16 v[64:67],v[32:35],a[32:39],v1
v_cmp_eq_u32 vcc,-1,v124
v_smfmac_f32_16x16x64_bf16 v[68:71],v[32:35],a[40:47],v1
v_smfmac_f32_16x16x64_bf16 v[72:75],v[32:35],a[48:55],v1
s_cbranch_vccnz fl_100472
seg_100456:
v_smfmac_f32_16x16x64_bf16 v[76:79],v[32:35],a[56:63],v1
segb_100464:
v_smfmac_f32_16x16x64_bf16 v[48:51],v[36:39],a[64:71],v1
buffer_load_dword v125,off,s[20:23],s92 sc1
s_waitcnt vmcnt(4)
v_max3_u32 v124,v40,v41,v42
v_smfmac_f32_16x16x64_bf16 v[52:55],v[36:39],a[72:79],v1
v_max3_u32 v124,v124,v43,v44
v_smfmac_f32_16x16x64_bf16 v[56:59],v[36:39],a[80:87],v1
v_max3_u32 v124,v124,v45,v46
v_smfmac_f32_16x16x64_bf16 v[60:63],v[36:39],a[88:95],v1
v_max_u32 v124,v124,v47
v_smfmac_f32_16x16x64_bf16 v[64:67],v[36:39],a[96:103],v1
v_cmp_eq_u32 vcc,-1,v124
v_smfmac_f32_16x16x64_bf16 v[68:71],v[36:39],a[104:111],v1
v_smfmac_f32_16x16x64_bf16 v[72:75],v[36:39],a[112:119],v1
s_cbranch_vccnz fl_100473
seg_100457:
v_smfmac_f32_16x16x64_bf16 v[76:79],v[36:39],a[120:127],v1
segb_100465:
v_smfmac_f32_16x16x64_bf16 v[48:51],v[40:43],a[128:135],v1
s_cmp_lg_u32 s61,0
s_cbranch_scc1 pq_100447
pk_100448:
buffer_load_dwordx4 v[104:107],v0,s[20:23],s99 offen
v_smfmac_f32_16x16x64_bf16 v[52:55],v[40:43],a[136:143],v1
buffer_load_dwordx4 v[108:111],v0,s[20:23],s99 offen offset:1024
s_add_u32 s64,s79,2
v_smfmac_f32_16x16x64_bf16 v[48:51],v[44:47],a[192:199],v1
s_and_b32 s64,s64,3
s_lshl_b32 s100,s64,19
v_smfmac_f32_16x16x64_bf16 v[52:55],v[44:47],a[200:207],v1
s_mov_b32 s61,s63
s_nop 1
v_add_f32 v48,v48,v49
v_smfmac_f32_16x16x64_bf16 v[56:59],v[40:43],a[144:151],v1
ds_write_addtid_b32 v48 offset:0
v_add_f32 v50,v50,v51
v_smfmac_f32_16x16x64_bf16 v[60:63],v[40:43],a[152:159],v1
ds_write_addtid_b32 v50 offset:1040
v_add_f32 v52,v52,v53
v_smfmac_f32_16x16x64_bf16 v[56:59],v[44:47],a[208:215],v1
ds_write_addtid_b32 v52 offset:2080
v_add_f32 v54,v54,v55
v_smfmac_f32_16x16x64_bf16 v[60:63],v[44:47],a[216:223],v1
ds_write_addtid_b32 v54 offset:3120
s_nop 1
v_add_f32 v56,v56,v57
v_smfmac_f32_16x16x64_bf16 v[64:67],v[40:43],a[160:167],v1
ds_write_addtid_b32 v56 offset:4160
v_add_f32 v58,v58,v59
v_smfmac_f32_16x16x64_bf16 v[68:71],v[40:43],a[168:175],v1
ds_write_addtid_b32 v58 offset:5200
v_add_f32 v60,v60,v61
v_smfmac_f32_16x16x64_bf16 v[64:67],v[44:47],a[224:231],v1
ds_write_addtid_b32 v60 offset:6240
v_add_f32 v62,v62,v63
v_smfmac_f32_16x16x64_bf16 v[68:71],v[44:47],a[232:239],v1
ds_write_addtid_b32 v62 offset:7280
s_nop 1
v_add_f32 v64,v64,v65
v_smfmac_f32_16x16x64_bf16 v[72:75],v[40:43],a[176:183],v1
ds_write_addtid_b32 v64 offset:8448
v_add_f32 v66,v66,v67
v_smfmac_f32_16x16x64_bf16 v[76:79],v[40:43],a[184:191],v1
ds_write_addtid_b32 v66 offset:9488
v_add_f32 v68,v68,v69
v_smfmac_f32_16x16x64_bf16 v[72:75],v[44:47],a[240:247],v1
ds_write_addtid_b32 v68 offset:10528
v_add_f32 v70,v70,v71
v_smfmac_f32_16x16x64_bf16 v[76:79],v[44:47],a[248:255],v1
ds_write_addtid_b32 v70 offset:11568
s_nop 1
v_add_f32 v72,v72,v73
v_smfmac_f32_16x16x64_bf16 v[80:83],v[16:19],v[208:215],v1
ds_write_addtid_b32 v72 offset:12608
v_add_f32 v74,v74,v75
v_smfmac_f32_16x16x64_bf16 v[80:83],v[32:35],v[208:215],v1
ds_write_addtid_b32 v74 offset:13648
v_add_f32 v76,v76,v77
ds_write_addtid_b32 v76 offset:14688
v_add_f32 v78,v78,v79
ds_write_addtid_b32 v78 offset:15728
doneA_100484:
s_waitcnt lgkmcnt(0)
s_barrier
s_cmp_gt_u32 s50,1
s_cbranch_scc1 w23_100485
v_smfmac_f32_16x16x64_bf16 v[84:87],v[16:19],v[216:223],v1
v_smfmac_f32_16x16x64_bf16 v[84:87],v[32:35],v[216:223],v1
v_smfmac_f32_16x16x64_bf16 v[88:91],v[16:19],v[224:231],v1
v_smfmac_f32_16x16x64_bf16 v[88:91],v[32:35],v[224:231],v1
v_smfmac_f32_16x16x64_bf16 v[92:95],v[16:19],v[232:239],v1
ds_read_b128 v[48:51],v7 offset:0
ds_read_b128 v[52:55],v7 offset:1024
v_smfmac_f32_16x16x64_bf16 v[92:95],v[32:35],v[232:239],v1
ds_read_b128 v[56:59],v7 offset:2048
ds_read_b128 v[60:63],v7 offset:3072
v_smfmac_f32_16x16x64_bf16 v[80:83],v[20:23],v[240:247],v1
ds_read_b128 v[64:67],v7 offset:4096
ds_read_b128 v[68:71],v7 offset:5120
v_smfmac_f32_16x16x64_bf16 v[80:83],v[36:39],v[240:247],v1
ds_read_b128 v[72:75],v7 offset:6144
ds_read_b128 v[76:79],v7 offset:7168
v_smfmac_f32_16x16x64_bf16 v[84:87],v[20:23],v[248:255],v1
v_smfmac_f32_16x16x64_bf16 v[84:87],v[36:39],v[248:255],v1
s_waitcnt lgkmcnt(6)
v_smfmac_f32_16x16x64_bf16 v[88:91],v[20:23],v[48:55],v1
v_smfmac_f32_16x16x64_bf16 v[88:91],v[36:39],v[48:55],v1
ds_read_b128 v[48:51],v7 offset:8192
ds_read_b128 v[52:55],v7 offset:9216
s_waitcnt lgkmcnt(6)
v_smfmac_f32_16x16x64_bf16 v[92:95],v[20:23],v[56:63],v1
v_smfmac_f32_16x16x64_bf16 v[92:95],v[36:39],v[56:63],v1
ds_read_b128 v[56:59],v7 offset:10240
ds_read_b128 v[60:63],v7 offset:11264
s_waitcnt lgkmcnt(6)
v_smfmac_f32_16x16x64_bf16 v[80:83],v[24:27],v[64:71],v1
v_smfmac_f32_16x16x64_bf16 v[80:83],v[40:43],v[64:71],v1
ds_read_b128 v[64:67],v7 offset:12288
ds_read_b128 v[68:71],v7 offset:13312
s_waitcnt lgkmcnt(6)
v_smfmac_f32_16x16x64_bf16 v[84:87],v[24:27],v[72:79],v1
v_smfmac_f32_16x16x64_bf16 v[84:87],v[40:43],v[72:79],v1
ds_read_b128 v[72:75],v7 offset:14336
ds_read_b128 v[76:79],v7 offset:15360
s_waitcnt lgkmcnt(6)
v_smfmac_f32_16x16x64_bf16 v[88:91],v[24:27],v[48:55],v1
v_smfmac_f32_16x16x64_bf16 v[88:91],v[40:43],v[48:55],v1
ds_read_b128 v[48:51],v7 offset:16384
ds_read_b128 v[52:55],v7 offset:17408
s_waitcnt lgkmcnt(6)
v_smfmac_f32_16x16x64_bf16 v[92:95],v[24:27],v[56:63],v1
v_smfmac_f32_16x16x64_bf16 v[92:95],v[40:43],v[56:63],v1
ds_read_b128 v[56:59],v7 offset:18432
ds_read_b128 v[60:63],v7 offset:19456
s_waitcnt lgkmcnt(6)
v_smfmac_f32_16x16x64_bf16 v[80:83],v[28:31],v[64:71],v1
v_smfmac_f32_16x16x64_bf16 v[80:83],v[44:47],v[64:71],v1
s_waitcnt lgkmcnt(4)
v_smfmac_f32_16x16x64_bf16 v[84:87],v[28:31],v[72:79],v1
v_smfmac_f32_16x16x64_bf16 v[84:87],v[44:47],v[72:79],v1
s_waitcnt lgkmcnt(2)
v_smfmac_f32_16x16x64_bf16 v[88:91],v[28:31],v[48:55],v1
v_add_f32 v80,v80,v81
v_smfmac_f32_16x16x64_bf16 v[88:91],v[44:47],v[48:55],v1
v_add_f32 v82,v82,v83
s_waitcnt lgkmcnt(0)
v_smfmac_f32_16x16x64_bf16 v[92:95],v[28:31],v[56:63],v1
v_cvt_pk_bf16_f32 v80,v80,v82
v_smfmac_f32_16x16x64_bf16 v[92:95],v[44:47],v[56:63],v1
buffer_load_dwordx4 v[16:19],v2,s[20:23],s94 offen offset:0 sc1
ds_write_addtid_b32 v80 offset:16896
v_add_f32 v84,v84,v85
buffer_load_dwordx4 v[32:35],v2,s[20:23],s94 offen offset:1536 sc1
buffer_load_dwordx4 v[20:23],v2,s[20:23],s95 offen offset:0 sc1
buffer_load_dwordx4 v[36:39],v2,s[20:23],s95 offen offset:1536 sc1
buffer_load_dword v120,v3,s[20:23],s94 offen offset:0 sc1
buffer_load_dword v121,v3,s[20:23],s94 offen offset:1536 sc1
buffer_load_dword v122,v3,s[20:23],s95 offen offset:0 sc1
buffer_load_dword v123,v3,s[20:23],s95 offen offset:1536 sc1
v_add_f32 v86,v86,v87
v_cvt_pk_bf16_f32 v84,v84,v86
v_add_f32 v88,v88,v89
v_add_f32 v90,v90,v91
v_cvt_pk_bf16_f32 v88,v88,v90
v_add_f32 v92,v92,v93
v_add_f32 v94,v94,v95
v_cvt_pk_bf16_f32 v92,v92,v94
ds_write_addtid_b32 v84 offset:17920
ds_write_addtid_b32 v88 offset:18944
ds_write_addtid_b32 v92 offset:19968
.p2align 5
s_nop 0
s_nop 0
s_nop 0
s_nop 0
s_nop 0
sp_100489:
s_waitcnt vmcnt(6)
v_pk_add_f32 v[16:17],v[16:17],v[32:33]
v_pk_add_f32 v[18:19],v[18:19],v[34:35]
s_waitcnt vmcnt(4)
v_pk_add_f32 v[20:21],v[20:21],v[36:37]
v_pk_add_f32 v[22:23],v[22:23],v[38:39]
v_pk_add_f32 v[16:17],v[16:17],v[20:21]
v_pk_add_f32 v[18:19],v[18:19],v[22:23]
v_max3_f32 v124,v16,v17,v18
v_pk_add_f32 v[20:21],v[16:17],v[18:19]
s_waitcnt vmcnt(0)
v_pk_add_f32 v[120:121],v[120:121],v[122:123]
v_add_f32 v120,v120,v121
v_max3_f32 v124,v124,v19,v120
v_add_f32 v20,v20,v120
v_cmp_u_f32 vcc,v20,v21
v_max_f32_dpp v124,v124,v124 row_ror:8 row_mask:0xf bank_mask:0xf
v_mov_b32 v125,v124
s_cbranch_vccnz srt_100491
sok_100490:
s_nop 0
v_permlane16_swap_b32 v125,v124
v_max_f32 v124,v124,v125
v_mov_b32 v125,v124
s_nop 1
v_permlane32_swap_b32 v125,v124
v_max_f32 v124,v124,v125
v_mul_f32 v124,s80,v124
v_fma_f32 v16,v16,s80,-v124
v_fma_f32 v17,v17,s80,-v124
v_fma_f32 v18,v18,s80,-v124
v_fma_f32 v19,v19,s80,-v124
v_fma_f32 v120,v120,s80,-v124
s_waitcnt lgkmcnt(0)
s_barrier
ds_read2st64_b32 v[112:113],v127 offset0:66 offset1:67
ds_read2st64_b32 v[114:115],v127 offset0:68 offset1:69
ds_read2st64_b32 v[116:117],v127 offset0:70 offset1:71
ds_read2st64_b32 v[118:119],v127 offset0:72 offset1:73
v_exp_f32 v16,v16
v_exp_f32 v17,v17
v_exp_f32 v18,v18
v_exp_f32 v19,v19
v_cvt_pk_bf16_f32 v48,v16,v17
v_cvt_pk_bf16_f32 v49,v18,v19
v_exp_f32 v120,v120
v_mov_b32_dpp v50,v48 row_ror:8 row_mask:0xf bank_mask:0xf
v_mov_b32_dpp v51,v49 row_ror:8 row_mask:0xf bank_mask:0xf
v_mov_b32_dpp v121,v120 row_ror:8 row_mask:0xf bank_mask:0xf
v_cvt_pk_bf16_f32 v52,v120,v121
v_mfma_f32_16x16x32_bf16 v[64:67],v[8:11],v[48:51],0
v_mov_b32 v53,v52
v_mfma_f32_16x16x32_bf16 v[56:59],v[96:99],v[48:51],0
v_mov_b32 v54,v52
v_mov_b32 v55,v52
v_mfma_f32_16x16x32_bf16 v[60:63],v[100:103],v[48:51],0
v_mfma_f32_16x16x32_bf16 v[64:67],v[12:15],v[52:55],v[64:67]
s_waitcnt lgkmcnt(0)
v_mfma_f32_16x16x32_bf16 v[56:59],v[112:115],v[52:55],v[56:59]
v_mfma_f32_16x16x32_bf16 v[60:63],v[116:119],v[52:55],v[60:63]
s_nop 0
v_rcp_f32 v66,v64
s_nop 2
v_pk_mul_f32 v[56:57],v[56:57],v[66:67] op_sel_hi:[1,0]
v_pk_mul_f32 v[58:59],v[58:59],v[66:67] op_sel_hi:[1,0]
s_nop 0
v_pk_mul_f32 v[60:61],v[60:61],v[66:67] op_sel_hi:[1,0]
v_pk_mul_f32 v[62:63],v[62:63],v[66:67] op_sel_hi:[1,0]
v_cvt_pk_bf16_f32 v120,v56,v57
v_cvt_pk_bf16_f32 v121,v58,v59
v_cvt_pk_bf16_f32 v122,v60,v61
v_cvt_pk_bf16_f32 v123,v62,v63
buffer_store_dwordx4 v[120:123],v6,s[20:23],s98 offen
s_barrier
ds_read_b128 v[48:51],v7 offset:20480
ds_read_b128 v[52:55],v7 offset:21504
ds_read_b128 v[56:59],v7 offset:22528
ds_read_b128 v[60:63],v7 offset:23552
ds_read_b128 v[64:67],v7 offset:24576
ds_read_b128 v[68:71],v7 offset:25600
ds_read_b128 v[72:75],v7 offset:26624
ds_read_b128 v[76:79],v7 offset:27648
ds_read_b128 v[80:83],v7 offset:28672
ds_read_b128 v[84:87],v7 offset:29696
ds_read_b128 v[88:91],v7 offset:30720
ds_read_b128 v[92:95],v7 offset:31744
v_mov_b32 v96,0
v_mov_b32 v97,0
v_mov_b32 v98,0
v_mov_b32 v99,0
v_mov_b32 v100,0
v_mov_b32 v101,0
v_mov_b32 v102,0
v_mov_b32 v103,0
s_nop 11
buffer_load_dwordx4 v[16:19],v0,s[20:23],s96 offen offset:0 sc1
v_mov_b32 v120,v5
v_mov_b32 v121,v5
v_mov_b32 v122,v5
v_mov_b32 v123,v5
s_nop 1
v_mfma_f32_16x16x32_bf16 v[112:115],v[120:123],v[112:115],0
buffer_load_dwordx4 v[20:23],v0,s[20:23],s96 offen offset:1024 sc1
v_mfma_f32_16x16x32_bf16 v[116:119],v[120:123],v[116:119],0
s_add_u32 s79,s79,1
s_and_b32 s64,s79,3
s_lshl_b32 s64,s64,19
s_lshl_b32 s65,s79,8
buffer_load_dwordx4 v[24:27],v0,s[20:23],s96 offen offset:2048 sc1
s_and_b32 s65,s65,0x2000
s_lshl_b32 s66,s79,16
s_xor_b32 s88,s73,s65
s_add_u32 s88,s88,s66
s_sub_u32 s88,s88,s54
s_add_u32 s89,s71,s64
s_add_u32 s92,s70,s64
s_xor_b32 s93,s72,s65
buffer_load_dwordx4 v[28:31],v0,s[20:23],s96 offen offset:3072 sc1
s_add_u32 s93,s93,s66
s_add_u32 s94,s76,s64
s_add_u32 s95,s94,4096
s_add_u32 s98,s75,s64
s_add_u32 s60,s74,s64
v_cvt_pk_bf16_f32 v112,v112,v113
v_cvt_pk_bf16_f32 v113,v114,v115
v_cvt_pk_bf16_f32 v114,v116,v117
buffer_load_dwordx4 v[32:35],v0,s[20:23],s97 offen offset:0 sc1
v_cvt_pk_bf16_f32 v115,v118,v119
s_nop 6
buffer_load_dwordx4 v[36:39],v0,s[20:23],s97 offen offset:1024 sc1
s_nop 7
buffer_load_dwordx4 v[40:43],v0,s[20:23],s97 offen offset:2048 sc1
s_nop 7
buffer_load_dwordx4 v[44:47],v0,s[20:23],s97 offen offset:3072 sc1
s_branch ogo_100486
.p2align 5
s_nop 0
s_nop 0
s_nop 0
s_nop 0
w23_100485:
ds_read_b128 v[48:51],v2 offset:0
ds_read_b128 v[52:55],v2 offset:256
ds_read_b128 v[56:59],v2 offset:512
ds_read_b128 v[60:63],v2 offset:768
ds_read_b128 v[64:67],v2 offset:16
ds_read_b128 v[68:71],v2 offset:272
ds_read_b128 v[72:75],v2 offset:528
ds_read_b128 v[76:79],v2 offset:784
s_waitcnt lgkmcnt(6)
v_pk_add_f32 v[48:49],v[48:49],v[52:53]
v_pk_add_f32 v[50:51],v[50:51],v[54:55]
s_waitcnt lgkmcnt(4)
v_pk_add_f32 v[56:57],v[56:57],v[60:61]
v_pk_add_f32 v[58:59],v[58:59],v[62:63]
v_pk_add_f32 v[48:49],v[48:49],v[56:57]
v_pk_add_f32 v[50:51],v[50:51],v[58:59]
v_cvt_pk_bf16_f32 v112,v48,v49
v_cvt_pk_bf16_f32 v113,v50,v51
s_waitcnt lgkmcnt(2)
v_pk_add_f32 v[64:65],v[64:65],v[68:69]
v_pk_add_f32 v[66:67],v[66:67],v[70:71]
s_waitcnt lgkmcnt(0)
v_pk_add_f32 v[72:73],v[72:73],v[76:77]
v_pk_add_f32 v[74:75],v[74:75],v[78:79]
v_pk_add_f32 v[64:65],v[64:65],v[72:73]
v_pk_add_f32 v[66:67],v[66:67],v[74:75]
v_cvt_pk_bf16_f32 v114,v64,v65
v_cvt_pk_bf16_f32 v115,v66,v67
s_nop 1
v_mfma_f32_16x16x32_bf16 v[116:119],v[96:99],v[112:115],0
v_mfma_f32_16x16x32_bf16 v[120:123],v[100:103],v[112:115],0
v_mfma_f32_16x16x32_bf16 v[12:15],v[112:115],v[112:115],0
ds_read_b128 v[48:51],v7 offset:0
ds_read_b128 v[52:55],v7 offset:1024
ds_read_b128 v[56:59],v7 offset:2048
ds_read_b128 v[60:63],v7 offset:3072
ds_read_b128 v[64:67],v7 offset:4096
buffer_store_dwordx4 v[116:119],v3,s[20:23],s94 offen
buffer_store_dwordx4 v[120:123],v3,s[20:23],s94 offen offset:512
s_nop 0
buffer_store_dwordx4 v[12:15],v3,s[20:23],s94 offen offset:1024
ds_read_b128 v[68:71],v7 offset:5120
ds_read_b128 v[72:75],v7 offset:6144
ds_read_b128 v[76:79],v7 offset:7168
v_smfmac_f32_16x16x64_bf16 v[84:87],v[16:19],v[216:223],v1
v_smfmac_f32_16x16x64_bf16 v[84:87],v[32:35],v[216:223],v1
v_smfmac_f32_16x16x64_bf16 v[88:91],v[16:19],v[224:231],v1
v_smfmac_f32_16x16x64_bf16 v[88:91],v[32:35],v[224:231],v1
v_smfmac_f32_16x16x64_bf16 v[92:95],v[16:19],v[232:239],v1
v_smfmac_f32_16x16x64_bf16 v[92:95],v[32:35],v[232:239],v1
v_smfmac_f32_16x16x64_bf16 v[80:83],v[20:23],v[240:247],v1
v_smfmac_f32_16x16x64_bf16 v[80:83],v[36:39],v[240:247],v1
v_smfmac_f32_16x16x64_bf16 v[84:87],v[20:23],v[248:255],v1
v_smfmac_f32_16x16x64_bf16 v[84:87],v[36:39],v[248:255],v1
s_waitcnt lgkmcnt(6)
v_smfmac_f32_16x16x64_bf16 v[88:91],v[20:23],v[48:55],v1
v_smfmac_f32_16x16x64_bf16 v[88:91],v[36:39],v[48:55],v1
ds_read_b128 v[48:51],v7 offset:8192
ds_read_b128 v[52:55],v7 offset:9216
s_waitcnt lgkmcnt(6)
v_smfmac_f32_16x16x64_bf16 v[92:95],v[20:23],v[56:63],v1
v_smfmac_f32_16x16x64_bf16 v[92:95],v[36:39],v[56:63],v1
ds_read_b128 v[56:59],v7 offset:10240
ds_read_b128 v[60:63],v7 offset:11264
s_waitcnt lgkmcnt(6)
v_smfmac_f32_16x16x64_bf16 v[80:83],v[24:27],v[64:71],v1
v_smfmac_f32_16x16x64_bf16 v[80:83],v[40:43],v[64:71],v1
ds_read_b128 v[64:67],v7 offset:12288
ds_read_b128 v[68:71],v7 offset:13312
s_waitcnt lgkmcnt(6)
v_smfmac_f32_16x16x64_bf16 v[84:87],v[24:27],v[72:79],v1
v_smfmac_f32_16x16x64_bf16 v[84:87],v[40:43],v[72:79],v1
ds_read_b128 v[72:75],v7 offset:14336
ds_read_b128 v[76:79],v7 offset:15360
s_waitcnt lgkmcnt(6)
v_smfmac_f32_16x16x64_bf16 v[88:91],v[24:27],v[48:55],v1
v_smfmac_f32_16x16x64_bf16 v[88:91],v[40:43],v[48:55],v1
ds_read_b128 v[48:51],v7 offset:16384
ds_read_b128 v[52:55],v7 offset:17408
s_waitcnt lgkmcnt(6)
v_smfmac_f32_16x16x64_bf16 v[92:95],v[24:27],v[56:63],v1
v_smfmac_f32_16x16x64_bf16 v[92:95],v[40:43],v[56:63],v1
ds_read_b128 v[56:59],v7 offset:18432
ds_read_b128 v[60:63],v7 offset:19456
s_waitcnt lgkmcnt(6)
v_smfmac_f32_16x16x64_bf16 v[80:83],v[28:31],v[64:71],v1
v_smfmac_f32_16x16x64_bf16 v[80:83],v[44:47],v[64:71],v1
s_waitcnt lgkmcnt(4)
v_smfmac_f32_16x16x64_bf16 v[84:87],v[28:31],v[72:79],v1
v_smfmac_f32_16x16x64_bf16 v[84:87],v[44:47],v[72:79],v1
s_waitcnt lgkmcnt(2)
v_smfmac_f32_16x16x64_bf16 v[88:91],v[28:31],v[48:55],v1
v_add_f32 v80,v80,v81
v_smfmac_f32_16x16x64_bf16 v[88:91],v[44:47],v[48:55],v1
v_add_f32 v82,v82,v83
s_waitcnt lgkmcnt(0)
v_smfmac_f32_16x16x64_bf16 v[92:95],v[28:31],v[56:63],v1
v_cvt_pk_bf16_f32 v80,v80,v82
v_smfmac_f32_16x16x64_bf16 v[92:95],v[44:47],v[56:63],v1
ds_write_addtid_b32 v80 offset:16896
v_add_f32 v84,v84,v85
v_add_f32 v86,v86,v87
v_cvt_pk_bf16_f32 v84,v84,v86
v_add_f32 v88,v88,v89
v_add_f32 v90,v90,v91
v_cvt_pk_bf16_f32 v88,v88,v90
s_nop 0
v_add_f32 v92,v92,v93
v_add_f32 v94,v94,v95
v_cvt_pk_bf16_f32 v92,v92,v94
ds_write_addtid_b32 v84 offset:17920
ds_write_addtid_b32 v88 offset:18944
ds_write_addtid_b32 v92 offset:19968
s_waitcnt lgkmcnt(0)
s_barrier
ds_read_b128 v[48:51],v7 offset:20480
ds_read_b128 v[52:55],v7 offset:21504
ds_read_b128 v[56:59],v7 offset:22528
ds_read_b128 v[60:63],v7 offset:23552
ds_read_b128 v[64:67],v7 offset:24576
ds_read_b128 v[68:71],v7 offset:25600
ds_read_b128 v[72:75],v7 offset:26624
ds_read_b128 v[76:79],v7 offset:27648
ds_read_b128 v[80:83],v7 offset:28672
ds_read_b128 v[84:87],v7 offset:29696
ds_read_b128 v[88:91],v7 offset:30720
ds_read_b128 v[92:95],v7 offset:31744
s_add_u32 s65,s76,s100
s_add_u32 s66,s75,s100
s_add_u32 s64,s71,s100
s_cmp_eq_u32 s50,2
s_cselect_b32 s66,s66,s64
buffer_store_dwordx4 v[8:11],v0,s[20:23],s65 offen
s_cmp_eq_u32 s50,2
s_cselect_b32 exec_hi,-1,0
buffer_store_dwordx4 v[8:11],v0,s[20:23],s66 offen
s_mov_b32 exec_hi,0
buffer_store_dwordx4 v[8:11],v0,s[20:23],s65 offen offset:1024
s_mov_b64 exec,-1
v_mov_b32 v96,0
v_mov_b32 v97,0
v_mov_b32 v98,0
v_mov_b32 v99,0
v_mov_b32 v100,0
v_mov_b32 v101,0
v_mov_b32 v102,0
v_mov_b32 v103,0
s_barrier
s_nop 15
s_nop 15
s_nop 7
buffer_load_dwordx4 v[16:19],v0,s[20:23],s96 offen offset:0 sc1
s_add_u32 s79,s79,1
s_and_b32 s64,s79,3
s_lshl_b32 s64,s64,19
s_lshl_b32 s65,s79,8
s_and_b32 s65,s65,0x2000
s_lshl_b32 s66,s79,16
s_xor_b32 s88,s73,s65
s_add_u32 s88,s88,s66
buffer_load_dwordx4 v[20:23],v0,s[20:23],s96 offen offset:1024 sc1
s_sub_u32 s88,s88,s54
s_add_u32 s89,s71,s64
s_add_u32 s92,s70,s64
s_xor_b32 s93,s72,s65
s_add_u32 s93,s93,s66
s_add_u32 s94,s76,s64
s_add_u32 s95,s94,4096
s_add_u32 s98,s75,s64
buffer_load_dwordx4 v[24:27],v0,s[20:23],s96 offen offset:2048 sc1
s_add_u32 s60,s74,s64
s_nop 6
buffer_load_dwordx4 v[28:31],v0,s[20:23],s96 offen offset:3072 sc1
s_nop 7
buffer_load_dwordx4 v[32:35],v0,s[20:23],s97 offen offset:0 sc1
s_nop 7
buffer_load_dwordx4 v[36:39],v0,s[20:23],s97 offen offset:1024 sc1
s_nop 7
buffer_load_dwordx4 v[40:43],v0,s[20:23],s97 offen offset:2048 sc1
s_nop 7
buffer_load_dwordx4 v[44:47],v0,s[20:23],s97 offen offset:3072 sc1
.p2align 5
s_nop 0
s_nop 0
s_nop 0
s_nop 0
ogo_100486:
s_waitcnt lgkmcnt(0)
s_waitcnt vmcnt(6)
v_max3_u32 v124,v16,v17,v18
v_max3_u32 v124,v124,v19,v20
v_max3_u32 v124,v124,v21,v22
v_max_u32 v124,v124,v23
v_cmp_eq_u32 vcc,-1,v124
s_cbranch_vccnz of_100492
v_smfmac_f32_16x16x64_bf16 v[96:99],v[16:19],v[48:55],v1
v_smfmac_f32_16x16x64_bf16 v[100:103],v[16:19],v[56:63],v1
v_smfmac_f32_16x16x64_bf16 v[96:99],v[20:23],v[64:71],v1
v_smfmac_f32_16x16x64_bf16 v[100:103],v[20:23],v[72:79],v1
s_waitcnt vmcnt(4)
v_max3_u32 v124,v24,v25,v26
v_max3_u32 v124,v124,v27,v28
v_max3_u32 v124,v124,v29,v30
v_max_u32 v124,v124,v31
v_cmp_eq_u32 vcc,-1,v124
s_cbranch_vccnz of_100493
v_smfmac_f32_16x16x64_bf16 v[96:99],v[24:27],v[80:87],v1
v_smfmac_f32_16x16x64_bf16 v[100:103],v[24:27],v[88:95],v1
v_smfmac_f32_16x16x64_bf16 v[96:99],v[28:31],v[128:135],v1
v_smfmac_f32_16x16x64_bf16 v[100:103],v[28:31],v[136:143],v1
s_waitcnt vmcnt(2)
v_max3_u32 v124,v32,v33,v34
v_max3_u32 v124,v124,v35,v36
v_max3_u32 v124,v124,v37,v38
v_max_u32 v124,v124,v39
v_cmp_eq_u32 vcc,-1,v124
s_cbranch_vccnz of_100494
v_smfmac_f32_16x16x64_bf16 v[96:99],v[32:35],v[144:151],v1
v_smfmac_f32_16x16x64_bf16 v[100:103],v[32:35],v[152:159],v1
v_smfmac_f32_16x16x64_bf16 v[96:99],v[36:39],v[160:167],v1
v_smfmac_f32_16x16x64_bf16 v[100:103],v[36:39],v[168:175],v1
s_waitcnt vmcnt(1)
v_max3_u32 v124,v40,v41,v42
v_max_u32 v124,v124,v43
v_cmp_eq_u32 vcc,-1,v124
s_cbranch_vccnz of_100495
v_smfmac_f32_16x16x64_bf16 v[96:99],v[40:43],v[176:183],v1
v_smfmac_f32_16x16x64_bf16 v[100:103],v[40:43],v[184:191],v1
s_waitcnt vmcnt(0)
v_max3_u32 v124,v44,v45,v46
v_max_u32 v124,v124,v47
v_cmp_eq_u32 vcc,-1,v124
s_cbranch_vccnz of_100496
v_smfmac_f32_16x16x64_bf16 v[96:99],v[44:47],v[192:199],v1
v_smfmac_f32_16x16x64_bf16 v[100:103],v[44:47],v[200:207],v1
oback_100503:
buffer_load_dword v119,off,s[20:23],s68 sc1
s_nop 3
v_add_f32 v96,v96,v97
v_add_f32 v98,v98,v99
s_nop 0
v_add_f32 v100,v100,v101
v_add_f32 v102,v102,v103
ds_write_addtid_b32 v96 offset:20992
ds_write_addtid_b32 v98 offset:23072
ds_write_addtid_b32 v100 offset:22016
ds_write_addtid_b32 v102 offset:24096
s_mov_b32 s96,s60
s_add_u32 s97,s60,4096
s_cmp_gt_u32 s50,1
s_waitcnt lgkmcnt(0)
s_barrier
s_cbranch_scc1 loop_100439
ds_read2st64_b32 v[48:49],v4 offset0:82 offset1:86
ds_read2st64_b32 v[50:51],v4 offset0:83 offset1:87
ds_read2st64_b32 v[52:53],v4 offset0:84 offset1:88
ds_read2st64_b32 v[54:55],v4 offset0:85 offset1:89
v_mov_b32 v96,v104
v_mov_b32 v97,v105
v_mov_b32 v98,v106
v_mov_b32 v99,v107
v_mov_b32 v100,v108
v_mov_b32 v101,v109
v_mov_b32 v102,v110
v_mov_b32 v103,v111
s_waitcnt lgkmcnt(2)
v_pk_add_f32 v[48:49],v[48:49],v[50:51]
s_waitcnt lgkmcnt(0)
v_pk_add_f32 v[52:53],v[52:53],v[54:55]
v_pk_add_f32 v[48:49],v[48:49],v[52:53]
v_cvt_pk_bf16_f32 v124,v48,v49
buffer_store_dword v124,v127,s[20:23],s89 offen
s_nop 7
buffer_store_dword v124,v127,s[20:23],s88 offen sc1
s_branch loop0_100443x
last_100440:
s_waitcnt vmcnt(3)
v_max3_u32 v124,v16,v17,v18
v_max_u32 v124,v124,v19
v_cmp_eq_u32 vcc,-1,v124
v_cndmask_b32 v121,2.0,v127,s[86:87]
s_cbranch_vccnz flb_100528
seg_100504:
segb_100512:
v_smfmac_f32_16x16x64_bf16 v[64:67],v[16:19],a[32:39],v1
buffer_load_dword v125,off,s[20:23],s92 sc1
buffer_load_dwordx4 v[32:35],v0,s[20:23],s93 offen offset:0 sc1
s_waitcnt vmcnt(4)
v_max3_u32 v124,v20,v21,v22
v_smfmac_f32_16x16x64_bf16 v[68:71],v[16:19],a[40:47],v1
v_max_u32 v124,v124,v23
v_cmp_eq_u32 vcc,-1,v124
v_smfmac_f32_16x16x64_bf16 v[72:75],v[16:19],a[48:55],v1
v_smfmac_f32_16x16x64_bf16 v[76:79],v[16:19],a[56:63],v1
s_cbranch_vccnz fl_100521
seg_100505:
segb_100513:
v_smfmac_f32_16x16x64_bf16 v[64:67],v[20:23],a[96:103],v1
buffer_load_dword v125,off,s[20:23],s92 sc1
buffer_load_dwordx4 v[36:39],v0,s[20:23],s93 offen offset:1024 sc1
s_waitcnt vmcnt(5)
v_max3_u32 v124,v24,v25,v26
v_smfmac_f32_16x16x64_bf16 v[68:71],v[20:23],a[104:111],v1
v_max_u32 v124,v124,v27
v_cmp_eq_u32 vcc,-1,v124
v_smfmac_f32_16x16x64_bf16 v[72:75],v[20:23],a[112:119],v1
v_smfmac_f32_16x16x64_bf16 v[76:79],v[20:23],a[120:127],v1
s_cbranch_vccnz fl_100522
seg_100506:
segb_100514:
v_smfmac_f32_16x16x64_bf16 v[64:67],v[24:27],a[160:167],v1
buffer_load_dword v125,off,s[20:23],s92 sc1
buffer_load_dwordx4 v[40:43],v0,s[20:23],s93 offen offset:2048 sc1
buffer_load_dwordx4 v[44:47],v0,s[20:23],s93 offen offset:3072 sc1
s_waitcnt vmcnt(7)
v_max3_u32 v124,v28,v29,v30
v_smfmac_f32_16x16x64_bf16 v[68:71],v[24:27],a[168:175],v1
v_max_u32 v124,v124,v31
v_cmp_eq_u32 vcc,-1,v124
v_smfmac_f32_16x16x64_bf16 v[72:75],v[24:27],a[176:183],v1
v_smfmac_f32_16x16x64_bf16 v[76:79],v[24:27],a[184:191],v1
s_cbranch_vccnz fl_100523
seg_100507:
segb_100515:
v_smfmac_f32_16x16x64_bf16 v[64:67],v[28:31],a[224:231],v1
buffer_load_dword v125,off,s[20:23],s92 sc1
buffer_store_dword v126,v121,s[20:23],s69 offen sc1
s_waitcnt vmcnt(7)
v_max3_u32 v124,v32,v33,v34
v_smfmac_f32_16x16x64_bf16 v[68:71],v[28:31],a[232:239],v1
v_max_u32 v124,v124,v35
v_cmp_eq_u32 vcc,-1,v124
v_smfmac_f32_16x16x64_bf16 v[72:75],v[28:31],a[240:247],v1
v_smfmac_f32_16x16x64_bf16 v[76:79],v[28:31],a[248:255],v1
s_cbranch_vccnz fl_100524
seg_100508:
segb_100516:
v_smfmac_f32_16x16x64_bf16 v[64:67],v[32:35],a[32:39],v1
buffer_load_dword v125,off,s[20:23],s92 sc1
s_waitcnt vmcnt(6)
v_max3_u32 v124,v36,v37,v38
v_smfmac_f32_16x16x64_bf16 v[68:71],v[32:35],a[40:47],v1
v_max_u32 v124,v124,v39
v_cmp_eq_u32 vcc,-1,v124
v_smfmac_f32_16x16x64_bf16 v[72:75],v[32:35],a[48:55],v1
v_smfmac_f32_16x16x64_bf16 v[76:79],v[32:35],a[56:63],v1
s_cbranch_vccnz fl_100525
seg_100509:
segb_100517:
v_smfmac_f32_16x16x64_bf16 v[64:67],v[36:39],a[96:103],v1
buffer_load_dword v125,off,s[20:23],s92 sc1
s_waitcnt vmcnt(4)
v_max3_u32 v124,v40,v41,v42
v_smfmac_f32_16x16x64_bf16 v[68:71],v[36:39],a[104:111],v1
v_max3_u32 v124,v124,v43,v44
v_max3_u32 v124,v124,v45,v46
v_max_u32 v124,v124,v47
v_cmp_eq_u32 vcc,-1,v124
v_smfmac_f32_16x16x64_bf16 v[72:75],v[36:39],a[112:119],v1
v_smfmac_f32_16x16x64_bf16 v[76:79],v[36:39],a[120:127],v1
s_cbranch_vccnz fl_100526
seg_100510:
segb_100518:
v_smfmac_f32_16x16x64_bf16 v[64:67],v[40:43],a[160:167],v1
v_smfmac_f32_16x16x64_bf16 v[68:71],v[40:43],a[168:175],v1
v_smfmac_f32_16x16x64_bf16 v[64:67],v[44:47],a[224:231],v1
v_smfmac_f32_16x16x64_bf16 v[68:71],v[44:47],a[232:239],v1
v_smfmac_f32_16x16x64_bf16 v[72:75],v[40:43],a[176:183],v1
s_nop 1
v_add_f32 v64,v64,v65
v_smfmac_f32_16x16x64_bf16 v[76:79],v[40:43],a[184:191],v1
ds_write_addtid_b32 v64 offset:8448
v_add_f32 v66,v66,v67
v_smfmac_f32_16x16x64_bf16 v[72:75],v[44:47],a[240:247],v1
ds_write_addtid_b32 v66 offset:9488
v_add_f32 v68,v68,v69
v_smfmac_f32_16x16x64_bf16 v[76:79],v[44:47],a[248:255],v1
ds_write_addtid_b32 v68 offset:10528
v_add_f32 v70,v70,v71
v_smfmac_f32_16x16x64_bf16 v[80:83],v[16:19],v[208:215],v1
ds_write_addtid_b32 v70 offset:11568
v_add_f32 v72,v72,v73
v_smfmac_f32_16x16x64_bf16 v[80:83],v[32:35],v[208:215],v1
ds_write_addtid_b32 v72 offset:12608
v_add_f32 v74,v74,v75
v_smfmac_f32_16x16x64_bf16 v[84:87],v[16:19],v[216:223],v1
ds_write_addtid_b32 v74 offset:13648
v_add_f32 v76,v76,v77
v_smfmac_f32_16x16x64_bf16 v[84:87],v[32:35],v[216:223],v1
ds_write_addtid_b32 v76 offset:14688
v_add_f32 v78,v78,v79
v_smfmac_f32_16x16x64_bf16 v[88:91],v[16:19],v[224:231],v1
ds_write_addtid_b32 v78 offset:15728
v_smfmac_f32_16x16x64_bf16 v[88:91],v[32:35],v[224:231],v1
v_smfmac_f32_16x16x64_bf16 v[92:95],v[16:19],v[232:239],v1
v_smfmac_f32_16x16x64_bf16 v[92:95],v[32:35],v[232:239],v1
doneA_100537:
s_waitcnt vmcnt(0) lgkmcnt(0)
s_add_u32 s64,s79,0
s_lshl_b32 s65,s64,12
s_and_b32 s65,s65,0x2000
s_xor_b32 s65,s65,s67
s_lshl_b32 s64,s64,20
s_add_u32 s65,s65,s64
s_add_u32 s101,s65,s78
v_smfmac_f32_16x16x64_bf16 v[80:83],v[20:23],v[240:247],v1
ds_read_b128 v[48:51],v7 offset:0
ds_read_b128 v[52:55],v7 offset:1024
v_smfmac_f32_16x16x64_bf16 v[80:83],v[36:39],v[240:247],v1
ds_read_b128 v[56:59],v7 offset:2048
ds_read_b128 v[60:63],v7 offset:3072
v_smfmac_f32_16x16x64_bf16 v[84:87],v[20:23],v[248:255],v1
ds_read_b128 v[64:67],v7 offset:4096
ds_read_b128 v[68:71],v7 offset:5120
v_smfmac_f32_16x16x64_bf16 v[84:87],v[36:39],v[248:255],v1
ds_read_b128 v[72:75],v7 offset:6144
ds_read_b128 v[76:79],v7 offset:7168
s_waitcnt lgkmcnt(6)
v_smfmac_f32_16x16x64_bf16 v[88:91],v[20:23],v[48:55],v1
v_smfmac_f32_16x16x64_bf16 v[88:91],v[36:39],v[48:55],v1
ds_read_b128 v[48:51],v7 offset:8192
ds_read_b128 v[52:55],v7 offset:9216
s_waitcnt lgkmcnt(6)
v_smfmac_f32_16x16x64_bf16 v[92:95],v[20:23],v[56:63],v1
v_smfmac_f32_16x16x64_bf16 v[92:95],v[36:39],v[56:63],v1
ds_read_b128 v[56:59],v7 offset:10240
ds_read_b128 v[60:63],v7 offset:11264
s_waitcnt lgkmcnt(6)
v_smfmac_f32_16x16x64_bf16 v[80:83],v[24:27],v[64:71],v1
v_smfmac_f32_16x16x64_bf16 v[80:83],v[40:43],v[64:71],v1
ds_read_b128 v[64:67],v7 offset:12288
ds_read_b128 v[68:71],v7 offset:13312
s_waitcnt lgkmcnt(6)
v_smfmac_f32_16x16x64_bf16 v[84:87],v[24:27],v[72:79],v1
v_smfmac_f32_16x16x64_bf16 v[84:87],v[40:43],v[72:79],v1
ds_read_b128 v[72:75],v7 offset:14336
ds_read_b128 v[76:79],v7 offset:15360
s_waitcnt lgkmcnt(6)
v_smfmac_f32_16x16x64_bf16 v[88:91],v[24:27],v[48:55],v1
v_smfmac_f32_16x16x64_bf16 v[88:91],v[40:43],v[48:55],v1
ds_read_b128 v[48:51],v7 offset:16384
ds_read_b128 v[52:55],v7 offset:17408
s_waitcnt lgkmcnt(6)
v_smfmac_f32_16x16x64_bf16 v[92:95],v[24:27],v[56:63],v1
v_smfmac_f32_16x16x64_bf16 v[92:95],v[40:43],v[56:63],v1
ds_read_b128 v[56:59],v7 offset:18432
ds_read_b128 v[60:63],v7 offset:19456
s_waitcnt lgkmcnt(6)
v_smfmac_f32_16x16x64_bf16 v[80:83],v[28:31],v[64:71],v1
v_smfmac_f32_16x16x64_bf16 v[80:83],v[44:47],v[64:71],v1
s_waitcnt lgkmcnt(4)
v_smfmac_f32_16x16x64_bf16 v[84:87],v[28:31],v[72:79],v1
v_smfmac_f32_16x16x64_bf16 v[84:87],v[44:47],v[72:79],v1
s_waitcnt lgkmcnt(2)
v_smfmac_f32_16x16x64_bf16 v[88:91],v[28:31],v[48:55],v1
v_add_f32 v80,v80,v81
v_smfmac_f32_16x16x64_bf16 v[88:91],v[44:47],v[48:55],v1
v_add_f32 v82,v82,v83
s_waitcnt lgkmcnt(0)
v_smfmac_f32_16x16x64_bf16 v[92:95],v[28:31],v[56:63],v1
v_cvt_pk_bf16_f32 v80,v80,v82
v_smfmac_f32_16x16x64_bf16 v[92:95],v[44:47],v[56:63],v1
ds_write_addtid_b32 v80 offset:16896
v_add_f32 v84,v84,v85
v_add_f32 v86,v86,v87
v_cvt_pk_bf16_f32 v84,v84,v86
v_add_f32 v88,v88,v89
v_add_f32 v90,v90,v91
v_cvt_pk_bf16_f32 v88,v88,v90
s_nop 0
v_add_f32 v92,v92,v93
v_add_f32 v94,v94,v95
v_cvt_pk_bf16_f32 v92,v92,v94
ds_write_addtid_b32 v84 offset:17920
ds_write_addtid_b32 v88 offset:18944
ds_write_addtid_b32 v92 offset:19968
s_waitcnt lgkmcnt(0)
s_barrier
s_cmp_gt_u32 s50,1
s_cbranch_scc1 l23_100538
ds_read2st64_b32 v[112:113],v127 offset0:66 offset1:67
ds_read2st64_b32 v[114:115],v127 offset0:68 offset1:69
ds_read2st64_b32 v[116:117],v127 offset0:70 offset1:71
ds_read2st64_b32 v[118:119],v127 offset0:72 offset1:73
s_waitcnt lgkmcnt(0)
v_mov_b32 v120,v5
v_mov_b32 v121,v5
v_mov_b32 v122,v5
v_mov_b32 v123,v5
s_nop 1
v_mfma_f32_16x16x32_bf16 v[112:115],v[120:123],v[112:115],0
v_mfma_f32_16x16x32_bf16 v[116:119],v[120:123],v[116:119],0
s_nop 4
v_cvt_pk_bf16_f32 v112,v112,v113
v_cvt_pk_bf16_f32 v113,v114,v115
s_nop 0
v_cvt_pk_bf16_f32 v114,v116,v117
v_cvt_pk_bf16_f32 v115,v118,v119
s_branch lj_100539
l23_100538:
ds_read_b128 v[48:51],v2 offset:0
ds_read_b128 v[52:55],v2 offset:256
ds_read_b128 v[56:59],v2 offset:512
ds_read_b128 v[60:63],v2 offset:768
ds_read_b128 v[64:67],v2 offset:16
ds_read_b128 v[68:71],v2 offset:272
ds_read_b128 v[72:75],v2 offset:528
ds_read_b128 v[76:79],v2 offset:784
s_waitcnt lgkmcnt(6)
v_pk_add_f32 v[48:49],v[48:49],v[52:53]
v_pk_add_f32 v[50:51],v[50:51],v[54:55]
s_waitcnt lgkmcnt(4)
v_pk_add_f32 v[56:57],v[56:57],v[60:61]
v_pk_add_f32 v[58:59],v[58:59],v[62:63]
v_pk_add_f32 v[48:49],v[48:49],v[56:57]
v_pk_add_f32 v[50:51],v[50:51],v[58:59]
v_cvt_pk_bf16_f32 v112,v48,v49
v_cvt_pk_bf16_f32 v113,v50,v51
s_waitcnt lgkmcnt(2)
v_pk_add_f32 v[64:65],v[64:65],v[68:69]
v_pk_add_f32 v[66:67],v[66:67],v[70:71]
s_waitcnt lgkmcnt(0)
v_pk_add_f32 v[72:73],v[72:73],v[76:77]
v_pk_add_f32 v[74:75],v[74:75],v[78:79]
v_pk_add_f32 v[64:65],v[64:65],v[72:73]
v_pk_add_f32 v[66:67],v[66:67],v[74:75]
v_cvt_pk_bf16_f32 v114,v64,v65
v_cvt_pk_bf16_f32 v115,v66,v67
lj_100539:
v_cndmask_b32 v120,2.0,v0,s[82:83]
v_cndmask_b32 v121,2.0,v127,s[86:87]
buffer_store_dwordx4 v[112:115],v120,s[20:23],s101 offen sc1
s_waitcnt vmcnt(0)
s_barrier
v_mov_b32 v126,64
buffer_store_dword v126,v121,s[20:23],s69 offen sc1
s_branch recfin_100430
pe_100445:
s_waitcnt vmcnt(5)
v_readfirstlane_b32 s91,v119
s_cmp_gt_u32 s91,s79
s_cbranch_scc0 pb_100446
s_add_u32 s64,s79,0
s_lshl_b32 s65,s64,12
s_and_b32 s65,s65,0x2000
s_xor_b32 s65,s65,s67
s_lshl_b32 s64,s64,20
s_add_u32 s65,s65,s64
s_add_u32 s62,s65,s77
buffer_load_dwordx4 v[96:99],v0,s[20:23],s62 offen
buffer_load_dwordx4 v[100:103],v0,s[20:23],s62 offen offset:1024
s_mov_b32 s61,0
s_branch pb_100446
pq_100447:
s_cmp_gt_u32 s91,s79
s_cbranch_scc1 pg_100450
pl_100449:
buffer_load_dword v124,off,s[20:23],s68 sc1
s_waitcnt vmcnt(0)
v_readfirstlane_b32 s91,v124
s_cmp_gt_u32 s91,s79
s_cbranch_scc1 pg_100450
s_sleep 2
s_sub_u32 s90,s90,1
s_cmp_gt_i32 s90,0
s_cbranch_scc1 pl_100449
pg_100450:
s_add_u32 s64,s79,0
s_lshl_b32 s65,s64,12
s_and_b32 s65,s65,0x2000
s_xor_b32 s65,s65,s67
s_lshl_b32 s64,s64,20
s_add_u32 s65,s65,s64
s_add_u32 s62,s65,s77
buffer_load_dwordx4 v[96:99],v0,s[20:23],s62 offen
buffer_load_dwordx4 v[100:103],v0,s[20:23],s62 offen offset:1024
s_waitcnt vmcnt(0)
s_branch pk_100448
fl_100467:
flb_100475:
buffer_load_dwordx4 v[16:19],v0,s[20:23],s92 offen offset:0 sc1
s_mov_b32 s55,1
buffer_load_dwordx4 v[32:35],v0,s[20:23],s93 offen offset:0 sc1
s_waitcnt vmcnt(4)
v_max3_u32 v124,v20,v21,v22
v_max_u32 v124,v124,v23
v_cmp_eq_u32 vcc,-1,v124
s_cbranch_vccnz dfl_100540
v_smfmac_f32_16x16x64_bf16 v[48:51],v[20:23],a[64:71],v1
buffer_load_dword v125,off,s[20:23],s92 sc1
v_smfmac_f32_16x16x64_bf16 v[52:55],v[20:23],a[72:79],v1
buffer_load_dwordx4 v[36:39],v0,s[20:23],s93 offen offset:1024 sc1
v_smfmac_f32_16x16x64_bf16 v[56:59],v[20:23],a[80:87],v1
s_waitcnt vmcnt(5)
v_max3_u32 v124,v24,v25,v26
v_smfmac_f32_16x16x64_bf16 v[60:63],v[20:23],a[88:95],v1
v_max_u32 v124,v124,v27
v_smfmac_f32_16x16x64_bf16 v[64:67],v[20:23],a[96:103],v1
v_cmp_eq_u32 vcc,-1,v124
v_smfmac_f32_16x16x64_bf16 v[68:71],v[20:23],a[104:111],v1
v_smfmac_f32_16x16x64_bf16 v[72:75],v[20:23],a[112:119],v1
v_smfmac_f32_16x16x64_bf16 v[76:79],v[20:23],a[120:127],v1
s_cbranch_vccnz dfl_100541
v_smfmac_f32_16x16x64_bf16 v[48:51],v[24:27],a[128:135],v1
buffer_load_dword v125,off,s[20:23],s92 sc1
v_smfmac_f32_16x16x64_bf16 v[52:55],v[24:27],a[136:143],v1
buffer_load_dwordx4 v[40:43],v0,s[20:23],s93 offen offset:2048 sc1
v_smfmac_f32_16x16x64_bf16 v[56:59],v[24:27],a[144:151],v1
buffer_load_dwordx4 v[44:47],v0,s[20:23],s93 offen offset:3072 sc1
s_waitcnt vmcnt(7)
v_max3_u32 v124,v28,v29,v30
v_smfmac_f32_16x16x64_bf16 v[60:63],v[24:27],a[152:159],v1
v_max_u32 v124,v124,v31
v_smfmac_f32_16x16x64_bf16 v[64:67],v[24:27],a[160:167],v1
v_cmp_eq_u32 vcc,-1,v124
v_smfmac_f32_16x16x64_bf16 v[68:71],v[24:27],a[168:175],v1
v_smfmac_f32_16x16x64_bf16 v[72:75],v[24:27],a[176:183],v1
v_smfmac_f32_16x16x64_bf16 v[76:79],v[24:27],a[184:191],v1
s_cbranch_vccnz dfl_100542
v_smfmac_f32_16x16x64_bf16 v[48:51],v[28:31],a[192:199],v1
buffer_load_dword v125,off,s[20:23],s92 sc1
v_smfmac_f32_16x16x64_bf16 v[52:55],v[28:31],a[200:207],v1
buffer_store_dword v126,v121,s[20:23],s69 offen sc1
v_smfmac_f32_16x16x64_bf16 v[56:59],v[28:31],a[208:215],v1
s_waitcnt vmcnt(8)
v_max3_u32 v124,v16,v17,v18
v_smfmac_f32_16x16x64_bf16 v[60:63],v[28:31],a[216:223],v1
v_max_u32 v124,v124,v19
v_smfmac_f32_16x16x64_bf16 v[64:67],v[28:31],a[224:231],v1
v_cmp_eq_u32 vcc,-1,v124
v_smfmac_f32_16x16x64_bf16 v[68:71],v[28:31],a[232:239],v1
v_smfmac_f32_16x16x64_bf16 v[72:75],v[28:31],a[240:247],v1
v_smfmac_f32_16x16x64_bf16 v[76:79],v[28:31],a[248:255],v1
s_cbranch_vccnz lfb_100547
s_mov_b32 s55,0
v_smfmac_f32_16x16x64_bf16 v[48:51],v[16:19],a[0:7],v1
v_smfmac_f32_16x16x64_bf16 v[52:55],v[16:19],a[8:15],v1
v_smfmac_f32_16x16x64_bf16 v[56:59],v[16:19],a[16:23],v1
s_waitcnt vmcnt(7)
v_max3_u32 v124,v32,v33,v34
v_max_u32 v124,v124,v35
v_cmp_eq_u32 vcc,-1,v124
v_smfmac_f32_16x16x64_bf16 v[60:63],v[16:19],a[24:31],v1
v_smfmac_f32_16x16x64_bf16 v[64:67],v[16:19],a[32:39],v1
v_smfmac_f32_16x16x64_bf16 v[68:71],v[16:19],a[40:47],v1
v_smfmac_f32_16x16x64_bf16 v[72:75],v[16:19],a[48:55],v1
v_smfmac_f32_16x16x64_bf16 v[76:79],v[16:19],a[56:63],v1
s_cbranch_vccnz flb_100479
s_branch segb_100463
fl_100468:
v_smfmac_f32_16x16x64_bf16 v[76:79],v[16:19],a[56:63],v1
flb_100476:
buffer_load_dwordx4 v[20:23],v0,s[20:23],s92 offen offset:1024 sc1
s_mov_b32 s55,2
buffer_load_dwordx4 v[36:39],v0,s[20:23],s93 offen offset:1024 sc1
s_waitcnt vmcnt(5)
v_max3_u32 v124,v24,v25,v26
v_max_u32 v124,v124,v27
v_cmp_eq_u32 vcc,-1,v124
s_cbranch_vccnz dfl_100541
v_smfmac_f32_16x16x64_bf16 v[48:51],v[24:27],a[128:135],v1
buffer_load_dword v125,off,s[20:23],s92 sc1
v_smfmac_f32_16x16x64_bf16 v[52:55],v[24:27],a[136:143],v1
buffer_load_dwordx4 v[40:43],v0,s[20:23],s93 offen offset:2048 sc1
v_smfmac_f32_16x16x64_bf16 v[56:59],v[24:27],a[144:151],v1
buffer_load_dwordx4 v[44:47],v0,s[20:23],s93 offen offset:3072 sc1
s_waitcnt vmcnt(7)
v_max3_u32 v124,v28,v29,v30
v_smfmac_f32_16x16x64_bf16 v[60:63],v[24:27],a[152:159],v1
v_max_u32 v124,v124,v31
v_smfmac_f32_16x16x64_bf16 v[64:67],v[24:27],a[160:167],v1
v_cmp_eq_u32 vcc,-1,v124
v_smfmac_f32_16x16x64_bf16 v[68:71],v[24:27],a[168:175],v1
v_smfmac_f32_16x16x64_bf16 v[72:75],v[24:27],a[176:183],v1
v_smfmac_f32_16x16x64_bf16 v[76:79],v[24:27],a[184:191],v1
s_cbranch_vccnz dfl_100542
v_smfmac_f32_16x16x64_bf16 v[48:51],v[28:31],a[192:199],v1
buffer_load_dword v125,off,s[20:23],s92 sc1
v_smfmac_f32_16x16x64_bf16 v[52:55],v[28:31],a[200:207],v1
buffer_store_dword v126,v121,s[20:23],s69 offen sc1
v_smfmac_f32_16x16x64_bf16 v[56:59],v[28:31],a[208:215],v1
s_waitcnt vmcnt(6)
v_max3_u32 v124,v20,v21,v22
v_smfmac_f32_16x16x64_bf16 v[60:63],v[28:31],a[216:223],v1
v_max_u32 v124,v124,v23
v_smfmac_f32_16x16x64_bf16 v[64:67],v[28:31],a[224:231],v1
v_cmp_eq_u32 vcc,-1,v124
v_smfmac_f32_16x16x64_bf16 v[68:71],v[28:31],a[232:239],v1
v_smfmac_f32_16x16x64_bf16 v[72:75],v[28:31],a[240:247],v1
v_smfmac_f32_16x16x64_bf16 v[76:79],v[28:31],a[248:255],v1
s_cbranch_vccnz lfb_100547
s_mov_b32 s55,0
v_smfmac_f32_16x16x64_bf16 v[48:51],v[20:23],a[64:71],v1
v_smfmac_f32_16x16x64_bf16 v[52:55],v[20:23],a[72:79],v1
v_smfmac_f32_16x16x64_bf16 v[56:59],v[20:23],a[80:87],v1
s_waitcnt vmcnt(7)
v_max3_u32 v124,v32,v33,v34
v_max_u32 v124,v124,v35
v_cmp_eq_u32 vcc,-1,v124
v_smfmac_f32_16x16x64_bf16 v[60:63],v[20:23],a[88:95],v1
v_smfmac_f32_16x16x64_bf16 v[64:67],v[20:23],a[96:103],v1
v_smfmac_f32_16x16x64_bf16 v[68:71],v[20:23],a[104:111],v1
v_smfmac_f32_16x16x64_bf16 v[72:75],v[20:23],a[112:119],v1
v_smfmac_f32_16x16x64_bf16 v[76:79],v[20:23],a[120:127],v1
s_cbranch_vccnz flb_100479
s_branch segb_100463
fl_100469:
v_smfmac_f32_16x16x64_bf16 v[76:79],v[20:23],a[120:127],v1
flb_100477:
buffer_load_dwordx4 v[24:27],v0,s[20:23],s92 offen offset:2048 sc1
s_mov_b32 s55,4
buffer_load_dwordx4 v[40:43],v0,s[20:23],s93 offen offset:2048 sc1
buffer_load_dwordx4 v[44:47],v0,s[20:23],s93 offen offset:3072 sc1
s_waitcnt vmcnt(7)
v_max3_u32 v124,v28,v29,v30
v_max_u32 v124,v124,v31
v_cmp_eq_u32 vcc,-1,v124
s_cbranch_vccnz dfl_100542
v_smfmac_f32_16x16x64_bf16 v[48:51],v[28:31],a[192:199],v1
buffer_load_dword v125,off,s[20:23],s92 sc1
v_smfmac_f32_16x16x64_bf16 v[52:55],v[28:31],a[200:207],v1
buffer_store_dword v126,v121,s[20:23],s69 offen sc1
v_smfmac_f32_16x16x64_bf16 v[56:59],v[28:31],a[208:215],v1
s_waitcnt vmcnt(4)
v_max3_u32 v124,v24,v25,v26
v_smfmac_f32_16x16x64_bf16 v[60:63],v[28:31],a[216:223],v1
v_max_u32 v124,v124,v27
v_smfmac_f32_16x16x64_bf16 v[64:67],v[28:31],a[224:231],v1
v_cmp_eq_u32 vcc,-1,v124
v_smfmac_f32_16x16x64_bf16 v[68:71],v[28:31],a[232:239],v1
v_smfmac_f32_16x16x64_bf16 v[72:75],v[28:31],a[240:247],v1
v_smfmac_f32_16x16x64_bf16 v[76:79],v[28:31],a[248:255],v1
s_cbranch_vccnz lfb_100547
s_mov_b32 s55,0
v_smfmac_f32_16x16x64_bf16 v[48:51],v[24:27],a[128:135],v1
v_smfmac_f32_16x16x64_bf16 v[52:55],v[24:27],a[136:143],v1
v_smfmac_f32_16x16x64_bf16 v[56:59],v[24:27],a[144:151],v1
s_waitcnt vmcnt(7)
v_max3_u32 v124,v32,v33,v34
v_max_u32 v124,v124,v35
v_cmp_eq_u32 vcc,-1,v124
v_smfmac_f32_16x16x64_bf16 v[60:63],v[24:27],a[152:159],v1
v_smfmac_f32_16x16x64_bf16 v[64:67],v[24:27],a[160:167],v1
v_smfmac_f32_16x16x64_bf16 v[68:71],v[24:27],a[168:175],v1
v_smfmac_f32_16x16x64_bf16 v[72:75],v[24:27],a[176:183],v1
v_smfmac_f32_16x16x64_bf16 v[76:79],v[24:27],a[184:191],v1
s_cbranch_vccnz flb_100479
s_branch segb_100463
fl_100470:
v_smfmac_f32_16x16x64_bf16 v[76:79],v[24:27],a[184:191],v1
flb_100478:
buffer_load_dwordx4 v[28:31],v0,s[20:23],s92 offen offset:3072 sc1
s_mov_b32 s55,8
buffer_store_dword v126,v121,s[20:23],s69 offen sc1
s_waitcnt vmcnt(1)
v_max3_u32 v124,v28,v29,v30
v_max_u32 v124,v124,v31
v_cmp_eq_u32 vcc,-1,v124
s_cbranch_vccnz lfb_100547
s_mov_b32 s55,0
v_smfmac_f32_16x16x64_bf16 v[48:51],v[28:31],a[192:199],v1
v_smfmac_f32_16x16x64_bf16 v[52:55],v[28:31],a[200:207],v1
v_smfmac_f32_16x16x64_bf16 v[56:59],v[28:31],a[208:215],v1
s_waitcnt vmcnt(7)
v_max3_u32 v124,v32,v33,v34
v_max_u32 v124,v124,v35
v_cmp_eq_u32 vcc,-1,v124
v_smfmac_f32_16x16x64_bf16 v[60:63],v[28:31],a[216:223],v1
v_smfmac_f32_16x16x64_bf16 v[64:67],v[28:31],a[224:231],v1
v_smfmac_f32_16x16x64_bf16 v[68:71],v[28:31],a[232:239],v1
v_smfmac_f32_16x16x64_bf16 v[72:75],v[28:31],a[240:247],v1
v_smfmac_f32_16x16x64_bf16 v[76:79],v[28:31],a[248:255],v1
s_cbranch_vccnz flb_100479
s_branch segb_100463
fl_100471:
v_smfmac_f32_16x16x64_bf16 v[76:79],v[28:31],a[248:255],v1
flb_100479:
buffer_load_dwordx4 v[32:35],v0,s[20:23],s93 offen offset:0 sc1
s_mov_b32 s55,240
s_bitcmp1_b32 s55,5
s_cbranch_scc0 rdn_100550
s_waitcnt vmcnt(6)
v_max3_u32 v124,v36,v37,v38
v_max_u32 v124,v124,v39
v_cmp_eq_u32 vcc,-1,v124
s_cbranch_vccnz rfa_100551
buffer_load_dword v125,off,s[20:23],s92 sc1
s_bitset0_b32 s55,5
v_smfmac_f32_16x16x64_bf16 v[48:51],v[36:39],a[64:71],v1
v_smfmac_f32_16x16x64_bf16 v[52:55],v[36:39],a[72:79],v1
v_smfmac_f32_16x16x64_bf16 v[56:59],v[36:39],a[80:87],v1
v_smfmac_f32_16x16x64_bf16 v[60:63],v[36:39],a[88:95],v1
v_smfmac_f32_16x16x64_bf16 v[64:67],v[36:39],a[96:103],v1
v_smfmac_f32_16x16x64_bf16 v[68:71],v[36:39],a[104:111],v1
v_smfmac_f32_16x16x64_bf16 v[72:75],v[36:39],a[112:119],v1
v_smfmac_f32_16x16x64_bf16 v[76:79],v[36:39],a[120:127],v1
s_cmp_eq_u32 s55,0
s_cbranch_scc1 segb_100465
s_branch rnx_100552
rdn_100550:
buffer_load_dword v125,off,s[20:23],s92 sc1
s_branch rnx_100552
rfa_100551:
buffer_load_dwordx4 v[36:39],v0,s[20:23],s93 offen offset:1024 sc1
rnx_100552:
s_bitcmp1_b32 s55,6
s_cbranch_scc0 rdn_100553
s_waitcnt vmcnt(5)
v_max3_u32 v124,v40,v41,v42
v_max_u32 v124,v124,v43
v_cmp_eq_u32 vcc,-1,v124
s_cbranch_vccnz rfa_100554
buffer_load_dword v125,off,s[20:23],s92 sc1
s_bitset0_b32 s55,6
s_cmp_eq_u32 s55,0
s_cbranch_scc1 segb_100465
s_branch rnx_100555
rdn_100553:
buffer_load_dword v125,off,s[20:23],s92 sc1
s_branch rnx_100555
rfa_100554:
buffer_load_dwordx4 v[40:43],v0,s[20:23],s93 offen offset:2048 sc1
rnx_100555:
s_bitcmp1_b32 s55,7
s_cbranch_scc0 rdn_100556
s_waitcnt vmcnt(5)
v_max3_u32 v124,v44,v45,v46
v_max_u32 v124,v124,v47
v_cmp_eq_u32 vcc,-1,v124
s_cbranch_vccnz rfa_100557
buffer_load_dword v125,off,s[20:23],s92 sc1
s_bitset0_b32 s55,7
s_cmp_eq_u32 s55,0
s_cbranch_scc1 segb_100465
s_branch rnx_100558
rdn_100556:
buffer_load_dword v125,off,s[20:23],s92 sc1
s_branch rnx_100558
rfa_100557:
buffer_load_dwordx4 v[44:47],v0,s[20:23],s93 offen offset:3072 sc1
rnx_100558:
rot_100549:
s_bitcmp1_b32 s55,4
s_cbranch_scc0 rdn_100559
s_waitcnt vmcnt(3)
v_max3_u32 v124,v32,v33,v34
v_max_u32 v124,v124,v35
v_cmp_eq_u32 vcc,-1,v124
s_cbranch_vccnz rfa_100560
buffer_load_dword v125,off,s[20:23],s92 sc1
s_bitset0_b32 s55,4
v_smfmac_f32_16x16x64_bf16 v[48:51],v[32:35],a[0:7],v1
v_smfmac_f32_16x16x64_bf16 v[52:55],v[32:35],a[8:15],v1
v_smfmac_f32_16x16x64_bf16 v[56:59],v[32:35],a[16:23],v1
v_smfmac_f32_16x16x64_bf16 v[60:63],v[32:35],a[24:31],v1
v_smfmac_f32_16x16x64_bf16 v[64:67],v[32:35],a[32:39],v1
v_smfmac_f32_16x16x64_bf16 v[68:71],v[32:35],a[40:47],v1
v_smfmac_f32_16x16x64_bf16 v[72:75],v[32:35],a[48:55],v1
v_smfmac_f32_16x16x64_bf16 v[76:79],v[32:35],a[56:63],v1
s_cmp_eq_u32 s55,0
s_cbranch_scc1 segb_100465
s_branch rnx_100561
rdn_100559:
buffer_load_dword v125,off,s[20:23],s92 sc1
s_branch rnx_100561
rfa_100560:
buffer_load_dwordx4 v[32:35],v0,s[20:23],s93 offen offset:0 sc1
rnx_100561:
s_bitcmp1_b32 s55,5
s_cbranch_scc0 rdn_100562
s_waitcnt vmcnt(3)
v_max3_u32 v124,v36,v37,v38
v_max_u32 v124,v124,v39
v_cmp_eq_u32 vcc,-1,v124
s_cbranch_vccnz rfa_100563
buffer_load_dword v125,off,s[20:23],s92 sc1
s_bitset0_b32 s55,5
v_smfmac_f32_16x16x64_bf16 v[48:51],v[36:39],a[64:71],v1
v_smfmac_f32_16x16x64_bf16 v[52:55],v[36:39],a[72:79],v1
v_smfmac_f32_16x16x64_bf16 v[56:59],v[36:39],a[80:87],v1
v_smfmac_f32_16x16x64_bf16 v[60:63],v[36:39],a[88:95],v1
v_smfmac_f32_16x16x64_bf16 v[64:67],v[36:39],a[96:103],v1
v_smfmac_f32_16x16x64_bf16 v[68:71],v[36:39],a[104:111],v1
v_smfmac_f32_16x16x64_bf16 v[72:75],v[36:39],a[112:119],v1
v_smfmac_f32_16x16x64_bf16 v[76:79],v[36:39],a[120:127],v1
s_cmp_eq_u32 s55,0
s_cbranch_scc1 segb_100465
s_branch rnx_100564
rdn_100562:
buffer_load_dword v125,off,s[20:23],s92 sc1
s_branch rnx_100564
rfa_100563:
buffer_load_dwordx4 v[36:39],v0,s[20:23],s93 offen offset:1024 sc1
rnx_100564:
s_bitcmp1_b32 s55,6
s_cbranch_scc0 rdn_100565
s_waitcnt vmcnt(3)
v_max3_u32 v124,v40,v41,v42
v_max_u32 v124,v124,v43
v_cmp_eq_u32 vcc,-1,v124
s_cbranch_vccnz rfa_100566
buffer_load_dword v125,off,s[20:23],s92 sc1
s_bitset0_b32 s55,6
s_cmp_eq_u32 s55,0
s_cbranch_scc1 segb_100465
s_branch rnx_100567
rdn_100565:
buffer_load_dword v125,off,s[20:23],s92 sc1
s_branch rnx_100567
rfa_100566:
buffer_load_dwordx4 v[40:43],v0,s[20:23],s93 offen offset:2048 sc1
rnx_100567:
s_bitcmp1_b32 s55,7
s_cbranch_scc0 rdn_100568
s_waitcnt vmcnt(3)
v_max3_u32 v124,v44,v45,v46
v_max_u32 v124,v124,v47
v_cmp_eq_u32 vcc,-1,v124
s_cbranch_vccnz rfa_100569
buffer_load_dword v125,off,s[20:23],s92 sc1
s_bitset0_b32 s55,7
s_cmp_eq_u32 s55,0
s_cbranch_scc1 segb_100465
s_branch rnx_100570
rdn_100568:
buffer_load_dword v125,off,s[20:23],s92 sc1
s_branch rnx_100570
rfa_100569:
buffer_load_dwordx4 v[44:47],v0,s[20:23],s93 offen offset:3072 sc1
rnx_100570:
s_sub_u32 s90,s90,1
s_cmp_gt_i32 s90,0
s_cbranch_scc1 rot_100549
s_mov_b32 s55,0
s_branch segb_100465
fl_100472:
v_smfmac_f32_16x16x64_bf16 v[76:79],v[32:35],a[56:63],v1
flb_100480:
buffer_load_dwordx4 v[36:39],v0,s[20:23],s93 offen offset:1024 sc1
s_mov_b32 s55,224
s_bitcmp1_b32 s55,6
s_cbranch_scc0 rdn_100572
s_waitcnt vmcnt(5)
v_max3_u32 v124,v40,v41,v42
v_max_u32 v124,v124,v43
v_cmp_eq_u32 vcc,-1,v124
s_cbranch_vccnz rfa_100573
buffer_load_dword v125,off,s[20:23],s92 sc1
s_bitset0_b32 s55,6
s_cmp_eq_u32 s55,0
s_cbranch_scc1 segb_100465
s_branch rnx_100574
rdn_100572:
buffer_load_dword v125,off,s[20:23],s92 sc1
s_branch rnx_100574
rfa_100573:
buffer_load_dwordx4 v[40:43],v0,s[20:23],s93 offen offset:2048 sc1
rnx_100574:
s_bitcmp1_b32 s55,7
s_cbranch_scc0 rdn_100575
s_waitcnt vmcnt(5)
v_max3_u32 v124,v44,v45,v46
v_max_u32 v124,v124,v47
v_cmp_eq_u32 vcc,-1,v124
s_cbranch_vccnz rfa_100576
buffer_load_dword v125,off,s[20:23],s92 sc1
s_bitset0_b32 s55,7
s_cmp_eq_u32 s55,0
s_cbranch_scc1 segb_100465
s_branch rnx_100577
rdn_100575:
buffer_load_dword v125,off,s[20:23],s92 sc1
s_branch rnx_100577
rfa_100576:
buffer_load_dwordx4 v[44:47],v0,s[20:23],s93 offen offset:3072 sc1
rnx_100577:
rot_100571:
s_bitcmp1_b32 s55,5
s_cbranch_scc0 rdn_100578
s_waitcnt vmcnt(2)
v_max3_u32 v124,v36,v37,v38
v_max_u32 v124,v124,v39
v_cmp_eq_u32 vcc,-1,v124
s_cbranch_vccnz rfa_100579
buffer_load_dword v125,off,s[20:23],s92 sc1
s_bitset0_b32 s55,5
v_smfmac_f32_16x16x64_bf16 v[48:51],v[36:39],a[64:71],v1
v_smfmac_f32_16x16x64_bf16 v[52:55],v[36:39],a[72:79],v1
v_smfmac_f32_16x16x64_bf16 v[56:59],v[36:39],a[80:87],v1
v_smfmac_f32_16x16x64_bf16 v[60:63],v[36:39],a[88:95],v1
v_smfmac_f32_16x16x64_bf16 v[64:67],v[36:39],a[96:103],v1
v_smfmac_f32_16x16x64_bf16 v[68:71],v[36:39],a[104:111],v1
v_smfmac_f32_16x16x64_bf16 v[72:75],v[36:39],a[112:119],v1
v_smfmac_f32_16x16x64_bf16 v[76:79],v[36:39],a[120:127],v1
s_cmp_eq_u32 s55,0
s_cbranch_scc1 segb_100465
s_branch rnx_100580
rdn_100578:
buffer_load_dword v125,off,s[20:23],s92 sc1
s_branch rnx_100580
rfa_100579:
buffer_load_dwordx4 v[36:39],v0,s[20:23],s93 offen offset:1024 sc1
rnx_100580:
s_bitcmp1_b32 s55,6
s_cbranch_scc0 rdn_100581
s_waitcnt vmcnt(2)
v_max3_u32 v124,v40,v41,v42
v_max_u32 v124,v124,v43
v_cmp_eq_u32 vcc,-1,v124
s_cbranch_vccnz rfa_100582
buffer_load_dword v125,off,s[20:23],s92 sc1
s_bitset0_b32 s55,6
s_cmp_eq_u32 s55,0
s_cbranch_scc1 segb_100465
s_branch rnx_100583
rdn_100581:
buffer_load_dword v125,off,s[20:23],s92 sc1
s_branch rnx_100583
rfa_100582:
buffer_load_dwordx4 v[40:43],v0,s[20:23],s93 offen offset:2048 sc1
rnx_100583:
s_bitcmp1_b32 s55,7
s_cbranch_scc0 rdn_100584
s_waitcnt vmcnt(2)
v_max3_u32 v124,v44,v45,v46
v_max_u32 v124,v124,v47
v_cmp_eq_u32 vcc,-1,v124
s_cbranch_vccnz rfa_100585
buffer_load_dword v125,off,s[20:23],s92 sc1
s_bitset0_b32 s55,7
s_cmp_eq_u32 s55,0
s_cbranch_scc1 segb_100465
s_branch rnx_100586
rdn_100584:
buffer_load_dword v125,off,s[20:23],s92 sc1
s_branch rnx_100586
rfa_100585:
buffer_load_dwordx4 v[44:47],v0,s[20:23],s93 offen offset:3072 sc1
rnx_100586:
s_sub_u32 s90,s90,1
s_cmp_gt_i32 s90,0
s_cbranch_scc1 rot_100571
s_mov_b32 s55,0
s_branch segb_100465
fl_100473:
v_smfmac_f32_16x16x64_bf16 v[76:79],v[36:39],a[120:127],v1
flb_100481:
s_mov_b32 s55,192
s_bitcmp1_b32 s55,6
s_cbranch_scc0 rdn_100588
s_waitcnt vmcnt(5)
v_max3_u32 v124,v40,v41,v42
v_max_u32 v124,v124,v43
v_cmp_eq_u32 vcc,-1,v124
s_cbranch_vccnz rfa_100589
buffer_load_dword v125,off,s[20:23],s92 sc1
s_bitset0_b32 s55,6
s_cmp_eq_u32 s55,0
s_cbranch_scc1 segb_100465
s_branch rnx_100590
rdn_100588:
buffer_load_dword v125,off,s[20:23],s92 sc1
s_branch rnx_100590
rfa_100589:
buffer_load_dwordx4 v[40:43],v0,s[20:23],s93 offen offset:2048 sc1
rnx_100590:
s_bitcmp1_b32 s55,7
s_cbranch_scc0 rdn_100591
s_waitcnt vmcnt(5)
v_max3_u32 v124,v44,v45,v46
v_max_u32 v124,v124,v47
v_cmp_eq_u32 vcc,-1,v124
s_cbranch_vccnz rfa_100592
buffer_load_dword v125,off,s[20:23],s92 sc1
s_bitset0_b32 s55,7
s_cmp_eq_u32 s55,0
s_cbranch_scc1 segb_100465
s_branch rnx_100593
rdn_100591:
buffer_load_dword v125,off,s[20:23],s92 sc1
s_branch rnx_100593
rfa_100592:
buffer_load_dwordx4 v[44:47],v0,s[20:23],s93 offen offset:3072 sc1
rnx_100593:
rot_100587:
s_bitcmp1_b32 s55,6
s_cbranch_scc0 rdn_100594
s_waitcnt vmcnt(1)
v_max3_u32 v124,v40,v41,v42
v_max_u32 v124,v124,v43
v_cmp_eq_u32 vcc,-1,v124
s_cbranch_vccnz rfa_100595
buffer_load_dword v125,off,s[20:23],s92 sc1
s_bitset0_b32 s55,6
s_cmp_eq_u32 s55,0
s_cbranch_scc1 segb_100465
s_branch rnx_100596
rdn_100594:
buffer_load_dword v125,off,s[20:23],s92 sc1
s_branch rnx_100596
rfa_100595:
buffer_load_dwordx4 v[40:43],v0,s[20:23],s93 offen offset:2048 sc1
rnx_100596:
s_bitcmp1_b32 s55,7
s_cbranch_scc0 rdn_100597
s_waitcnt vmcnt(1)
v_max3_u32 v124,v44,v45,v46
v_max_u32 v124,v124,v47
v_cmp_eq_u32 vcc,-1,v124
s_cbranch_vccnz rfa_100598
buffer_load_dword v125,off,s[20:23],s92 sc1
s_bitset0_b32 s55,7
s_cmp_eq_u32 s55,0
s_cbranch_scc1 segb_100465
s_branch rnx_100599
rdn_100597:
buffer_load_dword v125,off,s[20:23],s92 sc1
s_branch rnx_100599
rfa_100598:
buffer_load_dwordx4 v[44:47],v0,s[20:23],s93 offen offset:3072 sc1
rnx_100599:
s_sub_u32 s90,s90,1
s_cmp_gt_i32 s90,0
s_cbranch_scc1 rot_100587
s_mov_b32 s55,0
s_branch segb_100465
dfl_100540:
buffer_load_dwordx4 v[20:23],v0,s[20:23],s92 offen offset:1024 sc1
s_bitset1_b32 s55,1
buffer_load_dwordx4 v[36:39],v0,s[20:23],s93 offen offset:1024 sc1
s_waitcnt vmcnt(5)
v_max3_u32 v124,v24,v25,v26
v_max_u32 v124,v124,v27
v_cmp_eq_u32 vcc,-1,v124
s_cbranch_vccnz dfl_100541
s_branch dseg_100544
dfl_100541:
buffer_load_dwordx4 v[24:27],v0,s[20:23],s92 offen offset:2048 sc1
s_bitset1_b32 s55,2
buffer_load_dwordx4 v[40:43],v0,s[20:23],s93 offen offset:2048 sc1
buffer_load_dwordx4 v[44:47],v0,s[20:23],s93 offen offset:3072 sc1
s_waitcnt vmcnt(7)
v_max3_u32 v124,v28,v29,v30
v_max_u32 v124,v124,v31
v_cmp_eq_u32 vcc,-1,v124
s_cbranch_vccnz dfl_100542
s_branch dseg_100545
dfl_100542:
buffer_load_dwordx4 v[28:31],v0,s[20:23],s92 offen offset:3072 sc1
s_bitset1_b32 s55,3
buffer_store_dword v126,v121,s[20:23],s69 offen sc1
s_branch lap2_100546
dseg_100544:
v_smfmac_f32_16x16x64_bf16 v[48:51],v[24:27],a[128:135],v1
buffer_load_dword v125,off,s[20:23],s92 sc1
v_smfmac_f32_16x16x64_bf16 v[52:55],v[24:27],a[136:143],v1
buffer_load_dwordx4 v[40:43],v0,s[20:23],s93 offen offset:2048 sc1
v_smfmac_f32_16x16x64_bf16 v[56:59],v[24:27],a[144:151],v1
buffer_load_dwordx4 v[44:47],v0,s[20:23],s93 offen offset:3072 sc1
s_waitcnt vmcnt(7)
v_max3_u32 v124,v28,v29,v30
v_smfmac_f32_16x16x64_bf16 v[60:63],v[24:27],a[152:159],v1
v_max_u32 v124,v124,v31
v_smfmac_f32_16x16x64_bf16 v[64:67],v[24:27],a[160:167],v1
v_cmp_eq_u32 vcc,-1,v124
v_smfmac_f32_16x16x64_bf16 v[68:71],v[24:27],a[168:175],v1
v_smfmac_f32_16x16x64_bf16 v[72:75],v[24:27],a[176:183],v1
v_smfmac_f32_16x16x64_bf16 v[76:79],v[24:27],a[184:191],v1
s_cbranch_vccnz dfl_100542
dseg_100545:
v_smfmac_f32_16x16x64_bf16 v[48:51],v[28:31],a[192:199],v1
buffer_load_dword v125,off,s[20:23],s92 sc1
v_smfmac_f32_16x16x64_bf16 v[52:55],v[28:31],a[200:207],v1
buffer_store_dword v126,v121,s[20:23],s69 offen sc1
v_smfmac_f32_16x16x64_bf16 v[56:59],v[28:31],a[208:215],v1
v_smfmac_f32_16x16x64_bf16 v[60:63],v[28:31],a[216:223],v1
v_smfmac_f32_16x16x64_bf16 v[64:67],v[28:31],a[224:231],v1
v_smfmac_f32_16x16x64_bf16 v[68:71],v[28:31],a[232:239],v1
v_smfmac_f32_16x16x64_bf16 v[72:75],v[28:31],a[240:247],v1
v_smfmac_f32_16x16x64_bf16 v[76:79],v[28:31],a[248:255],v1
lap2_100546:
s_bitcmp1_b32 s55,0
s_cbranch_scc0 l2s_100600
s_waitcnt vmcnt(8)
v_max3_u32 v124,v16,v17,v18
v_max_u32 v124,v124,v19
v_cmp_eq_u32 vcc,-1,v124
s_cbranch_vccnz l2s_100600
s_bitset0_b32 s55,0
v_smfmac_f32_16x16x64_bf16 v[48:51],v[16:19],a[0:7],v1
v_smfmac_f32_16x16x64_bf16 v[52:55],v[16:19],a[8:15],v1
v_smfmac_f32_16x16x64_bf16 v[56:59],v[16:19],a[16:23],v1
v_smfmac_f32_16x16x64_bf16 v[60:63],v[16:19],a[24:31],v1
v_smfmac_f32_16x16x64_bf16 v[64:67],v[16:19],a[32:39],v1
v_smfmac_f32_16x16x64_bf16 v[68:71],v[16:19],a[40:47],v1
v_smfmac_f32_16x16x64_bf16 v[72:75],v[16:19],a[48:55],v1
v_smfmac_f32_16x16x64_bf16 v[76:79],v[16:19],a[56:63],v1
l2s_100600:
s_bitcmp1_b32 s55,1
s_cbranch_scc0 l2s_100602
s_waitcnt vmcnt(6)
v_max3_u32 v124,v20,v21,v22
v_max_u32 v124,v124,v23
v_cmp_eq_u32 vcc,-1,v124
s_cbranch_vccnz l2s_100602
s_bitset0_b32 s55,1
v_smfmac_f32_16x16x64_bf16 v[48:51],v[20:23],a[64:71],v1
v_smfmac_f32_16x16x64_bf16 v[52:55],v[20:23],a[72:79],v1
v_smfmac_f32_16x16x64_bf16 v[56:59],v[20:23],a[80:87],v1
v_smfmac_f32_16x16x64_bf16 v[60:63],v[20:23],a[88:95],v1
v_smfmac_f32_16x16x64_bf16 v[64:67],v[20:23],a[96:103],v1
v_smfmac_f32_16x16x64_bf16 v[68:71],v[20:23],a[104:111],v1
v_smfmac_f32_16x16x64_bf16 v[72:75],v[20:23],a[112:119],v1
v_smfmac_f32_16x16x64_bf16 v[76:79],v[20:23],a[120:127],v1
l2s_100602:
s_bitcmp1_b32 s55,2
s_cbranch_scc0 l2s_100604
s_waitcnt vmcnt(4)
v_max3_u32 v124,v24,v25,v26
v_max_u32 v124,v124,v27
v_cmp_eq_u32 vcc,-1,v124
s_cbranch_vccnz l2s_100604
s_bitset0_b32 s55,2
v_smfmac_f32_16x16x64_bf16 v[48:51],v[24:27],a[128:135],v1
v_smfmac_f32_16x16x64_bf16 v[52:55],v[24:27],a[136:143],v1
v_smfmac_f32_16x16x64_bf16 v[56:59],v[24:27],a[144:151],v1
v_smfmac_f32_16x16x64_bf16 v[60:63],v[24:27],a[152:159],v1
v_smfmac_f32_16x16x64_bf16 v[64:67],v[24:27],a[160:167],v1
v_smfmac_f32_16x16x64_bf16 v[68:71],v[24:27],a[168:175],v1
v_smfmac_f32_16x16x64_bf16 v[72:75],v[24:27],a[176:183],v1
v_smfmac_f32_16x16x64_bf16 v[76:79],v[24:27],a[184:191],v1
l2s_100604:
s_bitcmp1_b32 s55,3
s_cbranch_scc0 l2s_100606
s_waitcnt vmcnt(1)
v_max3_u32 v124,v28,v29,v30
v_max_u32 v124,v124,v31
v_cmp_eq_u32 vcc,-1,v124
s_cbranch_vccnz l2s_100606
s_bitset0_b32 s55,3
v_smfmac_f32_16x16x64_bf16 v[48:51],v[28:31],a[192:199],v1
v_smfmac_f32_16x16x64_bf16 v[52:55],v[28:31],a[200:207],v1
v_smfmac_f32_16x16x64_bf16 v[56:59],v[28:31],a[208:215],v1
v_smfmac_f32_16x16x64_bf16 v[60:63],v[28:31],a[216:223],v1
v_smfmac_f32_16x16x64_bf16 v[64:67],v[28:31],a[224:231],v1
v_smfmac_f32_16x16x64_bf16 v[68:71],v[28:31],a[232:239],v1
v_smfmac_f32_16x16x64_bf16 v[72:75],v[28:31],a[240:247],v1
v_smfmac_f32_16x16x64_bf16 v[76:79],v[28:31],a[248:255],v1
l2s_100606:
s_cmp_eq_u32 s55,0
s_cbranch_scc0 lfb_100547
Ldone_100548:
s_waitcnt vmcnt(7)
v_max3_u32 v124,v32,v33,v34
v_max_u32 v124,v124,v35
v_cmp_eq_u32 vcc,-1,v124
s_cbranch_vccnz flb_100479
s_branch segb_100463
lfb_100547:
s_bitcmp1_b32 s55,0
s_cbranch_scc0 dsk_100608
buffer_load_dwordx4 v[16:19],v0,s[20:23],s92 offen offset:0 sc1
dsk_100608:
s_bitcmp1_b32 s55,1
s_cbranch_scc0 dsk_100609
buffer_load_dwordx4 v[20:23],v0,s[20:23],s92 offen offset:1024 sc1
dsk_100609:
s_bitcmp1_b32 s55,2
s_cbranch_scc0 dsk_100610
buffer_load_dwordx4 v[24:27],v0,s[20:23],s92 offen offset:2048 sc1
dsk_100610:
s_bitcmp1_b32 s55,3
s_cbranch_scc0 dsk_100611
buffer_load_dwordx4 v[28:31],v0,s[20:23],s92 offen offset:3072 sc1
dsk_100611:
s_bitcmp1_b32 s55,0
s_cbranch_scc0 dsk_100612
s_waitcnt vmcnt(2)
v_max3_u32 v124,v16,v17,v18
v_max_u32 v124,v124,v19
v_cmp_eq_u32 vcc,-1,v124
s_cbranch_vccz dgo_100613
s_nop 15
buffer_load_dwordx4 v[104:107],v0,s[20:23],s92 offen offset:0 sc1
s_nop 15
buffer_load_dwordx4 v[108:111],v0,s[20:23],s92 offen offset:0 sc1
dlp_100614:
s_waitcnt vmcnt(2)
v_max3_u32 v124,v16,v17,v18
v_max_u32 v124,v124,v19
v_cmp_eq_u32 vcc,-1,v124
s_cbranch_vccz dgo_100613
buffer_load_dwordx4 v[16:19],v0,s[20:23],s92 offen offset:0 sc1
s_waitcnt vmcnt(2)
v_max3_u32 v124,v104,v105,v106
v_max_u32 v124,v124,v107
v_cmp_eq_u32 vcc,-1,v124
s_cbranch_vccz dcp_100616
buffer_load_dwordx4 v[104:107],v0,s[20:23],s92 offen offset:0 sc1
s_waitcnt vmcnt(2)
v_max3_u32 v124,v108,v109,v110
v_max_u32 v124,v124,v111
v_cmp_eq_u32 vcc,-1,v124
s_cbranch_vccz dcp_100617
buffer_load_dwordx4 v[108:111],v0,s[20:23],s92 offen offset:0 sc1
s_sub_u32 s90,s90,1
s_cmp_gt_i32 s90,0
s_cbranch_scc1 dlp_100614
s_branch dgo_100613
dcp_100616:
v_mov_b32 v16,v104
v_mov_b32 v17,v105
v_mov_b32 v18,v106
v_mov_b32 v19,v107
s_nop 1
s_branch dgo_100613
dcp_100617:
v_mov_b32 v16,v108
v_mov_b32 v17,v109
v_mov_b32 v18,v110
v_mov_b32 v19,v111
s_nop 1
dgo_100613:
v_smfmac_f32_16x16x64_bf16 v[48:51],v[16:19],a[0:7],v1
v_smfmac_f32_16x16x64_bf16 v[52:55],v[16:19],a[8:15],v1
v_smfmac_f32_16x16x64_bf16 v[56:59],v[16:19],a[16:23],v1
v_smfmac_f32_16x16x64_bf16 v[60:63],v[16:19],a[24:31],v1
v_smfmac_f32_16x16x64_bf16 v[64:67],v[16:19],a[32:39],v1
v_smfmac_f32_16x16x64_bf16 v[68:71],v[16:19],a[40:47],v1
v_smfmac_f32_16x16x64_bf16 v[72:75],v[16:19],a[48:55],v1
v_smfmac_f32_16x16x64_bf16 v[76:79],v[16:19],a[56:63],v1
dsk_100612:
s_bitcmp1_b32 s55,1
s_cbranch_scc0 dsk_100618
s_waitcnt vmcnt(2)
v_max3_u32 v124,v20,v21,v22
v_max_u32 v124,v124,v23
v_cmp_eq_u32 vcc,-1,v124
s_cbranch_vccz dgo_100619
s_nop 15
buffer_load_dwordx4 v[104:107],v0,s[20:23],s92 offen offset:1024 sc1
s_nop 15
buffer_load_dwordx4 v[108:111],v0,s[20:23],s92 offen offset:1024 sc1
dlp_100620:
s_waitcnt vmcnt(2)
v_max3_u32 v124,v20,v21,v22
v_max_u32 v124,v124,v23
v_cmp_eq_u32 vcc,-1,v124
s_cbranch_vccz dgo_100619
buffer_load_dwordx4 v[20:23],v0,s[20:23],s92 offen offset:1024 sc1
s_waitcnt vmcnt(2)
v_max3_u32 v124,v104,v105,v106
v_max_u32 v124,v124,v107
v_cmp_eq_u32 vcc,-1,v124
s_cbranch_vccz dcp_100622
buffer_load_dwordx4 v[104:107],v0,s[20:23],s92 offen offset:1024 sc1
s_waitcnt vmcnt(2)
v_max3_u32 v124,v108,v109,v110
v_max_u32 v124,v124,v111
v_cmp_eq_u32 vcc,-1,v124
s_cbranch_vccz dcp_100623
buffer_load_dwordx4 v[108:111],v0,s[20:23],s92 offen offset:1024 sc1
s_sub_u32 s90,s90,1
s_cmp_gt_i32 s90,0
s_cbranch_scc1 dlp_100620
s_branch dgo_100619
dcp_100622:
v_mov_b32 v20,v104
v_mov_b32 v21,v105
v_mov_b32 v22,v106
v_mov_b32 v23,v107
s_nop 1
s_branch dgo_100619
dcp_100623:
v_mov_b32 v20,v108
v_mov_b32 v21,v109
v_mov_b32 v22,v110
v_mov_b32 v23,v111
s_nop 1
dgo_100619:
v_smfmac_f32_16x16x64_bf16 v[48:51],v[20:23],a[64:71],v1
v_smfmac_f32_16x16x64_bf16 v[52:55],v[20:23],a[72:79],v1
v_smfmac_f32_16x16x64_bf16 v[56:59],v[20:23],a[80:87],v1
v_smfmac_f32_16x16x64_bf16 v[60:63],v[20:23],a[88:95],v1
v_smfmac_f32_16x16x64_bf16 v[64:67],v[20:23],a[96:103],v1
v_smfmac_f32_16x16x64_bf16 v[68:71],v[20:23],a[104:111],v1
v_smfmac_f32_16x16x64_bf16 v[72:75],v[20:23],a[112:119],v1
v_smfmac_f32_16x16x64_bf16 v[76:79],v[20:23],a[120:127],v1
dsk_100618:
s_bitcmp1_b32 s55,2
s_cbranch_scc0 dsk_100624
s_waitcnt vmcnt(2)
v_max3_u32 v124,v24,v25,v26
v_max_u32 v124,v124,v27
v_cmp_eq_u32 vcc,-1,v124
s_cbranch_vccz dgo_100625
s_nop 15
buffer_load_dwordx4 v[104:107],v0,s[20:23],s92 offen offset:2048 sc1
s_nop 15
buffer_load_dwordx4 v[108:111],v0,s[20:23],s92 offen offset:2048 sc1
dlp_100626:
s_waitcnt vmcnt(2)
v_max3_u32 v124,v24,v25,v26
v_max_u32 v124,v124,v27
v_cmp_eq_u32 vcc,-1,v124
s_cbranch_vccz dgo_100625
buffer_load_dwordx4 v[24:27],v0,s[20:23],s92 offen offset:2048 sc1
s_waitcnt vmcnt(2)
v_max3_u32 v124,v104,v105,v106
v_max_u32 v124,v124,v107
v_cmp_eq_u32 vcc,-1,v124
s_cbranch_vccz dcp_100628
buffer_load_dwordx4 v[104:107],v0,s[20:23],s92 offen offset:2048 sc1
s_waitcnt vmcnt(2)
v_max3_u32 v124,v108,v109,v110
v_max_u32 v124,v124,v111
v_cmp_eq_u32 vcc,-1,v124
s_cbranch_vccz dcp_100629
buffer_load_dwordx4 v[108:111],v0,s[20:23],s92 offen offset:2048 sc1
s_sub_u32 s90,s90,1
s_cmp_gt_i32 s90,0
s_cbranch_scc1 dlp_100626
s_branch dgo_100625
dcp_100628:
v_mov_b32 v24,v104
v_mov_b32 v25,v105
v_mov_b32 v26,v106
v_mov_b32 v27,v107
s_nop 1
s_branch dgo_100625
dcp_100629:
v_mov_b32 v24,v108
v_mov_b32 v25,v109
v_mov_b32 v26,v110
v_mov_b32 v27,v111
s_nop 1
dgo_100625:
v_smfmac_f32_16x16x64_bf16 v[48:51],v[24:27],a[128:135],v1
v_smfmac_f32_16x16x64_bf16 v[52:55],v[24:27],a[136:143],v1
v_smfmac_f32_16x16x64_bf16 v[56:59],v[24:27],a[144:151],v1
v_smfmac_f32_16x16x64_bf16 v[60:63],v[24:27],a[152:159],v1
v_smfmac_f32_16x16x64_bf16 v[64:67],v[24:27],a[160:167],v1
v_smfmac_f32_16x16x64_bf16 v[68:71],v[24:27],a[168:175],v1
v_smfmac_f32_16x16x64_bf16 v[72:75],v[24:27],a[176:183],v1
v_smfmac_f32_16x16x64_bf16 v[76:79],v[24:27],a[184:191],v1
dsk_100624:
s_bitcmp1_b32 s55,3
s_cbranch_scc0 dsk_100630
s_waitcnt vmcnt(2)
v_max3_u32 v124,v28,v29,v30
v_max_u32 v124,v124,v31
v_cmp_eq_u32 vcc,-1,v124
s_cbranch_vccz dgo_100631
s_nop 15
buffer_load_dwordx4 v[104:107],v0,s[20:23],s92 offen offset:3072 sc1
s_nop 15
buffer_load_dwordx4 v[108:111],v0,s[20:23],s92 offen offset:3072 sc1
dlp_100632:
s_waitcnt vmcnt(2)
v_max3_u32 v124,v28,v29,v30
v_max_u32 v124,v124,v31
v_cmp_eq_u32 vcc,-1,v124
s_cbranch_vccz dgo_100631
buffer_load_dwordx4 v[28:31],v0,s[20:23],s92 offen offset:3072 sc1
s_waitcnt vmcnt(2)
v_max3_u32 v124,v104,v105,v106
v_max_u32 v124,v124,v107
v_cmp_eq_u32 vcc,-1,v124
s_cbranch_vccz dcp_100634
buffer_load_dwordx4 v[104:107],v0,s[20:23],s92 offen offset:3072 sc1
s_waitcnt vmcnt(2)
v_max3_u32 v124,v108,v109,v110
v_max_u32 v124,v124,v111
v_cmp_eq_u32 vcc,-1,v124
s_cbranch_vccz dcp_100635
buffer_load_dwordx4 v[108:111],v0,s[20:23],s92 offen offset:3072 sc1
s_sub_u32 s90,s90,1
s_cmp_gt_i32 s90,0
s_cbranch_scc1 dlp_100632
s_branch dgo_100631
dcp_100634:
v_mov_b32 v28,v104
v_mov_b32 v29,v105
v_mov_b32 v30,v106
v_mov_b32 v31,v107
s_nop 1
s_branch dgo_100631
dcp_100635:
v_mov_b32 v28,v108
v_mov_b32 v29,v109
v_mov_b32 v30,v110
v_mov_b32 v31,v111
s_nop 1
dgo_100631:
v_smfmac_f32_16x16x64_bf16 v[48:51],v[28:31],a[192:199],v1
v_smfmac_f32_16x16x64_bf16 v[52:55],v[28:31],a[200:207],v1
v_smfmac_f32_16x16x64_bf16 v[56:59],v[28:31],a[208:215],v1
v_smfmac_f32_16x16x64_bf16 v[60:63],v[28:31],a[216:223],v1
v_smfmac_f32_16x16x64_bf16 v[64:67],v[28:31],a[224:231],v1
v_smfmac_f32_16x16x64_bf16 v[68:71],v[28:31],a[232:239],v1
v_smfmac_f32_16x16x64_bf16 v[72:75],v[28:31],a[240:247],v1
v_smfmac_f32_16x16x64_bf16 v[76:79],v[28:31],a[248:255],v1
dsk_100630:
s_mov_b32 s55,0
s_branch Ldone_100548
slowA_100483:
buffer_load_dwordx4 v[44:47],v0,s[20:23],s93 offen offset:3072 sc1
dsk_100636:
s_bitcmp1_b32 s55,7
s_cbranch_scc0 dsk_100637
s_waitcnt vmcnt(2)
v_max3_u32 v124,v44,v45,v46
v_max_u32 v124,v124,v47
v_cmp_eq_u32 vcc,-1,v124
s_cbranch_vccz dgo_100638
s_nop 15
s_nop 3
buffer_load_dwordx4 v[104:107],v0,s[20:23],s93 offen offset:3072 sc1
s_nop 15
s_nop 3
buffer_load_dwordx4 v[108:111],v0,s[20:23],s93 offen offset:3072 sc1
dlp_100639:
s_waitcnt vmcnt(2)
v_max3_u32 v124,v44,v45,v46
v_max_u32 v124,v124,v47
v_cmp_eq_u32 vcc,-1,v124
s_cbranch_vccz dgo_100638
buffer_load_dwordx4 v[44:47],v0,s[20:23],s93 offen offset:3072 sc1
s_waitcnt vmcnt(2)
v_max3_u32 v124,v104,v105,v106
v_max_u32 v124,v124,v107
v_cmp_eq_u32 vcc,-1,v124
s_cbranch_vccz dcp_100641
buffer_load_dwordx4 v[104:107],v0,s[20:23],s93 offen offset:3072 sc1
s_waitcnt vmcnt(2)
v_max3_u32 v124,v108,v109,v110
v_max_u32 v124,v124,v111
v_cmp_eq_u32 vcc,-1,v124
s_cbranch_vccz dcp_100642
buffer_load_dwordx4 v[108:111],v0,s[20:23],s93 offen offset:3072 sc1
s_sub_u32 s90,s90,1
s_cmp_gt_i32 s90,0
s_cbranch_scc1 dlp_100639
s_branch dgo_100638
dcp_100641:
v_mov_b32 v44,v104
v_mov_b32 v45,v105
v_mov_b32 v46,v106
v_mov_b32 v47,v107
s_nop 1
s_branch dgo_100638
dcp_100642:
v_mov_b32 v44,v108
v_mov_b32 v45,v109
v_mov_b32 v46,v110
v_mov_b32 v47,v111
s_nop 1
dgo_100638:
dsk_100637:
s_mov_b32 s55,0
s_branch segb_100465
srt_100491:
s_sub_u32 s90,s90,1
s_cmp_gt_i32 s90,0
s_cbranch_scc0 sok_100490
buffer_load_dwordx4 v[16:19],v2,s[20:23],s94 offen offset:0 sc1
buffer_load_dwordx4 v[32:35],v2,s[20:23],s94 offen offset:1536 sc1
buffer_load_dwordx4 v[20:23],v2,s[20:23],s95 offen offset:0 sc1
buffer_load_dwordx4 v[36:39],v2,s[20:23],s95 offen offset:1536 sc1
buffer_load_dword v120,v3,s[20:23],s94 offen offset:0 sc1
buffer_load_dword v121,v3,s[20:23],s94 offen offset:1536 sc1
buffer_load_dword v122,v3,s[20:23],s95 offen offset:0 sc1
buffer_load_dword v123,v3,s[20:23],s95 offen offset:1536 sc1
s_branch sp_100489
of_100492:
s_mov_b32 s55,3
buffer_load_dwordx4 v[16:19],v0,s[20:23],s96 offen offset:0 sc1
buffer_load_dwordx4 v[20:23],v0,s[20:23],s96 offen offset:1024 sc1
s_waitcnt vmcnt(6)
v_max3_u32 v124,v24,v25,v26
v_max3_u32 v124,v124,v27,v28
v_max3_u32 v124,v124,v29,v30
v_max_u32 v124,v124,v31
v_cmp_eq_u32 vcc,-1,v124
s_cbranch_vccnz ost_100644
v_smfmac_f32_16x16x64_bf16 v[96:99],v[24:27],v[80:87],v1
buffer_load_dword v120,off,s[20:23],s96 sc1
v_smfmac_f32_16x16x64_bf16 v[100:103],v[24:27],v[88:95],v1
buffer_load_dword v120,off,s[20:23],s96 sc1
v_smfmac_f32_16x16x64_bf16 v[96:99],v[28:31],v[128:135],v1
v_smfmac_f32_16x16x64_bf16 v[100:103],v[28:31],v[136:143],v1
ort_100645:
s_waitcnt vmcnt(6)
v_max3_u32 v124,v32,v33,v34
v_max3_u32 v124,v124,v35,v36
v_max3_u32 v124,v124,v37,v38
v_max_u32 v124,v124,v39
v_cmp_eq_u32 vcc,-1,v124
s_cbranch_vccnz ost_100646
v_smfmac_f32_16x16x64_bf16 v[96:99],v[32:35],v[144:151],v1
buffer_load_dword v120,off,s[20:23],s96 sc1
v_smfmac_f32_16x16x64_bf16 v[100:103],v[32:35],v[152:159],v1
buffer_load_dword v120,off,s[20:23],s96 sc1
v_smfmac_f32_16x16x64_bf16 v[96:99],v[36:39],v[160:167],v1
v_smfmac_f32_16x16x64_bf16 v[100:103],v[36:39],v[168:175],v1
ort_100647:
s_waitcnt vmcnt(7)
v_max3_u32 v124,v40,v41,v42
v_max_u32 v124,v124,v43
v_cmp_eq_u32 vcc,-1,v124
s_cbranch_vccnz ost_100648
v_smfmac_f32_16x16x64_bf16 v[96:99],v[40:43],v[176:183],v1
buffer_load_dword v120,off,s[20:23],s96 sc1
v_smfmac_f32_16x16x64_bf16 v[100:103],v[40:43],v[184:191],v1
ort_100649:
s_waitcnt vmcnt(7)
v_max3_u32 v124,v44,v45,v46
v_max_u32 v124,v124,v47
v_cmp_eq_u32 vcc,-1,v124
s_cbranch_vccnz ost_100650
v_smfmac_f32_16x16x64_bf16 v[96:99],v[44:47],v[192:199],v1
buffer_load_dword v120,off,s[20:23],s96 sc1
v_smfmac_f32_16x16x64_bf16 v[100:103],v[44:47],v[200:207],v1
ort_100651:
s_waitcnt vmcnt(6)
v_max3_u32 v124,v16,v17,v18
v_max3_u32 v124,v124,v19,v20
v_max3_u32 v124,v124,v21,v22
v_max_u32 v124,v124,v23
v_cmp_eq_u32 vcc,-1,v124
s_cbranch_vccnz olap2_100643
s_andn2_b32 s55,s55,3
v_smfmac_f32_16x16x64_bf16 v[96:99],v[16:19],v[48:55],v1
v_smfmac_f32_16x16x64_bf16 v[100:103],v[16:19],v[56:63],v1
v_smfmac_f32_16x16x64_bf16 v[96:99],v[20:23],v[64:71],v1
v_smfmac_f32_16x16x64_bf16 v[100:103],v[20:23],v[72:79],v1
s_cbranch_scc0 oback_100503
s_branch olap2_100643
ost_100644:
buffer_load_dwordx4 v[24:27],v0,s[20:23],s96 offen offset:2048 sc1
buffer_load_dwordx4 v[28:31],v0,s[20:23],s96 offen offset:3072 sc1
s_or_b32 s55,s55,12
s_branch ort_100645
ost_100646:
buffer_load_dwordx4 v[32:35],v0,s[20:23],s97 offen offset:0 sc1
buffer_load_dwordx4 v[36:39],v0,s[20:23],s97 offen offset:1024 sc1
s_or_b32 s55,s55,48
s_branch ort_100647
ost_100648:
buffer_load_dwordx4 v[40:43],v0,s[20:23],s97 offen offset:2048 sc1
s_or_b32 s55,s55,64
s_branch ort_100649
ost_100650:
buffer_load_dwordx4 v[44:47],v0,s[20:23],s97 offen offset:3072 sc1
s_or_b32 s55,s55,128
s_branch ort_100651
of_100493:
s_mov_b32 s55,12
buffer_load_dwordx4 v[24:27],v0,s[20:23],s96 offen offset:2048 sc1
buffer_load_dwordx4 v[28:31],v0,s[20:23],s96 offen offset:3072 sc1
s_waitcnt vmcnt(4)
v_max3_u32 v124,v32,v33,v34
v_max3_u32 v124,v124,v35,v36
v_max3_u32 v124,v124,v37,v38
v_max_u32 v124,v124,v39
v_cmp_eq_u32 vcc,-1,v124
s_cbranch_vccnz ost_100653
v_smfmac_f32_16x16x64_bf16 v[96:99],v[32:35],v[144:151],v1
buffer_load_dword v120,off,s[20:23],s96 sc1
v_smfmac_f32_16x16x64_bf16 v[100:103],v[32:35],v[152:159],v1
buffer_load_dword v120,off,s[20:23],s96 sc1
v_smfmac_f32_16x16x64_bf16 v[96:99],v[36:39],v[160:167],v1
v_smfmac_f32_16x16x64_bf16 v[100:103],v[36:39],v[168:175],v1
ort_100654:
s_waitcnt vmcnt(5)
v_max3_u32 v124,v40,v41,v42
v_max_u32 v124,v124,v43
v_cmp_eq_u32 vcc,-1,v124
s_cbranch_vccnz ost_100655
v_smfmac_f32_16x16x64_bf16 v[96:99],v[40:43],v[176:183],v1
buffer_load_dword v120,off,s[20:23],s96 sc1
v_smfmac_f32_16x16x64_bf16 v[100:103],v[40:43],v[184:191],v1
ort_100656:
s_waitcnt vmcnt(5)
v_max3_u32 v124,v44,v45,v46
v_max_u32 v124,v124,v47
v_cmp_eq_u32 vcc,-1,v124
s_cbranch_vccnz ost_100657
v_smfmac_f32_16x16x64_bf16 v[96:99],v[44:47],v[192:199],v1
buffer_load_dword v120,off,s[20:23],s96 sc1
v_smfmac_f32_16x16x64_bf16 v[100:103],v[44:47],v[200:207],v1
ort_100658:
s_waitcnt vmcnt(4)
v_max3_u32 v124,v24,v25,v26
v_max3_u32 v124,v124,v27,v28
v_max3_u32 v124,v124,v29,v30
v_max_u32 v124,v124,v31
v_cmp_eq_u32 vcc,-1,v124
s_cbranch_vccnz olap2_100643
s_andn2_b32 s55,s55,12
v_smfmac_f32_16x16x64_bf16 v[96:99],v[24:27],v[80:87],v1
v_smfmac_f32_16x16x64_bf16 v[100:103],v[24:27],v[88:95],v1
v_smfmac_f32_16x16x64_bf16 v[96:99],v[28:31],v[128:135],v1
v_smfmac_f32_16x16x64_bf16 v[100:103],v[28:31],v[136:143],v1
s_cbranch_scc0 oback_100503
s_branch olap2_100643
ost_100653:
buffer_load_dwordx4 v[32:35],v0,s[20:23],s97 offen offset:0 sc1
buffer_load_dwordx4 v[36:39],v0,s[20:23],s97 offen offset:1024 sc1
s_or_b32 s55,s55,48
s_branch ort_100654
ost_100655:
buffer_load_dwordx4 v[40:43],v0,s[20:23],s97 offen offset:2048 sc1
s_or_b32 s55,s55,64
s_branch ort_100656
ost_100657:
buffer_load_dwordx4 v[44:47],v0,s[20:23],s97 offen offset:3072 sc1
s_or_b32 s55,s55,128
s_branch ort_100658
of_100494:
s_mov_b32 s55,48
buffer_load_dwordx4 v[32:35],v0,s[20:23],s97 offen offset:0 sc1
buffer_load_dwordx4 v[36:39],v0,s[20:23],s97 offen offset:1024 sc1
s_waitcnt vmcnt(3)
v_max3_u32 v124,v40,v41,v42
v_max_u32 v124,v124,v43
v_cmp_eq_u32 vcc,-1,v124
s_cbranch_vccnz ost_100660
v_smfmac_f32_16x16x64_bf16 v[96:99],v[40:43],v[176:183],v1
buffer_load_dword v120,off,s[20:23],s96 sc1
v_smfmac_f32_16x16x64_bf16 v[100:103],v[40:43],v[184:191],v1
ort_100661:
s_waitcnt vmcnt(3)
v_max3_u32 v124,v44,v45,v46
v_max_u32 v124,v124,v47
v_cmp_eq_u32 vcc,-1,v124
s_cbranch_vccnz ost_100662
v_smfmac_f32_16x16x64_bf16 v[96:99],v[44:47],v[192:199],v1
buffer_load_dword v120,off,s[20:23],s96 sc1
v_smfmac_f32_16x16x64_bf16 v[100:103],v[44:47],v[200:207],v1
ort_100663:
s_waitcnt vmcnt(2)
v_max3_u32 v124,v32,v33,v34
v_max3_u32 v124,v124,v35,v36
v_max3_u32 v124,v124,v37,v38
v_max_u32 v124,v124,v39
v_cmp_eq_u32 vcc,-1,v124
s_cbranch_vccnz olap2_100643
s_andn2_b32 s55,s55,48
v_smfmac_f32_16x16x64_bf16 v[96:99],v[32:35],v[144:151],v1
v_smfmac_f32_16x16x64_bf16 v[100:103],v[32:35],v[152:159],v1
v_smfmac_f32_16x16x64_bf16 v[96:99],v[36:39],v[160:167],v1
v_smfmac_f32_16x16x64_bf16 v[100:103],v[36:39],v[168:175],v1
s_cbranch_scc0 oback_100503
s_branch olap2_100643
ost_100660:
buffer_load_dwordx4 v[40:43],v0,s[20:23],s97 offen offset:2048 sc1
s_or_b32 s55,s55,64
s_branch ort_100661
ost_100662:
buffer_load_dwordx4 v[44:47],v0,s[20:23],s97 offen offset:3072 sc1
s_or_b32 s55,s55,128
s_branch ort_100663
of_100495:
s_mov_b32 s55,64
buffer_load_dwordx4 v[40:43],v0,s[20:23],s97 offen offset:2048 sc1
s_waitcnt vmcnt(1)
v_max3_u32 v124,v44,v45,v46
v_max_u32 v124,v124,v47
v_cmp_eq_u32 vcc,-1,v124
s_cbranch_vccnz ost_100665
v_smfmac_f32_16x16x64_bf16 v[96:99],v[44:47],v[192:199],v1
buffer_load_dword v120,off,s[20:23],s96 sc1
v_smfmac_f32_16x16x64_bf16 v[100:103],v[44:47],v[200:207],v1
ort_100666:
s_waitcnt vmcnt(1)
v_max3_u32 v124,v40,v41,v42
v_max_u32 v124,v124,v43
v_cmp_eq_u32 vcc,-1,v124
s_cbranch_vccnz olap2_100643
s_andn2_b32 s55,s55,64
v_smfmac_f32_16x16x64_bf16 v[96:99],v[40:43],v[176:183],v1
v_smfmac_f32_16x16x64_bf16 v[100:103],v[40:43],v[184:191],v1
s_cbranch_scc0 oback_100503
s_branch olap2_100643
ost_100665:
buffer_load_dwordx4 v[44:47],v0,s[20:23],s97 offen offset:3072 sc1
s_or_b32 s55,s55,128
s_branch ort_100666
of_100496:
s_mov_b32 s55,128
s_branch oslow_100502
olap2_100643:
s_bitcmp1_b32 s55,0
s_cbranch_scc0 l2s_100668
s_waitcnt vmcnt(6)
v_max3_u32 v124,v16,v17,v18
v_max3_u32 v124,v124,v19,v20
v_max3_u32 v124,v124,v21,v22
v_max_u32 v124,v124,v23
v_cmp_eq_u32 vcc,-1,v124
s_cbranch_vccnz l2s_100668
s_andn2_b32 s55,s55,3
v_smfmac_f32_16x16x64_bf16 v[96:99],v[16:19],v[48:55],v1
v_smfmac_f32_16x16x64_bf16 v[100:103],v[16:19],v[56:63],v1
v_smfmac_f32_16x16x64_bf16 v[96:99],v[20:23],v[64:71],v1
v_smfmac_f32_16x16x64_bf16 v[100:103],v[20:23],v[72:79],v1
l2s_100668:
s_bitcmp1_b32 s55,2
s_cbranch_scc0 l2s_100669
s_waitcnt vmcnt(4)
v_max3_u32 v124,v24,v25,v26
v_max3_u32 v124,v124,v27,v28
v_max3_u32 v124,v124,v29,v30
v_max_u32 v124,v124,v31
v_cmp_eq_u32 vcc,-1,v124
s_cbranch_vccnz l2s_100669
s_andn2_b32 s55,s55,12
v_smfmac_f32_16x16x64_bf16 v[96:99],v[24:27],v[80:87],v1
v_smfmac_f32_16x16x64_bf16 v[100:103],v[24:27],v[88:95],v1
v_smfmac_f32_16x16x64_bf16 v[96:99],v[28:31],v[128:135],v1
v_smfmac_f32_16x16x64_bf16 v[100:103],v[28:31],v[136:143],v1
l2s_100669:
s_bitcmp1_b32 s55,4
s_cbranch_scc0 l2s_100670
s_waitcnt vmcnt(2)
v_max3_u32 v124,v32,v33,v34
v_max3_u32 v124,v124,v35,v36
v_max3_u32 v124,v124,v37,v38
v_max_u32 v124,v124,v39
v_cmp_eq_u32 vcc,-1,v124
s_cbranch_vccnz l2s_100670
s_andn2_b32 s55,s55,48
v_smfmac_f32_16x16x64_bf16 v[96:99],v[32:35],v[144:151],v1
v_smfmac_f32_16x16x64_bf16 v[100:103],v[32:35],v[152:159],v1
v_smfmac_f32_16x16x64_bf16 v[96:99],v[36:39],v[160:167],v1
v_smfmac_f32_16x16x64_bf16 v[100:103],v[36:39],v[168:175],v1
l2s_100670:
s_bitcmp1_b32 s55,6
s_cbranch_scc0 l2s_100671
s_waitcnt vmcnt(1)
v_max3_u32 v124,v40,v41,v42
v_max_u32 v124,v124,v43
v_cmp_eq_u32 vcc,-1,v124
s_cbranch_vccnz l2s_100671
s_andn2_b32 s55,s55,64
v_smfmac_f32_16x16x64_bf16 v[96:99],v[40:43],v[176:183],v1
v_smfmac_f32_16x16x64_bf16 v[100:103],v[40:43],v[184:191],v1
l2s_100671:
s_bitcmp1_b32 s55,7
s_cbranch_scc0 l2s_100672
s_waitcnt vmcnt(0)
v_max3_u32 v124,v44,v45,v46
v_max_u32 v124,v124,v47
v_cmp_eq_u32 vcc,-1,v124
s_cbranch_vccnz l2s_100672
s_andn2_b32 s55,s55,128
v_smfmac_f32_16x16x64_bf16 v[96:99],v[44:47],v[192:199],v1
v_smfmac_f32_16x16x64_bf16 v[100:103],v[44:47],v[200:207],v1
l2s_100672:
s_cmp_eq_u32 s55,0
s_cbranch_scc1 oback_100503
oslow_100502:
s_bitcmp1_b32 s55,0
s_cbranch_scc0 dsk_100673
buffer_load_dwordx4 v[16:19],v0,s[20:23],s96 offen offset:0 sc1
dsk_100673:
s_bitcmp1_b32 s55,1
s_cbranch_scc0 dsk_100674
buffer_load_dwordx4 v[20:23],v0,s[20:23],s96 offen offset:1024 sc1
dsk_100674:
s_bitcmp1_b32 s55,2
s_cbranch_scc0 dsk_100675
buffer_load_dwordx4 v[24:27],v0,s[20:23],s96 offen offset:2048 sc1
dsk_100675:
s_bitcmp1_b32 s55,3
s_cbranch_scc0 dsk_100676
buffer_load_dwordx4 v[28:31],v0,s[20:23],s96 offen offset:3072 sc1
dsk_100676:
s_bitcmp1_b32 s55,4
s_cbranch_scc0 dsk_100677
buffer_load_dwordx4 v[32:35],v0,s[20:23],s97 offen offset:0 sc1
dsk_100677:
s_bitcmp1_b32 s55,5
s_cbranch_scc0 dsk_100678
buffer_load_dwordx4 v[36:39],v0,s[20:23],s97 offen offset:1024 sc1
dsk_100678:
s_bitcmp1_b32 s55,6
s_cbranch_scc0 dsk_100679
buffer_load_dwordx4 v[40:43],v0,s[20:23],s97 offen offset:2048 sc1
dsk_100679:
s_bitcmp1_b32 s55,7
s_cbranch_scc0 dsk_100680
buffer_load_dwordx4 v[44:47],v0,s[20:23],s97 offen offset:3072 sc1
dsk_100680:
s_bitcmp1_b32 s55,0
s_cbranch_scc0 dsk_100681
s_waitcnt vmcnt(2)
v_max3_u32 v124,v16,v17,v18
v_max_u32 v124,v124,v19
v_cmp_eq_u32 vcc,-1,v124
s_cbranch_vccz dgo_100682
s_nop 15
buffer_load_dwordx4 v[116:119],v0,s[20:23],s96 offen offset:0 sc1
s_nop 15
buffer_load_dwordx4 v[120:123],v0,s[20:23],s96 offen offset:0 sc1
dlp_100683:
s_waitcnt vmcnt(2)
v_max3_u32 v124,v16,v17,v18
v_max_u32 v124,v124,v19
v_cmp_eq_u32 vcc,-1,v124
s_cbranch_vccz dgo_100682
buffer_load_dwordx4 v[16:19],v0,s[20:23],s96 offen offset:0 sc1
s_waitcnt vmcnt(2)
v_max3_u32 v124,v116,v117,v118
v_max_u32 v124,v124,v119
v_cmp_eq_u32 vcc,-1,v124
s_cbranch_vccz dcp_100685
buffer_load_dwordx4 v[116:119],v0,s[20:23],s96 offen offset:0 sc1
s_waitcnt vmcnt(2)
v_max3_u32 v124,v120,v121,v122
v_max_u32 v124,v124,v123
v_cmp_eq_u32 vcc,-1,v124
s_cbranch_vccz dcp_100686
buffer_load_dwordx4 v[120:123],v0,s[20:23],s96 offen offset:0 sc1
s_sub_u32 s90,s90,1
s_cmp_gt_i32 s90,0
s_cbranch_scc1 dlp_100683
s_branch dgo_100682
dcp_100685:
v_mov_b32 v16,v116
v_mov_b32 v17,v117
v_mov_b32 v18,v118
v_mov_b32 v19,v119
s_nop 1
s_branch dgo_100682
dcp_100686:
v_mov_b32 v16,v120
v_mov_b32 v17,v121
v_mov_b32 v18,v122
v_mov_b32 v19,v123
s_nop 1
dgo_100682:
v_smfmac_f32_16x16x64_bf16 v[96:99],v[16:19],v[48:55],v1
v_smfmac_f32_16x16x64_bf16 v[100:103],v[16:19],v[56:63],v1
dsk_100681:
s_bitcmp1_b32 s55,1
s_cbranch_scc0 dsk_100687
s_waitcnt vmcnt(2)
v_max3_u32 v124,v20,v21,v22
v_max_u32 v124,v124,v23
v_cmp_eq_u32 vcc,-1,v124
s_cbranch_vccz dgo_100688
s_nop 15
buffer_load_dwordx4 v[116:119],v0,s[20:23],s96 offen offset:1024 sc1
s_nop 15
buffer_load_dwordx4 v[120:123],v0,s[20:23],s96 offen offset:1024 sc1
dlp_100689:
s_waitcnt vmcnt(2)
v_max3_u32 v124,v20,v21,v22
v_max_u32 v124,v124,v23
v_cmp_eq_u32 vcc,-1,v124
s_cbranch_vccz dgo_100688
buffer_load_dwordx4 v[20:23],v0,s[20:23],s96 offen offset:1024 sc1
s_waitcnt vmcnt(2)
v_max3_u32 v124,v116,v117,v118
v_max_u32 v124,v124,v119
v_cmp_eq_u32 vcc,-1,v124
s_cbranch_vccz dcp_100691
buffer_load_dwordx4 v[116:119],v0,s[20:23],s96 offen offset:1024 sc1
s_waitcnt vmcnt(2)
v_max3_u32 v124,v120,v121,v122
v_max_u32 v124,v124,v123
v_cmp_eq_u32 vcc,-1,v124
s_cbranch_vccz dcp_100692
buffer_load_dwordx4 v[120:123],v0,s[20:23],s96 offen offset:1024 sc1
s_sub_u32 s90,s90,1
s_cmp_gt_i32 s90,0
s_cbranch_scc1 dlp_100689
s_branch dgo_100688
dcp_100691:
v_mov_b32 v20,v116
v_mov_b32 v21,v117
v_mov_b32 v22,v118
v_mov_b32 v23,v119
s_nop 1
s_branch dgo_100688
dcp_100692:
v_mov_b32 v20,v120
v_mov_b32 v21,v121
v_mov_b32 v22,v122
v_mov_b32 v23,v123
s_nop 1
dgo_100688:
v_smfmac_f32_16x16x64_bf16 v[96:99],v[20:23],v[64:71],v1
v_smfmac_f32_16x16x64_bf16 v[100:103],v[20:23],v[72:79],v1
dsk_100687:
s_bitcmp1_b32 s55,2
s_cbranch_scc0 dsk_100693
s_waitcnt vmcnt(2)
v_max3_u32 v124,v24,v25,v26
v_max_u32 v124,v124,v27
v_cmp_eq_u32 vcc,-1,v124
s_cbranch_vccz dgo_100694
s_nop 15
buffer_load_dwordx4 v[116:119],v0,s[20:23],s96 offen offset:2048 sc1
s_nop 15
buffer_load_dwordx4 v[120:123],v0,s[20:23],s96 offen offset:2048 sc1
dlp_100695:
s_waitcnt vmcnt(2)
v_max3_u32 v124,v24,v25,v26
v_max_u32 v124,v124,v27
v_cmp_eq_u32 vcc,-1,v124
s_cbranch_vccz dgo_100694
buffer_load_dwordx4 v[24:27],v0,s[20:23],s96 offen offset:2048 sc1
s_waitcnt vmcnt(2)
v_max3_u32 v124,v116,v117,v118
v_max_u32 v124,v124,v119
v_cmp_eq_u32 vcc,-1,v124
s_cbranch_vccz dcp_100697
buffer_load_dwordx4 v[116:119],v0,s[20:23],s96 offen offset:2048 sc1
s_waitcnt vmcnt(2)
v_max3_u32 v124,v120,v121,v122
v_max_u32 v124,v124,v123
v_cmp_eq_u32 vcc,-1,v124
s_cbranch_vccz dcp_100698
buffer_load_dwordx4 v[120:123],v0,s[20:23],s96 offen offset:2048 sc1
s_sub_u32 s90,s90,1
s_cmp_gt_i32 s90,0
s_cbranch_scc1 dlp_100695
s_branch dgo_100694
dcp_100697:
v_mov_b32 v24,v116
v_mov_b32 v25,v117
v_mov_b32 v26,v118
v_mov_b32 v27,v119
s_nop 1
s_branch dgo_100694
dcp_100698:
v_mov_b32 v24,v120
v_mov_b32 v25,v121
v_mov_b32 v26,v122
v_mov_b32 v27,v123
s_nop 1
dgo_100694:
v_smfmac_f32_16x16x64_bf16 v[96:99],v[24:27],v[80:87],v1
v_smfmac_f32_16x16x64_bf16 v[100:103],v[24:27],v[88:95],v1
dsk_100693:
s_bitcmp1_b32 s55,3
s_cbranch_scc0 dsk_100699
s_waitcnt vmcnt(2)
v_max3_u32 v124,v28,v29,v30
v_max_u32 v124,v124,v31
v_cmp_eq_u32 vcc,-1,v124
s_cbranch_vccz dgo_100700
s_nop 15
buffer_load_dwordx4 v[116:119],v0,s[20:23],s96 offen offset:3072 sc1
s_nop 15
buffer_load_dwordx4 v[120:123],v0,s[20:23],s96 offen offset:3072 sc1
dlp_100701:
s_waitcnt vmcnt(2)
v_max3_u32 v124,v28,v29,v30
v_max_u32 v124,v124,v31
v_cmp_eq_u32 vcc,-1,v124
s_cbranch_vccz dgo_100700
buffer_load_dwordx4 v[28:31],v0,s[20:23],s96 offen offset:3072 sc1
s_waitcnt vmcnt(2)
v_max3_u32 v124,v116,v117,v118
v_max_u32 v124,v124,v119
v_cmp_eq_u32 vcc,-1,v124
s_cbranch_vccz dcp_100703
buffer_load_dwordx4 v[116:119],v0,s[20:23],s96 offen offset:3072 sc1
s_waitcnt vmcnt(2)
v_max3_u32 v124,v120,v121,v122
v_max_u32 v124,v124,v123
v_cmp_eq_u32 vcc,-1,v124
s_cbranch_vccz dcp_100704
buffer_load_dwordx4 v[120:123],v0,s[20:23],s96 offen offset:3072 sc1
s_sub_u32 s90,s90,1
s_cmp_gt_i32 s90,0
s_cbranch_scc1 dlp_100701
s_branch dgo_100700
dcp_100703:
v_mov_b32 v28,v116
v_mov_b32 v29,v117
v_mov_b32 v30,v118
v_mov_b32 v31,v119
s_nop 1
s_branch dgo_100700
dcp_100704:
v_mov_b32 v28,v120
v_mov_b32 v29,v121
v_mov_b32 v30,v122
v_mov_b32 v31,v123
s_nop 1
dgo_100700:
v_smfmac_f32_16x16x64_bf16 v[96:99],v[28:31],v[128:135],v1
v_smfmac_f32_16x16x64_bf16 v[100:103],v[28:31],v[136:143],v1
dsk_100699:
s_bitcmp1_b32 s55,4
s_cbranch_scc0 dsk_100705
s_waitcnt vmcnt(2)
v_max3_u32 v124,v32,v33,v34
v_max_u32 v124,v124,v35
v_cmp_eq_u32 vcc,-1,v124
s_cbranch_vccz dgo_100706
s_nop 15
buffer_load_dwordx4 v[116:119],v0,s[20:23],s97 offen offset:0 sc1
s_nop 15
buffer_load_dwordx4 v[120:123],v0,s[20:23],s97 offen offset:0 sc1
dlp_100707:
s_waitcnt vmcnt(2)
v_max3_u32 v124,v32,v33,v34
v_max_u32 v124,v124,v35
v_cmp_eq_u32 vcc,-1,v124
s_cbranch_vccz dgo_100706
buffer_load_dwordx4 v[32:35],v0,s[20:23],s97 offen offset:0 sc1
s_waitcnt vmcnt(2)
v_max3_u32 v124,v116,v117,v118
v_max_u32 v124,v124,v119
v_cmp_eq_u32 vcc,-1,v124
s_cbranch_vccz dcp_100709
buffer_load_dwordx4 v[116:119],v0,s[20:23],s97 offen offset:0 sc1
s_waitcnt vmcnt(2)
v_max3_u32 v124,v120,v121,v122
v_max_u32 v124,v124,v123
v_cmp_eq_u32 vcc,-1,v124
s_cbranch_vccz dcp_100710
buffer_load_dwordx4 v[120:123],v0,s[20:23],s97 offen offset:0 sc1
s_sub_u32 s90,s90,1
s_cmp_gt_i32 s90,0
s_cbranch_scc1 dlp_100707
s_branch dgo_100706
dcp_100709:
v_mov_b32 v32,v116
v_mov_b32 v33,v117
v_mov_b32 v34,v118
v_mov_b32 v35,v119
s_nop 1
s_branch dgo_100706
dcp_100710:
v_mov_b32 v32,v120
v_mov_b32 v33,v121
v_mov_b32 v34,v122
v_mov_b32 v35,v123
s_nop 1
dgo_100706:
v_smfmac_f32_16x16x64_bf16 v[96:99],v[32:35],v[144:151],v1
v_smfmac_f32_16x16x64_bf16 v[100:103],v[32:35],v[152:159],v1
dsk_100705:
s_bitcmp1_b32 s55,5
s_cbranch_scc0 dsk_100711
s_waitcnt vmcnt(2)
v_max3_u32 v124,v36,v37,v38
v_max_u32 v124,v124,v39
v_cmp_eq_u32 vcc,-1,v124
s_cbranch_vccz dgo_100712
s_nop 15
buffer_load_dwordx4 v[116:119],v0,s[20:23],s97 offen offset:1024 sc1
s_nop 15
buffer_load_dwordx4 v[120:123],v0,s[20:23],s97 offen offset:1024 sc1
dlp_100713:
s_waitcnt vmcnt(2)
v_max3_u32 v124,v36,v37,v38
v_max_u32 v124,v124,v39
v_cmp_eq_u32 vcc,-1,v124
s_cbranch_vccz dgo_100712
buffer_load_dwordx4 v[36:39],v0,s[20:23],s97 offen offset:1024 sc1
s_waitcnt vmcnt(2)
v_max3_u32 v124,v116,v117,v118
v_max_u32 v124,v124,v119
v_cmp_eq_u32 vcc,-1,v124
s_cbranch_vccz dcp_100715
buffer_load_dwordx4 v[116:119],v0,s[20:23],s97 offen offset:1024 sc1
s_waitcnt vmcnt(2)
v_max3_u32 v124,v120,v121,v122
v_max_u32 v124,v124,v123
v_cmp_eq_u32 vcc,-1,v124
s_cbranch_vccz dcp_100716
buffer_load_dwordx4 v[120:123],v0,s[20:23],s97 offen offset:1024 sc1
s_sub_u32 s90,s90,1
s_cmp_gt_i32 s90,0
s_cbranch_scc1 dlp_100713
s_branch dgo_100712
dcp_100715:
v_mov_b32 v36,v116
v_mov_b32 v37,v117
v_mov_b32 v38,v118
v_mov_b32 v39,v119
s_nop 1
s_branch dgo_100712
dcp_100716:
v_mov_b32 v36,v120
v_mov_b32 v37,v121
v_mov_b32 v38,v122
v_mov_b32 v39,v123
s_nop 1
dgo_100712:
v_smfmac_f32_16x16x64_bf16 v[96:99],v[36:39],v[160:167],v1
v_smfmac_f32_16x16x64_bf16 v[100:103],v[36:39],v[168:175],v1
dsk_100711:
s_bitcmp1_b32 s55,6
s_cbranch_scc0 dsk_100717
s_waitcnt vmcnt(2)
v_max3_u32 v124,v40,v41,v42
v_max_u32 v124,v124,v43
v_cmp_eq_u32 vcc,-1,v124
s_cbranch_vccz dgo_100718
s_nop 15
buffer_load_dwordx4 v[116:119],v0,s[20:23],s97 offen offset:2048 sc1
s_nop 15
buffer_load_dwordx4 v[120:123],v0,s[20:23],s97 offen offset:2048 sc1
dlp_100719:
s_waitcnt vmcnt(2)
v_max3_u32 v124,v40,v41,v42
v_max_u32 v124,v124,v43
v_cmp_eq_u32 vcc,-1,v124
s_cbranch_vccz dgo_100718
buffer_load_dwordx4 v[40:43],v0,s[20:23],s97 offen offset:2048 sc1
s_waitcnt vmcnt(2)
v_max3_u32 v124,v116,v117,v118
v_max_u32 v124,v124,v119
v_cmp_eq_u32 vcc,-1,v124
s_cbranch_vccz dcp_100721
buffer_load_dwordx4 v[116:119],v0,s[20:23],s97 offen offset:2048 sc1
s_waitcnt vmcnt(2)
v_max3_u32 v124,v120,v121,v122
v_max_u32 v124,v124,v123
v_cmp_eq_u32 vcc,-1,v124
s_cbranch_vccz dcp_100722
buffer_load_dwordx4 v[120:123],v0,s[20:23],s97 offen offset:2048 sc1
s_sub_u32 s90,s90,1
s_cmp_gt_i32 s90,0
s_cbranch_scc1 dlp_100719
s_branch dgo_100718
dcp_100721:
v_mov_b32 v40,v116
v_mov_b32 v41,v117
v_mov_b32 v42,v118
v_mov_b32 v43,v119
s_nop 1
s_branch dgo_100718
dcp_100722:
v_mov_b32 v40,v120
v_mov_b32 v41,v121
v_mov_b32 v42,v122
v_mov_b32 v43,v123
s_nop 1
dgo_100718:
v_smfmac_f32_16x16x64_bf16 v[96:99],v[40:43],v[176:183],v1
v_smfmac_f32_16x16x64_bf16 v[100:103],v[40:43],v[184:191],v1
dsk_100717:
s_bitcmp1_b32 s55,7
s_cbranch_scc0 dsk_100723
s_waitcnt vmcnt(2)
v_max3_u32 v124,v44,v45,v46
v_max_u32 v124,v124,v47
v_cmp_eq_u32 vcc,-1,v124
s_cbranch_vccz dgo_100724
s_nop 15
buffer_load_dwordx4 v[116:119],v0,s[20:23],s97 offen offset:3072 sc1
s_nop 15
buffer_load_dwordx4 v[120:123],v0,s[20:23],s97 offen offset:3072 sc1
dlp_100725:
s_waitcnt vmcnt(2)
v_max3_u32 v124,v44,v45,v46
v_max_u32 v124,v124,v47
v_cmp_eq_u32 vcc,-1,v124
s_cbranch_vccz dgo_100724
buffer_load_dwordx4 v[44:47],v0,s[20:23],s97 offen offset:3072 sc1
s_waitcnt vmcnt(2)
v_max3_u32 v124,v116,v117,v118
v_max_u32 v124,v124,v119
v_cmp_eq_u32 vcc,-1,v124
s_cbranch_vccz dcp_100727
buffer_load_dwordx4 v[116:119],v0,s[20:23],s97 offen offset:3072 sc1
s_waitcnt vmcnt(2)
v_max3_u32 v124,v120,v121,v122
v_max_u32 v124,v124,v123
v_cmp_eq_u32 vcc,-1,v124
s_cbranch_vccz dcp_100728
buffer_load_dwordx4 v[120:123],v0,s[20:23],s97 offen offset:3072 sc1
s_sub_u32 s90,s90,1
s_cmp_gt_i32 s90,0
s_cbranch_scc1 dlp_100725
s_branch dgo_100724
dcp_100727:
v_mov_b32 v44,v116
v_mov_b32 v45,v117
v_mov_b32 v46,v118
v_mov_b32 v47,v119
s_nop 1
s_branch dgo_100724
dcp_100728:
v_mov_b32 v44,v120
v_mov_b32 v45,v121
v_mov_b32 v46,v122
v_mov_b32 v47,v123
s_nop 1
dgo_100724:
v_smfmac_f32_16x16x64_bf16 v[96:99],v[44:47],v[192:199],v1
v_smfmac_f32_16x16x64_bf16 v[100:103],v[44:47],v[200:207],v1
dsk_100723:
s_mov_b32 s55,0
s_branch oback_100503
fl_100520:
flb_100528:
buffer_load_dwordx4 v[16:19],v0,s[20:23],s92 offen offset:0 sc1
s_mov_b32 s55,1
buffer_load_dwordx4 v[32:35],v0,s[20:23],s93 offen offset:0 sc1
s_waitcnt vmcnt(4)
v_max3_u32 v124,v20,v21,v22
v_max_u32 v124,v124,v23
v_cmp_eq_u32 vcc,-1,v124
s_cbranch_vccnz dfl_100729
v_smfmac_f32_16x16x64_bf16 v[64:67],v[20:23],a[96:103],v1
buffer_load_dword v125,off,s[20:23],s92 sc1
buffer_load_dwordx4 v[36:39],v0,s[20:23],s93 offen offset:1024 sc1
s_waitcnt vmcnt(5)
v_max3_u32 v124,v24,v25,v26
v_smfmac_f32_16x16x64_bf16 v[68:71],v[20:23],a[104:111],v1
v_max_u32 v124,v124,v27
v_cmp_eq_u32 vcc,-1,v124
v_smfmac_f32_16x16x64_bf16 v[72:75],v[20:23],a[112:119],v1
v_smfmac_f32_16x16x64_bf16 v[76:79],v[20:23],a[120:127],v1
s_cbranch_vccnz dfl_100730
v_smfmac_f32_16x16x64_bf16 v[64:67],v[24:27],a[160:167],v1
buffer_load_dword v125,off,s[20:23],s92 sc1
buffer_load_dwordx4 v[40:43],v0,s[20:23],s93 offen offset:2048 sc1
buffer_load_dwordx4 v[44:47],v0,s[20:23],s93 offen offset:3072 sc1
s_waitcnt vmcnt(7)
v_max3_u32 v124,v28,v29,v30
v_smfmac_f32_16x16x64_bf16 v[68:71],v[24:27],a[168:175],v1
v_max_u32 v124,v124,v31
v_cmp_eq_u32 vcc,-1,v124
v_smfmac_f32_16x16x64_bf16 v[72:75],v[24:27],a[176:183],v1
v_smfmac_f32_16x16x64_bf16 v[76:79],v[24:27],a[184:191],v1
s_cbranch_vccnz dfl_100731
v_smfmac_f32_16x16x64_bf16 v[64:67],v[28:31],a[224:231],v1
buffer_load_dword v125,off,s[20:23],s92 sc1
buffer_store_dword v126,v121,s[20:23],s69 offen sc1
s_waitcnt vmcnt(8)
v_max3_u32 v124,v16,v17,v18
v_smfmac_f32_16x16x64_bf16 v[68:71],v[28:31],a[232:239],v1
v_max_u32 v124,v124,v19
v_cmp_eq_u32 vcc,-1,v124
v_smfmac_f32_16x16x64_bf16 v[72:75],v[28:31],a[240:247],v1
v_smfmac_f32_16x16x64_bf16 v[76:79],v[28:31],a[248:255],v1
s_cbranch_vccnz lfb_100736
s_mov_b32 s55,0
v_smfmac_f32_16x16x64_bf16 v[64:67],v[16:19],a[32:39],v1
s_waitcnt vmcnt(7)
v_max3_u32 v124,v32,v33,v34
v_max_u32 v124,v124,v35
v_cmp_eq_u32 vcc,-1,v124
v_smfmac_f32_16x16x64_bf16 v[68:71],v[16:19],a[40:47],v1
v_smfmac_f32_16x16x64_bf16 v[72:75],v[16:19],a[48:55],v1
v_smfmac_f32_16x16x64_bf16 v[76:79],v[16:19],a[56:63],v1
s_cbranch_vccnz flb_100532
s_branch segb_100516
fl_100521:
flb_100529:
buffer_load_dwordx4 v[20:23],v0,s[20:23],s92 offen offset:1024 sc1
s_mov_b32 s55,2
buffer_load_dwordx4 v[36:39],v0,s[20:23],s93 offen offset:1024 sc1
s_waitcnt vmcnt(5)
v_max3_u32 v124,v24,v25,v26
v_max_u32 v124,v124,v27
v_cmp_eq_u32 vcc,-1,v124
s_cbranch_vccnz dfl_100730
v_smfmac_f32_16x16x64_bf16 v[64:67],v[24:27],a[160:167],v1
buffer_load_dword v125,off,s[20:23],s92 sc1
buffer_load_dwordx4 v[40:43],v0,s[20:23],s93 offen offset:2048 sc1
buffer_load_dwordx4 v[44:47],v0,s[20:23],s93 offen offset:3072 sc1
s_waitcnt vmcnt(7)
v_max3_u32 v124,v28,v29,v30
v_smfmac_f32_16x16x64_bf16 v[68:71],v[24:27],a[168:175],v1
v_max_u32 v124,v124,v31
v_cmp_eq_u32 vcc,-1,v124
v_smfmac_f32_16x16x64_bf16 v[72:75],v[24:27],a[176:183],v1
v_smfmac_f32_16x16x64_bf16 v[76:79],v[24:27],a[184:191],v1
s_cbranch_vccnz dfl_100731
v_smfmac_f32_16x16x64_bf16 v[64:67],v[28:31],a[224:231],v1
buffer_load_dword v125,off,s[20:23],s92 sc1
buffer_store_dword v126,v121,s[20:23],s69 offen sc1
s_waitcnt vmcnt(6)
v_max3_u32 v124,v20,v21,v22
v_smfmac_f32_16x16x64_bf16 v[68:71],v[28:31],a[232:239],v1
v_max_u32 v124,v124,v23
v_cmp_eq_u32 vcc,-1,v124
v_smfmac_f32_16x16x64_bf16 v[72:75],v[28:31],a[240:247],v1
v_smfmac_f32_16x16x64_bf16 v[76:79],v[28:31],a[248:255],v1
s_cbranch_vccnz lfb_100736
s_mov_b32 s55,0
v_smfmac_f32_16x16x64_bf16 v[64:67],v[20:23],a[96:103],v1
s_waitcnt vmcnt(7)
v_max3_u32 v124,v32,v33,v34
v_max_u32 v124,v124,v35
v_cmp_eq_u32 vcc,-1,v124
v_smfmac_f32_16x16x64_bf16 v[68:71],v[20:23],a[104:111],v1
v_smfmac_f32_16x16x64_bf16 v[72:75],v[20:23],a[112:119],v1
v_smfmac_f32_16x16x64_bf16 v[76:79],v[20:23],a[120:127],v1
s_cbranch_vccnz flb_100532
s_branch segb_100516
fl_100522:
flb_100530:
buffer_load_dwordx4 v[24:27],v0,s[20:23],s92 offen offset:2048 sc1
s_mov_b32 s55,4
buffer_load_dwordx4 v[40:43],v0,s[20:23],s93 offen offset:2048 sc1
buffer_load_dwordx4 v[44:47],v0,s[20:23],s93 offen offset:3072 sc1
s_waitcnt vmcnt(7)
v_max3_u32 v124,v28,v29,v30
v_max_u32 v124,v124,v31
v_cmp_eq_u32 vcc,-1,v124
s_cbranch_vccnz dfl_100731
v_smfmac_f32_16x16x64_bf16 v[64:67],v[28:31],a[224:231],v1
buffer_load_dword v125,off,s[20:23],s92 sc1
buffer_store_dword v126,v121,s[20:23],s69 offen sc1
s_waitcnt vmcnt(4)
v_max3_u32 v124,v24,v25,v26
v_smfmac_f32_16x16x64_bf16 v[68:71],v[28:31],a[232:239],v1
v_max_u32 v124,v124,v27
v_cmp_eq_u32 vcc,-1,v124
v_smfmac_f32_16x16x64_bf16 v[72:75],v[28:31],a[240:247],v1
v_smfmac_f32_16x16x64_bf16 v[76:79],v[28:31],a[248:255],v1
s_cbranch_vccnz lfb_100736
s_mov_b32 s55,0
v_smfmac_f32_16x16x64_bf16 v[64:67],v[24:27],a[160:167],v1
s_waitcnt vmcnt(7)
v_max3_u32 v124,v32,v33,v34
v_max_u32 v124,v124,v35
v_cmp_eq_u32 vcc,-1,v124
v_smfmac_f32_16x16x64_bf16 v[68:71],v[24:27],a[168:175],v1
v_smfmac_f32_16x16x64_bf16 v[72:75],v[24:27],a[176:183],v1
v_smfmac_f32_16x16x64_bf16 v[76:79],v[24:27],a[184:191],v1
s_cbranch_vccnz flb_100532
s_branch segb_100516
fl_100523:
flb_100531:
buffer_load_dwordx4 v[28:31],v0,s[20:23],s92 offen offset:3072 sc1
s_mov_b32 s55,8
buffer_store_dword v126,v121,s[20:23],s69 offen sc1
s_waitcnt vmcnt(1)
v_max3_u32 v124,v28,v29,v30
v_max_u32 v124,v124,v31
v_cmp_eq_u32 vcc,-1,v124
s_cbranch_vccnz lfb_100736
s_mov_b32 s55,0
v_smfmac_f32_16x16x64_bf16 v[64:67],v[28:31],a[224:231],v1
s_waitcnt vmcnt(7)
v_max3_u32 v124,v32,v33,v34
v_max_u32 v124,v124,v35
v_cmp_eq_u32 vcc,-1,v124
v_smfmac_f32_16x16x64_bf16 v[68:71],v[28:31],a[232:239],v1
v_smfmac_f32_16x16x64_bf16 v[72:75],v[28:31],a[240:247],v1
v_smfmac_f32_16x16x64_bf16 v[76:79],v[28:31],a[248:255],v1
s_cbranch_vccnz flb_100532
s_branch segb_100516
fl_100524:
flb_100532:
buffer_load_dwordx4 v[32:35],v0,s[20:23],s93 offen offset:0 sc1
s_mov_b32 s55,240
s_bitcmp1_b32 s55,5
s_cbranch_scc0 rdn_100739
s_waitcnt vmcnt(6)
v_max3_u32 v124,v36,v37,v38
v_max_u32 v124,v124,v39
v_cmp_eq_u32 vcc,-1,v124
s_cbranch_vccnz rfa_100740
buffer_load_dword v125,off,s[20:23],s92 sc1
s_bitset0_b32 s55,5
v_smfmac_f32_16x16x64_bf16 v[64:67],v[36:39],a[96:103],v1
v_smfmac_f32_16x16x64_bf16 v[68:71],v[36:39],a[104:111],v1
v_smfmac_f32_16x16x64_bf16 v[72:75],v[36:39],a[112:119],v1
v_smfmac_f32_16x16x64_bf16 v[76:79],v[36:39],a[120:127],v1
s_cmp_eq_u32 s55,0
s_cbranch_scc1 segb_100518
s_branch rnx_100741
rdn_100739:
buffer_load_dword v125,off,s[20:23],s92 sc1
s_branch rnx_100741
rfa_100740:
buffer_load_dwordx4 v[36:39],v0,s[20:23],s93 offen offset:1024 sc1
rnx_100741:
s_bitcmp1_b32 s55,6
s_cbranch_scc0 rdn_100742
s_waitcnt vmcnt(5)
v_max3_u32 v124,v40,v41,v42
v_max_u32 v124,v124,v43
v_cmp_eq_u32 vcc,-1,v124
s_cbranch_vccnz rfa_100743
buffer_load_dword v125,off,s[20:23],s92 sc1
s_bitset0_b32 s55,6
s_cmp_eq_u32 s55,0
s_cbranch_scc1 segb_100518
s_branch rnx_100744
rdn_100742:
buffer_load_dword v125,off,s[20:23],s92 sc1
s_branch rnx_100744
rfa_100743:
buffer_load_dwordx4 v[40:43],v0,s[20:23],s93 offen offset:2048 sc1
rnx_100744:
s_bitcmp1_b32 s55,7
s_cbranch_scc0 rdn_100745
s_waitcnt vmcnt(5)
v_max3_u32 v124,v44,v45,v46
v_max_u32 v124,v124,v47
v_cmp_eq_u32 vcc,-1,v124
s_cbranch_vccnz rfa_100746
buffer_load_dword v125,off,s[20:23],s92 sc1
s_bitset0_b32 s55,7
s_cmp_eq_u32 s55,0
s_cbranch_scc1 segb_100518
s_branch rnx_100747
rdn_100745:
buffer_load_dword v125,off,s[20:23],s92 sc1
s_branch rnx_100747
rfa_100746:
buffer_load_dwordx4 v[44:47],v0,s[20:23],s93 offen offset:3072 sc1
rnx_100747:
rot_100738:
s_bitcmp1_b32 s55,4
s_cbranch_scc0 rdn_100748
s_waitcnt vmcnt(3)
v_max3_u32 v124,v32,v33,v34
v_max_u32 v124,v124,v35
v_cmp_eq_u32 vcc,-1,v124
s_cbranch_vccnz rfa_100749
buffer_load_dword v125,off,s[20:23],s92 sc1
s_bitset0_b32 s55,4
v_smfmac_f32_16x16x64_bf16 v[64:67],v[32:35],a[32:39],v1
v_smfmac_f32_16x16x64_bf16 v[68:71],v[32:35],a[40:47],v1
v_smfmac_f32_16x16x64_bf16 v[72:75],v[32:35],a[48:55],v1
v_smfmac_f32_16x16x64_bf16 v[76:79],v[32:35],a[56:63],v1
s_cmp_eq_u32 s55,0
s_cbranch_scc1 segb_100518
s_branch rnx_100750
rdn_100748:
buffer_load_dword v125,off,s[20:23],s92 sc1
s_branch rnx_100750
rfa_100749:
buffer_load_dwordx4 v[32:35],v0,s[20:23],s93 offen offset:0 sc1
rnx_100750:
s_bitcmp1_b32 s55,5
s_cbranch_scc0 rdn_100751
s_waitcnt vmcnt(3)
v_max3_u32 v124,v36,v37,v38
v_max_u32 v124,v124,v39
v_cmp_eq_u32 vcc,-1,v124
s_cbranch_vccnz rfa_100752
buffer_load_dword v125,off,s[20:23],s92 sc1
s_bitset0_b32 s55,5
v_smfmac_f32_16x16x64_bf16 v[64:67],v[36:39],a[96:103],v1
v_smfmac_f32_16x16x64_bf16 v[68:71],v[36:39],a[104:111],v1
v_smfmac_f32_16x16x64_bf16 v[72:75],v[36:39],a[112:119],v1
v_smfmac_f32_16x16x64_bf16 v[76:79],v[36:39],a[120:127],v1
s_cmp_eq_u32 s55,0
s_cbranch_scc1 segb_100518
s_branch rnx_100753
rdn_100751:
buffer_load_dword v125,off,s[20:23],s92 sc1
s_branch rnx_100753
rfa_100752:
buffer_load_dwordx4 v[36:39],v0,s[20:23],s93 offen offset:1024 sc1
rnx_100753:
s_bitcmp1_b32 s55,6
s_cbranch_scc0 rdn_100754
s_waitcnt vmcnt(3)
v_max3_u32 v124,v40,v41,v42
v_max_u32 v124,v124,v43
v_cmp_eq_u32 vcc,-1,v124
s_cbranch_vccnz rfa_100755
buffer_load_dword v125,off,s[20:23],s92 sc1
s_bitset0_b32 s55,6
s_cmp_eq_u32 s55,0
s_cbranch_scc1 segb_100518
s_branch rnx_100756
rdn_100754:
buffer_load_dword v125,off,s[20:23],s92 sc1
s_branch rnx_100756
rfa_100755:
buffer_load_dwordx4 v[40:43],v0,s[20:23],s93 offen offset:2048 sc1
rnx_100756:
s_bitcmp1_b32 s55,7
s_cbranch_scc0 rdn_100757
s_waitcnt vmcnt(3)
v_max3_u32 v124,v44,v45,v46
v_max_u32 v124,v124,v47
v_cmp_eq_u32 vcc,-1,v124
s_cbranch_vccnz rfa_100758
buffer_load_dword v125,off,s[20:23],s92 sc1
s_bitset0_b32 s55,7
s_cmp_eq_u32 s55,0
s_cbranch_scc1 segb_100518
s_branch rnx_100759
rdn_100757:
buffer_load_dword v125,off,s[20:23],s92 sc1
s_branch rnx_100759
rfa_100758:
buffer_load_dwordx4 v[44:47],v0,s[20:23],s93 offen offset:3072 sc1
rnx_100759:
s_sub_u32 s90,s90,1
s_cmp_gt_i32 s90,0
s_cbranch_scc1 rot_100738
s_mov_b32 s55,0
s_branch segb_100518
fl_100525:
flb_100533:
buffer_load_dwordx4 v[36:39],v0,s[20:23],s93 offen offset:1024 sc1
s_mov_b32 s55,224
s_bitcmp1_b32 s55,6
s_cbranch_scc0 rdn_100761
s_waitcnt vmcnt(5)
v_max3_u32 v124,v40,v41,v42
v_max_u32 v124,v124,v43
v_cmp_eq_u32 vcc,-1,v124
s_cbranch_vccnz rfa_100762
buffer_load_dword v125,off,s[20:23],s92 sc1
s_bitset0_b32 s55,6
s_cmp_eq_u32 s55,0
s_cbranch_scc1 segb_100518
s_branch rnx_100763
rdn_100761:
buffer_load_dword v125,off,s[20:23],s92 sc1
s_branch rnx_100763
rfa_100762:
buffer_load_dwordx4 v[40:43],v0,s[20:23],s93 offen offset:2048 sc1
rnx_100763:
s_bitcmp1_b32 s55,7
s_cbranch_scc0 rdn_100764
s_waitcnt vmcnt(5)
v_max3_u32 v124,v44,v45,v46
v_max_u32 v124,v124,v47
v_cmp_eq_u32 vcc,-1,v124
s_cbranch_vccnz rfa_100765
buffer_load_dword v125,off,s[20:23],s92 sc1
s_bitset0_b32 s55,7
s_cmp_eq_u32 s55,0
s_cbranch_scc1 segb_100518
s_branch rnx_100766
rdn_100764:
buffer_load_dword v125,off,s[20:23],s92 sc1
s_branch rnx_100766
rfa_100765:
buffer_load_dwordx4 v[44:47],v0,s[20:23],s93 offen offset:3072 sc1
rnx_100766:
rot_100760:
s_bitcmp1_b32 s55,5
s_cbranch_scc0 rdn_100767
s_waitcnt vmcnt(2)
v_max3_u32 v124,v36,v37,v38
v_max_u32 v124,v124,v39
v_cmp_eq_u32 vcc,-1,v124
s_cbranch_vccnz rfa_100768
buffer_load_dword v125,off,s[20:23],s92 sc1
s_bitset0_b32 s55,5
v_smfmac_f32_16x16x64_bf16 v[64:67],v[36:39],a[96:103],v1
v_smfmac_f32_16x16x64_bf16 v[68:71],v[36:39],a[104:111],v1
v_smfmac_f32_16x16x64_bf16 v[72:75],v[36:39],a[112:119],v1
v_smfmac_f32_16x16x64_bf16 v[76:79],v[36:39],a[120:127],v1
s_cmp_eq_u32 s55,0
s_cbranch_scc1 segb_100518
s_branch rnx_100769
rdn_100767:
buffer_load_dword v125,off,s[20:23],s92 sc1
s_branch rnx_100769
rfa_100768:
buffer_load_dwordx4 v[36:39],v0,s[20:23],s93 offen offset:1024 sc1
rnx_100769:
s_bitcmp1_b32 s55,6
s_cbranch_scc0 rdn_100770
s_waitcnt vmcnt(2)
v_max3_u32 v124,v40,v41,v42
v_max_u32 v124,v124,v43
v_cmp_eq_u32 vcc,-1,v124
s_cbranch_vccnz rfa_100771
buffer_load_dword v125,off,s[20:23],s92 sc1
s_bitset0_b32 s55,6
s_cmp_eq_u32 s55,0
s_cbranch_scc1 segb_100518
s_branch rnx_100772
rdn_100770:
buffer_load_dword v125,off,s[20:23],s92 sc1
s_branch rnx_100772
rfa_100771:
buffer_load_dwordx4 v[40:43],v0,s[20:23],s93 offen offset:2048 sc1
rnx_100772:
s_bitcmp1_b32 s55,7
s_cbranch_scc0 rdn_100773
s_waitcnt vmcnt(2)
v_max3_u32 v124,v44,v45,v46
v_max_u32 v124,v124,v47
v_cmp_eq_u32 vcc,-1,v124
s_cbranch_vccnz rfa_100774
buffer_load_dword v125,off,s[20:23],s92 sc1
s_bitset0_b32 s55,7
s_cmp_eq_u32 s55,0
s_cbranch_scc1 segb_100518
s_branch rnx_100775
rdn_100773:
buffer_load_dword v125,off,s[20:23],s92 sc1
s_branch rnx_100775
rfa_100774:
buffer_load_dwordx4 v[44:47],v0,s[20:23],s93 offen offset:3072 sc1
rnx_100775:
s_sub_u32 s90,s90,1
s_cmp_gt_i32 s90,0
s_cbranch_scc1 rot_100760
s_mov_b32 s55,0
s_branch segb_100518
fl_100526:
flb_100534:
s_mov_b32 s55,192
s_bitcmp1_b32 s55,6
s_cbranch_scc0 rdn_100777
s_waitcnt vmcnt(5)
v_max3_u32 v124,v40,v41,v42
v_max_u32 v124,v124,v43
v_cmp_eq_u32 vcc,-1,v124
s_cbranch_vccnz rfa_100778
buffer_load_dword v125,off,s[20:23],s92 sc1
s_bitset0_b32 s55,6
s_cmp_eq_u32 s55,0
s_cbranch_scc1 segb_100518
s_branch rnx_100779
rdn_100777:
buffer_load_dword v125,off,s[20:23],s92 sc1
s_branch rnx_100779
rfa_100778:
buffer_load_dwordx4 v[40:43],v0,s[20:23],s93 offen offset:2048 sc1
rnx_100779:
s_bitcmp1_b32 s55,7
s_cbranch_scc0 rdn_100780
s_waitcnt vmcnt(5)
v_max3_u32 v124,v44,v45,v46
v_max_u32 v124,v124,v47
v_cmp_eq_u32 vcc,-1,v124
s_cbranch_vccnz rfa_100781
buffer_load_dword v125,off,s[20:23],s92 sc1
s_bitset0_b32 s55,7
s_cmp_eq_u32 s55,0
s_cbranch_scc1 segb_100518
s_branch rnx_100782
rdn_100780:
buffer_load_dword v125,off,s[20:23],s92 sc1
s_branch rnx_100782
rfa_100781:
buffer_load_dwordx4 v[44:47],v0,s[20:23],s93 offen offset:3072 sc1
rnx_100782:
rot_100776:
s_bitcmp1_b32 s55,6
s_cbranch_scc0 rdn_100783
s_waitcnt vmcnt(1)
v_max3_u32 v124,v40,v41,v42
v_max_u32 v124,v124,v43
v_cmp_eq_u32 vcc,-1,v124
s_cbranch_vccnz rfa_100784
buffer_load_dword v125,off,s[20:23],s92 sc1
s_bitset0_b32 s55,6
s_cmp_eq_u32 s55,0
s_cbranch_scc1 segb_100518
s_branch rnx_100785
rdn_100783:
buffer_load_dword v125,off,s[20:23],s92 sc1
s_branch rnx_100785
rfa_100784:
buffer_load_dwordx4 v[40:43],v0,s[20:23],s93 offen offset:2048 sc1
rnx_100785:
s_bitcmp1_b32 s55,7
s_cbranch_scc0 rdn_100786
s_waitcnt vmcnt(1)
v_max3_u32 v124,v44,v45,v46
v_max_u32 v124,v124,v47
v_cmp_eq_u32 vcc,-1,v124
s_cbranch_vccnz rfa_100787
buffer_load_dword v125,off,s[20:23],s92 sc1
s_bitset0_b32 s55,7
s_cmp_eq_u32 s55,0
s_cbranch_scc1 segb_100518
s_branch rnx_100788
rdn_100786:
buffer_load_dword v125,off,s[20:23],s92 sc1
s_branch rnx_100788
rfa_100787:
buffer_load_dwordx4 v[44:47],v0,s[20:23],s93 offen offset:3072 sc1
rnx_100788:
s_sub_u32 s90,s90,1
s_cmp_gt_i32 s90,0
s_cbranch_scc1 rot_100776
s_mov_b32 s55,0
s_branch segb_100518
dfl_100729:
buffer_load_dwordx4 v[20:23],v0,s[20:23],s92 offen offset:1024 sc1
s_bitset1_b32 s55,1
buffer_load_dwordx4 v[36:39],v0,s[20:23],s93 offen offset:1024 sc1
s_waitcnt vmcnt(5)
v_max3_u32 v124,v24,v25,v26
v_max_u32 v124,v124,v27
v_cmp_eq_u32 vcc,-1,v124
s_cbranch_vccnz dfl_100730
s_branch dseg_100733
dfl_100730:
buffer_load_dwordx4 v[24:27],v0,s[20:23],s92 offen offset:2048 sc1
s_bitset1_b32 s55,2
buffer_load_dwordx4 v[40:43],v0,s[20:23],s93 offen offset:2048 sc1
buffer_load_dwordx4 v[44:47],v0,s[20:23],s93 offen offset:3072 sc1
s_waitcnt vmcnt(7)
v_max3_u32 v124,v28,v29,v30
v_max_u32 v124,v124,v31
v_cmp_eq_u32 vcc,-1,v124
s_cbranch_vccnz dfl_100731
s_branch dseg_100734
dfl_100731:
buffer_load_dwordx4 v[28:31],v0,s[20:23],s92 offen offset:3072 sc1
s_bitset1_b32 s55,3
buffer_store_dword v126,v121,s[20:23],s69 offen sc1
s_branch lap2_100735
dseg_100733:
v_smfmac_f32_16x16x64_bf16 v[64:67],v[24:27],a[160:167],v1
buffer_load_dword v125,off,s[20:23],s92 sc1
buffer_load_dwordx4 v[40:43],v0,s[20:23],s93 offen offset:2048 sc1
buffer_load_dwordx4 v[44:47],v0,s[20:23],s93 offen offset:3072 sc1
s_waitcnt vmcnt(7)
v_max3_u32 v124,v28,v29,v30
v_smfmac_f32_16x16x64_bf16 v[68:71],v[24:27],a[168:175],v1
v_max_u32 v124,v124,v31
v_cmp_eq_u32 vcc,-1,v124
v_smfmac_f32_16x16x64_bf16 v[72:75],v[24:27],a[176:183],v1
v_smfmac_f32_16x16x64_bf16 v[76:79],v[24:27],a[184:191],v1
s_cbranch_vccnz dfl_100731
dseg_100734:
v_smfmac_f32_16x16x64_bf16 v[64:67],v[28:31],a[224:231],v1
buffer_load_dword v125,off,s[20:23],s92 sc1
v_smfmac_f32_16x16x64_bf16 v[68:71],v[28:31],a[232:239],v1
buffer_store_dword v126,v121,s[20:23],s69 offen sc1
v_smfmac_f32_16x16x64_bf16 v[72:75],v[28:31],a[240:247],v1
v_smfmac_f32_16x16x64_bf16 v[76:79],v[28:31],a[248:255],v1
lap2_100735:
s_bitcmp1_b32 s55,0
s_cbranch_scc0 l2s_100789
s_waitcnt vmcnt(8)
v_max3_u32 v124,v16,v17,v18
v_max_u32 v124,v124,v19
v_cmp_eq_u32 vcc,-1,v124
s_cbranch_vccnz l2s_100789
s_bitset0_b32 s55,0
v_smfmac_f32_16x16x64_bf16 v[64:67],v[16:19],a[32:39],v1
v_smfmac_f32_16x16x64_bf16 v[68:71],v[16:19],a[40:47],v1
v_smfmac_f32_16x16x64_bf16 v[72:75],v[16:19],a[48:55],v1
v_smfmac_f32_16x16x64_bf16 v[76:79],v[16:19],a[56:63],v1
l2s_100789:
s_bitcmp1_b32 s55,1
s_cbranch_scc0 l2s_100791
s_waitcnt vmcnt(6)
v_max3_u32 v124,v20,v21,v22
v_max_u32 v124,v124,v23
v_cmp_eq_u32 vcc,-1,v124
s_cbranch_vccnz l2s_100791
s_bitset0_b32 s55,1
v_smfmac_f32_16x16x64_bf16 v[64:67],v[20:23],a[96:103],v1
v_smfmac_f32_16x16x64_bf16 v[68:71],v[20:23],a[104:111],v1
v_smfmac_f32_16x16x64_bf16 v[72:75],v[20:23],a[112:119],v1
v_smfmac_f32_16x16x64_bf16 v[76:79],v[20:23],a[120:127],v1
l2s_100791:
s_bitcmp1_b32 s55,2
s_cbranch_scc0 l2s_100793
s_waitcnt vmcnt(4)
v_max3_u32 v124,v24,v25,v26
v_max_u32 v124,v124,v27
v_cmp_eq_u32 vcc,-1,v124
s_cbranch_vccnz l2s_100793
s_bitset0_b32 s55,2
v_smfmac_f32_16x16x64_bf16 v[64:67],v[24:27],a[160:167],v1
v_smfmac_f32_16x16x64_bf16 v[68:71],v[24:27],a[168:175],v1
v_smfmac_f32_16x16x64_bf16 v[72:75],v[24:27],a[176:183],v1
v_smfmac_f32_16x16x64_bf16 v[76:79],v[24:27],a[184:191],v1
l2s_100793:
s_bitcmp1_b32 s55,3
s_cbranch_scc0 l2s_100795
s_waitcnt vmcnt(1)
v_max3_u32 v124,v28,v29,v30
v_max_u32 v124,v124,v31
v_cmp_eq_u32 vcc,-1,v124
s_cbranch_vccnz l2s_100795
s_bitset0_b32 s55,3
v_smfmac_f32_16x16x64_bf16 v[64:67],v[28:31],a[224:231],v1
v_smfmac_f32_16x16x64_bf16 v[68:71],v[28:31],a[232:239],v1
v_smfmac_f32_16x16x64_bf16 v[72:75],v[28:31],a[240:247],v1
v_smfmac_f32_16x16x64_bf16 v[76:79],v[28:31],a[248:255],v1
l2s_100795:
s_cmp_eq_u32 s55,0
s_cbranch_scc0 lfb_100736
Ldone_100737:
s_waitcnt vmcnt(7)
v_max3_u32 v124,v32,v33,v34
v_max_u32 v124,v124,v35
v_cmp_eq_u32 vcc,-1,v124
s_cbranch_vccnz flb_100532
s_branch segb_100516
lfb_100736:
s_bitcmp1_b32 s55,0
s_cbranch_scc0 dsk_100797
buffer_load_dwordx4 v[16:19],v0,s[20:23],s92 offen offset:0 sc1
dsk_100797:
s_bitcmp1_b32 s55,1
s_cbranch_scc0 dsk_100798
buffer_load_dwordx4 v[20:23],v0,s[20:23],s92 offen offset:1024 sc1
dsk_100798:
s_bitcmp1_b32 s55,2
s_cbranch_scc0 dsk_100799
buffer_load_dwordx4 v[24:27],v0,s[20:23],s92 offen offset:2048 sc1
dsk_100799:
s_bitcmp1_b32 s55,3
s_cbranch_scc0 dsk_100800
buffer_load_dwordx4 v[28:31],v0,s[20:23],s92 offen offset:3072 sc1
dsk_100800:
s_bitcmp1_b32 s55,0
s_cbranch_scc0 dsk_100801
s_waitcnt vmcnt(2)
v_max3_u32 v124,v16,v17,v18
v_max_u32 v124,v124,v19
v_cmp_eq_u32 vcc,-1,v124
s_cbranch_vccz dgo_100802
s_nop 15
buffer_load_dwordx4 v[104:107],v0,s[20:23],s92 offen offset:0 sc1
s_nop 15
buffer_load_dwordx4 v[108:111],v0,s[20:23],s92 offen offset:0 sc1
dlp_100803:
s_waitcnt vmcnt(2)
v_max3_u32 v124,v16,v17,v18
v_max_u32 v124,v124,v19
v_cmp_eq_u32 vcc,-1,v124
s_cbranch_vccz dgo_100802
buffer_load_dwordx4 v[16:19],v0,s[20:23],s92 offen offset:0 sc1
s_waitcnt vmcnt(2)
v_max3_u32 v124,v104,v105,v106
v_max_u32 v124,v124,v107
v_cmp_eq_u32 vcc,-1,v124
s_cbranch_vccz dcp_100805
buffer_load_dwordx4 v[104:107],v0,s[20:23],s92 offen offset:0 sc1
s_waitcnt vmcnt(2)
v_max3_u32 v124,v108,v109,v110
v_max_u32 v124,v124,v111
v_cmp_eq_u32 vcc,-1,v124
s_cbranch_vccz dcp_100806
buffer_load_dwordx4 v[108:111],v0,s[20:23],s92 offen offset:0 sc1
s_sub_u32 s90,s90,1
s_cmp_gt_i32 s90,0
s_cbranch_scc1 dlp_100803
s_branch dgo_100802
dcp_100805:
v_mov_b32 v16,v104
v_mov_b32 v17,v105
v_mov_b32 v18,v106
v_mov_b32 v19,v107
s_nop 1
s_branch dgo_100802
dcp_100806:
v_mov_b32 v16,v108
v_mov_b32 v17,v109
v_mov_b32 v18,v110
v_mov_b32 v19,v111
s_nop 1
dgo_100802:
v_smfmac_f32_16x16x64_bf16 v[64:67],v[16:19],a[32:39],v1
v_smfmac_f32_16x16x64_bf16 v[68:71],v[16:19],a[40:47],v1
v_smfmac_f32_16x16x64_bf16 v[72:75],v[16:19],a[48:55],v1
v_smfmac_f32_16x16x64_bf16 v[76:79],v[16:19],a[56:63],v1
dsk_100801:
s_bitcmp1_b32 s55,1
s_cbranch_scc0 dsk_100807
s_waitcnt vmcnt(2)
v_max3_u32 v124,v20,v21,v22
v_max_u32 v124,v124,v23
v_cmp_eq_u32 vcc,-1,v124
s_cbranch_vccz dgo_100808
s_nop 15
buffer_load_dwordx4 v[104:107],v0,s[20:23],s92 offen offset:1024 sc1
s_nop 15
buffer_load_dwordx4 v[108:111],v0,s[20:23],s92 offen offset:1024 sc1
dlp_100809:
s_waitcnt vmcnt(2)
v_max3_u32 v124,v20,v21,v22
v_max_u32 v124,v124,v23
v_cmp_eq_u32 vcc,-1,v124
s_cbranch_vccz dgo_100808
buffer_load_dwordx4 v[20:23],v0,s[20:23],s92 offen offset:1024 sc1
s_waitcnt vmcnt(2)
v_max3_u32 v124,v104,v105,v106
v_max_u32 v124,v124,v107
v_cmp_eq_u32 vcc,-1,v124
s_cbranch_vccz dcp_100811
buffer_load_dwordx4 v[104:107],v0,s[20:23],s92 offen offset:1024 sc1
s_waitcnt vmcnt(2)
v_max3_u32 v124,v108,v109,v110
v_max_u32 v124,v124,v111
v_cmp_eq_u32 vcc,-1,v124
s_cbranch_vccz dcp_100812
buffer_load_dwordx4 v[108:111],v0,s[20:23],s92 offen offset:1024 sc1
s_sub_u32 s90,s90,1
s_cmp_gt_i32 s90,0
s_cbranch_scc1 dlp_100809
s_branch dgo_100808
dcp_100811:
v_mov_b32 v20,v104
v_mov_b32 v21,v105
v_mov_b32 v22,v106
v_mov_b32 v23,v107
s_nop 1
s_branch dgo_100808
dcp_100812:
v_mov_b32 v20,v108
v_mov_b32 v21,v109
v_mov_b32 v22,v110
v_mov_b32 v23,v111
s_nop 1
dgo_100808:
v_smfmac_f32_16x16x64_bf16 v[64:67],v[20:23],a[96:103],v1
v_smfmac_f32_16x16x64_bf16 v[68:71],v[20:23],a[104:111],v1
v_smfmac_f32_16x16x64_bf16 v[72:75],v[20:23],a[112:119],v1
v_smfmac_f32_16x16x64_bf16 v[76:79],v[20:23],a[120:127],v1
dsk_100807:
s_bitcmp1_b32 s55,2
s_cbranch_scc0 dsk_100813
s_waitcnt vmcnt(2)
v_max3_u32 v124,v24,v25,v26
v_max_u32 v124,v124,v27
v_cmp_eq_u32 vcc,-1,v124
s_cbranch_vccz dgo_100814
s_nop 15
buffer_load_dwordx4 v[104:107],v0,s[20:23],s92 offen offset:2048 sc1
s_nop 15
buffer_load_dwordx4 v[108:111],v0,s[20:23],s92 offen offset:2048 sc1
dlp_100815:
s_waitcnt vmcnt(2)
v_max3_u32 v124,v24,v25,v26
v_max_u32 v124,v124,v27
v_cmp_eq_u32 vcc,-1,v124
s_cbranch_vccz dgo_100814
buffer_load_dwordx4 v[24:27],v0,s[20:23],s92 offen offset:2048 sc1
s_waitcnt vmcnt(2)
v_max3_u32 v124,v104,v105,v106
v_max_u32 v124,v124,v107
v_cmp_eq_u32 vcc,-1,v124
s_cbranch_vccz dcp_100817
buffer_load_dwordx4 v[104:107],v0,s[20:23],s92 offen offset:2048 sc1
s_waitcnt vmcnt(2)
v_max3_u32 v124,v108,v109,v110
v_max_u32 v124,v124,v111
v_cmp_eq_u32 vcc,-1,v124
s_cbranch_vccz dcp_100818
buffer_load_dwordx4 v[108:111],v0,s[20:23],s92 offen offset:2048 sc1
s_sub_u32 s90,s90,1
s_cmp_gt_i32 s90,0
s_cbranch_scc1 dlp_100815
s_branch dgo_100814
dcp_100817:
v_mov_b32 v24,v104
v_mov_b32 v25,v105
v_mov_b32 v26,v106
v_mov_b32 v27,v107
s_nop 1
s_branch dgo_100814
dcp_100818:
v_mov_b32 v24,v108
v_mov_b32 v25,v109
v_mov_b32 v26,v110
v_mov_b32 v27,v111
s_nop 1
dgo_100814:
v_smfmac_f32_16x16x64_bf16 v[64:67],v[24:27],a[160:167],v1
v_smfmac_f32_16x16x64_bf16 v[68:71],v[24:27],a[168:175],v1
v_smfmac_f32_16x16x64_bf16 v[72:75],v[24:27],a[176:183],v1
v_smfmac_f32_16x16x64_bf16 v[76:79],v[24:27],a[184:191],v1
dsk_100813:
s_bitcmp1_b32 s55,3
s_cbranch_scc0 dsk_100819
s_waitcnt vmcnt(2)
v_max3_u32 v124,v28,v29,v30
v_max_u32 v124,v124,v31
v_cmp_eq_u32 vcc,-1,v124
s_cbranch_vccz dgo_100820
s_nop 15
buffer_load_dwordx4 v[104:107],v0,s[20:23],s92 offen offset:3072 sc1
s_nop 15
buffer_load_dwordx4 v[108:111],v0,s[20:23],s92 offen offset:3072 sc1
dlp_100821:
s_waitcnt vmcnt(2)
v_max3_u32 v124,v28,v29,v30
v_max_u32 v124,v124,v31
v_cmp_eq_u32 vcc,-1,v124
s_cbranch_vccz dgo_100820
buffer_load_dwordx4 v[28:31],v0,s[20:23],s92 offen offset:3072 sc1
s_waitcnt vmcnt(2)
v_max3_u32 v124,v104,v105,v106
v_max_u32 v124,v124,v107
v_cmp_eq_u32 vcc,-1,v124
s_cbranch_vccz dcp_100823
buffer_load_dwordx4 v[104:107],v0,s[20:23],s92 offen offset:3072 sc1
s_waitcnt vmcnt(2)
v_max3_u32 v124,v108,v109,v110
v_max_u32 v124,v124,v111
v_cmp_eq_u32 vcc,-1,v124
s_cbranch_vccz dcp_100824
buffer_load_dwordx4 v[108:111],v0,s[20:23],s92 offen offset:3072 sc1
s_sub_u32 s90,s90,1
s_cmp_gt_i32 s90,0
s_cbranch_scc1 dlp_100821
s_branch dgo_100820
dcp_100823:
v_mov_b32 v28,v104
v_mov_b32 v29,v105
v_mov_b32 v30,v106
v_mov_b32 v31,v107
s_nop 1
s_branch dgo_100820
dcp_100824:
v_mov_b32 v28,v108
v_mov_b32 v29,v109
v_mov_b32 v30,v110
v_mov_b32 v31,v111
s_nop 1
dgo_100820:
v_smfmac_f32_16x16x64_bf16 v[64:67],v[28:31],a[224:231],v1
v_smfmac_f32_16x16x64_bf16 v[68:71],v[28:31],a[232:239],v1
v_smfmac_f32_16x16x64_bf16 v[72:75],v[28:31],a[240:247],v1
v_smfmac_f32_16x16x64_bf16 v[76:79],v[28:31],a[248:255],v1
dsk_100819:
s_mov_b32 s55,0
s_branch Ldone_100737
slowA_100536:
buffer_load_dwordx4 v[44:47],v0,s[20:23],s93 offen offset:3072 sc1
dsk_100825:
s_bitcmp1_b32 s55,7
s_cbranch_scc0 dsk_100826
s_waitcnt vmcnt(2)
v_max3_u32 v124,v44,v45,v46
v_max_u32 v124,v124,v47
v_cmp_eq_u32 vcc,-1,v124
s_cbranch_vccz dgo_100827
s_nop 15
s_nop 3
buffer_load_dwordx4 v[104:107],v0,s[20:23],s93 offen offset:3072 sc1
s_nop 15
s_nop 3
buffer_load_dwordx4 v[108:111],v0,s[20:23],s93 offen offset:3072 sc1
dlp_100828:
s_waitcnt vmcnt(2)
v_max3_u32 v124,v44,v45,v46
v_max_u32 v124,v124,v47
v_cmp_eq_u32 vcc,-1,v124
s_cbranch_vccz dgo_100827
buffer_load_dwordx4 v[44:47],v0,s[20:23],s93 offen offset:3072 sc1
s_waitcnt vmcnt(2)
v_max3_u32 v124,v104,v105,v106
v_max_u32 v124,v124,v107
v_cmp_eq_u32 vcc,-1,v124
s_cbranch_vccz dcp_100830
buffer_load_dwordx4 v[104:107],v0,s[20:23],s93 offen offset:3072 sc1
s_waitcnt vmcnt(2)
v_max3_u32 v124,v108,v109,v110
v_max_u32 v124,v124,v111
v_cmp_eq_u32 vcc,-1,v124
s_cbranch_vccz dcp_100831
buffer_load_dwordx4 v[108:111],v0,s[20:23],s93 offen offset:3072 sc1
s_sub_u32 s90,s90,1
s_cmp_gt_i32 s90,0
s_cbranch_scc1 dlp_100828
s_branch dgo_100827
dcp_100830:
v_mov_b32 v44,v104
v_mov_b32 v45,v105
v_mov_b32 v46,v106
v_mov_b32 v47,v107
s_nop 1
s_branch dgo_100827
dcp_100831:
v_mov_b32 v44,v108
v_mov_b32 v45,v109
v_mov_b32 v46,v110
v_mov_b32 v47,v111
s_nop 1
dgo_100827:
dsk_100826:
s_mov_b32 s55,0
s_branch segb_100518
recslow_100429:
buffer_load_dword v119,off,s[20:23],s68 sc1
s_mov_b32 s55,0
s_cmp_lg_u32 s50,0
s_cbranch_scc1 np0_100834
v_mov_b32 v120,0
v_mov_b32 v121,0
s_cmp_lg_u32 s58,0
s_cbranch_scc1 z1_100835
v_mov_b32 v120,v32
v_mov_b32 v121,v33
v_mov_b32 v122,v34
v_mov_b32 v123,v35
v_lshl_or_b32 v120,v122,16,v120
v_lshl_or_b32 v121,v123,16,v121
v_min_u32 v120,s81,v120
v_min_u32 v121,s81,v121
z1_100835:
buffer_store_dword v120,v4,s[20:23],s71 offen sc1
buffer_store_dword v121,v4,s[20:23],s71 offen offset:32 sc1
buffer_store_dword v120,v4,s[20:23],s73 offen sc1
buffer_store_dword v121,v4,s[20:23],s73 offen offset:32 sc1
np0_100834:
v_lshrrev_b32 v124,2,v0
v_bfe_u32 v125,v124,5,1
v_mul_u32_u24 v125,2048,v125
s_and_b32 s64,s50,1
s_lshl_b32 s64,s64,5
v_add3_u32 v4,v124,v125,s64
s_mov_b32 s61,1
s_mov_b32 s92,s70
s_mov_b32 s93,s72
s_mov_b32 s94,s76
s_add_u32 s95,s94,4096
s_mov_b32 s96,s74
s_add_u32 s97,s96,4096
s_mov_b32 s98,s75
s_barrier
v_mov_b32 v96,v104
v_mov_b32 v97,v105
v_mov_b32 v98,v106
v_mov_b32 v99,v107
v_mov_b32 v100,v108
v_mov_b32 v101,v109
v_mov_b32 v102,v110
v_mov_b32 v103,v111
v_mov_b32 v48,0
v_mov_b32 v49,0
v_mov_b32 v50,0
v_mov_b32 v51,0
v_mov_b32 v52,0
v_mov_b32 v53,0
v_mov_b32 v54,0
v_mov_b32 v55,0
v_mov_b32 v56,0
v_mov_b32 v57,0
v_mov_b32 v58,0
v_mov_b32 v59,0
v_mov_b32 v60,0
v_mov_b32 v61,0
v_mov_b32 v62,0
v_mov_b32 v63,0
v_mov_b32 v64,0
v_mov_b32 v65,0
v_mov_b32 v66,0
v_mov_b32 v67,0
v_mov_b32 v68,0
v_mov_b32 v69,0
v_mov_b32 v70,0
v_mov_b32 v71,0
v_mov_b32 v72,0
v_mov_b32 v73,0
v_mov_b32 v74,0
v_mov_b32 v75,0
v_mov_b32 v76,0
v_mov_b32 v77,0
v_mov_b32 v78,0
v_mov_b32 v79,0
v_mov_b32 v80,0
v_mov_b32 v81,0
v_mov_b32 v82,0
v_mov_b32 v83,0
v_mov_b32 v84,0
v_mov_b32 v85,0
v_mov_b32 v86,0
v_mov_b32 v87,0
v_mov_b32 v88,0
v_mov_b32 v89,0
v_mov_b32 v90,0
v_mov_b32 v91,0
v_mov_b32 v92,0
v_mov_b32 v93,0
v_mov_b32 v94,0
v_mov_b32 v95,0
s_cmp_gt_u32 s50,1
s_cbranch_scc0 loop0_100836x
.p2align 6
s_nop 0
s_nop 0
s_nop 0
s_nop 0
s_nop 0
s_nop 0
s_nop 0
loop_100832:
v_mov_b32 v125,0
s_nop 1
v_mfma_f32_16x16x1_4b_f32 v[48:63],v125,v125,0
v_mfma_f32_16x16x1_4b_f32 v[64:79],v125,v125,0
v_mfma_f32_16x16x1_4b_f32 v[80:95],v125,v125,0
s_max_u32 s66,s79,1
s_sub_u32 s66,s66,1
v_cndmask_b32 v126,2.0,v0,s[82:83]
s_add_u32 s64,s66,0
s_lshl_b32 s65,s64,12
s_and_b32 s65,s65,0x2000
s_xor_b32 s65,s65,s67
s_lshl_b32 s64,s64,20
s_add_u32 s65,s65,s64
s_add_u32 s101,s65,s78
buffer_store_dwordx4 v[112:115],v126,s[20:23],s101 offen sc1
s_nop 15
s_nop 15
s_nop 15
s_nop 7
buffer_load_dwordx4 v[16:19],v0,s[20:23],s92 offen offset:0 sc1
s_nop 7
buffer_load_dwordx4 v[20:23],v0,s[20:23],s92 offen offset:1024 sc1
s_nop 7
buffer_load_dwordx4 v[24:27],v0,s[20:23],s92 offen offset:2048 sc1
s_nop 7
buffer_load_dwordx4 v[28:31],v0,s[20:23],s92 offen offset:3072 sc1
v_mov_b32 v96,v104
v_mov_b32 v97,v105
v_mov_b32 v98,v106
v_mov_b32 v99,v107
v_mov_b32 v100,v108
v_mov_b32 v101,v109
v_mov_b32 v102,v110
v_mov_b32 v103,v111
s_branch ja_100837
loop0_100836x:
v_mov_b32 v125,0
s_nop 1
v_mfma_f32_16x16x1_4b_f32 v[48:63],v125,v125,0
v_mfma_f32_16x16x1_4b_f32 v[64:79],v125,v125,0
v_mfma_f32_16x16x1_4b_f32 v[80:95],v125,v125,0
s_max_u32 s66,s79,1
s_sub_u32 s66,s66,1
v_cndmask_b32 v126,2.0,v0,s[82:83]
s_add_u32 s64,s66,0
s_lshl_b32 s65,s64,12
s_and_b32 s65,s65,0x2000
s_xor_b32 s65,s65,s67
s_lshl_b32 s64,s64,20
s_add_u32 s65,s65,s64
s_add_u32 s101,s65,s78
buffer_store_dwordx4 v[112:115],v126,s[20:23],s101 offen sc1
s_nop 15
s_nop 3
buffer_load_dwordx4 v[16:19],v0,s[20:23],s92 offen offset:0 sc1
s_nop 7
buffer_load_dwordx4 v[20:23],v0,s[20:23],s92 offen offset:1024 sc1
s_nop 7
buffer_load_dwordx4 v[24:27],v0,s[20:23],s92 offen offset:2048 sc1
s_nop 7
buffer_load_dwordx4 v[28:31],v0,s[20:23],s92 offen offset:3072 sc1
ja_100837:
.p2align 5
s_nop 0
s_nop 0
s_cmp_lg_u32 s61,0
s_cbranch_scc1 pe_100838
pb_100839:
v_mov_b32 v126,s79
s_cmp_eq_u32 s79,63
s_cbranch_scc1 last_100833
s_add_u32 s64,s79,1
s_lshl_b32 s65,s64,12
s_and_b32 s65,s65,0x2000
s_xor_b32 s65,s65,s67
s_lshl_b32 s64,s64,20
s_add_u32 s65,s65,s64
s_add_u32 s99,s65,s77
s_waitcnt vmcnt(3)
v_max3_u32 v124,v16,v17,v18
v_max_u32 v124,v124,v19
v_cmp_eq_u32 vcc,-1,v124
v_cndmask_b32 v121,2.0,v127,s[86:87]
v_readfirstlane_b32 s91,v119
s_add_u32 s64,s79,1
s_cmp_gt_u32 s91,s64
s_cselect_b32 s99,s99,2.0
s_cselect_b32 s63,0,1
s_cbranch_vccnz flb_100868
seg_100844:
segb_100852:
v_smfmac_f32_16x16x64_bf16 v[48:51],v[16:19],a[0:7],v1
buffer_load_dword v125,off,s[20:23],s92 sc1
v_smfmac_f32_16x16x64_bf16 v[52:55],v[16:19],a[8:15],v1
buffer_load_dwordx4 v[32:35],v0,s[20:23],s93 offen offset:0 sc1
v_smfmac_f32_16x16x64_bf16 v[56:59],v[16:19],a[16:23],v1
s_waitcnt vmcnt(4)
v_max3_u32 v124,v20,v21,v22
v_smfmac_f32_16x16x64_bf16 v[60:63],v[16:19],a[24:31],v1
v_max_u32 v124,v124,v23
v_smfmac_f32_16x16x64_bf16 v[64:67],v[16:19],a[32:39],v1
v_cmp_eq_u32 vcc,-1,v124
v_smfmac_f32_16x16x64_bf16 v[68:71],v[16:19],a[40:47],v1
v_smfmac_f32_16x16x64_bf16 v[72:75],v[16:19],a[48:55],v1
s_cbranch_vccnz fl_100861
seg_100845:
v_smfmac_f32_16x16x64_bf16 v[76:79],v[16:19],a[56:63],v1
segb_100853:
v_smfmac_f32_16x16x64_bf16 v[48:51],v[20:23],a[64:71],v1
buffer_load_dword v125,off,s[20:23],s92 sc1
v_smfmac_f32_16x16x64_bf16 v[52:55],v[20:23],a[72:79],v1
buffer_load_dwordx4 v[36:39],v0,s[20:23],s93 offen offset:1024 sc1
v_smfmac_f32_16x16x64_bf16 v[56:59],v[20:23],a[80:87],v1
s_waitcnt vmcnt(5)
v_max3_u32 v124,v24,v25,v26
v_smfmac_f32_16x16x64_bf16 v[60:63],v[20:23],a[88:95],v1
v_max_u32 v124,v124,v27
v_smfmac_f32_16x16x64_bf16 v[64:67],v[20:23],a[96:103],v1
v_cmp_eq_u32 vcc,-1,v124
v_smfmac_f32_16x16x64_bf16 v[68:71],v[20:23],a[104:111],v1
v_smfmac_f32_16x16x64_bf16 v[72:75],v[20:23],a[112:119],v1
s_cbranch_vccnz fl_100862
seg_100846:
v_smfmac_f32_16x16x64_bf16 v[76:79],v[20:23],a[120:127],v1
segb_100854:
v_smfmac_f32_16x16x64_bf16 v[48:51],v[24:27],a[128:135],v1
buffer_load_dword v125,off,s[20:23],s92 sc1
v_smfmac_f32_16x16x64_bf16 v[52:55],v[24:27],a[136:143],v1
buffer_load_dwordx4 v[40:43],v0,s[20:23],s93 offen offset:2048 sc1
v_smfmac_f32_16x16x64_bf16 v[56:59],v[24:27],a[144:151],v1
buffer_load_dwordx4 v[44:47],v0,s[20:23],s93 offen offset:3072 sc1
s_waitcnt vmcnt(7)
v_max3_u32 v124,v28,v29,v30
v_smfmac_f32_16x16x64_bf16 v[60:63],v[24:27],a[152:159],v1
v_max_u32 v124,v124,v31
v_smfmac_f32_16x16x64_bf16 v[64:67],v[24:27],a[160:167],v1
v_cmp_eq_u32 vcc,-1,v124
v_smfmac_f32_16x16x64_bf16 v[68:71],v[24:27],a[168:175],v1
v_smfmac_f32_16x16x64_bf16 v[72:75],v[24:27],a[176:183],v1
s_cbranch_vccnz fl_100863
seg_100847:
v_smfmac_f32_16x16x64_bf16 v[76:79],v[24:27],a[184:191],v1
segb_100855:
v_smfmac_f32_16x16x64_bf16 v[48:51],v[28:31],a[192:199],v1
buffer_load_dword v125,off,s[20:23],s92 sc1
v_smfmac_f32_16x16x64_bf16 v[52:55],v[28:31],a[200:207],v1
buffer_store_dword v126,v121,s[20:23],s69 offen sc1
v_smfmac_f32_16x16x64_bf16 v[56:59],v[28:31],a[208:215],v1
s_waitcnt vmcnt(7)
v_max3_u32 v124,v32,v33,v34
v_smfmac_f32_16x16x64_bf16 v[60:63],v[28:31],a[216:223],v1
v_max_u32 v124,v124,v35
v_smfmac_f32_16x16x64_bf16 v[64:67],v[28:31],a[224:231],v1
v_cmp_eq_u32 vcc,-1,v124
v_smfmac_f32_16x16x64_bf16 v[68:71],v[28:31],a[232:239],v1
v_smfmac_f32_16x16x64_bf16 v[72:75],v[28:31],a[240:247],v1
s_cbranch_vccnz fl_100864
seg_100848:
v_smfmac_f32_16x16x64_bf16 v[76:79],v[28:31],a[248:255],v1
segb_100856:
v_smfmac_f32_16x16x64_bf16 v[48:51],v[32:35],a[0:7],v1
buffer_load_dword v125,off,s[20:23],s92 sc1
v_smfmac_f32_16x16x64_bf16 v[52:55],v[32:35],a[8:15],v1
v_smfmac_f32_16x16x64_bf16 v[56:59],v[32:35],a[16:23],v1
s_waitcnt vmcnt(6)
v_max3_u32 v124,v36,v37,v38
v_smfmac_f32_16x16x64_bf16 v[60:63],v[32:35],a[24:31],v1
v_max_u32 v124,v124,v39
v_smfmac_f32_16x16x64_bf16 v[64:67],v[32:35],a[32:39],v1
v_cmp_eq_u32 vcc,-1,v124
v_smfmac_f32_16x16x64_bf16 v[68:71],v[32:35],a[40:47],v1
v_smfmac_f32_16x16x64_bf16 v[72:75],v[32:35],a[48:55],v1
s_cbranch_vccnz fl_100865
seg_100849:
v_smfmac_f32_16x16x64_bf16 v[76:79],v[32:35],a[56:63],v1
segb_100857:
v_smfmac_f32_16x16x64_bf16 v[48:51],v[36:39],a[64:71],v1
buffer_load_dword v125,off,s[20:23],s92 sc1
s_waitcnt vmcnt(4)
v_max3_u32 v124,v40,v41,v42
v_smfmac_f32_16x16x64_bf16 v[52:55],v[36:39],a[72:79],v1
v_max3_u32 v124,v124,v43,v44
v_smfmac_f32_16x16x64_bf16 v[56:59],v[36:39],a[80:87],v1
v_max3_u32 v124,v124,v45,v46
v_smfmac_f32_16x16x64_bf16 v[60:63],v[36:39],a[88:95],v1
v_max_u32 v124,v124,v47
v_smfmac_f32_16x16x64_bf16 v[64:67],v[36:39],a[96:103],v1
v_cmp_eq_u32 vcc,-1,v124
v_smfmac_f32_16x16x64_bf16 v[68:71],v[36:39],a[104:111],v1
v_smfmac_f32_16x16x64_bf16 v[72:75],v[36:39],a[112:119],v1
s_cbranch_vccnz fl_100866
seg_100850:
v_smfmac_f32_16x16x64_bf16 v[76:79],v[36:39],a[120:127],v1
segb_100858:
v_smfmac_f32_16x16x64_bf16 v[48:51],v[40:43],a[128:135],v1
s_cmp_lg_u32 s61,0
s_cbranch_scc1 pq_100840
pk_100841:
buffer_load_dwordx4 v[104:107],v0,s[20:23],s99 offen
v_smfmac_f32_16x16x64_bf16 v[52:55],v[40:43],a[136:143],v1
buffer_load_dwordx4 v[108:111],v0,s[20:23],s99 offen offset:1024
s_add_u32 s64,s79,2
v_smfmac_f32_16x16x64_bf16 v[48:51],v[44:47],a[192:199],v1
s_and_b32 s64,s64,3
s_lshl_b32 s100,s64,19
v_smfmac_f32_16x16x64_bf16 v[52:55],v[44:47],a[200:207],v1
s_mov_b32 s61,s63
s_nop 1
v_add_f32 v48,v48,v49
v_smfmac_f32_16x16x64_bf16 v[56:59],v[40:43],a[144:151],v1
ds_write_addtid_b32 v48 offset:0
v_add_f32 v50,v50,v51
v_smfmac_f32_16x16x64_bf16 v[60:63],v[40:43],a[152:159],v1
ds_write_addtid_b32 v50 offset:1040
v_add_f32 v52,v52,v53
v_smfmac_f32_16x16x64_bf16 v[56:59],v[44:47],a[208:215],v1
ds_write_addtid_b32 v52 offset:2080
v_add_f32 v54,v54,v55
v_smfmac_f32_16x16x64_bf16 v[60:63],v[44:47],a[216:223],v1
ds_write_addtid_b32 v54 offset:3120
s_nop 1
v_add_f32 v56,v56,v57
v_smfmac_f32_16x16x64_bf16 v[64:67],v[40:43],a[160:167],v1
ds_write_addtid_b32 v56 offset:4160
v_add_f32 v58,v58,v59
v_smfmac_f32_16x16x64_bf16 v[68:71],v[40:43],a[168:175],v1
ds_write_addtid_b32 v58 offset:5200
v_add_f32 v60,v60,v61
v_smfmac_f32_16x16x64_bf16 v[64:67],v[44:47],a[224:231],v1
ds_write_addtid_b32 v60 offset:6240
v_add_f32 v62,v62,v63
v_smfmac_f32_16x16x64_bf16 v[68:71],v[44:47],a[232:239],v1
ds_write_addtid_b32 v62 offset:7280
s_nop 1
v_add_f32 v64,v64,v65
v_smfmac_f32_16x16x64_bf16 v[72:75],v[40:43],a[176:183],v1
ds_write_addtid_b32 v64 offset:8448
v_add_f32 v66,v66,v67
v_smfmac_f32_16x16x64_bf16 v[76:79],v[40:43],a[184:191],v1
ds_write_addtid_b32 v66 offset:9488
v_add_f32 v68,v68,v69
v_smfmac_f32_16x16x64_bf16 v[72:75],v[44:47],a[240:247],v1
ds_write_addtid_b32 v68 offset:10528
v_add_f32 v70,v70,v71
v_smfmac_f32_16x16x64_bf16 v[76:79],v[44:47],a[248:255],v1
ds_write_addtid_b32 v70 offset:11568
s_nop 1
v_add_f32 v72,v72,v73
v_smfmac_f32_16x16x64_bf16 v[80:83],v[16:19],v[208:215],v1
ds_write_addtid_b32 v72 offset:12608
v_add_f32 v74,v74,v75
v_smfmac_f32_16x16x64_bf16 v[80:83],v[32:35],v[208:215],v1
ds_write_addtid_b32 v74 offset:13648
v_add_f32 v76,v76,v77
ds_write_addtid_b32 v76 offset:14688
v_add_f32 v78,v78,v79
ds_write_addtid_b32 v78 offset:15728
doneA_100877:
s_waitcnt lgkmcnt(0)
s_barrier
s_cmp_gt_u32 s50,1
s_cbranch_scc1 w23_100878
v_smfmac_f32_16x16x64_bf16 v[84:87],v[16:19],v[216:223],v1
v_smfmac_f32_16x16x64_bf16 v[84:87],v[32:35],v[216:223],v1
v_smfmac_f32_16x16x64_bf16 v[88:91],v[16:19],v[224:231],v1
v_smfmac_f32_16x16x64_bf16 v[88:91],v[32:35],v[224:231],v1
v_smfmac_f32_16x16x64_bf16 v[92:95],v[16:19],v[232:239],v1
ds_read_b128 v[48:51],v7 offset:0
ds_read_b128 v[52:55],v7 offset:1024
v_smfmac_f32_16x16x64_bf16 v[92:95],v[32:35],v[232:239],v1
ds_read_b128 v[56:59],v7 offset:2048
ds_read_b128 v[60:63],v7 offset:3072
v_smfmac_f32_16x16x64_bf16 v[80:83],v[20:23],v[240:247],v1
ds_read_b128 v[64:67],v7 offset:4096
ds_read_b128 v[68:71],v7 offset:5120
v_smfmac_f32_16x16x64_bf16 v[80:83],v[36:39],v[240:247],v1
ds_read_b128 v[72:75],v7 offset:6144
ds_read_b128 v[76:79],v7 offset:7168
v_smfmac_f32_16x16x64_bf16 v[84:87],v[20:23],v[248:255],v1
v_smfmac_f32_16x16x64_bf16 v[84:87],v[36:39],v[248:255],v1
s_waitcnt lgkmcnt(6)
v_smfmac_f32_16x16x64_bf16 v[88:91],v[20:23],v[48:55],v1
v_smfmac_f32_16x16x64_bf16 v[88:91],v[36:39],v[48:55],v1
ds_read_b128 v[48:51],v7 offset:8192
ds_read_b128 v[52:55],v7 offset:9216
s_waitcnt lgkmcnt(6)
v_smfmac_f32_16x16x64_bf16 v[92:95],v[20:23],v[56:63],v1
v_smfmac_f32_16x16x64_bf16 v[92:95],v[36:39],v[56:63],v1
ds_read_b128 v[56:59],v7 offset:10240
ds_read_b128 v[60:63],v7 offset:11264
s_waitcnt lgkmcnt(6)
v_smfmac_f32_16x16x64_bf16 v[80:83],v[24:27],v[64:71],v1
v_smfmac_f32_16x16x64_bf16 v[80:83],v[40:43],v[64:71],v1
ds_read_b128 v[64:67],v7 offset:12288
ds_read_b128 v[68:71],v7 offset:13312
s_waitcnt lgkmcnt(6)
v_smfmac_f32_16x16x64_bf16 v[84:87],v[24:27],v[72:79],v1
v_smfmac_f32_16x16x64_bf16 v[84:87],v[40:43],v[72:79],v1
ds_read_b128 v[72:75],v7 offset:14336
ds_read_b128 v[76:79],v7 offset:15360
s_waitcnt lgkmcnt(6)
v_smfmac_f32_16x16x64_bf16 v[88:91],v[24:27],v[48:55],v1
v_smfmac_f32_16x16x64_bf16 v[88:91],v[40:43],v[48:55],v1
ds_read_b128 v[48:51],v7 offset:16384
ds_read_b128 v[52:55],v7 offset:17408
s_waitcnt lgkmcnt(6)
v_smfmac_f32_16x16x64_bf16 v[92:95],v[24:27],v[56:63],v1
v_smfmac_f32_16x16x64_bf16 v[92:95],v[40:43],v[56:63],v1
ds_read_b128 v[56:59],v7 offset:18432
ds_read_b128 v[60:63],v7 offset:19456
s_waitcnt lgkmcnt(6)
v_smfmac_f32_16x16x64_bf16 v[80:83],v[28:31],v[64:71],v1
v_smfmac_f32_16x16x64_bf16 v[80:83],v[44:47],v[64:71],v1
s_waitcnt lgkmcnt(4)
v_smfmac_f32_16x16x64_bf16 v[84:87],v[28:31],v[72:79],v1
v_smfmac_f32_16x16x64_bf16 v[84:87],v[44:47],v[72:79],v1
s_waitcnt lgkmcnt(2)
v_smfmac_f32_16x16x64_bf16 v[88:91],v[28:31],v[48:55],v1
v_add_f32 v80,v80,v81
v_smfmac_f32_16x16x64_bf16 v[88:91],v[44:47],v[48:55],v1
v_add_f32 v82,v82,v83
s_waitcnt lgkmcnt(0)
v_smfmac_f32_16x16x64_bf16 v[92:95],v[28:31],v[56:63],v1
v_cvt_pk_bf16_f32 v80,v80,v82
v_smfmac_f32_16x16x64_bf16 v[92:95],v[44:47],v[56:63],v1
buffer_load_dwordx4 v[16:19],v2,s[20:23],s94 offen offset:0 sc1
ds_write_addtid_b32 v80 offset:16896
v_add_f32 v84,v84,v85
buffer_load_dwordx4 v[32:35],v2,s[20:23],s94 offen offset:1536 sc1
buffer_load_dwordx4 v[20:23],v2,s[20:23],s95 offen offset:0 sc1
buffer_load_dwordx4 v[36:39],v2,s[20:23],s95 offen offset:1536 sc1
buffer_load_dword v120,v3,s[20:23],s94 offen offset:0 sc1
buffer_load_dword v121,v3,s[20:23],s94 offen offset:1536 sc1
buffer_load_dword v122,v3,s[20:23],s95 offen offset:0 sc1
buffer_load_dword v123,v3,s[20:23],s95 offen offset:1536 sc1
v_add_f32 v86,v86,v87
v_cvt_pk_bf16_f32 v84,v84,v86
v_add_f32 v88,v88,v89
v_add_f32 v90,v90,v91
v_cvt_pk_bf16_f32 v88,v88,v90
v_add_f32 v92,v92,v93
v_add_f32 v94,v94,v95
v_cvt_pk_bf16_f32 v92,v92,v94
ds_write_addtid_b32 v84 offset:17920
ds_write_addtid_b32 v88 offset:18944
ds_write_addtid_b32 v92 offset:19968
.p2align 5
s_nop 0
s_nop 0
s_nop 0
s_nop 0
s_nop 0
sp_100882:
s_waitcnt vmcnt(6)
v_pk_add_f32 v[16:17],v[16:17],v[32:33]
v_pk_add_f32 v[18:19],v[18:19],v[34:35]
s_waitcnt vmcnt(4)
v_pk_add_f32 v[20:21],v[20:21],v[36:37]
v_pk_add_f32 v[22:23],v[22:23],v[38:39]
v_pk_add_f32 v[16:17],v[16:17],v[20:21]
v_pk_add_f32 v[18:19],v[18:19],v[22:23]
v_max3_f32 v124,v16,v17,v18
v_pk_add_f32 v[20:21],v[16:17],v[18:19]
s_waitcnt vmcnt(0)
v_pk_add_f32 v[120:121],v[120:121],v[122:123]
v_add_f32 v120,v120,v121
v_max3_f32 v124,v124,v19,v120
v_add_f32 v20,v20,v120
v_cmp_u_f32 vcc,v20,v21
v_max_f32_dpp v124,v124,v124 row_ror:8 row_mask:0xf bank_mask:0xf
v_mov_b32 v125,v124
s_cbranch_vccnz srt_100884
sok_100883:
s_nop 0
v_permlane16_swap_b32 v125,v124
v_max_f32 v124,v124,v125
v_mov_b32 v125,v124
s_nop 1
v_permlane32_swap_b32 v125,v124
v_max_f32 v124,v124,v125
v_mul_f32 v124,s80,v124
v_fma_f32 v16,v16,s80,-v124
v_fma_f32 v17,v17,s80,-v124
v_fma_f32 v18,v18,s80,-v124
v_fma_f32 v19,v19,s80,-v124
v_fma_f32 v120,v120,s80,-v124
s_waitcnt lgkmcnt(0)
s_barrier
ds_read2st64_b32 v[112:113],v127 offset0:66 offset1:67
ds_read2st64_b32 v[114:115],v127 offset0:68 offset1:69
ds_read2st64_b32 v[116:117],v127 offset0:70 offset1:71
ds_read2st64_b32 v[118:119],v127 offset0:72 offset1:73
v_exp_f32 v16,v16
v_exp_f32 v17,v17
v_exp_f32 v18,v18
v_exp_f32 v19,v19
v_cvt_pk_bf16_f32 v48,v16,v17
v_cvt_pk_bf16_f32 v49,v18,v19
v_exp_f32 v120,v120
v_mov_b32_dpp v50,v48 row_ror:8 row_mask:0xf bank_mask:0xf
v_mov_b32_dpp v51,v49 row_ror:8 row_mask:0xf bank_mask:0xf
v_mov_b32_dpp v121,v120 row_ror:8 row_mask:0xf bank_mask:0xf
v_cvt_pk_bf16_f32 v52,v120,v121
v_mfma_f32_16x16x32_bf16 v[64:67],v[8:11],v[48:51],0
v_mov_b32 v53,v52
v_mfma_f32_16x16x32_bf16 v[56:59],v[96:99],v[48:51],0
v_mov_b32 v54,v52
v_mov_b32 v55,v52
v_mfma_f32_16x16x32_bf16 v[60:63],v[100:103],v[48:51],0
v_mfma_f32_16x16x32_bf16 v[64:67],v[12:15],v[52:55],v[64:67]
s_waitcnt lgkmcnt(0)
v_mfma_f32_16x16x32_bf16 v[56:59],v[112:115],v[52:55],v[56:59]
v_mfma_f32_16x16x32_bf16 v[60:63],v[116:119],v[52:55],v[60:63]
s_nop 0
v_rcp_f32 v66,v64
s_nop 2
v_pk_mul_f32 v[56:57],v[56:57],v[66:67] op_sel_hi:[1,0]
v_pk_mul_f32 v[58:59],v[58:59],v[66:67] op_sel_hi:[1,0]
s_nop 0
v_pk_mul_f32 v[60:61],v[60:61],v[66:67] op_sel_hi:[1,0]
v_pk_mul_f32 v[62:63],v[62:63],v[66:67] op_sel_hi:[1,0]
v_cvt_pk_bf16_f32 v120,v56,v57
v_cvt_pk_bf16_f32 v121,v58,v59
v_cvt_pk_bf16_f32 v122,v60,v61
v_cvt_pk_bf16_f32 v123,v62,v63
buffer_store_dwordx4 v[120:123],v6,s[20:23],s98 offen sc1
s_barrier
ds_read_b128 v[48:51],v7 offset:20480
ds_read_b128 v[52:55],v7 offset:21504
ds_read_b128 v[56:59],v7 offset:22528
ds_read_b128 v[60:63],v7 offset:23552
ds_read_b128 v[64:67],v7 offset:24576
ds_read_b128 v[68:71],v7 offset:25600
ds_read_b128 v[72:75],v7 offset:26624
ds_read_b128 v[76:79],v7 offset:27648
ds_read_b128 v[80:83],v7 offset:28672
ds_read_b128 v[84:87],v7 offset:29696
ds_read_b128 v[88:91],v7 offset:30720
ds_read_b128 v[92:95],v7 offset:31744
v_mov_b32 v96,0
v_mov_b32 v97,0
v_mov_b32 v98,0
v_mov_b32 v99,0
v_mov_b32 v100,0
v_mov_b32 v101,0
v_mov_b32 v102,0
v_mov_b32 v103,0
s_nop 11
buffer_load_dwordx4 v[16:19],v0,s[20:23],s96 offen offset:0 sc1
v_mov_b32 v120,v5
v_mov_b32 v121,v5
v_mov_b32 v122,v5
v_mov_b32 v123,v5
s_nop 1
v_mfma_f32_16x16x32_bf16 v[112:115],v[120:123],v[112:115],0
buffer_load_dwordx4 v[20:23],v0,s[20:23],s96 offen offset:1024 sc1
v_mfma_f32_16x16x32_bf16 v[116:119],v[120:123],v[116:119],0
s_add_u32 s79,s79,1
s_and_b32 s64,s79,3
s_lshl_b32 s64,s64,19
s_lshl_b32 s65,s79,8
buffer_load_dwordx4 v[24:27],v0,s[20:23],s96 offen offset:2048 sc1
s_and_b32 s65,s65,0x2000
s_lshl_b32 s66,s79,16
s_xor_b32 s88,s73,s65
s_add_u32 s88,s88,s66
s_sub_u32 s88,s88,s54
s_add_u32 s89,s71,s64
s_add_u32 s92,s70,s64
s_xor_b32 s93,s72,s65
buffer_load_dwordx4 v[28:31],v0,s[20:23],s96 offen offset:3072 sc1
s_add_u32 s93,s93,s66
s_add_u32 s94,s76,s64
s_add_u32 s95,s94,4096
s_add_u32 s98,s75,s64
s_add_u32 s60,s74,s64
v_cvt_pk_bf16_f32 v112,v112,v113
v_cvt_pk_bf16_f32 v113,v114,v115
v_cvt_pk_bf16_f32 v114,v116,v117
buffer_load_dwordx4 v[32:35],v0,s[20:23],s97 offen offset:0 sc1
v_cvt_pk_bf16_f32 v115,v118,v119
s_nop 6
buffer_load_dwordx4 v[36:39],v0,s[20:23],s97 offen offset:1024 sc1
s_nop 7
buffer_load_dwordx4 v[40:43],v0,s[20:23],s97 offen offset:2048 sc1
s_nop 7
buffer_load_dwordx4 v[44:47],v0,s[20:23],s97 offen offset:3072 sc1
s_branch ogo_100879
.p2align 5
s_nop 0
s_nop 0
s_nop 0
s_nop 0
w23_100878:
ds_read_b128 v[48:51],v2 offset:0
ds_read_b128 v[52:55],v2 offset:256
ds_read_b128 v[56:59],v2 offset:512
ds_read_b128 v[60:63],v2 offset:768
ds_read_b128 v[64:67],v2 offset:16
ds_read_b128 v[68:71],v2 offset:272
ds_read_b128 v[72:75],v2 offset:528
ds_read_b128 v[76:79],v2 offset:784
s_waitcnt lgkmcnt(6)
v_pk_add_f32 v[48:49],v[48:49],v[52:53]
v_pk_add_f32 v[50:51],v[50:51],v[54:55]
s_waitcnt lgkmcnt(4)
v_pk_add_f32 v[56:57],v[56:57],v[60:61]
v_pk_add_f32 v[58:59],v[58:59],v[62:63]
v_pk_add_f32 v[48:49],v[48:49],v[56:57]
v_pk_add_f32 v[50:51],v[50:51],v[58:59]
v_cvt_pk_bf16_f32 v112,v48,v49
v_cvt_pk_bf16_f32 v113,v50,v51
s_waitcnt lgkmcnt(2)
v_pk_add_f32 v[64:65],v[64:65],v[68:69]
v_pk_add_f32 v[66:67],v[66:67],v[70:71]
s_waitcnt lgkmcnt(0)
v_pk_add_f32 v[72:73],v[72:73],v[76:77]
v_pk_add_f32 v[74:75],v[74:75],v[78:79]
v_pk_add_f32 v[64:65],v[64:65],v[72:73]
v_pk_add_f32 v[66:67],v[66:67],v[74:75]
v_cvt_pk_bf16_f32 v114,v64,v65
v_cvt_pk_bf16_f32 v115,v66,v67
s_nop 1
v_mfma_f32_16x16x32_bf16 v[116:119],v[96:99],v[112:115],0
v_mfma_f32_16x16x32_bf16 v[120:123],v[100:103],v[112:115],0
v_mfma_f32_16x16x32_bf16 v[12:15],v[112:115],v[112:115],0
ds_read_b128 v[48:51],v7 offset:0
ds_read_b128 v[52:55],v7 offset:1024
ds_read_b128 v[56:59],v7 offset:2048
ds_read_b128 v[60:63],v7 offset:3072
ds_read_b128 v[64:67],v7 offset:4096
buffer_store_dwordx4 v[116:119],v3,s[20:23],s94 offen sc1
buffer_store_dwordx4 v[120:123],v3,s[20:23],s94 offen offset:512 sc1
s_nop 0
buffer_store_dwordx4 v[12:15],v3,s[20:23],s94 offen offset:1024 sc1
ds_read_b128 v[68:71],v7 offset:5120
ds_read_b128 v[72:75],v7 offset:6144
ds_read_b128 v[76:79],v7 offset:7168
v_smfmac_f32_16x16x64_bf16 v[84:87],v[16:19],v[216:223],v1
v_smfmac_f32_16x16x64_bf16 v[84:87],v[32:35],v[216:223],v1
v_smfmac_f32_16x16x64_bf16 v[88:91],v[16:19],v[224:231],v1
v_smfmac_f32_16x16x64_bf16 v[88:91],v[32:35],v[224:231],v1
v_smfmac_f32_16x16x64_bf16 v[92:95],v[16:19],v[232:239],v1
v_smfmac_f32_16x16x64_bf16 v[92:95],v[32:35],v[232:239],v1
v_smfmac_f32_16x16x64_bf16 v[80:83],v[20:23],v[240:247],v1
v_smfmac_f32_16x16x64_bf16 v[80:83],v[36:39],v[240:247],v1
v_smfmac_f32_16x16x64_bf16 v[84:87],v[20:23],v[248:255],v1
v_smfmac_f32_16x16x64_bf16 v[84:87],v[36:39],v[248:255],v1
s_waitcnt lgkmcnt(6)
v_smfmac_f32_16x16x64_bf16 v[88:91],v[20:23],v[48:55],v1
v_smfmac_f32_16x16x64_bf16 v[88:91],v[36:39],v[48:55],v1
ds_read_b128 v[48:51],v7 offset:8192
ds_read_b128 v[52:55],v7 offset:9216
s_waitcnt lgkmcnt(6)
v_smfmac_f32_16x16x64_bf16 v[92:95],v[20:23],v[56:63],v1
v_smfmac_f32_16x16x64_bf16 v[92:95],v[36:39],v[56:63],v1
ds_read_b128 v[56:59],v7 offset:10240
ds_read_b128 v[60:63],v7 offset:11264
s_waitcnt lgkmcnt(6)
v_smfmac_f32_16x16x64_bf16 v[80:83],v[24:27],v[64:71],v1
v_smfmac_f32_16x16x64_bf16 v[80:83],v[40:43],v[64:71],v1
ds_read_b128 v[64:67],v7 offset:12288
ds_read_b128 v[68:71],v7 offset:13312
s_waitcnt lgkmcnt(6)
v_smfmac_f32_16x16x64_bf16 v[84:87],v[24:27],v[72:79],v1
v_smfmac_f32_16x16x64_bf16 v[84:87],v[40:43],v[72:79],v1
ds_read_b128 v[72:75],v7 offset:14336
ds_read_b128 v[76:79],v7 offset:15360
s_waitcnt lgkmcnt(6)
v_smfmac_f32_16x16x64_bf16 v[88:91],v[24:27],v[48:55],v1
v_smfmac_f32_16x16x64_bf16 v[88:91],v[40:43],v[48:55],v1
ds_read_b128 v[48:51],v7 offset:16384
ds_read_b128 v[52:55],v7 offset:17408
s_waitcnt lgkmcnt(6)
v_smfmac_f32_16x16x64_bf16 v[92:95],v[24:27],v[56:63],v1
v_smfmac_f32_16x16x64_bf16 v[92:95],v[40:43],v[56:63],v1
ds_read_b128 v[56:59],v7 offset:18432
ds_read_b128 v[60:63],v7 offset:19456
s_waitcnt lgkmcnt(6)
v_smfmac_f32_16x16x64_bf16 v[80:83],v[28:31],v[64:71],v1
v_smfmac_f32_16x16x64_bf16 v[80:83],v[44:47],v[64:71],v1
s_waitcnt lgkmcnt(4)
v_smfmac_f32_16x16x64_bf16 v[84:87],v[28:31],v[72:79],v1
v_smfmac_f32_16x16x64_bf16 v[84:87],v[44:47],v[72:79],v1
s_waitcnt lgkmcnt(2)
v_smfmac_f32_16x16x64_bf16 v[88:91],v[28:31],v[48:55],v1
v_add_f32 v80,v80,v81
v_smfmac_f32_16x16x64_bf16 v[88:91],v[44:47],v[48:55],v1
v_add_f32 v82,v82,v83
s_waitcnt lgkmcnt(0)
v_smfmac_f32_16x16x64_bf16 v[92:95],v[28:31],v[56:63],v1
v_cvt_pk_bf16_f32 v80,v80,v82
v_smfmac_f32_16x16x64_bf16 v[92:95],v[44:47],v[56:63],v1
ds_write_addtid_b32 v80 offset:16896
v_add_f32 v84,v84,v85
v_add_f32 v86,v86,v87
v_cvt_pk_bf16_f32 v84,v84,v86
v_add_f32 v88,v88,v89
v_add_f32 v90,v90,v91
v_cvt_pk_bf16_f32 v88,v88,v90
s_nop 0
v_add_f32 v92,v92,v93
v_add_f32 v94,v94,v95
v_cvt_pk_bf16_f32 v92,v92,v94
ds_write_addtid_b32 v84 offset:17920
ds_write_addtid_b32 v88 offset:18944
ds_write_addtid_b32 v92 offset:19968
s_waitcnt lgkmcnt(0)
s_barrier
ds_read_b128 v[48:51],v7 offset:20480
ds_read_b128 v[52:55],v7 offset:21504
ds_read_b128 v[56:59],v7 offset:22528
ds_read_b128 v[60:63],v7 offset:23552
ds_read_b128 v[64:67],v7 offset:24576
ds_read_b128 v[68:71],v7 offset:25600
ds_read_b128 v[72:75],v7 offset:26624
ds_read_b128 v[76:79],v7 offset:27648
ds_read_b128 v[80:83],v7 offset:28672
ds_read_b128 v[84:87],v7 offset:29696
ds_read_b128 v[88:91],v7 offset:30720
ds_read_b128 v[92:95],v7 offset:31744
s_add_u32 s65,s76,s100
s_add_u32 s66,s75,s100
s_add_u32 s64,s71,s100
s_cmp_eq_u32 s50,2
s_cselect_b32 s66,s66,s64
buffer_store_dwordx4 v[8:11],v0,s[20:23],s65 offen sc1
s_cmp_eq_u32 s50,2
s_cselect_b32 exec_hi,-1,0
buffer_store_dwordx4 v[8:11],v0,s[20:23],s66 offen sc1
s_mov_b32 exec_hi,0
buffer_store_dwordx4 v[8:11],v0,s[20:23],s65 offen offset:1024 sc1
s_mov_b64 exec,-1
v_mov_b32 v96,0
v_mov_b32 v97,0
v_mov_b32 v98,0
v_mov_b32 v99,0
v_mov_b32 v100,0
v_mov_b32 v101,0
v_mov_b32 v102,0
v_mov_b32 v103,0
s_barrier
s_nop 15
s_nop 15
s_nop 7
buffer_load_dwordx4 v[16:19],v0,s[20:23],s96 offen offset:0 sc1
s_add_u32 s79,s79,1
s_and_b32 s64,s79,3
s_lshl_b32 s64,s64,19
s_lshl_b32 s65,s79,8
s_and_b32 s65,s65,0x2000
s_lshl_b32 s66,s79,16
s_xor_b32 s88,s73,s65
s_add_u32 s88,s88,s66
buffer_load_dwordx4 v[20:23],v0,s[20:23],s96 offen offset:1024 sc1
s_sub_u32 s88,s88,s54
s_add_u32 s89,s71,s64
s_add_u32 s92,s70,s64
s_xor_b32 s93,s72,s65
s_add_u32 s93,s93,s66
s_add_u32 s94,s76,s64
s_add_u32 s95,s94,4096
s_add_u32 s98,s75,s64
buffer_load_dwordx4 v[24:27],v0,s[20:23],s96 offen offset:2048 sc1
s_add_u32 s60,s74,s64
s_nop 6
buffer_load_dwordx4 v[28:31],v0,s[20:23],s96 offen offset:3072 sc1
s_nop 7
buffer_load_dwordx4 v[32:35],v0,s[20:23],s97 offen offset:0 sc1
s_nop 7
buffer_load_dwordx4 v[36:39],v0,s[20:23],s97 offen offset:1024 sc1
s_nop 7
buffer_load_dwordx4 v[40:43],v0,s[20:23],s97 offen offset:2048 sc1
s_nop 7
buffer_load_dwordx4 v[44:47],v0,s[20:23],s97 offen offset:3072 sc1
.p2align 5
s_nop 0
s_nop 0
s_nop 0
s_nop 0
ogo_100879:
s_waitcnt lgkmcnt(0)
s_waitcnt vmcnt(6)
v_max3_u32 v124,v16,v17,v18
v_max3_u32 v124,v124,v19,v20
v_max3_u32 v124,v124,v21,v22
v_max_u32 v124,v124,v23
v_cmp_eq_u32 vcc,-1,v124
s_cbranch_vccnz of_100885
v_smfmac_f32_16x16x64_bf16 v[96:99],v[16:19],v[48:55],v1
v_smfmac_f32_16x16x64_bf16 v[100:103],v[16:19],v[56:63],v1
v_smfmac_f32_16x16x64_bf16 v[96:99],v[20:23],v[64:71],v1
v_smfmac_f32_16x16x64_bf16 v[100:103],v[20:23],v[72:79],v1
s_waitcnt vmcnt(4)
v_max3_u32 v124,v24,v25,v26
v_max3_u32 v124,v124,v27,v28
v_max3_u32 v124,v124,v29,v30
v_max_u32 v124,v124,v31
v_cmp_eq_u32 vcc,-1,v124
s_cbranch_vccnz of_100886
v_smfmac_f32_16x16x64_bf16 v[96:99],v[24:27],v[80:87],v1
v_smfmac_f32_16x16x64_bf16 v[100:103],v[24:27],v[88:95],v1
v_smfmac_f32_16x16x64_bf16 v[96:99],v[28:31],v[128:135],v1
v_smfmac_f32_16x16x64_bf16 v[100:103],v[28:31],v[136:143],v1
s_waitcnt vmcnt(2)
v_max3_u32 v124,v32,v33,v34
v_max3_u32 v124,v124,v35,v36
v_max3_u32 v124,v124,v37,v38
v_max_u32 v124,v124,v39
v_cmp_eq_u32 vcc,-1,v124
s_cbranch_vccnz of_100887
v_smfmac_f32_16x16x64_bf16 v[96:99],v[32:35],v[144:151],v1
v_smfmac_f32_16x16x64_bf16 v[100:103],v[32:35],v[152:159],v1
v_smfmac_f32_16x16x64_bf16 v[96:99],v[36:39],v[160:167],v1
v_smfmac_f32_16x16x64_bf16 v[100:103],v[36:39],v[168:175],v1
s_waitcnt vmcnt(1)
v_max3_u32 v124,v40,v41,v42
v_max_u32 v124,v124,v43
v_cmp_eq_u32 vcc,-1,v124
s_cbranch_vccnz of_100888
v_smfmac_f32_16x16x64_bf16 v[96:99],v[40:43],v[176:183],v1
v_smfmac_f32_16x16x64_bf16 v[100:103],v[40:43],v[184:191],v1
s_waitcnt vmcnt(0)
v_max3_u32 v124,v44,v45,v46
v_max_u32 v124,v124,v47
v_cmp_eq_u32 vcc,-1,v124
s_cbranch_vccnz of_100889
v_smfmac_f32_16x16x64_bf16 v[96:99],v[44:47],v[192:199],v1
v_smfmac_f32_16x16x64_bf16 v[100:103],v[44:47],v[200:207],v1
oback_100896:
buffer_load_dword v119,off,s[20:23],s68 sc1
s_nop 3
v_add_f32 v96,v96,v97
v_add_f32 v98,v98,v99
s_nop 0
v_add_f32 v100,v100,v101
v_add_f32 v102,v102,v103
ds_write_addtid_b32 v96 offset:20992
ds_write_addtid_b32 v98 offset:23072
ds_write_addtid_b32 v100 offset:22016
ds_write_addtid_b32 v102 offset:24096
s_mov_b32 s96,s60
s_add_u32 s97,s60,4096
s_cmp_gt_u32 s50,1
s_waitcnt lgkmcnt(0)
s_barrier
s_cbranch_scc1 loop_100832
ds_read2st64_b32 v[48:49],v4 offset0:82 offset1:86
ds_read2st64_b32 v[50:51],v4 offset0:83 offset1:87
ds_read2st64_b32 v[52:53],v4 offset0:84 offset1:88
ds_read2st64_b32 v[54:55],v4 offset0:85 offset1:89
v_mov_b32 v96,v104
v_mov_b32 v97,v105
v_mov_b32 v98,v106
v_mov_b32 v99,v107
v_mov_b32 v100,v108
v_mov_b32 v101,v109
v_mov_b32 v102,v110
v_mov_b32 v103,v111
s_waitcnt lgkmcnt(2)
v_pk_add_f32 v[48:49],v[48:49],v[50:51]
s_waitcnt lgkmcnt(0)
v_pk_add_f32 v[52:53],v[52:53],v[54:55]
v_pk_add_f32 v[48:49],v[48:49],v[52:53]
v_cvt_pk_bf16_f32 v124,v48,v49
buffer_store_dword v124,v127,s[20:23],s89 offen sc1
s_nop 7
buffer_store_dword v124,v127,s[20:23],s88 offen sc1
s_branch loop0_100836x
last_100833:
s_waitcnt vmcnt(3)
v_max3_u32 v124,v16,v17,v18
v_max_u32 v124,v124,v19
v_cmp_eq_u32 vcc,-1,v124
v_cndmask_b32 v121,2.0,v127,s[86:87]
s_cbranch_vccnz flb_100921
seg_100897:
segb_100905:
v_smfmac_f32_16x16x64_bf16 v[64:67],v[16:19],a[32:39],v1
buffer_load_dword v125,off,s[20:23],s92 sc1
buffer_load_dwordx4 v[32:35],v0,s[20:23],s93 offen offset:0 sc1
s_waitcnt vmcnt(4)
v_max3_u32 v124,v20,v21,v22
v_smfmac_f32_16x16x64_bf16 v[68:71],v[16:19],a[40:47],v1
v_max_u32 v124,v124,v23
v_cmp_eq_u32 vcc,-1,v124
v_smfmac_f32_16x16x64_bf16 v[72:75],v[16:19],a[48:55],v1
v_smfmac_f32_16x16x64_bf16 v[76:79],v[16:19],a[56:63],v1
s_cbranch_vccnz fl_100914
seg_100898:
segb_100906:
v_smfmac_f32_16x16x64_bf16 v[64:67],v[20:23],a[96:103],v1
buffer_load_dword v125,off,s[20:23],s92 sc1
buffer_load_dwordx4 v[36:39],v0,s[20:23],s93 offen offset:1024 sc1
s_waitcnt vmcnt(5)
v_max3_u32 v124,v24,v25,v26
v_smfmac_f32_16x16x64_bf16 v[68:71],v[20:23],a[104:111],v1
v_max_u32 v124,v124,v27
v_cmp_eq_u32 vcc,-1,v124
v_smfmac_f32_16x16x64_bf16 v[72:75],v[20:23],a[112:119],v1
v_smfmac_f32_16x16x64_bf16 v[76:79],v[20:23],a[120:127],v1
s_cbranch_vccnz fl_100915
seg_100899:
segb_100907:
v_smfmac_f32_16x16x64_bf16 v[64:67],v[24:27],a[160:167],v1
buffer_load_dword v125,off,s[20:23],s92 sc1
buffer_load_dwordx4 v[40:43],v0,s[20:23],s93 offen offset:2048 sc1
buffer_load_dwordx4 v[44:47],v0,s[20:23],s93 offen offset:3072 sc1
s_waitcnt vmcnt(7)
v_max3_u32 v124,v28,v29,v30
v_smfmac_f32_16x16x64_bf16 v[68:71],v[24:27],a[168:175],v1
v_max_u32 v124,v124,v31
v_cmp_eq_u32 vcc,-1,v124
v_smfmac_f32_16x16x64_bf16 v[72:75],v[24:27],a[176:183],v1
v_smfmac_f32_16x16x64_bf16 v[76:79],v[24:27],a[184:191],v1
s_cbranch_vccnz fl_100916
seg_100900:
segb_100908:
v_smfmac_f32_16x16x64_bf16 v[64:67],v[28:31],a[224:231],v1
buffer_load_dword v125,off,s[20:23],s92 sc1
buffer_store_dword v126,v121,s[20:23],s69 offen sc1
s_waitcnt vmcnt(7)
v_max3_u32 v124,v32,v33,v34
v_smfmac_f32_16x16x64_bf16 v[68:71],v[28:31],a[232:239],v1
v_max_u32 v124,v124,v35
v_cmp_eq_u32 vcc,-1,v124
v_smfmac_f32_16x16x64_bf16 v[72:75],v[28:31],a[240:247],v1
v_smfmac_f32_16x16x64_bf16 v[76:79],v[28:31],a[248:255],v1
s_cbranch_vccnz fl_100917
seg_100901:
segb_100909:
v_smfmac_f32_16x16x64_bf16 v[64:67],v[32:35],a[32:39],v1
buffer_load_dword v125,off,s[20:23],s92 sc1
s_waitcnt vmcnt(6)
v_max3_u32 v124,v36,v37,v38
v_smfmac_f32_16x16x64_bf16 v[68:71],v[32:35],a[40:47],v1
v_max_u32 v124,v124,v39
v_cmp_eq_u32 vcc,-1,v124
v_smfmac_f32_16x16x64_bf16 v[72:75],v[32:35],a[48:55],v1
v_smfmac_f32_16x16x64_bf16 v[76:79],v[32:35],a[56:63],v1
s_cbranch_vccnz fl_100918
seg_100902:
segb_100910:
v_smfmac_f32_16x16x64_bf16 v[64:67],v[36:39],a[96:103],v1
buffer_load_dword v125,off,s[20:23],s92 sc1
s_waitcnt vmcnt(4)
v_max3_u32 v124,v40,v41,v42
v_smfmac_f32_16x16x64_bf16 v[68:71],v[36:39],a[104:111],v1
v_max3_u32 v124,v124,v43,v44
v_max3_u32 v124,v124,v45,v46
v_max_u32 v124,v124,v47
v_cmp_eq_u32 vcc,-1,v124
v_smfmac_f32_16x16x64_bf16 v[72:75],v[36:39],a[112:119],v1
v_smfmac_f32_16x16x64_bf16 v[76:79],v[36:39],a[120:127],v1
s_cbranch_vccnz fl_100919
seg_100903:
segb_100911:
v_smfmac_f32_16x16x64_bf16 v[64:67],v[40:43],a[160:167],v1
v_smfmac_f32_16x16x64_bf16 v[68:71],v[40:43],a[168:175],v1
v_smfmac_f32_16x16x64_bf16 v[64:67],v[44:47],a[224:231],v1
v_smfmac_f32_16x16x64_bf16 v[68:71],v[44:47],a[232:239],v1
v_smfmac_f32_16x16x64_bf16 v[72:75],v[40:43],a[176:183],v1
s_nop 1
v_add_f32 v64,v64,v65
v_smfmac_f32_16x16x64_bf16 v[76:79],v[40:43],a[184:191],v1
ds_write_addtid_b32 v64 offset:8448
v_add_f32 v66,v66,v67
v_smfmac_f32_16x16x64_bf16 v[72:75],v[44:47],a[240:247],v1
ds_write_addtid_b32 v66 offset:9488
v_add_f32 v68,v68,v69
v_smfmac_f32_16x16x64_bf16 v[76:79],v[44:47],a[248:255],v1
ds_write_addtid_b32 v68 offset:10528
v_add_f32 v70,v70,v71
v_smfmac_f32_16x16x64_bf16 v[80:83],v[16:19],v[208:215],v1
ds_write_addtid_b32 v70 offset:11568
v_add_f32 v72,v72,v73
v_smfmac_f32_16x16x64_bf16 v[80:83],v[32:35],v[208:215],v1
ds_write_addtid_b32 v72 offset:12608
v_add_f32 v74,v74,v75
v_smfmac_f32_16x16x64_bf16 v[84:87],v[16:19],v[216:223],v1
ds_write_addtid_b32 v74 offset:13648
v_add_f32 v76,v76,v77
v_smfmac_f32_16x16x64_bf16 v[84:87],v[32:35],v[216:223],v1
ds_write_addtid_b32 v76 offset:14688
v_add_f32 v78,v78,v79
v_smfmac_f32_16x16x64_bf16 v[88:91],v[16:19],v[224:231],v1
ds_write_addtid_b32 v78 offset:15728
v_smfmac_f32_16x16x64_bf16 v[88:91],v[32:35],v[224:231],v1
v_smfmac_f32_16x16x64_bf16 v[92:95],v[16:19],v[232:239],v1
v_smfmac_f32_16x16x64_bf16 v[92:95],v[32:35],v[232:239],v1
doneA_100930:
s_waitcnt vmcnt(0) lgkmcnt(0)
s_add_u32 s64,s79,0
s_lshl_b32 s65,s64,12
s_and_b32 s65,s65,0x2000
s_xor_b32 s65,s65,s67
s_lshl_b32 s64,s64,20
s_add_u32 s65,s65,s64
s_add_u32 s101,s65,s78
v_smfmac_f32_16x16x64_bf16 v[80:83],v[20:23],v[240:247],v1
ds_read_b128 v[48:51],v7 offset:0
ds_read_b128 v[52:55],v7 offset:1024
v_smfmac_f32_16x16x64_bf16 v[80:83],v[36:39],v[240:247],v1
ds_read_b128 v[56:59],v7 offset:2048
ds_read_b128 v[60:63],v7 offset:3072
v_smfmac_f32_16x16x64_bf16 v[84:87],v[20:23],v[248:255],v1
ds_read_b128 v[64:67],v7 offset:4096
ds_read_b128 v[68:71],v7 offset:5120
v_smfmac_f32_16x16x64_bf16 v[84:87],v[36:39],v[248:255],v1
ds_read_b128 v[72:75],v7 offset:6144
ds_read_b128 v[76:79],v7 offset:7168
s_waitcnt lgkmcnt(6)
v_smfmac_f32_16x16x64_bf16 v[88:91],v[20:23],v[48:55],v1
v_smfmac_f32_16x16x64_bf16 v[88:91],v[36:39],v[48:55],v1
ds_read_b128 v[48:51],v7 offset:8192
ds_read_b128 v[52:55],v7 offset:9216
s_waitcnt lgkmcnt(6)
v_smfmac_f32_16x16x64_bf16 v[92:95],v[20:23],v[56:63],v1
v_smfmac_f32_16x16x64_bf16 v[92:95],v[36:39],v[56:63],v1
ds_read_b128 v[56:59],v7 offset:10240
ds_read_b128 v[60:63],v7 offset:11264
s_waitcnt lgkmcnt(6)
v_smfmac_f32_16x16x64_bf16 v[80:83],v[24:27],v[64:71],v1
v_smfmac_f32_16x16x64_bf16 v[80:83],v[40:43],v[64:71],v1
ds_read_b128 v[64:67],v7 offset:12288
ds_read_b128 v[68:71],v7 offset:13312
s_waitcnt lgkmcnt(6)
v_smfmac_f32_16x16x64_bf16 v[84:87],v[24:27],v[72:79],v1
v_smfmac_f32_16x16x64_bf16 v[84:87],v[40:43],v[72:79],v1
ds_read_b128 v[72:75],v7 offset:14336
ds_read_b128 v[76:79],v7 offset:15360
s_waitcnt lgkmcnt(6)
v_smfmac_f32_16x16x64_bf16 v[88:91],v[24:27],v[48:55],v1
v_smfmac_f32_16x16x64_bf16 v[88:91],v[40:43],v[48:55],v1
ds_read_b128 v[48:51],v7 offset:16384
ds_read_b128 v[52:55],v7 offset:17408
s_waitcnt lgkmcnt(6)
v_smfmac_f32_16x16x64_bf16 v[92:95],v[24:27],v[56:63],v1
v_smfmac_f32_16x16x64_bf16 v[92:95],v[40:43],v[56:63],v1
ds_read_b128 v[56:59],v7 offset:18432
ds_read_b128 v[60:63],v7 offset:19456
s_waitcnt lgkmcnt(6)
v_smfmac_f32_16x16x64_bf16 v[80:83],v[28:31],v[64:71],v1
v_smfmac_f32_16x16x64_bf16 v[80:83],v[44:47],v[64:71],v1
s_waitcnt lgkmcnt(4)
v_smfmac_f32_16x16x64_bf16 v[84:87],v[28:31],v[72:79],v1
v_smfmac_f32_16x16x64_bf16 v[84:87],v[44:47],v[72:79],v1
s_waitcnt lgkmcnt(2)
v_smfmac_f32_16x16x64_bf16 v[88:91],v[28:31],v[48:55],v1
v_add_f32 v80,v80,v81
v_smfmac_f32_16x16x64_bf16 v[88:91],v[44:47],v[48:55],v1
v_add_f32 v82,v82,v83
s_waitcnt lgkmcnt(0)
v_smfmac_f32_16x16x64_bf16 v[92:95],v[28:31],v[56:63],v1
v_cvt_pk_bf16_f32 v80,v80,v82
v_smfmac_f32_16x16x64_bf16 v[92:95],v[44:47],v[56:63],v1
ds_write_addtid_b32 v80 offset:16896
v_add_f32 v84,v84,v85
v_add_f32 v86,v86,v87
v_cvt_pk_bf16_f32 v84,v84,v86
v_add_f32 v88,v88,v89
v_add_f32 v90,v90,v91
v_cvt_pk_bf16_f32 v88,v88,v90
s_nop 0
v_add_f32 v92,v92,v93
v_add_f32 v94,v94,v95
v_cvt_pk_bf16_f32 v92,v92,v94
ds_write_addtid_b32 v84 offset:17920
ds_write_addtid_b32 v88 offset:18944
ds_write_addtid_b32 v92 offset:19968
s_waitcnt lgkmcnt(0)
s_barrier
s_cmp_gt_u32 s50,1
s_cbranch_scc1 l23_100931
ds_read2st64_b32 v[112:113],v127 offset0:66 offset1:67
ds_read2st64_b32 v[114:115],v127 offset0:68 offset1:69
ds_read2st64_b32 v[116:117],v127 offset0:70 offset1:71
ds_read2st64_b32 v[118:119],v127 offset0:72 offset1:73
s_waitcnt lgkmcnt(0)
v_mov_b32 v120,v5
v_mov_b32 v121,v5
v_mov_b32 v122,v5
v_mov_b32 v123,v5
s_nop 1
v_mfma_f32_16x16x32_bf16 v[112:115],v[120:123],v[112:115],0
v_mfma_f32_16x16x32_bf16 v[116:119],v[120:123],v[116:119],0
s_nop 4
v_cvt_pk_bf16_f32 v112,v112,v113
v_cvt_pk_bf16_f32 v113,v114,v115
s_nop 0
v_cvt_pk_bf16_f32 v114,v116,v117
v_cvt_pk_bf16_f32 v115,v118,v119
s_branch lj_100932
l23_100931:
ds_read_b128 v[48:51],v2 offset:0
ds_read_b128 v[52:55],v2 offset:256
ds_read_b128 v[56:59],v2 offset:512
ds_read_b128 v[60:63],v2 offset:768
ds_read_b128 v[64:67],v2 offset:16
ds_read_b128 v[68:71],v2 offset:272
ds_read_b128 v[72:75],v2 offset:528
ds_read_b128 v[76:79],v2 offset:784
s_waitcnt lgkmcnt(6)
v_pk_add_f32 v[48:49],v[48:49],v[52:53]
v_pk_add_f32 v[50:51],v[50:51],v[54:55]
s_waitcnt lgkmcnt(4)
v_pk_add_f32 v[56:57],v[56:57],v[60:61]
v_pk_add_f32 v[58:59],v[58:59],v[62:63]
v_pk_add_f32 v[48:49],v[48:49],v[56:57]
v_pk_add_f32 v[50:51],v[50:51],v[58:59]
v_cvt_pk_bf16_f32 v112,v48,v49
v_cvt_pk_bf16_f32 v113,v50,v51
s_waitcnt lgkmcnt(2)
v_pk_add_f32 v[64:65],v[64:65],v[68:69]
v_pk_add_f32 v[66:67],v[66:67],v[70:71]
s_waitcnt lgkmcnt(0)
v_pk_add_f32 v[72:73],v[72:73],v[76:77]
v_pk_add_f32 v[74:75],v[74:75],v[78:79]
v_pk_add_f32 v[64:65],v[64:65],v[72:73]
v_pk_add_f32 v[66:67],v[66:67],v[74:75]
v_cvt_pk_bf16_f32 v114,v64,v65
v_cvt_pk_bf16_f32 v115,v66,v67
lj_100932:
v_cndmask_b32 v120,2.0,v0,s[82:83]
v_cndmask_b32 v121,2.0,v127,s[86:87]
buffer_store_dwordx4 v[112:115],v120,s[20:23],s101 offen sc1
s_waitcnt vmcnt(0)
s_barrier
v_mov_b32 v126,64
buffer_store_dword v126,v121,s[20:23],s69 offen sc1
s_branch recfin_100430
pe_100838:
s_waitcnt vmcnt(5)
v_readfirstlane_b32 s91,v119
s_cmp_gt_u32 s91,s79
s_cbranch_scc0 pb_100839
s_add_u32 s64,s79,0
s_lshl_b32 s65,s64,12
s_and_b32 s65,s65,0x2000
s_xor_b32 s65,s65,s67
s_lshl_b32 s64,s64,20
s_add_u32 s65,s65,s64
s_add_u32 s62,s65,s77
buffer_load_dwordx4 v[96:99],v0,s[20:23],s62 offen
buffer_load_dwordx4 v[100:103],v0,s[20:23],s62 offen offset:1024
s_mov_b32 s61,0
s_branch pb_100839
pq_100840:
s_cmp_gt_u32 s91,s79
s_cbranch_scc1 pg_100843
pl_100842:
buffer_load_dword v124,off,s[20:23],s68 sc1
s_waitcnt vmcnt(0)
v_readfirstlane_b32 s91,v124
s_cmp_gt_u32 s91,s79
s_cbranch_scc1 pg_100843
s_sleep 2
s_sub_u32 s90,s90,1
s_cmp_gt_i32 s90,0
s_cbranch_scc1 pl_100842
pg_100843:
s_add_u32 s64,s79,0
s_lshl_b32 s65,s64,12
s_and_b32 s65,s65,0x2000
s_xor_b32 s65,s65,s67
s_lshl_b32 s64,s64,20
s_add_u32 s65,s65,s64
s_add_u32 s62,s65,s77
buffer_load_dwordx4 v[96:99],v0,s[20:23],s62 offen
buffer_load_dwordx4 v[100:103],v0,s[20:23],s62 offen offset:1024
s_waitcnt vmcnt(0)
s_branch pk_100841
fl_100860:
flb_100868:
buffer_load_dwordx4 v[16:19],v0,s[20:23],s92 offen offset:0 sc1
s_mov_b32 s55,1
buffer_load_dwordx4 v[32:35],v0,s[20:23],s93 offen offset:0 sc1
s_waitcnt vmcnt(4)
v_max3_u32 v124,v20,v21,v22
v_max_u32 v124,v124,v23
v_cmp_eq_u32 vcc,-1,v124
s_cbranch_vccnz dfl_100933
v_smfmac_f32_16x16x64_bf16 v[48:51],v[20:23],a[64:71],v1
buffer_load_dword v125,off,s[20:23],s92 sc1
v_smfmac_f32_16x16x64_bf16 v[52:55],v[20:23],a[72:79],v1
buffer_load_dwordx4 v[36:39],v0,s[20:23],s93 offen offset:1024 sc1
v_smfmac_f32_16x16x64_bf16 v[56:59],v[20:23],a[80:87],v1
s_waitcnt vmcnt(5)
v_max3_u32 v124,v24,v25,v26
v_smfmac_f32_16x16x64_bf16 v[60:63],v[20:23],a[88:95],v1
v_max_u32 v124,v124,v27
v_smfmac_f32_16x16x64_bf16 v[64:67],v[20:23],a[96:103],v1
v_cmp_eq_u32 vcc,-1,v124
v_smfmac_f32_16x16x64_bf16 v[68:71],v[20:23],a[104:111],v1
v_smfmac_f32_16x16x64_bf16 v[72:75],v[20:23],a[112:119],v1
v_smfmac_f32_16x16x64_bf16 v[76:79],v[20:23],a[120:127],v1
s_cbranch_vccnz dfl_100934
v_smfmac_f32_16x16x64_bf16 v[48:51],v[24:27],a[128:135],v1
buffer_load_dword v125,off,s[20:23],s92 sc1
v_smfmac_f32_16x16x64_bf16 v[52:55],v[24:27],a[136:143],v1
buffer_load_dwordx4 v[40:43],v0,s[20:23],s93 offen offset:2048 sc1
v_smfmac_f32_16x16x64_bf16 v[56:59],v[24:27],a[144:151],v1
buffer_load_dwordx4 v[44:47],v0,s[20:23],s93 offen offset:3072 sc1
s_waitcnt vmcnt(7)
v_max3_u32 v124,v28,v29,v30
v_smfmac_f32_16x16x64_bf16 v[60:63],v[24:27],a[152:159],v1
v_max_u32 v124,v124,v31
v_smfmac_f32_16x16x64_bf16 v[64:67],v[24:27],a[160:167],v1
v_cmp_eq_u32 vcc,-1,v124
v_smfmac_f32_16x16x64_bf16 v[68:71],v[24:27],a[168:175],v1
v_smfmac_f32_16x16x64_bf16 v[72:75],v[24:27],a[176:183],v1
v_smfmac_f32_16x16x64_bf16 v[76:79],v[24:27],a[184:191],v1
s_cbranch_vccnz dfl_100935
v_smfmac_f32_16x16x64_bf16 v[48:51],v[28:31],a[192:199],v1
buffer_load_dword v125,off,s[20:23],s92 sc1
v_smfmac_f32_16x16x64_bf16 v[52:55],v[28:31],a[200:207],v1
buffer_store_dword v126,v121,s[20:23],s69 offen sc1
v_smfmac_f32_16x16x64_bf16 v[56:59],v[28:31],a[208:215],v1
s_waitcnt vmcnt(8)
v_max3_u32 v124,v16,v17,v18
v_smfmac_f32_16x16x64_bf16 v[60:63],v[28:31],a[216:223],v1
v_max_u32 v124,v124,v19
v_smfmac_f32_16x16x64_bf16 v[64:67],v[28:31],a[224:231],v1
v_cmp_eq_u32 vcc,-1,v124
v_smfmac_f32_16x16x64_bf16 v[68:71],v[28:31],a[232:239],v1
v_smfmac_f32_16x16x64_bf16 v[72:75],v[28:31],a[240:247],v1
v_smfmac_f32_16x16x64_bf16 v[76:79],v[28:31],a[248:255],v1
s_cbranch_vccnz lfb_100940
s_mov_b32 s55,0
v_smfmac_f32_16x16x64_bf16 v[48:51],v[16:19],a[0:7],v1
v_smfmac_f32_16x16x64_bf16 v[52:55],v[16:19],a[8:15],v1
v_smfmac_f32_16x16x64_bf16 v[56:59],v[16:19],a[16:23],v1
s_waitcnt vmcnt(7)
v_max3_u32 v124,v32,v33,v34
v_max_u32 v124,v124,v35
v_cmp_eq_u32 vcc,-1,v124
v_smfmac_f32_16x16x64_bf16 v[60:63],v[16:19],a[24:31],v1
v_smfmac_f32_16x16x64_bf16 v[64:67],v[16:19],a[32:39],v1
v_smfmac_f32_16x16x64_bf16 v[68:71],v[16:19],a[40:47],v1
v_smfmac_f32_16x16x64_bf16 v[72:75],v[16:19],a[48:55],v1
v_smfmac_f32_16x16x64_bf16 v[76:79],v[16:19],a[56:63],v1
s_cbranch_vccnz flb_100872
s_branch segb_100856
fl_100861:
v_smfmac_f32_16x16x64_bf16 v[76:79],v[16:19],a[56:63],v1
flb_100869:
buffer_load_dwordx4 v[20:23],v0,s[20:23],s92 offen offset:1024 sc1
s_mov_b32 s55,2
buffer_load_dwordx4 v[36:39],v0,s[20:23],s93 offen offset:1024 sc1
s_waitcnt vmcnt(5)
v_max3_u32 v124,v24,v25,v26
v_max_u32 v124,v124,v27
v_cmp_eq_u32 vcc,-1,v124
s_cbranch_vccnz dfl_100934
v_smfmac_f32_16x16x64_bf16 v[48:51],v[24:27],a[128:135],v1
buffer_load_dword v125,off,s[20:23],s92 sc1
v_smfmac_f32_16x16x64_bf16 v[52:55],v[24:27],a[136:143],v1
buffer_load_dwordx4 v[40:43],v0,s[20:23],s93 offen offset:2048 sc1
v_smfmac_f32_16x16x64_bf16 v[56:59],v[24:27],a[144:151],v1
buffer_load_dwordx4 v[44:47],v0,s[20:23],s93 offen offset:3072 sc1
s_waitcnt vmcnt(7)
v_max3_u32 v124,v28,v29,v30
v_smfmac_f32_16x16x64_bf16 v[60:63],v[24:27],a[152:159],v1
v_max_u32 v124,v124,v31
v_smfmac_f32_16x16x64_bf16 v[64:67],v[24:27],a[160:167],v1
v_cmp_eq_u32 vcc,-1,v124
v_smfmac_f32_16x16x64_bf16 v[68:71],v[24:27],a[168:175],v1
v_smfmac_f32_16x16x64_bf16 v[72:75],v[24:27],a[176:183],v1
v_smfmac_f32_16x16x64_bf16 v[76:79],v[24:27],a[184:191],v1
s_cbranch_vccnz dfl_100935
v_smfmac_f32_16x16x64_bf16 v[48:51],v[28:31],a[192:199],v1
buffer_load_dword v125,off,s[20:23],s92 sc1
v_smfmac_f32_16x16x64_bf16 v[52:55],v[28:31],a[200:207],v1
buffer_store_dword v126,v121,s[20:23],s69 offen sc1
v_smfmac_f32_16x16x64_bf16 v[56:59],v[28:31],a[208:215],v1
s_waitcnt vmcnt(6)
v_max3_u32 v124,v20,v21,v22
v_smfmac_f32_16x16x64_bf16 v[60:63],v[28:31],a[216:223],v1
v_max_u32 v124,v124,v23
v_smfmac_f32_16x16x64_bf16 v[64:67],v[28:31],a[224:231],v1
v_cmp_eq_u32 vcc,-1,v124
v_smfmac_f32_16x16x64_bf16 v[68:71],v[28:31],a[232:239],v1
v_smfmac_f32_16x16x64_bf16 v[72:75],v[28:31],a[240:247],v1
v_smfmac_f32_16x16x64_bf16 v[76:79],v[28:31],a[248:255],v1
s_cbranch_vccnz lfb_100940
s_mov_b32 s55,0
v_smfmac_f32_16x16x64_bf16 v[48:51],v[20:23],a[64:71],v1
v_smfmac_f32_16x16x64_bf16 v[52:55],v[20:23],a[72:79],v1
v_smfmac_f32_16x16x64_bf16 v[56:59],v[20:23],a[80:87],v1
s_waitcnt vmcnt(7)
v_max3_u32 v124,v32,v33,v34
v_max_u32 v124,v124,v35
v_cmp_eq_u32 vcc,-1,v124
v_smfmac_f32_16x16x64_bf16 v[60:63],v[20:23],a[88:95],v1
v_smfmac_f32_16x16x64_bf16 v[64:67],v[20:23],a[96:103],v1
v_smfmac_f32_16x16x64_bf16 v[68:71],v[20:23],a[104:111],v1
v_smfmac_f32_16x16x64_bf16 v[72:75],v[20:23],a[112:119],v1
v_smfmac_f32_16x16x64_bf16 v[76:79],v[20:23],a[120:127],v1
s_cbranch_vccnz flb_100872
s_branch segb_100856
fl_100862:
v_smfmac_f32_16x16x64_bf16 v[76:79],v[20:23],a[120:127],v1
flb_100870:
buffer_load_dwordx4 v[24:27],v0,s[20:23],s92 offen offset:2048 sc1
s_mov_b32 s55,4
buffer_load_dwordx4 v[40:43],v0,s[20:23],s93 offen offset:2048 sc1
buffer_load_dwordx4 v[44:47],v0,s[20:23],s93 offen offset:3072 sc1
s_waitcnt vmcnt(7)
v_max3_u32 v124,v28,v29,v30
v_max_u32 v124,v124,v31
v_cmp_eq_u32 vcc,-1,v124
s_cbranch_vccnz dfl_100935
v_smfmac_f32_16x16x64_bf16 v[48:51],v[28:31],a[192:199],v1
buffer_load_dword v125,off,s[20:23],s92 sc1
v_smfmac_f32_16x16x64_bf16 v[52:55],v[28:31],a[200:207],v1
buffer_store_dword v126,v121,s[20:23],s69 offen sc1
v_smfmac_f32_16x16x64_bf16 v[56:59],v[28:31],a[208:215],v1
s_waitcnt vmcnt(4)
v_max3_u32 v124,v24,v25,v26
v_smfmac_f32_16x16x64_bf16 v[60:63],v[28:31],a[216:223],v1
v_max_u32 v124,v124,v27
v_smfmac_f32_16x16x64_bf16 v[64:67],v[28:31],a[224:231],v1
v_cmp_eq_u32 vcc,-1,v124
v_smfmac_f32_16x16x64_bf16 v[68:71],v[28:31],a[232:239],v1
v_smfmac_f32_16x16x64_bf16 v[72:75],v[28:31],a[240:247],v1
v_smfmac_f32_16x16x64_bf16 v[76:79],v[28:31],a[248:255],v1
s_cbranch_vccnz lfb_100940
s_mov_b32 s55,0
v_smfmac_f32_16x16x64_bf16 v[48:51],v[24:27],a[128:135],v1
v_smfmac_f32_16x16x64_bf16 v[52:55],v[24:27],a[136:143],v1
v_smfmac_f32_16x16x64_bf16 v[56:59],v[24:27],a[144:151],v1
s_waitcnt vmcnt(7)
v_max3_u32 v124,v32,v33,v34
v_max_u32 v124,v124,v35
v_cmp_eq_u32 vcc,-1,v124
v_smfmac_f32_16x16x64_bf16 v[60:63],v[24:27],a[152:159],v1
v_smfmac_f32_16x16x64_bf16 v[64:67],v[24:27],a[160:167],v1
v_smfmac_f32_16x16x64_bf16 v[68:71],v[24:27],a[168:175],v1
v_smfmac_f32_16x16x64_bf16 v[72:75],v[24:27],a[176:183],v1
v_smfmac_f32_16x16x64_bf16 v[76:79],v[24:27],a[184:191],v1
s_cbranch_vccnz flb_100872
s_branch segb_100856
fl_100863:
v_smfmac_f32_16x16x64_bf16 v[76:79],v[24:27],a[184:191],v1
flb_100871:
buffer_load_dwordx4 v[28:31],v0,s[20:23],s92 offen offset:3072 sc1
s_mov_b32 s55,8
buffer_store_dword v126,v121,s[20:23],s69 offen sc1
s_waitcnt vmcnt(1)
v_max3_u32 v124,v28,v29,v30
v_max_u32 v124,v124,v31
v_cmp_eq_u32 vcc,-1,v124
s_cbranch_vccnz lfb_100940
s_mov_b32 s55,0
v_smfmac_f32_16x16x64_bf16 v[48:51],v[28:31],a[192:199],v1
v_smfmac_f32_16x16x64_bf16 v[52:55],v[28:31],a[200:207],v1
v_smfmac_f32_16x16x64_bf16 v[56:59],v[28:31],a[208:215],v1
s_waitcnt vmcnt(7)
v_max3_u32 v124,v32,v33,v34
v_max_u32 v124,v124,v35
v_cmp_eq_u32 vcc,-1,v124
v_smfmac_f32_16x16x64_bf16 v[60:63],v[28:31],a[216:223],v1
v_smfmac_f32_16x16x64_bf16 v[64:67],v[28:31],a[224:231],v1
v_smfmac_f32_16x16x64_bf16 v[68:71],v[28:31],a[232:239],v1
v_smfmac_f32_16x16x64_bf16 v[72:75],v[28:31],a[240:247],v1
v_smfmac_f32_16x16x64_bf16 v[76:79],v[28:31],a[248:255],v1
s_cbranch_vccnz flb_100872
s_branch segb_100856
fl_100864:
v_smfmac_f32_16x16x64_bf16 v[76:79],v[28:31],a[248:255],v1
flb_100872:
buffer_load_dwordx4 v[32:35],v0,s[20:23],s93 offen offset:0 sc1
s_mov_b32 s55,240
s_bitcmp1_b32 s55,5
s_cbranch_scc0 rdn_100943
s_waitcnt vmcnt(6)
v_max3_u32 v124,v36,v37,v38
v_max_u32 v124,v124,v39
v_cmp_eq_u32 vcc,-1,v124
s_cbranch_vccnz rfa_100944
buffer_load_dword v125,off,s[20:23],s92 sc1
s_bitset0_b32 s55,5
v_smfmac_f32_16x16x64_bf16 v[48:51],v[36:39],a[64:71],v1
v_smfmac_f32_16x16x64_bf16 v[52:55],v[36:39],a[72:79],v1
v_smfmac_f32_16x16x64_bf16 v[56:59],v[36:39],a[80:87],v1
v_smfmac_f32_16x16x64_bf16 v[60:63],v[36:39],a[88:95],v1
v_smfmac_f32_16x16x64_bf16 v[64:67],v[36:39],a[96:103],v1
v_smfmac_f32_16x16x64_bf16 v[68:71],v[36:39],a[104:111],v1
v_smfmac_f32_16x16x64_bf16 v[72:75],v[36:39],a[112:119],v1
v_smfmac_f32_16x16x64_bf16 v[76:79],v[36:39],a[120:127],v1
s_cmp_eq_u32 s55,0
s_cbranch_scc1 segb_100858
s_branch rnx_100945
rdn_100943:
buffer_load_dword v125,off,s[20:23],s92 sc1
s_branch rnx_100945
rfa_100944:
buffer_load_dwordx4 v[36:39],v0,s[20:23],s93 offen offset:1024 sc1
rnx_100945:
s_bitcmp1_b32 s55,6
s_cbranch_scc0 rdn_100946
s_waitcnt vmcnt(5)
v_max3_u32 v124,v40,v41,v42
v_max_u32 v124,v124,v43
v_cmp_eq_u32 vcc,-1,v124
s_cbranch_vccnz rfa_100947
buffer_load_dword v125,off,s[20:23],s92 sc1
s_bitset0_b32 s55,6
s_cmp_eq_u32 s55,0
s_cbranch_scc1 segb_100858
s_branch rnx_100948
rdn_100946:
buffer_load_dword v125,off,s[20:23],s92 sc1
s_branch rnx_100948
rfa_100947:
buffer_load_dwordx4 v[40:43],v0,s[20:23],s93 offen offset:2048 sc1
rnx_100948:
s_bitcmp1_b32 s55,7
s_cbranch_scc0 rdn_100949
s_waitcnt vmcnt(5)
v_max3_u32 v124,v44,v45,v46
v_max_u32 v124,v124,v47
v_cmp_eq_u32 vcc,-1,v124
s_cbranch_vccnz rfa_100950
buffer_load_dword v125,off,s[20:23],s92 sc1
s_bitset0_b32 s55,7
s_cmp_eq_u32 s55,0
s_cbranch_scc1 segb_100858
s_branch rnx_100951
rdn_100949:
buffer_load_dword v125,off,s[20:23],s92 sc1
s_branch rnx_100951
rfa_100950:
buffer_load_dwordx4 v[44:47],v0,s[20:23],s93 offen offset:3072 sc1
rnx_100951:
rot_100942:
s_bitcmp1_b32 s55,4
s_cbranch_scc0 rdn_100952
s_waitcnt vmcnt(3)
v_max3_u32 v124,v32,v33,v34
v_max_u32 v124,v124,v35
v_cmp_eq_u32 vcc,-1,v124
s_cbranch_vccnz rfa_100953
buffer_load_dword v125,off,s[20:23],s92 sc1
s_bitset0_b32 s55,4
v_smfmac_f32_16x16x64_bf16 v[48:51],v[32:35],a[0:7],v1
v_smfmac_f32_16x16x64_bf16 v[52:55],v[32:35],a[8:15],v1
v_smfmac_f32_16x16x64_bf16 v[56:59],v[32:35],a[16:23],v1
v_smfmac_f32_16x16x64_bf16 v[60:63],v[32:35],a[24:31],v1
v_smfmac_f32_16x16x64_bf16 v[64:67],v[32:35],a[32:39],v1
v_smfmac_f32_16x16x64_bf16 v[68:71],v[32:35],a[40:47],v1
v_smfmac_f32_16x16x64_bf16 v[72:75],v[32:35],a[48:55],v1
v_smfmac_f32_16x16x64_bf16 v[76:79],v[32:35],a[56:63],v1
s_cmp_eq_u32 s55,0
s_cbranch_scc1 segb_100858
s_branch rnx_100954
rdn_100952:
buffer_load_dword v125,off,s[20:23],s92 sc1
s_branch rnx_100954
rfa_100953:
buffer_load_dwordx4 v[32:35],v0,s[20:23],s93 offen offset:0 sc1
rnx_100954:
s_bitcmp1_b32 s55,5
s_cbranch_scc0 rdn_100955
s_waitcnt vmcnt(3)
v_max3_u32 v124,v36,v37,v38
v_max_u32 v124,v124,v39
v_cmp_eq_u32 vcc,-1,v124
s_cbranch_vccnz rfa_100956
buffer_load_dword v125,off,s[20:23],s92 sc1
s_bitset0_b32 s55,5
v_smfmac_f32_16x16x64_bf16 v[48:51],v[36:39],a[64:71],v1
v_smfmac_f32_16x16x64_bf16 v[52:55],v[36:39],a[72:79],v1
v_smfmac_f32_16x16x64_bf16 v[56:59],v[36:39],a[80:87],v1
v_smfmac_f32_16x16x64_bf16 v[60:63],v[36:39],a[88:95],v1
v_smfmac_f32_16x16x64_bf16 v[64:67],v[36:39],a[96:103],v1
v_smfmac_f32_16x16x64_bf16 v[68:71],v[36:39],a[104:111],v1
v_smfmac_f32_16x16x64_bf16 v[72:75],v[36:39],a[112:119],v1
v_smfmac_f32_16x16x64_bf16 v[76:79],v[36:39],a[120:127],v1
s_cmp_eq_u32 s55,0
s_cbranch_scc1 segb_100858
s_branch rnx_100957
rdn_100955:
buffer_load_dword v125,off,s[20:23],s92 sc1
s_branch rnx_100957
rfa_100956:
buffer_load_dwordx4 v[36:39],v0,s[20:23],s93 offen offset:1024 sc1
rnx_100957:
s_bitcmp1_b32 s55,6
s_cbranch_scc0 rdn_100958
s_waitcnt vmcnt(3)
v_max3_u32 v124,v40,v41,v42
v_max_u32 v124,v124,v43
v_cmp_eq_u32 vcc,-1,v124
s_cbranch_vccnz rfa_100959
buffer_load_dword v125,off,s[20:23],s92 sc1
s_bitset0_b32 s55,6
s_cmp_eq_u32 s55,0
s_cbranch_scc1 segb_100858
s_branch rnx_100960
rdn_100958:
buffer_load_dword v125,off,s[20:23],s92 sc1
s_branch rnx_100960
rfa_100959:
buffer_load_dwordx4 v[40:43],v0,s[20:23],s93 offen offset:2048 sc1
rnx_100960:
s_bitcmp1_b32 s55,7
s_cbranch_scc0 rdn_100961
s_waitcnt vmcnt(3)
v_max3_u32 v124,v44,v45,v46
v_max_u32 v124,v124,v47
v_cmp_eq_u32 vcc,-1,v124
s_cbranch_vccnz rfa_100962
buffer_load_dword v125,off,s[20:23],s92 sc1
s_bitset0_b32 s55,7
s_cmp_eq_u32 s55,0
s_cbranch_scc1 segb_100858
s_branch rnx_100963
rdn_100961:
buffer_load_dword v125,off,s[20:23],s92 sc1
s_branch rnx_100963
rfa_100962:
buffer_load_dwordx4 v[44:47],v0,s[20:23],s93 offen offset:3072 sc1
rnx_100963:
s_sub_u32 s90,s90,1
s_cmp_gt_i32 s90,0
s_cbranch_scc1 rot_100942
s_mov_b32 s55,0
s_branch segb_100858
fl_100865:
v_smfmac_f32_16x16x64_bf16 v[76:79],v[32:35],a[56:63],v1
flb_100873:
buffer_load_dwordx4 v[36:39],v0,s[20:23],s93 offen offset:1024 sc1
s_mov_b32 s55,224
s_bitcmp1_b32 s55,6
s_cbranch_scc0 rdn_100965
s_waitcnt vmcnt(5)
v_max3_u32 v124,v40,v41,v42
v_max_u32 v124,v124,v43
v_cmp_eq_u32 vcc,-1,v124
s_cbranch_vccnz rfa_100966
buffer_load_dword v125,off,s[20:23],s92 sc1
s_bitset0_b32 s55,6
s_cmp_eq_u32 s55,0
s_cbranch_scc1 segb_100858
s_branch rnx_100967
rdn_100965:
buffer_load_dword v125,off,s[20:23],s92 sc1
s_branch rnx_100967
rfa_100966:
buffer_load_dwordx4 v[40:43],v0,s[20:23],s93 offen offset:2048 sc1
rnx_100967:
s_bitcmp1_b32 s55,7
s_cbranch_scc0 rdn_100968
s_waitcnt vmcnt(5)
v_max3_u32 v124,v44,v45,v46
v_max_u32 v124,v124,v47
v_cmp_eq_u32 vcc,-1,v124
s_cbranch_vccnz rfa_100969
buffer_load_dword v125,off,s[20:23],s92 sc1
s_bitset0_b32 s55,7
s_cmp_eq_u32 s55,0
s_cbranch_scc1 segb_100858
s_branch rnx_100970
rdn_100968:
buffer_load_dword v125,off,s[20:23],s92 sc1
s_branch rnx_100970
rfa_100969:
buffer_load_dwordx4 v[44:47],v0,s[20:23],s93 offen offset:3072 sc1
rnx_100970:
rot_100964:
s_bitcmp1_b32 s55,5
s_cbranch_scc0 rdn_100971
s_waitcnt vmcnt(2)
v_max3_u32 v124,v36,v37,v38
v_max_u32 v124,v124,v39
v_cmp_eq_u32 vcc,-1,v124
s_cbranch_vccnz rfa_100972
buffer_load_dword v125,off,s[20:23],s92 sc1
s_bitset0_b32 s55,5
v_smfmac_f32_16x16x64_bf16 v[48:51],v[36:39],a[64:71],v1
v_smfmac_f32_16x16x64_bf16 v[52:55],v[36:39],a[72:79],v1
v_smfmac_f32_16x16x64_bf16 v[56:59],v[36:39],a[80:87],v1
v_smfmac_f32_16x16x64_bf16 v[60:63],v[36:39],a[88:95],v1
v_smfmac_f32_16x16x64_bf16 v[64:67],v[36:39],a[96:103],v1
v_smfmac_f32_16x16x64_bf16 v[68:71],v[36:39],a[104:111],v1
v_smfmac_f32_16x16x64_bf16 v[72:75],v[36:39],a[112:119],v1
v_smfmac_f32_16x16x64_bf16 v[76:79],v[36:39],a[120:127],v1
s_cmp_eq_u32 s55,0
s_cbranch_scc1 segb_100858
s_branch rnx_100973
rdn_100971:
buffer_load_dword v125,off,s[20:23],s92 sc1
s_branch rnx_100973
rfa_100972:
buffer_load_dwordx4 v[36:39],v0,s[20:23],s93 offen offset:1024 sc1
rnx_100973:
s_bitcmp1_b32 s55,6
s_cbranch_scc0 rdn_100974
s_waitcnt vmcnt(2)
v_max3_u32 v124,v40,v41,v42
v_max_u32 v124,v124,v43
v_cmp_eq_u32 vcc,-1,v124
s_cbranch_vccnz rfa_100975
buffer_load_dword v125,off,s[20:23],s92 sc1
s_bitset0_b32 s55,6
s_cmp_eq_u32 s55,0
s_cbranch_scc1 segb_100858
s_branch rnx_100976
rdn_100974:
buffer_load_dword v125,off,s[20:23],s92 sc1
s_branch rnx_100976
rfa_100975:
buffer_load_dwordx4 v[40:43],v0,s[20:23],s93 offen offset:2048 sc1
rnx_100976:
s_bitcmp1_b32 s55,7
s_cbranch_scc0 rdn_100977
s_waitcnt vmcnt(2)
v_max3_u32 v124,v44,v45,v46
v_max_u32 v124,v124,v47
v_cmp_eq_u32 vcc,-1,v124
s_cbranch_vccnz rfa_100978
buffer_load_dword v125,off,s[20:23],s92 sc1
s_bitset0_b32 s55,7
s_cmp_eq_u32 s55,0
s_cbranch_scc1 segb_100858
s_branch rnx_100979
rdn_100977:
buffer_load_dword v125,off,s[20:23],s92 sc1
s_branch rnx_100979
rfa_100978:
buffer_load_dwordx4 v[44:47],v0,s[20:23],s93 offen offset:3072 sc1
rnx_100979:
s_sub_u32 s90,s90,1
s_cmp_gt_i32 s90,0
s_cbranch_scc1 rot_100964
s_mov_b32 s55,0
s_branch segb_100858
fl_100866:
v_smfmac_f32_16x16x64_bf16 v[76:79],v[36:39],a[120:127],v1
flb_100874:
s_mov_b32 s55,192
s_bitcmp1_b32 s55,6
s_cbranch_scc0 rdn_100981
s_waitcnt vmcnt(5)
v_max3_u32 v124,v40,v41,v42
v_max_u32 v124,v124,v43
v_cmp_eq_u32 vcc,-1,v124
s_cbranch_vccnz rfa_100982
buffer_load_dword v125,off,s[20:23],s92 sc1
s_bitset0_b32 s55,6
s_cmp_eq_u32 s55,0
s_cbranch_scc1 segb_100858
s_branch rnx_100983
rdn_100981:
buffer_load_dword v125,off,s[20:23],s92 sc1
s_branch rnx_100983
rfa_100982:
buffer_load_dwordx4 v[40:43],v0,s[20:23],s93 offen offset:2048 sc1
rnx_100983:
s_bitcmp1_b32 s55,7
s_cbranch_scc0 rdn_100984
s_waitcnt vmcnt(5)
v_max3_u32 v124,v44,v45,v46
v_max_u32 v124,v124,v47
v_cmp_eq_u32 vcc,-1,v124
s_cbranch_vccnz rfa_100985
buffer_load_dword v125,off,s[20:23],s92 sc1
s_bitset0_b32 s55,7
s_cmp_eq_u32 s55,0
s_cbranch_scc1 segb_100858
s_branch rnx_100986
rdn_100984:
buffer_load_dword v125,off,s[20:23],s92 sc1
s_branch rnx_100986
rfa_100985:
buffer_load_dwordx4 v[44:47],v0,s[20:23],s93 offen offset:3072 sc1
rnx_100986:
rot_100980:
s_bitcmp1_b32 s55,6
s_cbranch_scc0 rdn_100987
s_waitcnt vmcnt(1)
v_max3_u32 v124,v40,v41,v42
v_max_u32 v124,v124,v43
v_cmp_eq_u32 vcc,-1,v124
s_cbranch_vccnz rfa_100988
buffer_load_dword v125,off,s[20:23],s92 sc1
s_bitset0_b32 s55,6
s_cmp_eq_u32 s55,0
s_cbranch_scc1 segb_100858
s_branch rnx_100989
rdn_100987:
buffer_load_dword v125,off,s[20:23],s92 sc1
s_branch rnx_100989
rfa_100988:
buffer_load_dwordx4 v[40:43],v0,s[20:23],s93 offen offset:2048 sc1
rnx_100989:
s_bitcmp1_b32 s55,7
s_cbranch_scc0 rdn_100990
s_waitcnt vmcnt(1)
v_max3_u32 v124,v44,v45,v46
v_max_u32 v124,v124,v47
v_cmp_eq_u32 vcc,-1,v124
s_cbranch_vccnz rfa_100991
buffer_load_dword v125,off,s[20:23],s92 sc1
s_bitset0_b32 s55,7
s_cmp_eq_u32 s55,0
s_cbranch_scc1 segb_100858
s_branch rnx_100992
rdn_100990:
buffer_load_dword v125,off,s[20:23],s92 sc1
s_branch rnx_100992
rfa_100991:
buffer_load_dwordx4 v[44:47],v0,s[20:23],s93 offen offset:3072 sc1
rnx_100992:
s_sub_u32 s90,s90,1
s_cmp_gt_i32 s90,0
s_cbranch_scc1 rot_100980
s_mov_b32 s55,0
s_branch segb_100858
dfl_100933:
buffer_load_dwordx4 v[20:23],v0,s[20:23],s92 offen offset:1024 sc1
s_bitset1_b32 s55,1
buffer_load_dwordx4 v[36:39],v0,s[20:23],s93 offen offset:1024 sc1
s_waitcnt vmcnt(5)
v_max3_u32 v124,v24,v25,v26
v_max_u32 v124,v124,v27
v_cmp_eq_u32 vcc,-1,v124
s_cbranch_vccnz dfl_100934
s_branch dseg_100937
dfl_100934:
buffer_load_dwordx4 v[24:27],v0,s[20:23],s92 offen offset:2048 sc1
s_bitset1_b32 s55,2
buffer_load_dwordx4 v[40:43],v0,s[20:23],s93 offen offset:2048 sc1
buffer_load_dwordx4 v[44:47],v0,s[20:23],s93 offen offset:3072 sc1
s_waitcnt vmcnt(7)
v_max3_u32 v124,v28,v29,v30
v_max_u32 v124,v124,v31
v_cmp_eq_u32 vcc,-1,v124
s_cbranch_vccnz dfl_100935
s_branch dseg_100938
dfl_100935:
buffer_load_dwordx4 v[28:31],v0,s[20:23],s92 offen offset:3072 sc1
s_bitset1_b32 s55,3
buffer_store_dword v126,v121,s[20:23],s69 offen sc1
s_branch lap2_100939
dseg_100937:
v_smfmac_f32_16x16x64_bf16 v[48:51],v[24:27],a[128:135],v1
buffer_load_dword v125,off,s[20:23],s92 sc1
v_smfmac_f32_16x16x64_bf16 v[52:55],v[24:27],a[136:143],v1
buffer_load_dwordx4 v[40:43],v0,s[20:23],s93 offen offset:2048 sc1
v_smfmac_f32_16x16x64_bf16 v[56:59],v[24:27],a[144:151],v1
buffer_load_dwordx4 v[44:47],v0,s[20:23],s93 offen offset:3072 sc1
s_waitcnt vmcnt(7)
v_max3_u32 v124,v28,v29,v30
v_smfmac_f32_16x16x64_bf16 v[60:63],v[24:27],a[152:159],v1
v_max_u32 v124,v124,v31
v_smfmac_f32_16x16x64_bf16 v[64:67],v[24:27],a[160:167],v1
v_cmp_eq_u32 vcc,-1,v124
v_smfmac_f32_16x16x64_bf16 v[68:71],v[24:27],a[168:175],v1
v_smfmac_f32_16x16x64_bf16 v[72:75],v[24:27],a[176:183],v1
v_smfmac_f32_16x16x64_bf16 v[76:79],v[24:27],a[184:191],v1
s_cbranch_vccnz dfl_100935
dseg_100938:
v_smfmac_f32_16x16x64_bf16 v[48:51],v[28:31],a[192:199],v1
buffer_load_dword v125,off,s[20:23],s92 sc1
v_smfmac_f32_16x16x64_bf16 v[52:55],v[28:31],a[200:207],v1
buffer_store_dword v126,v121,s[20:23],s69 offen sc1
v_smfmac_f32_16x16x64_bf16 v[56:59],v[28:31],a[208:215],v1
v_smfmac_f32_16x16x64_bf16 v[60:63],v[28:31],a[216:223],v1
v_smfmac_f32_16x16x64_bf16 v[64:67],v[28:31],a[224:231],v1
v_smfmac_f32_16x16x64_bf16 v[68:71],v[28:31],a[232:239],v1
v_smfmac_f32_16x16x64_bf16 v[72:75],v[28:31],a[240:247],v1
v_smfmac_f32_16x16x64_bf16 v[76:79],v[28:31],a[248:255],v1
lap2_100939:
s_bitcmp1_b32 s55,0
s_cbranch_scc0 l2s_100993
s_waitcnt vmcnt(8)
v_max3_u32 v124,v16,v17,v18
v_max_u32 v124,v124,v19
v_cmp_eq_u32 vcc,-1,v124
s_cbranch_vccnz l2s_100993
s_bitset0_b32 s55,0
v_smfmac_f32_16x16x64_bf16 v[48:51],v[16:19],a[0:7],v1
v_smfmac_f32_16x16x64_bf16 v[52:55],v[16:19],a[8:15],v1
v_smfmac_f32_16x16x64_bf16 v[56:59],v[16:19],a[16:23],v1
v_smfmac_f32_16x16x64_bf16 v[60:63],v[16:19],a[24:31],v1
v_smfmac_f32_16x16x64_bf16 v[64:67],v[16:19],a[32:39],v1
v_smfmac_f32_16x16x64_bf16 v[68:71],v[16:19],a[40:47],v1
v_smfmac_f32_16x16x64_bf16 v[72:75],v[16:19],a[48:55],v1
v_smfmac_f32_16x16x64_bf16 v[76:79],v[16:19],a[56:63],v1
l2s_100993:
s_bitcmp1_b32 s55,1
s_cbranch_scc0 l2s_100995
s_waitcnt vmcnt(6)
v_max3_u32 v124,v20,v21,v22
v_max_u32 v124,v124,v23
v_cmp_eq_u32 vcc,-1,v124
s_cbranch_vccnz l2s_100995
s_bitset0_b32 s55,1
v_smfmac_f32_16x16x64_bf16 v[48:51],v[20:23],a[64:71],v1
v_smfmac_f32_16x16x64_bf16 v[52:55],v[20:23],a[72:79],v1
v_smfmac_f32_16x16x64_bf16 v[56:59],v[20:23],a[80:87],v1
v_smfmac_f32_16x16x64_bf16 v[60:63],v[20:23],a[88:95],v1
v_smfmac_f32_16x16x64_bf16 v[64:67],v[20:23],a[96:103],v1
v_smfmac_f32_16x16x64_bf16 v[68:71],v[20:23],a[104:111],v1
v_smfmac_f32_16x16x64_bf16 v[72:75],v[20:23],a[112:119],v1
v_smfmac_f32_16x16x64_bf16 v[76:79],v[20:23],a[120:127],v1
l2s_100995:
s_bitcmp1_b32 s55,2
s_cbranch_scc0 l2s_100997
s_waitcnt vmcnt(4)
v_max3_u32 v124,v24,v25,v26
v_max_u32 v124,v124,v27
v_cmp_eq_u32 vcc,-1,v124
s_cbranch_vccnz l2s_100997
s_bitset0_b32 s55,2
v_smfmac_f32_16x16x64_bf16 v[48:51],v[24:27],a[128:135],v1
v_smfmac_f32_16x16x64_bf16 v[52:55],v[24:27],a[136:143],v1
v_smfmac_f32_16x16x64_bf16 v[56:59],v[24:27],a[144:151],v1
v_smfmac_f32_16x16x64_bf16 v[60:63],v[24:27],a[152:159],v1
v_smfmac_f32_16x16x64_bf16 v[64:67],v[24:27],a[160:167],v1
v_smfmac_f32_16x16x64_bf16 v[68:71],v[24:27],a[168:175],v1
v_smfmac_f32_16x16x64_bf16 v[72:75],v[24:27],a[176:183],v1
v_smfmac_f32_16x16x64_bf16 v[76:79],v[24:27],a[184:191],v1
l2s_100997:
s_bitcmp1_b32 s55,3
s_cbranch_scc0 l2s_100999
s_waitcnt vmcnt(1)
v_max3_u32 v124,v28,v29,v30
v_max_u32 v124,v124,v31
v_cmp_eq_u32 vcc,-1,v124
s_cbranch_vccnz l2s_100999
s_bitset0_b32 s55,3
v_smfmac_f32_16x16x64_bf16 v[48:51],v[28:31],a[192:199],v1
v_smfmac_f32_16x16x64_bf16 v[52:55],v[28:31],a[200:207],v1
v_smfmac_f32_16x16x64_bf16 v[56:59],v[28:31],a[208:215],v1
v_smfmac_f32_16x16x64_bf16 v[60:63],v[28:31],a[216:223],v1
v_smfmac_f32_16x16x64_bf16 v[64:67],v[28:31],a[224:231],v1
v_smfmac_f32_16x16x64_bf16 v[68:71],v[28:31],a[232:239],v1
v_smfmac_f32_16x16x64_bf16 v[72:75],v[28:31],a[240:247],v1
v_smfmac_f32_16x16x64_bf16 v[76:79],v[28:31],a[248:255],v1
l2s_100999:
s_cmp_eq_u32 s55,0
s_cbranch_scc0 lfb_100940
Ldone_100941:
s_waitcnt vmcnt(7)
v_max3_u32 v124,v32,v33,v34
v_max_u32 v124,v124,v35
v_cmp_eq_u32 vcc,-1,v124
s_cbranch_vccnz flb_100872
s_branch segb_100856
lfb_100940:
s_bitcmp1_b32 s55,0
s_cbranch_scc0 dsk_101001
buffer_load_dwordx4 v[16:19],v0,s[20:23],s92 offen offset:0 sc1
dsk_101001:
s_bitcmp1_b32 s55,1
s_cbranch_scc0 dsk_101002
buffer_load_dwordx4 v[20:23],v0,s[20:23],s92 offen offset:1024 sc1
dsk_101002:
s_bitcmp1_b32 s55,2
s_cbranch_scc0 dsk_101003
buffer_load_dwordx4 v[24:27],v0,s[20:23],s92 offen offset:2048 sc1
dsk_101003:
s_bitcmp1_b32 s55,3
s_cbranch_scc0 dsk_101004
buffer_load_dwordx4 v[28:31],v0,s[20:23],s92 offen offset:3072 sc1
dsk_101004:
s_bitcmp1_b32 s55,0
s_cbranch_scc0 dsk_101005
s_waitcnt vmcnt(2)
v_max3_u32 v124,v16,v17,v18
v_max_u32 v124,v124,v19
v_cmp_eq_u32 vcc,-1,v124
s_cbranch_vccz dgo_101006
s_nop 15
buffer_load_dwordx4 v[104:107],v0,s[20:23],s92 offen offset:0 sc1
s_nop 15
buffer_load_dwordx4 v[108:111],v0,s[20:23],s92 offen offset:0 sc1
dlp_101007:
s_waitcnt vmcnt(2)
v_max3_u32 v124,v16,v17,v18
v_max_u32 v124,v124,v19
v_cmp_eq_u32 vcc,-1,v124
s_cbranch_vccz dgo_101006
buffer_load_dwordx4 v[16:19],v0,s[20:23],s92 offen offset:0 sc1
s_waitcnt vmcnt(2)
v_max3_u32 v124,v104,v105,v106
v_max_u32 v124,v124,v107
v_cmp_eq_u32 vcc,-1,v124
s_cbranch_vccz dcp_101009
buffer_load_dwordx4 v[104:107],v0,s[20:23],s92 offen offset:0 sc1
s_waitcnt vmcnt(2)
v_max3_u32 v124,v108,v109,v110
v_max_u32 v124,v124,v111
v_cmp_eq_u32 vcc,-1,v124
s_cbranch_vccz dcp_101010
buffer_load_dwordx4 v[108:111],v0,s[20:23],s92 offen offset:0 sc1
s_sub_u32 s90,s90,1
s_cmp_gt_i32 s90,0
s_cbranch_scc1 dlp_101007
s_branch dgo_101006
dcp_101009:
v_mov_b32 v16,v104
v_mov_b32 v17,v105
v_mov_b32 v18,v106
v_mov_b32 v19,v107
s_nop 1
s_branch dgo_101006
dcp_101010:
v_mov_b32 v16,v108
v_mov_b32 v17,v109
v_mov_b32 v18,v110
v_mov_b32 v19,v111
s_nop 1
dgo_101006:
v_smfmac_f32_16x16x64_bf16 v[48:51],v[16:19],a[0:7],v1
v_smfmac_f32_16x16x64_bf16 v[52:55],v[16:19],a[8:15],v1
v_smfmac_f32_16x16x64_bf16 v[56:59],v[16:19],a[16:23],v1
v_smfmac_f32_16x16x64_bf16 v[60:63],v[16:19],a[24:31],v1
v_smfmac_f32_16x16x64_bf16 v[64:67],v[16:19],a[32:39],v1
v_smfmac_f32_16x16x64_bf16 v[68:71],v[16:19],a[40:47],v1
v_smfmac_f32_16x16x64_bf16 v[72:75],v[16:19],a[48:55],v1
v_smfmac_f32_16x16x64_bf16 v[76:79],v[16:19],a[56:63],v1
dsk_101005:
s_bitcmp1_b32 s55,1
s_cbranch_scc0 dsk_101011
s_waitcnt vmcnt(2)
v_max3_u32 v124,v20,v21,v22
v_max_u32 v124,v124,v23
v_cmp_eq_u32 vcc,-1,v124
s_cbranch_vccz dgo_101012
s_nop 15
buffer_load_dwordx4 v[104:107],v0,s[20:23],s92 offen offset:1024 sc1
s_nop 15
buffer_load_dwordx4 v[108:111],v0,s[20:23],s92 offen offset:1024 sc1
dlp_101013:
s_waitcnt vmcnt(2)
v_max3_u32 v124,v20,v21,v22
v_max_u32 v124,v124,v23
v_cmp_eq_u32 vcc,-1,v124
s_cbranch_vccz dgo_101012
buffer_load_dwordx4 v[20:23],v0,s[20:23],s92 offen offset:1024 sc1
s_waitcnt vmcnt(2)
v_max3_u32 v124,v104,v105,v106
v_max_u32 v124,v124,v107
v_cmp_eq_u32 vcc,-1,v124
s_cbranch_vccz dcp_101015
buffer_load_dwordx4 v[104:107],v0,s[20:23],s92 offen offset:1024 sc1
s_waitcnt vmcnt(2)
v_max3_u32 v124,v108,v109,v110
v_max_u32 v124,v124,v111
v_cmp_eq_u32 vcc,-1,v124
s_cbranch_vccz dcp_101016
buffer_load_dwordx4 v[108:111],v0,s[20:23],s92 offen offset:1024 sc1
s_sub_u32 s90,s90,1
s_cmp_gt_i32 s90,0
s_cbranch_scc1 dlp_101013
s_branch dgo_101012
dcp_101015:
v_mov_b32 v20,v104
v_mov_b32 v21,v105
v_mov_b32 v22,v106
v_mov_b32 v23,v107
s_nop 1
s_branch dgo_101012
dcp_101016:
v_mov_b32 v20,v108
v_mov_b32 v21,v109
v_mov_b32 v22,v110
v_mov_b32 v23,v111
s_nop 1
dgo_101012:
v_smfmac_f32_16x16x64_bf16 v[48:51],v[20:23],a[64:71],v1
v_smfmac_f32_16x16x64_bf16 v[52:55],v[20:23],a[72:79],v1
v_smfmac_f32_16x16x64_bf16 v[56:59],v[20:23],a[80:87],v1
v_smfmac_f32_16x16x64_bf16 v[60:63],v[20:23],a[88:95],v1
v_smfmac_f32_16x16x64_bf16 v[64:67],v[20:23],a[96:103],v1
v_smfmac_f32_16x16x64_bf16 v[68:71],v[20:23],a[104:111],v1
v_smfmac_f32_16x16x64_bf16 v[72:75],v[20:23],a[112:119],v1
v_smfmac_f32_16x16x64_bf16 v[76:79],v[20:23],a[120:127],v1
dsk_101011:
s_bitcmp1_b32 s55,2
s_cbranch_scc0 dsk_101017
s_waitcnt vmcnt(2)
v_max3_u32 v124,v24,v25,v26
v_max_u32 v124,v124,v27
v_cmp_eq_u32 vcc,-1,v124
s_cbranch_vccz dgo_101018
s_nop 15
buffer_load_dwordx4 v[104:107],v0,s[20:23],s92 offen offset:2048 sc1
s_nop 15
buffer_load_dwordx4 v[108:111],v0,s[20:23],s92 offen offset:2048 sc1
dlp_101019:
s_waitcnt vmcnt(2)
v_max3_u32 v124,v24,v25,v26
v_max_u32 v124,v124,v27
v_cmp_eq_u32 vcc,-1,v124
s_cbranch_vccz dgo_101018
buffer_load_dwordx4 v[24:27],v0,s[20:23],s92 offen offset:2048 sc1
s_waitcnt vmcnt(2)
v_max3_u32 v124,v104,v105,v106
v_max_u32 v124,v124,v107
v_cmp_eq_u32 vcc,-1,v124
s_cbranch_vccz dcp_101021
buffer_load_dwordx4 v[104:107],v0,s[20:23],s92 offen offset:2048 sc1
s_waitcnt vmcnt(2)
v_max3_u32 v124,v108,v109,v110
v_max_u32 v124,v124,v111
v_cmp_eq_u32 vcc,-1,v124
s_cbranch_vccz dcp_101022
buffer_load_dwordx4 v[108:111],v0,s[20:23],s92 offen offset:2048 sc1
s_sub_u32 s90,s90,1
s_cmp_gt_i32 s90,0
s_cbranch_scc1 dlp_101019
s_branch dgo_101018
dcp_101021:
v_mov_b32 v24,v104
v_mov_b32 v25,v105
v_mov_b32 v26,v106
v_mov_b32 v27,v107
s_nop 1
s_branch dgo_101018
dcp_101022:
v_mov_b32 v24,v108
v_mov_b32 v25,v109
v_mov_b32 v26,v110
v_mov_b32 v27,v111
s_nop 1
dgo_101018:
v_smfmac_f32_16x16x64_bf16 v[48:51],v[24:27],a[128:135],v1
v_smfmac_f32_16x16x64_bf16 v[52:55],v[24:27],a[136:143],v1
v_smfmac_f32_16x16x64_bf16 v[56:59],v[24:27],a[144:151],v1
v_smfmac_f32_16x16x64_bf16 v[60:63],v[24:27],a[152:159],v1
v_smfmac_f32_16x16x64_bf16 v[64:67],v[24:27],a[160:167],v1
v_smfmac_f32_16x16x64_bf16 v[68:71],v[24:27],a[168:175],v1
v_smfmac_f32_16x16x64_bf16 v[72:75],v[24:27],a[176:183],v1
v_smfmac_f32_16x16x64_bf16 v[76:79],v[24:27],a[184:191],v1
dsk_101017:
s_bitcmp1_b32 s55,3
s_cbranch_scc0 dsk_101023
s_waitcnt vmcnt(2)
v_max3_u32 v124,v28,v29,v30
v_max_u32 v124,v124,v31
v_cmp_eq_u32 vcc,-1,v124
s_cbranch_vccz dgo_101024
s_nop 15
buffer_load_dwordx4 v[104:107],v0,s[20:23],s92 offen offset:3072 sc1
s_nop 15
buffer_load_dwordx4 v[108:111],v0,s[20:23],s92 offen offset:3072 sc1
dlp_101025:
s_waitcnt vmcnt(2)
v_max3_u32 v124,v28,v29,v30
v_max_u32 v124,v124,v31
v_cmp_eq_u32 vcc,-1,v124
s_cbranch_vccz dgo_101024
buffer_load_dwordx4 v[28:31],v0,s[20:23],s92 offen offset:3072 sc1
s_waitcnt vmcnt(2)
v_max3_u32 v124,v104,v105,v106
v_max_u32 v124,v124,v107
v_cmp_eq_u32 vcc,-1,v124
s_cbranch_vccz dcp_101027
buffer_load_dwordx4 v[104:107],v0,s[20:23],s92 offen offset:3072 sc1
s_waitcnt vmcnt(2)
v_max3_u32 v124,v108,v109,v110
v_max_u32 v124,v124,v111
v_cmp_eq_u32 vcc,-1,v124
s_cbranch_vccz dcp_101028
buffer_load_dwordx4 v[108:111],v0,s[20:23],s92 offen offset:3072 sc1
s_sub_u32 s90,s90,1
s_cmp_gt_i32 s90,0
s_cbranch_scc1 dlp_101025
s_branch dgo_101024
dcp_101027:
v_mov_b32 v28,v104
v_mov_b32 v29,v105
v_mov_b32 v30,v106
v_mov_b32 v31,v107
s_nop 1
s_branch dgo_101024
dcp_101028:
v_mov_b32 v28,v108
v_mov_b32 v29,v109
v_mov_b32 v30,v110
v_mov_b32 v31,v111
s_nop 1
dgo_101024:
v_smfmac_f32_16x16x64_bf16 v[48:51],v[28:31],a[192:199],v1
v_smfmac_f32_16x16x64_bf16 v[52:55],v[28:31],a[200:207],v1
v_smfmac_f32_16x16x64_bf16 v[56:59],v[28:31],a[208:215],v1
v_smfmac_f32_16x16x64_bf16 v[60:63],v[28:31],a[216:223],v1
v_smfmac_f32_16x16x64_bf16 v[64:67],v[28:31],a[224:231],v1
v_smfmac_f32_16x16x64_bf16 v[68:71],v[28:31],a[232:239],v1
v_smfmac_f32_16x16x64_bf16 v[72:75],v[28:31],a[240:247],v1
v_smfmac_f32_16x16x64_bf16 v[76:79],v[28:31],a[248:255],v1
dsk_101023:
s_mov_b32 s55,0
s_branch Ldone_100941
slowA_100876:
buffer_load_dwordx4 v[44:47],v0,s[20:23],s93 offen offset:3072 sc1
dsk_101029:
s_bitcmp1_b32 s55,7
s_cbranch_scc0 dsk_101030
s_waitcnt vmcnt(2)
v_max3_u32 v124,v44,v45,v46
v_max_u32 v124,v124,v47
v_cmp_eq_u32 vcc,-1,v124
s_cbranch_vccz dgo_101031
s_nop 15
s_nop 3
buffer_load_dwordx4 v[104:107],v0,s[20:23],s93 offen offset:3072 sc1
s_nop 15
s_nop 3
buffer_load_dwordx4 v[108:111],v0,s[20:23],s93 offen offset:3072 sc1
dlp_101032:
s_waitcnt vmcnt(2)
v_max3_u32 v124,v44,v45,v46
v_max_u32 v124,v124,v47
v_cmp_eq_u32 vcc,-1,v124
s_cbranch_vccz dgo_101031
buffer_load_dwordx4 v[44:47],v0,s[20:23],s93 offen offset:3072 sc1
s_waitcnt vmcnt(2)
v_max3_u32 v124,v104,v105,v106
v_max_u32 v124,v124,v107
v_cmp_eq_u32 vcc,-1,v124
s_cbranch_vccz dcp_101034
buffer_load_dwordx4 v[104:107],v0,s[20:23],s93 offen offset:3072 sc1
s_waitcnt vmcnt(2)
v_max3_u32 v124,v108,v109,v110
v_max_u32 v124,v124,v111
v_cmp_eq_u32 vcc,-1,v124
s_cbranch_vccz dcp_101035
buffer_load_dwordx4 v[108:111],v0,s[20:23],s93 offen offset:3072 sc1
s_sub_u32 s90,s90,1
s_cmp_gt_i32 s90,0
s_cbranch_scc1 dlp_101032
s_branch dgo_101031
dcp_101034:
v_mov_b32 v44,v104
v_mov_b32 v45,v105
v_mov_b32 v46,v106
v_mov_b32 v47,v107
s_nop 1
s_branch dgo_101031
dcp_101035:
v_mov_b32 v44,v108
v_mov_b32 v45,v109
v_mov_b32 v46,v110
v_mov_b32 v47,v111
s_nop 1
dgo_101031:
dsk_101030:
s_mov_b32 s55,0
s_branch segb_100858
srt_100884:
s_sub_u32 s90,s90,1
s_cmp_gt_i32 s90,0
s_cbranch_scc0 sok_100883
buffer_load_dwordx4 v[16:19],v2,s[20:23],s94 offen offset:0 sc1
buffer_load_dwordx4 v[32:35],v2,s[20:23],s94 offen offset:1536 sc1
buffer_load_dwordx4 v[20:23],v2,s[20:23],s95 offen offset:0 sc1
buffer_load_dwordx4 v[36:39],v2,s[20:23],s95 offen offset:1536 sc1
buffer_load_dword v120,v3,s[20:23],s94 offen offset:0 sc1
buffer_load_dword v121,v3,s[20:23],s94 offen offset:1536 sc1
buffer_load_dword v122,v3,s[20:23],s95 offen offset:0 sc1
buffer_load_dword v123,v3,s[20:23],s95 offen offset:1536 sc1
s_branch sp_100882
of_100885:
s_mov_b32 s55,3
buffer_load_dwordx4 v[16:19],v0,s[20:23],s96 offen offset:0 sc1
buffer_load_dwordx4 v[20:23],v0,s[20:23],s96 offen offset:1024 sc1
s_waitcnt vmcnt(6)
v_max3_u32 v124,v24,v25,v26
v_max3_u32 v124,v124,v27,v28
v_max3_u32 v124,v124,v29,v30
v_max_u32 v124,v124,v31
v_cmp_eq_u32 vcc,-1,v124
s_cbranch_vccnz ost_101037
v_smfmac_f32_16x16x64_bf16 v[96:99],v[24:27],v[80:87],v1
buffer_load_dword v120,off,s[20:23],s96 sc1
v_smfmac_f32_16x16x64_bf16 v[100:103],v[24:27],v[88:95],v1
buffer_load_dword v120,off,s[20:23],s96 sc1
v_smfmac_f32_16x16x64_bf16 v[96:99],v[28:31],v[128:135],v1
v_smfmac_f32_16x16x64_bf16 v[100:103],v[28:31],v[136:143],v1
ort_101038:
s_waitcnt vmcnt(6)
v_max3_u32 v124,v32,v33,v34
v_max3_u32 v124,v124,v35,v36
v_max3_u32 v124,v124,v37,v38
v_max_u32 v124,v124,v39
v_cmp_eq_u32 vcc,-1,v124
s_cbranch_vccnz ost_101039
v_smfmac_f32_16x16x64_bf16 v[96:99],v[32:35],v[144:151],v1
buffer_load_dword v120,off,s[20:23],s96 sc1
v_smfmac_f32_16x16x64_bf16 v[100:103],v[32:35],v[152:159],v1
buffer_load_dword v120,off,s[20:23],s96 sc1
v_smfmac_f32_16x16x64_bf16 v[96:99],v[36:39],v[160:167],v1
v_smfmac_f32_16x16x64_bf16 v[100:103],v[36:39],v[168:175],v1
ort_101040:
s_waitcnt vmcnt(7)
v_max3_u32 v124,v40,v41,v42
v_max_u32 v124,v124,v43
v_cmp_eq_u32 vcc,-1,v124
s_cbranch_vccnz ost_101041
v_smfmac_f32_16x16x64_bf16 v[96:99],v[40:43],v[176:183],v1
buffer_load_dword v120,off,s[20:23],s96 sc1
v_smfmac_f32_16x16x64_bf16 v[100:103],v[40:43],v[184:191],v1
ort_101042:
s_waitcnt vmcnt(7)
v_max3_u32 v124,v44,v45,v46
v_max_u32 v124,v124,v47
v_cmp_eq_u32 vcc,-1,v124
s_cbranch_vccnz ost_101043
v_smfmac_f32_16x16x64_bf16 v[96:99],v[44:47],v[192:199],v1
buffer_load_dword v120,off,s[20:23],s96 sc1
v_smfmac_f32_16x16x64_bf16 v[100:103],v[44:47],v[200:207],v1
ort_101044:
s_waitcnt vmcnt(6)
v_max3_u32 v124,v16,v17,v18
v_max3_u32 v124,v124,v19,v20
v_max3_u32 v124,v124,v21,v22
v_max_u32 v124,v124,v23
v_cmp_eq_u32 vcc,-1,v124
s_cbranch_vccnz olap2_101036
s_andn2_b32 s55,s55,3
v_smfmac_f32_16x16x64_bf16 v[96:99],v[16:19],v[48:55],v1
v_smfmac_f32_16x16x64_bf16 v[100:103],v[16:19],v[56:63],v1
v_smfmac_f32_16x16x64_bf16 v[96:99],v[20:23],v[64:71],v1
v_smfmac_f32_16x16x64_bf16 v[100:103],v[20:23],v[72:79],v1
s_cbranch_scc0 oback_100896
s_branch olap2_101036
ost_101037:
buffer_load_dwordx4 v[24:27],v0,s[20:23],s96 offen offset:2048 sc1
buffer_load_dwordx4 v[28:31],v0,s[20:23],s96 offen offset:3072 sc1
s_or_b32 s55,s55,12
s_branch ort_101038
ost_101039:
buffer_load_dwordx4 v[32:35],v0,s[20:23],s97 offen offset:0 sc1
buffer_load_dwordx4 v[36:39],v0,s[20:23],s97 offen offset:1024 sc1
s_or_b32 s55,s55,48
s_branch ort_101040
ost_101041:
buffer_load_dwordx4 v[40:43],v0,s[20:23],s97 offen offset:2048 sc1
s_or_b32 s55,s55,64
s_branch ort_101042
ost_101043:
buffer_load_dwordx4 v[44:47],v0,s[20:23],s97 offen offset:3072 sc1
s_or_b32 s55,s55,128
s_branch ort_101044
of_100886:
s_mov_b32 s55,12
buffer_load_dwordx4 v[24:27],v0,s[20:23],s96 offen offset:2048 sc1
buffer_load_dwordx4 v[28:31],v0,s[20:23],s96 offen offset:3072 sc1
s_waitcnt vmcnt(4)
v_max3_u32 v124,v32,v33,v34
v_max3_u32 v124,v124,v35,v36
v_max3_u32 v124,v124,v37,v38
v_max_u32 v124,v124,v39
v_cmp_eq_u32 vcc,-1,v124
s_cbranch_vccnz ost_101046
v_smfmac_f32_16x16x64_bf16 v[96:99],v[32:35],v[144:151],v1
buffer_load_dword v120,off,s[20:23],s96 sc1
v_smfmac_f32_16x16x64_bf16 v[100:103],v[32:35],v[152:159],v1
buffer_load_dword v120,off,s[20:23],s96 sc1
v_smfmac_f32_16x16x64_bf16 v[96:99],v[36:39],v[160:167],v1
v_smfmac_f32_16x16x64_bf16 v[100:103],v[36:39],v[168:175],v1
ort_101047:
s_waitcnt vmcnt(5)
v_max3_u32 v124,v40,v41,v42
v_max_u32 v124,v124,v43
v_cmp_eq_u32 vcc,-1,v124
s_cbranch_vccnz ost_101048
v_smfmac_f32_16x16x64_bf16 v[96:99],v[40:43],v[176:183],v1
buffer_load_dword v120,off,s[20:23],s96 sc1
v_smfmac_f32_16x16x64_bf16 v[100:103],v[40:43],v[184:191],v1
ort_101049:
s_waitcnt vmcnt(5)
v_max3_u32 v124,v44,v45,v46
v_max_u32 v124,v124,v47
v_cmp_eq_u32 vcc,-1,v124
s_cbranch_vccnz ost_101050
v_smfmac_f32_16x16x64_bf16 v[96:99],v[44:47],v[192:199],v1
buffer_load_dword v120,off,s[20:23],s96 sc1
v_smfmac_f32_16x16x64_bf16 v[100:103],v[44:47],v[200:207],v1
ort_101051:
s_waitcnt vmcnt(4)
v_max3_u32 v124,v24,v25,v26
v_max3_u32 v124,v124,v27,v28
v_max3_u32 v124,v124,v29,v30
v_max_u32 v124,v124,v31
v_cmp_eq_u32 vcc,-1,v124
s_cbranch_vccnz olap2_101036
s_andn2_b32 s55,s55,12
v_smfmac_f32_16x16x64_bf16 v[96:99],v[24:27],v[80:87],v1
v_smfmac_f32_16x16x64_bf16 v[100:103],v[24:27],v[88:95],v1
v_smfmac_f32_16x16x64_bf16 v[96:99],v[28:31],v[128:135],v1
v_smfmac_f32_16x16x64_bf16 v[100:103],v[28:31],v[136:143],v1
s_cbranch_scc0 oback_100896
s_branch olap2_101036
ost_101046:
buffer_load_dwordx4 v[32:35],v0,s[20:23],s97 offen offset:0 sc1
buffer_load_dwordx4 v[36:39],v0,s[20:23],s97 offen offset:1024 sc1
s_or_b32 s55,s55,48
s_branch ort_101047
ost_101048:
buffer_load_dwordx4 v[40:43],v0,s[20:23],s97 offen offset:2048 sc1
s_or_b32 s55,s55,64
s_branch ort_101049
ost_101050:
buffer_load_dwordx4 v[44:47],v0,s[20:23],s97 offen offset:3072 sc1
s_or_b32 s55,s55,128
s_branch ort_101051
of_100887:
s_mov_b32 s55,48
buffer_load_dwordx4 v[32:35],v0,s[20:23],s97 offen offset:0 sc1
buffer_load_dwordx4 v[36:39],v0,s[20:23],s97 offen offset:1024 sc1
s_waitcnt vmcnt(3)
v_max3_u32 v124,v40,v41,v42
v_max_u32 v124,v124,v43
v_cmp_eq_u32 vcc,-1,v124
s_cbranch_vccnz ost_101053
v_smfmac_f32_16x16x64_bf16 v[96:99],v[40:43],v[176:183],v1
buffer_load_dword v120,off,s[20:23],s96 sc1
v_smfmac_f32_16x16x64_bf16 v[100:103],v[40:43],v[184:191],v1
ort_101054:
s_waitcnt vmcnt(3)
v_max3_u32 v124,v44,v45,v46
v_max_u32 v124,v124,v47
v_cmp_eq_u32 vcc,-1,v124
s_cbranch_vccnz ost_101055
v_smfmac_f32_16x16x64_bf16 v[96:99],v[44:47],v[192:199],v1
buffer_load_dword v120,off,s[20:23],s96 sc1
v_smfmac_f32_16x16x64_bf16 v[100:103],v[44:47],v[200:207],v1
ort_101056:
s_waitcnt vmcnt(2)
v_max3_u32 v124,v32,v33,v34
v_max3_u32 v124,v124,v35,v36
v_max3_u32 v124,v124,v37,v38
v_max_u32 v124,v124,v39
v_cmp_eq_u32 vcc,-1,v124
s_cbranch_vccnz olap2_101036
s_andn2_b32 s55,s55,48
v_smfmac_f32_16x16x64_bf16 v[96:99],v[32:35],v[144:151],v1
v_smfmac_f32_16x16x64_bf16 v[100:103],v[32:35],v[152:159],v1
v_smfmac_f32_16x16x64_bf16 v[96:99],v[36:39],v[160:167],v1
v_smfmac_f32_16x16x64_bf16 v[100:103],v[36:39],v[168:175],v1
s_cbranch_scc0 oback_100896
s_branch olap2_101036
ost_101053:
buffer_load_dwordx4 v[40:43],v0,s[20:23],s97 offen offset:2048 sc1
s_or_b32 s55,s55,64
s_branch ort_101054
ost_101055:
buffer_load_dwordx4 v[44:47],v0,s[20:23],s97 offen offset:3072 sc1
s_or_b32 s55,s55,128
s_branch ort_101056
of_100888:
s_mov_b32 s55,64
buffer_load_dwordx4 v[40:43],v0,s[20:23],s97 offen offset:2048 sc1
s_waitcnt vmcnt(1)
v_max3_u32 v124,v44,v45,v46
v_max_u32 v124,v124,v47
v_cmp_eq_u32 vcc,-1,v124
s_cbranch_vccnz ost_101058
v_smfmac_f32_16x16x64_bf16 v[96:99],v[44:47],v[192:199],v1
buffer_load_dword v120,off,s[20:23],s96 sc1
v_smfmac_f32_16x16x64_bf16 v[100:103],v[44:47],v[200:207],v1
ort_101059:
s_waitcnt vmcnt(1)
v_max3_u32 v124,v40,v41,v42
v_max_u32 v124,v124,v43
v_cmp_eq_u32 vcc,-1,v124
s_cbranch_vccnz olap2_101036
s_andn2_b32 s55,s55,64
v_smfmac_f32_16x16x64_bf16 v[96:99],v[40:43],v[176:183],v1
v_smfmac_f32_16x16x64_bf16 v[100:103],v[40:43],v[184:191],v1
s_cbranch_scc0 oback_100896
s_branch olap2_101036
ost_101058:
buffer_load_dwordx4 v[44:47],v0,s[20:23],s97 offen offset:3072 sc1
s_or_b32 s55,s55,128
s_branch ort_101059
of_100889:
s_mov_b32 s55,128
s_branch oslow_100895
olap2_101036:
s_bitcmp1_b32 s55,0
s_cbranch_scc0 l2s_101061
s_waitcnt vmcnt(6)
v_max3_u32 v124,v16,v17,v18
v_max3_u32 v124,v124,v19,v20
v_max3_u32 v124,v124,v21,v22
v_max_u32 v124,v124,v23
v_cmp_eq_u32 vcc,-1,v124
s_cbranch_vccnz l2s_101061
s_andn2_b32 s55,s55,3
v_smfmac_f32_16x16x64_bf16 v[96:99],v[16:19],v[48:55],v1
v_smfmac_f32_16x16x64_bf16 v[100:103],v[16:19],v[56:63],v1
v_smfmac_f32_16x16x64_bf16 v[96:99],v[20:23],v[64:71],v1
v_smfmac_f32_16x16x64_bf16 v[100:103],v[20:23],v[72:79],v1
l2s_101061:
s_bitcmp1_b32 s55,2
s_cbranch_scc0 l2s_101062
s_waitcnt vmcnt(4)
v_max3_u32 v124,v24,v25,v26
v_max3_u32 v124,v124,v27,v28
v_max3_u32 v124,v124,v29,v30
v_max_u32 v124,v124,v31
v_cmp_eq_u32 vcc,-1,v124
s_cbranch_vccnz l2s_101062
s_andn2_b32 s55,s55,12
v_smfmac_f32_16x16x64_bf16 v[96:99],v[24:27],v[80:87],v1
v_smfmac_f32_16x16x64_bf16 v[100:103],v[24:27],v[88:95],v1
v_smfmac_f32_16x16x64_bf16 v[96:99],v[28:31],v[128:135],v1
v_smfmac_f32_16x16x64_bf16 v[100:103],v[28:31],v[136:143],v1
l2s_101062:
s_bitcmp1_b32 s55,4
s_cbranch_scc0 l2s_101063
s_waitcnt vmcnt(2)
v_max3_u32 v124,v32,v33,v34
v_max3_u32 v124,v124,v35,v36
v_max3_u32 v124,v124,v37,v38
v_max_u32 v124,v124,v39
v_cmp_eq_u32 vcc,-1,v124
s_cbranch_vccnz l2s_101063
s_andn2_b32 s55,s55,48
v_smfmac_f32_16x16x64_bf16 v[96:99],v[32:35],v[144:151],v1
v_smfmac_f32_16x16x64_bf16 v[100:103],v[32:35],v[152:159],v1
v_smfmac_f32_16x16x64_bf16 v[96:99],v[36:39],v[160:167],v1
v_smfmac_f32_16x16x64_bf16 v[100:103],v[36:39],v[168:175],v1
l2s_101063:
s_bitcmp1_b32 s55,6
s_cbranch_scc0 l2s_101064
s_waitcnt vmcnt(1)
v_max3_u32 v124,v40,v41,v42
v_max_u32 v124,v124,v43
v_cmp_eq_u32 vcc,-1,v124
s_cbranch_vccnz l2s_101064
s_andn2_b32 s55,s55,64
v_smfmac_f32_16x16x64_bf16 v[96:99],v[40:43],v[176:183],v1
v_smfmac_f32_16x16x64_bf16 v[100:103],v[40:43],v[184:191],v1
l2s_101064:
s_bitcmp1_b32 s55,7
s_cbranch_scc0 l2s_101065
s_waitcnt vmcnt(0)
v_max3_u32 v124,v44,v45,v46
v_max_u32 v124,v124,v47
v_cmp_eq_u32 vcc,-1,v124
s_cbranch_vccnz l2s_101065
s_andn2_b32 s55,s55,128
v_smfmac_f32_16x16x64_bf16 v[96:99],v[44:47],v[192:199],v1
v_smfmac_f32_16x16x64_bf16 v[100:103],v[44:47],v[200:207],v1
l2s_101065:
s_cmp_eq_u32 s55,0
s_cbranch_scc1 oback_100896
oslow_100895:
s_bitcmp1_b32 s55,0
s_cbranch_scc0 dsk_101066
buffer_load_dwordx4 v[16:19],v0,s[20:23],s96 offen offset:0 sc1
dsk_101066:
s_bitcmp1_b32 s55,1
s_cbranch_scc0 dsk_101067
buffer_load_dwordx4 v[20:23],v0,s[20:23],s96 offen offset:1024 sc1
dsk_101067:
s_bitcmp1_b32 s55,2
s_cbranch_scc0 dsk_101068
buffer_load_dwordx4 v[24:27],v0,s[20:23],s96 offen offset:2048 sc1
dsk_101068:
s_bitcmp1_b32 s55,3
s_cbranch_scc0 dsk_101069
buffer_load_dwordx4 v[28:31],v0,s[20:23],s96 offen offset:3072 sc1
dsk_101069:
s_bitcmp1_b32 s55,4
s_cbranch_scc0 dsk_101070
buffer_load_dwordx4 v[32:35],v0,s[20:23],s97 offen offset:0 sc1
dsk_101070:
s_bitcmp1_b32 s55,5
s_cbranch_scc0 dsk_101071
buffer_load_dwordx4 v[36:39],v0,s[20:23],s97 offen offset:1024 sc1
dsk_101071:
s_bitcmp1_b32 s55,6
s_cbranch_scc0 dsk_101072
buffer_load_dwordx4 v[40:43],v0,s[20:23],s97 offen offset:2048 sc1
dsk_101072:
s_bitcmp1_b32 s55,7
s_cbranch_scc0 dsk_101073
buffer_load_dwordx4 v[44:47],v0,s[20:23],s97 offen offset:3072 sc1
dsk_101073:
s_bitcmp1_b32 s55,0
s_cbranch_scc0 dsk_101074
s_waitcnt vmcnt(2)
v_max3_u32 v124,v16,v17,v18
v_max_u32 v124,v124,v19
v_cmp_eq_u32 vcc,-1,v124
s_cbranch_vccz dgo_101075
s_nop 15
buffer_load_dwordx4 v[116:119],v0,s[20:23],s96 offen offset:0 sc1
s_nop 15
buffer_load_dwordx4 v[120:123],v0,s[20:23],s96 offen offset:0 sc1
dlp_101076:
s_waitcnt vmcnt(2)
v_max3_u32 v124,v16,v17,v18
v_max_u32 v124,v124,v19
v_cmp_eq_u32 vcc,-1,v124
s_cbranch_vccz dgo_101075
buffer_load_dwordx4 v[16:19],v0,s[20:23],s96 offen offset:0 sc1
s_waitcnt vmcnt(2)
v_max3_u32 v124,v116,v117,v118
v_max_u32 v124,v124,v119
v_cmp_eq_u32 vcc,-1,v124
s_cbranch_vccz dcp_101078
buffer_load_dwordx4 v[116:119],v0,s[20:23],s96 offen offset:0 sc1
s_waitcnt vmcnt(2)
v_max3_u32 v124,v120,v121,v122
v_max_u32 v124,v124,v123
v_cmp_eq_u32 vcc,-1,v124
s_cbranch_vccz dcp_101079
buffer_load_dwordx4 v[120:123],v0,s[20:23],s96 offen offset:0 sc1
s_sub_u32 s90,s90,1
s_cmp_gt_i32 s90,0
s_cbranch_scc1 dlp_101076
s_branch dgo_101075
dcp_101078:
v_mov_b32 v16,v116
v_mov_b32 v17,v117
v_mov_b32 v18,v118
v_mov_b32 v19,v119
s_nop 1
s_branch dgo_101075
dcp_101079:
v_mov_b32 v16,v120
v_mov_b32 v17,v121
v_mov_b32 v18,v122
v_mov_b32 v19,v123
s_nop 1
dgo_101075:
v_smfmac_f32_16x16x64_bf16 v[96:99],v[16:19],v[48:55],v1
v_smfmac_f32_16x16x64_bf16 v[100:103],v[16:19],v[56:63],v1
dsk_101074:
s_bitcmp1_b32 s55,1
s_cbranch_scc0 dsk_101080
s_waitcnt vmcnt(2)
v_max3_u32 v124,v20,v21,v22
v_max_u32 v124,v124,v23
v_cmp_eq_u32 vcc,-1,v124
s_cbranch_vccz dgo_101081
s_nop 15
buffer_load_dwordx4 v[116:119],v0,s[20:23],s96 offen offset:1024 sc1
s_nop 15
buffer_load_dwordx4 v[120:123],v0,s[20:23],s96 offen offset:1024 sc1
dlp_101082:
s_waitcnt vmcnt(2)
v_max3_u32 v124,v20,v21,v22
v_max_u32 v124,v124,v23
v_cmp_eq_u32 vcc,-1,v124
s_cbranch_vccz dgo_101081
buffer_load_dwordx4 v[20:23],v0,s[20:23],s96 offen offset:1024 sc1
s_waitcnt vmcnt(2)
v_max3_u32 v124,v116,v117,v118
v_max_u32 v124,v124,v119
v_cmp_eq_u32 vcc,-1,v124
s_cbranch_vccz dcp_101084
buffer_load_dwordx4 v[116:119],v0,s[20:23],s96 offen offset:1024 sc1
s_waitcnt vmcnt(2)
v_max3_u32 v124,v120,v121,v122
v_max_u32 v124,v124,v123
v_cmp_eq_u32 vcc,-1,v124
s_cbranch_vccz dcp_101085
buffer_load_dwordx4 v[120:123],v0,s[20:23],s96 offen offset:1024 sc1
s_sub_u32 s90,s90,1
s_cmp_gt_i32 s90,0
s_cbranch_scc1 dlp_101082
s_branch dgo_101081
dcp_101084:
v_mov_b32 v20,v116
v_mov_b32 v21,v117
v_mov_b32 v22,v118
v_mov_b32 v23,v119
s_nop 1
s_branch dgo_101081
dcp_101085:
v_mov_b32 v20,v120
v_mov_b32 v21,v121
v_mov_b32 v22,v122
v_mov_b32 v23,v123
s_nop 1
dgo_101081:
v_smfmac_f32_16x16x64_bf16 v[96:99],v[20:23],v[64:71],v1
v_smfmac_f32_16x16x64_bf16 v[100:103],v[20:23],v[72:79],v1
dsk_101080:
s_bitcmp1_b32 s55,2
s_cbranch_scc0 dsk_101086
s_waitcnt vmcnt(2)
v_max3_u32 v124,v24,v25,v26
v_max_u32 v124,v124,v27
v_cmp_eq_u32 vcc,-1,v124
s_cbranch_vccz dgo_101087
s_nop 15
buffer_load_dwordx4 v[116:119],v0,s[20:23],s96 offen offset:2048 sc1
s_nop 15
buffer_load_dwordx4 v[120:123],v0,s[20:23],s96 offen offset:2048 sc1
dlp_101088:
s_waitcnt vmcnt(2)
v_max3_u32 v124,v24,v25,v26
v_max_u32 v124,v124,v27
v_cmp_eq_u32 vcc,-1,v124
s_cbranch_vccz dgo_101087
buffer_load_dwordx4 v[24:27],v0,s[20:23],s96 offen offset:2048 sc1
s_waitcnt vmcnt(2)
v_max3_u32 v124,v116,v117,v118
v_max_u32 v124,v124,v119
v_cmp_eq_u32 vcc,-1,v124
s_cbranch_vccz dcp_101090
buffer_load_dwordx4 v[116:119],v0,s[20:23],s96 offen offset:2048 sc1
s_waitcnt vmcnt(2)
v_max3_u32 v124,v120,v121,v122
v_max_u32 v124,v124,v123
v_cmp_eq_u32 vcc,-1,v124
s_cbranch_vccz dcp_101091
buffer_load_dwordx4 v[120:123],v0,s[20:23],s96 offen offset:2048 sc1
s_sub_u32 s90,s90,1
s_cmp_gt_i32 s90,0
s_cbranch_scc1 dlp_101088
s_branch dgo_101087
dcp_101090:
v_mov_b32 v24,v116
v_mov_b32 v25,v117
v_mov_b32 v26,v118
v_mov_b32 v27,v119
s_nop 1
s_branch dgo_101087
dcp_101091:
v_mov_b32 v24,v120
v_mov_b32 v25,v121
v_mov_b32 v26,v122
v_mov_b32 v27,v123
s_nop 1
dgo_101087:
v_smfmac_f32_16x16x64_bf16 v[96:99],v[24:27],v[80:87],v1
v_smfmac_f32_16x16x64_bf16 v[100:103],v[24:27],v[88:95],v1
dsk_101086:
s_bitcmp1_b32 s55,3
s_cbranch_scc0 dsk_101092
s_waitcnt vmcnt(2)
v_max3_u32 v124,v28,v29,v30
v_max_u32 v124,v124,v31
v_cmp_eq_u32 vcc,-1,v124
s_cbranch_vccz dgo_101093
s_nop 15
buffer_load_dwordx4 v[116:119],v0,s[20:23],s96 offen offset:3072 sc1
s_nop 15
buffer_load_dwordx4 v[120:123],v0,s[20:23],s96 offen offset:3072 sc1
dlp_101094:
s_waitcnt vmcnt(2)
v_max3_u32 v124,v28,v29,v30
v_max_u32 v124,v124,v31
v_cmp_eq_u32 vcc,-1,v124
s_cbranch_vccz dgo_101093
buffer_load_dwordx4 v[28:31],v0,s[20:23],s96 offen offset:3072 sc1
s_waitcnt vmcnt(2)
v_max3_u32 v124,v116,v117,v118
v_max_u32 v124,v124,v119
v_cmp_eq_u32 vcc,-1,v124
s_cbranch_vccz dcp_101096
buffer_load_dwordx4 v[116:119],v0,s[20:23],s96 offen offset:3072 sc1
s_waitcnt vmcnt(2)
v_max3_u32 v124,v120,v121,v122
v_max_u32 v124,v124,v123
v_cmp_eq_u32 vcc,-1,v124
s_cbranch_vccz dcp_101097
buffer_load_dwordx4 v[120:123],v0,s[20:23],s96 offen offset:3072 sc1
s_sub_u32 s90,s90,1
s_cmp_gt_i32 s90,0
s_cbranch_scc1 dlp_101094
s_branch dgo_101093
dcp_101096:
v_mov_b32 v28,v116
v_mov_b32 v29,v117
v_mov_b32 v30,v118
v_mov_b32 v31,v119
s_nop 1
s_branch dgo_101093
dcp_101097:
v_mov_b32 v28,v120
v_mov_b32 v29,v121
v_mov_b32 v30,v122
v_mov_b32 v31,v123
s_nop 1
dgo_101093:
v_smfmac_f32_16x16x64_bf16 v[96:99],v[28:31],v[128:135],v1
v_smfmac_f32_16x16x64_bf16 v[100:103],v[28:31],v[136:143],v1
dsk_101092:
s_bitcmp1_b32 s55,4
s_cbranch_scc0 dsk_101098
s_waitcnt vmcnt(2)
v_max3_u32 v124,v32,v33,v34
v_max_u32 v124,v124,v35
v_cmp_eq_u32 vcc,-1,v124
s_cbranch_vccz dgo_101099
s_nop 15
buffer_load_dwordx4 v[116:119],v0,s[20:23],s97 offen offset:0 sc1
s_nop 15
buffer_load_dwordx4 v[120:123],v0,s[20:23],s97 offen offset:0 sc1
dlp_101100:
s_waitcnt vmcnt(2)
v_max3_u32 v124,v32,v33,v34
v_max_u32 v124,v124,v35
v_cmp_eq_u32 vcc,-1,v124
s_cbranch_vccz dgo_101099
buffer_load_dwordx4 v[32:35],v0,s[20:23],s97 offen offset:0 sc1
s_waitcnt vmcnt(2)
v_max3_u32 v124,v116,v117,v118
v_max_u32 v124,v124,v119
v_cmp_eq_u32 vcc,-1,v124
s_cbranch_vccz dcp_101102
buffer_load_dwordx4 v[116:119],v0,s[20:23],s97 offen offset:0 sc1
s_waitcnt vmcnt(2)
v_max3_u32 v124,v120,v121,v122
v_max_u32 v124,v124,v123
v_cmp_eq_u32 vcc,-1,v124
s_cbranch_vccz dcp_101103
buffer_load_dwordx4 v[120:123],v0,s[20:23],s97 offen offset:0 sc1
s_sub_u32 s90,s90,1
s_cmp_gt_i32 s90,0
s_cbranch_scc1 dlp_101100
s_branch dgo_101099
dcp_101102:
v_mov_b32 v32,v116
v_mov_b32 v33,v117
v_mov_b32 v34,v118
v_mov_b32 v35,v119
s_nop 1
s_branch dgo_101099
dcp_101103:
v_mov_b32 v32,v120
v_mov_b32 v33,v121
v_mov_b32 v34,v122
v_mov_b32 v35,v123
s_nop 1
dgo_101099:
v_smfmac_f32_16x16x64_bf16 v[96:99],v[32:35],v[144:151],v1
v_smfmac_f32_16x16x64_bf16 v[100:103],v[32:35],v[152:159],v1
dsk_101098:
s_bitcmp1_b32 s55,5
s_cbranch_scc0 dsk_101104
s_waitcnt vmcnt(2)
v_max3_u32 v124,v36,v37,v38
v_max_u32 v124,v124,v39
v_cmp_eq_u32 vcc,-1,v124
s_cbranch_vccz dgo_101105
s_nop 15
buffer_load_dwordx4 v[116:119],v0,s[20:23],s97 offen offset:1024 sc1
s_nop 15
buffer_load_dwordx4 v[120:123],v0,s[20:23],s97 offen offset:1024 sc1
dlp_101106:
s_waitcnt vmcnt(2)
v_max3_u32 v124,v36,v37,v38
v_max_u32 v124,v124,v39
v_cmp_eq_u32 vcc,-1,v124
s_cbranch_vccz dgo_101105
buffer_load_dwordx4 v[36:39],v0,s[20:23],s97 offen offset:1024 sc1
s_waitcnt vmcnt(2)
v_max3_u32 v124,v116,v117,v118
v_max_u32 v124,v124,v119
v_cmp_eq_u32 vcc,-1,v124
s_cbranch_vccz dcp_101108
buffer_load_dwordx4 v[116:119],v0,s[20:23],s97 offen offset:1024 sc1
s_waitcnt vmcnt(2)
v_max3_u32 v124,v120,v121,v122
v_max_u32 v124,v124,v123
v_cmp_eq_u32 vcc,-1,v124
s_cbranch_vccz dcp_101109
buffer_load_dwordx4 v[120:123],v0,s[20:23],s97 offen offset:1024 sc1
s_sub_u32 s90,s90,1
s_cmp_gt_i32 s90,0
s_cbranch_scc1 dlp_101106
s_branch dgo_101105
dcp_101108:
v_mov_b32 v36,v116
v_mov_b32 v37,v117
v_mov_b32 v38,v118
v_mov_b32 v39,v119
s_nop 1
s_branch dgo_101105
dcp_101109:
v_mov_b32 v36,v120
v_mov_b32 v37,v121
v_mov_b32 v38,v122
v_mov_b32 v39,v123
s_nop 1
dgo_101105:
v_smfmac_f32_16x16x64_bf16 v[96:99],v[36:39],v[160:167],v1
v_smfmac_f32_16x16x64_bf16 v[100:103],v[36:39],v[168:175],v1
dsk_101104:
s_bitcmp1_b32 s55,6
s_cbranch_scc0 dsk_101110
s_waitcnt vmcnt(2)
v_max3_u32 v124,v40,v41,v42
v_max_u32 v124,v124,v43
v_cmp_eq_u32 vcc,-1,v124
s_cbranch_vccz dgo_101111
s_nop 15
buffer_load_dwordx4 v[116:119],v0,s[20:23],s97 offen offset:2048 sc1
s_nop 15
buffer_load_dwordx4 v[120:123],v0,s[20:23],s97 offen offset:2048 sc1
dlp_101112:
s_waitcnt vmcnt(2)
v_max3_u32 v124,v40,v41,v42
v_max_u32 v124,v124,v43
v_cmp_eq_u32 vcc,-1,v124
s_cbranch_vccz dgo_101111
buffer_load_dwordx4 v[40:43],v0,s[20:23],s97 offen offset:2048 sc1
s_waitcnt vmcnt(2)
v_max3_u32 v124,v116,v117,v118
v_max_u32 v124,v124,v119
v_cmp_eq_u32 vcc,-1,v124
s_cbranch_vccz dcp_101114
buffer_load_dwordx4 v[116:119],v0,s[20:23],s97 offen offset:2048 sc1
s_waitcnt vmcnt(2)
v_max3_u32 v124,v120,v121,v122
v_max_u32 v124,v124,v123
v_cmp_eq_u32 vcc,-1,v124
s_cbranch_vccz dcp_101115
buffer_load_dwordx4 v[120:123],v0,s[20:23],s97 offen offset:2048 sc1
s_sub_u32 s90,s90,1
s_cmp_gt_i32 s90,0
s_cbranch_scc1 dlp_101112
s_branch dgo_101111
dcp_101114:
v_mov_b32 v40,v116
v_mov_b32 v41,v117
v_mov_b32 v42,v118
v_mov_b32 v43,v119
s_nop 1
s_branch dgo_101111
dcp_101115:
v_mov_b32 v40,v120
v_mov_b32 v41,v121
v_mov_b32 v42,v122
v_mov_b32 v43,v123
s_nop 1
dgo_101111:
v_smfmac_f32_16x16x64_bf16 v[96:99],v[40:43],v[176:183],v1
v_smfmac_f32_16x16x64_bf16 v[100:103],v[40:43],v[184:191],v1
dsk_101110:
s_bitcmp1_b32 s55,7
s_cbranch_scc0 dsk_101116
s_waitcnt vmcnt(2)
v_max3_u32 v124,v44,v45,v46
v_max_u32 v124,v124,v47
v_cmp_eq_u32 vcc,-1,v124
s_cbranch_vccz dgo_101117
s_nop 15
buffer_load_dwordx4 v[116:119],v0,s[20:23],s97 offen offset:3072 sc1
s_nop 15
buffer_load_dwordx4 v[120:123],v0,s[20:23],s97 offen offset:3072 sc1
dlp_101118:
s_waitcnt vmcnt(2)
v_max3_u32 v124,v44,v45,v46
v_max_u32 v124,v124,v47
v_cmp_eq_u32 vcc,-1,v124
s_cbranch_vccz dgo_101117
buffer_load_dwordx4 v[44:47],v0,s[20:23],s97 offen offset:3072 sc1
s_waitcnt vmcnt(2)
v_max3_u32 v124,v116,v117,v118
v_max_u32 v124,v124,v119
v_cmp_eq_u32 vcc,-1,v124
s_cbranch_vccz dcp_101120
buffer_load_dwordx4 v[116:119],v0,s[20:23],s97 offen offset:3072 sc1
s_waitcnt vmcnt(2)
v_max3_u32 v124,v120,v121,v122
v_max_u32 v124,v124,v123
v_cmp_eq_u32 vcc,-1,v124
s_cbranch_vccz dcp_101121
buffer_load_dwordx4 v[120:123],v0,s[20:23],s97 offen offset:3072 sc1
s_sub_u32 s90,s90,1
s_cmp_gt_i32 s90,0
s_cbranch_scc1 dlp_101118
s_branch dgo_101117
dcp_101120:
v_mov_b32 v44,v116
v_mov_b32 v45,v117
v_mov_b32 v46,v118
v_mov_b32 v47,v119
s_nop 1
s_branch dgo_101117
dcp_101121:
v_mov_b32 v44,v120
v_mov_b32 v45,v121
v_mov_b32 v46,v122
v_mov_b32 v47,v123
s_nop 1
dgo_101117:
v_smfmac_f32_16x16x64_bf16 v[96:99],v[44:47],v[192:199],v1
v_smfmac_f32_16x16x64_bf16 v[100:103],v[44:47],v[200:207],v1
dsk_101116:
s_mov_b32 s55,0
s_branch oback_100896
fl_100913:
flb_100921:
buffer_load_dwordx4 v[16:19],v0,s[20:23],s92 offen offset:0 sc1
s_mov_b32 s55,1
buffer_load_dwordx4 v[32:35],v0,s[20:23],s93 offen offset:0 sc1
s_waitcnt vmcnt(4)
v_max3_u32 v124,v20,v21,v22
v_max_u32 v124,v124,v23
v_cmp_eq_u32 vcc,-1,v124
s_cbranch_vccnz dfl_101122
v_smfmac_f32_16x16x64_bf16 v[64:67],v[20:23],a[96:103],v1
buffer_load_dword v125,off,s[20:23],s92 sc1
buffer_load_dwordx4 v[36:39],v0,s[20:23],s93 offen offset:1024 sc1
s_waitcnt vmcnt(5)
v_max3_u32 v124,v24,v25,v26
v_smfmac_f32_16x16x64_bf16 v[68:71],v[20:23],a[104:111],v1
v_max_u32 v124,v124,v27
v_cmp_eq_u32 vcc,-1,v124
v_smfmac_f32_16x16x64_bf16 v[72:75],v[20:23],a[112:119],v1
v_smfmac_f32_16x16x64_bf16 v[76:79],v[20:23],a[120:127],v1
s_cbranch_vccnz dfl_101123
v_smfmac_f32_16x16x64_bf16 v[64:67],v[24:27],a[160:167],v1
buffer_load_dword v125,off,s[20:23],s92 sc1
buffer_load_dwordx4 v[40:43],v0,s[20:23],s93 offen offset:2048 sc1
buffer_load_dwordx4 v[44:47],v0,s[20:23],s93 offen offset:3072 sc1
s_waitcnt vmcnt(7)
v_max3_u32 v124,v28,v29,v30
v_smfmac_f32_16x16x64_bf16 v[68:71],v[24:27],a[168:175],v1
v_max_u32 v124,v124,v31
v_cmp_eq_u32 vcc,-1,v124
v_smfmac_f32_16x16x64_bf16 v[72:75],v[24:27],a[176:183],v1
v_smfmac_f32_16x16x64_bf16 v[76:79],v[24:27],a[184:191],v1
s_cbranch_vccnz dfl_101124
v_smfmac_f32_16x16x64_bf16 v[64:67],v[28:31],a[224:231],v1
buffer_load_dword v125,off,s[20:23],s92 sc1
buffer_store_dword v126,v121,s[20:23],s69 offen sc1
s_waitcnt vmcnt(8)
v_max3_u32 v124,v16,v17,v18
v_smfmac_f32_16x16x64_bf16 v[68:71],v[28:31],a[232:239],v1
v_max_u32 v124,v124,v19
v_cmp_eq_u32 vcc,-1,v124
v_smfmac_f32_16x16x64_bf16 v[72:75],v[28:31],a[240:247],v1
v_smfmac_f32_16x16x64_bf16 v[76:79],v[28:31],a[248:255],v1
s_cbranch_vccnz lfb_101129
s_mov_b32 s55,0
v_smfmac_f32_16x16x64_bf16 v[64:67],v[16:19],a[32:39],v1
s_waitcnt vmcnt(7)
v_max3_u32 v124,v32,v33,v34
v_max_u32 v124,v124,v35
v_cmp_eq_u32 vcc,-1,v124
v_smfmac_f32_16x16x64_bf16 v[68:71],v[16:19],a[40:47],v1
v_smfmac_f32_16x16x64_bf16 v[72:75],v[16:19],a[48:55],v1
v_smfmac_f32_16x16x64_bf16 v[76:79],v[16:19],a[56:63],v1
s_cbranch_vccnz flb_100925
s_branch segb_100909
fl_100914:
flb_100922:
buffer_load_dwordx4 v[20:23],v0,s[20:23],s92 offen offset:1024 sc1
s_mov_b32 s55,2
buffer_load_dwordx4 v[36:39],v0,s[20:23],s93 offen offset:1024 sc1
s_waitcnt vmcnt(5)
v_max3_u32 v124,v24,v25,v26
v_max_u32 v124,v124,v27
v_cmp_eq_u32 vcc,-1,v124
s_cbranch_vccnz dfl_101123
v_smfmac_f32_16x16x64_bf16 v[64:67],v[24:27],a[160:167],v1
buffer_load_dword v125,off,s[20:23],s92 sc1
buffer_load_dwordx4 v[40:43],v0,s[20:23],s93 offen offset:2048 sc1
buffer_load_dwordx4 v[44:47],v0,s[20:23],s93 offen offset:3072 sc1
s_waitcnt vmcnt(7)
v_max3_u32 v124,v28,v29,v30
v_smfmac_f32_16x16x64_bf16 v[68:71],v[24:27],a[168:175],v1
v_max_u32 v124,v124,v31
v_cmp_eq_u32 vcc,-1,v124
v_smfmac_f32_16x16x64_bf16 v[72:75],v[24:27],a[176:183],v1
v_smfmac_f32_16x16x64_bf16 v[76:79],v[24:27],a[184:191],v1
s_cbranch_vccnz dfl_101124
v_smfmac_f32_16x16x64_bf16 v[64:67],v[28:31],a[224:231],v1
buffer_load_dword v125,off,s[20:23],s92 sc1
buffer_store_dword v126,v121,s[20:23],s69 offen sc1
s_waitcnt vmcnt(6)
v_max3_u32 v124,v20,v21,v22
v_smfmac_f32_16x16x64_bf16 v[68:71],v[28:31],a[232:239],v1
v_max_u32 v124,v124,v23
v_cmp_eq_u32 vcc,-1,v124
v_smfmac_f32_16x16x64_bf16 v[72:75],v[28:31],a[240:247],v1
v_smfmac_f32_16x16x64_bf16 v[76:79],v[28:31],a[248:255],v1
s_cbranch_vccnz lfb_101129
s_mov_b32 s55,0
v_smfmac_f32_16x16x64_bf16 v[64:67],v[20:23],a[96:103],v1
s_waitcnt vmcnt(7)
v_max3_u32 v124,v32,v33,v34
v_max_u32 v124,v124,v35
v_cmp_eq_u32 vcc,-1,v124
v_smfmac_f32_16x16x64_bf16 v[68:71],v[20:23],a[104:111],v1
v_smfmac_f32_16x16x64_bf16 v[72:75],v[20:23],a[112:119],v1
v_smfmac_f32_16x16x64_bf16 v[76:79],v[20:23],a[120:127],v1
s_cbranch_vccnz flb_100925
s_branch segb_100909
fl_100915:
flb_100923:
buffer_load_dwordx4 v[24:27],v0,s[20:23],s92 offen offset:2048 sc1
s_mov_b32 s55,4
buffer_load_dwordx4 v[40:43],v0,s[20:23],s93 offen offset:2048 sc1
buffer_load_dwordx4 v[44:47],v0,s[20:23],s93 offen offset:3072 sc1
s_waitcnt vmcnt(7)
v_max3_u32 v124,v28,v29,v30
v_max_u32 v124,v124,v31
v_cmp_eq_u32 vcc,-1,v124
s_cbranch_vccnz dfl_101124
v_smfmac_f32_16x16x64_bf16 v[64:67],v[28:31],a[224:231],v1
buffer_load_dword v125,off,s[20:23],s92 sc1
buffer_store_dword v126,v121,s[20:23],s69 offen sc1
s_waitcnt vmcnt(4)
v_max3_u32 v124,v24,v25,v26
v_smfmac_f32_16x16x64_bf16 v[68:71],v[28:31],a[232:239],v1
v_max_u32 v124,v124,v27
v_cmp_eq_u32 vcc,-1,v124
v_smfmac_f32_16x16x64_bf16 v[72:75],v[28:31],a[240:247],v1
v_smfmac_f32_16x16x64_bf16 v[76:79],v[28:31],a[248:255],v1
s_cbranch_vccnz lfb_101129
s_mov_b32 s55,0
v_smfmac_f32_16x16x64_bf16 v[64:67],v[24:27],a[160:167],v1
s_waitcnt vmcnt(7)
v_max3_u32 v124,v32,v33,v34
v_max_u32 v124,v124,v35
v_cmp_eq_u32 vcc,-1,v124
v_smfmac_f32_16x16x64_bf16 v[68:71],v[24:27],a[168:175],v1
v_smfmac_f32_16x16x64_bf16 v[72:75],v[24:27],a[176:183],v1
v_smfmac_f32_16x16x64_bf16 v[76:79],v[24:27],a[184:191],v1
s_cbranch_vccnz flb_100925
s_branch segb_100909
fl_100916:
flb_100924:
buffer_load_dwordx4 v[28:31],v0,s[20:23],s92 offen offset:3072 sc1
s_mov_b32 s55,8
buffer_store_dword v126,v121,s[20:23],s69 offen sc1
s_waitcnt vmcnt(1)
v_max3_u32 v124,v28,v29,v30
v_max_u32 v124,v124,v31
v_cmp_eq_u32 vcc,-1,v124
s_cbranch_vccnz lfb_101129
s_mov_b32 s55,0
v_smfmac_f32_16x16x64_bf16 v[64:67],v[28:31],a[224:231],v1
s_waitcnt vmcnt(7)
v_max3_u32 v124,v32,v33,v34
v_max_u32 v124,v124,v35
v_cmp_eq_u32 vcc,-1,v124
v_smfmac_f32_16x16x64_bf16 v[68:71],v[28:31],a[232:239],v1
v_smfmac_f32_16x16x64_bf16 v[72:75],v[28:31],a[240:247],v1
v_smfmac_f32_16x16x64_bf16 v[76:79],v[28:31],a[248:255],v1
s_cbranch_vccnz flb_100925
s_branch segb_100909
fl_100917:
flb_100925:
buffer_load_dwordx4 v[32:35],v0,s[20:23],s93 offen offset:0 sc1
s_mov_b32 s55,240
s_bitcmp1_b32 s55,5
s_cbranch_scc0 rdn_101132
s_waitcnt vmcnt(6)
v_max3_u32 v124,v36,v37,v38
v_max_u32 v124,v124,v39
v_cmp_eq_u32 vcc,-1,v124
s_cbranch_vccnz rfa_101133
buffer_load_dword v125,off,s[20:23],s92 sc1
s_bitset0_b32 s55,5
v_smfmac_f32_16x16x64_bf16 v[64:67],v[36:39],a[96:103],v1
v_smfmac_f32_16x16x64_bf16 v[68:71],v[36:39],a[104:111],v1
v_smfmac_f32_16x16x64_bf16 v[72:75],v[36:39],a[112:119],v1
v_smfmac_f32_16x16x64_bf16 v[76:79],v[36:39],a[120:127],v1
s_cmp_eq_u32 s55,0
s_cbranch_scc1 segb_100911
s_branch rnx_101134
rdn_101132:
buffer_load_dword v125,off,s[20:23],s92 sc1
s_branch rnx_101134
rfa_101133:
buffer_load_dwordx4 v[36:39],v0,s[20:23],s93 offen offset:1024 sc1
rnx_101134:
s_bitcmp1_b32 s55,6
s_cbranch_scc0 rdn_101135
s_waitcnt vmcnt(5)
v_max3_u32 v124,v40,v41,v42
v_max_u32 v124,v124,v43
v_cmp_eq_u32 vcc,-1,v124
s_cbranch_vccnz rfa_101136
buffer_load_dword v125,off,s[20:23],s92 sc1
s_bitset0_b32 s55,6
s_cmp_eq_u32 s55,0
s_cbranch_scc1 segb_100911
s_branch rnx_101137
rdn_101135:
buffer_load_dword v125,off,s[20:23],s92 sc1
s_branch rnx_101137
rfa_101136:
buffer_load_dwordx4 v[40:43],v0,s[20:23],s93 offen offset:2048 sc1
rnx_101137:
s_bitcmp1_b32 s55,7
s_cbranch_scc0 rdn_101138
s_waitcnt vmcnt(5)
v_max3_u32 v124,v44,v45,v46
v_max_u32 v124,v124,v47
v_cmp_eq_u32 vcc,-1,v124
s_cbranch_vccnz rfa_101139
buffer_load_dword v125,off,s[20:23],s92 sc1
s_bitset0_b32 s55,7
s_cmp_eq_u32 s55,0
s_cbranch_scc1 segb_100911
s_branch rnx_101140
rdn_101138:
buffer_load_dword v125,off,s[20:23],s92 sc1
s_branch rnx_101140
rfa_101139:
buffer_load_dwordx4 v[44:47],v0,s[20:23],s93 offen offset:3072 sc1
rnx_101140:
rot_101131:
s_bitcmp1_b32 s55,4
s_cbranch_scc0 rdn_101141
s_waitcnt vmcnt(3)
v_max3_u32 v124,v32,v33,v34
v_max_u32 v124,v124,v35
v_cmp_eq_u32 vcc,-1,v124
s_cbranch_vccnz rfa_101142
buffer_load_dword v125,off,s[20:23],s92 sc1
s_bitset0_b32 s55,4
v_smfmac_f32_16x16x64_bf16 v[64:67],v[32:35],a[32:39],v1
v_smfmac_f32_16x16x64_bf16 v[68:71],v[32:35],a[40:47],v1
v_smfmac_f32_16x16x64_bf16 v[72:75],v[32:35],a[48:55],v1
v_smfmac_f32_16x16x64_bf16 v[76:79],v[32:35],a[56:63],v1
s_cmp_eq_u32 s55,0
s_cbranch_scc1 segb_100911
s_branch rnx_101143
rdn_101141:
buffer_load_dword v125,off,s[20:23],s92 sc1
s_branch rnx_101143
rfa_101142:
buffer_load_dwordx4 v[32:35],v0,s[20:23],s93 offen offset:0 sc1
rnx_101143:
s_bitcmp1_b32 s55,5
s_cbranch_scc0 rdn_101144
s_waitcnt vmcnt(3)
v_max3_u32 v124,v36,v37,v38
v_max_u32 v124,v124,v39
v_cmp_eq_u32 vcc,-1,v124
s_cbranch_vccnz rfa_101145
buffer_load_dword v125,off,s[20:23],s92 sc1
s_bitset0_b32 s55,5
v_smfmac_f32_16x16x64_bf16 v[64:67],v[36:39],a[96:103],v1
v_smfmac_f32_16x16x64_bf16 v[68:71],v[36:39],a[104:111],v1
v_smfmac_f32_16x16x64_bf16 v[72:75],v[36:39],a[112:119],v1
v_smfmac_f32_16x16x64_bf16 v[76:79],v[36:39],a[120:127],v1
s_cmp_eq_u32 s55,0
s_cbranch_scc1 segb_100911
s_branch rnx_101146
rdn_101144:
buffer_load_dword v125,off,s[20:23],s92 sc1
s_branch rnx_101146
rfa_101145:
buffer_load_dwordx4 v[36:39],v0,s[20:23],s93 offen offset:1024 sc1
rnx_101146:
s_bitcmp1_b32 s55,6
s_cbranch_scc0 rdn_101147
s_waitcnt vmcnt(3)
v_max3_u32 v124,v40,v41,v42
v_max_u32 v124,v124,v43
v_cmp_eq_u32 vcc,-1,v124
s_cbranch_vccnz rfa_101148
buffer_load_dword v125,off,s[20:23],s92 sc1
s_bitset0_b32 s55,6
s_cmp_eq_u32 s55,0
s_cbranch_scc1 segb_100911
s_branch rnx_101149
rdn_101147:
buffer_load_dword v125,off,s[20:23],s92 sc1
s_branch rnx_101149
rfa_101148:
buffer_load_dwordx4 v[40:43],v0,s[20:23],s93 offen offset:2048 sc1
rnx_101149:
s_bitcmp1_b32 s55,7
s_cbranch_scc0 rdn_101150
s_waitcnt vmcnt(3)
v_max3_u32 v124,v44,v45,v46
v_max_u32 v124,v124,v47
v_cmp_eq_u32 vcc,-1,v124
s_cbranch_vccnz rfa_101151
buffer_load_dword v125,off,s[20:23],s92 sc1
s_bitset0_b32 s55,7
s_cmp_eq_u32 s55,0
s_cbranch_scc1 segb_100911
s_branch rnx_101152
rdn_101150:
buffer_load_dword v125,off,s[20:23],s92 sc1
s_branch rnx_101152
rfa_101151:
buffer_load_dwordx4 v[44:47],v0,s[20:23],s93 offen offset:3072 sc1
rnx_101152:
s_sub_u32 s90,s90,1
s_cmp_gt_i32 s90,0
s_cbranch_scc1 rot_101131
s_mov_b32 s55,0
s_branch segb_100911
fl_100918:
flb_100926:
buffer_load_dwordx4 v[36:39],v0,s[20:23],s93 offen offset:1024 sc1
s_mov_b32 s55,224
s_bitcmp1_b32 s55,6
s_cbranch_scc0 rdn_101154
s_waitcnt vmcnt(5)
v_max3_u32 v124,v40,v41,v42
v_max_u32 v124,v124,v43
v_cmp_eq_u32 vcc,-1,v124
s_cbranch_vccnz rfa_101155
buffer_load_dword v125,off,s[20:23],s92 sc1
s_bitset0_b32 s55,6
s_cmp_eq_u32 s55,0
s_cbranch_scc1 segb_100911
s_branch rnx_101156
rdn_101154:
buffer_load_dword v125,off,s[20:23],s92 sc1
s_branch rnx_101156
rfa_101155:
buffer_load_dwordx4 v[40:43],v0,s[20:23],s93 offen offset:2048 sc1
rnx_101156:
s_bitcmp1_b32 s55,7
s_cbranch_scc0 rdn_101157
s_waitcnt vmcnt(5)
v_max3_u32 v124,v44,v45,v46
v_max_u32 v124,v124,v47
v_cmp_eq_u32 vcc,-1,v124
s_cbranch_vccnz rfa_101158
buffer_load_dword v125,off,s[20:23],s92 sc1
s_bitset0_b32 s55,7
s_cmp_eq_u32 s55,0
s_cbranch_scc1 segb_100911
s_branch rnx_101159
rdn_101157:
buffer_load_dword v125,off,s[20:23],s92 sc1
s_branch rnx_101159
rfa_101158:
buffer_load_dwordx4 v[44:47],v0,s[20:23],s93 offen offset:3072 sc1
rnx_101159:
rot_101153:
s_bitcmp1_b32 s55,5
s_cbranch_scc0 rdn_101160
s_waitcnt vmcnt(2)
v_max3_u32 v124,v36,v37,v38
v_max_u32 v124,v124,v39
v_cmp_eq_u32 vcc,-1,v124
s_cbranch_vccnz rfa_101161
buffer_load_dword v125,off,s[20:23],s92 sc1
s_bitset0_b32 s55,5
v_smfmac_f32_16x16x64_bf16 v[64:67],v[36:39],a[96:103],v1
v_smfmac_f32_16x16x64_bf16 v[68:71],v[36:39],a[104:111],v1
v_smfmac_f32_16x16x64_bf16 v[72:75],v[36:39],a[112:119],v1
v_smfmac_f32_16x16x64_bf16 v[76:79],v[36:39],a[120:127],v1
s_cmp_eq_u32 s55,0
s_cbranch_scc1 segb_100911
s_branch rnx_101162
rdn_101160:
buffer_load_dword v125,off,s[20:23],s92 sc1
s_branch rnx_101162
rfa_101161:
buffer_load_dwordx4 v[36:39],v0,s[20:23],s93 offen offset:1024 sc1
rnx_101162:
s_bitcmp1_b32 s55,6
s_cbranch_scc0 rdn_101163
s_waitcnt vmcnt(2)
v_max3_u32 v124,v40,v41,v42
v_max_u32 v124,v124,v43
v_cmp_eq_u32 vcc,-1,v124
s_cbranch_vccnz rfa_101164
buffer_load_dword v125,off,s[20:23],s92 sc1
s_bitset0_b32 s55,6
s_cmp_eq_u32 s55,0
s_cbranch_scc1 segb_100911
s_branch rnx_101165
rdn_101163:
buffer_load_dword v125,off,s[20:23],s92 sc1
s_branch rnx_101165
rfa_101164:
buffer_load_dwordx4 v[40:43],v0,s[20:23],s93 offen offset:2048 sc1
rnx_101165:
s_bitcmp1_b32 s55,7
s_cbranch_scc0 rdn_101166
s_waitcnt vmcnt(2)
v_max3_u32 v124,v44,v45,v46
v_max_u32 v124,v124,v47
v_cmp_eq_u32 vcc,-1,v124
s_cbranch_vccnz rfa_101167
buffer_load_dword v125,off,s[20:23],s92 sc1
s_bitset0_b32 s55,7
s_cmp_eq_u32 s55,0
s_cbranch_scc1 segb_100911
s_branch rnx_101168
rdn_101166:
buffer_load_dword v125,off,s[20:23],s92 sc1
s_branch rnx_101168
rfa_101167:
buffer_load_dwordx4 v[44:47],v0,s[20:23],s93 offen offset:3072 sc1
rnx_101168:
s_sub_u32 s90,s90,1
s_cmp_gt_i32 s90,0
s_cbranch_scc1 rot_101153
s_mov_b32 s55,0
s_branch segb_100911
fl_100919:
flb_100927:
s_mov_b32 s55,192
s_bitcmp1_b32 s55,6
s_cbranch_scc0 rdn_101170
s_waitcnt vmcnt(5)
v_max3_u32 v124,v40,v41,v42
v_max_u32 v124,v124,v43
v_cmp_eq_u32 vcc,-1,v124
s_cbranch_vccnz rfa_101171
buffer_load_dword v125,off,s[20:23],s92 sc1
s_bitset0_b32 s55,6
s_cmp_eq_u32 s55,0
s_cbranch_scc1 segb_100911
s_branch rnx_101172
rdn_101170:
buffer_load_dword v125,off,s[20:23],s92 sc1
s_branch rnx_101172
rfa_101171:
buffer_load_dwordx4 v[40:43],v0,s[20:23],s93 offen offset:2048 sc1
rnx_101172:
s_bitcmp1_b32 s55,7
s_cbranch_scc0 rdn_101173
s_waitcnt vmcnt(5)
v_max3_u32 v124,v44,v45,v46
v_max_u32 v124,v124,v47
v_cmp_eq_u32 vcc,-1,v124
s_cbranch_vccnz rfa_101174
buffer_load_dword v125,off,s[20:23],s92 sc1
s_bitset0_b32 s55,7
s_cmp_eq_u32 s55,0
s_cbranch_scc1 segb_100911
s_branch rnx_101175
rdn_101173:
buffer_load_dword v125,off,s[20:23],s92 sc1
s_branch rnx_101175
rfa_101174:
buffer_load_dwordx4 v[44:47],v0,s[20:23],s93 offen offset:3072 sc1
rnx_101175:
rot_101169:
s_bitcmp1_b32 s55,6
s_cbranch_scc0 rdn_101176
s_waitcnt vmcnt(1)
v_max3_u32 v124,v40,v41,v42
v_max_u32 v124,v124,v43
v_cmp_eq_u32 vcc,-1,v124
s_cbranch_vccnz rfa_101177
buffer_load_dword v125,off,s[20:23],s92 sc1
s_bitset0_b32 s55,6
s_cmp_eq_u32 s55,0
s_cbranch_scc1 segb_100911
s_branch rnx_101178
rdn_101176:
buffer_load_dword v125,off,s[20:23],s92 sc1
s_branch rnx_101178
rfa_101177:
buffer_load_dwordx4 v[40:43],v0,s[20:23],s93 offen offset:2048 sc1
rnx_101178:
s_bitcmp1_b32 s55,7
s_cbranch_scc0 rdn_101179
s_waitcnt vmcnt(1)
v_max3_u32 v124,v44,v45,v46
v_max_u32 v124,v124,v47
v_cmp_eq_u32 vcc,-1,v124
s_cbranch_vccnz rfa_101180
buffer_load_dword v125,off,s[20:23],s92 sc1
s_bitset0_b32 s55,7
s_cmp_eq_u32 s55,0
s_cbranch_scc1 segb_100911
s_branch rnx_101181
rdn_101179:
buffer_load_dword v125,off,s[20:23],s92 sc1
s_branch rnx_101181
rfa_101180:
buffer_load_dwordx4 v[44:47],v0,s[20:23],s93 offen offset:3072 sc1
rnx_101181:
s_sub_u32 s90,s90,1
s_cmp_gt_i32 s90,0
s_cbranch_scc1 rot_101169
s_mov_b32 s55,0
s_branch segb_100911
dfl_101122:
buffer_load_dwordx4 v[20:23],v0,s[20:23],s92 offen offset:1024 sc1
s_bitset1_b32 s55,1
buffer_load_dwordx4 v[36:39],v0,s[20:23],s93 offen offset:1024 sc1
s_waitcnt vmcnt(5)
v_max3_u32 v124,v24,v25,v26
v_max_u32 v124,v124,v27
v_cmp_eq_u32 vcc,-1,v124
s_cbranch_vccnz dfl_101123
s_branch dseg_101126
dfl_101123:
buffer_load_dwordx4 v[24:27],v0,s[20:23],s92 offen offset:2048 sc1
s_bitset1_b32 s55,2
buffer_load_dwordx4 v[40:43],v0,s[20:23],s93 offen offset:2048 sc1
buffer_load_dwordx4 v[44:47],v0,s[20:23],s93 offen offset:3072 sc1
s_waitcnt vmcnt(7)
v_max3_u32 v124,v28,v29,v30
v_max_u32 v124,v124,v31
v_cmp_eq_u32 vcc,-1,v124
s_cbranch_vccnz dfl_101124
s_branch dseg_101127
dfl_101124:
buffer_load_dwordx4 v[28:31],v0,s[20:23],s92 offen offset:3072 sc1
s_bitset1_b32 s55,3
buffer_store_dword v126,v121,s[20:23],s69 offen sc1
s_branch lap2_101128
dseg_101126:
v_smfmac_f32_16x16x64_bf16 v[64:67],v[24:27],a[160:167],v1
buffer_load_dword v125,off,s[20:23],s92 sc1
buffer_load_dwordx4 v[40:43],v0,s[20:23],s93 offen offset:2048 sc1
buffer_load_dwordx4 v[44:47],v0,s[20:23],s93 offen offset:3072 sc1
s_waitcnt vmcnt(7)
v_max3_u32 v124,v28,v29,v30
v_smfmac_f32_16x16x64_bf16 v[68:71],v[24:27],a[168:175],v1
v_max_u32 v124,v124,v31
v_cmp_eq_u32 vcc,-1,v124
v_smfmac_f32_16x16x64_bf16 v[72:75],v[24:27],a[176:183],v1
v_smfmac_f32_16x16x64_bf16 v[76:79],v[24:27],a[184:191],v1
s_cbranch_vccnz dfl_101124
dseg_101127:
v_smfmac_f32_16x16x64_bf16 v[64:67],v[28:31],a[224:231],v1
buffer_load_dword v125,off,s[20:23],s92 sc1
v_smfmac_f32_16x16x64_bf16 v[68:71],v[28:31],a[232:239],v1
buffer_store_dword v126,v121,s[20:23],s69 offen sc1
v_smfmac_f32_16x16x64_bf16 v[72:75],v[28:31],a[240:247],v1
v_smfmac_f32_16x16x64_bf16 v[76:79],v[28:31],a[248:255],v1
lap2_101128:
s_bitcmp1_b32 s55,0
s_cbranch_scc0 l2s_101182
s_waitcnt vmcnt(8)
v_max3_u32 v124,v16,v17,v18
v_max_u32 v124,v124,v19
v_cmp_eq_u32 vcc,-1,v124
s_cbranch_vccnz l2s_101182
s_bitset0_b32 s55,0
v_smfmac_f32_16x16x64_bf16 v[64:67],v[16:19],a[32:39],v1
v_smfmac_f32_16x16x64_bf16 v[68:71],v[16:19],a[40:47],v1
v_smfmac_f32_16x16x64_bf16 v[72:75],v[16:19],a[48:55],v1
v_smfmac_f32_16x16x64_bf16 v[76:79],v[16:19],a[56:63],v1
l2s_101182:
s_bitcmp1_b32 s55,1
s_cbranch_scc0 l2s_101184
s_waitcnt vmcnt(6)
v_max3_u32 v124,v20,v21,v22
v_max_u32 v124,v124,v23
v_cmp_eq_u32 vcc,-1,v124
s_cbranch_vccnz l2s_101184
s_bitset0_b32 s55,1
v_smfmac_f32_16x16x64_bf16 v[64:67],v[20:23],a[96:103],v1
v_smfmac_f32_16x16x64_bf16 v[68:71],v[20:23],a[104:111],v1
v_smfmac_f32_16x16x64_bf16 v[72:75],v[20:23],a[112:119],v1
v_smfmac_f32_16x16x64_bf16 v[76:79],v[20:23],a[120:127],v1
l2s_101184:
s_bitcmp1_b32 s55,2
s_cbranch_scc0 l2s_101186
s_waitcnt vmcnt(4)
v_max3_u32 v124,v24,v25,v26
v_max_u32 v124,v124,v27
v_cmp_eq_u32 vcc,-1,v124
s_cbranch_vccnz l2s_101186
s_bitset0_b32 s55,2
v_smfmac_f32_16x16x64_bf16 v[64:67],v[24:27],a[160:167],v1
v_smfmac_f32_16x16x64_bf16 v[68:71],v[24:27],a[168:175],v1
v_smfmac_f32_16x16x64_bf16 v[72:75],v[24:27],a[176:183],v1
v_smfmac_f32_16x16x64_bf16 v[76:79],v[24:27],a[184:191],v1
l2s_101186:
s_bitcmp1_b32 s55,3
s_cbranch_scc0 l2s_101188
s_waitcnt vmcnt(1)
v_max3_u32 v124,v28,v29,v30
v_max_u32 v124,v124,v31
v_cmp_eq_u32 vcc,-1,v124
s_cbranch_vccnz l2s_101188
s_bitset0_b32 s55,3
v_smfmac_f32_16x16x64_bf16 v[64:67],v[28:31],a[224:231],v1
v_smfmac_f32_16x16x64_bf16 v[68:71],v[28:31],a[232:239],v1
v_smfmac_f32_16x16x64_bf16 v[72:75],v[28:31],a[240:247],v1
v_smfmac_f32_16x16x64_bf16 v[76:79],v[28:31],a[248:255],v1
l2s_101188:
s_cmp_eq_u32 s55,0
s_cbranch_scc0 lfb_101129
Ldone_101130:
s_waitcnt vmcnt(7)
v_max3_u32 v124,v32,v33,v34
v_max_u32 v124,v124,v35
v_cmp_eq_u32 vcc,-1,v124
s_cbranch_vccnz flb_100925
s_branch segb_100909
lfb_101129:
s_bitcmp1_b32 s55,0
s_cbranch_scc0 dsk_101190
buffer_load_dwordx4 v[16:19],v0,s[20:23],s92 offen offset:0 sc1
dsk_101190:
s_bitcmp1_b32 s55,1
s_cbranch_scc0 dsk_101191
buffer_load_dwordx4 v[20:23],v0,s[20:23],s92 offen offset:1024 sc1
dsk_101191:
s_bitcmp1_b32 s55,2
s_cbranch_scc0 dsk_101192
buffer_load_dwordx4 v[24:27],v0,s[20:23],s92 offen offset:2048 sc1
dsk_101192:
s_bitcmp1_b32 s55,3
s_cbranch_scc0 dsk_101193
buffer_load_dwordx4 v[28:31],v0,s[20:23],s92 offen offset:3072 sc1
dsk_101193:
s_bitcmp1_b32 s55,0
s_cbranch_scc0 dsk_101194
s_waitcnt vmcnt(2)
v_max3_u32 v124,v16,v17,v18
v_max_u32 v124,v124,v19
v_cmp_eq_u32 vcc,-1,v124
s_cbranch_vccz dgo_101195
s_nop 15
buffer_load_dwordx4 v[104:107],v0,s[20:23],s92 offen offset:0 sc1
s_nop 15
buffer_load_dwordx4 v[108:111],v0,s[20:23],s92 offen offset:0 sc1
dlp_101196:
s_waitcnt vmcnt(2)
v_max3_u32 v124,v16,v17,v18
v_max_u32 v124,v124,v19
v_cmp_eq_u32 vcc,-1,v124
s_cbranch_vccz dgo_101195
buffer_load_dwordx4 v[16:19],v0,s[20:23],s92 offen offset:0 sc1
s_waitcnt vmcnt(2)
v_max3_u32 v124,v104,v105,v106
v_max_u32 v124,v124,v107
v_cmp_eq_u32 vcc,-1,v124
s_cbranch_vccz dcp_101198
buffer_load_dwordx4 v[104:107],v0,s[20:23],s92 offen offset:0 sc1
s_waitcnt vmcnt(2)
v_max3_u32 v124,v108,v109,v110
v_max_u32 v124,v124,v111
v_cmp_eq_u32 vcc,-1,v124
s_cbranch_vccz dcp_101199
buffer_load_dwordx4 v[108:111],v0,s[20:23],s92 offen offset:0 sc1
s_sub_u32 s90,s90,1
s_cmp_gt_i32 s90,0
s_cbranch_scc1 dlp_101196
s_branch dgo_101195
dcp_101198:
v_mov_b32 v16,v104
v_mov_b32 v17,v105
v_mov_b32 v18,v106
v_mov_b32 v19,v107
s_nop 1
s_branch dgo_101195
dcp_101199:
v_mov_b32 v16,v108
v_mov_b32 v17,v109
v_mov_b32 v18,v110
v_mov_b32 v19,v111
s_nop 1
dgo_101195:
v_smfmac_f32_16x16x64_bf16 v[64:67],v[16:19],a[32:39],v1
v_smfmac_f32_16x16x64_bf16 v[68:71],v[16:19],a[40:47],v1
v_smfmac_f32_16x16x64_bf16 v[72:75],v[16:19],a[48:55],v1
v_smfmac_f32_16x16x64_bf16 v[76:79],v[16:19],a[56:63],v1
dsk_101194:
s_bitcmp1_b32 s55,1
s_cbranch_scc0 dsk_101200
s_waitcnt vmcnt(2)
v_max3_u32 v124,v20,v21,v22
v_max_u32 v124,v124,v23
v_cmp_eq_u32 vcc,-1,v124
s_cbranch_vccz dgo_101201
s_nop 15
buffer_load_dwordx4 v[104:107],v0,s[20:23],s92 offen offset:1024 sc1
s_nop 15
buffer_load_dwordx4 v[108:111],v0,s[20:23],s92 offen offset:1024 sc1
dlp_101202:
s_waitcnt vmcnt(2)
v_max3_u32 v124,v20,v21,v22
v_max_u32 v124,v124,v23
v_cmp_eq_u32 vcc,-1,v124
s_cbranch_vccz dgo_101201
buffer_load_dwordx4 v[20:23],v0,s[20:23],s92 offen offset:1024 sc1
s_waitcnt vmcnt(2)
v_max3_u32 v124,v104,v105,v106
v_max_u32 v124,v124,v107
v_cmp_eq_u32 vcc,-1,v124
s_cbranch_vccz dcp_101204
buffer_load_dwordx4 v[104:107],v0,s[20:23],s92 offen offset:1024 sc1
s_waitcnt vmcnt(2)
v_max3_u32 v124,v108,v109,v110
v_max_u32 v124,v124,v111
v_cmp_eq_u32 vcc,-1,v124
s_cbranch_vccz dcp_101205
buffer_load_dwordx4 v[108:111],v0,s[20:23],s92 offen offset:1024 sc1
s_sub_u32 s90,s90,1
s_cmp_gt_i32 s90,0
s_cbranch_scc1 dlp_101202
s_branch dgo_101201
dcp_101204:
v_mov_b32 v20,v104
v_mov_b32 v21,v105
v_mov_b32 v22,v106
v_mov_b32 v23,v107
s_nop 1
s_branch dgo_101201
dcp_101205:
v_mov_b32 v20,v108
v_mov_b32 v21,v109
v_mov_b32 v22,v110
v_mov_b32 v23,v111
s_nop 1
dgo_101201:
v_smfmac_f32_16x16x64_bf16 v[64:67],v[20:23],a[96:103],v1
v_smfmac_f32_16x16x64_bf16 v[68:71],v[20:23],a[104:111],v1
v_smfmac_f32_16x16x64_bf16 v[72:75],v[20:23],a[112:119],v1
v_smfmac_f32_16x16x64_bf16 v[76:79],v[20:23],a[120:127],v1
dsk_101200:
s_bitcmp1_b32 s55,2
s_cbranch_scc0 dsk_101206
s_waitcnt vmcnt(2)
v_max3_u32 v124,v24,v25,v26
v_max_u32 v124,v124,v27
v_cmp_eq_u32 vcc,-1,v124
s_cbranch_vccz dgo_101207
s_nop 15
buffer_load_dwordx4 v[104:107],v0,s[20:23],s92 offen offset:2048 sc1
s_nop 15
buffer_load_dwordx4 v[108:111],v0,s[20:23],s92 offen offset:2048 sc1
dlp_101208:
s_waitcnt vmcnt(2)
v_max3_u32 v124,v24,v25,v26
v_max_u32 v124,v124,v27
v_cmp_eq_u32 vcc,-1,v124
s_cbranch_vccz dgo_101207
buffer_load_dwordx4 v[24:27],v0,s[20:23],s92 offen offset:2048 sc1
s_waitcnt vmcnt(2)
v_max3_u32 v124,v104,v105,v106
v_max_u32 v124,v124,v107
v_cmp_eq_u32 vcc,-1,v124
s_cbranch_vccz dcp_101210
buffer_load_dwordx4 v[104:107],v0,s[20:23],s92 offen offset:2048 sc1
s_waitcnt vmcnt(2)
v_max3_u32 v124,v108,v109,v110
v_max_u32 v124,v124,v111
v_cmp_eq_u32 vcc,-1,v124
s_cbranch_vccz dcp_101211
buffer_load_dwordx4 v[108:111],v0,s[20:23],s92 offen offset:2048 sc1
s_sub_u32 s90,s90,1
s_cmp_gt_i32 s90,0
s_cbranch_scc1 dlp_101208
s_branch dgo_101207
dcp_101210:
v_mov_b32 v24,v104
v_mov_b32 v25,v105
v_mov_b32 v26,v106
v_mov_b32 v27,v107
s_nop 1
s_branch dgo_101207
dcp_101211:
v_mov_b32 v24,v108
v_mov_b32 v25,v109
v_mov_b32 v26,v110
v_mov_b32 v27,v111
s_nop 1
dgo_101207:
v_smfmac_f32_16x16x64_bf16 v[64:67],v[24:27],a[160:167],v1
v_smfmac_f32_16x16x64_bf16 v[68:71],v[24:27],a[168:175],v1
v_smfmac_f32_16x16x64_bf16 v[72:75],v[24:27],a[176:183],v1
v_smfmac_f32_16x16x64_bf16 v[76:79],v[24:27],a[184:191],v1
dsk_101206:
s_bitcmp1_b32 s55,3
s_cbranch_scc0 dsk_101212
s_waitcnt vmcnt(2)
v_max3_u32 v124,v28,v29,v30
v_max_u32 v124,v124,v31
v_cmp_eq_u32 vcc,-1,v124
s_cbranch_vccz dgo_101213
s_nop 15
buffer_load_dwordx4 v[104:107],v0,s[20:23],s92 offen offset:3072 sc1
s_nop 15
buffer_load_dwordx4 v[108:111],v0,s[20:23],s92 offen offset:3072 sc1
dlp_101214:
s_waitcnt vmcnt(2)
v_max3_u32 v124,v28,v29,v30
v_max_u32 v124,v124,v31
v_cmp_eq_u32 vcc,-1,v124
s_cbranch_vccz dgo_101213
buffer_load_dwordx4 v[28:31],v0,s[20:23],s92 offen offset:3072 sc1
s_waitcnt vmcnt(2)
v_max3_u32 v124,v104,v105,v106
v_max_u32 v124,v124,v107
v_cmp_eq_u32 vcc,-1,v124
s_cbranch_vccz dcp_101216
buffer_load_dwordx4 v[104:107],v0,s[20:23],s92 offen offset:3072 sc1
s_waitcnt vmcnt(2)
v_max3_u32 v124,v108,v109,v110
v_max_u32 v124,v124,v111
v_cmp_eq_u32 vcc,-1,v124
s_cbranch_vccz dcp_101217
buffer_load_dwordx4 v[108:111],v0,s[20:23],s92 offen offset:3072 sc1
s_sub_u32 s90,s90,1
s_cmp_gt_i32 s90,0
s_cbranch_scc1 dlp_101214
s_branch dgo_101213
dcp_101216:
v_mov_b32 v28,v104
v_mov_b32 v29,v105
v_mov_b32 v30,v106
v_mov_b32 v31,v107
s_nop 1
s_branch dgo_101213
dcp_101217:
v_mov_b32 v28,v108
v_mov_b32 v29,v109
v_mov_b32 v30,v110
v_mov_b32 v31,v111
s_nop 1
dgo_101213:
v_smfmac_f32_16x16x64_bf16 v[64:67],v[28:31],a[224:231],v1
v_smfmac_f32_16x16x64_bf16 v[68:71],v[28:31],a[232:239],v1
v_smfmac_f32_16x16x64_bf16 v[72:75],v[28:31],a[240:247],v1
v_smfmac_f32_16x16x64_bf16 v[76:79],v[28:31],a[248:255],v1
dsk_101212:
s_mov_b32 s55,0
s_branch Ldone_101130
slowA_100929:
buffer_load_dwordx4 v[44:47],v0,s[20:23],s93 offen offset:3072 sc1
dsk_101218:
s_bitcmp1_b32 s55,7
s_cbranch_scc0 dsk_101219
s_waitcnt vmcnt(2)
v_max3_u32 v124,v44,v45,v46
v_max_u32 v124,v124,v47
v_cmp_eq_u32 vcc,-1,v124
s_cbranch_vccz dgo_101220
s_nop 15
s_nop 3
buffer_load_dwordx4 v[104:107],v0,s[20:23],s93 offen offset:3072 sc1
s_nop 15
s_nop 3
buffer_load_dwordx4 v[108:111],v0,s[20:23],s93 offen offset:3072 sc1
dlp_101221:
s_waitcnt vmcnt(2)
v_max3_u32 v124,v44,v45,v46
v_max_u32 v124,v124,v47
v_cmp_eq_u32 vcc,-1,v124
s_cbranch_vccz dgo_101220
buffer_load_dwordx4 v[44:47],v0,s[20:23],s93 offen offset:3072 sc1
s_waitcnt vmcnt(2)
v_max3_u32 v124,v104,v105,v106
v_max_u32 v124,v124,v107
v_cmp_eq_u32 vcc,-1,v124
s_cbranch_vccz dcp_101223
buffer_load_dwordx4 v[104:107],v0,s[20:23],s93 offen offset:3072 sc1
s_waitcnt vmcnt(2)
v_max3_u32 v124,v108,v109,v110
v_max_u32 v124,v124,v111
v_cmp_eq_u32 vcc,-1,v124
s_cbranch_vccz dcp_101224
buffer_load_dwordx4 v[108:111],v0,s[20:23],s93 offen offset:3072 sc1
s_sub_u32 s90,s90,1
s_cmp_gt_i32 s90,0
s_cbranch_scc1 dlp_101221
s_branch dgo_101220
dcp_101223:
v_mov_b32 v44,v104
v_mov_b32 v45,v105
v_mov_b32 v46,v106
v_mov_b32 v47,v107
s_nop 1
s_branch dgo_101220
dcp_101224:
v_mov_b32 v44,v108
v_mov_b32 v45,v109
v_mov_b32 v46,v110
v_mov_b32 v47,v111
s_nop 1
dgo_101220:
dsk_101219:
s_mov_b32 s55,0
s_branch segb_100911
recfin_100430:
s_endpgm
.section .rodata,"a"
.p2align 6
.amdhsa_kernel flow_kernel
  .amdhsa_next_free_vgpr 512
  .amdhsa_next_free_sgpr 102
  .amdhsa_accum_offset 256
  .amdhsa_group_segment_fixed_size 0
  .amdhsa_kernarg_size 136
  .amdhsa_user_sgpr_count 2
  .amdhsa_user_sgpr_kernarg_segment_ptr 1
  .amdhsa_system_sgpr_workgroup_id_x 1
.end_amdhsa_kernel
```
